```python
import torch

def _softmax(x, axis=-1):
    return torch.softmax(x, dim=axis)

def _gelu(x):
    return torch.nn.functional.gelu(x, approximate='tanh')

def _silu(x):
    return torch.nn.functional.silu(x)

def _sigmoid(x):
    return torch.sigmoid(x)

def _layernorm(x, axis=-1, eps=1e-05):
    m = x.mean(dim=axis, keepdim=True)
    v = x.var(dim=axis, keepdim=True, unbiased=False)
    return (x - m) / torch.sqrt(v + eps)

def _scatter_add(tgt, idx, src, axis=0):
    return tgt.clone().index_add_(axis, idx, src)

def _segment_sum(src, seg, n):
    out = torch.zeros((n,) + src.shape[1:], dtype=src.dtype)
    return out.index_add_(0, seg, src)

def _pad(x, pw):
    flat = tuple((v for pair in reversed(pw) for v in pair))
    return torch.nn.functional.pad(x, flat)
kernel_name = 'interleave_layers__spectral_gfnet__memory_aug_recurrent_mem_tr__prompt'

def setup_inputs():

    _w = lambda a: (lambda t: t.to(torch.bfloat16) if t.is_floating_point() else t)(torch.as_tensor(a))

    def _A_setup():
        B, S, D = (1, 2048, 640)
        Df = D // 2 + 1
        return {'x': _w((lambda *s: torch.randn(*s, dtype=torch.bfloat16) * 0.05)(B, S, D)), 'w_r': _w((lambda *s: torch.randn(*s, dtype=torch.bfloat16) * 0.4)(S, Df) * 0.02), 'w_i': _w((lambda *s: torch.randn(*s, dtype=torch.bfloat16) * 0.4)(S, Df) * 0.02)}
    _A_in = _A_setup()

    def _B_setup():
        B, S, Dm = (1, 2048, 640)
        H, Dh = (32, 128)
        M, seg = (8, 32)
        seg = min(seg, S)
        S = S // seg * seg
        return {'x': _w((lambda *s: torch.randn(*s, dtype=torch.bfloat16) * 0.05)(B, S, Dm)), 'mem0': _w((lambda *s: torch.randn(*s, dtype=torch.bfloat16) * 0.2)(B, M, Dm)), 'Wq': _w((lambda *s: torch.randn(*s, dtype=torch.bfloat16) * 1.6)(Dm, H, Dh) * Dm ** (-0.5)), 'Wk': _w((lambda *s: torch.randn(*s, dtype=torch.bfloat16) * 1.6)(Dm, H, Dh) * Dm ** (-0.5)), 'Wv': _w((lambda *s: torch.randn(*s, dtype=torch.bfloat16) * 0.2)(Dm, H, Dh) * Dm ** (-0.5)), 'Wo': _w((lambda *s: torch.randn(*s, dtype=torch.bfloat16) * 0.2)(H, Dh, Dm) * (H * Dh) ** (-0.5)), 'seg_len': seg}
    _B_in = _B_setup()
    return {'A_x': _A_in['x'], 'A_w_r': _A_in['w_r'], 'A_w_i': _A_in['w_i'], 'B_x': _B_in['x'], 'B_mem0': _B_in['mem0'], 'B_Wq': _B_in['Wq'], 'B_Wk': _B_in['Wk'], 'B_Wv': _B_in['Wv'], 'B_Wo': _B_in['Wo'], 'B_seg_len': _B_in['seg_len']}

def reference(A_x, A_w_r, A_w_i, B_x, B_mem0, B_Wq, B_Wk, B_Wv, B_Wo, B_seg_len):

    def _A_ref(x, w_r, w_i):
        B, S, D = x.shape
        X = (lambda x, axes=(-2, -1): torch.fft.rfft2(x.float(), dim=axes))(x, axes=(-2, -1))
        W = w_r + 1j * w_i
        X = X * W
        y = (lambda x, s, axes=(-2, -1): torch.fft.irfft2(x, s=s, dim=axes).to(torch.bfloat16))(X, (S, D), axes=(-2, -1))
        return y

    def _B_ref(x, mem0, Wq, Wk, Wv, Wo, seg_len):
        B, S, Dm = x.shape
        H, Dh = (Wq.shape[1], Wq.shape[2])
        M = mem0.shape[1]
        scale = Dh ** (-0.5)
        n_seg = S // seg_len
        L = M + seg_len
        idx = torch.arange(L)
        mask = (idx[:, None] < M) | (idx[:, None] >= idx[None, :])
        mem = mem0
        outs = []
        for s in range(n_seg):
            xs = x[:, s * seg_len:(s + 1) * seg_len, :].clone()
            h = torch.concatenate([mem, xs], axis=1)
            q = torch.einsum('btd,dhe->bhte', h, Wq)
            k = torch.einsum('btd,dhe->bhte', h, Wk)
            v = torch.einsum('btd,dhe->bhte', h, Wv)
            scores = torch.einsum('bhqe,bhke->bhqk', q, k) * scale
            scores = torch.where(mask[None, None], scores, -1000000000.0)
            p = _softmax(scores, axis=-1)
            o = torch.einsum('bhqk,bhke->bhqe', p, v)
            o = torch.einsum('bhte,hed->btd', o, Wo)
            mem = o[:, :M, :].clone()
            outs.append(o[:, M:, :])
        return torch.concatenate(outs, axis=1)
    x = A_x
    x = x + _A_ref(_layernorm(x, axis=-1), A_w_r, A_w_i)
    x = x + _B_ref(_layernorm(x, axis=-1), B_mem0, B_Wq, B_Wk, B_Wv, B_Wo, B_seg_len)
    x = x + _A_ref(_layernorm(x, axis=-1), A_w_r, A_w_i)
    x = x + _B_ref(_layernorm(x, axis=-1), B_mem0, B_Wq, B_Wk, B_Wv, B_Wo, B_seg_len)
    return x
```

```asm
; @launch grid=(256,1,1) block=(256,1,1) lds=163840
.amdgcn_target "amdgcn-amd-amdhsa--gfx950"
.text
.globl interleave_layers__spectral_gfnet__memory_aug_recurrent_mem_tr__prompt_kernel
.p2align 8
.type interleave_layers__spectral_gfnet__memory_aug_recurrent_mem_tr__prompt_kernel,@function
interleave_layers__spectral_gfnet__memory_aug_recurrent_mem_tr__prompt_kernel:
s_cmp_ge_u32 s2, 256
s_cbranch_scc1 L_end
s_load_dwordx2 s[4:5], s[0:1], 96
s_load_dwordx2 s[8:9], s[0:1], 88
s_mov_b32 s6, 268435456
s_mov_b32 s7, 0x20000
s_mov_b32 s10, 256
s_mov_b32 s11, 0x20000
s_getreg_b32 s12, hwreg(HW_REG_XCC_ID, 0, 3)
v_lshrrev_b32 v1, 6, v0
s_nop 0
v_readfirstlane_b32 s13, v1
s_waitcnt lgkmcnt(0)
s_cmp_lg_u32 s13, 0
s_cbranch_scc1 reg_2
v_lshlrev_b32 v1, 2, v0
s_lshl_b32 s15, s2, 8
v_mov_b32 v2, 0
buffer_store_dword v2, v1, s[4:7], s15 offen sc1
s_waitcnt vmcnt(0)
s_lshl_b32 s15, s12, 2
v_mov_b32 v2, 1
s_mov_b64 exec, 1
buffer_atomic_add v2, off, s[8:11], s15 sc0
s_mov_b64 exec, -1
v_and_b32 v1, 7, v0
v_lshlrev_b32 v1, 2, v1
s_mov_b32 s16, 0
reg_1:
buffer_load_dword v3, v1, s[8:11], 0 offen sc1
s_add_u32 s16, s16, 1
s_cmp_gt_u32 s16, 262144
s_cbranch_scc1 L_fail
s_waitcnt vmcnt(0)
v_add_u32_dpp v4, v3, v3 quad_perm:[1,0,3,2] row_mask:0xf bank_mask:0xf
s_nop 1
v_add_u32_dpp v4, v4, v4 quad_perm:[2,3,0,1] row_mask:0xf bank_mask:0xf
s_nop 1
v_add_u32_dpp v4, v4, v4 row_ror:4 row_mask:0xf bank_mask:0xf
v_cmp_ne_u32 vcc, 0x100, v4
s_cbranch_vccnz reg_1
v_readfirstlane_b32 s17, v2
v_readlane_b32 s20, v3, 0
v_readlane_b32 s21, v3, 1
v_readlane_b32 s22, v3, 2
v_readlane_b32 s23, v3, 3
v_readlane_b32 s24, v3, 4
v_readlane_b32 s25, v3, 5
v_readlane_b32 s26, v3, 6
v_readlane_b32 s27, v3, 7
s_mov_b32 s15, 7
s_cmp_ge_u32 s26, 32
s_cselect_b32 s15, 6, s15
s_cmp_ge_u32 s25, 32
s_cselect_b32 s15, 5, s15
s_cmp_ge_u32 s24, 32
s_cselect_b32 s15, 4, s15
s_cmp_ge_u32 s23, 32
s_cselect_b32 s15, 3, s15
s_cmp_ge_u32 s22, 32
s_cselect_b32 s15, 2, s15
s_cmp_ge_u32 s21, 32
s_cselect_b32 s15, 1, s15
s_cmp_ge_u32 s20, 32
s_cselect_b32 s15, 0, s15
s_mov_b32 s16, s17
s_cmp_gt_u32 s12, 0
s_cselect_b32 s18, s20, 0
s_add_u32 s16, s16, s18
s_cmp_gt_u32 s12, 1
s_cselect_b32 s18, s21, 0
s_add_u32 s16, s16, s18
s_cmp_gt_u32 s12, 2
s_cselect_b32 s18, s22, 0
s_add_u32 s16, s16, s18
s_cmp_gt_u32 s12, 3
s_cselect_b32 s18, s23, 0
s_add_u32 s16, s16, s18
s_cmp_gt_u32 s12, 4
s_cselect_b32 s18, s24, 0
s_add_u32 s16, s16, s18
s_cmp_gt_u32 s12, 5
s_cselect_b32 s18, s25, 0
s_add_u32 s16, s16, s18
s_cmp_gt_u32 s12, 6
s_cselect_b32 s18, s26, 0
s_add_u32 s16, s16, s18
s_add_u32 s18, s16, 32
s_cmp_lt_u32 s12, s15
s_cselect_b32 s16, s18, s16
s_cmp_eq_u32 s12, s15
s_cselect_b32 s18, s17, 32
s_cmp_lt_u32 s18, 32
s_cselect_b32 s16, s18, s16
v_mov_b32 v1, 0
v_mov_b32 v2, s16
ds_write_b32 v1, v2
s_waitcnt lgkmcnt(0)
reg_2:
s_barrier
v_mov_b32 v1, 0
ds_read_b32 v2, v1
s_waitcnt lgkmcnt(0)
v_readfirstlane_b32 s14, v2
s_barrier
s_cmp_lt_u32 s14, 32
s_cbranch_scc1 L_chain
s_sub_u32 s15, s14, 32
v_and_b32 v0, 63, v0
v_lshlrev_b32 v0, 4, v0
s_mov_b32 s24, 0x3f803f80
s_mul_i32 s31, s13, 10240
s_mov_b32 s22, s6
s_mov_b32 s23, 0
s_mov_b32 s16, 0
s_cmp_ge_u32 s15, 64
s_cbranch_scc1 roleA_4
s_and_b32 s32, s15, 31
s_cmp_ge_u32 s15, 32
s_cbranch_scc1 roleV_3
s_lshl_b32 s26, s32, 8
s_lshl_b32 s18, s13, 6
s_add_u32 s26, s26, s18
s_load_dwordx2 s[36:37], s[0:1], 48
s_mov_b32 s38, 5242880
s_mov_b32 s39, 0x20000
s_waitcnt lgkmcnt(0)
v_lshrrev_b32 v32, 6, v0
v_mul_u32_u24 v32, 8192, v32
v_and_b32 v33, 48, v0
v_add_u32 v30, v32, v33
v_bfe_u32 v32, v0, 6, 2
v_lshrrev_b32 v33, 9, v0
v_lshl_add_u32 v32, v33, 3, v32
v_lshlrev_b32 v31, 6, v32
v_and_b32 v32, 16, v0
v_add_u32 v31, v31, v32
v_bfe_u32 v32, v0, 5, 1
v_lshl_add_u32 v31, v32, 3, v31
v_bfe_u32 v32, v0, 8, 1
v_lshl_add_u32 v31, v32, 5, v31
s_mul_i32 s18, s13, 36864
v_add_u32 v31, s18, v31
s_barrier
s_add_u32 m0, s18, 0
s_add_u32 s19, s26, 0
buffer_load_dwordx4 v30, s[36:39], s19 offen lds
s_add_u32 m0, s18, 1024
s_add_u32 s19, s26, 131072
buffer_load_dwordx4 v30, s[36:39], s19 offen lds
s_add_u32 m0, s18, 2048
s_add_u32 s19, s26, 262144
buffer_load_dwordx4 v30, s[36:39], s19 offen lds
s_add_u32 m0, s18, 3072
s_add_u32 s19, s26, 393216
buffer_load_dwordx4 v30, s[36:39], s19 offen lds
s_add_u32 m0, s18, 4096
s_add_u32 s19, s26, 524288
buffer_load_dwordx4 v30, s[36:39], s19 offen lds
s_add_u32 m0, s18, 5120
s_add_u32 s19, s26, 655360
buffer_load_dwordx4 v30, s[36:39], s19 offen lds
s_add_u32 m0, s18, 6144
s_add_u32 s19, s26, 786432
buffer_load_dwordx4 v30, s[36:39], s19 offen lds
s_add_u32 m0, s18, 7168
s_add_u32 s19, s26, 917504
buffer_load_dwordx4 v30, s[36:39], s19 offen lds
s_add_u32 m0, s18, 8192
s_add_u32 s19, s26, 1048576
buffer_load_dwordx4 v30, s[36:39], s19 offen lds
s_add_u32 m0, s18, 9216
s_add_u32 s19, s26, 1179648
buffer_load_dwordx4 v30, s[36:39], s19 offen lds
s_add_u32 m0, s18, 10240
s_add_u32 s19, s26, 1310720
buffer_load_dwordx4 v30, s[36:39], s19 offen lds
s_add_u32 m0, s18, 11264
s_add_u32 s19, s26, 1441792
buffer_load_dwordx4 v30, s[36:39], s19 offen lds
s_add_u32 m0, s18, 12288
s_add_u32 s19, s26, 1572864
buffer_load_dwordx4 v30, s[36:39], s19 offen lds
s_add_u32 m0, s18, 13312
s_add_u32 s19, s26, 1703936
buffer_load_dwordx4 v30, s[36:39], s19 offen lds
s_add_u32 m0, s18, 14336
s_add_u32 s19, s26, 1835008
buffer_load_dwordx4 v30, s[36:39], s19 offen lds
s_add_u32 m0, s18, 15360
s_add_u32 s19, s26, 1966080
buffer_load_dwordx4 v30, s[36:39], s19 offen lds
s_add_u32 m0, s18, 16384
s_add_u32 s19, s26, 2097152
buffer_load_dwordx4 v30, s[36:39], s19 offen lds
s_add_u32 m0, s18, 17408
s_add_u32 s19, s26, 2228224
buffer_load_dwordx4 v30, s[36:39], s19 offen lds
s_add_u32 m0, s18, 18432
s_add_u32 s19, s26, 2359296
buffer_load_dwordx4 v30, s[36:39], s19 offen lds
s_add_u32 m0, s18, 19456
s_add_u32 s19, s26, 2490368
buffer_load_dwordx4 v30, s[36:39], s19 offen lds
s_add_u32 m0, s18, 20480
s_add_u32 s19, s26, 2621440
buffer_load_dwordx4 v30, s[36:39], s19 offen lds
s_add_u32 m0, s18, 21504
s_add_u32 s19, s26, 2752512
buffer_load_dwordx4 v30, s[36:39], s19 offen lds
s_add_u32 m0, s18, 22528
s_add_u32 s19, s26, 2883584
buffer_load_dwordx4 v30, s[36:39], s19 offen lds
s_add_u32 m0, s18, 23552
s_add_u32 s19, s26, 3014656
buffer_load_dwordx4 v30, s[36:39], s19 offen lds
s_add_u32 m0, s18, 24576
s_add_u32 s19, s26, 3145728
buffer_load_dwordx4 v30, s[36:39], s19 offen lds
s_add_u32 m0, s18, 25600
s_add_u32 s19, s26, 3276800
buffer_load_dwordx4 v30, s[36:39], s19 offen lds
s_add_u32 m0, s18, 26624
s_add_u32 s19, s26, 3407872
buffer_load_dwordx4 v30, s[36:39], s19 offen lds
s_add_u32 m0, s18, 27648
s_add_u32 s19, s26, 3538944
buffer_load_dwordx4 v30, s[36:39], s19 offen lds
s_add_u32 m0, s18, 28672
s_add_u32 s19, s26, 3670016
buffer_load_dwordx4 v30, s[36:39], s19 offen lds
s_add_u32 m0, s18, 29696
s_add_u32 s19, s26, 3801088
buffer_load_dwordx4 v30, s[36:39], s19 offen lds
s_add_u32 m0, s18, 30720
s_add_u32 s19, s26, 3932160
buffer_load_dwordx4 v30, s[36:39], s19 offen lds
s_add_u32 m0, s18, 31744
s_add_u32 s19, s26, 4063232
buffer_load_dwordx4 v30, s[36:39], s19 offen lds
s_add_u32 m0, s18, 32768
s_add_u32 s19, s26, 4194304
buffer_load_dwordx4 v30, s[36:39], s19 offen lds
s_add_u32 m0, s18, 33792
s_add_u32 s19, s26, 4325376
buffer_load_dwordx4 v30, s[36:39], s19 offen lds
s_add_u32 m0, s18, 34816
s_add_u32 s19, s26, 4456448
buffer_load_dwordx4 v30, s[36:39], s19 offen lds
s_add_u32 m0, s18, 35840
s_add_u32 s19, s26, 4587520
buffer_load_dwordx4 v30, s[36:39], s19 offen lds
s_waitcnt vmcnt(32)
ds_read_b64_tr_b16 a[0:1], v31 offset:0
ds_read_b64_tr_b16 a[2:3], v31 offset:256
ds_read_b64_tr_b16 a[4:5], v31 offset:1024
ds_read_b64_tr_b16 a[6:7], v31 offset:1280
ds_read_b64_tr_b16 a[8:9], v31 offset:2048
ds_read_b64_tr_b16 a[10:11], v31 offset:2304
ds_read_b64_tr_b16 a[12:13], v31 offset:3072
ds_read_b64_tr_b16 a[14:15], v31 offset:3328
s_waitcnt lgkmcnt(0)
s_add_u32 m0, s18, 0
s_add_u32 s19, s26, 4718592
buffer_load_dwordx4 v30, s[36:39], s19 offen lds
s_add_u32 m0, s18, 1024
s_add_u32 s19, s26, 4849664
buffer_load_dwordx4 v30, s[36:39], s19 offen lds
s_add_u32 m0, s18, 2048
s_add_u32 s19, s26, 4980736
buffer_load_dwordx4 v30, s[36:39], s19 offen lds
s_add_u32 m0, s18, 3072
s_add_u32 s19, s26, 5111808
buffer_load_dwordx4 v30, s[36:39], s19 offen lds
s_waitcnt vmcnt(32)
ds_read_b64_tr_b16 a[16:17], v31 offset:4096
ds_read_b64_tr_b16 a[18:19], v31 offset:4352
ds_read_b64_tr_b16 a[20:21], v31 offset:5120
ds_read_b64_tr_b16 a[22:23], v31 offset:5376
ds_read_b64_tr_b16 a[24:25], v31 offset:6144
ds_read_b64_tr_b16 a[26:27], v31 offset:6400
ds_read_b64_tr_b16 a[28:29], v31 offset:7168
ds_read_b64_tr_b16 a[30:31], v31 offset:7424
s_waitcnt vmcnt(28)
ds_read_b64_tr_b16 a[32:33], v31 offset:8192
ds_read_b64_tr_b16 a[34:35], v31 offset:8448
ds_read_b64_tr_b16 a[36:37], v31 offset:9216
ds_read_b64_tr_b16 a[38:39], v31 offset:9472
ds_read_b64_tr_b16 a[40:41], v31 offset:10240
ds_read_b64_tr_b16 a[42:43], v31 offset:10496
ds_read_b64_tr_b16 a[44:45], v31 offset:11264
ds_read_b64_tr_b16 a[46:47], v31 offset:11520
s_waitcnt vmcnt(24)
ds_read_b64_tr_b16 a[48:49], v31 offset:12288
ds_read_b64_tr_b16 a[50:51], v31 offset:12544
ds_read_b64_tr_b16 a[52:53], v31 offset:13312
ds_read_b64_tr_b16 a[54:55], v31 offset:13568
ds_read_b64_tr_b16 a[56:57], v31 offset:14336
ds_read_b64_tr_b16 a[58:59], v31 offset:14592
ds_read_b64_tr_b16 a[60:61], v31 offset:15360
ds_read_b64_tr_b16 a[62:63], v31 offset:15616
s_waitcnt vmcnt(20)
ds_read_b64_tr_b16 a[64:65], v31 offset:16384
ds_read_b64_tr_b16 a[66:67], v31 offset:16640
ds_read_b64_tr_b16 a[68:69], v31 offset:17408
ds_read_b64_tr_b16 a[70:71], v31 offset:17664
ds_read_b64_tr_b16 a[72:73], v31 offset:18432
ds_read_b64_tr_b16 a[74:75], v31 offset:18688
ds_read_b64_tr_b16 a[76:77], v31 offset:19456
ds_read_b64_tr_b16 a[78:79], v31 offset:19712
s_waitcnt vmcnt(16)
ds_read_b64_tr_b16 a[80:81], v31 offset:20480
ds_read_b64_tr_b16 a[82:83], v31 offset:20736
ds_read_b64_tr_b16 a[84:85], v31 offset:21504
ds_read_b64_tr_b16 a[86:87], v31 offset:21760
ds_read_b64_tr_b16 a[88:89], v31 offset:22528
ds_read_b64_tr_b16 a[90:91], v31 offset:22784
ds_read_b64_tr_b16 a[92:93], v31 offset:23552
ds_read_b64_tr_b16 a[94:95], v31 offset:23808
s_waitcnt vmcnt(12)
ds_read_b64_tr_b16 a[96:97], v31 offset:24576
ds_read_b64_tr_b16 a[98:99], v31 offset:24832
ds_read_b64_tr_b16 a[100:101], v31 offset:25600
ds_read_b64_tr_b16 a[102:103], v31 offset:25856
ds_read_b64_tr_b16 a[104:105], v31 offset:26624
ds_read_b64_tr_b16 a[106:107], v31 offset:26880
ds_read_b64_tr_b16 a[108:109], v31 offset:27648
ds_read_b64_tr_b16 a[110:111], v31 offset:27904
s_waitcnt vmcnt(8)
ds_read_b64_tr_b16 a[112:113], v31 offset:28672
ds_read_b64_tr_b16 a[114:115], v31 offset:28928
ds_read_b64_tr_b16 a[116:117], v31 offset:29696
ds_read_b64_tr_b16 a[118:119], v31 offset:29952
ds_read_b64_tr_b16 a[120:121], v31 offset:30720
ds_read_b64_tr_b16 a[122:123], v31 offset:30976
ds_read_b64_tr_b16 a[124:125], v31 offset:31744
ds_read_b64_tr_b16 a[126:127], v31 offset:32000
s_waitcnt vmcnt(4)
ds_read_b64_tr_b16 a[128:129], v31 offset:32768
ds_read_b64_tr_b16 a[130:131], v31 offset:33024
ds_read_b64_tr_b16 a[132:133], v31 offset:33792
ds_read_b64_tr_b16 a[134:135], v31 offset:34048
ds_read_b64_tr_b16 a[136:137], v31 offset:34816
ds_read_b64_tr_b16 a[138:139], v31 offset:35072
ds_read_b64_tr_b16 a[140:141], v31 offset:35840
ds_read_b64_tr_b16 a[142:143], v31 offset:36096
s_waitcnt vmcnt(0)
ds_read_b64_tr_b16 a[144:145], v31 offset:0
ds_read_b64_tr_b16 a[146:147], v31 offset:256
ds_read_b64_tr_b16 a[148:149], v31 offset:1024
ds_read_b64_tr_b16 a[150:151], v31 offset:1280
ds_read_b64_tr_b16 a[152:153], v31 offset:2048
ds_read_b64_tr_b16 a[154:155], v31 offset:2304
ds_read_b64_tr_b16 a[156:157], v31 offset:3072
ds_read_b64_tr_b16 a[158:159], v31 offset:3328
s_waitcnt lgkmcnt(0)
s_barrier
v_mov_b32 v32, s24
v_mov_b32 v33, s24
v_mov_b32 v34, s24
v_mov_b32 v35, s24
s_nop 1
v_mfma_f32_32x32x16_bf16 v[36:51], a[0:3], v[32:35], 0
v_mfma_f32_32x32x16_bf16 v[36:51], a[4:7], v[32:35], v[36:51]
v_mfma_f32_32x32x16_bf16 v[36:51], a[8:11], v[32:35], v[36:51]
v_mfma_f32_32x32x16_bf16 v[36:51], a[12:15], v[32:35], v[36:51]
v_mfma_f32_32x32x16_bf16 v[36:51], a[16:19], v[32:35], v[36:51]
v_mfma_f32_32x32x16_bf16 v[36:51], a[20:23], v[32:35], v[36:51]
v_mfma_f32_32x32x16_bf16 v[36:51], a[24:27], v[32:35], v[36:51]
v_mfma_f32_32x32x16_bf16 v[36:51], a[28:31], v[32:35], v[36:51]
v_mfma_f32_32x32x16_bf16 v[36:51], a[32:35], v[32:35], v[36:51]
v_mfma_f32_32x32x16_bf16 v[36:51], a[36:39], v[32:35], v[36:51]
v_mfma_f32_32x32x16_bf16 v[36:51], a[40:43], v[32:35], v[36:51]
v_mfma_f32_32x32x16_bf16 v[36:51], a[44:47], v[32:35], v[36:51]
v_mfma_f32_32x32x16_bf16 v[36:51], a[48:51], v[32:35], v[36:51]
v_mfma_f32_32x32x16_bf16 v[36:51], a[52:55], v[32:35], v[36:51]
v_mfma_f32_32x32x16_bf16 v[36:51], a[56:59], v[32:35], v[36:51]
v_mfma_f32_32x32x16_bf16 v[36:51], a[60:63], v[32:35], v[36:51]
v_mfma_f32_32x32x16_bf16 v[36:51], a[64:67], v[32:35], v[36:51]
v_mfma_f32_32x32x16_bf16 v[36:51], a[68:71], v[32:35], v[36:51]
v_mfma_f32_32x32x16_bf16 v[36:51], a[72:75], v[32:35], v[36:51]
v_mfma_f32_32x32x16_bf16 v[36:51], a[76:79], v[32:35], v[36:51]
v_mfma_f32_32x32x16_bf16 v[36:51], a[80:83], v[32:35], v[36:51]
v_mfma_f32_32x32x16_bf16 v[36:51], a[84:87], v[32:35], v[36:51]
v_mfma_f32_32x32x16_bf16 v[36:51], a[88:91], v[32:35], v[36:51]
v_mfma_f32_32x32x16_bf16 v[36:51], a[92:95], v[32:35], v[36:51]
v_mfma_f32_32x32x16_bf16 v[36:51], a[96:99], v[32:35], v[36:51]
v_mfma_f32_32x32x16_bf16 v[36:51], a[100:103], v[32:35], v[36:51]
v_mfma_f32_32x32x16_bf16 v[36:51], a[104:107], v[32:35], v[36:51]
v_mfma_f32_32x32x16_bf16 v[36:51], a[108:111], v[32:35], v[36:51]
v_mfma_f32_32x32x16_bf16 v[36:51], a[112:115], v[32:35], v[36:51]
v_mfma_f32_32x32x16_bf16 v[36:51], a[116:119], v[32:35], v[36:51]
v_mfma_f32_32x32x16_bf16 v[36:51], a[120:123], v[32:35], v[36:51]
v_mfma_f32_32x32x16_bf16 v[36:51], a[124:127], v[32:35], v[36:51]
v_mfma_f32_32x32x16_bf16 v[36:51], a[128:131], v[32:35], v[36:51]
v_mfma_f32_32x32x16_bf16 v[36:51], a[132:135], v[32:35], v[36:51]
v_mfma_f32_32x32x16_bf16 v[36:51], a[136:139], v[32:35], v[36:51]
v_mfma_f32_32x32x16_bf16 v[36:51], a[140:143], v[32:35], v[36:51]
v_mfma_f32_32x32x16_bf16 v[36:51], a[144:147], v[32:35], v[36:51]
v_mfma_f32_32x32x16_bf16 v[36:51], a[148:151], v[32:35], v[36:51]
v_mfma_f32_32x32x16_bf16 v[36:51], a[152:155], v[32:35], v[36:51]
v_mfma_f32_32x32x16_bf16 v[36:51], a[156:159], v[32:35], v[36:51]
s_nop 11
v_mov_b32 v8, v36
v_mov_b32 v9, v37
v_mov_b32 v10, v38
v_mov_b32 v11, v39
v_mov_b32 v12, v40
v_mov_b32 v13, v41
v_mov_b32 v14, v42
v_mov_b32 v15, v43
v_mov_b32 v16, v44
v_mov_b32 v17, v45
v_mov_b32 v18, v46
v_mov_b32 v19, v47
v_mov_b32 v20, v48
v_mov_b32 v21, v49
v_mov_b32 v22, v50
v_mov_b32 v23, v51
v_and_b32 v5, 0x70, v0
v_lshrrev_b32 v24, 8, v0
v_lshl_add_u32 v5, v24, 7, v5
v_bfe_u32 v24, v0, 7, 1
v_lshl_add_u32 v5, v24, 12, v5
s_lshr_b32 s34, s13, 1
s_lshl_b32 s34, s34, 13
s_and_b32 s18, s13, 1
s_lshl_b32 s18, s18, 10
s_add_u32 s34, s34, s18
s_lshl_b32 s18, s32, 14
s_add_u32 s34, s34, s18
v_bfe_u32 v6, v0, 7, 2
v_mul_u32_u24 v6, 10240, v6
v_bfe_u32 v24, v0, 5, 2
v_lshl_add_u32 v6, v24, 6, v6
v_lshrrev_b32 v24, 9, v0
v_lshl_add_u32 v6, v24, 5, v6
v_and_b32 v24, 16, v0
v_add_u32 v6, v24, v6
v_add_u32 v7, 81920, v0
s_add_u32 s49, s31, 81920
s_lshl_b32 s47, s32, 7
s_add_u32 s47, s47, 0
s_mul_i32 s48, s13, 2560
s_add_u32 s48, s48, 12582912
s_add_u32 s46, s34, 110100480
s_mov_b32 s35, 0
kvlay_5:
s_mul_i32 s26, s16, 6291456
s_add_u32 s26, s26, 88080384
s_add_u32 s26, s26, s31
s_mul_i32 s27, s16, 34603008
s_add_u32 s27, s27, 16777216
s_add_u32 s27, s27, s34
s_lshl_b32 s29, s16, 1
s_add_u32 s29, s29, 1
s_mov_b32 s28, 0
s_cmp_lg_u32 s13, 0
s_cbranch_scc1 polld_11
v_min_u32 v28, 624, v0
s_mov_b32 s21, 8192
s_mov_b32 s17, 0
poll_10:
buffer_load_dwordx4 v[24:27], v28, s[4:7], s21 offen offset:0 sc1
s_add_u32 s17, s17, 1
s_cmp_gt_u32 s17, 262144
s_cbranch_scc1 L_fail
s_waitcnt vmcnt(0)
v_min3_u32 v24, v24, v25, v26
v_min_u32 v24, v24, v27
v_cmp_gt_u32 vcc, s29, v24
s_cbranch_vccz polld_11
s_sleep 2
s_branch poll_10
polld_11:
s_barrier
v_xor_b32 v1, 40960, v0
s_mov_b32 s25, s31
s_add_u32 m0, s25, 2048
s_add_u32 s20, s26, 0
buffer_load_dwordx4 v0, s[4:7], s20 offen sc1 lds
s_add_u32 m0, s25, 3072
s_add_u32 s20, s26, 1024
buffer_load_dwordx4 v0, s[4:7], s20 offen sc1 lds
s_add_u32 m0, s25, 4096
s_add_u32 s20, s26, 2048
buffer_load_dwordx4 v0, s[4:7], s20 offen sc1 lds
s_add_u32 m0, s25, 5120
s_add_u32 s20, s26, 3072
buffer_load_dwordx4 v0, s[4:7], s20 offen sc1 lds
s_add_u32 m0, s25, 6144
s_add_u32 s20, s26, 4096
buffer_load_dwordx4 v0, s[4:7], s20 offen sc1 lds
s_add_u32 m0, s25, 7168
s_add_u32 s20, s26, 5120
buffer_load_dwordx4 v0, s[4:7], s20 offen sc1 lds
s_add_u32 m0, s25, 8192
s_add_u32 s20, s26, 6144
buffer_load_dwordx4 v0, s[4:7], s20 offen sc1 lds
s_add_u32 m0, s25, 9216
s_add_u32 s20, s26, 7168
buffer_load_dwordx4 v0, s[4:7], s20 offen sc1 lds
s_add_u32 m0, s25, 10240
s_add_u32 s20, s26, 8192
buffer_load_dwordx4 v0, s[4:7], s20 offen sc1 lds
s_add_u32 m0, s25, 11264
s_add_u32 s20, s26, 9216
buffer_load_dwordx4 v0, s[4:7], s20 offen sc1 lds
kvx_6:
v_xor_b32 v1, 40960, v1
s_sub_u32 s25, s25, s31
s_xor_b32 s25, s25, 40960
s_add_u32 s25, s25, s31
s_add_u32 s26, s26, 40960
s_cmp_lg_u32 s28, 31
s_cbranch_scc1 kvnop_7
s_add_u32 s29, s29, 1
s_cmp_lg_u32 s13, 0
s_cbranch_scc1 polld_13
v_min_u32 v28, 624, v0
s_mov_b32 s21, 8192
s_mov_b32 s17, 0
poll_12:
buffer_load_dwordx4 v[24:27], v28, s[4:7], s21 offen offset:0 sc1
s_add_u32 s17, s17, 1
s_cmp_gt_u32 s17, 262144
s_cbranch_scc1 L_fail
s_waitcnt vmcnt(0)
v_min3_u32 v24, v24, v25, v26
v_min_u32 v24, v24, v27
v_cmp_gt_u32 vcc, s29, v24
s_cbranch_vccz polld_13
s_sleep 2
s_branch poll_12
polld_13:
s_barrier
kvnop_7:
s_cmp_eq_u32 s28, 63
s_cselect_b32 s26, s6, s26
s_waitcnt vmcnt(0)
s_barrier
ds_read_b128 v[48:51], v1 offset:2048
s_add_u32 m0, s25, 2048
s_add_u32 s20, s26, 0
buffer_load_dwordx4 v0, s[4:7], s20 offen sc1 lds
ds_read_b128 v[52:55], v1 offset:3072
ds_read_b128 v[56:59], v1 offset:4096
v_add_u32 v2, s31, v1
v_mov_b32 v3, s23
s_add_u32 m0, s25, 3072
s_add_u32 s20, s26, 1024
buffer_load_dwordx4 v0, s[4:7], s20 offen sc1 lds
ds_read_b128 v[64:67], v2 offset:2048
s_add_u32 m0, s25, 4096
s_add_u32 s20, s26, 2048
buffer_load_dwordx4 v0, s[4:7], s20 offen sc1 lds
s_waitcnt lgkmcnt(3)
v_mfma_f32_32x32x16_bf16 v[32:47], a[0:3], v[48:51], 0
s_add_u32 m0, s25, 5120
s_add_u32 s20, s26, 3072
buffer_load_dwordx4 v0, s[4:7], s20 offen sc1 lds
ds_read_b128 v[60:63], v1 offset:5120
s_waitcnt lgkmcnt(3)
ds_read_b128 v[68:71], v2 offset:3072
ds_read_b128 v[48:51], v1 offset:6144
v_mfma_f32_32x32x16_bf16 v[32:47], a[4:7], v[52:55], v[32:47]
v_mov_b64 v[72:73], 0
s_waitcnt lgkmcnt(3)
v_dot2c_f32_bf16 v72, s24, v64
v_dot2c_f32_bf16 v72, s24, v65
v_dot2c_f32_bf16 v73, v64, v64
v_mfma_f32_32x32x16_bf16 v[32:47], a[8:11], v[56:59], v[32:47]
ds_read_b128 v[52:55], v1 offset:7168
v_dot2c_f32_bf16 v73, v65, v65
s_waitcnt lgkmcnt(3)
ds_read_b128 v[56:59], v1 offset:8192
v_dot2c_f32_bf16 v72, s24, v66
v_mfma_f32_32x32x16_bf16 v[32:47], a[12:15], v[60:63], v[32:47]
s_waitcnt lgkmcnt(3)
ds_read_b128 v[60:63], v1 offset:9216
v_dot2c_f32_bf16 v73, v66, v66
s_waitcnt lgkmcnt(3)
v_dot2c_f32_bf16 v72, s24, v67
v_dot2c_f32_bf16 v73, v67, v67
v_dot2c_f32_bf16 v72, s24, v68
v_mfma_f32_32x32x16_bf16 v[32:47], a[16:19], v[48:51], v[32:47]
ds_read_b128 v[64:67], v2 offset:4096
v_dot2c_f32_bf16 v72, s24, v69
v_dot2c_f32_bf16 v73, v68, v68
s_waitcnt lgkmcnt(3)
v_dot2c_f32_bf16 v73, v69, v69
v_dot2c_f32_bf16 v73, v70, v70
v_mfma_f32_32x32x16_bf16 v[32:47], a[20:23], v[52:55], v[32:47]
s_waitcnt lgkmcnt(2)
ds_read_b128 v[52:55], v1 offset:11264
ds_read_b128 v[48:51], v1 offset:10240
s_waitcnt lgkmcnt(3)
v_dot2c_f32_bf16 v73, v71, v71
v_mfma_f32_32x32x16_bf16 v[32:47], a[24:27], v[56:59], v[32:47]
s_add_u32 m0, s25, 6144
s_add_u32 s20, s26, 4096
buffer_load_dwordx4 v0, s[4:7], s20 offen sc1 lds
ds_read_b128 v[56:59], v1 offset:12288
v_dot2c_f32_bf16 v72, s24, v70
v_dot2c_f32_bf16 v72, s24, v71
s_waitcnt lgkmcnt(3)
v_mfma_f32_32x32x16_bf16 v[32:47], a[28:31], v[60:63], v[32:47]
ds_read_b128 v[68:71], v2 offset:5120
ds_read_b128 v[60:63], v1 offset:13312
v_dot2c_f32_bf16 v73, v64, v64
v_dot2c_f32_bf16 v72, s24, v64
s_waitcnt lgkmcnt(3)
v_dot2c_f32_bf16 v73, v65, v65
v_mfma_f32_32x32x16_bf16 v[32:47], a[32:35], v[48:51], v[32:47]
ds_read_b128 v[48:51], v1 offset:14336
v_dot2c_f32_bf16 v72, s24, v65
v_dot2c_f32_bf16 v72, s24, v66
v_dot2c_f32_bf16 v73, v66, v66
v_dot2c_f32_bf16 v73, v67, v67
v_dot2c_f32_bf16 v72, s24, v67
v_mfma_f32_32x32x16_bf16 v[32:47], a[36:39], v[52:55], v[32:47]
ds_read_b128 v[64:67], v2 offset:6144
ds_read_b128 v[52:55], v1 offset:15360
s_waitcnt lgkmcnt(4)
v_dot2c_f32_bf16 v73, v68, v68
v_dot2c_f32_bf16 v73, v69, v69
v_dot2c_f32_bf16 v72, s24, v68
v_mfma_f32_32x32x16_bf16 v[32:47], a[40:43], v[56:59], v[32:47]
s_waitcnt lgkmcnt(3)
ds_read_b128 v[56:59], v1 offset:16384
v_dot2c_f32_bf16 v73, v70, v70
v_dot2c_f32_bf16 v72, s24, v69
v_dot2c_f32_bf16 v72, s24, v70
v_dot2c_f32_bf16 v72, s24, v71
v_dot2c_f32_bf16 v73, v71, v71
v_mfma_f32_32x32x16_bf16 v[32:47], a[44:47], v[60:63], v[32:47]
s_waitcnt lgkmcnt(3)
s_waitcnt lgkmcnt(2)
ds_read_b128 v[68:71], v2 offset:7168
ds_read_b128 v[60:63], v1 offset:17408
v_dot2c_f32_bf16 v73, v64, v64
s_waitcnt lgkmcnt(3)
v_dot2c_f32_bf16 v73, v65, v65
v_mfma_f32_32x32x16_bf16 v[32:47], a[48:51], v[48:51], v[32:47]
s_add_u32 m0, s25, 7168
s_add_u32 s20, s26, 5120
buffer_load_dwordx4 v0, s[4:7], s20 offen sc1 lds
ds_read_b128 v[48:51], v1 offset:18432
v_dot2c_f32_bf16 v72, s24, v64
v_dot2c_f32_bf16 v72, s24, v65
v_dot2c_f32_bf16 v72, s24, v66
v_mfma_f32_32x32x16_bf16 v[32:47], a[52:55], v[52:55], v[32:47]
ds_read_b128 v[52:55], v1 offset:19456
s_waitcnt lgkmcnt(3)
v_dot2c_f32_bf16 v73, v66, v66
v_dot2c_f32_bf16 v73, v67, v67
v_dot2c_f32_bf16 v72, s24, v67
v_dot2c_f32_bf16 v73, v68, v68
v_mfma_f32_32x32x16_bf16 v[32:47], a[56:59], v[56:59], v[32:47]
s_waitcnt lgkmcnt(2)
ds_read_b128 v[64:67], v2 offset:8192
ds_read_b128 v[56:59], v1 offset:20480
s_add_u32 m0, s25, 8192
s_add_u32 s20, s26, 6144
buffer_load_dwordx4 v0, s[4:7], s20 offen sc1 lds
v_dot2c_f32_bf16 v72, s24, v68
v_mfma_f32_32x32x16_bf16 v[32:47], a[60:63], v[60:63], v[32:47]
ds_read_b128 v[60:63], v1 offset:21504
s_waitcnt lgkmcnt(3)
v_dot2c_f32_bf16 v72, s24, v69
v_dot2c_f32_bf16 v73, v69, v69
v_dot2c_f32_bf16 v73, v70, v70
v_dot2c_f32_bf16 v73, v71, v71
v_mfma_f32_32x32x16_bf16 v[32:47], a[64:67], v[48:51], v[32:47]
ds_read_b128 v[48:51], v1 offset:22528
v_dot2c_f32_bf16 v72, s24, v70
v_dot2c_f32_bf16 v72, s24, v71
s_waitcnt lgkmcnt(3)
ds_read_b128 v[68:71], v2 offset:9216
v_mfma_f32_32x32x16_bf16 v[32:47], a[68:71], v[52:55], v[32:47]
s_waitcnt lgkmcnt(3)
ds_read_b128 v[52:55], v1 offset:23552
v_dot2c_f32_bf16 v73, v64, v64
v_dot2c_f32_bf16 v73, v65, v65
v_dot2c_f32_bf16 v72, s24, v64
v_dot2c_f32_bf16 v72, s24, v65
v_dot2c_f32_bf16 v72, s24, v66
v_mfma_f32_32x32x16_bf16 v[32:47], a[72:75], v[56:59], v[32:47]
s_waitcnt lgkmcnt(3)
ds_read_b128 v[56:59], v1 offset:24576
v_dot2c_f32_bf16 v73, v66, v66
v_dot2c_f32_bf16 v73, v67, v67
v_dot2c_f32_bf16 v72, s24, v67
v_mfma_f32_32x32x16_bf16 v[32:47], a[76:79], v[60:63], v[32:47]
s_add_u32 m0, s25, 9216
s_add_u32 s20, s26, 7168
buffer_load_dwordx4 v0, s[4:7], s20 offen sc1 lds
ds_read_b128 v[64:67], v2 offset:10240
s_waitcnt lgkmcnt(2)
ds_read_b128 v[60:63], v1 offset:25600
v_dot2c_f32_bf16 v72, s24, v68
v_mfma_f32_32x32x16_bf16 v[32:47], a[80:83], v[48:51], v[32:47]
v_dot2c_f32_bf16 v73, v68, v68
v_dot2c_f32_bf16 v73, v69, v69
v_dot2c_f32_bf16 v72, s24, v69
v_dot2c_f32_bf16 v72, s24, v70
v_dot2c_f32_bf16 v73, v70, v70
v_dot2c_f32_bf16 v72, s24, v71
v_mfma_f32_32x32x16_bf16 v[32:47], a[84:87], v[52:55], v[32:47]
ds_read_b128 v[48:51], v1 offset:26624
v_dot2c_f32_bf16 v73, v71, v71
s_waitcnt lgkmcnt(3)
ds_read_b128 v[68:71], v2 offset:11264
ds_read_b128 v[52:55], v1 offset:27648
v_mfma_f32_32x32x16_bf16 v[32:47], a[88:91], v[56:59], v[32:47]
s_waitcnt lgkmcnt(3)
ds_read_b128 v[56:59], v1 offset:28672
v_dot2c_f32_bf16 v72, s24, v64
v_dot2c_f32_bf16 v73, v64, v64
v_dot2c_f32_bf16 v72, s24, v65
v_mfma_f32_32x32x16_bf16 v[32:47], a[92:95], v[60:63], v[32:47]
ds_read_b128 v[60:63], v1 offset:29696
v_and_b32 v64, 0x1ff, v0
s_waitcnt lgkmcnt(4)
v_dot2c_f32_bf16 v73, v65, v65
s_waitcnt lgkmcnt(3)
v_mfma_f32_32x32x16_bf16 v[32:47], a[96:99], v[48:51], v[32:47]
v_dot2c_f32_bf16 v72, s24, v66
v_dot2c_f32_bf16 v73, v66, v66
v_dot2c_f32_bf16 v72, s24, v67
v_dot2c_f32_bf16 v73, v67, v67
s_waitcnt lgkmcnt(2)
v_dot2c_f32_bf16 v73, v68, v68
v_mfma_f32_32x32x16_bf16 v[32:47], a[100:103], v[52:55], v[32:47]
ds_read_b128 v[52:55], v1 offset:31744
ds_read_b128 v[48:51], v1 offset:30720
s_waitcnt lgkmcnt(3)
v_dot2c_f32_bf16 v72, s24, v68
v_dot2c_f32_bf16 v73, v69, v69
v_mfma_f32_32x32x16_bf16 v[32:47], a[104:107], v[56:59], v[32:47]
s_waitcnt lgkmcnt(2)
ds_read_b128 v[56:59], v1 offset:32768
v_dot2c_f32_bf16 v72, s24, v69
v_dot2c_f32_bf16 v73, v70, v70
v_dot2c_f32_bf16 v72, s24, v70
v_dot2c_f32_bf16 v73, v71, v71
v_dot2c_f32_bf16 v72, s24, v71
v_mfma_f32_32x32x16_bf16 v[32:47], a[108:111], v[60:63], v[32:47]
s_waitcnt lgkmcnt(2)
ds_read_b128 v[60:63], v1 offset:33792
v_permlane32_swap_b32 v72, v73
s_waitcnt lgkmcnt(2)
v_add_f32 v72, v72, v73
v_mfma_f32_32x32x16_bf16 v[32:47], a[112:115], v[48:51], v[32:47]
v_lshl_add_u32 v73, s13, 2, v0
ds_write_b32 v73, v72 offset:0
ds_read_b128 v[48:51], v1 offset:34816
v_mfma_f32_32x32x16_bf16 v[32:47], a[116:119], v[52:55], v[32:47]
ds_read_b128 v[52:55], v1 offset:35840
s_waitcnt lgkmcnt(4)
s_waitcnt lgkmcnt(3)
v_mfma_f32_32x32x16_bf16 v[32:47], a[120:123], v[56:59], v[32:47]
s_add_u32 m0, s25, 10240
s_add_u32 s20, s26, 8192
buffer_load_dwordx4 v0, s[4:7], s20 offen sc1 lds
s_waitcnt lgkmcnt(2)
ds_read_b128 v[56:59], v1 offset:36864
v_mfma_f32_32x32x16_bf16 v[32:47], a[124:127], v[60:63], v[32:47]
s_barrier
ds_read_b128 v[72:75], v64 offset:0
s_waitcnt lgkmcnt(3)
s_waitcnt lgkmcnt(2)
v_mfma_f32_32x32x16_bf16 v[32:47], a[128:131], v[48:51], v[32:47]
ds_read_b128 v[60:63], v1 offset:37888
ds_read_b128 v[48:51], v1 offset:38912
s_add_u32 m0, s25, 11264
s_add_u32 s20, s26, 9216
buffer_load_dwordx4 v0, s[4:7], s20 offen sc1 lds
v_mfma_f32_32x32x16_bf16 v[32:47], a[132:135], v[52:55], v[32:47]
ds_read_b128 v[76:79], v64 offset:512
s_waitcnt lgkmcnt(3)
ds_read_b128 v[52:55], v1 offset:39936
v_add_f32 v74, v74, v75
v_mfma_f32_32x32x16_bf16 v[32:47], a[136:139], v[56:59], v[32:47]
s_mov_b64 exec, 1
buffer_store_dword v3, off, s[4:7], s22 sc1
s_mov_b64 exec, -1
s_waitcnt lgkmcnt(3)
ds_read_b128 v[56:59], v1 offset:40960
s_waitcnt lgkmcnt(3)
v_mfma_f32_32x32x16_bf16 v[32:47], a[140:143], v[60:63], v[32:47]
s_waitcnt lgkmcnt(2)
v_add_f32 v76, v76, v77
v_add_f32 v72, v72, v73
v_add_f32 v78, v78, v79
v_add_f32 v72, v72, v74
v_mfma_f32_32x32x16_bf16 v[32:47], a[144:147], v[48:51], v[32:47]
ds_read_b128 v[60:63], v1 offset:41984
s_waitcnt lgkmcnt(2)
v_add_f32 v76, v76, v78
v_mul_f32 v72, 0x3acccccd, v72
v_mul_f32 v76, 0x3acccccd, v76
v_fma_f32 v76, -v72, v72, v76
v_mfma_f32_32x32x16_bf16 v[32:47], a[148:151], v[52:55], v[32:47]
s_waitcnt lgkmcnt(1)
v_max_f32 v76, 0, v76
v_add_f32 v76, 0x3727c5ac, v76
v_rsq_f32 v76, v76
v_mfma_f32_32x32x16_bf16 v[32:47], a[152:155], v[56:59], v[32:47]
v_mul_f32 v72, v76, v72
s_waitcnt lgkmcnt(0)
v_mul_f32 v85, v72, v13
v_mul_f32 v84, v72, v12
v_mul_f32 v88, v72, v16
v_mul_f32 v94, v72, v22
v_mfma_f32_32x32x16_bf16 v[32:47], a[156:159], v[60:63], v[32:47]
s_nop 0
v_mul_f32 v83, v72, v11
v_mul_f32 v82, v72, v10
v_mul_f32 v80, v72, v8
v_mul_f32 v81, v72, v9
v_mul_f32 v93, v72, v21
v_mul_f32 v90, v72, v18
v_mul_f32 v86, v72, v14
v_mul_f32 v92, v72, v20
v_mul_f32 v87, v72, v15
v_mul_f32 v95, v72, v23
v_mul_f32 v89, v72, v17
v_fma_f32 v32, v32, v76, -v80
v_fma_f32 v41, v41, v76, -v89
v_mul_f32 v91, v72, v19
v_fma_f32 v38, v38, v76, -v86
v_fma_f32 v36, v36, v76, -v84
v_fma_f32 v46, v46, v76, -v94
v_fma_f32 v42, v42, v76, -v90
v_fma_f32 v39, v39, v76, -v87
v_cvt_pk_bf16_f32 v51, v38, v39
v_fma_f32 v37, v37, v76, -v85
v_fma_f32 v35, v35, v76, -v83
v_fma_f32 v43, v43, v76, -v91
v_fma_f32 v40, v40, v76, -v88
v_fma_f32 v33, v33, v76, -v81
v_cvt_pk_bf16_f32 v50, v36, v37
v_cvt_pk_bf16_f32 v48, v32, v33
v_cvt_pk_bf16_f32 v52, v40, v41
v_fma_f32 v47, v47, v76, -v95
v_fma_f32 v44, v44, v76, -v92
v_fma_f32 v45, v45, v76, -v93
v_fma_f32 v34, v34, v76, -v82
v_cvt_pk_bf16_f32 v55, v46, v47
v_cvt_pk_bf16_f32 v53, v42, v43
v_cvt_pk_bf16_f32 v49, v34, v35
v_cvt_pk_bf16_f32 v54, v44, v45
buffer_store_dwordx4 v[48:51], v5, s[4:7], s27 offen offset:0 sc1
buffer_store_dwordx4 v[52:55], v5, s[4:7], s27 offen offset:512 sc1
s_add_u32 s28, s28, 1
s_lshl_b32 s18, s16, 6
s_add_u32 s18, s18, s28
s_add_u32 s27, s27, 524288
s_cmp_eq_u32 s13, 0
s_cselect_b32 s22, s47, s6
s_mov_b32 s23, s18
s_and_b32 s18, s28, 3
s_cbranch_scc1 kvx_6
s_cmp_lt_u32 s28, 12
s_cbranch_scc1 kvx_6
kvm_8:
s_waitcnt vmcnt(0)
s_barrier
v_mov_b32 v3, s23
s_mov_b64 exec, 1
buffer_store_dword v3, off, s[4:7], s22 sc1
s_mov_b64 exec, -1
s_mov_b32 s22, s6
s_add_u32 s35, s35, 1
s_lshl_b32 s30, s35, 2
s_cmp_lg_u32 s13, 0
s_cbranch_scc1 polld_15
v_lshrrev_b32 v28, 2, v0
v_min_u32 v28, 36, v28
s_mov_b32 s21, 4096
s_mov_b32 s17, 0
poll_14:
buffer_load_dword v24, v28, s[4:7], s21 offen offset:0 sc1
s_add_u32 s17, s17, 1
s_cmp_gt_u32 s17, 262144
s_cbranch_scc1 L_fail
s_waitcnt vmcnt(0)
v_cmp_gt_u32 vcc, s30, v24
s_cbranch_vccz polld_15
s_sleep 2
s_branch poll_14
polld_15:
s_barrier
s_add_u32 m0, s49, 2048
s_add_u32 s20, s48, 0
buffer_load_dwordx4 v6, s[4:7], s20 offen sc1 lds
s_add_u32 m0, s49, 3072
s_add_u32 s20, s48, 256
buffer_load_dwordx4 v6, s[4:7], s20 offen sc1 lds
s_add_u32 m0, s49, 4096
s_add_u32 s20, s48, 512
buffer_load_dwordx4 v6, s[4:7], s20 offen sc1 lds
s_add_u32 m0, s49, 5120
s_add_u32 s20, s48, 768
buffer_load_dwordx4 v6, s[4:7], s20 offen sc1 lds
s_add_u32 m0, s49, 6144
s_add_u32 s20, s48, 1024
buffer_load_dwordx4 v6, s[4:7], s20 offen sc1 lds
s_add_u32 m0, s49, 7168
s_add_u32 s20, s48, 1280
buffer_load_dwordx4 v6, s[4:7], s20 offen sc1 lds
s_add_u32 m0, s49, 8192
s_add_u32 s20, s48, 1536
buffer_load_dwordx4 v6, s[4:7], s20 offen sc1 lds
s_add_u32 m0, s49, 9216
s_add_u32 s20, s48, 1792
buffer_load_dwordx4 v6, s[4:7], s20 offen sc1 lds
s_add_u32 m0, s49, 10240
s_add_u32 s20, s48, 2048
buffer_load_dwordx4 v6, s[4:7], s20 offen sc1 lds
s_add_u32 m0, s49, 11264
s_add_u32 s20, s48, 2304
buffer_load_dwordx4 v6, s[4:7], s20 offen sc1 lds
s_waitcnt vmcnt(0)
s_barrier
ds_read_b128 v[48:51], v7 offset:2048
ds_read_b128 v[52:55], v7 offset:3072
ds_read_b128 v[56:59], v7 offset:4096
ds_read_b128 v[60:63], v7 offset:5120
s_waitcnt lgkmcnt(3)
v_mfma_f32_32x32x16_bf16 v[32:47], a[0:3], v[48:51], 0
ds_read_b128 v[48:51], v7 offset:6144
s_waitcnt lgkmcnt(3)
v_mfma_f32_32x32x16_bf16 v[32:47], a[4:7], v[52:55], v[32:47]
s_waitcnt lgkmcnt(2)
ds_read_b128 v[52:55], v7 offset:7168
v_mfma_f32_32x32x16_bf16 v[32:47], a[8:11], v[56:59], v[32:47]
s_waitcnt lgkmcnt(2)
ds_read_b128 v[56:59], v7 offset:8192
v_mfma_f32_32x32x16_bf16 v[32:47], a[12:15], v[60:63], v[32:47]
s_waitcnt lgkmcnt(2)
ds_read_b128 v[60:63], v7 offset:9216
v_mfma_f32_32x32x16_bf16 v[32:47], a[16:19], v[48:51], v[32:47]
s_waitcnt lgkmcnt(2)
ds_read_b128 v[48:51], v7 offset:10240
v_mfma_f32_32x32x16_bf16 v[32:47], a[20:23], v[52:55], v[32:47]
s_waitcnt lgkmcnt(2)
ds_read_b128 v[52:55], v7 offset:11264
v_mfma_f32_32x32x16_bf16 v[32:47], a[24:27], v[56:59], v[32:47]
s_waitcnt lgkmcnt(2)
ds_read_b128 v[56:59], v7 offset:12288
v_mfma_f32_32x32x16_bf16 v[32:47], a[28:31], v[60:63], v[32:47]
s_waitcnt lgkmcnt(2)
ds_read_b128 v[60:63], v7 offset:13312
v_mfma_f32_32x32x16_bf16 v[32:47], a[32:35], v[48:51], v[32:47]
s_waitcnt lgkmcnt(2)
ds_read_b128 v[48:51], v7 offset:14336
v_mfma_f32_32x32x16_bf16 v[32:47], a[36:39], v[52:55], v[32:47]
s_waitcnt lgkmcnt(2)
ds_read_b128 v[52:55], v7 offset:15360
v_mfma_f32_32x32x16_bf16 v[32:47], a[40:43], v[56:59], v[32:47]
s_waitcnt lgkmcnt(2)
ds_read_b128 v[56:59], v7 offset:16384
v_mfma_f32_32x32x16_bf16 v[32:47], a[44:47], v[60:63], v[32:47]
s_waitcnt lgkmcnt(2)
ds_read_b128 v[60:63], v7 offset:17408
v_mfma_f32_32x32x16_bf16 v[32:47], a[48:51], v[48:51], v[32:47]
s_waitcnt lgkmcnt(2)
ds_read_b128 v[48:51], v7 offset:18432
v_mfma_f32_32x32x16_bf16 v[32:47], a[52:55], v[52:55], v[32:47]
s_waitcnt lgkmcnt(2)
ds_read_b128 v[52:55], v7 offset:19456
v_mfma_f32_32x32x16_bf16 v[32:47], a[56:59], v[56:59], v[32:47]
s_waitcnt lgkmcnt(2)
ds_read_b128 v[56:59], v7 offset:20480
v_mfma_f32_32x32x16_bf16 v[32:47], a[60:63], v[60:63], v[32:47]
s_waitcnt lgkmcnt(2)
ds_read_b128 v[60:63], v7 offset:21504
v_mfma_f32_32x32x16_bf16 v[32:47], a[64:67], v[48:51], v[32:47]
s_waitcnt lgkmcnt(2)
ds_read_b128 v[48:51], v7 offset:22528
v_mfma_f32_32x32x16_bf16 v[32:47], a[68:71], v[52:55], v[32:47]
s_waitcnt lgkmcnt(2)
ds_read_b128 v[52:55], v7 offset:23552
v_mfma_f32_32x32x16_bf16 v[32:47], a[72:75], v[56:59], v[32:47]
s_waitcnt lgkmcnt(2)
ds_read_b128 v[56:59], v7 offset:24576
v_mfma_f32_32x32x16_bf16 v[32:47], a[76:79], v[60:63], v[32:47]
s_waitcnt lgkmcnt(2)
ds_read_b128 v[60:63], v7 offset:25600
v_mfma_f32_32x32x16_bf16 v[32:47], a[80:83], v[48:51], v[32:47]
s_waitcnt lgkmcnt(2)
ds_read_b128 v[48:51], v7 offset:26624
v_mfma_f32_32x32x16_bf16 v[32:47], a[84:87], v[52:55], v[32:47]
s_waitcnt lgkmcnt(2)
ds_read_b128 v[52:55], v7 offset:27648
v_mfma_f32_32x32x16_bf16 v[32:47], a[88:91], v[56:59], v[32:47]
s_waitcnt lgkmcnt(2)
ds_read_b128 v[56:59], v7 offset:28672
v_mfma_f32_32x32x16_bf16 v[32:47], a[92:95], v[60:63], v[32:47]
s_waitcnt lgkmcnt(2)
ds_read_b128 v[60:63], v7 offset:29696
v_mfma_f32_32x32x16_bf16 v[32:47], a[96:99], v[48:51], v[32:47]
s_waitcnt lgkmcnt(2)
ds_read_b128 v[48:51], v7 offset:30720
v_mfma_f32_32x32x16_bf16 v[32:47], a[100:103], v[52:55], v[32:47]
s_waitcnt lgkmcnt(2)
ds_read_b128 v[52:55], v7 offset:31744
v_mfma_f32_32x32x16_bf16 v[32:47], a[104:107], v[56:59], v[32:47]
s_waitcnt lgkmcnt(2)
ds_read_b128 v[56:59], v7 offset:32768
v_mfma_f32_32x32x16_bf16 v[32:47], a[108:111], v[60:63], v[32:47]
s_waitcnt lgkmcnt(2)
ds_read_b128 v[60:63], v7 offset:33792
v_mfma_f32_32x32x16_bf16 v[32:47], a[112:115], v[48:51], v[32:47]
s_waitcnt lgkmcnt(2)
ds_read_b128 v[48:51], v7 offset:34816
v_mfma_f32_32x32x16_bf16 v[32:47], a[116:119], v[52:55], v[32:47]
s_waitcnt lgkmcnt(2)
ds_read_b128 v[52:55], v7 offset:35840
v_mfma_f32_32x32x16_bf16 v[32:47], a[120:123], v[56:59], v[32:47]
s_waitcnt lgkmcnt(2)
ds_read_b128 v[56:59], v7 offset:36864
v_mfma_f32_32x32x16_bf16 v[32:47], a[124:127], v[60:63], v[32:47]
s_waitcnt lgkmcnt(2)
ds_read_b128 v[60:63], v7 offset:37888
v_mfma_f32_32x32x16_bf16 v[32:47], a[128:131], v[48:51], v[32:47]
s_waitcnt lgkmcnt(2)
ds_read_b128 v[48:51], v7 offset:38912
v_mfma_f32_32x32x16_bf16 v[32:47], a[132:135], v[52:55], v[32:47]
s_waitcnt lgkmcnt(2)
ds_read_b128 v[52:55], v7 offset:39936
v_mfma_f32_32x32x16_bf16 v[32:47], a[136:139], v[56:59], v[32:47]
s_waitcnt lgkmcnt(2)
ds_read_b128 v[56:59], v7 offset:40960
v_mfma_f32_32x32x16_bf16 v[32:47], a[140:143], v[60:63], v[32:47]
s_waitcnt lgkmcnt(2)
ds_read_b128 v[60:63], v7 offset:41984
v_mfma_f32_32x32x16_bf16 v[32:47], a[144:147], v[48:51], v[32:47]
s_waitcnt lgkmcnt(2)
v_mfma_f32_32x32x16_bf16 v[32:47], a[148:151], v[52:55], v[32:47]
s_waitcnt lgkmcnt(1)
v_mfma_f32_32x32x16_bf16 v[32:47], a[152:155], v[56:59], v[32:47]
s_waitcnt lgkmcnt(0)
v_mfma_f32_32x32x16_bf16 v[32:47], a[156:159], v[60:63], v[32:47]
s_nop 11
v_cvt_pk_bf16_f32 v48, v32, v33
v_cvt_pk_bf16_f32 v49, v34, v35
v_cvt_pk_bf16_f32 v50, v36, v37
v_cvt_pk_bf16_f32 v51, v38, v39
v_cvt_pk_bf16_f32 v52, v40, v41
v_cvt_pk_bf16_f32 v53, v42, v43
v_cvt_pk_bf16_f32 v54, v44, v45
v_cvt_pk_bf16_f32 v55, v46, v47
buffer_store_dwordx4 v[48:51], v5, s[4:7], s46 offen offset:0 sc1
buffer_store_dwordx4 v[52:55], v5, s[4:7], s46 offen offset:512 sc1
s_add_u32 s48, s48, 40960
s_add_u32 s46, s46, 524288
s_add_u32 s18, s47, 8
s_cmp_eq_u32 s13, 0
s_cselect_b32 s22, s18, s6
s_mov_b32 s23, s35
s_cmp_lt_u32 s28, 64
s_cbranch_scc1 kvx_6
s_and_b32 s18, s35, 15
s_cbranch_scc1 kvm_8
s_waitcnt vmcnt(0)
s_barrier
v_mov_b32 v3, s23
s_mov_b64 exec, 1
buffer_store_dword v3, off, s[4:7], s22 sc1
s_mov_b64 exec, -1
s_mov_b32 s22, s6
s_add_u32 s16, s16, 1
s_cmp_lt_u32 s16, 2
s_cbranch_scc1 kvlay_5
s_endpgm
roleV_3:
s_lshl_b32 s26, s32, 8
s_lshl_b32 s18, s13, 6
s_add_u32 s26, s26, s18
s_load_dwordx2 s[36:37], s[0:1], 56
s_mov_b32 s38, 5242880
s_mov_b32 s39, 0x20000
s_waitcnt lgkmcnt(0)
v_lshrrev_b32 v20, 6, v0
v_mul_u32_u24 v20, 8192, v20
v_and_b32 v21, 48, v0
v_add_u32 v18, v20, v21
v_bfe_u32 v20, v0, 6, 2
v_lshrrev_b32 v21, 9, v0
v_lshl_add_u32 v20, v21, 3, v20
v_lshlrev_b32 v19, 6, v20
v_and_b32 v20, 48, v0
v_add_u32 v19, v19, v20
v_bfe_u32 v20, v0, 8, 1
v_lshl_add_u32 v19, v20, 3, v19
s_mul_i32 s18, s13, 36864
v_add_u32 v19, s18, v19
s_barrier
s_add_u32 m0, s18, 0
s_add_u32 s19, s26, 0
buffer_load_dwordx4 v18, s[36:39], s19 offen lds
s_add_u32 m0, s18, 1024
s_add_u32 s19, s26, 131072
buffer_load_dwordx4 v18, s[36:39], s19 offen lds
s_add_u32 m0, s18, 2048
s_add_u32 s19, s26, 262144
buffer_load_dwordx4 v18, s[36:39], s19 offen lds
s_add_u32 m0, s18, 3072
s_add_u32 s19, s26, 393216
buffer_load_dwordx4 v18, s[36:39], s19 offen lds
s_add_u32 m0, s18, 4096
s_add_u32 s19, s26, 524288
buffer_load_dwordx4 v18, s[36:39], s19 offen lds
s_add_u32 m0, s18, 5120
s_add_u32 s19, s26, 655360
buffer_load_dwordx4 v18, s[36:39], s19 offen lds
s_add_u32 m0, s18, 6144
s_add_u32 s19, s26, 786432
buffer_load_dwordx4 v18, s[36:39], s19 offen lds
s_add_u32 m0, s18, 7168
s_add_u32 s19, s26, 917504
buffer_load_dwordx4 v18, s[36:39], s19 offen lds
s_add_u32 m0, s18, 8192
s_add_u32 s19, s26, 1048576
buffer_load_dwordx4 v18, s[36:39], s19 offen lds
s_add_u32 m0, s18, 9216
s_add_u32 s19, s26, 1179648
buffer_load_dwordx4 v18, s[36:39], s19 offen lds
s_add_u32 m0, s18, 10240
s_add_u32 s19, s26, 1310720
buffer_load_dwordx4 v18, s[36:39], s19 offen lds
s_add_u32 m0, s18, 11264
s_add_u32 s19, s26, 1441792
buffer_load_dwordx4 v18, s[36:39], s19 offen lds
s_add_u32 m0, s18, 12288
s_add_u32 s19, s26, 1572864
buffer_load_dwordx4 v18, s[36:39], s19 offen lds
s_add_u32 m0, s18, 13312
s_add_u32 s19, s26, 1703936
buffer_load_dwordx4 v18, s[36:39], s19 offen lds
s_add_u32 m0, s18, 14336
s_add_u32 s19, s26, 1835008
buffer_load_dwordx4 v18, s[36:39], s19 offen lds
s_add_u32 m0, s18, 15360
s_add_u32 s19, s26, 1966080
buffer_load_dwordx4 v18, s[36:39], s19 offen lds
s_add_u32 m0, s18, 16384
s_add_u32 s19, s26, 2097152
buffer_load_dwordx4 v18, s[36:39], s19 offen lds
s_add_u32 m0, s18, 17408
s_add_u32 s19, s26, 2228224
buffer_load_dwordx4 v18, s[36:39], s19 offen lds
s_add_u32 m0, s18, 18432
s_add_u32 s19, s26, 2359296
buffer_load_dwordx4 v18, s[36:39], s19 offen lds
s_add_u32 m0, s18, 19456
s_add_u32 s19, s26, 2490368
buffer_load_dwordx4 v18, s[36:39], s19 offen lds
s_add_u32 m0, s18, 20480
s_add_u32 s19, s26, 2621440
buffer_load_dwordx4 v18, s[36:39], s19 offen lds
s_add_u32 m0, s18, 21504
s_add_u32 s19, s26, 2752512
buffer_load_dwordx4 v18, s[36:39], s19 offen lds
s_add_u32 m0, s18, 22528
s_add_u32 s19, s26, 2883584
buffer_load_dwordx4 v18, s[36:39], s19 offen lds
s_add_u32 m0, s18, 23552
s_add_u32 s19, s26, 3014656
buffer_load_dwordx4 v18, s[36:39], s19 offen lds
s_add_u32 m0, s18, 24576
s_add_u32 s19, s26, 3145728
buffer_load_dwordx4 v18, s[36:39], s19 offen lds
s_add_u32 m0, s18, 25600
s_add_u32 s19, s26, 3276800
buffer_load_dwordx4 v18, s[36:39], s19 offen lds
s_add_u32 m0, s18, 26624
s_add_u32 s19, s26, 3407872
buffer_load_dwordx4 v18, s[36:39], s19 offen lds
s_add_u32 m0, s18, 27648
s_add_u32 s19, s26, 3538944
buffer_load_dwordx4 v18, s[36:39], s19 offen lds
s_add_u32 m0, s18, 28672
s_add_u32 s19, s26, 3670016
buffer_load_dwordx4 v18, s[36:39], s19 offen lds
s_add_u32 m0, s18, 29696
s_add_u32 s19, s26, 3801088
buffer_load_dwordx4 v18, s[36:39], s19 offen lds
s_add_u32 m0, s18, 30720
s_add_u32 s19, s26, 3932160
buffer_load_dwordx4 v18, s[36:39], s19 offen lds
s_add_u32 m0, s18, 31744
s_add_u32 s19, s26, 4063232
buffer_load_dwordx4 v18, s[36:39], s19 offen lds
s_add_u32 m0, s18, 32768
s_add_u32 s19, s26, 4194304
buffer_load_dwordx4 v18, s[36:39], s19 offen lds
s_add_u32 m0, s18, 33792
s_add_u32 s19, s26, 4325376
buffer_load_dwordx4 v18, s[36:39], s19 offen lds
s_add_u32 m0, s18, 34816
s_add_u32 s19, s26, 4456448
buffer_load_dwordx4 v18, s[36:39], s19 offen lds
s_add_u32 m0, s18, 35840
s_add_u32 s19, s26, 4587520
buffer_load_dwordx4 v18, s[36:39], s19 offen lds
s_waitcnt vmcnt(32)
ds_read_b64_tr_b16 a[0:1], v19 offset:0
ds_read_b64_tr_b16 a[2:3], v19 offset:256
ds_read_b64_tr_b16 a[4:5], v19 offset:1024
ds_read_b64_tr_b16 a[6:7], v19 offset:1280
ds_read_b64_tr_b16 a[8:9], v19 offset:2048
ds_read_b64_tr_b16 a[10:11], v19 offset:2304
ds_read_b64_tr_b16 a[12:13], v19 offset:3072
ds_read_b64_tr_b16 a[14:15], v19 offset:3328
s_waitcnt lgkmcnt(0)
s_add_u32 m0, s18, 0
s_add_u32 s19, s26, 4718592
buffer_load_dwordx4 v18, s[36:39], s19 offen lds
s_add_u32 m0, s18, 1024
s_add_u32 s19, s26, 4849664
buffer_load_dwordx4 v18, s[36:39], s19 offen lds
s_add_u32 m0, s18, 2048
s_add_u32 s19, s26, 4980736
buffer_load_dwordx4 v18, s[36:39], s19 offen lds
s_add_u32 m0, s18, 3072
s_add_u32 s19, s26, 5111808
buffer_load_dwordx4 v18, s[36:39], s19 offen lds
s_waitcnt vmcnt(32)
ds_read_b64_tr_b16 a[16:17], v19 offset:4096
ds_read_b64_tr_b16 a[18:19], v19 offset:4352
ds_read_b64_tr_b16 a[20:21], v19 offset:5120
ds_read_b64_tr_b16 a[22:23], v19 offset:5376
ds_read_b64_tr_b16 a[24:25], v19 offset:6144
ds_read_b64_tr_b16 a[26:27], v19 offset:6400
ds_read_b64_tr_b16 a[28:29], v19 offset:7168
ds_read_b64_tr_b16 a[30:31], v19 offset:7424
s_waitcnt vmcnt(28)
ds_read_b64_tr_b16 a[32:33], v19 offset:8192
ds_read_b64_tr_b16 a[34:35], v19 offset:8448
ds_read_b64_tr_b16 a[36:37], v19 offset:9216
ds_read_b64_tr_b16 a[38:39], v19 offset:9472
ds_read_b64_tr_b16 a[40:41], v19 offset:10240
ds_read_b64_tr_b16 a[42:43], v19 offset:10496
ds_read_b64_tr_b16 a[44:45], v19 offset:11264
ds_read_b64_tr_b16 a[46:47], v19 offset:11520
s_waitcnt vmcnt(24)
ds_read_b64_tr_b16 a[48:49], v19 offset:12288
ds_read_b64_tr_b16 a[50:51], v19 offset:12544
ds_read_b64_tr_b16 a[52:53], v19 offset:13312
ds_read_b64_tr_b16 a[54:55], v19 offset:13568
ds_read_b64_tr_b16 a[56:57], v19 offset:14336
ds_read_b64_tr_b16 a[58:59], v19 offset:14592
ds_read_b64_tr_b16 a[60:61], v19 offset:15360
ds_read_b64_tr_b16 a[62:63], v19 offset:15616
s_waitcnt vmcnt(20)
ds_read_b64_tr_b16 a[64:65], v19 offset:16384
ds_read_b64_tr_b16 a[66:67], v19 offset:16640
ds_read_b64_tr_b16 a[68:69], v19 offset:17408
ds_read_b64_tr_b16 a[70:71], v19 offset:17664
ds_read_b64_tr_b16 a[72:73], v19 offset:18432
ds_read_b64_tr_b16 a[74:75], v19 offset:18688
ds_read_b64_tr_b16 a[76:77], v19 offset:19456
ds_read_b64_tr_b16 a[78:79], v19 offset:19712
s_waitcnt vmcnt(16)
ds_read_b64_tr_b16 a[80:81], v19 offset:20480
ds_read_b64_tr_b16 a[82:83], v19 offset:20736
ds_read_b64_tr_b16 a[84:85], v19 offset:21504
ds_read_b64_tr_b16 a[86:87], v19 offset:21760
ds_read_b64_tr_b16 a[88:89], v19 offset:22528
ds_read_b64_tr_b16 a[90:91], v19 offset:22784
ds_read_b64_tr_b16 a[92:93], v19 offset:23552
ds_read_b64_tr_b16 a[94:95], v19 offset:23808
s_waitcnt vmcnt(12)
ds_read_b64_tr_b16 a[96:97], v19 offset:24576
ds_read_b64_tr_b16 a[98:99], v19 offset:24832
ds_read_b64_tr_b16 a[100:101], v19 offset:25600
ds_read_b64_tr_b16 a[102:103], v19 offset:25856
ds_read_b64_tr_b16 a[104:105], v19 offset:26624
ds_read_b64_tr_b16 a[106:107], v19 offset:26880
ds_read_b64_tr_b16 a[108:109], v19 offset:27648
ds_read_b64_tr_b16 a[110:111], v19 offset:27904
s_waitcnt vmcnt(8)
ds_read_b64_tr_b16 a[112:113], v19 offset:28672
ds_read_b64_tr_b16 a[114:115], v19 offset:28928
ds_read_b64_tr_b16 a[116:117], v19 offset:29696
ds_read_b64_tr_b16 a[118:119], v19 offset:29952
ds_read_b64_tr_b16 a[120:121], v19 offset:30720
ds_read_b64_tr_b16 a[122:123], v19 offset:30976
ds_read_b64_tr_b16 a[124:125], v19 offset:31744
ds_read_b64_tr_b16 a[126:127], v19 offset:32000
s_waitcnt vmcnt(4)
ds_read_b64_tr_b16 a[128:129], v19 offset:32768
ds_read_b64_tr_b16 a[130:131], v19 offset:33024
ds_read_b64_tr_b16 a[132:133], v19 offset:33792
ds_read_b64_tr_b16 a[134:135], v19 offset:34048
ds_read_b64_tr_b16 a[136:137], v19 offset:34816
ds_read_b64_tr_b16 a[138:139], v19 offset:35072
ds_read_b64_tr_b16 a[140:141], v19 offset:35840
ds_read_b64_tr_b16 a[142:143], v19 offset:36096
s_waitcnt vmcnt(0)
ds_read_b64_tr_b16 a[144:145], v19 offset:0
ds_read_b64_tr_b16 a[146:147], v19 offset:256
ds_read_b64_tr_b16 a[148:149], v19 offset:1024
ds_read_b64_tr_b16 a[150:151], v19 offset:1280
ds_read_b64_tr_b16 a[152:153], v19 offset:2048
ds_read_b64_tr_b16 a[154:155], v19 offset:2304
ds_read_b64_tr_b16 a[156:157], v19 offset:3072
ds_read_b64_tr_b16 a[158:159], v19 offset:3328
s_waitcnt lgkmcnt(0)
s_barrier
v_mov_b32 v20, s24
v_mov_b32 v21, s24
v_mov_b32 v22, s24
v_mov_b32 v23, s24
s_nop 1
v_mfma_f32_32x32x16_bf16 v[24:39], v[20:23], a[0:3], 0
v_mfma_f32_32x32x16_bf16 v[24:39], v[20:23], a[4:7], v[24:39]
v_mfma_f32_32x32x16_bf16 v[24:39], v[20:23], a[8:11], v[24:39]
v_mfma_f32_32x32x16_bf16 v[24:39], v[20:23], a[12:15], v[24:39]
v_mfma_f32_32x32x16_bf16 v[24:39], v[20:23], a[16:19], v[24:39]
v_mfma_f32_32x32x16_bf16 v[24:39], v[20:23], a[20:23], v[24:39]
v_mfma_f32_32x32x16_bf16 v[24:39], v[20:23], a[24:27], v[24:39]
v_mfma_f32_32x32x16_bf16 v[24:39], v[20:23], a[28:31], v[24:39]
v_mfma_f32_32x32x16_bf16 v[24:39], v[20:23], a[32:35], v[24:39]
v_mfma_f32_32x32x16_bf16 v[24:39], v[20:23], a[36:39], v[24:39]
v_mfma_f32_32x32x16_bf16 v[24:39], v[20:23], a[40:43], v[24:39]
v_mfma_f32_32x32x16_bf16 v[24:39], v[20:23], a[44:47], v[24:39]
v_mfma_f32_32x32x16_bf16 v[24:39], v[20:23], a[48:51], v[24:39]
v_mfma_f32_32x32x16_bf16 v[24:39], v[20:23], a[52:55], v[24:39]
v_mfma_f32_32x32x16_bf16 v[24:39], v[20:23], a[56:59], v[24:39]
v_mfma_f32_32x32x16_bf16 v[24:39], v[20:23], a[60:63], v[24:39]
v_mfma_f32_32x32x16_bf16 v[24:39], v[20:23], a[64:67], v[24:39]
v_mfma_f32_32x32x16_bf16 v[24:39], v[20:23], a[68:71], v[24:39]
v_mfma_f32_32x32x16_bf16 v[24:39], v[20:23], a[72:75], v[24:39]
v_mfma_f32_32x32x16_bf16 v[24:39], v[20:23], a[76:79], v[24:39]
v_mfma_f32_32x32x16_bf16 v[24:39], v[20:23], a[80:83], v[24:39]
v_mfma_f32_32x32x16_bf16 v[24:39], v[20:23], a[84:87], v[24:39]
v_mfma_f32_32x32x16_bf16 v[24:39], v[20:23], a[88:91], v[24:39]
v_mfma_f32_32x32x16_bf16 v[24:39], v[20:23], a[92:95], v[24:39]
v_mfma_f32_32x32x16_bf16 v[24:39], v[20:23], a[96:99], v[24:39]
v_mfma_f32_32x32x16_bf16 v[24:39], v[20:23], a[100:103], v[24:39]
v_mfma_f32_32x32x16_bf16 v[24:39], v[20:23], a[104:107], v[24:39]
v_mfma_f32_32x32x16_bf16 v[24:39], v[20:23], a[108:111], v[24:39]
v_mfma_f32_32x32x16_bf16 v[24:39], v[20:23], a[112:115], v[24:39]
v_mfma_f32_32x32x16_bf16 v[24:39], v[20:23], a[116:119], v[24:39]
v_mfma_f32_32x32x16_bf16 v[24:39], v[20:23], a[120:123], v[24:39]
v_mfma_f32_32x32x16_bf16 v[24:39], v[20:23], a[124:127], v[24:39]
v_mfma_f32_32x32x16_bf16 v[24:39], v[20:23], a[128:131], v[24:39]
v_mfma_f32_32x32x16_bf16 v[24:39], v[20:23], a[132:135], v[24:39]
v_mfma_f32_32x32x16_bf16 v[24:39], v[20:23], a[136:139], v[24:39]
v_mfma_f32_32x32x16_bf16 v[24:39], v[20:23], a[140:143], v[24:39]
v_mfma_f32_32x32x16_bf16 v[24:39], v[20:23], a[144:147], v[24:39]
v_mfma_f32_32x32x16_bf16 v[24:39], v[20:23], a[148:151], v[24:39]
v_mfma_f32_32x32x16_bf16 v[24:39], v[20:23], a[152:155], v[24:39]
v_mfma_f32_32x32x16_bf16 v[24:39], v[20:23], a[156:159], v[24:39]
s_nop 11
v_mov_b32 v5, v24
v_and_b32 v6, 0xf0, v0
v_bfe_u32 v12, v0, 8, 1
v_lshl_add_u32 v6, v12, 10, v6
v_lshrrev_b32 v12, 9, v0
v_lshl_add_u32 v6, v12, 8, v6
s_lshl_b32 s34, s13, 12
s_add_u32 s34, s34, 2048
s_lshl_b32 s18, s32, 14
s_add_u32 s34, s34, s18
v_bfe_u32 v7, v0, 7, 2
v_mul_u32_u24 v7, 10240, v7
v_bfe_u32 v12, v0, 5, 2
v_lshl_add_u32 v7, v12, 6, v7
v_lshrrev_b32 v12, 9, v0
v_lshl_add_u32 v7, v12, 5, v7
v_and_b32 v12, 16, v0
v_add_u32 v7, v12, v7
v_add_u32 v8, 81920, v0
s_add_u32 s49, s31, 81920
s_lshl_b32 s47, s32, 7
s_add_u32 s47, s47, 4
s_mul_i32 s48, s13, 2560
s_add_u32 s48, s48, 12582912
s_add_u32 s46, s34, 110100480
s_mov_b32 s35, 0
kvlay_16:
s_mul_i32 s26, s16, 6291456
s_add_u32 s26, s26, 88080384
s_add_u32 s26, s26, s31
s_mul_i32 s27, s16, 34603008
s_add_u32 s27, s27, 16777216
s_add_u32 s27, s27, s34
s_lshl_b32 s29, s16, 1
s_add_u32 s29, s29, 1
s_mov_b32 s28, 0
s_cmp_lg_u32 s13, 0
s_cbranch_scc1 polld_22
v_min_u32 v16, 624, v0
s_mov_b32 s21, 8192
s_mov_b32 s17, 0
poll_21:
buffer_load_dwordx4 v[12:15], v16, s[4:7], s21 offen offset:0 sc1
s_add_u32 s17, s17, 1
s_cmp_gt_u32 s17, 262144
s_cbranch_scc1 L_fail
s_waitcnt vmcnt(0)
v_min3_u32 v12, v12, v13, v14
v_min_u32 v12, v12, v15
v_cmp_gt_u32 vcc, s29, v12
s_cbranch_vccz polld_22
s_sleep 2
s_branch poll_21
polld_22:
s_barrier
v_xor_b32 v1, 40960, v0
s_mov_b32 s25, s31
s_add_u32 m0, s25, 2048
s_add_u32 s20, s26, 0
buffer_load_dwordx4 v0, s[4:7], s20 offen sc1 lds
s_add_u32 m0, s25, 3072
s_add_u32 s20, s26, 1024
buffer_load_dwordx4 v0, s[4:7], s20 offen sc1 lds
s_add_u32 m0, s25, 4096
s_add_u32 s20, s26, 2048
buffer_load_dwordx4 v0, s[4:7], s20 offen sc1 lds
s_add_u32 m0, s25, 5120
s_add_u32 s20, s26, 3072
buffer_load_dwordx4 v0, s[4:7], s20 offen sc1 lds
s_add_u32 m0, s25, 6144
s_add_u32 s20, s26, 4096
buffer_load_dwordx4 v0, s[4:7], s20 offen sc1 lds
s_add_u32 m0, s25, 7168
s_add_u32 s20, s26, 5120
buffer_load_dwordx4 v0, s[4:7], s20 offen sc1 lds
s_add_u32 m0, s25, 8192
s_add_u32 s20, s26, 6144
buffer_load_dwordx4 v0, s[4:7], s20 offen sc1 lds
s_add_u32 m0, s25, 9216
s_add_u32 s20, s26, 7168
buffer_load_dwordx4 v0, s[4:7], s20 offen sc1 lds
s_add_u32 m0, s25, 10240
s_add_u32 s20, s26, 8192
buffer_load_dwordx4 v0, s[4:7], s20 offen sc1 lds
s_add_u32 m0, s25, 11264
s_add_u32 s20, s26, 9216
buffer_load_dwordx4 v0, s[4:7], s20 offen sc1 lds
kvx_17:
v_xor_b32 v1, 40960, v1
s_sub_u32 s25, s25, s31
s_xor_b32 s25, s25, 40960
s_add_u32 s25, s25, s31
s_add_u32 s26, s26, 40960
s_cmp_lg_u32 s28, 31
s_cbranch_scc1 kvnop_18
s_add_u32 s29, s29, 1
s_cmp_lg_u32 s13, 0
s_cbranch_scc1 polld_24
v_min_u32 v16, 624, v0
s_mov_b32 s21, 8192
s_mov_b32 s17, 0
poll_23:
buffer_load_dwordx4 v[12:15], v16, s[4:7], s21 offen offset:0 sc1
s_add_u32 s17, s17, 1
s_cmp_gt_u32 s17, 262144
s_cbranch_scc1 L_fail
s_waitcnt vmcnt(0)
v_min3_u32 v12, v12, v13, v14
v_min_u32 v12, v12, v15
v_cmp_gt_u32 vcc, s29, v12
s_cbranch_vccz polld_24
s_sleep 2
s_branch poll_23
polld_24:
s_barrier
kvnop_18:
s_cmp_eq_u32 s28, 63
s_cselect_b32 s26, s6, s26
s_waitcnt vmcnt(0)
s_barrier
ds_read_b128 v[36:39], v1 offset:2048
ds_read_b128 v[40:43], v1 offset:3072
ds_read_b128 v[44:47], v1 offset:4096
s_add_u32 m0, s25, 2048
s_add_u32 s20, s26, 0
buffer_load_dwordx4 v0, s[4:7], s20 offen sc1 lds
s_add_u32 m0, s25, 3072
s_add_u32 s20, s26, 1024
buffer_load_dwordx4 v0, s[4:7], s20 offen sc1 lds
ds_read_b128 v[48:51], v1 offset:5120
v_add_u32 v2, s31, v1
s_add_u32 m0, s25, 4096
s_add_u32 s20, s26, 2048
buffer_load_dwordx4 v0, s[4:7], s20 offen sc1 lds
ds_read_b128 v[52:55], v2 offset:2048
s_waitcnt lgkmcnt(4)
v_mfma_f32_32x32x16_bf16 v[20:35], v[36:39], a[0:3], 0
ds_read_b128 v[36:39], v1 offset:6144
v_mov_b64 v[60:61], 0
ds_read_b128 v[56:59], v2 offset:3072
s_waitcnt lgkmcnt(4)
v_mfma_f32_32x32x16_bf16 v[20:35], v[40:43], a[4:7], v[20:35]
s_add_u32 m0, s25, 5120
s_add_u32 s20, s26, 3072
buffer_load_dwordx4 v0, s[4:7], s20 offen sc1 lds
ds_read_b128 v[40:43], v1 offset:7168
s_add_u32 m0, s25, 6144
s_add_u32 s20, s26, 4096
buffer_load_dwordx4 v0, s[4:7], s20 offen sc1 lds
v_mfma_f32_32x32x16_bf16 v[20:35], v[44:47], a[8:11], v[20:35]
s_waitcnt lgkmcnt(3)
ds_read_b128 v[44:47], v1 offset:8192
v_dot2c_f32_bf16 v61, v52, v52
v_dot2c_f32_bf16 v60, s24, v52
v_dot2c_f32_bf16 v61, v53, v53
v_dot2c_f32_bf16 v61, v54, v54
v_dot2c_f32_bf16 v61, v55, v55
v_mfma_f32_32x32x16_bf16 v[20:35], v[48:51], a[12:15], v[20:35]
s_add_u32 m0, s25, 7168
s_add_u32 s20, s26, 5120
buffer_load_dwordx4 v0, s[4:7], s20 offen sc1 lds
s_waitcnt lgkmcnt(1)
v_dot2c_f32_bf16 v60, s24, v53
v_dot2c_f32_bf16 v61, v56, v56
v_dot2c_f32_bf16 v60, s24, v54
v_mfma_f32_32x32x16_bf16 v[20:35], v[36:39], a[16:19], v[20:35]
ds_read_b128 v[48:51], v1 offset:9216
ds_read_b128 v[36:39], v1 offset:10240
v_dot2c_f32_bf16 v61, v57, v57
v_dot2c_f32_bf16 v60, s24, v55
v_dot2c_f32_bf16 v61, v58, v58
v_dot2c_f32_bf16 v60, s24, v56
v_mfma_f32_32x32x16_bf16 v[20:35], v[40:43], a[20:23], v[20:35]
s_waitcnt lgkmcnt(2)
ds_read_b128 v[52:55], v2 offset:4096
ds_read_b128 v[40:43], v1 offset:11264
v_dot2c_f32_bf16 v61, v59, v59
v_dot2c_f32_bf16 v60, s24, v57
v_dot2c_f32_bf16 v60, s24, v58
v_dot2c_f32_bf16 v60, s24, v59
v_mfma_f32_32x32x16_bf16 v[20:35], v[44:47], a[24:27], v[20:35]
s_waitcnt lgkmcnt(3)
ds_read_b128 v[44:47], v1 offset:12288
ds_read_b128 v[56:59], v2 offset:5120
s_add_u32 m0, s25, 8192
s_add_u32 s20, s26, 6144
buffer_load_dwordx4 v0, s[4:7], s20 offen sc1 lds
v_mfma_f32_32x32x16_bf16 v[20:35], v[48:51], a[28:31], v[20:35]
s_waitcnt lgkmcnt(3)
ds_read_b128 v[48:51], v1 offset:13312
v_dot2c_f32_bf16 v61, v52, v52
v_dot2c_f32_bf16 v61, v53, v53
v_dot2c_f32_bf16 v60, s24, v52
v_dot2c_f32_bf16 v60, s24, v53
v_mfma_f32_32x32x16_bf16 v[20:35], v[36:39], a[32:35], v[20:35]
ds_read_b128 v[36:39], v1 offset:14336
v_dot2c_f32_bf16 v60, s24, v54
v_dot2c_f32_bf16 v61, v54, v54
v_dot2c_f32_bf16 v60, s24, v55
v_dot2c_f32_bf16 v61, v55, v55
s_waitcnt lgkmcnt(2)
v_mfma_f32_32x32x16_bf16 v[20:35], v[40:43], a[36:39], v[20:35]
ds_read_b128 v[52:55], v2 offset:6144
ds_read_b128 v[40:43], v1 offset:15360
v_dot2c_f32_bf16 v61, v56, v56
v_dot2c_f32_bf16 v60, s24, v56
v_dot2c_f32_bf16 v61, v57, v57
v_dot2c_f32_bf16 v61, v58, v58
v_mfma_f32_32x32x16_bf16 v[20:35], v[44:47], a[40:43], v[20:35]
s_waitcnt lgkmcnt(3)
s_add_u32 m0, s25, 9216
s_add_u32 s20, s26, 7168
buffer_load_dwordx4 v0, s[4:7], s20 offen sc1 lds
v_dot2c_f32_bf16 v60, s24, v57
v_dot2c_f32_bf16 v60, s24, v58
v_dot2c_f32_bf16 v60, s24, v59
v_mfma_f32_32x32x16_bf16 v[20:35], v[48:51], a[44:47], v[20:35]
ds_read_b128 v[44:47], v1 offset:16384
ds_read_b128 v[48:51], v1 offset:17408
s_waitcnt lgkmcnt(3)
v_dot2c_f32_bf16 v61, v59, v59
v_dot2c_f32_bf16 v60, s24, v52
v_dot2c_f32_bf16 v61, v52, v52
v_mfma_f32_32x32x16_bf16 v[20:35], v[36:39], a[48:51], v[20:35]
s_waitcnt lgkmcnt(2)
ds_read_b128 v[36:39], v1 offset:18432
ds_read_b128 v[56:59], v2 offset:7168
v_dot2c_f32_bf16 v61, v53, v53
v_dot2c_f32_bf16 v61, v54, v54
v_dot2c_f32_bf16 v60, s24, v53
v_dot2c_f32_bf16 v60, s24, v54
v_mfma_f32_32x32x16_bf16 v[20:35], v[40:43], a[52:55], v[20:35]
s_add_u32 m0, s25, 10240
s_add_u32 s20, s26, 8192
buffer_load_dwordx4 v0, s[4:7], s20 offen sc1 lds
s_waitcnt lgkmcnt(3)
ds_read_b128 v[40:43], v1 offset:19456
v_dot2c_f32_bf16 v61, v55, v55
v_mfma_f32_32x32x16_bf16 v[20:35], v[44:47], a[56:59], v[20:35]
s_add_u32 m0, s25, 11264
s_add_u32 s20, s26, 9216
buffer_load_dwordx4 v0, s[4:7], s20 offen sc1 lds
ds_read_b128 v[44:47], v1 offset:20480
v_dot2c_f32_bf16 v60, s24, v55
s_waitcnt lgkmcnt(2)
v_dot2c_f32_bf16 v61, v56, v56
v_mfma_f32_32x32x16_bf16 v[20:35], v[48:51], a[60:63], v[20:35]
ds_read_b128 v[52:55], v2 offset:8192
ds_read_b128 v[48:51], v1 offset:21504
v_dot2c_f32_bf16 v61, v57, v57
v_dot2c_f32_bf16 v61, v58, v58
v_dot2c_f32_bf16 v60, s24, v56
v_dot2c_f32_bf16 v60, s24, v57
v_mfma_f32_32x32x16_bf16 v[20:35], v[36:39], a[64:67], v[20:35]
s_waitcnt lgkmcnt(3)
v_dot2c_f32_bf16 v60, s24, v58
ds_read_b128 v[36:39], v1 offset:22528
v_dot2c_f32_bf16 v60, s24, v59
v_dot2c_f32_bf16 v61, v59, v59
v_mfma_f32_32x32x16_bf16 v[20:35], v[40:43], a[68:71], v[20:35]
s_waitcnt lgkmcnt(3)
ds_read_b128 v[56:59], v2 offset:9216
ds_read_b128 v[40:43], v1 offset:23552
s_waitcnt lgkmcnt(4)
v_dot2c_f32_bf16 v61, v52, v52
v_dot2c_f32_bf16 v61, v53, v53
v_dot2c_f32_bf16 v61, v54, v54
v_mfma_f32_32x32x16_bf16 v[20:35], v[44:47], a[72:75], v[20:35]
s_waitcnt lgkmcnt(3)
ds_read_b128 v[44:47], v1 offset:24576
v_dot2c_f32_bf16 v60, s24, v52
v_dot2c_f32_bf16 v61, v55, v55
v_dot2c_f32_bf16 v60, s24, v53
v_dot2c_f32_bf16 v60, s24, v54
v_dot2c_f32_bf16 v60, s24, v55
v_mfma_f32_32x32x16_bf16 v[20:35], v[48:51], a[76:79], v[20:35]
ds_read_b128 v[52:55], v2 offset:10240
ds_read_b128 v[48:51], v1 offset:25600
s_waitcnt lgkmcnt(4)
v_dot2c_f32_bf16 v60, s24, v56
v_dot2c_f32_bf16 v60, s24, v57
v_dot2c_f32_bf16 v61, v56, v56
v_dot2c_f32_bf16 v61, v57, v57
v_dot2c_f32_bf16 v60, s24, v58
v_dot2c_f32_bf16 v60, s24, v59
v_dot2c_f32_bf16 v61, v58, v58
v_dot2c_f32_bf16 v61, v59, v59
v_mfma_f32_32x32x16_bf16 v[20:35], v[36:39], a[80:83], v[20:35]
ds_read_b128 v[56:59], v2 offset:11264
ds_read_b128 v[36:39], v1 offset:26624
s_waitcnt lgkmcnt(3)
v_dot2c_f32_bf16 v60, s24, v52
v_dot2c_f32_bf16 v60, s24, v53
v_mfma_f32_32x32x16_bf16 v[20:35], v[40:43], a[84:87], v[20:35]
ds_read_b128 v[40:43], v1 offset:27648
v_dot2c_f32_bf16 v61, v52, v52
v_dot2c_f32_bf16 v60, s24, v54
v_dot2c_f32_bf16 v61, v53, v53
v_dot2c_f32_bf16 v61, v54, v54
v_dot2c_f32_bf16 v60, s24, v55
v_dot2c_f32_bf16 v61, v55, v55
v_mfma_f32_32x32x16_bf16 v[20:35], v[44:47], a[88:91], v[20:35]
s_waitcnt lgkmcnt(2)
v_dot2c_f32_bf16 v61, v56, v56
v_dot2c_f32_bf16 v60, s24, v56
v_dot2c_f32_bf16 v61, v57, v57
v_dot2c_f32_bf16 v61, v58, v58
v_dot2c_f32_bf16 v61, v59, v59
v_dot2c_f32_bf16 v60, s24, v57
v_dot2c_f32_bf16 v60, s24, v58
v_dot2c_f32_bf16 v60, s24, v59
v_mfma_f32_32x32x16_bf16 v[20:35], v[48:51], a[92:95], v[20:35]
s_waitcnt lgkmcnt(1)
ds_read_b128 v[48:51], v1 offset:29696
ds_read_b128 v[44:47], v1 offset:28672
v_permlane32_swap_b32 v60, v61
v_add_f32 v60, v60, v61
v_lshl_add_u32 v61, s13, 2, v0
v_mfma_f32_32x32x16_bf16 v[20:35], v[36:39], a[96:99], v[20:35]
ds_write_b32 v61, v60 offset:0
v_and_b32 v52, 0x1ff, v0
s_waitcnt lgkmcnt(3)
ds_read_b128 v[36:39], v1 offset:30720
v_mfma_f32_32x32x16_bf16 v[20:35], v[40:43], a[100:103], v[20:35]
v_mov_b32 v3, s23
s_waitcnt lgkmcnt(2)
ds_read_b128 v[40:43], v1 offset:31744
v_mfma_f32_32x32x16_bf16 v[20:35], v[44:47], a[104:107], v[20:35]
ds_read_b128 v[44:47], v1 offset:32768
s_waitcnt lgkmcnt(3)
s_barrier
v_mfma_f32_32x32x16_bf16 v[20:35], v[48:51], a[108:111], v[20:35]
ds_read_b128 v[60:63], v52 offset:0
ds_read_b128 v[48:51], v1 offset:33792
ds_read_b128 v[64:67], v52 offset:512
s_waitcnt lgkmcnt(5)
s_waitcnt lgkmcnt(4)
v_mfma_f32_32x32x16_bf16 v[20:35], v[36:39], a[112:115], v[20:35]
ds_read_b128 v[36:39], v1 offset:34816
s_mov_b64 exec, 1
buffer_store_dword v3, off, s[4:7], s22 sc1
s_mov_b64 exec, -1
s_waitcnt lgkmcnt(4)
v_mfma_f32_32x32x16_bf16 v[20:35], v[40:43], a[116:119], v[20:35]
s_waitcnt lgkmcnt(3)
ds_read_b128 v[40:43], v1 offset:35840
v_add_f32 v60, v60, v61
v_add_f32 v62, v62, v63
v_add_f32 v60, v60, v62
v_mfma_f32_32x32x16_bf16 v[20:35], v[44:47], a[120:123], v[20:35]
s_waitcnt lgkmcnt(2)
ds_read_b128 v[44:47], v1 offset:36864
v_add_f32 v64, v64, v65
v_mul_f32 v60, 0x3acccccd, v60
v_add_f32 v66, v66, v67
v_add_f32 v64, v64, v66
v_mfma_f32_32x32x16_bf16 v[20:35], v[48:51], a[124:127], v[20:35]
s_waitcnt lgkmcnt(2)
ds_read_b128 v[48:51], v1 offset:37888
v_bfe_u32 v62, v0, 5, 5
v_mul_f32 v64, 0x3acccccd, v64
v_and_b32 v62, 16, v62
v_fma_f32 v64, -v60, v60, v64
v_lshrrev_b32 v61, 2, v0
v_mfma_f32_32x32x16_bf16 v[20:35], v[36:39], a[128:131], v[20:35]
ds_read_b128 v[36:39], v1 offset:38912
v_max_f32 v64, 0, v64
v_add_f32 v64, 0x3727c5ac, v64
v_rsq_f32 v64, v64
s_waitcnt lgkmcnt(3)
v_mfma_f32_32x32x16_bf16 v[20:35], v[40:43], a[132:135], v[20:35]
s_waitcnt lgkmcnt(2)
ds_read_b128 v[40:43], v1 offset:39936
v_mul_f32 v60, v64, v60
v_lshl_add_u32 v61, s13, 8, v61
v_lshl_add_u32 v62, s13, 8, v62
v_permlane32_swap_b32 v64, v60
v_mfma_f32_32x32x16_bf16 v[20:35], v[44:47], a[136:139], v[20:35]
ds_read_b128 v[44:47], v1 offset:40960
ds_write_b32 v61, v64 offset:1024
s_waitcnt lgkmcnt(4)
ds_read_b128 v[92:95], v62 offset:1216
s_waitcnt lgkmcnt(4)
v_mfma_f32_32x32x16_bf16 v[20:35], v[48:51], a[140:143], v[20:35]
ds_read_b128 v[96:99], v62 offset:1248
ds_read_b128 v[88:91], v62 offset:1184
ds_read_b128 v[48:51], v1 offset:41984
s_waitcnt lgkmcnt(6)
ds_read_b128 v[84:87], v62 offset:1152
v_mfma_f32_32x32x16_bf16 v[20:35], v[36:39], a[144:147], v[20:35]
ds_read_b128 v[76:79], v62 offset:1088
ds_read_b128 v[72:75], v62 offset:1056
ds_read_b128 v[80:83], v62 offset:1120
s_waitcnt lgkmcnt(9)
v_mfma_f32_32x32x16_bf16 v[20:35], v[40:43], a[148:151], v[20:35]
s_waitcnt lgkmcnt(7)
ds_read_b128 v[68:71], v62 offset:1024
v_mul_f32 v94, v94, v5
s_waitcnt lgkmcnt(7)
v_mul_f32 v93, v93, v5
v_mul_f32 v98, v98, v5
v_mfma_f32_32x32x16_bf16 v[20:35], v[44:47], a[152:155], v[20:35]
v_mul_f32 v99, v99, v5
v_mul_f32 v96, v96, v5
s_waitcnt lgkmcnt(6)
s_waitcnt lgkmcnt(5)
v_mul_f32 v91, v91, v5
v_mfma_f32_32x32x16_bf16 v[20:35], v[48:51], a[156:159], v[20:35]
s_waitcnt lgkmcnt(4)
v_mul_f32 v95, v95, v5
v_mul_f32 v86, v86, v5
v_mul_f32 v97, v97, v5
v_mul_f32 v90, v90, v5
v_mul_f32 v88, v88, v5
v_mul_f32 v89, v89, v5
v_mul_f32 v85, v85, v5
v_mul_f32 v84, v84, v5
v_mul_f32 v92, v92, v5
v_mul_f32 v87, v87, v5
s_waitcnt lgkmcnt(1)
v_fma_f32 v35, v35, v83, -v99
v_fma_f32 v33, v33, v81, -v97
v_fma_f32 v24, v24, v72, -v88
s_waitcnt lgkmcnt(0)
v_fma_f32 v22, v22, v70, -v86
v_fma_f32 v32, v32, v80, -v96
v_fma_f32 v27, v27, v75, -v91
v_fma_f32 v30, v30, v78, -v94
v_fma_f32 v21, v21, v69, -v85
v_fma_f32 v20, v20, v68, -v84
v_fma_f32 v28, v28, v76, -v92
v_fma_f32 v31, v31, v79, -v95
v_fma_f32 v25, v25, v73, -v89
v_cvt_pk_bf16_f32 v36, v20, v21
v_fma_f32 v34, v34, v82, -v98
v_fma_f32 v26, v26, v74, -v90
v_cvt_pk_bf16_f32 v39, v26, v27
v_fma_f32 v29, v29, v77, -v93
v_cvt_pk_bf16_f32 v38, v24, v25
v_cvt_pk_bf16_f32 v43, v34, v35
v_cvt_pk_bf16_f32 v41, v30, v31
v_cvt_pk_bf16_f32 v42, v32, v33
v_fma_f32 v23, v23, v71, -v87
v_cvt_pk_bf16_f32 v37, v22, v23
v_cvt_pk_bf16_f32 v40, v28, v29
buffer_store_dwordx4 v[36:39], v6, s[4:7], s27 offen offset:0 sc1
buffer_store_dwordx4 v[40:43], v6, s[4:7], s27 offen offset:512 sc1
s_add_u32 s28, s28, 1
s_lshl_b32 s18, s16, 6
s_add_u32 s18, s18, s28
s_add_u32 s27, s27, 524288
s_cmp_eq_u32 s13, 0
s_cselect_b32 s22, s47, s6
s_mov_b32 s23, s18
s_and_b32 s18, s28, 3
s_cbranch_scc1 kvx_17
s_cmp_lt_u32 s28, 12
s_cbranch_scc1 kvx_17
kvm_19:
s_waitcnt vmcnt(0)
s_barrier
v_mov_b32 v3, s23
s_mov_b64 exec, 1
buffer_store_dword v3, off, s[4:7], s22 sc1
s_mov_b64 exec, -1
s_mov_b32 s22, s6
s_add_u32 s35, s35, 1
s_lshl_b32 s30, s35, 2
s_cmp_lg_u32 s13, 0
s_cbranch_scc1 polld_26
v_lshrrev_b32 v16, 2, v0
v_min_u32 v16, 36, v16
s_mov_b32 s21, 4096
s_mov_b32 s17, 0
poll_25:
buffer_load_dword v12, v16, s[4:7], s21 offen offset:0 sc1
s_add_u32 s17, s17, 1
s_cmp_gt_u32 s17, 262144
s_cbranch_scc1 L_fail
s_waitcnt vmcnt(0)
v_cmp_gt_u32 vcc, s30, v12
s_cbranch_vccz polld_26
s_sleep 2
s_branch poll_25
polld_26:
s_barrier
s_add_u32 m0, s49, 2048
s_add_u32 s20, s48, 0
buffer_load_dwordx4 v7, s[4:7], s20 offen sc1 lds
s_add_u32 m0, s49, 3072
s_add_u32 s20, s48, 256
buffer_load_dwordx4 v7, s[4:7], s20 offen sc1 lds
s_add_u32 m0, s49, 4096
s_add_u32 s20, s48, 512
buffer_load_dwordx4 v7, s[4:7], s20 offen sc1 lds
s_add_u32 m0, s49, 5120
s_add_u32 s20, s48, 768
buffer_load_dwordx4 v7, s[4:7], s20 offen sc1 lds
s_add_u32 m0, s49, 6144
s_add_u32 s20, s48, 1024
buffer_load_dwordx4 v7, s[4:7], s20 offen sc1 lds
s_add_u32 m0, s49, 7168
s_add_u32 s20, s48, 1280
buffer_load_dwordx4 v7, s[4:7], s20 offen sc1 lds
s_add_u32 m0, s49, 8192
s_add_u32 s20, s48, 1536
buffer_load_dwordx4 v7, s[4:7], s20 offen sc1 lds
s_add_u32 m0, s49, 9216
s_add_u32 s20, s48, 1792
buffer_load_dwordx4 v7, s[4:7], s20 offen sc1 lds
s_add_u32 m0, s49, 10240
s_add_u32 s20, s48, 2048
buffer_load_dwordx4 v7, s[4:7], s20 offen sc1 lds
s_add_u32 m0, s49, 11264
s_add_u32 s20, s48, 2304
buffer_load_dwordx4 v7, s[4:7], s20 offen sc1 lds
s_waitcnt vmcnt(0)
s_barrier
ds_read_b128 v[36:39], v8 offset:2048
ds_read_b128 v[40:43], v8 offset:3072
ds_read_b128 v[44:47], v8 offset:4096
ds_read_b128 v[48:51], v8 offset:5120
s_waitcnt lgkmcnt(3)
v_mfma_f32_32x32x16_bf16 v[20:35], v[36:39], a[0:3], 0
ds_read_b128 v[36:39], v8 offset:6144
s_waitcnt lgkmcnt(3)
v_mfma_f32_32x32x16_bf16 v[20:35], v[40:43], a[4:7], v[20:35]
s_waitcnt lgkmcnt(2)
ds_read_b128 v[40:43], v8 offset:7168
v_mfma_f32_32x32x16_bf16 v[20:35], v[44:47], a[8:11], v[20:35]
s_waitcnt lgkmcnt(2)
ds_read_b128 v[44:47], v8 offset:8192
v_mfma_f32_32x32x16_bf16 v[20:35], v[48:51], a[12:15], v[20:35]
s_waitcnt lgkmcnt(2)
ds_read_b128 v[48:51], v8 offset:9216
v_mfma_f32_32x32x16_bf16 v[20:35], v[36:39], a[16:19], v[20:35]
s_waitcnt lgkmcnt(2)
ds_read_b128 v[36:39], v8 offset:10240
v_mfma_f32_32x32x16_bf16 v[20:35], v[40:43], a[20:23], v[20:35]
s_waitcnt lgkmcnt(2)
ds_read_b128 v[40:43], v8 offset:11264
v_mfma_f32_32x32x16_bf16 v[20:35], v[44:47], a[24:27], v[20:35]
s_waitcnt lgkmcnt(2)
ds_read_b128 v[44:47], v8 offset:12288
v_mfma_f32_32x32x16_bf16 v[20:35], v[48:51], a[28:31], v[20:35]
s_waitcnt lgkmcnt(2)
ds_read_b128 v[48:51], v8 offset:13312
v_mfma_f32_32x32x16_bf16 v[20:35], v[36:39], a[32:35], v[20:35]
s_waitcnt lgkmcnt(2)
ds_read_b128 v[36:39], v8 offset:14336
v_mfma_f32_32x32x16_bf16 v[20:35], v[40:43], a[36:39], v[20:35]
s_waitcnt lgkmcnt(2)
ds_read_b128 v[40:43], v8 offset:15360
v_mfma_f32_32x32x16_bf16 v[20:35], v[44:47], a[40:43], v[20:35]
s_waitcnt lgkmcnt(2)
ds_read_b128 v[44:47], v8 offset:16384
v_mfma_f32_32x32x16_bf16 v[20:35], v[48:51], a[44:47], v[20:35]
s_waitcnt lgkmcnt(2)
ds_read_b128 v[48:51], v8 offset:17408
v_mfma_f32_32x32x16_bf16 v[20:35], v[36:39], a[48:51], v[20:35]
s_waitcnt lgkmcnt(2)
ds_read_b128 v[36:39], v8 offset:18432
v_mfma_f32_32x32x16_bf16 v[20:35], v[40:43], a[52:55], v[20:35]
s_waitcnt lgkmcnt(2)
ds_read_b128 v[40:43], v8 offset:19456
v_mfma_f32_32x32x16_bf16 v[20:35], v[44:47], a[56:59], v[20:35]
s_waitcnt lgkmcnt(2)
ds_read_b128 v[44:47], v8 offset:20480
v_mfma_f32_32x32x16_bf16 v[20:35], v[48:51], a[60:63], v[20:35]
s_waitcnt lgkmcnt(2)
ds_read_b128 v[48:51], v8 offset:21504
v_mfma_f32_32x32x16_bf16 v[20:35], v[36:39], a[64:67], v[20:35]
s_waitcnt lgkmcnt(2)
ds_read_b128 v[36:39], v8 offset:22528
v_mfma_f32_32x32x16_bf16 v[20:35], v[40:43], a[68:71], v[20:35]
s_waitcnt lgkmcnt(2)
ds_read_b128 v[40:43], v8 offset:23552
v_mfma_f32_32x32x16_bf16 v[20:35], v[44:47], a[72:75], v[20:35]
s_waitcnt lgkmcnt(2)
ds_read_b128 v[44:47], v8 offset:24576
v_mfma_f32_32x32x16_bf16 v[20:35], v[48:51], a[76:79], v[20:35]
s_waitcnt lgkmcnt(2)
ds_read_b128 v[48:51], v8 offset:25600
v_mfma_f32_32x32x16_bf16 v[20:35], v[36:39], a[80:83], v[20:35]
s_waitcnt lgkmcnt(2)
ds_read_b128 v[36:39], v8 offset:26624
v_mfma_f32_32x32x16_bf16 v[20:35], v[40:43], a[84:87], v[20:35]
s_waitcnt lgkmcnt(2)
ds_read_b128 v[40:43], v8 offset:27648
v_mfma_f32_32x32x16_bf16 v[20:35], v[44:47], a[88:91], v[20:35]
s_waitcnt lgkmcnt(2)
ds_read_b128 v[44:47], v8 offset:28672
v_mfma_f32_32x32x16_bf16 v[20:35], v[48:51], a[92:95], v[20:35]
s_waitcnt lgkmcnt(2)
ds_read_b128 v[48:51], v8 offset:29696
v_mfma_f32_32x32x16_bf16 v[20:35], v[36:39], a[96:99], v[20:35]
s_waitcnt lgkmcnt(2)
ds_read_b128 v[36:39], v8 offset:30720
v_mfma_f32_32x32x16_bf16 v[20:35], v[40:43], a[100:103], v[20:35]
s_waitcnt lgkmcnt(2)
ds_read_b128 v[40:43], v8 offset:31744
v_mfma_f32_32x32x16_bf16 v[20:35], v[44:47], a[104:107], v[20:35]
s_waitcnt lgkmcnt(2)
ds_read_b128 v[44:47], v8 offset:32768
v_mfma_f32_32x32x16_bf16 v[20:35], v[48:51], a[108:111], v[20:35]
s_waitcnt lgkmcnt(2)
ds_read_b128 v[48:51], v8 offset:33792
v_mfma_f32_32x32x16_bf16 v[20:35], v[36:39], a[112:115], v[20:35]
s_waitcnt lgkmcnt(2)
ds_read_b128 v[36:39], v8 offset:34816
v_mfma_f32_32x32x16_bf16 v[20:35], v[40:43], a[116:119], v[20:35]
s_waitcnt lgkmcnt(2)
ds_read_b128 v[40:43], v8 offset:35840
v_mfma_f32_32x32x16_bf16 v[20:35], v[44:47], a[120:123], v[20:35]
s_waitcnt lgkmcnt(2)
ds_read_b128 v[44:47], v8 offset:36864
v_mfma_f32_32x32x16_bf16 v[20:35], v[48:51], a[124:127], v[20:35]
s_waitcnt lgkmcnt(2)
ds_read_b128 v[48:51], v8 offset:37888
v_mfma_f32_32x32x16_bf16 v[20:35], v[36:39], a[128:131], v[20:35]
s_waitcnt lgkmcnt(2)
ds_read_b128 v[36:39], v8 offset:38912
v_mfma_f32_32x32x16_bf16 v[20:35], v[40:43], a[132:135], v[20:35]
s_waitcnt lgkmcnt(2)
ds_read_b128 v[40:43], v8 offset:39936
v_mfma_f32_32x32x16_bf16 v[20:35], v[44:47], a[136:139], v[20:35]
s_waitcnt lgkmcnt(2)
ds_read_b128 v[44:47], v8 offset:40960
v_mfma_f32_32x32x16_bf16 v[20:35], v[48:51], a[140:143], v[20:35]
s_waitcnt lgkmcnt(2)
ds_read_b128 v[48:51], v8 offset:41984
v_mfma_f32_32x32x16_bf16 v[20:35], v[36:39], a[144:147], v[20:35]
s_waitcnt lgkmcnt(2)
v_mfma_f32_32x32x16_bf16 v[20:35], v[40:43], a[148:151], v[20:35]
s_waitcnt lgkmcnt(1)
v_mfma_f32_32x32x16_bf16 v[20:35], v[44:47], a[152:155], v[20:35]
s_waitcnt lgkmcnt(0)
v_mfma_f32_32x32x16_bf16 v[20:35], v[48:51], a[156:159], v[20:35]
s_nop 11
v_cvt_pk_bf16_f32 v36, v20, v21
v_cvt_pk_bf16_f32 v37, v22, v23
v_cvt_pk_bf16_f32 v38, v24, v25
v_cvt_pk_bf16_f32 v39, v26, v27
v_cvt_pk_bf16_f32 v40, v28, v29
v_cvt_pk_bf16_f32 v41, v30, v31
v_cvt_pk_bf16_f32 v42, v32, v33
v_cvt_pk_bf16_f32 v43, v34, v35
buffer_store_dwordx4 v[36:39], v6, s[4:7], s46 offen offset:0 sc1
buffer_store_dwordx4 v[40:43], v6, s[4:7], s46 offen offset:512 sc1
s_add_u32 s48, s48, 40960
s_add_u32 s46, s46, 524288
s_add_u32 s18, s47, 8
s_cmp_eq_u32 s13, 0
s_cselect_b32 s22, s18, s6
s_mov_b32 s23, s35
s_cmp_lt_u32 s28, 64
s_cbranch_scc1 kvx_17
s_and_b32 s18, s35, 15
s_cbranch_scc1 kvm_19
s_waitcnt vmcnt(0)
s_barrier
v_mov_b32 v3, s23
s_mov_b64 exec, 1
buffer_store_dword v3, off, s[4:7], s22 sc1
s_mov_b64 exec, -1
s_mov_b32 s22, s6
s_add_u32 s16, s16, 1
s_cmp_lt_u32 s16, 2
s_cbranch_scc1 kvlay_16
s_endpgm
roleA_4:
s_sub_u32 s35, s15, 64
s_mul_i32 s46, s35, 13108
s_lshr_b32 s46, s46, 16
s_mul_i32 s18, s46, 5
s_sub_u32 s34, s35, s18
v_bfe_u32 v5, v0, 4, 5
v_mul_u32_u24 v5, 1280, v5
v_lshrrev_b32 v8, 9, v0
v_lshl_add_u32 v5, v8, 4, v5
v_and_b32 v6, 0x1ff, v0
v_lshlrev_b32 v6, 1, v6
v_lshl_add_u32 v6, v8, 4, v6
s_load_dwordx2 s[40:41], s[0:1], 0
s_mov_b32 s42, 2621440
s_mov_b32 s43, 0x20000
s_waitcnt lgkmcnt(0)
s_mul_i32 s26, s46, 40960
s_mul_i32 s18, s13, 320
s_add_u32 s26, s26, s18
s_add_u32 m0, s31, 2048
s_add_u32 s20, s26, 0
buffer_load_dwordx4 v5, s[40:43], s20 offen sc1 lds
s_add_u32 m0, s31, 3072
s_add_u32 s20, s26, 32
buffer_load_dwordx4 v5, s[40:43], s20 offen sc1 lds
s_add_u32 m0, s31, 4096
s_add_u32 s20, s26, 64
buffer_load_dwordx4 v5, s[40:43], s20 offen sc1 lds
s_add_u32 m0, s31, 5120
s_add_u32 s20, s26, 96
buffer_load_dwordx4 v5, s[40:43], s20 offen sc1 lds
s_add_u32 m0, s31, 6144
s_add_u32 s20, s26, 128
buffer_load_dwordx4 v5, s[40:43], s20 offen sc1 lds
s_add_u32 m0, s31, 7168
s_add_u32 s20, s26, 160
buffer_load_dwordx4 v5, s[40:43], s20 offen sc1 lds
s_add_u32 m0, s31, 8192
s_add_u32 s20, s26, 192
buffer_load_dwordx4 v5, s[40:43], s20 offen sc1 lds
s_add_u32 m0, s31, 9216
s_add_u32 s20, s26, 224
buffer_load_dwordx4 v5, s[40:43], s20 offen sc1 lds
s_add_u32 m0, s31, 10240
s_add_u32 s20, s26, 256
buffer_load_dwordx4 v5, s[40:43], s20 offen sc1 lds
s_add_u32 m0, s31, 11264
s_add_u32 s20, s26, 288
buffer_load_dwordx4 v5, s[40:43], s20 offen sc1 lds
s_add_u32 s26, s26, 1310720
s_add_u32 s25, s31, 40960
s_add_u32 m0, s25, 2048
s_add_u32 s20, s26, 0
buffer_load_dwordx4 v5, s[40:43], s20 offen sc1 lds
s_add_u32 m0, s25, 3072
s_add_u32 s20, s26, 32
buffer_load_dwordx4 v5, s[40:43], s20 offen sc1 lds
s_add_u32 m0, s25, 4096
s_add_u32 s20, s26, 64
buffer_load_dwordx4 v5, s[40:43], s20 offen sc1 lds
s_add_u32 m0, s25, 5120
s_add_u32 s20, s26, 96
buffer_load_dwordx4 v5, s[40:43], s20 offen sc1 lds
s_add_u32 m0, s25, 6144
s_add_u32 s20, s26, 128
buffer_load_dwordx4 v5, s[40:43], s20 offen sc1 lds
s_add_u32 m0, s25, 7168
s_add_u32 s20, s26, 160
buffer_load_dwordx4 v5, s[40:43], s20 offen sc1 lds
s_add_u32 m0, s25, 8192
s_add_u32 s20, s26, 192
buffer_load_dwordx4 v5, s[40:43], s20 offen sc1 lds
s_add_u32 m0, s25, 9216
s_add_u32 s20, s26, 224
buffer_load_dwordx4 v5, s[40:43], s20 offen sc1 lds
s_add_u32 m0, s25, 10240
s_add_u32 s20, s26, 256
buffer_load_dwordx4 v5, s[40:43], s20 offen sc1 lds
s_add_u32 m0, s25, 11264
s_add_u32 s20, s26, 288
buffer_load_dwordx4 v5, s[40:43], s20 offen sc1 lds
s_lshl_b32 s18, s34, 7
s_lshl_b32 s19, s13, 5
s_add_u32 s18, s18, s19
s_mov_b32 s19, 0x3acccccd
v_bfe_u32 v196, v0, 4, 5
v_lshrrev_b32 v193, 9, v0
v_add_u32 v196, s18, v196
v_and_b32 v194, 1, v196
v_mul_u32_u24 v194, 160, v194
v_lshrrev_b32 v192, 1, v196
v_add_u32 v192, 1, v192
v_lshlrev_b32 v193, 3, v193
v_mad_u32_u24 v194, v193, v192, v194
s_mov_b32 s20, 16
v_mad_u32_u24 v195, v192, s20, 0
v_cvt_f32_u32 v195, v195
v_mul_f32 v196, s19, v195
v_rndne_f32 v196, v196
v_fmac_f32 v195, 0xc4200000, v196
v_mul_f32 v195, s19, v195
v_cos_f32 v195, v195
s_nop 0
v_add_f32 v195, v195, v195
s_mov_b32 s20, 0
v_mad_u32_u24 v176, v192, s20, v194
v_cvt_f32_u32 v176, v176
v_mul_f32 v196, s19, v176
v_rndne_f32 v196, v196
v_fmac_f32 v176, 0xc4200000, v196
v_mul_f32 v176, s19, v176
v_cos_f32 v176, v176
s_mov_b32 s20, 1
v_mad_u32_u24 v177, v192, s20, v194
v_cvt_f32_u32 v177, v177
v_mul_f32 v196, s19, v177
v_rndne_f32 v196, v196
v_fmac_f32 v177, 0xc4200000, v196
v_mul_f32 v177, s19, v177
v_cos_f32 v177, v177
s_mov_b32 s20, 2
v_mad_u32_u24 v178, v192, s20, v194
v_cvt_f32_u32 v178, v178
v_mul_f32 v196, s19, v178
v_rndne_f32 v196, v196
v_fmac_f32 v178, 0xc4200000, v196
v_mul_f32 v178, s19, v178
v_cos_f32 v178, v178
s_mov_b32 s20, 3
v_mad_u32_u24 v179, v192, s20, v194
v_cvt_f32_u32 v179, v179
v_mul_f32 v196, s19, v179
v_rndne_f32 v196, v196
v_fmac_f32 v179, 0xc4200000, v196
v_mul_f32 v179, s19, v179
v_cos_f32 v179, v179
s_mov_b32 s20, 4
v_mad_u32_u24 v180, v192, s20, v194
v_cvt_f32_u32 v180, v180
v_mul_f32 v196, s19, v180
v_rndne_f32 v196, v196
v_fmac_f32 v180, 0xc4200000, v196
v_mul_f32 v180, s19, v180
v_cos_f32 v180, v180
s_mov_b32 s20, 5
v_mad_u32_u24 v181, v192, s20, v194
v_cvt_f32_u32 v181, v181
v_mul_f32 v196, s19, v181
v_rndne_f32 v196, v196
v_fmac_f32 v181, 0xc4200000, v196
v_mul_f32 v181, s19, v181
v_cos_f32 v181, v181
s_mov_b32 s20, 6
v_mad_u32_u24 v182, v192, s20, v194
v_cvt_f32_u32 v182, v182
v_mul_f32 v196, s19, v182
v_rndne_f32 v196, v196
v_fmac_f32 v182, 0xc4200000, v196
v_mul_f32 v182, s19, v182
v_cos_f32 v182, v182
s_mov_b32 s20, 7
v_mad_u32_u24 v183, v192, s20, v194
v_cvt_f32_u32 v183, v183
v_mul_f32 v196, s19, v183
v_rndne_f32 v196, v196
v_fmac_f32 v183, 0xc4200000, v196
v_mul_f32 v183, s19, v183
v_cos_f32 v183, v183
v_cvt_pk_bf16_f32 v16, v176, v177
v_cvt_pk_bf16_f32 v17, v178, v179
v_cvt_pk_bf16_f32 v18, v180, v181
v_cvt_pk_bf16_f32 v19, v182, v183
s_mov_b32 s20, 16
v_mad_u32_u24 v184, v192, s20, v194
v_cvt_f32_u32 v184, v184
v_mul_f32 v196, s19, v184
v_rndne_f32 v196, v196
v_fmac_f32 v184, 0xc4200000, v196
v_mul_f32 v184, s19, v184
v_cos_f32 v184, v184
s_mov_b32 s20, 17
v_mad_u32_u24 v185, v192, s20, v194
v_cvt_f32_u32 v185, v185
v_mul_f32 v196, s19, v185
v_rndne_f32 v196, v196
v_fmac_f32 v185, 0xc4200000, v196
v_mul_f32 v185, s19, v185
v_cos_f32 v185, v185
s_mov_b32 s20, 18
v_mad_u32_u24 v186, v192, s20, v194
v_cvt_f32_u32 v186, v186
v_mul_f32 v196, s19, v186
v_rndne_f32 v196, v196
v_fmac_f32 v186, 0xc4200000, v196
v_mul_f32 v186, s19, v186
v_cos_f32 v186, v186
s_mov_b32 s20, 19
v_mad_u32_u24 v187, v192, s20, v194
v_cvt_f32_u32 v187, v187
v_mul_f32 v196, s19, v187
v_rndne_f32 v196, v196
v_fmac_f32 v187, 0xc4200000, v196
v_mul_f32 v187, s19, v187
v_cos_f32 v187, v187
s_mov_b32 s20, 20
v_mad_u32_u24 v188, v192, s20, v194
v_cvt_f32_u32 v188, v188
v_mul_f32 v196, s19, v188
v_rndne_f32 v196, v196
v_fmac_f32 v188, 0xc4200000, v196
v_mul_f32 v188, s19, v188
v_cos_f32 v188, v188
s_mov_b32 s20, 21
v_mad_u32_u24 v189, v192, s20, v194
v_cvt_f32_u32 v189, v189
v_mul_f32 v196, s19, v189
v_rndne_f32 v196, v196
v_fmac_f32 v189, 0xc4200000, v196
v_mul_f32 v189, s19, v189
v_cos_f32 v189, v189
s_mov_b32 s20, 22
v_mad_u32_u24 v190, v192, s20, v194
v_cvt_f32_u32 v190, v190
v_mul_f32 v196, s19, v190
v_rndne_f32 v196, v196
v_fmac_f32 v190, 0xc4200000, v196
v_mul_f32 v190, s19, v190
v_cos_f32 v190, v190
s_mov_b32 s20, 23
v_mad_u32_u24 v191, v192, s20, v194
v_cvt_f32_u32 v191, v191
v_mul_f32 v196, s19, v191
v_rndne_f32 v196, v196
v_fmac_f32 v191, 0xc4200000, v196
v_mul_f32 v191, s19, v191
v_cos_f32 v191, v191
v_cvt_pk_bf16_f32 v20, v184, v185
v_cvt_pk_bf16_f32 v21, v186, v187
v_cvt_pk_bf16_f32 v22, v188, v189
v_cvt_pk_bf16_f32 v23, v190, v191
v_fma_f32 v176, v195, v184, -v176
v_fma_f32 v177, v195, v185, -v177
v_fma_f32 v178, v195, v186, -v178
v_fma_f32 v179, v195, v187, -v179
v_fma_f32 v180, v195, v188, -v180
v_fma_f32 v181, v195, v189, -v181
v_fma_f32 v182, v195, v190, -v182
v_fma_f32 v183, v195, v191, -v183
v_cvt_pk_bf16_f32 v24, v176, v177
v_cvt_pk_bf16_f32 v25, v178, v179
v_cvt_pk_bf16_f32 v26, v180, v181
v_cvt_pk_bf16_f32 v27, v182, v183
v_fma_f32 v184, v195, v176, -v184
v_fma_f32 v185, v195, v177, -v185
v_fma_f32 v186, v195, v178, -v186
v_fma_f32 v187, v195, v179, -v187
v_fma_f32 v188, v195, v180, -v188
v_fma_f32 v189, v195, v181, -v189
v_fma_f32 v190, v195, v182, -v190
v_fma_f32 v191, v195, v183, -v191
v_cvt_pk_bf16_f32 v28, v184, v185
v_cvt_pk_bf16_f32 v29, v186, v187
v_cvt_pk_bf16_f32 v30, v188, v189
v_cvt_pk_bf16_f32 v31, v190, v191
v_fma_f32 v176, v195, v184, -v176
v_fma_f32 v177, v195, v185, -v177
v_fma_f32 v178, v195, v186, -v178
v_fma_f32 v179, v195, v187, -v179
v_fma_f32 v180, v195, v188, -v180
v_fma_f32 v181, v195, v189, -v181
v_fma_f32 v182, v195, v190, -v182
v_fma_f32 v183, v195, v191, -v183
v_cvt_pk_bf16_f32 v32, v176, v177
v_cvt_pk_bf16_f32 v33, v178, v179
v_cvt_pk_bf16_f32 v34, v180, v181
v_cvt_pk_bf16_f32 v35, v182, v183
v_fma_f32 v184, v195, v176, -v184
v_fma_f32 v185, v195, v177, -v185
v_fma_f32 v186, v195, v178, -v186
v_fma_f32 v187, v195, v179, -v187
v_fma_f32 v188, v195, v180, -v188
v_fma_f32 v189, v195, v181, -v189
v_fma_f32 v190, v195, v182, -v190
v_fma_f32 v191, v195, v183, -v191
v_cvt_pk_bf16_f32 v36, v184, v185
v_cvt_pk_bf16_f32 v37, v186, v187
v_cvt_pk_bf16_f32 v38, v188, v189
v_cvt_pk_bf16_f32 v39, v190, v191
v_fma_f32 v176, v195, v184, -v176
v_fma_f32 v177, v195, v185, -v177
v_fma_f32 v178, v195, v186, -v178
v_fma_f32 v179, v195, v187, -v179
v_fma_f32 v180, v195, v188, -v180
v_fma_f32 v181, v195, v189, -v181
v_fma_f32 v182, v195, v190, -v182
v_fma_f32 v183, v195, v191, -v183
v_cvt_pk_bf16_f32 v40, v176, v177
v_cvt_pk_bf16_f32 v41, v178, v179
v_cvt_pk_bf16_f32 v42, v180, v181
v_cvt_pk_bf16_f32 v43, v182, v183
v_fma_f32 v184, v195, v176, -v184
v_fma_f32 v185, v195, v177, -v185
v_fma_f32 v186, v195, v178, -v186
v_fma_f32 v187, v195, v179, -v187
v_fma_f32 v188, v195, v180, -v188
v_fma_f32 v189, v195, v181, -v189
v_fma_f32 v190, v195, v182, -v190
v_fma_f32 v191, v195, v183, -v191
v_cvt_pk_bf16_f32 v44, v184, v185
v_cvt_pk_bf16_f32 v45, v186, v187
v_cvt_pk_bf16_f32 v46, v188, v189
v_cvt_pk_bf16_f32 v47, v190, v191
v_fma_f32 v176, v195, v184, -v176
v_fma_f32 v177, v195, v185, -v177
v_fma_f32 v178, v195, v186, -v178
v_fma_f32 v179, v195, v187, -v179
v_fma_f32 v180, v195, v188, -v180
v_fma_f32 v181, v195, v189, -v181
v_fma_f32 v182, v195, v190, -v182
v_fma_f32 v183, v195, v191, -v183
v_cvt_pk_bf16_f32 v48, v176, v177
v_cvt_pk_bf16_f32 v49, v178, v179
v_cvt_pk_bf16_f32 v50, v180, v181
v_cvt_pk_bf16_f32 v51, v182, v183
v_fma_f32 v184, v195, v176, -v184
v_fma_f32 v185, v195, v177, -v185
v_fma_f32 v186, v195, v178, -v186
v_fma_f32 v187, v195, v179, -v187
v_fma_f32 v188, v195, v180, -v188
v_fma_f32 v189, v195, v181, -v189
v_fma_f32 v190, v195, v182, -v190
v_fma_f32 v191, v195, v183, -v191
v_cvt_pk_bf16_f32 v52, v184, v185
v_cvt_pk_bf16_f32 v53, v186, v187
v_cvt_pk_bf16_f32 v54, v188, v189
v_cvt_pk_bf16_f32 v55, v190, v191
v_fma_f32 v176, v195, v184, -v176
v_fma_f32 v177, v195, v185, -v177
v_fma_f32 v178, v195, v186, -v178
v_fma_f32 v179, v195, v187, -v179
v_fma_f32 v180, v195, v188, -v180
v_fma_f32 v181, v195, v189, -v181
v_fma_f32 v182, v195, v190, -v182
v_fma_f32 v183, v195, v191, -v183
v_cvt_pk_bf16_f32 v56, v176, v177
v_cvt_pk_bf16_f32 v57, v178, v179
v_cvt_pk_bf16_f32 v58, v180, v181
v_cvt_pk_bf16_f32 v59, v182, v183
v_fma_f32 v184, v195, v176, -v184
v_fma_f32 v185, v195, v177, -v185
v_fma_f32 v186, v195, v178, -v186
v_fma_f32 v187, v195, v179, -v187
v_fma_f32 v188, v195, v180, -v188
v_fma_f32 v189, v195, v181, -v189
v_fma_f32 v190, v195, v182, -v190
v_fma_f32 v191, v195, v183, -v191
v_cvt_pk_bf16_f32 v60, v184, v185
v_cvt_pk_bf16_f32 v61, v186, v187
v_cvt_pk_bf16_f32 v62, v188, v189
v_cvt_pk_bf16_f32 v63, v190, v191
v_fma_f32 v176, v195, v184, -v176
v_fma_f32 v177, v195, v185, -v177
v_fma_f32 v178, v195, v186, -v178
v_fma_f32 v179, v195, v187, -v179
v_fma_f32 v180, v195, v188, -v180
v_fma_f32 v181, v195, v189, -v181
v_fma_f32 v182, v195, v190, -v182
v_fma_f32 v183, v195, v191, -v183
v_cvt_pk_bf16_f32 v64, v176, v177
v_cvt_pk_bf16_f32 v65, v178, v179
v_cvt_pk_bf16_f32 v66, v180, v181
v_cvt_pk_bf16_f32 v67, v182, v183
v_fma_f32 v184, v195, v176, -v184
v_fma_f32 v185, v195, v177, -v185
v_fma_f32 v186, v195, v178, -v186
v_fma_f32 v187, v195, v179, -v187
v_fma_f32 v188, v195, v180, -v188
v_fma_f32 v189, v195, v181, -v189
v_fma_f32 v190, v195, v182, -v190
v_fma_f32 v191, v195, v183, -v191
v_cvt_pk_bf16_f32 v68, v184, v185
v_cvt_pk_bf16_f32 v69, v186, v187
v_cvt_pk_bf16_f32 v70, v188, v189
v_cvt_pk_bf16_f32 v71, v190, v191
v_fma_f32 v176, v195, v184, -v176
v_fma_f32 v177, v195, v185, -v177
v_fma_f32 v178, v195, v186, -v178
v_fma_f32 v179, v195, v187, -v179
v_fma_f32 v180, v195, v188, -v180
v_fma_f32 v181, v195, v189, -v181
v_fma_f32 v182, v195, v190, -v182
v_fma_f32 v183, v195, v191, -v183
v_cvt_pk_bf16_f32 v72, v176, v177
v_cvt_pk_bf16_f32 v73, v178, v179
v_cvt_pk_bf16_f32 v74, v180, v181
v_cvt_pk_bf16_f32 v75, v182, v183
v_fma_f32 v184, v195, v176, -v184
v_fma_f32 v185, v195, v177, -v185
v_fma_f32 v186, v195, v178, -v186
v_fma_f32 v187, v195, v179, -v187
v_fma_f32 v188, v195, v180, -v188
v_fma_f32 v189, v195, v181, -v189
v_fma_f32 v190, v195, v182, -v190
v_fma_f32 v191, v195, v183, -v191
v_cvt_pk_bf16_f32 v76, v184, v185
v_cvt_pk_bf16_f32 v77, v186, v187
v_cvt_pk_bf16_f32 v78, v188, v189
v_cvt_pk_bf16_f32 v79, v190, v191
v_fma_f32 v176, v195, v184, -v176
v_fma_f32 v177, v195, v185, -v177
v_fma_f32 v178, v195, v186, -v178
v_fma_f32 v179, v195, v187, -v179
v_fma_f32 v180, v195, v188, -v180
v_fma_f32 v181, v195, v189, -v181
v_fma_f32 v182, v195, v190, -v182
v_fma_f32 v183, v195, v191, -v183
v_cvt_pk_bf16_f32 v80, v176, v177
v_cvt_pk_bf16_f32 v81, v178, v179
v_cvt_pk_bf16_f32 v82, v180, v181
v_cvt_pk_bf16_f32 v83, v182, v183
v_fma_f32 v184, v195, v176, -v184
v_fma_f32 v185, v195, v177, -v185
v_fma_f32 v186, v195, v178, -v186
v_fma_f32 v187, v195, v179, -v187
v_fma_f32 v188, v195, v180, -v188
v_fma_f32 v189, v195, v181, -v189
v_fma_f32 v190, v195, v182, -v190
v_fma_f32 v191, v195, v183, -v191
v_cvt_pk_bf16_f32 v84, v184, v185
v_cvt_pk_bf16_f32 v85, v186, v187
v_cvt_pk_bf16_f32 v86, v188, v189
v_cvt_pk_bf16_f32 v87, v190, v191
v_fma_f32 v176, v195, v184, -v176
v_fma_f32 v177, v195, v185, -v177
v_fma_f32 v178, v195, v186, -v178
v_fma_f32 v179, v195, v187, -v179
v_fma_f32 v180, v195, v188, -v180
v_fma_f32 v181, v195, v189, -v181
v_fma_f32 v182, v195, v190, -v182
v_fma_f32 v183, v195, v191, -v183
v_cvt_pk_bf16_f32 v88, v176, v177
v_cvt_pk_bf16_f32 v89, v178, v179
v_cvt_pk_bf16_f32 v90, v180, v181
v_cvt_pk_bf16_f32 v91, v182, v183
v_fma_f32 v184, v195, v176, -v184
v_fma_f32 v185, v195, v177, -v185
v_fma_f32 v186, v195, v178, -v186
v_fma_f32 v187, v195, v179, -v187
v_fma_f32 v188, v195, v180, -v188
v_fma_f32 v189, v195, v181, -v189
v_fma_f32 v190, v195, v182, -v190
v_fma_f32 v191, v195, v183, -v191
v_cvt_pk_bf16_f32 v92, v184, v185
v_cvt_pk_bf16_f32 v93, v186, v187
v_cvt_pk_bf16_f32 v94, v188, v189
v_cvt_pk_bf16_f32 v95, v190, v191
s_mov_b32 s20, 320
v_mad_u32_u24 v176, v192, s20, v194
v_cvt_f32_u32 v176, v176
v_mul_f32 v196, s19, v176
v_rndne_f32 v196, v196
v_fmac_f32 v176, 0xc4200000, v196
v_mul_f32 v176, s19, v176
v_cos_f32 v176, v176
s_mov_b32 s20, 321
v_mad_u32_u24 v177, v192, s20, v194
v_cvt_f32_u32 v177, v177
v_mul_f32 v196, s19, v177
v_rndne_f32 v196, v196
v_fmac_f32 v177, 0xc4200000, v196
v_mul_f32 v177, s19, v177
v_cos_f32 v177, v177
s_mov_b32 s20, 322
v_mad_u32_u24 v178, v192, s20, v194
v_cvt_f32_u32 v178, v178
v_mul_f32 v196, s19, v178
v_rndne_f32 v196, v196
v_fmac_f32 v178, 0xc4200000, v196
v_mul_f32 v178, s19, v178
v_cos_f32 v178, v178
s_mov_b32 s20, 323
v_mad_u32_u24 v179, v192, s20, v194
v_cvt_f32_u32 v179, v179
v_mul_f32 v196, s19, v179
v_rndne_f32 v196, v196
v_fmac_f32 v179, 0xc4200000, v196
v_mul_f32 v179, s19, v179
v_cos_f32 v179, v179
s_mov_b32 s20, 324
v_mad_u32_u24 v180, v192, s20, v194
v_cvt_f32_u32 v180, v180
v_mul_f32 v196, s19, v180
v_rndne_f32 v196, v196
v_fmac_f32 v180, 0xc4200000, v196
v_mul_f32 v180, s19, v180
v_cos_f32 v180, v180
s_mov_b32 s20, 325
v_mad_u32_u24 v181, v192, s20, v194
v_cvt_f32_u32 v181, v181
v_mul_f32 v196, s19, v181
v_rndne_f32 v196, v196
v_fmac_f32 v181, 0xc4200000, v196
v_mul_f32 v181, s19, v181
v_cos_f32 v181, v181
s_mov_b32 s20, 326
v_mad_u32_u24 v182, v192, s20, v194
v_cvt_f32_u32 v182, v182
v_mul_f32 v196, s19, v182
v_rndne_f32 v196, v196
v_fmac_f32 v182, 0xc4200000, v196
v_mul_f32 v182, s19, v182
v_cos_f32 v182, v182
s_mov_b32 s20, 327
v_mad_u32_u24 v183, v192, s20, v194
v_cvt_f32_u32 v183, v183
v_mul_f32 v196, s19, v183
v_rndne_f32 v196, v196
v_fmac_f32 v183, 0xc4200000, v196
v_mul_f32 v183, s19, v183
v_cos_f32 v183, v183
v_cvt_pk_bf16_f32 v96, v176, v177
v_cvt_pk_bf16_f32 v97, v178, v179
v_cvt_pk_bf16_f32 v98, v180, v181
v_cvt_pk_bf16_f32 v99, v182, v183
s_mov_b32 s20, 336
v_mad_u32_u24 v184, v192, s20, v194
v_cvt_f32_u32 v184, v184
v_mul_f32 v196, s19, v184
v_rndne_f32 v196, v196
v_fmac_f32 v184, 0xc4200000, v196
v_mul_f32 v184, s19, v184
v_cos_f32 v184, v184
s_mov_b32 s20, 337
v_mad_u32_u24 v185, v192, s20, v194
v_cvt_f32_u32 v185, v185
v_mul_f32 v196, s19, v185
v_rndne_f32 v196, v196
v_fmac_f32 v185, 0xc4200000, v196
v_mul_f32 v185, s19, v185
v_cos_f32 v185, v185
s_mov_b32 s20, 338
v_mad_u32_u24 v186, v192, s20, v194
v_cvt_f32_u32 v186, v186
v_mul_f32 v196, s19, v186
v_rndne_f32 v196, v196
v_fmac_f32 v186, 0xc4200000, v196
v_mul_f32 v186, s19, v186
v_cos_f32 v186, v186
s_mov_b32 s20, 339
v_mad_u32_u24 v187, v192, s20, v194
v_cvt_f32_u32 v187, v187
v_mul_f32 v196, s19, v187
v_rndne_f32 v196, v196
v_fmac_f32 v187, 0xc4200000, v196
v_mul_f32 v187, s19, v187
v_cos_f32 v187, v187
s_mov_b32 s20, 340
v_mad_u32_u24 v188, v192, s20, v194
v_cvt_f32_u32 v188, v188
v_mul_f32 v196, s19, v188
v_rndne_f32 v196, v196
v_fmac_f32 v188, 0xc4200000, v196
v_mul_f32 v188, s19, v188
v_cos_f32 v188, v188
s_mov_b32 s20, 341
v_mad_u32_u24 v189, v192, s20, v194
v_cvt_f32_u32 v189, v189
v_mul_f32 v196, s19, v189
v_rndne_f32 v196, v196
v_fmac_f32 v189, 0xc4200000, v196
v_mul_f32 v189, s19, v189
v_cos_f32 v189, v189
s_mov_b32 s20, 342
v_mad_u32_u24 v190, v192, s20, v194
v_cvt_f32_u32 v190, v190
v_mul_f32 v196, s19, v190
v_rndne_f32 v196, v196
v_fmac_f32 v190, 0xc4200000, v196
v_mul_f32 v190, s19, v190
v_cos_f32 v190, v190
s_mov_b32 s20, 343
v_mad_u32_u24 v191, v192, s20, v194
v_cvt_f32_u32 v191, v191
v_mul_f32 v196, s19, v191
v_rndne_f32 v196, v196
v_fmac_f32 v191, 0xc4200000, v196
v_mul_f32 v191, s19, v191
v_cos_f32 v191, v191
v_cvt_pk_bf16_f32 v100, v184, v185
v_cvt_pk_bf16_f32 v101, v186, v187
v_cvt_pk_bf16_f32 v102, v188, v189
v_cvt_pk_bf16_f32 v103, v190, v191
v_fma_f32 v176, v195, v184, -v176
v_fma_f32 v177, v195, v185, -v177
v_fma_f32 v178, v195, v186, -v178
v_fma_f32 v179, v195, v187, -v179
v_fma_f32 v180, v195, v188, -v180
v_fma_f32 v181, v195, v189, -v181
v_fma_f32 v182, v195, v190, -v182
v_fma_f32 v183, v195, v191, -v183
v_cvt_pk_bf16_f32 v104, v176, v177
v_cvt_pk_bf16_f32 v105, v178, v179
v_cvt_pk_bf16_f32 v106, v180, v181
v_cvt_pk_bf16_f32 v107, v182, v183
v_fma_f32 v184, v195, v176, -v184
v_fma_f32 v185, v195, v177, -v185
v_fma_f32 v186, v195, v178, -v186
v_fma_f32 v187, v195, v179, -v187
v_fma_f32 v188, v195, v180, -v188
v_fma_f32 v189, v195, v181, -v189
v_fma_f32 v190, v195, v182, -v190
v_fma_f32 v191, v195, v183, -v191
v_cvt_pk_bf16_f32 v108, v184, v185
v_cvt_pk_bf16_f32 v109, v186, v187
v_cvt_pk_bf16_f32 v110, v188, v189
v_cvt_pk_bf16_f32 v111, v190, v191
v_fma_f32 v176, v195, v184, -v176
v_fma_f32 v177, v195, v185, -v177
v_fma_f32 v178, v195, v186, -v178
v_fma_f32 v179, v195, v187, -v179
v_fma_f32 v180, v195, v188, -v180
v_fma_f32 v181, v195, v189, -v181
v_fma_f32 v182, v195, v190, -v182
v_fma_f32 v183, v195, v191, -v183
v_cvt_pk_bf16_f32 v112, v176, v177
v_cvt_pk_bf16_f32 v113, v178, v179
v_cvt_pk_bf16_f32 v114, v180, v181
v_cvt_pk_bf16_f32 v115, v182, v183
v_fma_f32 v184, v195, v176, -v184
v_fma_f32 v185, v195, v177, -v185
v_fma_f32 v186, v195, v178, -v186
v_fma_f32 v187, v195, v179, -v187
v_fma_f32 v188, v195, v180, -v188
v_fma_f32 v189, v195, v181, -v189
v_fma_f32 v190, v195, v182, -v190
v_fma_f32 v191, v195, v183, -v191
v_cvt_pk_bf16_f32 v116, v184, v185
v_cvt_pk_bf16_f32 v117, v186, v187
v_cvt_pk_bf16_f32 v118, v188, v189
v_cvt_pk_bf16_f32 v119, v190, v191
v_fma_f32 v176, v195, v184, -v176
v_fma_f32 v177, v195, v185, -v177
v_fma_f32 v178, v195, v186, -v178
v_fma_f32 v179, v195, v187, -v179
v_fma_f32 v180, v195, v188, -v180
v_fma_f32 v181, v195, v189, -v181
v_fma_f32 v182, v195, v190, -v182
v_fma_f32 v183, v195, v191, -v183
v_cvt_pk_bf16_f32 v120, v176, v177
v_cvt_pk_bf16_f32 v121, v178, v179
v_cvt_pk_bf16_f32 v122, v180, v181
v_cvt_pk_bf16_f32 v123, v182, v183
v_fma_f32 v184, v195, v176, -v184
v_fma_f32 v185, v195, v177, -v185
v_fma_f32 v186, v195, v178, -v186
v_fma_f32 v187, v195, v179, -v187
v_fma_f32 v188, v195, v180, -v188
v_fma_f32 v189, v195, v181, -v189
v_fma_f32 v190, v195, v182, -v190
v_fma_f32 v191, v195, v183, -v191
v_cvt_pk_bf16_f32 v124, v184, v185
v_cvt_pk_bf16_f32 v125, v186, v187
v_cvt_pk_bf16_f32 v126, v188, v189
v_cvt_pk_bf16_f32 v127, v190, v191
v_fma_f32 v176, v195, v184, -v176
v_fma_f32 v177, v195, v185, -v177
v_fma_f32 v178, v195, v186, -v178
v_fma_f32 v179, v195, v187, -v179
v_fma_f32 v180, v195, v188, -v180
v_fma_f32 v181, v195, v189, -v181
v_fma_f32 v182, v195, v190, -v182
v_fma_f32 v183, v195, v191, -v183
v_cvt_pk_bf16_f32 v128, v176, v177
v_cvt_pk_bf16_f32 v129, v178, v179
v_cvt_pk_bf16_f32 v130, v180, v181
v_cvt_pk_bf16_f32 v131, v182, v183
v_fma_f32 v184, v195, v176, -v184
v_fma_f32 v185, v195, v177, -v185
v_fma_f32 v186, v195, v178, -v186
v_fma_f32 v187, v195, v179, -v187
v_fma_f32 v188, v195, v180, -v188
v_fma_f32 v189, v195, v181, -v189
v_fma_f32 v190, v195, v182, -v190
v_fma_f32 v191, v195, v183, -v191
v_cvt_pk_bf16_f32 v132, v184, v185
v_cvt_pk_bf16_f32 v133, v186, v187
v_cvt_pk_bf16_f32 v134, v188, v189
v_cvt_pk_bf16_f32 v135, v190, v191
v_fma_f32 v176, v195, v184, -v176
v_fma_f32 v177, v195, v185, -v177
v_fma_f32 v178, v195, v186, -v178
v_fma_f32 v179, v195, v187, -v179
v_fma_f32 v180, v195, v188, -v180
v_fma_f32 v181, v195, v189, -v181
v_fma_f32 v182, v195, v190, -v182
v_fma_f32 v183, v195, v191, -v183
v_cvt_pk_bf16_f32 v136, v176, v177
v_cvt_pk_bf16_f32 v137, v178, v179
v_cvt_pk_bf16_f32 v138, v180, v181
v_cvt_pk_bf16_f32 v139, v182, v183
v_fma_f32 v184, v195, v176, -v184
v_fma_f32 v185, v195, v177, -v185
v_fma_f32 v186, v195, v178, -v186
v_fma_f32 v187, v195, v179, -v187
v_fma_f32 v188, v195, v180, -v188
v_fma_f32 v189, v195, v181, -v189
v_fma_f32 v190, v195, v182, -v190
v_fma_f32 v191, v195, v183, -v191
v_cvt_pk_bf16_f32 v140, v184, v185
v_cvt_pk_bf16_f32 v141, v186, v187
v_cvt_pk_bf16_f32 v142, v188, v189
v_cvt_pk_bf16_f32 v143, v190, v191
v_fma_f32 v176, v195, v184, -v176
v_fma_f32 v177, v195, v185, -v177
v_fma_f32 v178, v195, v186, -v178
v_fma_f32 v179, v195, v187, -v179
v_fma_f32 v180, v195, v188, -v180
v_fma_f32 v181, v195, v189, -v181
v_fma_f32 v182, v195, v190, -v182
v_fma_f32 v183, v195, v191, -v183
v_cvt_pk_bf16_f32 v144, v176, v177
v_cvt_pk_bf16_f32 v145, v178, v179
v_cvt_pk_bf16_f32 v146, v180, v181
v_cvt_pk_bf16_f32 v147, v182, v183
v_fma_f32 v184, v195, v176, -v184
v_fma_f32 v185, v195, v177, -v185
v_fma_f32 v186, v195, v178, -v186
v_fma_f32 v187, v195, v179, -v187
v_fma_f32 v188, v195, v180, -v188
v_fma_f32 v189, v195, v181, -v189
v_fma_f32 v190, v195, v182, -v190
v_fma_f32 v191, v195, v183, -v191
v_cvt_pk_bf16_f32 v148, v184, v185
v_cvt_pk_bf16_f32 v149, v186, v187
v_cvt_pk_bf16_f32 v150, v188, v189
v_cvt_pk_bf16_f32 v151, v190, v191
v_fma_f32 v176, v195, v184, -v176
v_fma_f32 v177, v195, v185, -v177
v_fma_f32 v178, v195, v186, -v178
v_fma_f32 v179, v195, v187, -v179
v_fma_f32 v180, v195, v188, -v180
v_fma_f32 v181, v195, v189, -v181
v_fma_f32 v182, v195, v190, -v182
v_fma_f32 v183, v195, v191, -v183
v_cvt_pk_bf16_f32 v152, v176, v177
v_cvt_pk_bf16_f32 v153, v178, v179
v_cvt_pk_bf16_f32 v154, v180, v181
v_cvt_pk_bf16_f32 v155, v182, v183
v_fma_f32 v184, v195, v176, -v184
v_fma_f32 v185, v195, v177, -v185
v_fma_f32 v186, v195, v178, -v186
v_fma_f32 v187, v195, v179, -v187
v_fma_f32 v188, v195, v180, -v188
v_fma_f32 v189, v195, v181, -v189
v_fma_f32 v190, v195, v182, -v190
v_fma_f32 v191, v195, v183, -v191
v_cvt_pk_bf16_f32 v156, v184, v185
v_cvt_pk_bf16_f32 v157, v186, v187
v_cvt_pk_bf16_f32 v158, v188, v189
v_cvt_pk_bf16_f32 v159, v190, v191
v_fma_f32 v176, v195, v184, -v176
v_fma_f32 v177, v195, v185, -v177
v_fma_f32 v178, v195, v186, -v178
v_fma_f32 v179, v195, v187, -v179
v_fma_f32 v180, v195, v188, -v180
v_fma_f32 v181, v195, v189, -v181
v_fma_f32 v182, v195, v190, -v182
v_fma_f32 v183, v195, v191, -v183
v_cvt_pk_bf16_f32 v160, v176, v177
v_cvt_pk_bf16_f32 v161, v178, v179
v_cvt_pk_bf16_f32 v162, v180, v181
v_cvt_pk_bf16_f32 v163, v182, v183
v_fma_f32 v184, v195, v176, -v184
v_fma_f32 v185, v195, v177, -v185
v_fma_f32 v186, v195, v178, -v186
v_fma_f32 v187, v195, v179, -v187
v_fma_f32 v188, v195, v180, -v188
v_fma_f32 v189, v195, v181, -v189
v_fma_f32 v190, v195, v182, -v190
v_fma_f32 v191, v195, v183, -v191
v_cvt_pk_bf16_f32 v164, v184, v185
v_cvt_pk_bf16_f32 v165, v186, v187
v_cvt_pk_bf16_f32 v166, v188, v189
v_cvt_pk_bf16_f32 v167, v190, v191
v_fma_f32 v176, v195, v184, -v176
v_fma_f32 v177, v195, v185, -v177
v_fma_f32 v178, v195, v186, -v178
v_fma_f32 v179, v195, v187, -v179
v_fma_f32 v180, v195, v188, -v180
v_fma_f32 v181, v195, v189, -v181
v_fma_f32 v182, v195, v190, -v182
v_fma_f32 v183, v195, v191, -v183
v_cvt_pk_bf16_f32 v168, v176, v177
v_cvt_pk_bf16_f32 v169, v178, v179
v_cvt_pk_bf16_f32 v170, v180, v181
v_cvt_pk_bf16_f32 v171, v182, v183
v_fma_f32 v184, v195, v176, -v184
v_fma_f32 v185, v195, v177, -v185
v_fma_f32 v186, v195, v178, -v186
v_fma_f32 v187, v195, v179, -v187
v_fma_f32 v188, v195, v180, -v188
v_fma_f32 v189, v195, v181, -v189
v_fma_f32 v190, v195, v182, -v190
v_fma_f32 v191, v195, v183, -v191
v_cvt_pk_bf16_f32 v172, v184, v185
v_cvt_pk_bf16_f32 v173, v186, v187
v_cvt_pk_bf16_f32 v174, v188, v189
v_cvt_pk_bf16_f32 v175, v190, v191
v_accvgpr_write_b32 a0, v16
v_accvgpr_write_b32 a1, v17
v_accvgpr_write_b32 a2, v18
v_accvgpr_write_b32 a3, v19
v_accvgpr_write_b32 a4, v20
v_accvgpr_write_b32 a5, v21
v_accvgpr_write_b32 a6, v22
v_accvgpr_write_b32 a7, v23
v_accvgpr_write_b32 a8, v24
v_accvgpr_write_b32 a9, v25
v_accvgpr_write_b32 a10, v26
v_accvgpr_write_b32 a11, v27
v_accvgpr_write_b32 a12, v28
v_accvgpr_write_b32 a13, v29
v_accvgpr_write_b32 a14, v30
v_accvgpr_write_b32 a15, v31
v_accvgpr_write_b32 a16, v32
v_accvgpr_write_b32 a17, v33
v_accvgpr_write_b32 a18, v34
v_accvgpr_write_b32 a19, v35
v_accvgpr_write_b32 a20, v36
v_accvgpr_write_b32 a21, v37
v_accvgpr_write_b32 a22, v38
v_accvgpr_write_b32 a23, v39
v_accvgpr_write_b32 a24, v40
v_accvgpr_write_b32 a25, v41
v_accvgpr_write_b32 a26, v42
v_accvgpr_write_b32 a27, v43
v_accvgpr_write_b32 a28, v44
v_accvgpr_write_b32 a29, v45
v_accvgpr_write_b32 a30, v46
v_accvgpr_write_b32 a31, v47
v_accvgpr_write_b32 a32, v48
v_accvgpr_write_b32 a33, v49
v_accvgpr_write_b32 a34, v50
v_accvgpr_write_b32 a35, v51
v_accvgpr_write_b32 a36, v52
v_accvgpr_write_b32 a37, v53
v_accvgpr_write_b32 a38, v54
v_accvgpr_write_b32 a39, v55
v_accvgpr_write_b32 a40, v56
v_accvgpr_write_b32 a41, v57
v_accvgpr_write_b32 a42, v58
v_accvgpr_write_b32 a43, v59
v_accvgpr_write_b32 a44, v60
v_accvgpr_write_b32 a45, v61
v_accvgpr_write_b32 a46, v62
v_accvgpr_write_b32 a47, v63
v_accvgpr_write_b32 a48, v64
v_accvgpr_write_b32 a49, v65
v_accvgpr_write_b32 a50, v66
v_accvgpr_write_b32 a51, v67
v_accvgpr_write_b32 a52, v68
v_accvgpr_write_b32 a53, v69
v_accvgpr_write_b32 a54, v70
v_accvgpr_write_b32 a55, v71
v_accvgpr_write_b32 a56, v72
v_accvgpr_write_b32 a57, v73
v_accvgpr_write_b32 a58, v74
v_accvgpr_write_b32 a59, v75
v_accvgpr_write_b32 a60, v76
v_accvgpr_write_b32 a61, v77
v_accvgpr_write_b32 a62, v78
v_accvgpr_write_b32 a63, v79
v_accvgpr_write_b32 a64, v80
v_accvgpr_write_b32 a65, v81
v_accvgpr_write_b32 a66, v82
v_accvgpr_write_b32 a67, v83
v_accvgpr_write_b32 a68, v84
v_accvgpr_write_b32 a69, v85
v_accvgpr_write_b32 a70, v86
v_accvgpr_write_b32 a71, v87
v_accvgpr_write_b32 a72, v88
v_accvgpr_write_b32 a73, v89
v_accvgpr_write_b32 a74, v90
v_accvgpr_write_b32 a75, v91
v_accvgpr_write_b32 a76, v92
v_accvgpr_write_b32 a77, v93
v_accvgpr_write_b32 a78, v94
v_accvgpr_write_b32 a79, v95
v_accvgpr_write_b32 a80, v96
v_accvgpr_write_b32 a81, v97
v_accvgpr_write_b32 a82, v98
v_accvgpr_write_b32 a83, v99
v_accvgpr_write_b32 a84, v100
v_accvgpr_write_b32 a85, v101
v_accvgpr_write_b32 a86, v102
v_accvgpr_write_b32 a87, v103
v_accvgpr_write_b32 a88, v104
v_accvgpr_write_b32 a89, v105
v_accvgpr_write_b32 a90, v106
v_accvgpr_write_b32 a91, v107
v_accvgpr_write_b32 a92, v108
v_accvgpr_write_b32 a93, v109
v_accvgpr_write_b32 a94, v110
v_accvgpr_write_b32 a95, v111
v_accvgpr_write_b32 a96, v112
v_accvgpr_write_b32 a97, v113
v_accvgpr_write_b32 a98, v114
v_accvgpr_write_b32 a99, v115
v_accvgpr_write_b32 a100, v116
v_accvgpr_write_b32 a101, v117
v_accvgpr_write_b32 a102, v118
v_accvgpr_write_b32 a103, v119
v_accvgpr_write_b32 a104, v120
v_accvgpr_write_b32 a105, v121
v_accvgpr_write_b32 a106, v122
v_accvgpr_write_b32 a107, v123
v_accvgpr_write_b32 a108, v124
v_accvgpr_write_b32 a109, v125
v_accvgpr_write_b32 a110, v126
v_accvgpr_write_b32 a111, v127
v_accvgpr_write_b32 a112, v128
v_accvgpr_write_b32 a113, v129
v_accvgpr_write_b32 a114, v130
v_accvgpr_write_b32 a115, v131
v_accvgpr_write_b32 a116, v132
v_accvgpr_write_b32 a117, v133
v_accvgpr_write_b32 a118, v134
v_accvgpr_write_b32 a119, v135
v_accvgpr_write_b32 a120, v136
v_accvgpr_write_b32 a121, v137
v_accvgpr_write_b32 a122, v138
v_accvgpr_write_b32 a123, v139
v_accvgpr_write_b32 a124, v140
v_accvgpr_write_b32 a125, v141
v_accvgpr_write_b32 a126, v142
v_accvgpr_write_b32 a127, v143
v_accvgpr_write_b32 a128, v144
v_accvgpr_write_b32 a129, v145
v_accvgpr_write_b32 a130, v146
v_accvgpr_write_b32 a131, v147
v_accvgpr_write_b32 a132, v148
v_accvgpr_write_b32 a133, v149
v_accvgpr_write_b32 a134, v150
v_accvgpr_write_b32 a135, v151
v_accvgpr_write_b32 a136, v152
v_accvgpr_write_b32 a137, v153
v_accvgpr_write_b32 a138, v154
v_accvgpr_write_b32 a139, v155
v_accvgpr_write_b32 a140, v156
v_accvgpr_write_b32 a141, v157
v_accvgpr_write_b32 a142, v158
v_accvgpr_write_b32 a143, v159
v_accvgpr_write_b32 a144, v160
v_accvgpr_write_b32 a145, v161
v_accvgpr_write_b32 a146, v162
v_accvgpr_write_b32 a147, v163
v_accvgpr_write_b32 a148, v164
v_accvgpr_write_b32 a149, v165
v_accvgpr_write_b32 a150, v166
v_accvgpr_write_b32 a151, v167
v_accvgpr_write_b32 a152, v168
v_accvgpr_write_b32 a153, v169
v_accvgpr_write_b32 a154, v170
v_accvgpr_write_b32 a155, v171
v_accvgpr_write_b32 a156, v172
v_accvgpr_write_b32 a157, v173
v_accvgpr_write_b32 a158, v174
v_accvgpr_write_b32 a159, v175
v_mov_b32 v16, s24
v_mov_b32 v17, s24
v_mov_b32 v18, s24
v_mov_b32 v19, s24
s_nop 1
v_mfma_f32_32x32x16_bf16 v[20:35], v[16:19], a[0:3], 0
v_mfma_f32_32x32x16_bf16 v[20:35], v[16:19], a[4:7], v[20:35]
v_mfma_f32_32x32x16_bf16 v[20:35], v[16:19], a[8:11], v[20:35]
v_mfma_f32_32x32x16_bf16 v[20:35], v[16:19], a[12:15], v[20:35]
v_mfma_f32_32x32x16_bf16 v[20:35], v[16:19], a[16:19], v[20:35]
v_mfma_f32_32x32x16_bf16 v[20:35], v[16:19], a[20:23], v[20:35]
v_mfma_f32_32x32x16_bf16 v[20:35], v[16:19], a[24:27], v[20:35]
v_mfma_f32_32x32x16_bf16 v[20:35], v[16:19], a[28:31], v[20:35]
v_mfma_f32_32x32x16_bf16 v[20:35], v[16:19], a[32:35], v[20:35]
v_mfma_f32_32x32x16_bf16 v[20:35], v[16:19], a[36:39], v[20:35]
v_mfma_f32_32x32x16_bf16 v[20:35], v[16:19], a[40:43], v[20:35]
v_mfma_f32_32x32x16_bf16 v[20:35], v[16:19], a[44:47], v[20:35]
v_mfma_f32_32x32x16_bf16 v[20:35], v[16:19], a[48:51], v[20:35]
v_mfma_f32_32x32x16_bf16 v[20:35], v[16:19], a[52:55], v[20:35]
v_mfma_f32_32x32x16_bf16 v[20:35], v[16:19], a[56:59], v[20:35]
v_mfma_f32_32x32x16_bf16 v[20:35], v[16:19], a[60:63], v[20:35]
v_mfma_f32_32x32x16_bf16 v[20:35], v[16:19], a[64:67], v[20:35]
v_mfma_f32_32x32x16_bf16 v[20:35], v[16:19], a[68:71], v[20:35]
v_mfma_f32_32x32x16_bf16 v[20:35], v[16:19], a[72:75], v[20:35]
v_mfma_f32_32x32x16_bf16 v[20:35], v[16:19], a[76:79], v[20:35]
v_mfma_f32_32x32x16_bf16 v[20:35], v[16:19], a[80:83], v[20:35]
v_mfma_f32_32x32x16_bf16 v[20:35], v[16:19], a[84:87], v[20:35]
v_mfma_f32_32x32x16_bf16 v[20:35], v[16:19], a[88:91], v[20:35]
v_mfma_f32_32x32x16_bf16 v[20:35], v[16:19], a[92:95], v[20:35]
v_mfma_f32_32x32x16_bf16 v[20:35], v[16:19], a[96:99], v[20:35]
v_mfma_f32_32x32x16_bf16 v[20:35], v[16:19], a[100:103], v[20:35]
v_mfma_f32_32x32x16_bf16 v[20:35], v[16:19], a[104:107], v[20:35]
v_mfma_f32_32x32x16_bf16 v[20:35], v[16:19], a[108:111], v[20:35]
v_mfma_f32_32x32x16_bf16 v[20:35], v[16:19], a[112:115], v[20:35]
v_mfma_f32_32x32x16_bf16 v[20:35], v[16:19], a[116:119], v[20:35]
v_mfma_f32_32x32x16_bf16 v[20:35], v[16:19], a[120:123], v[20:35]
v_mfma_f32_32x32x16_bf16 v[20:35], v[16:19], a[124:127], v[20:35]
v_mfma_f32_32x32x16_bf16 v[20:35], v[16:19], a[128:131], v[20:35]
v_mfma_f32_32x32x16_bf16 v[20:35], v[16:19], a[132:135], v[20:35]
v_mfma_f32_32x32x16_bf16 v[20:35], v[16:19], a[136:139], v[20:35]
v_mfma_f32_32x32x16_bf16 v[20:35], v[16:19], a[140:143], v[20:35]
v_mfma_f32_32x32x16_bf16 v[20:35], v[16:19], a[144:147], v[20:35]
v_mfma_f32_32x32x16_bf16 v[20:35], v[16:19], a[148:151], v[20:35]
v_mfma_f32_32x32x16_bf16 v[20:35], v[16:19], a[152:155], v[20:35]
v_mfma_f32_32x32x16_bf16 v[20:35], v[16:19], a[156:159], v[20:35]
s_nop 11
v_mov_b32 v7, v20
s_lshl_b32 s18, s34, 2
s_add_u32 s18, s18, s13
s_lshl_b32 s33, s18, 11
s_mul_i32 s27, s46, 40960
s_add_u32 s27, s27, s33
s_add_u32 s27, s27, 97517568
s_mov_b32 s28, 0
v_mov_b32 v1, v0
p1_27:
s_waitcnt vmcnt(0)
s_barrier
ds_read_b128 v[32:35], v1 offset:2048
v_add_u32 v2, s31, v1
ds_read_b128 v[48:51], v2 offset:2048
v_mov_b64 v[56:57], 0
ds_read_b128 v[36:39], v1 offset:3072
ds_read_b128 v[40:43], v1 offset:4096
ds_read_b128 v[44:47], v1 offset:5120
ds_read_b128 v[52:55], v2 offset:3072
s_waitcnt lgkmcnt(5)
v_mfma_f32_32x32x16_bf16 v[16:31], v[32:35], a[0:3], 0
ds_read_b128 v[32:35], v1 offset:6144
s_waitcnt lgkmcnt(5)
v_dot2c_f32_bf16 v56, s24, v48
v_dot2c_f32_bf16 v57, v48, v48
v_dot2c_f32_bf16 v57, v49, v49
s_waitcnt lgkmcnt(4)
v_mfma_f32_32x32x16_bf16 v[16:31], v[36:39], a[4:7], v[16:31]
v_dot2c_f32_bf16 v56, s24, v49
v_dot2c_f32_bf16 v56, s24, v50
s_waitcnt lgkmcnt(3)
v_dot2c_f32_bf16 v57, v50, v50
v_dot2c_f32_bf16 v57, v51, v51
v_dot2c_f32_bf16 v56, s24, v51
v_mfma_f32_32x32x16_bf16 v[16:31], v[40:43], a[8:11], v[16:31]
ds_read_b128 v[40:43], v1 offset:8192
s_waitcnt lgkmcnt(2)
ds_read_b128 v[36:39], v1 offset:7168
v_dot2c_f32_bf16 v57, v52, v52
v_dot2c_f32_bf16 v57, v53, v53
v_dot2c_f32_bf16 v57, v54, v54
v_mfma_f32_32x32x16_bf16 v[16:31], v[44:47], a[12:15], v[16:31]
ds_read_b128 v[48:51], v2 offset:4096
ds_read_b128 v[44:47], v1 offset:9216
s_waitcnt lgkmcnt(4)
v_dot2c_f32_bf16 v56, s24, v52
v_dot2c_f32_bf16 v56, s24, v53
v_dot2c_f32_bf16 v57, v55, v55
v_mfma_f32_32x32x16_bf16 v[16:31], v[32:35], a[16:19], v[16:31]
v_dot2c_f32_bf16 v56, s24, v54
v_dot2c_f32_bf16 v56, s24, v55
s_waitcnt lgkmcnt(2)
ds_read_b128 v[52:55], v2 offset:5120
v_mfma_f32_32x32x16_bf16 v[16:31], v[36:39], a[20:23], v[16:31]
ds_read_b128 v[36:39], v1 offset:11264
ds_read_b128 v[32:35], v1 offset:10240
s_waitcnt lgkmcnt(3)
v_dot2c_f32_bf16 v57, v48, v48
v_mfma_f32_32x32x16_bf16 v[16:31], v[40:43], a[24:27], v[16:31]
ds_read_b128 v[40:43], v1 offset:12288
v_dot2c_f32_bf16 v57, v49, v49
v_dot2c_f32_bf16 v56, s24, v48
v_dot2c_f32_bf16 v57, v50, v50
v_dot2c_f32_bf16 v56, s24, v49
s_waitcnt lgkmcnt(3)
v_mfma_f32_32x32x16_bf16 v[16:31], v[44:47], a[28:31], v[16:31]
ds_read_b128 v[44:47], v1 offset:13312
v_dot2c_f32_bf16 v57, v51, v51
v_dot2c_f32_bf16 v56, s24, v50
v_dot2c_f32_bf16 v56, s24, v51
v_dot2c_f32_bf16 v56, s24, v52
s_waitcnt lgkmcnt(2)
v_mfma_f32_32x32x16_bf16 v[16:31], v[32:35], a[32:35], v[16:31]
v_dot2c_f32_bf16 v57, v52, v52
ds_read_b128 v[48:51], v2 offset:6144
ds_read_b128 v[32:35], v1 offset:14336
v_mfma_f32_32x32x16_bf16 v[16:31], v[36:39], a[36:39], v[16:31]
ds_read_b128 v[36:39], v1 offset:15360
s_waitcnt lgkmcnt(3)
v_dot2c_f32_bf16 v56, s24, v53
v_dot2c_f32_bf16 v57, v53, v53
v_dot2c_f32_bf16 v57, v54, v54
v_dot2c_f32_bf16 v56, s24, v54
v_mfma_f32_32x32x16_bf16 v[16:31], v[40:43], a[40:43], v[16:31]
v_dot2c_f32_bf16 v56, s24, v55
v_dot2c_f32_bf16 v57, v55, v55
s_waitcnt lgkmcnt(2)
ds_read_b128 v[40:43], v1 offset:16384
v_dot2c_f32_bf16 v56, s24, v48
v_mfma_f32_32x32x16_bf16 v[16:31], v[44:47], a[44:47], v[16:31]
ds_read_b128 v[52:55], v2 offset:7168
s_waitcnt lgkmcnt(3)
ds_read_b128 v[44:47], v1 offset:17408
v_dot2c_f32_bf16 v56, s24, v49
v_dot2c_f32_bf16 v57, v48, v48
v_mov_b32 v3, s23
v_mfma_f32_32x32x16_bf16 v[16:31], v[32:35], a[48:51], v[16:31]
s_waitcnt lgkmcnt(3)
ds_read_b128 v[32:35], v1 offset:18432
v_dot2c_f32_bf16 v57, v49, v49
v_dot2c_f32_bf16 v56, s24, v50
v_dot2c_f32_bf16 v57, v50, v50
v_dot2c_f32_bf16 v56, s24, v51
v_dot2c_f32_bf16 v57, v51, v51
v_mfma_f32_32x32x16_bf16 v[16:31], v[36:39], a[52:55], v[16:31]
s_waitcnt lgkmcnt(2)
ds_read_b128 v[48:51], v2 offset:8192
v_dot2c_f32_bf16 v56, s24, v52
v_dot2c_f32_bf16 v57, v52, v52
v_dot2c_f32_bf16 v57, v53, v53
v_dot2c_f32_bf16 v57, v54, v54
v_mfma_f32_32x32x16_bf16 v[16:31], v[40:43], a[56:59], v[16:31]
s_waitcnt lgkmcnt(2)
ds_read_b128 v[40:43], v1 offset:20480
ds_read_b128 v[36:39], v1 offset:19456
v_dot2c_f32_bf16 v56, s24, v53
v_dot2c_f32_bf16 v56, s24, v54
v_dot2c_f32_bf16 v57, v55, v55
v_dot2c_f32_bf16 v56, s24, v55
v_mfma_f32_32x32x16_bf16 v[16:31], v[44:47], a[60:63], v[16:31]
ds_read_b128 v[52:55], v2 offset:9216
s_waitcnt lgkmcnt(3)
ds_read_b128 v[44:47], v1 offset:21504
v_dot2c_f32_bf16 v56, s24, v48
v_dot2c_f32_bf16 v56, s24, v49
v_dot2c_f32_bf16 v56, s24, v50
v_mfma_f32_32x32x16_bf16 v[16:31], v[32:35], a[64:67], v[16:31]
ds_read_b128 v[32:35], v1 offset:22528
v_dot2c_f32_bf16 v57, v48, v48
v_dot2c_f32_bf16 v57, v49, v49
v_dot2c_f32_bf16 v56, s24, v51
v_dot2c_f32_bf16 v57, v50, v50
s_waitcnt lgkmcnt(3)
v_dot2c_f32_bf16 v57, v51, v51
v_mfma_f32_32x32x16_bf16 v[16:31], v[36:39], a[68:71], v[16:31]
s_waitcnt lgkmcnt(2)
ds_read_b128 v[48:51], v2 offset:10240
v_dot2c_f32_bf16 v57, v52, v52
v_dot2c_f32_bf16 v56, s24, v52
v_dot2c_f32_bf16 v56, s24, v53
v_dot2c_f32_bf16 v57, v53, v53
v_mfma_f32_32x32x16_bf16 v[16:31], v[40:43], a[72:75], v[16:31]
s_waitcnt lgkmcnt(1)
ds_read_b128 v[40:43], v1 offset:24576
ds_read_b128 v[36:39], v1 offset:23552
v_dot2c_f32_bf16 v56, s24, v54
v_dot2c_f32_bf16 v56, s24, v55
v_dot2c_f32_bf16 v57, v54, v54
v_dot2c_f32_bf16 v57, v55, v55
v_mfma_f32_32x32x16_bf16 v[16:31], v[44:47], a[76:79], v[16:31]
ds_read_b128 v[52:55], v2 offset:11264
s_waitcnt lgkmcnt(3)
v_dot2c_f32_bf16 v57, v48, v48
v_dot2c_f32_bf16 v56, s24, v48
v_dot2c_f32_bf16 v56, s24, v49
v_dot2c_f32_bf16 v56, s24, v50
v_mfma_f32_32x32x16_bf16 v[16:31], v[32:35], a[80:83], v[16:31]
ds_read_b128 v[44:47], v1 offset:25600
ds_read_b128 v[32:35], v1 offset:26624
v_dot2c_f32_bf16 v57, v49, v49
v_dot2c_f32_bf16 v56, s24, v51
v_dot2c_f32_bf16 v57, v50, v50
s_waitcnt lgkmcnt(3)
v_dot2c_f32_bf16 v57, v51, v51
v_mfma_f32_32x32x16_bf16 v[16:31], v[36:39], a[84:87], v[16:31]
s_waitcnt lgkmcnt(2)
v_dot2c_f32_bf16 v56, s24, v52
v_dot2c_f32_bf16 v56, s24, v53
v_dot2c_f32_bf16 v57, v52, v52
v_dot2c_f32_bf16 v56, s24, v54
v_dot2c_f32_bf16 v56, s24, v55
v_dot2c_f32_bf16 v57, v53, v53
v_mfma_f32_32x32x16_bf16 v[16:31], v[40:43], a[88:91], v[16:31]
s_waitcnt lgkmcnt(1)
ds_read_b128 v[40:43], v1 offset:28672
v_dot2c_f32_bf16 v57, v54, v54
v_dot2c_f32_bf16 v57, v55, v55
ds_read_b128 v[36:39], v1 offset:27648
v_mfma_f32_32x32x16_bf16 v[16:31], v[44:47], a[92:95], v[16:31]
s_nop 0
v_permlane32_swap_b32 v56, v57
v_add_f32 v56, v56, v57
v_lshl_add_u32 v57, s13, 2, v0
s_waitcnt lgkmcnt(2)
ds_write_b32 v57, v56 offset:0
v_mfma_f32_32x32x16_bf16 v[16:31], v[32:35], a[96:99], v[16:31]
ds_read_b128 v[32:35], v1 offset:30720
s_waitcnt lgkmcnt(2)
ds_read_b128 v[44:47], v1 offset:29696
v_and_b32 v48, 0x1ff, v0
v_mfma_f32_32x32x16_bf16 v[16:31], v[36:39], a[100:103], v[16:31]
ds_read_b128 v[36:39], v1 offset:31744
s_waitcnt lgkmcnt(3)
v_mfma_f32_32x32x16_bf16 v[16:31], v[40:43], a[104:107], v[16:31]
s_barrier
ds_read_b128 v[60:63], v48 offset:512
s_waitcnt lgkmcnt(2)
ds_read_b128 v[56:59], v48 offset:0
v_mfma_f32_32x32x16_bf16 v[16:31], v[44:47], a[108:111], v[16:31]
s_waitcnt lgkmcnt(2)
ds_read_b128 v[40:43], v1 offset:32768
ds_read_b128 v[44:47], v1 offset:33792
v_mfma_f32_32x32x16_bf16 v[16:31], v[32:35], a[112:115], v[16:31]
ds_read_b128 v[32:35], v1 offset:34816
s_waitcnt lgkmcnt(4)
v_mfma_f32_32x32x16_bf16 v[16:31], v[36:39], a[116:119], v[16:31]
s_waitcnt lgkmcnt(3)
ds_read_b128 v[36:39], v1 offset:35840
v_add_f32 v62, v62, v63
v_add_f32 v58, v58, v59
v_add_f32 v56, v56, v57
s_waitcnt lgkmcnt(3)
v_add_f32 v56, v56, v58
v_mfma_f32_32x32x16_bf16 v[16:31], v[40:43], a[120:123], v[16:31]
v_add_f32 v60, v60, v61
v_add_f32 v60, v60, v62
v_mul_f32 v56, 0x3acccccd, v56
s_waitcnt lgkmcnt(1)
v_mul_f32 v60, 0x3acccccd, v60
v_fma_f32 v60, -v56, v56, v60
v_mfma_f32_32x32x16_bf16 v[16:31], v[44:47], a[124:127], v[16:31]
ds_read_b128 v[40:43], v1 offset:36864
ds_read_b128 v[44:47], v1 offset:37888
v_max_f32 v60, 0, v60
v_add_f32 v60, 0x3727c5ac, v60
v_rsq_f32 v60, v60
v_mfma_f32_32x32x16_bf16 v[16:31], v[32:35], a[128:131], v[16:31]
s_waitcnt lgkmcnt(2)
v_mul_f32 v56, v60, v56
v_bfe_u32 v58, v0, 5, 5
v_and_b32 v58, 16, v58
v_lshrrev_b32 v57, 2, v0
v_permlane32_swap_b32 v60, v56
v_mfma_f32_32x32x16_bf16 v[16:31], v[36:39], a[132:135], v[16:31]
ds_read_b128 v[32:35], v1 offset:38912
s_waitcnt lgkmcnt(2)
ds_read_b128 v[36:39], v1 offset:39936
v_lshl_add_u32 v58, s13, 8, v58
v_lshl_add_u32 v57, s13, 8, v57
v_mfma_f32_32x32x16_bf16 v[16:31], v[40:43], a[136:139], v[16:31]
ds_write_b32 v57, v60 offset:1024
s_waitcnt lgkmcnt(3)
ds_read_b128 v[88:91], v58 offset:1216
ds_read_b128 v[40:43], v1 offset:40960
v_mfma_f32_32x32x16_bf16 v[16:31], v[44:47], a[140:143], v[16:31]
ds_read_b128 v[80:83], v58 offset:1152
s_waitcnt lgkmcnt(5)
ds_read_b128 v[44:47], v1 offset:41984
ds_read_b128 v[84:87], v58 offset:1184
s_waitcnt lgkmcnt(6)
v_mfma_f32_32x32x16_bf16 v[16:31], v[32:35], a[144:147], v[16:31]
ds_read_b128 v[92:95], v58 offset:1248
ds_read_b128 v[64:67], v58 offset:1024
s_mov_b64 exec, 1
buffer_store_dword v3, off, s[4:7], s22 sc1
s_mov_b64 exec, -1
v_mfma_f32_32x32x16_bf16 v[16:31], v[36:39], a[148:151], v[16:31]
s_waitcnt lgkmcnt(6)
ds_read_b128 v[72:75], v58 offset:1088
s_waitcnt lgkmcnt(6)
ds_read_b128 v[68:71], v58 offset:1056
ds_read_b128 v[76:79], v58 offset:1120
v_mul_f32 v88, v88, v7
v_mfma_f32_32x32x16_bf16 v[16:31], v[40:43], a[152:155], v[16:31]
s_waitcnt lgkmcnt(6)
v_mul_f32 v90, v90, v7
v_mul_f32 v81, v81, v7
v_mul_f32 v82, v82, v7
v_mul_f32 v89, v89, v7
s_waitcnt lgkmcnt(5)
v_mul_f32 v91, v91, v7
v_mfma_f32_32x32x16_bf16 v[16:31], v[44:47], a[156:159], v[16:31]
s_waitcnt lgkmcnt(4)
v_mul_f32 v87, v87, v7
v_mul_f32 v93, v93, v7
v_mul_f32 v86, v86, v7
v_mul_f32 v83, v83, v7
v_mul_f32 v85, v85, v7
v_mul_f32 v80, v80, v7
v_mul_f32 v95, v95, v7
s_waitcnt lgkmcnt(2)
v_mul_f32 v92, v92, v7
v_mul_f32 v94, v94, v7
v_mul_f32 v84, v84, v7
v_fma_f32 v19, v19, v67, -v83
v_fma_f32 v25, v25, v73, -v89
v_fma_f32 v17, v17, v65, -v81
v_fma_f32 v18, v18, v66, -v82
s_waitcnt lgkmcnt(0)
v_fma_f32 v22, v22, v70, -v86
v_fma_f32 v26, v26, v74, -v90
v_fma_f32 v16, v16, v64, -v80
v_fma_f32 v23, v23, v71, -v87
v_fma_f32 v27, v27, v75, -v91
v_fma_f32 v30, v30, v78, -v94
v_fma_f32 v21, v21, v69, -v85
v_fma_f32 v29, v29, v77, -v93
v_fma_f32 v31, v31, v79, -v95
v_cvt_pk_bf16_f32 v39, v30, v31
v_fma_f32 v28, v28, v76, -v92
v_fma_f32 v20, v20, v68, -v84
v_cvt_pk_bf16_f32 v37, v26, v27
v_cvt_pk_bf16_f32 v34, v20, v21
v_fma_f32 v24, v24, v72, -v88
v_cvt_pk_bf16_f32 v35, v22, v23
v_cvt_pk_bf16_f32 v32, v16, v17
v_cvt_pk_bf16_f32 v38, v28, v29
v_cvt_pk_bf16_f32 v36, v24, v25
v_cvt_pk_bf16_f32 v33, v18, v19
buffer_store_dwordx4 v[32:35], v6, s[4:7], s27 offen offset:0 sc1
buffer_store_dwordx4 v[36:39], v6, s[4:7], s27 offen offset:1024 sc1
v_xor_b32 v1, 40960, v1
s_add_u32 s27, s27, 1310720
s_add_u32 s28, s28, 1
s_cmp_lt_u32 s28, 2
s_cbranch_scc1 p1_27
s_lshl_b32 s18, s35, 2
s_add_u32 s18, s18, 5120
s_cmp_eq_u32 s13, 0
s_cselect_b32 s22, s18, s6
s_mov_b32 s23, 1
s_waitcnt vmcnt(0)
s_barrier
v_mov_b32 v3, s23
s_mov_b64 exec, 1
buffer_store_dword v3, off, s[4:7], s22 sc1
s_mov_b64 exec, -1
s_mov_b32 s22, s6
s_load_dwordx2 s[36:37], s[0:1], 8
s_mov_b32 s38, 1314816
s_mov_b32 s39, 0x20000
s_waitcnt lgkmcnt(0)
s_load_dwordx2 s[48:49], s[0:1], 16
s_mov_b32 s50, 1314816
s_mov_b32 s51, 0x20000
s_waitcnt lgkmcnt(0)
v_bfe_u32 v13, v0, 4, 4
v_and_b32 v3, 0x300, v0
v_add_u32 v13, v13, v3
v_lshl_add_u32 v13, s13, 4, v13
v_mul_u32_u24 v13, 642, v13
s_lshl_b32 s18, s35, 2
s_add_u32 s18, s18, 2
s_add_u32 s19, s18, 0
buffer_load_ushort v16, v13, s[36:39], s19 offen offset:0
buffer_load_ushort v32, v13, s[48:51], s19 offen offset:0
buffer_load_ushort v24, v13, s[36:39], s19 offen offset:2
buffer_load_ushort v40, v13, s[48:51], s19 offen offset:2
s_add_u32 s19, s18, 41088
buffer_load_ushort v17, v13, s[36:39], s19 offen offset:0
buffer_load_ushort v33, v13, s[48:51], s19 offen offset:0
buffer_load_ushort v25, v13, s[36:39], s19 offen offset:2
buffer_load_ushort v41, v13, s[48:51], s19 offen offset:2
s_add_u32 s19, s18, 82176
buffer_load_ushort v18, v13, s[36:39], s19 offen offset:0
buffer_load_ushort v34, v13, s[48:51], s19 offen offset:0
buffer_load_ushort v26, v13, s[36:39], s19 offen offset:2
buffer_load_ushort v42, v13, s[48:51], s19 offen offset:2
s_add_u32 s19, s18, 123264
buffer_load_ushort v19, v13, s[36:39], s19 offen offset:0
buffer_load_ushort v35, v13, s[48:51], s19 offen offset:0
buffer_load_ushort v27, v13, s[36:39], s19 offen offset:2
buffer_load_ushort v43, v13, s[48:51], s19 offen offset:2
s_add_u32 s19, s18, 657408
buffer_load_ushort v20, v13, s[36:39], s19 offen offset:0
buffer_load_ushort v36, v13, s[48:51], s19 offen offset:0
buffer_load_ushort v28, v13, s[36:39], s19 offen offset:2
buffer_load_ushort v44, v13, s[48:51], s19 offen offset:2
s_add_u32 s19, s18, 698496
buffer_load_ushort v21, v13, s[36:39], s19 offen offset:0
buffer_load_ushort v37, v13, s[48:51], s19 offen offset:0
buffer_load_ushort v29, v13, s[36:39], s19 offen offset:2
buffer_load_ushort v45, v13, s[48:51], s19 offen offset:2
s_add_u32 s19, s18, 739584
buffer_load_ushort v22, v13, s[36:39], s19 offen offset:0
buffer_load_ushort v38, v13, s[48:51], s19 offen offset:0
buffer_load_ushort v30, v13, s[36:39], s19 offen offset:2
buffer_load_ushort v46, v13, s[48:51], s19 offen offset:2
s_add_u32 s19, s18, 780672
buffer_load_ushort v23, v13, s[36:39], s19 offen offset:0
buffer_load_ushort v39, v13, s[48:51], s19 offen offset:0
buffer_load_ushort v31, v13, s[36:39], s19 offen offset:2
buffer_load_ushort v47, v13, s[48:51], s19 offen offset:2
s_lshl_b32 s18, s13, 12
s_add_u32 s18, s18, 147456
v_add_u32 v13, s18, v0
s_waitcnt vmcnt(30)
v_lshl_or_b32 v16, v32, 16, v16
s_waitcnt vmcnt(26)
v_lshl_or_b32 v17, v33, 16, v17
s_waitcnt vmcnt(22)
v_lshl_or_b32 v18, v34, 16, v18
s_waitcnt vmcnt(18)
v_lshl_or_b32 v19, v35, 16, v19
s_waitcnt vmcnt(14)
v_lshl_or_b32 v20, v36, 16, v20
s_waitcnt vmcnt(10)
v_lshl_or_b32 v21, v37, 16, v21
s_waitcnt vmcnt(6)
v_lshl_or_b32 v22, v38, 16, v22
s_waitcnt vmcnt(2)
v_lshl_or_b32 v23, v39, 16, v23
v_lshl_or_b32 v24, v40, 16, v24
v_lshl_or_b32 v25, v41, 16, v25
v_lshl_or_b32 v26, v42, 16, v26
v_lshl_or_b32 v27, v43, 16, v27
v_lshl_or_b32 v28, v44, 16, v28
v_lshl_or_b32 v29, v45, 16, v29
v_lshl_or_b32 v30, v46, 16, v30
s_waitcnt vmcnt(0)
v_lshl_or_b32 v31, v47, 16, v31
ds_write_b128 v13, v[16:19] offset:0
ds_write_b128 v13, v[20:23] offset:1024
ds_write_b128 v13, v[24:27] offset:2048
ds_write_b128 v13, v[28:31] offset:3072
alay_28:
v_bfe_u32 v96, v0, 4, 4
v_lshrrev_b32 v97, 8, v0
v_lshlrev_b32 v97, 2, v97
v_lshl_add_u32 v98, s13, 4, v96
v_add_u32 v99, 0, v97
v_mul_u32_u24 v99, v99, v98
v_and_b32 v99, 63, v99
v_cvt_f32_u32 v99, v99
v_mul_f32 v99, 0x3c800000, v99
v_cos_f32 v104, v99
v_sin_f32 v112, v99
v_add_u32 v99, 1, v97
v_mul_u32_u24 v99, v99, v98
v_and_b32 v99, 63, v99
v_cvt_f32_u32 v99, v99
v_mul_f32 v99, 0x3c800000, v99
v_cos_f32 v105, v99
v_sin_f32 v113, v99
v_add_u32 v99, 2, v97
v_mul_u32_u24 v99, v99, v98
v_and_b32 v99, 63, v99
v_cvt_f32_u32 v99, v99
v_mul_f32 v99, 0x3c800000, v99
v_cos_f32 v106, v99
v_sin_f32 v114, v99
v_add_u32 v99, 3, v97
v_mul_u32_u24 v99, v99, v98
v_and_b32 v99, 63, v99
v_cvt_f32_u32 v99, v99
v_mul_f32 v99, 0x3c800000, v99
v_cos_f32 v107, v99
v_sin_f32 v115, v99
v_add_u32 v99, 16, v97
v_mul_u32_u24 v99, v99, v98
v_and_b32 v99, 63, v99
v_cvt_f32_u32 v99, v99
v_mul_f32 v99, 0x3c800000, v99
v_cos_f32 v108, v99
v_sin_f32 v116, v99
v_add_u32 v99, 17, v97
v_mul_u32_u24 v99, v99, v98
v_and_b32 v99, 63, v99
v_cvt_f32_u32 v99, v99
v_mul_f32 v99, 0x3c800000, v99
v_cos_f32 v109, v99
v_sin_f32 v117, v99
v_add_u32 v99, 18, v97
v_mul_u32_u24 v99, v99, v98
v_and_b32 v99, 63, v99
v_cvt_f32_u32 v99, v99
v_mul_f32 v99, 0x3c800000, v99
v_cos_f32 v110, v99
v_sin_f32 v118, v99
v_add_u32 v99, 19, v97
v_mul_u32_u24 v99, v99, v98
v_and_b32 v99, 63, v99
v_cvt_f32_u32 v99, v99
v_mul_f32 v99, 0x3c800000, v99
v_cos_f32 v111, v99
v_sin_f32 v119, v99
v_cvt_pk_bf16_f32 v16, v104, v105
v_cvt_pk_bf16_f32 v24, v112, v113
v_xor_b32 v32, 0x80008000, v24
v_cvt_pk_bf16_f32 v17, v106, v107
v_cvt_pk_bf16_f32 v25, v114, v115
v_xor_b32 v33, 0x80008000, v25
v_cvt_pk_bf16_f32 v18, v108, v109
v_cvt_pk_bf16_f32 v26, v116, v117
v_xor_b32 v34, 0x80008000, v26
v_cvt_pk_bf16_f32 v19, v110, v111
v_cvt_pk_bf16_f32 v27, v118, v119
v_xor_b32 v35, 0x80008000, v27
v_add_u32 v99, 32, v97
v_mul_u32_u24 v99, v99, v98
v_and_b32 v99, 63, v99
v_cvt_f32_u32 v99, v99
v_mul_f32 v99, 0x3c800000, v99
v_cos_f32 v104, v99
v_sin_f32 v112, v99
v_add_u32 v99, 33, v97
v_mul_u32_u24 v99, v99, v98
v_and_b32 v99, 63, v99
v_cvt_f32_u32 v99, v99
v_mul_f32 v99, 0x3c800000, v99
v_cos_f32 v105, v99
v_sin_f32 v113, v99
v_add_u32 v99, 34, v97
v_mul_u32_u24 v99, v99, v98
v_and_b32 v99, 63, v99
v_cvt_f32_u32 v99, v99
v_mul_f32 v99, 0x3c800000, v99
v_cos_f32 v106, v99
v_sin_f32 v114, v99
v_add_u32 v99, 35, v97
v_mul_u32_u24 v99, v99, v98
v_and_b32 v99, 63, v99
v_cvt_f32_u32 v99, v99
v_mul_f32 v99, 0x3c800000, v99
v_cos_f32 v107, v99
v_sin_f32 v115, v99
v_add_u32 v99, 48, v97
v_mul_u32_u24 v99, v99, v98
v_and_b32 v99, 63, v99
v_cvt_f32_u32 v99, v99
v_mul_f32 v99, 0x3c800000, v99
v_cos_f32 v108, v99
v_sin_f32 v116, v99
v_add_u32 v99, 49, v97
v_mul_u32_u24 v99, v99, v98
v_and_b32 v99, 63, v99
v_cvt_f32_u32 v99, v99
v_mul_f32 v99, 0x3c800000, v99
v_cos_f32 v109, v99
v_sin_f32 v117, v99
v_add_u32 v99, 50, v97
v_mul_u32_u24 v99, v99, v98
v_and_b32 v99, 63, v99
v_cvt_f32_u32 v99, v99
v_mul_f32 v99, 0x3c800000, v99
v_cos_f32 v110, v99
v_sin_f32 v118, v99
v_add_u32 v99, 51, v97
v_mul_u32_u24 v99, v99, v98
v_and_b32 v99, 63, v99
v_cvt_f32_u32 v99, v99
v_mul_f32 v99, 0x3c800000, v99
v_cos_f32 v111, v99
v_sin_f32 v119, v99
v_cvt_pk_bf16_f32 v20, v104, v105
v_cvt_pk_bf16_f32 v28, v112, v113
v_xor_b32 v36, 0x80008000, v28
v_cvt_pk_bf16_f32 v21, v106, v107
v_cvt_pk_bf16_f32 v29, v114, v115
v_xor_b32 v37, 0x80008000, v29
v_cvt_pk_bf16_f32 v22, v108, v109
v_cvt_pk_bf16_f32 v30, v116, v117
v_xor_b32 v38, 0x80008000, v30
v_cvt_pk_bf16_f32 v23, v110, v111
v_cvt_pk_bf16_f32 v31, v118, v119
v_xor_b32 v39, 0x80008000, v31
v_add_u32 v99, 0, v97
v_mul_u32_u24 v99, v99, v98
v_and_b32 v99, 2047, v99
v_cvt_f32_u32 v99, v99
v_mul_f32 v99, 0x3a000000, v99
v_cos_f32 v64, v99
v_sin_f32 v72, v99
v_add_u32 v99, 1, v97
v_mul_u32_u24 v99, v99, v98
v_and_b32 v99, 2047, v99
v_cvt_f32_u32 v99, v99
v_mul_f32 v99, 0x3a000000, v99
v_cos_f32 v65, v99
v_sin_f32 v73, v99
v_add_u32 v99, 2, v97
v_mul_u32_u24 v99, v99, v98
v_and_b32 v99, 2047, v99
v_cvt_f32_u32 v99, v99
v_mul_f32 v99, 0x3a000000, v99
v_cos_f32 v66, v99
v_sin_f32 v74, v99
v_add_u32 v99, 3, v97
v_mul_u32_u24 v99, v99, v98
v_and_b32 v99, 2047, v99
v_cvt_f32_u32 v99, v99
v_mul_f32 v99, 0x3a000000, v99
v_cos_f32 v67, v99
v_sin_f32 v75, v99
v_add_u32 v99, 16, v97
v_mul_u32_u24 v99, v99, v98
v_and_b32 v99, 2047, v99
v_cvt_f32_u32 v99, v99
v_mul_f32 v99, 0x3a000000, v99
v_cos_f32 v68, v99
v_sin_f32 v76, v99
v_add_u32 v99, 17, v97
v_mul_u32_u24 v99, v99, v98
v_and_b32 v99, 2047, v99
v_cvt_f32_u32 v99, v99
v_mul_f32 v99, 0x3a000000, v99
v_cos_f32 v69, v99
v_sin_f32 v77, v99
v_add_u32 v99, 18, v97
v_mul_u32_u24 v99, v99, v98
v_and_b32 v99, 2047, v99
v_cvt_f32_u32 v99, v99
v_mul_f32 v99, 0x3a000000, v99
v_cos_f32 v70, v99
v_sin_f32 v78, v99
v_add_u32 v99, 19, v97
v_mul_u32_u24 v99, v99, v98
v_and_b32 v99, 2047, v99
v_cvt_f32_u32 v99, v99
v_mul_f32 v99, 0x3a000000, v99
v_cos_f32 v71, v99
v_sin_f32 v79, v99
v_lshl_add_u32 v100, s13, 4, v97
v_add_u32 v98, 0, v96
v_add_u32 v99, 0, v97
v_mul_u32_u24 v99, v99, v98
v_and_b32 v99, 31, v99
v_cvt_f32_u32 v99, v99
v_mul_f32 v99, 0x3d000000, v99
v_cos_f32 v104, v99
v_sin_f32 v112, v99
v_add_u32 v99, 1, v97
v_mul_u32_u24 v99, v99, v98
v_and_b32 v99, 31, v99
v_cvt_f32_u32 v99, v99
v_mul_f32 v99, 0x3d000000, v99
v_cos_f32 v105, v99
v_sin_f32 v113, v99
v_add_u32 v99, 2, v97
v_mul_u32_u24 v99, v99, v98
v_and_b32 v99, 31, v99
v_cvt_f32_u32 v99, v99
v_mul_f32 v99, 0x3d000000, v99
v_cos_f32 v106, v99
v_sin_f32 v114, v99
v_add_u32 v99, 3, v97
v_mul_u32_u24 v99, v99, v98
v_and_b32 v99, 31, v99
v_cvt_f32_u32 v99, v99
v_mul_f32 v99, 0x3d000000, v99
v_cos_f32 v107, v99
v_sin_f32 v115, v99
v_add_u32 v99, 16, v97
v_mul_u32_u24 v99, v99, v98
v_and_b32 v99, 31, v99
v_cvt_f32_u32 v99, v99
v_mul_f32 v99, 0x3d000000, v99
v_cos_f32 v108, v99
v_sin_f32 v116, v99
v_add_u32 v99, 17, v97
v_mul_u32_u24 v99, v99, v98
v_and_b32 v99, 31, v99
v_cvt_f32_u32 v99, v99
v_mul_f32 v99, 0x3d000000, v99
v_cos_f32 v109, v99
v_sin_f32 v117, v99
v_add_u32 v99, 18, v97
v_mul_u32_u24 v99, v99, v98
v_and_b32 v99, 31, v99
v_cvt_f32_u32 v99, v99
v_mul_f32 v99, 0x3d000000, v99
v_cos_f32 v110, v99
v_sin_f32 v118, v99
v_add_u32 v99, 19, v97
v_mul_u32_u24 v99, v99, v98
v_and_b32 v99, 31, v99
v_cvt_f32_u32 v99, v99
v_mul_f32 v99, 0x3d000000, v99
v_cos_f32 v111, v99
v_sin_f32 v119, v99
v_cvt_pk_bf16_f32 v40, v104, v105
v_cvt_pk_bf16_f32 v48, v112, v113
v_xor_b32 v56, 0x80008000, v48
v_cvt_pk_bf16_f32 v41, v106, v107
v_cvt_pk_bf16_f32 v49, v114, v115
v_xor_b32 v57, 0x80008000, v49
v_cvt_pk_bf16_f32 v42, v108, v109
v_cvt_pk_bf16_f32 v50, v116, v117
v_xor_b32 v58, 0x80008000, v50
v_cvt_pk_bf16_f32 v43, v110, v111
v_cvt_pk_bf16_f32 v51, v118, v119
v_xor_b32 v59, 0x80008000, v51
v_add_u32 v99, 0, v100
v_mul_u32_u24 v99, v99, v98
v_and_b32 v99, 2047, v99
v_cvt_f32_u32 v99, v99
v_mul_f32 v99, 0x3a000000, v99
v_cos_f32 v80, v99
v_sin_f32 v88, v99
v_mul_f32 v80, 0x3a000000, v80
v_mul_f32 v88, 0x3a000000, v88
v_add_u32 v99, 1, v100
v_mul_u32_u24 v99, v99, v98
v_and_b32 v99, 2047, v99
v_cvt_f32_u32 v99, v99
v_mul_f32 v99, 0x3a000000, v99
v_cos_f32 v81, v99
v_sin_f32 v89, v99
v_mul_f32 v81, 0x3a000000, v81
v_mul_f32 v89, 0x3a000000, v89
v_add_u32 v99, 2, v100
v_mul_u32_u24 v99, v99, v98
v_and_b32 v99, 2047, v99
v_cvt_f32_u32 v99, v99
v_mul_f32 v99, 0x3a000000, v99
v_cos_f32 v82, v99
v_sin_f32 v90, v99
v_mul_f32 v82, 0x3a000000, v82
v_mul_f32 v90, 0x3a000000, v90
v_add_u32 v99, 3, v100
v_mul_u32_u24 v99, v99, v98
v_and_b32 v99, 2047, v99
v_cvt_f32_u32 v99, v99
v_mul_f32 v99, 0x3a000000, v99
v_cos_f32 v83, v99
v_sin_f32 v91, v99
v_mul_f32 v83, 0x3a000000, v83
v_mul_f32 v91, 0x3a000000, v91
v_add_u32 v98, 16, v96
v_add_u32 v99, 0, v97
v_mul_u32_u24 v99, v99, v98
v_and_b32 v99, 31, v99
v_cvt_f32_u32 v99, v99
v_mul_f32 v99, 0x3d000000, v99
v_cos_f32 v104, v99
v_sin_f32 v112, v99
v_add_u32 v99, 1, v97
v_mul_u32_u24 v99, v99, v98
v_and_b32 v99, 31, v99
v_cvt_f32_u32 v99, v99
v_mul_f32 v99, 0x3d000000, v99
v_cos_f32 v105, v99
v_sin_f32 v113, v99
v_add_u32 v99, 2, v97
v_mul_u32_u24 v99, v99, v98
v_and_b32 v99, 31, v99
v_cvt_f32_u32 v99, v99
v_mul_f32 v99, 0x3d000000, v99
v_cos_f32 v106, v99
v_sin_f32 v114, v99
v_add_u32 v99, 3, v97
v_mul_u32_u24 v99, v99, v98
v_and_b32 v99, 31, v99
v_cvt_f32_u32 v99, v99
v_mul_f32 v99, 0x3d000000, v99
v_cos_f32 v107, v99
v_sin_f32 v115, v99
v_add_u32 v99, 16, v97
v_mul_u32_u24 v99, v99, v98
v_and_b32 v99, 31, v99
v_cvt_f32_u32 v99, v99
v_mul_f32 v99, 0x3d000000, v99
v_cos_f32 v108, v99
v_sin_f32 v116, v99
v_add_u32 v99, 17, v97
v_mul_u32_u24 v99, v99, v98
v_and_b32 v99, 31, v99
v_cvt_f32_u32 v99, v99
v_mul_f32 v99, 0x3d000000, v99
v_cos_f32 v109, v99
v_sin_f32 v117, v99
v_add_u32 v99, 18, v97
v_mul_u32_u24 v99, v99, v98
v_and_b32 v99, 31, v99
v_cvt_f32_u32 v99, v99
v_mul_f32 v99, 0x3d000000, v99
v_cos_f32 v110, v99
v_sin_f32 v118, v99
v_add_u32 v99, 19, v97
v_mul_u32_u24 v99, v99, v98
v_and_b32 v99, 31, v99
v_cvt_f32_u32 v99, v99
v_mul_f32 v99, 0x3d000000, v99
v_cos_f32 v111, v99
v_sin_f32 v119, v99
v_cvt_pk_bf16_f32 v44, v104, v105
v_cvt_pk_bf16_f32 v52, v112, v113
v_xor_b32 v60, 0x80008000, v52
v_cvt_pk_bf16_f32 v45, v106, v107
v_cvt_pk_bf16_f32 v53, v114, v115
v_xor_b32 v61, 0x80008000, v53
v_cvt_pk_bf16_f32 v46, v108, v109
v_cvt_pk_bf16_f32 v54, v116, v117
v_xor_b32 v62, 0x80008000, v54
v_cvt_pk_bf16_f32 v47, v110, v111
v_cvt_pk_bf16_f32 v55, v118, v119
v_xor_b32 v63, 0x80008000, v55
v_add_u32 v99, 0, v100
v_mul_u32_u24 v99, v99, v98
v_and_b32 v99, 2047, v99
v_cvt_f32_u32 v99, v99
v_mul_f32 v99, 0x3a000000, v99
v_cos_f32 v84, v99
v_sin_f32 v92, v99
v_mul_f32 v84, 0x3a000000, v84
v_mul_f32 v92, 0x3a000000, v92
v_add_u32 v99, 1, v100
v_mul_u32_u24 v99, v99, v98
v_and_b32 v99, 2047, v99
v_cvt_f32_u32 v99, v99
v_mul_f32 v99, 0x3a000000, v99
v_cos_f32 v85, v99
v_sin_f32 v93, v99
v_mul_f32 v85, 0x3a000000, v85
v_mul_f32 v93, 0x3a000000, v93
v_add_u32 v99, 2, v100
v_mul_u32_u24 v99, v99, v98
v_and_b32 v99, 2047, v99
v_cvt_f32_u32 v99, v99
v_mul_f32 v99, 0x3a000000, v99
v_cos_f32 v86, v99
v_sin_f32 v94, v99
v_mul_f32 v86, 0x3a000000, v86
v_mul_f32 v94, 0x3a000000, v94
v_add_u32 v99, 3, v100
v_mul_u32_u24 v99, v99, v98
v_and_b32 v99, 2047, v99
v_cvt_f32_u32 v99, v99
v_mul_f32 v99, 0x3a000000, v99
v_cos_f32 v87, v99
v_sin_f32 v95, v99
v_mul_f32 v87, 0x3a000000, v87
v_mul_f32 v95, 0x3a000000, v95
v_lshrrev_b32 v98, 6, v0
v_and_b32 v99, 7, v98
v_lshlrev_b32 v99, 5, v99
v_lshl_add_u32 v98, v98, 8, v99
v_and_b32 v99, 16, v0
v_add_u32 v98, v98, v99
v_bfe_u32 v99, v0, 5, 1
v_lshl_add_u32 v224, v99, 3, v98
v_xor_b32 v225, 32, v224
v_xor_b32 v226, 64, v224
v_xor_b32 v227, 96, v224
v_xor_b32 v228, 128, v224
v_xor_b32 v229, 160, v224
v_xor_b32 v230, 192, v224
v_xor_b32 v231, 224, v224
v_lshrrev_b32 v98, 8, v0
v_bfe_u32 v99, v0, 5, 3
v_xor_b32 v99, v99, v98
v_mul_u32_u24 v98, 40960, v98
v_and_b32 v96, 16, v0
v_add_u32 v98, v98, v96
v_and_b32 v96, 3, v99
v_lshl_add_u32 v98, v96, 5, v98
v_lshrrev_b32 v99, 2, v99
v_lshl_add_u32 v232, v99, 10, v98
v_xor_b32 v99, 1, v99
v_lshl_add_u32 v233, v99, 10, v98
s_lshl_b32 s18, s13, 12
s_add_u32 s19, s18, 147456
v_add_u32 v99, s19, v0
ds_read_b128 v[208:211], v99 offset:0
ds_read_b128 v[212:215], v99 offset:1024
ds_read_b128 v[216:219], v99 offset:2048
ds_read_b128 v[220:223], v99 offset:3072
s_mov_b32 s25, s18
s_mul_i32 s26, s16, 3145728
s_mul_i32 s19, s13, 655360
s_add_u32 s26, s26, s19
s_lshl_b32 s19, s35, 8
s_add_u32 s27, s26, s19
s_add_u32 s27, s27, 103809024
s_lshr_b32 s19, s35, 3
s_lshl_b32 s19, s19, 11
s_add_u32 s26, s26, s19
s_and_b32 s19, s35, 7
s_lshl_b32 s19, s19, 7
s_add_u32 s26, s26, s19
s_add_u32 s26, s26, 97517568
s_cmp_lg_u32 s16, 0
s_cbranch_scc1 cw_29
s_cmp_lg_u32 s13, 0
s_cbranch_scc1 polld_32
v_min_u32 v12, 624, v0
s_mov_b32 s21, 5120
s_mov_b32 s17, 0
poll_31:
buffer_load_dwordx4 v[8:11], v12, s[4:7], s21 offen offset:0 sc1
s_add_u32 s17, s17, 1
s_cmp_gt_u32 s17, 262144
s_cbranch_scc1 L_fail
s_waitcnt vmcnt(0)
v_min3_u32 v8, v8, v9, v10
v_min_u32 v8, v8, v11
v_cmp_gt_u32 vcc, 1, v8
s_cbranch_vccz polld_32
s_sleep 2
s_branch poll_31
polld_32:
s_barrier
s_branch cw_30
cw_29:
s_cmp_lg_u32 s13, 0
s_cbranch_scc1 polld_34
v_lshrrev_b32 v12, 2, v0
v_min_u32 v12, 56, v12
s_mov_b32 s21, 6144
s_mov_b32 s17, 0
poll_33:
buffer_load_dword v8, v12, s[4:7], s21 offen offset:0 sc1
s_add_u32 s17, s17, 1
s_cmp_gt_u32 s17, 262144
s_cbranch_scc1 L_fail
s_waitcnt vmcnt(0)
v_cmp_gt_u32 vcc, 1, v8
s_cbranch_vccz polld_34
s_sleep 2
s_branch poll_33
polld_34:
s_barrier
cw_30:
s_add_u32 m0, s25, 0
s_add_u32 s20, s26, 0
buffer_load_dwordx4 v232, s[4:7], s20 offen sc1 lds
s_add_u32 m0, s25, 1024
s_add_u32 s20, s26, 163840
buffer_load_dwordx4 v233, s[4:7], s20 offen sc1 lds
s_add_u32 m0, s25, 2048
s_add_u32 s20, s26, 327680
buffer_load_dwordx4 v232, s[4:7], s20 offen sc1 lds
s_add_u32 m0, s25, 3072
s_add_u32 s20, s26, 491520
buffer_load_dwordx4 v233, s[4:7], s20 offen sc1 lds
s_lshr_b32 s18, s13, 1
s_lshl_b32 s18, s18, 10
s_and_b32 s19, s13, 1
s_lshl_b32 s19, s19, 3
s_add_u32 s18, s18, s19
v_add_u32 v234, s18, v0
v_bfe_u32 v235, v0, 4, 4
v_mul_u32_u24 v235, 40960, v235
v_lshrrev_b32 v99, 8, v0
v_lshl_add_u32 v235, v99, 4, v235
s_waitcnt vmcnt(0)
s_barrier
ds_read_b64_tr_b16 v[112:113], v225 offset:0
ds_read_b64_tr_b16 v[98:99], v224 offset:4096
ds_read_b64_tr_b16 v[114:115], v225 offset:4096
ds_read_b64_tr_b16 v[96:97], v224 offset:0
ds_read_b64_tr_b16 v[106:107], v228 offset:4096
ds_read_b64_tr_b16 v[120:121], v229 offset:0
ds_read_b64_tr_b16 v[104:105], v228 offset:0
ds_read_b64_tr_b16 v[116:117], v225 offset:8192
ds_read_b64_tr_b16 v[118:119], v225 offset:12288
ds_read_b64_tr_b16 v[102:103], v224 offset:12288
ds_read_b64_tr_b16 v[110:111], v228 offset:12288
ds_read_b64_tr_b16 v[100:101], v224 offset:8192
ds_read_b64_tr_b16 v[122:123], v229 offset:4096
ds_read_b64_tr_b16 v[108:109], v228 offset:8192
ds_read_b64_tr_b16 v[124:125], v229 offset:8192
ds_read_b64_tr_b16 v[152:153], v231 offset:0
ds_read_b64_tr_b16 v[128:129], v226 offset:0
s_waitcnt lgkmcnt(14)
v_mfma_f32_16x16x32_bf16 v[168:171], v[112:115], v[16:19], 0
s_waitcnt lgkmcnt(13)
ds_read_b64_tr_b16 v[126:127], v229 offset:12288
ds_read_b64_tr_b16 v[158:159], v231 offset:12288
v_mfma_f32_16x16x32_bf16 v[160:163], v[96:99], v[16:19], 0
ds_read_b64_tr_b16 v[130:131], v226 offset:4096
ds_read_b64_tr_b16 v[132:133], v226 offset:8192
v_mfma_f32_16x16x32_bf16 v[168:171], v[96:99], v[32:35], v[168:171]
s_waitcnt lgkmcnt(13)
ds_read_b64_tr_b16 v[138:139], v230 offset:4096
ds_read_b64_tr_b16 v[150:151], v227 offset:12288
v_mfma_f32_16x16x32_bf16 v[160:163], v[112:115], v[24:27], v[160:163]
s_waitcnt lgkmcnt(13)
ds_read_b64_tr_b16 v[140:141], v230 offset:8192
ds_read_b64_tr_b16 v[146:147], v227 offset:4096
v_mfma_f32_16x16x32_bf16 v[164:167], v[104:107], v[16:19], 0
s_waitcnt lgkmcnt(13)
ds_read_b64_tr_b16 v[144:145], v227 offset:0
v_lshlrev_b32 v96, 16, v208
v_mfma_f32_16x16x32_bf16 v[168:171], v[116:119], v[20:23], v[168:171]
ds_read_b64_tr_b16 v[136:137], v230 offset:0
ds_read_b64_tr_b16 v[156:157], v231 offset:8192
v_mfma_f32_16x16x32_bf16 v[160:163], v[100:103], v[20:23], v[160:163]
s_waitcnt lgkmcnt(14)
ds_read_b64_tr_b16 v[148:149], v227 offset:8192
v_lshlrev_b32 v114, 16, v217
v_mfma_f32_16x16x32_bf16 v[160:163], v[116:119], v[28:31], v[160:163]
ds_read_b64_tr_b16 v[142:143], v230 offset:12288
ds_read_b64_tr_b16 v[154:155], v231 offset:4096
v_mfma_f32_16x16x32_bf16 v[164:167], v[120:123], v[24:27], v[164:167]
s_nop 0
ds_read_b64_tr_b16 v[134:135], v226 offset:12288
v_lshlrev_b32 v112, 16, v216
v_mfma_f32_16x16x32_bf16 v[168:171], v[100:103], v[36:39], v[168:171]
s_waitcnt lgkmcnt(14)
v_mul_f32 v233, v161, v73
v_mul_f32 v232, v160, v72
v_mfma_f32_16x16x32_bf16 v[172:175], v[120:123], v[16:19], 0
v_mul_f32 v160, v160, v64
v_mul_f32 v161, v161, v65
v_mfma_f32_16x16x32_bf16 v[164:167], v[108:111], v[20:23], v[164:167]
s_waitcnt lgkmcnt(6)
v_fma_f32 v161, v169, v73, v161
v_fma_f32 v160, v168, v72, v160
v_mfma_f32_16x16x32_bf16 v[184:187], v[144:147], v[16:19], 0
v_fma_f32 v169, v169, v65, -v233
v_fma_f32 v168, v168, v64, -v232
v_mfma_f32_16x16x32_bf16 v[176:179], v[128:131], v[16:19], 0
v_mul_f32 v232, v162, v74
v_mul_f32 v233, v163, v75
v_mfma_f32_16x16x32_bf16 v[176:179], v[144:147], v[24:27], v[176:179]
v_mul_f32 v162, v162, v66
v_mul_f32 v163, v163, v67
v_mfma_f32_16x16x32_bf16 v[164:167], v[124:127], v[28:31], v[164:167]
s_waitcnt lgkmcnt(0)
v_fma_f32 v162, v170, v74, v162
v_fma_f32 v163, v171, v75, v163
v_mfma_f32_16x16x32_bf16 v[172:175], v[104:107], v[32:35], v[172:175]
v_fma_f32 v170, v170, v66, -v232
v_fma_f32 v171, v171, v67, -v233
v_mfma_f32_16x16x32_bf16 v[172:175], v[124:127], v[20:23], v[172:175]
s_nop 0
v_mul_f32 v232, v164, v76
v_and_b32 v119, 0xffff0000, v219
v_mfma_f32_16x16x32_bf16 v[172:175], v[108:111], v[36:39], v[172:175]
v_mul_f32 v233, v165, v77
v_cvt_pk_bf16_f32 v197, v170, v171
v_mfma_f32_16x16x32_bf16 v[188:191], v[152:155], v[16:19], 0
s_nop 0
v_mul_f32 v164, v164, v68
v_mul_f32 v165, v165, v69
v_mfma_f32_16x16x32_bf16 v[176:179], v[132:135], v[20:23], v[176:179]
s_nop 0
v_fma_f32 v164, v172, v76, v164
v_fma_f32 v172, v172, v68, -v232
v_mfma_f32_16x16x32_bf16 v[180:183], v[136:139], v[16:19], 0
v_fma_f32 v165, v173, v77, v165
v_fma_f32 v173, v173, v69, -v233
v_mfma_f32_16x16x32_bf16 v[184:187], v[128:131], v[32:35], v[184:187]
v_mul_f32 v232, v166, v78
v_mul_f32 v166, v166, v70
v_mfma_f32_16x16x32_bf16 v[176:179], v[148:151], v[28:31], v[176:179]
v_mul_f32 v233, v167, v79
v_cvt_pk_bf16_f32 v192, v160, v161
v_mfma_f32_16x16x32_bf16 v[184:187], v[148:151], v[20:23], v[184:187]
v_mul_f32 v167, v167, v71
v_fma_f32 v167, v175, v79, v167
v_mfma_f32_16x16x32_bf16 v[188:191], v[136:139], v[32:35], v[188:191]
v_fma_f32 v166, v174, v78, v166
v_lshlrev_b32 v100, 16, v210
v_mfma_f32_16x16x32_bf16 v[184:187], v[132:135], v[36:39], v[184:187]
v_cvt_pk_bf16_f32 v194, v164, v165
v_fma_f32 v174, v174, v70, -v232
v_mfma_f32_16x16x32_bf16 v[180:183], v[152:155], v[24:27], v[180:183]
v_cvt_pk_bf16_f32 v195, v166, v167
v_cvt_pk_bf16_f32 v198, v172, v173
v_mfma_f32_16x16x32_bf16 v[188:191], v[156:159], v[20:23], v[188:191]
v_cvt_pk_bf16_f32 v193, v162, v163
v_mul_f32 v232, v176, v72
v_mfma_f32_16x16x32_bf16 v[180:183], v[140:143], v[20:23], v[180:183]
v_fma_f32 v175, v175, v71, -v233
v_cvt_pk_bf16_f32 v199, v174, v175
v_mfma_f32_16x16x32_bf16 v[188:191], v[140:143], v[36:39], v[188:191]
v_mul_f32 v233, v177, v73
v_mul_f32 v177, v177, v65
v_mfma_f32_16x16x32_bf16 v[160:163], v[40:43], v[192:195], 0
v_fma_f32 v177, v185, v73, v177
v_mul_f32 v176, v176, v64
v_mfma_f32_16x16x32_bf16 v[180:183], v[156:159], v[28:31], v[180:183]
v_lshlrev_b32 v120, 16, v220
v_cvt_pk_bf16_f32 v196, v168, v169
v_fma_f32 v185, v185, v65, -v233
v_mul_f32 v233, v179, v75
v_mfma_f32_16x16x32_bf16 v[168:171], v[40:43], v[196:199], 0
v_mul_f32 v179, v179, v67
v_fma_f32 v176, v184, v72, v176
v_mfma_f32_16x16x32_bf16 v[164:167], v[44:47], v[192:195], 0
v_fma_f32 v184, v184, v64, -v232
v_mul_f32 v232, v178, v74
v_mfma_f32_16x16x32_bf16 v[160:163], v[48:51], v[196:199], v[160:163]
v_fma_f32 v179, v187, v75, v179
v_cvt_pk_bf16_f32 v200, v176, v177
v_mfma_f32_16x16x32_bf16 v[172:175], v[44:47], v[196:199], 0
v_fma_f32 v187, v187, v67, -v233
v_and_b32 v97, 0xffff0000, v208
v_mul_f32 v178, v178, v66
v_mul_f32 v233, v181, v77
v_fma_f32 v178, v186, v74, v178
v_mfma_f32_16x16x32_bf16 v[164:167], v[52:55], v[196:199], v[164:167]
v_fma_f32 v186, v186, v66, -v232
v_mul_f32 v181, v181, v69
v_mfma_f32_16x16x32_bf16 v[172:175], v[60:63], v[192:195], v[172:175]
v_fma_f32 v181, v189, v77, v181
v_mul_f32 v232, v180, v76
v_mfma_f32_16x16x32_bf16 v[168:171], v[56:59], v[192:195], v[168:171]
v_fma_f32 v189, v189, v69, -v233
v_mul_f32 v233, v183, v79
v_mul_f32 v183, v183, v71
v_mul_f32 v180, v180, v68
v_fma_f32 v183, v191, v79, v183
v_fma_f32 v180, v188, v76, v180
v_lshlrev_b32 v124, 16, v222
v_fma_f32 v188, v188, v68, -v232
v_cvt_pk_bf16_f32 v201, v178, v179
v_mul_f32 v232, v182, v78
v_mul_f32 v182, v182, v70
v_fma_f32 v191, v191, v71, -v233
v_cvt_pk_bf16_f32 v202, v180, v181
v_cvt_pk_bf16_f32 v206, v188, v189
v_fma_f32 v182, v190, v78, v182
v_cvt_pk_bf16_f32 v203, v182, v183
v_and_b32 v105, 0xffff0000, v212
v_and_b32 v103, 0xffff0000, v211
v_cvt_pk_bf16_f32 v205, v186, v187
v_mfma_f32_16x16x32_bf16 v[176:179], v[40:43], v[200:203], 0
v_and_b32 v99, 0xffff0000, v209
v_fma_f32 v190, v190, v70, -v232
v_lshlrev_b32 v98, 16, v209
v_mfma_f32_16x16x32_bf16 v[180:183], v[44:47], v[200:203], 0
v_cvt_pk_bf16_f32 v207, v190, v191
v_cvt_pk_bf16_f32 v204, v184, v185
v_mul_f32 v232, v160, v97
v_and_b32 v107, 0xffff0000, v213
v_mfma_f32_16x16x32_bf16 v[180:183], v[52:55], v[204:207], v[180:183]
v_lshlrev_b32 v102, 16, v211
v_lshlrev_b32 v110, 16, v215
v_mfma_f32_16x16x32_bf16 v[188:191], v[44:47], v[204:207], 0
v_mul_f32 v160, v160, v96
v_lshlrev_b32 v104, 16, v212
v_mfma_f32_16x16x32_bf16 v[184:187], v[40:43], v[204:207], 0
v_mul_f32 v233, v161, v99
v_and_b32 v101, 0xffff0000, v210
v_mfma_f32_16x16x32_bf16 v[176:179], v[48:51], v[204:207], v[176:179]
v_lshlrev_b32 v108, 16, v214
v_mul_f32 v161, v161, v98
v_mfma_f32_16x16x32_bf16 v[188:191], v[60:63], v[200:203], v[188:191]
v_fma_f32 v161, v169, -v99, v161
v_fma_f32 v169, v169, v98, v233
v_mfma_f32_16x16x32_bf16 v[184:187], v[56:59], v[200:203], v[184:187]
v_fma_f32 v160, v168, -v97, v160
v_mul_f32 v233, v163, v103
v_fma_f32 v168, v168, v96, v232
v_mul_f32 v232, v162, v101
v_mul_f32 v163, v163, v102
v_lshlrev_b32 v106, 16, v213
v_mul_f32 v162, v162, v100
v_fma_f32 v163, v171, -v103, v163
v_fma_f32 v171, v171, v102, v233
v_and_b32 v111, 0xffff0000, v215
v_fma_f32 v162, v170, -v101, v162
v_cvt_pk_bf16_f32 v196, v168, v169
v_mul_f32 v233, v165, v107
v_and_b32 v113, 0xffff0000, v216
v_mul_f32 v165, v165, v106
v_fma_f32 v170, v170, v100, v232
v_mul_f32 v232, v164, v105
v_fma_f32 v165, v173, -v107, v165
v_mul_f32 v164, v164, v104
v_and_b32 v109, 0xffff0000, v214
v_and_b32 v115, 0xffff0000, v217
v_cvt_pk_bf16_f32 v197, v170, v171
v_fma_f32 v173, v173, v106, v233
v_mul_f32 v233, v167, v111
v_fma_f32 v164, v172, -v105, v164
v_fma_f32 v172, v172, v104, v232
v_mul_f32 v232, v166, v109
v_mul_f32 v167, v167, v110
v_and_b32 v121, 0xffff0000, v220
v_mul_f32 v166, v166, v108
v_fma_f32 v166, v174, -v109, v166
v_fma_f32 v167, v175, -v111, v167
v_fma_f32 v175, v175, v110, v233
v_fma_f32 v174, v174, v108, v232
v_cvt_pk_bf16_f32 v198, v172, v173
v_cvt_pk_bf16_f32 v194, v164, v165
v_cvt_pk_bf16_f32 v199, v174, v175
v_cvt_pk_bf16_f32 v195, v166, v167
v_mul_f32 v233, v177, v115
v_mfma_f32_16x16x32_bf16 v[172:175], v[196:199], v[44:47], 0
v_cvt_pk_bf16_f32 v193, v162, v163
v_cvt_pk_bf16_f32 v192, v160, v161
v_mfma_f32_16x16x32_bf16 v[168:171], v[196:199], v[40:43], 0
v_lshlrev_b32 v118, 16, v219
v_mul_f32 v232, v176, v113
v_mfma_f32_16x16x32_bf16 v[164:167], v[192:195], v[44:47], 0
v_mul_f32 v176, v176, v112
v_fma_f32 v176, v184, -v113, v176
v_mul_f32 v177, v177, v114
v_mfma_f32_16x16x32_bf16 v[172:175], v[192:195], v[52:55], v[172:175]
v_fma_f32 v177, v185, -v115, v177
v_fma_f32 v185, v185, v114, v233
v_mfma_f32_16x16x32_bf16 v[168:171], v[192:195], v[48:51], v[168:171]
v_and_b32 v117, 0xffff0000, v218
v_mul_f32 v233, v179, v119
v_mul_f32 v179, v179, v118
v_mfma_f32_16x16x32_bf16 v[160:163], v[192:195], v[40:43], 0
v_lshlrev_b32 v122, 16, v221
v_fma_f32 v184, v184, v112, v232
v_cvt_pk_bf16_f32 v204, v184, v185
v_mfma_f32_16x16x32_bf16 v[160:163], v[196:199], v[56:59], v[160:163]
v_mul_f32 v232, v178, v117
v_fma_f32 v179, v187, -v119, v179
v_lshlrev_b32 v126, 16, v223
v_mfma_f32_16x16x32_bf16 v[164:167], v[196:199], v[60:63], v[164:167]
v_and_b32 v127, 0xffff0000, v223
v_and_b32 v123, 0xffff0000, v221
v_cvt_pk_bf16_f32 v200, v176, v177
v_lshlrev_b32 v116, 16, v218
v_fma_f32 v187, v187, v118, v233
v_mul_f32 v178, v178, v116
v_fma_f32 v178, v186, -v117, v178
v_and_b32 v125, 0xffff0000, v222
v_mul_f32 v233, v181, v123
v_fma_f32 v186, v186, v116, v232
v_mul_f32 v232, v180, v121
v_mul_f32 v180, v180, v120
v_fma_f32 v180, v188, -v121, v180
v_mul_f32 v181, v181, v122
v_fma_f32 v181, v189, -v123, v181
v_cvt_pk_bf16_f32 v202, v180, v181
v_fma_f32 v188, v188, v120, v232
v_fma_f32 v189, v189, v122, v233
v_mul_f32 v233, v183, v127
v_cvt_pk_bf16_f32 v201, v178, v179
v_mul_f32 v183, v183, v126
v_fma_f32 v183, v191, -v127, v183
v_mul_f32 v232, v182, v125
v_fma_f32 v191, v191, v126, v233
v_mul_f32 v182, v182, v124
v_fma_f32 v182, v190, -v125, v182
v_cvt_pk_bf16_f32 v206, v188, v189
v_cvt_pk_bf16_f32 v203, v182, v183
v_mul_f32 v233, v161, v89
v_mul_f32 v161, v161, v81
v_mfma_f32_16x16x32_bf16 v[176:179], v[200:203], v[40:43], 0
v_fma_f32 v190, v190, v124, v232
v_cvt_pk_bf16_f32 v207, v190, v191
v_cvt_pk_bf16_f32 v205, v186, v187
v_fma_f32 v161, v169, -v89, v161
v_fma_f32 v169, v169, v81, v233
v_mfma_f32_16x16x32_bf16 v[180:183], v[200:203], v[44:47], 0
v_mul_f32 v232, v160, v88
v_mul_f32 v160, v160, v80
v_mfma_f32_16x16x32_bf16 v[184:187], v[204:207], v[40:43], 0
v_fma_f32 v160, v168, -v88, v160
v_mul_f32 v233, v163, v91
v_mfma_f32_16x16x32_bf16 v[188:191], v[204:207], v[44:47], 0
v_fma_f32 v168, v168, v80, v232
v_mul_f32 v163, v163, v83
v_mfma_f32_16x16x32_bf16 v[176:179], v[204:207], v[56:59], v[176:179]
v_mul_f32 v232, v162, v90
v_fma_f32 v163, v171, -v91, v163
v_mfma_f32_16x16x32_bf16 v[180:183], v[204:207], v[60:63], v[180:183]
v_mul_f32 v162, v162, v82
v_fma_f32 v171, v171, v83, v233
v_fma_f32 v162, v170, -v90, v162
v_cvt_pk_bf16_f32 v196, v168, v169
v_mul_f32 v233, v165, v93
v_fma_f32 v170, v170, v82, v232
v_mfma_f32_16x16x32_bf16 v[184:187], v[200:203], v[48:51], v[184:187]
v_mul_f32 v232, v164, v92
v_mul_f32 v164, v164, v84
v_fma_f32 v164, v172, -v92, v164
v_fma_f32 v172, v172, v84, v232
v_mul_f32 v165, v165, v85
v_mul_f32 v232, v166, v94
v_fma_f32 v165, v173, -v93, v165
v_mul_f32 v166, v166, v86
v_fma_f32 v173, v173, v85, v233
v_mul_f32 v233, v167, v95
v_mul_f32 v167, v167, v87
v_cvt_pk_bf16_f32 v192, v160, v161
v_cvt_pk_bf16_f32 v198, v172, v173
v_fma_f32 v166, v174, -v94, v166
v_fma_f32 v167, v175, -v95, v167
v_fma_f32 v175, v175, v87, v233
v_mul_f32 v233, v177, v89
v_fma_f32 v174, v174, v86, v232
v_mul_f32 v232, v176, v88
v_cvt_pk_bf16_f32 v199, v174, v175
v_mul_f32 v176, v176, v80
v_cvt_pk_bf16_f32 v194, v164, v165
v_cvt_pk_bf16_f32 v195, v166, v167
v_mul_f32 v177, v177, v81
v_cvt_pk_bf16_f32 v193, v162, v163
v_fma_f32 v177, v185, -v89, v177
v_cvt_pk_bf16_f32 v197, v170, v171
v_fma_f32 v176, v184, -v88, v176
v_mfma_f32_16x16x32_bf16 v[188:191], v[200:203], v[52:55], v[188:191]
ds_write_b64 v234, v[194:195] offset:18432
ds_write_b64 v234, v[196:197] offset:20480
ds_write_b64 v234, v[198:199] offset:22528
v_fma_f32 v184, v184, v80, v232
v_mul_f32 v232, v178, v90
v_mul_f32 v178, v178, v82
v_fma_f32 v185, v185, v81, v233
v_fma_f32 v178, v186, -v90, v178
v_fma_f32 v186, v186, v82, v232
v_mul_f32 v233, v179, v91
v_mul_f32 v232, v180, v92
v_mul_f32 v179, v179, v83
v_mul_f32 v180, v180, v84
v_fma_f32 v179, v187, -v91, v179
v_cvt_pk_bf16_f32 v204, v184, v185
v_fma_f32 v180, v188, -v92, v180
v_fma_f32 v187, v187, v83, v233
v_mul_f32 v233, v181, v93
v_cvt_pk_bf16_f32 v201, v178, v179
v_mul_f32 v181, v181, v85
v_cvt_pk_bf16_f32 v200, v176, v177
v_cvt_pk_bf16_f32 v205, v186, v187
v_fma_f32 v181, v189, -v93, v181
v_fma_f32 v189, v189, v85, v233
v_mul_f32 v233, v183, v95
v_fma_f32 v188, v188, v84, v232
ds_write_b64 v234, v[200:201] offset:24576
ds_write_b64 v234, v[204:205] offset:28672
ds_write_b64 v234, v[192:193] offset:16384
v_mul_f32 v232, v182, v94
v_mul_f32 v182, v182, v86
v_mul_f32 v183, v183, v87
v_fma_f32 v182, v190, -v94, v182
v_cvt_pk_bf16_f32 v202, v180, v181
v_fma_f32 v183, v191, -v95, v183
v_cvt_pk_bf16_f32 v203, v182, v183
v_fma_f32 v190, v190, v86, v232
v_cvt_pk_bf16_f32 v206, v188, v189
s_waitcnt lgkmcnt(0)
ds_write_b64 v234, v[202:203] offset:26624
v_fma_f32 v191, v191, v87, v233
v_cvt_pk_bf16_f32 v207, v190, v191
s_waitcnt lgkmcnt(0)
ds_write_b64 v234, v[206:207] offset:30720
s_waitcnt lgkmcnt(0)
s_barrier
ds_read_b128 v[112:115], v0 offset:20480
ds_read_b128 v[120:123], v0 offset:22528
ds_read_b128 v[96:99], v0 offset:16384
ds_read_b128 v[104:107], v0 offset:18432
ds_read_b128 v[100:103], v0 offset:17408
ds_read_b128 v[144:147], v0 offset:28672
ds_read_b128 v[108:111], v0 offset:19456
ds_read_b128 v[128:131], v0 offset:24576
s_waitcnt lgkmcnt(7)
v_mfma_f32_16x16x32_bf16 v[168:171], v[112:115], v[16:19], 0
ds_read_b128 v[152:155], v0 offset:30720
s_waitcnt lgkmcnt(7)
v_mfma_f32_16x16x32_bf16 v[172:175], v[120:123], v[16:19], 0
s_waitcnt lgkmcnt(6)
v_mfma_f32_16x16x32_bf16 v[160:163], v[96:99], v[16:19], 0
v_mfma_f32_16x16x32_bf16 v[160:163], v[112:115], v[32:35], v[160:163]
ds_read_b128 v[116:119], v0 offset:21504
v_mfma_f32_16x16x32_bf16 v[168:171], v[96:99], v[24:27], v[168:171]
s_waitcnt lgkmcnt(5)
s_waitcnt lgkmcnt(4)
v_mfma_f32_16x16x32_bf16 v[160:163], v[100:103], v[20:23], v[160:163]
v_mfma_f32_16x16x32_bf16 v[164:167], v[104:107], v[16:19], 0
ds_read_b128 v[124:127], v0 offset:23552
ds_read_b128 v[140:143], v0 offset:27648
v_mfma_f32_16x16x32_bf16 v[172:175], v[104:107], v[24:27], v[172:175]
s_waitcnt lgkmcnt(4)
ds_read_b128 v[148:151], v0 offset:29696
s_waitcnt lgkmcnt(4)
v_mfma_f32_16x16x32_bf16 v[176:179], v[128:131], v[16:19], 0
s_waitcnt lgkmcnt(3)
v_mfma_f32_16x16x32_bf16 v[184:187], v[144:147], v[16:19], 0
ds_read_b128 v[136:139], v0 offset:26624
v_mfma_f32_16x16x32_bf16 v[164:167], v[120:123], v[32:35], v[164:167]
ds_read_b128 v[132:135], v0 offset:25600
v_mfma_f32_16x16x32_bf16 v[168:171], v[116:119], v[20:23], v[168:171]
s_waitcnt lgkmcnt(4)
v_mfma_f32_16x16x32_bf16 v[168:171], v[100:103], v[28:31], v[168:171]
v_mfma_f32_16x16x32_bf16 v[184:187], v[128:131], v[24:27], v[184:187]
v_mfma_f32_16x16x32_bf16 v[160:163], v[116:119], v[36:39], v[160:163]
v_mfma_f32_16x16x32_bf16 v[172:175], v[124:127], v[20:23], v[172:175]
s_waitcnt lgkmcnt(0)
v_mfma_f32_16x16x32_bf16 v[164:167], v[108:111], v[20:23], v[164:167]
v_mfma_f32_16x16x32_bf16 v[180:183], v[136:139], v[16:19], 0
ds_read_b128 v[156:159], v0 offset:31744
v_mfma_f32_16x16x32_bf16 v[176:179], v[144:147], v[32:35], v[176:179]
v_mfma_f32_16x16x32_bf16 v[164:167], v[124:127], v[36:39], v[164:167]
s_nop 0
v_cvt_pk_bf16_f32 v192, v160, v161
v_mfma_f32_16x16x32_bf16 v[184:187], v[148:151], v[20:23], v[184:187]
v_mfma_f32_16x16x32_bf16 v[176:179], v[132:135], v[20:23], v[176:179]
s_waitcnt lgkmcnt(0)
v_mfma_f32_16x16x32_bf16 v[172:175], v[108:111], v[28:31], v[172:175]
v_cvt_pk_bf16_f32 v197, v170, v171
v_mfma_f32_16x16x32_bf16 v[184:187], v[132:135], v[28:31], v[184:187]
v_cvt_pk_bf16_f32 v195, v166, v167
v_mfma_f32_16x16x32_bf16 v[180:183], v[152:155], v[32:35], v[180:183]
s_nop 0
v_cvt_pk_bf16_f32 v196, v168, v169
v_cvt_pk_bf16_f32 v193, v162, v163
v_mfma_f32_16x16x32_bf16 v[180:183], v[140:143], v[20:23], v[180:183]
s_nop 0
v_cvt_pk_bf16_f32 v194, v164, v165
v_cvt_pk_bf16_f32 v205, v186, v187
v_mfma_f32_16x16x32_bf16 v[188:191], v[152:155], v[16:19], 0
v_cvt_pk_bf16_f32 v198, v172, v173
v_cvt_pk_bf16_f32 v199, v174, v175
v_mfma_f32_16x16x32_bf16 v[180:183], v[156:159], v[36:39], v[180:183]
s_nop 0
buffer_store_dwordx4 v[192:195], v235, s[4:7], s27 offen offset:0 sc1
s_nop 2
v_mfma_f32_16x16x32_bf16 v[176:179], v[148:151], v[36:39], v[176:179]
s_nop 1
v_cvt_pk_bf16_f32 v202, v180, v181
v_mfma_f32_16x16x32_bf16 v[188:191], v[136:139], v[24:27], v[188:191]
v_cvt_pk_bf16_f32 v204, v184, v185
v_cvt_pk_bf16_f32 v203, v182, v183
v_mfma_f32_16x16x32_bf16 v[188:191], v[156:159], v[20:23], v[188:191]
s_nop 0
v_cvt_pk_bf16_f32 v201, v178, v179
v_cvt_pk_bf16_f32 v200, v176, v177
v_mfma_f32_16x16x32_bf16 v[188:191], v[140:143], v[28:31], v[188:191]
buffer_store_dwordx4 v[196:199], v235, s[4:7], s27 offen offset:64 sc1
s_nop 2
buffer_store_dwordx4 v[200:203], v235, s[4:7], s27 offen offset:128 sc1
s_nop 2
v_cvt_pk_bf16_f32 v206, v188, v189
v_cvt_pk_bf16_f32 v207, v190, v191
buffer_store_dwordx4 v[204:207], v235, s[4:7], s27 offen offset:192 sc1
s_lshl_b32 s18, s35, 2
s_add_u32 s18, s18, 7168
s_add_u32 s29, s16, 1
s_cmp_eq_u32 s13, 0
s_cselect_b32 s22, s18, s6
s_mov_b32 s23, s29
s_waitcnt vmcnt(0)
s_barrier
v_mov_b32 v3, s23
s_mov_b64 exec, 1
buffer_store_dword v3, off, s[4:7], s22 sc1
s_mov_b64 exec, -1
s_mov_b32 s22, s6
s_lshl_b32 s18, s34, 7
s_lshl_b32 s19, s13, 5
s_add_u32 s18, s18, s19
s_mov_b32 s19, 0x3acccccd
v_bfe_u32 v204, v0, 4, 5
v_lshrrev_b32 v201, 9, v0
v_and_b32 v200, 19, v204
v_bfe_u32 v205, v204, 2, 1
v_lshl_add_u32 v200, v205, 3, v200
v_bfe_u32 v205, v204, 3, 1
v_lshl_add_u32 v200, v205, 2, v200
v_add_u32 v200, s18, v200
v_lshlrev_b32 v201, 2, v201
v_mov_b32 v202, 0
v_mad_u32_u24 v202, v201, v200, v202
s_mov_b32 s20, 8
v_mad_u32_u24 v203, v200, s20, 0
v_cvt_f32_u32 v203, v203
v_mul_f32 v204, s19, v203
v_rndne_f32 v204, v204
v_fmac_f32 v203, 0xc4200000, v204
v_mul_f32 v203, s19, v203
v_cos_f32 v203, v203
s_nop 0
v_add_f32 v203, v203, v203
s_mov_b32 s20, 1
v_mad_u32_u24 v184, v200, s20, v202
v_cvt_f32_u32 v184, v184
v_mul_f32 v204, s19, v184
v_rndne_f32 v204, v204
v_fmac_f32 v184, 0xc4200000, v204
v_mul_f32 v184, s19, v184
v_cos_f32 v184, v184
s_mov_b32 s20, 1
v_mad_u32_u24 v185, v200, s20, v202
v_add_u32 v185, 160, v185
v_cvt_f32_u32 v185, v185
v_mul_f32 v204, s19, v185
v_rndne_f32 v204, v204
v_fmac_f32 v185, 0xc4200000, v204
v_mul_f32 v185, s19, v185
v_cos_f32 v185, v185
s_mov_b32 s20, 2
v_mad_u32_u24 v186, v200, s20, v202
v_cvt_f32_u32 v186, v186
v_mul_f32 v204, s19, v186
v_rndne_f32 v204, v204
v_fmac_f32 v186, 0xc4200000, v204
v_mul_f32 v186, s19, v186
v_cos_f32 v186, v186
s_mov_b32 s20, 2
v_mad_u32_u24 v187, v200, s20, v202
v_add_u32 v187, 160, v187
v_cvt_f32_u32 v187, v187
v_mul_f32 v204, s19, v187
v_rndne_f32 v204, v204
v_fmac_f32 v187, 0xc4200000, v204
v_mul_f32 v187, s19, v187
v_cos_f32 v187, v187
s_mov_b32 s20, 3
v_mad_u32_u24 v188, v200, s20, v202
v_cvt_f32_u32 v188, v188
v_mul_f32 v204, s19, v188
v_rndne_f32 v204, v204
v_fmac_f32 v188, 0xc4200000, v204
v_mul_f32 v188, s19, v188
v_cos_f32 v188, v188
s_mov_b32 s20, 3
v_mad_u32_u24 v189, v200, s20, v202
v_add_u32 v189, 160, v189
v_cvt_f32_u32 v189, v189
v_mul_f32 v204, s19, v189
v_rndne_f32 v204, v204
v_fmac_f32 v189, 0xc4200000, v204
v_mul_f32 v189, s19, v189
v_cos_f32 v189, v189
s_mov_b32 s20, 4
v_mad_u32_u24 v190, v200, s20, v202
v_cvt_f32_u32 v190, v190
v_mul_f32 v204, s19, v190
v_rndne_f32 v204, v204
v_fmac_f32 v190, 0xc4200000, v204
v_mul_f32 v190, s19, v190
v_cos_f32 v190, v190
s_mov_b32 s20, 4
v_mad_u32_u24 v191, v200, s20, v202
v_add_u32 v191, 160, v191
v_cvt_f32_u32 v191, v191
v_mul_f32 v204, s19, v191
v_rndne_f32 v204, v204
v_fmac_f32 v191, 0xc4200000, v204
v_mul_f32 v191, s19, v191
v_cos_f32 v191, v191
v_cvt_pk_bf16_f32 v16, v184, v185
v_cvt_pk_bf16_f32 v17, v186, v187
v_cvt_pk_bf16_f32 v18, v188, v189
v_cvt_pk_bf16_f32 v19, v190, v191
s_mov_b32 s20, 9
v_mad_u32_u24 v192, v200, s20, v202
v_cvt_f32_u32 v192, v192
v_mul_f32 v204, s19, v192
v_rndne_f32 v204, v204
v_fmac_f32 v192, 0xc4200000, v204
v_mul_f32 v192, s19, v192
v_cos_f32 v192, v192
s_mov_b32 s20, 9
v_mad_u32_u24 v193, v200, s20, v202
v_add_u32 v193, 160, v193
v_cvt_f32_u32 v193, v193
v_mul_f32 v204, s19, v193
v_rndne_f32 v204, v204
v_fmac_f32 v193, 0xc4200000, v204
v_mul_f32 v193, s19, v193
v_cos_f32 v193, v193
s_mov_b32 s20, 10
v_mad_u32_u24 v194, v200, s20, v202
v_cvt_f32_u32 v194, v194
v_mul_f32 v204, s19, v194
v_rndne_f32 v204, v204
v_fmac_f32 v194, 0xc4200000, v204
v_mul_f32 v194, s19, v194
v_cos_f32 v194, v194
s_mov_b32 s20, 10
v_mad_u32_u24 v195, v200, s20, v202
v_add_u32 v195, 160, v195
v_cvt_f32_u32 v195, v195
v_mul_f32 v204, s19, v195
v_rndne_f32 v204, v204
v_fmac_f32 v195, 0xc4200000, v204
v_mul_f32 v195, s19, v195
v_cos_f32 v195, v195
s_mov_b32 s20, 11
v_mad_u32_u24 v196, v200, s20, v202
v_cvt_f32_u32 v196, v196
v_mul_f32 v204, s19, v196
v_rndne_f32 v204, v204
v_fmac_f32 v196, 0xc4200000, v204
v_mul_f32 v196, s19, v196
v_cos_f32 v196, v196
s_mov_b32 s20, 11
v_mad_u32_u24 v197, v200, s20, v202
v_add_u32 v197, 160, v197
v_cvt_f32_u32 v197, v197
v_mul_f32 v204, s19, v197
v_rndne_f32 v204, v204
v_fmac_f32 v197, 0xc4200000, v204
v_mul_f32 v197, s19, v197
v_cos_f32 v197, v197
s_mov_b32 s20, 12
v_mad_u32_u24 v198, v200, s20, v202
v_cvt_f32_u32 v198, v198
v_mul_f32 v204, s19, v198
v_rndne_f32 v204, v204
v_fmac_f32 v198, 0xc4200000, v204
v_mul_f32 v198, s19, v198
v_cos_f32 v198, v198
s_mov_b32 s20, 12
v_mad_u32_u24 v199, v200, s20, v202
v_add_u32 v199, 160, v199
v_cvt_f32_u32 v199, v199
v_mul_f32 v204, s19, v199
v_rndne_f32 v204, v204
v_fmac_f32 v199, 0xc4200000, v204
v_mul_f32 v199, s19, v199
v_cos_f32 v199, v199
v_cvt_pk_bf16_f32 v20, v192, v193
v_cvt_pk_bf16_f32 v21, v194, v195
v_cvt_pk_bf16_f32 v22, v196, v197
v_cvt_pk_bf16_f32 v23, v198, v199
v_fma_f32 v184, v203, v192, -v184
v_fma_f32 v185, v203, v193, -v185
v_fma_f32 v186, v203, v194, -v186
v_fma_f32 v187, v203, v195, -v187
v_fma_f32 v188, v203, v196, -v188
v_fma_f32 v189, v203, v197, -v189
v_fma_f32 v190, v203, v198, -v190
v_fma_f32 v191, v203, v199, -v191
v_cvt_pk_bf16_f32 v24, v184, v185
v_cvt_pk_bf16_f32 v25, v186, v187
v_cvt_pk_bf16_f32 v26, v188, v189
v_cvt_pk_bf16_f32 v27, v190, v191
v_fma_f32 v192, v203, v184, -v192
v_fma_f32 v193, v203, v185, -v193
v_fma_f32 v194, v203, v186, -v194
v_fma_f32 v195, v203, v187, -v195
v_fma_f32 v196, v203, v188, -v196
v_fma_f32 v197, v203, v189, -v197
v_fma_f32 v198, v203, v190, -v198
v_fma_f32 v199, v203, v191, -v199
v_cvt_pk_bf16_f32 v28, v192, v193
v_cvt_pk_bf16_f32 v29, v194, v195
v_cvt_pk_bf16_f32 v30, v196, v197
v_cvt_pk_bf16_f32 v31, v198, v199
v_fma_f32 v184, v203, v192, -v184
v_fma_f32 v185, v203, v193, -v185
v_fma_f32 v186, v203, v194, -v186
v_fma_f32 v187, v203, v195, -v187
v_fma_f32 v188, v203, v196, -v188
v_fma_f32 v189, v203, v197, -v189
v_fma_f32 v190, v203, v198, -v190
v_fma_f32 v191, v203, v199, -v191
v_cvt_pk_bf16_f32 v32, v184, v185
v_cvt_pk_bf16_f32 v33, v186, v187
v_cvt_pk_bf16_f32 v34, v188, v189
v_cvt_pk_bf16_f32 v35, v190, v191
v_fma_f32 v192, v203, v184, -v192
v_fma_f32 v193, v203, v185, -v193
v_fma_f32 v194, v203, v186, -v194
v_fma_f32 v195, v203, v187, -v195
v_fma_f32 v196, v203, v188, -v196
v_fma_f32 v197, v203, v189, -v197
v_fma_f32 v198, v203, v190, -v198
v_fma_f32 v199, v203, v191, -v199
v_cvt_pk_bf16_f32 v36, v192, v193
v_cvt_pk_bf16_f32 v37, v194, v195
v_cvt_pk_bf16_f32 v38, v196, v197
v_cvt_pk_bf16_f32 v39, v198, v199
v_fma_f32 v184, v203, v192, -v184
v_fma_f32 v185, v203, v193, -v185
v_fma_f32 v186, v203, v194, -v186
v_fma_f32 v187, v203, v195, -v187
v_fma_f32 v188, v203, v196, -v188
v_fma_f32 v189, v203, v197, -v189
v_fma_f32 v190, v203, v198, -v190
v_fma_f32 v191, v203, v199, -v191
v_cvt_pk_bf16_f32 v40, v184, v185
v_cvt_pk_bf16_f32 v41, v186, v187
v_cvt_pk_bf16_f32 v42, v188, v189
v_cvt_pk_bf16_f32 v43, v190, v191
v_fma_f32 v192, v203, v184, -v192
v_fma_f32 v193, v203, v185, -v193
v_fma_f32 v194, v203, v186, -v194
v_fma_f32 v195, v203, v187, -v195
v_fma_f32 v196, v203, v188, -v196
v_fma_f32 v197, v203, v189, -v197
v_fma_f32 v198, v203, v190, -v198
v_fma_f32 v199, v203, v191, -v199
v_cvt_pk_bf16_f32 v44, v192, v193
v_cvt_pk_bf16_f32 v45, v194, v195
v_cvt_pk_bf16_f32 v46, v196, v197
v_cvt_pk_bf16_f32 v47, v198, v199
v_fma_f32 v184, v203, v192, -v184
v_fma_f32 v185, v203, v193, -v185
v_fma_f32 v186, v203, v194, -v186
v_fma_f32 v187, v203, v195, -v187
v_fma_f32 v188, v203, v196, -v188
v_fma_f32 v189, v203, v197, -v189
v_fma_f32 v190, v203, v198, -v190
v_fma_f32 v191, v203, v199, -v191
v_cvt_pk_bf16_f32 v48, v184, v185
v_cvt_pk_bf16_f32 v49, v186, v187
v_cvt_pk_bf16_f32 v50, v188, v189
v_cvt_pk_bf16_f32 v51, v190, v191
v_fma_f32 v192, v203, v184, -v192
v_fma_f32 v193, v203, v185, -v193
v_fma_f32 v194, v203, v186, -v194
v_fma_f32 v195, v203, v187, -v195
v_fma_f32 v196, v203, v188, -v196
v_fma_f32 v197, v203, v189, -v197
v_fma_f32 v198, v203, v190, -v198
v_fma_f32 v199, v203, v191, -v199
v_cvt_pk_bf16_f32 v52, v192, v193
v_cvt_pk_bf16_f32 v53, v194, v195
v_cvt_pk_bf16_f32 v54, v196, v197
v_cvt_pk_bf16_f32 v55, v198, v199
v_fma_f32 v184, v203, v192, -v184
v_fma_f32 v185, v203, v193, -v185
v_fma_f32 v186, v203, v194, -v186
v_fma_f32 v187, v203, v195, -v187
v_fma_f32 v188, v203, v196, -v188
v_fma_f32 v189, v203, v197, -v189
v_fma_f32 v190, v203, v198, -v190
v_fma_f32 v191, v203, v199, -v191
v_cvt_pk_bf16_f32 v56, v184, v185
v_cvt_pk_bf16_f32 v57, v186, v187
v_cvt_pk_bf16_f32 v58, v188, v189
v_cvt_pk_bf16_f32 v59, v190, v191
v_fma_f32 v192, v203, v184, -v192
v_fma_f32 v193, v203, v185, -v193
v_fma_f32 v194, v203, v186, -v194
v_fma_f32 v195, v203, v187, -v195
v_fma_f32 v196, v203, v188, -v196
v_fma_f32 v197, v203, v189, -v197
v_fma_f32 v198, v203, v190, -v198
v_fma_f32 v199, v203, v191, -v199
v_cvt_pk_bf16_f32 v60, v192, v193
v_cvt_pk_bf16_f32 v61, v194, v195
v_cvt_pk_bf16_f32 v62, v196, v197
v_cvt_pk_bf16_f32 v63, v198, v199
v_fma_f32 v184, v203, v192, -v184
v_fma_f32 v185, v203, v193, -v185
v_fma_f32 v186, v203, v194, -v186
v_fma_f32 v187, v203, v195, -v187
v_fma_f32 v188, v203, v196, -v188
v_fma_f32 v189, v203, v197, -v189
v_fma_f32 v190, v203, v198, -v190
v_fma_f32 v191, v203, v199, -v191
v_cvt_pk_bf16_f32 v64, v184, v185
v_cvt_pk_bf16_f32 v65, v186, v187
v_cvt_pk_bf16_f32 v66, v188, v189
v_cvt_pk_bf16_f32 v67, v190, v191
v_fma_f32 v192, v203, v184, -v192
v_fma_f32 v193, v203, v185, -v193
v_fma_f32 v194, v203, v186, -v194
v_fma_f32 v195, v203, v187, -v195
v_fma_f32 v196, v203, v188, -v196
v_fma_f32 v197, v203, v189, -v197
v_fma_f32 v198, v203, v190, -v198
v_fma_f32 v199, v203, v191, -v199
v_cvt_pk_bf16_f32 v68, v192, v193
v_cvt_pk_bf16_f32 v69, v194, v195
v_cvt_pk_bf16_f32 v70, v196, v197
v_cvt_pk_bf16_f32 v71, v198, v199
v_fma_f32 v184, v203, v192, -v184
v_fma_f32 v185, v203, v193, -v185
v_fma_f32 v186, v203, v194, -v186
v_fma_f32 v187, v203, v195, -v187
v_fma_f32 v188, v203, v196, -v188
v_fma_f32 v189, v203, v197, -v189
v_fma_f32 v190, v203, v198, -v190
v_fma_f32 v191, v203, v199, -v191
v_cvt_pk_bf16_f32 v72, v184, v185
v_cvt_pk_bf16_f32 v73, v186, v187
v_cvt_pk_bf16_f32 v74, v188, v189
v_cvt_pk_bf16_f32 v75, v190, v191
v_fma_f32 v192, v203, v184, -v192
v_fma_f32 v193, v203, v185, -v193
v_fma_f32 v194, v203, v186, -v194
v_fma_f32 v195, v203, v187, -v195
v_fma_f32 v196, v203, v188, -v196
v_fma_f32 v197, v203, v189, -v197
v_fma_f32 v198, v203, v190, -v198
v_fma_f32 v199, v203, v191, -v199
v_cvt_pk_bf16_f32 v76, v192, v193
v_cvt_pk_bf16_f32 v77, v194, v195
v_cvt_pk_bf16_f32 v78, v196, v197
v_cvt_pk_bf16_f32 v79, v198, v199
v_fma_f32 v184, v203, v192, -v184
v_fma_f32 v185, v203, v193, -v185
v_fma_f32 v186, v203, v194, -v186
v_fma_f32 v187, v203, v195, -v187
v_fma_f32 v188, v203, v196, -v188
v_fma_f32 v189, v203, v197, -v189
v_fma_f32 v190, v203, v198, -v190
v_fma_f32 v191, v203, v199, -v191
v_cvt_pk_bf16_f32 v80, v184, v185
v_cvt_pk_bf16_f32 v81, v186, v187
v_cvt_pk_bf16_f32 v82, v188, v189
v_cvt_pk_bf16_f32 v83, v190, v191
v_fma_f32 v192, v203, v184, -v192
v_fma_f32 v193, v203, v185, -v193
v_fma_f32 v194, v203, v186, -v194
v_fma_f32 v195, v203, v187, -v195
v_fma_f32 v196, v203, v188, -v196
v_fma_f32 v197, v203, v189, -v197
v_fma_f32 v198, v203, v190, -v198
v_fma_f32 v199, v203, v191, -v199
v_cvt_pk_bf16_f32 v84, v192, v193
v_cvt_pk_bf16_f32 v85, v194, v195
v_cvt_pk_bf16_f32 v86, v196, v197
v_cvt_pk_bf16_f32 v87, v198, v199
v_fma_f32 v184, v203, v192, -v184
v_fma_f32 v185, v203, v193, -v185
v_fma_f32 v186, v203, v194, -v186
v_fma_f32 v187, v203, v195, -v187
v_fma_f32 v188, v203, v196, -v188
v_fma_f32 v189, v203, v197, -v189
v_fma_f32 v190, v203, v198, -v190
v_fma_f32 v191, v203, v199, -v191
v_cvt_pk_bf16_f32 v88, v184, v185
v_cvt_pk_bf16_f32 v89, v186, v187
v_cvt_pk_bf16_f32 v90, v188, v189
v_cvt_pk_bf16_f32 v91, v190, v191
v_fma_f32 v192, v203, v184, -v192
v_fma_f32 v193, v203, v185, -v193
v_fma_f32 v194, v203, v186, -v194
v_fma_f32 v195, v203, v187, -v195
v_fma_f32 v196, v203, v188, -v196
v_fma_f32 v197, v203, v189, -v197
v_fma_f32 v198, v203, v190, -v198
v_fma_f32 v199, v203, v191, -v199
v_cvt_pk_bf16_f32 v92, v192, v193
v_cvt_pk_bf16_f32 v93, v194, v195
v_cvt_pk_bf16_f32 v94, v196, v197
v_cvt_pk_bf16_f32 v95, v198, v199
s_mov_b32 s20, 161
v_mad_u32_u24 v184, v200, s20, v202
v_cvt_f32_u32 v184, v184
v_mul_f32 v204, s19, v184
v_rndne_f32 v204, v204
v_fmac_f32 v184, 0xc4200000, v204
v_mul_f32 v184, s19, v184
v_cos_f32 v184, v184
s_mov_b32 s20, 161
v_mad_u32_u24 v185, v200, s20, v202
v_add_u32 v185, 160, v185
v_cvt_f32_u32 v185, v185
v_mul_f32 v204, s19, v185
v_rndne_f32 v204, v204
v_fmac_f32 v185, 0xc4200000, v204
v_mul_f32 v185, s19, v185
v_cos_f32 v185, v185
s_mov_b32 s20, 162
v_mad_u32_u24 v186, v200, s20, v202
v_cvt_f32_u32 v186, v186
v_mul_f32 v204, s19, v186
v_rndne_f32 v204, v204
v_fmac_f32 v186, 0xc4200000, v204
v_mul_f32 v186, s19, v186
v_cos_f32 v186, v186
s_mov_b32 s20, 162
v_mad_u32_u24 v187, v200, s20, v202
v_add_u32 v187, 160, v187
v_cvt_f32_u32 v187, v187
v_mul_f32 v204, s19, v187
v_rndne_f32 v204, v204
v_fmac_f32 v187, 0xc4200000, v204
v_mul_f32 v187, s19, v187
v_cos_f32 v187, v187
s_mov_b32 s20, 163
v_mad_u32_u24 v188, v200, s20, v202
v_cvt_f32_u32 v188, v188
v_mul_f32 v204, s19, v188
v_rndne_f32 v204, v204
v_fmac_f32 v188, 0xc4200000, v204
v_mul_f32 v188, s19, v188
v_cos_f32 v188, v188
s_mov_b32 s20, 163
v_mad_u32_u24 v189, v200, s20, v202
v_add_u32 v189, 160, v189
v_cvt_f32_u32 v189, v189
v_mul_f32 v204, s19, v189
v_rndne_f32 v204, v204
v_fmac_f32 v189, 0xc4200000, v204
v_mul_f32 v189, s19, v189
v_cos_f32 v189, v189
s_mov_b32 s20, 164
v_mad_u32_u24 v190, v200, s20, v202
v_cvt_f32_u32 v190, v190
v_mul_f32 v204, s19, v190
v_rndne_f32 v204, v204
v_fmac_f32 v190, 0xc4200000, v204
v_mul_f32 v190, s19, v190
v_cos_f32 v190, v190
s_mov_b32 s20, 164
v_mad_u32_u24 v191, v200, s20, v202
v_add_u32 v191, 160, v191
v_cvt_f32_u32 v191, v191
v_mul_f32 v204, s19, v191
v_rndne_f32 v204, v204
v_fmac_f32 v191, 0xc4200000, v204
v_mul_f32 v191, s19, v191
v_cos_f32 v191, v191
v_cvt_pk_bf16_f32 v96, v184, v185
v_cvt_pk_bf16_f32 v97, v186, v187
v_cvt_pk_bf16_f32 v98, v188, v189
v_cvt_pk_bf16_f32 v99, v190, v191
s_mov_b32 s20, 169
v_mad_u32_u24 v192, v200, s20, v202
v_cvt_f32_u32 v192, v192
v_mul_f32 v204, s19, v192
v_rndne_f32 v204, v204
v_fmac_f32 v192, 0xc4200000, v204
v_mul_f32 v192, s19, v192
v_cos_f32 v192, v192
s_mov_b32 s20, 169
v_mad_u32_u24 v193, v200, s20, v202
v_add_u32 v193, 160, v193
v_cvt_f32_u32 v193, v193
v_mul_f32 v204, s19, v193
v_rndne_f32 v204, v204
v_fmac_f32 v193, 0xc4200000, v204
v_mul_f32 v193, s19, v193
v_cos_f32 v193, v193
s_mov_b32 s20, 170
v_mad_u32_u24 v194, v200, s20, v202
v_cvt_f32_u32 v194, v194
v_mul_f32 v204, s19, v194
v_rndne_f32 v204, v204
v_fmac_f32 v194, 0xc4200000, v204
v_mul_f32 v194, s19, v194
v_cos_f32 v194, v194
s_mov_b32 s20, 170
v_mad_u32_u24 v195, v200, s20, v202
v_add_u32 v195, 160, v195
v_cvt_f32_u32 v195, v195
v_mul_f32 v204, s19, v195
v_rndne_f32 v204, v204
v_fmac_f32 v195, 0xc4200000, v204
v_mul_f32 v195, s19, v195
v_cos_f32 v195, v195
s_mov_b32 s20, 171
v_mad_u32_u24 v196, v200, s20, v202
v_cvt_f32_u32 v196, v196
v_mul_f32 v204, s19, v196
v_rndne_f32 v204, v204
v_fmac_f32 v196, 0xc4200000, v204
v_mul_f32 v196, s19, v196
v_cos_f32 v196, v196
s_mov_b32 s20, 171
v_mad_u32_u24 v197, v200, s20, v202
v_add_u32 v197, 160, v197
v_cvt_f32_u32 v197, v197
v_mul_f32 v204, s19, v197
v_rndne_f32 v204, v204
v_fmac_f32 v197, 0xc4200000, v204
v_mul_f32 v197, s19, v197
v_cos_f32 v197, v197
s_mov_b32 s20, 172
v_mad_u32_u24 v198, v200, s20, v202
v_cvt_f32_u32 v198, v198
v_mul_f32 v204, s19, v198
v_rndne_f32 v204, v204
v_fmac_f32 v198, 0xc4200000, v204
v_mul_f32 v198, s19, v198
v_cos_f32 v198, v198
s_mov_b32 s20, 172
v_mad_u32_u24 v199, v200, s20, v202
v_add_u32 v199, 160, v199
v_cvt_f32_u32 v199, v199
v_mul_f32 v204, s19, v199
v_rndne_f32 v204, v204
v_fmac_f32 v199, 0xc4200000, v204
v_mul_f32 v199, s19, v199
v_cos_f32 v199, v199
v_cvt_pk_bf16_f32 v100, v192, v193
v_cvt_pk_bf16_f32 v101, v194, v195
v_cvt_pk_bf16_f32 v102, v196, v197
v_cvt_pk_bf16_f32 v103, v198, v199
v_fma_f32 v184, v203, v192, -v184
v_fma_f32 v185, v203, v193, -v185
v_fma_f32 v186, v203, v194, -v186
v_fma_f32 v187, v203, v195, -v187
v_fma_f32 v188, v203, v196, -v188
v_fma_f32 v189, v203, v197, -v189
v_fma_f32 v190, v203, v198, -v190
v_fma_f32 v191, v203, v199, -v191
v_cvt_pk_bf16_f32 v104, v184, v185
v_cvt_pk_bf16_f32 v105, v186, v187
v_cvt_pk_bf16_f32 v106, v188, v189
v_cvt_pk_bf16_f32 v107, v190, v191
v_fma_f32 v192, v203, v184, -v192
v_fma_f32 v193, v203, v185, -v193
v_fma_f32 v194, v203, v186, -v194
v_fma_f32 v195, v203, v187, -v195
v_fma_f32 v196, v203, v188, -v196
v_fma_f32 v197, v203, v189, -v197
v_fma_f32 v198, v203, v190, -v198
v_fma_f32 v199, v203, v191, -v199
v_cvt_pk_bf16_f32 v108, v192, v193
v_cvt_pk_bf16_f32 v109, v194, v195
v_cvt_pk_bf16_f32 v110, v196, v197
v_cvt_pk_bf16_f32 v111, v198, v199
v_fma_f32 v184, v203, v192, -v184
v_fma_f32 v185, v203, v193, -v185
v_fma_f32 v186, v203, v194, -v186
v_fma_f32 v187, v203, v195, -v187
v_fma_f32 v188, v203, v196, -v188
v_fma_f32 v189, v203, v197, -v189
v_fma_f32 v190, v203, v198, -v190
v_fma_f32 v191, v203, v199, -v191
v_cvt_pk_bf16_f32 v112, v184, v185
v_cvt_pk_bf16_f32 v113, v186, v187
v_cvt_pk_bf16_f32 v114, v188, v189
v_cvt_pk_bf16_f32 v115, v190, v191
v_fma_f32 v192, v203, v184, -v192
v_fma_f32 v193, v203, v185, -v193
v_fma_f32 v194, v203, v186, -v194
v_fma_f32 v195, v203, v187, -v195
v_fma_f32 v196, v203, v188, -v196
v_fma_f32 v197, v203, v189, -v197
v_fma_f32 v198, v203, v190, -v198
v_fma_f32 v199, v203, v191, -v199
v_cvt_pk_bf16_f32 v116, v192, v193
v_cvt_pk_bf16_f32 v117, v194, v195
v_cvt_pk_bf16_f32 v118, v196, v197
v_cvt_pk_bf16_f32 v119, v198, v199
v_fma_f32 v184, v203, v192, -v184
v_fma_f32 v185, v203, v193, -v185
v_fma_f32 v186, v203, v194, -v186
v_fma_f32 v187, v203, v195, -v187
v_fma_f32 v188, v203, v196, -v188
v_fma_f32 v189, v203, v197, -v189
v_fma_f32 v190, v203, v198, -v190
v_fma_f32 v191, v203, v199, -v191
v_cvt_pk_bf16_f32 v120, v184, v185
v_cvt_pk_bf16_f32 v121, v186, v187
v_cvt_pk_bf16_f32 v122, v188, v189
v_cvt_pk_bf16_f32 v123, v190, v191
v_fma_f32 v192, v203, v184, -v192
v_fma_f32 v193, v203, v185, -v193
v_fma_f32 v194, v203, v186, -v194
v_fma_f32 v195, v203, v187, -v195
v_fma_f32 v196, v203, v188, -v196
v_fma_f32 v197, v203, v189, -v197
v_fma_f32 v198, v203, v190, -v198
v_fma_f32 v199, v203, v191, -v199
v_cvt_pk_bf16_f32 v124, v192, v193
v_cvt_pk_bf16_f32 v125, v194, v195
v_cvt_pk_bf16_f32 v126, v196, v197
v_cvt_pk_bf16_f32 v127, v198, v199
v_fma_f32 v184, v203, v192, -v184
v_fma_f32 v185, v203, v193, -v185
v_fma_f32 v186, v203, v194, -v186
v_fma_f32 v187, v203, v195, -v187
v_fma_f32 v188, v203, v196, -v188
v_fma_f32 v189, v203, v197, -v189
v_fma_f32 v190, v203, v198, -v190
v_fma_f32 v191, v203, v199, -v191
v_cvt_pk_bf16_f32 v128, v184, v185
v_cvt_pk_bf16_f32 v129, v186, v187
v_cvt_pk_bf16_f32 v130, v188, v189
v_cvt_pk_bf16_f32 v131, v190, v191
v_fma_f32 v192, v203, v184, -v192
v_fma_f32 v193, v203, v185, -v193
v_fma_f32 v194, v203, v186, -v194
v_fma_f32 v195, v203, v187, -v195
v_fma_f32 v196, v203, v188, -v196
v_fma_f32 v197, v203, v189, -v197
v_fma_f32 v198, v203, v190, -v198
v_fma_f32 v199, v203, v191, -v199
v_cvt_pk_bf16_f32 v132, v192, v193
v_cvt_pk_bf16_f32 v133, v194, v195
v_cvt_pk_bf16_f32 v134, v196, v197
v_cvt_pk_bf16_f32 v135, v198, v199
v_fma_f32 v184, v203, v192, -v184
v_fma_f32 v185, v203, v193, -v185
v_fma_f32 v186, v203, v194, -v186
v_fma_f32 v187, v203, v195, -v187
v_fma_f32 v188, v203, v196, -v188
v_fma_f32 v189, v203, v197, -v189
v_fma_f32 v190, v203, v198, -v190
v_fma_f32 v191, v203, v199, -v191
v_cvt_pk_bf16_f32 v136, v184, v185
v_cvt_pk_bf16_f32 v137, v186, v187
v_cvt_pk_bf16_f32 v138, v188, v189
v_cvt_pk_bf16_f32 v139, v190, v191
v_fma_f32 v192, v203, v184, -v192
v_fma_f32 v193, v203, v185, -v193
v_fma_f32 v194, v203, v186, -v194
v_fma_f32 v195, v203, v187, -v195
v_fma_f32 v196, v203, v188, -v196
v_fma_f32 v197, v203, v189, -v197
v_fma_f32 v198, v203, v190, -v198
v_fma_f32 v199, v203, v191, -v199
v_cvt_pk_bf16_f32 v140, v192, v193
v_cvt_pk_bf16_f32 v141, v194, v195
v_cvt_pk_bf16_f32 v142, v196, v197
v_cvt_pk_bf16_f32 v143, v198, v199
v_fma_f32 v184, v203, v192, -v184
v_fma_f32 v185, v203, v193, -v185
v_fma_f32 v186, v203, v194, -v186
v_fma_f32 v187, v203, v195, -v187
v_fma_f32 v188, v203, v196, -v188
v_fma_f32 v189, v203, v197, -v189
v_fma_f32 v190, v203, v198, -v190
v_fma_f32 v191, v203, v199, -v191
v_cvt_pk_bf16_f32 v144, v184, v185
v_cvt_pk_bf16_f32 v145, v186, v187
v_cvt_pk_bf16_f32 v146, v188, v189
v_cvt_pk_bf16_f32 v147, v190, v191
v_fma_f32 v192, v203, v184, -v192
v_fma_f32 v193, v203, v185, -v193
v_fma_f32 v194, v203, v186, -v194
v_fma_f32 v195, v203, v187, -v195
v_fma_f32 v196, v203, v188, -v196
v_fma_f32 v197, v203, v189, -v197
v_fma_f32 v198, v203, v190, -v198
v_fma_f32 v199, v203, v191, -v199
v_cvt_pk_bf16_f32 v148, v192, v193
v_cvt_pk_bf16_f32 v149, v194, v195
v_cvt_pk_bf16_f32 v150, v196, v197
v_cvt_pk_bf16_f32 v151, v198, v199
v_fma_f32 v184, v203, v192, -v184
v_fma_f32 v185, v203, v193, -v185
v_fma_f32 v186, v203, v194, -v186
v_fma_f32 v187, v203, v195, -v187
v_fma_f32 v188, v203, v196, -v188
v_fma_f32 v189, v203, v197, -v189
v_fma_f32 v190, v203, v198, -v190
v_fma_f32 v191, v203, v199, -v191
v_cvt_pk_bf16_f32 v152, v184, v185
v_cvt_pk_bf16_f32 v153, v186, v187
v_cvt_pk_bf16_f32 v154, v188, v189
v_cvt_pk_bf16_f32 v155, v190, v191
v_fma_f32 v192, v203, v184, -v192
v_fma_f32 v193, v203, v185, -v193
v_fma_f32 v194, v203, v186, -v194
v_fma_f32 v195, v203, v187, -v195
v_fma_f32 v196, v203, v188, -v196
v_fma_f32 v197, v203, v189, -v197
v_fma_f32 v198, v203, v190, -v198
v_fma_f32 v199, v203, v191, -v199
v_cvt_pk_bf16_f32 v156, v192, v193
v_cvt_pk_bf16_f32 v157, v194, v195
v_cvt_pk_bf16_f32 v158, v196, v197
v_cvt_pk_bf16_f32 v159, v198, v199
v_fma_f32 v184, v203, v192, -v184
v_fma_f32 v185, v203, v193, -v185
v_fma_f32 v186, v203, v194, -v186
v_fma_f32 v187, v203, v195, -v187
v_fma_f32 v188, v203, v196, -v188
v_fma_f32 v189, v203, v197, -v189
v_fma_f32 v190, v203, v198, -v190
v_fma_f32 v191, v203, v199, -v191
v_cvt_pk_bf16_f32 v160, v184, v185
v_cvt_pk_bf16_f32 v161, v186, v187
v_cvt_pk_bf16_f32 v162, v188, v189
v_cvt_pk_bf16_f32 v163, v190, v191
v_fma_f32 v192, v203, v184, -v192
v_fma_f32 v193, v203, v185, -v193
v_fma_f32 v194, v203, v186, -v194
v_fma_f32 v195, v203, v187, -v195
v_fma_f32 v196, v203, v188, -v196
v_fma_f32 v197, v203, v189, -v197
v_fma_f32 v198, v203, v190, -v198
v_fma_f32 v199, v203, v191, -v199
v_cvt_pk_bf16_f32 v164, v192, v193
v_cvt_pk_bf16_f32 v165, v194, v195
v_cvt_pk_bf16_f32 v166, v196, v197
v_cvt_pk_bf16_f32 v167, v198, v199
v_fma_f32 v184, v203, v192, -v184
v_fma_f32 v185, v203, v193, -v185
v_fma_f32 v186, v203, v194, -v186
v_fma_f32 v187, v203, v195, -v187
v_fma_f32 v188, v203, v196, -v188
v_fma_f32 v189, v203, v197, -v189
v_fma_f32 v190, v203, v198, -v190
v_fma_f32 v191, v203, v199, -v191
v_cvt_pk_bf16_f32 v168, v184, v185
v_cvt_pk_bf16_f32 v169, v186, v187
v_cvt_pk_bf16_f32 v170, v188, v189
v_cvt_pk_bf16_f32 v171, v190, v191
v_fma_f32 v192, v203, v184, -v192
v_fma_f32 v193, v203, v185, -v193
v_fma_f32 v194, v203, v186, -v194
v_fma_f32 v195, v203, v187, -v195
v_fma_f32 v196, v203, v188, -v196
v_fma_f32 v197, v203, v189, -v197
v_fma_f32 v198, v203, v190, -v198
v_fma_f32 v199, v203, v191, -v199
s_mov_b32 exec_lo, 0
v_mul_f32 v198, 0.5, v198
s_mov_b32 exec_lo, -1
v_cvt_pk_bf16_f32 v172, v192, v193
v_cvt_pk_bf16_f32 v173, v194, v195
v_cvt_pk_bf16_f32 v174, v196, v197
v_cvt_pk_bf16_f32 v175, v198, v199
v_and_b32 v1, 0x2f0, v0
v_bfe_u32 v3, v0, 8, 1
v_lshl_add_u32 v1, v3, 3, v1
s_mul_i32 s18, s46, 40960
s_mul_i32 s19, s16, 3145728
s_add_u32 s26, s18, s19
s_add_u32 s27, s26, s19
s_add_u32 s27, s27, s33
s_add_u32 s27, s27, 88080384
s_add_u32 s26, s26, s31
s_add_u32 s26, s26, 103809024
s_mov_b32 s39, 0x20000
s_cmp_lg_u32 s16, 0
s_cbranch_scc1 rs_35
s_mov_b64 s[36:37], s[40:41]
s_mov_b32 s38, s42
s_lshr_b32 s47, s33, 5
s_add_u32 s47, s47, s18
s_add_u32 s48, s47, 32
v_mov_b32 v13, v5
s_branch rs_36
rs_35:
s_mov_b64 s[36:37], s[4:5]
s_mov_b32 s38, s6
s_sub_u32 s47, s27, 3145728
s_add_u32 s48, s47, 1024
v_mov_b32 v13, v0
rs_36:
s_cmp_lg_u32 s13, 0
s_cbranch_scc1 polld_38
v_min_u32 v12, 624, v0
s_mov_b32 s21, 7168
s_mov_b32 s17, 0
poll_37:
buffer_load_dwordx4 v[8:11], v12, s[4:7], s21 offen offset:0 sc1
s_add_u32 s17, s17, 1
s_cmp_gt_u32 s17, 262144
s_cbranch_scc1 L_fail
s_waitcnt vmcnt(0)
v_min3_u32 v8, v8, v9, v10
v_min_u32 v8, v8, v11
v_cmp_gt_u32 vcc, s29, v8
s_cbranch_vccz polld_38
s_sleep 2
s_branch poll_37
polld_38:
s_barrier
s_add_u32 m0, s31, 2048
s_add_u32 s20, s26, 0
buffer_load_dwordx4 v0, s[4:7], s20 offen sc1 lds
s_add_u32 m0, s31, 3072
s_add_u32 s20, s26, 1024
buffer_load_dwordx4 v0, s[4:7], s20 offen sc1 lds
s_add_u32 m0, s31, 4096
s_add_u32 s20, s26, 2048
buffer_load_dwordx4 v0, s[4:7], s20 offen sc1 lds
s_add_u32 m0, s31, 5120
s_add_u32 s20, s26, 3072
buffer_load_dwordx4 v0, s[4:7], s20 offen sc1 lds
s_add_u32 m0, s31, 6144
s_add_u32 s20, s26, 4096
buffer_load_dwordx4 v0, s[4:7], s20 offen sc1 lds
s_add_u32 m0, s31, 7168
s_add_u32 s20, s26, 5120
buffer_load_dwordx4 v0, s[4:7], s20 offen sc1 lds
s_add_u32 m0, s31, 8192
s_add_u32 s20, s26, 6144
buffer_load_dwordx4 v0, s[4:7], s20 offen sc1 lds
s_add_u32 m0, s31, 9216
s_add_u32 s20, s26, 7168
buffer_load_dwordx4 v0, s[4:7], s20 offen sc1 lds
s_add_u32 m0, s31, 10240
s_add_u32 s20, s26, 8192
buffer_load_dwordx4 v0, s[4:7], s20 offen sc1 lds
s_add_u32 m0, s31, 11264
s_add_u32 s20, s26, 9216
buffer_load_dwordx4 v0, s[4:7], s20 offen sc1 lds
s_add_u32 s26, s26, 1310720
s_add_u32 s25, s31, 40960
s_mov_b32 s28, 0
p3_39:
s_waitcnt vmcnt(0)
s_barrier
ds_read_b64_tr_b16 v[200:201], v1 offset:2048
ds_read_b64_tr_b16 v[202:203], v1 offset:2304
ds_read_b64_tr_b16 v[214:215], v1 offset:5376
ds_read_b64_tr_b16 v[204:205], v1 offset:3072
ds_read_b64_tr_b16 v[210:211], v1 offset:4352
ds_read_b64_tr_b16 v[206:207], v1 offset:3328
ds_read_b64_tr_b16 v[212:213], v1 offset:5120
ds_read_b64_tr_b16 v[208:209], v1 offset:4096
buffer_load_dwordx4 v[176:179], v13, s[36:39], s47 offen sc1
s_waitcnt lgkmcnt(6)
v_mfma_f32_32x32x16_bf16 v[184:199], v[16:19], v[200:203], 0
ds_read_b64_tr_b16 v[200:201], v1 offset:6144
s_waitcnt lgkmcnt(3)
v_mfma_f32_32x32x16_bf16 v[184:199], v[20:23], v[204:207], v[184:199]
ds_read_b64_tr_b16 v[202:203], v1 offset:6400
buffer_load_dwordx4 v[180:183], v13, s[36:39], s48 offen sc1
s_waitcnt lgkmcnt(2)
v_mfma_f32_32x32x16_bf16 v[184:199], v[24:27], v[208:211], v[184:199]
ds_read_b64_tr_b16 v[206:207], v1 offset:7424
s_waitcnt lgkmcnt(2)
ds_read_b64_tr_b16 v[210:211], v1 offset:8448
ds_read_b64_tr_b16 v[204:205], v1 offset:7168
ds_read_b64_tr_b16 v[208:209], v1 offset:8192
v_mfma_f32_32x32x16_bf16 v[184:199], v[28:31], v[212:215], v[184:199]
ds_read_b64_tr_b16 v[214:215], v1 offset:9472
s_waitcnt lgkmcnt(5)
ds_read_b64_tr_b16 v[212:213], v1 offset:9216
s_add_u32 m0, s25, 2048
s_add_u32 s20, s26, 0
buffer_load_dwordx4 v0, s[4:7], s20 offen sc1 lds
v_mfma_f32_32x32x16_bf16 v[184:199], v[32:35], v[200:203], v[184:199]
s_waitcnt lgkmcnt(3)
s_add_u32 m0, s25, 3072
s_add_u32 s20, s26, 1024
buffer_load_dwordx4 v0, s[4:7], s20 offen sc1 lds
v_mfma_f32_32x32x16_bf16 v[184:199], v[36:39], v[204:207], v[184:199]
ds_read_b64_tr_b16 v[200:201], v1 offset:10240
s_waitcnt lgkmcnt(3)
ds_read_b64_tr_b16 v[202:203], v1 offset:10496
s_waitcnt lgkmcnt(3)
ds_read_b64_tr_b16 v[204:205], v1 offset:11264
ds_read_b64_tr_b16 v[206:207], v1 offset:11520
v_mfma_f32_32x32x16_bf16 v[184:199], v[40:43], v[208:211], v[184:199]
s_waitcnt lgkmcnt(4)
ds_read_b64_tr_b16 v[210:211], v1 offset:12544
ds_read_b64_tr_b16 v[208:209], v1 offset:12288
v_mfma_f32_32x32x16_bf16 v[184:199], v[44:47], v[212:215], v[184:199]
ds_read_b64_tr_b16 v[212:213], v1 offset:13312
ds_read_b64_tr_b16 v[214:215], v1 offset:13568
s_waitcnt lgkmcnt(7)
s_waitcnt lgkmcnt(6)
s_waitcnt lgkmcnt(4)
v_mfma_f32_32x32x16_bf16 v[184:199], v[48:51], v[200:203], v[184:199]
ds_read_b64_tr_b16 v[202:203], v1 offset:14592
s_waitcnt lgkmcnt(3)
ds_read_b64_tr_b16 v[200:201], v1 offset:14336
v_mfma_f32_32x32x16_bf16 v[184:199], v[52:55], v[204:207], v[184:199]
s_add_u32 m0, s25, 4096
s_add_u32 s20, s26, 2048
buffer_load_dwordx4 v0, s[4:7], s20 offen sc1 lds
s_add_u32 m0, s25, 5120
s_add_u32 s20, s26, 3072
buffer_load_dwordx4 v0, s[4:7], s20 offen sc1 lds
ds_read_b64_tr_b16 v[204:205], v1 offset:15360
v_mfma_f32_32x32x16_bf16 v[184:199], v[56:59], v[208:211], v[184:199]
ds_read_b64_tr_b16 v[210:211], v1 offset:16640
ds_read_b64_tr_b16 v[208:209], v1 offset:16384
ds_read_b64_tr_b16 v[206:207], v1 offset:15616
s_waitcnt lgkmcnt(6)
s_waitcnt lgkmcnt(5)
v_mfma_f32_32x32x16_bf16 v[184:199], v[60:63], v[212:215], v[184:199]
s_waitcnt lgkmcnt(3)
ds_read_b64_tr_b16 v[214:215], v1 offset:17664
v_mfma_f32_32x32x16_bf16 v[184:199], v[64:67], v[200:203], v[184:199]
ds_read_b64_tr_b16 v[202:203], v1 offset:18688
s_waitcnt lgkmcnt(2)
ds_read_b64_tr_b16 v[212:213], v1 offset:17408
ds_read_b64_tr_b16 v[200:201], v1 offset:18432
v_mfma_f32_32x32x16_bf16 v[184:199], v[68:71], v[204:207], v[184:199]
ds_read_b64_tr_b16 v[204:205], v1 offset:19456
s_add_u32 m0, s25, 6144
s_add_u32 s20, s26, 4096
buffer_load_dwordx4 v0, s[4:7], s20 offen sc1 lds
ds_read_b64_tr_b16 v[206:207], v1 offset:19712
v_mfma_f32_32x32x16_bf16 v[184:199], v[72:75], v[208:211], v[184:199]
s_waitcnt lgkmcnt(2)
ds_read_b64_tr_b16 v[208:209], v1 offset:20480
v_mfma_f32_32x32x16_bf16 v[184:199], v[76:79], v[212:215], v[184:199]
ds_read_b64_tr_b16 v[212:213], v1 offset:21504
s_waitcnt lgkmcnt(2)
ds_read_b64_tr_b16 v[210:211], v1 offset:20736
ds_read_b64_tr_b16 v[214:215], v1 offset:21760
v_mfma_f32_32x32x16_bf16 v[184:199], v[80:83], v[200:203], v[184:199]
ds_read_b64_tr_b16 v[202:203], v1 offset:22784
ds_read_b64_tr_b16 v[200:201], v1 offset:22528
s_waitcnt lgkmcnt(5)
v_mfma_f32_32x32x16_bf16 v[184:199], v[84:87], v[204:207], v[184:199]
s_waitcnt lgkmcnt(4)
ds_read_b64_tr_b16 v[206:207], v1 offset:23808
s_waitcnt lgkmcnt(4)
v_mfma_f32_32x32x16_bf16 v[184:199], v[88:91], v[208:211], v[184:199]
s_waitcnt lgkmcnt(3)
ds_read_b64_tr_b16 v[208:209], v1 offset:24576
ds_read_b64_tr_b16 v[210:211], v1 offset:24832
s_waitcnt lgkmcnt(4)
ds_read_b64_tr_b16 v[204:205], v1 offset:23552
s_waitcnt lgkmcnt(4)
v_mfma_f32_32x32x16_bf16 v[184:199], v[92:95], v[212:215], v[184:199]
s_barrier
s_waitcnt lgkmcnt(3)
v_mfma_f32_32x32x16_bf16 v[184:199], v[96:99], v[200:203], v[184:199]
ds_read_b64_tr_b16 v[200:201], v1 offset:26624
s_waitcnt lgkmcnt(2)
ds_read_b64_tr_b16 v[214:215], v1 offset:25856
ds_read_b64_tr_b16 v[202:203], v1 offset:26880
ds_read_b64_tr_b16 v[212:213], v1 offset:25600
s_waitcnt lgkmcnt(4)
v_mfma_f32_32x32x16_bf16 v[184:199], v[100:103], v[204:207], v[184:199]
s_add_u32 m0, s25, 7168
s_add_u32 s20, s26, 5120
buffer_load_dwordx4 v0, s[4:7], s20 offen sc1 lds
ds_read_b64_tr_b16 v[204:205], v1 offset:27648
v_mfma_f32_32x32x16_bf16 v[184:199], v[104:107], v[208:211], v[184:199]
ds_read_b64_tr_b16 v[206:207], v1 offset:27904
s_waitcnt lgkmcnt(3)
ds_read_b64_tr_b16 v[210:211], v1 offset:28928
s_waitcnt lgkmcnt(3)
ds_read_b64_tr_b16 v[208:209], v1 offset:28672
v_mfma_f32_32x32x16_bf16 v[184:199], v[108:111], v[212:215], v[184:199]
ds_read_b64_tr_b16 v[214:215], v1 offset:29952
s_waitcnt lgkmcnt(4)
s_add_u32 m0, s25, 8192
s_add_u32 s20, s26, 6144
buffer_load_dwordx4 v0, s[4:7], s20 offen sc1 lds
ds_read_b64_tr_b16 v[212:213], v1 offset:29696
v_mfma_f32_32x32x16_bf16 v[184:199], v[112:115], v[200:203], v[184:199]
s_waitcnt lgkmcnt(4)
v_mov_b32 v3, s23
ds_read_b64_tr_b16 v[200:201], v1 offset:30720
ds_read_b64_tr_b16 v[202:203], v1 offset:30976
s_waitcnt lgkmcnt(5)
v_mfma_f32_32x32x16_bf16 v[184:199], v[116:119], v[204:207], v[184:199]
ds_read_b64_tr_b16 v[204:205], v1 offset:31744
s_waitcnt lgkmcnt(5)
s_waitcnt lgkmcnt(4)
ds_read_b64_tr_b16 v[206:207], v1 offset:32000
v_mfma_f32_32x32x16_bf16 v[184:199], v[120:123], v[208:211], v[184:199]
s_waitcnt lgkmcnt(4)
s_add_u32 m0, s25, 9216
s_add_u32 s20, s26, 7168
buffer_load_dwordx4 v0, s[4:7], s20 offen sc1 lds
ds_read_b64_tr_b16 v[210:211], v1 offset:33024
v_mfma_f32_32x32x16_bf16 v[184:199], v[124:127], v[212:215], v[184:199]
s_waitcnt lgkmcnt(4)
ds_read_b64_tr_b16 v[214:215], v1 offset:34048
s_add_u32 m0, s25, 10240
s_add_u32 s20, s26, 8192
buffer_load_dwordx4 v0, s[4:7], s20 offen sc1 lds
ds_read_b64_tr_b16 v[208:209], v1 offset:32768
s_waitcnt lgkmcnt(5)
v_mfma_f32_32x32x16_bf16 v[184:199], v[128:131], v[200:203], v[184:199]
s_waitcnt lgkmcnt(3)
ds_read_b64_tr_b16 v[202:203], v1 offset:35072
s_waitcnt lgkmcnt(3)
ds_read_b64_tr_b16 v[212:213], v1 offset:33792
ds_read_b64_tr_b16 v[200:201], v1 offset:34816
v_mfma_f32_32x32x16_bf16 v[184:199], v[132:135], v[204:207], v[184:199]
s_waitcnt lgkmcnt(4)
ds_read_b64_tr_b16 v[206:207], v1 offset:36096
ds_read_b64_tr_b16 v[204:205], v1 offset:35840
s_waitcnt lgkmcnt(5)
v_mfma_f32_32x32x16_bf16 v[184:199], v[136:139], v[208:211], v[184:199]
ds_read_b64_tr_b16 v[210:211], v1 offset:37120
s_waitcnt lgkmcnt(4)
ds_read_b64_tr_b16 v[208:209], v1 offset:36864
v_mfma_f32_32x32x16_bf16 v[184:199], v[140:143], v[212:215], v[184:199]
ds_read_b64_tr_b16 v[214:215], v1 offset:38144
s_waitcnt lgkmcnt(3)
s_add_u32 m0, s25, 11264
s_add_u32 s20, s26, 9216
buffer_load_dwordx4 v0, s[4:7], s20 offen sc1 lds
v_mfma_f32_32x32x16_bf16 v[184:199], v[144:147], v[200:203], v[184:199]
s_waitcnt lgkmcnt(2)
ds_read_b64_tr_b16 v[200:201], v1 offset:38912
ds_read_b64_tr_b16 v[202:203], v1 offset:39168
ds_read_b64_tr_b16 v[212:213], v1 offset:37888
v_mfma_f32_32x32x16_bf16 v[184:199], v[148:151], v[204:207], v[184:199]
s_waitcnt lgkmcnt(3)
ds_read_b64_tr_b16 v[206:207], v1 offset:40192
s_waitcnt vmcnt(11)
ds_read_b64_tr_b16 v[204:205], v1 offset:39936
v_mfma_f32_32x32x16_bf16 v[184:199], v[152:155], v[208:211], v[184:199]
s_mov_b64 exec, 1
buffer_store_dword v3, off, s[4:7], s22 sc1
s_mov_b64 exec, -1
s_waitcnt lgkmcnt(3)
s_waitcnt lgkmcnt(2)
s_waitcnt vmcnt(11)
v_mfma_f32_32x32x16_bf16 v[184:199], v[156:159], v[212:215], v[184:199]
ds_read_b64_tr_b16 v[210:211], v1 offset:41216
ds_read_b64_tr_b16 v[208:209], v1 offset:40960
ds_read_b64_tr_b16 v[214:215], v1 offset:42240
s_waitcnt lgkmcnt(4)
s_waitcnt lgkmcnt(3)
v_mfma_f32_32x32x16_bf16 v[184:199], v[160:163], v[200:203], v[184:199]
ds_read_b64_tr_b16 v[212:213], v1 offset:41984
v_and_b32 v4, 0xffff0000, v176
v_mfma_f32_32x32x16_bf16 v[184:199], v[164:167], v[204:207], v[184:199]
s_waitcnt lgkmcnt(1)
v_lshlrev_b32 v3, 16, v176
v_mfma_f32_32x32x16_bf16 v[184:199], v[168:171], v[208:211], v[184:199]
s_waitcnt lgkmcnt(0)
v_mfma_f32_32x32x16_bf16 v[184:199], v[172:175], v[212:215], v[184:199]
s_nop 11
v_fmamk_f32 v185, v185, 0x3b4ccccd, v4
v_fmamk_f32 v184, v184, 0x3b4ccccd, v3
v_and_b32 v4, 0xffff0000, v177
v_lshlrev_b32 v3, 16, v177
v_fmamk_f32 v186, v186, 0x3b4ccccd, v3
v_fmamk_f32 v187, v187, 0x3b4ccccd, v4
v_and_b32 v4, 0xffff0000, v178
v_lshlrev_b32 v3, 16, v178
v_fmamk_f32 v188, v188, 0x3b4ccccd, v3
v_fmamk_f32 v189, v189, 0x3b4ccccd, v4
v_and_b32 v4, 0xffff0000, v179
v_cvt_pk_bf16_f32 v202, v188, v189
v_cvt_pk_bf16_f32 v201, v186, v187
v_lshlrev_b32 v3, 16, v179
v_fmamk_f32 v191, v191, 0x3b4ccccd, v4
v_fmamk_f32 v190, v190, 0x3b4ccccd, v3
v_and_b32 v4, 0xffff0000, v180
v_fmamk_f32 v193, v193, 0x3b4ccccd, v4
v_and_b32 v4, 0xffff0000, v181
v_cvt_pk_bf16_f32 v200, v184, v185
v_lshlrev_b32 v3, 16, v180
v_cvt_pk_bf16_f32 v203, v190, v191
v_fmamk_f32 v195, v195, 0x3b4ccccd, v4
v_fmamk_f32 v192, v192, 0x3b4ccccd, v3
v_and_b32 v4, 0xffff0000, v182
v_lshlrev_b32 v3, 16, v181
v_fmamk_f32 v194, v194, 0x3b4ccccd, v3
v_lshlrev_b32 v3, 16, v182
v_cvt_pk_bf16_f32 v204, v192, v193
v_fmamk_f32 v196, v196, 0x3b4ccccd, v3
v_fmamk_f32 v197, v197, 0x3b4ccccd, v4
v_cvt_pk_bf16_f32 v206, v196, v197
v_and_b32 v4, 0xffff0000, v183
v_lshlrev_b32 v3, 16, v183
v_fmamk_f32 v198, v198, 0x3b4ccccd, v3
v_fmamk_f32 v199, v199, 0x3b4ccccd, v4
v_cvt_pk_bf16_f32 v205, v194, v195
v_cvt_pk_bf16_f32 v207, v198, v199
buffer_store_dwordx4 v[200:203], v0, s[4:7], s27 offen offset:0 sc1
buffer_store_dwordx4 v[204:207], v0, s[4:7], s27 offen offset:1024 sc1
v_xor_b32 v1, 40960, v1
s_mov_b32 s26, s6
s_mov_b32 s25, s31
s_add_u32 s27, s27, 1310720
s_add_u32 s47, s47, 1310720
s_add_u32 s48, s48, 1310720
s_add_u32 s28, s28, 1
s_lshl_b32 s18, s35, 2
s_add_u32 s18, s18, 8192
s_lshl_b32 s19, s16, 1
s_add_u32 s19, s19, s28
s_cmp_eq_u32 s13, 0
s_cselect_b32 s22, s18, s6
s_mov_b32 s23, s19
s_cmp_lt_u32 s28, 2
s_cbranch_scc1 p3_39
s_waitcnt vmcnt(0)
s_barrier
v_mov_b32 v3, s23
s_mov_b64 exec, 1
buffer_store_dword v3, off, s[4:7], s22 sc1
s_mov_b64 exec, -1
s_mov_b32 s22, s6
s_cmp_ge_u32 s35, 144
s_cbranch_scc1 p1b_41
s_cmp_ge_u32 s35, 64
s_cbranch_scc1 wo_40
s_and_b32 s32, s35, 31
s_cmp_lg_u32 s16, 0
s_cbranch_scc1 qw_43
s_lshl_b32 s26, s32, 8
s_lshl_b32 s18, s13, 6
s_add_u32 s26, s26, s18
s_load_dwordx2 s[36:37], s[0:1], 40
s_mov_b32 s38, 5242880
s_mov_b32 s39, 0x20000
s_waitcnt lgkmcnt(0)
v_lshrrev_b32 v34, 6, v0
v_mul_u32_u24 v34, 8192, v34
v_and_b32 v35, 48, v0
v_add_u32 v32, v34, v35
v_bfe_u32 v34, v0, 6, 2
v_lshrrev_b32 v35, 9, v0
v_lshl_add_u32 v34, v35, 3, v34
v_lshlrev_b32 v33, 6, v34
v_and_b32 v34, 16, v0
v_add_u32 v33, v33, v34
v_bfe_u32 v34, v0, 5, 1
v_lshl_add_u32 v33, v34, 3, v33
v_bfe_u32 v34, v0, 8, 1
v_lshl_add_u32 v33, v34, 5, v33
s_mul_i32 s18, s13, 36864
v_add_u32 v33, s18, v33
s_barrier
s_add_u32 m0, s18, 0
s_add_u32 s19, s26, 0
buffer_load_dwordx4 v32, s[36:39], s19 offen lds
s_add_u32 m0, s18, 1024
s_add_u32 s19, s26, 131072
buffer_load_dwordx4 v32, s[36:39], s19 offen lds
s_add_u32 m0, s18, 2048
s_add_u32 s19, s26, 262144
buffer_load_dwordx4 v32, s[36:39], s19 offen lds
s_add_u32 m0, s18, 3072
s_add_u32 s19, s26, 393216
buffer_load_dwordx4 v32, s[36:39], s19 offen lds
s_add_u32 m0, s18, 4096
s_add_u32 s19, s26, 524288
buffer_load_dwordx4 v32, s[36:39], s19 offen lds
s_add_u32 m0, s18, 5120
s_add_u32 s19, s26, 655360
buffer_load_dwordx4 v32, s[36:39], s19 offen lds
s_add_u32 m0, s18, 6144
s_add_u32 s19, s26, 786432
buffer_load_dwordx4 v32, s[36:39], s19 offen lds
s_add_u32 m0, s18, 7168
s_add_u32 s19, s26, 917504
buffer_load_dwordx4 v32, s[36:39], s19 offen lds
s_add_u32 m0, s18, 8192
s_add_u32 s19, s26, 1048576
buffer_load_dwordx4 v32, s[36:39], s19 offen lds
s_add_u32 m0, s18, 9216
s_add_u32 s19, s26, 1179648
buffer_load_dwordx4 v32, s[36:39], s19 offen lds
s_add_u32 m0, s18, 10240
s_add_u32 s19, s26, 1310720
buffer_load_dwordx4 v32, s[36:39], s19 offen lds
s_add_u32 m0, s18, 11264
s_add_u32 s19, s26, 1441792
buffer_load_dwordx4 v32, s[36:39], s19 offen lds
s_add_u32 m0, s18, 12288
s_add_u32 s19, s26, 1572864
buffer_load_dwordx4 v32, s[36:39], s19 offen lds
s_add_u32 m0, s18, 13312
s_add_u32 s19, s26, 1703936
buffer_load_dwordx4 v32, s[36:39], s19 offen lds
s_add_u32 m0, s18, 14336
s_add_u32 s19, s26, 1835008
buffer_load_dwordx4 v32, s[36:39], s19 offen lds
s_add_u32 m0, s18, 15360
s_add_u32 s19, s26, 1966080
buffer_load_dwordx4 v32, s[36:39], s19 offen lds
s_add_u32 m0, s18, 16384
s_add_u32 s19, s26, 2097152
buffer_load_dwordx4 v32, s[36:39], s19 offen lds
s_add_u32 m0, s18, 17408
s_add_u32 s19, s26, 2228224
buffer_load_dwordx4 v32, s[36:39], s19 offen lds
s_add_u32 m0, s18, 18432
s_add_u32 s19, s26, 2359296
buffer_load_dwordx4 v32, s[36:39], s19 offen lds
s_add_u32 m0, s18, 19456
s_add_u32 s19, s26, 2490368
buffer_load_dwordx4 v32, s[36:39], s19 offen lds
s_add_u32 m0, s18, 20480
s_add_u32 s19, s26, 2621440
buffer_load_dwordx4 v32, s[36:39], s19 offen lds
s_add_u32 m0, s18, 21504
s_add_u32 s19, s26, 2752512
buffer_load_dwordx4 v32, s[36:39], s19 offen lds
s_add_u32 m0, s18, 22528
s_add_u32 s19, s26, 2883584
buffer_load_dwordx4 v32, s[36:39], s19 offen lds
s_add_u32 m0, s18, 23552
s_add_u32 s19, s26, 3014656
buffer_load_dwordx4 v32, s[36:39], s19 offen lds
s_add_u32 m0, s18, 24576
s_add_u32 s19, s26, 3145728
buffer_load_dwordx4 v32, s[36:39], s19 offen lds
s_add_u32 m0, s18, 25600
s_add_u32 s19, s26, 3276800
buffer_load_dwordx4 v32, s[36:39], s19 offen lds
s_add_u32 m0, s18, 26624
s_add_u32 s19, s26, 3407872
buffer_load_dwordx4 v32, s[36:39], s19 offen lds
s_add_u32 m0, s18, 27648
s_add_u32 s19, s26, 3538944
buffer_load_dwordx4 v32, s[36:39], s19 offen lds
s_add_u32 m0, s18, 28672
s_add_u32 s19, s26, 3670016
buffer_load_dwordx4 v32, s[36:39], s19 offen lds
s_add_u32 m0, s18, 29696
s_add_u32 s19, s26, 3801088
buffer_load_dwordx4 v32, s[36:39], s19 offen lds
s_add_u32 m0, s18, 30720
s_add_u32 s19, s26, 3932160
buffer_load_dwordx4 v32, s[36:39], s19 offen lds
s_add_u32 m0, s18, 31744
s_add_u32 s19, s26, 4063232
buffer_load_dwordx4 v32, s[36:39], s19 offen lds
s_add_u32 m0, s18, 32768
s_add_u32 s19, s26, 4194304
buffer_load_dwordx4 v32, s[36:39], s19 offen lds
s_add_u32 m0, s18, 33792
s_add_u32 s19, s26, 4325376
buffer_load_dwordx4 v32, s[36:39], s19 offen lds
s_add_u32 m0, s18, 34816
s_add_u32 s19, s26, 4456448
buffer_load_dwordx4 v32, s[36:39], s19 offen lds
s_add_u32 m0, s18, 35840
s_add_u32 s19, s26, 4587520
buffer_load_dwordx4 v32, s[36:39], s19 offen lds
s_waitcnt vmcnt(32)
ds_read_b64_tr_b16 a[0:1], v33 offset:0
ds_read_b64_tr_b16 a[2:3], v33 offset:256
ds_read_b64_tr_b16 a[4:5], v33 offset:1024
ds_read_b64_tr_b16 a[6:7], v33 offset:1280
ds_read_b64_tr_b16 a[8:9], v33 offset:2048
ds_read_b64_tr_b16 a[10:11], v33 offset:2304
ds_read_b64_tr_b16 a[12:13], v33 offset:3072
ds_read_b64_tr_b16 a[14:15], v33 offset:3328
s_waitcnt lgkmcnt(0)
s_add_u32 m0, s18, 0
s_add_u32 s19, s26, 4718592
buffer_load_dwordx4 v32, s[36:39], s19 offen lds
s_add_u32 m0, s18, 1024
s_add_u32 s19, s26, 4849664
buffer_load_dwordx4 v32, s[36:39], s19 offen lds
s_add_u32 m0, s18, 2048
s_add_u32 s19, s26, 4980736
buffer_load_dwordx4 v32, s[36:39], s19 offen lds
s_add_u32 m0, s18, 3072
s_add_u32 s19, s26, 5111808
buffer_load_dwordx4 v32, s[36:39], s19 offen lds
s_waitcnt vmcnt(32)
ds_read_b64_tr_b16 a[16:17], v33 offset:4096
ds_read_b64_tr_b16 a[18:19], v33 offset:4352
ds_read_b64_tr_b16 a[20:21], v33 offset:5120
ds_read_b64_tr_b16 a[22:23], v33 offset:5376
ds_read_b64_tr_b16 a[24:25], v33 offset:6144
ds_read_b64_tr_b16 a[26:27], v33 offset:6400
ds_read_b64_tr_b16 a[28:29], v33 offset:7168
ds_read_b64_tr_b16 a[30:31], v33 offset:7424
s_waitcnt vmcnt(28)
ds_read_b64_tr_b16 a[32:33], v33 offset:8192
ds_read_b64_tr_b16 a[34:35], v33 offset:8448
ds_read_b64_tr_b16 a[36:37], v33 offset:9216
ds_read_b64_tr_b16 a[38:39], v33 offset:9472
ds_read_b64_tr_b16 a[40:41], v33 offset:10240
ds_read_b64_tr_b16 a[42:43], v33 offset:10496
ds_read_b64_tr_b16 a[44:45], v33 offset:11264
ds_read_b64_tr_b16 a[46:47], v33 offset:11520
s_waitcnt vmcnt(24)
ds_read_b64_tr_b16 a[48:49], v33 offset:12288
ds_read_b64_tr_b16 a[50:51], v33 offset:12544
ds_read_b64_tr_b16 a[52:53], v33 offset:13312
ds_read_b64_tr_b16 a[54:55], v33 offset:13568
ds_read_b64_tr_b16 a[56:57], v33 offset:14336
ds_read_b64_tr_b16 a[58:59], v33 offset:14592
ds_read_b64_tr_b16 a[60:61], v33 offset:15360
ds_read_b64_tr_b16 a[62:63], v33 offset:15616
s_waitcnt vmcnt(20)
ds_read_b64_tr_b16 a[64:65], v33 offset:16384
ds_read_b64_tr_b16 a[66:67], v33 offset:16640
ds_read_b64_tr_b16 a[68:69], v33 offset:17408
ds_read_b64_tr_b16 a[70:71], v33 offset:17664
ds_read_b64_tr_b16 a[72:73], v33 offset:18432
ds_read_b64_tr_b16 a[74:75], v33 offset:18688
ds_read_b64_tr_b16 a[76:77], v33 offset:19456
ds_read_b64_tr_b16 a[78:79], v33 offset:19712
s_waitcnt vmcnt(16)
ds_read_b64_tr_b16 a[80:81], v33 offset:20480
ds_read_b64_tr_b16 a[82:83], v33 offset:20736
ds_read_b64_tr_b16 a[84:85], v33 offset:21504
ds_read_b64_tr_b16 a[86:87], v33 offset:21760
ds_read_b64_tr_b16 a[88:89], v33 offset:22528
ds_read_b64_tr_b16 a[90:91], v33 offset:22784
ds_read_b64_tr_b16 a[92:93], v33 offset:23552
ds_read_b64_tr_b16 a[94:95], v33 offset:23808
s_waitcnt vmcnt(12)
ds_read_b64_tr_b16 a[96:97], v33 offset:24576
ds_read_b64_tr_b16 a[98:99], v33 offset:24832
ds_read_b64_tr_b16 a[100:101], v33 offset:25600
ds_read_b64_tr_b16 a[102:103], v33 offset:25856
ds_read_b64_tr_b16 a[104:105], v33 offset:26624
ds_read_b64_tr_b16 a[106:107], v33 offset:26880
ds_read_b64_tr_b16 a[108:109], v33 offset:27648
ds_read_b64_tr_b16 a[110:111], v33 offset:27904
s_waitcnt vmcnt(8)
ds_read_b64_tr_b16 a[112:113], v33 offset:28672
ds_read_b64_tr_b16 a[114:115], v33 offset:28928
ds_read_b64_tr_b16 a[116:117], v33 offset:29696
ds_read_b64_tr_b16 a[118:119], v33 offset:29952
ds_read_b64_tr_b16 a[120:121], v33 offset:30720
ds_read_b64_tr_b16 a[122:123], v33 offset:30976
ds_read_b64_tr_b16 a[124:125], v33 offset:31744
ds_read_b64_tr_b16 a[126:127], v33 offset:32000
s_waitcnt vmcnt(4)
ds_read_b64_tr_b16 a[128:129], v33 offset:32768
ds_read_b64_tr_b16 a[130:131], v33 offset:33024
ds_read_b64_tr_b16 a[132:133], v33 offset:33792
ds_read_b64_tr_b16 a[134:135], v33 offset:34048
ds_read_b64_tr_b16 a[136:137], v33 offset:34816
ds_read_b64_tr_b16 a[138:139], v33 offset:35072
ds_read_b64_tr_b16 a[140:141], v33 offset:35840
ds_read_b64_tr_b16 a[142:143], v33 offset:36096
s_waitcnt vmcnt(0)
ds_read_b64_tr_b16 a[144:145], v33 offset:0
ds_read_b64_tr_b16 a[146:147], v33 offset:256
ds_read_b64_tr_b16 a[148:149], v33 offset:1024
ds_read_b64_tr_b16 a[150:151], v33 offset:1280
ds_read_b64_tr_b16 a[152:153], v33 offset:2048
ds_read_b64_tr_b16 a[154:155], v33 offset:2304
ds_read_b64_tr_b16 a[156:157], v33 offset:3072
ds_read_b64_tr_b16 a[158:159], v33 offset:3328
s_waitcnt lgkmcnt(0)
s_barrier
v_mov_b32 v32, s24
v_mov_b32 v33, s24
v_mov_b32 v34, s24
v_mov_b32 v35, s24
s_nop 1
v_mfma_f32_32x32x16_bf16 v[36:51], a[0:3], v[32:35], 0
v_mfma_f32_32x32x16_bf16 v[36:51], a[4:7], v[32:35], v[36:51]
v_mfma_f32_32x32x16_bf16 v[36:51], a[8:11], v[32:35], v[36:51]
v_mfma_f32_32x32x16_bf16 v[36:51], a[12:15], v[32:35], v[36:51]
v_mfma_f32_32x32x16_bf16 v[36:51], a[16:19], v[32:35], v[36:51]
v_mfma_f32_32x32x16_bf16 v[36:51], a[20:23], v[32:35], v[36:51]
v_mfma_f32_32x32x16_bf16 v[36:51], a[24:27], v[32:35], v[36:51]
v_mfma_f32_32x32x16_bf16 v[36:51], a[28:31], v[32:35], v[36:51]
v_mfma_f32_32x32x16_bf16 v[36:51], a[32:35], v[32:35], v[36:51]
v_mfma_f32_32x32x16_bf16 v[36:51], a[36:39], v[32:35], v[36:51]
v_mfma_f32_32x32x16_bf16 v[36:51], a[40:43], v[32:35], v[36:51]
v_mfma_f32_32x32x16_bf16 v[36:51], a[44:47], v[32:35], v[36:51]
v_mfma_f32_32x32x16_bf16 v[36:51], a[48:51], v[32:35], v[36:51]
v_mfma_f32_32x32x16_bf16 v[36:51], a[52:55], v[32:35], v[36:51]
v_mfma_f32_32x32x16_bf16 v[36:51], a[56:59], v[32:35], v[36:51]
v_mfma_f32_32x32x16_bf16 v[36:51], a[60:63], v[32:35], v[36:51]
v_mfma_f32_32x32x16_bf16 v[36:51], a[64:67], v[32:35], v[36:51]
v_mfma_f32_32x32x16_bf16 v[36:51], a[68:71], v[32:35], v[36:51]
v_mfma_f32_32x32x16_bf16 v[36:51], a[72:75], v[32:35], v[36:51]
v_mfma_f32_32x32x16_bf16 v[36:51], a[76:79], v[32:35], v[36:51]
v_mfma_f32_32x32x16_bf16 v[36:51], a[80:83], v[32:35], v[36:51]
v_mfma_f32_32x32x16_bf16 v[36:51], a[84:87], v[32:35], v[36:51]
v_mfma_f32_32x32x16_bf16 v[36:51], a[88:91], v[32:35], v[36:51]
v_mfma_f32_32x32x16_bf16 v[36:51], a[92:95], v[32:35], v[36:51]
v_mfma_f32_32x32x16_bf16 v[36:51], a[96:99], v[32:35], v[36:51]
v_mfma_f32_32x32x16_bf16 v[36:51], a[100:103], v[32:35], v[36:51]
v_mfma_f32_32x32x16_bf16 v[36:51], a[104:107], v[32:35], v[36:51]
v_mfma_f32_32x32x16_bf16 v[36:51], a[108:111], v[32:35], v[36:51]
v_mfma_f32_32x32x16_bf16 v[36:51], a[112:115], v[32:35], v[36:51]
v_mfma_f32_32x32x16_bf16 v[36:51], a[116:119], v[32:35], v[36:51]
v_mfma_f32_32x32x16_bf16 v[36:51], a[120:123], v[32:35], v[36:51]
v_mfma_f32_32x32x16_bf16 v[36:51], a[124:127], v[32:35], v[36:51]
v_mfma_f32_32x32x16_bf16 v[36:51], a[128:131], v[32:35], v[36:51]
v_mfma_f32_32x32x16_bf16 v[36:51], a[132:135], v[32:35], v[36:51]
v_mfma_f32_32x32x16_bf16 v[36:51], a[136:139], v[32:35], v[36:51]
v_mfma_f32_32x32x16_bf16 v[36:51], a[140:143], v[32:35], v[36:51]
v_mfma_f32_32x32x16_bf16 v[36:51], a[144:147], v[32:35], v[36:51]
v_mfma_f32_32x32x16_bf16 v[36:51], a[148:151], v[32:35], v[36:51]
v_mfma_f32_32x32x16_bf16 v[36:51], a[152:155], v[32:35], v[36:51]
v_mfma_f32_32x32x16_bf16 v[36:51], a[156:159], v[32:35], v[36:51]
s_nop 11
v_mov_b32 v16, v36
v_mov_b32 v17, v37
v_mov_b32 v18, v38
v_mov_b32 v19, v39
v_mov_b32 v20, v40
v_mov_b32 v21, v41
v_mov_b32 v22, v42
v_mov_b32 v23, v43
v_mov_b32 v24, v44
v_mov_b32 v25, v45
v_mov_b32 v26, v46
v_mov_b32 v27, v47
v_mov_b32 v28, v48
v_mov_b32 v29, v49
v_mov_b32 v30, v50
v_mov_b32 v31, v51
v_accvgpr_write_b32 a160, v16
v_accvgpr_write_b32 a161, v17
v_accvgpr_write_b32 a162, v18
v_accvgpr_write_b32 a163, v19
v_accvgpr_write_b32 a164, v20
v_accvgpr_write_b32 a165, v21
v_accvgpr_write_b32 a166, v22
v_accvgpr_write_b32 a167, v23
v_accvgpr_write_b32 a168, v24
v_accvgpr_write_b32 a169, v25
v_accvgpr_write_b32 a170, v26
v_accvgpr_write_b32 a171, v27
v_accvgpr_write_b32 a172, v28
v_accvgpr_write_b32 a173, v29
v_accvgpr_write_b32 a174, v30
v_accvgpr_write_b32 a175, v31
qw_43:
v_accvgpr_read_b32 v16, a160
v_accvgpr_read_b32 v17, a161
v_accvgpr_read_b32 v18, a162
v_accvgpr_read_b32 v19, a163
v_accvgpr_read_b32 v20, a164
v_accvgpr_read_b32 v21, a165
v_accvgpr_read_b32 v22, a166
v_accvgpr_read_b32 v23, a167
v_accvgpr_read_b32 v24, a168
v_accvgpr_read_b32 v25, a169
v_accvgpr_read_b32 v26, a170
v_accvgpr_read_b32 v27, a171
v_accvgpr_read_b32 v28, a172
v_accvgpr_read_b32 v29, a173
v_accvgpr_read_b32 v30, a174
v_accvgpr_read_b32 v31, a175
s_lshl_b32 s29, s16, 1
s_add_u32 s29, s29, 2
s_lshr_b32 s47, s35, 5
s_lshl_b32 s48, s32, 7
s_add_u32 s48, s48, 0
s_cmp_lg_u32 s13, 0
s_cbranch_scc1 polld_45
v_min_u32 v12, 624, v0
s_mov_b32 s21, 8192
s_mov_b32 s17, 0
poll_44:
buffer_load_dwordx4 v[8:11], v12, s[4:7], s21 offen offset:0 sc1
s_add_u32 s17, s17, 1
s_cmp_gt_u32 s17, 262144
s_cbranch_scc1 L_fail
s_waitcnt vmcnt(0)
v_min3_u32 v8, v8, v9, v10
v_min_u32 v8, v8, v11
v_cmp_gt_u32 vcc, s29, v8
s_cbranch_vccz polld_45
s_sleep 2
s_branch poll_44
polld_45:
s_barrier
qr_46:
s_mul_i32 s26, s16, 6291456
s_mul_i32 s18, s47, 163840
s_add_u32 s26, s26, s18
s_add_u32 s26, s26, s31
s_add_u32 s26, s26, 88080384
s_lshl_b32 s18, s13, 11
s_add_u32 s18, s18, 83968
v_add_u32 v13, s18, v0
s_mov_b32 s28, 0
v_xor_b32 v1, 40960, v0
s_mov_b32 s25, s31
s_add_u32 m0, s25, 2048
s_add_u32 s20, s26, 0
buffer_load_dwordx4 v0, s[4:7], s20 offen sc1 lds
s_add_u32 m0, s25, 3072
s_add_u32 s20, s26, 1024
buffer_load_dwordx4 v0, s[4:7], s20 offen sc1 lds
s_add_u32 m0, s25, 4096
s_add_u32 s20, s26, 2048
buffer_load_dwordx4 v0, s[4:7], s20 offen sc1 lds
s_add_u32 m0, s25, 5120
s_add_u32 s20, s26, 3072
buffer_load_dwordx4 v0, s[4:7], s20 offen sc1 lds
s_add_u32 m0, s25, 6144
s_add_u32 s20, s26, 4096
buffer_load_dwordx4 v0, s[4:7], s20 offen sc1 lds
s_add_u32 m0, s25, 7168
s_add_u32 s20, s26, 5120
buffer_load_dwordx4 v0, s[4:7], s20 offen sc1 lds
s_add_u32 m0, s25, 8192
s_add_u32 s20, s26, 6144
buffer_load_dwordx4 v0, s[4:7], s20 offen sc1 lds
s_add_u32 m0, s25, 9216
s_add_u32 s20, s26, 7168
buffer_load_dwordx4 v0, s[4:7], s20 offen sc1 lds
s_add_u32 m0, s25, 10240
s_add_u32 s20, s26, 8192
buffer_load_dwordx4 v0, s[4:7], s20 offen sc1 lds
s_add_u32 m0, s25, 11264
s_add_u32 s20, s26, 9216
buffer_load_dwordx4 v0, s[4:7], s20 offen sc1 lds
qu_47:
v_xor_b32 v1, 40960, v1
s_sub_u32 s25, s25, s31
s_xor_b32 s25, s25, 40960
s_add_u32 s25, s25, s31
s_add_u32 s26, s26, 40960
s_cmp_eq_u32 s28, 3
s_cselect_b32 s26, s6, s26
s_waitcnt vmcnt(0)
s_barrier
ds_read_b128 v[48:51], v1 offset:2048
s_add_u32 m0, s25, 2048
s_add_u32 s20, s26, 0
buffer_load_dwordx4 v0, s[4:7], s20 offen sc1 lds
ds_read_b128 v[52:55], v1 offset:3072
s_add_u32 m0, s25, 3072
s_add_u32 s20, s26, 1024
buffer_load_dwordx4 v0, s[4:7], s20 offen sc1 lds
ds_read_b128 v[56:59], v1 offset:4096
v_add_u32 v2, s31, v1
s_add_u32 m0, s25, 4096
s_add_u32 s20, s26, 2048
buffer_load_dwordx4 v0, s[4:7], s20 offen sc1 lds
ds_read_b128 v[64:67], v2 offset:2048
ds_read_b128 v[60:63], v1 offset:5120
s_waitcnt lgkmcnt(4)
v_mfma_f32_32x32x16_bf16 v[32:47], a[0:3], v[48:51], 0
s_add_u32 m0, s25, 5120
s_add_u32 s20, s26, 3072
buffer_load_dwordx4 v0, s[4:7], s20 offen sc1 lds
s_add_u32 m0, s25, 6144
s_add_u32 s20, s26, 4096
buffer_load_dwordx4 v0, s[4:7], s20 offen sc1 lds
s_waitcnt lgkmcnt(3)
v_mfma_f32_32x32x16_bf16 v[32:47], a[4:7], v[52:55], v[32:47]
ds_read_b128 v[68:71], v2 offset:3072
ds_read_b128 v[48:51], v1 offset:6144
v_mov_b64 v[72:73], 0
s_waitcnt lgkmcnt(3)
v_dot2c_f32_bf16 v73, v64, v64
v_dot2c_f32_bf16 v72, s24, v64
v_mfma_f32_32x32x16_bf16 v[32:47], a[8:11], v[56:59], v[32:47]
s_waitcnt lgkmcnt(2)
ds_read_b128 v[56:59], v1 offset:8192
ds_read_b128 v[52:55], v1 offset:7168
v_dot2c_f32_bf16 v72, s24, v65
v_dot2c_f32_bf16 v72, s24, v66
v_dot2c_f32_bf16 v73, v65, v65
v_dot2c_f32_bf16 v73, v66, v66
v_mfma_f32_32x32x16_bf16 v[32:47], a[12:15], v[60:63], v[32:47]
s_add_u32 m0, s25, 7168
s_add_u32 s20, s26, 5120
buffer_load_dwordx4 v0, s[4:7], s20 offen sc1 lds
ds_read_b128 v[60:63], v1 offset:9216
v_dot2c_f32_bf16 v73, v67, v67
v_dot2c_f32_bf16 v72, s24, v67
s_waitcnt lgkmcnt(3)
v_mfma_f32_32x32x16_bf16 v[32:47], a[16:19], v[48:51], v[32:47]
ds_read_b128 v[48:51], v1 offset:10240
ds_read_b128 v[64:67], v2 offset:4096
v_dot2c_f32_bf16 v73, v68, v68
v_dot2c_f32_bf16 v72, s24, v68
v_dot2c_f32_bf16 v73, v69, v69
s_waitcnt lgkmcnt(3)
v_mfma_f32_32x32x16_bf16 v[32:47], a[20:23], v[52:55], v[32:47]
s_add_u32 m0, s25, 8192
s_add_u32 s20, s26, 6144
buffer_load_dwordx4 v0, s[4:7], s20 offen sc1 lds
ds_read_b128 v[52:55], v1 offset:11264
v_dot2c_f32_bf16 v73, v70, v70
v_dot2c_f32_bf16 v72, s24, v69
v_dot2c_f32_bf16 v72, s24, v70
v_mfma_f32_32x32x16_bf16 v[32:47], a[24:27], v[56:59], v[32:47]
s_waitcnt lgkmcnt(2)
ds_read_b128 v[56:59], v1 offset:12288
v_dot2c_f32_bf16 v73, v71, v71
v_dot2c_f32_bf16 v72, s24, v71
s_waitcnt lgkmcnt(2)
v_mfma_f32_32x32x16_bf16 v[32:47], a[28:31], v[60:63], v[32:47]
ds_read_b128 v[68:71], v2 offset:5120
v_dot2c_f32_bf16 v73, v64, v64
v_dot2c_f32_bf16 v73, v65, v65
v_dot2c_f32_bf16 v72, s24, v64
v_dot2c_f32_bf16 v73, v66, v66
v_dot2c_f32_bf16 v72, s24, v65
v_mfma_f32_32x32x16_bf16 v[32:47], a[32:35], v[48:51], v[32:47]
s_waitcnt lgkmcnt(2)
ds_read_b128 v[60:63], v1 offset:13312
s_add_u32 m0, s25, 9216
s_add_u32 s20, s26, 7168
buffer_load_dwordx4 v0, s[4:7], s20 offen sc1 lds
v_mfma_f32_32x32x16_bf16 v[32:47], a[36:39], v[52:55], v[32:47]
s_waitcnt lgkmcnt(1)
ds_read_b128 v[48:51], v1 offset:14336
ds_read_b128 v[52:55], v1 offset:15360
v_dot2c_f32_bf16 v73, v67, v67
v_dot2c_f32_bf16 v72, s24, v66
v_dot2c_f32_bf16 v72, s24, v67
v_mfma_f32_32x32x16_bf16 v[32:47], a[40:43], v[56:59], v[32:47]
ds_read_b128 v[64:67], v2 offset:6144
v_dot2c_f32_bf16 v73, v68, v68
v_dot2c_f32_bf16 v72, s24, v68
s_waitcnt lgkmcnt(3)
v_mfma_f32_32x32x16_bf16 v[32:47], a[44:47], v[60:63], v[32:47]
ds_read_b128 v[56:59], v1 offset:16384
ds_read_b128 v[60:63], v1 offset:17408
s_waitcnt lgkmcnt(4)
v_dot2c_f32_bf16 v72, s24, v69
v_dot2c_f32_bf16 v72, s24, v70
v_dot2c_f32_bf16 v73, v69, v69
v_mfma_f32_32x32x16_bf16 v[32:47], a[48:51], v[48:51], v[32:47]
ds_read_b128 v[48:51], v1 offset:18432
v_dot2c_f32_bf16 v73, v70, v70
v_dot2c_f32_bf16 v73, v71, v71
s_waitcnt lgkmcnt(3)
v_dot2c_f32_bf16 v73, v64, v64
v_dot2c_f32_bf16 v72, s24, v71
v_mfma_f32_32x32x16_bf16 v[32:47], a[52:55], v[52:55], v[32:47]
ds_read_b128 v[52:55], v1 offset:19456
ds_read_b128 v[68:71], v2 offset:7168
s_waitcnt lgkmcnt(4)
v_dot2c_f32_bf16 v72, s24, v64
v_dot2c_f32_bf16 v73, v65, v65
v_dot2c_f32_bf16 v72, s24, v65
v_mfma_f32_32x32x16_bf16 v[32:47], a[56:59], v[56:59], v[32:47]
s_waitcnt lgkmcnt(3)
s_add_u32 m0, s25, 10240
s_add_u32 s20, s26, 8192
buffer_load_dwordx4 v0, s[4:7], s20 offen sc1 lds
v_dot2c_f32_bf16 v72, s24, v66
v_dot2c_f32_bf16 v73, v66, v66
v_dot2c_f32_bf16 v73, v67, v67
v_mfma_f32_32x32x16_bf16 v[32:47], a[60:63], v[60:63], v[32:47]
ds_read_b128 v[56:59], v1 offset:20480
v_dot2c_f32_bf16 v72, s24, v67
s_waitcnt lgkmcnt(2)
ds_read_b128 v[60:63], v1 offset:21504
ds_read_b128 v[64:67], v2 offset:8192
v_mfma_f32_32x32x16_bf16 v[32:47], a[64:67], v[48:51], v[32:47]
ds_read_b128 v[48:51], v1 offset:22528
s_waitcnt lgkmcnt(4)
v_dot2c_f32_bf16 v73, v68, v68
v_dot2c_f32_bf16 v72, s24, v68
v_dot2c_f32_bf16 v72, s24, v69
v_dot2c_f32_bf16 v72, s24, v70
v_mfma_f32_32x32x16_bf16 v[32:47], a[68:71], v[52:55], v[32:47]
ds_read_b128 v[52:55], v1 offset:23552
v_dot2c_f32_bf16 v73, v69, v69
s_waitcnt lgkmcnt(4)
v_dot2c_f32_bf16 v73, v70, v70
v_dot2c_f32_bf16 v73, v71, v71
v_dot2c_f32_bf16 v72, s24, v71
v_mfma_f32_32x32x16_bf16 v[32:47], a[72:75], v[56:59], v[32:47]
s_waitcnt lgkmcnt(3)
ds_read_b128 v[68:71], v2 offset:9216
s_waitcnt lgkmcnt(3)
ds_read_b128 v[56:59], v1 offset:24576
v_dot2c_f32_bf16 v73, v64, v64
v_dot2c_f32_bf16 v72, s24, v64
v_dot2c_f32_bf16 v72, s24, v65
v_mfma_f32_32x32x16_bf16 v[32:47], a[76:79], v[60:63], v[32:47]
s_waitcnt lgkmcnt(3)
ds_read_b128 v[60:63], v1 offset:25600
v_dot2c_f32_bf16 v72, s24, v66
v_dot2c_f32_bf16 v73, v65, v65
v_dot2c_f32_bf16 v73, v66, v66
v_dot2c_f32_bf16 v73, v67, v67
v_dot2c_f32_bf16 v72, s24, v67
v_mfma_f32_32x32x16_bf16 v[32:47], a[80:83], v[48:51], v[32:47]
ds_read_b128 v[48:51], v1 offset:26624
s_waitcnt lgkmcnt(3)
v_dot2c_f32_bf16 v73, v68, v68
v_dot2c_f32_bf16 v72, s24, v68
v_dot2c_f32_bf16 v73, v69, v69
v_dot2c_f32_bf16 v72, s24, v69
v_mfma_f32_32x32x16_bf16 v[32:47], a[84:87], v[52:55], v[32:47]
ds_read_b128 v[64:67], v2 offset:10240
ds_read_b128 v[52:55], v1 offset:27648
s_waitcnt lgkmcnt(3)
v_dot2c_f32_bf16 v72, s24, v70
v_dot2c_f32_bf16 v73, v70, v70
v_dot2c_f32_bf16 v73, v71, v71
v_mfma_f32_32x32x16_bf16 v[32:47], a[88:91], v[56:59], v[32:47]
ds_read_b128 v[56:59], v1 offset:28672
s_add_u32 m0, s25, 11264
s_add_u32 s20, s26, 9216
buffer_load_dwordx4 v0, s[4:7], s20 offen sc1 lds
v_dot2c_f32_bf16 v72, s24, v71
v_mfma_f32_32x32x16_bf16 v[32:47], a[92:95], v[60:63], v[32:47]
ds_read_b128 v[68:71], v2 offset:11264
ds_read_b128 v[60:63], v1 offset:29696
s_waitcnt lgkmcnt(4)
s_waitcnt lgkmcnt(3)
v_mfma_f32_32x32x16_bf16 v[32:47], a[96:99], v[48:51], v[32:47]
ds_read_b128 v[48:51], v1 offset:30720
v_dot2c_f32_bf16 v72, s24, v64
v_dot2c_f32_bf16 v73, v64, v64
v_dot2c_f32_bf16 v73, v65, v65
s_waitcnt lgkmcnt(3)
v_dot2c_f32_bf16 v72, s24, v65
v_mfma_f32_32x32x16_bf16 v[32:47], a[100:103], v[52:55], v[32:47]
v_dot2c_f32_bf16 v72, s24, v66
v_dot2c_f32_bf16 v72, s24, v67
s_waitcnt lgkmcnt(2)
v_dot2c_f32_bf16 v73, v66, v66
v_dot2c_f32_bf16 v73, v67, v67
v_dot2c_f32_bf16 v73, v68, v68
v_mfma_f32_32x32x16_bf16 v[32:47], a[104:107], v[56:59], v[32:47]
s_waitcnt lgkmcnt(1)
ds_read_b128 v[52:55], v1 offset:31744
ds_read_b128 v[56:59], v1 offset:32768
v_dot2c_f32_bf16 v73, v69, v69
s_waitcnt lgkmcnt(2)
v_mov_b32 v3, s23
v_dot2c_f32_bf16 v72, s24, v68
v_mfma_f32_32x32x16_bf16 v[32:47], a[108:111], v[60:63], v[32:47]
ds_read_b128 v[60:63], v1 offset:33792
v_dot2c_f32_bf16 v72, s24, v69
v_dot2c_f32_bf16 v72, s24, v70
v_dot2c_f32_bf16 v73, v70, v70
v_dot2c_f32_bf16 v72, s24, v71
v_dot2c_f32_bf16 v73, v71, v71
v_mfma_f32_32x32x16_bf16 v[32:47], a[112:115], v[48:51], v[32:47]
v_and_b32 v64, 0x1ff, v0
s_waitcnt lgkmcnt(2)
v_permlane32_swap_b32 v72, v73
v_add_f32 v72, v72, v73
v_lshl_add_u32 v73, s13, 2, v0
v_mfma_f32_32x32x16_bf16 v[32:47], a[116:119], v[52:55], v[32:47]
ds_write_b32 v73, v72 offset:0
s_waitcnt lgkmcnt(1)
ds_read_b128 v[48:51], v1 offset:34816
v_mfma_f32_32x32x16_bf16 v[32:47], a[120:123], v[56:59], v[32:47]
ds_read_b128 v[52:55], v1 offset:35840
v_mfma_f32_32x32x16_bf16 v[32:47], a[124:127], v[60:63], v[32:47]
ds_read_b128 v[56:59], v1 offset:36864
s_waitcnt lgkmcnt(2)
ds_read_b128 v[60:63], v1 offset:37888
v_mfma_f32_32x32x16_bf16 v[32:47], a[128:131], v[48:51], v[32:47]
s_barrier
ds_read_b128 v[76:79], v64 offset:512
s_waitcnt lgkmcnt(3)
ds_read_b128 v[48:51], v1 offset:38912
v_mfma_f32_32x32x16_bf16 v[32:47], a[132:135], v[52:55], v[32:47]
s_mov_b64 exec, 1
buffer_store_dword v3, off, s[4:7], s22 sc1
s_mov_b64 exec, -1
ds_read_b128 v[72:75], v64 offset:0
s_waitcnt lgkmcnt(4)
v_mfma_f32_32x32x16_bf16 v[32:47], a[136:139], v[56:59], v[32:47]
ds_read_b128 v[56:59], v1 offset:40960
s_waitcnt lgkmcnt(4)
ds_read_b128 v[52:55], v1 offset:39936
v_mfma_f32_32x32x16_bf16 v[32:47], a[140:143], v[60:63], v[32:47]
s_waitcnt lgkmcnt(4)
ds_read_b128 v[60:63], v1 offset:41984
v_add_f32 v78, v78, v79
v_add_f32 v76, v76, v77
s_waitcnt lgkmcnt(3)
v_add_f32 v72, v72, v73
v_add_f32 v74, v74, v75
v_mfma_f32_32x32x16_bf16 v[32:47], a[144:147], v[48:51], v[32:47]
v_add_f32 v72, v72, v74
v_add_f32 v76, v76, v78
v_mul_f32 v76, 0x3acccccd, v76
v_mul_f32 v72, 0x3acccccd, v72
s_waitcnt lgkmcnt(1)
v_fma_f32 v76, -v72, v72, v76
v_mfma_f32_32x32x16_bf16 v[32:47], a[148:151], v[52:55], v[32:47]
v_max_f32 v76, 0, v76
v_add_f32 v76, 0x3727c5ac, v76
v_rsq_f32 v76, v76
s_nop 0
v_mul_f32 v76, 0x3e0293ee, v76
v_mfma_f32_32x32x16_bf16 v[32:47], a[152:155], v[56:59], v[32:47]
s_waitcnt lgkmcnt(0)
v_mul_f32 v72, v76, v72
v_mul_f32 v87, v72, v23
v_mul_f32 v81, v72, v17
v_mul_f32 v85, v72, v21
v_mul_f32 v93, v72, v29
v_mfma_f32_32x32x16_bf16 v[32:47], a[156:159], v[60:63], v[32:47]
s_nop 0
v_mul_f32 v83, v72, v19
v_mul_f32 v92, v72, v28
v_mul_f32 v94, v72, v30
v_mul_f32 v90, v72, v26
v_mul_f32 v80, v72, v16
v_mul_f32 v89, v72, v25
v_mul_f32 v91, v72, v27
v_mul_f32 v88, v72, v24
v_mul_f32 v84, v72, v20
v_mul_f32 v95, v72, v31
v_mul_f32 v86, v72, v22
v_fma_f32 v44, v44, v76, -v92
v_fma_f32 v37, v37, v76, -v85
v_fma_f32 v41, v41, v76, -v89
v_fma_f32 v39, v39, v76, -v87
v_fma_f32 v46, v46, v76, -v94
v_fma_f32 v36, v36, v76, -v84
v_fma_f32 v33, v33, v76, -v81
v_fma_f32 v35, v35, v76, -v83
v_cvt_pk_bf16_f32 v50, v36, v37
v_fma_f32 v47, v47, v76, -v95
v_fma_f32 v45, v45, v76, -v93
v_mul_f32 v82, v72, v18
v_fma_f32 v42, v42, v76, -v90
v_fma_f32 v34, v34, v76, -v82
v_fma_f32 v32, v32, v76, -v80
v_fma_f32 v43, v43, v76, -v91
v_fma_f32 v38, v38, v76, -v86
v_fma_f32 v40, v40, v76, -v88
v_cvt_pk_bf16_f32 v51, v38, v39
v_cvt_pk_bf16_f32 v48, v32, v33
v_cvt_pk_bf16_f32 v54, v44, v45
v_cvt_pk_bf16_f32 v55, v46, v47
v_cvt_pk_bf16_f32 v52, v40, v41
v_cvt_pk_bf16_f32 v49, v34, v35
v_cvt_pk_bf16_f32 v53, v42, v43
ds_write_b128 v13, v[52:55] offset:1024
ds_write_b128 v13, v[48:51] offset:0
v_add_u32 v13, 8192, v13
s_add_u32 s28, s28, 1
s_cmp_lt_u32 s28, 4
s_cbranch_scc1 qu_47
s_waitcnt lgkmcnt(0)
s_barrier
s_lshl_b32 s30, s47, 2
s_add_u32 s30, s30, s13
s_lshl_b32 s18, s16, 6
s_add_u32 s29, s18, s30
s_lshl_b32 s27, s29, 18
s_lshl_b32 s19, s32, 13
s_add_u32 s27, s27, s19
s_add_u32 s27, s27, 127926272
s_mul_i32 s18, s16, 34603008
s_lshl_b32 s19, s30, 19
s_add_u32 s18, s18, s19
s_lshl_b32 s19, s32, 14
s_add_u32 s18, s18, s19
s_lshl_b32 s30, s29, 7
s_add_u32 s29, s29, 1
s_lshl_b32 s19, s13, 13
s_add_u32 s19, s19, 83968
v_add_u32 v200, s19, v0
s_add_u32 s49, s18, 16777216
s_add_u32 s50, s18, 16781312
s_add_u32 s51, s18, 16785408
s_add_u32 s52, s18, 16789504
ds_read_b128 v[32:35], v200 offset:0
ds_read_b128 v[36:39], v200 offset:1024
ds_read_b128 v[40:43], v200 offset:2048
ds_read_b128 v[44:47], v200 offset:3072
ds_read_b128 v[48:51], v200 offset:4096
ds_read_b128 v[52:55], v200 offset:5120
ds_read_b128 v[56:59], v200 offset:6144
ds_read_b128 v[60:63], v200 offset:7168
v_and_b32 v14, 0x70, v0
v_lshrrev_b32 v200, 8, v0
v_lshl_add_u32 v14, v200, 7, v14
v_bfe_u32 v200, v0, 7, 1
v_lshl_add_u32 v14, v200, 12, v14
v_and_b32 v15, 0x70, v0
v_lshrrev_b32 v200, 8, v0
v_lshl_add_u32 v15, v200, 7, v15
v_bfe_u32 v200, v0, 7, 1
v_lshl_add_u32 v15, v200, 10, v15
v_bfe_u32 v200, v0, 4, 5
v_lshrrev_b32 v144, 9, v0
v_lshlrev_b32 v144, 2, v144
v_sub_u32 v200, v200, v144
v_mov_b32 v145, 0xf149f2ca
v_cmp_gt_i32 vcc, 0, v200
s_nop 1
v_cndmask_b32 v128, 0, v145, vcc
v_cmp_gt_i32 vcc, 1, v200
s_nop 1
v_cndmask_b32 v129, 0, v145, vcc
v_cmp_gt_i32 vcc, 2, v200
s_nop 1
v_cndmask_b32 v130, 0, v145, vcc
v_cmp_gt_i32 vcc, 3, v200
s_nop 1
v_cndmask_b32 v131, 0, v145, vcc
v_cmp_gt_i32 vcc, 8, v200
s_nop 1
v_cndmask_b32 v132, 0, v145, vcc
v_cmp_gt_i32 vcc, 9, v200
s_nop 1
v_cndmask_b32 v133, 0, v145, vcc
v_cmp_gt_i32 vcc, 10, v200
s_nop 1
v_cndmask_b32 v134, 0, v145, vcc
v_cmp_gt_i32 vcc, 11, v200
s_nop 1
v_cndmask_b32 v135, 0, v145, vcc
v_cmp_gt_i32 vcc, 16, v200
s_nop 1
v_cndmask_b32 v136, 0, v145, vcc
v_cmp_gt_i32 vcc, 17, v200
s_nop 1
v_cndmask_b32 v137, 0, v145, vcc
v_cmp_gt_i32 vcc, 18, v200
s_nop 1
v_cndmask_b32 v138, 0, v145, vcc
v_cmp_gt_i32 vcc, 19, v200
s_nop 1
v_cndmask_b32 v139, 0, v145, vcc
v_cmp_gt_i32 vcc, 24, v200
s_nop 1
v_cndmask_b32 v140, 0, v145, vcc
v_cmp_gt_i32 vcc, 25, v200
s_nop 1
v_cndmask_b32 v141, 0, v145, vcc
v_cmp_gt_i32 vcc, 26, v200
s_nop 1
v_cndmask_b32 v142, 0, v145, vcc
v_cmp_gt_i32 vcc, 27, v200
s_nop 1
v_cndmask_b32 v143, 0, v145, vcc
v_lshrrev_b32 v12, 2, v0
v_min_u32 v12, 4, v12
s_mov_b32 s17, 0
poll_48:
buffer_load_dword v8, v12, s[4:7], s48 offen offset:0 sc1
s_add_u32 s17, s17, 1
s_cmp_gt_u32 s17, 262144
s_cbranch_scc1 L_fail
s_waitcnt vmcnt(0)
v_cmp_gt_u32 vcc, s29, v8
s_cbranch_vccz polld_49
s_sleep 2
s_branch poll_48
polld_49:
buffer_load_dwordx4 v[64:67], v14, s[4:7], s49 offen offset:0 sc1
buffer_load_dwordx4 v[68:71], v14, s[4:7], s49 offen offset:512 sc1
buffer_load_dwordx4 v[72:75], v14, s[4:7], s49 offen offset:1024 sc1
buffer_load_dwordx4 v[76:79], v14, s[4:7], s49 offen offset:1536 sc1
buffer_load_dwordx4 v[80:83], v14, s[4:7], s51 offen offset:0 sc1
buffer_load_dwordx4 v[84:87], v14, s[4:7], s51 offen offset:512 sc1
buffer_load_dwordx4 v[88:91], v14, s[4:7], s51 offen offset:1024 sc1
buffer_load_dwordx4 v[92:95], v14, s[4:7], s51 offen offset:1536 sc1
buffer_load_dwordx4 v[96:99], v15, s[4:7], s49 offen offset:2048 sc1
buffer_load_dwordx4 v[100:103], v15, s[4:7], s49 offen offset:2560 sc1
buffer_load_dwordx4 v[104:107], v15, s[4:7], s50 offen offset:2048 sc1
buffer_load_dwordx4 v[108:111], v15, s[4:7], s50 offen offset:2560 sc1
buffer_load_dwordx4 v[112:115], v15, s[4:7], s51 offen offset:2048 sc1
buffer_load_dwordx4 v[116:119], v15, s[4:7], s51 offen offset:2560 sc1
buffer_load_dwordx4 v[120:123], v15, s[4:7], s52 offen offset:2048 sc1
buffer_load_dwordx4 v[124:127], v15, s[4:7], s52 offen offset:2560 sc1
s_waitcnt vmcnt(15) lgkmcnt(7)
v_mfma_f32_32x32x16_bf16 v[128:143], v[64:67], v[32:35], v[128:143]
s_waitcnt vmcnt(14) lgkmcnt(6)
v_mfma_f32_32x32x16_bf16 v[128:143], v[68:71], v[36:39], v[128:143]
s_waitcnt vmcnt(13) lgkmcnt(5)
v_mfma_f32_32x32x16_bf16 v[128:143], v[72:75], v[40:43], v[128:143]
s_waitcnt vmcnt(12) lgkmcnt(4)
v_mfma_f32_32x32x16_bf16 v[128:143], v[76:79], v[44:47], v[128:143]
s_waitcnt vmcnt(11) lgkmcnt(3)
v_mfma_f32_32x32x16_bf16 v[128:143], v[80:83], v[48:51], v[128:143]
s_waitcnt vmcnt(10) lgkmcnt(2)
v_mfma_f32_32x32x16_bf16 v[128:143], v[84:87], v[52:55], v[128:143]
s_waitcnt vmcnt(9) lgkmcnt(1)
v_mfma_f32_32x32x16_bf16 v[128:143], v[88:91], v[56:59], v[128:143]
s_waitcnt vmcnt(8) lgkmcnt(0)
v_mfma_f32_32x32x16_bf16 v[128:143], v[92:95], v[60:63], v[128:143]
s_lshl_b32 s18, s16, 4
s_add_u32 s29, s18, s47
s_lshl_b32 s18, s29, 19
s_lshl_b32 s19, s32, 14
s_add_u32 s18, s18, s19
s_add_u32 s29, s29, 1
s_and_b32 s19, s13, 1
s_lshr_b32 s20, s13, 1
v_and_b32 v14, 0x170, v14
v_lshl_add_u32 v14, s19, 12, v14
v_lshl_add_u32 v14, s20, 7, v14
v_lshl_add_u32 v15, s19, 3, v15
v_lshl_add_u32 v15, s20, 9, v15
s_add_u32 s49, s18, 110100480
s_add_u32 s50, s18, 110104576
s_add_u32 s51, s18, 110108672
s_add_u32 s52, s18, 110112768
v_max3_f32 v200, v128, v129, v130
v_max3_f32 v200, v200, v131, v132
v_max3_f32 v200, v200, v133, v134
v_max3_f32 v200, v200, v135, v136
v_max3_f32 v200, v200, v137, v138
v_max3_f32 v200, v200, v139, v140
v_max3_f32 v200, v200, v141, v142
v_max_f32 v200, v200, v143
v_lshrrev_b32 v12, 2, v0
v_min_u32 v12, 4, v12
s_mov_b32 s17, 0
poll_50:
buffer_load_dword v8, v12, s[4:7], s48 offen offset:8 sc1
s_add_u32 s17, s17, 1
s_cmp_gt_u32 s17, 262144
s_cbranch_scc1 L_fail
s_waitcnt vmcnt(0)
v_cmp_gt_u32 vcc, s29, v8
s_cbranch_vccz polld_51
s_sleep 2
s_branch poll_50
polld_51:
buffer_load_dwordx4 v[64:67], v14, s[4:7], s49 offen offset:0 sc1
buffer_load_dwordx4 v[68:71], v14, s[4:7], s49 offen offset:512 sc1
buffer_load_dwordx4 v[72:75], v14, s[4:7], s49 offen offset:1024 sc1
buffer_load_dwordx4 v[76:79], v14, s[4:7], s49 offen offset:1536 sc1
buffer_load_dwordx4 v[80:83], v14, s[4:7], s51 offen offset:0 sc1
buffer_load_dwordx4 v[84:87], v14, s[4:7], s51 offen offset:512 sc1
buffer_load_dwordx4 v[88:91], v14, s[4:7], s51 offen offset:1024 sc1
buffer_load_dwordx4 v[92:95], v14, s[4:7], s51 offen offset:1536 sc1
buffer_load_dwordx2 v[192:193], v15, s[4:7], s49 offen offset:2048 sc1
buffer_load_dwordx2 v[194:195], v15, s[4:7], s50 offen offset:2048 sc1
buffer_load_dwordx2 v[196:197], v15, s[4:7], s51 offen offset:2048 sc1
buffer_load_dwordx2 v[198:199], v15, s[4:7], s52 offen offset:2048 sc1
s_waitcnt vmcnt(11)
v_mfma_f32_32x32x16_bf16 v[144:159], v[64:67], v[32:35], 0
s_waitcnt vmcnt(10)
v_mfma_f32_32x32x16_bf16 v[144:159], v[68:71], v[36:39], v[144:159]
s_waitcnt vmcnt(9)
v_mfma_f32_32x32x16_bf16 v[144:159], v[72:75], v[40:43], v[144:159]
s_waitcnt vmcnt(8)
v_mfma_f32_32x32x16_bf16 v[144:159], v[76:79], v[44:47], v[144:159]
s_waitcnt vmcnt(7)
v_mfma_f32_32x32x16_bf16 v[144:159], v[80:83], v[48:51], v[144:159]
s_waitcnt vmcnt(6)
v_mfma_f32_32x32x16_bf16 v[144:159], v[84:87], v[52:55], v[144:159]
s_waitcnt vmcnt(5)
v_mfma_f32_32x32x16_bf16 v[144:159], v[88:91], v[56:59], v[144:159]
s_waitcnt vmcnt(4)
v_mfma_f32_32x32x16_bf16 v[144:159], v[92:95], v[60:63], v[144:159]
s_nop 11
v_max3_f32 v148, v200, v144, v145
v_max3_f32 v148, v148, v146, v147
v_mov_b32 v150, v148
s_nop 1
v_permlane32_swap_b32 v148, v150
v_max_f32 v148, v148, v150
v_sub_f32 v147, v147, v148
v_sub_f32 v145, v145, v148
v_sub_f32 v144, v144, v148
v_exp_f32 v144, v144
v_sub_f32 v146, v146, v148
v_exp_f32 v146, v146
v_exp_f32 v145, v145
v_exp_f32 v147, v147
v_cvt_pk_bf16_f32 v40, v144, v145
v_cvt_pk_bf16_f32 v41, v146, v147
v_sub_f32 v128, v128, v148
v_sub_f32 v132, v132, v148
s_waitcnt vmcnt(0)
v_mfma_f32_32x32x8_bf16 v[80:95], v[198:199], v[40:41], 0
v_sub_f32 v129, v129, v148
v_exp_f32 v132, v132
v_sub_f32 v135, v135, v148
v_sub_f32 v133, v133, v148
v_sub_f32 v134, v134, v148
v_mfma_f32_32x32x8_bf16 v[160:175], v[192:193], v[40:41], 0
v_exp_f32 v129, v129
v_exp_f32 v128, v128
v_sub_f32 v130, v130, v148
v_sub_f32 v131, v131, v148
v_mfma_f32_32x32x8_bf16 v[176:191], v[194:195], v[40:41], 0
v_exp_f32 v130, v130
v_exp_f32 v135, v135
v_exp_f32 v131, v131
v_mfma_f32_32x32x8_bf16 v[64:79], v[196:197], v[40:41], 0
v_cvt_pk_bf16_f32 v33, v130, v131
v_exp_f32 v133, v133
v_exp_f32 v134, v134
v_cvt_pk_bf16_f32 v34, v132, v133
v_cvt_pk_bf16_f32 v35, v134, v135
v_cvt_pk_bf16_f32 v32, v128, v129
v_sub_f32 v138, v138, v148
v_add_f32 v149, v128, v129
v_mfma_f32_32x32x16_bf16 v[160:175], v[96:99], v[32:35], v[160:175]
v_add_f32 v149, v149, v130
v_sub_f32 v136, v136, v148
v_sub_f32 v143, v143, v148
v_exp_f32 v143, v143
v_add_f32 v149, v149, v131
v_mfma_f32_32x32x16_bf16 v[176:191], v[104:107], v[32:35], v[176:191]
v_sub_f32 v139, v139, v148
v_sub_f32 v137, v137, v148
v_exp_f32 v138, v138
v_sub_f32 v140, v140, v148
v_sub_f32 v141, v141, v148
v_mfma_f32_32x32x16_bf16 v[80:95], v[120:123], v[32:35], v[80:95]
v_exp_f32 v136, v136
v_exp_f32 v137, v137
v_exp_f32 v139, v139
v_mfma_f32_32x32x16_bf16 v[64:79], v[112:115], v[32:35], v[64:79]
v_exp_f32 v140, v140
v_cvt_pk_bf16_f32 v37, v138, v139
v_sub_f32 v142, v142, v148
v_exp_f32 v141, v141
v_exp_f32 v142, v142
v_cvt_pk_bf16_f32 v36, v136, v137
v_cvt_pk_bf16_f32 v38, v140, v141
v_cvt_pk_bf16_f32 v39, v142, v143
v_add_f32 v149, v149, v132
v_add_f32 v149, v149, v133
v_mfma_f32_32x32x16_bf16 v[160:175], v[100:103], v[36:39], v[160:175]
v_add_f32 v149, v149, v134
v_add_f32 v149, v149, v135
v_add_f32 v149, v149, v136
v_add_f32 v149, v149, v137
v_add_f32 v149, v149, v138
v_add_f32 v149, v149, v139
v_mfma_f32_32x32x16_bf16 v[176:191], v[108:111], v[36:39], v[176:191]
v_add_f32 v149, v149, v140
v_add_f32 v149, v149, v141
v_add_f32 v149, v149, v142
v_add_f32 v149, v149, v143
v_add_f32 v149, v149, v144
v_add_f32 v149, v149, v145
v_add_f32 v149, v149, v146
v_add_f32 v149, v149, v147
v_mov_b32 v150, v149
v_mfma_f32_32x32x16_bf16 v[80:95], v[124:127], v[36:39], v[80:95]
s_nop 0
v_permlane32_swap_b32 v149, v150
v_add_f32 v149, v149, v150
v_rcp_f32 v149, v149
v_mfma_f32_32x32x16_bf16 v[64:79], v[116:119], v[36:39], v[64:79]
s_add_u32 s19, s27, 4096
v_mul_f32 v177, v177, v149
v_mul_f32 v184, v184, v149
v_mul_f32 v161, v161, v149
v_mul_f32 v187, v187, v149
v_mul_f32 v170, v170, v149
v_mul_f32 v189, v189, v149
v_mul_f32 v167, v167, v149
v_mul_f32 v163, v163, v149
v_mul_f32 v160, v160, v149
v_mul_f32 v87, v87, v149
v_mul_f32 v93, v93, v149
v_mul_f32 v83, v83, v149
v_cvt_pk_bf16_f32 v160, v160, v161
v_mul_f32 v86, v86, v149
v_mul_f32 v162, v162, v149
v_mul_f32 v173, v173, v149
v_mul_f32 v78, v78, v149
v_mul_f32 v79, v79, v149
v_mul_f32 v179, v179, v149
v_mul_f32 v176, v176, v149
v_cvt_pk_bf16_f32 v161, v162, v163
v_mul_f32 v168, v168, v149
v_mul_f32 v166, v166, v149
v_mul_f32 v174, v174, v149
v_mul_f32 v180, v180, v149
v_mul_f32 v68, v68, v149
v_mul_f32 v66, v66, v149
v_mul_f32 v169, v169, v149
v_mul_f32 v171, v171, v149
v_mul_f32 v181, v181, v149
v_mul_f32 v80, v80, v149
v_mul_f32 v164, v164, v149
v_mul_f32 v165, v165, v149
v_mul_f32 v64, v64, v149
v_mul_f32 v185, v185, v149
v_mul_f32 v76, v76, v149
v_cvt_pk_bf16_f32 v176, v176, v177
v_mul_f32 v94, v94, v149
v_mul_f32 v73, v73, v149
v_mul_f32 v190, v190, v149
v_mul_f32 v72, v72, v149
v_mul_f32 v84, v84, v149
v_mul_f32 v178, v178, v149
v_cvt_pk_bf16_f32 v162, v164, v165
v_mul_f32 v71, v71, v149
v_mul_f32 v91, v91, v149
v_mul_f32 v65, v65, v149
v_mul_f32 v191, v191, v149
v_cvt_pk_bf16_f32 v177, v178, v179
v_mul_f32 v81, v81, v149
v_mul_f32 v74, v74, v149
v_mul_f32 v77, v77, v149
v_mul_f32 v186, v186, v149
v_cvt_pk_bf16_f32 v165, v170, v171
v_mul_f32 v172, v172, v149
v_cvt_pk_bf16_f32 v164, v168, v169
v_cvt_pk_bf16_f32 v163, v166, v167
v_cvt_pk_bf16_f32 v64, v64, v65
v_mul_f32 v82, v82, v149
v_mul_f32 v175, v175, v149
v_cvt_pk_bf16_f32 v166, v172, v173
v_mul_f32 v188, v188, v149
v_mul_f32 v183, v183, v149
v_mul_f32 v67, v67, v149
v_cvt_pk_bf16_f32 v178, v180, v181
v_cvt_pk_bf16_f32 v167, v174, v175
v_mul_f32 v182, v182, v149
v_cvt_pk_bf16_f32 v179, v182, v183
buffer_store_dwordx4 v[160:163], v0, s[4:7], s27 offen offset:0 sc1
buffer_store_dwordx4 v[164:167], v0, s[4:7], s27 offen offset:1024 sc1
buffer_store_dwordx4 v[176:179], v0, s[4:7], s27 offen offset:2048 sc1
v_cvt_pk_bf16_f32 v65, v66, v67
v_mul_f32 v90, v90, v149
v_mul_f32 v88, v88, v149
v_mul_f32 v69, v69, v149
v_cvt_pk_bf16_f32 v80, v80, v81
v_mul_f32 v95, v95, v149
v_mul_f32 v85, v85, v149
v_cvt_pk_bf16_f32 v81, v82, v83
v_mul_f32 v89, v89, v149
v_cvt_pk_bf16_f32 v82, v84, v85
v_cvt_pk_bf16_f32 v66, v68, v69
v_mul_f32 v70, v70, v149
v_cvt_pk_bf16_f32 v83, v86, v87
v_cvt_pk_bf16_f32 v85, v90, v91
v_cvt_pk_bf16_f32 v67, v70, v71
v_cvt_pk_bf16_f32 v87, v94, v95
v_mul_f32 v92, v92, v149
v_cvt_pk_bf16_f32 v84, v88, v89
v_cvt_pk_bf16_f32 v68, v72, v73
v_mul_f32 v75, v75, v149
v_cvt_pk_bf16_f32 v86, v92, v93
v_cvt_pk_bf16_f32 v69, v74, v75
v_cvt_pk_bf16_f32 v182, v188, v189
v_cvt_pk_bf16_f32 v180, v184, v185
v_cvt_pk_bf16_f32 v71, v78, v79
v_cvt_pk_bf16_f32 v181, v186, v187
v_cvt_pk_bf16_f32 v70, v76, v77
v_cvt_pk_bf16_f32 v183, v190, v191
buffer_store_dwordx4 v[180:183], v0, s[4:7], s27 offen offset:3072 sc1
buffer_store_dwordx4 v[64:67], v0, s[4:7], s19 offen offset:0 sc1
buffer_store_dwordx4 v[68:71], v0, s[4:7], s19 offen offset:1024 sc1
buffer_store_dwordx4 v[80:83], v0, s[4:7], s19 offen offset:2048 sc1
buffer_store_dwordx4 v[84:87], v0, s[4:7], s19 offen offset:3072 sc1
s_lshl_b32 s18, s32, 2
s_add_u32 s18, s18, s30
s_add_u32 s18, s18, 16384
s_waitcnt vmcnt(0)
v_mov_b32 v3, 1
s_mov_b64 exec, 1
buffer_store_dword v3, off, s[4:7], s18 sc1
s_mov_b64 exec, -1
s_add_u32 s47, s47, 2
s_cmp_lt_u32 s47, 16
s_cbranch_scc1 qr_46
s_barrier
s_branch aend_42
wo_40:
s_sub_u32 s18, s35, 64
s_mul_i32 s30, s18, 3277
s_lshr_b32 s30, s30, 16
s_mul_i32 s19, s30, 20
s_sub_u32 s47, s18, s19
s_cmp_lg_u32 s16, 0
s_cbranch_scc1 ww_52
s_mul_i32 s26, s13, 1310720
s_lshl_b32 s18, s47, 6
s_add_u32 s26, s26, s18
s_load_dwordx2 s[36:37], s[0:1], 64
s_mov_b32 s38, 5242880
s_mov_b32 s39, 0x20000
s_waitcnt lgkmcnt(0)
v_lshrrev_b32 v214, 6, v0
v_mul_u32_u24 v214, 1280, v214
v_and_b32 v215, 48, v0
v_add_u32 v212, v214, v215
v_bfe_u32 v214, v0, 6, 2
v_lshrrev_b32 v215, 9, v0
v_lshl_add_u32 v214, v215, 3, v214
v_lshlrev_b32 v213, 6, v214
v_and_b32 v214, 16, v0
v_add_u32 v213, v213, v214
v_bfe_u32 v214, v0, 5, 1
v_lshl_add_u32 v213, v214, 3, v213
v_bfe_u32 v214, v0, 8, 1
v_lshl_add_u32 v213, v214, 5, v213
s_mul_i32 s18, s13, 36864
v_add_u32 v213, s18, v213
s_barrier
s_add_u32 m0, s18, 0
s_add_u32 s19, s26, 0
buffer_load_dwordx4 v212, s[36:39], s19 offen lds
s_add_u32 m0, s18, 1024
s_add_u32 s19, s26, 20480
buffer_load_dwordx4 v212, s[36:39], s19 offen lds
s_add_u32 m0, s18, 2048
s_add_u32 s19, s26, 40960
buffer_load_dwordx4 v212, s[36:39], s19 offen lds
s_add_u32 m0, s18, 3072
s_add_u32 s19, s26, 61440
buffer_load_dwordx4 v212, s[36:39], s19 offen lds
s_add_u32 m0, s18, 4096
s_add_u32 s19, s26, 81920
buffer_load_dwordx4 v212, s[36:39], s19 offen lds
s_add_u32 m0, s18, 5120
s_add_u32 s19, s26, 102400
buffer_load_dwordx4 v212, s[36:39], s19 offen lds
s_add_u32 m0, s18, 6144
s_add_u32 s19, s26, 122880
buffer_load_dwordx4 v212, s[36:39], s19 offen lds
s_add_u32 m0, s18, 7168
s_add_u32 s19, s26, 143360
buffer_load_dwordx4 v212, s[36:39], s19 offen lds
s_add_u32 m0, s18, 8192
s_add_u32 s19, s26, 163840
buffer_load_dwordx4 v212, s[36:39], s19 offen lds
s_add_u32 m0, s18, 9216
s_add_u32 s19, s26, 184320
buffer_load_dwordx4 v212, s[36:39], s19 offen lds
s_add_u32 m0, s18, 10240
s_add_u32 s19, s26, 204800
buffer_load_dwordx4 v212, s[36:39], s19 offen lds
s_add_u32 m0, s18, 11264
s_add_u32 s19, s26, 225280
buffer_load_dwordx4 v212, s[36:39], s19 offen lds
s_add_u32 m0, s18, 12288
s_add_u32 s19, s26, 245760
buffer_load_dwordx4 v212, s[36:39], s19 offen lds
s_add_u32 m0, s18, 13312
s_add_u32 s19, s26, 266240
buffer_load_dwordx4 v212, s[36:39], s19 offen lds
s_add_u32 m0, s18, 14336
s_add_u32 s19, s26, 286720
buffer_load_dwordx4 v212, s[36:39], s19 offen lds
s_add_u32 m0, s18, 15360
s_add_u32 s19, s26, 307200
buffer_load_dwordx4 v212, s[36:39], s19 offen lds
s_add_u32 m0, s18, 16384
s_add_u32 s19, s26, 327680
buffer_load_dwordx4 v212, s[36:39], s19 offen lds
s_add_u32 m0, s18, 17408
s_add_u32 s19, s26, 348160
buffer_load_dwordx4 v212, s[36:39], s19 offen lds
s_add_u32 m0, s18, 18432
s_add_u32 s19, s26, 368640
buffer_load_dwordx4 v212, s[36:39], s19 offen lds
s_add_u32 m0, s18, 19456
s_add_u32 s19, s26, 389120
buffer_load_dwordx4 v212, s[36:39], s19 offen lds
s_add_u32 m0, s18, 20480
s_add_u32 s19, s26, 409600
buffer_load_dwordx4 v212, s[36:39], s19 offen lds
s_add_u32 m0, s18, 21504
s_add_u32 s19, s26, 430080
buffer_load_dwordx4 v212, s[36:39], s19 offen lds
s_add_u32 m0, s18, 22528
s_add_u32 s19, s26, 450560
buffer_load_dwordx4 v212, s[36:39], s19 offen lds
s_add_u32 m0, s18, 23552
s_add_u32 s19, s26, 471040
buffer_load_dwordx4 v212, s[36:39], s19 offen lds
s_add_u32 m0, s18, 24576
s_add_u32 s19, s26, 491520
buffer_load_dwordx4 v212, s[36:39], s19 offen lds
s_add_u32 m0, s18, 25600
s_add_u32 s19, s26, 512000
buffer_load_dwordx4 v212, s[36:39], s19 offen lds
s_add_u32 m0, s18, 26624
s_add_u32 s19, s26, 532480
buffer_load_dwordx4 v212, s[36:39], s19 offen lds
s_add_u32 m0, s18, 27648
s_add_u32 s19, s26, 552960
buffer_load_dwordx4 v212, s[36:39], s19 offen lds
s_add_u32 m0, s18, 28672
s_add_u32 s19, s26, 573440
buffer_load_dwordx4 v212, s[36:39], s19 offen lds
s_add_u32 m0, s18, 29696
s_add_u32 s19, s26, 593920
buffer_load_dwordx4 v212, s[36:39], s19 offen lds
s_add_u32 m0, s18, 30720
s_add_u32 s19, s26, 614400
buffer_load_dwordx4 v212, s[36:39], s19 offen lds
s_add_u32 m0, s18, 31744
s_add_u32 s19, s26, 634880
buffer_load_dwordx4 v212, s[36:39], s19 offen lds
s_add_u32 m0, s18, 32768
s_add_u32 s19, s26, 655360
buffer_load_dwordx4 v212, s[36:39], s19 offen lds
s_add_u32 m0, s18, 33792
s_add_u32 s19, s26, 675840
buffer_load_dwordx4 v212, s[36:39], s19 offen lds
s_add_u32 m0, s18, 34816
s_add_u32 s19, s26, 696320
buffer_load_dwordx4 v212, s[36:39], s19 offen lds
s_add_u32 m0, s18, 35840
s_add_u32 s19, s26, 716800
buffer_load_dwordx4 v212, s[36:39], s19 offen lds
s_waitcnt vmcnt(32)
ds_read_b64_tr_b16 a[0:1], v213 offset:0
ds_read_b64_tr_b16 a[2:3], v213 offset:256
ds_read_b64_tr_b16 a[4:5], v213 offset:1024
ds_read_b64_tr_b16 a[6:7], v213 offset:1280
ds_read_b64_tr_b16 a[8:9], v213 offset:2048
ds_read_b64_tr_b16 a[10:11], v213 offset:2304
ds_read_b64_tr_b16 a[12:13], v213 offset:3072
ds_read_b64_tr_b16 a[14:15], v213 offset:3328
s_waitcnt lgkmcnt(0)
s_add_u32 m0, s18, 0
s_add_u32 s19, s26, 737280
buffer_load_dwordx4 v212, s[36:39], s19 offen lds
s_add_u32 m0, s18, 1024
s_add_u32 s19, s26, 757760
buffer_load_dwordx4 v212, s[36:39], s19 offen lds
s_add_u32 m0, s18, 2048
s_add_u32 s19, s26, 778240
buffer_load_dwordx4 v212, s[36:39], s19 offen lds
s_add_u32 m0, s18, 3072
s_add_u32 s19, s26, 798720
buffer_load_dwordx4 v212, s[36:39], s19 offen lds
s_waitcnt vmcnt(32)
ds_read_b64_tr_b16 a[16:17], v213 offset:4096
ds_read_b64_tr_b16 a[18:19], v213 offset:4352
ds_read_b64_tr_b16 a[20:21], v213 offset:5120
ds_read_b64_tr_b16 a[22:23], v213 offset:5376
ds_read_b64_tr_b16 a[24:25], v213 offset:6144
ds_read_b64_tr_b16 a[26:27], v213 offset:6400
ds_read_b64_tr_b16 a[28:29], v213 offset:7168
ds_read_b64_tr_b16 a[30:31], v213 offset:7424
s_waitcnt lgkmcnt(0)
s_add_u32 m0, s18, 4096
s_add_u32 s19, s26, 819200
buffer_load_dwordx4 v212, s[36:39], s19 offen lds
s_add_u32 m0, s18, 5120
s_add_u32 s19, s26, 839680
buffer_load_dwordx4 v212, s[36:39], s19 offen lds
s_add_u32 m0, s18, 6144
s_add_u32 s19, s26, 860160
buffer_load_dwordx4 v212, s[36:39], s19 offen lds
s_add_u32 m0, s18, 7168
s_add_u32 s19, s26, 880640
buffer_load_dwordx4 v212, s[36:39], s19 offen lds
s_waitcnt vmcnt(32)
ds_read_b64_tr_b16 a[32:33], v213 offset:8192
ds_read_b64_tr_b16 a[34:35], v213 offset:8448
ds_read_b64_tr_b16 a[36:37], v213 offset:9216
ds_read_b64_tr_b16 a[38:39], v213 offset:9472
ds_read_b64_tr_b16 a[40:41], v213 offset:10240
ds_read_b64_tr_b16 a[42:43], v213 offset:10496
ds_read_b64_tr_b16 a[44:45], v213 offset:11264
ds_read_b64_tr_b16 a[46:47], v213 offset:11520
s_waitcnt lgkmcnt(0)
s_add_u32 m0, s18, 8192
s_add_u32 s19, s26, 901120
buffer_load_dwordx4 v212, s[36:39], s19 offen lds
s_add_u32 m0, s18, 9216
s_add_u32 s19, s26, 921600
buffer_load_dwordx4 v212, s[36:39], s19 offen lds
s_add_u32 m0, s18, 10240
s_add_u32 s19, s26, 942080
buffer_load_dwordx4 v212, s[36:39], s19 offen lds
s_add_u32 m0, s18, 11264
s_add_u32 s19, s26, 962560
buffer_load_dwordx4 v212, s[36:39], s19 offen lds
s_waitcnt vmcnt(32)
ds_read_b64_tr_b16 a[48:49], v213 offset:12288
ds_read_b64_tr_b16 a[50:51], v213 offset:12544
ds_read_b64_tr_b16 a[52:53], v213 offset:13312
ds_read_b64_tr_b16 a[54:55], v213 offset:13568
ds_read_b64_tr_b16 a[56:57], v213 offset:14336
ds_read_b64_tr_b16 a[58:59], v213 offset:14592
ds_read_b64_tr_b16 a[60:61], v213 offset:15360
ds_read_b64_tr_b16 a[62:63], v213 offset:15616
s_waitcnt lgkmcnt(0)
s_add_u32 m0, s18, 12288
s_add_u32 s19, s26, 983040
buffer_load_dwordx4 v212, s[36:39], s19 offen lds
s_add_u32 m0, s18, 13312
s_add_u32 s19, s26, 1003520
buffer_load_dwordx4 v212, s[36:39], s19 offen lds
s_add_u32 m0, s18, 14336
s_add_u32 s19, s26, 1024000
buffer_load_dwordx4 v212, s[36:39], s19 offen lds
s_add_u32 m0, s18, 15360
s_add_u32 s19, s26, 1044480
buffer_load_dwordx4 v212, s[36:39], s19 offen lds
s_waitcnt vmcnt(32)
ds_read_b64_tr_b16 a[64:65], v213 offset:16384
ds_read_b64_tr_b16 a[66:67], v213 offset:16640
ds_read_b64_tr_b16 a[68:69], v213 offset:17408
ds_read_b64_tr_b16 a[70:71], v213 offset:17664
ds_read_b64_tr_b16 a[72:73], v213 offset:18432
ds_read_b64_tr_b16 a[74:75], v213 offset:18688
ds_read_b64_tr_b16 a[76:77], v213 offset:19456
ds_read_b64_tr_b16 a[78:79], v213 offset:19712
s_waitcnt lgkmcnt(0)
s_add_u32 m0, s18, 16384
s_add_u32 s19, s26, 1064960
buffer_load_dwordx4 v212, s[36:39], s19 offen lds
s_add_u32 m0, s18, 17408
s_add_u32 s19, s26, 1085440
buffer_load_dwordx4 v212, s[36:39], s19 offen lds
s_add_u32 m0, s18, 18432
s_add_u32 s19, s26, 1105920
buffer_load_dwordx4 v212, s[36:39], s19 offen lds
s_add_u32 m0, s18, 19456
s_add_u32 s19, s26, 1126400
buffer_load_dwordx4 v212, s[36:39], s19 offen lds
s_waitcnt vmcnt(32)
ds_read_b64_tr_b16 a[80:81], v213 offset:20480
ds_read_b64_tr_b16 a[82:83], v213 offset:20736
ds_read_b64_tr_b16 a[84:85], v213 offset:21504
ds_read_b64_tr_b16 a[86:87], v213 offset:21760
ds_read_b64_tr_b16 a[88:89], v213 offset:22528
ds_read_b64_tr_b16 a[90:91], v213 offset:22784
ds_read_b64_tr_b16 a[92:93], v213 offset:23552
ds_read_b64_tr_b16 a[94:95], v213 offset:23808
s_waitcnt lgkmcnt(0)
s_add_u32 m0, s18, 20480
s_add_u32 s19, s26, 1146880
buffer_load_dwordx4 v212, s[36:39], s19 offen lds
s_add_u32 m0, s18, 21504
s_add_u32 s19, s26, 1167360
buffer_load_dwordx4 v212, s[36:39], s19 offen lds
s_add_u32 m0, s18, 22528
s_add_u32 s19, s26, 1187840
buffer_load_dwordx4 v212, s[36:39], s19 offen lds
s_add_u32 m0, s18, 23552
s_add_u32 s19, s26, 1208320
buffer_load_dwordx4 v212, s[36:39], s19 offen lds
s_waitcnt vmcnt(32)
ds_read_b64_tr_b16 a[96:97], v213 offset:24576
ds_read_b64_tr_b16 a[98:99], v213 offset:24832
ds_read_b64_tr_b16 a[100:101], v213 offset:25600
ds_read_b64_tr_b16 a[102:103], v213 offset:25856
ds_read_b64_tr_b16 a[104:105], v213 offset:26624
ds_read_b64_tr_b16 a[106:107], v213 offset:26880
ds_read_b64_tr_b16 a[108:109], v213 offset:27648
ds_read_b64_tr_b16 a[110:111], v213 offset:27904
s_waitcnt lgkmcnt(0)
s_add_u32 m0, s18, 24576
s_add_u32 s19, s26, 1228800
buffer_load_dwordx4 v212, s[36:39], s19 offen lds
s_add_u32 m0, s18, 25600
s_add_u32 s19, s26, 1249280
buffer_load_dwordx4 v212, s[36:39], s19 offen lds
s_add_u32 m0, s18, 26624
s_add_u32 s19, s26, 1269760
buffer_load_dwordx4 v212, s[36:39], s19 offen lds
s_add_u32 m0, s18, 27648
s_add_u32 s19, s26, 1290240
buffer_load_dwordx4 v212, s[36:39], s19 offen lds
s_waitcnt vmcnt(32)
ds_read_b64_tr_b16 a[112:113], v213 offset:28672
ds_read_b64_tr_b16 a[114:115], v213 offset:28928
ds_read_b64_tr_b16 a[116:117], v213 offset:29696
ds_read_b64_tr_b16 a[118:119], v213 offset:29952
ds_read_b64_tr_b16 a[120:121], v213 offset:30720
ds_read_b64_tr_b16 a[122:123], v213 offset:30976
ds_read_b64_tr_b16 a[124:125], v213 offset:31744
ds_read_b64_tr_b16 a[126:127], v213 offset:32000
s_waitcnt vmcnt(28)
ds_read_b64_tr_b16 a[128:129], v213 offset:32768
ds_read_b64_tr_b16 a[130:131], v213 offset:33024
ds_read_b64_tr_b16 a[132:133], v213 offset:33792
ds_read_b64_tr_b16 a[134:135], v213 offset:34048
ds_read_b64_tr_b16 a[136:137], v213 offset:34816
ds_read_b64_tr_b16 a[138:139], v213 offset:35072
ds_read_b64_tr_b16 a[140:141], v213 offset:35840
ds_read_b64_tr_b16 a[142:143], v213 offset:36096
s_waitcnt vmcnt(24)
ds_read_b64_tr_b16 a[144:145], v213 offset:0
ds_read_b64_tr_b16 a[146:147], v213 offset:256
ds_read_b64_tr_b16 a[148:149], v213 offset:1024
ds_read_b64_tr_b16 a[150:151], v213 offset:1280
ds_read_b64_tr_b16 a[152:153], v213 offset:2048
ds_read_b64_tr_b16 a[154:155], v213 offset:2304
ds_read_b64_tr_b16 a[156:157], v213 offset:3072
ds_read_b64_tr_b16 a[158:159], v213 offset:3328
s_waitcnt vmcnt(20)
ds_read_b64_tr_b16 a[160:161], v213 offset:4096
ds_read_b64_tr_b16 a[162:163], v213 offset:4352
ds_read_b64_tr_b16 a[164:165], v213 offset:5120
ds_read_b64_tr_b16 a[166:167], v213 offset:5376
ds_read_b64_tr_b16 a[168:169], v213 offset:6144
ds_read_b64_tr_b16 a[170:171], v213 offset:6400
ds_read_b64_tr_b16 a[172:173], v213 offset:7168
ds_read_b64_tr_b16 a[174:175], v213 offset:7424
s_waitcnt vmcnt(16)
ds_read_b64_tr_b16 a[176:177], v213 offset:8192
ds_read_b64_tr_b16 a[178:179], v213 offset:8448
ds_read_b64_tr_b16 a[180:181], v213 offset:9216
ds_read_b64_tr_b16 a[182:183], v213 offset:9472
ds_read_b64_tr_b16 a[184:185], v213 offset:10240
ds_read_b64_tr_b16 a[186:187], v213 offset:10496
ds_read_b64_tr_b16 a[188:189], v213 offset:11264
ds_read_b64_tr_b16 a[190:191], v213 offset:11520
s_waitcnt vmcnt(12)
ds_read_b64_tr_b16 a[192:193], v213 offset:12288
ds_read_b64_tr_b16 a[194:195], v213 offset:12544
ds_read_b64_tr_b16 a[196:197], v213 offset:13312
ds_read_b64_tr_b16 a[198:199], v213 offset:13568
ds_read_b64_tr_b16 a[200:201], v213 offset:14336
ds_read_b64_tr_b16 a[202:203], v213 offset:14592
ds_read_b64_tr_b16 a[204:205], v213 offset:15360
ds_read_b64_tr_b16 a[206:207], v213 offset:15616
s_waitcnt vmcnt(8)
ds_read_b64_tr_b16 a[208:209], v213 offset:16384
ds_read_b64_tr_b16 a[210:211], v213 offset:16640
ds_read_b64_tr_b16 a[212:213], v213 offset:17408
ds_read_b64_tr_b16 a[214:215], v213 offset:17664
ds_read_b64_tr_b16 a[216:217], v213 offset:18432
ds_read_b64_tr_b16 a[218:219], v213 offset:18688
ds_read_b64_tr_b16 a[220:221], v213 offset:19456
ds_read_b64_tr_b16 a[222:223], v213 offset:19712
s_waitcnt vmcnt(4)
ds_read_b64_tr_b16 a[224:225], v213 offset:20480
ds_read_b64_tr_b16 a[226:227], v213 offset:20736
ds_read_b64_tr_b16 a[228:229], v213 offset:21504
ds_read_b64_tr_b16 a[230:231], v213 offset:21760
ds_read_b64_tr_b16 a[232:233], v213 offset:22528
ds_read_b64_tr_b16 a[234:235], v213 offset:22784
ds_read_b64_tr_b16 a[236:237], v213 offset:23552
ds_read_b64_tr_b16 a[238:239], v213 offset:23808
s_waitcnt vmcnt(0)
ds_read_b64_tr_b16 a[240:241], v213 offset:24576
ds_read_b64_tr_b16 a[242:243], v213 offset:24832
ds_read_b64_tr_b16 a[244:245], v213 offset:25600
ds_read_b64_tr_b16 a[246:247], v213 offset:25856
ds_read_b64_tr_b16 a[248:249], v213 offset:26624
ds_read_b64_tr_b16 a[250:251], v213 offset:26880
ds_read_b64_tr_b16 a[252:253], v213 offset:27648
ds_read_b64_tr_b16 a[254:255], v213 offset:27904
s_waitcnt lgkmcnt(0)
s_barrier
ww_52:
s_load_dwordx2 s[48:49], s[0:1], 80
s_mov_b32 s50, 2621440
s_mov_b32 s51, 0x20000
s_waitcnt lgkmcnt(0)
s_lshl_b32 s18, s13, 12
v_add_u32 v13, s18, v0
s_lshl_b32 s18, s13, 11
v_add_u32 v14, s18, v0
ws_53:
s_lshl_b32 s18, s16, 6
s_add_u32 s18, s18, s30
s_lshl_b32 s26, s18, 18
s_lshl_b32 s19, s13, 16
s_add_u32 s26, s26, s19
s_add_u32 s26, s26, 127926272
s_lshl_b32 s18, s18, 7
s_lshl_b32 s19, s13, 5
s_add_u32 s18, s18, s19
s_add_u32 s28, s18, 16384
s_mul_i32 s27, s30, 40960
s_and_b32 s18, s13, 1
s_lshl_b32 s19, s47, 1
s_add_u32 s29, s18, s19
v_lshrrev_b32 v12, 2, v0
v_min_u32 v12, 28, v12
s_mov_b32 s17, 0
poll_57:
buffer_load_dword v8, v12, s[4:7], s28 offen offset:0 sc1
s_add_u32 s17, s17, 1
s_cmp_gt_u32 s17, 262144
s_cbranch_scc1 L_fail
s_waitcnt vmcnt(0)
v_cmp_gt_u32 vcc, 1, v8
s_cbranch_vccz polld_58
s_sleep 2
s_branch poll_57
polld_58:
s_lshl_b32 s18, s29, 10
s_add_u32 s18, s18, s27
s_mul_i32 s19, s16, 6291456
s_add_u32 s18, s18, s19
s_add_u32 s18, s18, 88080384
s_add_u32 s19, s26, 0
buffer_load_dwordx4 v[16:19], v0, s[4:7], s19 offen offset:0 sc1
buffer_load_dwordx4 v[20:23], v0, s[4:7], s19 offen offset:1024 sc1
buffer_load_dwordx4 v[24:27], v0, s[4:7], s19 offen offset:2048 sc1
buffer_load_dwordx4 v[28:31], v0, s[4:7], s19 offen offset:3072 sc1
s_add_u32 s19, s26, 4096
buffer_load_dwordx4 v[32:35], v0, s[4:7], s19 offen offset:0 sc1
buffer_load_dwordx4 v[36:39], v0, s[4:7], s19 offen offset:1024 sc1
buffer_load_dwordx4 v[40:43], v0, s[4:7], s19 offen offset:2048 sc1
buffer_load_dwordx4 v[44:47], v0, s[4:7], s19 offen offset:3072 sc1
s_add_u32 s19, s26, 8192
buffer_load_dwordx4 v[48:51], v0, s[4:7], s19 offen offset:0 sc1
buffer_load_dwordx4 v[52:55], v0, s[4:7], s19 offen offset:1024 sc1
buffer_load_dwordx4 v[56:59], v0, s[4:7], s19 offen offset:2048 sc1
buffer_load_dwordx4 v[60:63], v0, s[4:7], s19 offen offset:3072 sc1
s_add_u32 s19, s26, 12288
buffer_load_dwordx4 v[64:67], v0, s[4:7], s19 offen offset:0 sc1
buffer_load_dwordx4 v[68:71], v0, s[4:7], s19 offen offset:1024 sc1
buffer_load_dwordx4 v[72:75], v0, s[4:7], s19 offen offset:2048 sc1
buffer_load_dwordx4 v[76:79], v0, s[4:7], s19 offen offset:3072 sc1
s_add_u32 s19, s26, 16384
buffer_load_dwordx4 v[80:83], v0, s[4:7], s19 offen offset:0 sc1
buffer_load_dwordx4 v[84:87], v0, s[4:7], s19 offen offset:1024 sc1
buffer_load_dwordx4 v[88:91], v0, s[4:7], s19 offen offset:2048 sc1
buffer_load_dwordx4 v[92:95], v0, s[4:7], s19 offen offset:3072 sc1
s_add_u32 s19, s26, 20480
buffer_load_dwordx4 v[96:99], v0, s[4:7], s19 offen offset:0 sc1
buffer_load_dwordx4 v[100:103], v0, s[4:7], s19 offen offset:1024 sc1
buffer_load_dwordx4 v[104:107], v0, s[4:7], s19 offen offset:2048 sc1
buffer_load_dwordx4 v[108:111], v0, s[4:7], s19 offen offset:3072 sc1
s_add_u32 s19, s26, 24576
buffer_load_dwordx4 v[112:115], v0, s[4:7], s19 offen offset:0 sc1
buffer_load_dwordx4 v[116:119], v0, s[4:7], s19 offen offset:1024 sc1
buffer_load_dwordx4 v[120:123], v0, s[4:7], s19 offen offset:2048 sc1
buffer_load_dwordx4 v[124:127], v0, s[4:7], s19 offen offset:3072 sc1
s_add_u32 s19, s26, 28672
buffer_load_dwordx4 v[128:131], v0, s[4:7], s19 offen offset:0 sc1
buffer_load_dwordx4 v[132:135], v0, s[4:7], s19 offen offset:1024 sc1
buffer_load_dwordx4 v[136:139], v0, s[4:7], s19 offen offset:2048 sc1
buffer_load_dwordx4 v[140:143], v0, s[4:7], s19 offen offset:3072 sc1
s_add_u32 s19, s26, 32768
buffer_load_dwordx4 v[144:147], v0, s[4:7], s19 offen offset:0 sc1
buffer_load_dwordx4 v[148:151], v0, s[4:7], s19 offen offset:1024 sc1
buffer_load_dwordx4 v[152:155], v0, s[4:7], s19 offen offset:2048 sc1
buffer_load_dwordx4 v[156:159], v0, s[4:7], s19 offen offset:3072 sc1
s_add_u32 s19, s26, 36864
buffer_load_dwordx4 v[160:163], v0, s[4:7], s19 offen offset:0 sc1
buffer_load_dwordx4 v[164:167], v0, s[4:7], s19 offen offset:1024 sc1
buffer_load_dwordx4 v[168:171], v0, s[4:7], s19 offen offset:2048 sc1
buffer_load_dwordx4 v[172:175], v0, s[4:7], s19 offen offset:3072 sc1
s_add_u32 s19, s26, 40960
buffer_load_dwordx4 v[176:179], v0, s[4:7], s19 offen offset:0 sc1
buffer_load_dwordx4 v[180:183], v0, s[4:7], s19 offen offset:1024 sc1
buffer_load_dwordx4 v[184:187], v0, s[4:7], s19 offen offset:2048 sc1
buffer_load_dwordx4 v[188:191], v0, s[4:7], s19 offen offset:3072 sc1
s_waitcnt vmcnt(43)
v_mfma_f32_32x32x16_bf16 v[192:207], a[0:3], v[16:19], 0
s_add_u32 s19, s26, 45056
buffer_load_dwordx4 v[16:19], v0, s[4:7], s19 offen offset:0 sc1
s_waitcnt vmcnt(43)
v_mfma_f32_32x32x16_bf16 v[192:207], a[4:7], v[20:23], v[192:207]
buffer_load_dwordx4 v[20:23], v0, s[4:7], s19 offen offset:1024 sc1
s_waitcnt vmcnt(43)
v_mfma_f32_32x32x16_bf16 v[192:207], a[8:11], v[24:27], v[192:207]
buffer_load_dwordx4 v[24:27], v0, s[4:7], s19 offen offset:2048 sc1
s_waitcnt vmcnt(43)
v_mfma_f32_32x32x16_bf16 v[192:207], a[12:15], v[28:31], v[192:207]
buffer_load_dwordx4 v[28:31], v0, s[4:7], s19 offen offset:3072 sc1
s_waitcnt vmcnt(43)
v_mfma_f32_32x32x16_bf16 v[192:207], a[16:19], v[32:35], v[192:207]
s_add_u32 s19, s26, 49152
buffer_load_dwordx4 v[32:35], v0, s[4:7], s19 offen offset:0 sc1
s_waitcnt vmcnt(43)
v_mfma_f32_32x32x16_bf16 v[192:207], a[20:23], v[36:39], v[192:207]
buffer_load_dwordx4 v[36:39], v0, s[4:7], s19 offen offset:1024 sc1
s_waitcnt vmcnt(43)
v_mfma_f32_32x32x16_bf16 v[192:207], a[24:27], v[40:43], v[192:207]
buffer_load_dwordx4 v[40:43], v0, s[4:7], s19 offen offset:2048 sc1
s_waitcnt vmcnt(43)
v_mfma_f32_32x32x16_bf16 v[192:207], a[28:31], v[44:47], v[192:207]
buffer_load_dwordx4 v[44:47], v0, s[4:7], s19 offen offset:3072 sc1
s_waitcnt vmcnt(43)
v_mfma_f32_32x32x16_bf16 v[192:207], a[32:35], v[48:51], v[192:207]
s_add_u32 s19, s26, 53248
buffer_load_dwordx4 v[48:51], v0, s[4:7], s19 offen offset:0 sc1
s_waitcnt vmcnt(43)
v_mfma_f32_32x32x16_bf16 v[192:207], a[36:39], v[52:55], v[192:207]
buffer_load_dwordx4 v[52:55], v0, s[4:7], s19 offen offset:1024 sc1
s_waitcnt vmcnt(43)
v_mfma_f32_32x32x16_bf16 v[192:207], a[40:43], v[56:59], v[192:207]
buffer_load_dwordx4 v[56:59], v0, s[4:7], s19 offen offset:2048 sc1
s_waitcnt vmcnt(43)
v_mfma_f32_32x32x16_bf16 v[192:207], a[44:47], v[60:63], v[192:207]
buffer_load_dwordx4 v[60:63], v0, s[4:7], s19 offen offset:3072 sc1
s_waitcnt vmcnt(43)
v_mfma_f32_32x32x16_bf16 v[192:207], a[48:51], v[64:67], v[192:207]
s_add_u32 s19, s26, 57344
buffer_load_dwordx4 v[64:67], v0, s[4:7], s19 offen offset:0 sc1
s_waitcnt vmcnt(43)
v_mfma_f32_32x32x16_bf16 v[192:207], a[52:55], v[68:71], v[192:207]
buffer_load_dwordx4 v[68:71], v0, s[4:7], s19 offen offset:1024 sc1
s_waitcnt vmcnt(43)
v_mfma_f32_32x32x16_bf16 v[192:207], a[56:59], v[72:75], v[192:207]
buffer_load_dwordx4 v[72:75], v0, s[4:7], s19 offen offset:2048 sc1
s_waitcnt vmcnt(43)
v_mfma_f32_32x32x16_bf16 v[192:207], a[60:63], v[76:79], v[192:207]
buffer_load_dwordx4 v[76:79], v0, s[4:7], s19 offen offset:3072 sc1
s_waitcnt vmcnt(43)
v_mfma_f32_32x32x16_bf16 v[192:207], a[64:67], v[80:83], v[192:207]
s_add_u32 s19, s26, 61440
buffer_load_dwordx4 v[80:83], v0, s[4:7], s19 offen offset:0 sc1
s_waitcnt vmcnt(43)
v_mfma_f32_32x32x16_bf16 v[192:207], a[68:71], v[84:87], v[192:207]
buffer_load_dwordx4 v[84:87], v0, s[4:7], s19 offen offset:1024 sc1
s_waitcnt vmcnt(43)
v_mfma_f32_32x32x16_bf16 v[192:207], a[72:75], v[88:91], v[192:207]
buffer_load_dwordx4 v[88:91], v0, s[4:7], s19 offen offset:2048 sc1
s_waitcnt vmcnt(43)
v_mfma_f32_32x32x16_bf16 v[192:207], a[76:79], v[92:95], v[192:207]
buffer_load_dwordx4 v[92:95], v0, s[4:7], s19 offen offset:3072 sc1
s_waitcnt vmcnt(43)
v_mfma_f32_32x32x16_bf16 v[192:207], a[80:83], v[96:99], v[192:207]
buffer_load_dwordx4 v[208:211], v0, s[4:7], s18 offen sc1
s_waitcnt vmcnt(43)
v_mfma_f32_32x32x16_bf16 v[192:207], a[84:87], v[100:103], v[192:207]
s_waitcnt vmcnt(42)
v_mfma_f32_32x32x16_bf16 v[192:207], a[88:91], v[104:107], v[192:207]
s_waitcnt vmcnt(41)
v_mfma_f32_32x32x16_bf16 v[192:207], a[92:95], v[108:111], v[192:207]
s_waitcnt vmcnt(40)
v_mfma_f32_32x32x16_bf16 v[192:207], a[96:99], v[112:115], v[192:207]
s_waitcnt vmcnt(39)
v_mfma_f32_32x32x16_bf16 v[192:207], a[100:103], v[116:119], v[192:207]
s_waitcnt vmcnt(38)
v_mfma_f32_32x32x16_bf16 v[192:207], a[104:107], v[120:123], v[192:207]
s_waitcnt vmcnt(37)
v_mfma_f32_32x32x16_bf16 v[192:207], a[108:111], v[124:127], v[192:207]
s_waitcnt vmcnt(36)
v_mfma_f32_32x32x16_bf16 v[192:207], a[112:115], v[128:131], v[192:207]
s_waitcnt vmcnt(35)
v_mfma_f32_32x32x16_bf16 v[192:207], a[116:119], v[132:135], v[192:207]
s_waitcnt vmcnt(34)
v_mfma_f32_32x32x16_bf16 v[192:207], a[120:123], v[136:139], v[192:207]
s_waitcnt vmcnt(33)
v_mfma_f32_32x32x16_bf16 v[192:207], a[124:127], v[140:143], v[192:207]
s_waitcnt vmcnt(32)
v_mfma_f32_32x32x16_bf16 v[192:207], a[128:131], v[144:147], v[192:207]
s_waitcnt vmcnt(31)
v_mfma_f32_32x32x16_bf16 v[192:207], a[132:135], v[148:151], v[192:207]
s_waitcnt vmcnt(30)
v_mfma_f32_32x32x16_bf16 v[192:207], a[136:139], v[152:155], v[192:207]
s_waitcnt vmcnt(29)
v_mfma_f32_32x32x16_bf16 v[192:207], a[140:143], v[156:159], v[192:207]
s_waitcnt vmcnt(28)
v_mfma_f32_32x32x16_bf16 v[192:207], a[144:147], v[160:163], v[192:207]
s_waitcnt vmcnt(27)
v_mfma_f32_32x32x16_bf16 v[192:207], a[148:151], v[164:167], v[192:207]
s_waitcnt vmcnt(26)
v_mfma_f32_32x32x16_bf16 v[192:207], a[152:155], v[168:171], v[192:207]
s_waitcnt vmcnt(25)
v_mfma_f32_32x32x16_bf16 v[192:207], a[156:159], v[172:175], v[192:207]
s_waitcnt vmcnt(24)
v_mfma_f32_32x32x16_bf16 v[192:207], a[160:163], v[176:179], v[192:207]
s_waitcnt vmcnt(23)
v_mfma_f32_32x32x16_bf16 v[192:207], a[164:167], v[180:183], v[192:207]
s_waitcnt vmcnt(22)
v_mfma_f32_32x32x16_bf16 v[192:207], a[168:171], v[184:187], v[192:207]
s_waitcnt vmcnt(21)
v_mfma_f32_32x32x16_bf16 v[192:207], a[172:175], v[188:191], v[192:207]
s_waitcnt vmcnt(20)
v_mfma_f32_32x32x16_bf16 v[192:207], a[176:179], v[16:19], v[192:207]
s_waitcnt vmcnt(19)
v_mfma_f32_32x32x16_bf16 v[192:207], a[180:183], v[20:23], v[192:207]
s_waitcnt vmcnt(18)
v_mfma_f32_32x32x16_bf16 v[192:207], a[184:187], v[24:27], v[192:207]
s_waitcnt vmcnt(17)
v_mfma_f32_32x32x16_bf16 v[192:207], a[188:191], v[28:31], v[192:207]
s_waitcnt vmcnt(16)
v_mfma_f32_32x32x16_bf16 v[192:207], a[192:195], v[32:35], v[192:207]
s_waitcnt vmcnt(15)
v_mfma_f32_32x32x16_bf16 v[192:207], a[196:199], v[36:39], v[192:207]
s_waitcnt vmcnt(14)
v_mfma_f32_32x32x16_bf16 v[192:207], a[200:203], v[40:43], v[192:207]
s_waitcnt vmcnt(13)
v_mfma_f32_32x32x16_bf16 v[192:207], a[204:207], v[44:47], v[192:207]
s_waitcnt vmcnt(12)
v_mfma_f32_32x32x16_bf16 v[192:207], a[208:211], v[48:51], v[192:207]
s_waitcnt vmcnt(11)
v_mfma_f32_32x32x16_bf16 v[192:207], a[212:215], v[52:55], v[192:207]
s_waitcnt vmcnt(10)
v_mfma_f32_32x32x16_bf16 v[192:207], a[216:219], v[56:59], v[192:207]
s_waitcnt vmcnt(9)
v_mfma_f32_32x32x16_bf16 v[192:207], a[220:223], v[60:63], v[192:207]
s_waitcnt vmcnt(8)
v_mfma_f32_32x32x16_bf16 v[192:207], a[224:227], v[64:67], v[192:207]
s_waitcnt vmcnt(7)
v_mfma_f32_32x32x16_bf16 v[192:207], a[228:231], v[68:71], v[192:207]
s_waitcnt vmcnt(6)
v_mfma_f32_32x32x16_bf16 v[192:207], a[232:235], v[72:75], v[192:207]
s_waitcnt vmcnt(5)
v_mfma_f32_32x32x16_bf16 v[192:207], a[236:239], v[76:79], v[192:207]
s_waitcnt vmcnt(4)
v_mfma_f32_32x32x16_bf16 v[192:207], a[240:243], v[80:83], v[192:207]
s_waitcnt vmcnt(3)
v_mfma_f32_32x32x16_bf16 v[192:207], a[244:247], v[84:87], v[192:207]
s_waitcnt vmcnt(2)
v_mfma_f32_32x32x16_bf16 v[192:207], a[248:251], v[88:91], v[192:207]
s_waitcnt vmcnt(1)
v_mfma_f32_32x32x16_bf16 v[192:207], a[252:255], v[92:95], v[192:207]
s_nop 11
ds_write_b128 v13, v[192:195] offset:0
ds_write_b128 v13, v[196:199] offset:1024
ds_write_b128 v13, v[200:203] offset:2048
ds_write_b128 v13, v[204:207] offset:3072
s_waitcnt lgkmcnt(0)
s_barrier
s_cmp_ge_u32 s13, 2
s_cbranch_scc1 wn_54
ds_read_b128 v[16:19], v14 offset:0
ds_read_b128 v[20:23], v14 offset:1024
ds_read_b128 v[24:27], v14 offset:4096
ds_read_b128 v[28:31], v14 offset:5120
ds_read_b128 v[32:35], v14 offset:8192
ds_read_b128 v[36:39], v14 offset:9216
ds_read_b128 v[40:43], v14 offset:12288
ds_read_b128 v[44:47], v14 offset:13312
s_waitcnt vmcnt(0)
v_lshlrev_b32 v192, 16, v208
v_and_b32 v193, 0xffff0000, v208
v_lshlrev_b32 v194, 16, v209
v_and_b32 v195, 0xffff0000, v209
v_lshlrev_b32 v196, 16, v210
v_and_b32 v197, 0xffff0000, v210
v_lshlrev_b32 v198, 16, v211
v_and_b32 v199, 0xffff0000, v211
s_waitcnt lgkmcnt(5)
v_add_f32 v16, v16, v24
s_waitcnt lgkmcnt(1)
v_add_f32 v32, v32, v40
v_add_f32 v17, v17, v25
v_add_f32 v33, v33, v41
v_add_f32 v18, v18, v26
v_add_f32 v34, v34, v42
v_add_f32 v19, v19, v27
v_add_f32 v35, v35, v43
v_add_f32 v20, v20, v28
s_waitcnt lgkmcnt(0)
v_add_f32 v36, v36, v44
v_add_f32 v21, v21, v29
v_add_f32 v37, v37, v45
v_add_f32 v22, v22, v30
v_add_f32 v38, v38, v46
v_add_f32 v23, v23, v31
v_add_f32 v39, v39, v47
v_add_f32 v16, v16, v32
v_add_f32 v17, v17, v33
v_add_f32 v18, v18, v34
v_add_f32 v19, v19, v35
v_add_f32 v20, v20, v36
v_add_f32 v21, v21, v37
v_add_f32 v22, v22, v38
v_add_f32 v23, v23, v39
v_add_f32 v16, v16, v192
v_add_f32 v17, v17, v193
v_add_f32 v18, v18, v194
v_add_f32 v19, v19, v195
v_add_f32 v20, v20, v196
v_add_f32 v21, v21, v197
v_add_f32 v22, v22, v198
v_add_f32 v23, v23, v199
v_cvt_pk_bf16_f32 v208, v16, v17
v_cvt_pk_bf16_f32 v209, v18, v19
v_cvt_pk_bf16_f32 v210, v20, v21
v_cvt_pk_bf16_f32 v211, v22, v23
s_cmp_lg_u32 s16, 0
s_cbranch_scc1 wo_55
s_add_u32 s18, s18, 3145728
buffer_store_dwordx4 v[208:211], v0, s[4:7], s18 offen sc1
s_branch wn_54
wo_55:
s_lshl_b32 s18, s29, 5
s_add_u32 s18, s18, s27
buffer_store_dwordx4 v[208:211], v5, s[48:51], s18 offen
wn_54:
s_lshl_b32 s18, s30, 7
s_lshl_b32 s19, s47, 2
s_add_u32 s18, s18, s19
s_add_u32 s18, s18, 32768
s_cmp_eq_u32 s13, 0
s_cselect_b32 s22, s18, s6
s_mov_b32 s23, 1
s_waitcnt vmcnt(0)
s_barrier
v_mov_b32 v3, s23
s_mov_b64 exec, 1
buffer_store_dword v3, off, s[4:7], s22 sc1
s_mov_b64 exec, -1
s_mov_b32 s22, s6
s_add_u32 s30, s30, 4
s_cmp_lt_u32 s30, 64
s_cbranch_scc1 ws_53
s_branch aend_42
p1b_41:
s_cmp_lg_u32 s16, 0
s_cbranch_scc1 aend_42
s_cmp_eq_u32 s35, 144
s_cbranch_scc1 aend_42
s_sub_u32 s30, s46, 29
p1q_59:
s_lshl_b32 s18, s30, 7
s_add_u32 s18, s18, 32768
s_cmp_lg_u32 s13, 0
s_cbranch_scc1 polld_61
v_lshrrev_b32 v12, 2, v0
v_min_u32 v12, 76, v12
s_mov_b32 s17, 0
poll_60:
buffer_load_dword v8, v12, s[4:7], s18 offen offset:0 sc1
s_add_u32 s17, s17, 1
s_cmp_gt_u32 s17, 262144
s_cbranch_scc1 L_fail
s_waitcnt vmcnt(0)
v_cmp_gt_u32 vcc, 1, v8
s_cbranch_vccz polld_61
s_sleep 2
s_branch poll_60
polld_61:
s_barrier
s_mul_i32 s18, s30, 40960
s_add_u32 s26, s18, 91226112
s_add_u32 s26, s26, s31
s_add_u32 s27, s18, 100663296
s_add_u32 s27, s27, s33
s_add_u32 m0, s31, 2048
s_add_u32 s20, s26, 0
buffer_load_dwordx4 v0, s[4:7], s20 offen sc1 lds
s_add_u32 m0, s31, 3072
s_add_u32 s20, s26, 1024
buffer_load_dwordx4 v0, s[4:7], s20 offen sc1 lds
s_add_u32 m0, s31, 4096
s_add_u32 s20, s26, 2048
buffer_load_dwordx4 v0, s[4:7], s20 offen sc1 lds
s_add_u32 m0, s31, 5120
s_add_u32 s20, s26, 3072
buffer_load_dwordx4 v0, s[4:7], s20 offen sc1 lds
s_add_u32 m0, s31, 6144
s_add_u32 s20, s26, 4096
buffer_load_dwordx4 v0, s[4:7], s20 offen sc1 lds
s_add_u32 m0, s31, 7168
s_add_u32 s20, s26, 5120
buffer_load_dwordx4 v0, s[4:7], s20 offen sc1 lds
s_add_u32 m0, s31, 8192
s_add_u32 s20, s26, 6144
buffer_load_dwordx4 v0, s[4:7], s20 offen sc1 lds
s_add_u32 m0, s31, 9216
s_add_u32 s20, s26, 7168
buffer_load_dwordx4 v0, s[4:7], s20 offen sc1 lds
s_add_u32 m0, s31, 10240
s_add_u32 s20, s26, 8192
buffer_load_dwordx4 v0, s[4:7], s20 offen sc1 lds
s_add_u32 m0, s31, 11264
s_add_u32 s20, s26, 9216
buffer_load_dwordx4 v0, s[4:7], s20 offen sc1 lds
s_waitcnt vmcnt(0)
s_barrier
ds_read_b128 v[32:35], v0 offset:2048
v_add_u32 v2, s31, v0
ds_read_b128 v[48:51], v2 offset:2048
ds_read_b128 v[36:39], v0 offset:3072
ds_read_b128 v[40:43], v0 offset:4096
v_mov_b64 v[56:57], 0
ds_read_b128 v[52:55], v2 offset:3072
ds_read_b128 v[44:47], v0 offset:5120
s_waitcnt lgkmcnt(5)
v_mfma_f32_32x32x16_bf16 v[16:31], v[32:35], a[0:3], 0
ds_read_b128 v[32:35], v0 offset:6144
s_waitcnt lgkmcnt(5)
v_dot2c_f32_bf16 v56, s24, v48
v_dot2c_f32_bf16 v56, s24, v49
v_dot2c_f32_bf16 v57, v48, v48
s_waitcnt lgkmcnt(4)
v_mfma_f32_32x32x16_bf16 v[16:31], v[36:39], a[4:7], v[16:31]
ds_read_b128 v[36:39], v0 offset:7168
v_dot2c_f32_bf16 v57, v49, v49
v_dot2c_f32_bf16 v56, s24, v50
s_waitcnt lgkmcnt(4)
v_dot2c_f32_bf16 v57, v50, v50
v_dot2c_f32_bf16 v57, v51, v51
v_mfma_f32_32x32x16_bf16 v[16:31], v[40:43], a[8:11], v[16:31]
s_waitcnt lgkmcnt(2)
ds_read_b128 v[40:43], v0 offset:8192
v_dot2c_f32_bf16 v56, s24, v51
v_dot2c_f32_bf16 v57, v52, v52
v_dot2c_f32_bf16 v57, v53, v53
v_mfma_f32_32x32x16_bf16 v[16:31], v[44:47], a[12:15], v[16:31]
s_waitcnt lgkmcnt(2)
ds_read_b128 v[48:51], v2 offset:4096
ds_read_b128 v[44:47], v0 offset:9216
v_dot2c_f32_bf16 v56, s24, v52
v_dot2c_f32_bf16 v56, s24, v53
s_waitcnt lgkmcnt(3)
v_dot2c_f32_bf16 v56, s24, v54
v_mfma_f32_32x32x16_bf16 v[16:31], v[32:35], a[16:19], v[16:31]
ds_read_b128 v[32:35], v0 offset:10240
v_dot2c_f32_bf16 v57, v54, v54
v_dot2c_f32_bf16 v56, s24, v55
v_dot2c_f32_bf16 v57, v55, v55
s_waitcnt lgkmcnt(3)
v_mfma_f32_32x32x16_bf16 v[16:31], v[36:39], a[20:23], v[16:31]
ds_read_b128 v[36:39], v0 offset:11264
ds_read_b128 v[52:55], v2 offset:5120
v_mov_b32 v3, s23
v_mfma_f32_32x32x16_bf16 v[16:31], v[40:43], a[24:27], v[16:31]
s_waitcnt lgkmcnt(3)
ds_read_b128 v[40:43], v0 offset:12288
v_dot2c_f32_bf16 v57, v48, v48
v_dot2c_f32_bf16 v57, v49, v49
v_dot2c_f32_bf16 v56, s24, v48
v_dot2c_f32_bf16 v57, v50, v50
v_mfma_f32_32x32x16_bf16 v[16:31], v[44:47], a[28:31], v[16:31]
s_waitcnt lgkmcnt(3)
ds_read_b128 v[44:47], v0 offset:13312
v_dot2c_f32_bf16 v57, v51, v51
s_waitcnt lgkmcnt(3)
v_dot2c_f32_bf16 v56, s24, v49
v_dot2c_f32_bf16 v56, s24, v50
v_dot2c_f32_bf16 v56, s24, v51
v_mfma_f32_32x32x16_bf16 v[16:31], v[32:35], a[32:35], v[16:31]
s_waitcnt lgkmcnt(2)
ds_read_b128 v[48:51], v2 offset:6144
ds_read_b128 v[32:35], v0 offset:14336
v_dot2c_f32_bf16 v56, s24, v52
v_dot2c_f32_bf16 v57, v52, v52
v_dot2c_f32_bf16 v57, v53, v53
v_dot2c_f32_bf16 v56, s24, v53
v_mfma_f32_32x32x16_bf16 v[16:31], v[36:39], a[36:39], v[16:31]
ds_read_b128 v[36:39], v0 offset:15360
s_waitcnt lgkmcnt(4)
v_dot2c_f32_bf16 v56, s24, v54
v_dot2c_f32_bf16 v57, v54, v54
v_dot2c_f32_bf16 v57, v55, v55
v_dot2c_f32_bf16 v56, s24, v55
v_mfma_f32_32x32x16_bf16 v[16:31], v[40:43], a[40:43], v[16:31]
ds_read_b128 v[52:55], v2 offset:7168
ds_read_b128 v[40:43], v0 offset:16384
s_waitcnt lgkmcnt(4)
v_dot2c_f32_bf16 v57, v48, v48
v_dot2c_f32_bf16 v56, s24, v48
v_dot2c_f32_bf16 v56, s24, v49
v_mfma_f32_32x32x16_bf16 v[16:31], v[44:47], a[44:47], v[16:31]
s_waitcnt lgkmcnt(2)
ds_read_b128 v[44:47], v0 offset:17408
v_dot2c_f32_bf16 v56, s24, v50
v_dot2c_f32_bf16 v56, s24, v51
v_dot2c_f32_bf16 v57, v49, v49
v_dot2c_f32_bf16 v57, v50, v50
v_mfma_f32_32x32x16_bf16 v[16:31], v[32:35], a[48:51], v[16:31]
v_dot2c_f32_bf16 v57, v51, v51
s_waitcnt lgkmcnt(2)
ds_read_b128 v[32:35], v0 offset:18432
ds_read_b128 v[48:51], v2 offset:8192
v_dot2c_f32_bf16 v57, v52, v52
v_mfma_f32_32x32x16_bf16 v[16:31], v[36:39], a[52:55], v[16:31]
s_waitcnt lgkmcnt(2)
ds_read_b128 v[36:39], v0 offset:19456
v_dot2c_f32_bf16 v57, v53, v53
v_dot2c_f32_bf16 v56, s24, v52
v_mfma_f32_32x32x16_bf16 v[16:31], v[40:43], a[56:59], v[16:31]
ds_read_b128 v[40:43], v0 offset:20480
v_dot2c_f32_bf16 v56, s24, v53
v_dot2c_f32_bf16 v56, s24, v54
v_dot2c_f32_bf16 v57, v54, v54
v_dot2c_f32_bf16 v56, s24, v55
v_dot2c_f32_bf16 v57, v55, v55
v_mfma_f32_32x32x16_bf16 v[16:31], v[44:47], a[60:63], v[16:31]
s_waitcnt lgkmcnt(2)
ds_read_b128 v[52:55], v2 offset:9216
ds_read_b128 v[44:47], v0 offset:21504
v_dot2c_f32_bf16 v56, s24, v48
v_dot2c_f32_bf16 v57, v48, v48
v_dot2c_f32_bf16 v57, v49, v49
v_dot2c_f32_bf16 v56, s24, v49
v_mfma_f32_32x32x16_bf16 v[16:31], v[32:35], a[64:67], v[16:31]
ds_read_b128 v[32:35], v0 offset:22528
s_waitcnt lgkmcnt(3)
v_dot2c_f32_bf16 v56, s24, v50
v_dot2c_f32_bf16 v57, v50, v50
v_dot2c_f32_bf16 v56, s24, v51
v_dot2c_f32_bf16 v57, v51, v51
v_mfma_f32_32x32x16_bf16 v[16:31], v[36:39], a[68:71], v[16:31]
s_waitcnt lgkmcnt(2)
ds_read_b128 v[48:51], v2 offset:10240
v_dot2c_f32_bf16 v56, s24, v52
v_dot2c_f32_bf16 v57, v52, v52
v_dot2c_f32_bf16 v57, v53, v53
v_dot2c_f32_bf16 v56, s24, v53
v_mfma_f32_32x32x16_bf16 v[16:31], v[40:43], a[72:75], v[16:31]
s_waitcnt lgkmcnt(2)
ds_read_b128 v[36:39], v0 offset:23552
ds_read_b128 v[40:43], v0 offset:24576
v_dot2c_f32_bf16 v56, s24, v54
v_dot2c_f32_bf16 v57, v54, v54
v_dot2c_f32_bf16 v57, v55, v55
v_dot2c_f32_bf16 v56, s24, v55
v_mfma_f32_32x32x16_bf16 v[16:31], v[44:47], a[76:79], v[16:31]
ds_read_b128 v[52:55], v2 offset:11264
s_waitcnt lgkmcnt(3)
ds_read_b128 v[44:47], v0 offset:25600
v_dot2c_f32_bf16 v57, v48, v48
v_dot2c_f32_bf16 v56, s24, v48
v_dot2c_f32_bf16 v57, v49, v49
v_mfma_f32_32x32x16_bf16 v[16:31], v[32:35], a[80:83], v[16:31]
ds_read_b128 v[32:35], v0 offset:26624
v_dot2c_f32_bf16 v56, s24, v49
v_dot2c_f32_bf16 v56, s24, v50
v_dot2c_f32_bf16 v57, v50, v50
v_dot2c_f32_bf16 v56, s24, v51
s_waitcnt lgkmcnt(4)
v_mfma_f32_32x32x16_bf16 v[16:31], v[36:39], a[84:87], v[16:31]
ds_read_b128 v[36:39], v0 offset:27648
s_waitcnt lgkmcnt(3)
v_dot2c_f32_bf16 v57, v51, v51
v_dot2c_f32_bf16 v57, v52, v52
v_dot2c_f32_bf16 v56, s24, v52
v_dot2c_f32_bf16 v56, s24, v53
v_mfma_f32_32x32x16_bf16 v[16:31], v[40:43], a[88:91], v[16:31]
s_waitcnt lgkmcnt(2)
v_dot2c_f32_bf16 v57, v53, v53
v_dot2c_f32_bf16 v57, v54, v54
v_dot2c_f32_bf16 v56, s24, v54
v_and_b32 v48, 0x1ff, v0
v_dot2c_f32_bf16 v57, v55, v55
v_dot2c_f32_bf16 v56, s24, v55
v_mfma_f32_32x32x16_bf16 v[16:31], v[44:47], a[92:95], v[16:31]
s_waitcnt lgkmcnt(1)
ds_read_b128 v[40:43], v0 offset:28672
ds_read_b128 v[44:47], v0 offset:29696
v_permlane32_swap_b32 v56, v57
v_add_f32 v56, v56, v57
v_lshl_add_u32 v57, s13, 2, v0
v_mfma_f32_32x32x16_bf16 v[16:31], v[32:35], a[96:99], v[16:31]
ds_write_b32 v57, v56 offset:0
ds_read_b128 v[32:35], v0 offset:30720
s_waitcnt lgkmcnt(4)
v_mfma_f32_32x32x16_bf16 v[16:31], v[36:39], a[100:103], v[16:31]
ds_read_b128 v[36:39], v0 offset:31744
s_waitcnt lgkmcnt(3)
v_mfma_f32_32x32x16_bf16 v[16:31], v[40:43], a[104:107], v[16:31]
ds_read_b128 v[40:43], v0 offset:32768
s_waitcnt lgkmcnt(3)
s_barrier
v_mfma_f32_32x32x16_bf16 v[16:31], v[44:47], a[108:111], v[16:31]
s_waitcnt lgkmcnt(2)
ds_read_b128 v[56:59], v48 offset:0
ds_read_b128 v[60:63], v48 offset:512
s_waitcnt lgkmcnt(3)
ds_read_b128 v[44:47], v0 offset:33792
v_mfma_f32_32x32x16_bf16 v[16:31], v[32:35], a[112:115], v[16:31]
s_mov_b64 exec, 1
buffer_store_dword v3, off, s[4:7], s22 sc1
s_mov_b64 exec, -1
ds_read_b128 v[32:35], v0 offset:34816
v_mfma_f32_32x32x16_bf16 v[16:31], v[36:39], a[116:119], v[16:31]
ds_read_b128 v[36:39], v0 offset:35840
s_waitcnt lgkmcnt(4)
v_add_f32 v58, v58, v59
v_add_f32 v56, v56, v57
v_add_f32 v56, v56, v58
v_bfe_u32 v58, v0, 5, 5
v_lshrrev_b32 v57, 2, v0
v_mfma_f32_32x32x16_bf16 v[16:31], v[40:43], a[120:123], v[16:31]
s_waitcnt lgkmcnt(2)
v_mul_f32 v56, 0x3acccccd, v56
v_add_f32 v62, v62, v63
v_add_f32 v60, v60, v61
v_add_f32 v60, v60, v62
v_mul_f32 v60, 0x3acccccd, v60
v_fma_f32 v60, -v56, v56, v60
v_mfma_f32_32x32x16_bf16 v[16:31], v[44:47], a[124:127], v[16:31]
s_waitcnt lgkmcnt(1)
ds_read_b128 v[40:43], v0 offset:36864
ds_read_b128 v[44:47], v0 offset:37888
v_max_f32 v60, 0, v60
v_add_f32 v60, 0x3727c5ac, v60
v_rsq_f32 v60, v60
v_mfma_f32_32x32x16_bf16 v[16:31], v[32:35], a[128:131], v[16:31]
s_waitcnt lgkmcnt(2)
ds_read_b128 v[32:35], v0 offset:38912
v_and_b32 v58, 16, v58
v_mul_f32 v56, v60, v56
v_lshl_add_u32 v58, s13, 8, v58
v_lshl_add_u32 v57, s13, 8, v57
v_permlane32_swap_b32 v60, v56
v_mfma_f32_32x32x16_bf16 v[16:31], v[36:39], a[132:135], v[16:31]
s_waitcnt lgkmcnt(2)
ds_read_b128 v[36:39], v0 offset:39936
ds_write_b32 v57, v60 offset:1024
ds_read_b128 v[80:83], v58 offset:1152
s_waitcnt lgkmcnt(4)
v_mfma_f32_32x32x16_bf16 v[16:31], v[40:43], a[136:139], v[16:31]
ds_read_b128 v[84:87], v58 offset:1184
ds_read_b128 v[92:95], v58 offset:1248
s_waitcnt lgkmcnt(5)
ds_read_b128 v[40:43], v0 offset:40960
v_mfma_f32_32x32x16_bf16 v[16:31], v[44:47], a[140:143], v[16:31]
ds_read_b128 v[44:47], v0 offset:41984
ds_read_b128 v[88:91], v58 offset:1216
v_mfma_f32_32x32x16_bf16 v[16:31], v[32:35], a[144:147], v[16:31]
ds_read_b128 v[76:79], v58 offset:1120
s_waitcnt lgkmcnt(6)
ds_read_b128 v[68:71], v58 offset:1056
ds_read_b128 v[72:75], v58 offset:1088
v_mul_f32 v81, v81, v7
v_mfma_f32_32x32x16_bf16 v[16:31], v[36:39], a[148:151], v[16:31]
v_mul_f32 v82, v82, v7
s_waitcnt lgkmcnt(6)
v_mul_f32 v80, v80, v7
s_waitcnt lgkmcnt(5)
v_mfma_f32_32x32x16_bf16 v[16:31], v[40:43], a[152:155], v[16:31]
ds_read_b128 v[64:67], v58 offset:1024
s_waitcnt lgkmcnt(5)
s_waitcnt lgkmcnt(4)
v_mul_f32 v83, v83, v7
v_mul_f32 v91, v91, v7
v_mul_f32 v90, v90, v7
v_mfma_f32_32x32x16_bf16 v[16:31], v[44:47], a[156:159], v[16:31]
s_nop 0
v_mul_f32 v93, v93, v7
v_mul_f32 v95, v95, v7
v_mul_f32 v87, v87, v7
v_mul_f32 v86, v86, v7
s_waitcnt lgkmcnt(2)
v_mul_f32 v89, v89, v7
v_mul_f32 v84, v84, v7
v_mul_f32 v85, v85, v7
v_mul_f32 v94, v94, v7
v_mul_f32 v92, v92, v7
s_waitcnt lgkmcnt(0)
v_fma_f32 v31, v31, v79, -v95
v_fma_f32 v16, v16, v64, -v80
v_fma_f32 v20, v20, v68, -v84
v_fma_f32 v25, v25, v73, -v89
v_fma_f32 v27, v27, v75, -v91
v_fma_f32 v30, v30, v78, -v94
v_fma_f32 v22, v22, v70, -v86
v_cvt_pk_bf16_f32 v39, v30, v31
v_fma_f32 v26, v26, v74, -v90
v_mul_f32 v88, v88, v7
v_fma_f32 v28, v28, v76, -v92
v_fma_f32 v24, v24, v72, -v88
v_fma_f32 v17, v17, v65, -v81
v_fma_f32 v18, v18, v66, -v82
v_fma_f32 v29, v29, v77, -v93
v_cvt_pk_bf16_f32 v32, v16, v17
v_fma_f32 v19, v19, v67, -v83
v_fma_f32 v23, v23, v71, -v87
v_fma_f32 v21, v21, v69, -v85
v_cvt_pk_bf16_f32 v37, v26, v27
v_cvt_pk_bf16_f32 v35, v22, v23
v_cvt_pk_bf16_f32 v33, v18, v19
v_cvt_pk_bf16_f32 v34, v20, v21
v_cvt_pk_bf16_f32 v36, v24, v25
v_cvt_pk_bf16_f32 v38, v28, v29
buffer_store_dwordx4 v[32:35], v6, s[4:7], s27 offen offset:0 sc1
buffer_store_dwordx4 v[36:39], v6, s[4:7], s27 offen offset:1024 sc1
s_add_u32 s30, s30, 3
s_cmp_lt_u32 s30, 64
s_cbranch_scc1 p1q_59
s_lshl_b32 s18, s35, 2
s_add_u32 s18, s18, 5564
s_cmp_eq_u32 s13, 0
s_cselect_b32 s22, s18, s6
s_mov_b32 s23, 1
s_waitcnt vmcnt(0)
s_barrier
v_mov_b32 v3, s23
s_mov_b64 exec, 1
buffer_store_dword v3, off, s[4:7], s22 sc1
s_mov_b64 exec, -1
s_mov_b32 s22, s6
aend_42:
s_add_u32 s16, s16, 1
s_cmp_lt_u32 s16, 2
s_cbranch_scc1 alay_28
s_endpgm
L_chain:
s_and_b32 s12, s14, 1
s_cmp_lg_u32 s12, 0
s_cbranch_scc1 grp_62
s_mov_b32 s15, s14
s_mov_b32 s16, s13
s_lshr_b32 s30, s14, 1
v_and_b32 v64, 63, v0
v_and_b32 v65, 15, v64
v_lshrrev_b32 v66, 4, v64
v_lshlrev_b32 v0, 4, v64
v_and_b32 v67, 2, v64
v_mov_b32 v68, 0x4444
v_mov_b32 v69, 0xeeee
v_cmp_eq_u32 vcc, 0, v67
s_nop 1
v_cndmask_b32 v1, v69, v68, vcc
s_mul_i32 s33, s16, 36864
s_add_u32 s33, s33, 16384
v_add_u32 v2, s33, v0
v_lshrrev_b32 v67, 2, v65
v_xor_b32 v68, v66, v67
v_lshlrev_b32 v68, 3, v68
v_lshl_add_u32 v68, v65, 5, v68
s_lshl_b32 s33, s16, 10
s_add_u32 s33, s33, 10240
v_add_u32 v3, s33, v68
v_lshl_add_u32 v68, v66, 2, v67
v_and_b32 v69, 3, v65
v_xor_b32 v69, v69, v66
v_lshlrev_b32 v69, 3, v69
v_lshl_add_u32 v68, v68, 5, v69
v_add_u32 v4, 10240, v68
v_and_b32 v69, 1, v65
v_lshl_add_u32 v68, v67, 1, v69
v_lshlrev_b32 v68, 4, v68
v_lshl_add_u32 v68, v66, 7, v68
v_add_u32 v5, 14336, v68
v_bfe_u32 v69, v65, 1, 1
v_mul_u32_u24 v69, 640, v69
v_xor_b32 v6, v69, v5
s_mov_b32 s54, 0x33333333
s_mov_b32 s55, 0x33333333
s_mov_b32 s56, 0x3f803f80
s_mov_b32 s57, 0x3f803f80
s_mov_b32 s58, 0x3f803f80
s_mov_b32 s59, 0
s_mov_b32 s46, 729808896
s_mov_b32 s47, 671088640
v_lshlrev_b32 v68, 3, v65
v_lshl_add_u32 v7, v66, 12, v68
s_lshl_b32 s33, s16, 14
s_lshl_b32 s34, s15, 7
s_add_u32 s33, s33, s34
s_add_u32 s26, s33, 65536
s_lshl_b32 s33, s16, 5
s_add_u32 s32, s33, s15
s_lshl_b32 s33, s32, 12
s_add_u32 s27, s33, 65536
s_lshr_b32 s33, s32, 2
s_lshl_b32 s33, s33, 9
s_and_b32 s34, s32, 3
s_lshl_b32 s34, s34, 6
s_add_u32 s33, s33, s34
s_add_u32 s40, s33, 393216
s_lshl_b32 s33, s15, 7
s_add_u32 s28, s33, 0
s_lshl_b32 s33, s30, 2
s_add_u32 s33, s33, 4096
s_cmp_lt_u32 s30, 10
s_cselect_b32 s29, s33, 268435456
s_cselect_b32 s30, s30, 0
s_cselect_b32 s31, 12582912, s29
s_lshl_b32 s30, s30, 10
s_and_b32 s33, s15, 3
s_lshl_b32 s33, s33, 7
s_add_u32 s41, s33, 425984
s_lshl_b32 s33, s15, 2
s_add_u32 s42, s33, 425984
s_mov_b32 s44, 0x3e0293ee
s_lshl_b32 s33, s15, 2
s_add_u32 s33, s33, s16
s_mul_i32 s34, s33, 18432
s_add_u32 s23, s34, 1048576
s_mul_i32 s34, s33, 36864
s_add_u32 s43, s34, 6291456
s_add_u32 s60, s26, 0
s_add_u32 s61, s26, 65536
s_add_u32 s62, s26, 131072
s_add_u32 s63, s26, 196608
s_add_u32 s64, s26, 262144
s_add_u32 s65, s23, 0
s_add_u32 s66, s23, 4096
s_add_u32 s67, s23, 8192
s_add_u32 s68, s23, 12288
s_add_u32 s69, s23, 16384
v_mov_b32 v72, 0
v_mov_b32 v73, 0
s_mov_b32 s33, s26
buffer_store_dwordx2 v[72:73], v7, s[4:7], s33 offen
s_add_u32 s33, s33, 65536
buffer_store_dwordx2 v[72:73], v7, s[4:7], s33 offen
s_add_u32 s33, s33, 65536
buffer_store_dwordx2 v[72:73], v7, s[4:7], s33 offen
s_add_u32 s33, s33, 65536
buffer_store_dwordx2 v[72:73], v7, s[4:7], s33 offen
s_add_u32 s33, s33, 65536
buffer_store_dwordx2 v[72:73], v7, s[4:7], s33 offen
s_add_u32 s33, s33, 65536
buffer_store_dword v72, off, s[4:7], s42 offset:0
buffer_store_dword v72, off, s[4:7], s42 offset:128
buffer_store_dword v72, off, s[4:7], s42 offset:256
buffer_store_dword v72, off, s[4:7], s42 offset:384
s_load_dwordx2 s[48:49], s[0:1], 32
s_mov_b32 s50, 10240
s_mov_b32 s51, 0x20000
s_cmp_ge_u32 s32, 80
s_cbranch_scc1 nm0_63
s_and_b32 s33, s32, 3
s_mul_i32 s33, s33, 2560
s_lshr_b32 s34, s32, 2
s_lshl_b32 s34, s34, 6
s_add_u32 s33, s33, s34
v_bfe_u32 v68, v65, 1, 2
v_lshlrev_b32 v68, 4, v68
v_and_b32 v69, 1, v65
v_lshl_add_u32 v68, v69, 2, v68
v_and_b32 v69, 1, v66
v_mul_u32_u24 v69, 1280, v69
v_add_u32 v68, v68, v69
s_waitcnt lgkmcnt(0)
buffer_load_dword v74, v68, s[48:51], s33 offen
buffer_load_dword v75, v68, s[48:51], s33 offen offset:8
v_and_b32 v68, 32, v0
v_bfe_u32 v69, v0, 6, 1
v_lshl_add_u32 v68, v69, 8, v68
v_bfe_u32 v69, v0, 8, 1
v_lshl_add_u32 v68, v69, 4, v68
v_bfe_u32 v69, v0, 4, 1
v_lshl_add_u32 v68, v69, 3, v68
s_add_u32 s34, s40, 16384
buffer_store_dwordx2 v[72:73], v68, s[4:7], s40 offen
s_waitcnt vmcnt(1)
buffer_store_dwordx2 v[74:75], v68, s[4:7], s34 offen
nm0_63:
s_waitcnt vmcnt(0) lgkmcnt(0)
v_lshrrev_b32 v67, 2, v64
v_and_b32 v68, 3, v64
v_lshlrev_b32 v68, 4, v68
v_lshl_add_u32 v8, v67, 13, v68
v_mul_u32_u24 v67, 1280, v67
v_add_u32 v9, v67, v68
v_lshrrev_b32 v67, 1, v66
v_lshlrev_b32 v67, 4, v67
v_and_b32 v68, 1, v66
v_lshl_add_u32 v67, v68, 1, v67
v_lshrrev_b32 v68, 3, v65
v_lshl_add_u32 v67, v68, 3, v67
v_bfe_u32 v68, v65, 2, 1
v_add_u32 v67, v67, v68
v_and_b32 v69, 3, v65
v_lshlrev_b32 v10, 4, v69
v_lshl_add_u32 v10, v67, 6, v10
v_lshl_add_u32 v67, v66, 2, v68
v_lshlrev_b32 v11, 4, v69
v_lshl_add_u32 v11, v67, 6, v11
v_lshrrev_b32 v68, 3, v65
v_lshl_add_u32 v11, v68, 3, v11
s_mul_i32 s36, s16, 36864
s_add_u32 s36, s36, 16384
v_add_u32 v10, s36, v10
v_add_u32 v11, s36, v11
s_load_dwordx2 s[72:73], s[0:1], 40
s_mov_b32 s74, 5242880
s_mov_b32 s75, 0x20000
s_load_dwordx2 s[76:77], s[0:1], 48
s_mov_b32 s78, 5242880
s_mov_b32 s79, 0x20000
s_load_dwordx2 s[80:81], s[0:1], 56
s_mov_b32 s82, 5242880
s_mov_b32 s83, 0x20000
s_load_dwordx2 s[84:85], s[0:1], 64
s_mov_b32 s86, 5242880
s_mov_b32 s87, 0x20000
s_xor_b32 s33, s16, 0
s_add_u32 s33, s33, 0
s_lshl_b32 s33, s33, 19
s_lshl_b32 s34, s15, 8
s_add_u32 s33, s33, s34
s_lshl_b32 s34, s16, 6
s_add_u32 s33, s33, s34
s_add_u32 m0, s36, 0
s_waitcnt lgkmcnt(0)
buffer_load_dwordx4 v8, s[72:75], s33 offen lds
s_add_u32 s33, s33, 131072
s_add_u32 m0, s36, 1024
s_nop 0
buffer_load_dwordx4 v8, s[72:75], s33 offen lds
s_add_u32 s33, s33, 131072
s_add_u32 m0, s36, 2048
s_nop 0
buffer_load_dwordx4 v8, s[72:75], s33 offen lds
s_add_u32 s33, s33, 131072
s_add_u32 m0, s36, 3072
s_nop 0
buffer_load_dwordx4 v8, s[72:75], s33 offen lds
s_xor_b32 s33, s16, 0
s_add_u32 s33, s33, 4
s_lshl_b32 s33, s33, 19
s_lshl_b32 s34, s15, 8
s_add_u32 s33, s33, s34
s_lshl_b32 s34, s16, 6
s_add_u32 s33, s33, s34
s_add_u32 m0, s36, 4096
s_nop 0
buffer_load_dwordx4 v8, s[72:75], s33 offen lds
s_add_u32 s33, s33, 131072
s_add_u32 m0, s36, 5120
s_nop 0
buffer_load_dwordx4 v8, s[72:75], s33 offen lds
s_add_u32 s33, s33, 131072
s_add_u32 m0, s36, 6144
s_nop 0
buffer_load_dwordx4 v8, s[72:75], s33 offen lds
s_add_u32 s33, s33, 131072
s_add_u32 m0, s36, 7168
s_nop 0
buffer_load_dwordx4 v8, s[72:75], s33 offen lds
s_xor_b32 s33, s16, 1
s_add_u32 s33, s33, 0
s_lshl_b32 s33, s33, 19
s_lshl_b32 s34, s15, 8
s_add_u32 s33, s33, s34
s_lshl_b32 s34, s16, 6
s_add_u32 s33, s33, s34
s_add_u32 m0, s36, 8192
s_nop 0
buffer_load_dwordx4 v8, s[72:75], s33 offen lds
s_add_u32 s33, s33, 131072
s_add_u32 m0, s36, 9216
s_nop 0
buffer_load_dwordx4 v8, s[72:75], s33 offen lds
s_add_u32 s33, s33, 131072
s_add_u32 m0, s36, 10240
s_nop 0
buffer_load_dwordx4 v8, s[72:75], s33 offen lds
s_add_u32 s33, s33, 131072
s_add_u32 m0, s36, 11264
s_nop 0
buffer_load_dwordx4 v8, s[72:75], s33 offen lds
s_xor_b32 s33, s16, 1
s_add_u32 s33, s33, 4
s_lshl_b32 s33, s33, 19
s_lshl_b32 s34, s15, 8
s_add_u32 s33, s33, s34
s_lshl_b32 s34, s16, 6
s_add_u32 s33, s33, s34
s_add_u32 m0, s36, 12288
s_nop 0
buffer_load_dwordx4 v8, s[72:75], s33 offen lds
s_add_u32 s33, s33, 131072
s_add_u32 m0, s36, 13312
s_nop 0
buffer_load_dwordx4 v8, s[72:75], s33 offen lds
s_add_u32 s33, s33, 131072
s_add_u32 m0, s36, 14336
s_nop 0
buffer_load_dwordx4 v8, s[72:75], s33 offen lds
s_add_u32 s33, s33, 131072
s_add_u32 m0, s36, 15360
s_nop 0
buffer_load_dwordx4 v8, s[72:75], s33 offen lds
s_xor_b32 s33, s16, 2
s_add_u32 s33, s33, 0
s_lshl_b32 s33, s33, 19
s_lshl_b32 s34, s15, 8
s_add_u32 s33, s33, s34
s_lshl_b32 s34, s16, 6
s_add_u32 s33, s33, s34
s_add_u32 m0, s36, 16384
s_nop 0
buffer_load_dwordx4 v8, s[72:75], s33 offen lds
s_add_u32 s33, s33, 131072
s_add_u32 m0, s36, 17408
s_nop 0
buffer_load_dwordx4 v8, s[72:75], s33 offen lds
s_add_u32 s33, s33, 131072
s_add_u32 m0, s36, 18432
s_nop 0
buffer_load_dwordx4 v8, s[72:75], s33 offen lds
s_add_u32 s33, s33, 131072
s_add_u32 m0, s36, 19456
s_nop 0
buffer_load_dwordx4 v8, s[72:75], s33 offen lds
s_xor_b32 s33, s16, 2
s_add_u32 s33, s33, 4
s_lshl_b32 s33, s33, 19
s_lshl_b32 s34, s15, 8
s_add_u32 s33, s33, s34
s_lshl_b32 s34, s16, 6
s_add_u32 s33, s33, s34
s_add_u32 m0, s36, 20480
s_nop 0
buffer_load_dwordx4 v8, s[72:75], s33 offen lds
s_add_u32 s33, s33, 131072
s_add_u32 m0, s36, 21504
s_nop 0
buffer_load_dwordx4 v8, s[72:75], s33 offen lds
s_add_u32 s33, s33, 131072
s_add_u32 m0, s36, 22528
s_nop 0
buffer_load_dwordx4 v8, s[72:75], s33 offen lds
s_add_u32 s33, s33, 131072
s_add_u32 m0, s36, 23552
s_nop 0
buffer_load_dwordx4 v8, s[72:75], s33 offen lds
s_xor_b32 s33, s16, 3
s_add_u32 s33, s33, 0
s_lshl_b32 s33, s33, 19
s_lshl_b32 s34, s15, 8
s_add_u32 s33, s33, s34
s_lshl_b32 s34, s16, 6
s_add_u32 s33, s33, s34
s_add_u32 m0, s36, 24576
s_nop 0
buffer_load_dwordx4 v8, s[72:75], s33 offen lds
s_add_u32 s33, s33, 131072
s_add_u32 m0, s36, 25600
s_nop 0
buffer_load_dwordx4 v8, s[72:75], s33 offen lds
s_add_u32 s33, s33, 131072
s_add_u32 m0, s36, 26624
s_nop 0
buffer_load_dwordx4 v8, s[72:75], s33 offen lds
s_add_u32 s33, s33, 131072
s_add_u32 m0, s36, 27648
s_nop 0
buffer_load_dwordx4 v8, s[72:75], s33 offen lds
s_xor_b32 s33, s16, 3
s_add_u32 s33, s33, 4
s_lshl_b32 s33, s33, 19
s_lshl_b32 s34, s15, 8
s_add_u32 s33, s33, s34
s_lshl_b32 s34, s16, 6
s_add_u32 s33, s33, s34
s_add_u32 m0, s36, 28672
s_nop 0
buffer_load_dwordx4 v8, s[72:75], s33 offen lds
s_add_u32 s33, s33, 131072
s_add_u32 m0, s36, 29696
s_nop 0
buffer_load_dwordx4 v8, s[72:75], s33 offen lds
s_add_u32 s33, s33, 131072
s_add_u32 m0, s36, 30720
s_nop 0
buffer_load_dwordx4 v8, s[72:75], s33 offen lds
s_add_u32 s33, s33, 131072
s_add_u32 m0, s36, 31744
s_nop 0
buffer_load_dwordx4 v8, s[72:75], s33 offen lds
s_mov_b32 s33, 8
s_lshl_b32 s33, s33, 19
s_lshl_b32 s34, s15, 8
s_add_u32 s33, s33, s34
s_lshl_b32 s34, s16, 6
s_add_u32 s33, s33, s34
s_add_u32 m0, s36, 32768
s_nop 0
buffer_load_dwordx4 v8, s[72:75], s33 offen lds
s_add_u32 s33, s33, 131072
s_add_u32 m0, s36, 33792
s_nop 0
buffer_load_dwordx4 v8, s[72:75], s33 offen lds
s_add_u32 s33, s33, 131072
s_add_u32 m0, s36, 34816
s_nop 0
buffer_load_dwordx4 v8, s[72:75], s33 offen lds
s_add_u32 s33, s33, 131072
s_add_u32 m0, s36, 35840
s_nop 0
buffer_load_dwordx4 v8, s[72:75], s33 offen lds
s_waitcnt vmcnt(32)
ds_read_b64_tr_b16 v[72:73], v10 offset:0
ds_read_b64_tr_b16 v[74:75], v10 offset:256
ds_read_b64_tr_b16 v[76:77], v10 offset:2048
ds_read_b64_tr_b16 v[78:79], v10 offset:2304
ds_read_b64_tr_b16 v[80:81], v10 offset:8
ds_read_b64_tr_b16 v[82:83], v10 offset:264
ds_read_b64_tr_b16 v[84:85], v10 offset:2056
ds_read_b64_tr_b16 v[86:87], v10 offset:2312
s_waitcnt lgkmcnt(0)
s_add_u32 s33, s23, 0
buffer_store_dwordx4 v[72:75], v0, s[4:7], s33 offen offset:0
buffer_store_dwordx4 v[76:79], v0, s[4:7], s33 offen offset:1024
s_add_u32 s33, s23, 2048
buffer_store_dwordx4 v[80:83], v0, s[4:7], s33 offen offset:0
buffer_store_dwordx4 v[84:87], v0, s[4:7], s33 offen offset:1024
s_mov_b32 s33, 9
s_lshl_b32 s33, s33, 19
s_lshl_b32 s34, s15, 8
s_add_u32 s33, s33, s34
s_lshl_b32 s34, s16, 6
s_add_u32 s33, s33, s34
s_add_u32 m0, s36, 0
s_nop 0
buffer_load_dwordx4 v8, s[72:75], s33 offen lds
s_add_u32 s33, s33, 131072
s_add_u32 m0, s36, 1024
s_nop 0
buffer_load_dwordx4 v8, s[72:75], s33 offen lds
s_add_u32 s33, s33, 131072
s_add_u32 m0, s36, 2048
s_nop 0
buffer_load_dwordx4 v8, s[72:75], s33 offen lds
s_add_u32 s33, s33, 131072
s_add_u32 m0, s36, 3072
s_nop 0
buffer_load_dwordx4 v8, s[72:75], s33 offen lds
s_waitcnt vmcnt(36)
ds_read_b64_tr_b16 a[8:9], v10 offset:4096
ds_read_b64_tr_b16 a[10:11], v10 offset:4352
ds_read_b64_tr_b16 a[12:13], v10 offset:6144
ds_read_b64_tr_b16 a[14:15], v10 offset:6400
ds_read_b64_tr_b16 a[16:17], v10 offset:4104
ds_read_b64_tr_b16 a[18:19], v10 offset:4360
ds_read_b64_tr_b16 a[20:21], v10 offset:6152
ds_read_b64_tr_b16 a[22:23], v10 offset:6408
s_waitcnt lgkmcnt(0)
s_xor_b32 s33, s16, 0
s_add_u32 s33, s33, 0
s_lshl_b32 s33, s33, 19
s_lshl_b32 s34, s15, 8
s_add_u32 s33, s33, s34
s_lshl_b32 s34, s16, 6
s_add_u32 s33, s33, s34
s_add_u32 m0, s36, 4096
s_nop 0
buffer_load_dwordx4 v8, s[76:79], s33 offen lds
s_add_u32 s33, s33, 131072
s_add_u32 m0, s36, 5120
s_nop 0
buffer_load_dwordx4 v8, s[76:79], s33 offen lds
s_add_u32 s33, s33, 131072
s_add_u32 m0, s36, 6144
s_nop 0
buffer_load_dwordx4 v8, s[76:79], s33 offen lds
s_add_u32 s33, s33, 131072
s_add_u32 m0, s36, 7168
s_nop 0
buffer_load_dwordx4 v8, s[76:79], s33 offen lds
s_waitcnt vmcnt(36)
ds_read_b64_tr_b16 a[48:49], v10 offset:8192
ds_read_b64_tr_b16 a[50:51], v10 offset:8448
ds_read_b64_tr_b16 a[52:53], v10 offset:10240
ds_read_b64_tr_b16 a[54:55], v10 offset:10496
ds_read_b64_tr_b16 a[56:57], v10 offset:8200
ds_read_b64_tr_b16 a[58:59], v10 offset:8456
ds_read_b64_tr_b16 a[60:61], v10 offset:10248
ds_read_b64_tr_b16 a[62:63], v10 offset:10504
s_waitcnt lgkmcnt(0)
s_xor_b32 s33, s16, 0
s_add_u32 s33, s33, 4
s_lshl_b32 s33, s33, 19
s_lshl_b32 s34, s15, 8
s_add_u32 s33, s33, s34
s_lshl_b32 s34, s16, 6
s_add_u32 s33, s33, s34
s_add_u32 m0, s36, 8192
s_nop 0
buffer_load_dwordx4 v8, s[76:79], s33 offen lds
s_add_u32 s33, s33, 131072
s_add_u32 m0, s36, 9216
s_nop 0
buffer_load_dwordx4 v8, s[76:79], s33 offen lds
s_add_u32 s33, s33, 131072
s_add_u32 m0, s36, 10240
s_nop 0
buffer_load_dwordx4 v8, s[76:79], s33 offen lds
s_add_u32 s33, s33, 131072
s_add_u32 m0, s36, 11264
s_nop 0
buffer_load_dwordx4 v8, s[76:79], s33 offen lds
s_waitcnt vmcnt(36)
ds_read_b64_tr_b16 a[64:65], v10 offset:12288
ds_read_b64_tr_b16 a[66:67], v10 offset:12544
ds_read_b64_tr_b16 a[68:69], v10 offset:14336
ds_read_b64_tr_b16 a[70:71], v10 offset:14592
ds_read_b64_tr_b16 a[72:73], v10 offset:12296
ds_read_b64_tr_b16 a[74:75], v10 offset:12552
ds_read_b64_tr_b16 a[76:77], v10 offset:14344
ds_read_b64_tr_b16 a[78:79], v10 offset:14600
s_waitcnt lgkmcnt(0)
s_xor_b32 s33, s16, 1
s_add_u32 s33, s33, 0
s_lshl_b32 s33, s33, 19
s_lshl_b32 s34, s15, 8
s_add_u32 s33, s33, s34
s_lshl_b32 s34, s16, 6
s_add_u32 s33, s33, s34
s_add_u32 m0, s36, 12288
s_nop 0
buffer_load_dwordx4 v8, s[76:79], s33 offen lds
s_add_u32 s33, s33, 131072
s_add_u32 m0, s36, 13312
s_nop 0
buffer_load_dwordx4 v8, s[76:79], s33 offen lds
s_add_u32 s33, s33, 131072
s_add_u32 m0, s36, 14336
s_nop 0
buffer_load_dwordx4 v8, s[76:79], s33 offen lds
s_add_u32 s33, s33, 131072
s_add_u32 m0, s36, 15360
s_nop 0
buffer_load_dwordx4 v8, s[76:79], s33 offen lds
s_waitcnt vmcnt(36)
ds_read_b64_tr_b16 v[48:49], v10 offset:16384
ds_read_b64_tr_b16 v[50:51], v10 offset:16640
ds_read_b64_tr_b16 v[52:53], v10 offset:18432
ds_read_b64_tr_b16 v[54:55], v10 offset:18688
ds_read_b64_tr_b16 a[80:81], v10 offset:16392
ds_read_b64_tr_b16 a[82:83], v10 offset:16648
ds_read_b64_tr_b16 a[84:85], v10 offset:18440
ds_read_b64_tr_b16 a[86:87], v10 offset:18696
s_waitcnt lgkmcnt(0)
s_add_u32 s33, s43, 4096
buffer_store_dwordx4 v[48:51], v0, s[4:7], s33 offen offset:0
buffer_store_dwordx4 v[52:55], v0, s[4:7], s33 offen offset:1024
s_xor_b32 s33, s16, 1
s_add_u32 s33, s33, 4
s_lshl_b32 s33, s33, 19
s_lshl_b32 s34, s15, 8
s_add_u32 s33, s33, s34
s_lshl_b32 s34, s16, 6
s_add_u32 s33, s33, s34
s_add_u32 m0, s36, 16384
s_nop 0
buffer_load_dwordx4 v8, s[76:79], s33 offen lds
s_add_u32 s33, s33, 131072
s_add_u32 m0, s36, 17408
s_nop 0
buffer_load_dwordx4 v8, s[76:79], s33 offen lds
s_add_u32 s33, s33, 131072
s_add_u32 m0, s36, 18432
s_nop 0
buffer_load_dwordx4 v8, s[76:79], s33 offen lds
s_add_u32 s33, s33, 131072
s_add_u32 m0, s36, 19456
s_nop 0
buffer_load_dwordx4 v8, s[76:79], s33 offen lds
s_waitcnt vmcnt(38)
ds_read_b64_tr_b16 a[88:89], v10 offset:20480
ds_read_b64_tr_b16 a[90:91], v10 offset:20736
ds_read_b64_tr_b16 a[92:93], v10 offset:22528
ds_read_b64_tr_b16 a[94:95], v10 offset:22784
ds_read_b64_tr_b16 a[96:97], v10 offset:20488
ds_read_b64_tr_b16 a[98:99], v10 offset:20744
ds_read_b64_tr_b16 a[100:101], v10 offset:22536
ds_read_b64_tr_b16 a[102:103], v10 offset:22792
s_waitcnt lgkmcnt(0)
s_xor_b32 s33, s16, 2
s_add_u32 s33, s33, 0
s_lshl_b32 s33, s33, 19
s_lshl_b32 s34, s15, 8
s_add_u32 s33, s33, s34
s_lshl_b32 s34, s16, 6
s_add_u32 s33, s33, s34
s_add_u32 m0, s36, 20480
s_nop 0
buffer_load_dwordx4 v8, s[76:79], s33 offen lds
s_add_u32 s33, s33, 131072
s_add_u32 m0, s36, 21504
s_nop 0
buffer_load_dwordx4 v8, s[76:79], s33 offen lds
s_add_u32 s33, s33, 131072
s_add_u32 m0, s36, 22528
s_nop 0
buffer_load_dwordx4 v8, s[76:79], s33 offen lds
s_add_u32 s33, s33, 131072
s_add_u32 m0, s36, 23552
s_nop 0
buffer_load_dwordx4 v8, s[76:79], s33 offen lds
s_waitcnt vmcnt(38)
ds_read_b64_tr_b16 v[56:57], v10 offset:24576
ds_read_b64_tr_b16 v[58:59], v10 offset:24832
ds_read_b64_tr_b16 v[60:61], v10 offset:26624
ds_read_b64_tr_b16 v[62:63], v10 offset:26880
ds_read_b64_tr_b16 a[104:105], v10 offset:24584
ds_read_b64_tr_b16 a[106:107], v10 offset:24840
ds_read_b64_tr_b16 a[108:109], v10 offset:26632
ds_read_b64_tr_b16 a[110:111], v10 offset:26888
s_waitcnt lgkmcnt(0)
s_add_u32 s33, s23, 8192
buffer_store_dwordx4 v[56:59], v0, s[4:7], s33 offen offset:0
buffer_store_dwordx4 v[60:63], v0, s[4:7], s33 offen offset:1024
s_xor_b32 s33, s16, 2
s_add_u32 s33, s33, 4
s_lshl_b32 s33, s33, 19
s_lshl_b32 s34, s15, 8
s_add_u32 s33, s33, s34
s_lshl_b32 s34, s16, 6
s_add_u32 s33, s33, s34
s_add_u32 m0, s36, 24576
s_nop 0
buffer_load_dwordx4 v8, s[76:79], s33 offen lds
s_add_u32 s33, s33, 131072
s_add_u32 m0, s36, 25600
s_nop 0
buffer_load_dwordx4 v8, s[76:79], s33 offen lds
s_add_u32 s33, s33, 131072
s_add_u32 m0, s36, 26624
s_nop 0
buffer_load_dwordx4 v8, s[76:79], s33 offen lds
s_add_u32 s33, s33, 131072
s_add_u32 m0, s36, 27648
s_nop 0
buffer_load_dwordx4 v8, s[76:79], s33 offen lds
s_waitcnt vmcnt(40)
ds_read_b64_tr_b16 v[72:73], v10 offset:28672
ds_read_b64_tr_b16 v[74:75], v10 offset:28928
ds_read_b64_tr_b16 v[76:77], v10 offset:30720
ds_read_b64_tr_b16 v[78:79], v10 offset:30976
ds_read_b64_tr_b16 a[112:113], v10 offset:28680
ds_read_b64_tr_b16 a[114:115], v10 offset:28936
ds_read_b64_tr_b16 a[116:117], v10 offset:30728
ds_read_b64_tr_b16 a[118:119], v10 offset:30984
s_waitcnt lgkmcnt(0)
s_add_u32 s33, s43, 6144
buffer_store_dwordx4 v[72:75], v0, s[4:7], s33 offen offset:0
buffer_store_dwordx4 v[76:79], v0, s[4:7], s33 offen offset:1024
s_xor_b32 s33, s16, 3
s_add_u32 s33, s33, 0
s_lshl_b32 s33, s33, 19
s_lshl_b32 s34, s15, 8
s_add_u32 s33, s33, s34
s_lshl_b32 s34, s16, 6
s_add_u32 s33, s33, s34
s_add_u32 m0, s36, 28672
s_nop 0
buffer_load_dwordx4 v8, s[76:79], s33 offen lds
s_add_u32 s33, s33, 131072
s_add_u32 m0, s36, 29696
s_nop 0
buffer_load_dwordx4 v8, s[76:79], s33 offen lds
s_add_u32 s33, s33, 131072
s_add_u32 m0, s36, 30720
s_nop 0
buffer_load_dwordx4 v8, s[76:79], s33 offen lds
s_add_u32 s33, s33, 131072
s_add_u32 m0, s36, 31744
s_nop 0
buffer_load_dwordx4 v8, s[76:79], s33 offen lds
s_waitcnt vmcnt(42)
ds_read_b64_tr_b16 a[120:121], v10 offset:32768
ds_read_b64_tr_b16 a[122:123], v10 offset:33024
ds_read_b64_tr_b16 a[124:125], v10 offset:34816
ds_read_b64_tr_b16 a[126:127], v10 offset:35072
ds_read_b64_tr_b16 a[128:129], v10 offset:32776
ds_read_b64_tr_b16 a[130:131], v10 offset:33032
ds_read_b64_tr_b16 a[132:133], v10 offset:34824
ds_read_b64_tr_b16 a[134:135], v10 offset:35080
s_waitcnt lgkmcnt(0)
s_xor_b32 s33, s16, 3
s_add_u32 s33, s33, 4
s_lshl_b32 s33, s33, 19
s_lshl_b32 s34, s15, 8
s_add_u32 s33, s33, s34
s_lshl_b32 s34, s16, 6
s_add_u32 s33, s33, s34
s_add_u32 m0, s36, 32768
s_nop 0
buffer_load_dwordx4 v8, s[76:79], s33 offen lds
s_add_u32 s33, s33, 131072
s_add_u32 m0, s36, 33792
s_nop 0
buffer_load_dwordx4 v8, s[76:79], s33 offen lds
s_add_u32 s33, s33, 131072
s_add_u32 m0, s36, 34816
s_nop 0
buffer_load_dwordx4 v8, s[76:79], s33 offen lds
s_add_u32 s33, s33, 131072
s_add_u32 m0, s36, 35840
s_nop 0
buffer_load_dwordx4 v8, s[76:79], s33 offen lds
s_waitcnt vmcnt(38)
ds_read_b64_tr_b16 v[80:81], v10 offset:0
ds_read_b64_tr_b16 v[82:83], v10 offset:256
ds_read_b64_tr_b16 v[84:85], v10 offset:2048
ds_read_b64_tr_b16 v[86:87], v10 offset:2304
ds_read_b64_tr_b16 a[136:137], v10 offset:8
ds_read_b64_tr_b16 a[138:139], v10 offset:264
ds_read_b64_tr_b16 a[140:141], v10 offset:2056
ds_read_b64_tr_b16 a[142:143], v10 offset:2312
s_waitcnt lgkmcnt(0)
s_add_u32 s33, s43, 8192
buffer_store_dwordx4 v[80:83], v0, s[4:7], s33 offen offset:0
buffer_store_dwordx4 v[84:87], v0, s[4:7], s33 offen offset:1024
s_mov_b32 s33, 8
s_lshl_b32 s33, s33, 19
s_lshl_b32 s34, s15, 8
s_add_u32 s33, s33, s34
s_lshl_b32 s34, s16, 6
s_add_u32 s33, s33, s34
s_add_u32 m0, s36, 0
s_nop 0
buffer_load_dwordx4 v8, s[76:79], s33 offen lds
s_add_u32 s33, s33, 131072
s_add_u32 m0, s36, 1024
s_nop 0
buffer_load_dwordx4 v8, s[76:79], s33 offen lds
s_add_u32 s33, s33, 131072
s_add_u32 m0, s36, 2048
s_nop 0
buffer_load_dwordx4 v8, s[76:79], s33 offen lds
s_add_u32 s33, s33, 131072
s_add_u32 m0, s36, 3072
s_nop 0
buffer_load_dwordx4 v8, s[76:79], s33 offen lds
s_waitcnt vmcnt(40)
ds_read_b64_tr_b16 v[48:49], v10 offset:4096
ds_read_b64_tr_b16 v[50:51], v10 offset:4352
ds_read_b64_tr_b16 v[52:53], v10 offset:6144
ds_read_b64_tr_b16 v[54:55], v10 offset:6400
ds_read_b64_tr_b16 v[56:57], v10 offset:4104
ds_read_b64_tr_b16 v[58:59], v10 offset:4360
ds_read_b64_tr_b16 v[60:61], v10 offset:6152
ds_read_b64_tr_b16 v[62:63], v10 offset:6408
s_waitcnt lgkmcnt(0)
s_add_u32 s33, s23, 4096
buffer_store_dwordx4 v[48:51], v0, s[4:7], s33 offen offset:0
buffer_store_dwordx4 v[52:55], v0, s[4:7], s33 offen offset:1024
s_add_u32 s33, s23, 6144
buffer_store_dwordx4 v[56:59], v0, s[4:7], s33 offen offset:0
buffer_store_dwordx4 v[60:63], v0, s[4:7], s33 offen offset:1024
s_mov_b32 s33, 9
s_lshl_b32 s33, s33, 19
s_lshl_b32 s34, s15, 8
s_add_u32 s33, s33, s34
s_lshl_b32 s34, s16, 6
s_add_u32 s33, s33, s34
s_add_u32 m0, s36, 4096
s_nop 0
buffer_load_dwordx4 v8, s[76:79], s33 offen lds
s_add_u32 s33, s33, 131072
s_add_u32 m0, s36, 5120
s_nop 0
buffer_load_dwordx4 v8, s[76:79], s33 offen lds
s_add_u32 s33, s33, 131072
s_add_u32 m0, s36, 6144
s_nop 0
buffer_load_dwordx4 v8, s[76:79], s33 offen lds
s_add_u32 s33, s33, 131072
s_add_u32 m0, s36, 7168
s_nop 0
buffer_load_dwordx4 v8, s[76:79], s33 offen lds
s_waitcnt vmcnt(44)
ds_read_b64_tr_b16 a[24:25], v10 offset:8192
ds_read_b64_tr_b16 a[26:27], v10 offset:8448
ds_read_b64_tr_b16 a[28:29], v10 offset:10240
ds_read_b64_tr_b16 a[30:31], v10 offset:10496
ds_read_b64_tr_b16 a[32:33], v10 offset:8200
ds_read_b64_tr_b16 a[34:35], v10 offset:8456
ds_read_b64_tr_b16 a[36:37], v10 offset:10248
ds_read_b64_tr_b16 a[38:39], v10 offset:10504
s_waitcnt lgkmcnt(0)
s_xor_b32 s33, s16, 0
s_add_u32 s33, s33, 0
s_lshl_b32 s33, s33, 19
s_lshl_b32 s34, s15, 8
s_add_u32 s33, s33, s34
s_lshl_b32 s34, s16, 6
s_add_u32 s33, s33, s34
s_add_u32 m0, s36, 8192
s_nop 0
buffer_load_dwordx4 v8, s[80:83], s33 offen lds
s_add_u32 s33, s33, 131072
s_add_u32 m0, s36, 9216
s_nop 0
buffer_load_dwordx4 v8, s[80:83], s33 offen lds
s_add_u32 s33, s33, 131072
s_add_u32 m0, s36, 10240
s_nop 0
buffer_load_dwordx4 v8, s[80:83], s33 offen lds
s_add_u32 s33, s33, 131072
s_add_u32 m0, s36, 11264
s_nop 0
buffer_load_dwordx4 v8, s[80:83], s33 offen lds
s_waitcnt vmcnt(44)
ds_read_b64_tr_b16 v[72:73], v10 offset:12288
ds_read_b64_tr_b16 v[74:75], v10 offset:12544
ds_read_b64_tr_b16 v[76:77], v10 offset:14336
ds_read_b64_tr_b16 v[78:79], v10 offset:14592
ds_read_b64_tr_b16 v[80:81], v10 offset:12296
ds_read_b64_tr_b16 v[82:83], v10 offset:12552
ds_read_b64_tr_b16 v[84:85], v10 offset:14344
ds_read_b64_tr_b16 v[86:87], v10 offset:14600
s_waitcnt lgkmcnt(0)
s_add_u32 s33, s23, 10240
buffer_store_dwordx4 v[72:75], v0, s[4:7], s33 offen offset:0
buffer_store_dwordx4 v[76:79], v0, s[4:7], s33 offen offset:1024
s_add_u32 s33, s43, 10240
buffer_store_dwordx4 v[80:83], v0, s[4:7], s33 offen offset:0
buffer_store_dwordx4 v[84:87], v0, s[4:7], s33 offen offset:1024
s_xor_b32 s33, s16, 0
s_add_u32 s33, s33, 4
s_lshl_b32 s33, s33, 19
s_lshl_b32 s34, s15, 8
s_add_u32 s33, s33, s34
s_lshl_b32 s34, s16, 6
s_add_u32 s33, s33, s34
s_add_u32 m0, s36, 12288
s_nop 0
buffer_load_dwordx4 v8, s[80:83], s33 offen lds
s_add_u32 s33, s33, 131072
s_add_u32 m0, s36, 13312
s_nop 0
buffer_load_dwordx4 v8, s[80:83], s33 offen lds
s_add_u32 s33, s33, 131072
s_add_u32 m0, s36, 14336
s_nop 0
buffer_load_dwordx4 v8, s[80:83], s33 offen lds
s_add_u32 s33, s33, 131072
s_add_u32 m0, s36, 15360
s_nop 0
buffer_load_dwordx4 v8, s[80:83], s33 offen lds
s_waitcnt vmcnt(46)
ds_read_b64_tr_b16 a[144:145], v10 offset:16384
ds_read_b64_tr_b16 a[146:147], v10 offset:16640
ds_read_b64_tr_b16 a[148:149], v10 offset:18432
ds_read_b64_tr_b16 a[150:151], v10 offset:18688
ds_read_b64_tr_b16 a[152:153], v10 offset:16392
ds_read_b64_tr_b16 a[154:155], v10 offset:16648
ds_read_b64_tr_b16 a[156:157], v10 offset:18440
ds_read_b64_tr_b16 a[158:159], v10 offset:18696
s_waitcnt lgkmcnt(0)
s_xor_b32 s33, s16, 1
s_add_u32 s33, s33, 0
s_lshl_b32 s33, s33, 19
s_lshl_b32 s34, s15, 8
s_add_u32 s33, s33, s34
s_lshl_b32 s34, s16, 6
s_add_u32 s33, s33, s34
s_add_u32 m0, s36, 16384
s_nop 0
buffer_load_dwordx4 v8, s[80:83], s33 offen lds
s_add_u32 s33, s33, 131072
s_add_u32 m0, s36, 17408
s_nop 0
buffer_load_dwordx4 v8, s[80:83], s33 offen lds
s_add_u32 s33, s33, 131072
s_add_u32 m0, s36, 18432
s_nop 0
buffer_load_dwordx4 v8, s[80:83], s33 offen lds
s_add_u32 s33, s33, 131072
s_add_u32 m0, s36, 19456
s_nop 0
buffer_load_dwordx4 v8, s[80:83], s33 offen lds
s_waitcnt vmcnt(46)
ds_read_b64_tr_b16 a[160:161], v10 offset:20480
ds_read_b64_tr_b16 a[162:163], v10 offset:20736
ds_read_b64_tr_b16 a[164:165], v10 offset:22528
ds_read_b64_tr_b16 a[166:167], v10 offset:22784
ds_read_b64_tr_b16 v[48:49], v10 offset:20488
ds_read_b64_tr_b16 v[50:51], v10 offset:20744
ds_read_b64_tr_b16 v[52:53], v10 offset:22536
ds_read_b64_tr_b16 v[54:55], v10 offset:22792
s_waitcnt lgkmcnt(0)
s_add_u32 s33, s43, 12288
buffer_store_dwordx4 v[48:51], v0, s[4:7], s33 offen offset:0
buffer_store_dwordx4 v[52:55], v0, s[4:7], s33 offen offset:1024
s_xor_b32 s33, s16, 1
s_add_u32 s33, s33, 4
s_lshl_b32 s33, s33, 19
s_lshl_b32 s34, s15, 8
s_add_u32 s33, s33, s34
s_lshl_b32 s34, s16, 6
s_add_u32 s33, s33, s34
s_add_u32 m0, s36, 20480
s_nop 0
buffer_load_dwordx4 v8, s[80:83], s33 offen lds
s_add_u32 s33, s33, 131072
s_add_u32 m0, s36, 21504
s_nop 0
buffer_load_dwordx4 v8, s[80:83], s33 offen lds
s_add_u32 s33, s33, 131072
s_add_u32 m0, s36, 22528
s_nop 0
buffer_load_dwordx4 v8, s[80:83], s33 offen lds
s_add_u32 s33, s33, 131072
s_add_u32 m0, s36, 23552
s_nop 0
buffer_load_dwordx4 v8, s[80:83], s33 offen lds
s_waitcnt vmcnt(46)
ds_read_b64_tr_b16 a[168:169], v10 offset:24576
ds_read_b64_tr_b16 a[170:171], v10 offset:24832
ds_read_b64_tr_b16 a[172:173], v10 offset:26624
ds_read_b64_tr_b16 a[174:175], v10 offset:26880
ds_read_b64_tr_b16 a[176:177], v10 offset:24584
ds_read_b64_tr_b16 a[178:179], v10 offset:24840
ds_read_b64_tr_b16 a[180:181], v10 offset:26632
ds_read_b64_tr_b16 a[182:183], v10 offset:26888
s_waitcnt lgkmcnt(0)
s_xor_b32 s33, s16, 2
s_add_u32 s33, s33, 0
s_lshl_b32 s33, s33, 19
s_lshl_b32 s34, s15, 8
s_add_u32 s33, s33, s34
s_lshl_b32 s34, s16, 6
s_add_u32 s33, s33, s34
s_add_u32 m0, s36, 24576
s_nop 0
buffer_load_dwordx4 v8, s[80:83], s33 offen lds
s_add_u32 s33, s33, 131072
s_add_u32 m0, s36, 25600
s_nop 0
buffer_load_dwordx4 v8, s[80:83], s33 offen lds
s_add_u32 s33, s33, 131072
s_add_u32 m0, s36, 26624
s_nop 0
buffer_load_dwordx4 v8, s[80:83], s33 offen lds
s_add_u32 s33, s33, 131072
s_add_u32 m0, s36, 27648
s_nop 0
buffer_load_dwordx4 v8, s[80:83], s33 offen lds
s_waitcnt vmcnt(44)
ds_read_b64_tr_b16 a[184:185], v10 offset:28672
ds_read_b64_tr_b16 a[186:187], v10 offset:28928
ds_read_b64_tr_b16 a[188:189], v10 offset:30720
ds_read_b64_tr_b16 a[190:191], v10 offset:30976
ds_read_b64_tr_b16 v[56:57], v10 offset:28680
ds_read_b64_tr_b16 v[58:59], v10 offset:28936
ds_read_b64_tr_b16 v[60:61], v10 offset:30728
ds_read_b64_tr_b16 v[62:63], v10 offset:30984
s_waitcnt lgkmcnt(0)
s_add_u32 s33, s43, 14336
buffer_store_dwordx4 v[56:59], v0, s[4:7], s33 offen offset:0
buffer_store_dwordx4 v[60:63], v0, s[4:7], s33 offen offset:1024
s_xor_b32 s33, s16, 2
s_add_u32 s33, s33, 4
s_lshl_b32 s33, s33, 19
s_lshl_b32 s34, s15, 8
s_add_u32 s33, s33, s34
s_lshl_b32 s34, s16, 6
s_add_u32 s33, s33, s34
s_add_u32 m0, s36, 28672
s_nop 0
buffer_load_dwordx4 v8, s[80:83], s33 offen lds
s_add_u32 s33, s33, 131072
s_add_u32 m0, s36, 29696
s_nop 0
buffer_load_dwordx4 v8, s[80:83], s33 offen lds
s_add_u32 s33, s33, 131072
s_add_u32 m0, s36, 30720
s_nop 0
buffer_load_dwordx4 v8, s[80:83], s33 offen lds
s_add_u32 s33, s33, 131072
s_add_u32 m0, s36, 31744
s_nop 0
buffer_load_dwordx4 v8, s[80:83], s33 offen lds
s_waitcnt vmcnt(46)
ds_read_b64_tr_b16 a[192:193], v10 offset:32768
ds_read_b64_tr_b16 a[194:195], v10 offset:33024
ds_read_b64_tr_b16 a[196:197], v10 offset:34816
ds_read_b64_tr_b16 a[198:199], v10 offset:35072
ds_read_b64_tr_b16 a[200:201], v10 offset:32776
ds_read_b64_tr_b16 a[202:203], v10 offset:33032
ds_read_b64_tr_b16 a[204:205], v10 offset:34824
ds_read_b64_tr_b16 a[206:207], v10 offset:35080
s_waitcnt lgkmcnt(0)
s_xor_b32 s33, s16, 3
s_add_u32 s33, s33, 0
s_lshl_b32 s33, s33, 19
s_lshl_b32 s34, s15, 8
s_add_u32 s33, s33, s34
s_lshl_b32 s34, s16, 6
s_add_u32 s33, s33, s34
s_add_u32 m0, s36, 32768
s_nop 0
buffer_load_dwordx4 v8, s[80:83], s33 offen lds
s_add_u32 s33, s33, 131072
s_add_u32 m0, s36, 33792
s_nop 0
buffer_load_dwordx4 v8, s[80:83], s33 offen lds
s_add_u32 s33, s33, 131072
s_add_u32 m0, s36, 34816
s_nop 0
buffer_load_dwordx4 v8, s[80:83], s33 offen lds
s_add_u32 s33, s33, 131072
s_add_u32 m0, s36, 35840
s_nop 0
buffer_load_dwordx4 v8, s[80:83], s33 offen lds
s_waitcnt vmcnt(44)
ds_read_b64_tr_b16 a[208:209], v10 offset:0
ds_read_b64_tr_b16 a[210:211], v10 offset:256
ds_read_b64_tr_b16 a[212:213], v10 offset:2048
ds_read_b64_tr_b16 a[214:215], v10 offset:2304
ds_read_b64_tr_b16 v[72:73], v10 offset:8
ds_read_b64_tr_b16 v[74:75], v10 offset:264
ds_read_b64_tr_b16 v[76:77], v10 offset:2056
ds_read_b64_tr_b16 v[78:79], v10 offset:2312
s_waitcnt lgkmcnt(0)
s_add_u32 s33, s43, 16384
buffer_store_dwordx4 v[72:75], v0, s[4:7], s33 offen offset:0
buffer_store_dwordx4 v[76:79], v0, s[4:7], s33 offen offset:1024
s_xor_b32 s33, s16, 3
s_add_u32 s33, s33, 4
s_lshl_b32 s33, s33, 19
s_lshl_b32 s34, s15, 8
s_add_u32 s33, s33, s34
s_lshl_b32 s34, s16, 6
s_add_u32 s33, s33, s34
s_add_u32 m0, s36, 0
s_nop 0
buffer_load_dwordx4 v8, s[80:83], s33 offen lds
s_add_u32 s33, s33, 131072
s_add_u32 m0, s36, 1024
s_nop 0
buffer_load_dwordx4 v8, s[80:83], s33 offen lds
s_add_u32 s33, s33, 131072
s_add_u32 m0, s36, 2048
s_nop 0
buffer_load_dwordx4 v8, s[80:83], s33 offen lds
s_add_u32 s33, s33, 131072
s_add_u32 m0, s36, 3072
s_nop 0
buffer_load_dwordx4 v8, s[80:83], s33 offen lds
s_waitcnt vmcnt(42)
ds_read_b64_tr_b16 a[216:217], v10 offset:4096
ds_read_b64_tr_b16 a[218:219], v10 offset:4352
ds_read_b64_tr_b16 a[220:221], v10 offset:6144
ds_read_b64_tr_b16 a[222:223], v10 offset:6400
ds_read_b64_tr_b16 a[224:225], v10 offset:4104
ds_read_b64_tr_b16 a[226:227], v10 offset:4360
ds_read_b64_tr_b16 a[228:229], v10 offset:6152
ds_read_b64_tr_b16 a[230:231], v10 offset:6408
s_waitcnt lgkmcnt(0)
s_mov_b32 s33, 8
s_lshl_b32 s33, s33, 19
s_lshl_b32 s34, s15, 8
s_add_u32 s33, s33, s34
s_lshl_b32 s34, s16, 6
s_add_u32 s33, s33, s34
s_add_u32 m0, s36, 4096
s_nop 0
buffer_load_dwordx4 v8, s[80:83], s33 offen lds
s_add_u32 s33, s33, 131072
s_add_u32 m0, s36, 5120
s_nop 0
buffer_load_dwordx4 v8, s[80:83], s33 offen lds
s_add_u32 s33, s33, 131072
s_add_u32 m0, s36, 6144
s_nop 0
buffer_load_dwordx4 v8, s[80:83], s33 offen lds
s_add_u32 s33, s33, 131072
s_add_u32 m0, s36, 7168
s_nop 0
buffer_load_dwordx4 v8, s[80:83], s33 offen lds
s_waitcnt vmcnt(42)
ds_read_b64_tr_b16 v[80:81], v10 offset:8192
ds_read_b64_tr_b16 v[82:83], v10 offset:8448
ds_read_b64_tr_b16 v[84:85], v10 offset:10240
ds_read_b64_tr_b16 v[86:87], v10 offset:10496
ds_read_b64_tr_b16 a[0:1], v10 offset:8200
ds_read_b64_tr_b16 a[2:3], v10 offset:8456
ds_read_b64_tr_b16 a[4:5], v10 offset:10248
ds_read_b64_tr_b16 a[6:7], v10 offset:10504
s_waitcnt lgkmcnt(0)
s_add_u32 s33, s43, 0
buffer_store_dwordx4 v[80:83], v0, s[4:7], s33 offen offset:0
buffer_store_dwordx4 v[84:87], v0, s[4:7], s33 offen offset:1024
s_mov_b32 s33, 9
s_lshl_b32 s33, s33, 19
s_lshl_b32 s34, s15, 8
s_add_u32 s33, s33, s34
s_lshl_b32 s34, s16, 6
s_add_u32 s33, s33, s34
s_add_u32 m0, s36, 8192
s_nop 0
buffer_load_dwordx4 v8, s[80:83], s33 offen lds
s_add_u32 s33, s33, 131072
s_add_u32 m0, s36, 9216
s_nop 0
buffer_load_dwordx4 v8, s[80:83], s33 offen lds
s_add_u32 s33, s33, 131072
s_add_u32 m0, s36, 10240
s_nop 0
buffer_load_dwordx4 v8, s[80:83], s33 offen lds
s_add_u32 s33, s33, 131072
s_add_u32 m0, s36, 11264
s_nop 0
buffer_load_dwordx4 v8, s[80:83], s33 offen lds
s_waitcnt vmcnt(40)
ds_read_b64_tr_b16 v[48:49], v10 offset:12288
ds_read_b64_tr_b16 v[50:51], v10 offset:12544
ds_read_b64_tr_b16 v[52:53], v10 offset:14336
ds_read_b64_tr_b16 v[54:55], v10 offset:14592
ds_read_b64_tr_b16 a[40:41], v10 offset:12296
ds_read_b64_tr_b16 a[42:43], v10 offset:12552
ds_read_b64_tr_b16 a[44:45], v10 offset:14344
ds_read_b64_tr_b16 a[46:47], v10 offset:14600
s_waitcnt lgkmcnt(0)
s_add_u32 s33, s43, 2048
buffer_store_dwordx4 v[48:51], v0, s[4:7], s33 offen offset:0
buffer_store_dwordx4 v[52:55], v0, s[4:7], s33 offen offset:1024
s_xor_b32 s33, s16, 0
s_lshl_b32 s33, s33, 5
s_lshl_b32 s34, s15, 7
s_add_u32 s33, s33, s34
s_add_u32 s33, s33, 0
s_mul_i32 s33, s33, 1280
s_lshl_b32 s34, s16, 6
s_add_u32 s33, s33, s34
s_add_u32 s33, s33, 0
s_add_u32 m0, s36, 12288
s_nop 0
buffer_load_dwordx4 v9, s[84:87], s33 offen lds
s_xor_b32 s33, s16, 0
s_lshl_b32 s33, s33, 5
s_lshl_b32 s34, s15, 7
s_add_u32 s33, s33, s34
s_add_u32 s33, s33, 16
s_mul_i32 s33, s33, 1280
s_lshl_b32 s34, s16, 6
s_add_u32 s33, s33, s34
s_add_u32 s33, s33, 0
s_add_u32 m0, s36, 13312
s_nop 0
buffer_load_dwordx4 v9, s[84:87], s33 offen lds
s_xor_b32 s33, s16, 1
s_lshl_b32 s33, s33, 5
s_lshl_b32 s34, s15, 7
s_add_u32 s33, s33, s34
s_add_u32 s33, s33, 0
s_mul_i32 s33, s33, 1280
s_lshl_b32 s34, s16, 6
s_add_u32 s33, s33, s34
s_add_u32 s33, s33, 0
s_add_u32 m0, s36, 14336
s_nop 0
buffer_load_dwordx4 v9, s[84:87], s33 offen lds
s_xor_b32 s33, s16, 1
s_lshl_b32 s33, s33, 5
s_lshl_b32 s34, s15, 7
s_add_u32 s33, s33, s34
s_add_u32 s33, s33, 16
s_mul_i32 s33, s33, 1280
s_lshl_b32 s34, s16, 6
s_add_u32 s33, s33, s34
s_add_u32 s33, s33, 0
s_add_u32 m0, s36, 15360
s_nop 0
buffer_load_dwordx4 v9, s[84:87], s33 offen lds
s_waitcnt vmcnt(42)
ds_read_b64_tr_b16 v[56:57], v10 offset:16384
ds_read_b64_tr_b16 v[58:59], v10 offset:16640
ds_read_b64_tr_b16 v[60:61], v10 offset:18432
ds_read_b64_tr_b16 v[62:63], v10 offset:18688
ds_read_b64_tr_b16 a[232:233], v10 offset:16392
ds_read_b64_tr_b16 a[234:235], v10 offset:16648
ds_read_b64_tr_b16 a[236:237], v10 offset:18440
ds_read_b64_tr_b16 a[238:239], v10 offset:18696
s_waitcnt lgkmcnt(0)
s_add_u32 s33, s43, 18432
buffer_store_dwordx4 v[56:59], v0, s[4:7], s33 offen offset:0
buffer_store_dwordx4 v[60:63], v0, s[4:7], s33 offen offset:1024
s_xor_b32 s33, s16, 2
s_lshl_b32 s33, s33, 5
s_lshl_b32 s34, s15, 7
s_add_u32 s33, s33, s34
s_add_u32 s33, s33, 0
s_mul_i32 s33, s33, 1280
s_lshl_b32 s34, s16, 6
s_add_u32 s33, s33, s34
s_add_u32 s33, s33, 0
s_add_u32 m0, s36, 16384
s_nop 0
buffer_load_dwordx4 v9, s[84:87], s33 offen lds
s_xor_b32 s33, s16, 2
s_lshl_b32 s33, s33, 5
s_lshl_b32 s34, s15, 7
s_add_u32 s33, s33, s34
s_add_u32 s33, s33, 16
s_mul_i32 s33, s33, 1280
s_lshl_b32 s34, s16, 6
s_add_u32 s33, s33, s34
s_add_u32 s33, s33, 0
s_add_u32 m0, s36, 17408
s_nop 0
buffer_load_dwordx4 v9, s[84:87], s33 offen lds
s_xor_b32 s33, s16, 3
s_lshl_b32 s33, s33, 5
s_lshl_b32 s34, s15, 7
s_add_u32 s33, s33, s34
s_add_u32 s33, s33, 0
s_mul_i32 s33, s33, 1280
s_lshl_b32 s34, s16, 6
s_add_u32 s33, s33, s34
s_add_u32 s33, s33, 0
s_add_u32 m0, s36, 18432
s_nop 0
buffer_load_dwordx4 v9, s[84:87], s33 offen lds
s_xor_b32 s33, s16, 3
s_lshl_b32 s33, s33, 5
s_lshl_b32 s34, s15, 7
s_add_u32 s33, s33, s34
s_add_u32 s33, s33, 16
s_mul_i32 s33, s33, 1280
s_lshl_b32 s34, s16, 6
s_add_u32 s33, s33, s34
s_add_u32 s33, s33, 0
s_add_u32 m0, s36, 19456
s_nop 0
buffer_load_dwordx4 v9, s[84:87], s33 offen lds
s_waitcnt vmcnt(42)
ds_read_b64_tr_b16 a[240:241], v10 offset:20480
ds_read_b64_tr_b16 a[242:243], v10 offset:20736
ds_read_b64_tr_b16 a[244:245], v10 offset:22528
ds_read_b64_tr_b16 a[246:247], v10 offset:22784
ds_read_b64_tr_b16 v[72:73], v10 offset:20488
ds_read_b64_tr_b16 v[74:75], v10 offset:20744
ds_read_b64_tr_b16 v[76:77], v10 offset:22536
ds_read_b64_tr_b16 v[78:79], v10 offset:22792
s_waitcnt lgkmcnt(0)
s_add_u32 s33, s43, 20480
buffer_store_dwordx4 v[72:75], v0, s[4:7], s33 offen offset:0
buffer_store_dwordx4 v[76:79], v0, s[4:7], s33 offen offset:1024
s_xor_b32 s33, s16, 0
s_lshl_b32 s33, s33, 5
s_lshl_b32 s34, s15, 7
s_add_u32 s33, s33, s34
s_add_u32 s33, s33, 0
s_mul_i32 s33, s33, 1280
s_lshl_b32 s34, s16, 6
s_add_u32 s33, s33, s34
s_add_u32 s33, s33, 256
s_add_u32 m0, s36, 20480
s_nop 0
buffer_load_dwordx4 v9, s[84:87], s33 offen lds
s_xor_b32 s33, s16, 0
s_lshl_b32 s33, s33, 5
s_lshl_b32 s34, s15, 7
s_add_u32 s33, s33, s34
s_add_u32 s33, s33, 16
s_mul_i32 s33, s33, 1280
s_lshl_b32 s34, s16, 6
s_add_u32 s33, s33, s34
s_add_u32 s33, s33, 256
s_add_u32 m0, s36, 21504
s_nop 0
buffer_load_dwordx4 v9, s[84:87], s33 offen lds
s_xor_b32 s33, s16, 1
s_lshl_b32 s33, s33, 5
s_lshl_b32 s34, s15, 7
s_add_u32 s33, s33, s34
s_add_u32 s33, s33, 0
s_mul_i32 s33, s33, 1280
s_lshl_b32 s34, s16, 6
s_add_u32 s33, s33, s34
s_add_u32 s33, s33, 256
s_add_u32 m0, s36, 22528
s_nop 0
buffer_load_dwordx4 v9, s[84:87], s33 offen lds
s_xor_b32 s33, s16, 1
s_lshl_b32 s33, s33, 5
s_lshl_b32 s34, s15, 7
s_add_u32 s33, s33, s34
s_add_u32 s33, s33, 16
s_mul_i32 s33, s33, 1280
s_lshl_b32 s34, s16, 6
s_add_u32 s33, s33, s34
s_add_u32 s33, s33, 256
s_add_u32 m0, s36, 23552
s_nop 0
buffer_load_dwordx4 v9, s[84:87], s33 offen lds
s_waitcnt vmcnt(44)
ds_read_b64_tr_b16 a[248:249], v10 offset:24576
ds_read_b64_tr_b16 a[250:251], v10 offset:24832
ds_read_b64_tr_b16 a[252:253], v10 offset:26624
ds_read_b64_tr_b16 a[254:255], v10 offset:26880
ds_read_b64_tr_b16 v[88:89], v10 offset:24584
ds_read_b64_tr_b16 v[90:91], v10 offset:24840
ds_read_b64_tr_b16 v[92:93], v10 offset:26632
ds_read_b64_tr_b16 v[94:95], v10 offset:26888
s_waitcnt lgkmcnt(0)
s_xor_b32 s33, s16, 2
s_lshl_b32 s33, s33, 5
s_lshl_b32 s34, s15, 7
s_add_u32 s33, s33, s34
s_add_u32 s33, s33, 0
s_mul_i32 s33, s33, 1280
s_lshl_b32 s34, s16, 6
s_add_u32 s33, s33, s34
s_add_u32 s33, s33, 256
s_add_u32 m0, s36, 24576
s_nop 0
buffer_load_dwordx4 v9, s[84:87], s33 offen lds
s_xor_b32 s33, s16, 2
s_lshl_b32 s33, s33, 5
s_lshl_b32 s34, s15, 7
s_add_u32 s33, s33, s34
s_add_u32 s33, s33, 16
s_mul_i32 s33, s33, 1280
s_lshl_b32 s34, s16, 6
s_add_u32 s33, s33, s34
s_add_u32 s33, s33, 256
s_add_u32 m0, s36, 25600
s_nop 0
buffer_load_dwordx4 v9, s[84:87], s33 offen lds
s_xor_b32 s33, s16, 3
s_lshl_b32 s33, s33, 5
s_lshl_b32 s34, s15, 7
s_add_u32 s33, s33, s34
s_add_u32 s33, s33, 0
s_mul_i32 s33, s33, 1280
s_lshl_b32 s34, s16, 6
s_add_u32 s33, s33, s34
s_add_u32 s33, s33, 256
s_add_u32 m0, s36, 26624
s_nop 0
buffer_load_dwordx4 v9, s[84:87], s33 offen lds
s_xor_b32 s33, s16, 3
s_lshl_b32 s33, s33, 5
s_lshl_b32 s34, s15, 7
s_add_u32 s33, s33, s34
s_add_u32 s33, s33, 16
s_mul_i32 s33, s33, 1280
s_lshl_b32 s34, s16, 6
s_add_u32 s33, s33, s34
s_add_u32 s33, s33, 256
s_add_u32 m0, s36, 27648
s_nop 0
buffer_load_dwordx4 v9, s[84:87], s33 offen lds
s_waitcnt vmcnt(42)
ds_read_b64_tr_b16 v[96:97], v10 offset:28672
ds_read_b64_tr_b16 v[98:99], v10 offset:28928
ds_read_b64_tr_b16 v[100:101], v10 offset:30720
ds_read_b64_tr_b16 v[102:103], v10 offset:30976
ds_read_b64_tr_b16 v[80:81], v10 offset:28680
ds_read_b64_tr_b16 v[82:83], v10 offset:28936
ds_read_b64_tr_b16 v[84:85], v10 offset:30728
ds_read_b64_tr_b16 v[86:87], v10 offset:30984
s_waitcnt lgkmcnt(0)
s_add_u32 s33, s43, 22528
buffer_store_dwordx4 v[80:83], v0, s[4:7], s33 offen offset:0
buffer_store_dwordx4 v[84:87], v0, s[4:7], s33 offen offset:1024
s_xor_b32 s33, s16, 0
s_lshl_b32 s33, s33, 5
s_lshl_b32 s34, s15, 7
s_add_u32 s33, s33, s34
s_add_u32 s33, s33, 0
s_mul_i32 s33, s33, 1280
s_lshl_b32 s34, s16, 6
s_add_u32 s33, s33, s34
s_add_u32 s33, s33, 512
s_add_u32 m0, s36, 28672
s_nop 0
buffer_load_dwordx4 v9, s[84:87], s33 offen lds
s_xor_b32 s33, s16, 0
s_lshl_b32 s33, s33, 5
s_lshl_b32 s34, s15, 7
s_add_u32 s33, s33, s34
s_add_u32 s33, s33, 16
s_mul_i32 s33, s33, 1280
s_lshl_b32 s34, s16, 6
s_add_u32 s33, s33, s34
s_add_u32 s33, s33, 512
s_add_u32 m0, s36, 29696
s_nop 0
buffer_load_dwordx4 v9, s[84:87], s33 offen lds
s_xor_b32 s33, s16, 1
s_lshl_b32 s33, s33, 5
s_lshl_b32 s34, s15, 7
s_add_u32 s33, s33, s34
s_add_u32 s33, s33, 0
s_mul_i32 s33, s33, 1280
s_lshl_b32 s34, s16, 6
s_add_u32 s33, s33, s34
s_add_u32 s33, s33, 512
s_add_u32 m0, s36, 30720
s_nop 0
buffer_load_dwordx4 v9, s[84:87], s33 offen lds
s_xor_b32 s33, s16, 1
s_lshl_b32 s33, s33, 5
s_lshl_b32 s34, s15, 7
s_add_u32 s33, s33, s34
s_add_u32 s33, s33, 16
s_mul_i32 s33, s33, 1280
s_lshl_b32 s34, s16, 6
s_add_u32 s33, s33, s34
s_add_u32 s33, s33, 512
s_add_u32 m0, s36, 31744
s_nop 0
buffer_load_dwordx4 v9, s[84:87], s33 offen lds
s_waitcnt vmcnt(44)
ds_read_b64_tr_b16 v[104:105], v10 offset:32768
ds_read_b64_tr_b16 v[106:107], v10 offset:33024
ds_read_b64_tr_b16 v[108:109], v10 offset:34816
ds_read_b64_tr_b16 v[110:111], v10 offset:35072
ds_read_b64_tr_b16 v[112:113], v10 offset:32776
ds_read_b64_tr_b16 v[114:115], v10 offset:33032
ds_read_b64_tr_b16 v[116:117], v10 offset:34824
ds_read_b64_tr_b16 v[118:119], v10 offset:35080
s_waitcnt lgkmcnt(0)
s_xor_b32 s33, s16, 2
s_lshl_b32 s33, s33, 5
s_lshl_b32 s34, s15, 7
s_add_u32 s33, s33, s34
s_add_u32 s33, s33, 0
s_mul_i32 s33, s33, 1280
s_lshl_b32 s34, s16, 6
s_add_u32 s33, s33, s34
s_add_u32 s33, s33, 512
s_add_u32 m0, s36, 32768
s_nop 0
buffer_load_dwordx4 v9, s[84:87], s33 offen lds
s_xor_b32 s33, s16, 2
s_lshl_b32 s33, s33, 5
s_lshl_b32 s34, s15, 7
s_add_u32 s33, s33, s34
s_add_u32 s33, s33, 16
s_mul_i32 s33, s33, 1280
s_lshl_b32 s34, s16, 6
s_add_u32 s33, s33, s34
s_add_u32 s33, s33, 512
s_add_u32 m0, s36, 33792
s_nop 0
buffer_load_dwordx4 v9, s[84:87], s33 offen lds
s_xor_b32 s33, s16, 3
s_lshl_b32 s33, s33, 5
s_lshl_b32 s34, s15, 7
s_add_u32 s33, s33, s34
s_add_u32 s33, s33, 0
s_mul_i32 s33, s33, 1280
s_lshl_b32 s34, s16, 6
s_add_u32 s33, s33, s34
s_add_u32 s33, s33, 512
s_add_u32 m0, s36, 34816
s_nop 0
buffer_load_dwordx4 v9, s[84:87], s33 offen lds
s_xor_b32 s33, s16, 3
s_lshl_b32 s33, s33, 5
s_lshl_b32 s34, s15, 7
s_add_u32 s33, s33, s34
s_add_u32 s33, s33, 16
s_mul_i32 s33, s33, 1280
s_lshl_b32 s34, s16, 6
s_add_u32 s33, s33, s34
s_add_u32 s33, s33, 512
s_add_u32 m0, s36, 35840
s_nop 0
buffer_load_dwordx4 v9, s[84:87], s33 offen lds
s_waitcnt vmcnt(42)
ds_read_b64_tr_b16 v[120:121], v10 offset:0
ds_read_b64_tr_b16 v[122:123], v10 offset:256
ds_read_b64_tr_b16 v[124:125], v10 offset:2048
ds_read_b64_tr_b16 v[126:127], v10 offset:2304
ds_read_b64_tr_b16 v[128:129], v10 offset:8
ds_read_b64_tr_b16 v[130:131], v10 offset:264
ds_read_b64_tr_b16 v[132:133], v10 offset:2056
ds_read_b64_tr_b16 v[134:135], v10 offset:2312
s_waitcnt lgkmcnt(0)
s_xor_b32 s33, s16, 0
s_lshl_b32 s33, s33, 5
s_lshl_b32 s34, s15, 7
s_add_u32 s33, s33, s34
s_add_u32 s33, s33, 0
s_mul_i32 s33, s33, 1280
s_lshl_b32 s34, s16, 6
s_add_u32 s33, s33, s34
s_add_u32 s33, s33, 768
s_add_u32 m0, s36, 0
s_nop 0
buffer_load_dwordx4 v9, s[84:87], s33 offen lds
s_xor_b32 s33, s16, 0
s_lshl_b32 s33, s33, 5
s_lshl_b32 s34, s15, 7
s_add_u32 s33, s33, s34
s_add_u32 s33, s33, 16
s_mul_i32 s33, s33, 1280
s_lshl_b32 s34, s16, 6
s_add_u32 s33, s33, s34
s_add_u32 s33, s33, 768
s_add_u32 m0, s36, 1024
s_nop 0
buffer_load_dwordx4 v9, s[84:87], s33 offen lds
s_xor_b32 s33, s16, 1
s_lshl_b32 s33, s33, 5
s_lshl_b32 s34, s15, 7
s_add_u32 s33, s33, s34
s_add_u32 s33, s33, 0
s_mul_i32 s33, s33, 1280
s_lshl_b32 s34, s16, 6
s_add_u32 s33, s33, s34
s_add_u32 s33, s33, 768
s_add_u32 m0, s36, 2048
s_nop 0
buffer_load_dwordx4 v9, s[84:87], s33 offen lds
s_xor_b32 s33, s16, 1
s_lshl_b32 s33, s33, 5
s_lshl_b32 s34, s15, 7
s_add_u32 s33, s33, s34
s_add_u32 s33, s33, 16
s_mul_i32 s33, s33, 1280
s_lshl_b32 s34, s16, 6
s_add_u32 s33, s33, s34
s_add_u32 s33, s33, 768
s_add_u32 m0, s36, 3072
s_nop 0
buffer_load_dwordx4 v9, s[84:87], s33 offen lds
s_waitcnt vmcnt(42)
ds_read_b64_tr_b16 v[136:137], v10 offset:4096
ds_read_b64_tr_b16 v[138:139], v10 offset:4352
ds_read_b64_tr_b16 v[140:141], v10 offset:6144
ds_read_b64_tr_b16 v[142:143], v10 offset:6400
ds_read_b64_tr_b16 v[144:145], v10 offset:4104
ds_read_b64_tr_b16 v[146:147], v10 offset:4360
ds_read_b64_tr_b16 v[148:149], v10 offset:6152
ds_read_b64_tr_b16 v[150:151], v10 offset:6408
s_waitcnt lgkmcnt(0)
s_xor_b32 s33, s16, 2
s_lshl_b32 s33, s33, 5
s_lshl_b32 s34, s15, 7
s_add_u32 s33, s33, s34
s_add_u32 s33, s33, 0
s_mul_i32 s33, s33, 1280
s_lshl_b32 s34, s16, 6
s_add_u32 s33, s33, s34
s_add_u32 s33, s33, 768
s_add_u32 m0, s36, 4096
s_nop 0
buffer_load_dwordx4 v9, s[84:87], s33 offen lds
s_xor_b32 s33, s16, 2
s_lshl_b32 s33, s33, 5
s_lshl_b32 s34, s15, 7
s_add_u32 s33, s33, s34
s_add_u32 s33, s33, 16
s_mul_i32 s33, s33, 1280
s_lshl_b32 s34, s16, 6
s_add_u32 s33, s33, s34
s_add_u32 s33, s33, 768
s_add_u32 m0, s36, 5120
s_nop 0
buffer_load_dwordx4 v9, s[84:87], s33 offen lds
s_xor_b32 s33, s16, 3
s_lshl_b32 s33, s33, 5
s_lshl_b32 s34, s15, 7
s_add_u32 s33, s33, s34
s_add_u32 s33, s33, 0
s_mul_i32 s33, s33, 1280
s_lshl_b32 s34, s16, 6
s_add_u32 s33, s33, s34
s_add_u32 s33, s33, 768
s_add_u32 m0, s36, 6144
s_nop 0
buffer_load_dwordx4 v9, s[84:87], s33 offen lds
s_xor_b32 s33, s16, 3
s_lshl_b32 s33, s33, 5
s_lshl_b32 s34, s15, 7
s_add_u32 s33, s33, s34
s_add_u32 s33, s33, 16
s_mul_i32 s33, s33, 1280
s_lshl_b32 s34, s16, 6
s_add_u32 s33, s33, s34
s_add_u32 s33, s33, 768
s_add_u32 m0, s36, 7168
s_nop 0
buffer_load_dwordx4 v9, s[84:87], s33 offen lds
s_waitcnt vmcnt(40)
ds_read_b64_tr_b16 v[152:153], v10 offset:8192
ds_read_b64_tr_b16 v[154:155], v10 offset:8448
ds_read_b64_tr_b16 v[156:157], v10 offset:10240
ds_read_b64_tr_b16 v[158:159], v10 offset:10496
ds_read_b64_tr_b16 v[160:161], v10 offset:8200
ds_read_b64_tr_b16 v[162:163], v10 offset:8456
ds_read_b64_tr_b16 v[164:165], v10 offset:10248
ds_read_b64_tr_b16 v[166:167], v10 offset:10504
s_waitcnt lgkmcnt(0)
s_xor_b32 s33, s16, 0
s_lshl_b32 s33, s33, 5
s_lshl_b32 s34, s15, 7
s_add_u32 s33, s33, s34
s_add_u32 s33, s33, 0
s_mul_i32 s33, s33, 1280
s_lshl_b32 s34, s16, 6
s_add_u32 s33, s33, s34
s_add_u32 s33, s33, 1024
s_add_u32 m0, s36, 8192
s_nop 0
buffer_load_dwordx4 v9, s[84:87], s33 offen lds
s_xor_b32 s33, s16, 0
s_lshl_b32 s33, s33, 5
s_lshl_b32 s34, s15, 7
s_add_u32 s33, s33, s34
s_add_u32 s33, s33, 16
s_mul_i32 s33, s33, 1280
s_lshl_b32 s34, s16, 6
s_add_u32 s33, s33, s34
s_add_u32 s33, s33, 1024
s_add_u32 m0, s36, 9216
s_nop 0
buffer_load_dwordx4 v9, s[84:87], s33 offen lds
s_xor_b32 s33, s16, 1
s_lshl_b32 s33, s33, 5
s_lshl_b32 s34, s15, 7
s_add_u32 s33, s33, s34
s_add_u32 s33, s33, 0
s_mul_i32 s33, s33, 1280
s_lshl_b32 s34, s16, 6
s_add_u32 s33, s33, s34
s_add_u32 s33, s33, 1024
s_add_u32 m0, s36, 10240
s_nop 0
buffer_load_dwordx4 v9, s[84:87], s33 offen lds
s_xor_b32 s33, s16, 1
s_lshl_b32 s33, s33, 5
s_lshl_b32 s34, s15, 7
s_add_u32 s33, s33, s34
s_add_u32 s33, s33, 16
s_mul_i32 s33, s33, 1280
s_lshl_b32 s34, s16, 6
s_add_u32 s33, s33, s34
s_add_u32 s33, s33, 1024
s_add_u32 m0, s36, 11264
s_nop 0
buffer_load_dwordx4 v9, s[84:87], s33 offen lds
s_waitcnt vmcnt(38)
ds_read_b64_tr_b16 v[48:49], v11 offset:12288
ds_read_b64_tr_b16 v[50:51], v11 offset:12416
ds_read_b64_tr_b16 v[52:53], v11 offset:13312
ds_read_b64_tr_b16 v[54:55], v11 offset:13440
ds_read_b64_tr_b16 v[56:57], v11 offset:14336
ds_read_b64_tr_b16 v[58:59], v11 offset:14464
ds_read_b64_tr_b16 v[60:61], v11 offset:15360
ds_read_b64_tr_b16 v[62:63], v11 offset:15488
s_waitcnt lgkmcnt(0)
s_add_u32 s33, s23, 12288
buffer_store_dwordx4 v[48:51], v0, s[4:7], s33 offen offset:0
buffer_store_dwordx4 v[52:55], v0, s[4:7], s33 offen offset:1024
s_add_u32 s33, s43, 24576
buffer_store_dwordx4 v[56:59], v0, s[4:7], s33 offen offset:0
buffer_store_dwordx4 v[60:63], v0, s[4:7], s33 offen offset:1024
s_xor_b32 s33, s16, 2
s_lshl_b32 s33, s33, 5
s_lshl_b32 s34, s15, 7
s_add_u32 s33, s33, s34
s_add_u32 s33, s33, 0
s_mul_i32 s33, s33, 1280
s_lshl_b32 s34, s16, 6
s_add_u32 s33, s33, s34
s_add_u32 s33, s33, 1024
s_add_u32 m0, s36, 12288
s_nop 0
buffer_load_dwordx4 v9, s[84:87], s33 offen lds
s_xor_b32 s33, s16, 2
s_lshl_b32 s33, s33, 5
s_lshl_b32 s34, s15, 7
s_add_u32 s33, s33, s34
s_add_u32 s33, s33, 16
s_mul_i32 s33, s33, 1280
s_lshl_b32 s34, s16, 6
s_add_u32 s33, s33, s34
s_add_u32 s33, s33, 1024
s_add_u32 m0, s36, 13312
s_nop 0
buffer_load_dwordx4 v9, s[84:87], s33 offen lds
s_xor_b32 s33, s16, 3
s_lshl_b32 s33, s33, 5
s_lshl_b32 s34, s15, 7
s_add_u32 s33, s33, s34
s_add_u32 s33, s33, 0
s_mul_i32 s33, s33, 1280
s_lshl_b32 s34, s16, 6
s_add_u32 s33, s33, s34
s_add_u32 s33, s33, 1024
s_add_u32 m0, s36, 14336
s_nop 0
buffer_load_dwordx4 v9, s[84:87], s33 offen lds
s_xor_b32 s33, s16, 3
s_lshl_b32 s33, s33, 5
s_lshl_b32 s34, s15, 7
s_add_u32 s33, s33, s34
s_add_u32 s33, s33, 16
s_mul_i32 s33, s33, 1280
s_lshl_b32 s34, s16, 6
s_add_u32 s33, s33, s34
s_add_u32 s33, s33, 1024
s_add_u32 m0, s36, 15360
s_nop 0
buffer_load_dwordx4 v9, s[84:87], s33 offen lds
s_waitcnt vmcnt(40)
ds_read_b64_tr_b16 v[72:73], v11 offset:16384
ds_read_b64_tr_b16 v[74:75], v11 offset:16512
ds_read_b64_tr_b16 v[76:77], v11 offset:17408
ds_read_b64_tr_b16 v[78:79], v11 offset:17536
ds_read_b64_tr_b16 v[184:185], v11 offset:18432
ds_read_b64_tr_b16 v[186:187], v11 offset:18560
ds_read_b64_tr_b16 v[188:189], v11 offset:19456
ds_read_b64_tr_b16 v[190:191], v11 offset:19584
s_waitcnt lgkmcnt(0)
s_add_u32 s33, s43, 26624
buffer_store_dwordx4 v[72:75], v0, s[4:7], s33 offen offset:0
buffer_store_dwordx4 v[76:79], v0, s[4:7], s33 offen offset:1024
s_waitcnt vmcnt(36)
ds_read_b64_tr_b16 v[80:81], v11 offset:20480
ds_read_b64_tr_b16 v[82:83], v11 offset:20608
ds_read_b64_tr_b16 v[84:85], v11 offset:21504
ds_read_b64_tr_b16 v[86:87], v11 offset:21632
ds_read_b64_tr_b16 v[192:193], v11 offset:22528
ds_read_b64_tr_b16 v[194:195], v11 offset:22656
ds_read_b64_tr_b16 v[196:197], v11 offset:23552
ds_read_b64_tr_b16 v[198:199], v11 offset:23680
s_waitcnt lgkmcnt(0)
s_add_u32 s33, s23, 14336
buffer_store_dwordx4 v[80:83], v0, s[4:7], s33 offen offset:0
buffer_store_dwordx4 v[84:87], v0, s[4:7], s33 offen offset:1024
s_waitcnt vmcnt(34)
ds_read_b64_tr_b16 v[48:49], v11 offset:24576
ds_read_b64_tr_b16 v[50:51], v11 offset:24704
ds_read_b64_tr_b16 v[52:53], v11 offset:25600
ds_read_b64_tr_b16 v[54:55], v11 offset:25728
ds_read_b64_tr_b16 v[200:201], v11 offset:26624
ds_read_b64_tr_b16 v[202:203], v11 offset:26752
ds_read_b64_tr_b16 v[204:205], v11 offset:27648
ds_read_b64_tr_b16 v[206:207], v11 offset:27776
s_waitcnt lgkmcnt(0)
s_add_u32 s33, s43, 28672
buffer_store_dwordx4 v[48:51], v0, s[4:7], s33 offen offset:0
buffer_store_dwordx4 v[52:55], v0, s[4:7], s33 offen offset:1024
s_waitcnt vmcnt(30)
ds_read_b64_tr_b16 v[168:169], v11 offset:28672
ds_read_b64_tr_b16 v[170:171], v11 offset:28800
ds_read_b64_tr_b16 v[172:173], v11 offset:29696
ds_read_b64_tr_b16 v[174:175], v11 offset:29824
ds_read_b64_tr_b16 v[56:57], v11 offset:30720
ds_read_b64_tr_b16 v[58:59], v11 offset:30848
ds_read_b64_tr_b16 v[60:61], v11 offset:31744
ds_read_b64_tr_b16 v[62:63], v11 offset:31872
s_waitcnt lgkmcnt(0)
s_add_u32 s33, s43, 30720
buffer_store_dwordx4 v[56:59], v0, s[4:7], s33 offen offset:0
buffer_store_dwordx4 v[60:63], v0, s[4:7], s33 offen offset:1024
s_waitcnt vmcnt(28)
ds_read_b64_tr_b16 v[72:73], v11 offset:32768
ds_read_b64_tr_b16 v[74:75], v11 offset:32896
ds_read_b64_tr_b16 v[76:77], v11 offset:33792
ds_read_b64_tr_b16 v[78:79], v11 offset:33920
ds_read_b64_tr_b16 v[208:209], v11 offset:34816
ds_read_b64_tr_b16 v[210:211], v11 offset:34944
ds_read_b64_tr_b16 v[212:213], v11 offset:35840
ds_read_b64_tr_b16 v[214:215], v11 offset:35968
s_waitcnt lgkmcnt(0)
s_add_u32 s33, s43, 32768
buffer_store_dwordx4 v[72:75], v0, s[4:7], s33 offen offset:0
buffer_store_dwordx4 v[76:79], v0, s[4:7], s33 offen offset:1024
s_waitcnt vmcnt(26)
ds_read_b64_tr_b16 v[176:177], v11 offset:0
ds_read_b64_tr_b16 v[178:179], v11 offset:128
ds_read_b64_tr_b16 v[180:181], v11 offset:1024
ds_read_b64_tr_b16 v[182:183], v11 offset:1152
ds_read_b64_tr_b16 v[216:217], v11 offset:2048
ds_read_b64_tr_b16 v[218:219], v11 offset:2176
ds_read_b64_tr_b16 v[220:221], v11 offset:3072
ds_read_b64_tr_b16 v[222:223], v11 offset:3200
s_waitcnt lgkmcnt(0)
s_waitcnt vmcnt(22)
ds_read_b64_tr_b16 v[80:81], v11 offset:4096
ds_read_b64_tr_b16 v[82:83], v11 offset:4224
ds_read_b64_tr_b16 v[84:85], v11 offset:5120
ds_read_b64_tr_b16 v[86:87], v11 offset:5248
ds_read_b64_tr_b16 v[224:225], v11 offset:6144
ds_read_b64_tr_b16 v[226:227], v11 offset:6272
ds_read_b64_tr_b16 v[228:229], v11 offset:7168
ds_read_b64_tr_b16 v[230:231], v11 offset:7296
s_waitcnt lgkmcnt(0)
s_add_u32 s33, s43, 34816
buffer_store_dwordx4 v[80:83], v0, s[4:7], s33 offen offset:0
buffer_store_dwordx4 v[84:87], v0, s[4:7], s33 offen offset:1024
s_waitcnt vmcnt(20)
ds_read_b64_tr_b16 v[48:49], v11 offset:8192
ds_read_b64_tr_b16 v[50:51], v11 offset:8320
ds_read_b64_tr_b16 v[52:53], v11 offset:9216
ds_read_b64_tr_b16 v[54:55], v11 offset:9344
ds_read_b64_tr_b16 v[232:233], v11 offset:10240
ds_read_b64_tr_b16 v[234:235], v11 offset:10368
ds_read_b64_tr_b16 v[236:237], v11 offset:11264
ds_read_b64_tr_b16 v[238:239], v11 offset:11392
s_waitcnt lgkmcnt(0)
s_add_u32 s33, s23, 16384
buffer_store_dwordx4 v[48:51], v0, s[4:7], s33 offen offset:0
buffer_store_dwordx4 v[52:55], v0, s[4:7], s33 offen offset:1024
s_waitcnt vmcnt(14)
ds_read_b64_tr_b16 v[240:241], v11 offset:12288
ds_read_b64_tr_b16 v[242:243], v11 offset:12416
ds_read_b64_tr_b16 v[244:245], v11 offset:13312
ds_read_b64_tr_b16 v[246:247], v11 offset:13440
ds_read_b64_tr_b16 v[248:249], v11 offset:14336
ds_read_b64_tr_b16 v[250:251], v11 offset:14464
ds_read_b64_tr_b16 v[252:253], v11 offset:15360
ds_read_b64_tr_b16 v[254:255], v11 offset:15488
s_waitcnt lgkmcnt(0)
s_waitcnt vmcnt(0)
s_add_u32 m0, s36, 0
s_add_u32 s33, s43, 0
buffer_load_dwordx4 v0, s[4:7], s33 offen sc1 lds
s_add_u32 m0, s36, 1024
s_add_u32 s33, s43, 1024
buffer_load_dwordx4 v0, s[4:7], s33 offen sc1 lds
s_add_u32 m0, s36, 2048
s_add_u32 s33, s43, 2048
buffer_load_dwordx4 v0, s[4:7], s33 offen sc1 lds
s_add_u32 m0, s36, 3072
s_add_u32 s33, s43, 3072
buffer_load_dwordx4 v0, s[4:7], s33 offen sc1 lds
s_add_u32 m0, s36, 4096
s_add_u32 s33, s43, 4096
buffer_load_dwordx4 v0, s[4:7], s33 offen sc1 lds
s_add_u32 m0, s36, 5120
s_add_u32 s33, s43, 5120
buffer_load_dwordx4 v0, s[4:7], s33 offen sc1 lds
s_add_u32 m0, s36, 6144
s_add_u32 s33, s43, 6144
buffer_load_dwordx4 v0, s[4:7], s33 offen sc1 lds
s_add_u32 m0, s36, 7168
s_add_u32 s33, s43, 7168
buffer_load_dwordx4 v0, s[4:7], s33 offen sc1 lds
s_add_u32 m0, s36, 8192
s_add_u32 s33, s43, 8192
buffer_load_dwordx4 v0, s[4:7], s33 offen sc1 lds
s_add_u32 m0, s36, 9216
s_add_u32 s33, s43, 9216
buffer_load_dwordx4 v0, s[4:7], s33 offen sc1 lds
s_add_u32 m0, s36, 10240
s_add_u32 s33, s43, 10240
buffer_load_dwordx4 v0, s[4:7], s33 offen sc1 lds
s_add_u32 m0, s36, 11264
s_add_u32 s33, s43, 11264
buffer_load_dwordx4 v0, s[4:7], s33 offen sc1 lds
s_add_u32 m0, s36, 12288
s_add_u32 s33, s43, 12288
buffer_load_dwordx4 v0, s[4:7], s33 offen sc1 lds
s_add_u32 m0, s36, 13312
s_add_u32 s33, s43, 13312
buffer_load_dwordx4 v0, s[4:7], s33 offen sc1 lds
s_add_u32 m0, s36, 14336
s_add_u32 s33, s43, 14336
buffer_load_dwordx4 v0, s[4:7], s33 offen sc1 lds
s_add_u32 m0, s36, 15360
s_add_u32 s33, s43, 15360
buffer_load_dwordx4 v0, s[4:7], s33 offen sc1 lds
s_add_u32 m0, s36, 16384
s_add_u32 s33, s43, 16384
buffer_load_dwordx4 v0, s[4:7], s33 offen sc1 lds
s_add_u32 m0, s36, 17408
s_add_u32 s33, s43, 17408
buffer_load_dwordx4 v0, s[4:7], s33 offen sc1 lds
s_add_u32 m0, s36, 18432
s_add_u32 s33, s43, 18432
buffer_load_dwordx4 v0, s[4:7], s33 offen sc1 lds
s_add_u32 m0, s36, 19456
s_add_u32 s33, s43, 19456
buffer_load_dwordx4 v0, s[4:7], s33 offen sc1 lds
s_add_u32 m0, s36, 20480
s_add_u32 s33, s43, 20480
buffer_load_dwordx4 v0, s[4:7], s33 offen sc1 lds
s_add_u32 m0, s36, 21504
s_add_u32 s33, s43, 21504
buffer_load_dwordx4 v0, s[4:7], s33 offen sc1 lds
s_add_u32 m0, s36, 22528
s_add_u32 s33, s43, 22528
buffer_load_dwordx4 v0, s[4:7], s33 offen sc1 lds
s_add_u32 m0, s36, 23552
s_add_u32 s33, s43, 23552
buffer_load_dwordx4 v0, s[4:7], s33 offen sc1 lds
s_add_u32 m0, s36, 24576
s_add_u32 s33, s43, 24576
buffer_load_dwordx4 v0, s[4:7], s33 offen sc1 lds
s_add_u32 m0, s36, 25600
s_add_u32 s33, s43, 25600
buffer_load_dwordx4 v0, s[4:7], s33 offen sc1 lds
s_add_u32 m0, s36, 26624
s_add_u32 s33, s43, 26624
buffer_load_dwordx4 v0, s[4:7], s33 offen sc1 lds
s_add_u32 m0, s36, 27648
s_add_u32 s33, s43, 27648
buffer_load_dwordx4 v0, s[4:7], s33 offen sc1 lds
s_add_u32 m0, s36, 28672
s_add_u32 s33, s43, 28672
buffer_load_dwordx4 v0, s[4:7], s33 offen sc1 lds
s_add_u32 m0, s36, 29696
s_add_u32 s33, s43, 29696
buffer_load_dwordx4 v0, s[4:7], s33 offen sc1 lds
s_add_u32 m0, s36, 30720
s_add_u32 s33, s43, 30720
buffer_load_dwordx4 v0, s[4:7], s33 offen sc1 lds
s_add_u32 m0, s36, 31744
s_add_u32 s33, s43, 31744
buffer_load_dwordx4 v0, s[4:7], s33 offen sc1 lds
s_add_u32 m0, s36, 32768
s_add_u32 s33, s43, 32768
buffer_load_dwordx4 v0, s[4:7], s33 offen sc1 lds
s_add_u32 m0, s36, 33792
s_add_u32 s33, s43, 33792
buffer_load_dwordx4 v0, s[4:7], s33 offen sc1 lds
s_add_u32 m0, s36, 34816
s_add_u32 s33, s43, 34816
buffer_load_dwordx4 v0, s[4:7], s33 offen sc1 lds
s_add_u32 m0, s36, 35840
s_add_u32 s33, s43, 35840
buffer_load_dwordx4 v0, s[4:7], s33 offen sc1 lds
s_waitcnt vmcnt(0)
s_barrier
s_cmp_lg_u32 s16, 0
s_cbranch_scc1 cb_65
v_mov_b32 v67, 32
v_mov_b32 v68, 1
s_mov_b64 exec, 1
buffer_atomic_add v68, v67, s[8:11], 0 offen
s_mov_b32 s37, 0
cb_64:
buffer_load_dword v68, v67, s[8:11], 0 offen sc1
s_add_u32 s37, s37, 1
s_cmp_gt_u32 s37, 262144
s_cbranch_scc1 L_fail
s_waitcnt vmcnt(0)
v_cmp_gt_u32 vcc, 32, v68
s_cbranch_vccnz cb_64
s_mov_b64 exec, -1
cb_65:
s_barrier
s_mov_b32 s18, 0
s_mov_b32 s45, 0
s_cmp_eq_u32 s16, 1
s_cbranch_scc1 wave_67
s_cmp_eq_u32 s16, 2
s_cbranch_scc1 wave_68
s_cmp_eq_u32 s16, 3
s_cbranch_scc1 wave_69
wave_66:
layer_70:
s_lshl_b32 s17, s45, 6
s_mul_i32 s34, s45, 34603008
s_lshl_b32 s35, s15, 14
s_add_u32 s34, s34, s35
s_add_u32 s24, s34, 16777216
s_mul_i32 s34, s17, 10240
s_add_u32 s34, s34, s30
s_add_u32 s25, s34, s31
s_mov_b32 s19, 0
s_add_u32 s43, s17, 2
s_add_u32 s38, s17, 63
s_add_u32 s39, s17, 64
s_add_u32 s34, s24, 524288
v_mov_b32 v7, 0
s_mov_b32 s20, 409600
s_mov_b32 s21, 413696
s_mov_b32 s22, 417792
v_cmp_gt_u32 vcc, s43, v7
s_cmp_eq_u32 vcc_hi, 0
s_cbranch_scc1 kv_77
s_mov_b32 s37, 0
kv_76:
v_bfe_u32 v7, v0, 2, 3
buffer_load_dword v7, v7, s[4:7], s28 offen sc1
s_add_u32 s37, s37, 1
s_cmp_gt_u32 s37, 262144
s_cbranch_scc1 L_fail
s_waitcnt vmcnt(0)
v_cmp_gt_u32 vcc, s43, v7
s_cbranch_vccnz kv_76
kv_77:
buffer_load_dwordx4 v[64:67], v0, s[4:7], s65 offen offset:0 sc1
buffer_load_dwordx4 v[68:71], v0, s[4:7], s65 offen offset:1024 sc1
buffer_load_dwordx4 v[72:75], v0, s[4:7], s65 offen offset:2048 sc1
buffer_load_dwordx4 v[76:79], v0, s[4:7], s65 offen offset:3072 sc1
ds_read_b128 v[80:83], v2 offset:0
ds_read_b128 v[84:87], v2 offset:1024
buffer_load_dwordx4 v[48:51], v0, s[4:7], s66 offen offset:0 sc1
buffer_load_dwordx4 v[52:55], v0, s[4:7], s66 offen offset:1024 sc1
buffer_load_dwordx4 v[56:59], v0, s[4:7], s66 offen offset:2048 sc1
buffer_load_dwordx4 v[60:63], v0, s[4:7], s66 offen offset:3072 sc1
v_mov_b64 v[8:9], 0
v_mov_b64 v[10:11], 0
v_mov_b64 v[12:13], 0
v_mov_b64 v[14:15], 0
v_mov_b64 v[16:17], 0
v_mov_b64 v[18:19], 0
v_mov_b64 v[20:21], 0
v_mov_b64 v[22:23], 0
v_mov_b64 v[24:25], 0
v_mov_b64 v[26:27], 0
v_mov_b64 v[28:29], 0
v_mov_b64 v[30:31], 0
v_bfe_u32 v7, v0, 2, 3
v_add_u32 v7, s28, v7
s_mov_b32 exec_hi, 0
v_and_b32 v7, 255, v0
v_lshl_add_u32 v7, v7, 3, s34
s_mov_b32 exec_hi, -1
s_mov_b32 s37, 0
gather_71:
buffer_load_dwordx4 v[32:35], v0, s[4:7], s20 offen sc1
buffer_load_dwordx4 v[36:39], v0, s[4:7], s21 offen sc1
buffer_load_dwordx4 v[40:43], v0, s[4:7], s22 offen sc1
s_add_u32 s37, s37, 1
s_cmp_gt_u32 s37, 262144
s_cbranch_scc1 L_fail
s_waitcnt vmcnt(2)
v_bitop3_b32 v44, v32, v34, s18 bitop3:0x7e
s_waitcnt vmcnt(1)
v_bitop3_b32 v45, v36, v38, s18 bitop3:0x7e
v_or_b32 v44, v44, v45
s_waitcnt vmcnt(0)
v_bitop3_b32 v46, v40, v42, s18 bitop3:0x7e
v_bitop3_b32 v44, v44, v46, s19 bitop3:0xa8
v_cmp_ne_u32 vcc, 0, v44
s_cbranch_vccnz gather_71
v_smfmac_f32_16x16x64_bf16 v[8:11], v[32:35], v[64:71], v1
ds_write_b128 v0, v[32:35] offset:0
buffer_load_dwordx4 v[64:67], v0, s[4:7], s67 offen offset:0 sc1
v_smfmac_f32_16x16x64_bf16 v[12:15], v[32:35], v[72:79], v1
ds_write_b128 v0, v[36:39] offset:4096
v_smfmac_f32_16x16x64_bf16 v[20:23], v[32:35], v[56:63], v1
buffer_load_dwordx4 v[68:71], v0, s[4:7], s67 offen offset:1024 sc1
s_waitcnt lgkmcnt(2)
v_smfmac_f32_16x16x64_bf16 v[24:27], v[32:35], v[80:87], v1
ds_write_b128 v0, v[40:43] offset:8192
v_smfmac_f32_16x16x64_bf16 v[8:11], v[36:39], a[8:15], v1
ds_read_b128 v[80:83], v2 offset:2048
buffer_load_dwordx4 v[72:75], v0, s[4:7], s67 offen offset:2048 sc1
v_smfmac_f32_16x16x64_bf16 v[16:19], v[32:35], v[48:55], v1
s_waitcnt lgkmcnt(1)
ds_read_b128 v[84:87], v2 offset:3072
buffer_load_dwordx4 v[76:79], v0, s[4:7], s67 offen offset:3072 sc1
v_smfmac_f32_16x16x64_bf16 v[16:19], v[36:39], a[24:31], v1
buffer_load_dwordx4 v[48:51], v0, s[4:7], s24 offen offset:0 nt sc1
buffer_load_dwordx4 v[52:55], v0, s[4:7], s24 offen offset:1024 nt sc1
v_smfmac_f32_16x16x64_bf16 v[28:31], v[32:35], a[0:7], v1
s_barrier
ds_read_b128 v[40:43], v0 offset:1024
v_smfmac_f32_16x16x64_bf16 v[28:31], v[36:39], a[40:47], v1
s_waitcnt lgkmcnt(1)
ds_read_b128 v[44:47], v0 offset:5120
ds_read_b128 v[32:35], v0 offset:2048
v_smfmac_f32_16x16x64_bf16 v[24:27], v[36:39], v[80:87], v1
v_smfmac_f32_16x16x64_bf16 v[12:15], v[36:39], a[16:23], v1
ds_read_b128 v[84:87], v2 offset:5120
ds_read_b128 v[80:83], v2 offset:4096
v_smfmac_f32_16x16x64_bf16 v[20:23], v[36:39], a[32:39], v1
ds_read_b128 v[36:39], v0 offset:6144
s_waitcnt lgkmcnt(5)
v_smfmac_f32_16x16x64_bf16 v[8:11], v[40:43], a[48:55], v1
buffer_load_dwordx4 v[56:59], v0, s[4:7], s24 offen offset:2048 nt sc1
v_smfmac_f32_16x16x64_bf16 v[12:15], v[40:43], a[56:63], v1
s_waitcnt lgkmcnt(4)
ds_read_b128 v[40:43], v0 offset:3072
s_xor_b32 s18, s18, 1
v_smfmac_f32_16x16x64_bf16 v[12:15], v[44:47], a[72:79], v1
s_waitcnt lgkmcnt(4)
buffer_load_dwordx4 v[60:63], v0, s[4:7], s24 offen offset:3072 nt sc1
v_smfmac_f32_16x16x64_bf16 v[8:11], v[44:47], a[64:71], v1
s_waitcnt lgkmcnt(3)
s_waitcnt lgkmcnt(2)
v_smfmac_f32_16x16x64_bf16 v[8:11], v[32:35], v[80:87], v1
s_waitcnt vmcnt(7)
ds_read_b128 v[84:87], v2 offset:7168
s_add_u32 s24, s24, 524288
v_smfmac_f32_16x16x64_bf16 v[12:15], v[32:35], a[80:87], v1
ds_read_b128 v[32:35], v0 offset:7168
s_waitcnt lgkmcnt(2)
v_smfmac_f32_16x16x64_bf16 v[8:11], v[36:39], a[88:95], v1
ds_read_b128 v[80:83], v2 offset:6144
v_smfmac_f32_16x16x64_bf16 v[12:15], v[36:39], a[96:103], v1
s_waitcnt vmcnt(6)
ds_read_b128 v[36:39], v0 offset:8192
v_smfmac_f32_16x16x64_bf16 v[8:11], v[40:43], v[64:71], v1
ds_read_b128 v[64:67], v2 offset:8192
ds_read_b128 v[68:71], v2 offset:9216
v_smfmac_f32_16x16x64_bf16 v[12:15], v[40:43], a[104:111], v1
ds_read_b128 v[40:43], v0 offset:9216
s_waitcnt lgkmcnt(5)
v_smfmac_f32_16x16x64_bf16 v[12:15], v[32:35], a[112:119], v1
s_waitcnt lgkmcnt(4)
buffer_load_dword v7, v7, s[4:7], 0 offen sc1
v_smfmac_f32_16x16x64_bf16 v[8:11], v[32:35], v[80:87], v1
s_waitcnt lgkmcnt(3)
ds_read_b128 v[32:35], v0 offset:1024
ds_read_b128 v[84:87], v2 offset:11264
v_smfmac_f32_16x16x64_bf16 v[8:11], v[36:39], a[120:127], v1
ds_read_b128 v[80:83], v2 offset:10240
v_smfmac_f32_16x16x64_bf16 v[12:15], v[36:39], a[128:135], v1
s_waitcnt lgkmcnt(4)
ds_read_b128 v[36:39], v0 offset:5120
s_waitcnt lgkmcnt(4)
v_smfmac_f32_16x16x64_bf16 v[8:11], v[40:43], v[64:71], v1
s_waitcnt vmcnt(5)
ds_read_b128 v[64:67], v2 offset:12288
ds_read_b128 v[68:71], v2 offset:13312
v_smfmac_f32_16x16x64_bf16 v[12:15], v[40:43], a[136:143], v1
s_waitcnt lgkmcnt(5)
ds_read_b128 v[40:43], v0 offset:2048
v_smfmac_f32_16x16x64_bf16 v[16:19], v[32:35], v[72:79], v1
s_nop 0
ds_read_b128 v[72:75], v2 offset:14336
v_add_f32 v9, v9, v11
v_add_f32 v8, v8, v10
s_nop 0
v_add_f32 v13, v13, v15
v_add_f32 v12, v12, v14
v_mul_f32 v9, s44, v9
s_waitcnt lgkmcnt(4)
v_mul_f32 v8, s44, v8
v_mul_f32 v12, s44, v12
v_mul_f32 v13, s44, v13
v_cvt_pk_bf16_f32 v12, v12, v13
v_cvt_pk_bf16_f32 v8, v8, v9
v_smfmac_f32_16x16x64_bf16 v[20:23], v[32:35], v[80:87], v1
s_add_u32 s17, s17, 1
ds_read_b128 v[32:35], v0 offset:6144
ds_write2_b32 v3, v8, v12 offset0:0 offset1:128
v_smfmac_f32_16x16x64_bf16 v[16:19], v[36:39], a[144:151], v1
ds_read_b128 v[80:83], v2 offset:16384
v_smfmac_f32_16x16x64_bf16 v[20:23], v[36:39], a[152:159], v1
ds_read_b128 v[36:39], v0 offset:3072
ds_read_b128 v[76:79], v2 offset:15360
s_waitcnt vmcnt(3)
s_waitcnt lgkmcnt(4)
v_smfmac_f32_16x16x64_bf16 v[16:19], v[40:43], a[160:167], v1
ds_read_b128 v[84:87], v2 offset:17408
v_smfmac_f32_16x16x64_bf16 v[20:23], v[40:43], v[64:71], v1
s_waitcnt lgkmcnt(4)
ds_read_b128 v[40:43], v0 offset:7168
ds_read_b128 v[64:67], v2 offset:18432
v_smfmac_f32_16x16x64_bf16 v[16:19], v[32:35], a[168:175], v1
s_barrier
v_smfmac_f32_16x16x64_bf16 v[20:23], v[32:35], a[176:183], v1
s_waitcnt lgkmcnt(3)
ds_read_b128 v[32:35], v0 offset:8192
ds_read_b64_tr_b16 v[12:13], v4 offset:1024
v_smfmac_f32_16x16x64_bf16 v[16:19], v[36:39], a[184:191], v1
ds_read_b64_tr_b16 v[10:11], v4 offset:512
v_smfmac_f32_16x16x64_bf16 v[20:23], v[36:39], v[72:79], v1
s_waitcnt lgkmcnt(4)
ds_read_b128 v[36:39], v0 offset:9216
ds_read_b64_tr_b16 v[8:9], v4 offset:0
v_smfmac_f32_16x16x64_bf16 v[16:19], v[40:43], a[192:199], v1
ds_read_b64_tr_b16 v[14:15], v4 offset:1536
ds_read_b128 v[76:79], v2 offset:21504
v_smfmac_f32_16x16x64_bf16 v[20:23], v[40:43], a[200:207], v1
ds_read_b128 v[40:43], v0 offset:1024
s_waitcnt lgkmcnt(7)
v_smfmac_f32_16x16x64_bf16 v[20:23], v[32:35], v[80:87], v1
ds_read_b128 v[68:71], v2 offset:19456
ds_read_b128 v[84:87], v2 offset:23552
v_smfmac_f32_16x16x64_bf16 v[16:19], v[32:35], a[208:215], v1
s_waitcnt lgkmcnt(6)
ds_read_b128 v[72:75], v2 offset:20480
v_smfmac_f32_16x16x64_bf16 v[20:23], v[36:39], a[224:231], v1
s_waitcnt lgkmcnt(6)
ds_read_b128 v[32:35], v0 offset:5120
ds_read_b128 v[80:83], v2 offset:22528
v_smfmac_f32_16x16x64_bf16 v[16:19], v[36:39], a[216:223], v1
ds_read_b128 v[36:39], v0 offset:2048
s_waitcnt lgkmcnt(7)
v_mfma_f32_16x16x32_bf16 v[44:47], v[48:51], v[8:11], 0
s_nop 0
v_add_f32 v20, v20, v22
v_add_f32 v21, v21, v23
v_mfma_f32_16x16x32_bf16 v[44:47], v[52:55], v[12:15], v[44:47]
s_nop 0
v_add_f32 v17, v17, v19
v_add_f32 v16, v16, v18
s_waitcnt lgkmcnt(5)
v_cvt_pk_bf16_f32 v20, v20, v21
v_smfmac_f32_16x16x64_bf16 v[28:31], v[40:43], a[232:239], v1
s_mov_b64 exec, s[54:55]
s_nop 0
ds_write_b128 v5, v[44:47] offset:0
s_mov_b64 exec, -1
v_smfmac_f32_16x16x64_bf16 v[24:27], v[40:43], v[64:71], v1
s_waitcnt lgkmcnt(3)
ds_read_b128 v[40:43], v0 offset:6144
v_cvt_pk_bf16_f32 v16, v16, v17
v_smfmac_f32_16x16x64_bf16 v[24:27], v[32:35], a[240:247], v1
ds_write2_b32 v3, v16, v20 offset0:1 offset1:129
v_smfmac_f32_16x16x64_bf16 v[28:31], v[32:35], v[72:79], v1
s_waitcnt lgkmcnt(3)
ds_read_b128 v[32:35], v0 offset:3072
buffer_load_dwordx4 v[64:67], v0, s[4:7], s68 offen offset:0 sc1
v_smfmac_f32_16x16x64_bf16 v[24:27], v[36:39], a[248:255], v1
buffer_load_dwordx4 v[68:71], v0, s[4:7], s68 offen offset:1024 sc1
v_smfmac_f32_16x16x64_bf16 v[28:31], v[36:39], v[88:95], v1
ds_read_b128 v[36:39], v0 offset:7168
s_waitcnt lgkmcnt(3)
v_smfmac_f32_16x16x64_bf16 v[24:27], v[40:43], v[96:103], v1
s_mov_b32 s20, 393216
buffer_load_dwordx4 v[72:75], v0, s[4:7], s68 offen offset:2048 sc1
v_smfmac_f32_16x16x64_bf16 v[28:31], v[40:43], v[80:87], v1
s_waitcnt lgkmcnt(2)
ds_read_b128 v[40:43], v0 offset:8192
s_waitcnt lgkmcnt(2)
v_smfmac_f32_16x16x64_bf16 v[28:31], v[32:35], v[112:119], v1
s_barrier
ds_read_b128 v[52:55], v6 offset:1024
v_smfmac_f32_16x16x64_bf16 v[24:27], v[32:35], v[104:111], v1
s_waitcnt lgkmcnt(2)
ds_read_b128 v[32:35], v0 offset:9216
ds_read_b128 v[48:51], v6 offset:0
v_smfmac_f32_16x16x64_bf16 v[24:27], v[36:39], v[120:127], v1
ds_read_b64_tr_b16 v[8:9], v4 offset:0
ds_read_b64_tr_b16 v[10:11], v4 offset:512
v_smfmac_f32_16x16x64_bf16 v[28:31], v[36:39], v[128:135], v1
s_waitcnt lgkmcnt(5)
buffer_load_dwordx4 v[76:79], v0, s[4:7], s68 offen offset:3072 sc1
v_smfmac_f32_16x16x64_bf16 v[28:31], v[40:43], v[144:151], v1
buffer_load_dwordx4 v[80:83], v0, s[4:7], s69 offen offset:0 sc1
ds_read_b64_tr_b16 v[20:21], v4 offset:3072
ds_read_b64_tr_b16 v[18:19], v4 offset:2560
v_smfmac_f32_16x16x64_bf16 v[24:27], v[40:43], v[136:143], v1
s_waitcnt lgkmcnt(5)
ds_read_b64_tr_b16 v[12:13], v4 offset:1024
ds_read_b64_tr_b16 v[14:15], v4 offset:1536
v_smfmac_f32_16x16x64_bf16 v[28:31], v[32:35], v[160:167], v1
s_waitcnt lgkmcnt(6)
ds_read_b64_tr_b16 v[16:17], v4 offset:2048
v_add_f32 v48, v48, v52
v_smfmac_f32_16x16x64_bf16 v[24:27], v[32:35], v[152:159], v1
s_waitcnt lgkmcnt(5)
ds_read_b64_tr_b16 v[22:23], v4 offset:3584
v_add_f32 v51, v51, v55
v_exp_f32 v48, v48
v_add_f32 v50, v50, v54
v_exp_f32 v51, v51
v_exp_f32 v50, v50
v_mfma_f32_16x16x32_bf16 v[44:47], v[8:11], v[8:11], 0
s_waitcnt lgkmcnt(1)
v_cvt_pk_bf16_f32 v55, v50, v51
v_add_f32 v49, v49, v53
v_mfma_f32_16x16x32_bf16 v[44:47], v[12:15], v[12:15], v[44:47]
s_waitcnt vmcnt(6)
v_exp_f32 v49, v49
v_mfma_f32_16x16x32_bf16 v[44:47], v[16:19], v[16:19], v[44:47]
s_waitcnt lgkmcnt(0)
v_cvt_pk_bf16_f32 v54, v48, v49
v_mov_b32_dpp v51, v55 quad_perm:[2,3,2,3] row_mask:0xf bank_mask:0xf
v_mfma_f32_16x16x32_bf16 v[44:47], v[20:23], v[20:23], v[44:47]
v_mov_b32_dpp v50, v54 quad_perm:[2,3,2,3] row_mask:0xf bank_mask:0xf
v_mov_b32_dpp v48, v54 quad_perm:[0,1,0,1] row_mask:0xf bank_mask:0xf
v_mov_b32_dpp v49, v55 quad_perm:[0,1,0,1] row_mask:0xf bank_mask:0xf
v_mov_b64 v[22:23], s[56:57]
v_mov_b64 v[54:55], s[58:59]
v_mfma_f32_16x16x32_bf16 v[12:15], v[60:63], v[48:51], 0
s_nop 0
v_mov_b64 v[20:21], s[56:57]
v_exp_f32_dpp v44, v46 quad_perm:[0,1,0,1] row_mask:0xf bank_mask:0xf
v_mfma_f32_16x16x32_bf16 v[8:11], v[56:59], v[48:51], 0
v_exp_f32_dpp v45, v47 quad_perm:[0,1,0,1] row_mask:0xf bank_mask:0xf
v_mfma_f32_16x16x32_bf16 v[16:19], v[20:23], v[48:51], 0
s_nop 0
v_cvt_pk_bf16_f32 v53, v44, v45
v_cvt_pk_bf16_f32 v24, v24, v25
v_cvt_pk_bf16_f32 v52, v44, v45
v_cvt_pk_bf16_f32 v25, v26, v27
v_mov_b64 v[38:39], 0
v_mfma_f32_16x16x16_bf16 v[16:19], v[54:55], v[52:53], v[16:19]
s_nop 0
v_cvt_pk_bf16_f32 v27, v30, v31
v_cvt_pk_bf16_f32 v26, v28, v29
v_mfma_f32_16x16x16_bf16 v[8:11], v[24:25], v[52:53], v[8:11]
s_nop 0
buffer_load_dwordx4 v[84:87], v0, s[4:7], s69 offen offset:1024 sc1
v_mfma_f32_16x16x16_bf16 v[12:15], v[26:27], v[52:53], v[12:15]
s_barrier
v_rcp_f32 v18, v16
v_subrev_u32 v17, s46, v16
v_mov_b64 v[40:41], 0
v_mov_b64 v[34:35], 0
v_mul_f32 v8, v8, v18
v_mul_f32 v9, v9, v18
v_cvt_pk_bf16_f32 v8, v8, v9
v_mul_f32 v10, v10, v18
v_mul_f32 v13, v13, v18
v_mul_f32 v11, v11, v18
v_cvt_pk_bf16_f32 v9, v10, v11
v_mul_f32 v12, v12, v18
v_cmp_lt_u32 vcc, s47, v17
v_mul_f32 v14, v14, v18
v_mul_f32 v15, v15, v18
v_cvt_pk_bf16_f32 v11, v14, v15
v_mov_b64 v[32:33], 0
s_waitcnt vmcnt(4)
v_cvt_pk_bf16_f32 v10, v12, v13
s_cbranch_vccnz rare_72
back_73:
s_mov_b64 exec, s[54:55]
ds_write_b128 v5, v[8:11] offset:0
s_mov_b64 exec, -1
v_mov_b64 v[48:49], 0
v_mov_b64 v[50:51], 0
v_smfmac_f32_16x16x64_bf16 v[32:35], v[8:11], v[64:71], v1
s_add_u32 s25, s25, 10240
ds_read_b128 v[16:19], v2 offset:24576
v_mov_b64 v[36:37], 0
v_mov_b64 v[42:43], 0
v_smfmac_f32_16x16x64_bf16 v[48:51], v[8:11], v[176:183], v1
ds_read_b128 v[28:31], v2 offset:27648
buffer_load_dwordx4 v[64:67], v0, s[4:7], s65 offen offset:0 sc1
ds_read_b128 v[24:27], v2 offset:26624
v_smfmac_f32_16x16x64_bf16 v[40:43], v[8:11], v[168:175], v1
ds_read_b128 v[20:23], v2 offset:25600
s_add_u32 s43, s17, 2
s_waitcnt lgkmcnt(4)
s_barrier
ds_read_b128 v[56:59], v5 offset:512
buffer_load_dwordx4 v[68:71], v0, s[4:7], s65 offen offset:1024 sc1
s_waitcnt vmcnt(4)
ds_read_b128 v[12:15], v5 offset:1536
v_smfmac_f32_16x16x64_bf16 v[36:39], v[8:11], v[72:79], v1
s_waitcnt lgkmcnt(5)
ds_read_b128 v[60:63], v5 offset:1024
v_mov_b64 v[54:55], 0
s_waitcnt lgkmcnt(3)
s_mov_b32 s37, 0
s_mov_b32 s19, 1
buffer_load_dwordx4 v[72:75], v0, s[4:7], s65 offen offset:2048 sc1
v_bfe_u32 v45, v0, 1, 7
v_mov_b64 v[52:53], 0
s_waitcnt lgkmcnt(2)
v_smfmac_f32_16x16x64_bf16 v[32:35], v[56:59], v[16:23], v1
buffer_load_dwordx4 v[76:79], v0, s[4:7], s65 offen offset:3072 sc1
ds_read_b128 v[16:19], v2 offset:30720
v_smfmac_f32_16x16x64_bf16 v[48:51], v[56:59], v[216:223], v1
s_waitcnt lgkmcnt(2)
ds_read_b128 v[20:23], v2 offset:31744
v_lshrrev_b32 v44, 8, v0
s_waitcnt vmcnt(5)
s_waitcnt vmcnt(4)
v_smfmac_f32_16x16x64_bf16 v[52:55], v[8:11], v[80:87], v1
s_waitcnt lgkmcnt(2)
ds_read_b128 v[84:87], v2 offset:29696
s_mov_b32 s21, 397312
v_smfmac_f32_16x16x64_bf16 v[32:35], v[60:63], v[24:31], v1
ds_read_b128 v[80:83], v2 offset:28672
s_min_u32 s43, s43, s39
v_smfmac_f32_16x16x64_bf16 v[32:35], v[12:15], v[184:191], v1
s_waitcnt lgkmcnt(3)
ds_read_b128 v[24:27], v2 offset:32768
s_waitcnt lgkmcnt(3)
v_smfmac_f32_16x16x64_bf16 v[40:43], v[56:59], v[16:23], v1
ds_read_b128 v[28:31], v2 offset:33792
v_lshl_or_b32 v44, v44, 12, v45
v_smfmac_f32_16x16x64_bf16 v[36:39], v[56:59], v[192:199], v1
s_waitcnt lgkmcnt(3)
v_cvt_pk_bf16_f32 v32, v32, v33
v_cvt_pk_bf16_f32 v33, v34, v35
v_and_or_b32 v32, v32, -2, s18
s_waitcnt lgkmcnt(2)
v_smfmac_f32_16x16x64_bf16 v[36:39], v[60:63], v[80:87], v1
buffer_store_dwordx2 v[32:33], v44, s[4:7], s60 offen
v_smfmac_f32_16x16x64_bf16 v[36:39], v[12:15], v[200:207], v1
s_waitcnt lgkmcnt(1)
s_waitcnt lgkmcnt(0)
ds_read_b128 v[80:83], v2 offset:34816
v_smfmac_f32_16x16x64_bf16 v[40:43], v[60:63], v[24:31], v1
s_nop 0
ds_read_b128 v[84:87], v2 offset:35840
s_add_u32 s34, s24, 524288
s_nop 0
v_cvt_pk_bf16_f32 v36, v36, v37
v_and_or_b32 v36, v36, -2, s18
v_cvt_pk_bf16_f32 v37, v38, v39
v_smfmac_f32_16x16x64_bf16 v[40:43], v[12:15], v[208:215], v1
buffer_store_dwordx2 v[36:37], v44, s[4:7], s61 offen
v_smfmac_f32_16x16x64_bf16 v[52:55], v[56:59], v[232:239], v1
s_nop 2
v_smfmac_f32_16x16x64_bf16 v[52:55], v[60:63], v[240:247], v1
s_nop 0
s_waitcnt lgkmcnt(0)
v_cvt_pk_bf16_f32 v40, v40, v41
v_cvt_pk_bf16_f32 v41, v42, v43
v_and_or_b32 v40, v40, -2, s18
v_smfmac_f32_16x16x64_bf16 v[48:51], v[60:63], v[80:87], v1
s_mov_b32 s22, 401408
buffer_store_dwordx2 v[40:41], v44, s[4:7], s62 offen
v_smfmac_f32_16x16x64_bf16 v[48:51], v[12:15], v[224:231], v1
s_nop 2
v_smfmac_f32_16x16x64_bf16 v[52:55], v[12:15], v[248:255], v1
s_nop 3
v_cvt_pk_bf16_f32 v48, v48, v49
v_and_or_b32 v48, v48, -2, s18
v_cvt_pk_bf16_f32 v49, v50, v51
buffer_store_dwordx2 v[48:49], v44, s[4:7], s63 offen
v_cvt_pk_bf16_f32 v52, v52, v53
v_cvt_pk_bf16_f32 v53, v54, v55
v_and_or_b32 v52, v52, -2, s18
buffer_store_dwordx2 v[52:53], v44, s[4:7], s64 offen
v_bfe_u32 v34, v0, 6, 1
v_lshlrev_b32 v34, 4, v34
v_mov_b32 v35, 0x3f80
v_lshlrev_b32 v34, v34, v35
v_bfe_i32 v35, v0, 4, 1
v_and_b32 v45, v34, v35
v_and_b32 v47, v34, v35
v_xor_b32 v44, v34, v45
v_xor_b32 v46, v34, v45
v_and_b32 v36, 32, v0
v_bfe_u32 v37, v0, 6, 1
v_lshl_add_u32 v36, v37, 8, v36
v_bfe_u32 v37, v0, 8, 1
v_lshl_add_u32 v36, v37, 4, v36
v_bfe_u32 v37, v0, 4, 1
v_lshl_add_u32 v36, v37, 3, v36
ds_read_b128 v[80:83], v2 offset:0
ds_read_b128 v[84:87], v2 offset:1024
v_mov_b64 v[24:25], 0
v_mov_b64 v[26:27], 0
v_mov_b64 v[28:29], 0
v_mov_b64 v[30:31], 0
v_bfe_u32 v7, v0, 2, 3
v_add_u32 v7, s28, v7
s_mov_b32 exec_hi, 0
v_and_b32 v7, 255, v0
v_lshl_add_u32 v7, v7, 3, s34
s_mov_b32 exec_hi, -1
s_nop 15
s_nop 15
s_nop 14
buffer_load_dwordx4 v[8:11], v0, s[4:7], s27 offen offset:0 sc1
buffer_load_dwordx4 v[12:15], v0, s[4:7], s27 offen offset:1024 sc1
buffer_load_dwordx4 v[16:19], v0, s[4:7], s27 offen offset:2048 sc1
buffer_load_dwordx4 v[20:23], v0, s[4:7], s27 offen offset:3072 sc1
s_barrier
buffer_load_dwordx4 v[48:51], v0, s[4:7], s66 offen offset:0 sc1
buffer_load_dwordx4 v[52:55], v0, s[4:7], s66 offen offset:1024 sc1
buffer_load_dwordx4 v[56:59], v0, s[4:7], s66 offen offset:2048 sc1
buffer_load_dwordx4 v[60:63], v0, s[4:7], s66 offen offset:3072 sc1
v_mov_b64 v[40:41], 0
v_mov_b64 v[42:43], 0
s_waitcnt vmcnt(6)
s_nop 0
v_smfmac_f32_16x16x64_bf16 v[40:43], v[44:47], v[8:15], v1
v_bitop3_b32 v34, v8, v10, s18 bitop3:0x7e
v_bitop3_b32 v35, v12, v14, s18 bitop3:0x7e
s_waitcnt vmcnt(4)
v_smfmac_f32_16x16x64_bf16 v[40:43], v[44:47], v[16:23], v1
v_bitop3_b32 v32, v16, v18, s18 bitop3:0x7e
v_bitop3_b32 v33, v20, v22, s18 bitop3:0x7e
v_or3_b32 v34, v34, v35, v32
v_bitop3_b32 v34, v34, v33, 1 bitop3:0xa8
v_cmp_ne_u32 vcc, 0, v34
s_cbranch_vccnz red_78
red_78_ok:
s_nop 1
v_add_f32_dpp v40, v40, v40 row_ror:8 row_mask:0xf bank_mask:0xf
v_add_f32_dpp v41, v41, v41 row_ror:8 row_mask:0xf bank_mask:0xf
v_add_f32_dpp v42, v42, v42 row_ror:8 row_mask:0xf bank_mask:0xf
v_add_f32_dpp v43, v43, v43 row_ror:8 row_mask:0xf bank_mask:0xf
v_cvt_pk_bf16_f32 v40, v40, v41
v_cvt_pk_bf16_f32 v41, v42, v43
v_and_or_b32 v40, v40, -2, s18
s_mov_b64 exec, 0x00ff00ff
buffer_store_dwordx2 v[40:41], v36, s[4:7], s40 offen
s_mov_b64 exec, -1
g2_80:
v_mov_b64 v[8:9], 0
v_mov_b64 v[10:11], 0
v_mov_b64 v[12:13], 0
v_mov_b64 v[14:15], 0
v_mov_b64 v[16:17], 0
v_mov_b64 v[18:19], 0
v_mov_b64 v[20:21], 0
v_mov_b64 v[22:23], 0
s_mov_b32 s37, 0
s_cmp_eq_u32 s17, s38
s_barrier
s_nop 15
s_nop 7
s_cbranch_scc0 gather_71
s_branch exit_74
red_78:
buffer_load_dwordx4 v[8:11], v0, s[4:7], s27 offen offset:0 sc1
buffer_load_dwordx4 v[12:15], v0, s[4:7], s27 offen offset:1024 sc1
buffer_load_dwordx4 v[16:19], v0, s[4:7], s27 offen offset:2048 sc1
buffer_load_dwordx4 v[20:23], v0, s[4:7], s27 offen offset:3072 sc1
s_add_u32 s37, s37, 1
s_cmp_gt_u32 s37, 262144
s_cbranch_scc1 L_fail
v_mov_b64 v[40:41], 0
v_mov_b64 v[42:43], 0
s_waitcnt vmcnt(2)
s_nop 0
v_smfmac_f32_16x16x64_bf16 v[40:43], v[44:47], v[8:15], v1
v_bitop3_b32 v34, v8, v10, s18 bitop3:0x7e
v_bitop3_b32 v35, v12, v14, s18 bitop3:0x7e
s_waitcnt vmcnt(0)
v_smfmac_f32_16x16x64_bf16 v[40:43], v[44:47], v[16:23], v1
v_bitop3_b32 v32, v16, v18, s18 bitop3:0x7e
v_bitop3_b32 v33, v20, v22, s18 bitop3:0x7e
v_or3_b32 v34, v34, v35, v32
v_bitop3_b32 v34, v34, v33, 1 bitop3:0xa8
v_cmp_ne_u32 vcc, 0, v34
s_cbranch_vccnz red_78
s_branch red_78_ok
rare_72:
ds_read_b128 v[48:51], v6 offset:0
ds_read_b128 v[52:55], v6 offset:1024
s_waitcnt lgkmcnt(0)
s_barrier
v_add_f32 v48, v48, v52
v_add_f32 v49, v49, v53
v_add_f32 v50, v50, v54
v_add_f32 v51, v51, v55
v_mov_b32_dpp v46, v46 quad_perm:[0,1,0,1] row_mask:0xf bank_mask:0xf
v_mov_b32_dpp v47, v47 quad_perm:[0,1,0,1] row_mask:0xf bank_mask:0xf
v_max3_f32 v19, v48, v49, v50
v_max3_f32 v19, v19, v51, v46
v_max_f32 v19, v19, v47
s_nop 1
v_max_f32_dpp v19, v19, v19 quad_perm:[2,3,0,1] row_mask:0xf bank_mask:0xf
v_mov_b32 v44, v19
s_nop 1
v_permlane32_swap_b32 v19, v44
v_max_f32 v19, v19, v44
v_mov_b32 v44, v19
s_nop 1
v_permlane16_swap_b32 v19, v44
v_max_f32 v19, v19, v44
v_sub_f32 v48, v48, v19
v_sub_f32 v49, v49, v19
v_sub_f32 v50, v50, v19
v_sub_f32 v51, v51, v19
v_sub_f32 v46, v46, v19
v_sub_f32 v47, v47, v19
v_exp_f32 v48, v48
v_exp_f32 v49, v49
v_exp_f32 v50, v50
v_exp_f32 v51, v51
v_cvt_pk_bf16_f32 v54, v48, v49
v_cvt_pk_bf16_f32 v55, v50, v51
s_nop 0
v_mov_b32_dpp v48, v54 quad_perm:[0,1,0,1] row_mask:0xf bank_mask:0xf
v_mov_b32_dpp v49, v55 quad_perm:[0,1,0,1] row_mask:0xf bank_mask:0xf
v_mov_b32_dpp v50, v54 quad_perm:[2,3,2,3] row_mask:0xf bank_mask:0xf
v_mov_b32_dpp v51, v55 quad_perm:[2,3,2,3] row_mask:0xf bank_mask:0xf
v_mov_b64 v[20:21], s[56:57]
v_mov_b64 v[22:23], s[56:57]
v_mfma_f32_16x16x32_bf16 v[8:11], v[56:59], v[48:51], 0
v_mfma_f32_16x16x32_bf16 v[12:15], v[60:63], v[48:51], 0
v_mfma_f32_16x16x32_bf16 v[16:19], v[20:23], v[48:51], 0
v_mov_b64 v[54:55], s[58:59]
v_exp_f32_dpp v44, v46 quad_perm:[0,1,0,1] row_mask:0xf bank_mask:0xf
v_exp_f32_dpp v45, v47 quad_perm:[0,1,0,1] row_mask:0xf bank_mask:0xf
s_nop 0
v_cvt_pk_bf16_f32 v52, v44, v45
v_cvt_pk_bf16_f32 v53, v44, v45
s_nop 1
v_mfma_f32_16x16x16_bf16 v[16:19], v[54:55], v[52:53], v[16:19]
v_mfma_f32_16x16x16_bf16 v[8:11], v[24:25], v[52:53], v[8:11]
v_mfma_f32_16x16x16_bf16 v[12:15], v[26:27], v[52:53], v[12:15]
s_nop 5
v_rcp_f32 v18, v16
s_nop 0
v_mul_f32 v8, v8, v18
v_mul_f32 v9, v9, v18
v_mul_f32 v10, v10, v18
v_mul_f32 v11, v11, v18
v_mul_f32 v12, v12, v18
v_mul_f32 v13, v13, v18
v_mul_f32 v14, v14, v18
v_mul_f32 v15, v15, v18
v_cvt_pk_bf16_f32 v8, v8, v9
v_cvt_pk_bf16_f32 v9, v10, v11
v_cvt_pk_bf16_f32 v10, v12, v13
v_cvt_pk_bf16_f32 v11, v14, v15
s_branch back_73
exit_74:
buffer_load_dwordx4 v[32:35], v0, s[4:7], s20 offen sc1
buffer_load_dwordx4 v[36:39], v0, s[4:7], s21 offen sc1
buffer_load_dwordx4 v[40:43], v0, s[4:7], s22 offen sc1
s_add_u32 s37, s37, 1
s_cmp_gt_u32 s37, 262144
s_cbranch_scc1 L_fail
s_waitcnt vmcnt(2)
v_bitop3_b32 v44, v32, v34, s18 bitop3:0x7e
s_waitcnt vmcnt(1)
v_bitop3_b32 v45, v36, v38, s18 bitop3:0x7e
v_or_b32 v44, v44, v45
s_waitcnt vmcnt(0)
v_bitop3_b32 v46, v40, v42, s18 bitop3:0x7e
v_bitop3_b32 v44, v44, v46, s19 bitop3:0xa8
v_cmp_ne_u32 vcc, 0, v44
s_cbranch_vccnz exit_74
ds_write_b128 v0, v[32:35] offset:0
ds_write_b128 v0, v[36:39] offset:4096
ds_write_b128 v0, v[40:43] offset:8192
s_waitcnt lgkmcnt(0)
s_barrier
s_barrier
s_add_u32 s45, s45, 1
s_cmp_lt_u32 s45, 2
s_cbranch_scc1 layer_70
s_endpgm
wave_67:
layer_83:
s_lshl_b32 s17, s45, 6
s_mul_i32 s34, s45, 34603008
s_lshl_b32 s35, s15, 14
s_add_u32 s34, s34, s35
s_add_u32 s24, s34, 16781312
s_mul_i32 s34, s17, 10240
s_add_u32 s34, s34, s30
s_add_u32 s25, s34, s31
s_mov_b32 s19, 0
s_add_u32 s43, s17, 2
s_add_u32 s38, s17, 63
s_add_u32 s39, s17, 64
s_add_u32 s34, s24, 524288
v_mov_b32 v7, 0
s_mov_b32 s20, 410624
s_mov_b32 s21, 414720
s_mov_b32 s22, 418816
v_cmp_gt_u32 vcc, s43, v7
s_cmp_eq_u32 vcc_hi, 0
s_cbranch_scc1 kv_90
s_mov_b32 s37, 0
kv_89:
v_bfe_u32 v7, v0, 2, 3
buffer_load_dword v7, v7, s[4:7], s28 offen sc1
s_add_u32 s37, s37, 1
s_cmp_gt_u32 s37, 262144
s_cbranch_scc1 L_fail
s_waitcnt vmcnt(0)
v_cmp_gt_u32 vcc, s43, v7
s_cbranch_vccnz kv_89
kv_90:
buffer_load_dwordx4 v[64:67], v0, s[4:7], s65 offen offset:0 sc1
buffer_load_dwordx4 v[68:71], v0, s[4:7], s65 offen offset:1024 sc1
buffer_load_dwordx4 v[72:75], v0, s[4:7], s65 offen offset:2048 sc1
buffer_load_dwordx4 v[76:79], v0, s[4:7], s65 offen offset:3072 sc1
ds_read_b128 v[80:83], v2 offset:0
ds_read_b128 v[84:87], v2 offset:1024
buffer_load_dwordx4 v[48:51], v0, s[4:7], s66 offen offset:0 sc1
buffer_load_dwordx4 v[52:55], v0, s[4:7], s66 offen offset:1024 sc1
buffer_load_dwordx4 v[56:59], v0, s[4:7], s66 offen offset:2048 sc1
buffer_load_dwordx4 v[60:63], v0, s[4:7], s66 offen offset:3072 sc1
v_mov_b64 v[8:9], 0
v_mov_b64 v[10:11], 0
v_mov_b64 v[12:13], 0
v_mov_b64 v[14:15], 0
v_mov_b64 v[16:17], 0
v_mov_b64 v[18:19], 0
v_mov_b64 v[20:21], 0
v_mov_b64 v[22:23], 0
v_mov_b64 v[24:25], 0
v_mov_b64 v[26:27], 0
v_mov_b64 v[28:29], 0
v_mov_b64 v[30:31], 0
v_bfe_u32 v7, v0, 2, 3
v_add_u32 v7, s28, v7
s_mov_b32 exec_hi, 0
v_and_b32 v7, 255, v0
v_lshl_add_u32 v7, v7, 3, s34
s_mov_b32 exec_hi, -1
s_mov_b32 s37, 0
gather_84:
buffer_load_dwordx4 v[32:35], v0, s[4:7], s20 offen sc1
buffer_load_dwordx4 v[36:39], v0, s[4:7], s21 offen sc1
buffer_load_dwordx4 v[40:43], v0, s[4:7], s22 offen sc1
s_add_u32 s37, s37, 1
s_cmp_gt_u32 s37, 262144
s_cbranch_scc1 L_fail
s_waitcnt vmcnt(2)
v_bitop3_b32 v44, v32, v34, s18 bitop3:0x7e
s_waitcnt vmcnt(1)
v_bitop3_b32 v45, v36, v38, s18 bitop3:0x7e
v_or_b32 v44, v44, v45
s_waitcnt vmcnt(0)
v_bitop3_b32 v46, v40, v42, s18 bitop3:0x7e
v_bitop3_b32 v44, v44, v46, s19 bitop3:0xa8
v_cmp_ne_u32 vcc, 0, v44
s_cbranch_vccnz gather_84
v_smfmac_f32_16x16x64_bf16 v[8:11], v[32:35], v[64:71], v1
ds_write_b128 v0, v[32:35] offset:1024
buffer_load_dwordx4 v[64:67], v0, s[4:7], s67 offen offset:0 sc1
v_smfmac_f32_16x16x64_bf16 v[12:15], v[32:35], v[72:79], v1
ds_write_b128 v0, v[36:39] offset:5120
v_smfmac_f32_16x16x64_bf16 v[20:23], v[32:35], v[56:63], v1
buffer_load_dwordx4 v[68:71], v0, s[4:7], s67 offen offset:1024 sc1
s_waitcnt lgkmcnt(2)
v_smfmac_f32_16x16x64_bf16 v[24:27], v[32:35], v[80:87], v1
ds_write_b128 v0, v[40:43] offset:9216
v_smfmac_f32_16x16x64_bf16 v[8:11], v[36:39], a[8:15], v1
ds_read_b128 v[80:83], v2 offset:2048
buffer_load_dwordx4 v[72:75], v0, s[4:7], s67 offen offset:2048 sc1
v_smfmac_f32_16x16x64_bf16 v[16:19], v[32:35], v[48:55], v1
s_waitcnt lgkmcnt(1)
ds_read_b128 v[84:87], v2 offset:3072
buffer_load_dwordx4 v[76:79], v0, s[4:7], s67 offen offset:3072 sc1
v_smfmac_f32_16x16x64_bf16 v[16:19], v[36:39], a[24:31], v1
buffer_load_dwordx4 v[48:51], v0, s[4:7], s24 offen offset:0 nt sc1
buffer_load_dwordx4 v[52:55], v0, s[4:7], s24 offen offset:1024 nt sc1
v_smfmac_f32_16x16x64_bf16 v[28:31], v[32:35], a[0:7], v1
s_barrier
ds_read_b128 v[40:43], v0 offset:0
v_smfmac_f32_16x16x64_bf16 v[28:31], v[36:39], a[40:47], v1
s_waitcnt lgkmcnt(1)
ds_read_b128 v[44:47], v0 offset:4096
ds_read_b128 v[32:35], v0 offset:3072
v_smfmac_f32_16x16x64_bf16 v[24:27], v[36:39], v[80:87], v1
v_smfmac_f32_16x16x64_bf16 v[12:15], v[36:39], a[16:23], v1
ds_read_b128 v[84:87], v2 offset:5120
ds_read_b128 v[80:83], v2 offset:4096
v_smfmac_f32_16x16x64_bf16 v[20:23], v[36:39], a[32:39], v1
ds_read_b128 v[36:39], v0 offset:7168
s_waitcnt lgkmcnt(5)
v_smfmac_f32_16x16x64_bf16 v[8:11], v[40:43], a[48:55], v1
buffer_load_dwordx4 v[56:59], v0, s[4:7], s24 offen offset:2048 nt sc1
v_smfmac_f32_16x16x64_bf16 v[12:15], v[40:43], a[56:63], v1
s_waitcnt lgkmcnt(4)
ds_read_b128 v[40:43], v0 offset:2048
s_xor_b32 s18, s18, 1
v_smfmac_f32_16x16x64_bf16 v[12:15], v[44:47], a[72:79], v1
s_waitcnt lgkmcnt(4)
buffer_load_dwordx4 v[60:63], v0, s[4:7], s24 offen offset:3072 nt sc1
v_smfmac_f32_16x16x64_bf16 v[8:11], v[44:47], a[64:71], v1
s_waitcnt lgkmcnt(3)
s_waitcnt lgkmcnt(2)
v_smfmac_f32_16x16x64_bf16 v[8:11], v[32:35], v[80:87], v1
s_waitcnt vmcnt(7)
ds_read_b128 v[84:87], v2 offset:7168
s_add_u32 s24, s24, 524288
v_smfmac_f32_16x16x64_bf16 v[12:15], v[32:35], a[80:87], v1
ds_read_b128 v[32:35], v0 offset:6144
s_waitcnt lgkmcnt(2)
v_smfmac_f32_16x16x64_bf16 v[8:11], v[36:39], a[88:95], v1
ds_read_b128 v[80:83], v2 offset:6144
v_smfmac_f32_16x16x64_bf16 v[12:15], v[36:39], a[96:103], v1
s_waitcnt vmcnt(6)
ds_read_b128 v[36:39], v0 offset:8192
v_smfmac_f32_16x16x64_bf16 v[8:11], v[40:43], v[64:71], v1
ds_read_b128 v[64:67], v2 offset:8192
ds_read_b128 v[68:71], v2 offset:9216
v_smfmac_f32_16x16x64_bf16 v[12:15], v[40:43], a[104:111], v1
ds_read_b128 v[40:43], v0 offset:9216
s_waitcnt lgkmcnt(5)
v_smfmac_f32_16x16x64_bf16 v[12:15], v[32:35], a[112:119], v1
s_waitcnt lgkmcnt(4)
buffer_load_dword v7, v7, s[4:7], 0 offen sc1
v_smfmac_f32_16x16x64_bf16 v[8:11], v[32:35], v[80:87], v1
s_waitcnt lgkmcnt(3)
ds_read_b128 v[32:35], v0 offset:0
ds_read_b128 v[84:87], v2 offset:11264
v_smfmac_f32_16x16x64_bf16 v[8:11], v[36:39], a[120:127], v1
ds_read_b128 v[80:83], v2 offset:10240
v_smfmac_f32_16x16x64_bf16 v[12:15], v[36:39], a[128:135], v1
s_waitcnt lgkmcnt(4)
ds_read_b128 v[36:39], v0 offset:4096
s_waitcnt lgkmcnt(4)
v_smfmac_f32_16x16x64_bf16 v[8:11], v[40:43], v[64:71], v1
s_waitcnt vmcnt(5)
ds_read_b128 v[64:67], v2 offset:12288
ds_read_b128 v[68:71], v2 offset:13312
v_smfmac_f32_16x16x64_bf16 v[12:15], v[40:43], a[136:143], v1
s_waitcnt lgkmcnt(5)
ds_read_b128 v[40:43], v0 offset:3072
v_smfmac_f32_16x16x64_bf16 v[16:19], v[32:35], v[72:79], v1
s_nop 0
ds_read_b128 v[72:75], v2 offset:14336
v_add_f32 v9, v9, v11
v_add_f32 v8, v8, v10
s_nop 0
v_add_f32 v13, v13, v15
v_add_f32 v12, v12, v14
v_mul_f32 v9, s44, v9
s_waitcnt lgkmcnt(4)
v_mul_f32 v8, s44, v8
v_mul_f32 v12, s44, v12
v_mul_f32 v13, s44, v13
v_cvt_pk_bf16_f32 v12, v12, v13
v_cvt_pk_bf16_f32 v8, v8, v9
v_smfmac_f32_16x16x64_bf16 v[20:23], v[32:35], v[80:87], v1
s_add_u32 s17, s17, 1
ds_read_b128 v[32:35], v0 offset:7168
ds_write2_b32 v3, v8, v12 offset0:0 offset1:128
v_smfmac_f32_16x16x64_bf16 v[16:19], v[36:39], a[144:151], v1
ds_read_b128 v[80:83], v2 offset:16384
v_smfmac_f32_16x16x64_bf16 v[20:23], v[36:39], a[152:159], v1
ds_read_b128 v[36:39], v0 offset:2048
ds_read_b128 v[76:79], v2 offset:15360
s_waitcnt vmcnt(3)
s_waitcnt lgkmcnt(4)
v_smfmac_f32_16x16x64_bf16 v[16:19], v[40:43], a[160:167], v1
ds_read_b128 v[84:87], v2 offset:17408
v_smfmac_f32_16x16x64_bf16 v[20:23], v[40:43], v[64:71], v1
s_waitcnt lgkmcnt(4)
ds_read_b128 v[40:43], v0 offset:6144
ds_read_b128 v[64:67], v2 offset:18432
v_smfmac_f32_16x16x64_bf16 v[16:19], v[32:35], a[168:175], v1
s_barrier
v_smfmac_f32_16x16x64_bf16 v[20:23], v[32:35], a[176:183], v1
s_waitcnt lgkmcnt(3)
ds_read_b128 v[32:35], v0 offset:8192
ds_read_b64_tr_b16 v[12:13], v4 offset:1024
v_smfmac_f32_16x16x64_bf16 v[16:19], v[36:39], a[184:191], v1
ds_read_b64_tr_b16 v[10:11], v4 offset:512
v_smfmac_f32_16x16x64_bf16 v[20:23], v[36:39], v[72:79], v1
s_waitcnt lgkmcnt(4)
ds_read_b128 v[36:39], v0 offset:9216
ds_read_b64_tr_b16 v[8:9], v4 offset:0
v_smfmac_f32_16x16x64_bf16 v[16:19], v[40:43], a[192:199], v1
ds_read_b64_tr_b16 v[14:15], v4 offset:1536
ds_read_b128 v[76:79], v2 offset:21504
v_smfmac_f32_16x16x64_bf16 v[20:23], v[40:43], a[200:207], v1
ds_read_b128 v[40:43], v0 offset:0
s_waitcnt lgkmcnt(7)
v_smfmac_f32_16x16x64_bf16 v[20:23], v[32:35], v[80:87], v1
ds_read_b128 v[68:71], v2 offset:19456
ds_read_b128 v[84:87], v2 offset:23552
v_smfmac_f32_16x16x64_bf16 v[16:19], v[32:35], a[208:215], v1
s_waitcnt lgkmcnt(6)
ds_read_b128 v[72:75], v2 offset:20480
v_smfmac_f32_16x16x64_bf16 v[20:23], v[36:39], a[224:231], v1
s_waitcnt lgkmcnt(6)
ds_read_b128 v[32:35], v0 offset:4096
ds_read_b128 v[80:83], v2 offset:22528
v_smfmac_f32_16x16x64_bf16 v[16:19], v[36:39], a[216:223], v1
ds_read_b128 v[36:39], v0 offset:3072
s_waitcnt lgkmcnt(7)
v_mfma_f32_16x16x32_bf16 v[44:47], v[48:51], v[8:11], 0
s_nop 0
v_add_f32 v20, v20, v22
v_add_f32 v21, v21, v23
v_mfma_f32_16x16x32_bf16 v[44:47], v[52:55], v[12:15], v[44:47]
s_nop 0
v_add_f32 v17, v17, v19
v_add_f32 v16, v16, v18
v_xor_b32 v48, 128, v5
s_waitcnt lgkmcnt(5)
v_cvt_pk_bf16_f32 v20, v20, v21
v_smfmac_f32_16x16x64_bf16 v[28:31], v[40:43], a[232:239], v1
s_mov_b64 exec, s[54:55]
ds_write_b128 v48, v[44:47] offset:512
s_mov_b64 exec, -1
v_smfmac_f32_16x16x64_bf16 v[24:27], v[40:43], v[64:71], v1
s_waitcnt lgkmcnt(3)
ds_read_b128 v[40:43], v0 offset:7168
v_cvt_pk_bf16_f32 v16, v16, v17
v_smfmac_f32_16x16x64_bf16 v[24:27], v[32:35], a[240:247], v1
ds_write2_b32 v3, v16, v20 offset0:1 offset1:129
v_smfmac_f32_16x16x64_bf16 v[28:31], v[32:35], v[72:79], v1
s_waitcnt lgkmcnt(3)
ds_read_b128 v[32:35], v0 offset:2048
buffer_load_dwordx4 v[64:67], v0, s[4:7], s68 offen offset:0 sc1
v_smfmac_f32_16x16x64_bf16 v[24:27], v[36:39], a[248:255], v1
buffer_load_dwordx4 v[68:71], v0, s[4:7], s68 offen offset:1024 sc1
v_smfmac_f32_16x16x64_bf16 v[28:31], v[36:39], v[88:95], v1
ds_read_b128 v[36:39], v0 offset:6144
s_waitcnt lgkmcnt(3)
v_smfmac_f32_16x16x64_bf16 v[24:27], v[40:43], v[96:103], v1
s_mov_b32 s20, 394240
buffer_load_dwordx4 v[72:75], v0, s[4:7], s68 offen offset:2048 sc1
v_smfmac_f32_16x16x64_bf16 v[28:31], v[40:43], v[80:87], v1
s_waitcnt lgkmcnt(2)
ds_read_b128 v[40:43], v0 offset:8192
s_waitcnt lgkmcnt(2)
v_smfmac_f32_16x16x64_bf16 v[28:31], v[32:35], v[112:119], v1
s_barrier
ds_read_b128 v[52:55], v6 offset:1024
v_smfmac_f32_16x16x64_bf16 v[24:27], v[32:35], v[104:111], v1
s_waitcnt lgkmcnt(2)
ds_read_b128 v[32:35], v0 offset:9216
ds_read_b128 v[48:51], v6 offset:0
v_smfmac_f32_16x16x64_bf16 v[24:27], v[36:39], v[120:127], v1
ds_read_b64_tr_b16 v[8:9], v4 offset:0
ds_read_b64_tr_b16 v[10:11], v4 offset:512
v_smfmac_f32_16x16x64_bf16 v[28:31], v[36:39], v[128:135], v1
s_waitcnt lgkmcnt(5)
buffer_load_dwordx4 v[76:79], v0, s[4:7], s68 offen offset:3072 sc1
v_smfmac_f32_16x16x64_bf16 v[28:31], v[40:43], v[144:151], v1
buffer_load_dwordx4 v[80:83], v0, s[4:7], s69 offen offset:0 sc1
ds_read_b64_tr_b16 v[20:21], v4 offset:3072
ds_read_b64_tr_b16 v[18:19], v4 offset:2560
v_smfmac_f32_16x16x64_bf16 v[24:27], v[40:43], v[136:143], v1
s_waitcnt lgkmcnt(5)
ds_read_b64_tr_b16 v[12:13], v4 offset:1024
ds_read_b64_tr_b16 v[14:15], v4 offset:1536
v_smfmac_f32_16x16x64_bf16 v[28:31], v[32:35], v[160:167], v1
s_waitcnt lgkmcnt(6)
ds_read_b64_tr_b16 v[16:17], v4 offset:2048
v_add_f32 v48, v48, v52
v_smfmac_f32_16x16x64_bf16 v[24:27], v[32:35], v[152:159], v1
s_waitcnt lgkmcnt(5)
ds_read_b64_tr_b16 v[22:23], v4 offset:3584
v_add_f32 v51, v51, v55
v_exp_f32 v48, v48
v_add_f32 v50, v50, v54
v_exp_f32 v51, v51
v_exp_f32 v50, v50
v_mfma_f32_16x16x32_bf16 v[44:47], v[8:11], v[8:11], 0
s_waitcnt lgkmcnt(1)
v_cvt_pk_bf16_f32 v55, v50, v51
v_add_f32 v49, v49, v53
v_mfma_f32_16x16x32_bf16 v[44:47], v[12:15], v[12:15], v[44:47]
s_waitcnt vmcnt(6)
v_exp_f32 v49, v49
v_mfma_f32_16x16x32_bf16 v[44:47], v[16:19], v[16:19], v[44:47]
s_waitcnt lgkmcnt(0)
v_cvt_pk_bf16_f32 v54, v48, v49
v_mov_b32_dpp v51, v55 quad_perm:[2,3,2,3] row_mask:0xf bank_mask:0xf
v_mfma_f32_16x16x32_bf16 v[44:47], v[20:23], v[20:23], v[44:47]
v_mov_b32_dpp v50, v54 quad_perm:[2,3,2,3] row_mask:0xf bank_mask:0xf
v_mov_b32_dpp v48, v54 quad_perm:[0,1,0,1] row_mask:0xf bank_mask:0xf
v_mov_b32_dpp v49, v55 quad_perm:[0,1,0,1] row_mask:0xf bank_mask:0xf
v_mov_b64 v[22:23], s[56:57]
v_mov_b64 v[54:55], s[58:59]
v_mfma_f32_16x16x32_bf16 v[12:15], v[60:63], v[48:51], 0
s_nop 0
v_mov_b64 v[20:21], s[56:57]
v_exp_f32_dpp v44, v46 quad_perm:[0,1,0,1] row_mask:0xf bank_mask:0xf
v_mfma_f32_16x16x32_bf16 v[8:11], v[56:59], v[48:51], 0
v_exp_f32_dpp v45, v47 quad_perm:[0,1,0,1] row_mask:0xf bank_mask:0xf
v_mfma_f32_16x16x32_bf16 v[16:19], v[20:23], v[48:51], 0
s_nop 0
v_cvt_pk_bf16_f32 v53, v44, v45
v_cvt_pk_bf16_f32 v24, v24, v25
v_cvt_pk_bf16_f32 v52, v44, v45
v_cvt_pk_bf16_f32 v25, v26, v27
v_mov_b64 v[38:39], 0
v_mfma_f32_16x16x16_bf16 v[16:19], v[54:55], v[52:53], v[16:19]
s_nop 0
v_cvt_pk_bf16_f32 v27, v30, v31
v_cvt_pk_bf16_f32 v26, v28, v29
v_mfma_f32_16x16x16_bf16 v[8:11], v[24:25], v[52:53], v[8:11]
s_nop 0
buffer_load_dwordx4 v[84:87], v0, s[4:7], s69 offen offset:1024 sc1
v_mfma_f32_16x16x16_bf16 v[12:15], v[26:27], v[52:53], v[12:15]
s_barrier
v_rcp_f32 v18, v16
v_subrev_u32 v17, s46, v16
v_mov_b64 v[40:41], 0
v_mov_b64 v[34:35], 0
v_mul_f32 v8, v8, v18
v_mul_f32 v9, v9, v18
v_cvt_pk_bf16_f32 v8, v8, v9
v_mul_f32 v10, v10, v18
v_mul_f32 v13, v13, v18
v_mul_f32 v11, v11, v18
v_cvt_pk_bf16_f32 v9, v10, v11
v_mul_f32 v12, v12, v18
v_cmp_lt_u32 vcc, s47, v17
v_mul_f32 v14, v14, v18
v_mul_f32 v15, v15, v18
v_cvt_pk_bf16_f32 v11, v14, v15
v_mov_b64 v[32:33], 0
s_waitcnt vmcnt(4)
v_cvt_pk_bf16_f32 v10, v12, v13
s_cbranch_vccnz rare_85
back_86:
s_mov_b64 exec, s[54:55]
ds_write_b128 v5, v[8:11] offset:512
s_mov_b64 exec, -1
v_mov_b64 v[48:49], 0
v_mov_b64 v[50:51], 0
v_smfmac_f32_16x16x64_bf16 v[32:35], v[8:11], v[64:71], v1
s_add_u32 s25, s25, 10240
ds_read_b128 v[16:19], v2 offset:24576
v_mov_b64 v[36:37], 0
v_mov_b64 v[42:43], 0
v_smfmac_f32_16x16x64_bf16 v[48:51], v[8:11], v[176:183], v1
ds_read_b128 v[28:31], v2 offset:27648
buffer_load_dwordx4 v[64:67], v0, s[4:7], s65 offen offset:0 sc1
ds_read_b128 v[24:27], v2 offset:26624
v_smfmac_f32_16x16x64_bf16 v[40:43], v[8:11], v[168:175], v1
ds_read_b128 v[20:23], v2 offset:25600
s_add_u32 s43, s17, 2
s_waitcnt lgkmcnt(4)
s_barrier
ds_read_b128 v[56:59], v5 offset:0
buffer_load_dwordx4 v[68:71], v0, s[4:7], s65 offen offset:1024 sc1
s_waitcnt vmcnt(4)
ds_read_b128 v[12:15], v5 offset:1024
v_smfmac_f32_16x16x64_bf16 v[36:39], v[8:11], v[72:79], v1
s_waitcnt lgkmcnt(5)
ds_read_b128 v[60:63], v5 offset:1536
v_mov_b64 v[54:55], 0
s_waitcnt lgkmcnt(3)
s_mov_b32 s37, 0
s_mov_b32 s19, 1
buffer_load_dwordx4 v[72:75], v0, s[4:7], s65 offen offset:2048 sc1
v_bfe_u32 v45, v0, 1, 7
v_mov_b64 v[52:53], 0
s_waitcnt lgkmcnt(2)
v_smfmac_f32_16x16x64_bf16 v[32:35], v[56:59], v[16:23], v1
buffer_load_dwordx4 v[76:79], v0, s[4:7], s65 offen offset:3072 sc1
ds_read_b128 v[16:19], v2 offset:30720
v_smfmac_f32_16x16x64_bf16 v[48:51], v[56:59], v[216:223], v1
s_waitcnt lgkmcnt(2)
ds_read_b128 v[20:23], v2 offset:31744
v_lshrrev_b32 v44, 8, v0
s_waitcnt vmcnt(5)
s_waitcnt vmcnt(4)
v_smfmac_f32_16x16x64_bf16 v[52:55], v[8:11], v[80:87], v1
s_waitcnt lgkmcnt(2)
ds_read_b128 v[84:87], v2 offset:29696
s_mov_b32 s21, 398336
v_smfmac_f32_16x16x64_bf16 v[32:35], v[60:63], v[24:31], v1
ds_read_b128 v[80:83], v2 offset:28672
s_min_u32 s43, s43, s39
v_smfmac_f32_16x16x64_bf16 v[32:35], v[12:15], v[184:191], v1
s_waitcnt lgkmcnt(3)
ds_read_b128 v[24:27], v2 offset:32768
s_waitcnt lgkmcnt(3)
v_smfmac_f32_16x16x64_bf16 v[40:43], v[56:59], v[16:23], v1
ds_read_b128 v[28:31], v2 offset:33792
v_lshl_or_b32 v44, v44, 12, v45
v_smfmac_f32_16x16x64_bf16 v[36:39], v[56:59], v[192:199], v1
s_waitcnt lgkmcnt(3)
v_cvt_pk_bf16_f32 v32, v32, v33
v_cvt_pk_bf16_f32 v33, v34, v35
v_and_or_b32 v32, v32, -2, s18
s_waitcnt lgkmcnt(2)
v_smfmac_f32_16x16x64_bf16 v[36:39], v[60:63], v[80:87], v1
buffer_store_dwordx2 v[32:33], v44, s[4:7], s60 offen
v_smfmac_f32_16x16x64_bf16 v[36:39], v[12:15], v[200:207], v1
s_waitcnt lgkmcnt(1)
s_waitcnt lgkmcnt(0)
ds_read_b128 v[80:83], v2 offset:34816
v_smfmac_f32_16x16x64_bf16 v[40:43], v[60:63], v[24:31], v1
s_nop 0
ds_read_b128 v[84:87], v2 offset:35840
s_add_u32 s34, s24, 524288
s_nop 0
v_cvt_pk_bf16_f32 v36, v36, v37
v_and_or_b32 v36, v36, -2, s18
v_cvt_pk_bf16_f32 v37, v38, v39
v_smfmac_f32_16x16x64_bf16 v[40:43], v[12:15], v[208:215], v1
buffer_store_dwordx2 v[36:37], v44, s[4:7], s61 offen
v_smfmac_f32_16x16x64_bf16 v[52:55], v[56:59], v[232:239], v1
s_nop 2
v_smfmac_f32_16x16x64_bf16 v[52:55], v[60:63], v[240:247], v1
s_nop 0
s_waitcnt lgkmcnt(0)
v_cvt_pk_bf16_f32 v40, v40, v41
v_cvt_pk_bf16_f32 v41, v42, v43
v_and_or_b32 v40, v40, -2, s18
v_smfmac_f32_16x16x64_bf16 v[48:51], v[60:63], v[80:87], v1
s_mov_b32 s22, 402432
buffer_store_dwordx2 v[40:41], v44, s[4:7], s62 offen
v_smfmac_f32_16x16x64_bf16 v[48:51], v[12:15], v[224:231], v1
s_nop 2
v_smfmac_f32_16x16x64_bf16 v[52:55], v[12:15], v[248:255], v1
s_nop 3
v_cvt_pk_bf16_f32 v48, v48, v49
v_and_or_b32 v48, v48, -2, s18
v_cvt_pk_bf16_f32 v49, v50, v51
buffer_store_dwordx2 v[48:49], v44, s[4:7], s63 offen
v_cvt_pk_bf16_f32 v52, v52, v53
v_cvt_pk_bf16_f32 v53, v54, v55
v_and_or_b32 v52, v52, -2, s18
buffer_store_dwordx2 v[52:53], v44, s[4:7], s64 offen
v_bfe_u32 v34, v0, 6, 1
v_lshlrev_b32 v34, 4, v34
v_mov_b32 v35, 0x3f80
v_lshlrev_b32 v34, v34, v35
v_bfe_i32 v35, v0, 4, 1
v_and_b32 v45, v34, v35
v_and_b32 v47, v34, v35
v_xor_b32 v44, v34, v45
v_xor_b32 v46, v34, v45
v_and_b32 v36, 32, v0
v_bfe_u32 v37, v0, 6, 1
v_lshl_add_u32 v36, v37, 8, v36
v_bfe_u32 v37, v0, 8, 1
v_lshl_add_u32 v36, v37, 4, v36
v_bfe_u32 v37, v0, 4, 1
v_lshl_add_u32 v36, v37, 3, v36
ds_read_b128 v[80:83], v2 offset:0
ds_read_b128 v[84:87], v2 offset:1024
v_mov_b64 v[24:25], 0
v_mov_b64 v[26:27], 0
v_mov_b64 v[28:29], 0
v_mov_b64 v[30:31], 0
v_bfe_u32 v7, v0, 2, 3
v_add_u32 v7, s28, v7
s_mov_b32 exec_hi, 0
v_and_b32 v7, 255, v0
v_lshl_add_u32 v7, v7, 3, s34
s_mov_b32 exec_hi, -1
s_nop 15
s_nop 15
s_nop 15
s_nop 10
buffer_load_dwordx4 v[8:11], v0, s[4:7], s27 offen offset:0 sc1
buffer_load_dwordx4 v[12:15], v0, s[4:7], s27 offen offset:1024 sc1
buffer_load_dwordx4 v[16:19], v0, s[4:7], s27 offen offset:2048 sc1
buffer_load_dwordx4 v[20:23], v0, s[4:7], s27 offen offset:3072 sc1
s_barrier
buffer_load_dwordx4 v[48:51], v0, s[4:7], s66 offen offset:0 sc1
buffer_load_dwordx4 v[52:55], v0, s[4:7], s66 offen offset:1024 sc1
buffer_load_dwordx4 v[56:59], v0, s[4:7], s66 offen offset:2048 sc1
buffer_load_dwordx4 v[60:63], v0, s[4:7], s66 offen offset:3072 sc1
v_mov_b64 v[40:41], 0
v_mov_b64 v[42:43], 0
s_waitcnt vmcnt(6)
s_nop 0
v_smfmac_f32_16x16x64_bf16 v[40:43], v[44:47], v[8:15], v1
v_bitop3_b32 v34, v8, v10, s18 bitop3:0x7e
v_bitop3_b32 v35, v12, v14, s18 bitop3:0x7e
s_waitcnt vmcnt(4)
v_smfmac_f32_16x16x64_bf16 v[40:43], v[44:47], v[16:23], v1
v_bitop3_b32 v32, v16, v18, s18 bitop3:0x7e
v_bitop3_b32 v33, v20, v22, s18 bitop3:0x7e
v_or3_b32 v34, v34, v35, v32
v_bitop3_b32 v34, v34, v33, 1 bitop3:0xa8
v_cmp_ne_u32 vcc, 0, v34
s_cbranch_vccnz red_91
red_91_ok:
s_nop 1
v_add_f32_dpp v40, v40, v40 row_ror:8 row_mask:0xf bank_mask:0xf
v_add_f32_dpp v41, v41, v41 row_ror:8 row_mask:0xf bank_mask:0xf
v_add_f32_dpp v42, v42, v42 row_ror:8 row_mask:0xf bank_mask:0xf
v_add_f32_dpp v43, v43, v43 row_ror:8 row_mask:0xf bank_mask:0xf
v_cvt_pk_bf16_f32 v40, v40, v41
v_cvt_pk_bf16_f32 v41, v42, v43
v_and_or_b32 v40, v40, -2, s18
s_mov_b64 exec, 0x00ff00ff
buffer_store_dwordx2 v[40:41], v36, s[4:7], s40 offen
s_mov_b64 exec, -1
g2_93:
v_mov_b64 v[8:9], 0
v_mov_b64 v[10:11], 0
v_mov_b64 v[12:13], 0
v_mov_b64 v[14:15], 0
v_mov_b64 v[16:17], 0
v_mov_b64 v[18:19], 0
v_mov_b64 v[20:21], 0
v_mov_b64 v[22:23], 0
s_mov_b32 s37, 0
s_cmp_eq_u32 s17, s38
s_barrier
s_nop 15
s_nop 7
s_cbranch_scc0 gather_84
s_branch exit_87
red_91:
buffer_load_dwordx4 v[8:11], v0, s[4:7], s27 offen offset:0 sc1
buffer_load_dwordx4 v[12:15], v0, s[4:7], s27 offen offset:1024 sc1
buffer_load_dwordx4 v[16:19], v0, s[4:7], s27 offen offset:2048 sc1
buffer_load_dwordx4 v[20:23], v0, s[4:7], s27 offen offset:3072 sc1
s_add_u32 s37, s37, 1
s_cmp_gt_u32 s37, 262144
s_cbranch_scc1 L_fail
v_mov_b64 v[40:41], 0
v_mov_b64 v[42:43], 0
s_waitcnt vmcnt(2)
s_nop 0
v_smfmac_f32_16x16x64_bf16 v[40:43], v[44:47], v[8:15], v1
v_bitop3_b32 v34, v8, v10, s18 bitop3:0x7e
v_bitop3_b32 v35, v12, v14, s18 bitop3:0x7e
s_waitcnt vmcnt(0)
v_smfmac_f32_16x16x64_bf16 v[40:43], v[44:47], v[16:23], v1
v_bitop3_b32 v32, v16, v18, s18 bitop3:0x7e
v_bitop3_b32 v33, v20, v22, s18 bitop3:0x7e
v_or3_b32 v34, v34, v35, v32
v_bitop3_b32 v34, v34, v33, 1 bitop3:0xa8
v_cmp_ne_u32 vcc, 0, v34
s_cbranch_vccnz red_91
s_branch red_91_ok
rare_85:
ds_read_b128 v[48:51], v6 offset:0
ds_read_b128 v[52:55], v6 offset:1024
s_waitcnt lgkmcnt(0)
s_barrier
v_add_f32 v48, v48, v52
v_add_f32 v49, v49, v53
v_add_f32 v50, v50, v54
v_add_f32 v51, v51, v55
v_mov_b32_dpp v46, v46 quad_perm:[0,1,0,1] row_mask:0xf bank_mask:0xf
v_mov_b32_dpp v47, v47 quad_perm:[0,1,0,1] row_mask:0xf bank_mask:0xf
v_max3_f32 v19, v48, v49, v50
v_max3_f32 v19, v19, v51, v46
v_max_f32 v19, v19, v47
s_nop 1
v_max_f32_dpp v19, v19, v19 quad_perm:[2,3,0,1] row_mask:0xf bank_mask:0xf
v_mov_b32 v44, v19
s_nop 1
v_permlane32_swap_b32 v19, v44
v_max_f32 v19, v19, v44
v_mov_b32 v44, v19
s_nop 1
v_permlane16_swap_b32 v19, v44
v_max_f32 v19, v19, v44
v_sub_f32 v48, v48, v19
v_sub_f32 v49, v49, v19
v_sub_f32 v50, v50, v19
v_sub_f32 v51, v51, v19
v_sub_f32 v46, v46, v19
v_sub_f32 v47, v47, v19
v_exp_f32 v48, v48
v_exp_f32 v49, v49
v_exp_f32 v50, v50
v_exp_f32 v51, v51
v_cvt_pk_bf16_f32 v54, v48, v49
v_cvt_pk_bf16_f32 v55, v50, v51
s_nop 0
v_mov_b32_dpp v48, v54 quad_perm:[0,1,0,1] row_mask:0xf bank_mask:0xf
v_mov_b32_dpp v49, v55 quad_perm:[0,1,0,1] row_mask:0xf bank_mask:0xf
v_mov_b32_dpp v50, v54 quad_perm:[2,3,2,3] row_mask:0xf bank_mask:0xf
v_mov_b32_dpp v51, v55 quad_perm:[2,3,2,3] row_mask:0xf bank_mask:0xf
v_mov_b64 v[20:21], s[56:57]
v_mov_b64 v[22:23], s[56:57]
v_mfma_f32_16x16x32_bf16 v[8:11], v[56:59], v[48:51], 0
v_mfma_f32_16x16x32_bf16 v[12:15], v[60:63], v[48:51], 0
v_mfma_f32_16x16x32_bf16 v[16:19], v[20:23], v[48:51], 0
v_mov_b64 v[54:55], s[58:59]
v_exp_f32_dpp v44, v46 quad_perm:[0,1,0,1] row_mask:0xf bank_mask:0xf
v_exp_f32_dpp v45, v47 quad_perm:[0,1,0,1] row_mask:0xf bank_mask:0xf
s_nop 0
v_cvt_pk_bf16_f32 v52, v44, v45
v_cvt_pk_bf16_f32 v53, v44, v45
s_nop 1
v_mfma_f32_16x16x16_bf16 v[16:19], v[54:55], v[52:53], v[16:19]
v_mfma_f32_16x16x16_bf16 v[8:11], v[24:25], v[52:53], v[8:11]
v_mfma_f32_16x16x16_bf16 v[12:15], v[26:27], v[52:53], v[12:15]
s_nop 5
v_rcp_f32 v18, v16
s_nop 0
v_mul_f32 v8, v8, v18
v_mul_f32 v9, v9, v18
v_mul_f32 v10, v10, v18
v_mul_f32 v11, v11, v18
v_mul_f32 v12, v12, v18
v_mul_f32 v13, v13, v18
v_mul_f32 v14, v14, v18
v_mul_f32 v15, v15, v18
v_cvt_pk_bf16_f32 v8, v8, v9
v_cvt_pk_bf16_f32 v9, v10, v11
v_cvt_pk_bf16_f32 v10, v12, v13
v_cvt_pk_bf16_f32 v11, v14, v15
s_branch back_86
exit_87:
buffer_load_dwordx4 v[32:35], v0, s[4:7], s20 offen sc1
buffer_load_dwordx4 v[36:39], v0, s[4:7], s21 offen sc1
buffer_load_dwordx4 v[40:43], v0, s[4:7], s22 offen sc1
s_add_u32 s37, s37, 1
s_cmp_gt_u32 s37, 262144
s_cbranch_scc1 L_fail
s_waitcnt vmcnt(2)
v_bitop3_b32 v44, v32, v34, s18 bitop3:0x7e
s_waitcnt vmcnt(1)
v_bitop3_b32 v45, v36, v38, s18 bitop3:0x7e
v_or_b32 v44, v44, v45
s_waitcnt vmcnt(0)
v_bitop3_b32 v46, v40, v42, s18 bitop3:0x7e
v_bitop3_b32 v44, v44, v46, s19 bitop3:0xa8
v_cmp_ne_u32 vcc, 0, v44
s_cbranch_vccnz exit_87
ds_write_b128 v0, v[32:35] offset:1024
ds_write_b128 v0, v[36:39] offset:5120
ds_write_b128 v0, v[40:43] offset:9216
s_waitcnt lgkmcnt(0)
s_barrier
s_barrier
s_add_u32 s45, s45, 1
s_cmp_lt_u32 s45, 2
s_cbranch_scc1 layer_83
s_endpgm
wave_68:
layer_96:
s_lshl_b32 s17, s45, 6
s_mul_i32 s34, s45, 34603008
s_lshl_b32 s35, s15, 14
s_add_u32 s34, s34, s35
s_add_u32 s24, s34, 16785408
s_mul_i32 s34, s17, 10240
s_add_u32 s34, s34, s30
s_add_u32 s25, s34, s31
s_mov_b32 s19, 0
s_add_u32 s43, s17, 2
s_add_u32 s38, s17, 63
s_add_u32 s39, s17, 64
s_add_u32 s34, s24, 524288
v_mov_b32 v7, 0
s_mov_b32 s20, 411648
s_mov_b32 s21, 415744
v_cmp_gt_u32 vcc, s43, v7
s_cmp_eq_u32 vcc_hi, 0
s_cbranch_scc1 kv_103
s_mov_b32 s37, 0
kv_102:
v_bfe_u32 v7, v0, 2, 3
buffer_load_dword v7, v7, s[4:7], s28 offen sc1
s_add_u32 s37, s37, 1
s_cmp_gt_u32 s37, 262144
s_cbranch_scc1 L_fail
s_waitcnt vmcnt(0)
v_cmp_gt_u32 vcc, s43, v7
s_cbranch_vccnz kv_102
kv_103:
buffer_load_dwordx4 v[64:67], v0, s[4:7], s65 offen offset:0 sc1
buffer_load_dwordx4 v[68:71], v0, s[4:7], s65 offen offset:1024 sc1
buffer_load_dwordx4 v[72:75], v0, s[4:7], s65 offen offset:2048 sc1
buffer_load_dwordx4 v[76:79], v0, s[4:7], s65 offen offset:3072 sc1
ds_read_b128 v[80:83], v2 offset:0
ds_read_b128 v[84:87], v2 offset:1024
buffer_load_dwordx4 v[48:51], v0, s[4:7], s66 offen offset:0 sc1
buffer_load_dwordx4 v[52:55], v0, s[4:7], s66 offen offset:1024 sc1
buffer_load_dwordx4 v[56:59], v0, s[4:7], s66 offen offset:2048 sc1
buffer_load_dwordx4 v[60:63], v0, s[4:7], s66 offen offset:3072 sc1
v_mov_b64 v[8:9], 0
v_mov_b64 v[10:11], 0
v_mov_b64 v[12:13], 0
v_mov_b64 v[14:15], 0
v_mov_b64 v[16:17], 0
v_mov_b64 v[18:19], 0
v_mov_b64 v[20:21], 0
v_mov_b64 v[22:23], 0
v_mov_b64 v[24:25], 0
v_mov_b64 v[26:27], 0
v_mov_b64 v[28:29], 0
v_mov_b64 v[30:31], 0
v_bfe_u32 v7, v0, 2, 3
v_add_u32 v7, s28, v7
s_mov_b32 exec_hi, 0
v_and_b32 v7, 255, v0
v_lshl_add_u32 v7, v7, 3, s34
s_mov_b32 exec_hi, -1
s_mov_b32 s37, 0
gather_97:
buffer_load_dwordx4 v[32:35], v0, s[4:7], s20 offen sc1
buffer_load_dwordx4 v[36:39], v0, s[4:7], s21 offen sc1
s_add_u32 s37, s37, 1
s_cmp_gt_u32 s37, 262144
s_cbranch_scc1 L_fail
s_waitcnt vmcnt(1)
v_bitop3_b32 v44, v32, v34, s18 bitop3:0x7e
s_waitcnt vmcnt(0)
v_bitop3_b32 v45, v36, v38, s18 bitop3:0x7e
v_bitop3_b32 v44, v44, v45, s19 bitop3:0xa8
v_cmp_ne_u32 vcc, 0, v44
s_cbranch_vccnz gather_97
v_smfmac_f32_16x16x64_bf16 v[8:11], v[32:35], v[64:71], v1
ds_write_b128 v0, v[32:35] offset:2048
buffer_load_dwordx4 v[64:67], v0, s[4:7], s67 offen offset:0 sc1
v_smfmac_f32_16x16x64_bf16 v[12:15], v[32:35], v[72:79], v1
ds_write_b128 v0, v[36:39] offset:6144
v_smfmac_f32_16x16x64_bf16 v[20:23], v[32:35], v[56:63], v1
buffer_load_dwordx4 v[68:71], v0, s[4:7], s67 offen offset:1024 sc1
s_waitcnt lgkmcnt(2)
v_smfmac_f32_16x16x64_bf16 v[24:27], v[32:35], v[80:87], v1
v_smfmac_f32_16x16x64_bf16 v[8:11], v[36:39], a[8:15], v1
ds_read_b128 v[80:83], v2 offset:2048
buffer_load_dwordx4 v[72:75], v0, s[4:7], s67 offen offset:2048 sc1
v_smfmac_f32_16x16x64_bf16 v[16:19], v[32:35], v[48:55], v1
s_waitcnt lgkmcnt(1)
ds_read_b128 v[84:87], v2 offset:3072
buffer_load_dwordx4 v[76:79], v0, s[4:7], s67 offen offset:3072 sc1
v_smfmac_f32_16x16x64_bf16 v[16:19], v[36:39], a[24:31], v1
buffer_load_dwordx4 v[48:51], v0, s[4:7], s24 offen offset:0 nt sc1
buffer_load_dwordx4 v[52:55], v0, s[4:7], s24 offen offset:1024 nt sc1
v_smfmac_f32_16x16x64_bf16 v[28:31], v[32:35], a[0:7], v1
s_barrier
ds_read_b128 v[40:43], v0 offset:3072
v_smfmac_f32_16x16x64_bf16 v[28:31], v[36:39], a[40:47], v1
s_waitcnt lgkmcnt(1)
ds_read_b128 v[44:47], v0 offset:7168
ds_read_b128 v[32:35], v0 offset:0
v_smfmac_f32_16x16x64_bf16 v[24:27], v[36:39], v[80:87], v1
v_smfmac_f32_16x16x64_bf16 v[12:15], v[36:39], a[16:23], v1
ds_read_b128 v[84:87], v2 offset:5120
ds_read_b128 v[80:83], v2 offset:4096
v_smfmac_f32_16x16x64_bf16 v[20:23], v[36:39], a[32:39], v1
ds_read_b128 v[36:39], v0 offset:4096
s_waitcnt lgkmcnt(5)
v_smfmac_f32_16x16x64_bf16 v[8:11], v[40:43], a[48:55], v1
buffer_load_dwordx4 v[56:59], v0, s[4:7], s24 offen offset:2048 nt sc1
v_smfmac_f32_16x16x64_bf16 v[12:15], v[40:43], a[56:63], v1
s_waitcnt lgkmcnt(4)
ds_read_b128 v[40:43], v0 offset:1024
s_xor_b32 s18, s18, 1
v_smfmac_f32_16x16x64_bf16 v[12:15], v[44:47], a[72:79], v1
s_waitcnt lgkmcnt(4)
buffer_load_dwordx4 v[60:63], v0, s[4:7], s24 offen offset:3072 nt sc1
v_smfmac_f32_16x16x64_bf16 v[8:11], v[44:47], a[64:71], v1
s_waitcnt lgkmcnt(3)
s_waitcnt lgkmcnt(2)
v_smfmac_f32_16x16x64_bf16 v[8:11], v[32:35], v[80:87], v1
s_waitcnt vmcnt(7)
ds_read_b128 v[84:87], v2 offset:7168
s_add_u32 s24, s24, 524288
v_smfmac_f32_16x16x64_bf16 v[12:15], v[32:35], a[80:87], v1
ds_read_b128 v[32:35], v0 offset:5120
s_waitcnt lgkmcnt(2)
v_smfmac_f32_16x16x64_bf16 v[8:11], v[36:39], a[88:95], v1
ds_read_b128 v[80:83], v2 offset:6144
v_smfmac_f32_16x16x64_bf16 v[12:15], v[36:39], a[96:103], v1
s_waitcnt vmcnt(6)
ds_read_b128 v[36:39], v0 offset:8192
v_smfmac_f32_16x16x64_bf16 v[8:11], v[40:43], v[64:71], v1
ds_read_b128 v[64:67], v2 offset:8192
ds_read_b128 v[68:71], v2 offset:9216
v_smfmac_f32_16x16x64_bf16 v[12:15], v[40:43], a[104:111], v1
ds_read_b128 v[40:43], v0 offset:9216
s_waitcnt lgkmcnt(5)
v_smfmac_f32_16x16x64_bf16 v[12:15], v[32:35], a[112:119], v1
s_waitcnt lgkmcnt(4)
buffer_load_dword v7, v7, s[4:7], 0 offen sc1
v_smfmac_f32_16x16x64_bf16 v[8:11], v[32:35], v[80:87], v1
s_waitcnt lgkmcnt(3)
ds_read_b128 v[32:35], v0 offset:3072
ds_read_b128 v[84:87], v2 offset:11264
v_smfmac_f32_16x16x64_bf16 v[8:11], v[36:39], a[120:127], v1
ds_read_b128 v[80:83], v2 offset:10240
v_smfmac_f32_16x16x64_bf16 v[12:15], v[36:39], a[128:135], v1
s_waitcnt lgkmcnt(4)
ds_read_b128 v[36:39], v0 offset:7168
s_waitcnt lgkmcnt(4)
v_smfmac_f32_16x16x64_bf16 v[8:11], v[40:43], v[64:71], v1
s_waitcnt vmcnt(5)
ds_read_b128 v[64:67], v2 offset:12288
ds_read_b128 v[68:71], v2 offset:13312
v_smfmac_f32_16x16x64_bf16 v[12:15], v[40:43], a[136:143], v1
s_waitcnt lgkmcnt(5)
ds_read_b128 v[40:43], v0 offset:0
v_smfmac_f32_16x16x64_bf16 v[16:19], v[32:35], v[72:79], v1
s_nop 0
ds_read_b128 v[72:75], v2 offset:14336
v_add_f32 v9, v9, v11
v_add_f32 v8, v8, v10
s_nop 0
v_add_f32 v13, v13, v15
v_add_f32 v12, v12, v14
v_mul_f32 v9, s44, v9
s_waitcnt lgkmcnt(4)
v_mul_f32 v8, s44, v8
v_mul_f32 v12, s44, v12
v_mul_f32 v13, s44, v13
v_cvt_pk_bf16_f32 v12, v12, v13
v_cvt_pk_bf16_f32 v8, v8, v9
v_smfmac_f32_16x16x64_bf16 v[20:23], v[32:35], v[80:87], v1
s_add_u32 s17, s17, 1
ds_read_b128 v[32:35], v0 offset:4096
ds_write2_b32 v3, v8, v12 offset0:0 offset1:128
v_smfmac_f32_16x16x64_bf16 v[16:19], v[36:39], a[144:151], v1
ds_read_b128 v[80:83], v2 offset:16384
v_smfmac_f32_16x16x64_bf16 v[20:23], v[36:39], a[152:159], v1
ds_read_b128 v[36:39], v0 offset:1024
ds_read_b128 v[76:79], v2 offset:15360
s_waitcnt vmcnt(3)
s_waitcnt lgkmcnt(4)
v_smfmac_f32_16x16x64_bf16 v[16:19], v[40:43], a[160:167], v1
ds_read_b128 v[84:87], v2 offset:17408
v_smfmac_f32_16x16x64_bf16 v[20:23], v[40:43], v[64:71], v1
s_waitcnt lgkmcnt(4)
ds_read_b128 v[40:43], v0 offset:5120
ds_read_b128 v[64:67], v2 offset:18432
v_smfmac_f32_16x16x64_bf16 v[16:19], v[32:35], a[168:175], v1
s_barrier
v_smfmac_f32_16x16x64_bf16 v[20:23], v[32:35], a[176:183], v1
s_waitcnt lgkmcnt(3)
ds_read_b128 v[32:35], v0 offset:8192
ds_read_b64_tr_b16 v[12:13], v4 offset:3072
v_smfmac_f32_16x16x64_bf16 v[16:19], v[36:39], a[184:191], v1
ds_read_b64_tr_b16 v[10:11], v4 offset:2560
v_smfmac_f32_16x16x64_bf16 v[20:23], v[36:39], v[72:79], v1
s_waitcnt lgkmcnt(4)
ds_read_b128 v[36:39], v0 offset:9216
ds_read_b64_tr_b16 v[8:9], v4 offset:2048
v_smfmac_f32_16x16x64_bf16 v[16:19], v[40:43], a[192:199], v1
ds_read_b64_tr_b16 v[14:15], v4 offset:3584
ds_read_b128 v[76:79], v2 offset:21504
v_smfmac_f32_16x16x64_bf16 v[20:23], v[40:43], a[200:207], v1
ds_read_b128 v[40:43], v0 offset:3072
s_waitcnt lgkmcnt(7)
v_smfmac_f32_16x16x64_bf16 v[20:23], v[32:35], v[80:87], v1
ds_read_b128 v[68:71], v2 offset:19456
ds_read_b128 v[84:87], v2 offset:23552
v_smfmac_f32_16x16x64_bf16 v[16:19], v[32:35], a[208:215], v1
s_waitcnt lgkmcnt(6)
ds_read_b128 v[72:75], v2 offset:20480
v_smfmac_f32_16x16x64_bf16 v[20:23], v[36:39], a[224:231], v1
s_waitcnt lgkmcnt(6)
ds_read_b128 v[32:35], v0 offset:7168
ds_read_b128 v[80:83], v2 offset:22528
v_smfmac_f32_16x16x64_bf16 v[16:19], v[36:39], a[216:223], v1
ds_read_b128 v[36:39], v0 offset:0
s_waitcnt lgkmcnt(7)
v_mfma_f32_16x16x32_bf16 v[44:47], v[48:51], v[8:11], 0
s_nop 0
v_add_f32 v20, v20, v22
v_add_f32 v21, v21, v23
v_mfma_f32_16x16x32_bf16 v[44:47], v[52:55], v[12:15], v[44:47]
s_nop 0
v_add_f32 v17, v17, v19
v_add_f32 v16, v16, v18
s_waitcnt lgkmcnt(5)
v_cvt_pk_bf16_f32 v20, v20, v21
v_smfmac_f32_16x16x64_bf16 v[28:31], v[40:43], a[232:239], v1
s_mov_b64 exec, s[54:55]
s_nop 0
ds_write_b128 v5, v[44:47] offset:1024
s_mov_b64 exec, -1
v_smfmac_f32_16x16x64_bf16 v[24:27], v[40:43], v[64:71], v1
s_waitcnt lgkmcnt(3)
ds_read_b128 v[40:43], v0 offset:4096
v_cvt_pk_bf16_f32 v16, v16, v17
v_smfmac_f32_16x16x64_bf16 v[24:27], v[32:35], a[240:247], v1
ds_write2_b32 v3, v16, v20 offset0:1 offset1:129
v_smfmac_f32_16x16x64_bf16 v[28:31], v[32:35], v[72:79], v1
s_waitcnt lgkmcnt(3)
ds_read_b128 v[32:35], v0 offset:1024
buffer_load_dwordx4 v[64:67], v0, s[4:7], s68 offen offset:0 sc1
v_smfmac_f32_16x16x64_bf16 v[24:27], v[36:39], a[248:255], v1
buffer_load_dwordx4 v[68:71], v0, s[4:7], s68 offen offset:1024 sc1
v_smfmac_f32_16x16x64_bf16 v[28:31], v[36:39], v[88:95], v1
ds_read_b128 v[36:39], v0 offset:5120
s_waitcnt lgkmcnt(3)
v_smfmac_f32_16x16x64_bf16 v[24:27], v[40:43], v[96:103], v1
s_mov_b32 s20, 395264
buffer_load_dwordx4 v[72:75], v0, s[4:7], s68 offen offset:2048 sc1
v_smfmac_f32_16x16x64_bf16 v[28:31], v[40:43], v[80:87], v1
s_waitcnt lgkmcnt(2)
ds_read_b128 v[40:43], v0 offset:8192
s_waitcnt lgkmcnt(2)
v_smfmac_f32_16x16x64_bf16 v[28:31], v[32:35], v[112:119], v1
s_barrier
ds_read_b128 v[52:55], v6 offset:1024
v_smfmac_f32_16x16x64_bf16 v[24:27], v[32:35], v[104:111], v1
s_waitcnt lgkmcnt(2)
ds_read_b128 v[32:35], v0 offset:9216
ds_read_b128 v[48:51], v6 offset:0
v_smfmac_f32_16x16x64_bf16 v[24:27], v[36:39], v[120:127], v1
ds_read_b64_tr_b16 v[8:9], v4 offset:0
ds_read_b64_tr_b16 v[10:11], v4 offset:512
v_smfmac_f32_16x16x64_bf16 v[28:31], v[36:39], v[128:135], v1
s_waitcnt lgkmcnt(5)
buffer_load_dwordx4 v[76:79], v0, s[4:7], s68 offen offset:3072 sc1
v_smfmac_f32_16x16x64_bf16 v[28:31], v[40:43], v[144:151], v1
buffer_load_dwordx4 v[80:83], v0, s[4:7], s69 offen offset:0 sc1
ds_read_b64_tr_b16 v[20:21], v4 offset:3072
ds_read_b64_tr_b16 v[18:19], v4 offset:2560
v_smfmac_f32_16x16x64_bf16 v[24:27], v[40:43], v[136:143], v1
s_waitcnt lgkmcnt(5)
ds_read_b64_tr_b16 v[12:13], v4 offset:1024
ds_read_b64_tr_b16 v[14:15], v4 offset:1536
v_smfmac_f32_16x16x64_bf16 v[28:31], v[32:35], v[160:167], v1
s_waitcnt lgkmcnt(6)
ds_read_b64_tr_b16 v[16:17], v4 offset:2048
v_add_f32 v48, v48, v52
v_smfmac_f32_16x16x64_bf16 v[24:27], v[32:35], v[152:159], v1
s_waitcnt lgkmcnt(5)
ds_read_b64_tr_b16 v[22:23], v4 offset:3584
v_add_f32 v51, v51, v55
v_exp_f32 v48, v48
v_add_f32 v50, v50, v54
v_exp_f32 v51, v51
v_exp_f32 v50, v50
v_mfma_f32_16x16x32_bf16 v[44:47], v[8:11], v[8:11], 0
s_waitcnt lgkmcnt(1)
v_cvt_pk_bf16_f32 v55, v50, v51
v_add_f32 v49, v49, v53
v_mfma_f32_16x16x32_bf16 v[44:47], v[12:15], v[12:15], v[44:47]
s_waitcnt vmcnt(6)
v_exp_f32 v49, v49
v_mfma_f32_16x16x32_bf16 v[44:47], v[16:19], v[16:19], v[44:47]
s_waitcnt lgkmcnt(0)
v_cvt_pk_bf16_f32 v54, v48, v49
v_mov_b32_dpp v51, v55 quad_perm:[2,3,2,3] row_mask:0xf bank_mask:0xf
v_mfma_f32_16x16x32_bf16 v[44:47], v[20:23], v[20:23], v[44:47]
v_mov_b32_dpp v50, v54 quad_perm:[2,3,2,3] row_mask:0xf bank_mask:0xf
v_mov_b32_dpp v48, v54 quad_perm:[0,1,0,1] row_mask:0xf bank_mask:0xf
v_mov_b32_dpp v49, v55 quad_perm:[0,1,0,1] row_mask:0xf bank_mask:0xf
v_mov_b64 v[22:23], s[56:57]
v_mov_b64 v[54:55], s[58:59]
v_mfma_f32_16x16x32_bf16 v[12:15], v[60:63], v[48:51], 0
s_nop 0
v_mov_b64 v[20:21], s[56:57]
v_exp_f32_dpp v44, v46 quad_perm:[0,1,0,1] row_mask:0xf bank_mask:0xf
v_mfma_f32_16x16x32_bf16 v[8:11], v[56:59], v[48:51], 0
v_exp_f32_dpp v45, v47 quad_perm:[0,1,0,1] row_mask:0xf bank_mask:0xf
v_mfma_f32_16x16x32_bf16 v[16:19], v[20:23], v[48:51], 0
s_nop 0
v_cvt_pk_bf16_f32 v53, v44, v45
v_cvt_pk_bf16_f32 v24, v24, v25
v_cvt_pk_bf16_f32 v52, v44, v45
v_cvt_pk_bf16_f32 v25, v26, v27
v_mov_b64 v[38:39], 0
v_mfma_f32_16x16x16_bf16 v[16:19], v[54:55], v[52:53], v[16:19]
s_nop 0
v_cvt_pk_bf16_f32 v27, v30, v31
v_cvt_pk_bf16_f32 v26, v28, v29
v_mfma_f32_16x16x16_bf16 v[8:11], v[24:25], v[52:53], v[8:11]
s_nop 0
buffer_load_dwordx4 v[84:87], v0, s[4:7], s69 offen offset:1024 sc1
v_mfma_f32_16x16x16_bf16 v[12:15], v[26:27], v[52:53], v[12:15]
s_barrier
v_rcp_f32 v18, v16
v_subrev_u32 v17, s46, v16
v_mov_b64 v[40:41], 0
v_mov_b64 v[34:35], 0
v_mul_f32 v8, v8, v18
v_mul_f32 v9, v9, v18
v_cvt_pk_bf16_f32 v8, v8, v9
v_mul_f32 v10, v10, v18
v_mul_f32 v13, v13, v18
v_mul_f32 v11, v11, v18
v_cvt_pk_bf16_f32 v9, v10, v11
v_mul_f32 v12, v12, v18
v_cmp_lt_u32 vcc, s47, v17
v_mul_f32 v14, v14, v18
v_mul_f32 v15, v15, v18
v_cvt_pk_bf16_f32 v11, v14, v15
v_mov_b64 v[32:33], 0
s_waitcnt vmcnt(4)
v_cvt_pk_bf16_f32 v10, v12, v13
s_cbranch_vccnz rare_98
back_99:
s_mov_b64 exec, s[54:55]
ds_write_b128 v5, v[8:11] offset:1024
s_mov_b64 exec, -1
v_mov_b64 v[48:49], 0
v_mov_b64 v[50:51], 0
v_smfmac_f32_16x16x64_bf16 v[32:35], v[8:11], v[64:71], v1
s_add_u32 s25, s25, 10240
ds_read_b128 v[16:19], v2 offset:24576
v_mov_b64 v[36:37], 0
v_mov_b64 v[42:43], 0
v_smfmac_f32_16x16x64_bf16 v[48:51], v[8:11], v[176:183], v1
ds_read_b128 v[28:31], v2 offset:27648
buffer_load_dwordx4 v[64:67], v0, s[4:7], s65 offen offset:0 sc1
ds_read_b128 v[24:27], v2 offset:26624
v_smfmac_f32_16x16x64_bf16 v[40:43], v[8:11], v[168:175], v1
ds_read_b128 v[20:23], v2 offset:25600
s_add_u32 s43, s17, 2
s_waitcnt lgkmcnt(4)
s_barrier
ds_read_b128 v[56:59], v5 offset:1536
buffer_load_dwordx4 v[68:71], v0, s[4:7], s65 offen offset:1024 sc1
s_waitcnt vmcnt(4)
ds_read_b128 v[12:15], v5 offset:512
v_smfmac_f32_16x16x64_bf16 v[36:39], v[8:11], v[72:79], v1
s_waitcnt lgkmcnt(5)
ds_read_b128 v[60:63], v5 offset:0
v_mov_b64 v[54:55], 0
s_waitcnt lgkmcnt(3)
s_mov_b32 s37, 0
s_mov_b32 s19, 1
buffer_load_dwordx4 v[72:75], v0, s[4:7], s65 offen offset:2048 sc1
v_bfe_u32 v45, v0, 1, 7
v_mov_b64 v[52:53], 0
s_waitcnt lgkmcnt(2)
v_smfmac_f32_16x16x64_bf16 v[32:35], v[56:59], v[16:23], v1
buffer_load_dwordx4 v[76:79], v0, s[4:7], s65 offen offset:3072 sc1
ds_read_b128 v[16:19], v2 offset:30720
v_smfmac_f32_16x16x64_bf16 v[48:51], v[56:59], v[216:223], v1
s_waitcnt lgkmcnt(2)
ds_read_b128 v[20:23], v2 offset:31744
v_lshrrev_b32 v44, 8, v0
s_waitcnt vmcnt(5)
s_waitcnt vmcnt(4)
v_smfmac_f32_16x16x64_bf16 v[52:55], v[8:11], v[80:87], v1
s_waitcnt lgkmcnt(2)
ds_read_b128 v[84:87], v2 offset:29696
s_mov_b32 s21, 399360
v_smfmac_f32_16x16x64_bf16 v[32:35], v[60:63], v[24:31], v1
ds_read_b128 v[80:83], v2 offset:28672
s_min_u32 s43, s43, s39
v_smfmac_f32_16x16x64_bf16 v[32:35], v[12:15], v[184:191], v1
s_waitcnt lgkmcnt(3)
ds_read_b128 v[24:27], v2 offset:32768
s_waitcnt lgkmcnt(3)
v_smfmac_f32_16x16x64_bf16 v[40:43], v[56:59], v[16:23], v1
ds_read_b128 v[28:31], v2 offset:33792
v_lshl_or_b32 v44, v44, 12, v45
v_smfmac_f32_16x16x64_bf16 v[36:39], v[56:59], v[192:199], v1
s_waitcnt lgkmcnt(3)
v_cvt_pk_bf16_f32 v32, v32, v33
v_cvt_pk_bf16_f32 v33, v34, v35
v_and_or_b32 v32, v32, -2, s18
s_waitcnt lgkmcnt(2)
v_smfmac_f32_16x16x64_bf16 v[36:39], v[60:63], v[80:87], v1
buffer_store_dwordx2 v[32:33], v44, s[4:7], s60 offen
v_smfmac_f32_16x16x64_bf16 v[36:39], v[12:15], v[200:207], v1
s_waitcnt lgkmcnt(1)
s_waitcnt lgkmcnt(0)
ds_read_b128 v[80:83], v2 offset:34816
v_smfmac_f32_16x16x64_bf16 v[40:43], v[60:63], v[24:31], v1
s_nop 0
ds_read_b128 v[84:87], v2 offset:35840
s_add_u32 s34, s24, 524288
s_nop 0
v_cvt_pk_bf16_f32 v36, v36, v37
v_and_or_b32 v36, v36, -2, s18
v_cvt_pk_bf16_f32 v37, v38, v39
v_smfmac_f32_16x16x64_bf16 v[40:43], v[12:15], v[208:215], v1
buffer_store_dwordx2 v[36:37], v44, s[4:7], s61 offen
v_smfmac_f32_16x16x64_bf16 v[52:55], v[56:59], v[232:239], v1
s_nop 2
v_smfmac_f32_16x16x64_bf16 v[52:55], v[60:63], v[240:247], v1
s_nop 0
s_waitcnt lgkmcnt(0)
v_cvt_pk_bf16_f32 v40, v40, v41
v_cvt_pk_bf16_f32 v41, v42, v43
v_and_or_b32 v40, v40, -2, s18
v_smfmac_f32_16x16x64_bf16 v[48:51], v[60:63], v[80:87], v1
buffer_store_dwordx2 v[40:41], v44, s[4:7], s62 offen
v_smfmac_f32_16x16x64_bf16 v[48:51], v[12:15], v[224:231], v1
s_nop 2
v_smfmac_f32_16x16x64_bf16 v[52:55], v[12:15], v[248:255], v1
s_nop 3
v_cvt_pk_bf16_f32 v48, v48, v49
v_and_or_b32 v48, v48, -2, s18
v_cvt_pk_bf16_f32 v49, v50, v51
buffer_store_dwordx2 v[48:49], v44, s[4:7], s63 offen
v_cvt_pk_bf16_f32 v52, v52, v53
v_cvt_pk_bf16_f32 v53, v54, v55
v_and_or_b32 v52, v52, -2, s18
buffer_store_dwordx2 v[52:53], v44, s[4:7], s64 offen
v_bfe_u32 v34, v0, 6, 1
v_lshlrev_b32 v34, 4, v34
v_mov_b32 v35, 0x3f80
v_lshlrev_b32 v34, v34, v35
v_bfe_i32 v35, v0, 4, 1
v_and_b32 v45, v34, v35
v_and_b32 v47, v34, v35
v_xor_b32 v44, v34, v45
v_xor_b32 v46, v34, v45
v_and_b32 v36, 32, v0
v_bfe_u32 v37, v0, 6, 1
v_lshl_add_u32 v36, v37, 8, v36
v_bfe_u32 v37, v0, 8, 1
v_lshl_add_u32 v36, v37, 4, v36
v_bfe_u32 v37, v0, 4, 1
v_lshl_add_u32 v36, v37, 3, v36
ds_read_b128 v[80:83], v2 offset:0
ds_read_b128 v[84:87], v2 offset:1024
v_mov_b64 v[24:25], 0
v_mov_b64 v[26:27], 0
v_mov_b64 v[28:29], 0
v_mov_b64 v[30:31], 0
v_cmp_gt_u32 vcc, s43, v7
s_cmp_eq_u32 vcc_hi, 0
s_cbranch_scc1 kv_111
s_mov_b32 s37, 0
kv_110:
v_bfe_u32 v7, v0, 2, 3
buffer_load_dword v7, v7, s[4:7], s28 offen sc1
s_add_u32 s37, s37, 1
s_cmp_gt_u32 s37, 262144
s_cbranch_scc1 L_fail
s_waitcnt vmcnt(0)
v_cmp_gt_u32 vcc, s43, v7
s_cbranch_vccnz kv_110
kv_111:
s_mov_b32 s37, 0
v_bfe_u32 v7, v0, 2, 3
v_add_u32 v7, s28, v7
s_mov_b32 exec_hi, 0
v_and_b32 v7, 255, v0
v_lshl_add_u32 v7, v7, 3, s34
s_mov_b32 exec_hi, -1
s_nop 15
s_nop 15
s_nop 15
s_nop 9
s_cmp_ge_u32 s15, 16
s_cbranch_scc1 nored_105
buffer_load_dwordx4 v[8:11], v0, s[4:7], s27 offen offset:0 sc1
buffer_load_dwordx4 v[12:15], v0, s[4:7], s27 offen offset:1024 sc1
buffer_load_dwordx4 v[16:19], v0, s[4:7], s27 offen offset:2048 sc1
buffer_load_dwordx4 v[20:23], v0, s[4:7], s27 offen offset:3072 sc1
s_barrier
buffer_load_dwordx4 v[48:51], v0, s[4:7], s66 offen offset:0 sc1
buffer_load_dwordx4 v[52:55], v0, s[4:7], s66 offen offset:1024 sc1
buffer_load_dwordx4 v[56:59], v0, s[4:7], s66 offen offset:2048 sc1
buffer_load_dwordx4 v[60:63], v0, s[4:7], s66 offen offset:3072 sc1
v_mov_b64 v[40:41], 0
v_mov_b64 v[42:43], 0
s_waitcnt vmcnt(6)
s_nop 0
v_smfmac_f32_16x16x64_bf16 v[40:43], v[44:47], v[8:15], v1
v_bitop3_b32 v34, v8, v10, s18 bitop3:0x7e
v_bitop3_b32 v35, v12, v14, s18 bitop3:0x7e
s_waitcnt vmcnt(4)
v_smfmac_f32_16x16x64_bf16 v[40:43], v[44:47], v[16:23], v1
v_bitop3_b32 v32, v16, v18, s18 bitop3:0x7e
v_bitop3_b32 v33, v20, v22, s18 bitop3:0x7e
v_or3_b32 v34, v34, v35, v32
v_bitop3_b32 v34, v34, v33, 1 bitop3:0xa8
v_cmp_ne_u32 vcc, 0, v34
s_cbranch_vccnz red_104
red_104_ok:
s_nop 1
v_add_f32_dpp v40, v40, v40 row_ror:8 row_mask:0xf bank_mask:0xf
v_add_f32_dpp v41, v41, v41 row_ror:8 row_mask:0xf bank_mask:0xf
v_add_f32_dpp v42, v42, v42 row_ror:8 row_mask:0xf bank_mask:0xf
v_add_f32_dpp v43, v43, v43 row_ror:8 row_mask:0xf bank_mask:0xf
v_cvt_pk_bf16_f32 v40, v40, v41
v_cvt_pk_bf16_f32 v41, v42, v43
v_and_or_b32 v40, v40, -2, s18
s_mov_b64 exec, 0x00ff00ff
buffer_store_dwordx2 v[40:41], v36, s[4:7], s40 offen
s_mov_b64 exec, -1
s_branch g2_106
nored_105:
s_barrier
buffer_load_dwordx4 v[48:51], v0, s[4:7], s66 offen offset:0 sc1
buffer_load_dwordx4 v[52:55], v0, s[4:7], s66 offen offset:1024 sc1
buffer_load_dwordx4 v[56:59], v0, s[4:7], s66 offen offset:2048 sc1
buffer_load_dwordx4 v[60:63], v0, s[4:7], s66 offen offset:3072 sc1
g2_106:
v_mov_b64 v[8:9], 0
v_mov_b64 v[10:11], 0
v_mov_b64 v[12:13], 0
v_mov_b64 v[14:15], 0
v_mov_b64 v[16:17], 0
v_mov_b64 v[18:19], 0
v_mov_b64 v[20:21], 0
v_mov_b64 v[22:23], 0
s_mov_b32 s37, 0
s_cmp_eq_u32 s17, s38
s_barrier
s_nop 15
s_nop 7
s_cbranch_scc0 gather_97
s_branch exit_100
red_104:
buffer_load_dwordx4 v[8:11], v0, s[4:7], s27 offen offset:0 sc1
buffer_load_dwordx4 v[12:15], v0, s[4:7], s27 offen offset:1024 sc1
buffer_load_dwordx4 v[16:19], v0, s[4:7], s27 offen offset:2048 sc1
buffer_load_dwordx4 v[20:23], v0, s[4:7], s27 offen offset:3072 sc1
s_add_u32 s37, s37, 1
s_cmp_gt_u32 s37, 262144
s_cbranch_scc1 L_fail
v_mov_b64 v[40:41], 0
v_mov_b64 v[42:43], 0
s_waitcnt vmcnt(2)
s_nop 0
v_smfmac_f32_16x16x64_bf16 v[40:43], v[44:47], v[8:15], v1
v_bitop3_b32 v34, v8, v10, s18 bitop3:0x7e
v_bitop3_b32 v35, v12, v14, s18 bitop3:0x7e
s_waitcnt vmcnt(0)
v_smfmac_f32_16x16x64_bf16 v[40:43], v[44:47], v[16:23], v1
v_bitop3_b32 v32, v16, v18, s18 bitop3:0x7e
v_bitop3_b32 v33, v20, v22, s18 bitop3:0x7e
v_or3_b32 v34, v34, v35, v32
v_bitop3_b32 v34, v34, v33, 1 bitop3:0xa8
v_cmp_ne_u32 vcc, 0, v34
s_cbranch_vccnz red_104
s_branch red_104_ok
rare_98:
ds_read_b128 v[48:51], v6 offset:0
ds_read_b128 v[52:55], v6 offset:1024
s_waitcnt lgkmcnt(0)
s_barrier
v_add_f32 v48, v48, v52
v_add_f32 v49, v49, v53
v_add_f32 v50, v50, v54
v_add_f32 v51, v51, v55
v_mov_b32_dpp v46, v46 quad_perm:[0,1,0,1] row_mask:0xf bank_mask:0xf
v_mov_b32_dpp v47, v47 quad_perm:[0,1,0,1] row_mask:0xf bank_mask:0xf
v_max3_f32 v19, v48, v49, v50
v_max3_f32 v19, v19, v51, v46
v_max_f32 v19, v19, v47
s_nop 1
v_max_f32_dpp v19, v19, v19 quad_perm:[2,3,0,1] row_mask:0xf bank_mask:0xf
v_mov_b32 v44, v19
s_nop 1
v_permlane32_swap_b32 v19, v44
v_max_f32 v19, v19, v44
v_mov_b32 v44, v19
s_nop 1
v_permlane16_swap_b32 v19, v44
v_max_f32 v19, v19, v44
v_sub_f32 v48, v48, v19
v_sub_f32 v49, v49, v19
v_sub_f32 v50, v50, v19
v_sub_f32 v51, v51, v19
v_sub_f32 v46, v46, v19
v_sub_f32 v47, v47, v19
v_exp_f32 v48, v48
v_exp_f32 v49, v49
v_exp_f32 v50, v50
v_exp_f32 v51, v51
v_cvt_pk_bf16_f32 v54, v48, v49
v_cvt_pk_bf16_f32 v55, v50, v51
s_nop 0
v_mov_b32_dpp v48, v54 quad_perm:[0,1,0,1] row_mask:0xf bank_mask:0xf
v_mov_b32_dpp v49, v55 quad_perm:[0,1,0,1] row_mask:0xf bank_mask:0xf
v_mov_b32_dpp v50, v54 quad_perm:[2,3,2,3] row_mask:0xf bank_mask:0xf
v_mov_b32_dpp v51, v55 quad_perm:[2,3,2,3] row_mask:0xf bank_mask:0xf
v_mov_b64 v[20:21], s[56:57]
v_mov_b64 v[22:23], s[56:57]
v_mfma_f32_16x16x32_bf16 v[8:11], v[56:59], v[48:51], 0
v_mfma_f32_16x16x32_bf16 v[12:15], v[60:63], v[48:51], 0
v_mfma_f32_16x16x32_bf16 v[16:19], v[20:23], v[48:51], 0
v_mov_b64 v[54:55], s[58:59]
v_exp_f32_dpp v44, v46 quad_perm:[0,1,0,1] row_mask:0xf bank_mask:0xf
v_exp_f32_dpp v45, v47 quad_perm:[0,1,0,1] row_mask:0xf bank_mask:0xf
s_nop 0
v_cvt_pk_bf16_f32 v52, v44, v45
v_cvt_pk_bf16_f32 v53, v44, v45
s_nop 1
v_mfma_f32_16x16x16_bf16 v[16:19], v[54:55], v[52:53], v[16:19]
v_mfma_f32_16x16x16_bf16 v[8:11], v[24:25], v[52:53], v[8:11]
v_mfma_f32_16x16x16_bf16 v[12:15], v[26:27], v[52:53], v[12:15]
s_nop 5
v_rcp_f32 v18, v16
s_nop 0
v_mul_f32 v8, v8, v18
v_mul_f32 v9, v9, v18
v_mul_f32 v10, v10, v18
v_mul_f32 v11, v11, v18
v_mul_f32 v12, v12, v18
v_mul_f32 v13, v13, v18
v_mul_f32 v14, v14, v18
v_mul_f32 v15, v15, v18
v_cvt_pk_bf16_f32 v8, v8, v9
v_cvt_pk_bf16_f32 v9, v10, v11
v_cvt_pk_bf16_f32 v10, v12, v13
v_cvt_pk_bf16_f32 v11, v14, v15
s_branch back_99
exit_100:
buffer_load_dwordx4 v[32:35], v0, s[4:7], s20 offen sc1
buffer_load_dwordx4 v[36:39], v0, s[4:7], s21 offen sc1
s_add_u32 s37, s37, 1
s_cmp_gt_u32 s37, 262144
s_cbranch_scc1 L_fail
s_waitcnt vmcnt(1)
v_bitop3_b32 v44, v32, v34, s18 bitop3:0x7e
s_waitcnt vmcnt(0)
v_bitop3_b32 v45, v36, v38, s18 bitop3:0x7e
v_bitop3_b32 v44, v44, v45, s19 bitop3:0xa8
v_cmp_ne_u32 vcc, 0, v44
s_cbranch_vccnz exit_100
ds_write_b128 v0, v[32:35] offset:2048
ds_write_b128 v0, v[36:39] offset:6144
s_waitcnt lgkmcnt(0)
s_barrier
s_barrier
s_add_u32 s45, s45, 1
s_cmp_lt_u32 s45, 2
s_cbranch_scc1 layer_96
s_endpgm
wave_69:
layer_112:
s_lshl_b32 s17, s45, 6
s_mul_i32 s34, s45, 34603008
s_lshl_b32 s35, s15, 14
s_add_u32 s34, s34, s35
s_add_u32 s24, s34, 16789504
s_mul_i32 s34, s17, 10240
s_add_u32 s34, s34, s30
s_add_u32 s25, s34, s31
s_mov_b32 s19, 0
s_add_u32 s43, s17, 2
s_add_u32 s38, s17, 63
s_add_u32 s39, s17, 64
s_add_u32 s34, s24, 524288
v_mov_b32 v7, 0
s_mov_b32 s20, 412672
s_mov_b32 s21, 416768
v_cmp_gt_u32 vcc, s43, v7
s_cmp_eq_u32 vcc_hi, 0
s_cbranch_scc1 kv_119
s_mov_b32 s37, 0
kv_118:
v_bfe_u32 v7, v0, 2, 3
buffer_load_dword v7, v7, s[4:7], s28 offen sc1
s_add_u32 s37, s37, 1
s_cmp_gt_u32 s37, 262144
s_cbranch_scc1 L_fail
s_waitcnt vmcnt(0)
v_cmp_gt_u32 vcc, s43, v7
s_cbranch_vccnz kv_118
kv_119:
buffer_load_dwordx4 v[64:67], v0, s[4:7], s65 offen offset:0 sc1
buffer_load_dwordx4 v[68:71], v0, s[4:7], s65 offen offset:1024 sc1
buffer_load_dwordx4 v[72:75], v0, s[4:7], s65 offen offset:2048 sc1
buffer_load_dwordx4 v[76:79], v0, s[4:7], s65 offen offset:3072 sc1
ds_read_b128 v[80:83], v2 offset:0
ds_read_b128 v[84:87], v2 offset:1024
buffer_load_dwordx4 v[48:51], v0, s[4:7], s66 offen offset:0 sc1
buffer_load_dwordx4 v[52:55], v0, s[4:7], s66 offen offset:1024 sc1
buffer_load_dwordx4 v[56:59], v0, s[4:7], s66 offen offset:2048 sc1
buffer_load_dwordx4 v[60:63], v0, s[4:7], s66 offen offset:3072 sc1
v_mov_b64 v[8:9], 0
v_mov_b64 v[10:11], 0
v_mov_b64 v[12:13], 0
v_mov_b64 v[14:15], 0
v_mov_b64 v[16:17], 0
v_mov_b64 v[18:19], 0
v_mov_b64 v[20:21], 0
v_mov_b64 v[22:23], 0
v_mov_b64 v[24:25], 0
v_mov_b64 v[26:27], 0
v_mov_b64 v[28:29], 0
v_mov_b64 v[30:31], 0
v_bfe_u32 v7, v0, 2, 3
v_add_u32 v7, s28, v7
s_mov_b32 exec_hi, 0
v_and_b32 v7, 255, v0
v_lshl_add_u32 v7, v7, 3, s34
s_mov_b32 exec_hi, -1
s_mov_b32 s37, 0
gather_113:
buffer_load_dwordx4 v[32:35], v0, s[4:7], s20 offen sc1
buffer_load_dwordx4 v[36:39], v0, s[4:7], s21 offen sc1
s_add_u32 s37, s37, 1
s_cmp_gt_u32 s37, 262144
s_cbranch_scc1 L_fail
s_waitcnt vmcnt(1)
v_bitop3_b32 v44, v32, v34, s18 bitop3:0x7e
s_waitcnt vmcnt(0)
v_bitop3_b32 v45, v36, v38, s18 bitop3:0x7e
v_bitop3_b32 v44, v44, v45, s19 bitop3:0xa8
v_cmp_ne_u32 vcc, 0, v44
s_cbranch_vccnz gather_113
v_smfmac_f32_16x16x64_bf16 v[8:11], v[32:35], v[64:71], v1
ds_write_b128 v0, v[32:35] offset:3072
buffer_load_dwordx4 v[64:67], v0, s[4:7], s67 offen offset:0 sc1
v_smfmac_f32_16x16x64_bf16 v[12:15], v[32:35], v[72:79], v1
ds_write_b128 v0, v[36:39] offset:7168
v_smfmac_f32_16x16x64_bf16 v[20:23], v[32:35], v[56:63], v1
buffer_load_dwordx4 v[68:71], v0, s[4:7], s67 offen offset:1024 sc1
s_waitcnt lgkmcnt(2)
v_smfmac_f32_16x16x64_bf16 v[24:27], v[32:35], v[80:87], v1
v_smfmac_f32_16x16x64_bf16 v[8:11], v[36:39], a[8:15], v1
ds_read_b128 v[80:83], v2 offset:2048
buffer_load_dwordx4 v[72:75], v0, s[4:7], s67 offen offset:2048 sc1
v_smfmac_f32_16x16x64_bf16 v[16:19], v[32:35], v[48:55], v1
s_waitcnt lgkmcnt(1)
ds_read_b128 v[84:87], v2 offset:3072
buffer_load_dwordx4 v[76:79], v0, s[4:7], s67 offen offset:3072 sc1
v_smfmac_f32_16x16x64_bf16 v[16:19], v[36:39], a[24:31], v1
buffer_load_dwordx4 v[48:51], v0, s[4:7], s24 offen offset:0 nt sc1
buffer_load_dwordx4 v[52:55], v0, s[4:7], s24 offen offset:1024 nt sc1
v_smfmac_f32_16x16x64_bf16 v[28:31], v[32:35], a[0:7], v1
s_barrier
ds_read_b128 v[40:43], v0 offset:2048
v_smfmac_f32_16x16x64_bf16 v[28:31], v[36:39], a[40:47], v1
s_waitcnt lgkmcnt(1)
ds_read_b128 v[44:47], v0 offset:6144
ds_read_b128 v[32:35], v0 offset:1024
v_smfmac_f32_16x16x64_bf16 v[24:27], v[36:39], v[80:87], v1
v_smfmac_f32_16x16x64_bf16 v[12:15], v[36:39], a[16:23], v1
ds_read_b128 v[84:87], v2 offset:5120
ds_read_b128 v[80:83], v2 offset:4096
v_smfmac_f32_16x16x64_bf16 v[20:23], v[36:39], a[32:39], v1
ds_read_b128 v[36:39], v0 offset:5120
s_waitcnt lgkmcnt(5)
v_smfmac_f32_16x16x64_bf16 v[8:11], v[40:43], a[48:55], v1
buffer_load_dwordx4 v[56:59], v0, s[4:7], s24 offen offset:2048 nt sc1
v_smfmac_f32_16x16x64_bf16 v[12:15], v[40:43], a[56:63], v1
s_waitcnt lgkmcnt(4)
ds_read_b128 v[40:43], v0 offset:0
s_xor_b32 s18, s18, 1
v_smfmac_f32_16x16x64_bf16 v[12:15], v[44:47], a[72:79], v1
s_waitcnt lgkmcnt(4)
buffer_load_dwordx4 v[60:63], v0, s[4:7], s24 offen offset:3072 nt sc1
v_smfmac_f32_16x16x64_bf16 v[8:11], v[44:47], a[64:71], v1
s_waitcnt lgkmcnt(3)
s_waitcnt lgkmcnt(2)
v_smfmac_f32_16x16x64_bf16 v[8:11], v[32:35], v[80:87], v1
s_waitcnt vmcnt(7)
ds_read_b128 v[84:87], v2 offset:7168
s_add_u32 s24, s24, 524288
v_smfmac_f32_16x16x64_bf16 v[12:15], v[32:35], a[80:87], v1
ds_read_b128 v[32:35], v0 offset:4096
s_waitcnt lgkmcnt(2)
v_smfmac_f32_16x16x64_bf16 v[8:11], v[36:39], a[88:95], v1
ds_read_b128 v[80:83], v2 offset:6144
v_smfmac_f32_16x16x64_bf16 v[12:15], v[36:39], a[96:103], v1
s_waitcnt vmcnt(6)
ds_read_b128 v[36:39], v0 offset:8192
v_add_u32 v44, s30, v0
v_smfmac_f32_16x16x64_bf16 v[8:11], v[40:43], v[64:71], v1
ds_read_b128 v[64:67], v2 offset:8192
ds_read_b128 v[68:71], v2 offset:9216
v_mov_b32 v47, s17
v_smfmac_f32_16x16x64_bf16 v[12:15], v[40:43], a[104:111], v1
ds_read_b128 v[40:43], v0 offset:9216
s_waitcnt lgkmcnt(5)
v_smfmac_f32_16x16x64_bf16 v[12:15], v[32:35], a[112:119], v1
s_waitcnt lgkmcnt(4)
buffer_load_dword v7, v7, s[4:7], 0 offen sc1
v_smfmac_f32_16x16x64_bf16 v[8:11], v[32:35], v[80:87], v1
s_waitcnt lgkmcnt(3)
ds_read_b128 v[32:35], v0 offset:2048
ds_read_b128 v[84:87], v2 offset:11264
v_smfmac_f32_16x16x64_bf16 v[8:11], v[36:39], a[120:127], v1
s_mov_b64 exec, 1
buffer_store_dword v47, off, s[4:7], s29 sc1
s_mov_b64 exec, -1
ds_read_b128 v[80:83], v2 offset:10240
v_smfmac_f32_16x16x64_bf16 v[12:15], v[36:39], a[128:135], v1
s_waitcnt lgkmcnt(4)
ds_read_b128 v[36:39], v0 offset:6144
s_waitcnt lgkmcnt(4)
v_smfmac_f32_16x16x64_bf16 v[8:11], v[40:43], v[64:71], v1
s_waitcnt vmcnt(6)
ds_read_b128 v[64:67], v2 offset:12288
ds_read_b128 v[68:71], v2 offset:13312
v_smfmac_f32_16x16x64_bf16 v[12:15], v[40:43], a[136:143], v1
s_waitcnt lgkmcnt(5)
ds_read_b128 v[44:47], v44
ds_read_b128 v[40:43], v0 offset:1024
v_smfmac_f32_16x16x64_bf16 v[16:19], v[32:35], v[72:79], v1
s_nop 0
ds_read_b128 v[72:75], v2 offset:14336
v_add_f32 v9, v9, v11
v_add_f32 v8, v8, v10
v_add_f32 v13, v13, v15
v_add_f32 v12, v12, v14
v_mul_f32 v9, s44, v9
s_waitcnt lgkmcnt(5)
v_mul_f32 v8, s44, v8
v_mul_f32 v12, s44, v12
v_mul_f32 v13, s44, v13
v_cvt_pk_bf16_f32 v12, v12, v13
v_cvt_pk_bf16_f32 v8, v8, v9
v_smfmac_f32_16x16x64_bf16 v[20:23], v[32:35], v[80:87], v1
s_add_u32 s17, s17, 1
ds_read_b128 v[32:35], v0 offset:5120
ds_write2_b32 v3, v8, v12 offset0:0 offset1:128
v_smfmac_f32_16x16x64_bf16 v[16:19], v[36:39], a[144:151], v1
s_waitcnt lgkmcnt(4)
ds_read_b128 v[80:83], v2 offset:16384
v_swap_b32 v45, v46
v_smfmac_f32_16x16x64_bf16 v[20:23], v[36:39], a[152:159], v1
ds_read_b128 v[36:39], v0 offset:0
ds_read_b128 v[76:79], v2 offset:15360
buffer_store_dwordx4 v[44:47], v0, s[4:7], s25 offen sc1
s_waitcnt vmcnt(5)
s_waitcnt lgkmcnt(4)
v_smfmac_f32_16x16x64_bf16 v[16:19], v[40:43], a[160:167], v1
ds_read_b128 v[84:87], v2 offset:17408
v_smfmac_f32_16x16x64_bf16 v[20:23], v[40:43], v[64:71], v1
s_waitcnt lgkmcnt(4)
ds_read_b128 v[40:43], v0 offset:4096
ds_read_b128 v[64:67], v2 offset:18432
v_smfmac_f32_16x16x64_bf16 v[16:19], v[32:35], a[168:175], v1
s_barrier
v_smfmac_f32_16x16x64_bf16 v[20:23], v[32:35], a[176:183], v1
s_waitcnt lgkmcnt(3)
ds_read_b128 v[32:35], v0 offset:8192
ds_read_b64_tr_b16 v[12:13], v4 offset:3072
v_smfmac_f32_16x16x64_bf16 v[16:19], v[36:39], a[184:191], v1
ds_read_b64_tr_b16 v[10:11], v4 offset:2560
v_smfmac_f32_16x16x64_bf16 v[20:23], v[36:39], v[72:79], v1
s_waitcnt lgkmcnt(4)
ds_read_b128 v[36:39], v0 offset:9216
ds_read_b64_tr_b16 v[8:9], v4 offset:2048
v_smfmac_f32_16x16x64_bf16 v[16:19], v[40:43], a[192:199], v1
ds_read_b64_tr_b16 v[14:15], v4 offset:3584
ds_read_b128 v[76:79], v2 offset:21504
v_smfmac_f32_16x16x64_bf16 v[20:23], v[40:43], a[200:207], v1
ds_read_b128 v[40:43], v0 offset:2048
s_waitcnt lgkmcnt(7)
v_smfmac_f32_16x16x64_bf16 v[20:23], v[32:35], v[80:87], v1
ds_read_b128 v[68:71], v2 offset:19456
ds_read_b128 v[84:87], v2 offset:23552
v_smfmac_f32_16x16x64_bf16 v[16:19], v[32:35], a[208:215], v1
s_waitcnt lgkmcnt(6)
ds_read_b128 v[72:75], v2 offset:20480
v_smfmac_f32_16x16x64_bf16 v[20:23], v[36:39], a[224:231], v1
s_waitcnt lgkmcnt(6)
ds_read_b128 v[32:35], v0 offset:6144
ds_read_b128 v[80:83], v2 offset:22528
v_smfmac_f32_16x16x64_bf16 v[16:19], v[36:39], a[216:223], v1
ds_read_b128 v[36:39], v0 offset:1024
s_waitcnt lgkmcnt(7)
v_mfma_f32_16x16x32_bf16 v[44:47], v[48:51], v[8:11], 0
s_nop 0
v_add_f32 v20, v20, v22
v_add_f32 v21, v21, v23
v_mfma_f32_16x16x32_bf16 v[44:47], v[52:55], v[12:15], v[44:47]
s_nop 0
v_add_f32 v17, v17, v19
v_add_f32 v16, v16, v18
v_xor_b32 v48, 128, v5
s_waitcnt lgkmcnt(5)
v_cvt_pk_bf16_f32 v20, v20, v21
v_smfmac_f32_16x16x64_bf16 v[28:31], v[40:43], a[232:239], v1
s_mov_b64 exec, s[54:55]
ds_write_b128 v48, v[44:47] offset:1536
s_mov_b64 exec, -1
v_smfmac_f32_16x16x64_bf16 v[24:27], v[40:43], v[64:71], v1
s_waitcnt lgkmcnt(3)
ds_read_b128 v[40:43], v0 offset:5120
v_cvt_pk_bf16_f32 v16, v16, v17
v_smfmac_f32_16x16x64_bf16 v[24:27], v[32:35], a[240:247], v1
ds_write2_b32 v3, v16, v20 offset0:1 offset1:129
v_smfmac_f32_16x16x64_bf16 v[28:31], v[32:35], v[72:79], v1
s_waitcnt lgkmcnt(3)
ds_read_b128 v[32:35], v0 offset:0
buffer_load_dwordx4 v[64:67], v0, s[4:7], s68 offen offset:0 sc1
v_smfmac_f32_16x16x64_bf16 v[24:27], v[36:39], a[248:255], v1
buffer_load_dwordx4 v[68:71], v0, s[4:7], s68 offen offset:1024 sc1
v_smfmac_f32_16x16x64_bf16 v[28:31], v[36:39], v[88:95], v1
ds_read_b128 v[36:39], v0 offset:4096
s_waitcnt lgkmcnt(3)
v_smfmac_f32_16x16x64_bf16 v[24:27], v[40:43], v[96:103], v1
s_mov_b32 s20, 396288
buffer_load_dwordx4 v[72:75], v0, s[4:7], s68 offen offset:2048 sc1
v_smfmac_f32_16x16x64_bf16 v[28:31], v[40:43], v[80:87], v1
s_waitcnt lgkmcnt(2)
ds_read_b128 v[40:43], v0 offset:8192
s_waitcnt lgkmcnt(2)
v_smfmac_f32_16x16x64_bf16 v[28:31], v[32:35], v[112:119], v1
s_barrier
ds_read_b128 v[52:55], v6 offset:1024
v_smfmac_f32_16x16x64_bf16 v[24:27], v[32:35], v[104:111], v1
s_waitcnt lgkmcnt(2)
ds_read_b128 v[32:35], v0 offset:9216
ds_read_b128 v[48:51], v6 offset:0
v_smfmac_f32_16x16x64_bf16 v[24:27], v[36:39], v[120:127], v1
ds_read_b64_tr_b16 v[8:9], v4 offset:0
ds_read_b64_tr_b16 v[10:11], v4 offset:512
v_smfmac_f32_16x16x64_bf16 v[28:31], v[36:39], v[128:135], v1
s_waitcnt lgkmcnt(5)
buffer_load_dwordx4 v[76:79], v0, s[4:7], s68 offen offset:3072 sc1
v_smfmac_f32_16x16x64_bf16 v[28:31], v[40:43], v[144:151], v1
buffer_load_dwordx4 v[80:83], v0, s[4:7], s69 offen offset:0 sc1
ds_read_b64_tr_b16 v[20:21], v4 offset:3072
ds_read_b64_tr_b16 v[18:19], v4 offset:2560
v_smfmac_f32_16x16x64_bf16 v[24:27], v[40:43], v[136:143], v1
s_waitcnt lgkmcnt(5)
ds_read_b64_tr_b16 v[12:13], v4 offset:1024
ds_read_b64_tr_b16 v[14:15], v4 offset:1536
v_smfmac_f32_16x16x64_bf16 v[28:31], v[32:35], v[160:167], v1
s_waitcnt lgkmcnt(6)
ds_read_b64_tr_b16 v[16:17], v4 offset:2048
v_add_f32 v48, v48, v52
v_smfmac_f32_16x16x64_bf16 v[24:27], v[32:35], v[152:159], v1
s_waitcnt lgkmcnt(5)
ds_read_b64_tr_b16 v[22:23], v4 offset:3584
v_add_f32 v51, v51, v55
v_exp_f32 v48, v48
v_add_f32 v50, v50, v54
v_exp_f32 v51, v51
v_exp_f32 v50, v50
v_mfma_f32_16x16x32_bf16 v[44:47], v[8:11], v[8:11], 0
s_waitcnt lgkmcnt(1)
v_cvt_pk_bf16_f32 v55, v50, v51
v_add_f32 v49, v49, v53
v_mfma_f32_16x16x32_bf16 v[44:47], v[12:15], v[12:15], v[44:47]
s_waitcnt vmcnt(8)
v_exp_f32 v49, v49
v_mfma_f32_16x16x32_bf16 v[44:47], v[16:19], v[16:19], v[44:47]
s_waitcnt lgkmcnt(0)
v_cvt_pk_bf16_f32 v54, v48, v49
v_mov_b32_dpp v51, v55 quad_perm:[2,3,2,3] row_mask:0xf bank_mask:0xf
v_mfma_f32_16x16x32_bf16 v[44:47], v[20:23], v[20:23], v[44:47]
v_mov_b32_dpp v50, v54 quad_perm:[2,3,2,3] row_mask:0xf bank_mask:0xf
v_mov_b32_dpp v48, v54 quad_perm:[0,1,0,1] row_mask:0xf bank_mask:0xf
v_mov_b32_dpp v49, v55 quad_perm:[0,1,0,1] row_mask:0xf bank_mask:0xf
v_mov_b64 v[22:23], s[56:57]
v_mov_b64 v[54:55], s[58:59]
v_mfma_f32_16x16x32_bf16 v[12:15], v[60:63], v[48:51], 0
s_nop 0
v_mov_b64 v[20:21], s[56:57]
v_exp_f32_dpp v44, v46 quad_perm:[0,1,0,1] row_mask:0xf bank_mask:0xf
v_mfma_f32_16x16x32_bf16 v[8:11], v[56:59], v[48:51], 0
v_exp_f32_dpp v45, v47 quad_perm:[0,1,0,1] row_mask:0xf bank_mask:0xf
v_mfma_f32_16x16x32_bf16 v[16:19], v[20:23], v[48:51], 0
s_nop 0
v_cvt_pk_bf16_f32 v53, v44, v45
v_cvt_pk_bf16_f32 v24, v24, v25
v_cvt_pk_bf16_f32 v52, v44, v45
v_cvt_pk_bf16_f32 v25, v26, v27
v_mov_b64 v[38:39], 0
v_mfma_f32_16x16x16_bf16 v[16:19], v[54:55], v[52:53], v[16:19]
s_nop 0
v_cvt_pk_bf16_f32 v27, v30, v31
v_cvt_pk_bf16_f32 v26, v28, v29
v_mfma_f32_16x16x16_bf16 v[8:11], v[24:25], v[52:53], v[8:11]
s_nop 0
buffer_load_dwordx4 v[84:87], v0, s[4:7], s69 offen offset:1024 sc1
v_mfma_f32_16x16x16_bf16 v[12:15], v[26:27], v[52:53], v[12:15]
s_barrier
v_rcp_f32 v18, v16
v_subrev_u32 v17, s46, v16
v_mov_b64 v[40:41], 0
v_mov_b64 v[34:35], 0
v_mul_f32 v8, v8, v18
v_mul_f32 v9, v9, v18
v_cvt_pk_bf16_f32 v8, v8, v9
v_mul_f32 v10, v10, v18
v_mul_f32 v13, v13, v18
v_mul_f32 v11, v11, v18
v_cvt_pk_bf16_f32 v9, v10, v11
v_mul_f32 v12, v12, v18
v_cmp_lt_u32 vcc, s47, v17
v_mul_f32 v14, v14, v18
v_mul_f32 v15, v15, v18
v_cvt_pk_bf16_f32 v11, v14, v15
v_mov_b64 v[32:33], 0
s_waitcnt vmcnt(4)
v_cvt_pk_bf16_f32 v10, v12, v13
s_cbranch_vccnz rare_114
back_115:
s_mov_b64 exec, s[54:55]
ds_write_b128 v5, v[8:11] offset:1536
s_mov_b64 exec, -1
v_mov_b64 v[48:49], 0
v_mov_b64 v[50:51], 0
v_smfmac_f32_16x16x64_bf16 v[32:35], v[8:11], v[64:71], v1
s_add_u32 s25, s25, 10240
ds_read_b128 v[16:19], v2 offset:24576
v_mov_b64 v[36:37], 0
v_mov_b64 v[42:43], 0
v_smfmac_f32_16x16x64_bf16 v[48:51], v[8:11], v[176:183], v1
ds_read_b128 v[28:31], v2 offset:27648
buffer_load_dwordx4 v[64:67], v0, s[4:7], s65 offen offset:0 sc1
ds_read_b128 v[24:27], v2 offset:26624
v_smfmac_f32_16x16x64_bf16 v[40:43], v[8:11], v[168:175], v1
ds_read_b128 v[20:23], v2 offset:25600
s_add_u32 s43, s17, 2
s_waitcnt lgkmcnt(4)
s_barrier
ds_read_b128 v[56:59], v5 offset:1024
buffer_load_dwordx4 v[68:71], v0, s[4:7], s65 offen offset:1024 sc1
s_waitcnt vmcnt(4)
ds_read_b128 v[12:15], v5 offset:0
v_smfmac_f32_16x16x64_bf16 v[36:39], v[8:11], v[72:79], v1
s_waitcnt lgkmcnt(5)
ds_read_b128 v[60:63], v5 offset:512
v_mov_b64 v[54:55], 0
s_waitcnt lgkmcnt(3)
s_mov_b32 s37, 0
s_mov_b32 s19, 1
buffer_load_dwordx4 v[72:75], v0, s[4:7], s65 offen offset:2048 sc1
v_bfe_u32 v45, v0, 1, 7
v_mov_b64 v[52:53], 0
s_waitcnt lgkmcnt(2)
v_smfmac_f32_16x16x64_bf16 v[32:35], v[56:59], v[16:23], v1
buffer_load_dwordx4 v[76:79], v0, s[4:7], s65 offen offset:3072 sc1
ds_read_b128 v[16:19], v2 offset:30720
v_smfmac_f32_16x16x64_bf16 v[48:51], v[56:59], v[216:223], v1
s_waitcnt lgkmcnt(2)
ds_read_b128 v[20:23], v2 offset:31744
v_lshrrev_b32 v44, 8, v0
s_waitcnt vmcnt(5)
s_waitcnt vmcnt(4)
v_smfmac_f32_16x16x64_bf16 v[52:55], v[8:11], v[80:87], v1
s_waitcnt lgkmcnt(2)
ds_read_b128 v[84:87], v2 offset:29696
s_mov_b32 s21, 400384
v_smfmac_f32_16x16x64_bf16 v[32:35], v[60:63], v[24:31], v1
ds_read_b128 v[80:83], v2 offset:28672
s_min_u32 s43, s43, s39
v_smfmac_f32_16x16x64_bf16 v[32:35], v[12:15], v[184:191], v1
s_waitcnt lgkmcnt(3)
ds_read_b128 v[24:27], v2 offset:32768
s_waitcnt lgkmcnt(3)
v_smfmac_f32_16x16x64_bf16 v[40:43], v[56:59], v[16:23], v1
ds_read_b128 v[28:31], v2 offset:33792
v_lshl_or_b32 v44, v44, 12, v45
v_smfmac_f32_16x16x64_bf16 v[36:39], v[56:59], v[192:199], v1
s_waitcnt lgkmcnt(3)
v_cvt_pk_bf16_f32 v32, v32, v33
v_cvt_pk_bf16_f32 v33, v34, v35
v_and_or_b32 v32, v32, -2, s18
s_waitcnt lgkmcnt(2)
v_smfmac_f32_16x16x64_bf16 v[36:39], v[60:63], v[80:87], v1
buffer_store_dwordx2 v[32:33], v44, s[4:7], s60 offen
v_smfmac_f32_16x16x64_bf16 v[36:39], v[12:15], v[200:207], v1
s_waitcnt lgkmcnt(1)
s_waitcnt lgkmcnt(0)
ds_read_b128 v[80:83], v2 offset:34816
v_smfmac_f32_16x16x64_bf16 v[40:43], v[60:63], v[24:31], v1
s_nop 0
ds_read_b128 v[84:87], v2 offset:35840
s_add_u32 s34, s24, 524288
s_nop 0
v_cvt_pk_bf16_f32 v36, v36, v37
v_and_or_b32 v36, v36, -2, s18
v_cvt_pk_bf16_f32 v37, v38, v39
v_smfmac_f32_16x16x64_bf16 v[40:43], v[12:15], v[208:215], v1
buffer_store_dwordx2 v[36:37], v44, s[4:7], s61 offen
v_smfmac_f32_16x16x64_bf16 v[52:55], v[56:59], v[232:239], v1
s_nop 2
v_smfmac_f32_16x16x64_bf16 v[52:55], v[60:63], v[240:247], v1
s_nop 0
s_waitcnt lgkmcnt(0)
v_cvt_pk_bf16_f32 v40, v40, v41
v_cvt_pk_bf16_f32 v41, v42, v43
v_and_or_b32 v40, v40, -2, s18
v_smfmac_f32_16x16x64_bf16 v[48:51], v[60:63], v[80:87], v1
buffer_store_dwordx2 v[40:41], v44, s[4:7], s62 offen
v_smfmac_f32_16x16x64_bf16 v[48:51], v[12:15], v[224:231], v1
s_nop 2
v_smfmac_f32_16x16x64_bf16 v[52:55], v[12:15], v[248:255], v1
s_nop 3
v_cvt_pk_bf16_f32 v48, v48, v49
v_and_or_b32 v48, v48, -2, s18
v_cvt_pk_bf16_f32 v49, v50, v51
buffer_store_dwordx2 v[48:49], v44, s[4:7], s63 offen
v_cvt_pk_bf16_f32 v52, v52, v53
v_cvt_pk_bf16_f32 v53, v54, v55
v_and_or_b32 v52, v52, -2, s18
buffer_store_dwordx2 v[52:53], v44, s[4:7], s64 offen
ds_read_b128 v[80:83], v2 offset:0
ds_read_b128 v[84:87], v2 offset:1024
v_mov_b64 v[24:25], 0
v_mov_b64 v[26:27], 0
v_mov_b64 v[28:29], 0
v_mov_b64 v[30:31], 0
v_bfe_u32 v7, v0, 2, 3
v_add_u32 v7, s28, v7
s_mov_b32 exec_hi, 0
v_and_b32 v7, 255, v0
v_lshl_add_u32 v7, v7, 3, s34
s_mov_b32 exec_hi, -1
v_mov_b64 v[8:9], 0
v_mov_b64 v[10:11], 0
v_mov_b64 v[12:13], 0
v_mov_b64 v[14:15], 0
v_mov_b64 v[16:17], 0
v_mov_b64 v[18:19], 0
v_mov_b64 v[20:21], 0
v_mov_b64 v[22:23], 0
s_nop 15
s_nop 15
s_nop 15
s_nop 15
s_nop 15
s_nop 7
s_barrier
buffer_load_dwordx4 v[48:51], v0, s[4:7], s66 offen offset:0 sc1
buffer_load_dwordx4 v[52:55], v0, s[4:7], s66 offen offset:1024 sc1
buffer_load_dwordx4 v[56:59], v0, s[4:7], s66 offen offset:2048 sc1
buffer_load_dwordx4 v[60:63], v0, s[4:7], s66 offen offset:3072 sc1
s_nop 15
s_nop 15
s_nop 15
s_nop 13
s_mov_b32 s37, 0
s_cmp_eq_u32 s17, s38
s_barrier
s_nop 15
s_nop 7
s_cbranch_scc0 gather_113
s_branch exit_116
rare_114:
ds_read_b128 v[48:51], v6 offset:0
ds_read_b128 v[52:55], v6 offset:1024
s_waitcnt lgkmcnt(0)
s_barrier
v_add_f32 v48, v48, v52
v_add_f32 v49, v49, v53
v_add_f32 v50, v50, v54
v_add_f32 v51, v51, v55
v_mov_b32_dpp v46, v46 quad_perm:[0,1,0,1] row_mask:0xf bank_mask:0xf
v_mov_b32_dpp v47, v47 quad_perm:[0,1,0,1] row_mask:0xf bank_mask:0xf
v_max3_f32 v19, v48, v49, v50
v_max3_f32 v19, v19, v51, v46
v_max_f32 v19, v19, v47
s_nop 1
v_max_f32_dpp v19, v19, v19 quad_perm:[2,3,0,1] row_mask:0xf bank_mask:0xf
v_mov_b32 v44, v19
s_nop 1
v_permlane32_swap_b32 v19, v44
v_max_f32 v19, v19, v44
v_mov_b32 v44, v19
s_nop 1
v_permlane16_swap_b32 v19, v44
v_max_f32 v19, v19, v44
v_sub_f32 v48, v48, v19
v_sub_f32 v49, v49, v19
v_sub_f32 v50, v50, v19
v_sub_f32 v51, v51, v19
v_sub_f32 v46, v46, v19
v_sub_f32 v47, v47, v19
v_exp_f32 v48, v48
v_exp_f32 v49, v49
v_exp_f32 v50, v50
v_exp_f32 v51, v51
v_cvt_pk_bf16_f32 v54, v48, v49
v_cvt_pk_bf16_f32 v55, v50, v51
s_nop 0
v_mov_b32_dpp v48, v54 quad_perm:[0,1,0,1] row_mask:0xf bank_mask:0xf
v_mov_b32_dpp v49, v55 quad_perm:[0,1,0,1] row_mask:0xf bank_mask:0xf
v_mov_b32_dpp v50, v54 quad_perm:[2,3,2,3] row_mask:0xf bank_mask:0xf
v_mov_b32_dpp v51, v55 quad_perm:[2,3,2,3] row_mask:0xf bank_mask:0xf
v_mov_b64 v[20:21], s[56:57]
v_mov_b64 v[22:23], s[56:57]
v_mfma_f32_16x16x32_bf16 v[8:11], v[56:59], v[48:51], 0
v_mfma_f32_16x16x32_bf16 v[12:15], v[60:63], v[48:51], 0
v_mfma_f32_16x16x32_bf16 v[16:19], v[20:23], v[48:51], 0
v_mov_b64 v[54:55], s[58:59]
v_exp_f32_dpp v44, v46 quad_perm:[0,1,0,1] row_mask:0xf bank_mask:0xf
v_exp_f32_dpp v45, v47 quad_perm:[0,1,0,1] row_mask:0xf bank_mask:0xf
s_nop 0
v_cvt_pk_bf16_f32 v52, v44, v45
v_cvt_pk_bf16_f32 v53, v44, v45
s_nop 1
v_mfma_f32_16x16x16_bf16 v[16:19], v[54:55], v[52:53], v[16:19]
v_mfma_f32_16x16x16_bf16 v[8:11], v[24:25], v[52:53], v[8:11]
v_mfma_f32_16x16x16_bf16 v[12:15], v[26:27], v[52:53], v[12:15]
s_nop 5
v_rcp_f32 v18, v16
s_nop 0
v_mul_f32 v8, v8, v18
v_mul_f32 v9, v9, v18
v_mul_f32 v10, v10, v18
v_mul_f32 v11, v11, v18
v_mul_f32 v12, v12, v18
v_mul_f32 v13, v13, v18
v_mul_f32 v14, v14, v18
v_mul_f32 v15, v15, v18
v_cvt_pk_bf16_f32 v8, v8, v9
v_cvt_pk_bf16_f32 v9, v10, v11
v_cvt_pk_bf16_f32 v10, v12, v13
v_cvt_pk_bf16_f32 v11, v14, v15
s_branch back_115
exit_116:
buffer_load_dwordx4 v[32:35], v0, s[4:7], s20 offen sc1
buffer_load_dwordx4 v[36:39], v0, s[4:7], s21 offen sc1
s_add_u32 s37, s37, 1
s_cmp_gt_u32 s37, 262144
s_cbranch_scc1 L_fail
s_waitcnt vmcnt(1)
v_bitop3_b32 v44, v32, v34, s18 bitop3:0x7e
s_waitcnt vmcnt(0)
v_bitop3_b32 v45, v36, v38, s18 bitop3:0x7e
v_bitop3_b32 v44, v44, v45, s19 bitop3:0xa8
v_cmp_ne_u32 vcc, 0, v44
s_cbranch_vccnz exit_116
ds_write_b128 v0, v[32:35] offset:3072
ds_write_b128 v0, v[36:39] offset:7168
s_waitcnt lgkmcnt(0)
s_barrier
v_add_u32 v44, s30, v0
ds_read_b128 v[44:47], v44
s_waitcnt lgkmcnt(0)
v_swap_b32 v45, v46
buffer_store_dwordx4 v[44:47], v0, s[4:7], s25 offen sc1
s_add_u32 s33, s17, 1
s_waitcnt vmcnt(0)
v_mov_b32 v44, s33
s_mov_b64 exec, 1
buffer_store_dword v44, off, s[4:7], s29 sc1
s_mov_b64 exec, -1
s_barrier
s_add_u32 s45, s45, 1
s_cmp_lt_u32 s45, 2
s_cbranch_scc1 layer_112
s_endpgm
grp_62:
s_mov_b32 s15, s14
s_mov_b32 s16, s13
s_lshr_b32 s30, s14, 1
v_and_b32 v64, 63, v0
v_and_b32 v65, 15, v64
v_lshrrev_b32 v66, 4, v64
v_lshlrev_b32 v0, 4, v64
v_and_b32 v67, 2, v64
v_mov_b32 v68, 0x4444
v_mov_b32 v69, 0xeeee
v_cmp_eq_u32 vcc, 0, v67
s_nop 1
v_cndmask_b32 v1, v69, v68, vcc
s_mul_i32 s33, s16, 36864
s_add_u32 s33, s33, 16384
v_add_u32 v2, s33, v0
v_lshrrev_b32 v67, 2, v65
v_xor_b32 v68, v66, v67
v_lshlrev_b32 v68, 3, v68
v_lshl_add_u32 v68, v65, 5, v68
s_lshl_b32 s33, s16, 10
s_add_u32 s33, s33, 10240
v_add_u32 v3, s33, v68
v_lshl_add_u32 v68, v66, 2, v67
v_and_b32 v69, 3, v65
v_xor_b32 v69, v69, v66
v_lshlrev_b32 v69, 3, v69
v_lshl_add_u32 v68, v68, 5, v69
v_add_u32 v4, 10240, v68
v_and_b32 v69, 1, v65
v_lshl_add_u32 v68, v67, 1, v69
v_lshlrev_b32 v68, 4, v68
v_lshl_add_u32 v68, v66, 7, v68
v_add_u32 v5, 14336, v68
v_bfe_u32 v69, v65, 1, 1
v_mul_u32_u24 v69, 640, v69
v_xor_b32 v6, v69, v5
s_mov_b32 s54, 0x33333333
s_mov_b32 s55, 0x33333333
s_mov_b32 s56, 0x3f803f80
s_mov_b32 s57, 0x3f803f80
s_mov_b32 s58, 0x3f803f80
s_mov_b32 s59, 0
s_mov_b32 s46, 729808896
s_mov_b32 s47, 671088640
v_lshlrev_b32 v68, 3, v65
v_lshl_add_u32 v7, v66, 12, v68
s_lshl_b32 s33, s16, 14
s_lshl_b32 s34, s15, 7
s_add_u32 s33, s33, s34
s_add_u32 s26, s33, 65536
s_lshl_b32 s33, s16, 5
s_add_u32 s32, s33, s15
s_lshl_b32 s33, s32, 12
s_add_u32 s27, s33, 65536
s_lshr_b32 s33, s32, 2
s_lshl_b32 s33, s33, 9
s_and_b32 s34, s32, 3
s_lshl_b32 s34, s34, 6
s_add_u32 s33, s33, s34
s_add_u32 s40, s33, 393216
s_lshl_b32 s33, s15, 7
s_add_u32 s28, s33, 0
s_lshl_b32 s33, s30, 2
s_add_u32 s33, s33, 4096
s_cmp_lt_u32 s30, 10
s_cselect_b32 s29, s33, 268435456
s_cselect_b32 s30, s30, 0
s_cselect_b32 s31, 12582912, s29
s_lshl_b32 s30, s30, 10
s_and_b32 s33, s15, 3
s_lshl_b32 s33, s33, 7
s_add_u32 s41, s33, 425984
s_lshl_b32 s33, s15, 2
s_add_u32 s42, s33, 425984
s_mov_b32 s44, 0x3e0293ee
s_lshl_b32 s33, s15, 2
s_add_u32 s33, s33, s16
s_mul_i32 s34, s33, 18432
s_add_u32 s23, s34, 1048576
s_mul_i32 s34, s33, 36864
s_add_u32 s43, s34, 6291456
s_add_u32 s60, s26, 0
s_add_u32 s61, s26, 65536
s_add_u32 s62, s26, 131072
s_add_u32 s63, s26, 196608
s_add_u32 s64, s26, 262144
s_add_u32 s65, s23, 0
s_add_u32 s66, s23, 4096
s_add_u32 s67, s23, 8192
s_add_u32 s68, s23, 12288
s_add_u32 s69, s23, 16384
v_mov_b32 v72, 0
v_mov_b32 v73, 0
s_mov_b32 s33, s26
buffer_store_dwordx2 v[72:73], v7, s[4:7], s33 offen
s_add_u32 s33, s33, 65536
buffer_store_dwordx2 v[72:73], v7, s[4:7], s33 offen
s_add_u32 s33, s33, 65536
buffer_store_dwordx2 v[72:73], v7, s[4:7], s33 offen
s_add_u32 s33, s33, 65536
buffer_store_dwordx2 v[72:73], v7, s[4:7], s33 offen
s_add_u32 s33, s33, 65536
buffer_store_dwordx2 v[72:73], v7, s[4:7], s33 offen
s_add_u32 s33, s33, 65536
buffer_store_dword v72, off, s[4:7], s42 offset:0
buffer_store_dword v72, off, s[4:7], s42 offset:128
buffer_store_dword v72, off, s[4:7], s42 offset:256
buffer_store_dword v72, off, s[4:7], s42 offset:384
s_load_dwordx2 s[48:49], s[0:1], 32
s_mov_b32 s50, 10240
s_mov_b32 s51, 0x20000
s_cmp_ge_u32 s32, 80
s_cbranch_scc1 nm0_126
s_and_b32 s33, s32, 3
s_mul_i32 s33, s33, 2560
s_lshr_b32 s34, s32, 2
s_lshl_b32 s34, s34, 6
s_add_u32 s33, s33, s34
v_bfe_u32 v68, v65, 1, 2
v_lshlrev_b32 v68, 4, v68
v_and_b32 v69, 1, v65
v_lshl_add_u32 v68, v69, 2, v68
v_and_b32 v69, 1, v66
v_mul_u32_u24 v69, 1280, v69
v_add_u32 v68, v68, v69
s_waitcnt lgkmcnt(0)
buffer_load_dword v74, v68, s[48:51], s33 offen
buffer_load_dword v75, v68, s[48:51], s33 offen offset:8
v_and_b32 v68, 32, v0
v_bfe_u32 v69, v0, 6, 1
v_lshl_add_u32 v68, v69, 8, v68
v_bfe_u32 v69, v0, 8, 1
v_lshl_add_u32 v68, v69, 4, v68
v_bfe_u32 v69, v0, 4, 1
v_lshl_add_u32 v68, v69, 3, v68
s_add_u32 s34, s40, 16384
buffer_store_dwordx2 v[72:73], v68, s[4:7], s40 offen
s_waitcnt vmcnt(1)
buffer_store_dwordx2 v[74:75], v68, s[4:7], s34 offen
nm0_126:
s_waitcnt vmcnt(0) lgkmcnt(0)
v_lshrrev_b32 v67, 2, v64
v_and_b32 v68, 3, v64
v_lshlrev_b32 v68, 4, v68
v_lshl_add_u32 v8, v67, 13, v68
v_mul_u32_u24 v67, 1280, v67
v_add_u32 v9, v67, v68
v_lshrrev_b32 v67, 1, v66
v_lshlrev_b32 v67, 4, v67
v_and_b32 v68, 1, v66
v_lshl_add_u32 v67, v68, 1, v67
v_lshrrev_b32 v68, 3, v65
v_lshl_add_u32 v67, v68, 3, v67
v_bfe_u32 v68, v65, 2, 1
v_add_u32 v67, v67, v68
v_and_b32 v69, 3, v65
v_lshlrev_b32 v10, 4, v69
v_lshl_add_u32 v10, v67, 6, v10
v_lshl_add_u32 v67, v66, 2, v68
v_lshlrev_b32 v11, 4, v69
v_lshl_add_u32 v11, v67, 6, v11
v_lshrrev_b32 v68, 3, v65
v_lshl_add_u32 v11, v68, 3, v11
s_mul_i32 s36, s16, 36864
s_add_u32 s36, s36, 16384
v_add_u32 v10, s36, v10
v_add_u32 v11, s36, v11
s_load_dwordx2 s[72:73], s[0:1], 40
s_mov_b32 s74, 5242880
s_mov_b32 s75, 0x20000
s_load_dwordx2 s[76:77], s[0:1], 48
s_mov_b32 s78, 5242880
s_mov_b32 s79, 0x20000
s_load_dwordx2 s[80:81], s[0:1], 56
s_mov_b32 s82, 5242880
s_mov_b32 s83, 0x20000
s_load_dwordx2 s[84:85], s[0:1], 64
s_mov_b32 s86, 5242880
s_mov_b32 s87, 0x20000
s_xor_b32 s33, s16, 0
s_add_u32 s33, s33, 0
s_lshl_b32 s33, s33, 19
s_lshl_b32 s34, s15, 8
s_add_u32 s33, s33, s34
s_lshl_b32 s34, s16, 6
s_add_u32 s33, s33, s34
s_add_u32 m0, s36, 0
s_waitcnt lgkmcnt(0)
buffer_load_dwordx4 v8, s[72:75], s33 offen lds
s_add_u32 s33, s33, 131072
s_add_u32 m0, s36, 1024
s_nop 0
buffer_load_dwordx4 v8, s[72:75], s33 offen lds
s_add_u32 s33, s33, 131072
s_add_u32 m0, s36, 2048
s_nop 0
buffer_load_dwordx4 v8, s[72:75], s33 offen lds
s_add_u32 s33, s33, 131072
s_add_u32 m0, s36, 3072
s_nop 0
buffer_load_dwordx4 v8, s[72:75], s33 offen lds
s_xor_b32 s33, s16, 0
s_add_u32 s33, s33, 4
s_lshl_b32 s33, s33, 19
s_lshl_b32 s34, s15, 8
s_add_u32 s33, s33, s34
s_lshl_b32 s34, s16, 6
s_add_u32 s33, s33, s34
s_add_u32 m0, s36, 4096
s_nop 0
buffer_load_dwordx4 v8, s[72:75], s33 offen lds
s_add_u32 s33, s33, 131072
s_add_u32 m0, s36, 5120
s_nop 0
buffer_load_dwordx4 v8, s[72:75], s33 offen lds
s_add_u32 s33, s33, 131072
s_add_u32 m0, s36, 6144
s_nop 0
buffer_load_dwordx4 v8, s[72:75], s33 offen lds
s_add_u32 s33, s33, 131072
s_add_u32 m0, s36, 7168
s_nop 0
buffer_load_dwordx4 v8, s[72:75], s33 offen lds
s_xor_b32 s33, s16, 1
s_add_u32 s33, s33, 0
s_lshl_b32 s33, s33, 19
s_lshl_b32 s34, s15, 8
s_add_u32 s33, s33, s34
s_lshl_b32 s34, s16, 6
s_add_u32 s33, s33, s34
s_add_u32 m0, s36, 8192
s_nop 0
buffer_load_dwordx4 v8, s[72:75], s33 offen lds
s_add_u32 s33, s33, 131072
s_add_u32 m0, s36, 9216
s_nop 0
buffer_load_dwordx4 v8, s[72:75], s33 offen lds
s_add_u32 s33, s33, 131072
s_add_u32 m0, s36, 10240
s_nop 0
buffer_load_dwordx4 v8, s[72:75], s33 offen lds
s_add_u32 s33, s33, 131072
s_add_u32 m0, s36, 11264
s_nop 0
buffer_load_dwordx4 v8, s[72:75], s33 offen lds
s_xor_b32 s33, s16, 1
s_add_u32 s33, s33, 4
s_lshl_b32 s33, s33, 19
s_lshl_b32 s34, s15, 8
s_add_u32 s33, s33, s34
s_lshl_b32 s34, s16, 6
s_add_u32 s33, s33, s34
s_add_u32 m0, s36, 12288
s_nop 0
buffer_load_dwordx4 v8, s[72:75], s33 offen lds
s_add_u32 s33, s33, 131072
s_add_u32 m0, s36, 13312
s_nop 0
buffer_load_dwordx4 v8, s[72:75], s33 offen lds
s_add_u32 s33, s33, 131072
s_add_u32 m0, s36, 14336
s_nop 0
buffer_load_dwordx4 v8, s[72:75], s33 offen lds
s_add_u32 s33, s33, 131072
s_add_u32 m0, s36, 15360
s_nop 0
buffer_load_dwordx4 v8, s[72:75], s33 offen lds
s_xor_b32 s33, s16, 2
s_add_u32 s33, s33, 0
s_lshl_b32 s33, s33, 19
s_lshl_b32 s34, s15, 8
s_add_u32 s33, s33, s34
s_lshl_b32 s34, s16, 6
s_add_u32 s33, s33, s34
s_add_u32 m0, s36, 16384
s_nop 0
buffer_load_dwordx4 v8, s[72:75], s33 offen lds
s_add_u32 s33, s33, 131072
s_add_u32 m0, s36, 17408
s_nop 0
buffer_load_dwordx4 v8, s[72:75], s33 offen lds
s_add_u32 s33, s33, 131072
s_add_u32 m0, s36, 18432
s_nop 0
buffer_load_dwordx4 v8, s[72:75], s33 offen lds
s_add_u32 s33, s33, 131072
s_add_u32 m0, s36, 19456
s_nop 0
buffer_load_dwordx4 v8, s[72:75], s33 offen lds
s_xor_b32 s33, s16, 2
s_add_u32 s33, s33, 4
s_lshl_b32 s33, s33, 19
s_lshl_b32 s34, s15, 8
s_add_u32 s33, s33, s34
s_lshl_b32 s34, s16, 6
s_add_u32 s33, s33, s34
s_add_u32 m0, s36, 20480
s_nop 0
buffer_load_dwordx4 v8, s[72:75], s33 offen lds
s_add_u32 s33, s33, 131072
s_add_u32 m0, s36, 21504
s_nop 0
buffer_load_dwordx4 v8, s[72:75], s33 offen lds
s_add_u32 s33, s33, 131072
s_add_u32 m0, s36, 22528
s_nop 0
buffer_load_dwordx4 v8, s[72:75], s33 offen lds
s_add_u32 s33, s33, 131072
s_add_u32 m0, s36, 23552
s_nop 0
buffer_load_dwordx4 v8, s[72:75], s33 offen lds
s_xor_b32 s33, s16, 3
s_add_u32 s33, s33, 0
s_lshl_b32 s33, s33, 19
s_lshl_b32 s34, s15, 8
s_add_u32 s33, s33, s34
s_lshl_b32 s34, s16, 6
s_add_u32 s33, s33, s34
s_add_u32 m0, s36, 24576
s_nop 0
buffer_load_dwordx4 v8, s[72:75], s33 offen lds
s_add_u32 s33, s33, 131072
s_add_u32 m0, s36, 25600
s_nop 0
buffer_load_dwordx4 v8, s[72:75], s33 offen lds
s_add_u32 s33, s33, 131072
s_add_u32 m0, s36, 26624
s_nop 0
buffer_load_dwordx4 v8, s[72:75], s33 offen lds
s_add_u32 s33, s33, 131072
s_add_u32 m0, s36, 27648
s_nop 0
buffer_load_dwordx4 v8, s[72:75], s33 offen lds
s_xor_b32 s33, s16, 3
s_add_u32 s33, s33, 4
s_lshl_b32 s33, s33, 19
s_lshl_b32 s34, s15, 8
s_add_u32 s33, s33, s34
s_lshl_b32 s34, s16, 6
s_add_u32 s33, s33, s34
s_add_u32 m0, s36, 28672
s_nop 0
buffer_load_dwordx4 v8, s[72:75], s33 offen lds
s_add_u32 s33, s33, 131072
s_add_u32 m0, s36, 29696
s_nop 0
buffer_load_dwordx4 v8, s[72:75], s33 offen lds
s_add_u32 s33, s33, 131072
s_add_u32 m0, s36, 30720
s_nop 0
buffer_load_dwordx4 v8, s[72:75], s33 offen lds
s_add_u32 s33, s33, 131072
s_add_u32 m0, s36, 31744
s_nop 0
buffer_load_dwordx4 v8, s[72:75], s33 offen lds
s_mov_b32 s33, 8
s_lshl_b32 s33, s33, 19
s_lshl_b32 s34, s15, 8
s_add_u32 s33, s33, s34
s_lshl_b32 s34, s16, 6
s_add_u32 s33, s33, s34
s_add_u32 m0, s36, 32768
s_nop 0
buffer_load_dwordx4 v8, s[72:75], s33 offen lds
s_add_u32 s33, s33, 131072
s_add_u32 m0, s36, 33792
s_nop 0
buffer_load_dwordx4 v8, s[72:75], s33 offen lds
s_add_u32 s33, s33, 131072
s_add_u32 m0, s36, 34816
s_nop 0
buffer_load_dwordx4 v8, s[72:75], s33 offen lds
s_add_u32 s33, s33, 131072
s_add_u32 m0, s36, 35840
s_nop 0
buffer_load_dwordx4 v8, s[72:75], s33 offen lds
s_waitcnt vmcnt(32)
ds_read_b64_tr_b16 v[72:73], v10 offset:0
ds_read_b64_tr_b16 v[74:75], v10 offset:256
ds_read_b64_tr_b16 v[76:77], v10 offset:2048
ds_read_b64_tr_b16 v[78:79], v10 offset:2304
ds_read_b64_tr_b16 v[80:81], v10 offset:8
ds_read_b64_tr_b16 v[82:83], v10 offset:264
ds_read_b64_tr_b16 v[84:85], v10 offset:2056
ds_read_b64_tr_b16 v[86:87], v10 offset:2312
s_waitcnt lgkmcnt(0)
s_add_u32 s33, s23, 0
buffer_store_dwordx4 v[72:75], v0, s[4:7], s33 offen offset:0
buffer_store_dwordx4 v[76:79], v0, s[4:7], s33 offen offset:1024
s_add_u32 s33, s23, 2048
buffer_store_dwordx4 v[80:83], v0, s[4:7], s33 offen offset:0
buffer_store_dwordx4 v[84:87], v0, s[4:7], s33 offen offset:1024
s_mov_b32 s33, 9
s_lshl_b32 s33, s33, 19
s_lshl_b32 s34, s15, 8
s_add_u32 s33, s33, s34
s_lshl_b32 s34, s16, 6
s_add_u32 s33, s33, s34
s_add_u32 m0, s36, 0
s_nop 0
buffer_load_dwordx4 v8, s[72:75], s33 offen lds
s_add_u32 s33, s33, 131072
s_add_u32 m0, s36, 1024
s_nop 0
buffer_load_dwordx4 v8, s[72:75], s33 offen lds
s_add_u32 s33, s33, 131072
s_add_u32 m0, s36, 2048
s_nop 0
buffer_load_dwordx4 v8, s[72:75], s33 offen lds
s_add_u32 s33, s33, 131072
s_add_u32 m0, s36, 3072
s_nop 0
buffer_load_dwordx4 v8, s[72:75], s33 offen lds
s_waitcnt vmcnt(36)
ds_read_b64_tr_b16 a[8:9], v10 offset:4096
ds_read_b64_tr_b16 a[10:11], v10 offset:4352
ds_read_b64_tr_b16 a[12:13], v10 offset:6144
ds_read_b64_tr_b16 a[14:15], v10 offset:6400
ds_read_b64_tr_b16 a[16:17], v10 offset:4104
ds_read_b64_tr_b16 a[18:19], v10 offset:4360
ds_read_b64_tr_b16 a[20:21], v10 offset:6152
ds_read_b64_tr_b16 a[22:23], v10 offset:6408
s_waitcnt lgkmcnt(0)
s_xor_b32 s33, s16, 0
s_add_u32 s33, s33, 0
s_lshl_b32 s33, s33, 19
s_lshl_b32 s34, s15, 8
s_add_u32 s33, s33, s34
s_lshl_b32 s34, s16, 6
s_add_u32 s33, s33, s34
s_add_u32 m0, s36, 4096
s_nop 0
buffer_load_dwordx4 v8, s[76:79], s33 offen lds
s_add_u32 s33, s33, 131072
s_add_u32 m0, s36, 5120
s_nop 0
buffer_load_dwordx4 v8, s[76:79], s33 offen lds
s_add_u32 s33, s33, 131072
s_add_u32 m0, s36, 6144
s_nop 0
buffer_load_dwordx4 v8, s[76:79], s33 offen lds
s_add_u32 s33, s33, 131072
s_add_u32 m0, s36, 7168
s_nop 0
buffer_load_dwordx4 v8, s[76:79], s33 offen lds
s_waitcnt vmcnt(36)
ds_read_b64_tr_b16 a[40:41], v10 offset:8192
ds_read_b64_tr_b16 a[42:43], v10 offset:8448
ds_read_b64_tr_b16 a[44:45], v10 offset:10240
ds_read_b64_tr_b16 a[46:47], v10 offset:10496
ds_read_b64_tr_b16 a[48:49], v10 offset:8200
ds_read_b64_tr_b16 a[50:51], v10 offset:8456
ds_read_b64_tr_b16 a[52:53], v10 offset:10248
ds_read_b64_tr_b16 a[54:55], v10 offset:10504
s_waitcnt lgkmcnt(0)
s_xor_b32 s33, s16, 0
s_add_u32 s33, s33, 4
s_lshl_b32 s33, s33, 19
s_lshl_b32 s34, s15, 8
s_add_u32 s33, s33, s34
s_lshl_b32 s34, s16, 6
s_add_u32 s33, s33, s34
s_add_u32 m0, s36, 8192
s_nop 0
buffer_load_dwordx4 v8, s[76:79], s33 offen lds
s_add_u32 s33, s33, 131072
s_add_u32 m0, s36, 9216
s_nop 0
buffer_load_dwordx4 v8, s[76:79], s33 offen lds
s_add_u32 s33, s33, 131072
s_add_u32 m0, s36, 10240
s_nop 0
buffer_load_dwordx4 v8, s[76:79], s33 offen lds
s_add_u32 s33, s33, 131072
s_add_u32 m0, s36, 11264
s_nop 0
buffer_load_dwordx4 v8, s[76:79], s33 offen lds
s_waitcnt vmcnt(36)
ds_read_b64_tr_b16 a[56:57], v10 offset:12288
ds_read_b64_tr_b16 a[58:59], v10 offset:12544
ds_read_b64_tr_b16 a[60:61], v10 offset:14336
ds_read_b64_tr_b16 a[62:63], v10 offset:14592
ds_read_b64_tr_b16 v[48:49], v10 offset:12296
ds_read_b64_tr_b16 v[50:51], v10 offset:12552
ds_read_b64_tr_b16 v[52:53], v10 offset:14344
ds_read_b64_tr_b16 v[54:55], v10 offset:14600
s_waitcnt lgkmcnt(0)
s_add_u32 s33, s43, 6144
buffer_store_dwordx4 v[48:51], v0, s[4:7], s33 offen offset:0
buffer_store_dwordx4 v[52:55], v0, s[4:7], s33 offen offset:1024
s_xor_b32 s33, s16, 1
s_add_u32 s33, s33, 0
s_lshl_b32 s33, s33, 19
s_lshl_b32 s34, s15, 8
s_add_u32 s33, s33, s34
s_lshl_b32 s34, s16, 6
s_add_u32 s33, s33, s34
s_add_u32 m0, s36, 12288
s_nop 0
buffer_load_dwordx4 v8, s[76:79], s33 offen lds
s_add_u32 s33, s33, 131072
s_add_u32 m0, s36, 13312
s_nop 0
buffer_load_dwordx4 v8, s[76:79], s33 offen lds
s_add_u32 s33, s33, 131072
s_add_u32 m0, s36, 14336
s_nop 0
buffer_load_dwordx4 v8, s[76:79], s33 offen lds
s_add_u32 s33, s33, 131072
s_add_u32 m0, s36, 15360
s_nop 0
buffer_load_dwordx4 v8, s[76:79], s33 offen lds
s_waitcnt vmcnt(38)
ds_read_b64_tr_b16 a[64:65], v10 offset:16384
ds_read_b64_tr_b16 a[66:67], v10 offset:16640
ds_read_b64_tr_b16 a[68:69], v10 offset:18432
ds_read_b64_tr_b16 a[70:71], v10 offset:18688
ds_read_b64_tr_b16 a[72:73], v10 offset:16392
ds_read_b64_tr_b16 a[74:75], v10 offset:16648
ds_read_b64_tr_b16 a[76:77], v10 offset:18440
ds_read_b64_tr_b16 a[78:79], v10 offset:18696
s_waitcnt lgkmcnt(0)
s_xor_b32 s33, s16, 1
s_add_u32 s33, s33, 4
s_lshl_b32 s33, s33, 19
s_lshl_b32 s34, s15, 8
s_add_u32 s33, s33, s34
s_lshl_b32 s34, s16, 6
s_add_u32 s33, s33, s34
s_add_u32 m0, s36, 16384
s_nop 0
buffer_load_dwordx4 v8, s[76:79], s33 offen lds
s_add_u32 s33, s33, 131072
s_add_u32 m0, s36, 17408
s_nop 0
buffer_load_dwordx4 v8, s[76:79], s33 offen lds
s_add_u32 s33, s33, 131072
s_add_u32 m0, s36, 18432
s_nop 0
buffer_load_dwordx4 v8, s[76:79], s33 offen lds
s_add_u32 s33, s33, 131072
s_add_u32 m0, s36, 19456
s_nop 0
buffer_load_dwordx4 v8, s[76:79], s33 offen lds
s_waitcnt vmcnt(38)
ds_read_b64_tr_b16 v[56:57], v10 offset:20480
ds_read_b64_tr_b16 v[58:59], v10 offset:20736
ds_read_b64_tr_b16 v[60:61], v10 offset:22528
ds_read_b64_tr_b16 v[62:63], v10 offset:22784
ds_read_b64_tr_b16 a[80:81], v10 offset:20488
ds_read_b64_tr_b16 a[82:83], v10 offset:20744
ds_read_b64_tr_b16 a[84:85], v10 offset:22536
ds_read_b64_tr_b16 a[86:87], v10 offset:22792
s_waitcnt lgkmcnt(0)
s_add_u32 s33, s43, 8192
buffer_store_dwordx4 v[56:59], v0, s[4:7], s33 offen offset:0
buffer_store_dwordx4 v[60:63], v0, s[4:7], s33 offen offset:1024
s_xor_b32 s33, s16, 2
s_add_u32 s33, s33, 0
s_lshl_b32 s33, s33, 19
s_lshl_b32 s34, s15, 8
s_add_u32 s33, s33, s34
s_lshl_b32 s34, s16, 6
s_add_u32 s33, s33, s34
s_add_u32 m0, s36, 20480
s_nop 0
buffer_load_dwordx4 v8, s[76:79], s33 offen lds
s_add_u32 s33, s33, 131072
s_add_u32 m0, s36, 21504
s_nop 0
buffer_load_dwordx4 v8, s[76:79], s33 offen lds
s_add_u32 s33, s33, 131072
s_add_u32 m0, s36, 22528
s_nop 0
buffer_load_dwordx4 v8, s[76:79], s33 offen lds
s_add_u32 s33, s33, 131072
s_add_u32 m0, s36, 23552
s_nop 0
buffer_load_dwordx4 v8, s[76:79], s33 offen lds
s_waitcnt vmcnt(40)
ds_read_b64_tr_b16 v[72:73], v10 offset:24576
ds_read_b64_tr_b16 v[74:75], v10 offset:24832
ds_read_b64_tr_b16 v[76:77], v10 offset:26624
ds_read_b64_tr_b16 v[78:79], v10 offset:26880
ds_read_b64_tr_b16 v[80:81], v10 offset:24584
ds_read_b64_tr_b16 v[82:83], v10 offset:24840
ds_read_b64_tr_b16 v[84:85], v10 offset:26632
ds_read_b64_tr_b16 v[86:87], v10 offset:26888
s_waitcnt lgkmcnt(0)
s_add_u32 s33, s23, 8192
buffer_store_dwordx4 v[72:75], v0, s[4:7], s33 offen offset:0
buffer_store_dwordx4 v[76:79], v0, s[4:7], s33 offen offset:1024
s_add_u32 s33, s43, 10240
buffer_store_dwordx4 v[80:83], v0, s[4:7], s33 offen offset:0
buffer_store_dwordx4 v[84:87], v0, s[4:7], s33 offen offset:1024
s_xor_b32 s33, s16, 2
s_add_u32 s33, s33, 4
s_lshl_b32 s33, s33, 19
s_lshl_b32 s34, s15, 8
s_add_u32 s33, s33, s34
s_lshl_b32 s34, s16, 6
s_add_u32 s33, s33, s34
s_add_u32 m0, s36, 24576
s_nop 0
buffer_load_dwordx4 v8, s[76:79], s33 offen lds
s_add_u32 s33, s33, 131072
s_add_u32 m0, s36, 25600
s_nop 0
buffer_load_dwordx4 v8, s[76:79], s33 offen lds
s_add_u32 s33, s33, 131072
s_add_u32 m0, s36, 26624
s_nop 0
buffer_load_dwordx4 v8, s[76:79], s33 offen lds
s_add_u32 s33, s33, 131072
s_add_u32 m0, s36, 27648
s_nop 0
buffer_load_dwordx4 v8, s[76:79], s33 offen lds
s_waitcnt vmcnt(44)
ds_read_b64_tr_b16 a[88:89], v10 offset:28672
ds_read_b64_tr_b16 a[90:91], v10 offset:28928
ds_read_b64_tr_b16 a[92:93], v10 offset:30720
ds_read_b64_tr_b16 a[94:95], v10 offset:30976
ds_read_b64_tr_b16 a[96:97], v10 offset:28680
ds_read_b64_tr_b16 a[98:99], v10 offset:28936
ds_read_b64_tr_b16 a[100:101], v10 offset:30728
ds_read_b64_tr_b16 a[102:103], v10 offset:30984
s_waitcnt lgkmcnt(0)
s_xor_b32 s33, s16, 3
s_add_u32 s33, s33, 0
s_lshl_b32 s33, s33, 19
s_lshl_b32 s34, s15, 8
s_add_u32 s33, s33, s34
s_lshl_b32 s34, s16, 6
s_add_u32 s33, s33, s34
s_add_u32 m0, s36, 28672
s_nop 0
buffer_load_dwordx4 v8, s[76:79], s33 offen lds
s_add_u32 s33, s33, 131072
s_add_u32 m0, s36, 29696
s_nop 0
buffer_load_dwordx4 v8, s[76:79], s33 offen lds
s_add_u32 s33, s33, 131072
s_add_u32 m0, s36, 30720
s_nop 0
buffer_load_dwordx4 v8, s[76:79], s33 offen lds
s_add_u32 s33, s33, 131072
s_add_u32 m0, s36, 31744
s_nop 0
buffer_load_dwordx4 v8, s[76:79], s33 offen lds
s_waitcnt vmcnt(44)
ds_read_b64_tr_b16 v[48:49], v10 offset:32768
ds_read_b64_tr_b16 v[50:51], v10 offset:33024
ds_read_b64_tr_b16 v[52:53], v10 offset:34816
ds_read_b64_tr_b16 v[54:55], v10 offset:35072
ds_read_b64_tr_b16 a[104:105], v10 offset:32776
ds_read_b64_tr_b16 a[106:107], v10 offset:33032
ds_read_b64_tr_b16 a[108:109], v10 offset:34824
ds_read_b64_tr_b16 a[110:111], v10 offset:35080
s_waitcnt lgkmcnt(0)
s_add_u32 s33, s43, 12288
buffer_store_dwordx4 v[48:51], v0, s[4:7], s33 offen offset:0
buffer_store_dwordx4 v[52:55], v0, s[4:7], s33 offen offset:1024
s_xor_b32 s33, s16, 3
s_add_u32 s33, s33, 4
s_lshl_b32 s33, s33, 19
s_lshl_b32 s34, s15, 8
s_add_u32 s33, s33, s34
s_lshl_b32 s34, s16, 6
s_add_u32 s33, s33, s34
s_add_u32 m0, s36, 32768
s_nop 0
buffer_load_dwordx4 v8, s[76:79], s33 offen lds
s_add_u32 s33, s33, 131072
s_add_u32 m0, s36, 33792
s_nop 0
buffer_load_dwordx4 v8, s[76:79], s33 offen lds
s_add_u32 s33, s33, 131072
s_add_u32 m0, s36, 34816
s_nop 0
buffer_load_dwordx4 v8, s[76:79], s33 offen lds
s_add_u32 s33, s33, 131072
s_add_u32 m0, s36, 35840
s_nop 0
buffer_load_dwordx4 v8, s[76:79], s33 offen lds
s_waitcnt vmcnt(42)
ds_read_b64_tr_b16 a[112:113], v10 offset:0
ds_read_b64_tr_b16 a[114:115], v10 offset:256
ds_read_b64_tr_b16 a[116:117], v10 offset:2048
ds_read_b64_tr_b16 a[118:119], v10 offset:2304
ds_read_b64_tr_b16 a[120:121], v10 offset:8
ds_read_b64_tr_b16 a[122:123], v10 offset:264
ds_read_b64_tr_b16 a[124:125], v10 offset:2056
ds_read_b64_tr_b16 a[126:127], v10 offset:2312
s_waitcnt lgkmcnt(0)
s_mov_b32 s33, 8
s_lshl_b32 s33, s33, 19
s_lshl_b32 s34, s15, 8
s_add_u32 s33, s33, s34
s_lshl_b32 s34, s16, 6
s_add_u32 s33, s33, s34
s_add_u32 m0, s36, 0
s_nop 0
buffer_load_dwordx4 v8, s[76:79], s33 offen lds
s_add_u32 s33, s33, 131072
s_add_u32 m0, s36, 1024
s_nop 0
buffer_load_dwordx4 v8, s[76:79], s33 offen lds
s_add_u32 s33, s33, 131072
s_add_u32 m0, s36, 2048
s_nop 0
buffer_load_dwordx4 v8, s[76:79], s33 offen lds
s_add_u32 s33, s33, 131072
s_add_u32 m0, s36, 3072
s_nop 0
buffer_load_dwordx4 v8, s[76:79], s33 offen lds
s_waitcnt vmcnt(42)
ds_read_b64_tr_b16 v[56:57], v10 offset:4096
ds_read_b64_tr_b16 v[58:59], v10 offset:4352
ds_read_b64_tr_b16 v[60:61], v10 offset:6144
ds_read_b64_tr_b16 v[62:63], v10 offset:6400
ds_read_b64_tr_b16 v[72:73], v10 offset:4104
ds_read_b64_tr_b16 v[74:75], v10 offset:4360
ds_read_b64_tr_b16 v[76:77], v10 offset:6152
ds_read_b64_tr_b16 v[78:79], v10 offset:6408
s_waitcnt lgkmcnt(0)
s_add_u32 s33, s23, 4096
buffer_store_dwordx4 v[56:59], v0, s[4:7], s33 offen offset:0
buffer_store_dwordx4 v[60:63], v0, s[4:7], s33 offen offset:1024
s_add_u32 s33, s23, 6144
buffer_store_dwordx4 v[72:75], v0, s[4:7], s33 offen offset:0
buffer_store_dwordx4 v[76:79], v0, s[4:7], s33 offen offset:1024
s_mov_b32 s33, 9
s_lshl_b32 s33, s33, 19
s_lshl_b32 s34, s15, 8
s_add_u32 s33, s33, s34
s_lshl_b32 s34, s16, 6
s_add_u32 s33, s33, s34
s_add_u32 m0, s36, 4096
s_nop 0
buffer_load_dwordx4 v8, s[76:79], s33 offen lds
s_add_u32 s33, s33, 131072
s_add_u32 m0, s36, 5120
s_nop 0
buffer_load_dwordx4 v8, s[76:79], s33 offen lds
s_add_u32 s33, s33, 131072
s_add_u32 m0, s36, 6144
s_nop 0
buffer_load_dwordx4 v8, s[76:79], s33 offen lds
s_add_u32 s33, s33, 131072
s_add_u32 m0, s36, 7168
s_nop 0
buffer_load_dwordx4 v8, s[76:79], s33 offen lds
s_waitcnt vmcnt(46)
ds_read_b64_tr_b16 a[24:25], v10 offset:8192
ds_read_b64_tr_b16 a[26:27], v10 offset:8448
ds_read_b64_tr_b16 a[28:29], v10 offset:10240
ds_read_b64_tr_b16 a[30:31], v10 offset:10496
ds_read_b64_tr_b16 v[80:81], v10 offset:8200
ds_read_b64_tr_b16 v[82:83], v10 offset:8456
ds_read_b64_tr_b16 v[84:85], v10 offset:10248
ds_read_b64_tr_b16 v[86:87], v10 offset:10504
s_waitcnt lgkmcnt(0)
s_add_u32 s33, s43, 2048
buffer_store_dwordx4 v[80:83], v0, s[4:7], s33 offen offset:0
buffer_store_dwordx4 v[84:87], v0, s[4:7], s33 offen offset:1024
s_xor_b32 s33, s16, 0
s_add_u32 s33, s33, 0
s_lshl_b32 s33, s33, 19
s_lshl_b32 s34, s15, 8
s_add_u32 s33, s33, s34
s_lshl_b32 s34, s16, 6
s_add_u32 s33, s33, s34
s_add_u32 m0, s36, 8192
s_nop 0
buffer_load_dwordx4 v8, s[80:83], s33 offen lds
s_add_u32 s33, s33, 131072
s_add_u32 m0, s36, 9216
s_nop 0
buffer_load_dwordx4 v8, s[80:83], s33 offen lds
s_add_u32 s33, s33, 131072
s_add_u32 m0, s36, 10240
s_nop 0
buffer_load_dwordx4 v8, s[80:83], s33 offen lds
s_add_u32 s33, s33, 131072
s_add_u32 m0, s36, 11264
s_nop 0
buffer_load_dwordx4 v8, s[80:83], s33 offen lds
s_waitcnt vmcnt(46)
ds_read_b64_tr_b16 v[48:49], v10 offset:12288
ds_read_b64_tr_b16 v[50:51], v10 offset:12544
ds_read_b64_tr_b16 v[52:53], v10 offset:14336
ds_read_b64_tr_b16 v[54:55], v10 offset:14592
ds_read_b64_tr_b16 v[56:57], v10 offset:12296
ds_read_b64_tr_b16 v[58:59], v10 offset:12552
ds_read_b64_tr_b16 v[60:61], v10 offset:14344
ds_read_b64_tr_b16 v[62:63], v10 offset:14600
s_waitcnt lgkmcnt(0)
s_add_u32 s33, s23, 10240
buffer_store_dwordx4 v[48:51], v0, s[4:7], s33 offen offset:0
buffer_store_dwordx4 v[52:55], v0, s[4:7], s33 offen offset:1024
s_add_u32 s33, s43, 14336
buffer_store_dwordx4 v[56:59], v0, s[4:7], s33 offen offset:0
buffer_store_dwordx4 v[60:63], v0, s[4:7], s33 offen offset:1024
s_xor_b32 s33, s16, 0
s_add_u32 s33, s33, 4
s_lshl_b32 s33, s33, 19
s_lshl_b32 s34, s15, 8
s_add_u32 s33, s33, s34
s_lshl_b32 s34, s16, 6
s_add_u32 s33, s33, s34
s_add_u32 m0, s36, 12288
s_nop 0
buffer_load_dwordx4 v8, s[80:83], s33 offen lds
s_add_u32 s33, s33, 131072
s_add_u32 m0, s36, 13312
s_nop 0
buffer_load_dwordx4 v8, s[80:83], s33 offen lds
s_add_u32 s33, s33, 131072
s_add_u32 m0, s36, 14336
s_nop 0
buffer_load_dwordx4 v8, s[80:83], s33 offen lds
s_add_u32 s33, s33, 131072
s_add_u32 m0, s36, 15360
s_nop 0
buffer_load_dwordx4 v8, s[80:83], s33 offen lds
s_waitcnt vmcnt(50)
ds_read_b64_tr_b16 a[128:129], v10 offset:16384
ds_read_b64_tr_b16 a[130:131], v10 offset:16640
ds_read_b64_tr_b16 a[132:133], v10 offset:18432
ds_read_b64_tr_b16 a[134:135], v10 offset:18688
ds_read_b64_tr_b16 a[136:137], v10 offset:16392
ds_read_b64_tr_b16 a[138:139], v10 offset:16648
ds_read_b64_tr_b16 a[140:141], v10 offset:18440
ds_read_b64_tr_b16 a[142:143], v10 offset:18696
s_waitcnt lgkmcnt(0)
s_xor_b32 s33, s16, 1
s_add_u32 s33, s33, 0
s_lshl_b32 s33, s33, 19
s_lshl_b32 s34, s15, 8
s_add_u32 s33, s33, s34
s_lshl_b32 s34, s16, 6
s_add_u32 s33, s33, s34
s_add_u32 m0, s36, 16384
s_nop 0
buffer_load_dwordx4 v8, s[80:83], s33 offen lds
s_add_u32 s33, s33, 131072
s_add_u32 m0, s36, 17408
s_nop 0
buffer_load_dwordx4 v8, s[80:83], s33 offen lds
s_add_u32 s33, s33, 131072
s_add_u32 m0, s36, 18432
s_nop 0
buffer_load_dwordx4 v8, s[80:83], s33 offen lds
s_add_u32 s33, s33, 131072
s_add_u32 m0, s36, 19456
s_nop 0
buffer_load_dwordx4 v8, s[80:83], s33 offen lds
s_waitcnt vmcnt(48)
ds_read_b64_tr_b16 v[72:73], v10 offset:20480
ds_read_b64_tr_b16 v[74:75], v10 offset:20736
ds_read_b64_tr_b16 v[76:77], v10 offset:22528
ds_read_b64_tr_b16 v[78:79], v10 offset:22784
ds_read_b64_tr_b16 a[144:145], v10 offset:20488
ds_read_b64_tr_b16 a[146:147], v10 offset:20744
ds_read_b64_tr_b16 a[148:149], v10 offset:22536
ds_read_b64_tr_b16 a[150:151], v10 offset:22792
s_waitcnt lgkmcnt(0)
s_add_u32 s33, s43, 16384
buffer_store_dwordx4 v[72:75], v0, s[4:7], s33 offen offset:0
buffer_store_dwordx4 v[76:79], v0, s[4:7], s33 offen offset:1024
s_xor_b32 s33, s16, 1
s_add_u32 s33, s33, 4
s_lshl_b32 s33, s33, 19
s_lshl_b32 s34, s15, 8
s_add_u32 s33, s33, s34
s_lshl_b32 s34, s16, 6
s_add_u32 s33, s33, s34
s_add_u32 m0, s36, 20480
s_nop 0
buffer_load_dwordx4 v8, s[80:83], s33 offen lds
s_add_u32 s33, s33, 131072
s_add_u32 m0, s36, 21504
s_nop 0
buffer_load_dwordx4 v8, s[80:83], s33 offen lds
s_add_u32 s33, s33, 131072
s_add_u32 m0, s36, 22528
s_nop 0
buffer_load_dwordx4 v8, s[80:83], s33 offen lds
s_add_u32 s33, s33, 131072
s_add_u32 m0, s36, 23552
s_nop 0
buffer_load_dwordx4 v8, s[80:83], s33 offen lds
s_waitcnt vmcnt(46)
ds_read_b64_tr_b16 a[152:153], v10 offset:24576
ds_read_b64_tr_b16 a[154:155], v10 offset:24832
ds_read_b64_tr_b16 a[156:157], v10 offset:26624
ds_read_b64_tr_b16 a[158:159], v10 offset:26880
ds_read_b64_tr_b16 a[160:161], v10 offset:24584
ds_read_b64_tr_b16 a[162:163], v10 offset:24840
ds_read_b64_tr_b16 a[164:165], v10 offset:26632
ds_read_b64_tr_b16 a[166:167], v10 offset:26888
s_waitcnt lgkmcnt(0)
s_xor_b32 s33, s16, 2
s_add_u32 s33, s33, 0
s_lshl_b32 s33, s33, 19
s_lshl_b32 s34, s15, 8
s_add_u32 s33, s33, s34
s_lshl_b32 s34, s16, 6
s_add_u32 s33, s33, s34
s_add_u32 m0, s36, 24576
s_nop 0
buffer_load_dwordx4 v8, s[80:83], s33 offen lds
s_add_u32 s33, s33, 131072
s_add_u32 m0, s36, 25600
s_nop 0
buffer_load_dwordx4 v8, s[80:83], s33 offen lds
s_add_u32 s33, s33, 131072
s_add_u32 m0, s36, 26624
s_nop 0
buffer_load_dwordx4 v8, s[80:83], s33 offen lds
s_add_u32 s33, s33, 131072
s_add_u32 m0, s36, 27648
s_nop 0
buffer_load_dwordx4 v8, s[80:83], s33 offen lds
s_waitcnt vmcnt(46)
ds_read_b64_tr_b16 v[80:81], v10 offset:28672
ds_read_b64_tr_b16 v[82:83], v10 offset:28928
ds_read_b64_tr_b16 v[84:85], v10 offset:30720
ds_read_b64_tr_b16 v[86:87], v10 offset:30976
ds_read_b64_tr_b16 a[168:169], v10 offset:28680
ds_read_b64_tr_b16 a[170:171], v10 offset:28936
ds_read_b64_tr_b16 a[172:173], v10 offset:30728
ds_read_b64_tr_b16 a[174:175], v10 offset:30984
s_waitcnt lgkmcnt(0)
s_add_u32 s33, s23, 12288
buffer_store_dwordx4 v[80:83], v0, s[4:7], s33 offen offset:0
buffer_store_dwordx4 v[84:87], v0, s[4:7], s33 offen offset:1024
s_xor_b32 s33, s16, 2
s_add_u32 s33, s33, 4
s_lshl_b32 s33, s33, 19
s_lshl_b32 s34, s15, 8
s_add_u32 s33, s33, s34
s_lshl_b32 s34, s16, 6
s_add_u32 s33, s33, s34
s_add_u32 m0, s36, 28672
s_nop 0
buffer_load_dwordx4 v8, s[80:83], s33 offen lds
s_add_u32 s33, s33, 131072
s_add_u32 m0, s36, 29696
s_nop 0
buffer_load_dwordx4 v8, s[80:83], s33 offen lds
s_add_u32 s33, s33, 131072
s_add_u32 m0, s36, 30720
s_nop 0
buffer_load_dwordx4 v8, s[80:83], s33 offen lds
s_add_u32 s33, s33, 131072
s_add_u32 m0, s36, 31744
s_nop 0
buffer_load_dwordx4 v8, s[80:83], s33 offen lds
s_waitcnt vmcnt(46)
ds_read_b64_tr_b16 a[176:177], v10 offset:32768
ds_read_b64_tr_b16 a[178:179], v10 offset:33024
ds_read_b64_tr_b16 a[180:181], v10 offset:34816
ds_read_b64_tr_b16 a[182:183], v10 offset:35072
ds_read_b64_tr_b16 v[48:49], v10 offset:32776
ds_read_b64_tr_b16 v[50:51], v10 offset:33032
ds_read_b64_tr_b16 v[52:53], v10 offset:34824
ds_read_b64_tr_b16 v[54:55], v10 offset:35080
s_waitcnt lgkmcnt(0)
s_add_u32 s33, s43, 18432
buffer_store_dwordx4 v[48:51], v0, s[4:7], s33 offen offset:0
buffer_store_dwordx4 v[52:55], v0, s[4:7], s33 offen offset:1024
s_xor_b32 s33, s16, 3
s_add_u32 s33, s33, 0
s_lshl_b32 s33, s33, 19
s_lshl_b32 s34, s15, 8
s_add_u32 s33, s33, s34
s_lshl_b32 s34, s16, 6
s_add_u32 s33, s33, s34
s_add_u32 m0, s36, 32768
s_nop 0
buffer_load_dwordx4 v8, s[80:83], s33 offen lds
s_add_u32 s33, s33, 131072
s_add_u32 m0, s36, 33792
s_nop 0
buffer_load_dwordx4 v8, s[80:83], s33 offen lds
s_add_u32 s33, s33, 131072
s_add_u32 m0, s36, 34816
s_nop 0
buffer_load_dwordx4 v8, s[80:83], s33 offen lds
s_add_u32 s33, s33, 131072
s_add_u32 m0, s36, 35840
s_nop 0
buffer_load_dwordx4 v8, s[80:83], s33 offen lds
s_waitcnt vmcnt(48)
ds_read_b64_tr_b16 a[184:185], v10 offset:0
ds_read_b64_tr_b16 a[186:187], v10 offset:256
ds_read_b64_tr_b16 a[188:189], v10 offset:2048
ds_read_b64_tr_b16 a[190:191], v10 offset:2304
ds_read_b64_tr_b16 a[192:193], v10 offset:8
ds_read_b64_tr_b16 a[194:195], v10 offset:264
ds_read_b64_tr_b16 a[196:197], v10 offset:2056
ds_read_b64_tr_b16 a[198:199], v10 offset:2312
s_waitcnt lgkmcnt(0)
s_xor_b32 s33, s16, 3
s_add_u32 s33, s33, 4
s_lshl_b32 s33, s33, 19
s_lshl_b32 s34, s15, 8
s_add_u32 s33, s33, s34
s_lshl_b32 s34, s16, 6
s_add_u32 s33, s33, s34
s_add_u32 m0, s36, 0
s_nop 0
buffer_load_dwordx4 v8, s[80:83], s33 offen lds
s_add_u32 s33, s33, 131072
s_add_u32 m0, s36, 1024
s_nop 0
buffer_load_dwordx4 v8, s[80:83], s33 offen lds
s_add_u32 s33, s33, 131072
s_add_u32 m0, s36, 2048
s_nop 0
buffer_load_dwordx4 v8, s[80:83], s33 offen lds
s_add_u32 s33, s33, 131072
s_add_u32 m0, s36, 3072
s_nop 0
buffer_load_dwordx4 v8, s[80:83], s33 offen lds
s_waitcnt vmcnt(44)
ds_read_b64_tr_b16 a[200:201], v10 offset:4096
ds_read_b64_tr_b16 a[202:203], v10 offset:4352
ds_read_b64_tr_b16 a[204:205], v10 offset:6144
ds_read_b64_tr_b16 a[206:207], v10 offset:6400
ds_read_b64_tr_b16 a[208:209], v10 offset:4104
ds_read_b64_tr_b16 a[210:211], v10 offset:4360
ds_read_b64_tr_b16 a[212:213], v10 offset:6152
ds_read_b64_tr_b16 a[214:215], v10 offset:6408
s_waitcnt lgkmcnt(0)
s_mov_b32 s33, 8
s_lshl_b32 s33, s33, 19
s_lshl_b32 s34, s15, 8
s_add_u32 s33, s33, s34
s_lshl_b32 s34, s16, 6
s_add_u32 s33, s33, s34
s_add_u32 m0, s36, 4096
s_nop 0
buffer_load_dwordx4 v8, s[80:83], s33 offen lds
s_add_u32 s33, s33, 131072
s_add_u32 m0, s36, 5120
s_nop 0
buffer_load_dwordx4 v8, s[80:83], s33 offen lds
s_add_u32 s33, s33, 131072
s_add_u32 m0, s36, 6144
s_nop 0
buffer_load_dwordx4 v8, s[80:83], s33 offen lds
s_add_u32 s33, s33, 131072
s_add_u32 m0, s36, 7168
s_nop 0
buffer_load_dwordx4 v8, s[80:83], s33 offen lds
s_waitcnt vmcnt(42)
ds_read_b64_tr_b16 v[56:57], v10 offset:8192
ds_read_b64_tr_b16 v[58:59], v10 offset:8448
ds_read_b64_tr_b16 v[60:61], v10 offset:10240
ds_read_b64_tr_b16 v[62:63], v10 offset:10496
ds_read_b64_tr_b16 a[0:1], v10 offset:8200
ds_read_b64_tr_b16 a[2:3], v10 offset:8456
ds_read_b64_tr_b16 a[4:5], v10 offset:10248
ds_read_b64_tr_b16 a[6:7], v10 offset:10504
s_waitcnt lgkmcnt(0)
s_add_u32 s33, s43, 0
buffer_store_dwordx4 v[56:59], v0, s[4:7], s33 offen offset:0
buffer_store_dwordx4 v[60:63], v0, s[4:7], s33 offen offset:1024
s_mov_b32 s33, 9
s_lshl_b32 s33, s33, 19
s_lshl_b32 s34, s15, 8
s_add_u32 s33, s33, s34
s_lshl_b32 s34, s16, 6
s_add_u32 s33, s33, s34
s_add_u32 m0, s36, 8192
s_nop 0
buffer_load_dwordx4 v8, s[80:83], s33 offen lds
s_add_u32 s33, s33, 131072
s_add_u32 m0, s36, 9216
s_nop 0
buffer_load_dwordx4 v8, s[80:83], s33 offen lds
s_add_u32 s33, s33, 131072
s_add_u32 m0, s36, 10240
s_nop 0
buffer_load_dwordx4 v8, s[80:83], s33 offen lds
s_add_u32 s33, s33, 131072
s_add_u32 m0, s36, 11264
s_nop 0
buffer_load_dwordx4 v8, s[80:83], s33 offen lds
s_waitcnt vmcnt(40)
ds_read_b64_tr_b16 v[72:73], v10 offset:12288
ds_read_b64_tr_b16 v[74:75], v10 offset:12544
ds_read_b64_tr_b16 v[76:77], v10 offset:14336
ds_read_b64_tr_b16 v[78:79], v10 offset:14592
ds_read_b64_tr_b16 a[32:33], v10 offset:12296
ds_read_b64_tr_b16 a[34:35], v10 offset:12552
ds_read_b64_tr_b16 a[36:37], v10 offset:14344
ds_read_b64_tr_b16 a[38:39], v10 offset:14600
s_waitcnt lgkmcnt(0)
s_add_u32 s33, s43, 4096
buffer_store_dwordx4 v[72:75], v0, s[4:7], s33 offen offset:0
buffer_store_dwordx4 v[76:79], v0, s[4:7], s33 offen offset:1024
s_xor_b32 s33, s16, 0
s_lshl_b32 s33, s33, 5
s_lshl_b32 s34, s15, 7
s_add_u32 s33, s33, s34
s_add_u32 s33, s33, 0
s_mul_i32 s33, s33, 1280
s_lshl_b32 s34, s16, 6
s_add_u32 s33, s33, s34
s_add_u32 s33, s33, 0
s_add_u32 m0, s36, 12288
s_nop 0
buffer_load_dwordx4 v9, s[84:87], s33 offen lds
s_xor_b32 s33, s16, 0
s_lshl_b32 s33, s33, 5
s_lshl_b32 s34, s15, 7
s_add_u32 s33, s33, s34
s_add_u32 s33, s33, 16
s_mul_i32 s33, s33, 1280
s_lshl_b32 s34, s16, 6
s_add_u32 s33, s33, s34
s_add_u32 s33, s33, 0
s_add_u32 m0, s36, 13312
s_nop 0
buffer_load_dwordx4 v9, s[84:87], s33 offen lds
s_xor_b32 s33, s16, 1
s_lshl_b32 s33, s33, 5
s_lshl_b32 s34, s15, 7
s_add_u32 s33, s33, s34
s_add_u32 s33, s33, 0
s_mul_i32 s33, s33, 1280
s_lshl_b32 s34, s16, 6
s_add_u32 s33, s33, s34
s_add_u32 s33, s33, 0
s_add_u32 m0, s36, 14336
s_nop 0
buffer_load_dwordx4 v9, s[84:87], s33 offen lds
s_xor_b32 s33, s16, 1
s_lshl_b32 s33, s33, 5
s_lshl_b32 s34, s15, 7
s_add_u32 s33, s33, s34
s_add_u32 s33, s33, 16
s_mul_i32 s33, s33, 1280
s_lshl_b32 s34, s16, 6
s_add_u32 s33, s33, s34
s_add_u32 s33, s33, 0
s_add_u32 m0, s36, 15360
s_nop 0
buffer_load_dwordx4 v9, s[84:87], s33 offen lds
s_waitcnt vmcnt(42)
ds_read_b64_tr_b16 a[216:217], v10 offset:16384
ds_read_b64_tr_b16 a[218:219], v10 offset:16640
ds_read_b64_tr_b16 a[220:221], v10 offset:18432
ds_read_b64_tr_b16 a[222:223], v10 offset:18688
ds_read_b64_tr_b16 v[80:81], v10 offset:16392
ds_read_b64_tr_b16 v[82:83], v10 offset:16648
ds_read_b64_tr_b16 v[84:85], v10 offset:18440
ds_read_b64_tr_b16 v[86:87], v10 offset:18696
s_waitcnt lgkmcnt(0)
s_add_u32 s33, s43, 20480
buffer_store_dwordx4 v[80:83], v0, s[4:7], s33 offen offset:0
buffer_store_dwordx4 v[84:87], v0, s[4:7], s33 offen offset:1024
s_xor_b32 s33, s16, 2
s_lshl_b32 s33, s33, 5
s_lshl_b32 s34, s15, 7
s_add_u32 s33, s33, s34
s_add_u32 s33, s33, 0
s_mul_i32 s33, s33, 1280
s_lshl_b32 s34, s16, 6
s_add_u32 s33, s33, s34
s_add_u32 s33, s33, 0
s_add_u32 m0, s36, 16384
s_nop 0
buffer_load_dwordx4 v9, s[84:87], s33 offen lds
s_xor_b32 s33, s16, 2
s_lshl_b32 s33, s33, 5
s_lshl_b32 s34, s15, 7
s_add_u32 s33, s33, s34
s_add_u32 s33, s33, 16
s_mul_i32 s33, s33, 1280
s_lshl_b32 s34, s16, 6
s_add_u32 s33, s33, s34
s_add_u32 s33, s33, 0
s_add_u32 m0, s36, 17408
s_nop 0
buffer_load_dwordx4 v9, s[84:87], s33 offen lds
s_xor_b32 s33, s16, 3
s_lshl_b32 s33, s33, 5
s_lshl_b32 s34, s15, 7
s_add_u32 s33, s33, s34
s_add_u32 s33, s33, 0
s_mul_i32 s33, s33, 1280
s_lshl_b32 s34, s16, 6
s_add_u32 s33, s33, s34
s_add_u32 s33, s33, 0
s_add_u32 m0, s36, 18432
s_nop 0
buffer_load_dwordx4 v9, s[84:87], s33 offen lds
s_xor_b32 s33, s16, 3
s_lshl_b32 s33, s33, 5
s_lshl_b32 s34, s15, 7
s_add_u32 s33, s33, s34
s_add_u32 s33, s33, 16
s_mul_i32 s33, s33, 1280
s_lshl_b32 s34, s16, 6
s_add_u32 s33, s33, s34
s_add_u32 s33, s33, 0
s_add_u32 m0, s36, 19456
s_nop 0
buffer_load_dwordx4 v9, s[84:87], s33 offen lds
s_waitcnt vmcnt(42)
ds_read_b64_tr_b16 a[224:225], v10 offset:20480
ds_read_b64_tr_b16 a[226:227], v10 offset:20736
ds_read_b64_tr_b16 a[228:229], v10 offset:22528
ds_read_b64_tr_b16 a[230:231], v10 offset:22784
ds_read_b64_tr_b16 a[232:233], v10 offset:20488
ds_read_b64_tr_b16 a[234:235], v10 offset:20744
ds_read_b64_tr_b16 a[236:237], v10 offset:22536
ds_read_b64_tr_b16 a[238:239], v10 offset:22792
s_waitcnt lgkmcnt(0)
s_xor_b32 s33, s16, 0
s_lshl_b32 s33, s33, 5
s_lshl_b32 s34, s15, 7
s_add_u32 s33, s33, s34
s_add_u32 s33, s33, 0
s_mul_i32 s33, s33, 1280
s_lshl_b32 s34, s16, 6
s_add_u32 s33, s33, s34
s_add_u32 s33, s33, 256
s_add_u32 m0, s36, 20480
s_nop 0
buffer_load_dwordx4 v9, s[84:87], s33 offen lds
s_xor_b32 s33, s16, 0
s_lshl_b32 s33, s33, 5
s_lshl_b32 s34, s15, 7
s_add_u32 s33, s33, s34
s_add_u32 s33, s33, 16
s_mul_i32 s33, s33, 1280
s_lshl_b32 s34, s16, 6
s_add_u32 s33, s33, s34
s_add_u32 s33, s33, 256
s_add_u32 m0, s36, 21504
s_nop 0
buffer_load_dwordx4 v9, s[84:87], s33 offen lds
s_xor_b32 s33, s16, 1
s_lshl_b32 s33, s33, 5
s_lshl_b32 s34, s15, 7
s_add_u32 s33, s33, s34
s_add_u32 s33, s33, 0
s_mul_i32 s33, s33, 1280
s_lshl_b32 s34, s16, 6
s_add_u32 s33, s33, s34
s_add_u32 s33, s33, 256
s_add_u32 m0, s36, 22528
s_nop 0
buffer_load_dwordx4 v9, s[84:87], s33 offen lds
s_xor_b32 s33, s16, 1
s_lshl_b32 s33, s33, 5
s_lshl_b32 s34, s15, 7
s_add_u32 s33, s33, s34
s_add_u32 s33, s33, 16
s_mul_i32 s33, s33, 1280
s_lshl_b32 s34, s16, 6
s_add_u32 s33, s33, s34
s_add_u32 s33, s33, 256
s_add_u32 m0, s36, 23552
s_nop 0
buffer_load_dwordx4 v9, s[84:87], s33 offen lds
s_waitcnt vmcnt(42)
ds_read_b64_tr_b16 a[240:241], v10 offset:24576
ds_read_b64_tr_b16 a[242:243], v10 offset:24832
ds_read_b64_tr_b16 a[244:245], v10 offset:26624
ds_read_b64_tr_b16 a[246:247], v10 offset:26880
ds_read_b64_tr_b16 a[248:249], v10 offset:24584
ds_read_b64_tr_b16 a[250:251], v10 offset:24840
ds_read_b64_tr_b16 a[252:253], v10 offset:26632
ds_read_b64_tr_b16 a[254:255], v10 offset:26888
s_waitcnt lgkmcnt(0)
s_xor_b32 s33, s16, 2
s_lshl_b32 s33, s33, 5
s_lshl_b32 s34, s15, 7
s_add_u32 s33, s33, s34
s_add_u32 s33, s33, 0
s_mul_i32 s33, s33, 1280
s_lshl_b32 s34, s16, 6
s_add_u32 s33, s33, s34
s_add_u32 s33, s33, 256
s_add_u32 m0, s36, 24576
s_nop 0
buffer_load_dwordx4 v9, s[84:87], s33 offen lds
s_xor_b32 s33, s16, 2
s_lshl_b32 s33, s33, 5
s_lshl_b32 s34, s15, 7
s_add_u32 s33, s33, s34
s_add_u32 s33, s33, 16
s_mul_i32 s33, s33, 1280
s_lshl_b32 s34, s16, 6
s_add_u32 s33, s33, s34
s_add_u32 s33, s33, 256
s_add_u32 m0, s36, 25600
s_nop 0
buffer_load_dwordx4 v9, s[84:87], s33 offen lds
s_xor_b32 s33, s16, 3
s_lshl_b32 s33, s33, 5
s_lshl_b32 s34, s15, 7
s_add_u32 s33, s33, s34
s_add_u32 s33, s33, 0
s_mul_i32 s33, s33, 1280
s_lshl_b32 s34, s16, 6
s_add_u32 s33, s33, s34
s_add_u32 s33, s33, 256
s_add_u32 m0, s36, 26624
s_nop 0
buffer_load_dwordx4 v9, s[84:87], s33 offen lds
s_xor_b32 s33, s16, 3
s_lshl_b32 s33, s33, 5
s_lshl_b32 s34, s15, 7
s_add_u32 s33, s33, s34
s_add_u32 s33, s33, 16
s_mul_i32 s33, s33, 1280
s_lshl_b32 s34, s16, 6
s_add_u32 s33, s33, s34
s_add_u32 s33, s33, 256
s_add_u32 m0, s36, 27648
s_nop 0
buffer_load_dwordx4 v9, s[84:87], s33 offen lds
s_waitcnt vmcnt(40)
ds_read_b64_tr_b16 v[48:49], v10 offset:28672
ds_read_b64_tr_b16 v[50:51], v10 offset:28928
ds_read_b64_tr_b16 v[52:53], v10 offset:30720
ds_read_b64_tr_b16 v[54:55], v10 offset:30976
ds_read_b64_tr_b16 v[88:89], v10 offset:28680
ds_read_b64_tr_b16 v[90:91], v10 offset:28936
ds_read_b64_tr_b16 v[92:93], v10 offset:30728
ds_read_b64_tr_b16 v[94:95], v10 offset:30984
s_waitcnt lgkmcnt(0)
s_add_u32 s33, s23, 14336
buffer_store_dwordx4 v[48:51], v0, s[4:7], s33 offen offset:0
buffer_store_dwordx4 v[52:55], v0, s[4:7], s33 offen offset:1024
s_xor_b32 s33, s16, 0
s_lshl_b32 s33, s33, 5
s_lshl_b32 s34, s15, 7
s_add_u32 s33, s33, s34
s_add_u32 s33, s33, 0
s_mul_i32 s33, s33, 1280
s_lshl_b32 s34, s16, 6
s_add_u32 s33, s33, s34
s_add_u32 s33, s33, 512
s_add_u32 m0, s36, 28672
s_nop 0
buffer_load_dwordx4 v9, s[84:87], s33 offen lds
s_xor_b32 s33, s16, 0
s_lshl_b32 s33, s33, 5
s_lshl_b32 s34, s15, 7
s_add_u32 s33, s33, s34
s_add_u32 s33, s33, 16
s_mul_i32 s33, s33, 1280
s_lshl_b32 s34, s16, 6
s_add_u32 s33, s33, s34
s_add_u32 s33, s33, 512
s_add_u32 m0, s36, 29696
s_nop 0
buffer_load_dwordx4 v9, s[84:87], s33 offen lds
s_xor_b32 s33, s16, 1
s_lshl_b32 s33, s33, 5
s_lshl_b32 s34, s15, 7
s_add_u32 s33, s33, s34
s_add_u32 s33, s33, 0
s_mul_i32 s33, s33, 1280
s_lshl_b32 s34, s16, 6
s_add_u32 s33, s33, s34
s_add_u32 s33, s33, 512
s_add_u32 m0, s36, 30720
s_nop 0
buffer_load_dwordx4 v9, s[84:87], s33 offen lds
s_xor_b32 s33, s16, 1
s_lshl_b32 s33, s33, 5
s_lshl_b32 s34, s15, 7
s_add_u32 s33, s33, s34
s_add_u32 s33, s33, 16
s_mul_i32 s33, s33, 1280
s_lshl_b32 s34, s16, 6
s_add_u32 s33, s33, s34
s_add_u32 s33, s33, 512
s_add_u32 m0, s36, 31744
s_nop 0
buffer_load_dwordx4 v9, s[84:87], s33 offen lds
s_waitcnt vmcnt(40)
ds_read_b64_tr_b16 v[96:97], v10 offset:32768
ds_read_b64_tr_b16 v[98:99], v10 offset:33024
ds_read_b64_tr_b16 v[100:101], v10 offset:34816
ds_read_b64_tr_b16 v[102:103], v10 offset:35072
ds_read_b64_tr_b16 v[104:105], v10 offset:32776
ds_read_b64_tr_b16 v[106:107], v10 offset:33032
ds_read_b64_tr_b16 v[108:109], v10 offset:34824
ds_read_b64_tr_b16 v[110:111], v10 offset:35080
s_waitcnt lgkmcnt(0)
s_xor_b32 s33, s16, 2
s_lshl_b32 s33, s33, 5
s_lshl_b32 s34, s15, 7
s_add_u32 s33, s33, s34
s_add_u32 s33, s33, 0
s_mul_i32 s33, s33, 1280
s_lshl_b32 s34, s16, 6
s_add_u32 s33, s33, s34
s_add_u32 s33, s33, 512
s_add_u32 m0, s36, 32768
s_nop 0
buffer_load_dwordx4 v9, s[84:87], s33 offen lds
s_xor_b32 s33, s16, 2
s_lshl_b32 s33, s33, 5
s_lshl_b32 s34, s15, 7
s_add_u32 s33, s33, s34
s_add_u32 s33, s33, 16
s_mul_i32 s33, s33, 1280
s_lshl_b32 s34, s16, 6
s_add_u32 s33, s33, s34
s_add_u32 s33, s33, 512
s_add_u32 m0, s36, 33792
s_nop 0
buffer_load_dwordx4 v9, s[84:87], s33 offen lds
s_xor_b32 s33, s16, 3
s_lshl_b32 s33, s33, 5
s_lshl_b32 s34, s15, 7
s_add_u32 s33, s33, s34
s_add_u32 s33, s33, 0
s_mul_i32 s33, s33, 1280
s_lshl_b32 s34, s16, 6
s_add_u32 s33, s33, s34
s_add_u32 s33, s33, 512
s_add_u32 m0, s36, 34816
s_nop 0
buffer_load_dwordx4 v9, s[84:87], s33 offen lds
s_xor_b32 s33, s16, 3
s_lshl_b32 s33, s33, 5
s_lshl_b32 s34, s15, 7
s_add_u32 s33, s33, s34
s_add_u32 s33, s33, 16
s_mul_i32 s33, s33, 1280
s_lshl_b32 s34, s16, 6
s_add_u32 s33, s33, s34
s_add_u32 s33, s33, 512
s_add_u32 m0, s36, 35840
s_nop 0
buffer_load_dwordx4 v9, s[84:87], s33 offen lds
s_waitcnt vmcnt(40)
ds_read_b64_tr_b16 v[112:113], v10 offset:0
ds_read_b64_tr_b16 v[114:115], v10 offset:256
ds_read_b64_tr_b16 v[116:117], v10 offset:2048
ds_read_b64_tr_b16 v[118:119], v10 offset:2304
ds_read_b64_tr_b16 v[120:121], v10 offset:8
ds_read_b64_tr_b16 v[122:123], v10 offset:264
ds_read_b64_tr_b16 v[124:125], v10 offset:2056
ds_read_b64_tr_b16 v[126:127], v10 offset:2312
s_waitcnt lgkmcnt(0)
s_xor_b32 s33, s16, 0
s_lshl_b32 s33, s33, 5
s_lshl_b32 s34, s15, 7
s_add_u32 s33, s33, s34
s_add_u32 s33, s33, 0
s_mul_i32 s33, s33, 1280
s_lshl_b32 s34, s16, 6
s_add_u32 s33, s33, s34
s_add_u32 s33, s33, 768
s_add_u32 m0, s36, 0
s_nop 0
buffer_load_dwordx4 v9, s[84:87], s33 offen lds
s_xor_b32 s33, s16, 0
s_lshl_b32 s33, s33, 5
s_lshl_b32 s34, s15, 7
s_add_u32 s33, s33, s34
s_add_u32 s33, s33, 16
s_mul_i32 s33, s33, 1280
s_lshl_b32 s34, s16, 6
s_add_u32 s33, s33, s34
s_add_u32 s33, s33, 768
s_add_u32 m0, s36, 1024
s_nop 0
buffer_load_dwordx4 v9, s[84:87], s33 offen lds
s_xor_b32 s33, s16, 1
s_lshl_b32 s33, s33, 5
s_lshl_b32 s34, s15, 7
s_add_u32 s33, s33, s34
s_add_u32 s33, s33, 0
s_mul_i32 s33, s33, 1280
s_lshl_b32 s34, s16, 6
s_add_u32 s33, s33, s34
s_add_u32 s33, s33, 768
s_add_u32 m0, s36, 2048
s_nop 0
buffer_load_dwordx4 v9, s[84:87], s33 offen lds
s_xor_b32 s33, s16, 1
s_lshl_b32 s33, s33, 5
s_lshl_b32 s34, s15, 7
s_add_u32 s33, s33, s34
s_add_u32 s33, s33, 16
s_mul_i32 s33, s33, 1280
s_lshl_b32 s34, s16, 6
s_add_u32 s33, s33, s34
s_add_u32 s33, s33, 768
s_add_u32 m0, s36, 3072
s_nop 0
buffer_load_dwordx4 v9, s[84:87], s33 offen lds
s_waitcnt vmcnt(40)
ds_read_b64_tr_b16 v[128:129], v10 offset:4096
ds_read_b64_tr_b16 v[130:131], v10 offset:4352
ds_read_b64_tr_b16 v[132:133], v10 offset:6144
ds_read_b64_tr_b16 v[134:135], v10 offset:6400
ds_read_b64_tr_b16 v[136:137], v10 offset:4104
ds_read_b64_tr_b16 v[138:139], v10 offset:4360
ds_read_b64_tr_b16 v[140:141], v10 offset:6152
ds_read_b64_tr_b16 v[142:143], v10 offset:6408
s_waitcnt lgkmcnt(0)
s_xor_b32 s33, s16, 2
s_lshl_b32 s33, s33, 5
s_lshl_b32 s34, s15, 7
s_add_u32 s33, s33, s34
s_add_u32 s33, s33, 0
s_mul_i32 s33, s33, 1280
s_lshl_b32 s34, s16, 6
s_add_u32 s33, s33, s34
s_add_u32 s33, s33, 768
s_add_u32 m0, s36, 4096
s_nop 0
buffer_load_dwordx4 v9, s[84:87], s33 offen lds
s_xor_b32 s33, s16, 2
s_lshl_b32 s33, s33, 5
s_lshl_b32 s34, s15, 7
s_add_u32 s33, s33, s34
s_add_u32 s33, s33, 16
s_mul_i32 s33, s33, 1280
s_lshl_b32 s34, s16, 6
s_add_u32 s33, s33, s34
s_add_u32 s33, s33, 768
s_add_u32 m0, s36, 5120
s_nop 0
buffer_load_dwordx4 v9, s[84:87], s33 offen lds
s_xor_b32 s33, s16, 3
s_lshl_b32 s33, s33, 5
s_lshl_b32 s34, s15, 7
s_add_u32 s33, s33, s34
s_add_u32 s33, s33, 0
s_mul_i32 s33, s33, 1280
s_lshl_b32 s34, s16, 6
s_add_u32 s33, s33, s34
s_add_u32 s33, s33, 768
s_add_u32 m0, s36, 6144
s_nop 0
buffer_load_dwordx4 v9, s[84:87], s33 offen lds
s_xor_b32 s33, s16, 3
s_lshl_b32 s33, s33, 5
s_lshl_b32 s34, s15, 7
s_add_u32 s33, s33, s34
s_add_u32 s33, s33, 16
s_mul_i32 s33, s33, 1280
s_lshl_b32 s34, s16, 6
s_add_u32 s33, s33, s34
s_add_u32 s33, s33, 768
s_add_u32 m0, s36, 7168
s_nop 0
buffer_load_dwordx4 v9, s[84:87], s33 offen lds
s_waitcnt vmcnt(38)
ds_read_b64_tr_b16 v[144:145], v10 offset:8192
ds_read_b64_tr_b16 v[146:147], v10 offset:8448
ds_read_b64_tr_b16 v[148:149], v10 offset:10240
ds_read_b64_tr_b16 v[150:151], v10 offset:10496
ds_read_b64_tr_b16 v[56:57], v10 offset:8200
ds_read_b64_tr_b16 v[58:59], v10 offset:8456
ds_read_b64_tr_b16 v[60:61], v10 offset:10248
ds_read_b64_tr_b16 v[62:63], v10 offset:10504
s_waitcnt lgkmcnt(0)
s_add_u32 s33, s23, 16384
buffer_store_dwordx4 v[56:59], v0, s[4:7], s33 offen offset:0
buffer_store_dwordx4 v[60:63], v0, s[4:7], s33 offen offset:1024
s_xor_b32 s33, s16, 0
s_lshl_b32 s33, s33, 5
s_lshl_b32 s34, s15, 7
s_add_u32 s33, s33, s34
s_add_u32 s33, s33, 0
s_mul_i32 s33, s33, 1280
s_lshl_b32 s34, s16, 6
s_add_u32 s33, s33, s34
s_add_u32 s33, s33, 1024
s_add_u32 m0, s36, 8192
s_nop 0
buffer_load_dwordx4 v9, s[84:87], s33 offen lds
s_xor_b32 s33, s16, 0
s_lshl_b32 s33, s33, 5
s_lshl_b32 s34, s15, 7
s_add_u32 s33, s33, s34
s_add_u32 s33, s33, 16
s_mul_i32 s33, s33, 1280
s_lshl_b32 s34, s16, 6
s_add_u32 s33, s33, s34
s_add_u32 s33, s33, 1024
s_add_u32 m0, s36, 9216
s_nop 0
buffer_load_dwordx4 v9, s[84:87], s33 offen lds
s_xor_b32 s33, s16, 1
s_lshl_b32 s33, s33, 5
s_lshl_b32 s34, s15, 7
s_add_u32 s33, s33, s34
s_add_u32 s33, s33, 0
s_mul_i32 s33, s33, 1280
s_lshl_b32 s34, s16, 6
s_add_u32 s33, s33, s34
s_add_u32 s33, s33, 1024
s_add_u32 m0, s36, 10240
s_nop 0
buffer_load_dwordx4 v9, s[84:87], s33 offen lds
s_xor_b32 s33, s16, 1
s_lshl_b32 s33, s33, 5
s_lshl_b32 s34, s15, 7
s_add_u32 s33, s33, s34
s_add_u32 s33, s33, 16
s_mul_i32 s33, s33, 1280
s_lshl_b32 s34, s16, 6
s_add_u32 s33, s33, s34
s_add_u32 s33, s33, 1024
s_add_u32 m0, s36, 11264
s_nop 0
buffer_load_dwordx4 v9, s[84:87], s33 offen lds
s_waitcnt vmcnt(38)
ds_read_b64_tr_b16 v[72:73], v11 offset:12288
ds_read_b64_tr_b16 v[74:75], v11 offset:12416
ds_read_b64_tr_b16 v[76:77], v11 offset:13312
ds_read_b64_tr_b16 v[78:79], v11 offset:13440
ds_read_b64_tr_b16 v[80:81], v11 offset:14336
ds_read_b64_tr_b16 v[82:83], v11 offset:14464
ds_read_b64_tr_b16 v[84:85], v11 offset:15360
ds_read_b64_tr_b16 v[86:87], v11 offset:15488
s_waitcnt lgkmcnt(0)
s_add_u32 s33, s43, 22528
buffer_store_dwordx4 v[72:75], v0, s[4:7], s33 offen offset:0
buffer_store_dwordx4 v[76:79], v0, s[4:7], s33 offen offset:1024
s_add_u32 s33, s43, 24576
buffer_store_dwordx4 v[80:83], v0, s[4:7], s33 offen offset:0
buffer_store_dwordx4 v[84:87], v0, s[4:7], s33 offen offset:1024
s_xor_b32 s33, s16, 2
s_lshl_b32 s33, s33, 5
s_lshl_b32 s34, s15, 7
s_add_u32 s33, s33, s34
s_add_u32 s33, s33, 0
s_mul_i32 s33, s33, 1280
s_lshl_b32 s34, s16, 6
s_add_u32 s33, s33, s34
s_add_u32 s33, s33, 1024
s_add_u32 m0, s36, 12288
s_nop 0
buffer_load_dwordx4 v9, s[84:87], s33 offen lds
s_xor_b32 s33, s16, 2
s_lshl_b32 s33, s33, 5
s_lshl_b32 s34, s15, 7
s_add_u32 s33, s33, s34
s_add_u32 s33, s33, 16
s_mul_i32 s33, s33, 1280
s_lshl_b32 s34, s16, 6
s_add_u32 s33, s33, s34
s_add_u32 s33, s33, 1024
s_add_u32 m0, s36, 13312
s_nop 0
buffer_load_dwordx4 v9, s[84:87], s33 offen lds
s_xor_b32 s33, s16, 3
s_lshl_b32 s33, s33, 5
s_lshl_b32 s34, s15, 7
s_add_u32 s33, s33, s34
s_add_u32 s33, s33, 0
s_mul_i32 s33, s33, 1280
s_lshl_b32 s34, s16, 6
s_add_u32 s33, s33, s34
s_add_u32 s33, s33, 1024
s_add_u32 m0, s36, 14336
s_nop 0
buffer_load_dwordx4 v9, s[84:87], s33 offen lds
s_xor_b32 s33, s16, 3
s_lshl_b32 s33, s33, 5
s_lshl_b32 s34, s15, 7
s_add_u32 s33, s33, s34
s_add_u32 s33, s33, 16
s_mul_i32 s33, s33, 1280
s_lshl_b32 s34, s16, 6
s_add_u32 s33, s33, s34
s_add_u32 s33, s33, 1024
s_add_u32 m0, s36, 15360
s_nop 0
buffer_load_dwordx4 v9, s[84:87], s33 offen lds
s_waitcnt vmcnt(40)
ds_read_b64_tr_b16 v[48:49], v11 offset:16384
ds_read_b64_tr_b16 v[50:51], v11 offset:16512
ds_read_b64_tr_b16 v[52:53], v11 offset:17408
ds_read_b64_tr_b16 v[54:55], v11 offset:17536
ds_read_b64_tr_b16 v[184:185], v11 offset:18432
ds_read_b64_tr_b16 v[186:187], v11 offset:18560
ds_read_b64_tr_b16 v[188:189], v11 offset:19456
ds_read_b64_tr_b16 v[190:191], v11 offset:19584
s_waitcnt lgkmcnt(0)
s_add_u32 s33, s43, 26624
buffer_store_dwordx4 v[48:51], v0, s[4:7], s33 offen offset:0
buffer_store_dwordx4 v[52:55], v0, s[4:7], s33 offen offset:1024
s_waitcnt vmcnt(38)
ds_read_b64_tr_b16 v[152:153], v11 offset:20480
ds_read_b64_tr_b16 v[154:155], v11 offset:20608
ds_read_b64_tr_b16 v[156:157], v11 offset:21504
ds_read_b64_tr_b16 v[158:159], v11 offset:21632
ds_read_b64_tr_b16 v[56:57], v11 offset:22528
ds_read_b64_tr_b16 v[58:59], v11 offset:22656
ds_read_b64_tr_b16 v[60:61], v11 offset:23552
ds_read_b64_tr_b16 v[62:63], v11 offset:23680
s_waitcnt lgkmcnt(0)
s_add_u32 s33, s43, 28672
buffer_store_dwordx4 v[56:59], v0, s[4:7], s33 offen offset:0
buffer_store_dwordx4 v[60:63], v0, s[4:7], s33 offen offset:1024
s_waitcnt vmcnt(36)
ds_read_b64_tr_b16 v[192:193], v11 offset:24576
ds_read_b64_tr_b16 v[194:195], v11 offset:24704
ds_read_b64_tr_b16 v[196:197], v11 offset:25600
ds_read_b64_tr_b16 v[198:199], v11 offset:25728
ds_read_b64_tr_b16 v[200:201], v11 offset:26624
ds_read_b64_tr_b16 v[202:203], v11 offset:26752
ds_read_b64_tr_b16 v[204:205], v11 offset:27648
ds_read_b64_tr_b16 v[206:207], v11 offset:27776
s_waitcnt lgkmcnt(0)
s_waitcnt vmcnt(30)
ds_read_b64_tr_b16 v[160:161], v11 offset:28672
ds_read_b64_tr_b16 v[162:163], v11 offset:28800
ds_read_b64_tr_b16 v[164:165], v11 offset:29696
ds_read_b64_tr_b16 v[166:167], v11 offset:29824
ds_read_b64_tr_b16 v[72:73], v11 offset:30720
ds_read_b64_tr_b16 v[74:75], v11 offset:30848
ds_read_b64_tr_b16 v[76:77], v11 offset:31744
ds_read_b64_tr_b16 v[78:79], v11 offset:31872
s_waitcnt lgkmcnt(0)
s_add_u32 s33, s43, 30720
buffer_store_dwordx4 v[72:75], v0, s[4:7], s33 offen offset:0
buffer_store_dwordx4 v[76:79], v0, s[4:7], s33 offen offset:1024
s_waitcnt vmcnt(28)
ds_read_b64_tr_b16 v[80:81], v11 offset:32768
ds_read_b64_tr_b16 v[82:83], v11 offset:32896
ds_read_b64_tr_b16 v[84:85], v11 offset:33792
ds_read_b64_tr_b16 v[86:87], v11 offset:33920
ds_read_b64_tr_b16 v[208:209], v11 offset:34816
ds_read_b64_tr_b16 v[210:211], v11 offset:34944
ds_read_b64_tr_b16 v[212:213], v11 offset:35840
ds_read_b64_tr_b16 v[214:215], v11 offset:35968
s_waitcnt lgkmcnt(0)
s_add_u32 s33, s43, 32768
buffer_store_dwordx4 v[80:83], v0, s[4:7], s33 offen offset:0
buffer_store_dwordx4 v[84:87], v0, s[4:7], s33 offen offset:1024
s_waitcnt vmcnt(26)
ds_read_b64_tr_b16 v[168:169], v11 offset:0
ds_read_b64_tr_b16 v[170:171], v11 offset:128
ds_read_b64_tr_b16 v[172:173], v11 offset:1024
ds_read_b64_tr_b16 v[174:175], v11 offset:1152
ds_read_b64_tr_b16 v[48:49], v11 offset:2048
ds_read_b64_tr_b16 v[50:51], v11 offset:2176
ds_read_b64_tr_b16 v[52:53], v11 offset:3072
ds_read_b64_tr_b16 v[54:55], v11 offset:3200
s_waitcnt lgkmcnt(0)
s_add_u32 s33, s43, 34816
buffer_store_dwordx4 v[48:51], v0, s[4:7], s33 offen offset:0
buffer_store_dwordx4 v[52:55], v0, s[4:7], s33 offen offset:1024
s_waitcnt vmcnt(24)
ds_read_b64_tr_b16 v[216:217], v11 offset:4096
ds_read_b64_tr_b16 v[218:219], v11 offset:4224
ds_read_b64_tr_b16 v[220:221], v11 offset:5120
ds_read_b64_tr_b16 v[222:223], v11 offset:5248
ds_read_b64_tr_b16 v[224:225], v11 offset:6144
ds_read_b64_tr_b16 v[226:227], v11 offset:6272
ds_read_b64_tr_b16 v[228:229], v11 offset:7168
ds_read_b64_tr_b16 v[230:231], v11 offset:7296
s_waitcnt lgkmcnt(0)
s_waitcnt vmcnt(18)
ds_read_b64_tr_b16 v[176:177], v11 offset:8192
ds_read_b64_tr_b16 v[178:179], v11 offset:8320
ds_read_b64_tr_b16 v[180:181], v11 offset:9216
ds_read_b64_tr_b16 v[182:183], v11 offset:9344
ds_read_b64_tr_b16 v[232:233], v11 offset:10240
ds_read_b64_tr_b16 v[234:235], v11 offset:10368
ds_read_b64_tr_b16 v[236:237], v11 offset:11264
ds_read_b64_tr_b16 v[238:239], v11 offset:11392
s_waitcnt lgkmcnt(0)
s_waitcnt vmcnt(10)
ds_read_b64_tr_b16 v[240:241], v11 offset:12288
ds_read_b64_tr_b16 v[242:243], v11 offset:12416
ds_read_b64_tr_b16 v[244:245], v11 offset:13312
ds_read_b64_tr_b16 v[246:247], v11 offset:13440
ds_read_b64_tr_b16 v[248:249], v11 offset:14336
ds_read_b64_tr_b16 v[250:251], v11 offset:14464
ds_read_b64_tr_b16 v[252:253], v11 offset:15360
ds_read_b64_tr_b16 v[254:255], v11 offset:15488
s_waitcnt lgkmcnt(0)
s_waitcnt vmcnt(0)
s_add_u32 m0, s36, 0
s_add_u32 s33, s43, 0
buffer_load_dwordx4 v0, s[4:7], s33 offen sc1 lds
s_add_u32 m0, s36, 1024
s_add_u32 s33, s43, 1024
buffer_load_dwordx4 v0, s[4:7], s33 offen sc1 lds
s_add_u32 m0, s36, 2048
s_add_u32 s33, s43, 2048
buffer_load_dwordx4 v0, s[4:7], s33 offen sc1 lds
s_add_u32 m0, s36, 3072
s_add_u32 s33, s43, 3072
buffer_load_dwordx4 v0, s[4:7], s33 offen sc1 lds
s_add_u32 m0, s36, 4096
s_add_u32 s33, s43, 4096
buffer_load_dwordx4 v0, s[4:7], s33 offen sc1 lds
s_add_u32 m0, s36, 5120
s_add_u32 s33, s43, 5120
buffer_load_dwordx4 v0, s[4:7], s33 offen sc1 lds
s_add_u32 m0, s36, 6144
s_add_u32 s33, s43, 6144
buffer_load_dwordx4 v0, s[4:7], s33 offen sc1 lds
s_add_u32 m0, s36, 7168
s_add_u32 s33, s43, 7168
buffer_load_dwordx4 v0, s[4:7], s33 offen sc1 lds
s_add_u32 m0, s36, 8192
s_add_u32 s33, s43, 8192
buffer_load_dwordx4 v0, s[4:7], s33 offen sc1 lds
s_add_u32 m0, s36, 9216
s_add_u32 s33, s43, 9216
buffer_load_dwordx4 v0, s[4:7], s33 offen sc1 lds
s_add_u32 m0, s36, 10240
s_add_u32 s33, s43, 10240
buffer_load_dwordx4 v0, s[4:7], s33 offen sc1 lds
s_add_u32 m0, s36, 11264
s_add_u32 s33, s43, 11264
buffer_load_dwordx4 v0, s[4:7], s33 offen sc1 lds
s_add_u32 m0, s36, 12288
s_add_u32 s33, s43, 12288
buffer_load_dwordx4 v0, s[4:7], s33 offen sc1 lds
s_add_u32 m0, s36, 13312
s_add_u32 s33, s43, 13312
buffer_load_dwordx4 v0, s[4:7], s33 offen sc1 lds
s_add_u32 m0, s36, 14336
s_add_u32 s33, s43, 14336
buffer_load_dwordx4 v0, s[4:7], s33 offen sc1 lds
s_add_u32 m0, s36, 15360
s_add_u32 s33, s43, 15360
buffer_load_dwordx4 v0, s[4:7], s33 offen sc1 lds
s_add_u32 m0, s36, 16384
s_add_u32 s33, s43, 16384
buffer_load_dwordx4 v0, s[4:7], s33 offen sc1 lds
s_add_u32 m0, s36, 17408
s_add_u32 s33, s43, 17408
buffer_load_dwordx4 v0, s[4:7], s33 offen sc1 lds
s_add_u32 m0, s36, 18432
s_add_u32 s33, s43, 18432
buffer_load_dwordx4 v0, s[4:7], s33 offen sc1 lds
s_add_u32 m0, s36, 19456
s_add_u32 s33, s43, 19456
buffer_load_dwordx4 v0, s[4:7], s33 offen sc1 lds
s_add_u32 m0, s36, 20480
s_add_u32 s33, s43, 20480
buffer_load_dwordx4 v0, s[4:7], s33 offen sc1 lds
s_add_u32 m0, s36, 21504
s_add_u32 s33, s43, 21504
buffer_load_dwordx4 v0, s[4:7], s33 offen sc1 lds
s_add_u32 m0, s36, 22528
s_add_u32 s33, s43, 22528
buffer_load_dwordx4 v0, s[4:7], s33 offen sc1 lds
s_add_u32 m0, s36, 23552
s_add_u32 s33, s43, 23552
buffer_load_dwordx4 v0, s[4:7], s33 offen sc1 lds
s_add_u32 m0, s36, 24576
s_add_u32 s33, s43, 24576
buffer_load_dwordx4 v0, s[4:7], s33 offen sc1 lds
s_add_u32 m0, s36, 25600
s_add_u32 s33, s43, 25600
buffer_load_dwordx4 v0, s[4:7], s33 offen sc1 lds
s_add_u32 m0, s36, 26624
s_add_u32 s33, s43, 26624
buffer_load_dwordx4 v0, s[4:7], s33 offen sc1 lds
s_add_u32 m0, s36, 27648
s_add_u32 s33, s43, 27648
buffer_load_dwordx4 v0, s[4:7], s33 offen sc1 lds
s_add_u32 m0, s36, 28672
s_add_u32 s33, s43, 28672
buffer_load_dwordx4 v0, s[4:7], s33 offen sc1 lds
s_add_u32 m0, s36, 29696
s_add_u32 s33, s43, 29696
buffer_load_dwordx4 v0, s[4:7], s33 offen sc1 lds
s_add_u32 m0, s36, 30720
s_add_u32 s33, s43, 30720
buffer_load_dwordx4 v0, s[4:7], s33 offen sc1 lds
s_add_u32 m0, s36, 31744
s_add_u32 s33, s43, 31744
buffer_load_dwordx4 v0, s[4:7], s33 offen sc1 lds
s_add_u32 m0, s36, 32768
s_add_u32 s33, s43, 32768
buffer_load_dwordx4 v0, s[4:7], s33 offen sc1 lds
s_add_u32 m0, s36, 33792
s_add_u32 s33, s43, 33792
buffer_load_dwordx4 v0, s[4:7], s33 offen sc1 lds
s_add_u32 m0, s36, 34816
s_add_u32 s33, s43, 34816
buffer_load_dwordx4 v0, s[4:7], s33 offen sc1 lds
s_add_u32 m0, s36, 35840
s_add_u32 s33, s43, 35840
buffer_load_dwordx4 v0, s[4:7], s33 offen sc1 lds
s_waitcnt vmcnt(0)
s_barrier
s_cmp_lg_u32 s16, 0
s_cbranch_scc1 cb_128
v_mov_b32 v67, 32
v_mov_b32 v68, 1
s_mov_b64 exec, 1
buffer_atomic_add v68, v67, s[8:11], 0 offen
s_mov_b32 s37, 0
cb_127:
buffer_load_dword v68, v67, s[8:11], 0 offen sc1
s_add_u32 s37, s37, 1
s_cmp_gt_u32 s37, 262144
s_cbranch_scc1 L_fail
s_waitcnt vmcnt(0)
v_cmp_gt_u32 vcc, 32, v68
s_cbranch_vccnz cb_127
s_mov_b64 exec, -1
cb_128:
s_barrier
s_mov_b32 s18, 0
s_mov_b32 s45, 0
s_cmp_eq_u32 s16, 1
s_cbranch_scc1 wave_130
s_cmp_eq_u32 s16, 2
s_cbranch_scc1 wave_131
s_cmp_eq_u32 s16, 3
s_cbranch_scc1 wave_132
wave_129:
layer_133:
s_lshl_b32 s17, s45, 6
s_mul_i32 s34, s45, 34603008
s_lshl_b32 s35, s15, 14
s_add_u32 s34, s34, s35
s_add_u32 s24, s34, 16777216
s_mul_i32 s34, s17, 10240
s_add_u32 s34, s34, s30
s_add_u32 s25, s34, s31
s_mov_b32 s19, 0
s_add_u32 s43, s17, 2
s_add_u32 s38, s17, 63
s_add_u32 s39, s17, 64
s_add_u32 s34, s24, 524288
v_mov_b32 v7, 0
s_mov_b32 s20, 409600
s_mov_b32 s21, 413696
s_mov_b32 s22, 417792
v_cmp_gt_u32 vcc, s43, v7
s_cmp_eq_u32 vcc_hi, 0
s_cbranch_scc1 kv_140
s_mov_b32 s37, 0
kv_139:
v_bfe_u32 v7, v0, 2, 3
buffer_load_dword v7, v7, s[4:7], s28 offen sc1
s_add_u32 s37, s37, 1
s_cmp_gt_u32 s37, 262144
s_cbranch_scc1 L_fail
s_waitcnt vmcnt(0)
v_cmp_gt_u32 vcc, s43, v7
s_cbranch_vccnz kv_139
kv_140:
buffer_load_dwordx4 v[64:67], v0, s[4:7], s65 offen offset:0 sc1
buffer_load_dwordx4 v[68:71], v0, s[4:7], s65 offen offset:1024 sc1
buffer_load_dwordx4 v[72:75], v0, s[4:7], s65 offen offset:2048 sc1
buffer_load_dwordx4 v[76:79], v0, s[4:7], s65 offen offset:3072 sc1
ds_read_b128 v[80:83], v2 offset:0
ds_read_b128 v[84:87], v2 offset:1024
buffer_load_dwordx4 v[48:51], v0, s[4:7], s66 offen offset:0 sc1
buffer_load_dwordx4 v[52:55], v0, s[4:7], s66 offen offset:1024 sc1
buffer_load_dwordx4 v[56:59], v0, s[4:7], s66 offen offset:2048 sc1
buffer_load_dwordx4 v[60:63], v0, s[4:7], s66 offen offset:3072 sc1
v_mov_b64 v[8:9], 0
v_mov_b64 v[10:11], 0
v_mov_b64 v[12:13], 0
v_mov_b64 v[14:15], 0
v_mov_b64 v[16:17], 0
v_mov_b64 v[18:19], 0
v_mov_b64 v[20:21], 0
v_mov_b64 v[22:23], 0
v_mov_b64 v[24:25], 0
v_mov_b64 v[26:27], 0
v_mov_b64 v[28:29], 0
v_mov_b64 v[30:31], 0
v_bfe_u32 v7, v0, 2, 3
v_add_u32 v7, s28, v7
s_mov_b32 exec_hi, 0
v_and_b32 v7, 511, v0
v_lshl_add_u32 v7, v7, 3, s34
s_mov_b32 exec_hi, -1
s_mov_b32 s37, 0
gather_134:
buffer_load_dwordx4 v[32:35], v0, s[4:7], s20 offen sc1
buffer_load_dwordx4 v[36:39], v0, s[4:7], s21 offen sc1
buffer_load_dwordx4 v[40:43], v0, s[4:7], s22 offen sc1
s_add_u32 s37, s37, 1
s_cmp_gt_u32 s37, 262144
s_cbranch_scc1 L_fail
s_waitcnt vmcnt(2)
v_bitop3_b32 v44, v32, v34, s18 bitop3:0x7e
s_waitcnt vmcnt(1)
v_bitop3_b32 v45, v36, v38, s18 bitop3:0x7e
v_or_b32 v44, v44, v45
s_waitcnt vmcnt(0)
v_bitop3_b32 v46, v40, v42, s18 bitop3:0x7e
v_bitop3_b32 v44, v44, v46, s19 bitop3:0xa8
v_cmp_ne_u32 vcc, 0, v44
s_cbranch_vccnz gather_134
v_smfmac_f32_16x16x64_bf16 v[8:11], v[32:35], v[64:71], v1
buffer_load_dwordx4 v[64:67], v0, s[4:7], s67 offen offset:0 sc1
ds_write_b128 v0, v[36:39] offset:4096
v_smfmac_f32_16x16x64_bf16 v[20:23], v[32:35], v[56:63], v1
ds_read_b128 v[56:59], v2 offset:2048
buffer_load_dwordx4 v[68:71], v0, s[4:7], s67 offen offset:1024 sc1
ds_read_b128 v[60:63], v2 offset:3072
ds_write_b128 v0, v[32:35] offset:0
v_smfmac_f32_16x16x64_bf16 v[12:15], v[32:35], v[72:79], v1
buffer_load_dwordx4 v[72:75], v0, s[4:7], s67 offen offset:2048 sc1
s_waitcnt lgkmcnt(4)
v_smfmac_f32_16x16x64_bf16 v[24:27], v[32:35], v[80:87], v1
ds_write_b128 v0, v[40:43] offset:8192
v_smfmac_f32_16x16x64_bf16 v[16:19], v[32:35], v[48:55], v1
ds_read_b128 v[80:83], v2 offset:4096
ds_read_b128 v[84:87], v2 offset:5120
v_smfmac_f32_16x16x64_bf16 v[28:31], v[32:35], a[0:7], v1
s_waitcnt lgkmcnt(5)
s_waitcnt lgkmcnt(4)
v_smfmac_f32_16x16x64_bf16 v[20:23], v[36:39], v[56:63], v1
buffer_load_dwordx4 v[76:79], v0, s[4:7], s67 offen offset:3072 sc1
ds_read_b128 v[60:63], v2 offset:7168
ds_read_b128 v[56:59], v2 offset:6144
v_smfmac_f32_16x16x64_bf16 v[8:11], v[36:39], a[8:15], v1
s_waitcnt lgkmcnt(4)
s_barrier
ds_read_b128 v[40:43], v0 offset:1024
v_smfmac_f32_16x16x64_bf16 v[12:15], v[36:39], a[16:23], v1
s_waitcnt lgkmcnt(3)
ds_read_b128 v[44:47], v0 offset:5120
ds_read_b128 v[32:35], v0 offset:2048
v_smfmac_f32_16x16x64_bf16 v[24:27], v[36:39], v[80:87], v1
ds_read_b128 v[80:83], v2 offset:8192
v_smfmac_f32_16x16x64_bf16 v[28:31], v[36:39], a[32:39], v1
buffer_load_dwordx4 v[48:51], v0, s[4:7], s24 offen offset:0 nt sc1
v_smfmac_f32_16x16x64_bf16 v[16:19], v[36:39], a[24:31], v1
ds_read_b128 v[36:39], v0 offset:6144
s_waitcnt lgkmcnt(4)
v_smfmac_f32_16x16x64_bf16 v[8:11], v[40:43], a[40:47], v1
ds_read_b128 v[84:87], v2 offset:9216
s_waitcnt lgkmcnt(4)
v_smfmac_f32_16x16x64_bf16 v[12:15], v[40:43], a[48:55], v1
s_waitcnt vmcnt(4)
ds_read_b128 v[40:43], v0 offset:3072
v_smfmac_f32_16x16x64_bf16 v[12:15], v[44:47], v[56:63], v1
s_waitcnt lgkmcnt(4)
ds_read_b128 v[60:63], v2 offset:11264
ds_read_b128 v[56:59], v2 offset:10240
v_smfmac_f32_16x16x64_bf16 v[8:11], v[44:47], a[56:63], v1
buffer_load_dwordx4 v[52:55], v0, s[4:7], s24 offen offset:1024 nt sc1
v_smfmac_f32_16x16x64_bf16 v[8:11], v[32:35], a[64:71], v1
s_waitcnt lgkmcnt(4)
ds_read_b128 v[44:47], v0 offset:7168
s_waitcnt lgkmcnt(4)
v_smfmac_f32_16x16x64_bf16 v[12:15], v[32:35], a[72:79], v1
s_waitcnt vmcnt(4)
ds_read_b128 v[32:35], v0 offset:8192
s_waitcnt lgkmcnt(4)
v_smfmac_f32_16x16x64_bf16 v[8:11], v[36:39], v[80:87], v1
ds_read_b128 v[80:83], v2 offset:12288
ds_read_b128 v[84:87], v2 offset:13312
v_smfmac_f32_16x16x64_bf16 v[8:11], v[40:43], v[64:71], v1
buffer_load_dwordx4 v[64:67], v0, s[4:7], s68 offen offset:0 sc1
v_smfmac_f32_16x16x64_bf16 v[12:15], v[36:39], a[80:87], v1
s_waitcnt lgkmcnt(4)
ds_read_b128 v[36:39], v0 offset:9216
v_smfmac_f32_16x16x64_bf16 v[12:15], v[40:43], v[56:63], v1
ds_read_b128 v[40:43], v0 offset:1024
s_waitcnt lgkmcnt(5)
v_smfmac_f32_16x16x64_bf16 v[8:11], v[44:47], a[88:95], v1
buffer_load_dwordx4 v[68:71], v0, s[4:7], s68 offen offset:1024 sc1
v_smfmac_f32_16x16x64_bf16 v[12:15], v[44:47], a[96:103], v1
s_waitcnt lgkmcnt(4)
ds_read_b128 v[60:63], v2 offset:15360
s_waitcnt lgkmcnt(3)
v_smfmac_f32_16x16x64_bf16 v[12:15], v[32:35], a[104:111], v1
ds_read_b128 v[56:59], v2 offset:14336
s_waitcnt vmcnt(5)
v_smfmac_f32_16x16x64_bf16 v[8:11], v[32:35], v[80:87], v1
s_waitcnt vmcnt(4)
ds_read_b128 v[32:35], v0 offset:5120
s_waitcnt lgkmcnt(4)
v_smfmac_f32_16x16x64_bf16 v[8:11], v[36:39], a[112:119], v1
s_waitcnt lgkmcnt(3)
ds_read_b128 v[80:83], v2 offset:16384
ds_read_b128 v[84:87], v2 offset:17408
v_smfmac_f32_16x16x64_bf16 v[16:19], v[40:43], v[72:79], v1
s_mov_b32 s22, 401408
buffer_load_dwordx4 v[72:75], v0, s[4:7], s68 offen offset:2048 sc1
v_smfmac_f32_16x16x64_bf16 v[12:15], v[36:39], a[120:127], v1
s_waitcnt lgkmcnt(4)
ds_read_b128 v[36:39], v0 offset:2048
s_waitcnt lgkmcnt(4)
v_add_f32 v8, v8, v10
v_smfmac_f32_16x16x64_bf16 v[20:23], v[40:43], v[56:63], v1
s_waitcnt lgkmcnt(3)
buffer_load_dwordx4 v[76:79], v0, s[4:7], s68 offen offset:3072 sc1
v_smfmac_f32_16x16x64_bf16 v[20:23], v[32:35], a[136:143], v1
s_waitcnt lgkmcnt(2)
ds_read_b128 v[40:43], v0 offset:6144
v_mul_f32 v8, s44, v8
v_add_f32 v9, v9, v11
v_smfmac_f32_16x16x64_bf16 v[16:19], v[32:35], a[128:135], v1
buffer_load_dwordx4 v[56:59], v0, s[4:7], s24 offen offset:2048 nt sc1
ds_read_b128 v[32:35], v0 offset:3072
s_waitcnt lgkmcnt(2)
v_mul_f32 v9, s44, v9
v_add_f32 v12, v12, v14
v_smfmac_f32_16x16x64_bf16 v[16:19], v[36:39], v[80:87], v1
ds_read_b128 v[80:83], v2 offset:18432
v_cvt_pk_bf16_f32 v8, v8, v9
v_smfmac_f32_16x16x64_bf16 v[20:23], v[36:39], a[144:151], v1
s_waitcnt lgkmcnt(2)
ds_read_b128 v[84:87], v2 offset:19456
v_add_f32 v13, v13, v15
v_smfmac_f32_16x16x64_bf16 v[20:23], v[40:43], a[160:167], v1
s_xor_b32 s18, s18, 1
ds_read_b128 v[36:39], v0 offset:7168
v_mul_f32 v12, s44, v12
v_mul_f32 v13, s44, v13
v_cvt_pk_bf16_f32 v12, v12, v13
v_smfmac_f32_16x16x64_bf16 v[16:19], v[40:43], a[152:159], v1
s_waitcnt lgkmcnt(3)
ds_write2_b32 v3, v8, v12 offset0:0 offset1:128
v_smfmac_f32_16x16x64_bf16 v[20:23], v[32:35], a[168:175], v1
ds_read_b128 v[40:43], v0 offset:8192
buffer_load_dwordx4 v[60:63], v0, s[4:7], s24 offen offset:3072 nt sc1
s_mov_b32 s19, 1
s_waitcnt lgkmcnt(3)
s_waitcnt lgkmcnt(2)
v_smfmac_f32_16x16x64_bf16 v[20:23], v[36:39], v[80:87], v1
s_waitcnt vmcnt(7)
s_waitcnt vmcnt(5)
ds_read_b128 v[84:87], v2 offset:21504
s_waitcnt vmcnt(4)
v_smfmac_f32_16x16x64_bf16 v[16:19], v[32:35], v[64:71], v1
ds_read_b128 v[32:35], v0 offset:9216
buffer_load_dwordx4 v[64:67], v0, s[4:7], s69 offen offset:0 sc1
v_smfmac_f32_16x16x64_bf16 v[16:19], v[36:39], a[176:183], v1
s_waitcnt lgkmcnt(2)
ds_read_b128 v[36:39], v0 offset:1024
ds_read_b128 v[80:83], v2 offset:20480
buffer_load_dwordx4 v[68:71], v0, s[4:7], s69 offen offset:1024 sc1
v_smfmac_f32_16x16x64_bf16 v[16:19], v[40:43], a[184:191], v1
s_barrier
ds_read_b64_tr_b16 v[8:9], v4 offset:0
ds_read_b64_tr_b16 v[10:11], v4 offset:512
v_smfmac_f32_16x16x64_bf16 v[20:23], v[40:43], a[192:199], v1
s_waitcnt lgkmcnt(4)
ds_read_b64_tr_b16 v[14:15], v4 offset:1536
ds_read_b64_tr_b16 v[12:13], v4 offset:1024
v_smfmac_f32_16x16x64_bf16 v[16:19], v[32:35], a[200:207], v1
buffer_load_dword v7, v7, s[4:7], 0 offen sc1
v_smfmac_f32_16x16x64_bf16 v[20:23], v[32:35], a[208:215], v1
s_waitcnt lgkmcnt(5)
ds_read_b128 v[40:43], v0 offset:5120
ds_read_b128 v[32:35], v0 offset:2048
v_smfmac_f32_16x16x64_bf16 v[24:27], v[36:39], a[216:223], v1
s_waitcnt vmcnt(5)
s_waitcnt lgkmcnt(4)
v_add_f32 v16, v16, v18
v_add_f32 v17, v17, v19
v_mfma_f32_16x16x32_bf16 v[44:47], v[48:51], v[8:11], 0
s_waitcnt lgkmcnt(2)
v_cvt_pk_bf16_f32 v16, v16, v17
v_add_f32 v21, v21, v23
v_add_f32 v20, v20, v22
v_cvt_pk_bf16_f32 v20, v20, v21
v_mfma_f32_16x16x32_bf16 v[44:47], v[52:55], v[12:15], v[44:47]
s_nop 0
ds_write2_b32 v3, v16, v20 offset0:1 offset1:129
v_smfmac_f32_16x16x64_bf16 v[28:31], v[36:39], v[80:87], v1
s_waitcnt lgkmcnt(2)
ds_read_b128 v[36:39], v0 offset:6144
v_smfmac_f32_16x16x64_bf16 v[24:27], v[40:43], a[224:231], v1
s_mov_b64 exec, s[54:55]
s_nop 0
ds_write_b128 v5, v[44:47] offset:0
s_mov_b64 exec, -1
v_smfmac_f32_16x16x64_bf16 v[28:31], v[40:43], a[232:239], v1
ds_read_b128 v[40:43], v0 offset:3072
s_waitcnt lgkmcnt(4)
v_smfmac_f32_16x16x64_bf16 v[24:27], v[32:35], a[240:247], v1
s_waitcnt lgkmcnt(2)
v_smfmac_f32_16x16x64_bf16 v[28:31], v[32:35], a[248:255], v1
s_mov_b32 s37, 0
ds_read_b128 v[32:35], v0 offset:7168
ds_read_b128 v[80:83], v2 offset:22528
v_smfmac_f32_16x16x64_bf16 v[24:27], v[36:39], v[72:79], v1
buffer_load_dwordx4 v[72:75], v0, s[4:7], s65 offen offset:2048 sc1
v_smfmac_f32_16x16x64_bf16 v[28:31], v[36:39], v[88:95], v1
ds_read_b128 v[36:39], v0 offset:8192
s_waitcnt lgkmcnt(4)
s_barrier
ds_read_b128 v[52:55], v6 offset:1024
s_waitcnt lgkmcnt(4)
v_smfmac_f32_16x16x64_bf16 v[28:31], v[40:43], v[104:111], v1
s_waitcnt lgkmcnt(3)
ds_read_b128 v[48:51], v6 offset:0
v_smfmac_f32_16x16x64_bf16 v[24:27], v[40:43], v[96:103], v1
s_add_u32 s24, s24, 524288
ds_read_b128 v[40:43], v0 offset:9216
ds_read_b64_tr_b16 v[10:11], v4 offset:512
v_smfmac_f32_16x16x64_bf16 v[24:27], v[32:35], v[112:119], v1
s_waitcnt lgkmcnt(4)
ds_read_b64_tr_b16 v[12:13], v4 offset:1024
ds_read_b64_tr_b16 v[8:9], v4 offset:0
ds_read_b64_tr_b16 v[14:15], v4 offset:1536
v_smfmac_f32_16x16x64_bf16 v[28:31], v[32:35], v[120:127], v1
s_waitcnt vmcnt(2)
ds_read_b64_tr_b16 v[20:21], v4 offset:3072
ds_read_b64_tr_b16 v[16:17], v4 offset:2048
v_smfmac_f32_16x16x64_bf16 v[24:27], v[36:39], v[128:135], v1
s_waitcnt lgkmcnt(7)
ds_read_b64_tr_b16 v[18:19], v4 offset:2560
v_add_f32 v49, v49, v53
v_smfmac_f32_16x16x64_bf16 v[28:31], v[36:39], v[136:143], v1
s_waitcnt lgkmcnt(7)
ds_read_b64_tr_b16 v[22:23], v4 offset:3584
v_add_f32 v51, v51, v55
v_smfmac_f32_16x16x64_bf16 v[28:31], v[40:43], v[64:71], v1
s_barrier
v_smfmac_f32_16x16x64_bf16 v[24:27], v[40:43], v[144:151], v1
s_waitcnt lgkmcnt(4)
ds_read_b128 v[84:87], v2 offset:23552
v_add_f32 v50, v50, v54
v_mfma_f32_16x16x32_bf16 v[44:47], v[8:11], v[8:11], 0
s_waitcnt lgkmcnt(4)
v_exp_f32 v51, v51
v_mfma_f32_16x16x32_bf16 v[44:47], v[12:15], v[12:15], v[44:47]
s_waitcnt lgkmcnt(1)
v_add_f32 v48, v48, v52
v_exp_f32 v49, v49
v_mfma_f32_16x16x32_bf16 v[44:47], v[16:19], v[16:19], v[44:47]
v_exp_f32 v48, v48
v_exp_f32 v50, v50
v_cvt_pk_bf16_f32 v54, v48, v49
v_cvt_pk_bf16_f32 v55, v50, v51
v_mfma_f32_16x16x32_bf16 v[44:47], v[20:23], v[20:23], v[44:47]
s_add_u32 s17, s17, 1
v_mov_b32_dpp v48, v54 quad_perm:[0,1,0,1] row_mask:0xf bank_mask:0xf
v_mov_b32_dpp v51, v55 quad_perm:[2,3,2,3] row_mask:0xf bank_mask:0xf
v_mov_b32_dpp v50, v54 quad_perm:[2,3,2,3] row_mask:0xf bank_mask:0xf
v_mov_b32_dpp v49, v55 quad_perm:[0,1,0,1] row_mask:0xf bank_mask:0xf
v_mov_b64 v[22:23], s[56:57]
v_mov_b64 v[20:21], s[56:57]
v_mfma_f32_16x16x32_bf16 v[8:11], v[56:59], v[48:51], 0
v_exp_f32_dpp v44, v46 quad_perm:[0,1,0,1] row_mask:0xf bank_mask:0xf
v_mfma_f32_16x16x32_bf16 v[16:19], v[20:23], v[48:51], 0
v_exp_f32_dpp v45, v47 quad_perm:[0,1,0,1] row_mask:0xf bank_mask:0xf
v_mfma_f32_16x16x32_bf16 v[12:15], v[60:63], v[48:51], 0
s_waitcnt lgkmcnt(0)
v_cvt_pk_bf16_f32 v24, v24, v25
v_cvt_pk_bf16_f32 v53, v44, v45
v_mov_b64 v[54:55], s[58:59]
v_cvt_pk_bf16_f32 v52, v44, v45
v_cvt_pk_bf16_f32 v25, v26, v27
v_cvt_pk_bf16_f32 v26, v28, v29
v_mfma_f32_16x16x16_bf16 v[16:19], v[54:55], v[52:53], v[16:19]
v_cvt_pk_bf16_f32 v27, v30, v31
v_mov_b64 v[32:33], 0
v_mfma_f32_16x16x16_bf16 v[8:11], v[24:25], v[52:53], v[8:11]
s_nop 0
ds_read_b128 v[28:31], v2 offset:27648
v_mov_b64 v[34:35], 0
v_mfma_f32_16x16x16_bf16 v[12:15], v[26:27], v[52:53], v[12:15]
s_add_u32 s25, s25, 10240
v_subrev_u32 v17, s46, v16
v_rcp_f32 v18, v16
v_cmp_lt_u32 vcc, s47, v17
v_mul_f32 v10, v10, v18
v_mul_f32 v9, v9, v18
v_mul_f32 v8, v8, v18
v_cvt_pk_bf16_f32 v8, v8, v9
v_mul_f32 v12, v12, v18
v_mul_f32 v11, v11, v18
v_mul_f32 v15, v15, v18
v_cvt_pk_bf16_f32 v9, v10, v11
v_mul_f32 v14, v14, v18
v_mul_f32 v13, v13, v18
v_cvt_pk_bf16_f32 v11, v14, v15
v_cvt_pk_bf16_f32 v10, v12, v13
s_cbranch_vccnz rare_135
back_136:
s_mov_b64 exec, s[54:55]
ds_write_b128 v5, v[8:11] offset:0
s_mov_b64 exec, -1
v_mov_b64 v[50:51], 0
v_smfmac_f32_16x16x64_bf16 v[32:35], v[8:11], v[80:87], v1
ds_read_b128 v[80:83], v2 offset:28672
ds_read_b128 v[24:27], v2 offset:26624
ds_read_b128 v[84:87], v2 offset:29696
v_mov_b64 v[54:55], 0
v_mov_b64 v[52:53], 0
v_mov_b64 v[40:41], 0
v_mov_b64 v[38:39], 0
v_mov_b64 v[48:49], 0
v_smfmac_f32_16x16x64_bf16 v[52:55], v[8:11], v[176:183], v1
s_mov_b32 s20, 393216
ds_read_b128 v[16:19], v2 offset:24576
buffer_load_dwordx4 v[76:79], v0, s[4:7], s65 offen offset:3072 sc1
v_mov_b64 v[36:37], 0
v_mov_b64 v[42:43], 0
v_smfmac_f32_16x16x64_bf16 v[48:51], v[8:11], v[168:175], v1
s_waitcnt lgkmcnt(4)
ds_read_b128 v[20:23], v2 offset:25600
s_barrier
ds_read_b128 v[56:59], v5 offset:512
v_smfmac_f32_16x16x64_bf16 v[40:43], v[8:11], v[160:167], v1
s_waitcnt lgkmcnt(4)
ds_read_b128 v[60:63], v5 offset:1024
ds_read_b128 v[12:15], v5 offset:1536
v_bfe_u32 v45, v0, 1, 7
v_smfmac_f32_16x16x64_bf16 v[36:39], v[8:11], v[152:159], v1
buffer_load_dwordx4 v[64:67], v0, s[4:7], s65 offen offset:0 sc1
v_lshrrev_b32 v44, 8, v0
s_waitcnt lgkmcnt(3)
buffer_load_dwordx4 v[68:71], v0, s[4:7], s65 offen offset:1024 sc1
v_lshl_or_b32 v44, v44, 12, v45
s_waitcnt lgkmcnt(2)
v_smfmac_f32_16x16x64_bf16 v[32:35], v[56:59], v[16:23], v1
ds_read_b128 v[16:19], v2 offset:30720
s_waitcnt lgkmcnt(2)
v_smfmac_f32_16x16x64_bf16 v[32:35], v[60:63], v[24:31], v1
s_add_u32 s43, s17, 2
ds_read_b128 v[24:27], v2 offset:32768
s_waitcnt lgkmcnt(2)
v_smfmac_f32_16x16x64_bf16 v[32:35], v[12:15], v[184:191], v1
ds_read_b128 v[20:23], v2 offset:31744
ds_read_b128 v[28:31], v2 offset:33792
v_smfmac_f32_16x16x64_bf16 v[36:39], v[56:59], v[80:87], v1
ds_read_b128 v[84:87], v2 offset:35840
ds_read_b128 v[80:83], v2 offset:34816
v_smfmac_f32_16x16x64_bf16 v[36:39], v[60:63], v[192:199], v1
s_nop 1
v_cvt_pk_bf16_f32 v32, v32, v33
v_cvt_pk_bf16_f32 v33, v34, v35
v_smfmac_f32_16x16x64_bf16 v[36:39], v[12:15], v[200:207], v1
s_min_u32 s43, s43, s39
s_waitcnt lgkmcnt(5)
v_and_or_b32 v32, v32, -2, s18
v_smfmac_f32_16x16x64_bf16 v[52:55], v[56:59], v[232:239], v1
s_waitcnt lgkmcnt(3)
buffer_store_dwordx2 v[32:33], v44, s[4:7], s60 offen
v_smfmac_f32_16x16x64_bf16 v[40:43], v[56:59], v[16:23], v1
s_waitcnt lgkmcnt(2)
v_cvt_pk_bf16_f32 v36, v36, v37
v_smfmac_f32_16x16x64_bf16 v[40:43], v[60:63], v[24:31], v1
v_cvt_pk_bf16_f32 v37, v38, v39
v_smfmac_f32_16x16x64_bf16 v[40:43], v[12:15], v[208:215], v1
v_and_or_b32 v36, v36, -2, s18
v_smfmac_f32_16x16x64_bf16 v[52:55], v[60:63], v[240:247], v1
s_nop 0
buffer_store_dwordx2 v[36:37], v44, s[4:7], s61 offen
s_nop 0
v_smfmac_f32_16x16x64_bf16 v[52:55], v[12:15], v[248:255], v1
s_waitcnt lgkmcnt(0)
s_add_u32 s34, s24, 524288
v_cvt_pk_bf16_f32 v40, v40, v41
v_smfmac_f32_16x16x64_bf16 v[48:51], v[56:59], v[80:87], v1
v_cvt_pk_bf16_f32 v41, v42, v43
v_and_or_b32 v40, v40, -2, s18
v_smfmac_f32_16x16x64_bf16 v[48:51], v[60:63], v[216:223], v1
buffer_store_dwordx2 v[40:41], v44, s[4:7], s62 offen
v_smfmac_f32_16x16x64_bf16 v[48:51], v[12:15], v[224:231], v1
s_nop 1
v_cvt_pk_bf16_f32 v52, v52, v53
v_cvt_pk_bf16_f32 v53, v54, v55
s_nop 3
v_cvt_pk_bf16_f32 v48, v48, v49
v_and_or_b32 v48, v48, -2, s18
v_cvt_pk_bf16_f32 v49, v50, v51
buffer_store_dwordx2 v[48:49], v44, s[4:7], s63 offen
s_mov_b32 s21, 397312
v_and_or_b32 v52, v52, -2, s18
buffer_store_dwordx2 v[52:53], v44, s[4:7], s64 offen
v_bfe_u32 v34, v0, 6, 1
v_lshlrev_b32 v34, 4, v34
v_mov_b32 v35, 0x3f80
v_lshlrev_b32 v34, v34, v35
v_bfe_i32 v35, v0, 4, 1
v_and_b32 v45, v34, v35
v_and_b32 v47, v34, v35
v_xor_b32 v44, v34, v45
v_xor_b32 v46, v34, v45
v_and_b32 v36, 32, v0
v_bfe_u32 v37, v0, 6, 1
v_lshl_add_u32 v36, v37, 8, v36
v_bfe_u32 v37, v0, 8, 1
v_lshl_add_u32 v36, v37, 4, v36
v_bfe_u32 v37, v0, 4, 1
v_lshl_add_u32 v36, v37, 3, v36
ds_read_b128 v[80:83], v2 offset:0
ds_read_b128 v[84:87], v2 offset:1024
v_mov_b64 v[24:25], 0
v_mov_b64 v[26:27], 0
v_mov_b64 v[28:29], 0
v_mov_b64 v[30:31], 0
s_waitcnt vmcnt(9)
v_bfe_u32 v7, v0, 2, 3
v_add_u32 v7, s28, v7
s_mov_b32 exec_hi, 0
v_and_b32 v7, 511, v0
v_lshl_add_u32 v7, v7, 3, s34
s_mov_b32 exec_hi, -1
s_nop 15
s_nop 15
s_nop 14
buffer_load_dwordx4 v[8:11], v0, s[4:7], s27 offen offset:0 sc1
buffer_load_dwordx4 v[12:15], v0, s[4:7], s27 offen offset:1024 sc1
buffer_load_dwordx4 v[16:19], v0, s[4:7], s27 offen offset:2048 sc1
buffer_load_dwordx4 v[20:23], v0, s[4:7], s27 offen offset:3072 sc1
s_barrier
buffer_load_dwordx4 v[48:51], v0, s[4:7], s66 offen offset:0 sc1
buffer_load_dwordx4 v[52:55], v0, s[4:7], s66 offen offset:1024 sc1
buffer_load_dwordx4 v[56:59], v0, s[4:7], s66 offen offset:2048 sc1
buffer_load_dwordx4 v[60:63], v0, s[4:7], s66 offen offset:3072 sc1
v_mov_b64 v[40:41], 0
v_mov_b64 v[42:43], 0
s_waitcnt vmcnt(6)
s_nop 0
v_smfmac_f32_16x16x64_bf16 v[40:43], v[44:47], v[8:15], v1
v_bitop3_b32 v34, v8, v10, s18 bitop3:0x7e
v_bitop3_b32 v35, v12, v14, s18 bitop3:0x7e
s_waitcnt vmcnt(4)
v_smfmac_f32_16x16x64_bf16 v[40:43], v[44:47], v[16:23], v1
v_bitop3_b32 v32, v16, v18, s18 bitop3:0x7e
v_bitop3_b32 v33, v20, v22, s18 bitop3:0x7e
v_or3_b32 v34, v34, v35, v32
v_bitop3_b32 v34, v34, v33, 1 bitop3:0xa8
v_cmp_ne_u32 vcc, 0, v34
s_cbranch_vccnz red_141
red_141_ok:
s_nop 1
v_add_f32_dpp v40, v40, v40 row_ror:8 row_mask:0xf bank_mask:0xf
v_add_f32_dpp v41, v41, v41 row_ror:8 row_mask:0xf bank_mask:0xf
v_add_f32_dpp v42, v42, v42 row_ror:8 row_mask:0xf bank_mask:0xf
v_add_f32_dpp v43, v43, v43 row_ror:8 row_mask:0xf bank_mask:0xf
v_cvt_pk_bf16_f32 v40, v40, v41
v_cvt_pk_bf16_f32 v41, v42, v43
v_and_or_b32 v40, v40, -2, s18
s_mov_b64 exec, 0x00ff00ff
buffer_store_dwordx2 v[40:41], v36, s[4:7], s40 offen
s_mov_b64 exec, -1
g2_143:
v_mov_b64 v[8:9], 0
v_mov_b64 v[10:11], 0
v_mov_b64 v[12:13], 0
v_mov_b64 v[14:15], 0
v_mov_b64 v[16:17], 0
v_mov_b64 v[18:19], 0
v_mov_b64 v[20:21], 0
v_mov_b64 v[22:23], 0
s_mov_b32 s37, 0
s_cmp_eq_u32 s17, s38
s_barrier
s_nop 15
s_nop 7
s_cbranch_scc0 gather_134
s_branch exit_137
red_141:
buffer_load_dwordx4 v[8:11], v0, s[4:7], s27 offen offset:0 sc1
buffer_load_dwordx4 v[12:15], v0, s[4:7], s27 offen offset:1024 sc1
buffer_load_dwordx4 v[16:19], v0, s[4:7], s27 offen offset:2048 sc1
buffer_load_dwordx4 v[20:23], v0, s[4:7], s27 offen offset:3072 sc1
s_add_u32 s37, s37, 1
s_cmp_gt_u32 s37, 262144
s_cbranch_scc1 L_fail
v_mov_b64 v[40:41], 0
v_mov_b64 v[42:43], 0
s_waitcnt vmcnt(2)
s_nop 0
v_smfmac_f32_16x16x64_bf16 v[40:43], v[44:47], v[8:15], v1
v_bitop3_b32 v34, v8, v10, s18 bitop3:0x7e
v_bitop3_b32 v35, v12, v14, s18 bitop3:0x7e
s_waitcnt vmcnt(0)
v_smfmac_f32_16x16x64_bf16 v[40:43], v[44:47], v[16:23], v1
v_bitop3_b32 v32, v16, v18, s18 bitop3:0x7e
v_bitop3_b32 v33, v20, v22, s18 bitop3:0x7e
v_or3_b32 v34, v34, v35, v32
v_bitop3_b32 v34, v34, v33, 1 bitop3:0xa8
v_cmp_ne_u32 vcc, 0, v34
s_cbranch_vccnz red_141
s_branch red_141_ok
rare_135:
ds_read_b128 v[48:51], v6 offset:0
ds_read_b128 v[52:55], v6 offset:1024
s_waitcnt lgkmcnt(0)
s_barrier
v_add_f32 v48, v48, v52
v_add_f32 v49, v49, v53
v_add_f32 v50, v50, v54
v_add_f32 v51, v51, v55
v_mov_b32_dpp v46, v46 quad_perm:[0,1,0,1] row_mask:0xf bank_mask:0xf
v_mov_b32_dpp v47, v47 quad_perm:[0,1,0,1] row_mask:0xf bank_mask:0xf
v_max3_f32 v19, v48, v49, v50
v_max3_f32 v19, v19, v51, v46
v_max_f32 v19, v19, v47
s_nop 1
v_max_f32_dpp v19, v19, v19 quad_perm:[2,3,0,1] row_mask:0xf bank_mask:0xf
v_mov_b32 v44, v19
s_nop 1
v_permlane32_swap_b32 v19, v44
v_max_f32 v19, v19, v44
v_mov_b32 v44, v19
s_nop 1
v_permlane16_swap_b32 v19, v44
v_max_f32 v19, v19, v44
v_sub_f32 v48, v48, v19
v_sub_f32 v49, v49, v19
v_sub_f32 v50, v50, v19
v_sub_f32 v51, v51, v19
v_sub_f32 v46, v46, v19
v_sub_f32 v47, v47, v19
v_exp_f32 v48, v48
v_exp_f32 v49, v49
v_exp_f32 v50, v50
v_exp_f32 v51, v51
v_cvt_pk_bf16_f32 v54, v48, v49
v_cvt_pk_bf16_f32 v55, v50, v51
s_nop 0
v_mov_b32_dpp v48, v54 quad_perm:[0,1,0,1] row_mask:0xf bank_mask:0xf
v_mov_b32_dpp v49, v55 quad_perm:[0,1,0,1] row_mask:0xf bank_mask:0xf
v_mov_b32_dpp v50, v54 quad_perm:[2,3,2,3] row_mask:0xf bank_mask:0xf
v_mov_b32_dpp v51, v55 quad_perm:[2,3,2,3] row_mask:0xf bank_mask:0xf
v_mov_b64 v[20:21], s[56:57]
v_mov_b64 v[22:23], s[56:57]
v_mfma_f32_16x16x32_bf16 v[8:11], v[56:59], v[48:51], 0
v_mfma_f32_16x16x32_bf16 v[12:15], v[60:63], v[48:51], 0
v_mfma_f32_16x16x32_bf16 v[16:19], v[20:23], v[48:51], 0
v_mov_b64 v[54:55], s[58:59]
v_exp_f32_dpp v44, v46 quad_perm:[0,1,0,1] row_mask:0xf bank_mask:0xf
v_exp_f32_dpp v45, v47 quad_perm:[0,1,0,1] row_mask:0xf bank_mask:0xf
s_nop 0
v_cvt_pk_bf16_f32 v52, v44, v45
v_cvt_pk_bf16_f32 v53, v44, v45
s_nop 1
v_mfma_f32_16x16x16_bf16 v[16:19], v[54:55], v[52:53], v[16:19]
v_mfma_f32_16x16x16_bf16 v[8:11], v[24:25], v[52:53], v[8:11]
v_mfma_f32_16x16x16_bf16 v[12:15], v[26:27], v[52:53], v[12:15]
s_nop 5
v_rcp_f32 v18, v16
s_nop 0
v_mul_f32 v8, v8, v18
v_mul_f32 v9, v9, v18
v_mul_f32 v10, v10, v18
v_mul_f32 v11, v11, v18
v_mul_f32 v12, v12, v18
v_mul_f32 v13, v13, v18
v_mul_f32 v14, v14, v18
v_mul_f32 v15, v15, v18
v_cvt_pk_bf16_f32 v8, v8, v9
v_cvt_pk_bf16_f32 v9, v10, v11
v_cvt_pk_bf16_f32 v10, v12, v13
v_cvt_pk_bf16_f32 v11, v14, v15
s_branch back_136
exit_137:
buffer_load_dwordx4 v[32:35], v0, s[4:7], s20 offen sc1
buffer_load_dwordx4 v[36:39], v0, s[4:7], s21 offen sc1
buffer_load_dwordx4 v[40:43], v0, s[4:7], s22 offen sc1
s_add_u32 s37, s37, 1
s_cmp_gt_u32 s37, 262144
s_cbranch_scc1 L_fail
s_waitcnt vmcnt(2)
v_bitop3_b32 v44, v32, v34, s18 bitop3:0x7e
s_waitcnt vmcnt(1)
v_bitop3_b32 v45, v36, v38, s18 bitop3:0x7e
v_or_b32 v44, v44, v45
s_waitcnt vmcnt(0)
v_bitop3_b32 v46, v40, v42, s18 bitop3:0x7e
v_bitop3_b32 v44, v44, v46, s19 bitop3:0xa8
v_cmp_ne_u32 vcc, 0, v44
s_cbranch_vccnz exit_137
s_add_u32 s45, s45, 1
s_cmp_lt_u32 s45, 2
s_cbranch_scc1 layer_133
s_endpgm
wave_130:
layer_146:
s_lshl_b32 s17, s45, 6
s_mul_i32 s34, s45, 34603008
s_lshl_b32 s35, s15, 14
s_add_u32 s34, s34, s35
s_add_u32 s24, s34, 16781312
s_mul_i32 s34, s17, 10240
s_add_u32 s34, s34, s30
s_add_u32 s25, s34, s31
s_mov_b32 s19, 0
s_add_u32 s43, s17, 2
s_add_u32 s38, s17, 63
s_add_u32 s39, s17, 64
s_add_u32 s34, s24, 524288
v_mov_b32 v7, 0
s_mov_b32 s20, 410624
s_mov_b32 s21, 414720
s_mov_b32 s22, 418816
v_cmp_gt_u32 vcc, s43, v7
s_cmp_eq_u32 vcc_hi, 0
s_cbranch_scc1 kv_153
s_mov_b32 s37, 0
kv_152:
v_bfe_u32 v7, v0, 2, 3
buffer_load_dword v7, v7, s[4:7], s28 offen sc1
s_add_u32 s37, s37, 1
s_cmp_gt_u32 s37, 262144
s_cbranch_scc1 L_fail
s_waitcnt vmcnt(0)
v_cmp_gt_u32 vcc, s43, v7
s_cbranch_vccnz kv_152
kv_153:
buffer_load_dwordx4 v[64:67], v0, s[4:7], s65 offen offset:0 sc1
buffer_load_dwordx4 v[68:71], v0, s[4:7], s65 offen offset:1024 sc1
buffer_load_dwordx4 v[72:75], v0, s[4:7], s65 offen offset:2048 sc1
buffer_load_dwordx4 v[76:79], v0, s[4:7], s65 offen offset:3072 sc1
ds_read_b128 v[80:83], v2 offset:0
ds_read_b128 v[84:87], v2 offset:1024
buffer_load_dwordx4 v[48:51], v0, s[4:7], s66 offen offset:0 sc1
buffer_load_dwordx4 v[52:55], v0, s[4:7], s66 offen offset:1024 sc1
buffer_load_dwordx4 v[56:59], v0, s[4:7], s66 offen offset:2048 sc1
buffer_load_dwordx4 v[60:63], v0, s[4:7], s66 offen offset:3072 sc1
v_mov_b64 v[8:9], 0
v_mov_b64 v[10:11], 0
v_mov_b64 v[12:13], 0
v_mov_b64 v[14:15], 0
v_mov_b64 v[16:17], 0
v_mov_b64 v[18:19], 0
v_mov_b64 v[20:21], 0
v_mov_b64 v[22:23], 0
v_mov_b64 v[24:25], 0
v_mov_b64 v[26:27], 0
v_mov_b64 v[28:29], 0
v_mov_b64 v[30:31], 0
v_bfe_u32 v7, v0, 2, 3
v_add_u32 v7, s28, v7
s_mov_b32 exec_hi, 0
v_and_b32 v7, 511, v0
v_lshl_add_u32 v7, v7, 3, s34
s_mov_b32 exec_hi, -1
s_mov_b32 s37, 0
gather_147:
buffer_load_dwordx4 v[32:35], v0, s[4:7], s20 offen sc1
buffer_load_dwordx4 v[36:39], v0, s[4:7], s21 offen sc1
buffer_load_dwordx4 v[40:43], v0, s[4:7], s22 offen sc1
s_add_u32 s37, s37, 1
s_cmp_gt_u32 s37, 262144
s_cbranch_scc1 L_fail
s_waitcnt vmcnt(2)
v_bitop3_b32 v44, v32, v34, s18 bitop3:0x7e
s_waitcnt vmcnt(1)
v_bitop3_b32 v45, v36, v38, s18 bitop3:0x7e
v_or_b32 v44, v44, v45
s_waitcnt vmcnt(0)
v_bitop3_b32 v46, v40, v42, s18 bitop3:0x7e
v_bitop3_b32 v44, v44, v46, s19 bitop3:0xa8
v_cmp_ne_u32 vcc, 0, v44
s_cbranch_vccnz gather_147
v_smfmac_f32_16x16x64_bf16 v[8:11], v[32:35], v[64:71], v1
buffer_load_dwordx4 v[64:67], v0, s[4:7], s67 offen offset:0 sc1
ds_write_b128 v0, v[36:39] offset:5120
v_smfmac_f32_16x16x64_bf16 v[20:23], v[32:35], v[56:63], v1
ds_read_b128 v[56:59], v2 offset:2048
buffer_load_dwordx4 v[68:71], v0, s[4:7], s67 offen offset:1024 sc1
ds_read_b128 v[60:63], v2 offset:3072
ds_write_b128 v0, v[32:35] offset:1024
v_smfmac_f32_16x16x64_bf16 v[12:15], v[32:35], v[72:79], v1
buffer_load_dwordx4 v[72:75], v0, s[4:7], s67 offen offset:2048 sc1
s_waitcnt lgkmcnt(4)
v_smfmac_f32_16x16x64_bf16 v[24:27], v[32:35], v[80:87], v1
ds_write_b128 v0, v[40:43] offset:9216
v_smfmac_f32_16x16x64_bf16 v[16:19], v[32:35], v[48:55], v1
ds_read_b128 v[80:83], v2 offset:4096
ds_read_b128 v[84:87], v2 offset:5120
v_smfmac_f32_16x16x64_bf16 v[28:31], v[32:35], a[0:7], v1
s_waitcnt lgkmcnt(5)
s_waitcnt lgkmcnt(4)
v_smfmac_f32_16x16x64_bf16 v[20:23], v[36:39], v[56:63], v1
buffer_load_dwordx4 v[76:79], v0, s[4:7], s67 offen offset:3072 sc1
ds_read_b128 v[60:63], v2 offset:7168
ds_read_b128 v[56:59], v2 offset:6144
v_smfmac_f32_16x16x64_bf16 v[8:11], v[36:39], a[8:15], v1
s_waitcnt lgkmcnt(4)
s_barrier
ds_read_b128 v[40:43], v0 offset:0
v_smfmac_f32_16x16x64_bf16 v[12:15], v[36:39], a[16:23], v1
s_waitcnt lgkmcnt(3)
ds_read_b128 v[44:47], v0 offset:4096
ds_read_b128 v[32:35], v0 offset:3072
v_smfmac_f32_16x16x64_bf16 v[24:27], v[36:39], v[80:87], v1
ds_read_b128 v[80:83], v2 offset:8192
v_smfmac_f32_16x16x64_bf16 v[28:31], v[36:39], a[32:39], v1
buffer_load_dwordx4 v[48:51], v0, s[4:7], s24 offen offset:0 nt sc1
v_smfmac_f32_16x16x64_bf16 v[16:19], v[36:39], a[24:31], v1
ds_read_b128 v[36:39], v0 offset:7168
s_waitcnt lgkmcnt(4)
v_smfmac_f32_16x16x64_bf16 v[8:11], v[40:43], a[40:47], v1
ds_read_b128 v[84:87], v2 offset:9216
s_waitcnt lgkmcnt(4)
v_smfmac_f32_16x16x64_bf16 v[12:15], v[40:43], a[48:55], v1
s_waitcnt vmcnt(4)
ds_read_b128 v[40:43], v0 offset:2048
v_smfmac_f32_16x16x64_bf16 v[12:15], v[44:47], v[56:63], v1
s_waitcnt lgkmcnt(4)
ds_read_b128 v[60:63], v2 offset:11264
ds_read_b128 v[56:59], v2 offset:10240
v_smfmac_f32_16x16x64_bf16 v[8:11], v[44:47], a[56:63], v1
buffer_load_dwordx4 v[52:55], v0, s[4:7], s24 offen offset:1024 nt sc1
v_smfmac_f32_16x16x64_bf16 v[8:11], v[32:35], a[64:71], v1
s_waitcnt lgkmcnt(4)
ds_read_b128 v[44:47], v0 offset:6144
s_waitcnt lgkmcnt(4)
v_smfmac_f32_16x16x64_bf16 v[12:15], v[32:35], a[72:79], v1
s_waitcnt vmcnt(4)
ds_read_b128 v[32:35], v0 offset:8192
s_waitcnt lgkmcnt(4)
v_smfmac_f32_16x16x64_bf16 v[8:11], v[36:39], v[80:87], v1
ds_read_b128 v[80:83], v2 offset:12288
ds_read_b128 v[84:87], v2 offset:13312
v_smfmac_f32_16x16x64_bf16 v[8:11], v[40:43], v[64:71], v1
buffer_load_dwordx4 v[64:67], v0, s[4:7], s68 offen offset:0 sc1
v_smfmac_f32_16x16x64_bf16 v[12:15], v[36:39], a[80:87], v1
s_waitcnt lgkmcnt(4)
ds_read_b128 v[36:39], v0 offset:9216
v_smfmac_f32_16x16x64_bf16 v[12:15], v[40:43], v[56:63], v1
ds_read_b128 v[40:43], v0 offset:0
s_waitcnt lgkmcnt(5)
v_smfmac_f32_16x16x64_bf16 v[8:11], v[44:47], a[88:95], v1
buffer_load_dwordx4 v[68:71], v0, s[4:7], s68 offen offset:1024 sc1
v_smfmac_f32_16x16x64_bf16 v[12:15], v[44:47], a[96:103], v1
s_waitcnt lgkmcnt(4)
ds_read_b128 v[60:63], v2 offset:15360
s_waitcnt lgkmcnt(3)
v_smfmac_f32_16x16x64_bf16 v[12:15], v[32:35], a[104:111], v1
ds_read_b128 v[56:59], v2 offset:14336
s_waitcnt vmcnt(5)
v_smfmac_f32_16x16x64_bf16 v[8:11], v[32:35], v[80:87], v1
s_waitcnt vmcnt(4)
ds_read_b128 v[32:35], v0 offset:4096
s_waitcnt lgkmcnt(4)
v_smfmac_f32_16x16x64_bf16 v[8:11], v[36:39], a[112:119], v1
s_waitcnt lgkmcnt(3)
ds_read_b128 v[80:83], v2 offset:16384
ds_read_b128 v[84:87], v2 offset:17408
v_smfmac_f32_16x16x64_bf16 v[16:19], v[40:43], v[72:79], v1
s_mov_b32 s22, 402432
buffer_load_dwordx4 v[72:75], v0, s[4:7], s68 offen offset:2048 sc1
v_smfmac_f32_16x16x64_bf16 v[12:15], v[36:39], a[120:127], v1
s_waitcnt lgkmcnt(4)
ds_read_b128 v[36:39], v0 offset:3072
s_waitcnt lgkmcnt(4)
v_add_f32 v8, v8, v10
v_smfmac_f32_16x16x64_bf16 v[20:23], v[40:43], v[56:63], v1
s_waitcnt lgkmcnt(3)
buffer_load_dwordx4 v[76:79], v0, s[4:7], s68 offen offset:3072 sc1
v_smfmac_f32_16x16x64_bf16 v[20:23], v[32:35], a[136:143], v1
s_waitcnt lgkmcnt(2)
ds_read_b128 v[40:43], v0 offset:7168
v_mul_f32 v8, s44, v8
v_add_f32 v9, v9, v11
v_smfmac_f32_16x16x64_bf16 v[16:19], v[32:35], a[128:135], v1
buffer_load_dwordx4 v[56:59], v0, s[4:7], s24 offen offset:2048 nt sc1
ds_read_b128 v[32:35], v0 offset:2048
s_waitcnt lgkmcnt(2)
v_mul_f32 v9, s44, v9
v_add_f32 v12, v12, v14
v_smfmac_f32_16x16x64_bf16 v[16:19], v[36:39], v[80:87], v1
ds_read_b128 v[80:83], v2 offset:18432
v_cvt_pk_bf16_f32 v8, v8, v9
v_smfmac_f32_16x16x64_bf16 v[20:23], v[36:39], a[144:151], v1
s_waitcnt lgkmcnt(2)
ds_read_b128 v[84:87], v2 offset:19456
v_add_f32 v13, v13, v15
v_smfmac_f32_16x16x64_bf16 v[20:23], v[40:43], a[160:167], v1
s_xor_b32 s18, s18, 1
ds_read_b128 v[36:39], v0 offset:6144
v_mul_f32 v12, s44, v12
v_mul_f32 v13, s44, v13
v_cvt_pk_bf16_f32 v12, v12, v13
v_smfmac_f32_16x16x64_bf16 v[16:19], v[40:43], a[152:159], v1
s_waitcnt lgkmcnt(3)
ds_write2_b32 v3, v8, v12 offset0:0 offset1:128
v_smfmac_f32_16x16x64_bf16 v[20:23], v[32:35], a[168:175], v1
ds_read_b128 v[40:43], v0 offset:8192
buffer_load_dwordx4 v[60:63], v0, s[4:7], s24 offen offset:3072 nt sc1
s_mov_b32 s19, 1
s_waitcnt lgkmcnt(3)
s_waitcnt lgkmcnt(2)
v_smfmac_f32_16x16x64_bf16 v[20:23], v[36:39], v[80:87], v1
s_waitcnt vmcnt(7)
s_waitcnt vmcnt(5)
ds_read_b128 v[84:87], v2 offset:21504
s_waitcnt vmcnt(4)
v_smfmac_f32_16x16x64_bf16 v[16:19], v[32:35], v[64:71], v1
ds_read_b128 v[32:35], v0 offset:9216
buffer_load_dwordx4 v[64:67], v0, s[4:7], s69 offen offset:0 sc1
v_smfmac_f32_16x16x64_bf16 v[16:19], v[36:39], a[176:183], v1
s_waitcnt lgkmcnt(2)
ds_read_b128 v[36:39], v0 offset:0
ds_read_b128 v[80:83], v2 offset:20480
buffer_load_dwordx4 v[68:71], v0, s[4:7], s69 offen offset:1024 sc1
v_smfmac_f32_16x16x64_bf16 v[16:19], v[40:43], a[184:191], v1
s_barrier
ds_read_b64_tr_b16 v[8:9], v4 offset:0
ds_read_b64_tr_b16 v[10:11], v4 offset:512
v_smfmac_f32_16x16x64_bf16 v[20:23], v[40:43], a[192:199], v1
s_waitcnt lgkmcnt(4)
ds_read_b64_tr_b16 v[14:15], v4 offset:1536
ds_read_b64_tr_b16 v[12:13], v4 offset:1024
v_smfmac_f32_16x16x64_bf16 v[16:19], v[32:35], a[200:207], v1
buffer_load_dword v7, v7, s[4:7], 0 offen sc1
v_smfmac_f32_16x16x64_bf16 v[20:23], v[32:35], a[208:215], v1
s_waitcnt lgkmcnt(5)
ds_read_b128 v[40:43], v0 offset:4096
ds_read_b128 v[32:35], v0 offset:3072
v_smfmac_f32_16x16x64_bf16 v[24:27], v[36:39], a[216:223], v1
s_waitcnt vmcnt(5)
s_waitcnt lgkmcnt(4)
v_add_f32 v16, v16, v18
v_add_f32 v17, v17, v19
v_mfma_f32_16x16x32_bf16 v[44:47], v[48:51], v[8:11], 0
s_waitcnt lgkmcnt(2)
v_cvt_pk_bf16_f32 v16, v16, v17
v_add_f32 v21, v21, v23
v_add_f32 v20, v20, v22
v_cvt_pk_bf16_f32 v20, v20, v21
v_mfma_f32_16x16x32_bf16 v[44:47], v[52:55], v[12:15], v[44:47]
s_nop 0
ds_write2_b32 v3, v16, v20 offset0:1 offset1:129
v_smfmac_f32_16x16x64_bf16 v[28:31], v[36:39], v[80:87], v1
s_waitcnt lgkmcnt(2)
ds_read_b128 v[36:39], v0 offset:7168
v_xor_b32 v48, 128, v5
v_smfmac_f32_16x16x64_bf16 v[24:27], v[40:43], a[224:231], v1
s_mov_b64 exec, s[54:55]
ds_write_b128 v48, v[44:47] offset:512
s_mov_b64 exec, -1
v_smfmac_f32_16x16x64_bf16 v[28:31], v[40:43], a[232:239], v1
ds_read_b128 v[40:43], v0 offset:2048
s_waitcnt lgkmcnt(4)
v_smfmac_f32_16x16x64_bf16 v[24:27], v[32:35], a[240:247], v1
s_waitcnt lgkmcnt(2)
v_smfmac_f32_16x16x64_bf16 v[28:31], v[32:35], a[248:255], v1
s_mov_b32 s37, 0
ds_read_b128 v[32:35], v0 offset:6144
ds_read_b128 v[80:83], v2 offset:22528
v_smfmac_f32_16x16x64_bf16 v[24:27], v[36:39], v[72:79], v1
buffer_load_dwordx4 v[72:75], v0, s[4:7], s65 offen offset:2048 sc1
v_smfmac_f32_16x16x64_bf16 v[28:31], v[36:39], v[88:95], v1
ds_read_b128 v[36:39], v0 offset:8192
s_waitcnt lgkmcnt(4)
s_barrier
ds_read_b128 v[52:55], v6 offset:1024
s_waitcnt lgkmcnt(4)
v_smfmac_f32_16x16x64_bf16 v[28:31], v[40:43], v[104:111], v1
s_waitcnt lgkmcnt(3)
ds_read_b128 v[48:51], v6 offset:0
v_smfmac_f32_16x16x64_bf16 v[24:27], v[40:43], v[96:103], v1
s_add_u32 s24, s24, 524288
ds_read_b128 v[40:43], v0 offset:9216
ds_read_b64_tr_b16 v[10:11], v4 offset:512
v_smfmac_f32_16x16x64_bf16 v[24:27], v[32:35], v[112:119], v1
s_waitcnt lgkmcnt(4)
ds_read_b64_tr_b16 v[12:13], v4 offset:1024
ds_read_b64_tr_b16 v[8:9], v4 offset:0
ds_read_b64_tr_b16 v[14:15], v4 offset:1536
v_smfmac_f32_16x16x64_bf16 v[28:31], v[32:35], v[120:127], v1
s_waitcnt vmcnt(2)
ds_read_b64_tr_b16 v[20:21], v4 offset:3072
ds_read_b64_tr_b16 v[16:17], v4 offset:2048
v_smfmac_f32_16x16x64_bf16 v[24:27], v[36:39], v[128:135], v1
s_waitcnt lgkmcnt(7)
ds_read_b64_tr_b16 v[18:19], v4 offset:2560
v_add_f32 v49, v49, v53
v_smfmac_f32_16x16x64_bf16 v[28:31], v[36:39], v[136:143], v1
s_waitcnt lgkmcnt(7)
ds_read_b64_tr_b16 v[22:23], v4 offset:3584
v_add_f32 v51, v51, v55
v_smfmac_f32_16x16x64_bf16 v[28:31], v[40:43], v[64:71], v1
s_barrier
v_smfmac_f32_16x16x64_bf16 v[24:27], v[40:43], v[144:151], v1
s_waitcnt lgkmcnt(4)
ds_read_b128 v[84:87], v2 offset:23552
v_add_f32 v50, v50, v54
v_mfma_f32_16x16x32_bf16 v[44:47], v[8:11], v[8:11], 0
s_waitcnt lgkmcnt(4)
v_exp_f32 v51, v51
v_mfma_f32_16x16x32_bf16 v[44:47], v[12:15], v[12:15], v[44:47]
s_waitcnt lgkmcnt(1)
v_add_f32 v48, v48, v52
v_exp_f32 v49, v49
v_mfma_f32_16x16x32_bf16 v[44:47], v[16:19], v[16:19], v[44:47]
v_exp_f32 v48, v48
v_exp_f32 v50, v50
v_cvt_pk_bf16_f32 v54, v48, v49
v_cvt_pk_bf16_f32 v55, v50, v51
v_mfma_f32_16x16x32_bf16 v[44:47], v[20:23], v[20:23], v[44:47]
s_add_u32 s17, s17, 1
v_mov_b32_dpp v48, v54 quad_perm:[0,1,0,1] row_mask:0xf bank_mask:0xf
v_mov_b32_dpp v51, v55 quad_perm:[2,3,2,3] row_mask:0xf bank_mask:0xf
v_mov_b32_dpp v50, v54 quad_perm:[2,3,2,3] row_mask:0xf bank_mask:0xf
v_mov_b32_dpp v49, v55 quad_perm:[0,1,0,1] row_mask:0xf bank_mask:0xf
v_mov_b64 v[22:23], s[56:57]
v_mov_b64 v[20:21], s[56:57]
v_mfma_f32_16x16x32_bf16 v[8:11], v[56:59], v[48:51], 0
v_exp_f32_dpp v44, v46 quad_perm:[0,1,0,1] row_mask:0xf bank_mask:0xf
v_mfma_f32_16x16x32_bf16 v[16:19], v[20:23], v[48:51], 0
v_exp_f32_dpp v45, v47 quad_perm:[0,1,0,1] row_mask:0xf bank_mask:0xf
v_mfma_f32_16x16x32_bf16 v[12:15], v[60:63], v[48:51], 0
s_waitcnt lgkmcnt(0)
v_cvt_pk_bf16_f32 v24, v24, v25
v_cvt_pk_bf16_f32 v53, v44, v45
v_mov_b64 v[54:55], s[58:59]
v_cvt_pk_bf16_f32 v52, v44, v45
v_cvt_pk_bf16_f32 v25, v26, v27
v_cvt_pk_bf16_f32 v26, v28, v29
v_mfma_f32_16x16x16_bf16 v[16:19], v[54:55], v[52:53], v[16:19]
v_cvt_pk_bf16_f32 v27, v30, v31
v_mov_b64 v[32:33], 0
v_mfma_f32_16x16x16_bf16 v[8:11], v[24:25], v[52:53], v[8:11]
s_nop 0
ds_read_b128 v[28:31], v2 offset:27648
v_mov_b64 v[34:35], 0
v_mfma_f32_16x16x16_bf16 v[12:15], v[26:27], v[52:53], v[12:15]
s_add_u32 s25, s25, 10240
v_subrev_u32 v17, s46, v16
v_rcp_f32 v18, v16
v_cmp_lt_u32 vcc, s47, v17
v_mul_f32 v10, v10, v18
v_mul_f32 v9, v9, v18
v_mul_f32 v8, v8, v18
v_cvt_pk_bf16_f32 v8, v8, v9
v_mul_f32 v12, v12, v18
v_mul_f32 v11, v11, v18
v_mul_f32 v15, v15, v18
v_cvt_pk_bf16_f32 v9, v10, v11
v_mul_f32 v14, v14, v18
v_mul_f32 v13, v13, v18
v_cvt_pk_bf16_f32 v11, v14, v15
v_cvt_pk_bf16_f32 v10, v12, v13
s_cbranch_vccnz rare_148
back_149:
s_mov_b64 exec, s[54:55]
ds_write_b128 v5, v[8:11] offset:512
s_mov_b64 exec, -1
v_mov_b64 v[50:51], 0
v_smfmac_f32_16x16x64_bf16 v[32:35], v[8:11], v[80:87], v1
ds_read_b128 v[80:83], v2 offset:28672
ds_read_b128 v[24:27], v2 offset:26624
ds_read_b128 v[84:87], v2 offset:29696
v_mov_b64 v[54:55], 0
v_mov_b64 v[52:53], 0
v_mov_b64 v[40:41], 0
v_mov_b64 v[38:39], 0
v_mov_b64 v[48:49], 0
v_smfmac_f32_16x16x64_bf16 v[52:55], v[8:11], v[176:183], v1
s_mov_b32 s20, 394240
ds_read_b128 v[16:19], v2 offset:24576
buffer_load_dwordx4 v[76:79], v0, s[4:7], s65 offen offset:3072 sc1
v_mov_b64 v[36:37], 0
v_mov_b64 v[42:43], 0
v_smfmac_f32_16x16x64_bf16 v[48:51], v[8:11], v[168:175], v1
s_waitcnt lgkmcnt(4)
ds_read_b128 v[20:23], v2 offset:25600
s_barrier
ds_read_b128 v[56:59], v5 offset:0
v_smfmac_f32_16x16x64_bf16 v[40:43], v[8:11], v[160:167], v1
s_waitcnt lgkmcnt(4)
ds_read_b128 v[60:63], v5 offset:1536
ds_read_b128 v[12:15], v5 offset:1024
v_bfe_u32 v45, v0, 1, 7
v_smfmac_f32_16x16x64_bf16 v[36:39], v[8:11], v[152:159], v1
buffer_load_dwordx4 v[64:67], v0, s[4:7], s65 offen offset:0 sc1
v_lshrrev_b32 v44, 8, v0
s_waitcnt lgkmcnt(3)
buffer_load_dwordx4 v[68:71], v0, s[4:7], s65 offen offset:1024 sc1
v_lshl_or_b32 v44, v44, 12, v45
s_waitcnt lgkmcnt(2)
v_smfmac_f32_16x16x64_bf16 v[32:35], v[56:59], v[16:23], v1
ds_read_b128 v[16:19], v2 offset:30720
s_waitcnt lgkmcnt(2)
v_smfmac_f32_16x16x64_bf16 v[32:35], v[60:63], v[24:31], v1
s_add_u32 s43, s17, 2
ds_read_b128 v[24:27], v2 offset:32768
s_waitcnt lgkmcnt(2)
v_smfmac_f32_16x16x64_bf16 v[32:35], v[12:15], v[184:191], v1
ds_read_b128 v[20:23], v2 offset:31744
ds_read_b128 v[28:31], v2 offset:33792
v_smfmac_f32_16x16x64_bf16 v[36:39], v[56:59], v[80:87], v1
ds_read_b128 v[84:87], v2 offset:35840
ds_read_b128 v[80:83], v2 offset:34816
v_smfmac_f32_16x16x64_bf16 v[36:39], v[60:63], v[192:199], v1
s_nop 1
v_cvt_pk_bf16_f32 v32, v32, v33
v_cvt_pk_bf16_f32 v33, v34, v35
v_smfmac_f32_16x16x64_bf16 v[36:39], v[12:15], v[200:207], v1
s_min_u32 s43, s43, s39
s_waitcnt lgkmcnt(5)
v_and_or_b32 v32, v32, -2, s18
v_smfmac_f32_16x16x64_bf16 v[52:55], v[56:59], v[232:239], v1
s_waitcnt lgkmcnt(3)
buffer_store_dwordx2 v[32:33], v44, s[4:7], s60 offen
v_smfmac_f32_16x16x64_bf16 v[40:43], v[56:59], v[16:23], v1
s_waitcnt lgkmcnt(2)
v_cvt_pk_bf16_f32 v36, v36, v37
v_smfmac_f32_16x16x64_bf16 v[40:43], v[60:63], v[24:31], v1
v_cvt_pk_bf16_f32 v37, v38, v39
v_smfmac_f32_16x16x64_bf16 v[40:43], v[12:15], v[208:215], v1
v_and_or_b32 v36, v36, -2, s18
v_smfmac_f32_16x16x64_bf16 v[52:55], v[60:63], v[240:247], v1
s_nop 0
buffer_store_dwordx2 v[36:37], v44, s[4:7], s61 offen
s_nop 0
v_smfmac_f32_16x16x64_bf16 v[52:55], v[12:15], v[248:255], v1
s_waitcnt lgkmcnt(0)
s_add_u32 s34, s24, 524288
v_cvt_pk_bf16_f32 v40, v40, v41
v_smfmac_f32_16x16x64_bf16 v[48:51], v[56:59], v[80:87], v1
v_cvt_pk_bf16_f32 v41, v42, v43
v_and_or_b32 v40, v40, -2, s18
v_smfmac_f32_16x16x64_bf16 v[48:51], v[60:63], v[216:223], v1
buffer_store_dwordx2 v[40:41], v44, s[4:7], s62 offen
v_smfmac_f32_16x16x64_bf16 v[48:51], v[12:15], v[224:231], v1
s_nop 1
v_cvt_pk_bf16_f32 v52, v52, v53
v_cvt_pk_bf16_f32 v53, v54, v55
s_nop 3
v_cvt_pk_bf16_f32 v48, v48, v49
v_and_or_b32 v48, v48, -2, s18
v_cvt_pk_bf16_f32 v49, v50, v51
buffer_store_dwordx2 v[48:49], v44, s[4:7], s63 offen
s_mov_b32 s21, 398336
v_and_or_b32 v52, v52, -2, s18
buffer_store_dwordx2 v[52:53], v44, s[4:7], s64 offen
v_bfe_u32 v34, v0, 6, 1
v_lshlrev_b32 v34, 4, v34
v_mov_b32 v35, 0x3f80
v_lshlrev_b32 v34, v34, v35
v_bfe_i32 v35, v0, 4, 1
v_and_b32 v45, v34, v35
v_and_b32 v47, v34, v35
v_xor_b32 v44, v34, v45
v_xor_b32 v46, v34, v45
v_and_b32 v36, 32, v0
v_bfe_u32 v37, v0, 6, 1
v_lshl_add_u32 v36, v37, 8, v36
v_bfe_u32 v37, v0, 8, 1
v_lshl_add_u32 v36, v37, 4, v36
v_bfe_u32 v37, v0, 4, 1
v_lshl_add_u32 v36, v37, 3, v36
ds_read_b128 v[80:83], v2 offset:0
ds_read_b128 v[84:87], v2 offset:1024
v_mov_b64 v[24:25], 0
v_mov_b64 v[26:27], 0
v_mov_b64 v[28:29], 0
v_mov_b64 v[30:31], 0
s_waitcnt vmcnt(9)
v_bfe_u32 v7, v0, 2, 3
v_add_u32 v7, s28, v7
s_mov_b32 exec_hi, 0
v_and_b32 v7, 511, v0
v_lshl_add_u32 v7, v7, 3, s34
s_mov_b32 exec_hi, -1
s_nop 15
s_nop 15
s_nop 15
s_nop 10
buffer_load_dwordx4 v[8:11], v0, s[4:7], s27 offen offset:0 sc1
buffer_load_dwordx4 v[12:15], v0, s[4:7], s27 offen offset:1024 sc1
buffer_load_dwordx4 v[16:19], v0, s[4:7], s27 offen offset:2048 sc1
buffer_load_dwordx4 v[20:23], v0, s[4:7], s27 offen offset:3072 sc1
s_barrier
buffer_load_dwordx4 v[48:51], v0, s[4:7], s66 offen offset:0 sc1
buffer_load_dwordx4 v[52:55], v0, s[4:7], s66 offen offset:1024 sc1
buffer_load_dwordx4 v[56:59], v0, s[4:7], s66 offen offset:2048 sc1
buffer_load_dwordx4 v[60:63], v0, s[4:7], s66 offen offset:3072 sc1
v_mov_b64 v[40:41], 0
v_mov_b64 v[42:43], 0
s_waitcnt vmcnt(6)
s_nop 0
v_smfmac_f32_16x16x64_bf16 v[40:43], v[44:47], v[8:15], v1
v_bitop3_b32 v34, v8, v10, s18 bitop3:0x7e
v_bitop3_b32 v35, v12, v14, s18 bitop3:0x7e
s_waitcnt vmcnt(4)
v_smfmac_f32_16x16x64_bf16 v[40:43], v[44:47], v[16:23], v1
v_bitop3_b32 v32, v16, v18, s18 bitop3:0x7e
v_bitop3_b32 v33, v20, v22, s18 bitop3:0x7e
v_or3_b32 v34, v34, v35, v32
v_bitop3_b32 v34, v34, v33, 1 bitop3:0xa8
v_cmp_ne_u32 vcc, 0, v34
s_cbranch_vccnz red_154
red_154_ok:
s_nop 1
v_add_f32_dpp v40, v40, v40 row_ror:8 row_mask:0xf bank_mask:0xf
v_add_f32_dpp v41, v41, v41 row_ror:8 row_mask:0xf bank_mask:0xf
v_add_f32_dpp v42, v42, v42 row_ror:8 row_mask:0xf bank_mask:0xf
v_add_f32_dpp v43, v43, v43 row_ror:8 row_mask:0xf bank_mask:0xf
v_cvt_pk_bf16_f32 v40, v40, v41
v_cvt_pk_bf16_f32 v41, v42, v43
v_and_or_b32 v40, v40, -2, s18
s_mov_b64 exec, 0x00ff00ff
buffer_store_dwordx2 v[40:41], v36, s[4:7], s40 offen
s_mov_b64 exec, -1
g2_156:
v_mov_b64 v[8:9], 0
v_mov_b64 v[10:11], 0
v_mov_b64 v[12:13], 0
v_mov_b64 v[14:15], 0
v_mov_b64 v[16:17], 0
v_mov_b64 v[18:19], 0
v_mov_b64 v[20:21], 0
v_mov_b64 v[22:23], 0
s_mov_b32 s37, 0
s_cmp_eq_u32 s17, s38
s_barrier
s_nop 15
s_nop 7
s_cbranch_scc0 gather_147
s_branch exit_150
red_154:
buffer_load_dwordx4 v[8:11], v0, s[4:7], s27 offen offset:0 sc1
buffer_load_dwordx4 v[12:15], v0, s[4:7], s27 offen offset:1024 sc1
buffer_load_dwordx4 v[16:19], v0, s[4:7], s27 offen offset:2048 sc1
buffer_load_dwordx4 v[20:23], v0, s[4:7], s27 offen offset:3072 sc1
s_add_u32 s37, s37, 1
s_cmp_gt_u32 s37, 262144
s_cbranch_scc1 L_fail
v_mov_b64 v[40:41], 0
v_mov_b64 v[42:43], 0
s_waitcnt vmcnt(2)
s_nop 0
v_smfmac_f32_16x16x64_bf16 v[40:43], v[44:47], v[8:15], v1
v_bitop3_b32 v34, v8, v10, s18 bitop3:0x7e
v_bitop3_b32 v35, v12, v14, s18 bitop3:0x7e
s_waitcnt vmcnt(0)
v_smfmac_f32_16x16x64_bf16 v[40:43], v[44:47], v[16:23], v1
v_bitop3_b32 v32, v16, v18, s18 bitop3:0x7e
v_bitop3_b32 v33, v20, v22, s18 bitop3:0x7e
v_or3_b32 v34, v34, v35, v32
v_bitop3_b32 v34, v34, v33, 1 bitop3:0xa8
v_cmp_ne_u32 vcc, 0, v34
s_cbranch_vccnz red_154
s_branch red_154_ok
rare_148:
ds_read_b128 v[48:51], v6 offset:0
ds_read_b128 v[52:55], v6 offset:1024
s_waitcnt lgkmcnt(0)
s_barrier
v_add_f32 v48, v48, v52
v_add_f32 v49, v49, v53
v_add_f32 v50, v50, v54
v_add_f32 v51, v51, v55
v_mov_b32_dpp v46, v46 quad_perm:[0,1,0,1] row_mask:0xf bank_mask:0xf
v_mov_b32_dpp v47, v47 quad_perm:[0,1,0,1] row_mask:0xf bank_mask:0xf
v_max3_f32 v19, v48, v49, v50
v_max3_f32 v19, v19, v51, v46
v_max_f32 v19, v19, v47
s_nop 1
v_max_f32_dpp v19, v19, v19 quad_perm:[2,3,0,1] row_mask:0xf bank_mask:0xf
v_mov_b32 v44, v19
s_nop 1
v_permlane32_swap_b32 v19, v44
v_max_f32 v19, v19, v44
v_mov_b32 v44, v19
s_nop 1
v_permlane16_swap_b32 v19, v44
v_max_f32 v19, v19, v44
v_sub_f32 v48, v48, v19
v_sub_f32 v49, v49, v19
v_sub_f32 v50, v50, v19
v_sub_f32 v51, v51, v19
v_sub_f32 v46, v46, v19
v_sub_f32 v47, v47, v19
v_exp_f32 v48, v48
v_exp_f32 v49, v49
v_exp_f32 v50, v50
v_exp_f32 v51, v51
v_cvt_pk_bf16_f32 v54, v48, v49
v_cvt_pk_bf16_f32 v55, v50, v51
s_nop 0
v_mov_b32_dpp v48, v54 quad_perm:[0,1,0,1] row_mask:0xf bank_mask:0xf
v_mov_b32_dpp v49, v55 quad_perm:[0,1,0,1] row_mask:0xf bank_mask:0xf
v_mov_b32_dpp v50, v54 quad_perm:[2,3,2,3] row_mask:0xf bank_mask:0xf
v_mov_b32_dpp v51, v55 quad_perm:[2,3,2,3] row_mask:0xf bank_mask:0xf
v_mov_b64 v[20:21], s[56:57]
v_mov_b64 v[22:23], s[56:57]
v_mfma_f32_16x16x32_bf16 v[8:11], v[56:59], v[48:51], 0
v_mfma_f32_16x16x32_bf16 v[12:15], v[60:63], v[48:51], 0
v_mfma_f32_16x16x32_bf16 v[16:19], v[20:23], v[48:51], 0
v_mov_b64 v[54:55], s[58:59]
v_exp_f32_dpp v44, v46 quad_perm:[0,1,0,1] row_mask:0xf bank_mask:0xf
v_exp_f32_dpp v45, v47 quad_perm:[0,1,0,1] row_mask:0xf bank_mask:0xf
s_nop 0
v_cvt_pk_bf16_f32 v52, v44, v45
v_cvt_pk_bf16_f32 v53, v44, v45
s_nop 1
v_mfma_f32_16x16x16_bf16 v[16:19], v[54:55], v[52:53], v[16:19]
v_mfma_f32_16x16x16_bf16 v[8:11], v[24:25], v[52:53], v[8:11]
v_mfma_f32_16x16x16_bf16 v[12:15], v[26:27], v[52:53], v[12:15]
s_nop 5
v_rcp_f32 v18, v16
s_nop 0
v_mul_f32 v8, v8, v18
v_mul_f32 v9, v9, v18
v_mul_f32 v10, v10, v18
v_mul_f32 v11, v11, v18
v_mul_f32 v12, v12, v18
v_mul_f32 v13, v13, v18
v_mul_f32 v14, v14, v18
v_mul_f32 v15, v15, v18
v_cvt_pk_bf16_f32 v8, v8, v9
v_cvt_pk_bf16_f32 v9, v10, v11
v_cvt_pk_bf16_f32 v10, v12, v13
v_cvt_pk_bf16_f32 v11, v14, v15
s_branch back_149
exit_150:
buffer_load_dwordx4 v[32:35], v0, s[4:7], s20 offen sc1
buffer_load_dwordx4 v[36:39], v0, s[4:7], s21 offen sc1
buffer_load_dwordx4 v[40:43], v0, s[4:7], s22 offen sc1
s_add_u32 s37, s37, 1
s_cmp_gt_u32 s37, 262144
s_cbranch_scc1 L_fail
s_waitcnt vmcnt(2)
v_bitop3_b32 v44, v32, v34, s18 bitop3:0x7e
s_waitcnt vmcnt(1)
v_bitop3_b32 v45, v36, v38, s18 bitop3:0x7e
v_or_b32 v44, v44, v45
s_waitcnt vmcnt(0)
v_bitop3_b32 v46, v40, v42, s18 bitop3:0x7e
v_bitop3_b32 v44, v44, v46, s19 bitop3:0xa8
v_cmp_ne_u32 vcc, 0, v44
s_cbranch_vccnz exit_150
s_add_u32 s45, s45, 1
s_cmp_lt_u32 s45, 2
s_cbranch_scc1 layer_146
s_endpgm
wave_131:
layer_159:
s_lshl_b32 s17, s45, 6
s_mul_i32 s34, s45, 34603008
s_lshl_b32 s35, s15, 14
s_add_u32 s34, s34, s35
s_add_u32 s24, s34, 16785408
s_mul_i32 s34, s17, 10240
s_add_u32 s34, s34, s30
s_add_u32 s25, s34, s31
s_mov_b32 s19, 0
s_add_u32 s43, s17, 2
s_add_u32 s38, s17, 63
s_add_u32 s39, s17, 64
s_add_u32 s34, s24, 524288
v_mov_b32 v7, 0
s_mov_b32 s20, 411648
s_mov_b32 s21, 415744
v_cmp_gt_u32 vcc, s43, v7
s_cmp_eq_u32 vcc_hi, 0
s_cbranch_scc1 kv_166
s_mov_b32 s37, 0
kv_165:
v_bfe_u32 v7, v0, 2, 3
buffer_load_dword v7, v7, s[4:7], s28 offen sc1
s_add_u32 s37, s37, 1
s_cmp_gt_u32 s37, 262144
s_cbranch_scc1 L_fail
s_waitcnt vmcnt(0)
v_cmp_gt_u32 vcc, s43, v7
s_cbranch_vccnz kv_165
kv_166:
buffer_load_dwordx4 v[64:67], v0, s[4:7], s65 offen offset:0 sc1
buffer_load_dwordx4 v[68:71], v0, s[4:7], s65 offen offset:1024 sc1
buffer_load_dwordx4 v[72:75], v0, s[4:7], s65 offen offset:2048 sc1
buffer_load_dwordx4 v[76:79], v0, s[4:7], s65 offen offset:3072 sc1
ds_read_b128 v[80:83], v2 offset:0
ds_read_b128 v[84:87], v2 offset:1024
buffer_load_dwordx4 v[48:51], v0, s[4:7], s66 offen offset:0 sc1
buffer_load_dwordx4 v[52:55], v0, s[4:7], s66 offen offset:1024 sc1
buffer_load_dwordx4 v[56:59], v0, s[4:7], s66 offen offset:2048 sc1
buffer_load_dwordx4 v[60:63], v0, s[4:7], s66 offen offset:3072 sc1
v_mov_b64 v[8:9], 0
v_mov_b64 v[10:11], 0
v_mov_b64 v[12:13], 0
v_mov_b64 v[14:15], 0
v_mov_b64 v[16:17], 0
v_mov_b64 v[18:19], 0
v_mov_b64 v[20:21], 0
v_mov_b64 v[22:23], 0
v_mov_b64 v[24:25], 0
v_mov_b64 v[26:27], 0
v_mov_b64 v[28:29], 0
v_mov_b64 v[30:31], 0
v_bfe_u32 v7, v0, 2, 3
v_add_u32 v7, s28, v7
s_mov_b32 exec_hi, 0
v_and_b32 v7, 511, v0
v_lshl_add_u32 v7, v7, 3, s34
s_mov_b32 exec_hi, -1
s_mov_b32 s37, 0
gather_160:
buffer_load_dwordx4 v[32:35], v0, s[4:7], s20 offen sc1
buffer_load_dwordx4 v[36:39], v0, s[4:7], s21 offen sc1
s_add_u32 s37, s37, 1
s_cmp_gt_u32 s37, 262144
s_cbranch_scc1 L_fail
s_waitcnt vmcnt(1)
v_bitop3_b32 v44, v32, v34, s18 bitop3:0x7e
s_waitcnt vmcnt(0)
v_bitop3_b32 v45, v36, v38, s18 bitop3:0x7e
v_bitop3_b32 v44, v44, v45, s19 bitop3:0xa8
v_cmp_ne_u32 vcc, 0, v44
s_cbranch_vccnz gather_160
v_smfmac_f32_16x16x64_bf16 v[8:11], v[32:35], v[64:71], v1
buffer_load_dwordx4 v[64:67], v0, s[4:7], s67 offen offset:0 sc1
ds_write_b128 v0, v[36:39] offset:6144
v_smfmac_f32_16x16x64_bf16 v[20:23], v[32:35], v[56:63], v1
ds_read_b128 v[56:59], v2 offset:2048
buffer_load_dwordx4 v[68:71], v0, s[4:7], s67 offen offset:1024 sc1
ds_read_b128 v[60:63], v2 offset:3072
ds_write_b128 v0, v[32:35] offset:2048
v_smfmac_f32_16x16x64_bf16 v[12:15], v[32:35], v[72:79], v1
buffer_load_dwordx4 v[72:75], v0, s[4:7], s67 offen offset:2048 sc1
s_waitcnt lgkmcnt(4)
v_smfmac_f32_16x16x64_bf16 v[24:27], v[32:35], v[80:87], v1
v_smfmac_f32_16x16x64_bf16 v[16:19], v[32:35], v[48:55], v1
ds_read_b128 v[80:83], v2 offset:4096
ds_read_b128 v[84:87], v2 offset:5120
v_smfmac_f32_16x16x64_bf16 v[28:31], v[32:35], a[0:7], v1
s_waitcnt lgkmcnt(4)
s_waitcnt lgkmcnt(3)
v_smfmac_f32_16x16x64_bf16 v[20:23], v[36:39], v[56:63], v1
buffer_load_dwordx4 v[76:79], v0, s[4:7], s67 offen offset:3072 sc1
ds_read_b128 v[60:63], v2 offset:7168
ds_read_b128 v[56:59], v2 offset:6144
v_smfmac_f32_16x16x64_bf16 v[8:11], v[36:39], a[8:15], v1
s_waitcnt lgkmcnt(4)
s_barrier
ds_read_b128 v[40:43], v0 offset:3072
v_smfmac_f32_16x16x64_bf16 v[12:15], v[36:39], a[16:23], v1
s_waitcnt lgkmcnt(3)
ds_read_b128 v[44:47], v0 offset:7168
ds_read_b128 v[32:35], v0 offset:0
v_smfmac_f32_16x16x64_bf16 v[24:27], v[36:39], v[80:87], v1
ds_read_b128 v[80:83], v2 offset:8192
v_smfmac_f32_16x16x64_bf16 v[28:31], v[36:39], a[32:39], v1
buffer_load_dwordx4 v[48:51], v0, s[4:7], s24 offen offset:0 nt sc1
v_smfmac_f32_16x16x64_bf16 v[16:19], v[36:39], a[24:31], v1
ds_read_b128 v[36:39], v0 offset:4096
s_waitcnt lgkmcnt(4)
v_smfmac_f32_16x16x64_bf16 v[8:11], v[40:43], a[40:47], v1
ds_read_b128 v[84:87], v2 offset:9216
s_waitcnt lgkmcnt(4)
v_smfmac_f32_16x16x64_bf16 v[12:15], v[40:43], a[48:55], v1
s_waitcnt vmcnt(4)
ds_read_b128 v[40:43], v0 offset:1024
v_smfmac_f32_16x16x64_bf16 v[12:15], v[44:47], v[56:63], v1
s_waitcnt lgkmcnt(4)
ds_read_b128 v[60:63], v2 offset:11264
ds_read_b128 v[56:59], v2 offset:10240
v_smfmac_f32_16x16x64_bf16 v[8:11], v[44:47], a[56:63], v1
buffer_load_dwordx4 v[52:55], v0, s[4:7], s24 offen offset:1024 nt sc1
v_smfmac_f32_16x16x64_bf16 v[8:11], v[32:35], a[64:71], v1
s_waitcnt lgkmcnt(4)
ds_read_b128 v[44:47], v0 offset:5120
s_waitcnt lgkmcnt(4)
v_smfmac_f32_16x16x64_bf16 v[12:15], v[32:35], a[72:79], v1
s_waitcnt vmcnt(4)
ds_read_b128 v[32:35], v0 offset:8192
s_waitcnt lgkmcnt(4)
v_smfmac_f32_16x16x64_bf16 v[8:11], v[36:39], v[80:87], v1
ds_read_b128 v[80:83], v2 offset:12288
ds_read_b128 v[84:87], v2 offset:13312
v_smfmac_f32_16x16x64_bf16 v[8:11], v[40:43], v[64:71], v1
buffer_load_dwordx4 v[64:67], v0, s[4:7], s68 offen offset:0 sc1
v_smfmac_f32_16x16x64_bf16 v[12:15], v[36:39], a[80:87], v1
s_waitcnt lgkmcnt(4)
ds_read_b128 v[36:39], v0 offset:9216
v_smfmac_f32_16x16x64_bf16 v[12:15], v[40:43], v[56:63], v1
ds_read_b128 v[40:43], v0 offset:3072
s_waitcnt lgkmcnt(5)
v_smfmac_f32_16x16x64_bf16 v[8:11], v[44:47], a[88:95], v1
buffer_load_dwordx4 v[68:71], v0, s[4:7], s68 offen offset:1024 sc1
v_smfmac_f32_16x16x64_bf16 v[12:15], v[44:47], a[96:103], v1
s_waitcnt lgkmcnt(4)
ds_read_b128 v[60:63], v2 offset:15360
s_waitcnt lgkmcnt(3)
v_smfmac_f32_16x16x64_bf16 v[12:15], v[32:35], a[104:111], v1
ds_read_b128 v[56:59], v2 offset:14336
s_waitcnt vmcnt(5)
v_smfmac_f32_16x16x64_bf16 v[8:11], v[32:35], v[80:87], v1
s_waitcnt vmcnt(4)
ds_read_b128 v[32:35], v0 offset:7168
s_waitcnt lgkmcnt(4)
v_smfmac_f32_16x16x64_bf16 v[8:11], v[36:39], a[112:119], v1
s_waitcnt lgkmcnt(3)
ds_read_b128 v[80:83], v2 offset:16384
ds_read_b128 v[84:87], v2 offset:17408
v_smfmac_f32_16x16x64_bf16 v[16:19], v[40:43], v[72:79], v1
buffer_load_dwordx4 v[72:75], v0, s[4:7], s68 offen offset:2048 sc1
v_smfmac_f32_16x16x64_bf16 v[12:15], v[36:39], a[120:127], v1
s_waitcnt lgkmcnt(4)
ds_read_b128 v[36:39], v0 offset:0
s_waitcnt lgkmcnt(4)
v_add_f32 v8, v8, v10
v_smfmac_f32_16x16x64_bf16 v[20:23], v[40:43], v[56:63], v1
s_waitcnt lgkmcnt(3)
buffer_load_dwordx4 v[76:79], v0, s[4:7], s68 offen offset:3072 sc1
v_smfmac_f32_16x16x64_bf16 v[20:23], v[32:35], a[136:143], v1
s_waitcnt lgkmcnt(2)
ds_read_b128 v[40:43], v0 offset:4096
v_mul_f32 v8, s44, v8
v_add_f32 v9, v9, v11
v_smfmac_f32_16x16x64_bf16 v[16:19], v[32:35], a[128:135], v1
buffer_load_dwordx4 v[56:59], v0, s[4:7], s24 offen offset:2048 nt sc1
ds_read_b128 v[32:35], v0 offset:1024
s_waitcnt lgkmcnt(2)
v_mul_f32 v9, s44, v9
v_add_f32 v12, v12, v14
v_smfmac_f32_16x16x64_bf16 v[16:19], v[36:39], v[80:87], v1
ds_read_b128 v[80:83], v2 offset:18432
v_cvt_pk_bf16_f32 v8, v8, v9
v_smfmac_f32_16x16x64_bf16 v[20:23], v[36:39], a[144:151], v1
s_waitcnt lgkmcnt(2)
ds_read_b128 v[84:87], v2 offset:19456
v_add_f32 v13, v13, v15
v_smfmac_f32_16x16x64_bf16 v[20:23], v[40:43], a[160:167], v1
s_xor_b32 s18, s18, 1
ds_read_b128 v[36:39], v0 offset:5120
v_mul_f32 v12, s44, v12
v_mul_f32 v13, s44, v13
v_cvt_pk_bf16_f32 v12, v12, v13
v_smfmac_f32_16x16x64_bf16 v[16:19], v[40:43], a[152:159], v1
s_waitcnt lgkmcnt(3)
ds_write2_b32 v3, v8, v12 offset0:0 offset1:128
v_smfmac_f32_16x16x64_bf16 v[20:23], v[32:35], a[168:175], v1
ds_read_b128 v[40:43], v0 offset:8192
buffer_load_dwordx4 v[60:63], v0, s[4:7], s24 offen offset:3072 nt sc1
s_mov_b32 s19, 1
s_waitcnt lgkmcnt(3)
s_waitcnt lgkmcnt(2)
v_smfmac_f32_16x16x64_bf16 v[20:23], v[36:39], v[80:87], v1
s_waitcnt vmcnt(7)
s_waitcnt vmcnt(5)
ds_read_b128 v[84:87], v2 offset:21504
s_waitcnt vmcnt(4)
v_smfmac_f32_16x16x64_bf16 v[16:19], v[32:35], v[64:71], v1
ds_read_b128 v[32:35], v0 offset:9216
buffer_load_dwordx4 v[64:67], v0, s[4:7], s69 offen offset:0 sc1
v_smfmac_f32_16x16x64_bf16 v[16:19], v[36:39], a[176:183], v1
s_waitcnt lgkmcnt(2)
ds_read_b128 v[36:39], v0 offset:3072
ds_read_b128 v[80:83], v2 offset:20480
buffer_load_dwordx4 v[68:71], v0, s[4:7], s69 offen offset:1024 sc1
v_smfmac_f32_16x16x64_bf16 v[16:19], v[40:43], a[184:191], v1
s_barrier
ds_read_b64_tr_b16 v[8:9], v4 offset:2048
ds_read_b64_tr_b16 v[10:11], v4 offset:2560
v_smfmac_f32_16x16x64_bf16 v[20:23], v[40:43], a[192:199], v1
s_waitcnt lgkmcnt(4)
ds_read_b64_tr_b16 v[14:15], v4 offset:3584
ds_read_b64_tr_b16 v[12:13], v4 offset:3072
v_smfmac_f32_16x16x64_bf16 v[16:19], v[32:35], a[200:207], v1
buffer_load_dword v7, v7, s[4:7], 0 offen sc1
v_smfmac_f32_16x16x64_bf16 v[20:23], v[32:35], a[208:215], v1
s_waitcnt lgkmcnt(5)
ds_read_b128 v[40:43], v0 offset:7168
ds_read_b128 v[32:35], v0 offset:0
v_smfmac_f32_16x16x64_bf16 v[24:27], v[36:39], a[216:223], v1
s_waitcnt vmcnt(5)
s_waitcnt lgkmcnt(4)
v_add_f32 v16, v16, v18
v_add_f32 v17, v17, v19
v_mfma_f32_16x16x32_bf16 v[44:47], v[48:51], v[8:11], 0
s_waitcnt lgkmcnt(2)
v_cvt_pk_bf16_f32 v16, v16, v17
v_add_f32 v21, v21, v23
v_add_f32 v20, v20, v22
v_cvt_pk_bf16_f32 v20, v20, v21
v_mfma_f32_16x16x32_bf16 v[44:47], v[52:55], v[12:15], v[44:47]
s_nop 0
ds_write2_b32 v3, v16, v20 offset0:1 offset1:129
v_smfmac_f32_16x16x64_bf16 v[28:31], v[36:39], v[80:87], v1
s_waitcnt lgkmcnt(2)
ds_read_b128 v[36:39], v0 offset:4096
v_smfmac_f32_16x16x64_bf16 v[24:27], v[40:43], a[224:231], v1
s_mov_b64 exec, s[54:55]
s_nop 0
ds_write_b128 v5, v[44:47] offset:1024
s_mov_b64 exec, -1
v_smfmac_f32_16x16x64_bf16 v[28:31], v[40:43], a[232:239], v1
ds_read_b128 v[40:43], v0 offset:1024
s_waitcnt lgkmcnt(4)
v_smfmac_f32_16x16x64_bf16 v[24:27], v[32:35], a[240:247], v1
s_waitcnt lgkmcnt(2)
v_smfmac_f32_16x16x64_bf16 v[28:31], v[32:35], a[248:255], v1
s_mov_b32 s37, 0
ds_read_b128 v[32:35], v0 offset:5120
ds_read_b128 v[80:83], v2 offset:22528
v_smfmac_f32_16x16x64_bf16 v[24:27], v[36:39], v[72:79], v1
buffer_load_dwordx4 v[72:75], v0, s[4:7], s65 offen offset:2048 sc1
v_smfmac_f32_16x16x64_bf16 v[28:31], v[36:39], v[88:95], v1
ds_read_b128 v[36:39], v0 offset:8192
s_waitcnt lgkmcnt(4)
s_barrier
ds_read_b128 v[52:55], v6 offset:1024
s_waitcnt lgkmcnt(4)
v_smfmac_f32_16x16x64_bf16 v[28:31], v[40:43], v[104:111], v1
s_waitcnt lgkmcnt(3)
ds_read_b128 v[48:51], v6 offset:0
v_smfmac_f32_16x16x64_bf16 v[24:27], v[40:43], v[96:103], v1
s_add_u32 s24, s24, 524288
ds_read_b128 v[40:43], v0 offset:9216
ds_read_b64_tr_b16 v[10:11], v4 offset:512
v_smfmac_f32_16x16x64_bf16 v[24:27], v[32:35], v[112:119], v1
s_waitcnt lgkmcnt(4)
ds_read_b64_tr_b16 v[12:13], v4 offset:1024
ds_read_b64_tr_b16 v[8:9], v4 offset:0
ds_read_b64_tr_b16 v[14:15], v4 offset:1536
v_smfmac_f32_16x16x64_bf16 v[28:31], v[32:35], v[120:127], v1
s_waitcnt vmcnt(2)
ds_read_b64_tr_b16 v[20:21], v4 offset:3072
ds_read_b64_tr_b16 v[16:17], v4 offset:2048
v_smfmac_f32_16x16x64_bf16 v[24:27], v[36:39], v[128:135], v1
s_waitcnt lgkmcnt(7)
ds_read_b64_tr_b16 v[18:19], v4 offset:2560
v_add_f32 v49, v49, v53
v_smfmac_f32_16x16x64_bf16 v[28:31], v[36:39], v[136:143], v1
s_waitcnt lgkmcnt(7)
ds_read_b64_tr_b16 v[22:23], v4 offset:3584
v_add_f32 v51, v51, v55
v_smfmac_f32_16x16x64_bf16 v[28:31], v[40:43], v[64:71], v1
s_barrier
v_smfmac_f32_16x16x64_bf16 v[24:27], v[40:43], v[144:151], v1
s_waitcnt lgkmcnt(4)
ds_read_b128 v[84:87], v2 offset:23552
v_add_f32 v50, v50, v54
v_mfma_f32_16x16x32_bf16 v[44:47], v[8:11], v[8:11], 0
s_waitcnt lgkmcnt(4)
v_exp_f32 v51, v51
v_mfma_f32_16x16x32_bf16 v[44:47], v[12:15], v[12:15], v[44:47]
s_waitcnt lgkmcnt(1)
v_add_f32 v48, v48, v52
v_exp_f32 v49, v49
v_mfma_f32_16x16x32_bf16 v[44:47], v[16:19], v[16:19], v[44:47]
v_exp_f32 v48, v48
v_exp_f32 v50, v50
v_cvt_pk_bf16_f32 v54, v48, v49
v_cvt_pk_bf16_f32 v55, v50, v51
v_mfma_f32_16x16x32_bf16 v[44:47], v[20:23], v[20:23], v[44:47]
s_add_u32 s17, s17, 1
v_mov_b32_dpp v48, v54 quad_perm:[0,1,0,1] row_mask:0xf bank_mask:0xf
v_mov_b32_dpp v51, v55 quad_perm:[2,3,2,3] row_mask:0xf bank_mask:0xf
v_mov_b32_dpp v50, v54 quad_perm:[2,3,2,3] row_mask:0xf bank_mask:0xf
v_mov_b32_dpp v49, v55 quad_perm:[0,1,0,1] row_mask:0xf bank_mask:0xf
v_mov_b64 v[22:23], s[56:57]
v_mov_b64 v[20:21], s[56:57]
v_mfma_f32_16x16x32_bf16 v[8:11], v[56:59], v[48:51], 0
v_exp_f32_dpp v44, v46 quad_perm:[0,1,0,1] row_mask:0xf bank_mask:0xf
v_mfma_f32_16x16x32_bf16 v[16:19], v[20:23], v[48:51], 0
v_exp_f32_dpp v45, v47 quad_perm:[0,1,0,1] row_mask:0xf bank_mask:0xf
v_mfma_f32_16x16x32_bf16 v[12:15], v[60:63], v[48:51], 0
s_waitcnt lgkmcnt(0)
v_cvt_pk_bf16_f32 v24, v24, v25
v_cvt_pk_bf16_f32 v53, v44, v45
v_mov_b64 v[54:55], s[58:59]
v_cvt_pk_bf16_f32 v52, v44, v45
v_cvt_pk_bf16_f32 v25, v26, v27
v_cvt_pk_bf16_f32 v26, v28, v29
v_mfma_f32_16x16x16_bf16 v[16:19], v[54:55], v[52:53], v[16:19]
v_cvt_pk_bf16_f32 v27, v30, v31
v_mov_b64 v[32:33], 0
v_mfma_f32_16x16x16_bf16 v[8:11], v[24:25], v[52:53], v[8:11]
s_nop 0
ds_read_b128 v[28:31], v2 offset:27648
v_mov_b64 v[34:35], 0
v_mfma_f32_16x16x16_bf16 v[12:15], v[26:27], v[52:53], v[12:15]
s_add_u32 s25, s25, 10240
v_subrev_u32 v17, s46, v16
v_rcp_f32 v18, v16
v_cmp_lt_u32 vcc, s47, v17
v_mul_f32 v10, v10, v18
v_mul_f32 v9, v9, v18
v_mul_f32 v8, v8, v18
v_cvt_pk_bf16_f32 v8, v8, v9
v_mul_f32 v12, v12, v18
v_mul_f32 v11, v11, v18
v_mul_f32 v15, v15, v18
v_cvt_pk_bf16_f32 v9, v10, v11
v_mul_f32 v14, v14, v18
v_mul_f32 v13, v13, v18
v_cvt_pk_bf16_f32 v11, v14, v15
v_cvt_pk_bf16_f32 v10, v12, v13
s_cbranch_vccnz rare_161
back_162:
s_mov_b64 exec, s[54:55]
ds_write_b128 v5, v[8:11] offset:1024
s_mov_b64 exec, -1
v_mov_b64 v[50:51], 0
v_smfmac_f32_16x16x64_bf16 v[32:35], v[8:11], v[80:87], v1
ds_read_b128 v[80:83], v2 offset:28672
ds_read_b128 v[24:27], v2 offset:26624
ds_read_b128 v[84:87], v2 offset:29696
v_mov_b64 v[54:55], 0
v_mov_b64 v[52:53], 0
v_mov_b64 v[40:41], 0
v_mov_b64 v[38:39], 0
v_mov_b64 v[48:49], 0
v_smfmac_f32_16x16x64_bf16 v[52:55], v[8:11], v[176:183], v1
s_mov_b32 s20, 395264
ds_read_b128 v[16:19], v2 offset:24576
buffer_load_dwordx4 v[76:79], v0, s[4:7], s65 offen offset:3072 sc1
v_mov_b64 v[36:37], 0
v_mov_b64 v[42:43], 0
v_smfmac_f32_16x16x64_bf16 v[48:51], v[8:11], v[168:175], v1
s_waitcnt lgkmcnt(4)
ds_read_b128 v[20:23], v2 offset:25600
s_barrier
ds_read_b128 v[56:59], v5 offset:1536
v_smfmac_f32_16x16x64_bf16 v[40:43], v[8:11], v[160:167], v1
s_waitcnt lgkmcnt(4)
ds_read_b128 v[60:63], v5 offset:0
ds_read_b128 v[12:15], v5 offset:512
v_bfe_u32 v45, v0, 1, 7
v_smfmac_f32_16x16x64_bf16 v[36:39], v[8:11], v[152:159], v1
buffer_load_dwordx4 v[64:67], v0, s[4:7], s65 offen offset:0 sc1
v_lshrrev_b32 v44, 8, v0
s_waitcnt lgkmcnt(3)
buffer_load_dwordx4 v[68:71], v0, s[4:7], s65 offen offset:1024 sc1
v_lshl_or_b32 v44, v44, 12, v45
s_waitcnt lgkmcnt(2)
v_smfmac_f32_16x16x64_bf16 v[32:35], v[56:59], v[16:23], v1
ds_read_b128 v[16:19], v2 offset:30720
s_waitcnt lgkmcnt(2)
v_smfmac_f32_16x16x64_bf16 v[32:35], v[60:63], v[24:31], v1
s_add_u32 s43, s17, 2
ds_read_b128 v[24:27], v2 offset:32768
s_waitcnt lgkmcnt(2)
v_smfmac_f32_16x16x64_bf16 v[32:35], v[12:15], v[184:191], v1
ds_read_b128 v[20:23], v2 offset:31744
ds_read_b128 v[28:31], v2 offset:33792
v_smfmac_f32_16x16x64_bf16 v[36:39], v[56:59], v[80:87], v1
ds_read_b128 v[84:87], v2 offset:35840
ds_read_b128 v[80:83], v2 offset:34816
v_smfmac_f32_16x16x64_bf16 v[36:39], v[60:63], v[192:199], v1
s_nop 1
v_cvt_pk_bf16_f32 v32, v32, v33
v_cvt_pk_bf16_f32 v33, v34, v35
v_smfmac_f32_16x16x64_bf16 v[36:39], v[12:15], v[200:207], v1
s_min_u32 s43, s43, s39
s_waitcnt lgkmcnt(5)
v_and_or_b32 v32, v32, -2, s18
v_smfmac_f32_16x16x64_bf16 v[52:55], v[56:59], v[232:239], v1
s_waitcnt lgkmcnt(3)
buffer_store_dwordx2 v[32:33], v44, s[4:7], s60 offen
v_smfmac_f32_16x16x64_bf16 v[40:43], v[56:59], v[16:23], v1
s_waitcnt lgkmcnt(2)
v_cvt_pk_bf16_f32 v36, v36, v37
v_smfmac_f32_16x16x64_bf16 v[40:43], v[60:63], v[24:31], v1
v_cvt_pk_bf16_f32 v37, v38, v39
v_smfmac_f32_16x16x64_bf16 v[40:43], v[12:15], v[208:215], v1
v_and_or_b32 v36, v36, -2, s18
v_smfmac_f32_16x16x64_bf16 v[52:55], v[60:63], v[240:247], v1
s_nop 0
buffer_store_dwordx2 v[36:37], v44, s[4:7], s61 offen
s_nop 0
v_smfmac_f32_16x16x64_bf16 v[52:55], v[12:15], v[248:255], v1
s_waitcnt lgkmcnt(0)
s_add_u32 s34, s24, 524288
v_cvt_pk_bf16_f32 v40, v40, v41
v_smfmac_f32_16x16x64_bf16 v[48:51], v[56:59], v[80:87], v1
v_cvt_pk_bf16_f32 v41, v42, v43
v_and_or_b32 v40, v40, -2, s18
v_smfmac_f32_16x16x64_bf16 v[48:51], v[60:63], v[216:223], v1
buffer_store_dwordx2 v[40:41], v44, s[4:7], s62 offen
v_smfmac_f32_16x16x64_bf16 v[48:51], v[12:15], v[224:231], v1
s_nop 1
v_cvt_pk_bf16_f32 v52, v52, v53
v_cvt_pk_bf16_f32 v53, v54, v55
s_nop 3
v_cvt_pk_bf16_f32 v48, v48, v49
v_and_or_b32 v48, v48, -2, s18
v_cvt_pk_bf16_f32 v49, v50, v51
buffer_store_dwordx2 v[48:49], v44, s[4:7], s63 offen
s_mov_b32 s21, 399360
v_and_or_b32 v52, v52, -2, s18
buffer_store_dwordx2 v[52:53], v44, s[4:7], s64 offen
v_bfe_u32 v34, v0, 6, 1
v_lshlrev_b32 v34, 4, v34
v_mov_b32 v35, 0x3f80
v_lshlrev_b32 v34, v34, v35
v_bfe_i32 v35, v0, 4, 1
v_and_b32 v45, v34, v35
v_and_b32 v47, v34, v35
v_xor_b32 v44, v34, v45
v_xor_b32 v46, v34, v45
v_and_b32 v36, 32, v0
v_bfe_u32 v37, v0, 6, 1
v_lshl_add_u32 v36, v37, 8, v36
v_bfe_u32 v37, v0, 8, 1
v_lshl_add_u32 v36, v37, 4, v36
v_bfe_u32 v37, v0, 4, 1
v_lshl_add_u32 v36, v37, 3, v36
ds_read_b128 v[80:83], v2 offset:0
ds_read_b128 v[84:87], v2 offset:1024
v_mov_b64 v[24:25], 0
v_mov_b64 v[26:27], 0
v_mov_b64 v[28:29], 0
v_mov_b64 v[30:31], 0
s_waitcnt vmcnt(9)
v_cmp_gt_u32 vcc, s43, v7
s_cmp_eq_u32 vcc_hi, 0
s_cbranch_scc1 kv_174
s_mov_b32 s37, 0
kv_173:
v_bfe_u32 v7, v0, 2, 3
buffer_load_dword v7, v7, s[4:7], s28 offen sc1
s_add_u32 s37, s37, 1
s_cmp_gt_u32 s37, 262144
s_cbranch_scc1 L_fail
s_waitcnt vmcnt(0)
v_cmp_gt_u32 vcc, s43, v7
s_cbranch_vccnz kv_173
kv_174:
s_mov_b32 s37, 0
v_bfe_u32 v7, v0, 2, 3
v_add_u32 v7, s28, v7
s_mov_b32 exec_hi, 0
v_and_b32 v7, 511, v0
v_lshl_add_u32 v7, v7, 3, s34
s_mov_b32 exec_hi, -1
s_nop 15
s_nop 15
s_nop 15
s_nop 9
s_cmp_ge_u32 s15, 16
s_cbranch_scc1 nored_168
buffer_load_dwordx4 v[8:11], v0, s[4:7], s27 offen offset:0 sc1
buffer_load_dwordx4 v[12:15], v0, s[4:7], s27 offen offset:1024 sc1
buffer_load_dwordx4 v[16:19], v0, s[4:7], s27 offen offset:2048 sc1
buffer_load_dwordx4 v[20:23], v0, s[4:7], s27 offen offset:3072 sc1
s_barrier
buffer_load_dwordx4 v[48:51], v0, s[4:7], s66 offen offset:0 sc1
buffer_load_dwordx4 v[52:55], v0, s[4:7], s66 offen offset:1024 sc1
buffer_load_dwordx4 v[56:59], v0, s[4:7], s66 offen offset:2048 sc1
buffer_load_dwordx4 v[60:63], v0, s[4:7], s66 offen offset:3072 sc1
v_mov_b64 v[40:41], 0
v_mov_b64 v[42:43], 0
s_waitcnt vmcnt(6)
s_nop 0
v_smfmac_f32_16x16x64_bf16 v[40:43], v[44:47], v[8:15], v1
v_bitop3_b32 v34, v8, v10, s18 bitop3:0x7e
v_bitop3_b32 v35, v12, v14, s18 bitop3:0x7e
s_waitcnt vmcnt(4)
v_smfmac_f32_16x16x64_bf16 v[40:43], v[44:47], v[16:23], v1
v_bitop3_b32 v32, v16, v18, s18 bitop3:0x7e
v_bitop3_b32 v33, v20, v22, s18 bitop3:0x7e
v_or3_b32 v34, v34, v35, v32
v_bitop3_b32 v34, v34, v33, 1 bitop3:0xa8
v_cmp_ne_u32 vcc, 0, v34
s_cbranch_vccnz red_167
red_167_ok:
s_nop 1
v_add_f32_dpp v40, v40, v40 row_ror:8 row_mask:0xf bank_mask:0xf
v_add_f32_dpp v41, v41, v41 row_ror:8 row_mask:0xf bank_mask:0xf
v_add_f32_dpp v42, v42, v42 row_ror:8 row_mask:0xf bank_mask:0xf
v_add_f32_dpp v43, v43, v43 row_ror:8 row_mask:0xf bank_mask:0xf
v_cvt_pk_bf16_f32 v40, v40, v41
v_cvt_pk_bf16_f32 v41, v42, v43
v_and_or_b32 v40, v40, -2, s18
s_mov_b64 exec, 0x00ff00ff
buffer_store_dwordx2 v[40:41], v36, s[4:7], s40 offen
s_mov_b64 exec, -1
s_branch g2_169
nored_168:
s_barrier
buffer_load_dwordx4 v[48:51], v0, s[4:7], s66 offen offset:0 sc1
buffer_load_dwordx4 v[52:55], v0, s[4:7], s66 offen offset:1024 sc1
buffer_load_dwordx4 v[56:59], v0, s[4:7], s66 offen offset:2048 sc1
buffer_load_dwordx4 v[60:63], v0, s[4:7], s66 offen offset:3072 sc1
g2_169:
v_mov_b64 v[8:9], 0
v_mov_b64 v[10:11], 0
v_mov_b64 v[12:13], 0
v_mov_b64 v[14:15], 0
v_mov_b64 v[16:17], 0
v_mov_b64 v[18:19], 0
v_mov_b64 v[20:21], 0
v_mov_b64 v[22:23], 0
s_mov_b32 s37, 0
s_cmp_eq_u32 s17, s38
s_barrier
s_nop 15
s_nop 7
s_cbranch_scc0 gather_160
s_branch exit_163
red_167:
buffer_load_dwordx4 v[8:11], v0, s[4:7], s27 offen offset:0 sc1
buffer_load_dwordx4 v[12:15], v0, s[4:7], s27 offen offset:1024 sc1
buffer_load_dwordx4 v[16:19], v0, s[4:7], s27 offen offset:2048 sc1
buffer_load_dwordx4 v[20:23], v0, s[4:7], s27 offen offset:3072 sc1
s_add_u32 s37, s37, 1
s_cmp_gt_u32 s37, 262144
s_cbranch_scc1 L_fail
v_mov_b64 v[40:41], 0
v_mov_b64 v[42:43], 0
s_waitcnt vmcnt(2)
s_nop 0
v_smfmac_f32_16x16x64_bf16 v[40:43], v[44:47], v[8:15], v1
v_bitop3_b32 v34, v8, v10, s18 bitop3:0x7e
v_bitop3_b32 v35, v12, v14, s18 bitop3:0x7e
s_waitcnt vmcnt(0)
v_smfmac_f32_16x16x64_bf16 v[40:43], v[44:47], v[16:23], v1
v_bitop3_b32 v32, v16, v18, s18 bitop3:0x7e
v_bitop3_b32 v33, v20, v22, s18 bitop3:0x7e
v_or3_b32 v34, v34, v35, v32
v_bitop3_b32 v34, v34, v33, 1 bitop3:0xa8
v_cmp_ne_u32 vcc, 0, v34
s_cbranch_vccnz red_167
s_branch red_167_ok
rare_161:
ds_read_b128 v[48:51], v6 offset:0
ds_read_b128 v[52:55], v6 offset:1024
s_waitcnt lgkmcnt(0)
s_barrier
v_add_f32 v48, v48, v52
v_add_f32 v49, v49, v53
v_add_f32 v50, v50, v54
v_add_f32 v51, v51, v55
v_mov_b32_dpp v46, v46 quad_perm:[0,1,0,1] row_mask:0xf bank_mask:0xf
v_mov_b32_dpp v47, v47 quad_perm:[0,1,0,1] row_mask:0xf bank_mask:0xf
v_max3_f32 v19, v48, v49, v50
v_max3_f32 v19, v19, v51, v46
v_max_f32 v19, v19, v47
s_nop 1
v_max_f32_dpp v19, v19, v19 quad_perm:[2,3,0,1] row_mask:0xf bank_mask:0xf
v_mov_b32 v44, v19
s_nop 1
v_permlane32_swap_b32 v19, v44
v_max_f32 v19, v19, v44
v_mov_b32 v44, v19
s_nop 1
v_permlane16_swap_b32 v19, v44
v_max_f32 v19, v19, v44
v_sub_f32 v48, v48, v19
v_sub_f32 v49, v49, v19
v_sub_f32 v50, v50, v19
v_sub_f32 v51, v51, v19
v_sub_f32 v46, v46, v19
v_sub_f32 v47, v47, v19
v_exp_f32 v48, v48
v_exp_f32 v49, v49
v_exp_f32 v50, v50
v_exp_f32 v51, v51
v_cvt_pk_bf16_f32 v54, v48, v49
v_cvt_pk_bf16_f32 v55, v50, v51
s_nop 0
v_mov_b32_dpp v48, v54 quad_perm:[0,1,0,1] row_mask:0xf bank_mask:0xf
v_mov_b32_dpp v49, v55 quad_perm:[0,1,0,1] row_mask:0xf bank_mask:0xf
v_mov_b32_dpp v50, v54 quad_perm:[2,3,2,3] row_mask:0xf bank_mask:0xf
v_mov_b32_dpp v51, v55 quad_perm:[2,3,2,3] row_mask:0xf bank_mask:0xf
v_mov_b64 v[20:21], s[56:57]
v_mov_b64 v[22:23], s[56:57]
v_mfma_f32_16x16x32_bf16 v[8:11], v[56:59], v[48:51], 0
v_mfma_f32_16x16x32_bf16 v[12:15], v[60:63], v[48:51], 0
v_mfma_f32_16x16x32_bf16 v[16:19], v[20:23], v[48:51], 0
v_mov_b64 v[54:55], s[58:59]
v_exp_f32_dpp v44, v46 quad_perm:[0,1,0,1] row_mask:0xf bank_mask:0xf
v_exp_f32_dpp v45, v47 quad_perm:[0,1,0,1] row_mask:0xf bank_mask:0xf
s_nop 0
v_cvt_pk_bf16_f32 v52, v44, v45
v_cvt_pk_bf16_f32 v53, v44, v45
s_nop 1
v_mfma_f32_16x16x16_bf16 v[16:19], v[54:55], v[52:53], v[16:19]
v_mfma_f32_16x16x16_bf16 v[8:11], v[24:25], v[52:53], v[8:11]
v_mfma_f32_16x16x16_bf16 v[12:15], v[26:27], v[52:53], v[12:15]
s_nop 5
v_rcp_f32 v18, v16
s_nop 0
v_mul_f32 v8, v8, v18
v_mul_f32 v9, v9, v18
v_mul_f32 v10, v10, v18
v_mul_f32 v11, v11, v18
v_mul_f32 v12, v12, v18
v_mul_f32 v13, v13, v18
v_mul_f32 v14, v14, v18
v_mul_f32 v15, v15, v18
v_cvt_pk_bf16_f32 v8, v8, v9
v_cvt_pk_bf16_f32 v9, v10, v11
v_cvt_pk_bf16_f32 v10, v12, v13
v_cvt_pk_bf16_f32 v11, v14, v15
s_branch back_162
exit_163:
buffer_load_dwordx4 v[32:35], v0, s[4:7], s20 offen sc1
buffer_load_dwordx4 v[36:39], v0, s[4:7], s21 offen sc1
s_add_u32 s37, s37, 1
s_cmp_gt_u32 s37, 262144
s_cbranch_scc1 L_fail
s_waitcnt vmcnt(1)
v_bitop3_b32 v44, v32, v34, s18 bitop3:0x7e
s_waitcnt vmcnt(0)
v_bitop3_b32 v45, v36, v38, s18 bitop3:0x7e
v_bitop3_b32 v44, v44, v45, s19 bitop3:0xa8
v_cmp_ne_u32 vcc, 0, v44
s_cbranch_vccnz exit_163
s_add_u32 s45, s45, 1
s_cmp_lt_u32 s45, 2
s_cbranch_scc1 layer_159
s_endpgm
wave_132:
layer_175:
s_lshl_b32 s17, s45, 6
s_mul_i32 s34, s45, 34603008
s_lshl_b32 s35, s15, 14
s_add_u32 s34, s34, s35
s_add_u32 s24, s34, 16789504
s_mul_i32 s34, s17, 10240
s_add_u32 s34, s34, s30
s_add_u32 s25, s34, s31
s_mov_b32 s19, 0
s_add_u32 s43, s17, 2
s_add_u32 s38, s17, 63
s_add_u32 s39, s17, 64
s_add_u32 s34, s24, 524288
v_mov_b32 v7, 0
s_mov_b32 s20, 412672
s_mov_b32 s21, 416768
v_cmp_gt_u32 vcc, s43, v7
s_cmp_eq_u32 vcc_hi, 0
s_cbranch_scc1 kv_182
s_mov_b32 s37, 0
kv_181:
v_bfe_u32 v7, v0, 2, 3
buffer_load_dword v7, v7, s[4:7], s28 offen sc1
s_add_u32 s37, s37, 1
s_cmp_gt_u32 s37, 262144
s_cbranch_scc1 L_fail
s_waitcnt vmcnt(0)
v_cmp_gt_u32 vcc, s43, v7
s_cbranch_vccnz kv_181
kv_182:
buffer_load_dwordx4 v[64:67], v0, s[4:7], s65 offen offset:0 sc1
buffer_load_dwordx4 v[68:71], v0, s[4:7], s65 offen offset:1024 sc1
buffer_load_dwordx4 v[72:75], v0, s[4:7], s65 offen offset:2048 sc1
buffer_load_dwordx4 v[76:79], v0, s[4:7], s65 offen offset:3072 sc1
ds_read_b128 v[80:83], v2 offset:0
ds_read_b128 v[84:87], v2 offset:1024
buffer_load_dwordx4 v[48:51], v0, s[4:7], s66 offen offset:0 sc1
buffer_load_dwordx4 v[52:55], v0, s[4:7], s66 offen offset:1024 sc1
buffer_load_dwordx4 v[56:59], v0, s[4:7], s66 offen offset:2048 sc1
buffer_load_dwordx4 v[60:63], v0, s[4:7], s66 offen offset:3072 sc1
v_mov_b64 v[8:9], 0
v_mov_b64 v[10:11], 0
v_mov_b64 v[12:13], 0
v_mov_b64 v[14:15], 0
v_mov_b64 v[16:17], 0
v_mov_b64 v[18:19], 0
v_mov_b64 v[20:21], 0
v_mov_b64 v[22:23], 0
v_mov_b64 v[24:25], 0
v_mov_b64 v[26:27], 0
v_mov_b64 v[28:29], 0
v_mov_b64 v[30:31], 0
v_bfe_u32 v7, v0, 2, 3
v_add_u32 v7, s28, v7
s_mov_b32 exec_hi, 0
v_and_b32 v7, 511, v0
v_lshl_add_u32 v7, v7, 3, s34
s_mov_b32 exec_hi, -1
s_mov_b32 s37, 0
gather_176:
buffer_load_dwordx4 v[32:35], v0, s[4:7], s20 offen sc1
buffer_load_dwordx4 v[36:39], v0, s[4:7], s21 offen sc1
s_add_u32 s37, s37, 1
s_cmp_gt_u32 s37, 262144
s_cbranch_scc1 L_fail
s_waitcnt vmcnt(1)
v_bitop3_b32 v44, v32, v34, s18 bitop3:0x7e
s_waitcnt vmcnt(0)
v_bitop3_b32 v45, v36, v38, s18 bitop3:0x7e
v_bitop3_b32 v44, v44, v45, s19 bitop3:0xa8
v_cmp_ne_u32 vcc, 0, v44
s_cbranch_vccnz gather_176
v_smfmac_f32_16x16x64_bf16 v[8:11], v[32:35], v[64:71], v1
buffer_load_dwordx4 v[64:67], v0, s[4:7], s67 offen offset:0 sc1
ds_write_b128 v0, v[36:39] offset:7168
v_smfmac_f32_16x16x64_bf16 v[20:23], v[32:35], v[56:63], v1
ds_read_b128 v[56:59], v2 offset:2048
buffer_load_dwordx4 v[68:71], v0, s[4:7], s67 offen offset:1024 sc1
ds_read_b128 v[60:63], v2 offset:3072
ds_write_b128 v0, v[32:35] offset:3072
v_smfmac_f32_16x16x64_bf16 v[12:15], v[32:35], v[72:79], v1
buffer_load_dwordx4 v[72:75], v0, s[4:7], s67 offen offset:2048 sc1
s_waitcnt lgkmcnt(4)
v_smfmac_f32_16x16x64_bf16 v[24:27], v[32:35], v[80:87], v1
v_smfmac_f32_16x16x64_bf16 v[16:19], v[32:35], v[48:55], v1
ds_read_b128 v[80:83], v2 offset:4096
ds_read_b128 v[84:87], v2 offset:5120
v_smfmac_f32_16x16x64_bf16 v[28:31], v[32:35], a[0:7], v1
s_waitcnt lgkmcnt(4)
s_waitcnt lgkmcnt(3)
v_smfmac_f32_16x16x64_bf16 v[20:23], v[36:39], v[56:63], v1
buffer_load_dwordx4 v[76:79], v0, s[4:7], s67 offen offset:3072 sc1
ds_read_b128 v[60:63], v2 offset:7168
ds_read_b128 v[56:59], v2 offset:6144
v_smfmac_f32_16x16x64_bf16 v[8:11], v[36:39], a[8:15], v1
s_waitcnt lgkmcnt(4)
s_barrier
ds_read_b128 v[40:43], v0 offset:2048
v_smfmac_f32_16x16x64_bf16 v[12:15], v[36:39], a[16:23], v1
s_waitcnt lgkmcnt(3)
ds_read_b128 v[44:47], v0 offset:6144
ds_read_b128 v[32:35], v0 offset:1024
v_smfmac_f32_16x16x64_bf16 v[24:27], v[36:39], v[80:87], v1
ds_read_b128 v[80:83], v2 offset:8192
v_smfmac_f32_16x16x64_bf16 v[28:31], v[36:39], a[32:39], v1
buffer_load_dwordx4 v[48:51], v0, s[4:7], s24 offen offset:0 nt sc1
v_smfmac_f32_16x16x64_bf16 v[16:19], v[36:39], a[24:31], v1
ds_read_b128 v[36:39], v0 offset:5120
s_waitcnt lgkmcnt(4)
v_smfmac_f32_16x16x64_bf16 v[8:11], v[40:43], a[40:47], v1
ds_read_b128 v[84:87], v2 offset:9216
s_waitcnt lgkmcnt(4)
v_smfmac_f32_16x16x64_bf16 v[12:15], v[40:43], a[48:55], v1
s_waitcnt vmcnt(4)
ds_read_b128 v[40:43], v0 offset:0
v_smfmac_f32_16x16x64_bf16 v[12:15], v[44:47], v[56:63], v1
s_waitcnt lgkmcnt(4)
ds_read_b128 v[60:63], v2 offset:11264
ds_read_b128 v[56:59], v2 offset:10240
v_smfmac_f32_16x16x64_bf16 v[8:11], v[44:47], a[56:63], v1
buffer_load_dwordx4 v[52:55], v0, s[4:7], s24 offen offset:1024 nt sc1
v_smfmac_f32_16x16x64_bf16 v[8:11], v[32:35], a[64:71], v1
s_waitcnt lgkmcnt(4)
ds_read_b128 v[44:47], v0 offset:4096
s_waitcnt lgkmcnt(4)
v_smfmac_f32_16x16x64_bf16 v[12:15], v[32:35], a[72:79], v1
s_waitcnt vmcnt(4)
ds_read_b128 v[32:35], v0 offset:8192
s_waitcnt lgkmcnt(4)
v_smfmac_f32_16x16x64_bf16 v[8:11], v[36:39], v[80:87], v1
ds_read_b128 v[80:83], v2 offset:12288
ds_read_b128 v[84:87], v2 offset:13312
v_smfmac_f32_16x16x64_bf16 v[8:11], v[40:43], v[64:71], v1
buffer_load_dwordx4 v[64:67], v0, s[4:7], s68 offen offset:0 sc1
v_smfmac_f32_16x16x64_bf16 v[12:15], v[36:39], a[80:87], v1
s_waitcnt lgkmcnt(4)
ds_read_b128 v[36:39], v0 offset:9216
v_smfmac_f32_16x16x64_bf16 v[12:15], v[40:43], v[56:63], v1
ds_read_b128 v[40:43], v0 offset:2048
s_waitcnt lgkmcnt(5)
v_smfmac_f32_16x16x64_bf16 v[8:11], v[44:47], a[88:95], v1
buffer_load_dwordx4 v[68:71], v0, s[4:7], s68 offen offset:1024 sc1
v_smfmac_f32_16x16x64_bf16 v[12:15], v[44:47], a[96:103], v1
s_waitcnt lgkmcnt(4)
ds_read_b128 v[60:63], v2 offset:15360
s_waitcnt lgkmcnt(3)
v_smfmac_f32_16x16x64_bf16 v[12:15], v[32:35], a[104:111], v1
ds_read_b128 v[56:59], v2 offset:14336
s_waitcnt vmcnt(5)
v_smfmac_f32_16x16x64_bf16 v[8:11], v[32:35], v[80:87], v1
s_waitcnt vmcnt(4)
ds_read_b128 v[32:35], v0 offset:6144
s_waitcnt lgkmcnt(4)
v_smfmac_f32_16x16x64_bf16 v[8:11], v[36:39], a[112:119], v1
s_waitcnt lgkmcnt(3)
ds_read_b128 v[80:83], v2 offset:16384
ds_read_b128 v[84:87], v2 offset:17408
v_smfmac_f32_16x16x64_bf16 v[16:19], v[40:43], v[72:79], v1
buffer_load_dwordx4 v[72:75], v0, s[4:7], s68 offen offset:2048 sc1
v_smfmac_f32_16x16x64_bf16 v[12:15], v[36:39], a[120:127], v1
s_waitcnt lgkmcnt(4)
ds_read_b128 v[36:39], v0 offset:1024
s_waitcnt lgkmcnt(4)
v_add_f32 v8, v8, v10
v_smfmac_f32_16x16x64_bf16 v[20:23], v[40:43], v[56:63], v1
s_waitcnt lgkmcnt(3)
buffer_load_dwordx4 v[76:79], v0, s[4:7], s68 offen offset:3072 sc1
v_smfmac_f32_16x16x64_bf16 v[20:23], v[32:35], a[136:143], v1
s_waitcnt lgkmcnt(2)
ds_read_b128 v[40:43], v0 offset:5120
v_mul_f32 v8, s44, v8
v_add_f32 v9, v9, v11
v_smfmac_f32_16x16x64_bf16 v[16:19], v[32:35], a[128:135], v1
buffer_load_dwordx4 v[56:59], v0, s[4:7], s24 offen offset:2048 nt sc1
ds_read_b128 v[32:35], v0 offset:0
s_waitcnt lgkmcnt(2)
v_mul_f32 v9, s44, v9
v_add_f32 v12, v12, v14
v_smfmac_f32_16x16x64_bf16 v[16:19], v[36:39], v[80:87], v1
ds_read_b128 v[80:83], v2 offset:18432
v_cvt_pk_bf16_f32 v8, v8, v9
v_smfmac_f32_16x16x64_bf16 v[20:23], v[36:39], a[144:151], v1
s_waitcnt lgkmcnt(2)
ds_read_b128 v[84:87], v2 offset:19456
v_add_f32 v13, v13, v15
v_smfmac_f32_16x16x64_bf16 v[20:23], v[40:43], a[160:167], v1
s_xor_b32 s18, s18, 1
ds_read_b128 v[36:39], v0 offset:4096
v_mul_f32 v12, s44, v12
v_mul_f32 v13, s44, v13
v_cvt_pk_bf16_f32 v12, v12, v13
v_smfmac_f32_16x16x64_bf16 v[16:19], v[40:43], a[152:159], v1
s_waitcnt lgkmcnt(3)
ds_write2_b32 v3, v8, v12 offset0:0 offset1:128
v_smfmac_f32_16x16x64_bf16 v[20:23], v[32:35], a[168:175], v1
ds_read_b128 v[40:43], v0 offset:8192
buffer_load_dwordx4 v[60:63], v0, s[4:7], s24 offen offset:3072 nt sc1
s_mov_b32 s19, 1
s_waitcnt lgkmcnt(3)
s_waitcnt lgkmcnt(2)
v_smfmac_f32_16x16x64_bf16 v[20:23], v[36:39], v[80:87], v1
s_waitcnt vmcnt(7)
s_waitcnt vmcnt(5)
ds_read_b128 v[84:87], v2 offset:21504
s_waitcnt vmcnt(4)
v_smfmac_f32_16x16x64_bf16 v[16:19], v[32:35], v[64:71], v1
ds_read_b128 v[32:35], v0 offset:9216
buffer_load_dwordx4 v[64:67], v0, s[4:7], s69 offen offset:0 sc1
v_smfmac_f32_16x16x64_bf16 v[16:19], v[36:39], a[176:183], v1
s_waitcnt lgkmcnt(2)
ds_read_b128 v[36:39], v0 offset:2048
ds_read_b128 v[80:83], v2 offset:20480
buffer_load_dwordx4 v[68:71], v0, s[4:7], s69 offen offset:1024 sc1
v_smfmac_f32_16x16x64_bf16 v[16:19], v[40:43], a[184:191], v1
s_barrier
ds_read_b64_tr_b16 v[8:9], v4 offset:2048
ds_read_b64_tr_b16 v[10:11], v4 offset:2560
v_smfmac_f32_16x16x64_bf16 v[20:23], v[40:43], a[192:199], v1
s_waitcnt lgkmcnt(4)
ds_read_b64_tr_b16 v[14:15], v4 offset:3584
ds_read_b64_tr_b16 v[12:13], v4 offset:3072
v_smfmac_f32_16x16x64_bf16 v[16:19], v[32:35], a[200:207], v1
buffer_load_dword v7, v7, s[4:7], 0 offen sc1
v_smfmac_f32_16x16x64_bf16 v[20:23], v[32:35], a[208:215], v1
s_waitcnt lgkmcnt(5)
ds_read_b128 v[40:43], v0 offset:6144
ds_read_b128 v[32:35], v0 offset:1024
v_smfmac_f32_16x16x64_bf16 v[24:27], v[36:39], a[216:223], v1
s_waitcnt vmcnt(5)
s_waitcnt lgkmcnt(4)
v_add_f32 v16, v16, v18
v_add_f32 v17, v17, v19
v_mfma_f32_16x16x32_bf16 v[44:47], v[48:51], v[8:11], 0
s_waitcnt lgkmcnt(2)
v_cvt_pk_bf16_f32 v16, v16, v17
v_add_f32 v21, v21, v23
v_add_f32 v20, v20, v22
v_cvt_pk_bf16_f32 v20, v20, v21
v_mfma_f32_16x16x32_bf16 v[44:47], v[52:55], v[12:15], v[44:47]
s_nop 0
ds_write2_b32 v3, v16, v20 offset0:1 offset1:129
v_smfmac_f32_16x16x64_bf16 v[28:31], v[36:39], v[80:87], v1
s_waitcnt lgkmcnt(2)
ds_read_b128 v[36:39], v0 offset:5120
v_xor_b32 v48, 128, v5
v_smfmac_f32_16x16x64_bf16 v[24:27], v[40:43], a[224:231], v1
s_mov_b64 exec, s[54:55]
ds_write_b128 v48, v[44:47] offset:1536
s_mov_b64 exec, -1
v_smfmac_f32_16x16x64_bf16 v[28:31], v[40:43], a[232:239], v1
ds_read_b128 v[40:43], v0 offset:0
s_waitcnt lgkmcnt(4)
v_smfmac_f32_16x16x64_bf16 v[24:27], v[32:35], a[240:247], v1
s_waitcnt lgkmcnt(2)
v_smfmac_f32_16x16x64_bf16 v[28:31], v[32:35], a[248:255], v1
s_mov_b32 s37, 0
ds_read_b128 v[32:35], v0 offset:4096
ds_read_b128 v[80:83], v2 offset:22528
v_smfmac_f32_16x16x64_bf16 v[24:27], v[36:39], v[72:79], v1
buffer_load_dwordx4 v[72:75], v0, s[4:7], s65 offen offset:2048 sc1
v_smfmac_f32_16x16x64_bf16 v[28:31], v[36:39], v[88:95], v1
ds_read_b128 v[36:39], v0 offset:8192
s_waitcnt lgkmcnt(4)
s_barrier
ds_read_b128 v[52:55], v6 offset:1024
s_waitcnt lgkmcnt(4)
v_smfmac_f32_16x16x64_bf16 v[28:31], v[40:43], v[104:111], v1
s_waitcnt lgkmcnt(3)
ds_read_b128 v[48:51], v6 offset:0
v_smfmac_f32_16x16x64_bf16 v[24:27], v[40:43], v[96:103], v1
s_add_u32 s24, s24, 524288
ds_read_b128 v[40:43], v0 offset:9216
ds_read_b64_tr_b16 v[10:11], v4 offset:512
v_smfmac_f32_16x16x64_bf16 v[24:27], v[32:35], v[112:119], v1
s_waitcnt lgkmcnt(4)
ds_read_b64_tr_b16 v[12:13], v4 offset:1024
ds_read_b64_tr_b16 v[8:9], v4 offset:0
ds_read_b64_tr_b16 v[14:15], v4 offset:1536
v_smfmac_f32_16x16x64_bf16 v[28:31], v[32:35], v[120:127], v1
s_waitcnt vmcnt(2)
ds_read_b64_tr_b16 v[20:21], v4 offset:3072
ds_read_b64_tr_b16 v[16:17], v4 offset:2048
v_smfmac_f32_16x16x64_bf16 v[24:27], v[36:39], v[128:135], v1
s_waitcnt lgkmcnt(7)
ds_read_b64_tr_b16 v[18:19], v4 offset:2560
v_add_f32 v49, v49, v53
v_smfmac_f32_16x16x64_bf16 v[28:31], v[36:39], v[136:143], v1
s_waitcnt lgkmcnt(7)
ds_read_b64_tr_b16 v[22:23], v4 offset:3584
v_add_f32 v51, v51, v55
v_smfmac_f32_16x16x64_bf16 v[28:31], v[40:43], v[64:71], v1
s_barrier
v_smfmac_f32_16x16x64_bf16 v[24:27], v[40:43], v[144:151], v1
s_waitcnt lgkmcnt(4)
ds_read_b128 v[84:87], v2 offset:23552
v_add_f32 v50, v50, v54
v_mfma_f32_16x16x32_bf16 v[44:47], v[8:11], v[8:11], 0
s_waitcnt lgkmcnt(4)
v_exp_f32 v51, v51
v_mfma_f32_16x16x32_bf16 v[44:47], v[12:15], v[12:15], v[44:47]
s_waitcnt lgkmcnt(1)
v_add_f32 v48, v48, v52
v_exp_f32 v49, v49
v_mfma_f32_16x16x32_bf16 v[44:47], v[16:19], v[16:19], v[44:47]
v_exp_f32 v48, v48
v_exp_f32 v50, v50
v_cvt_pk_bf16_f32 v54, v48, v49
v_cvt_pk_bf16_f32 v55, v50, v51
v_mfma_f32_16x16x32_bf16 v[44:47], v[20:23], v[20:23], v[44:47]
s_add_u32 s17, s17, 1
v_mov_b32_dpp v48, v54 quad_perm:[0,1,0,1] row_mask:0xf bank_mask:0xf
v_mov_b32_dpp v51, v55 quad_perm:[2,3,2,3] row_mask:0xf bank_mask:0xf
v_mov_b32_dpp v50, v54 quad_perm:[2,3,2,3] row_mask:0xf bank_mask:0xf
v_mov_b32_dpp v49, v55 quad_perm:[0,1,0,1] row_mask:0xf bank_mask:0xf
v_mov_b64 v[22:23], s[56:57]
v_mov_b64 v[20:21], s[56:57]
v_mfma_f32_16x16x32_bf16 v[8:11], v[56:59], v[48:51], 0
v_exp_f32_dpp v44, v46 quad_perm:[0,1,0,1] row_mask:0xf bank_mask:0xf
v_mfma_f32_16x16x32_bf16 v[16:19], v[20:23], v[48:51], 0
v_exp_f32_dpp v45, v47 quad_perm:[0,1,0,1] row_mask:0xf bank_mask:0xf
v_mfma_f32_16x16x32_bf16 v[12:15], v[60:63], v[48:51], 0
s_waitcnt lgkmcnt(0)
v_cvt_pk_bf16_f32 v24, v24, v25
v_cvt_pk_bf16_f32 v53, v44, v45
v_mov_b64 v[54:55], s[58:59]
v_cvt_pk_bf16_f32 v52, v44, v45
v_cvt_pk_bf16_f32 v25, v26, v27
v_cvt_pk_bf16_f32 v26, v28, v29
v_mfma_f32_16x16x16_bf16 v[16:19], v[54:55], v[52:53], v[16:19]
v_cvt_pk_bf16_f32 v27, v30, v31
v_mov_b64 v[32:33], 0
v_mfma_f32_16x16x16_bf16 v[8:11], v[24:25], v[52:53], v[8:11]
s_nop 0
ds_read_b128 v[28:31], v2 offset:27648
v_mov_b64 v[34:35], 0
v_mfma_f32_16x16x16_bf16 v[12:15], v[26:27], v[52:53], v[12:15]
s_add_u32 s25, s25, 10240
v_subrev_u32 v17, s46, v16
v_rcp_f32 v18, v16
v_cmp_lt_u32 vcc, s47, v17
v_mul_f32 v10, v10, v18
v_mul_f32 v9, v9, v18
v_mul_f32 v8, v8, v18
v_cvt_pk_bf16_f32 v8, v8, v9
v_mul_f32 v12, v12, v18
v_mul_f32 v11, v11, v18
v_mul_f32 v15, v15, v18
v_cvt_pk_bf16_f32 v9, v10, v11
v_mul_f32 v14, v14, v18
v_mul_f32 v13, v13, v18
v_cvt_pk_bf16_f32 v11, v14, v15
v_cvt_pk_bf16_f32 v10, v12, v13
s_cbranch_vccnz rare_177
back_178:
s_mov_b64 exec, s[54:55]
ds_write_b128 v5, v[8:11] offset:1536
s_mov_b64 exec, -1
v_mov_b64 v[50:51], 0
v_smfmac_f32_16x16x64_bf16 v[32:35], v[8:11], v[80:87], v1
ds_read_b128 v[80:83], v2 offset:28672
ds_read_b128 v[24:27], v2 offset:26624
ds_read_b128 v[84:87], v2 offset:29696
v_mov_b64 v[54:55], 0
v_mov_b64 v[52:53], 0
v_mov_b64 v[40:41], 0
v_mov_b64 v[38:39], 0
v_mov_b64 v[48:49], 0
v_smfmac_f32_16x16x64_bf16 v[52:55], v[8:11], v[176:183], v1
s_mov_b32 s20, 396288
ds_read_b128 v[16:19], v2 offset:24576
buffer_load_dwordx4 v[76:79], v0, s[4:7], s65 offen offset:3072 sc1
v_mov_b64 v[36:37], 0
v_mov_b64 v[42:43], 0
v_smfmac_f32_16x16x64_bf16 v[48:51], v[8:11], v[168:175], v1
s_waitcnt lgkmcnt(4)
ds_read_b128 v[20:23], v2 offset:25600
s_barrier
ds_read_b128 v[56:59], v5 offset:1024
v_smfmac_f32_16x16x64_bf16 v[40:43], v[8:11], v[160:167], v1
s_waitcnt lgkmcnt(4)
ds_read_b128 v[60:63], v5 offset:512
ds_read_b128 v[12:15], v5 offset:0
v_bfe_u32 v45, v0, 1, 7
v_smfmac_f32_16x16x64_bf16 v[36:39], v[8:11], v[152:159], v1
buffer_load_dwordx4 v[64:67], v0, s[4:7], s65 offen offset:0 sc1
v_lshrrev_b32 v44, 8, v0
s_waitcnt lgkmcnt(3)
buffer_load_dwordx4 v[68:71], v0, s[4:7], s65 offen offset:1024 sc1
v_lshl_or_b32 v44, v44, 12, v45
s_waitcnt lgkmcnt(2)
v_smfmac_f32_16x16x64_bf16 v[32:35], v[56:59], v[16:23], v1
ds_read_b128 v[16:19], v2 offset:30720
s_waitcnt lgkmcnt(2)
v_smfmac_f32_16x16x64_bf16 v[32:35], v[60:63], v[24:31], v1
s_add_u32 s43, s17, 2
ds_read_b128 v[24:27], v2 offset:32768
s_waitcnt lgkmcnt(2)
v_smfmac_f32_16x16x64_bf16 v[32:35], v[12:15], v[184:191], v1
ds_read_b128 v[20:23], v2 offset:31744
ds_read_b128 v[28:31], v2 offset:33792
v_smfmac_f32_16x16x64_bf16 v[36:39], v[56:59], v[80:87], v1
ds_read_b128 v[84:87], v2 offset:35840
ds_read_b128 v[80:83], v2 offset:34816
v_smfmac_f32_16x16x64_bf16 v[36:39], v[60:63], v[192:199], v1
s_nop 1
v_cvt_pk_bf16_f32 v32, v32, v33
v_cvt_pk_bf16_f32 v33, v34, v35
v_smfmac_f32_16x16x64_bf16 v[36:39], v[12:15], v[200:207], v1
s_min_u32 s43, s43, s39
s_waitcnt lgkmcnt(5)
v_and_or_b32 v32, v32, -2, s18
v_smfmac_f32_16x16x64_bf16 v[52:55], v[56:59], v[232:239], v1
s_waitcnt lgkmcnt(3)
buffer_store_dwordx2 v[32:33], v44, s[4:7], s60 offen
v_smfmac_f32_16x16x64_bf16 v[40:43], v[56:59], v[16:23], v1
s_waitcnt lgkmcnt(2)
v_cvt_pk_bf16_f32 v36, v36, v37
v_smfmac_f32_16x16x64_bf16 v[40:43], v[60:63], v[24:31], v1
v_cvt_pk_bf16_f32 v37, v38, v39
v_smfmac_f32_16x16x64_bf16 v[40:43], v[12:15], v[208:215], v1
v_and_or_b32 v36, v36, -2, s18
v_smfmac_f32_16x16x64_bf16 v[52:55], v[60:63], v[240:247], v1
s_nop 0
buffer_store_dwordx2 v[36:37], v44, s[4:7], s61 offen
s_nop 0
v_smfmac_f32_16x16x64_bf16 v[52:55], v[12:15], v[248:255], v1
s_waitcnt lgkmcnt(0)
s_add_u32 s34, s24, 524288
v_cvt_pk_bf16_f32 v40, v40, v41
v_smfmac_f32_16x16x64_bf16 v[48:51], v[56:59], v[80:87], v1
v_cvt_pk_bf16_f32 v41, v42, v43
v_and_or_b32 v40, v40, -2, s18
v_smfmac_f32_16x16x64_bf16 v[48:51], v[60:63], v[216:223], v1
buffer_store_dwordx2 v[40:41], v44, s[4:7], s62 offen
v_smfmac_f32_16x16x64_bf16 v[48:51], v[12:15], v[224:231], v1
s_nop 1
v_cvt_pk_bf16_f32 v52, v52, v53
v_cvt_pk_bf16_f32 v53, v54, v55
s_nop 3
v_cvt_pk_bf16_f32 v48, v48, v49
v_and_or_b32 v48, v48, -2, s18
v_cvt_pk_bf16_f32 v49, v50, v51
buffer_store_dwordx2 v[48:49], v44, s[4:7], s63 offen
s_mov_b32 s21, 400384
v_and_or_b32 v52, v52, -2, s18
buffer_store_dwordx2 v[52:53], v44, s[4:7], s64 offen
ds_read_b128 v[80:83], v2 offset:0
ds_read_b128 v[84:87], v2 offset:1024
v_mov_b64 v[24:25], 0
v_mov_b64 v[26:27], 0
v_mov_b64 v[28:29], 0
v_mov_b64 v[30:31], 0
s_waitcnt vmcnt(9)
v_bfe_u32 v7, v0, 2, 3
v_add_u32 v7, s28, v7
s_mov_b32 exec_hi, 0
v_and_b32 v7, 511, v0
v_lshl_add_u32 v7, v7, 3, s34
s_mov_b32 exec_hi, -1
v_mov_b64 v[8:9], 0
v_mov_b64 v[10:11], 0
v_mov_b64 v[12:13], 0
v_mov_b64 v[14:15], 0
v_mov_b64 v[16:17], 0
v_mov_b64 v[18:19], 0
v_mov_b64 v[20:21], 0
v_mov_b64 v[22:23], 0
s_nop 15
s_nop 15
s_nop 15
s_nop 15
s_nop 15
s_nop 7
s_barrier
buffer_load_dwordx4 v[48:51], v0, s[4:7], s66 offen offset:0 sc1
buffer_load_dwordx4 v[52:55], v0, s[4:7], s66 offen offset:1024 sc1
buffer_load_dwordx4 v[56:59], v0, s[4:7], s66 offen offset:2048 sc1
buffer_load_dwordx4 v[60:63], v0, s[4:7], s66 offen offset:3072 sc1
s_nop 15
s_nop 15
s_nop 15
s_nop 13
s_mov_b32 s37, 0
s_cmp_eq_u32 s17, s38
s_barrier
s_nop 15
s_nop 7
s_cbranch_scc0 gather_176
s_branch exit_179
rare_177:
ds_read_b128 v[48:51], v6 offset:0
ds_read_b128 v[52:55], v6 offset:1024
s_waitcnt lgkmcnt(0)
s_barrier
v_add_f32 v48, v48, v52
v_add_f32 v49, v49, v53
v_add_f32 v50, v50, v54
v_add_f32 v51, v51, v55
v_mov_b32_dpp v46, v46 quad_perm:[0,1,0,1] row_mask:0xf bank_mask:0xf
v_mov_b32_dpp v47, v47 quad_perm:[0,1,0,1] row_mask:0xf bank_mask:0xf
v_max3_f32 v19, v48, v49, v50
v_max3_f32 v19, v19, v51, v46
v_max_f32 v19, v19, v47
s_nop 1
v_max_f32_dpp v19, v19, v19 quad_perm:[2,3,0,1] row_mask:0xf bank_mask:0xf
v_mov_b32 v44, v19
s_nop 1
v_permlane32_swap_b32 v19, v44
v_max_f32 v19, v19, v44
v_mov_b32 v44, v19
s_nop 1
v_permlane16_swap_b32 v19, v44
v_max_f32 v19, v19, v44
v_sub_f32 v48, v48, v19
v_sub_f32 v49, v49, v19
v_sub_f32 v50, v50, v19
v_sub_f32 v51, v51, v19
v_sub_f32 v46, v46, v19
v_sub_f32 v47, v47, v19
v_exp_f32 v48, v48
v_exp_f32 v49, v49
v_exp_f32 v50, v50
v_exp_f32 v51, v51
v_cvt_pk_bf16_f32 v54, v48, v49
v_cvt_pk_bf16_f32 v55, v50, v51
s_nop 0
v_mov_b32_dpp v48, v54 quad_perm:[0,1,0,1] row_mask:0xf bank_mask:0xf
v_mov_b32_dpp v49, v55 quad_perm:[0,1,0,1] row_mask:0xf bank_mask:0xf
v_mov_b32_dpp v50, v54 quad_perm:[2,3,2,3] row_mask:0xf bank_mask:0xf
v_mov_b32_dpp v51, v55 quad_perm:[2,3,2,3] row_mask:0xf bank_mask:0xf
v_mov_b64 v[20:21], s[56:57]
v_mov_b64 v[22:23], s[56:57]
v_mfma_f32_16x16x32_bf16 v[8:11], v[56:59], v[48:51], 0
v_mfma_f32_16x16x32_bf16 v[12:15], v[60:63], v[48:51], 0
v_mfma_f32_16x16x32_bf16 v[16:19], v[20:23], v[48:51], 0
v_mov_b64 v[54:55], s[58:59]
v_exp_f32_dpp v44, v46 quad_perm:[0,1,0,1] row_mask:0xf bank_mask:0xf
v_exp_f32_dpp v45, v47 quad_perm:[0,1,0,1] row_mask:0xf bank_mask:0xf
s_nop 0
v_cvt_pk_bf16_f32 v52, v44, v45
v_cvt_pk_bf16_f32 v53, v44, v45
s_nop 1
v_mfma_f32_16x16x16_bf16 v[16:19], v[54:55], v[52:53], v[16:19]
v_mfma_f32_16x16x16_bf16 v[8:11], v[24:25], v[52:53], v[8:11]
v_mfma_f32_16x16x16_bf16 v[12:15], v[26:27], v[52:53], v[12:15]
s_nop 5
v_rcp_f32 v18, v16
s_nop 0
v_mul_f32 v8, v8, v18
v_mul_f32 v9, v9, v18
v_mul_f32 v10, v10, v18
v_mul_f32 v11, v11, v18
v_mul_f32 v12, v12, v18
v_mul_f32 v13, v13, v18
v_mul_f32 v14, v14, v18
v_mul_f32 v15, v15, v18
v_cvt_pk_bf16_f32 v8, v8, v9
v_cvt_pk_bf16_f32 v9, v10, v11
v_cvt_pk_bf16_f32 v10, v12, v13
v_cvt_pk_bf16_f32 v11, v14, v15
s_branch back_178
exit_179:
buffer_load_dwordx4 v[32:35], v0, s[4:7], s20 offen sc1
buffer_load_dwordx4 v[36:39], v0, s[4:7], s21 offen sc1
s_add_u32 s37, s37, 1
s_cmp_gt_u32 s37, 262144
s_cbranch_scc1 L_fail
s_waitcnt vmcnt(1)
v_bitop3_b32 v44, v32, v34, s18 bitop3:0x7e
s_waitcnt vmcnt(0)
v_bitop3_b32 v45, v36, v38, s18 bitop3:0x7e
v_bitop3_b32 v44, v44, v45, s19 bitop3:0xa8
v_cmp_ne_u32 vcc, 0, v44
s_cbranch_vccnz exit_179
s_add_u32 s45, s45, 1
s_cmp_lt_u32 s45, 2
s_cbranch_scc1 layer_175
s_endpgm
grp_125:
L_fail:
s_mov_b64 exec, 1
v_mov_b32 v1, 0xdead
buffer_store_dword v1, off, s[8:11], 0 offset:60 sc1
L_end:
s_endpgm

.section .rodata,"a"
.p2align 6
.amdhsa_kernel interleave_layers__spectral_gfnet__memory_aug_recurrent_mem_tr__prompt_kernel
  .amdhsa_next_free_vgpr 512
  .amdhsa_next_free_sgpr 102
  .amdhsa_accum_offset 256
  .amdhsa_group_segment_fixed_size 0
  .amdhsa_kernarg_size 104
  .amdhsa_user_sgpr_count 2
  .amdhsa_user_sgpr_kernarg_segment_ptr 1
  .amdhsa_system_sgpr_workgroup_id_x 1
  .amdhsa_float_denorm_mode_32 3
  .amdhsa_ieee_mode 0
.end_amdhsa_kernel
```

```asm
; @launch grid=(256,1,1) block=(256,1,1) lds=163840
.amdgcn_target "amdgcn-amd-amdhsa--gfx950"
.text
.globl interleave_layers__spectral_gfnet__memory_aug_recurrent_mem_tr__prompt_kernel
.p2align 8
.type interleave_layers__spectral_gfnet__memory_aug_recurrent_mem_tr__prompt_kernel,@function
interleave_layers__spectral_gfnet__memory_aug_recurrent_mem_tr__prompt_kernel:
s_cmp_ge_u32 s2, 256
s_cbranch_scc1 L_end
s_load_dwordx2 s[4:5], s[0:1], 96
s_load_dwordx2 s[8:9], s[0:1], 88
s_mov_b32 s6, 268435456
s_mov_b32 s7, 0x20000
s_mov_b32 s10, 256
s_mov_b32 s11, 0x20000
s_getreg_b32 s12, hwreg(HW_REG_XCC_ID, 0, 3)
v_lshrrev_b32 v1, 6, v0
s_nop 0
v_readfirstlane_b32 s13, v1
s_waitcnt lgkmcnt(0)
s_cmp_lg_u32 s13, 0
s_cbranch_scc1 reg_3
s_cmp_ge_u32 s2, 16
s_cbranch_scc1 reg_4
v_lshlrev_b32 v1, 4, v0
s_lshl_b32 s15, s2, 12
v_mov_b64 v[4:5], 0
v_mov_b64 v[6:7], 0
buffer_store_dwordx4 v[4:7], v1, s[4:7], s15 offen offset:0 sc1
buffer_store_dwordx4 v[4:7], v1, s[4:7], s15 offen offset:1024 sc1
buffer_store_dwordx4 v[4:7], v1, s[4:7], s15 offen offset:2048 sc1
buffer_store_dwordx4 v[4:7], v1, s[4:7], s15 offen offset:3072 sc1
s_waitcnt vmcnt(0)
reg_4:
s_lshl_b32 s15, s12, 5
v_mov_b32 v2, 1
s_mov_b64 exec, 1
buffer_atomic_add v2, off, s[8:11], s15 sc0
s_mov_b64 exec, -1
v_and_b32 v1, 7, v0
v_lshlrev_b32 v1, 5, v1
s_mov_b32 s16, 0
reg_1:
buffer_load_dword v3, v1, s[8:11], 0 offen sc1
s_add_u32 s16, s16, 1
s_cmp_gt_u32 s16, 262144
s_cbranch_scc1 L_fail
s_waitcnt vmcnt(0)
v_add_u32_dpp v4, v3, v3 quad_perm:[1,0,3,2] row_mask:0xf bank_mask:0xf
s_nop 1
v_add_u32_dpp v4, v4, v4 quad_perm:[2,3,0,1] row_mask:0xf bank_mask:0xf
s_nop 1
v_add_u32_dpp v4, v4, v4 row_ror:4 row_mask:0xf bank_mask:0xf
v_cmp_ne_u32 vcc, 0x100, v4
s_cbranch_vccnz reg_1
v_readfirstlane_b32 s17, v2
v_readlane_b32 s20, v3, 0
v_readlane_b32 s21, v3, 1
v_readlane_b32 s22, v3, 2
v_readlane_b32 s23, v3, 3
v_readlane_b32 s24, v3, 4
v_readlane_b32 s25, v3, 5
v_readlane_b32 s26, v3, 6
v_readlane_b32 s27, v3, 7
s_mov_b32 s15, 7
s_cmp_ge_u32 s26, 32
s_cselect_b32 s15, 6, s15
s_cmp_ge_u32 s25, 32
s_cselect_b32 s15, 5, s15
s_cmp_ge_u32 s24, 32
s_cselect_b32 s15, 4, s15
s_cmp_ge_u32 s23, 32
s_cselect_b32 s15, 3, s15
s_cmp_ge_u32 s22, 32
s_cselect_b32 s15, 2, s15
s_cmp_ge_u32 s21, 32
s_cselect_b32 s15, 1, s15
s_cmp_ge_u32 s20, 32
s_cselect_b32 s15, 0, s15
s_mov_b32 s16, s17
s_cmp_gt_u32 s12, 0
s_cselect_b32 s18, s20, 0
s_add_u32 s16, s16, s18
s_cmp_gt_u32 s12, 1
s_cselect_b32 s18, s21, 0
s_add_u32 s16, s16, s18
s_cmp_gt_u32 s12, 2
s_cselect_b32 s18, s22, 0
s_add_u32 s16, s16, s18
s_cmp_gt_u32 s12, 3
s_cselect_b32 s18, s23, 0
s_add_u32 s16, s16, s18
s_cmp_gt_u32 s12, 4
s_cselect_b32 s18, s24, 0
s_add_u32 s16, s16, s18
s_cmp_gt_u32 s12, 5
s_cselect_b32 s18, s25, 0
s_add_u32 s16, s16, s18
s_cmp_gt_u32 s12, 6
s_cselect_b32 s18, s26, 0
s_add_u32 s16, s16, s18
s_add_u32 s18, s16, 32
s_cmp_lt_u32 s12, s15
s_cselect_b32 s16, s18, s16
s_cmp_eq_u32 s12, s15
s_cselect_b32 s18, s17, 32
s_cmp_lt_u32 s18, 32
s_cselect_b32 s16, s18, s16
v_mov_b32 v1, 0
v_mov_b32 v2, s16
ds_write_b32 v1, v2
s_waitcnt lgkmcnt(0)
s_branch reg_2
reg_3:
s_lshl_b32 s15, s13, 3
s_sub_u32 s15, s15, 8
s_load_dwordx2 s[20:21], s[0:1], s15
s_mov_b32 s16, 1314816
s_cmp_eq_u32 s13, 1
s_cselect_b32 s22, 2621440, s16
s_cselect_b32 s16, 80, 41
s_mov_b32 s23, 0x20000
s_mul_i32 s17, s16, s2
s_lshl_b32 s17, s17, 7
s_sub_u32 s16, s16, 1
v_and_b32 v1, 63, v0
v_add_u32 v2, 64, v1
v_min_u32 v1, s16, v1
v_min_u32 v2, s16, v2
v_lshlrev_b32 v1, 7, v1
v_lshlrev_b32 v2, 7, v2
s_waitcnt lgkmcnt(0)
buffer_load_dword v3, v1, s[20:23], s17 offen
buffer_load_dword v4, v2, s[20:23], s17 offen
reg_2:
s_barrier
v_mov_b32 v1, 0
ds_read_b32 v2, v1
s_waitcnt lgkmcnt(0)
v_readfirstlane_b32 s14, v2
s_barrier
s_cmp_lt_u32 s14, 32
s_cbranch_scc1 L_chain
s_sub_u32 s15, s14, 32
v_and_b32 v0, 63, v0
v_lshlrev_b32 v0, 4, v0
s_mov_b32 s24, 0x3f803f80
s_mul_i32 s31, s13, 10240
s_mov_b32 s22, s6
s_mov_b32 s23, 0
s_mov_b32 s16, 0
s_cmp_ge_u32 s15, 64
s_cbranch_scc1 roleA_6
s_and_b32 s32, s15, 31
s_cmp_ge_u32 s15, 32
s_cbranch_scc1 roleV_5
s_lshl_b32 s26, s32, 8
s_lshl_b32 s18, s13, 6
s_add_u32 s26, s26, s18
s_load_dwordx2 s[36:37], s[0:1], 48
s_mov_b32 s38, 5242880
s_mov_b32 s39, 0x20000
s_waitcnt lgkmcnt(0)
v_lshrrev_b32 v32, 6, v0
v_mul_u32_u24 v32, 8192, v32
v_and_b32 v33, 48, v0
v_add_u32 v30, v32, v33
v_bfe_u32 v32, v0, 6, 2
v_lshrrev_b32 v33, 9, v0
v_lshl_add_u32 v32, v33, 3, v32
v_lshlrev_b32 v31, 6, v32
v_and_b32 v32, 16, v0
v_add_u32 v31, v31, v32
v_bfe_u32 v32, v0, 5, 1
v_lshl_add_u32 v31, v32, 3, v31
v_bfe_u32 v32, v0, 8, 1
v_lshl_add_u32 v31, v32, 5, v31
s_mul_i32 s18, s13, 36864
v_add_u32 v31, s18, v31
s_barrier
s_add_u32 m0, s18, 0
s_add_u32 s19, s26, 0
buffer_load_dwordx4 v30, s[36:39], s19 offen lds
s_add_u32 m0, s18, 1024
s_add_u32 s19, s26, 131072
buffer_load_dwordx4 v30, s[36:39], s19 offen lds
s_add_u32 m0, s18, 2048
s_add_u32 s19, s26, 262144
buffer_load_dwordx4 v30, s[36:39], s19 offen lds
s_add_u32 m0, s18, 3072
s_add_u32 s19, s26, 393216
buffer_load_dwordx4 v30, s[36:39], s19 offen lds
s_add_u32 m0, s18, 4096
s_add_u32 s19, s26, 524288
buffer_load_dwordx4 v30, s[36:39], s19 offen lds
s_add_u32 m0, s18, 5120
s_add_u32 s19, s26, 655360
buffer_load_dwordx4 v30, s[36:39], s19 offen lds
s_add_u32 m0, s18, 6144
s_add_u32 s19, s26, 786432
buffer_load_dwordx4 v30, s[36:39], s19 offen lds
s_add_u32 m0, s18, 7168
s_add_u32 s19, s26, 917504
buffer_load_dwordx4 v30, s[36:39], s19 offen lds
s_add_u32 m0, s18, 8192
s_add_u32 s19, s26, 1048576
buffer_load_dwordx4 v30, s[36:39], s19 offen lds
s_add_u32 m0, s18, 9216
s_add_u32 s19, s26, 1179648
buffer_load_dwordx4 v30, s[36:39], s19 offen lds
s_add_u32 m0, s18, 10240
s_add_u32 s19, s26, 1310720
buffer_load_dwordx4 v30, s[36:39], s19 offen lds
s_add_u32 m0, s18, 11264
s_add_u32 s19, s26, 1441792
buffer_load_dwordx4 v30, s[36:39], s19 offen lds
s_add_u32 m0, s18, 12288
s_add_u32 s19, s26, 1572864
buffer_load_dwordx4 v30, s[36:39], s19 offen lds
s_add_u32 m0, s18, 13312
s_add_u32 s19, s26, 1703936
buffer_load_dwordx4 v30, s[36:39], s19 offen lds
s_add_u32 m0, s18, 14336
s_add_u32 s19, s26, 1835008
buffer_load_dwordx4 v30, s[36:39], s19 offen lds
s_add_u32 m0, s18, 15360
s_add_u32 s19, s26, 1966080
buffer_load_dwordx4 v30, s[36:39], s19 offen lds
s_add_u32 m0, s18, 16384
s_add_u32 s19, s26, 2097152
buffer_load_dwordx4 v30, s[36:39], s19 offen lds
s_add_u32 m0, s18, 17408
s_add_u32 s19, s26, 2228224
buffer_load_dwordx4 v30, s[36:39], s19 offen lds
s_add_u32 m0, s18, 18432
s_add_u32 s19, s26, 2359296
buffer_load_dwordx4 v30, s[36:39], s19 offen lds
s_add_u32 m0, s18, 19456
s_add_u32 s19, s26, 2490368
buffer_load_dwordx4 v30, s[36:39], s19 offen lds
s_add_u32 m0, s18, 20480
s_add_u32 s19, s26, 2621440
buffer_load_dwordx4 v30, s[36:39], s19 offen lds
s_add_u32 m0, s18, 21504
s_add_u32 s19, s26, 2752512
buffer_load_dwordx4 v30, s[36:39], s19 offen lds
s_add_u32 m0, s18, 22528
s_add_u32 s19, s26, 2883584
buffer_load_dwordx4 v30, s[36:39], s19 offen lds
s_add_u32 m0, s18, 23552
s_add_u32 s19, s26, 3014656
buffer_load_dwordx4 v30, s[36:39], s19 offen lds
s_add_u32 m0, s18, 24576
s_add_u32 s19, s26, 3145728
buffer_load_dwordx4 v30, s[36:39], s19 offen lds
s_add_u32 m0, s18, 25600
s_add_u32 s19, s26, 3276800
buffer_load_dwordx4 v30, s[36:39], s19 offen lds
s_add_u32 m0, s18, 26624
s_add_u32 s19, s26, 3407872
buffer_load_dwordx4 v30, s[36:39], s19 offen lds
s_add_u32 m0, s18, 27648
s_add_u32 s19, s26, 3538944
buffer_load_dwordx4 v30, s[36:39], s19 offen lds
s_add_u32 m0, s18, 28672
s_add_u32 s19, s26, 3670016
buffer_load_dwordx4 v30, s[36:39], s19 offen lds
s_add_u32 m0, s18, 29696
s_add_u32 s19, s26, 3801088
buffer_load_dwordx4 v30, s[36:39], s19 offen lds
s_add_u32 m0, s18, 30720
s_add_u32 s19, s26, 3932160
buffer_load_dwordx4 v30, s[36:39], s19 offen lds
s_add_u32 m0, s18, 31744
s_add_u32 s19, s26, 4063232
buffer_load_dwordx4 v30, s[36:39], s19 offen lds
s_add_u32 m0, s18, 32768
s_add_u32 s19, s26, 4194304
buffer_load_dwordx4 v30, s[36:39], s19 offen lds
s_add_u32 m0, s18, 33792
s_add_u32 s19, s26, 4325376
buffer_load_dwordx4 v30, s[36:39], s19 offen lds
s_add_u32 m0, s18, 34816
s_add_u32 s19, s26, 4456448
buffer_load_dwordx4 v30, s[36:39], s19 offen lds
s_add_u32 m0, s18, 35840
s_add_u32 s19, s26, 4587520
buffer_load_dwordx4 v30, s[36:39], s19 offen lds
s_waitcnt vmcnt(32)
ds_read_b64_tr_b16 a[0:1], v31 offset:0
ds_read_b64_tr_b16 a[2:3], v31 offset:256
ds_read_b64_tr_b16 a[4:5], v31 offset:1024
ds_read_b64_tr_b16 a[6:7], v31 offset:1280
ds_read_b64_tr_b16 a[8:9], v31 offset:2048
ds_read_b64_tr_b16 a[10:11], v31 offset:2304
ds_read_b64_tr_b16 a[12:13], v31 offset:3072
ds_read_b64_tr_b16 a[14:15], v31 offset:3328
s_waitcnt lgkmcnt(0)
s_add_u32 m0, s18, 0
s_add_u32 s19, s26, 4718592
buffer_load_dwordx4 v30, s[36:39], s19 offen lds
s_add_u32 m0, s18, 1024
s_add_u32 s19, s26, 4849664
buffer_load_dwordx4 v30, s[36:39], s19 offen lds
s_add_u32 m0, s18, 2048
s_add_u32 s19, s26, 4980736
buffer_load_dwordx4 v30, s[36:39], s19 offen lds
s_add_u32 m0, s18, 3072
s_add_u32 s19, s26, 5111808
buffer_load_dwordx4 v30, s[36:39], s19 offen lds
s_waitcnt vmcnt(32)
ds_read_b64_tr_b16 a[16:17], v31 offset:4096
ds_read_b64_tr_b16 a[18:19], v31 offset:4352
ds_read_b64_tr_b16 a[20:21], v31 offset:5120
ds_read_b64_tr_b16 a[22:23], v31 offset:5376
ds_read_b64_tr_b16 a[24:25], v31 offset:6144
ds_read_b64_tr_b16 a[26:27], v31 offset:6400
ds_read_b64_tr_b16 a[28:29], v31 offset:7168
ds_read_b64_tr_b16 a[30:31], v31 offset:7424
s_waitcnt vmcnt(28)
ds_read_b64_tr_b16 a[32:33], v31 offset:8192
ds_read_b64_tr_b16 a[34:35], v31 offset:8448
ds_read_b64_tr_b16 a[36:37], v31 offset:9216
ds_read_b64_tr_b16 a[38:39], v31 offset:9472
ds_read_b64_tr_b16 a[40:41], v31 offset:10240
ds_read_b64_tr_b16 a[42:43], v31 offset:10496
ds_read_b64_tr_b16 a[44:45], v31 offset:11264
ds_read_b64_tr_b16 a[46:47], v31 offset:11520
s_waitcnt vmcnt(24)
ds_read_b64_tr_b16 a[48:49], v31 offset:12288
ds_read_b64_tr_b16 a[50:51], v31 offset:12544
ds_read_b64_tr_b16 a[52:53], v31 offset:13312
ds_read_b64_tr_b16 a[54:55], v31 offset:13568
ds_read_b64_tr_b16 a[56:57], v31 offset:14336
ds_read_b64_tr_b16 a[58:59], v31 offset:14592
ds_read_b64_tr_b16 a[60:61], v31 offset:15360
ds_read_b64_tr_b16 a[62:63], v31 offset:15616
s_waitcnt vmcnt(20)
ds_read_b64_tr_b16 a[64:65], v31 offset:16384
ds_read_b64_tr_b16 a[66:67], v31 offset:16640
ds_read_b64_tr_b16 a[68:69], v31 offset:17408
ds_read_b64_tr_b16 a[70:71], v31 offset:17664
ds_read_b64_tr_b16 a[72:73], v31 offset:18432
ds_read_b64_tr_b16 a[74:75], v31 offset:18688
ds_read_b64_tr_b16 a[76:77], v31 offset:19456
ds_read_b64_tr_b16 a[78:79], v31 offset:19712
s_waitcnt vmcnt(16)
ds_read_b64_tr_b16 a[80:81], v31 offset:20480
ds_read_b64_tr_b16 a[82:83], v31 offset:20736
ds_read_b64_tr_b16 a[84:85], v31 offset:21504
ds_read_b64_tr_b16 a[86:87], v31 offset:21760
ds_read_b64_tr_b16 a[88:89], v31 offset:22528
ds_read_b64_tr_b16 a[90:91], v31 offset:22784
ds_read_b64_tr_b16 a[92:93], v31 offset:23552
ds_read_b64_tr_b16 a[94:95], v31 offset:23808
s_waitcnt vmcnt(12)
ds_read_b64_tr_b16 a[96:97], v31 offset:24576
ds_read_b64_tr_b16 a[98:99], v31 offset:24832
ds_read_b64_tr_b16 a[100:101], v31 offset:25600
ds_read_b64_tr_b16 a[102:103], v31 offset:25856
ds_read_b64_tr_b16 a[104:105], v31 offset:26624
ds_read_b64_tr_b16 a[106:107], v31 offset:26880
ds_read_b64_tr_b16 a[108:109], v31 offset:27648
ds_read_b64_tr_b16 a[110:111], v31 offset:27904
s_waitcnt vmcnt(8)
ds_read_b64_tr_b16 a[112:113], v31 offset:28672
ds_read_b64_tr_b16 a[114:115], v31 offset:28928
ds_read_b64_tr_b16 a[116:117], v31 offset:29696
ds_read_b64_tr_b16 a[118:119], v31 offset:29952
ds_read_b64_tr_b16 a[120:121], v31 offset:30720
ds_read_b64_tr_b16 a[122:123], v31 offset:30976
ds_read_b64_tr_b16 a[124:125], v31 offset:31744
ds_read_b64_tr_b16 a[126:127], v31 offset:32000
s_waitcnt vmcnt(4)
ds_read_b64_tr_b16 a[128:129], v31 offset:32768
ds_read_b64_tr_b16 a[130:131], v31 offset:33024
ds_read_b64_tr_b16 a[132:133], v31 offset:33792
ds_read_b64_tr_b16 a[134:135], v31 offset:34048
ds_read_b64_tr_b16 a[136:137], v31 offset:34816
ds_read_b64_tr_b16 a[138:139], v31 offset:35072
ds_read_b64_tr_b16 a[140:141], v31 offset:35840
ds_read_b64_tr_b16 a[142:143], v31 offset:36096
s_waitcnt vmcnt(0)
ds_read_b64_tr_b16 a[144:145], v31 offset:0
ds_read_b64_tr_b16 a[146:147], v31 offset:256
ds_read_b64_tr_b16 a[148:149], v31 offset:1024
ds_read_b64_tr_b16 a[150:151], v31 offset:1280
ds_read_b64_tr_b16 a[152:153], v31 offset:2048
ds_read_b64_tr_b16 a[154:155], v31 offset:2304
ds_read_b64_tr_b16 a[156:157], v31 offset:3072
ds_read_b64_tr_b16 a[158:159], v31 offset:3328
s_waitcnt lgkmcnt(0)
s_barrier
s_load_dwordx2 s[36:37], s[0:1], 40
s_mov_b32 s38, 5242880
s_mov_b32 s39, 0x20000
s_waitcnt lgkmcnt(0)
v_lshrrev_b32 v5, 5, v0
v_lshlrev_b32 v5, 13, v5
v_bfe_u32 v6, v0, 4, 1
v_lshl_add_u32 v5, v6, 7, v5
s_lshl_b32 s18, s32, 8
s_mul_i32 s19, s13, 1310720
s_add_u32 s18, s18, s19
buffer_load_dword v24, v5, s[36:39], s18 offen
s_add_u32 s18, s18, 262144
buffer_load_dword v25, v5, s[36:39], s18 offen
s_add_u32 s18, s18, 262144
buffer_load_dword v26, v5, s[36:39], s18 offen
s_add_u32 s18, s18, 262144
buffer_load_dword v27, v5, s[36:39], s18 offen
s_add_u32 s18, s18, 262144
buffer_load_dword v28, v5, s[36:39], s18 offen
s_add_u32 s18, s18, 262144
v_mov_b32 v32, s24
v_mov_b32 v33, s24
v_mov_b32 v34, s24
v_mov_b32 v35, s24
s_nop 1
v_mfma_f32_32x32x16_bf16 v[36:51], a[0:3], v[32:35], 0
v_mfma_f32_32x32x16_bf16 v[36:51], a[4:7], v[32:35], v[36:51]
v_mfma_f32_32x32x16_bf16 v[36:51], a[8:11], v[32:35], v[36:51]
v_mfma_f32_32x32x16_bf16 v[36:51], a[12:15], v[32:35], v[36:51]
v_mfma_f32_32x32x16_bf16 v[36:51], a[16:19], v[32:35], v[36:51]
v_mfma_f32_32x32x16_bf16 v[36:51], a[20:23], v[32:35], v[36:51]
v_mfma_f32_32x32x16_bf16 v[36:51], a[24:27], v[32:35], v[36:51]
v_mfma_f32_32x32x16_bf16 v[36:51], a[28:31], v[32:35], v[36:51]
v_mfma_f32_32x32x16_bf16 v[36:51], a[32:35], v[32:35], v[36:51]
v_mfma_f32_32x32x16_bf16 v[36:51], a[36:39], v[32:35], v[36:51]
v_mfma_f32_32x32x16_bf16 v[36:51], a[40:43], v[32:35], v[36:51]
v_mfma_f32_32x32x16_bf16 v[36:51], a[44:47], v[32:35], v[36:51]
v_mfma_f32_32x32x16_bf16 v[36:51], a[48:51], v[32:35], v[36:51]
v_mfma_f32_32x32x16_bf16 v[36:51], a[52:55], v[32:35], v[36:51]
v_mfma_f32_32x32x16_bf16 v[36:51], a[56:59], v[32:35], v[36:51]
v_mfma_f32_32x32x16_bf16 v[36:51], a[60:63], v[32:35], v[36:51]
v_mfma_f32_32x32x16_bf16 v[36:51], a[64:67], v[32:35], v[36:51]
v_mfma_f32_32x32x16_bf16 v[36:51], a[68:71], v[32:35], v[36:51]
v_mfma_f32_32x32x16_bf16 v[36:51], a[72:75], v[32:35], v[36:51]
v_mfma_f32_32x32x16_bf16 v[36:51], a[76:79], v[32:35], v[36:51]
v_mfma_f32_32x32x16_bf16 v[36:51], a[80:83], v[32:35], v[36:51]
v_mfma_f32_32x32x16_bf16 v[36:51], a[84:87], v[32:35], v[36:51]
v_mfma_f32_32x32x16_bf16 v[36:51], a[88:91], v[32:35], v[36:51]
v_mfma_f32_32x32x16_bf16 v[36:51], a[92:95], v[32:35], v[36:51]
v_mfma_f32_32x32x16_bf16 v[36:51], a[96:99], v[32:35], v[36:51]
v_mfma_f32_32x32x16_bf16 v[36:51], a[100:103], v[32:35], v[36:51]
v_mfma_f32_32x32x16_bf16 v[36:51], a[104:107], v[32:35], v[36:51]
v_mfma_f32_32x32x16_bf16 v[36:51], a[108:111], v[32:35], v[36:51]
v_mfma_f32_32x32x16_bf16 v[36:51], a[112:115], v[32:35], v[36:51]
v_mfma_f32_32x32x16_bf16 v[36:51], a[116:119], v[32:35], v[36:51]
v_mfma_f32_32x32x16_bf16 v[36:51], a[120:123], v[32:35], v[36:51]
v_mfma_f32_32x32x16_bf16 v[36:51], a[124:127], v[32:35], v[36:51]
v_mfma_f32_32x32x16_bf16 v[36:51], a[128:131], v[32:35], v[36:51]
v_mfma_f32_32x32x16_bf16 v[36:51], a[132:135], v[32:35], v[36:51]
v_mfma_f32_32x32x16_bf16 v[36:51], a[136:139], v[32:35], v[36:51]
v_mfma_f32_32x32x16_bf16 v[36:51], a[140:143], v[32:35], v[36:51]
v_mfma_f32_32x32x16_bf16 v[36:51], a[144:147], v[32:35], v[36:51]
v_mfma_f32_32x32x16_bf16 v[36:51], a[148:151], v[32:35], v[36:51]
v_mfma_f32_32x32x16_bf16 v[36:51], a[152:155], v[32:35], v[36:51]
v_mfma_f32_32x32x16_bf16 v[36:51], a[156:159], v[32:35], v[36:51]
s_nop 11
v_mov_b32 v8, v36
v_mov_b32 v9, v37
v_mov_b32 v10, v38
v_mov_b32 v11, v39
v_mov_b32 v12, v40
v_mov_b32 v13, v41
v_mov_b32 v14, v42
v_mov_b32 v15, v43
v_mov_b32 v16, v44
v_mov_b32 v17, v45
v_mov_b32 v18, v46
v_mov_b32 v19, v47
v_mov_b32 v20, v48
v_mov_b32 v21, v49
v_mov_b32 v22, v50
v_mov_b32 v23, v51
v_and_b32 v5, 0x70, v0
s_waitcnt vmcnt(4)
v_lshrrev_b32 v24, 8, v0
v_lshl_add_u32 v5, v24, 7, v5
v_bfe_u32 v24, v0, 7, 1
v_lshl_add_u32 v5, v24, 12, v5
s_lshr_b32 s34, s13, 1
s_lshl_b32 s34, s34, 13
s_and_b32 s18, s13, 1
s_lshl_b32 s18, s18, 10
s_add_u32 s34, s34, s18
s_lshl_b32 s18, s32, 14
s_add_u32 s34, s34, s18
v_bfe_u32 v6, v0, 7, 2
v_mul_u32_u24 v6, 10240, v6
v_bfe_u32 v24, v0, 5, 2
v_lshl_add_u32 v6, v24, 6, v6
v_lshrrev_b32 v24, 9, v0
v_lshl_add_u32 v6, v24, 5, v6
v_and_b32 v24, 16, v0
v_add_u32 v6, v24, v6
v_add_u32 v7, 81920, v0
s_add_u32 s49, s31, 81920
s_lshl_b32 s47, s32, 7
s_add_u32 s47, s47, 0
s_mul_i32 s48, s13, 2560
s_add_u32 s48, s48, 12582912
s_add_u32 s46, s34, 110100480
s_mov_b32 s35, 0
kvlay_7:
s_mul_i32 s26, s16, 6291456
s_add_u32 s26, s26, 88080384
s_add_u32 s26, s26, s31
s_mul_i32 s27, s16, 34603008
s_add_u32 s27, s27, 16777216
s_add_u32 s27, s27, s34
s_lshl_b32 s29, s16, 1
s_add_u32 s29, s29, 1
s_mov_b32 s28, 0
s_cmp_lg_u32 s13, 0
s_cbranch_scc1 polld_13
s_waitcnt vmcnt(0)
v_lshrrev_b32 v28, 2, v0
v_min_u32 v28, 36, v28
s_mov_b32 s21, 8192
s_mov_b32 s17, 0
poll_12:
buffer_load_dword v24, v28, s[4:7], s21 offen offset:0 sc1
s_add_u32 s17, s17, 1
s_cmp_gt_u32 s17, 262144
s_cbranch_scc1 L_fail
s_waitcnt vmcnt(0)
v_cmp_gt_u32 vcc, s29, v24
s_cbranch_vccz polld_13
s_sleep 2
s_branch poll_12
polld_13:
s_barrier
v_xor_b32 v1, 40960, v0
s_mov_b32 s25, s31
s_add_u32 m0, s25, 2048
s_add_u32 s20, s26, 0
buffer_load_dwordx4 v0, s[4:7], s20 offen sc1 lds
s_add_u32 m0, s25, 3072
s_add_u32 s20, s26, 1024
buffer_load_dwordx4 v0, s[4:7], s20 offen sc1 lds
s_add_u32 m0, s25, 4096
s_add_u32 s20, s26, 2048
buffer_load_dwordx4 v0, s[4:7], s20 offen sc1 lds
s_add_u32 m0, s25, 5120
s_add_u32 s20, s26, 3072
buffer_load_dwordx4 v0, s[4:7], s20 offen sc1 lds
s_add_u32 m0, s25, 6144
s_add_u32 s20, s26, 4096
buffer_load_dwordx4 v0, s[4:7], s20 offen sc1 lds
s_add_u32 m0, s25, 7168
s_add_u32 s20, s26, 5120
buffer_load_dwordx4 v0, s[4:7], s20 offen sc1 lds
s_add_u32 m0, s25, 8192
s_add_u32 s20, s26, 6144
buffer_load_dwordx4 v0, s[4:7], s20 offen sc1 lds
s_add_u32 m0, s25, 9216
s_add_u32 s20, s26, 7168
buffer_load_dwordx4 v0, s[4:7], s20 offen sc1 lds
s_add_u32 m0, s25, 10240
s_add_u32 s20, s26, 8192
buffer_load_dwordx4 v0, s[4:7], s20 offen sc1 lds
s_add_u32 m0, s25, 11264
s_add_u32 s20, s26, 9216
buffer_load_dwordx4 v0, s[4:7], s20 offen sc1 lds
s_waitcnt vmcnt(0)
kvx_8:
v_xor_b32 v1, 40960, v1
s_sub_u32 s25, s25, s31
s_xor_b32 s25, s25, 40960
s_add_u32 s25, s25, s31
s_add_u32 s26, s26, 40960
s_cmp_eq_u32 s28, 1
s_cbranch_scc1 kvnom_11
s_cmp_lg_u32 s28, 31
s_cbranch_scc1 kvnop_9
s_add_u32 s29, s29, 1
kvnom_11:
s_waitcnt vmcnt(0)
s_barrier
v_mov_b32 v3, s23
s_mov_b64 exec, 1
buffer_store_dword v3, off, s[4:7], s22 sc1
s_mov_b64 exec, -1
s_mov_b32 s22, s6
s_cmp_lg_u32 s13, 0
s_cbranch_scc1 polld_15
v_min_u32 v28, 624, v0
s_mov_b32 s21, 8192
s_mov_b32 s17, 0
poll_14:
buffer_load_dwordx4 v[24:27], v28, s[4:7], s21 offen offset:0 sc1
s_add_u32 s17, s17, 1
s_cmp_gt_u32 s17, 262144
s_cbranch_scc1 L_fail
s_waitcnt vmcnt(0)
v_min3_u32 v24, v24, v25, v26
v_min_u32 v24, v24, v27
v_cmp_gt_u32 vcc, s29, v24
s_cbranch_vccz polld_15
s_sleep 2
s_branch poll_14
polld_15:
s_barrier
kvnop_9:
s_cmp_eq_u32 s28, 63
s_cselect_b32 s26, s6, s26
s_waitcnt vmcnt(3)
s_barrier
v_add_u32 v2, s31, v1
s_add_u32 m0, s25, 2048
s_add_u32 s20, s26, 0
buffer_load_dwordx4 v0, s[4:7], s20 offen sc1 lds
ds_read_b128 v[72:75], v2 offset:2048
ds_read_b128 v[56:59], v1 offset:4096
s_add_u32 m0, s25, 3072
s_add_u32 s20, s26, 1024
buffer_load_dwordx4 v0, s[4:7], s20 offen sc1 lds
s_add_u32 m0, s25, 4096
s_add_u32 s20, s26, 2048
buffer_load_dwordx4 v0, s[4:7], s20 offen sc1 lds
ds_read_b128 v[76:79], v2 offset:3072
ds_read_b128 v[84:87], v2 offset:5120
ds_read_b128 v[80:83], v2 offset:4096
s_add_u32 m0, s25, 5120
s_add_u32 s20, s26, 3072
buffer_load_dwordx4 v0, s[4:7], s20 offen sc1 lds
ds_read_b128 v[52:55], v1 offset:3072
v_mov_b64 v[64:65], 0
s_waitcnt lgkmcnt(5)
v_dot2c_f32_bf16 v64, s24, v72
v_dot2c_f32_bf16 v65, v72, v72
v_dot2c_f32_bf16 v64, s24, v73
v_dot2c_f32_bf16 v65, v73, v73
v_dot2c_f32_bf16 v64, s24, v74
v_dot2c_f32_bf16 v65, v74, v74
v_dot2c_f32_bf16 v64, s24, v75
v_dot2c_f32_bf16 v65, v75, v75
s_waitcnt lgkmcnt(3)
v_dot2c_f32_bf16 v64, s24, v76
v_dot2c_f32_bf16 v65, v76, v76
v_dot2c_f32_bf16 v64, s24, v77
v_dot2c_f32_bf16 v65, v77, v77
v_dot2c_f32_bf16 v64, s24, v78
v_dot2c_f32_bf16 v65, v78, v78
v_dot2c_f32_bf16 v64, s24, v79
v_dot2c_f32_bf16 v65, v79, v79
s_waitcnt lgkmcnt(1)
ds_read_b128 v[76:79], v2 offset:7168
ds_read_b128 v[72:75], v2 offset:6144
ds_read_b128 v[48:51], v1 offset:2048
v_dot2c_f32_bf16 v64, s24, v80
v_dot2c_f32_bf16 v65, v80, v80
v_dot2c_f32_bf16 v64, s24, v81
v_dot2c_f32_bf16 v65, v81, v81
v_dot2c_f32_bf16 v64, s24, v82
v_dot2c_f32_bf16 v65, v82, v82
v_dot2c_f32_bf16 v64, s24, v83
v_dot2c_f32_bf16 v65, v83, v83
v_dot2c_f32_bf16 v64, s24, v84
v_dot2c_f32_bf16 v65, v84, v84
v_dot2c_f32_bf16 v64, s24, v85
v_dot2c_f32_bf16 v65, v85, v85
v_dot2c_f32_bf16 v64, s24, v86
v_dot2c_f32_bf16 v65, v86, v86
v_dot2c_f32_bf16 v64, s24, v87
v_dot2c_f32_bf16 v65, v87, v87
s_waitcnt lgkmcnt(1)
ds_read_b128 v[80:83], v2 offset:8192
ds_read_b128 v[84:87], v2 offset:9216
ds_read_b128 v[60:63], v1 offset:5120
v_dot2c_f32_bf16 v64, s24, v72
v_dot2c_f32_bf16 v65, v72, v72
v_dot2c_f32_bf16 v64, s24, v73
v_dot2c_f32_bf16 v65, v73, v73
v_dot2c_f32_bf16 v64, s24, v74
v_dot2c_f32_bf16 v65, v74, v74
v_dot2c_f32_bf16 v64, s24, v75
v_dot2c_f32_bf16 v65, v75, v75
v_dot2c_f32_bf16 v64, s24, v76
v_dot2c_f32_bf16 v65, v76, v76
v_dot2c_f32_bf16 v64, s24, v77
v_dot2c_f32_bf16 v65, v77, v77
v_dot2c_f32_bf16 v64, s24, v78
v_dot2c_f32_bf16 v65, v78, v78
v_dot2c_f32_bf16 v64, s24, v79
v_dot2c_f32_bf16 v65, v79, v79
s_waitcnt lgkmcnt(1)
ds_read_b128 v[72:75], v2 offset:10240
ds_read_b128 v[76:79], v2 offset:11264
s_add_u32 m0, s25, 6144
s_add_u32 s20, s26, 4096
buffer_load_dwordx4 v0, s[4:7], s20 offen sc1 lds
v_dot2c_f32_bf16 v64, s24, v80
v_dot2c_f32_bf16 v65, v80, v80
v_dot2c_f32_bf16 v64, s24, v81
v_dot2c_f32_bf16 v65, v81, v81
v_dot2c_f32_bf16 v64, s24, v82
v_dot2c_f32_bf16 v65, v82, v82
v_dot2c_f32_bf16 v64, s24, v83
v_dot2c_f32_bf16 v65, v83, v83
v_dot2c_f32_bf16 v64, s24, v84
v_dot2c_f32_bf16 v65, v84, v84
v_dot2c_f32_bf16 v64, s24, v85
v_dot2c_f32_bf16 v65, v85, v85
v_dot2c_f32_bf16 v64, s24, v86
v_dot2c_f32_bf16 v65, v86, v86
v_dot2c_f32_bf16 v64, s24, v87
s_waitcnt lgkmcnt(0)
v_dot2c_f32_bf16 v65, v87, v87
v_dot2c_f32_bf16 v64, s24, v72
v_dot2c_f32_bf16 v65, v72, v72
v_dot2c_f32_bf16 v64, s24, v73
v_dot2c_f32_bf16 v65, v73, v73
v_dot2c_f32_bf16 v64, s24, v74
v_dot2c_f32_bf16 v65, v74, v74
v_dot2c_f32_bf16 v64, s24, v75
v_dot2c_f32_bf16 v65, v75, v75
v_dot2c_f32_bf16 v64, s24, v76
v_dot2c_f32_bf16 v65, v76, v76
v_dot2c_f32_bf16 v64, s24, v77
v_dot2c_f32_bf16 v65, v77, v77
v_dot2c_f32_bf16 v64, s24, v78
v_dot2c_f32_bf16 v65, v78, v78
v_dot2c_f32_bf16 v64, s24, v79
v_dot2c_f32_bf16 v65, v79, v79
v_mfma_f32_32x32x16_bf16 v[32:47], a[0:3], v[48:51], 0
s_add_u32 m0, s25, 7168
s_add_u32 s20, s26, 5120
buffer_load_dwordx4 v0, s[4:7], s20 offen sc1 lds
v_mfma_f32_32x32x16_bf16 v[32:47], a[4:7], v[52:55], v[32:47]
ds_read_b128 v[48:51], v1 offset:6144
v_permlane32_swap_b32 v64, v65
ds_read_b128 v[52:55], v1 offset:7168
v_mfma_f32_32x32x16_bf16 v[32:47], a[8:11], v[56:59], v[32:47]
ds_read_b128 v[56:59], v1 offset:8192
s_add_u32 m0, s25, 8192
s_add_u32 s20, s26, 6144
buffer_load_dwordx4 v0, s[4:7], s20 offen sc1 lds
v_mfma_f32_32x32x16_bf16 v[32:47], a[12:15], v[60:63], v[32:47]
s_add_u32 m0, s25, 9216
s_add_u32 s20, s26, 7168
buffer_load_dwordx4 v0, s[4:7], s20 offen sc1 lds
s_waitcnt lgkmcnt(2)
v_mfma_f32_32x32x16_bf16 v[32:47], a[16:19], v[48:51], v[32:47]
v_add_f32 v64, v64, v65
s_waitcnt lgkmcnt(1)
ds_read_b128 v[60:63], v1 offset:9216
ds_read_b128 v[48:51], v1 offset:10240
v_mfma_f32_32x32x16_bf16 v[32:47], a[20:23], v[52:55], v[32:47]
s_waitcnt lgkmcnt(2)
ds_read_b128 v[52:55], v1 offset:11264
v_mfma_f32_32x32x16_bf16 v[32:47], a[24:27], v[56:59], v[32:47]
ds_read_b128 v[56:59], v1 offset:12288
s_waitcnt lgkmcnt(3)
v_mfma_f32_32x32x16_bf16 v[32:47], a[28:31], v[60:63], v[32:47]
ds_read_b128 v[60:63], v1 offset:13312
v_lshl_add_u32 v65, s13, 2, v0
s_waitcnt lgkmcnt(2)
ds_write_b32 v65, v64 offset:0
v_mfma_f32_32x32x16_bf16 v[32:47], a[32:35], v[48:51], v[32:47]
v_and_b32 v2, 0x1ff, v0
ds_read_b128 v[48:51], v1 offset:14336
v_mfma_f32_32x32x16_bf16 v[32:47], a[36:39], v[52:55], v[32:47]
s_add_u32 m0, s25, 10240
s_add_u32 s20, s26, 8192
buffer_load_dwordx4 v0, s[4:7], s20 offen sc1 lds
ds_read_b128 v[52:55], v1 offset:15360
v_mov_b32 v3, s23
s_waitcnt lgkmcnt(3)
v_mfma_f32_32x32x16_bf16 v[32:47], a[40:43], v[56:59], v[32:47]
v_mfma_f32_32x32x16_bf16 v[32:47], a[44:47], v[60:63], v[32:47]
s_waitcnt lgkmcnt(1)
ds_read_b128 v[56:59], v1 offset:16384
ds_read_b128 v[60:63], v1 offset:17408
s_add_u32 m0, s25, 11264
s_add_u32 s20, s26, 9216
buffer_load_dwordx4 v0, s[4:7], s20 offen sc1 lds
v_mfma_f32_32x32x16_bf16 v[32:47], a[48:51], v[48:51], v[32:47]
s_waitcnt lgkmcnt(2)
v_mfma_f32_32x32x16_bf16 v[32:47], a[52:55], v[52:55], v[32:47]
ds_read_b128 v[52:55], v1 offset:19456
s_waitcnt lgkmcnt(1)
ds_read_b128 v[48:51], v1 offset:18432
v_mfma_f32_32x32x16_bf16 v[32:47], a[56:59], v[56:59], v[32:47]
ds_read_b128 v[56:59], v1 offset:20480
v_mfma_f32_32x32x16_bf16 v[32:47], a[60:63], v[60:63], v[32:47]
s_waitcnt lgkmcnt(1)
v_mfma_f32_32x32x16_bf16 v[32:47], a[64:67], v[48:51], v[32:47]
ds_read_b128 v[48:51], v1 offset:22528
s_waitcnt lgkmcnt(1)
ds_read_b128 v[60:63], v1 offset:21504
v_mfma_f32_32x32x16_bf16 v[32:47], a[68:71], v[52:55], v[32:47]
v_mfma_f32_32x32x16_bf16 v[32:47], a[72:75], v[56:59], v[32:47]
ds_read_b128 v[56:59], v1 offset:24576
ds_read_b128 v[52:55], v1 offset:23552
s_waitcnt lgkmcnt(2)
v_mfma_f32_32x32x16_bf16 v[32:47], a[76:79], v[60:63], v[32:47]
ds_read_b128 v[60:63], v1 offset:25600
s_waitcnt vmcnt(10)
s_barrier
ds_read_b128 v[64:67], v2 offset:0
v_mfma_f32_32x32x16_bf16 v[32:47], a[80:83], v[48:51], v[32:47]
s_waitcnt lgkmcnt(3)
s_mov_b64 exec, 1
buffer_store_dword v3, off, s[4:7], s22 sc1
s_mov_b64 exec, -1
s_waitcnt lgkmcnt(2)
v_mfma_f32_32x32x16_bf16 v[32:47], a[84:87], v[52:55], v[32:47]
s_waitcnt lgkmcnt(1)
ds_read_b128 v[48:51], v1 offset:26624
ds_read_b128 v[52:55], v1 offset:27648
ds_read_b128 v[68:71], v2 offset:512
v_mfma_f32_32x32x16_bf16 v[32:47], a[88:91], v[56:59], v[32:47]
ds_read_b128 v[56:59], v1 offset:28672
v_mfma_f32_32x32x16_bf16 v[32:47], a[92:95], v[60:63], v[32:47]
s_waitcnt lgkmcnt(3)
v_mfma_f32_32x32x16_bf16 v[32:47], a[96:99], v[48:51], v[32:47]
s_waitcnt lgkmcnt(2)
ds_read_b128 v[48:51], v1 offset:30720
s_waitcnt lgkmcnt(2)
ds_read_b128 v[60:63], v1 offset:29696
v_add_f32 v68, v68, v69
s_waitcnt lgkmcnt(2)
v_mfma_f32_32x32x16_bf16 v[32:47], a[100:103], v[52:55], v[32:47]
v_add_f32 v70, v70, v71
ds_read_b128 v[52:55], v1 offset:31744
v_add_f32 v64, v64, v65
v_mfma_f32_32x32x16_bf16 v[32:47], a[104:107], v[56:59], v[32:47]
ds_read_b128 v[56:59], v1 offset:32768
s_waitcnt lgkmcnt(2)
v_mfma_f32_32x32x16_bf16 v[32:47], a[108:111], v[60:63], v[32:47]
v_add_f32 v68, v68, v70
v_add_f32 v66, v66, v67
v_add_f32 v64, v64, v66
v_mul_f32 v64, 0x3acccccd, v64
s_waitcnt lgkmcnt(1)
v_mfma_f32_32x32x16_bf16 v[32:47], a[112:115], v[48:51], v[32:47]
ds_read_b128 v[60:63], v1 offset:33792
ds_read_b128 v[48:51], v1 offset:34816
v_mul_f32 v68, 0x3acccccd, v68
v_fma_f32 v68, -v64, v64, v68
v_mfma_f32_32x32x16_bf16 v[32:47], a[116:119], v[52:55], v[32:47]
s_waitcnt lgkmcnt(2)
ds_read_b128 v[52:55], v1 offset:35840
v_mfma_f32_32x32x16_bf16 v[32:47], a[120:123], v[56:59], v[32:47]
ds_read_b128 v[56:59], v1 offset:36864
s_waitcnt lgkmcnt(3)
s_waitcnt lgkmcnt(2)
v_mfma_f32_32x32x16_bf16 v[32:47], a[124:127], v[60:63], v[32:47]
v_max_f32 v68, 0, v68
ds_read_b128 v[60:63], v1 offset:37888
s_waitcnt lgkmcnt(2)
v_mfma_f32_32x32x16_bf16 v[32:47], a[128:131], v[48:51], v[32:47]
ds_read_b128 v[48:51], v1 offset:38912
v_mfma_f32_32x32x16_bf16 v[32:47], a[132:135], v[52:55], v[32:47]
ds_read_b128 v[52:55], v1 offset:39936
v_add_f32 v68, 0x3727c5ac, v68
s_waitcnt lgkmcnt(2)
v_rsq_f32 v68, v68
v_mfma_f32_32x32x16_bf16 v[32:47], a[136:139], v[56:59], v[32:47]
s_waitcnt lgkmcnt(1)
v_mul_f32 v64, v68, v64
ds_read_b128 v[56:59], v1 offset:40960
v_mfma_f32_32x32x16_bf16 v[32:47], a[140:143], v[60:63], v[32:47]
v_mul_f32 v86, v64, v22
ds_read_b128 v[60:63], v1 offset:41984
v_mfma_f32_32x32x16_bf16 v[32:47], a[144:147], v[48:51], v[32:47]
v_mul_f32 v84, v64, v20
s_waitcnt lgkmcnt(2)
v_mul_f32 v85, v64, v21
s_waitcnt lgkmcnt(1)
v_mul_f32 v80, v64, v16
v_mfma_f32_32x32x16_bf16 v[32:47], a[148:151], v[52:55], v[32:47]
v_mul_f32 v78, v64, v14
v_mul_f32 v87, v64, v23
s_waitcnt lgkmcnt(0)
v_mfma_f32_32x32x16_bf16 v[32:47], a[152:155], v[56:59], v[32:47]
v_mul_f32 v74, v64, v10
v_mul_f32 v72, v64, v8
v_mul_f32 v75, v64, v11
v_mul_f32 v76, v64, v12
v_mul_f32 v82, v64, v18
v_mfma_f32_32x32x16_bf16 v[32:47], a[156:159], v[60:63], v[32:47]
s_nop 0
v_mul_f32 v83, v64, v19
v_mul_f32 v77, v64, v13
v_mul_f32 v73, v64, v9
v_mul_f32 v81, v64, v17
s_nop 6
v_fma_f32 v35, v35, v68, -v75
v_fma_f32 v38, v38, v68, -v78
v_fma_f32 v32, v32, v68, -v72
v_mul_f32 v79, v64, v15
v_fma_f32 v42, v42, v68, -v82
v_fma_f32 v43, v43, v68, -v83
v_fma_f32 v45, v45, v68, -v85
v_fma_f32 v36, v36, v68, -v76
v_fma_f32 v37, v37, v68, -v77
v_fma_f32 v39, v39, v68, -v79
v_fma_f32 v41, v41, v68, -v81
v_fma_f32 v40, v40, v68, -v80
v_cvt_pk_bf16_f32 v50, v36, v37
v_fma_f32 v33, v33, v68, -v73
v_fma_f32 v46, v46, v68, -v86
v_cvt_pk_bf16_f32 v51, v38, v39
v_fma_f32 v44, v44, v68, -v84
v_cvt_pk_bf16_f32 v52, v40, v41
v_cvt_pk_bf16_f32 v53, v42, v43
v_fma_f32 v34, v34, v68, -v74
v_cvt_pk_bf16_f32 v54, v44, v45
v_cvt_pk_bf16_f32 v48, v32, v33
v_fma_f32 v47, v47, v68, -v87
v_cvt_pk_bf16_f32 v49, v34, v35
v_cvt_pk_bf16_f32 v55, v46, v47
buffer_store_dwordx4 v[48:51], v5, s[4:7], s27 offen offset:0 sc1
buffer_store_dwordx4 v[52:55], v5, s[4:7], s27 offen offset:512 sc1
s_add_u32 s28, s28, 1
s_lshl_b32 s18, s16, 6
s_add_u32 s18, s18, s28
s_add_u32 s27, s27, 524288
s_cmp_eq_u32 s13, 0
s_cselect_b32 s22, s47, s6
s_mov_b32 s23, s18
s_cmp_lg_u32 s28, 1
s_cbranch_scc1 mk_16
mk_16:
s_cmp_lg_u32 s28, 2
s_cbranch_scc1 mk_17
mk_17:
s_cmp_lg_u32 s28, 3
s_cbranch_scc1 mk_18
mk_18:
s_cmp_lg_u32 s28, 11
s_cbranch_scc1 mk_19
mk_19:
s_and_b32 s18, s28, 3
s_cbranch_scc1 kvx_8
s_cmp_lt_u32 s28, 12
s_cbranch_scc1 kvx_8
kvm_10:
s_waitcnt vmcnt(0)
s_barrier
v_mov_b32 v3, s23
s_mov_b64 exec, 1
buffer_store_dword v3, off, s[4:7], s22 sc1
s_mov_b64 exec, -1
s_mov_b32 s22, s6
s_add_u32 s35, s35, 1
s_lshl_b32 s30, s35, 2
s_cmp_lg_u32 s13, 0
s_cbranch_scc1 polld_21
v_lshrrev_b32 v28, 2, v0
v_min_u32 v28, 36, v28
s_mov_b32 s21, 4096
s_mov_b32 s17, 0
poll_20:
buffer_load_dword v24, v28, s[4:7], s21 offen offset:0 sc1
s_add_u32 s17, s17, 1
s_cmp_gt_u32 s17, 262144
s_cbranch_scc1 L_fail
s_waitcnt vmcnt(0)
v_cmp_gt_u32 vcc, s30, v24
s_cbranch_vccz polld_21
s_sleep 2
s_branch poll_20
polld_21:
s_barrier
s_add_u32 m0, s49, 2048
s_add_u32 s20, s48, 0
buffer_load_dwordx4 v6, s[4:7], s20 offen sc1 lds
s_add_u32 m0, s49, 3072
s_add_u32 s20, s48, 256
buffer_load_dwordx4 v6, s[4:7], s20 offen sc1 lds
s_add_u32 m0, s49, 4096
s_add_u32 s20, s48, 512
buffer_load_dwordx4 v6, s[4:7], s20 offen sc1 lds
s_add_u32 m0, s49, 5120
s_add_u32 s20, s48, 768
buffer_load_dwordx4 v6, s[4:7], s20 offen sc1 lds
s_add_u32 m0, s49, 6144
s_add_u32 s20, s48, 1024
buffer_load_dwordx4 v6, s[4:7], s20 offen sc1 lds
s_add_u32 m0, s49, 7168
s_add_u32 s20, s48, 1280
buffer_load_dwordx4 v6, s[4:7], s20 offen sc1 lds
s_add_u32 m0, s49, 8192
s_add_u32 s20, s48, 1536
buffer_load_dwordx4 v6, s[4:7], s20 offen sc1 lds
s_add_u32 m0, s49, 9216
s_add_u32 s20, s48, 1792
buffer_load_dwordx4 v6, s[4:7], s20 offen sc1 lds
s_add_u32 m0, s49, 10240
s_add_u32 s20, s48, 2048
buffer_load_dwordx4 v6, s[4:7], s20 offen sc1 lds
s_add_u32 m0, s49, 11264
s_add_u32 s20, s48, 2304
buffer_load_dwordx4 v6, s[4:7], s20 offen sc1 lds
s_waitcnt vmcnt(0)
s_barrier
ds_read_b128 v[48:51], v7 offset:2048
ds_read_b128 v[52:55], v7 offset:3072
ds_read_b128 v[56:59], v7 offset:4096
ds_read_b128 v[60:63], v7 offset:5120
s_waitcnt lgkmcnt(3)
v_mfma_f32_32x32x16_bf16 v[32:47], a[0:3], v[48:51], 0
ds_read_b128 v[48:51], v7 offset:6144
s_waitcnt lgkmcnt(3)
v_mfma_f32_32x32x16_bf16 v[32:47], a[4:7], v[52:55], v[32:47]
s_waitcnt lgkmcnt(2)
ds_read_b128 v[52:55], v7 offset:7168
v_mfma_f32_32x32x16_bf16 v[32:47], a[8:11], v[56:59], v[32:47]
s_waitcnt lgkmcnt(2)
ds_read_b128 v[56:59], v7 offset:8192
v_mfma_f32_32x32x16_bf16 v[32:47], a[12:15], v[60:63], v[32:47]
s_waitcnt lgkmcnt(2)
ds_read_b128 v[60:63], v7 offset:9216
v_mfma_f32_32x32x16_bf16 v[32:47], a[16:19], v[48:51], v[32:47]
s_waitcnt lgkmcnt(2)
ds_read_b128 v[48:51], v7 offset:10240
v_mfma_f32_32x32x16_bf16 v[32:47], a[20:23], v[52:55], v[32:47]
s_waitcnt lgkmcnt(2)
ds_read_b128 v[52:55], v7 offset:11264
v_mfma_f32_32x32x16_bf16 v[32:47], a[24:27], v[56:59], v[32:47]
s_waitcnt lgkmcnt(2)
ds_read_b128 v[56:59], v7 offset:12288
v_mfma_f32_32x32x16_bf16 v[32:47], a[28:31], v[60:63], v[32:47]
s_waitcnt lgkmcnt(2)
ds_read_b128 v[60:63], v7 offset:13312
v_mfma_f32_32x32x16_bf16 v[32:47], a[32:35], v[48:51], v[32:47]
s_waitcnt lgkmcnt(2)
ds_read_b128 v[48:51], v7 offset:14336
v_mfma_f32_32x32x16_bf16 v[32:47], a[36:39], v[52:55], v[32:47]
s_waitcnt lgkmcnt(2)
ds_read_b128 v[52:55], v7 offset:15360
v_mfma_f32_32x32x16_bf16 v[32:47], a[40:43], v[56:59], v[32:47]
s_waitcnt lgkmcnt(2)
ds_read_b128 v[56:59], v7 offset:16384
v_mfma_f32_32x32x16_bf16 v[32:47], a[44:47], v[60:63], v[32:47]
s_waitcnt lgkmcnt(2)
ds_read_b128 v[60:63], v7 offset:17408
v_mfma_f32_32x32x16_bf16 v[32:47], a[48:51], v[48:51], v[32:47]
s_waitcnt lgkmcnt(2)
ds_read_b128 v[48:51], v7 offset:18432
v_mfma_f32_32x32x16_bf16 v[32:47], a[52:55], v[52:55], v[32:47]
s_waitcnt lgkmcnt(2)
ds_read_b128 v[52:55], v7 offset:19456
v_mfma_f32_32x32x16_bf16 v[32:47], a[56:59], v[56:59], v[32:47]
s_waitcnt lgkmcnt(2)
ds_read_b128 v[56:59], v7 offset:20480
v_mfma_f32_32x32x16_bf16 v[32:47], a[60:63], v[60:63], v[32:47]
s_waitcnt lgkmcnt(2)
ds_read_b128 v[60:63], v7 offset:21504
v_mfma_f32_32x32x16_bf16 v[32:47], a[64:67], v[48:51], v[32:47]
s_waitcnt lgkmcnt(2)
ds_read_b128 v[48:51], v7 offset:22528
v_mfma_f32_32x32x16_bf16 v[32:47], a[68:71], v[52:55], v[32:47]
s_waitcnt lgkmcnt(2)
ds_read_b128 v[52:55], v7 offset:23552
v_mfma_f32_32x32x16_bf16 v[32:47], a[72:75], v[56:59], v[32:47]
s_waitcnt lgkmcnt(2)
ds_read_b128 v[56:59], v7 offset:24576
v_mfma_f32_32x32x16_bf16 v[32:47], a[76:79], v[60:63], v[32:47]
s_waitcnt lgkmcnt(2)
ds_read_b128 v[60:63], v7 offset:25600
v_mfma_f32_32x32x16_bf16 v[32:47], a[80:83], v[48:51], v[32:47]
s_waitcnt lgkmcnt(2)
ds_read_b128 v[48:51], v7 offset:26624
v_mfma_f32_32x32x16_bf16 v[32:47], a[84:87], v[52:55], v[32:47]
s_waitcnt lgkmcnt(2)
ds_read_b128 v[52:55], v7 offset:27648
v_mfma_f32_32x32x16_bf16 v[32:47], a[88:91], v[56:59], v[32:47]
s_waitcnt lgkmcnt(2)
ds_read_b128 v[56:59], v7 offset:28672
v_mfma_f32_32x32x16_bf16 v[32:47], a[92:95], v[60:63], v[32:47]
s_waitcnt lgkmcnt(2)
ds_read_b128 v[60:63], v7 offset:29696
v_mfma_f32_32x32x16_bf16 v[32:47], a[96:99], v[48:51], v[32:47]
s_waitcnt lgkmcnt(2)
ds_read_b128 v[48:51], v7 offset:30720
v_mfma_f32_32x32x16_bf16 v[32:47], a[100:103], v[52:55], v[32:47]
s_waitcnt lgkmcnt(2)
ds_read_b128 v[52:55], v7 offset:31744
v_mfma_f32_32x32x16_bf16 v[32:47], a[104:107], v[56:59], v[32:47]
s_waitcnt lgkmcnt(2)
ds_read_b128 v[56:59], v7 offset:32768
v_mfma_f32_32x32x16_bf16 v[32:47], a[108:111], v[60:63], v[32:47]
s_waitcnt lgkmcnt(2)
ds_read_b128 v[60:63], v7 offset:33792
v_mfma_f32_32x32x16_bf16 v[32:47], a[112:115], v[48:51], v[32:47]
s_waitcnt lgkmcnt(2)
ds_read_b128 v[48:51], v7 offset:34816
v_mfma_f32_32x32x16_bf16 v[32:47], a[116:119], v[52:55], v[32:47]
s_waitcnt lgkmcnt(2)
ds_read_b128 v[52:55], v7 offset:35840
v_mfma_f32_32x32x16_bf16 v[32:47], a[120:123], v[56:59], v[32:47]
s_waitcnt lgkmcnt(2)
ds_read_b128 v[56:59], v7 offset:36864
v_mfma_f32_32x32x16_bf16 v[32:47], a[124:127], v[60:63], v[32:47]
s_waitcnt lgkmcnt(2)
ds_read_b128 v[60:63], v7 offset:37888
v_mfma_f32_32x32x16_bf16 v[32:47], a[128:131], v[48:51], v[32:47]
s_waitcnt lgkmcnt(2)
ds_read_b128 v[48:51], v7 offset:38912
v_mfma_f32_32x32x16_bf16 v[32:47], a[132:135], v[52:55], v[32:47]
s_waitcnt lgkmcnt(2)
ds_read_b128 v[52:55], v7 offset:39936
v_mfma_f32_32x32x16_bf16 v[32:47], a[136:139], v[56:59], v[32:47]
s_waitcnt lgkmcnt(2)
ds_read_b128 v[56:59], v7 offset:40960
v_mfma_f32_32x32x16_bf16 v[32:47], a[140:143], v[60:63], v[32:47]
s_waitcnt lgkmcnt(2)
ds_read_b128 v[60:63], v7 offset:41984
v_mfma_f32_32x32x16_bf16 v[32:47], a[144:147], v[48:51], v[32:47]
s_waitcnt lgkmcnt(2)
v_mfma_f32_32x32x16_bf16 v[32:47], a[148:151], v[52:55], v[32:47]
s_waitcnt lgkmcnt(1)
v_mfma_f32_32x32x16_bf16 v[32:47], a[152:155], v[56:59], v[32:47]
s_waitcnt lgkmcnt(0)
v_mfma_f32_32x32x16_bf16 v[32:47], a[156:159], v[60:63], v[32:47]
s_nop 11
v_cvt_pk_bf16_f32 v48, v32, v33
v_cvt_pk_bf16_f32 v49, v34, v35
v_cvt_pk_bf16_f32 v50, v36, v37
v_cvt_pk_bf16_f32 v51, v38, v39
v_cvt_pk_bf16_f32 v52, v40, v41
v_cvt_pk_bf16_f32 v53, v42, v43
v_cvt_pk_bf16_f32 v54, v44, v45
v_cvt_pk_bf16_f32 v55, v46, v47
buffer_store_dwordx4 v[48:51], v5, s[4:7], s46 offen offset:0 sc1
buffer_store_dwordx4 v[52:55], v5, s[4:7], s46 offen offset:512 sc1
s_add_u32 s48, s48, 40960
s_add_u32 s46, s46, 524288
s_add_u32 s18, s47, 8
s_cmp_eq_u32 s13, 0
s_cselect_b32 s22, s18, s6
s_mov_b32 s23, s35
s_cmp_lt_u32 s28, 64
s_cbranch_scc1 kvx_8
s_and_b32 s18, s35, 15
s_cbranch_scc1 kvm_10
s_waitcnt vmcnt(0)
s_barrier
v_mov_b32 v3, s23
s_mov_b64 exec, 1
buffer_store_dword v3, off, s[4:7], s22 sc1
s_mov_b64 exec, -1
s_mov_b32 s22, s6
s_add_u32 s16, s16, 1
s_cmp_lt_u32 s16, 2
s_cbranch_scc1 kvlay_7
s_endpgm
roleV_5:
s_lshl_b32 s26, s32, 8
s_lshl_b32 s18, s13, 6
s_add_u32 s26, s26, s18
s_load_dwordx2 s[36:37], s[0:1], 56
s_mov_b32 s38, 5242880
s_mov_b32 s39, 0x20000
s_waitcnt lgkmcnt(0)
v_lshrrev_b32 v20, 6, v0
v_mul_u32_u24 v20, 8192, v20
v_and_b32 v21, 48, v0
v_add_u32 v18, v20, v21
v_bfe_u32 v20, v0, 6, 2
v_lshrrev_b32 v21, 9, v0
v_lshl_add_u32 v20, v21, 3, v20
v_lshlrev_b32 v19, 6, v20
v_and_b32 v20, 48, v0
v_add_u32 v19, v19, v20
v_bfe_u32 v20, v0, 8, 1
v_lshl_add_u32 v19, v20, 3, v19
s_mul_i32 s18, s13, 36864
v_add_u32 v19, s18, v19
s_barrier
s_add_u32 m0, s18, 0
s_add_u32 s19, s26, 0
buffer_load_dwordx4 v18, s[36:39], s19 offen lds
s_add_u32 m0, s18, 1024
s_add_u32 s19, s26, 131072
buffer_load_dwordx4 v18, s[36:39], s19 offen lds
s_add_u32 m0, s18, 2048
s_add_u32 s19, s26, 262144
buffer_load_dwordx4 v18, s[36:39], s19 offen lds
s_add_u32 m0, s18, 3072
s_add_u32 s19, s26, 393216
buffer_load_dwordx4 v18, s[36:39], s19 offen lds
s_add_u32 m0, s18, 4096
s_add_u32 s19, s26, 524288
buffer_load_dwordx4 v18, s[36:39], s19 offen lds
s_add_u32 m0, s18, 5120
s_add_u32 s19, s26, 655360
buffer_load_dwordx4 v18, s[36:39], s19 offen lds
s_add_u32 m0, s18, 6144
s_add_u32 s19, s26, 786432
buffer_load_dwordx4 v18, s[36:39], s19 offen lds
s_add_u32 m0, s18, 7168
s_add_u32 s19, s26, 917504
buffer_load_dwordx4 v18, s[36:39], s19 offen lds
s_add_u32 m0, s18, 8192
s_add_u32 s19, s26, 1048576
buffer_load_dwordx4 v18, s[36:39], s19 offen lds
s_add_u32 m0, s18, 9216
s_add_u32 s19, s26, 1179648
buffer_load_dwordx4 v18, s[36:39], s19 offen lds
s_add_u32 m0, s18, 10240
s_add_u32 s19, s26, 1310720
buffer_load_dwordx4 v18, s[36:39], s19 offen lds
s_add_u32 m0, s18, 11264
s_add_u32 s19, s26, 1441792
buffer_load_dwordx4 v18, s[36:39], s19 offen lds
s_add_u32 m0, s18, 12288
s_add_u32 s19, s26, 1572864
buffer_load_dwordx4 v18, s[36:39], s19 offen lds
s_add_u32 m0, s18, 13312
s_add_u32 s19, s26, 1703936
buffer_load_dwordx4 v18, s[36:39], s19 offen lds
s_add_u32 m0, s18, 14336
s_add_u32 s19, s26, 1835008
buffer_load_dwordx4 v18, s[36:39], s19 offen lds
s_add_u32 m0, s18, 15360
s_add_u32 s19, s26, 1966080
buffer_load_dwordx4 v18, s[36:39], s19 offen lds
s_add_u32 m0, s18, 16384
s_add_u32 s19, s26, 2097152
buffer_load_dwordx4 v18, s[36:39], s19 offen lds
s_add_u32 m0, s18, 17408
s_add_u32 s19, s26, 2228224
buffer_load_dwordx4 v18, s[36:39], s19 offen lds
s_add_u32 m0, s18, 18432
s_add_u32 s19, s26, 2359296
buffer_load_dwordx4 v18, s[36:39], s19 offen lds
s_add_u32 m0, s18, 19456
s_add_u32 s19, s26, 2490368
buffer_load_dwordx4 v18, s[36:39], s19 offen lds
s_add_u32 m0, s18, 20480
s_add_u32 s19, s26, 2621440
buffer_load_dwordx4 v18, s[36:39], s19 offen lds
s_add_u32 m0, s18, 21504
s_add_u32 s19, s26, 2752512
buffer_load_dwordx4 v18, s[36:39], s19 offen lds
s_add_u32 m0, s18, 22528
s_add_u32 s19, s26, 2883584
buffer_load_dwordx4 v18, s[36:39], s19 offen lds
s_add_u32 m0, s18, 23552
s_add_u32 s19, s26, 3014656
buffer_load_dwordx4 v18, s[36:39], s19 offen lds
s_add_u32 m0, s18, 24576
s_add_u32 s19, s26, 3145728
buffer_load_dwordx4 v18, s[36:39], s19 offen lds
s_add_u32 m0, s18, 25600
s_add_u32 s19, s26, 3276800
buffer_load_dwordx4 v18, s[36:39], s19 offen lds
s_add_u32 m0, s18, 26624
s_add_u32 s19, s26, 3407872
buffer_load_dwordx4 v18, s[36:39], s19 offen lds
s_add_u32 m0, s18, 27648
s_add_u32 s19, s26, 3538944
buffer_load_dwordx4 v18, s[36:39], s19 offen lds
s_add_u32 m0, s18, 28672
s_add_u32 s19, s26, 3670016
buffer_load_dwordx4 v18, s[36:39], s19 offen lds
s_add_u32 m0, s18, 29696
s_add_u32 s19, s26, 3801088
buffer_load_dwordx4 v18, s[36:39], s19 offen lds
s_add_u32 m0, s18, 30720
s_add_u32 s19, s26, 3932160
buffer_load_dwordx4 v18, s[36:39], s19 offen lds
s_add_u32 m0, s18, 31744
s_add_u32 s19, s26, 4063232
buffer_load_dwordx4 v18, s[36:39], s19 offen lds
s_add_u32 m0, s18, 32768
s_add_u32 s19, s26, 4194304
buffer_load_dwordx4 v18, s[36:39], s19 offen lds
s_add_u32 m0, s18, 33792
s_add_u32 s19, s26, 4325376
buffer_load_dwordx4 v18, s[36:39], s19 offen lds
s_add_u32 m0, s18, 34816
s_add_u32 s19, s26, 4456448
buffer_load_dwordx4 v18, s[36:39], s19 offen lds
s_add_u32 m0, s18, 35840
s_add_u32 s19, s26, 4587520
buffer_load_dwordx4 v18, s[36:39], s19 offen lds
s_waitcnt vmcnt(32)
ds_read_b64_tr_b16 a[0:1], v19 offset:0
ds_read_b64_tr_b16 a[2:3], v19 offset:256
ds_read_b64_tr_b16 a[4:5], v19 offset:1024
ds_read_b64_tr_b16 a[6:7], v19 offset:1280
ds_read_b64_tr_b16 a[8:9], v19 offset:2048
ds_read_b64_tr_b16 a[10:11], v19 offset:2304
ds_read_b64_tr_b16 a[12:13], v19 offset:3072
ds_read_b64_tr_b16 a[14:15], v19 offset:3328
s_waitcnt lgkmcnt(0)
s_add_u32 m0, s18, 0
s_add_u32 s19, s26, 4718592
buffer_load_dwordx4 v18, s[36:39], s19 offen lds
s_add_u32 m0, s18, 1024
s_add_u32 s19, s26, 4849664
buffer_load_dwordx4 v18, s[36:39], s19 offen lds
s_add_u32 m0, s18, 2048
s_add_u32 s19, s26, 4980736
buffer_load_dwordx4 v18, s[36:39], s19 offen lds
s_add_u32 m0, s18, 3072
s_add_u32 s19, s26, 5111808
buffer_load_dwordx4 v18, s[36:39], s19 offen lds
s_waitcnt vmcnt(32)
ds_read_b64_tr_b16 a[16:17], v19 offset:4096
ds_read_b64_tr_b16 a[18:19], v19 offset:4352
ds_read_b64_tr_b16 a[20:21], v19 offset:5120
ds_read_b64_tr_b16 a[22:23], v19 offset:5376
ds_read_b64_tr_b16 a[24:25], v19 offset:6144
ds_read_b64_tr_b16 a[26:27], v19 offset:6400
ds_read_b64_tr_b16 a[28:29], v19 offset:7168
ds_read_b64_tr_b16 a[30:31], v19 offset:7424
s_waitcnt vmcnt(28)
ds_read_b64_tr_b16 a[32:33], v19 offset:8192
ds_read_b64_tr_b16 a[34:35], v19 offset:8448
ds_read_b64_tr_b16 a[36:37], v19 offset:9216
ds_read_b64_tr_b16 a[38:39], v19 offset:9472
ds_read_b64_tr_b16 a[40:41], v19 offset:10240
ds_read_b64_tr_b16 a[42:43], v19 offset:10496
ds_read_b64_tr_b16 a[44:45], v19 offset:11264
ds_read_b64_tr_b16 a[46:47], v19 offset:11520
s_waitcnt vmcnt(24)
ds_read_b64_tr_b16 a[48:49], v19 offset:12288
ds_read_b64_tr_b16 a[50:51], v19 offset:12544
ds_read_b64_tr_b16 a[52:53], v19 offset:13312
ds_read_b64_tr_b16 a[54:55], v19 offset:13568
ds_read_b64_tr_b16 a[56:57], v19 offset:14336
ds_read_b64_tr_b16 a[58:59], v19 offset:14592
ds_read_b64_tr_b16 a[60:61], v19 offset:15360
ds_read_b64_tr_b16 a[62:63], v19 offset:15616
s_waitcnt vmcnt(20)
ds_read_b64_tr_b16 a[64:65], v19 offset:16384
ds_read_b64_tr_b16 a[66:67], v19 offset:16640
ds_read_b64_tr_b16 a[68:69], v19 offset:17408
ds_read_b64_tr_b16 a[70:71], v19 offset:17664
ds_read_b64_tr_b16 a[72:73], v19 offset:18432
ds_read_b64_tr_b16 a[74:75], v19 offset:18688
ds_read_b64_tr_b16 a[76:77], v19 offset:19456
ds_read_b64_tr_b16 a[78:79], v19 offset:19712
s_waitcnt vmcnt(16)
ds_read_b64_tr_b16 a[80:81], v19 offset:20480
ds_read_b64_tr_b16 a[82:83], v19 offset:20736
ds_read_b64_tr_b16 a[84:85], v19 offset:21504
ds_read_b64_tr_b16 a[86:87], v19 offset:21760
ds_read_b64_tr_b16 a[88:89], v19 offset:22528
ds_read_b64_tr_b16 a[90:91], v19 offset:22784
ds_read_b64_tr_b16 a[92:93], v19 offset:23552
ds_read_b64_tr_b16 a[94:95], v19 offset:23808
s_waitcnt vmcnt(12)
ds_read_b64_tr_b16 a[96:97], v19 offset:24576
ds_read_b64_tr_b16 a[98:99], v19 offset:24832
ds_read_b64_tr_b16 a[100:101], v19 offset:25600
ds_read_b64_tr_b16 a[102:103], v19 offset:25856
ds_read_b64_tr_b16 a[104:105], v19 offset:26624
ds_read_b64_tr_b16 a[106:107], v19 offset:26880
ds_read_b64_tr_b16 a[108:109], v19 offset:27648
ds_read_b64_tr_b16 a[110:111], v19 offset:27904
s_waitcnt vmcnt(8)
ds_read_b64_tr_b16 a[112:113], v19 offset:28672
ds_read_b64_tr_b16 a[114:115], v19 offset:28928
ds_read_b64_tr_b16 a[116:117], v19 offset:29696
ds_read_b64_tr_b16 a[118:119], v19 offset:29952
ds_read_b64_tr_b16 a[120:121], v19 offset:30720
ds_read_b64_tr_b16 a[122:123], v19 offset:30976
ds_read_b64_tr_b16 a[124:125], v19 offset:31744
ds_read_b64_tr_b16 a[126:127], v19 offset:32000
s_waitcnt vmcnt(4)
ds_read_b64_tr_b16 a[128:129], v19 offset:32768
ds_read_b64_tr_b16 a[130:131], v19 offset:33024
ds_read_b64_tr_b16 a[132:133], v19 offset:33792
ds_read_b64_tr_b16 a[134:135], v19 offset:34048
ds_read_b64_tr_b16 a[136:137], v19 offset:34816
ds_read_b64_tr_b16 a[138:139], v19 offset:35072
ds_read_b64_tr_b16 a[140:141], v19 offset:35840
ds_read_b64_tr_b16 a[142:143], v19 offset:36096
s_waitcnt vmcnt(0)
ds_read_b64_tr_b16 a[144:145], v19 offset:0
ds_read_b64_tr_b16 a[146:147], v19 offset:256
ds_read_b64_tr_b16 a[148:149], v19 offset:1024
ds_read_b64_tr_b16 a[150:151], v19 offset:1280
ds_read_b64_tr_b16 a[152:153], v19 offset:2048
ds_read_b64_tr_b16 a[154:155], v19 offset:2304
ds_read_b64_tr_b16 a[156:157], v19 offset:3072
ds_read_b64_tr_b16 a[158:159], v19 offset:3328
s_waitcnt lgkmcnt(0)
s_barrier
s_load_dwordx2 s[36:37], s[0:1], 64
s_mov_b32 s38, 5242880
s_mov_b32 s39, 0x20000
s_waitcnt lgkmcnt(0)
v_lshlrev_b32 v6, 3, v0
s_mul_i32 s18, s32, 163840
s_mul_i32 s19, s13, 40960
s_add_u32 s18, s18, s19
buffer_load_dword v12, v6, s[36:39], s18 offen
s_add_u32 s18, s18, 8192
buffer_load_dword v13, v6, s[36:39], s18 offen
s_add_u32 s18, s18, 8192
buffer_load_dword v14, v6, s[36:39], s18 offen
s_add_u32 s18, s18, 8192
buffer_load_dword v15, v6, s[36:39], s18 offen
s_add_u32 s18, s18, 8192
buffer_load_dword v16, v6, s[36:39], s18 offen
s_add_u32 s18, s18, 8192
v_mov_b32 v20, s24
v_mov_b32 v21, s24
v_mov_b32 v22, s24
v_mov_b32 v23, s24
s_nop 1
v_mfma_f32_32x32x16_bf16 v[24:39], v[20:23], a[0:3], 0
v_mfma_f32_32x32x16_bf16 v[24:39], v[20:23], a[4:7], v[24:39]
v_mfma_f32_32x32x16_bf16 v[24:39], v[20:23], a[8:11], v[24:39]
v_mfma_f32_32x32x16_bf16 v[24:39], v[20:23], a[12:15], v[24:39]
v_mfma_f32_32x32x16_bf16 v[24:39], v[20:23], a[16:19], v[24:39]
v_mfma_f32_32x32x16_bf16 v[24:39], v[20:23], a[20:23], v[24:39]
v_mfma_f32_32x32x16_bf16 v[24:39], v[20:23], a[24:27], v[24:39]
v_mfma_f32_32x32x16_bf16 v[24:39], v[20:23], a[28:31], v[24:39]
v_mfma_f32_32x32x16_bf16 v[24:39], v[20:23], a[32:35], v[24:39]
v_mfma_f32_32x32x16_bf16 v[24:39], v[20:23], a[36:39], v[24:39]
v_mfma_f32_32x32x16_bf16 v[24:39], v[20:23], a[40:43], v[24:39]
v_mfma_f32_32x32x16_bf16 v[24:39], v[20:23], a[44:47], v[24:39]
v_mfma_f32_32x32x16_bf16 v[24:39], v[20:23], a[48:51], v[24:39]
v_mfma_f32_32x32x16_bf16 v[24:39], v[20:23], a[52:55], v[24:39]
v_mfma_f32_32x32x16_bf16 v[24:39], v[20:23], a[56:59], v[24:39]
v_mfma_f32_32x32x16_bf16 v[24:39], v[20:23], a[60:63], v[24:39]
v_mfma_f32_32x32x16_bf16 v[24:39], v[20:23], a[64:67], v[24:39]
v_mfma_f32_32x32x16_bf16 v[24:39], v[20:23], a[68:71], v[24:39]
v_mfma_f32_32x32x16_bf16 v[24:39], v[20:23], a[72:75], v[24:39]
v_mfma_f32_32x32x16_bf16 v[24:39], v[20:23], a[76:79], v[24:39]
v_mfma_f32_32x32x16_bf16 v[24:39], v[20:23], a[80:83], v[24:39]
v_mfma_f32_32x32x16_bf16 v[24:39], v[20:23], a[84:87], v[24:39]
v_mfma_f32_32x32x16_bf16 v[24:39], v[20:23], a[88:91], v[24:39]
v_mfma_f32_32x32x16_bf16 v[24:39], v[20:23], a[92:95], v[24:39]
v_mfma_f32_32x32x16_bf16 v[24:39], v[20:23], a[96:99], v[24:39]
v_mfma_f32_32x32x16_bf16 v[24:39], v[20:23], a[100:103], v[24:39]
v_mfma_f32_32x32x16_bf16 v[24:39], v[20:23], a[104:107], v[24:39]
v_mfma_f32_32x32x16_bf16 v[24:39], v[20:23], a[108:111], v[24:39]
v_mfma_f32_32x32x16_bf16 v[24:39], v[20:23], a[112:115], v[24:39]
v_mfma_f32_32x32x16_bf16 v[24:39], v[20:23], a[116:119], v[24:39]
v_mfma_f32_32x32x16_bf16 v[24:39], v[20:23], a[120:123], v[24:39]
v_mfma_f32_32x32x16_bf16 v[24:39], v[20:23], a[124:127], v[24:39]
v_mfma_f32_32x32x16_bf16 v[24:39], v[20:23], a[128:131], v[24:39]
v_mfma_f32_32x32x16_bf16 v[24:39], v[20:23], a[132:135], v[24:39]
v_mfma_f32_32x32x16_bf16 v[24:39], v[20:23], a[136:139], v[24:39]
v_mfma_f32_32x32x16_bf16 v[24:39], v[20:23], a[140:143], v[24:39]
v_mfma_f32_32x32x16_bf16 v[24:39], v[20:23], a[144:147], v[24:39]
v_mfma_f32_32x32x16_bf16 v[24:39], v[20:23], a[148:151], v[24:39]
v_mfma_f32_32x32x16_bf16 v[24:39], v[20:23], a[152:155], v[24:39]
v_mfma_f32_32x32x16_bf16 v[24:39], v[20:23], a[156:159], v[24:39]
s_nop 11
v_mov_b32 v5, v24
v_and_b32 v6, 0xf0, v0
s_waitcnt vmcnt(4)
v_bfe_u32 v12, v0, 8, 1
v_lshl_add_u32 v6, v12, 10, v6
v_lshrrev_b32 v12, 9, v0
v_lshl_add_u32 v6, v12, 8, v6
s_lshl_b32 s34, s13, 12
s_add_u32 s34, s34, 2048
s_lshl_b32 s18, s32, 14
s_add_u32 s34, s34, s18
v_bfe_u32 v7, v0, 7, 2
v_mul_u32_u24 v7, 10240, v7
v_bfe_u32 v12, v0, 5, 2
v_lshl_add_u32 v7, v12, 6, v7
v_lshrrev_b32 v12, 9, v0
v_lshl_add_u32 v7, v12, 5, v7
v_and_b32 v12, 16, v0
v_add_u32 v7, v12, v7
v_add_u32 v8, 81920, v0
s_add_u32 s49, s31, 81920
s_lshl_b32 s47, s32, 7
s_add_u32 s47, s47, 4
s_mul_i32 s48, s13, 2560
s_add_u32 s48, s48, 12582912
s_add_u32 s46, s34, 110100480
s_mov_b32 s35, 0
kvlay_22:
s_mul_i32 s26, s16, 6291456
s_add_u32 s26, s26, 88080384
s_add_u32 s26, s26, s31
s_mul_i32 s27, s16, 34603008
s_add_u32 s27, s27, 16777216
s_add_u32 s27, s27, s34
s_lshl_b32 s29, s16, 1
s_add_u32 s29, s29, 1
s_mov_b32 s28, 0
s_cmp_lg_u32 s13, 0
s_cbranch_scc1 polld_28
s_waitcnt vmcnt(0)
v_lshrrev_b32 v16, 2, v0
v_min_u32 v16, 36, v16
s_mov_b32 s21, 8192
s_mov_b32 s17, 0
poll_27:
buffer_load_dword v12, v16, s[4:7], s21 offen offset:0 sc1
s_add_u32 s17, s17, 1
s_cmp_gt_u32 s17, 262144
s_cbranch_scc1 L_fail
s_waitcnt vmcnt(0)
v_cmp_gt_u32 vcc, s29, v12
s_cbranch_vccz polld_28
s_sleep 2
s_branch poll_27
polld_28:
s_barrier
v_xor_b32 v1, 40960, v0
s_mov_b32 s25, s31
s_add_u32 m0, s25, 2048
s_add_u32 s20, s26, 0
buffer_load_dwordx4 v0, s[4:7], s20 offen sc1 lds
s_add_u32 m0, s25, 3072
s_add_u32 s20, s26, 1024
buffer_load_dwordx4 v0, s[4:7], s20 offen sc1 lds
s_add_u32 m0, s25, 4096
s_add_u32 s20, s26, 2048
buffer_load_dwordx4 v0, s[4:7], s20 offen sc1 lds
s_add_u32 m0, s25, 5120
s_add_u32 s20, s26, 3072
buffer_load_dwordx4 v0, s[4:7], s20 offen sc1 lds
s_add_u32 m0, s25, 6144
s_add_u32 s20, s26, 4096
buffer_load_dwordx4 v0, s[4:7], s20 offen sc1 lds
s_add_u32 m0, s25, 7168
s_add_u32 s20, s26, 5120
buffer_load_dwordx4 v0, s[4:7], s20 offen sc1 lds
s_add_u32 m0, s25, 8192
s_add_u32 s20, s26, 6144
buffer_load_dwordx4 v0, s[4:7], s20 offen sc1 lds
s_add_u32 m0, s25, 9216
s_add_u32 s20, s26, 7168
buffer_load_dwordx4 v0, s[4:7], s20 offen sc1 lds
s_add_u32 m0, s25, 10240
s_add_u32 s20, s26, 8192
buffer_load_dwordx4 v0, s[4:7], s20 offen sc1 lds
s_add_u32 m0, s25, 11264
s_add_u32 s20, s26, 9216
buffer_load_dwordx4 v0, s[4:7], s20 offen sc1 lds
s_waitcnt vmcnt(0)
kvx_23:
v_xor_b32 v1, 40960, v1
s_sub_u32 s25, s25, s31
s_xor_b32 s25, s25, 40960
s_add_u32 s25, s25, s31
s_add_u32 s26, s26, 40960
s_cmp_eq_u32 s28, 1
s_cbranch_scc1 kvnom_26
s_cmp_lg_u32 s28, 31
s_cbranch_scc1 kvnop_24
s_add_u32 s29, s29, 1
kvnom_26:
s_waitcnt vmcnt(0)
s_barrier
v_mov_b32 v3, s23
s_mov_b64 exec, 1
buffer_store_dword v3, off, s[4:7], s22 sc1
s_mov_b64 exec, -1
s_mov_b32 s22, s6
s_cmp_lg_u32 s13, 0
s_cbranch_scc1 polld_30
v_min_u32 v16, 624, v0
s_mov_b32 s21, 8192
s_mov_b32 s17, 0
poll_29:
buffer_load_dwordx4 v[12:15], v16, s[4:7], s21 offen offset:0 sc1
s_add_u32 s17, s17, 1
s_cmp_gt_u32 s17, 262144
s_cbranch_scc1 L_fail
s_waitcnt vmcnt(0)
v_min3_u32 v12, v12, v13, v14
v_min_u32 v12, v12, v15
v_cmp_gt_u32 vcc, s29, v12
s_cbranch_vccz polld_30
s_sleep 2
s_branch poll_29
polld_30:
s_barrier
kvnop_24:
s_cmp_eq_u32 s28, 63
s_cselect_b32 s26, s6, s26
s_waitcnt vmcnt(3)
s_barrier
v_add_u32 v2, s31, v1
s_add_u32 m0, s25, 2048
s_add_u32 s20, s26, 0
buffer_load_dwordx4 v0, s[4:7], s20 offen sc1 lds
ds_read_b128 v[60:63], v2 offset:2048
ds_read_b128 v[64:67], v2 offset:3072
ds_read_b128 v[72:75], v2 offset:5120
ds_read_b128 v[36:39], v1 offset:2048
s_add_u32 m0, s25, 3072
s_add_u32 s20, s26, 1024
buffer_load_dwordx4 v0, s[4:7], s20 offen sc1 lds
ds_read_b128 v[68:71], v2 offset:4096
s_add_u32 m0, s25, 4096
s_add_u32 s20, s26, 2048
buffer_load_dwordx4 v0, s[4:7], s20 offen sc1 lds
ds_read_b128 v[44:47], v1 offset:4096
s_add_u32 m0, s25, 5120
s_add_u32 s20, s26, 3072
buffer_load_dwordx4 v0, s[4:7], s20 offen sc1 lds
v_mov_b64 v[52:53], 0
s_waitcnt lgkmcnt(5)
v_dot2c_f32_bf16 v52, s24, v60
v_dot2c_f32_bf16 v53, v60, v60
v_dot2c_f32_bf16 v52, s24, v61
v_dot2c_f32_bf16 v53, v61, v61
v_dot2c_f32_bf16 v52, s24, v62
v_dot2c_f32_bf16 v53, v62, v62
v_dot2c_f32_bf16 v52, s24, v63
v_dot2c_f32_bf16 v53, v63, v63
s_waitcnt lgkmcnt(4)
v_dot2c_f32_bf16 v52, s24, v64
v_dot2c_f32_bf16 v53, v64, v64
v_dot2c_f32_bf16 v52, s24, v65
v_dot2c_f32_bf16 v53, v65, v65
v_dot2c_f32_bf16 v52, s24, v66
v_dot2c_f32_bf16 v53, v66, v66
v_dot2c_f32_bf16 v52, s24, v67
v_dot2c_f32_bf16 v53, v67, v67
s_waitcnt lgkmcnt(1)
ds_read_b128 v[64:67], v2 offset:7168
ds_read_b128 v[60:63], v2 offset:6144
ds_read_b128 v[48:51], v1 offset:5120
v_dot2c_f32_bf16 v52, s24, v68
v_dot2c_f32_bf16 v53, v68, v68
v_dot2c_f32_bf16 v52, s24, v69
v_dot2c_f32_bf16 v53, v69, v69
v_dot2c_f32_bf16 v52, s24, v70
v_dot2c_f32_bf16 v53, v70, v70
v_dot2c_f32_bf16 v52, s24, v71
v_dot2c_f32_bf16 v53, v71, v71
v_dot2c_f32_bf16 v52, s24, v72
v_dot2c_f32_bf16 v53, v72, v72
v_dot2c_f32_bf16 v52, s24, v73
v_dot2c_f32_bf16 v53, v73, v73
v_dot2c_f32_bf16 v52, s24, v74
v_dot2c_f32_bf16 v53, v74, v74
v_dot2c_f32_bf16 v52, s24, v75
v_dot2c_f32_bf16 v53, v75, v75
s_waitcnt lgkmcnt(1)
ds_read_b128 v[72:75], v2 offset:9216
ds_read_b128 v[68:71], v2 offset:8192
ds_read_b128 v[40:43], v1 offset:3072
v_dot2c_f32_bf16 v52, s24, v60
v_dot2c_f32_bf16 v53, v60, v60
v_dot2c_f32_bf16 v52, s24, v61
v_dot2c_f32_bf16 v53, v61, v61
v_dot2c_f32_bf16 v52, s24, v62
v_dot2c_f32_bf16 v53, v62, v62
v_dot2c_f32_bf16 v52, s24, v63
v_dot2c_f32_bf16 v53, v63, v63
v_dot2c_f32_bf16 v52, s24, v64
v_dot2c_f32_bf16 v53, v64, v64
v_dot2c_f32_bf16 v52, s24, v65
v_dot2c_f32_bf16 v53, v65, v65
v_dot2c_f32_bf16 v52, s24, v66
v_dot2c_f32_bf16 v53, v66, v66
v_dot2c_f32_bf16 v52, s24, v67
v_dot2c_f32_bf16 v53, v67, v67
s_waitcnt lgkmcnt(1)
ds_read_b128 v[64:67], v2 offset:11264
ds_read_b128 v[60:63], v2 offset:10240
s_add_u32 m0, s25, 6144
s_add_u32 s20, s26, 4096
buffer_load_dwordx4 v0, s[4:7], s20 offen sc1 lds
v_dot2c_f32_bf16 v52, s24, v68
v_dot2c_f32_bf16 v53, v68, v68
v_dot2c_f32_bf16 v52, s24, v69
v_dot2c_f32_bf16 v53, v69, v69
v_dot2c_f32_bf16 v52, s24, v70
v_dot2c_f32_bf16 v53, v70, v70
v_dot2c_f32_bf16 v52, s24, v71
v_dot2c_f32_bf16 v53, v71, v71
v_dot2c_f32_bf16 v52, s24, v72
v_dot2c_f32_bf16 v53, v72, v72
v_dot2c_f32_bf16 v52, s24, v73
v_dot2c_f32_bf16 v53, v73, v73
v_dot2c_f32_bf16 v52, s24, v74
v_dot2c_f32_bf16 v53, v74, v74
v_dot2c_f32_bf16 v52, s24, v75
s_waitcnt lgkmcnt(0)
v_dot2c_f32_bf16 v53, v75, v75
v_dot2c_f32_bf16 v52, s24, v60
v_dot2c_f32_bf16 v53, v60, v60
v_dot2c_f32_bf16 v52, s24, v61
v_dot2c_f32_bf16 v53, v61, v61
v_dot2c_f32_bf16 v52, s24, v62
v_dot2c_f32_bf16 v53, v62, v62
v_dot2c_f32_bf16 v52, s24, v63
v_dot2c_f32_bf16 v53, v63, v63
v_dot2c_f32_bf16 v52, s24, v64
v_dot2c_f32_bf16 v53, v64, v64
v_dot2c_f32_bf16 v52, s24, v65
v_dot2c_f32_bf16 v53, v65, v65
v_dot2c_f32_bf16 v52, s24, v66
v_dot2c_f32_bf16 v53, v66, v66
v_dot2c_f32_bf16 v52, s24, v67
v_dot2c_f32_bf16 v53, v67, v67
v_mfma_f32_32x32x16_bf16 v[20:35], v[36:39], a[0:3], 0
s_add_u32 m0, s25, 7168
s_add_u32 s20, s26, 5120
buffer_load_dwordx4 v0, s[4:7], s20 offen sc1 lds
ds_read_b128 v[36:39], v1 offset:6144
v_mfma_f32_32x32x16_bf16 v[20:35], v[40:43], a[4:7], v[20:35]
ds_read_b128 v[40:43], v1 offset:7168
s_add_u32 m0, s25, 8192
s_add_u32 s20, s26, 6144
buffer_load_dwordx4 v0, s[4:7], s20 offen sc1 lds
v_mfma_f32_32x32x16_bf16 v[20:35], v[44:47], a[8:11], v[20:35]
ds_read_b128 v[44:47], v1 offset:8192
v_mfma_f32_32x32x16_bf16 v[20:35], v[48:51], a[12:15], v[20:35]
s_waitcnt lgkmcnt(2)
ds_read_b128 v[48:51], v1 offset:9216
v_mfma_f32_32x32x16_bf16 v[20:35], v[36:39], a[16:19], v[20:35]
s_waitcnt lgkmcnt(1)
s_add_u32 m0, s25, 9216
s_add_u32 s20, s26, 7168
buffer_load_dwordx4 v0, s[4:7], s20 offen sc1 lds
v_mfma_f32_32x32x16_bf16 v[20:35], v[40:43], a[20:23], v[20:35]
s_waitcnt lgkmcnt(0)
ds_read_b128 v[36:39], v1 offset:10240
v_permlane32_swap_b32 v52, v53
v_mfma_f32_32x32x16_bf16 v[20:35], v[44:47], a[24:27], v[20:35]
ds_read_b128 v[40:43], v1 offset:11264
s_add_u32 m0, s25, 10240
s_add_u32 s20, s26, 8192
buffer_load_dwordx4 v0, s[4:7], s20 offen sc1 lds
v_mfma_f32_32x32x16_bf16 v[20:35], v[48:51], a[28:31], v[20:35]
ds_read_b128 v[44:47], v1 offset:12288
s_waitcnt lgkmcnt(2)
v_mfma_f32_32x32x16_bf16 v[20:35], v[36:39], a[32:35], v[20:35]
ds_read_b128 v[48:51], v1 offset:13312
s_waitcnt lgkmcnt(2)
ds_read_b128 v[36:39], v1 offset:14336
v_mfma_f32_32x32x16_bf16 v[20:35], v[40:43], a[36:39], v[20:35]
s_add_u32 m0, s25, 11264
s_add_u32 s20, s26, 9216
buffer_load_dwordx4 v0, s[4:7], s20 offen sc1 lds
v_add_f32 v52, v52, v53
s_waitcnt lgkmcnt(2)
ds_read_b128 v[40:43], v1 offset:15360
v_mfma_f32_32x32x16_bf16 v[20:35], v[44:47], a[40:43], v[20:35]
s_waitcnt lgkmcnt(2)
ds_read_b128 v[44:47], v1 offset:16384
s_waitcnt lgkmcnt(2)
v_mfma_f32_32x32x16_bf16 v[20:35], v[48:51], a[44:47], v[20:35]
ds_read_b128 v[48:51], v1 offset:17408
v_lshl_add_u32 v53, s13, 2, v0
s_waitcnt lgkmcnt(2)
v_mfma_f32_32x32x16_bf16 v[20:35], v[36:39], a[48:51], v[20:35]
v_mfma_f32_32x32x16_bf16 v[20:35], v[40:43], a[52:55], v[20:35]
ds_read_b128 v[36:39], v1 offset:18432
s_waitcnt lgkmcnt(2)
ds_write_b32 v53, v52 offset:0
ds_read_b128 v[40:43], v1 offset:19456
v_mfma_f32_32x32x16_bf16 v[20:35], v[44:47], a[56:59], v[20:35]
s_waitcnt lgkmcnt(3)
ds_read_b128 v[44:47], v1 offset:20480
v_and_b32 v2, 0x1ff, v0
v_mfma_f32_32x32x16_bf16 v[20:35], v[48:51], a[60:63], v[20:35]
s_waitcnt lgkmcnt(3)
v_mov_b32 v3, s23
ds_read_b128 v[48:51], v1 offset:21504
s_waitcnt lgkmcnt(3)
v_mfma_f32_32x32x16_bf16 v[20:35], v[36:39], a[64:67], v[20:35]
s_waitcnt lgkmcnt(2)
ds_read_b128 v[36:39], v1 offset:22528
v_mfma_f32_32x32x16_bf16 v[20:35], v[40:43], a[68:71], v[20:35]
s_waitcnt lgkmcnt(1)
v_mfma_f32_32x32x16_bf16 v[20:35], v[44:47], a[72:75], v[20:35]
s_waitcnt lgkmcnt(0)
ds_read_b128 v[44:47], v1 offset:24576
ds_read_b128 v[40:43], v1 offset:23552
v_mfma_f32_32x32x16_bf16 v[20:35], v[48:51], a[76:79], v[20:35]
ds_read_b128 v[48:51], v1 offset:25600
s_waitcnt vmcnt(10)
s_barrier
ds_read_b128 v[52:55], v2 offset:0
v_mfma_f32_32x32x16_bf16 v[20:35], v[36:39], a[80:83], v[20:35]
s_mov_b64 exec, 1
buffer_store_dword v3, off, s[4:7], s22 sc1
s_mov_b64 exec, -1
ds_read_b128 v[56:59], v2 offset:512
s_waitcnt lgkmcnt(3)
v_mfma_f32_32x32x16_bf16 v[20:35], v[40:43], a[84:87], v[20:35]
ds_read_b128 v[36:39], v1 offset:26624
ds_read_b128 v[40:43], v1 offset:27648
v_mfma_f32_32x32x16_bf16 v[20:35], v[44:47], a[88:91], v[20:35]
s_waitcnt lgkmcnt(3)
ds_read_b128 v[44:47], v1 offset:28672
v_add_f32 v52, v52, v53
s_waitcnt lgkmcnt(3)
v_add_f32 v56, v56, v57
v_mfma_f32_32x32x16_bf16 v[20:35], v[48:51], a[92:95], v[20:35]
ds_read_b128 v[48:51], v1 offset:29696
s_waitcnt lgkmcnt(3)
v_add_f32 v58, v58, v59
s_waitcnt lgkmcnt(2)
v_mfma_f32_32x32x16_bf16 v[20:35], v[36:39], a[96:99], v[20:35]
v_add_f32 v54, v54, v55
v_add_f32 v56, v56, v58
v_add_f32 v52, v52, v54
s_waitcnt lgkmcnt(1)
v_mul_f32 v52, 0x3acccccd, v52
v_mul_f32 v56, 0x3acccccd, v56
v_mfma_f32_32x32x16_bf16 v[20:35], v[40:43], a[100:103], v[20:35]
s_waitcnt lgkmcnt(0)
ds_read_b128 v[40:43], v1 offset:31744
ds_read_b128 v[36:39], v1 offset:30720
v_bfe_u32 v54, v0, 5, 5
v_fma_f32 v56, -v52, v52, v56
v_max_f32 v56, 0, v56
v_mfma_f32_32x32x16_bf16 v[20:35], v[44:47], a[104:107], v[20:35]
ds_read_b128 v[44:47], v1 offset:32768
v_and_b32 v54, 16, v54
v_add_f32 v56, 0x3727c5ac, v56
v_lshrrev_b32 v53, 2, v0
v_rsq_f32 v56, v56
v_mfma_f32_32x32x16_bf16 v[20:35], v[48:51], a[108:111], v[20:35]
s_waitcnt lgkmcnt(2)
ds_read_b128 v[48:51], v1 offset:33792
v_mul_f32 v52, v56, v52
v_lshl_add_u32 v53, s13, 8, v53
s_waitcnt lgkmcnt(2)
v_mfma_f32_32x32x16_bf16 v[20:35], v[36:39], a[112:115], v[20:35]
s_waitcnt lgkmcnt(1)
ds_read_b128 v[36:39], v1 offset:34816
v_lshl_add_u32 v54, s13, 8, v54
v_permlane32_swap_b32 v56, v52
v_mfma_f32_32x32x16_bf16 v[20:35], v[40:43], a[116:119], v[20:35]
ds_write_b32 v53, v56 offset:1024
ds_read_b128 v[40:43], v1 offset:35840
ds_read_b128 v[72:75], v54 offset:1120
s_waitcnt lgkmcnt(4)
ds_read_b128 v[80:83], v54 offset:1184
v_mfma_f32_32x32x16_bf16 v[20:35], v[44:47], a[120:123], v[20:35]
ds_read_b128 v[44:47], v1 offset:36864
s_waitcnt lgkmcnt(5)
v_mfma_f32_32x32x16_bf16 v[20:35], v[48:51], a[124:127], v[20:35]
ds_read_b128 v[88:91], v54 offset:1248
ds_read_b128 v[48:51], v1 offset:37888
ds_read_b128 v[84:87], v54 offset:1216
v_mfma_f32_32x32x16_bf16 v[20:35], v[36:39], a[128:131], v[20:35]
s_waitcnt lgkmcnt(6)
v_mfma_f32_32x32x16_bf16 v[20:35], v[40:43], a[132:135], v[20:35]
ds_read_b128 v[76:79], v54 offset:1152
ds_read_b128 v[36:39], v1 offset:38912
ds_read_b128 v[40:43], v1 offset:39936
s_waitcnt lgkmcnt(7)
s_waitcnt lgkmcnt(6)
v_mfma_f32_32x32x16_bf16 v[20:35], v[44:47], a[136:139], v[20:35]
s_waitcnt lgkmcnt(4)
v_mul_f32 v83, v83, v5
ds_read_b128 v[44:47], v1 offset:40960
v_mfma_f32_32x32x16_bf16 v[20:35], v[48:51], a[140:143], v[20:35]
ds_read_b128 v[68:71], v54 offset:1088
v_mul_f32 v91, v91, v5
s_waitcnt lgkmcnt(4)
s_waitcnt lgkmcnt(3)
ds_read_b128 v[60:63], v54 offset:1024
v_mfma_f32_32x32x16_bf16 v[20:35], v[36:39], a[144:147], v[20:35]
ds_read_b128 v[48:51], v1 offset:41984
v_mul_f32 v90, v90, v5
v_mul_f32 v76, v76, v5
v_mul_f32 v78, v78, v5
v_mul_f32 v82, v82, v5
s_waitcnt lgkmcnt(3)
v_mfma_f32_32x32x16_bf16 v[20:35], v[40:43], a[148:151], v[20:35]
v_mul_f32 v86, v86, v5
v_mul_f32 v84, v84, v5
ds_read_b128 v[64:67], v54 offset:1056
v_mfma_f32_32x32x16_bf16 v[20:35], v[44:47], a[152:155], v[20:35]
v_mul_f32 v87, v87, v5
s_waitcnt lgkmcnt(3)
v_mul_f32 v77, v77, v5
s_waitcnt lgkmcnt(1)
v_mul_f32 v80, v80, v5
v_mul_f32 v81, v81, v5
v_mfma_f32_32x32x16_bf16 v[20:35], v[48:51], a[156:159], v[20:35]
s_nop 0
v_mul_f32 v88, v88, v5
s_nop 2
s_waitcnt lgkmcnt(0)
v_mul_f32 v89, v89, v5
v_mul_f32 v79, v79, v5
s_nop 3
v_fma_f32 v26, v26, v66, -v82
v_fma_f32 v28, v28, v68, -v84
v_fma_f32 v25, v25, v65, -v81
v_fma_f32 v33, v33, v73, -v89
v_fma_f32 v23, v23, v63, -v79
v_fma_f32 v21, v21, v61, -v77
v_fma_f32 v27, v27, v67, -v83
v_fma_f32 v32, v32, v72, -v88
v_fma_f32 v24, v24, v64, -v80
v_mul_f32 v85, v85, v5
v_fma_f32 v29, v29, v69, -v85
v_fma_f32 v30, v30, v70, -v86
v_fma_f32 v20, v20, v60, -v76
v_fma_f32 v34, v34, v74, -v90
v_fma_f32 v35, v35, v75, -v91
v_cvt_pk_bf16_f32 v38, v24, v25
v_cvt_pk_bf16_f32 v39, v26, v27
v_fma_f32 v22, v22, v62, -v78
v_fma_f32 v31, v31, v71, -v87
v_cvt_pk_bf16_f32 v36, v20, v21
v_cvt_pk_bf16_f32 v40, v28, v29
v_cvt_pk_bf16_f32 v43, v34, v35
v_cvt_pk_bf16_f32 v42, v32, v33
v_cvt_pk_bf16_f32 v37, v22, v23
v_cvt_pk_bf16_f32 v41, v30, v31
buffer_store_dwordx4 v[36:39], v6, s[4:7], s27 offen offset:0 sc1
buffer_store_dwordx4 v[40:43], v6, s[4:7], s27 offen offset:512 sc1
s_add_u32 s28, s28, 1
s_lshl_b32 s18, s16, 6
s_add_u32 s18, s18, s28
s_add_u32 s27, s27, 524288
s_cmp_eq_u32 s13, 0
s_cselect_b32 s22, s47, s6
s_mov_b32 s23, s18
s_cmp_lg_u32 s28, 1
s_cbranch_scc1 mk_31
mk_31:
s_cmp_lg_u32 s28, 2
s_cbranch_scc1 mk_32
mk_32:
s_cmp_lg_u32 s28, 3
s_cbranch_scc1 mk_33
mk_33:
s_cmp_lg_u32 s28, 11
s_cbranch_scc1 mk_34
mk_34:
s_and_b32 s18, s28, 3
s_cbranch_scc1 kvx_23
s_cmp_lt_u32 s28, 12
s_cbranch_scc1 kvx_23
kvm_25:
s_waitcnt vmcnt(0)
s_barrier
v_mov_b32 v3, s23
s_mov_b64 exec, 1
buffer_store_dword v3, off, s[4:7], s22 sc1
s_mov_b64 exec, -1
s_mov_b32 s22, s6
s_add_u32 s35, s35, 1
s_lshl_b32 s30, s35, 2
s_cmp_lg_u32 s13, 0
s_cbranch_scc1 polld_36
v_lshrrev_b32 v16, 2, v0
v_min_u32 v16, 36, v16
s_mov_b32 s21, 4096
s_mov_b32 s17, 0
poll_35:
buffer_load_dword v12, v16, s[4:7], s21 offen offset:0 sc1
s_add_u32 s17, s17, 1
s_cmp_gt_u32 s17, 262144
s_cbranch_scc1 L_fail
s_waitcnt vmcnt(0)
v_cmp_gt_u32 vcc, s30, v12
s_cbranch_vccz polld_36
s_sleep 2
s_branch poll_35
polld_36:
s_barrier
s_add_u32 m0, s49, 2048
s_add_u32 s20, s48, 0
buffer_load_dwordx4 v7, s[4:7], s20 offen sc1 lds
s_add_u32 m0, s49, 3072
s_add_u32 s20, s48, 256
buffer_load_dwordx4 v7, s[4:7], s20 offen sc1 lds
s_add_u32 m0, s49, 4096
s_add_u32 s20, s48, 512
buffer_load_dwordx4 v7, s[4:7], s20 offen sc1 lds
s_add_u32 m0, s49, 5120
s_add_u32 s20, s48, 768
buffer_load_dwordx4 v7, s[4:7], s20 offen sc1 lds
s_add_u32 m0, s49, 6144
s_add_u32 s20, s48, 1024
buffer_load_dwordx4 v7, s[4:7], s20 offen sc1 lds
s_add_u32 m0, s49, 7168
s_add_u32 s20, s48, 1280
buffer_load_dwordx4 v7, s[4:7], s20 offen sc1 lds
s_add_u32 m0, s49, 8192
s_add_u32 s20, s48, 1536
buffer_load_dwordx4 v7, s[4:7], s20 offen sc1 lds
s_add_u32 m0, s49, 9216
s_add_u32 s20, s48, 1792
buffer_load_dwordx4 v7, s[4:7], s20 offen sc1 lds
s_add_u32 m0, s49, 10240
s_add_u32 s20, s48, 2048
buffer_load_dwordx4 v7, s[4:7], s20 offen sc1 lds
s_add_u32 m0, s49, 11264
s_add_u32 s20, s48, 2304
buffer_load_dwordx4 v7, s[4:7], s20 offen sc1 lds
s_waitcnt vmcnt(0)
s_barrier
ds_read_b128 v[36:39], v8 offset:2048
ds_read_b128 v[40:43], v8 offset:3072
ds_read_b128 v[44:47], v8 offset:4096
ds_read_b128 v[48:51], v8 offset:5120
s_waitcnt lgkmcnt(3)
v_mfma_f32_32x32x16_bf16 v[20:35], v[36:39], a[0:3], 0
ds_read_b128 v[36:39], v8 offset:6144
s_waitcnt lgkmcnt(3)
v_mfma_f32_32x32x16_bf16 v[20:35], v[40:43], a[4:7], v[20:35]
s_waitcnt lgkmcnt(2)
ds_read_b128 v[40:43], v8 offset:7168
v_mfma_f32_32x32x16_bf16 v[20:35], v[44:47], a[8:11], v[20:35]
s_waitcnt lgkmcnt(2)
ds_read_b128 v[44:47], v8 offset:8192
v_mfma_f32_32x32x16_bf16 v[20:35], v[48:51], a[12:15], v[20:35]
s_waitcnt lgkmcnt(2)
ds_read_b128 v[48:51], v8 offset:9216
v_mfma_f32_32x32x16_bf16 v[20:35], v[36:39], a[16:19], v[20:35]
s_waitcnt lgkmcnt(2)
ds_read_b128 v[36:39], v8 offset:10240
v_mfma_f32_32x32x16_bf16 v[20:35], v[40:43], a[20:23], v[20:35]
s_waitcnt lgkmcnt(2)
ds_read_b128 v[40:43], v8 offset:11264
v_mfma_f32_32x32x16_bf16 v[20:35], v[44:47], a[24:27], v[20:35]
s_waitcnt lgkmcnt(2)
ds_read_b128 v[44:47], v8 offset:12288
v_mfma_f32_32x32x16_bf16 v[20:35], v[48:51], a[28:31], v[20:35]
s_waitcnt lgkmcnt(2)
ds_read_b128 v[48:51], v8 offset:13312
v_mfma_f32_32x32x16_bf16 v[20:35], v[36:39], a[32:35], v[20:35]
s_waitcnt lgkmcnt(2)
ds_read_b128 v[36:39], v8 offset:14336
v_mfma_f32_32x32x16_bf16 v[20:35], v[40:43], a[36:39], v[20:35]
s_waitcnt lgkmcnt(2)
ds_read_b128 v[40:43], v8 offset:15360
v_mfma_f32_32x32x16_bf16 v[20:35], v[44:47], a[40:43], v[20:35]
s_waitcnt lgkmcnt(2)
ds_read_b128 v[44:47], v8 offset:16384
v_mfma_f32_32x32x16_bf16 v[20:35], v[48:51], a[44:47], v[20:35]
s_waitcnt lgkmcnt(2)
ds_read_b128 v[48:51], v8 offset:17408
v_mfma_f32_32x32x16_bf16 v[20:35], v[36:39], a[48:51], v[20:35]
s_waitcnt lgkmcnt(2)
ds_read_b128 v[36:39], v8 offset:18432
v_mfma_f32_32x32x16_bf16 v[20:35], v[40:43], a[52:55], v[20:35]
s_waitcnt lgkmcnt(2)
ds_read_b128 v[40:43], v8 offset:19456
v_mfma_f32_32x32x16_bf16 v[20:35], v[44:47], a[56:59], v[20:35]
s_waitcnt lgkmcnt(2)
ds_read_b128 v[44:47], v8 offset:20480
v_mfma_f32_32x32x16_bf16 v[20:35], v[48:51], a[60:63], v[20:35]
s_waitcnt lgkmcnt(2)
ds_read_b128 v[48:51], v8 offset:21504
v_mfma_f32_32x32x16_bf16 v[20:35], v[36:39], a[64:67], v[20:35]
s_waitcnt lgkmcnt(2)
ds_read_b128 v[36:39], v8 offset:22528
v_mfma_f32_32x32x16_bf16 v[20:35], v[40:43], a[68:71], v[20:35]
s_waitcnt lgkmcnt(2)
ds_read_b128 v[40:43], v8 offset:23552
v_mfma_f32_32x32x16_bf16 v[20:35], v[44:47], a[72:75], v[20:35]
s_waitcnt lgkmcnt(2)
ds_read_b128 v[44:47], v8 offset:24576
v_mfma_f32_32x32x16_bf16 v[20:35], v[48:51], a[76:79], v[20:35]
s_waitcnt lgkmcnt(2)
ds_read_b128 v[48:51], v8 offset:25600
v_mfma_f32_32x32x16_bf16 v[20:35], v[36:39], a[80:83], v[20:35]
s_waitcnt lgkmcnt(2)
ds_read_b128 v[36:39], v8 offset:26624
v_mfma_f32_32x32x16_bf16 v[20:35], v[40:43], a[84:87], v[20:35]
s_waitcnt lgkmcnt(2)
ds_read_b128 v[40:43], v8 offset:27648
v_mfma_f32_32x32x16_bf16 v[20:35], v[44:47], a[88:91], v[20:35]
s_waitcnt lgkmcnt(2)
ds_read_b128 v[44:47], v8 offset:28672
v_mfma_f32_32x32x16_bf16 v[20:35], v[48:51], a[92:95], v[20:35]
s_waitcnt lgkmcnt(2)
ds_read_b128 v[48:51], v8 offset:29696
v_mfma_f32_32x32x16_bf16 v[20:35], v[36:39], a[96:99], v[20:35]
s_waitcnt lgkmcnt(2)
ds_read_b128 v[36:39], v8 offset:30720
v_mfma_f32_32x32x16_bf16 v[20:35], v[40:43], a[100:103], v[20:35]
s_waitcnt lgkmcnt(2)
ds_read_b128 v[40:43], v8 offset:31744
v_mfma_f32_32x32x16_bf16 v[20:35], v[44:47], a[104:107], v[20:35]
s_waitcnt lgkmcnt(2)
ds_read_b128 v[44:47], v8 offset:32768
v_mfma_f32_32x32x16_bf16 v[20:35], v[48:51], a[108:111], v[20:35]
s_waitcnt lgkmcnt(2)
ds_read_b128 v[48:51], v8 offset:33792
v_mfma_f32_32x32x16_bf16 v[20:35], v[36:39], a[112:115], v[20:35]
s_waitcnt lgkmcnt(2)
ds_read_b128 v[36:39], v8 offset:34816
v_mfma_f32_32x32x16_bf16 v[20:35], v[40:43], a[116:119], v[20:35]
s_waitcnt lgkmcnt(2)
ds_read_b128 v[40:43], v8 offset:35840
v_mfma_f32_32x32x16_bf16 v[20:35], v[44:47], a[120:123], v[20:35]
s_waitcnt lgkmcnt(2)
ds_read_b128 v[44:47], v8 offset:36864
v_mfma_f32_32x32x16_bf16 v[20:35], v[48:51], a[124:127], v[20:35]
s_waitcnt lgkmcnt(2)
ds_read_b128 v[48:51], v8 offset:37888
v_mfma_f32_32x32x16_bf16 v[20:35], v[36:39], a[128:131], v[20:35]
s_waitcnt lgkmcnt(2)
ds_read_b128 v[36:39], v8 offset:38912
v_mfma_f32_32x32x16_bf16 v[20:35], v[40:43], a[132:135], v[20:35]
s_waitcnt lgkmcnt(2)
ds_read_b128 v[40:43], v8 offset:39936
v_mfma_f32_32x32x16_bf16 v[20:35], v[44:47], a[136:139], v[20:35]
s_waitcnt lgkmcnt(2)
ds_read_b128 v[44:47], v8 offset:40960
v_mfma_f32_32x32x16_bf16 v[20:35], v[48:51], a[140:143], v[20:35]
s_waitcnt lgkmcnt(2)
ds_read_b128 v[48:51], v8 offset:41984
v_mfma_f32_32x32x16_bf16 v[20:35], v[36:39], a[144:147], v[20:35]
s_waitcnt lgkmcnt(2)
v_mfma_f32_32x32x16_bf16 v[20:35], v[40:43], a[148:151], v[20:35]
s_waitcnt lgkmcnt(1)
v_mfma_f32_32x32x16_bf16 v[20:35], v[44:47], a[152:155], v[20:35]
s_waitcnt lgkmcnt(0)
v_mfma_f32_32x32x16_bf16 v[20:35], v[48:51], a[156:159], v[20:35]
s_nop 11
v_cvt_pk_bf16_f32 v36, v20, v21
v_cvt_pk_bf16_f32 v37, v22, v23
v_cvt_pk_bf16_f32 v38, v24, v25
v_cvt_pk_bf16_f32 v39, v26, v27
v_cvt_pk_bf16_f32 v40, v28, v29
v_cvt_pk_bf16_f32 v41, v30, v31
v_cvt_pk_bf16_f32 v42, v32, v33
v_cvt_pk_bf16_f32 v43, v34, v35
buffer_store_dwordx4 v[36:39], v6, s[4:7], s46 offen offset:0 sc1
buffer_store_dwordx4 v[40:43], v6, s[4:7], s46 offen offset:512 sc1
s_add_u32 s48, s48, 40960
s_add_u32 s46, s46, 524288
s_add_u32 s18, s47, 8
s_cmp_eq_u32 s13, 0
s_cselect_b32 s22, s18, s6
s_mov_b32 s23, s35
s_cmp_lt_u32 s28, 64
s_cbranch_scc1 kvx_23
s_and_b32 s18, s35, 15
s_cbranch_scc1 kvm_25
s_waitcnt vmcnt(0)
s_barrier
v_mov_b32 v3, s23
s_mov_b64 exec, 1
buffer_store_dword v3, off, s[4:7], s22 sc1
s_mov_b64 exec, -1
s_mov_b32 s22, s6
s_add_u32 s16, s16, 1
s_cmp_lt_u32 s16, 2
s_cbranch_scc1 kvlay_22
s_endpgm
roleA_6:
s_sub_u32 s35, s15, 64
s_mul_i32 s46, s35, 13108
s_lshr_b32 s46, s46, 16
s_mul_i32 s18, s46, 5
s_sub_u32 s34, s35, s18
v_bfe_u32 v5, v0, 4, 5
v_mul_u32_u24 v5, 1280, v5
v_lshrrev_b32 v8, 9, v0
v_lshl_add_u32 v5, v8, 4, v5
v_and_b32 v6, 0x1ff, v0
v_lshlrev_b32 v6, 1, v6
v_lshl_add_u32 v6, v8, 4, v6
s_load_dwordx2 s[40:41], s[0:1], 0
s_mov_b32 s42, 2621440
s_mov_b32 s43, 0x20000
s_waitcnt lgkmcnt(0)
s_load_dwordx2 s[36:37], s[0:1], 8
s_mov_b32 s38, 1314816
s_mov_b32 s39, 0x20000
s_waitcnt lgkmcnt(0)
s_load_dwordx2 s[48:49], s[0:1], 16
s_mov_b32 s50, 1314816
s_mov_b32 s51, 0x20000
s_waitcnt lgkmcnt(0)
v_lshrrev_b32 v8, 7, v0
v_lshl_add_u32 v8, s13, 3, v8
v_bfe_u32 v9, v8, 1, 3
v_lshlrev_b32 v9, 4, v9
v_xor_b32 v9, v9, v0
v_and_b32 v9, 0x70, v9
v_mul_u32_u24 v8, 1280, v8
v_add_u32 v8, v8, v9
s_mul_i32 s26, s46, 40960
s_lshl_b32 s25, s13, 10
s_add_u32 m0, s25, 2048
s_add_u32 s20, s26, 0
buffer_load_dwordx4 v8, s[40:43], s20 offen sc1 lds
s_add_u32 m0, s25, 6144
s_add_u32 s20, s26, 128
buffer_load_dwordx4 v8, s[40:43], s20 offen sc1 lds
s_add_u32 m0, s25, 10240
s_add_u32 s20, s26, 256
buffer_load_dwordx4 v8, s[40:43], s20 offen sc1 lds
s_add_u32 m0, s25, 14336
s_add_u32 s20, s26, 384
buffer_load_dwordx4 v8, s[40:43], s20 offen sc1 lds
s_add_u32 m0, s25, 18432
s_add_u32 s20, s26, 512
buffer_load_dwordx4 v8, s[40:43], s20 offen sc1 lds
s_add_u32 m0, s25, 22528
s_add_u32 s20, s26, 640
buffer_load_dwordx4 v8, s[40:43], s20 offen sc1 lds
s_add_u32 m0, s25, 26624
s_add_u32 s20, s26, 768
buffer_load_dwordx4 v8, s[40:43], s20 offen sc1 lds
s_add_u32 m0, s25, 30720
s_add_u32 s20, s26, 896
buffer_load_dwordx4 v8, s[40:43], s20 offen sc1 lds
s_add_u32 m0, s25, 34816
s_add_u32 s20, s26, 1024
buffer_load_dwordx4 v8, s[40:43], s20 offen sc1 lds
s_add_u32 m0, s25, 38912
s_add_u32 s20, s26, 1152
buffer_load_dwordx4 v8, s[40:43], s20 offen sc1 lds
s_add_u32 s26, s26, 1310720
s_add_u32 s25, s25, 40960
v_bfe_u32 v1, v0, 4, 4
v_and_b32 v9, 0x300, v0
v_add_u32 v1, v1, v9
v_lshl_add_u32 v1, s13, 4, v1
v_mul_u32_u24 v1, 642, v1
s_lshl_b32 s30, s35, 2
s_add_u32 s30, s30, 2
s_lshl_b32 s18, s13, 12
s_add_u32 s18, s18, 147456
s_waitcnt vmcnt(10)
v_add_u32 v4, s18, v0
v_bfe_u32 v176, v0, 5, 3
v_lshrrev_b32 v9, 9, v0
v_xor_b32 v176, v176, v9
v_lshlrev_b32 v176, 4, v176
v_and_b32 v9, 0x1f0, v0
v_lshl_add_u32 v176, v9, 3, v176
v_xor_b32 v177, 32, v176
v_xor_b32 v178, 64, v176
v_xor_b32 v179, 96, v176
s_lshl_b32 s18, s34, 7
s_lshl_b32 s19, s13, 5
s_add_u32 s18, s18, s19
s_mov_b32 s19, 0x3acccccd
v_bfe_u32 v202, v0, 4, 5
v_lshrrev_b32 v197, 9, v0
v_add_u32 v202, s18, v202
v_and_b32 v201, 1, v202
v_mul_u32_u24 v201, 160, v201
v_lshrrev_b32 v200, 1, v202
v_add_u32 v200, 1, v200
v_lshlrev_b32 v197, 3, v197
v_mad_u32_u24 v201, v197, v200, v201
v_mad_u32_u24 v196, v200, 16, 0
v_cvt_f32_u32 v196, v196
v_mul_f32 v202, s19, v196
v_rndne_f32 v202, v202
v_fmac_f32 v196, 0xc4200000, v202
v_mul_f32 v196, s19, v196
v_cos_f32 v196, v196
s_nop 0
v_add_f32 v196, v196, v196
v_mad_u32_u24 v198, v200, 1, 0
v_cvt_f32_u32 v198, v198
v_mul_f32 v202, s19, v198
v_rndne_f32 v202, v202
v_fmac_f32 v198, 0xc4200000, v202
v_mul_f32 v198, s19, v198
v_cos_f32 v198, v198
s_nop 0
v_add_f32 v198, v198, v198
v_mad_u32_u24 v183, v200, 3, v201
v_cvt_f32_u32 v183, v183
v_mul_f32 v202, s19, v183
v_rndne_f32 v202, v202
v_fmac_f32 v183, 0xc4200000, v202
v_mul_f32 v183, s19, v183
v_cos_f32 v183, v183
v_mad_u32_u24 v184, v200, 4, v201
v_cvt_f32_u32 v184, v184
v_mul_f32 v202, s19, v184
v_rndne_f32 v202, v202
v_fmac_f32 v184, 0xc4200000, v202
v_mul_f32 v184, s19, v184
v_cos_f32 v184, v184
s_nop 0
v_fma_f32 v185, v198, v184, -v183
v_fma_f32 v182, v198, v183, -v184
v_fma_f32 v186, v198, v185, -v184
v_fma_f32 v181, v198, v182, -v183
v_fma_f32 v187, v198, v186, -v185
v_fma_f32 v180, v198, v181, -v182
v_cvt_pk_bf16_f32 v16, v180, v181
v_cvt_pk_bf16_f32 v17, v182, v183
v_cvt_pk_bf16_f32 v18, v184, v185
v_cvt_pk_bf16_f32 v19, v186, v187
v_mad_u32_u24 v191, v200, 19, v201
v_cvt_f32_u32 v191, v191
v_mul_f32 v202, s19, v191
v_rndne_f32 v202, v202
v_fmac_f32 v191, 0xc4200000, v202
v_mul_f32 v191, s19, v191
v_cos_f32 v191, v191
v_mad_u32_u24 v192, v200, 20, v201
v_cvt_f32_u32 v192, v192
v_mul_f32 v202, s19, v192
v_rndne_f32 v202, v202
v_fmac_f32 v192, 0xc4200000, v202
v_mul_f32 v192, s19, v192
v_cos_f32 v192, v192
s_nop 0
v_fma_f32 v193, v198, v192, -v191
v_fma_f32 v190, v198, v191, -v192
v_fma_f32 v194, v198, v193, -v192
v_fma_f32 v189, v198, v190, -v191
v_fma_f32 v195, v198, v194, -v193
v_fma_f32 v188, v198, v189, -v190
v_cvt_pk_bf16_f32 v20, v188, v189
v_cvt_pk_bf16_f32 v21, v190, v191
v_cvt_pk_bf16_f32 v22, v192, v193
v_cvt_pk_bf16_f32 v23, v194, v195
v_pk_fma_f32 v[180:181], v[196:197], v[188:189], v[180:181] op_sel_hi:[0,1,1] neg_lo:[0,0,1] neg_hi:[0,0,1]
v_pk_fma_f32 v[182:183], v[196:197], v[190:191], v[182:183] op_sel_hi:[0,1,1] neg_lo:[0,0,1] neg_hi:[0,0,1]
v_pk_fma_f32 v[184:185], v[196:197], v[192:193], v[184:185] op_sel_hi:[0,1,1] neg_lo:[0,0,1] neg_hi:[0,0,1]
v_pk_fma_f32 v[186:187], v[196:197], v[194:195], v[186:187] op_sel_hi:[0,1,1] neg_lo:[0,0,1] neg_hi:[0,0,1]
v_cvt_pk_bf16_f32 v24, v180, v181
v_cvt_pk_bf16_f32 v25, v182, v183
v_cvt_pk_bf16_f32 v26, v184, v185
v_cvt_pk_bf16_f32 v27, v186, v187
v_pk_fma_f32 v[188:189], v[196:197], v[180:181], v[188:189] op_sel_hi:[0,1,1] neg_lo:[0,0,1] neg_hi:[0,0,1]
v_pk_fma_f32 v[190:191], v[196:197], v[182:183], v[190:191] op_sel_hi:[0,1,1] neg_lo:[0,0,1] neg_hi:[0,0,1]
v_pk_fma_f32 v[192:193], v[196:197], v[184:185], v[192:193] op_sel_hi:[0,1,1] neg_lo:[0,0,1] neg_hi:[0,0,1]
v_pk_fma_f32 v[194:195], v[196:197], v[186:187], v[194:195] op_sel_hi:[0,1,1] neg_lo:[0,0,1] neg_hi:[0,0,1]
v_cvt_pk_bf16_f32 v28, v188, v189
v_cvt_pk_bf16_f32 v29, v190, v191
v_cvt_pk_bf16_f32 v30, v192, v193
v_cvt_pk_bf16_f32 v31, v194, v195
v_pk_fma_f32 v[180:181], v[196:197], v[188:189], v[180:181] op_sel_hi:[0,1,1] neg_lo:[0,0,1] neg_hi:[0,0,1]
v_pk_fma_f32 v[182:183], v[196:197], v[190:191], v[182:183] op_sel_hi:[0,1,1] neg_lo:[0,0,1] neg_hi:[0,0,1]
v_pk_fma_f32 v[184:185], v[196:197], v[192:193], v[184:185] op_sel_hi:[0,1,1] neg_lo:[0,0,1] neg_hi:[0,0,1]
v_pk_fma_f32 v[186:187], v[196:197], v[194:195], v[186:187] op_sel_hi:[0,1,1] neg_lo:[0,0,1] neg_hi:[0,0,1]
v_cvt_pk_bf16_f32 v32, v180, v181
v_cvt_pk_bf16_f32 v33, v182, v183
v_cvt_pk_bf16_f32 v34, v184, v185
v_cvt_pk_bf16_f32 v35, v186, v187
v_pk_fma_f32 v[188:189], v[196:197], v[180:181], v[188:189] op_sel_hi:[0,1,1] neg_lo:[0,0,1] neg_hi:[0,0,1]
v_pk_fma_f32 v[190:191], v[196:197], v[182:183], v[190:191] op_sel_hi:[0,1,1] neg_lo:[0,0,1] neg_hi:[0,0,1]
v_pk_fma_f32 v[192:193], v[196:197], v[184:185], v[192:193] op_sel_hi:[0,1,1] neg_lo:[0,0,1] neg_hi:[0,0,1]
v_pk_fma_f32 v[194:195], v[196:197], v[186:187], v[194:195] op_sel_hi:[0,1,1] neg_lo:[0,0,1] neg_hi:[0,0,1]
v_cvt_pk_bf16_f32 v36, v188, v189
v_cvt_pk_bf16_f32 v37, v190, v191
v_cvt_pk_bf16_f32 v38, v192, v193
v_cvt_pk_bf16_f32 v39, v194, v195
v_pk_fma_f32 v[180:181], v[196:197], v[188:189], v[180:181] op_sel_hi:[0,1,1] neg_lo:[0,0,1] neg_hi:[0,0,1]
v_pk_fma_f32 v[182:183], v[196:197], v[190:191], v[182:183] op_sel_hi:[0,1,1] neg_lo:[0,0,1] neg_hi:[0,0,1]
v_pk_fma_f32 v[184:185], v[196:197], v[192:193], v[184:185] op_sel_hi:[0,1,1] neg_lo:[0,0,1] neg_hi:[0,0,1]
v_pk_fma_f32 v[186:187], v[196:197], v[194:195], v[186:187] op_sel_hi:[0,1,1] neg_lo:[0,0,1] neg_hi:[0,0,1]
v_cvt_pk_bf16_f32 v40, v180, v181
v_cvt_pk_bf16_f32 v41, v182, v183
v_cvt_pk_bf16_f32 v42, v184, v185
v_cvt_pk_bf16_f32 v43, v186, v187
v_pk_fma_f32 v[188:189], v[196:197], v[180:181], v[188:189] op_sel_hi:[0,1,1] neg_lo:[0,0,1] neg_hi:[0,0,1]
v_pk_fma_f32 v[190:191], v[196:197], v[182:183], v[190:191] op_sel_hi:[0,1,1] neg_lo:[0,0,1] neg_hi:[0,0,1]
v_pk_fma_f32 v[192:193], v[196:197], v[184:185], v[192:193] op_sel_hi:[0,1,1] neg_lo:[0,0,1] neg_hi:[0,0,1]
v_pk_fma_f32 v[194:195], v[196:197], v[186:187], v[194:195] op_sel_hi:[0,1,1] neg_lo:[0,0,1] neg_hi:[0,0,1]
v_cvt_pk_bf16_f32 v44, v188, v189
v_cvt_pk_bf16_f32 v45, v190, v191
v_cvt_pk_bf16_f32 v46, v192, v193
v_cvt_pk_bf16_f32 v47, v194, v195
v_pk_fma_f32 v[180:181], v[196:197], v[188:189], v[180:181] op_sel_hi:[0,1,1] neg_lo:[0,0,1] neg_hi:[0,0,1]
v_pk_fma_f32 v[182:183], v[196:197], v[190:191], v[182:183] op_sel_hi:[0,1,1] neg_lo:[0,0,1] neg_hi:[0,0,1]
v_pk_fma_f32 v[184:185], v[196:197], v[192:193], v[184:185] op_sel_hi:[0,1,1] neg_lo:[0,0,1] neg_hi:[0,0,1]
v_pk_fma_f32 v[186:187], v[196:197], v[194:195], v[186:187] op_sel_hi:[0,1,1] neg_lo:[0,0,1] neg_hi:[0,0,1]
v_cvt_pk_bf16_f32 v48, v180, v181
v_cvt_pk_bf16_f32 v49, v182, v183
v_cvt_pk_bf16_f32 v50, v184, v185
v_cvt_pk_bf16_f32 v51, v186, v187
v_pk_fma_f32 v[188:189], v[196:197], v[180:181], v[188:189] op_sel_hi:[0,1,1] neg_lo:[0,0,1] neg_hi:[0,0,1]
v_pk_fma_f32 v[190:191], v[196:197], v[182:183], v[190:191] op_sel_hi:[0,1,1] neg_lo:[0,0,1] neg_hi:[0,0,1]
v_pk_fma_f32 v[192:193], v[196:197], v[184:185], v[192:193] op_sel_hi:[0,1,1] neg_lo:[0,0,1] neg_hi:[0,0,1]
v_pk_fma_f32 v[194:195], v[196:197], v[186:187], v[194:195] op_sel_hi:[0,1,1] neg_lo:[0,0,1] neg_hi:[0,0,1]
v_cvt_pk_bf16_f32 v52, v188, v189
v_cvt_pk_bf16_f32 v53, v190, v191
v_cvt_pk_bf16_f32 v54, v192, v193
v_cvt_pk_bf16_f32 v55, v194, v195
v_pk_fma_f32 v[180:181], v[196:197], v[188:189], v[180:181] op_sel_hi:[0,1,1] neg_lo:[0,0,1] neg_hi:[0,0,1]
v_pk_fma_f32 v[182:183], v[196:197], v[190:191], v[182:183] op_sel_hi:[0,1,1] neg_lo:[0,0,1] neg_hi:[0,0,1]
v_pk_fma_f32 v[184:185], v[196:197], v[192:193], v[184:185] op_sel_hi:[0,1,1] neg_lo:[0,0,1] neg_hi:[0,0,1]
v_pk_fma_f32 v[186:187], v[196:197], v[194:195], v[186:187] op_sel_hi:[0,1,1] neg_lo:[0,0,1] neg_hi:[0,0,1]
v_cvt_pk_bf16_f32 v56, v180, v181
v_cvt_pk_bf16_f32 v57, v182, v183
v_cvt_pk_bf16_f32 v58, v184, v185
v_cvt_pk_bf16_f32 v59, v186, v187
s_add_u32 m0, s25, 2048
s_add_u32 s21, s26, 0
buffer_load_dwordx4 v8, s[40:43], s21 offen lds
v_pk_fma_f32 v[188:189], v[196:197], v[180:181], v[188:189] op_sel_hi:[0,1,1] neg_lo:[0,0,1] neg_hi:[0,0,1]
v_pk_fma_f32 v[190:191], v[196:197], v[182:183], v[190:191] op_sel_hi:[0,1,1] neg_lo:[0,0,1] neg_hi:[0,0,1]
v_pk_fma_f32 v[192:193], v[196:197], v[184:185], v[192:193] op_sel_hi:[0,1,1] neg_lo:[0,0,1] neg_hi:[0,0,1]
v_pk_fma_f32 v[194:195], v[196:197], v[186:187], v[194:195] op_sel_hi:[0,1,1] neg_lo:[0,0,1] neg_hi:[0,0,1]
v_cvt_pk_bf16_f32 v60, v188, v189
v_cvt_pk_bf16_f32 v61, v190, v191
v_cvt_pk_bf16_f32 v62, v192, v193
v_cvt_pk_bf16_f32 v63, v194, v195
s_add_u32 m0, s25, 6144
s_add_u32 s21, s26, 128
buffer_load_dwordx4 v8, s[40:43], s21 offen lds
v_pk_fma_f32 v[180:181], v[196:197], v[188:189], v[180:181] op_sel_hi:[0,1,1] neg_lo:[0,0,1] neg_hi:[0,0,1]
v_pk_fma_f32 v[182:183], v[196:197], v[190:191], v[182:183] op_sel_hi:[0,1,1] neg_lo:[0,0,1] neg_hi:[0,0,1]
v_pk_fma_f32 v[184:185], v[196:197], v[192:193], v[184:185] op_sel_hi:[0,1,1] neg_lo:[0,0,1] neg_hi:[0,0,1]
v_pk_fma_f32 v[186:187], v[196:197], v[194:195], v[186:187] op_sel_hi:[0,1,1] neg_lo:[0,0,1] neg_hi:[0,0,1]
v_cvt_pk_bf16_f32 v64, v180, v181
v_cvt_pk_bf16_f32 v65, v182, v183
v_cvt_pk_bf16_f32 v66, v184, v185
v_cvt_pk_bf16_f32 v67, v186, v187
s_add_u32 m0, s25, 10240
s_add_u32 s21, s26, 256
buffer_load_dwordx4 v8, s[40:43], s21 offen lds
v_pk_fma_f32 v[188:189], v[196:197], v[180:181], v[188:189] op_sel_hi:[0,1,1] neg_lo:[0,0,1] neg_hi:[0,0,1]
v_pk_fma_f32 v[190:191], v[196:197], v[182:183], v[190:191] op_sel_hi:[0,1,1] neg_lo:[0,0,1] neg_hi:[0,0,1]
v_pk_fma_f32 v[192:193], v[196:197], v[184:185], v[192:193] op_sel_hi:[0,1,1] neg_lo:[0,0,1] neg_hi:[0,0,1]
v_pk_fma_f32 v[194:195], v[196:197], v[186:187], v[194:195] op_sel_hi:[0,1,1] neg_lo:[0,0,1] neg_hi:[0,0,1]
v_cvt_pk_bf16_f32 v68, v188, v189
v_cvt_pk_bf16_f32 v69, v190, v191
v_cvt_pk_bf16_f32 v70, v192, v193
v_cvt_pk_bf16_f32 v71, v194, v195
s_add_u32 m0, s25, 14336
s_add_u32 s21, s26, 384
buffer_load_dwordx4 v8, s[40:43], s21 offen lds
v_pk_fma_f32 v[180:181], v[196:197], v[188:189], v[180:181] op_sel_hi:[0,1,1] neg_lo:[0,0,1] neg_hi:[0,0,1]
v_pk_fma_f32 v[182:183], v[196:197], v[190:191], v[182:183] op_sel_hi:[0,1,1] neg_lo:[0,0,1] neg_hi:[0,0,1]
v_pk_fma_f32 v[184:185], v[196:197], v[192:193], v[184:185] op_sel_hi:[0,1,1] neg_lo:[0,0,1] neg_hi:[0,0,1]
v_pk_fma_f32 v[186:187], v[196:197], v[194:195], v[186:187] op_sel_hi:[0,1,1] neg_lo:[0,0,1] neg_hi:[0,0,1]
v_cvt_pk_bf16_f32 v72, v180, v181
v_cvt_pk_bf16_f32 v73, v182, v183
v_cvt_pk_bf16_f32 v74, v184, v185
v_cvt_pk_bf16_f32 v75, v186, v187
s_add_u32 m0, s25, 18432
s_add_u32 s21, s26, 512
buffer_load_dwordx4 v8, s[40:43], s21 offen lds
v_pk_fma_f32 v[188:189], v[196:197], v[180:181], v[188:189] op_sel_hi:[0,1,1] neg_lo:[0,0,1] neg_hi:[0,0,1]
v_pk_fma_f32 v[190:191], v[196:197], v[182:183], v[190:191] op_sel_hi:[0,1,1] neg_lo:[0,0,1] neg_hi:[0,0,1]
v_pk_fma_f32 v[192:193], v[196:197], v[184:185], v[192:193] op_sel_hi:[0,1,1] neg_lo:[0,0,1] neg_hi:[0,0,1]
v_pk_fma_f32 v[194:195], v[196:197], v[186:187], v[194:195] op_sel_hi:[0,1,1] neg_lo:[0,0,1] neg_hi:[0,0,1]
v_cvt_pk_bf16_f32 v76, v188, v189
v_cvt_pk_bf16_f32 v77, v190, v191
v_cvt_pk_bf16_f32 v78, v192, v193
v_cvt_pk_bf16_f32 v79, v194, v195
s_add_u32 m0, s25, 22528
s_add_u32 s21, s26, 640
buffer_load_dwordx4 v8, s[40:43], s21 offen lds
v_pk_fma_f32 v[180:181], v[196:197], v[188:189], v[180:181] op_sel_hi:[0,1,1] neg_lo:[0,0,1] neg_hi:[0,0,1]
v_pk_fma_f32 v[182:183], v[196:197], v[190:191], v[182:183] op_sel_hi:[0,1,1] neg_lo:[0,0,1] neg_hi:[0,0,1]
v_pk_fma_f32 v[184:185], v[196:197], v[192:193], v[184:185] op_sel_hi:[0,1,1] neg_lo:[0,0,1] neg_hi:[0,0,1]
v_pk_fma_f32 v[186:187], v[196:197], v[194:195], v[186:187] op_sel_hi:[0,1,1] neg_lo:[0,0,1] neg_hi:[0,0,1]
v_cvt_pk_bf16_f32 v80, v180, v181
v_cvt_pk_bf16_f32 v81, v182, v183
v_cvt_pk_bf16_f32 v82, v184, v185
v_cvt_pk_bf16_f32 v83, v186, v187
s_add_u32 m0, s25, 26624
s_add_u32 s21, s26, 768
buffer_load_dwordx4 v8, s[40:43], s21 offen lds
v_pk_fma_f32 v[188:189], v[196:197], v[180:181], v[188:189] op_sel_hi:[0,1,1] neg_lo:[0,0,1] neg_hi:[0,0,1]
v_pk_fma_f32 v[190:191], v[196:197], v[182:183], v[190:191] op_sel_hi:[0,1,1] neg_lo:[0,0,1] neg_hi:[0,0,1]
v_pk_fma_f32 v[192:193], v[196:197], v[184:185], v[192:193] op_sel_hi:[0,1,1] neg_lo:[0,0,1] neg_hi:[0,0,1]
v_pk_fma_f32 v[194:195], v[196:197], v[186:187], v[194:195] op_sel_hi:[0,1,1] neg_lo:[0,0,1] neg_hi:[0,0,1]
v_cvt_pk_bf16_f32 v84, v188, v189
v_cvt_pk_bf16_f32 v85, v190, v191
v_cvt_pk_bf16_f32 v86, v192, v193
v_cvt_pk_bf16_f32 v87, v194, v195
s_add_u32 m0, s25, 30720
s_add_u32 s21, s26, 896
buffer_load_dwordx4 v8, s[40:43], s21 offen lds
v_pk_fma_f32 v[180:181], v[196:197], v[188:189], v[180:181] op_sel_hi:[0,1,1] neg_lo:[0,0,1] neg_hi:[0,0,1]
v_pk_fma_f32 v[182:183], v[196:197], v[190:191], v[182:183] op_sel_hi:[0,1,1] neg_lo:[0,0,1] neg_hi:[0,0,1]
v_pk_fma_f32 v[184:185], v[196:197], v[192:193], v[184:185] op_sel_hi:[0,1,1] neg_lo:[0,0,1] neg_hi:[0,0,1]
v_pk_fma_f32 v[186:187], v[196:197], v[194:195], v[186:187] op_sel_hi:[0,1,1] neg_lo:[0,0,1] neg_hi:[0,0,1]
v_cvt_pk_bf16_f32 v88, v180, v181
v_cvt_pk_bf16_f32 v89, v182, v183
v_cvt_pk_bf16_f32 v90, v184, v185
v_cvt_pk_bf16_f32 v91, v186, v187
s_add_u32 m0, s25, 34816
s_add_u32 s21, s26, 1024
buffer_load_dwordx4 v8, s[40:43], s21 offen lds
v_pk_fma_f32 v[188:189], v[196:197], v[180:181], v[188:189] op_sel_hi:[0,1,1] neg_lo:[0,0,1] neg_hi:[0,0,1]
v_pk_fma_f32 v[190:191], v[196:197], v[182:183], v[190:191] op_sel_hi:[0,1,1] neg_lo:[0,0,1] neg_hi:[0,0,1]
v_pk_fma_f32 v[192:193], v[196:197], v[184:185], v[192:193] op_sel_hi:[0,1,1] neg_lo:[0,0,1] neg_hi:[0,0,1]
v_pk_fma_f32 v[194:195], v[196:197], v[186:187], v[194:195] op_sel_hi:[0,1,1] neg_lo:[0,0,1] neg_hi:[0,0,1]
v_cvt_pk_bf16_f32 v92, v188, v189
v_cvt_pk_bf16_f32 v93, v190, v191
v_cvt_pk_bf16_f32 v94, v192, v193
v_cvt_pk_bf16_f32 v95, v194, v195
s_add_u32 m0, s25, 38912
s_add_u32 s21, s26, 1152
buffer_load_dwordx4 v8, s[40:43], s21 offen lds
s_mov_b32 s20, 323
v_mad_u32_u24 v183, v200, s20, v201
v_cvt_f32_u32 v183, v183
v_mul_f32 v202, s19, v183
v_rndne_f32 v202, v202
v_fmac_f32 v183, 0xc4200000, v202
v_mul_f32 v183, s19, v183
v_cos_f32 v183, v183
s_mov_b32 s20, 324
v_mad_u32_u24 v184, v200, s20, v201
v_cvt_f32_u32 v184, v184
v_mul_f32 v202, s19, v184
v_rndne_f32 v202, v202
v_fmac_f32 v184, 0xc4200000, v202
v_mul_f32 v184, s19, v184
v_cos_f32 v184, v184
s_nop 0
v_fma_f32 v185, v198, v184, -v183
v_fma_f32 v182, v198, v183, -v184
v_fma_f32 v186, v198, v185, -v184
v_fma_f32 v181, v198, v182, -v183
v_fma_f32 v187, v198, v186, -v185
v_fma_f32 v180, v198, v181, -v182
v_cvt_pk_bf16_f32 v96, v180, v181
v_cvt_pk_bf16_f32 v97, v182, v183
v_cvt_pk_bf16_f32 v98, v184, v185
v_cvt_pk_bf16_f32 v99, v186, v187
s_mov_b32 s20, 339
v_mad_u32_u24 v191, v200, s20, v201
v_cvt_f32_u32 v191, v191
v_mul_f32 v202, s19, v191
v_rndne_f32 v202, v202
v_fmac_f32 v191, 0xc4200000, v202
v_mul_f32 v191, s19, v191
v_cos_f32 v191, v191
s_mov_b32 s20, 340
v_mad_u32_u24 v192, v200, s20, v201
v_cvt_f32_u32 v192, v192
v_mul_f32 v202, s19, v192
v_rndne_f32 v202, v202
v_fmac_f32 v192, 0xc4200000, v202
v_mul_f32 v192, s19, v192
v_cos_f32 v192, v192
s_nop 0
v_fma_f32 v193, v198, v192, -v191
v_fma_f32 v190, v198, v191, -v192
v_fma_f32 v194, v198, v193, -v192
v_fma_f32 v189, v198, v190, -v191
v_fma_f32 v195, v198, v194, -v193
v_fma_f32 v188, v198, v189, -v190
v_cvt_pk_bf16_f32 v100, v188, v189
v_cvt_pk_bf16_f32 v101, v190, v191
v_cvt_pk_bf16_f32 v102, v192, v193
v_cvt_pk_bf16_f32 v103, v194, v195
v_pk_fma_f32 v[180:181], v[196:197], v[188:189], v[180:181] op_sel_hi:[0,1,1] neg_lo:[0,0,1] neg_hi:[0,0,1]
v_pk_fma_f32 v[182:183], v[196:197], v[190:191], v[182:183] op_sel_hi:[0,1,1] neg_lo:[0,0,1] neg_hi:[0,0,1]
v_pk_fma_f32 v[184:185], v[196:197], v[192:193], v[184:185] op_sel_hi:[0,1,1] neg_lo:[0,0,1] neg_hi:[0,0,1]
v_pk_fma_f32 v[186:187], v[196:197], v[194:195], v[186:187] op_sel_hi:[0,1,1] neg_lo:[0,0,1] neg_hi:[0,0,1]
v_cvt_pk_bf16_f32 v104, v180, v181
v_cvt_pk_bf16_f32 v105, v182, v183
v_cvt_pk_bf16_f32 v106, v184, v185
v_cvt_pk_bf16_f32 v107, v186, v187
v_pk_fma_f32 v[188:189], v[196:197], v[180:181], v[188:189] op_sel_hi:[0,1,1] neg_lo:[0,0,1] neg_hi:[0,0,1]
v_pk_fma_f32 v[190:191], v[196:197], v[182:183], v[190:191] op_sel_hi:[0,1,1] neg_lo:[0,0,1] neg_hi:[0,0,1]
v_pk_fma_f32 v[192:193], v[196:197], v[184:185], v[192:193] op_sel_hi:[0,1,1] neg_lo:[0,0,1] neg_hi:[0,0,1]
v_pk_fma_f32 v[194:195], v[196:197], v[186:187], v[194:195] op_sel_hi:[0,1,1] neg_lo:[0,0,1] neg_hi:[0,0,1]
v_cvt_pk_bf16_f32 v108, v188, v189
v_cvt_pk_bf16_f32 v109, v190, v191
v_cvt_pk_bf16_f32 v110, v192, v193
v_cvt_pk_bf16_f32 v111, v194, v195
v_pk_fma_f32 v[180:181], v[196:197], v[188:189], v[180:181] op_sel_hi:[0,1,1] neg_lo:[0,0,1] neg_hi:[0,0,1]
v_pk_fma_f32 v[182:183], v[196:197], v[190:191], v[182:183] op_sel_hi:[0,1,1] neg_lo:[0,0,1] neg_hi:[0,0,1]
v_pk_fma_f32 v[184:185], v[196:197], v[192:193], v[184:185] op_sel_hi:[0,1,1] neg_lo:[0,0,1] neg_hi:[0,0,1]
v_pk_fma_f32 v[186:187], v[196:197], v[194:195], v[186:187] op_sel_hi:[0,1,1] neg_lo:[0,0,1] neg_hi:[0,0,1]
v_cvt_pk_bf16_f32 v112, v180, v181
v_cvt_pk_bf16_f32 v113, v182, v183
v_cvt_pk_bf16_f32 v114, v184, v185
v_cvt_pk_bf16_f32 v115, v186, v187
v_pk_fma_f32 v[188:189], v[196:197], v[180:181], v[188:189] op_sel_hi:[0,1,1] neg_lo:[0,0,1] neg_hi:[0,0,1]
v_pk_fma_f32 v[190:191], v[196:197], v[182:183], v[190:191] op_sel_hi:[0,1,1] neg_lo:[0,0,1] neg_hi:[0,0,1]
v_pk_fma_f32 v[192:193], v[196:197], v[184:185], v[192:193] op_sel_hi:[0,1,1] neg_lo:[0,0,1] neg_hi:[0,0,1]
v_pk_fma_f32 v[194:195], v[196:197], v[186:187], v[194:195] op_sel_hi:[0,1,1] neg_lo:[0,0,1] neg_hi:[0,0,1]
v_cvt_pk_bf16_f32 v116, v188, v189
v_cvt_pk_bf16_f32 v117, v190, v191
v_cvt_pk_bf16_f32 v118, v192, v193
v_cvt_pk_bf16_f32 v119, v194, v195
v_pk_fma_f32 v[180:181], v[196:197], v[188:189], v[180:181] op_sel_hi:[0,1,1] neg_lo:[0,0,1] neg_hi:[0,0,1]
v_pk_fma_f32 v[182:183], v[196:197], v[190:191], v[182:183] op_sel_hi:[0,1,1] neg_lo:[0,0,1] neg_hi:[0,0,1]
v_pk_fma_f32 v[184:185], v[196:197], v[192:193], v[184:185] op_sel_hi:[0,1,1] neg_lo:[0,0,1] neg_hi:[0,0,1]
v_pk_fma_f32 v[186:187], v[196:197], v[194:195], v[186:187] op_sel_hi:[0,1,1] neg_lo:[0,0,1] neg_hi:[0,0,1]
v_cvt_pk_bf16_f32 v120, v180, v181
v_cvt_pk_bf16_f32 v121, v182, v183
v_cvt_pk_bf16_f32 v122, v184, v185
v_cvt_pk_bf16_f32 v123, v186, v187
v_pk_fma_f32 v[188:189], v[196:197], v[180:181], v[188:189] op_sel_hi:[0,1,1] neg_lo:[0,0,1] neg_hi:[0,0,1]
v_pk_fma_f32 v[190:191], v[196:197], v[182:183], v[190:191] op_sel_hi:[0,1,1] neg_lo:[0,0,1] neg_hi:[0,0,1]
v_pk_fma_f32 v[192:193], v[196:197], v[184:185], v[192:193] op_sel_hi:[0,1,1] neg_lo:[0,0,1] neg_hi:[0,0,1]
v_pk_fma_f32 v[194:195], v[196:197], v[186:187], v[194:195] op_sel_hi:[0,1,1] neg_lo:[0,0,1] neg_hi:[0,0,1]
v_cvt_pk_bf16_f32 v124, v188, v189
v_cvt_pk_bf16_f32 v125, v190, v191
v_cvt_pk_bf16_f32 v126, v192, v193
v_cvt_pk_bf16_f32 v127, v194, v195
v_pk_fma_f32 v[180:181], v[196:197], v[188:189], v[180:181] op_sel_hi:[0,1,1] neg_lo:[0,0,1] neg_hi:[0,0,1]
v_pk_fma_f32 v[182:183], v[196:197], v[190:191], v[182:183] op_sel_hi:[0,1,1] neg_lo:[0,0,1] neg_hi:[0,0,1]
v_pk_fma_f32 v[184:185], v[196:197], v[192:193], v[184:185] op_sel_hi:[0,1,1] neg_lo:[0,0,1] neg_hi:[0,0,1]
v_pk_fma_f32 v[186:187], v[196:197], v[194:195], v[186:187] op_sel_hi:[0,1,1] neg_lo:[0,0,1] neg_hi:[0,0,1]
v_cvt_pk_bf16_f32 v128, v180, v181
v_cvt_pk_bf16_f32 v129, v182, v183
v_cvt_pk_bf16_f32 v130, v184, v185
v_cvt_pk_bf16_f32 v131, v186, v187
v_pk_fma_f32 v[188:189], v[196:197], v[180:181], v[188:189] op_sel_hi:[0,1,1] neg_lo:[0,0,1] neg_hi:[0,0,1]
v_pk_fma_f32 v[190:191], v[196:197], v[182:183], v[190:191] op_sel_hi:[0,1,1] neg_lo:[0,0,1] neg_hi:[0,0,1]
v_pk_fma_f32 v[192:193], v[196:197], v[184:185], v[192:193] op_sel_hi:[0,1,1] neg_lo:[0,0,1] neg_hi:[0,0,1]
v_pk_fma_f32 v[194:195], v[196:197], v[186:187], v[194:195] op_sel_hi:[0,1,1] neg_lo:[0,0,1] neg_hi:[0,0,1]
v_cvt_pk_bf16_f32 v132, v188, v189
v_cvt_pk_bf16_f32 v133, v190, v191
v_cvt_pk_bf16_f32 v134, v192, v193
v_cvt_pk_bf16_f32 v135, v194, v195
v_pk_fma_f32 v[180:181], v[196:197], v[188:189], v[180:181] op_sel_hi:[0,1,1] neg_lo:[0,0,1] neg_hi:[0,0,1]
v_pk_fma_f32 v[182:183], v[196:197], v[190:191], v[182:183] op_sel_hi:[0,1,1] neg_lo:[0,0,1] neg_hi:[0,0,1]
v_pk_fma_f32 v[184:185], v[196:197], v[192:193], v[184:185] op_sel_hi:[0,1,1] neg_lo:[0,0,1] neg_hi:[0,0,1]
v_pk_fma_f32 v[186:187], v[196:197], v[194:195], v[186:187] op_sel_hi:[0,1,1] neg_lo:[0,0,1] neg_hi:[0,0,1]
v_cvt_pk_bf16_f32 v136, v180, v181
v_cvt_pk_bf16_f32 v137, v182, v183
v_cvt_pk_bf16_f32 v138, v184, v185
v_cvt_pk_bf16_f32 v139, v186, v187
v_pk_fma_f32 v[188:189], v[196:197], v[180:181], v[188:189] op_sel_hi:[0,1,1] neg_lo:[0,0,1] neg_hi:[0,0,1]
v_pk_fma_f32 v[190:191], v[196:197], v[182:183], v[190:191] op_sel_hi:[0,1,1] neg_lo:[0,0,1] neg_hi:[0,0,1]
v_pk_fma_f32 v[192:193], v[196:197], v[184:185], v[192:193] op_sel_hi:[0,1,1] neg_lo:[0,0,1] neg_hi:[0,0,1]
v_pk_fma_f32 v[194:195], v[196:197], v[186:187], v[194:195] op_sel_hi:[0,1,1] neg_lo:[0,0,1] neg_hi:[0,0,1]
v_cvt_pk_bf16_f32 v140, v188, v189
v_cvt_pk_bf16_f32 v141, v190, v191
v_cvt_pk_bf16_f32 v142, v192, v193
v_cvt_pk_bf16_f32 v143, v194, v195
v_pk_fma_f32 v[180:181], v[196:197], v[188:189], v[180:181] op_sel_hi:[0,1,1] neg_lo:[0,0,1] neg_hi:[0,0,1]
v_pk_fma_f32 v[182:183], v[196:197], v[190:191], v[182:183] op_sel_hi:[0,1,1] neg_lo:[0,0,1] neg_hi:[0,0,1]
v_pk_fma_f32 v[184:185], v[196:197], v[192:193], v[184:185] op_sel_hi:[0,1,1] neg_lo:[0,0,1] neg_hi:[0,0,1]
v_pk_fma_f32 v[186:187], v[196:197], v[194:195], v[186:187] op_sel_hi:[0,1,1] neg_lo:[0,0,1] neg_hi:[0,0,1]
v_cvt_pk_bf16_f32 v144, v180, v181
v_cvt_pk_bf16_f32 v145, v182, v183
v_cvt_pk_bf16_f32 v146, v184, v185
v_cvt_pk_bf16_f32 v147, v186, v187
v_pk_fma_f32 v[188:189], v[196:197], v[180:181], v[188:189] op_sel_hi:[0,1,1] neg_lo:[0,0,1] neg_hi:[0,0,1]
v_pk_fma_f32 v[190:191], v[196:197], v[182:183], v[190:191] op_sel_hi:[0,1,1] neg_lo:[0,0,1] neg_hi:[0,0,1]
v_pk_fma_f32 v[192:193], v[196:197], v[184:185], v[192:193] op_sel_hi:[0,1,1] neg_lo:[0,0,1] neg_hi:[0,0,1]
v_pk_fma_f32 v[194:195], v[196:197], v[186:187], v[194:195] op_sel_hi:[0,1,1] neg_lo:[0,0,1] neg_hi:[0,0,1]
v_cvt_pk_bf16_f32 v148, v188, v189
v_cvt_pk_bf16_f32 v149, v190, v191
v_cvt_pk_bf16_f32 v150, v192, v193
v_cvt_pk_bf16_f32 v151, v194, v195
v_pk_fma_f32 v[180:181], v[196:197], v[188:189], v[180:181] op_sel_hi:[0,1,1] neg_lo:[0,0,1] neg_hi:[0,0,1]
v_pk_fma_f32 v[182:183], v[196:197], v[190:191], v[182:183] op_sel_hi:[0,1,1] neg_lo:[0,0,1] neg_hi:[0,0,1]
v_pk_fma_f32 v[184:185], v[196:197], v[192:193], v[184:185] op_sel_hi:[0,1,1] neg_lo:[0,0,1] neg_hi:[0,0,1]
v_pk_fma_f32 v[186:187], v[196:197], v[194:195], v[186:187] op_sel_hi:[0,1,1] neg_lo:[0,0,1] neg_hi:[0,0,1]
v_cvt_pk_bf16_f32 v152, v180, v181
v_cvt_pk_bf16_f32 v153, v182, v183
v_cvt_pk_bf16_f32 v154, v184, v185
v_cvt_pk_bf16_f32 v155, v186, v187
v_pk_fma_f32 v[188:189], v[196:197], v[180:181], v[188:189] op_sel_hi:[0,1,1] neg_lo:[0,0,1] neg_hi:[0,0,1]
v_pk_fma_f32 v[190:191], v[196:197], v[182:183], v[190:191] op_sel_hi:[0,1,1] neg_lo:[0,0,1] neg_hi:[0,0,1]
v_pk_fma_f32 v[192:193], v[196:197], v[184:185], v[192:193] op_sel_hi:[0,1,1] neg_lo:[0,0,1] neg_hi:[0,0,1]
v_pk_fma_f32 v[194:195], v[196:197], v[186:187], v[194:195] op_sel_hi:[0,1,1] neg_lo:[0,0,1] neg_hi:[0,0,1]
v_cvt_pk_bf16_f32 v156, v188, v189
v_cvt_pk_bf16_f32 v157, v190, v191
v_cvt_pk_bf16_f32 v158, v192, v193
v_cvt_pk_bf16_f32 v159, v194, v195
v_pk_fma_f32 v[180:181], v[196:197], v[188:189], v[180:181] op_sel_hi:[0,1,1] neg_lo:[0,0,1] neg_hi:[0,0,1]
v_pk_fma_f32 v[182:183], v[196:197], v[190:191], v[182:183] op_sel_hi:[0,1,1] neg_lo:[0,0,1] neg_hi:[0,0,1]
v_pk_fma_f32 v[184:185], v[196:197], v[192:193], v[184:185] op_sel_hi:[0,1,1] neg_lo:[0,0,1] neg_hi:[0,0,1]
v_pk_fma_f32 v[186:187], v[196:197], v[194:195], v[186:187] op_sel_hi:[0,1,1] neg_lo:[0,0,1] neg_hi:[0,0,1]
v_cvt_pk_bf16_f32 v160, v180, v181
v_cvt_pk_bf16_f32 v161, v182, v183
v_cvt_pk_bf16_f32 v162, v184, v185
v_cvt_pk_bf16_f32 v163, v186, v187
v_pk_fma_f32 v[188:189], v[196:197], v[180:181], v[188:189] op_sel_hi:[0,1,1] neg_lo:[0,0,1] neg_hi:[0,0,1]
v_pk_fma_f32 v[190:191], v[196:197], v[182:183], v[190:191] op_sel_hi:[0,1,1] neg_lo:[0,0,1] neg_hi:[0,0,1]
v_pk_fma_f32 v[192:193], v[196:197], v[184:185], v[192:193] op_sel_hi:[0,1,1] neg_lo:[0,0,1] neg_hi:[0,0,1]
v_pk_fma_f32 v[194:195], v[196:197], v[186:187], v[194:195] op_sel_hi:[0,1,1] neg_lo:[0,0,1] neg_hi:[0,0,1]
v_cvt_pk_bf16_f32 v164, v188, v189
v_cvt_pk_bf16_f32 v165, v190, v191
v_cvt_pk_bf16_f32 v166, v192, v193
v_cvt_pk_bf16_f32 v167, v194, v195
v_pk_fma_f32 v[180:181], v[196:197], v[188:189], v[180:181] op_sel_hi:[0,1,1] neg_lo:[0,0,1] neg_hi:[0,0,1]
v_pk_fma_f32 v[182:183], v[196:197], v[190:191], v[182:183] op_sel_hi:[0,1,1] neg_lo:[0,0,1] neg_hi:[0,0,1]
v_pk_fma_f32 v[184:185], v[196:197], v[192:193], v[184:185] op_sel_hi:[0,1,1] neg_lo:[0,0,1] neg_hi:[0,0,1]
v_pk_fma_f32 v[186:187], v[196:197], v[194:195], v[186:187] op_sel_hi:[0,1,1] neg_lo:[0,0,1] neg_hi:[0,0,1]
v_cvt_pk_bf16_f32 v168, v180, v181
v_cvt_pk_bf16_f32 v169, v182, v183
v_cvt_pk_bf16_f32 v170, v184, v185
v_cvt_pk_bf16_f32 v171, v186, v187
v_pk_fma_f32 v[188:189], v[196:197], v[180:181], v[188:189] op_sel_hi:[0,1,1] neg_lo:[0,0,1] neg_hi:[0,0,1]
v_pk_fma_f32 v[190:191], v[196:197], v[182:183], v[190:191] op_sel_hi:[0,1,1] neg_lo:[0,0,1] neg_hi:[0,0,1]
v_pk_fma_f32 v[192:193], v[196:197], v[184:185], v[192:193] op_sel_hi:[0,1,1] neg_lo:[0,0,1] neg_hi:[0,0,1]
v_pk_fma_f32 v[194:195], v[196:197], v[186:187], v[194:195] op_sel_hi:[0,1,1] neg_lo:[0,0,1] neg_hi:[0,0,1]
v_cvt_pk_bf16_f32 v172, v188, v189
v_cvt_pk_bf16_f32 v173, v190, v191
v_cvt_pk_bf16_f32 v174, v192, v193
v_cvt_pk_bf16_f32 v175, v194, v195
v_mov_b32 v180, s24
v_mov_b32 v181, s24
v_mov_b32 v182, s24
v_mov_b32 v183, s24
s_nop 1
v_mfma_f32_32x32x16_bf16 v[184:199], v[180:183], v[16:19], 0
v_mfma_f32_32x32x16_bf16 v[184:199], v[180:183], v[20:23], v[184:199]
v_mfma_f32_32x32x16_bf16 v[184:199], v[180:183], v[24:27], v[184:199]
v_mfma_f32_32x32x16_bf16 v[184:199], v[180:183], v[28:31], v[184:199]
v_mfma_f32_32x32x16_bf16 v[184:199], v[180:183], v[32:35], v[184:199]
v_mfma_f32_32x32x16_bf16 v[184:199], v[180:183], v[36:39], v[184:199]
v_mfma_f32_32x32x16_bf16 v[184:199], v[180:183], v[40:43], v[184:199]
v_mfma_f32_32x32x16_bf16 v[184:199], v[180:183], v[44:47], v[184:199]
v_mfma_f32_32x32x16_bf16 v[184:199], v[180:183], v[48:51], v[184:199]
v_mfma_f32_32x32x16_bf16 v[184:199], v[180:183], v[52:55], v[184:199]
v_mfma_f32_32x32x16_bf16 v[184:199], v[180:183], v[56:59], v[184:199]
v_mfma_f32_32x32x16_bf16 v[184:199], v[180:183], v[60:63], v[184:199]
v_mfma_f32_32x32x16_bf16 v[184:199], v[180:183], v[64:67], v[184:199]
v_mfma_f32_32x32x16_bf16 v[184:199], v[180:183], v[68:71], v[184:199]
v_mfma_f32_32x32x16_bf16 v[184:199], v[180:183], v[72:75], v[184:199]
v_mfma_f32_32x32x16_bf16 v[184:199], v[180:183], v[76:79], v[184:199]
v_mfma_f32_32x32x16_bf16 v[184:199], v[180:183], v[80:83], v[184:199]
v_mfma_f32_32x32x16_bf16 v[184:199], v[180:183], v[84:87], v[184:199]
v_mfma_f32_32x32x16_bf16 v[184:199], v[180:183], v[88:91], v[184:199]
v_mfma_f32_32x32x16_bf16 v[184:199], v[180:183], v[92:95], v[184:199]
v_mfma_f32_32x32x16_bf16 v[184:199], v[180:183], v[96:99], v[184:199]
v_mfma_f32_32x32x16_bf16 v[184:199], v[180:183], v[100:103], v[184:199]
v_mfma_f32_32x32x16_bf16 v[184:199], v[180:183], v[104:107], v[184:199]
v_mfma_f32_32x32x16_bf16 v[184:199], v[180:183], v[108:111], v[184:199]
v_mfma_f32_32x32x16_bf16 v[184:199], v[180:183], v[112:115], v[184:199]
v_mfma_f32_32x32x16_bf16 v[184:199], v[180:183], v[116:119], v[184:199]
v_mfma_f32_32x32x16_bf16 v[184:199], v[180:183], v[120:123], v[184:199]
v_mfma_f32_32x32x16_bf16 v[184:199], v[180:183], v[124:127], v[184:199]
v_mfma_f32_32x32x16_bf16 v[184:199], v[180:183], v[128:131], v[184:199]
v_mfma_f32_32x32x16_bf16 v[184:199], v[180:183], v[132:135], v[184:199]
v_mfma_f32_32x32x16_bf16 v[184:199], v[180:183], v[136:139], v[184:199]
v_mfma_f32_32x32x16_bf16 v[184:199], v[180:183], v[140:143], v[184:199]
v_mfma_f32_32x32x16_bf16 v[184:199], v[180:183], v[144:147], v[184:199]
v_mfma_f32_32x32x16_bf16 v[184:199], v[180:183], v[148:151], v[184:199]
v_mfma_f32_32x32x16_bf16 v[184:199], v[180:183], v[152:155], v[184:199]
v_mfma_f32_32x32x16_bf16 v[184:199], v[180:183], v[156:159], v[184:199]
v_mfma_f32_32x32x16_bf16 v[184:199], v[180:183], v[160:163], v[184:199]
v_mfma_f32_32x32x16_bf16 v[184:199], v[180:183], v[164:167], v[184:199]
v_mfma_f32_32x32x16_bf16 v[184:199], v[180:183], v[168:171], v[184:199]
v_mfma_f32_32x32x16_bf16 v[184:199], v[180:183], v[172:175], v[184:199]
s_nop 11
v_mov_b32 v7, v184
s_lshl_b32 s18, s34, 2
s_add_u32 s18, s18, s13
s_lshl_b32 s33, s18, 11
s_mul_i32 s27, s46, 40960
s_add_u32 s27, s27, s33
s_add_u32 s27, s27, 97517568
s_mov_b32 s28, 0
s_waitcnt vmcnt(0)
p1_37:
s_barrier
s_lshl_b32 s18, s13, 5
v_xor_b32 v2, s18, v176
ds_read_b128 v[220:223], v2 offset:2048
ds_read_b128 v[224:227], v2 offset:6144
ds_read_b128 v[232:235], v2 offset:14336
ds_read_b128 v[228:231], v2 offset:10240
ds_read_b128 v[204:207], v178 offset:2048
v_mov_b64 v[212:213], 0
ds_read_b128 v[196:199], v176 offset:2048
ds_read_b128 v[200:203], v177 offset:2048
s_add_u32 s19, s30, 0
buffer_load_dword a0, v1, s[36:39], s19 offen
ds_read_b128 v[208:211], v179 offset:2048
s_waitcnt lgkmcnt(7)
v_dot2c_f32_bf16 v212, s24, v220
v_dot2c_f32_bf16 v213, v220, v220
v_dot2c_f32_bf16 v212, s24, v221
v_dot2c_f32_bf16 v213, v221, v221
v_dot2c_f32_bf16 v212, s24, v222
v_dot2c_f32_bf16 v213, v222, v222
v_dot2c_f32_bf16 v212, s24, v223
v_dot2c_f32_bf16 v213, v223, v223
s_waitcnt lgkmcnt(6)
ds_read_b128 v[220:223], v2 offset:18432
v_dot2c_f32_bf16 v212, s24, v224
v_dot2c_f32_bf16 v213, v224, v224
v_dot2c_f32_bf16 v212, s24, v225
v_dot2c_f32_bf16 v213, v225, v225
v_dot2c_f32_bf16 v212, s24, v226
v_dot2c_f32_bf16 v213, v226, v226
v_dot2c_f32_bf16 v212, s24, v227
s_waitcnt lgkmcnt(5)
v_dot2c_f32_bf16 v213, v227, v227
v_dot2c_f32_bf16 v212, s24, v228
v_dot2c_f32_bf16 v213, v228, v228
v_dot2c_f32_bf16 v212, s24, v229
v_dot2c_f32_bf16 v213, v229, v229
v_dot2c_f32_bf16 v212, s24, v230
v_dot2c_f32_bf16 v213, v230, v230
v_dot2c_f32_bf16 v212, s24, v231
v_dot2c_f32_bf16 v213, v231, v231
v_dot2c_f32_bf16 v212, s24, v232
v_dot2c_f32_bf16 v213, v232, v232
s_waitcnt lgkmcnt(0)
ds_read_b128 v[228:231], v2 offset:26624
ds_read_b128 v[224:227], v2 offset:22528
v_dot2c_f32_bf16 v212, s24, v233
v_dot2c_f32_bf16 v213, v233, v233
v_dot2c_f32_bf16 v212, s24, v234
v_dot2c_f32_bf16 v213, v234, v234
v_dot2c_f32_bf16 v212, s24, v235
v_dot2c_f32_bf16 v213, v235, v235
v_dot2c_f32_bf16 v212, s24, v220
v_dot2c_f32_bf16 v213, v220, v220
v_dot2c_f32_bf16 v212, s24, v221
v_dot2c_f32_bf16 v213, v221, v221
v_dot2c_f32_bf16 v212, s24, v222
v_dot2c_f32_bf16 v213, v222, v222
v_dot2c_f32_bf16 v212, s24, v223
v_dot2c_f32_bf16 v213, v223, v223
s_add_u32 s19, s30, 41088
buffer_load_dword a1, v1, s[36:39], s19 offen
ds_read_b128 v[220:223], v2 offset:34816
s_waitcnt lgkmcnt(1)
ds_read_b128 v[232:235], v2 offset:30720
v_dot2c_f32_bf16 v212, s24, v224
v_dot2c_f32_bf16 v213, v224, v224
v_dot2c_f32_bf16 v212, s24, v225
v_dot2c_f32_bf16 v213, v225, v225
v_dot2c_f32_bf16 v212, s24, v226
v_dot2c_f32_bf16 v213, v226, v226
v_dot2c_f32_bf16 v212, s24, v227
v_dot2c_f32_bf16 v213, v227, v227
v_dot2c_f32_bf16 v212, s24, v228
v_dot2c_f32_bf16 v213, v228, v228
v_dot2c_f32_bf16 v212, s24, v229
v_dot2c_f32_bf16 v213, v229, v229
v_dot2c_f32_bf16 v212, s24, v230
v_dot2c_f32_bf16 v213, v230, v230
v_dot2c_f32_bf16 v212, s24, v231
v_dot2c_f32_bf16 v213, v231, v231
s_waitcnt lgkmcnt(0)
ds_read_b128 v[224:227], v2 offset:38912
v_dot2c_f32_bf16 v212, s24, v232
v_dot2c_f32_bf16 v213, v232, v232
v_dot2c_f32_bf16 v212, s24, v233
v_dot2c_f32_bf16 v213, v233, v233
v_dot2c_f32_bf16 v212, s24, v234
v_dot2c_f32_bf16 v213, v234, v234
v_dot2c_f32_bf16 v212, s24, v235
v_dot2c_f32_bf16 v213, v235, v235
v_dot2c_f32_bf16 v212, s24, v220
v_dot2c_f32_bf16 v213, v220, v220
v_dot2c_f32_bf16 v212, s24, v221
v_dot2c_f32_bf16 v213, v221, v221
v_dot2c_f32_bf16 v212, s24, v222
v_dot2c_f32_bf16 v213, v222, v222
v_dot2c_f32_bf16 v212, s24, v223
v_dot2c_f32_bf16 v213, v223, v223
s_waitcnt lgkmcnt(0)
v_dot2c_f32_bf16 v212, s24, v224
v_dot2c_f32_bf16 v213, v224, v224
v_dot2c_f32_bf16 v212, s24, v225
v_dot2c_f32_bf16 v213, v225, v225
v_dot2c_f32_bf16 v212, s24, v226
v_dot2c_f32_bf16 v213, v226, v226
v_dot2c_f32_bf16 v212, s24, v227
v_dot2c_f32_bf16 v213, v227, v227
v_mfma_f32_32x32x16_bf16 v[180:195], v[196:199], v[16:19], 0
s_add_u32 s19, s30, 82176
buffer_load_dword a2, v1, s[36:39], s19 offen
ds_read_b128 v[196:199], v176 offset:6144
v_permlane32_swap_b32 v212, v213
v_add_f32 v212, v212, v213
v_mfma_f32_32x32x16_bf16 v[180:195], v[200:203], v[20:23], v[180:195]
v_lshl_add_u32 v213, s13, 2, v0
v_mfma_f32_32x32x16_bf16 v[180:195], v[204:207], v[24:27], v[180:195]
ds_write_b32 v213, v212 offset:0
ds_read_b128 v[200:203], v177 offset:6144
s_waitcnt lgkmcnt(2)
ds_read_b128 v[204:207], v178 offset:6144
v_mfma_f32_32x32x16_bf16 v[180:195], v[208:211], v[28:31], v[180:195]
ds_read_b128 v[208:211], v179 offset:6144
v_mfma_f32_32x32x16_bf16 v[180:195], v[196:199], v[32:35], v[180:195]
ds_read_b128 v[196:199], v176 offset:10240
s_add_u32 s19, s30, 123264
buffer_load_dword a3, v1, s[36:39], s19 offen
s_waitcnt lgkmcnt(4)
s_waitcnt lgkmcnt(3)
v_mfma_f32_32x32x16_bf16 v[180:195], v[200:203], v[36:39], v[180:195]
s_waitcnt lgkmcnt(2)
s_barrier
s_waitcnt lgkmcnt(1)
ds_read_b128 v[200:203], v177 offset:10240
v_mfma_f32_32x32x16_bf16 v[180:195], v[204:207], v[40:43], v[180:195]
s_waitcnt lgkmcnt(1)
ds_read_b128 v[204:207], v178 offset:10240
v_and_b32 v2, 0x1ff, v0
ds_read_b128 v[212:215], v2 offset:0
v_mfma_f32_32x32x16_bf16 v[180:195], v[208:211], v[44:47], v[180:195]
v_mfma_f32_32x32x16_bf16 v[180:195], v[196:199], v[48:51], v[180:195]
s_waitcnt lgkmcnt(2)
s_waitcnt lgkmcnt(1)
ds_read_b128 v[208:211], v179 offset:10240
v_mfma_f32_32x32x16_bf16 v[180:195], v[200:203], v[52:55], v[180:195]
ds_read_b128 v[196:199], v176 offset:14336
ds_read_b128 v[216:219], v2 offset:512
ds_read_b128 v[200:203], v177 offset:14336
v_mfma_f32_32x32x16_bf16 v[180:195], v[204:207], v[56:59], v[180:195]
s_waitcnt lgkmcnt(4)
ds_read_b128 v[204:207], v178 offset:14336
s_waitcnt lgkmcnt(4)
s_add_u32 s19, s30, 657408
buffer_load_dword a4, v1, s[36:39], s19 offen
v_mfma_f32_32x32x16_bf16 v[180:195], v[208:211], v[60:63], v[180:195]
s_waitcnt lgkmcnt(3)
ds_read_b128 v[208:211], v179 offset:14336
v_add_f32 v214, v214, v215
v_add_f32 v212, v212, v213
v_mfma_f32_32x32x16_bf16 v[180:195], v[196:199], v[64:67], v[180:195]
ds_read_b128 v[196:199], v176 offset:18432
s_waitcnt lgkmcnt(4)
v_add_f32 v212, v212, v214
v_add_f32 v216, v216, v217
s_waitcnt lgkmcnt(2)
v_mfma_f32_32x32x16_bf16 v[180:195], v[200:203], v[68:71], v[180:195]
v_add_f32 v218, v218, v219
v_lshrrev_b32 v213, 2, v0
v_add_f32 v216, v216, v218
v_mul_f32 v216, 0x3acccccd, v216
v_mul_f32 v212, 0x3acccccd, v212
v_fma_f32 v216, -v212, v212, v216
v_mfma_f32_32x32x16_bf16 v[180:195], v[204:207], v[72:75], v[180:195]
s_waitcnt lgkmcnt(0)
ds_read_b128 v[200:203], v177 offset:18432
ds_read_b128 v[204:207], v178 offset:18432
v_max_f32 v216, 0, v216
v_add_f32 v216, 0x3727c5ac, v216
v_mfma_f32_32x32x16_bf16 v[180:195], v[208:211], v[76:79], v[180:195]
ds_read_b128 v[208:211], v179 offset:18432
v_rsq_f32 v216, v216
v_mfma_f32_32x32x16_bf16 v[180:195], v[196:199], v[80:83], v[180:195]
ds_read_b128 v[196:199], v176 offset:22528
v_bfe_u32 v214, v0, 5, 5
v_and_b32 v214, 16, v214
v_mul_f32 v212, v216, v212
v_lshl_add_u32 v214, s13, 8, v214
s_waitcnt lgkmcnt(2)
v_mfma_f32_32x32x16_bf16 v[180:195], v[200:203], v[84:87], v[180:195]
s_add_u32 s19, s30, 698496
buffer_load_dword a5, v1, s[36:39], s19 offen
v_permlane32_swap_b32 v216, v212
s_waitcnt lgkmcnt(1)
v_lshl_add_u32 v213, s13, 8, v213
v_mfma_f32_32x32x16_bf16 v[180:195], v[204:207], v[88:91], v[180:195]
ds_write_b32 v213, v216 offset:1024
s_waitcnt lgkmcnt(1)
ds_read_b128 v[200:203], v177 offset:22528
ds_read_b128 v[204:207], v178 offset:22528
ds_read_b128 v[236:239], v214 offset:1152
v_mfma_f32_32x32x16_bf16 v[180:195], v[208:211], v[92:95], v[180:195]
v_mfma_f32_32x32x16_bf16 v[180:195], v[196:199], v[96:99], v[180:195]
ds_read_b128 v[244:247], v214 offset:1216
ds_read_b128 v[208:211], v179 offset:22528
ds_read_b128 v[196:199], v176 offset:26624
ds_read_b128 v[220:223], v214 offset:1024
s_waitcnt lgkmcnt(6)
v_mfma_f32_32x32x16_bf16 v[180:195], v[200:203], v[100:103], v[180:195]
s_waitcnt lgkmcnt(5)
ds_read_b128 v[200:203], v177 offset:26624
ds_read_b128 v[248:251], v214 offset:1248
v_mfma_f32_32x32x16_bf16 v[180:195], v[204:207], v[104:107], v[180:195]
s_waitcnt lgkmcnt(6)
ds_read_b128 v[232:235], v214 offset:1120
s_waitcnt lgkmcnt(5)
v_mfma_f32_32x32x16_bf16 v[180:195], v[208:211], v[108:111], v[180:195]
s_waitcnt lgkmcnt(4)
ds_read_b128 v[204:207], v178 offset:26624
v_mfma_f32_32x32x16_bf16 v[180:195], v[196:199], v[112:115], v[180:195]
ds_read_b128 v[196:199], v176 offset:30720
ds_read_b128 v[208:211], v179 offset:26624
s_waitcnt lgkmcnt(5)
ds_read_b128 v[228:231], v214 offset:1088
v_mfma_f32_32x32x16_bf16 v[180:195], v[200:203], v[116:119], v[180:195]
s_add_u32 s19, s30, 739584
buffer_load_dword a6, v1, s[36:39], s19 offen
ds_read_b128 v[200:203], v177 offset:30720
s_waitcnt lgkmcnt(4)
v_mfma_f32_32x32x16_bf16 v[180:195], v[204:207], v[120:123], v[180:195]
ds_read_b128 v[204:207], v178 offset:30720
s_waitcnt lgkmcnt(3)
v_mfma_f32_32x32x16_bf16 v[180:195], v[208:211], v[124:127], v[180:195]
v_mul_f32 v239, v239, v7
ds_read_b128 v[208:211], v179 offset:30720
ds_read_b128 v[224:227], v214 offset:1056
v_mfma_f32_32x32x16_bf16 v[180:195], v[196:199], v[128:131], v[180:195]
v_mul_f32 v246, v246, v7
s_waitcnt lgkmcnt(3)
ds_read_b128 v[196:199], v176 offset:34816
v_mfma_f32_32x32x16_bf16 v[180:195], v[200:203], v[132:135], v[180:195]
ds_read_b128 v[240:243], v214 offset:1184
v_mul_f32 v247, v247, v7
s_waitcnt lgkmcnt(4)
s_add_u32 s19, s30, 780672
buffer_load_dword a7, v1, s[36:39], s19 offen
v_mfma_f32_32x32x16_bf16 v[180:195], v[204:207], v[136:139], v[180:195]
ds_read_b128 v[204:207], v178 offset:34816
ds_read_b128 v[200:203], v177 offset:34816
v_mul_f32 v245, v245, v7
s_waitcnt lgkmcnt(5)
s_waitcnt lgkmcnt(3)
v_mfma_f32_32x32x16_bf16 v[180:195], v[208:211], v[140:143], v[180:195]
s_waitcnt lgkmcnt(2)
ds_read_b128 v[208:211], v179 offset:34816
v_mfma_f32_32x32x16_bf16 v[180:195], v[196:199], v[144:147], v[180:195]
ds_read_b128 v[196:199], v176 offset:38912
s_waitcnt lgkmcnt(3)
v_mul_f32 v238, v238, v7
v_mul_f32 v240, v240, v7
s_waitcnt lgkmcnt(2)
v_mul_f32 v243, v243, v7
v_mfma_f32_32x32x16_bf16 v[180:195], v[200:203], v[148:151], v[180:195]
ds_read_b128 v[200:203], v177 offset:38912
s_waitcnt lgkmcnt(2)
v_mfma_f32_32x32x16_bf16 v[180:195], v[204:207], v[152:155], v[180:195]
ds_read_b128 v[204:207], v178 offset:38912
v_mfma_f32_32x32x16_bf16 v[180:195], v[208:211], v[156:159], v[180:195]
s_waitcnt lgkmcnt(2)
v_mul_f32 v251, v251, v7
v_mul_f32 v242, v242, v7
ds_read_b128 v[208:211], v179 offset:38912
s_waitcnt lgkmcnt(2)
v_mfma_f32_32x32x16_bf16 v[180:195], v[196:199], v[160:163], v[180:195]
v_mul_f32 v241, v241, v7
v_mul_f32 v248, v248, v7
v_mul_f32 v249, v249, v7
v_mfma_f32_32x32x16_bf16 v[180:195], v[200:203], v[164:167], v[180:195]
v_mul_f32 v250, v250, v7
s_waitcnt lgkmcnt(1)
v_mfma_f32_32x32x16_bf16 v[180:195], v[204:207], v[168:171], v[180:195]
v_mul_f32 v237, v237, v7
s_waitcnt lgkmcnt(0)
v_mfma_f32_32x32x16_bf16 v[180:195], v[208:211], v[172:175], v[180:195]
s_nop 0
v_mul_f32 v236, v236, v7
v_mul_f32 v244, v244, v7
s_nop 8
v_fma_f32 v193, v193, v233, -v249
v_fma_f32 v184, v184, v224, -v240
v_fma_f32 v189, v189, v229, -v245
v_fma_f32 v183, v183, v223, -v239
v_fma_f32 v188, v188, v228, -v244
v_fma_f32 v181, v181, v221, -v237
v_fma_f32 v185, v185, v225, -v241
v_fma_f32 v194, v194, v234, -v250
v_fma_f32 v187, v187, v227, -v243
v_fma_f32 v191, v191, v231, -v247
v_fma_f32 v192, v192, v232, -v248
v_cvt_pk_bf16_f32 v202, v192, v193
v_fma_f32 v190, v190, v230, -v246
v_fma_f32 v195, v195, v235, -v251
v_fma_f32 v182, v182, v222, -v238
v_cvt_pk_bf16_f32 v198, v184, v185
v_cvt_pk_bf16_f32 v203, v194, v195
v_cvt_pk_bf16_f32 v197, v182, v183
v_fma_f32 v180, v180, v220, -v236
v_cvt_pk_bf16_f32 v200, v188, v189
v_fma_f32 v186, v186, v226, -v242
v_cvt_pk_bf16_f32 v196, v180, v181
v_cvt_pk_bf16_f32 v199, v186, v187
v_cvt_pk_bf16_f32 v201, v190, v191
buffer_store_dwordx4 v[196:199], v6, s[4:7], s27 offen offset:0 sc1
buffer_store_dwordx4 v[200:203], v6, s[4:7], s27 offen offset:1024 sc1
s_waitcnt vmcnt(6)
ds_write_b128 v4, a[0:3] offset:0
s_waitcnt vmcnt(2)
ds_write_b128 v4, a[4:7] offset:1024
v_add_u32 v4, 2048, v4
s_mov_b64 s[36:37], s[48:49]
v_add_u32 v176, 40960, v176
v_add_u32 v177, 40960, v177
v_add_u32 v178, 40960, v178
v_add_u32 v179, 40960, v179
s_add_u32 s27, s27, 1310720
s_add_u32 s28, s28, 1
s_cmp_lt_u32 s28, 2
s_cbranch_scc1 p1_37
s_lshl_b32 s18, s35, 2
s_add_u32 s18, s18, 5120
s_cmp_eq_u32 s13, 0
s_cselect_b32 s22, s18, s6
s_mov_b32 s23, 1
s_waitcnt vmcnt(0)
s_barrier
v_mov_b32 v3, s23
s_mov_b64 exec, 1
buffer_store_dword v3, off, s[4:7], s22 sc1
s_mov_b64 exec, -1
s_mov_b32 s22, s6
alay_38:
v_bfe_u32 v96, v0, 4, 4
v_lshrrev_b32 v97, 8, v0
v_lshlrev_b32 v97, 2, v97
v_lshl_add_u32 v98, s13, 4, v96
v_add_u32 v99, 0, v97
v_mul_u32_u24 v99, v99, v98
v_and_b32 v99, 63, v99
v_cvt_f32_u32 v99, v99
v_mul_f32 v99, 0x3c800000, v99
v_cos_f32 v104, v99
v_sin_f32 v112, v99
v_add_u32 v99, 1, v97
v_mul_u32_u24 v99, v99, v98
v_and_b32 v99, 63, v99
v_cvt_f32_u32 v99, v99
v_mul_f32 v99, 0x3c800000, v99
v_cos_f32 v105, v99
v_sin_f32 v113, v99
v_add_u32 v99, 2, v97
v_mul_u32_u24 v99, v99, v98
v_and_b32 v99, 63, v99
v_cvt_f32_u32 v99, v99
v_mul_f32 v99, 0x3c800000, v99
v_cos_f32 v106, v99
v_sin_f32 v114, v99
v_add_u32 v99, 3, v97
v_mul_u32_u24 v99, v99, v98
v_and_b32 v99, 63, v99
v_cvt_f32_u32 v99, v99
v_mul_f32 v99, 0x3c800000, v99
v_cos_f32 v107, v99
v_sin_f32 v115, v99
v_add_u32 v99, 16, v97
v_mul_u32_u24 v99, v99, v98
v_and_b32 v99, 63, v99
v_cvt_f32_u32 v99, v99
v_mul_f32 v99, 0x3c800000, v99
v_cos_f32 v108, v99
v_sin_f32 v116, v99
v_add_u32 v99, 17, v97
v_mul_u32_u24 v99, v99, v98
v_and_b32 v99, 63, v99
v_cvt_f32_u32 v99, v99
v_mul_f32 v99, 0x3c800000, v99
v_cos_f32 v109, v99
v_sin_f32 v117, v99
v_add_u32 v99, 18, v97
v_mul_u32_u24 v99, v99, v98
v_and_b32 v99, 63, v99
v_cvt_f32_u32 v99, v99
v_mul_f32 v99, 0x3c800000, v99
v_cos_f32 v110, v99
v_sin_f32 v118, v99
v_add_u32 v99, 19, v97
v_mul_u32_u24 v99, v99, v98
v_and_b32 v99, 63, v99
v_cvt_f32_u32 v99, v99
v_mul_f32 v99, 0x3c800000, v99
v_cos_f32 v111, v99
v_sin_f32 v119, v99
v_cvt_pk_bf16_f32 v16, v104, v105
v_cvt_pk_bf16_f32 v24, v112, v113
v_xor_b32 v32, 0x80008000, v24
v_cvt_pk_bf16_f32 v17, v106, v107
v_cvt_pk_bf16_f32 v25, v114, v115
v_xor_b32 v33, 0x80008000, v25
v_cvt_pk_bf16_f32 v18, v108, v109
v_cvt_pk_bf16_f32 v26, v116, v117
v_xor_b32 v34, 0x80008000, v26
v_cvt_pk_bf16_f32 v19, v110, v111
v_cvt_pk_bf16_f32 v27, v118, v119
v_xor_b32 v35, 0x80008000, v27
v_add_u32 v99, 32, v97
v_mul_u32_u24 v99, v99, v98
v_and_b32 v99, 63, v99
v_cvt_f32_u32 v99, v99
v_mul_f32 v99, 0x3c800000, v99
v_cos_f32 v104, v99
v_sin_f32 v112, v99
v_add_u32 v99, 33, v97
v_mul_u32_u24 v99, v99, v98
v_and_b32 v99, 63, v99
v_cvt_f32_u32 v99, v99
v_mul_f32 v99, 0x3c800000, v99
v_cos_f32 v105, v99
v_sin_f32 v113, v99
v_add_u32 v99, 34, v97
v_mul_u32_u24 v99, v99, v98
v_and_b32 v99, 63, v99
v_cvt_f32_u32 v99, v99
v_mul_f32 v99, 0x3c800000, v99
v_cos_f32 v106, v99
v_sin_f32 v114, v99
v_add_u32 v99, 35, v97
v_mul_u32_u24 v99, v99, v98
v_and_b32 v99, 63, v99
v_cvt_f32_u32 v99, v99
v_mul_f32 v99, 0x3c800000, v99
v_cos_f32 v107, v99
v_sin_f32 v115, v99
v_add_u32 v99, 48, v97
v_mul_u32_u24 v99, v99, v98
v_and_b32 v99, 63, v99
v_cvt_f32_u32 v99, v99
v_mul_f32 v99, 0x3c800000, v99
v_cos_f32 v108, v99
v_sin_f32 v116, v99
v_add_u32 v99, 49, v97
v_mul_u32_u24 v99, v99, v98
v_and_b32 v99, 63, v99
v_cvt_f32_u32 v99, v99
v_mul_f32 v99, 0x3c800000, v99
v_cos_f32 v109, v99
v_sin_f32 v117, v99
v_add_u32 v99, 50, v97
v_mul_u32_u24 v99, v99, v98
v_and_b32 v99, 63, v99
v_cvt_f32_u32 v99, v99
v_mul_f32 v99, 0x3c800000, v99
v_cos_f32 v110, v99
v_sin_f32 v118, v99
v_add_u32 v99, 51, v97
v_mul_u32_u24 v99, v99, v98
v_and_b32 v99, 63, v99
v_cvt_f32_u32 v99, v99
v_mul_f32 v99, 0x3c800000, v99
v_cos_f32 v111, v99
v_sin_f32 v119, v99
v_cvt_pk_bf16_f32 v20, v104, v105
v_cvt_pk_bf16_f32 v28, v112, v113
v_xor_b32 v36, 0x80008000, v28
v_cvt_pk_bf16_f32 v21, v106, v107
v_cvt_pk_bf16_f32 v29, v114, v115
v_xor_b32 v37, 0x80008000, v29
v_cvt_pk_bf16_f32 v22, v108, v109
v_cvt_pk_bf16_f32 v30, v116, v117
v_xor_b32 v38, 0x80008000, v30
v_cvt_pk_bf16_f32 v23, v110, v111
v_cvt_pk_bf16_f32 v31, v118, v119
v_xor_b32 v39, 0x80008000, v31
v_add_u32 v99, 0, v97
v_mul_u32_u24 v99, v99, v98
v_and_b32 v99, 2047, v99
v_cvt_f32_u32 v99, v99
v_mul_f32 v99, 0x3a000000, v99
v_cos_f32 v64, v99
v_sin_f32 v72, v99
v_add_u32 v99, 1, v97
v_mul_u32_u24 v99, v99, v98
v_and_b32 v99, 2047, v99
v_cvt_f32_u32 v99, v99
v_mul_f32 v99, 0x3a000000, v99
v_cos_f32 v65, v99
v_sin_f32 v73, v99
v_add_u32 v99, 2, v97
v_mul_u32_u24 v99, v99, v98
v_and_b32 v99, 2047, v99
v_cvt_f32_u32 v99, v99
v_mul_f32 v99, 0x3a000000, v99
v_cos_f32 v66, v99
v_sin_f32 v74, v99
v_add_u32 v99, 3, v97
v_mul_u32_u24 v99, v99, v98
v_and_b32 v99, 2047, v99
v_cvt_f32_u32 v99, v99
v_mul_f32 v99, 0x3a000000, v99
v_cos_f32 v67, v99
v_sin_f32 v75, v99
v_add_u32 v99, 16, v97
v_mul_u32_u24 v99, v99, v98
v_and_b32 v99, 2047, v99
v_cvt_f32_u32 v99, v99
v_mul_f32 v99, 0x3a000000, v99
v_cos_f32 v68, v99
v_sin_f32 v76, v99
v_add_u32 v99, 17, v97
v_mul_u32_u24 v99, v99, v98
v_and_b32 v99, 2047, v99
v_cvt_f32_u32 v99, v99
v_mul_f32 v99, 0x3a000000, v99
v_cos_f32 v69, v99
v_sin_f32 v77, v99
v_add_u32 v99, 18, v97
v_mul_u32_u24 v99, v99, v98
v_and_b32 v99, 2047, v99
v_cvt_f32_u32 v99, v99
v_mul_f32 v99, 0x3a000000, v99
v_cos_f32 v70, v99
v_sin_f32 v78, v99
v_add_u32 v99, 19, v97
v_mul_u32_u24 v99, v99, v98
v_and_b32 v99, 2047, v99
v_cvt_f32_u32 v99, v99
v_mul_f32 v99, 0x3a000000, v99
v_cos_f32 v71, v99
v_sin_f32 v79, v99
v_lshl_add_u32 v100, s13, 4, v97
v_add_u32 v98, 0, v96
v_add_u32 v99, 0, v97
v_mul_u32_u24 v99, v99, v98
v_and_b32 v99, 31, v99
v_cvt_f32_u32 v99, v99
v_mul_f32 v99, 0x3d000000, v99
v_cos_f32 v104, v99
v_sin_f32 v112, v99
v_add_u32 v99, 1, v97
v_mul_u32_u24 v99, v99, v98
v_and_b32 v99, 31, v99
v_cvt_f32_u32 v99, v99
v_mul_f32 v99, 0x3d000000, v99
v_cos_f32 v105, v99
v_sin_f32 v113, v99
v_add_u32 v99, 2, v97
v_mul_u32_u24 v99, v99, v98
v_and_b32 v99, 31, v99
v_cvt_f32_u32 v99, v99
v_mul_f32 v99, 0x3d000000, v99
v_cos_f32 v106, v99
v_sin_f32 v114, v99
v_add_u32 v99, 3, v97
v_mul_u32_u24 v99, v99, v98
v_and_b32 v99, 31, v99
v_cvt_f32_u32 v99, v99
v_mul_f32 v99, 0x3d000000, v99
v_cos_f32 v107, v99
v_sin_f32 v115, v99
v_add_u32 v99, 16, v97
v_mul_u32_u24 v99, v99, v98
v_and_b32 v99, 31, v99
v_cvt_f32_u32 v99, v99
v_mul_f32 v99, 0x3d000000, v99
v_cos_f32 v108, v99
v_sin_f32 v116, v99
v_add_u32 v99, 17, v97
v_mul_u32_u24 v99, v99, v98
v_and_b32 v99, 31, v99
v_cvt_f32_u32 v99, v99
v_mul_f32 v99, 0x3d000000, v99
v_cos_f32 v109, v99
v_sin_f32 v117, v99
v_add_u32 v99, 18, v97
v_mul_u32_u24 v99, v99, v98
v_and_b32 v99, 31, v99
v_cvt_f32_u32 v99, v99
v_mul_f32 v99, 0x3d000000, v99
v_cos_f32 v110, v99
v_sin_f32 v118, v99
v_add_u32 v99, 19, v97
v_mul_u32_u24 v99, v99, v98
v_and_b32 v99, 31, v99
v_cvt_f32_u32 v99, v99
v_mul_f32 v99, 0x3d000000, v99
v_cos_f32 v111, v99
v_sin_f32 v119, v99
v_cvt_pk_bf16_f32 v40, v104, v105
v_cvt_pk_bf16_f32 v48, v112, v113
v_xor_b32 v56, 0x80008000, v48
v_cvt_pk_bf16_f32 v41, v106, v107
v_cvt_pk_bf16_f32 v49, v114, v115
v_xor_b32 v57, 0x80008000, v49
v_cvt_pk_bf16_f32 v42, v108, v109
v_cvt_pk_bf16_f32 v50, v116, v117
v_xor_b32 v58, 0x80008000, v50
v_cvt_pk_bf16_f32 v43, v110, v111
v_cvt_pk_bf16_f32 v51, v118, v119
v_xor_b32 v59, 0x80008000, v51
v_add_u32 v99, 0, v100
v_mul_u32_u24 v99, v99, v98
v_and_b32 v99, 2047, v99
v_cvt_f32_u32 v99, v99
v_mul_f32 v99, 0x3a000000, v99
v_cos_f32 v80, v99
v_sin_f32 v88, v99
v_mul_f32 v80, 0x3a000000, v80
v_mul_f32 v88, 0x3a000000, v88
v_add_u32 v99, 1, v100
v_mul_u32_u24 v99, v99, v98
v_and_b32 v99, 2047, v99
v_cvt_f32_u32 v99, v99
v_mul_f32 v99, 0x3a000000, v99
v_cos_f32 v81, v99
v_sin_f32 v89, v99
v_mul_f32 v81, 0x3a000000, v81
v_mul_f32 v89, 0x3a000000, v89
v_add_u32 v99, 2, v100
v_mul_u32_u24 v99, v99, v98
v_and_b32 v99, 2047, v99
v_cvt_f32_u32 v99, v99
v_mul_f32 v99, 0x3a000000, v99
v_cos_f32 v82, v99
v_sin_f32 v90, v99
v_mul_f32 v82, 0x3a000000, v82
v_mul_f32 v90, 0x3a000000, v90
v_add_u32 v99, 3, v100
v_mul_u32_u24 v99, v99, v98
v_and_b32 v99, 2047, v99
v_cvt_f32_u32 v99, v99
v_mul_f32 v99, 0x3a000000, v99
v_cos_f32 v83, v99
v_sin_f32 v91, v99
v_mul_f32 v83, 0x3a000000, v83
v_mul_f32 v91, 0x3a000000, v91
v_add_u32 v98, 16, v96
v_add_u32 v99, 0, v97
v_mul_u32_u24 v99, v99, v98
v_and_b32 v99, 31, v99
v_cvt_f32_u32 v99, v99
v_mul_f32 v99, 0x3d000000, v99
v_cos_f32 v104, v99
v_sin_f32 v112, v99
v_add_u32 v99, 1, v97
v_mul_u32_u24 v99, v99, v98
v_and_b32 v99, 31, v99
v_cvt_f32_u32 v99, v99
v_mul_f32 v99, 0x3d000000, v99
v_cos_f32 v105, v99
v_sin_f32 v113, v99
v_add_u32 v99, 2, v97
v_mul_u32_u24 v99, v99, v98
v_and_b32 v99, 31, v99
v_cvt_f32_u32 v99, v99
v_mul_f32 v99, 0x3d000000, v99
v_cos_f32 v106, v99
v_sin_f32 v114, v99
v_add_u32 v99, 3, v97
v_mul_u32_u24 v99, v99, v98
v_and_b32 v99, 31, v99
v_cvt_f32_u32 v99, v99
v_mul_f32 v99, 0x3d000000, v99
v_cos_f32 v107, v99
v_sin_f32 v115, v99
v_add_u32 v99, 16, v97
v_mul_u32_u24 v99, v99, v98
v_and_b32 v99, 31, v99
v_cvt_f32_u32 v99, v99
v_mul_f32 v99, 0x3d000000, v99
v_cos_f32 v108, v99
v_sin_f32 v116, v99
v_add_u32 v99, 17, v97
v_mul_u32_u24 v99, v99, v98
v_and_b32 v99, 31, v99
v_cvt_f32_u32 v99, v99
v_mul_f32 v99, 0x3d000000, v99
v_cos_f32 v109, v99
v_sin_f32 v117, v99
v_add_u32 v99, 18, v97
v_mul_u32_u24 v99, v99, v98
v_and_b32 v99, 31, v99
v_cvt_f32_u32 v99, v99
v_mul_f32 v99, 0x3d000000, v99
v_cos_f32 v110, v99
v_sin_f32 v118, v99
v_add_u32 v99, 19, v97
v_mul_u32_u24 v99, v99, v98
v_and_b32 v99, 31, v99
v_cvt_f32_u32 v99, v99
v_mul_f32 v99, 0x3d000000, v99
v_cos_f32 v111, v99
v_sin_f32 v119, v99
v_cvt_pk_bf16_f32 v44, v104, v105
v_cvt_pk_bf16_f32 v52, v112, v113
v_xor_b32 v60, 0x80008000, v52
v_cvt_pk_bf16_f32 v45, v106, v107
v_cvt_pk_bf16_f32 v53, v114, v115
v_xor_b32 v61, 0x80008000, v53
v_cvt_pk_bf16_f32 v46, v108, v109
v_cvt_pk_bf16_f32 v54, v116, v117
v_xor_b32 v62, 0x80008000, v54
v_cvt_pk_bf16_f32 v47, v110, v111
v_cvt_pk_bf16_f32 v55, v118, v119
v_xor_b32 v63, 0x80008000, v55
v_add_u32 v99, 0, v100
v_mul_u32_u24 v99, v99, v98
v_and_b32 v99, 2047, v99
v_cvt_f32_u32 v99, v99
v_mul_f32 v99, 0x3a000000, v99
v_cos_f32 v84, v99
v_sin_f32 v92, v99
v_mul_f32 v84, 0x3a000000, v84
v_mul_f32 v92, 0x3a000000, v92
v_add_u32 v99, 1, v100
v_mul_u32_u24 v99, v99, v98
v_and_b32 v99, 2047, v99
v_cvt_f32_u32 v99, v99
v_mul_f32 v99, 0x3a000000, v99
v_cos_f32 v85, v99
v_sin_f32 v93, v99
v_mul_f32 v85, 0x3a000000, v85
v_mul_f32 v93, 0x3a000000, v93
v_add_u32 v99, 2, v100
v_mul_u32_u24 v99, v99, v98
v_and_b32 v99, 2047, v99
v_cvt_f32_u32 v99, v99
v_mul_f32 v99, 0x3a000000, v99
v_cos_f32 v86, v99
v_sin_f32 v94, v99
v_mul_f32 v86, 0x3a000000, v86
v_mul_f32 v94, 0x3a000000, v94
v_add_u32 v99, 3, v100
v_mul_u32_u24 v99, v99, v98
v_and_b32 v99, 2047, v99
v_cvt_f32_u32 v99, v99
v_mul_f32 v99, 0x3a000000, v99
v_cos_f32 v87, v99
v_sin_f32 v95, v99
v_mul_f32 v87, 0x3a000000, v87
v_mul_f32 v95, 0x3a000000, v95
v_lshrrev_b32 v98, 6, v0
v_and_b32 v99, 7, v98
v_lshlrev_b32 v99, 5, v99
v_lshl_add_u32 v98, v98, 8, v99
v_and_b32 v99, 16, v0
v_add_u32 v98, v98, v99
v_bfe_u32 v99, v0, 5, 1
v_lshl_add_u32 v224, v99, 3, v98
v_xor_b32 v225, 32, v224
v_xor_b32 v226, 64, v224
v_xor_b32 v227, 96, v224
v_xor_b32 v228, 128, v224
v_xor_b32 v229, 160, v224
v_xor_b32 v230, 192, v224
v_xor_b32 v231, 224, v224
v_lshrrev_b32 v98, 8, v0
v_bfe_u32 v99, v0, 5, 3
v_xor_b32 v99, v99, v98
v_mul_u32_u24 v98, 40960, v98
v_and_b32 v96, 16, v0
v_add_u32 v98, v98, v96
v_and_b32 v96, 3, v99
v_lshl_add_u32 v98, v96, 5, v98
v_lshrrev_b32 v99, 2, v99
v_lshl_add_u32 v232, v99, 10, v98
v_xor_b32 v99, 1, v99
v_lshl_add_u32 v233, v99, 10, v98
s_lshl_b32 s18, s13, 12
s_add_u32 s19, s18, 147456
v_add_u32 v99, s19, v0
ds_read_b128 v[208:211], v99 offset:0
ds_read_b128 v[212:215], v99 offset:1024
ds_read_b128 v[216:219], v99 offset:2048
ds_read_b128 v[220:223], v99 offset:3072
s_mov_b32 s25, s18
s_mul_i32 s26, s16, 3145728
s_mul_i32 s19, s13, 655360
s_add_u32 s26, s26, s19
s_lshl_b32 s19, s35, 8
s_add_u32 s27, s26, s19
s_add_u32 s27, s27, 103809024
s_lshr_b32 s19, s35, 3
s_lshl_b32 s19, s19, 11
s_add_u32 s26, s26, s19
s_and_b32 s19, s35, 7
s_lshl_b32 s19, s19, 7
s_add_u32 s26, s26, s19
s_add_u32 s26, s26, 97517568
s_cmp_lg_u32 s16, 0
s_cbranch_scc1 cw_39
s_cmp_lg_u32 s13, 0
s_cbranch_scc1 polld_42
v_min_u32 v12, 624, v0
s_mov_b32 s21, 5120
s_mov_b32 s17, 0
poll_41:
buffer_load_dwordx4 v[8:11], v12, s[4:7], s21 offen offset:0 sc1
s_add_u32 s17, s17, 1
s_cmp_gt_u32 s17, 262144
s_cbranch_scc1 L_fail
s_waitcnt vmcnt(0)
v_min3_u32 v8, v8, v9, v10
v_min_u32 v8, v8, v11
v_cmp_gt_u32 vcc, 1, v8
s_cbranch_vccz polld_42
s_sleep 2
s_branch poll_41
polld_42:
s_barrier
s_branch cw_40
cw_39:
s_cmp_lg_u32 s13, 0
s_cbranch_scc1 polld_44
v_lshrrev_b32 v12, 2, v0
v_min_u32 v12, 136, v12
s_mov_b32 s21, 6144
s_mov_b32 s17, 0
poll_43:
buffer_load_dword v8, v12, s[4:7], s21 offen offset:0 sc1
s_add_u32 s17, s17, 1
s_cmp_gt_u32 s17, 262144
s_cbranch_scc1 L_fail
s_waitcnt vmcnt(0)
v_cmp_gt_u32 vcc, 1, v8
s_cbranch_vccz polld_44
s_sleep 2
s_branch poll_43
polld_44:
s_barrier
cw_40:
s_add_u32 m0, s25, 0
s_add_u32 s20, s26, 0
buffer_load_dwordx4 v232, s[4:7], s20 offen sc1 lds
s_add_u32 m0, s25, 1024
s_add_u32 s20, s26, 163840
buffer_load_dwordx4 v233, s[4:7], s20 offen sc1 lds
s_add_u32 m0, s25, 2048
s_add_u32 s20, s26, 327680
buffer_load_dwordx4 v232, s[4:7], s20 offen sc1 lds
s_add_u32 m0, s25, 3072
s_add_u32 s20, s26, 491520
buffer_load_dwordx4 v233, s[4:7], s20 offen sc1 lds
s_lshr_b32 s18, s13, 1
s_lshl_b32 s18, s18, 10
s_and_b32 s19, s13, 1
s_lshl_b32 s19, s19, 3
s_add_u32 s18, s18, s19
v_add_u32 v234, s18, v0
v_bfe_u32 v235, v0, 4, 4
v_mul_u32_u24 v235, 40960, v235
v_lshrrev_b32 v99, 8, v0
v_lshl_add_u32 v235, v99, 4, v235
s_waitcnt vmcnt(0)
s_barrier
ds_read_b64_tr_b16 v[96:97], v224 offset:0
ds_read_b64_tr_b16 v[98:99], v224 offset:4096
ds_read_b64_tr_b16 v[114:115], v225 offset:4096
ds_read_b64_tr_b16 v[112:113], v225 offset:0
ds_read_b64_tr_b16 v[118:119], v225 offset:12288
ds_read_b64_tr_b16 v[102:103], v224 offset:12288
ds_read_b64_tr_b16 v[124:125], v229 offset:8192
ds_read_b64_tr_b16 v[100:101], v224 offset:8192
ds_read_b64_tr_b16 v[116:117], v225 offset:8192
ds_read_b64_tr_b16 v[120:121], v229 offset:0
ds_read_b64_tr_b16 v[122:123], v229 offset:4096
ds_read_b64_tr_b16 v[106:107], v228 offset:4096
ds_read_b64_tr_b16 v[142:143], v230 offset:12288
ds_read_b64_tr_b16 v[110:111], v228 offset:12288
ds_read_b64_tr_b16 v[104:105], v228 offset:0
ds_read_b64_tr_b16 v[156:157], v231 offset:8192
s_waitcnt lgkmcnt(14)
v_mfma_f32_16x16x32_bf16 v[160:163], v[96:99], v[16:19], 0
s_waitcnt lgkmcnt(13)
ds_read_b64_tr_b16 v[126:127], v229 offset:12288
s_waitcnt lgkmcnt(13)
v_mfma_f32_16x16x32_bf16 v[168:171], v[112:115], v[16:19], 0
s_waitcnt lgkmcnt(12)
ds_read_b64_tr_b16 v[108:109], v228 offset:8192
ds_read_b64_tr_b16 v[132:133], v226 offset:8192
v_mfma_f32_16x16x32_bf16 v[160:163], v[112:115], v[24:27], v[160:163]
ds_read_b64_tr_b16 v[146:147], v227 offset:4096
ds_read_b64_tr_b16 v[138:139], v230 offset:4096
v_mfma_f32_16x16x32_bf16 v[168:171], v[96:99], v[32:35], v[168:171]
s_waitcnt lgkmcnt(13)
ds_read_b64_tr_b16 v[154:155], v231 offset:4096
ds_read_b64_tr_b16 v[136:137], v230 offset:0
v_mfma_f32_16x16x32_bf16 v[160:163], v[100:103], v[20:23], v[160:163]
s_waitcnt lgkmcnt(12)
ds_read_b64_tr_b16 v[128:129], v226 offset:0
v_and_b32 v112, 0xffff0000, v208
v_mfma_f32_16x16x32_bf16 v[160:163], v[116:119], v[28:31], v[160:163]
ds_read_b64_tr_b16 v[158:159], v231 offset:12288
ds_read_b64_tr_b16 v[130:131], v226 offset:4096
v_mfma_f32_16x16x32_bf16 v[168:171], v[116:119], v[20:23], v[168:171]
ds_read_b64_tr_b16 v[150:151], v227 offset:12288
v_lshlrev_b32 v98, 16, v209
v_mfma_f32_16x16x32_bf16 v[168:171], v[100:103], v[36:39], v[168:171]
s_waitcnt lgkmcnt(12)
ds_read_b64_tr_b16 v[144:145], v227 offset:0
v_mul_f32 v232, v160, v72
v_mfma_f32_16x16x32_bf16 v[172:175], v[120:123], v[16:19], 0
s_waitcnt lgkmcnt(9)
ds_read_b64_tr_b16 v[148:149], v227 offset:8192
ds_read_b64_tr_b16 v[134:135], v226 offset:12288
v_mfma_f32_16x16x32_bf16 v[172:175], v[104:107], v[32:35], v[172:175]
v_and_b32 v113, 0xffff0000, v216
v_mul_f32 v160, v160, v64
v_mfma_f32_16x16x32_bf16 v[164:167], v[104:107], v[16:19], 0
s_waitcnt lgkmcnt(7)
v_mul_f32 v233, v161, v73
v_fma_f32 v160, v168, v72, v160
v_mfma_f32_16x16x32_bf16 v[172:175], v[124:127], v[20:23], v[172:175]
s_waitcnt lgkmcnt(6)
ds_read_b64_tr_b16 v[140:141], v230 offset:8192
v_fma_f32 v168, v168, v64, -v232
v_mfma_f32_16x16x32_bf16 v[172:175], v[108:111], v[36:39], v[172:175]
v_mul_f32 v232, v162, v74
v_mul_f32 v161, v161, v65
v_mfma_f32_16x16x32_bf16 v[164:167], v[120:123], v[24:27], v[164:167]
ds_read_b64_tr_b16 v[152:153], v231 offset:0
v_fma_f32 v161, v169, v73, v161
v_mfma_f32_16x16x32_bf16 v[164:167], v[108:111], v[20:23], v[164:167]
v_fma_f32 v169, v169, v65, -v233
v_mul_f32 v233, v163, v75
v_mfma_f32_16x16x32_bf16 v[164:167], v[124:127], v[28:31], v[164:167]
s_waitcnt lgkmcnt(4)
v_mul_f32 v162, v162, v66
v_mul_f32 v163, v163, v67
v_mfma_f32_16x16x32_bf16 v[180:183], v[136:139], v[16:19], 0
s_waitcnt lgkmcnt(2)
v_fma_f32 v163, v171, v75, v163
v_fma_f32 v162, v170, v74, v162
v_mfma_f32_16x16x32_bf16 v[184:187], v[144:147], v[16:19], 0
s_waitcnt lgkmcnt(0)
v_fma_f32 v171, v171, v67, -v233
v_mul_f32 v233, v165, v77
v_mfma_f32_16x16x32_bf16 v[188:191], v[152:155], v[16:19], 0
v_fma_f32 v170, v170, v66, -v232
v_cvt_pk_bf16_f32 v193, v162, v163
v_mfma_f32_16x16x32_bf16 v[176:179], v[128:131], v[16:19], 0
v_mul_f32 v232, v164, v76
v_mul_f32 v164, v164, v68
v_mfma_f32_16x16x32_bf16 v[184:187], v[128:131], v[32:35], v[184:187]
v_fma_f32 v164, v172, v76, v164
v_fma_f32 v172, v172, v68, -v232
v_mfma_f32_16x16x32_bf16 v[184:187], v[148:151], v[20:23], v[184:187]
v_mul_f32 v165, v165, v69
v_fma_f32 v165, v173, v77, v165
v_mfma_f32_16x16x32_bf16 v[176:179], v[144:147], v[24:27], v[176:179]
v_mul_f32 v232, v166, v78
v_lshlrev_b32 v100, 16, v210
v_mfma_f32_16x16x32_bf16 v[176:179], v[132:135], v[20:23], v[176:179]
v_fma_f32 v173, v173, v69, -v233
v_mul_f32 v233, v167, v79
v_mfma_f32_16x16x32_bf16 v[176:179], v[148:151], v[28:31], v[176:179]
v_cvt_pk_bf16_f32 v194, v164, v165
v_mul_f32 v166, v166, v70
v_mfma_f32_16x16x32_bf16 v[180:183], v[152:155], v[24:27], v[180:183]
v_mul_f32 v167, v167, v71
v_fma_f32 v166, v174, v78, v166
v_mfma_f32_16x16x32_bf16 v[180:183], v[140:143], v[20:23], v[180:183]
v_fma_f32 v167, v175, v79, v167
v_cvt_pk_bf16_f32 v196, v168, v169
v_mfma_f32_16x16x32_bf16 v[184:187], v[132:135], v[36:39], v[184:187]
v_cvt_pk_bf16_f32 v192, v160, v161
v_fma_f32 v174, v174, v70, -v232
v_mfma_f32_16x16x32_bf16 v[188:191], v[136:139], v[32:35], v[188:191]
v_cvt_pk_bf16_f32 v198, v172, v173
v_fma_f32 v175, v175, v71, -v233
v_mfma_f32_16x16x32_bf16 v[180:183], v[156:159], v[28:31], v[180:183]
v_cvt_pk_bf16_f32 v197, v170, v171
v_cvt_pk_bf16_f32 v199, v174, v175
v_mfma_f32_16x16x32_bf16 v[188:191], v[156:159], v[20:23], v[188:191]
v_mul_f32 v233, v177, v73
v_mul_f32 v177, v177, v65
v_mfma_f32_16x16x32_bf16 v[168:171], v[40:43], v[196:199], 0
v_cvt_pk_bf16_f32 v195, v166, v167
v_mul_f32 v232, v176, v72
v_mfma_f32_16x16x32_bf16 v[172:175], v[44:47], v[196:199], 0
v_mul_f32 v176, v176, v64
v_fma_f32 v177, v185, v73, v177
v_mfma_f32_16x16x32_bf16 v[188:191], v[140:143], v[36:39], v[188:191]
v_lshlrev_b32 v97, 16, v216
v_fma_f32 v176, v184, v72, v176
v_mfma_f32_16x16x32_bf16 v[168:171], v[56:59], v[192:195], v[168:171]
v_fma_f32 v184, v184, v64, -v232
v_mul_f32 v232, v178, v74
v_mfma_f32_16x16x32_bf16 v[160:163], v[40:43], v[192:195], 0
v_fma_f32 v185, v185, v65, -v233
v_mul_f32 v178, v178, v66
v_mfma_f32_16x16x32_bf16 v[160:163], v[48:51], v[196:199], v[160:163]
v_fma_f32 v178, v186, v74, v178
v_fma_f32 v186, v186, v66, -v232
v_mfma_f32_16x16x32_bf16 v[164:167], v[44:47], v[192:195], 0
v_mul_f32 v232, v180, v76
v_mul_f32 v180, v180, v68
v_mul_f32 v233, v179, v75
v_mfma_f32_16x16x32_bf16 v[172:175], v[60:63], v[192:195], v[172:175]
v_mul_f32 v179, v179, v67
v_cvt_pk_bf16_f32 v200, v176, v177
v_mfma_f32_16x16x32_bf16 v[164:167], v[52:55], v[196:199], v[164:167]
v_fma_f32 v179, v187, v75, v179
v_fma_f32 v187, v187, v67, -v233
v_fma_f32 v180, v188, v76, v180
v_mul_f32 v233, v181, v77
v_cvt_pk_bf16_f32 v204, v184, v185
v_mul_f32 v181, v181, v69
v_lshlrev_b32 v102, 16, v211
v_fma_f32 v188, v188, v68, -v232
v_cvt_pk_bf16_f32 v205, v186, v187
v_mul_f32 v232, v182, v78
v_cvt_pk_bf16_f32 v201, v178, v179
v_mul_f32 v182, v182, v70
v_fma_f32 v181, v189, v77, v181
v_fma_f32 v189, v189, v69, -v233
v_mul_f32 v233, v183, v79
v_fma_f32 v182, v190, v78, v182
v_cvt_pk_bf16_f32 v202, v180, v181
v_lshlrev_b32 v99, 16, v217
v_mul_f32 v183, v183, v71
v_fma_f32 v183, v191, v79, v183
v_cvt_pk_bf16_f32 v203, v182, v183
v_lshlrev_b32 v106, 16, v213
v_fma_f32 v191, v191, v71, -v233
v_fma_f32 v190, v190, v70, -v232
v_lshlrev_b32 v96, 16, v208
v_mfma_f32_16x16x32_bf16 v[176:179], v[40:43], v[200:203], 0
v_cvt_pk_bf16_f32 v207, v190, v191
v_lshlrev_b32 v103, 16, v219
v_mfma_f32_16x16x32_bf16 v[180:183], v[44:47], v[200:203], 0
v_mul_f32 v232, v160, v97
v_cvt_pk_bf16_f32 v206, v188, v189
v_mul_f32 v233, v161, v99
v_mul_f32 v161, v161, v98
v_mfma_f32_16x16x32_bf16 v[188:191], v[44:47], v[204:207], 0
v_and_b32 v117, 0xffff0000, v218
v_lshlrev_b32 v105, 16, v220
v_mfma_f32_16x16x32_bf16 v[184:187], v[40:43], v[204:207], 0
v_lshlrev_b32 v104, 16, v212
v_lshlrev_b32 v109, 16, v222
v_mfma_f32_16x16x32_bf16 v[180:183], v[52:55], v[204:207], v[180:183]
v_lshlrev_b32 v101, 16, v218
v_lshlrev_b32 v107, 16, v221
v_fma_f32 v161, v169, -v99, v161
v_mfma_f32_16x16x32_bf16 v[184:187], v[56:59], v[200:203], v[184:187]
v_lshlrev_b32 v108, 16, v214
v_lshlrev_b32 v111, 16, v223
v_fma_f32 v169, v169, v98, v233
v_mul_f32 v160, v160, v96
v_fma_f32 v160, v168, -v97, v160
v_fma_f32 v168, v168, v96, v232
v_mul_f32 v233, v163, v103
v_mul_f32 v232, v162, v101
v_mfma_f32_16x16x32_bf16 v[176:179], v[48:51], v[204:207], v[176:179]
v_mul_f32 v162, v162, v100
v_fma_f32 v162, v170, -v101, v162
v_mul_f32 v163, v163, v102
v_fma_f32 v163, v171, -v103, v163
v_cvt_pk_bf16_f32 v193, v162, v163
v_mfma_f32_16x16x32_bf16 v[188:191], v[60:63], v[200:203], v[188:191]
v_fma_f32 v170, v170, v100, v232
v_fma_f32 v171, v171, v102, v233
v_mul_f32 v233, v165, v107
v_mul_f32 v232, v164, v105
v_lshlrev_b32 v110, 16, v215
v_cvt_pk_bf16_f32 v192, v160, v161
v_cvt_pk_bf16_f32 v197, v170, v171
v_mul_f32 v165, v165, v106
v_mul_f32 v164, v164, v104
v_fma_f32 v164, v172, -v105, v164
v_fma_f32 v172, v172, v104, v232
v_fma_f32 v165, v173, -v107, v165
v_fma_f32 v173, v173, v106, v233
v_mul_f32 v233, v167, v111
v_mul_f32 v232, v166, v109
v_cvt_pk_bf16_f32 v194, v164, v165
v_mul_f32 v167, v167, v110
v_fma_f32 v167, v175, -v111, v167
v_mul_f32 v166, v166, v108
v_fma_f32 v166, v174, -v109, v166
v_cvt_pk_bf16_f32 v195, v166, v167
v_fma_f32 v175, v175, v110, v233
v_cvt_pk_bf16_f32 v198, v172, v173
v_mfma_f32_16x16x32_bf16 v[160:163], v[192:195], v[40:43], 0
v_fma_f32 v174, v174, v108, v232
v_cvt_pk_bf16_f32 v196, v168, v169
v_cvt_pk_bf16_f32 v199, v174, v175
v_and_b32 v115, 0xffff0000, v217
v_and_b32 v114, 0xffff0000, v209
v_and_b32 v119, 0xffff0000, v219
v_mul_f32 v232, v176, v113
v_mfma_f32_16x16x32_bf16 v[164:167], v[192:195], v[44:47], 0
v_and_b32 v127, 0xffff0000, v223
v_mul_f32 v233, v177, v115
v_mfma_f32_16x16x32_bf16 v[172:175], v[196:199], v[44:47], 0
v_mul_f32 v176, v176, v112
v_and_b32 v118, 0xffff0000, v211
v_mfma_f32_16x16x32_bf16 v[160:163], v[196:199], v[56:59], v[160:163]
v_and_b32 v121, 0xffff0000, v220
v_and_b32 v116, 0xffff0000, v210
v_and_b32 v124, 0xffff0000, v214
v_mul_f32 v177, v177, v114
v_fma_f32 v176, v184, -v113, v176
v_mfma_f32_16x16x32_bf16 v[168:171], v[196:199], v[40:43], 0
v_fma_f32 v177, v185, -v115, v177
v_fma_f32 v184, v184, v112, v232
v_mfma_f32_16x16x32_bf16 v[172:175], v[192:195], v[52:55], v[172:175]
v_fma_f32 v185, v185, v114, v233
v_mul_f32 v232, v178, v117
v_mfma_f32_16x16x32_bf16 v[164:167], v[196:199], v[60:63], v[164:167]
v_mul_f32 v178, v178, v116
v_cvt_pk_bf16_f32 v200, v176, v177
v_mfma_f32_16x16x32_bf16 v[168:171], v[192:195], v[48:51], v[168:171]
v_and_b32 v123, 0xffff0000, v221
v_mul_f32 v233, v179, v119
v_mul_f32 v179, v179, v118
v_and_b32 v122, 0xffff0000, v213
v_fma_f32 v179, v187, -v119, v179
v_fma_f32 v187, v187, v118, v233
v_fma_f32 v178, v186, -v117, v178
v_mul_f32 v233, v181, v123
v_and_b32 v126, 0xffff0000, v215
v_and_b32 v120, 0xffff0000, v212
v_fma_f32 v186, v186, v116, v232
v_and_b32 v125, 0xffff0000, v222
v_cvt_pk_bf16_f32 v205, v186, v187
v_mul_f32 v181, v181, v122
v_fma_f32 v181, v189, -v123, v181
v_fma_f32 v189, v189, v122, v233
v_mul_f32 v232, v180, v121
v_mul_f32 v180, v180, v120
v_mul_f32 v233, v183, v127
v_mul_f32 v183, v183, v126
v_fma_f32 v183, v191, -v127, v183
v_fma_f32 v180, v188, -v121, v180
v_fma_f32 v191, v191, v126, v233
v_fma_f32 v188, v188, v120, v232
v_mul_f32 v232, v182, v125
v_mul_f32 v233, v161, v89
v_mul_f32 v182, v182, v124
v_fma_f32 v182, v190, -v125, v182
v_cvt_pk_bf16_f32 v206, v188, v189
v_cvt_pk_bf16_f32 v204, v184, v185
v_cvt_pk_bf16_f32 v201, v178, v179
v_fma_f32 v190, v190, v124, v232
v_cvt_pk_bf16_f32 v207, v190, v191
v_mul_f32 v232, v160, v88
v_mul_f32 v160, v160, v80
v_mfma_f32_16x16x32_bf16 v[188:191], v[204:207], v[44:47], 0
v_fma_f32 v160, v168, -v88, v160
v_fma_f32 v168, v168, v80, v232
v_mul_f32 v232, v162, v90
v_mul_f32 v161, v161, v81
v_cvt_pk_bf16_f32 v203, v182, v183
v_mfma_f32_16x16x32_bf16 v[184:187], v[204:207], v[40:43], 0
v_fma_f32 v161, v169, -v89, v161
v_cvt_pk_bf16_f32 v202, v180, v181
v_fma_f32 v169, v169, v81, v233
v_mul_f32 v162, v162, v82
v_mfma_f32_16x16x32_bf16 v[180:183], v[200:203], v[44:47], 0
v_fma_f32 v162, v170, -v90, v162
v_mul_f32 v233, v163, v91
v_mfma_f32_16x16x32_bf16 v[176:179], v[200:203], v[40:43], 0
v_fma_f32 v170, v170, v82, v232
v_mul_f32 v163, v163, v83
v_mfma_f32_16x16x32_bf16 v[184:187], v[200:203], v[48:51], v[184:187]
v_fma_f32 v163, v171, -v91, v163
v_mul_f32 v232, v164, v92
v_mul_f32 v164, v164, v84
v_mfma_f32_16x16x32_bf16 v[176:179], v[204:207], v[56:59], v[176:179]
v_fma_f32 v171, v171, v83, v233
v_fma_f32 v164, v172, -v92, v164
v_mul_f32 v233, v165, v93
v_mul_f32 v165, v165, v85
v_fma_f32 v165, v173, -v93, v165
v_cvt_pk_bf16_f32 v192, v160, v161
v_mfma_f32_16x16x32_bf16 v[188:191], v[200:203], v[52:55], v[188:191]
v_fma_f32 v173, v173, v85, v233
v_mul_f32 v233, v167, v95
v_mul_f32 v167, v167, v87
v_fma_f32 v172, v172, v84, v232
v_cvt_pk_bf16_f32 v196, v168, v169
v_mul_f32 v232, v166, v94
v_cvt_pk_bf16_f32 v193, v162, v163
v_fma_f32 v167, v175, -v95, v167
v_mul_f32 v166, v166, v86
v_fma_f32 v166, v174, -v94, v166
v_fma_f32 v174, v174, v86, v232
v_mul_f32 v232, v176, v88
v_mul_f32 v176, v176, v80
v_cvt_pk_bf16_f32 v197, v170, v171
v_cvt_pk_bf16_f32 v195, v166, v167
v_fma_f32 v175, v175, v87, v233
v_mul_f32 v233, v177, v89
v_cvt_pk_bf16_f32 v199, v174, v175
v_cvt_pk_bf16_f32 v198, v172, v173
v_fma_f32 v176, v184, -v88, v176
v_mul_f32 v177, v177, v81
v_fma_f32 v177, v185, -v89, v177
v_mfma_f32_16x16x32_bf16 v[180:183], v[204:207], v[60:63], v[180:183]
ds_write_b64 v234, v[198:199] offset:22528
ds_write_b64 v234, v[192:193] offset:16384
ds_write_b64 v234, v[196:197] offset:20480
v_fma_f32 v185, v185, v81, v233
v_fma_f32 v184, v184, v80, v232
v_cvt_pk_bf16_f32 v200, v176, v177
v_mul_f32 v232, v178, v90
v_mul_f32 v233, v179, v91
v_mul_f32 v179, v179, v83
v_mul_f32 v178, v178, v82
v_fma_f32 v179, v187, -v91, v179
v_fma_f32 v178, v186, -v90, v178
v_fma_f32 v186, v186, v82, v232
v_cvt_pk_bf16_f32 v194, v164, v165
v_fma_f32 v187, v187, v83, v233
v_mul_f32 v233, v181, v93
v_mul_f32 v181, v181, v85
v_mul_f32 v232, v180, v92
v_fma_f32 v181, v189, -v93, v181
v_cvt_pk_bf16_f32 v204, v184, v185
v_cvt_pk_bf16_f32 v201, v178, v179
v_fma_f32 v189, v189, v85, v233
v_mul_f32 v180, v180, v84
v_fma_f32 v180, v188, -v92, v180
v_cvt_pk_bf16_f32 v205, v186, v187
s_waitcnt lgkmcnt(0)
ds_write_b64 v234, v[204:205] offset:28672
ds_write_b64 v234, v[200:201] offset:24576
ds_write_b64 v234, v[194:195] offset:18432
v_fma_f32 v188, v188, v84, v232
v_mul_f32 v233, v183, v95
v_mul_f32 v183, v183, v87
v_mul_f32 v232, v182, v94
v_fma_f32 v183, v191, -v95, v183
v_fma_f32 v191, v191, v87, v233
v_mul_f32 v182, v182, v86
v_cvt_pk_bf16_f32 v206, v188, v189
v_fma_f32 v182, v190, -v94, v182
v_fma_f32 v190, v190, v86, v232
v_cvt_pk_bf16_f32 v202, v180, v181
v_cvt_pk_bf16_f32 v207, v190, v191
ds_write_b64 v234, v[206:207] offset:30720
v_cvt_pk_bf16_f32 v203, v182, v183
s_waitcnt lgkmcnt(0)
ds_write_b64 v234, v[202:203] offset:26624
s_waitcnt lgkmcnt(0)
s_barrier
ds_read_b128 v[96:99], v0 offset:16384
ds_read_b128 v[112:115], v0 offset:20480
ds_read_b128 v[128:131], v0 offset:24576
ds_read_b128 v[124:127], v0 offset:23552
ds_read_b128 v[144:147], v0 offset:28672
ds_read_b128 v[120:123], v0 offset:22528
s_waitcnt lgkmcnt(5)
v_mfma_f32_16x16x32_bf16 v[160:163], v[96:99], v[16:19], 0
ds_read_b128 v[100:103], v0 offset:17408
s_waitcnt lgkmcnt(5)
v_mfma_f32_16x16x32_bf16 v[168:171], v[112:115], v[16:19], 0
ds_read_b128 v[136:139], v0 offset:26624
v_mfma_f32_16x16x32_bf16 v[160:163], v[112:115], v[32:35], v[160:163]
ds_read_b128 v[148:151], v0 offset:29696
s_waitcnt lgkmcnt(6)
v_mfma_f32_16x16x32_bf16 v[176:179], v[128:131], v[16:19], 0
v_mfma_f32_16x16x32_bf16 v[168:171], v[96:99], v[24:27], v[168:171]
s_waitcnt lgkmcnt(4)
ds_read_b128 v[116:119], v0 offset:21504
ds_read_b128 v[132:135], v0 offset:25600
v_mfma_f32_16x16x32_bf16 v[176:179], v[144:147], v[32:35], v[176:179]
ds_read_b128 v[156:159], v0 offset:31744
v_mfma_f32_16x16x32_bf16 v[184:187], v[144:147], v[16:19], 0
s_waitcnt lgkmcnt(5)
ds_read_b128 v[104:107], v0 offset:18432
v_mfma_f32_16x16x32_bf16 v[184:187], v[128:131], v[24:27], v[184:187]
ds_read_b128 v[152:155], v0 offset:30720
s_waitcnt lgkmcnt(5)
v_mfma_f32_16x16x32_bf16 v[184:187], v[148:151], v[20:23], v[184:187]
s_waitcnt lgkmcnt(4)
v_mfma_f32_16x16x32_bf16 v[160:163], v[100:103], v[20:23], v[160:163]
v_mfma_f32_16x16x32_bf16 v[168:171], v[116:119], v[20:23], v[168:171]
ds_read_b128 v[108:111], v0 offset:19456
v_mfma_f32_16x16x32_bf16 v[172:175], v[120:123], v[16:19], 0
ds_read_b128 v[140:143], v0 offset:27648
s_waitcnt lgkmcnt(3)
v_mfma_f32_16x16x32_bf16 v[164:167], v[104:107], v[16:19], 0
v_mfma_f32_16x16x32_bf16 v[164:167], v[120:123], v[32:35], v[164:167]
v_mfma_f32_16x16x32_bf16 v[180:183], v[136:139], v[16:19], 0
v_mfma_f32_16x16x32_bf16 v[160:163], v[116:119], v[36:39], v[160:163]
s_waitcnt lgkmcnt(1)
s_nop 0
v_mfma_f32_16x16x32_bf16 v[180:183], v[152:155], v[32:35], v[180:183]
s_nop 2
v_mfma_f32_16x16x32_bf16 v[176:179], v[132:135], v[20:23], v[176:179]
s_nop 0
v_cvt_pk_bf16_f32 v193, v162, v163
v_mfma_f32_16x16x32_bf16 v[168:171], v[100:103], v[28:31], v[168:171]
v_mfma_f32_16x16x32_bf16 v[164:167], v[108:111], v[20:23], v[164:167]
v_mfma_f32_16x16x32_bf16 v[176:179], v[148:151], v[36:39], v[176:179]
v_cvt_pk_bf16_f32 v192, v160, v161
s_nop 0
v_mfma_f32_16x16x32_bf16 v[164:167], v[124:127], v[36:39], v[164:167]
s_nop 2
v_mfma_f32_16x16x32_bf16 v[172:175], v[104:107], v[24:27], v[172:175]
s_nop 0
v_cvt_pk_bf16_f32 v200, v176, v177
v_mfma_f32_16x16x32_bf16 v[172:175], v[124:127], v[20:23], v[172:175]
s_nop 0
v_cvt_pk_bf16_f32 v194, v164, v165
s_waitcnt lgkmcnt(0)
v_mfma_f32_16x16x32_bf16 v[180:183], v[140:143], v[20:23], v[180:183]
v_cvt_pk_bf16_f32 v195, v166, v167
v_mfma_f32_16x16x32_bf16 v[180:183], v[156:159], v[36:39], v[180:183]
v_cvt_pk_bf16_f32 v196, v168, v169
v_cvt_pk_bf16_f32 v201, v178, v179
v_mfma_f32_16x16x32_bf16 v[172:175], v[108:111], v[28:31], v[172:175]
buffer_store_dwordx4 v[192:195], v235, s[4:7], s27 offen offset:0 sc1
s_nop 1
v_mfma_f32_16x16x32_bf16 v[184:187], v[132:135], v[28:31], v[184:187]
s_nop 0
v_cvt_pk_bf16_f32 v202, v180, v181
v_mfma_f32_16x16x32_bf16 v[188:191], v[152:155], v[16:19], 0
s_nop 0
v_cvt_pk_bf16_f32 v198, v172, v173
v_cvt_pk_bf16_f32 v203, v182, v183
v_mfma_f32_16x16x32_bf16 v[188:191], v[136:139], v[24:27], v[188:191]
s_nop 0
v_cvt_pk_bf16_f32 v205, v186, v187
v_cvt_pk_bf16_f32 v204, v184, v185
v_mfma_f32_16x16x32_bf16 v[188:191], v[156:159], v[20:23], v[188:191]
v_cvt_pk_bf16_f32 v199, v174, v175
v_cvt_pk_bf16_f32 v197, v170, v171
v_mfma_f32_16x16x32_bf16 v[188:191], v[140:143], v[28:31], v[188:191]
buffer_store_dwordx4 v[196:199], v235, s[4:7], s27 offen offset:64 sc1
s_nop 2
buffer_store_dwordx4 v[200:203], v235, s[4:7], s27 offen offset:128 sc1
s_nop 2
v_cvt_pk_bf16_f32 v207, v190, v191
v_cvt_pk_bf16_f32 v206, v188, v189
buffer_store_dwordx4 v[204:207], v235, s[4:7], s27 offen offset:192 sc1
s_lshl_b32 s18, s35, 2
s_add_u32 s18, s18, 7168
s_add_u32 s29, s16, 1
s_cmp_eq_u32 s13, 0
s_cselect_b32 s22, s18, s6
s_mov_b32 s23, s29
s_lshl_b32 s18, s34, 7
s_lshl_b32 s19, s13, 5
s_add_u32 s18, s18, s19
s_mov_b32 s19, 0x3acccccd
v_bfe_u32 v206, v0, 4, 5
v_lshrrev_b32 v201, 9, v0
v_and_b32 v204, 19, v206
v_bfe_u32 v207, v206, 2, 1
v_lshl_add_u32 v204, v207, 3, v204
v_bfe_u32 v207, v206, 3, 1
v_lshl_add_u32 v204, v207, 2, v204
v_add_u32 v204, s18, v204
v_lshlrev_b32 v201, 2, v201
v_mov_b32 v205, 0
v_mad_u32_u24 v205, v201, v204, v205
v_mad_u32_u24 v200, v204, 8, 0
v_cvt_f32_u32 v200, v200
v_mul_f32 v206, s19, v200
v_rndne_f32 v206, v206
v_fmac_f32 v200, 0xc4200000, v206
v_mul_f32 v200, s19, v200
v_cos_f32 v200, v200
s_nop 0
v_add_f32 v200, v200, v200
v_mad_u32_u24 v202, v204, 1, 0
v_cvt_f32_u32 v202, v202
v_mul_f32 v206, s19, v202
v_rndne_f32 v206, v206
v_fmac_f32 v202, 0xc4200000, v206
v_mul_f32 v202, s19, v202
v_cos_f32 v202, v202
s_nop 0
v_add_f32 v202, v202, v202
v_mad_u32_u24 v184, v204, 1, v205
v_cvt_f32_u32 v184, v184
v_mul_f32 v206, s19, v184
v_rndne_f32 v206, v206
v_fmac_f32 v184, 0xc4200000, v206
v_mul_f32 v184, s19, v184
v_sin_f32 v185, -v184
v_cos_f32 v184, v184
v_mad_u32_u24 v186, v204, 2, v205
v_cvt_f32_u32 v186, v186
v_mul_f32 v206, s19, v186
v_rndne_f32 v206, v206
v_fmac_f32 v186, 0xc4200000, v206
v_mul_f32 v186, s19, v186
v_sin_f32 v187, -v186
v_cos_f32 v186, v186
s_nop 0
v_pk_fma_f32 v[188:189], v[202:203], v[186:187], v[184:185] op_sel_hi:[0,1,1] neg_lo:[0,0,1] neg_hi:[0,0,1]
v_pk_fma_f32 v[190:191], v[202:203], v[188:189], v[186:187] op_sel_hi:[0,1,1] neg_lo:[0,0,1] neg_hi:[0,0,1]
v_cvt_pk_bf16_f32 v16, v184, v185
v_cvt_pk_bf16_f32 v17, v186, v187
v_cvt_pk_bf16_f32 v18, v188, v189
v_cvt_pk_bf16_f32 v19, v190, v191
v_mad_u32_u24 v192, v204, 9, v205
v_cvt_f32_u32 v192, v192
v_mul_f32 v206, s19, v192
v_rndne_f32 v206, v206
v_fmac_f32 v192, 0xc4200000, v206
v_mul_f32 v192, s19, v192
v_sin_f32 v193, -v192
v_cos_f32 v192, v192
v_mad_u32_u24 v194, v204, 10, v205
v_cvt_f32_u32 v194, v194
v_mul_f32 v206, s19, v194
v_rndne_f32 v206, v206
v_fmac_f32 v194, 0xc4200000, v206
v_mul_f32 v194, s19, v194
v_sin_f32 v195, -v194
v_cos_f32 v194, v194
s_nop 0
v_pk_fma_f32 v[196:197], v[202:203], v[194:195], v[192:193] op_sel_hi:[0,1,1] neg_lo:[0,0,1] neg_hi:[0,0,1]
v_pk_fma_f32 v[198:199], v[202:203], v[196:197], v[194:195] op_sel_hi:[0,1,1] neg_lo:[0,0,1] neg_hi:[0,0,1]
v_cvt_pk_bf16_f32 v20, v192, v193
v_cvt_pk_bf16_f32 v21, v194, v195
v_cvt_pk_bf16_f32 v22, v196, v197
v_cvt_pk_bf16_f32 v23, v198, v199
v_pk_fma_f32 v[184:185], v[200:201], v[192:193], v[184:185] op_sel_hi:[0,1,1] neg_lo:[0,0,1] neg_hi:[0,0,1]
v_pk_fma_f32 v[186:187], v[200:201], v[194:195], v[186:187] op_sel_hi:[0,1,1] neg_lo:[0,0,1] neg_hi:[0,0,1]
v_pk_fma_f32 v[188:189], v[200:201], v[196:197], v[188:189] op_sel_hi:[0,1,1] neg_lo:[0,0,1] neg_hi:[0,0,1]
v_pk_fma_f32 v[190:191], v[200:201], v[198:199], v[190:191] op_sel_hi:[0,1,1] neg_lo:[0,0,1] neg_hi:[0,0,1]
v_cvt_pk_bf16_f32 v24, v184, v185
v_cvt_pk_bf16_f32 v25, v186, v187
v_cvt_pk_bf16_f32 v26, v188, v189
v_cvt_pk_bf16_f32 v27, v190, v191
v_pk_fma_f32 v[192:193], v[200:201], v[184:185], v[192:193] op_sel_hi:[0,1,1] neg_lo:[0,0,1] neg_hi:[0,0,1]
v_pk_fma_f32 v[194:195], v[200:201], v[186:187], v[194:195] op_sel_hi:[0,1,1] neg_lo:[0,0,1] neg_hi:[0,0,1]
v_pk_fma_f32 v[196:197], v[200:201], v[188:189], v[196:197] op_sel_hi:[0,1,1] neg_lo:[0,0,1] neg_hi:[0,0,1]
v_pk_fma_f32 v[198:199], v[200:201], v[190:191], v[198:199] op_sel_hi:[0,1,1] neg_lo:[0,0,1] neg_hi:[0,0,1]
v_cvt_pk_bf16_f32 v28, v192, v193
v_cvt_pk_bf16_f32 v29, v194, v195
v_cvt_pk_bf16_f32 v30, v196, v197
v_cvt_pk_bf16_f32 v31, v198, v199
v_pk_fma_f32 v[184:185], v[200:201], v[192:193], v[184:185] op_sel_hi:[0,1,1] neg_lo:[0,0,1] neg_hi:[0,0,1]
v_pk_fma_f32 v[186:187], v[200:201], v[194:195], v[186:187] op_sel_hi:[0,1,1] neg_lo:[0,0,1] neg_hi:[0,0,1]
v_pk_fma_f32 v[188:189], v[200:201], v[196:197], v[188:189] op_sel_hi:[0,1,1] neg_lo:[0,0,1] neg_hi:[0,0,1]
v_pk_fma_f32 v[190:191], v[200:201], v[198:199], v[190:191] op_sel_hi:[0,1,1] neg_lo:[0,0,1] neg_hi:[0,0,1]
v_cvt_pk_bf16_f32 v32, v184, v185
v_cvt_pk_bf16_f32 v33, v186, v187
v_cvt_pk_bf16_f32 v34, v188, v189
v_cvt_pk_bf16_f32 v35, v190, v191
v_pk_fma_f32 v[192:193], v[200:201], v[184:185], v[192:193] op_sel_hi:[0,1,1] neg_lo:[0,0,1] neg_hi:[0,0,1]
v_pk_fma_f32 v[194:195], v[200:201], v[186:187], v[194:195] op_sel_hi:[0,1,1] neg_lo:[0,0,1] neg_hi:[0,0,1]
v_pk_fma_f32 v[196:197], v[200:201], v[188:189], v[196:197] op_sel_hi:[0,1,1] neg_lo:[0,0,1] neg_hi:[0,0,1]
v_pk_fma_f32 v[198:199], v[200:201], v[190:191], v[198:199] op_sel_hi:[0,1,1] neg_lo:[0,0,1] neg_hi:[0,0,1]
v_cvt_pk_bf16_f32 v36, v192, v193
v_cvt_pk_bf16_f32 v37, v194, v195
v_cvt_pk_bf16_f32 v38, v196, v197
v_cvt_pk_bf16_f32 v39, v198, v199
v_pk_fma_f32 v[184:185], v[200:201], v[192:193], v[184:185] op_sel_hi:[0,1,1] neg_lo:[0,0,1] neg_hi:[0,0,1]
v_pk_fma_f32 v[186:187], v[200:201], v[194:195], v[186:187] op_sel_hi:[0,1,1] neg_lo:[0,0,1] neg_hi:[0,0,1]
v_pk_fma_f32 v[188:189], v[200:201], v[196:197], v[188:189] op_sel_hi:[0,1,1] neg_lo:[0,0,1] neg_hi:[0,0,1]
v_pk_fma_f32 v[190:191], v[200:201], v[198:199], v[190:191] op_sel_hi:[0,1,1] neg_lo:[0,0,1] neg_hi:[0,0,1]
v_cvt_pk_bf16_f32 v40, v184, v185
v_cvt_pk_bf16_f32 v41, v186, v187
v_cvt_pk_bf16_f32 v42, v188, v189
v_cvt_pk_bf16_f32 v43, v190, v191
v_pk_fma_f32 v[192:193], v[200:201], v[184:185], v[192:193] op_sel_hi:[0,1,1] neg_lo:[0,0,1] neg_hi:[0,0,1]
v_pk_fma_f32 v[194:195], v[200:201], v[186:187], v[194:195] op_sel_hi:[0,1,1] neg_lo:[0,0,1] neg_hi:[0,0,1]
v_pk_fma_f32 v[196:197], v[200:201], v[188:189], v[196:197] op_sel_hi:[0,1,1] neg_lo:[0,0,1] neg_hi:[0,0,1]
v_pk_fma_f32 v[198:199], v[200:201], v[190:191], v[198:199] op_sel_hi:[0,1,1] neg_lo:[0,0,1] neg_hi:[0,0,1]
v_cvt_pk_bf16_f32 v44, v192, v193
v_cvt_pk_bf16_f32 v45, v194, v195
v_cvt_pk_bf16_f32 v46, v196, v197
v_cvt_pk_bf16_f32 v47, v198, v199
v_pk_fma_f32 v[184:185], v[200:201], v[192:193], v[184:185] op_sel_hi:[0,1,1] neg_lo:[0,0,1] neg_hi:[0,0,1]
v_pk_fma_f32 v[186:187], v[200:201], v[194:195], v[186:187] op_sel_hi:[0,1,1] neg_lo:[0,0,1] neg_hi:[0,0,1]
v_pk_fma_f32 v[188:189], v[200:201], v[196:197], v[188:189] op_sel_hi:[0,1,1] neg_lo:[0,0,1] neg_hi:[0,0,1]
v_pk_fma_f32 v[190:191], v[200:201], v[198:199], v[190:191] op_sel_hi:[0,1,1] neg_lo:[0,0,1] neg_hi:[0,0,1]
v_cvt_pk_bf16_f32 v48, v184, v185
v_cvt_pk_bf16_f32 v49, v186, v187
v_cvt_pk_bf16_f32 v50, v188, v189
v_cvt_pk_bf16_f32 v51, v190, v191
v_pk_fma_f32 v[192:193], v[200:201], v[184:185], v[192:193] op_sel_hi:[0,1,1] neg_lo:[0,0,1] neg_hi:[0,0,1]
v_pk_fma_f32 v[194:195], v[200:201], v[186:187], v[194:195] op_sel_hi:[0,1,1] neg_lo:[0,0,1] neg_hi:[0,0,1]
v_pk_fma_f32 v[196:197], v[200:201], v[188:189], v[196:197] op_sel_hi:[0,1,1] neg_lo:[0,0,1] neg_hi:[0,0,1]
v_pk_fma_f32 v[198:199], v[200:201], v[190:191], v[198:199] op_sel_hi:[0,1,1] neg_lo:[0,0,1] neg_hi:[0,0,1]
v_cvt_pk_bf16_f32 v52, v192, v193
v_cvt_pk_bf16_f32 v53, v194, v195
v_cvt_pk_bf16_f32 v54, v196, v197
v_cvt_pk_bf16_f32 v55, v198, v199
v_pk_fma_f32 v[184:185], v[200:201], v[192:193], v[184:185] op_sel_hi:[0,1,1] neg_lo:[0,0,1] neg_hi:[0,0,1]
v_pk_fma_f32 v[186:187], v[200:201], v[194:195], v[186:187] op_sel_hi:[0,1,1] neg_lo:[0,0,1] neg_hi:[0,0,1]
v_pk_fma_f32 v[188:189], v[200:201], v[196:197], v[188:189] op_sel_hi:[0,1,1] neg_lo:[0,0,1] neg_hi:[0,0,1]
v_pk_fma_f32 v[190:191], v[200:201], v[198:199], v[190:191] op_sel_hi:[0,1,1] neg_lo:[0,0,1] neg_hi:[0,0,1]
v_cvt_pk_bf16_f32 v56, v184, v185
v_cvt_pk_bf16_f32 v57, v186, v187
v_cvt_pk_bf16_f32 v58, v188, v189
v_cvt_pk_bf16_f32 v59, v190, v191
v_pk_fma_f32 v[192:193], v[200:201], v[184:185], v[192:193] op_sel_hi:[0,1,1] neg_lo:[0,0,1] neg_hi:[0,0,1]
v_pk_fma_f32 v[194:195], v[200:201], v[186:187], v[194:195] op_sel_hi:[0,1,1] neg_lo:[0,0,1] neg_hi:[0,0,1]
v_pk_fma_f32 v[196:197], v[200:201], v[188:189], v[196:197] op_sel_hi:[0,1,1] neg_lo:[0,0,1] neg_hi:[0,0,1]
v_pk_fma_f32 v[198:199], v[200:201], v[190:191], v[198:199] op_sel_hi:[0,1,1] neg_lo:[0,0,1] neg_hi:[0,0,1]
v_cvt_pk_bf16_f32 v60, v192, v193
v_cvt_pk_bf16_f32 v61, v194, v195
v_cvt_pk_bf16_f32 v62, v196, v197
v_cvt_pk_bf16_f32 v63, v198, v199
v_pk_fma_f32 v[184:185], v[200:201], v[192:193], v[184:185] op_sel_hi:[0,1,1] neg_lo:[0,0,1] neg_hi:[0,0,1]
v_pk_fma_f32 v[186:187], v[200:201], v[194:195], v[186:187] op_sel_hi:[0,1,1] neg_lo:[0,0,1] neg_hi:[0,0,1]
v_pk_fma_f32 v[188:189], v[200:201], v[196:197], v[188:189] op_sel_hi:[0,1,1] neg_lo:[0,0,1] neg_hi:[0,0,1]
v_pk_fma_f32 v[190:191], v[200:201], v[198:199], v[190:191] op_sel_hi:[0,1,1] neg_lo:[0,0,1] neg_hi:[0,0,1]
v_cvt_pk_bf16_f32 v64, v184, v185
v_cvt_pk_bf16_f32 v65, v186, v187
v_cvt_pk_bf16_f32 v66, v188, v189
v_cvt_pk_bf16_f32 v67, v190, v191
s_waitcnt vmcnt(0)
s_barrier
v_mov_b32 v3, s23
s_mov_b64 exec, 1
buffer_store_dword v3, off, s[4:7], s22 sc1
s_mov_b64 exec, -1
s_mov_b32 s22, s6
v_pk_fma_f32 v[192:193], v[200:201], v[184:185], v[192:193] op_sel_hi:[0,1,1] neg_lo:[0,0,1] neg_hi:[0,0,1]
v_pk_fma_f32 v[194:195], v[200:201], v[186:187], v[194:195] op_sel_hi:[0,1,1] neg_lo:[0,0,1] neg_hi:[0,0,1]
v_pk_fma_f32 v[196:197], v[200:201], v[188:189], v[196:197] op_sel_hi:[0,1,1] neg_lo:[0,0,1] neg_hi:[0,0,1]
v_pk_fma_f32 v[198:199], v[200:201], v[190:191], v[198:199] op_sel_hi:[0,1,1] neg_lo:[0,0,1] neg_hi:[0,0,1]
v_cvt_pk_bf16_f32 v68, v192, v193
v_cvt_pk_bf16_f32 v69, v194, v195
v_cvt_pk_bf16_f32 v70, v196, v197
v_cvt_pk_bf16_f32 v71, v198, v199
v_pk_fma_f32 v[184:185], v[200:201], v[192:193], v[184:185] op_sel_hi:[0,1,1] neg_lo:[0,0,1] neg_hi:[0,0,1]
v_pk_fma_f32 v[186:187], v[200:201], v[194:195], v[186:187] op_sel_hi:[0,1,1] neg_lo:[0,0,1] neg_hi:[0,0,1]
v_pk_fma_f32 v[188:189], v[200:201], v[196:197], v[188:189] op_sel_hi:[0,1,1] neg_lo:[0,0,1] neg_hi:[0,0,1]
v_pk_fma_f32 v[190:191], v[200:201], v[198:199], v[190:191] op_sel_hi:[0,1,1] neg_lo:[0,0,1] neg_hi:[0,0,1]
v_cvt_pk_bf16_f32 v72, v184, v185
v_cvt_pk_bf16_f32 v73, v186, v187
v_cvt_pk_bf16_f32 v74, v188, v189
v_cvt_pk_bf16_f32 v75, v190, v191
v_pk_fma_f32 v[192:193], v[200:201], v[184:185], v[192:193] op_sel_hi:[0,1,1] neg_lo:[0,0,1] neg_hi:[0,0,1]
v_pk_fma_f32 v[194:195], v[200:201], v[186:187], v[194:195] op_sel_hi:[0,1,1] neg_lo:[0,0,1] neg_hi:[0,0,1]
v_pk_fma_f32 v[196:197], v[200:201], v[188:189], v[196:197] op_sel_hi:[0,1,1] neg_lo:[0,0,1] neg_hi:[0,0,1]
v_pk_fma_f32 v[198:199], v[200:201], v[190:191], v[198:199] op_sel_hi:[0,1,1] neg_lo:[0,0,1] neg_hi:[0,0,1]
v_cvt_pk_bf16_f32 v76, v192, v193
v_cvt_pk_bf16_f32 v77, v194, v195
v_cvt_pk_bf16_f32 v78, v196, v197
v_cvt_pk_bf16_f32 v79, v198, v199
v_pk_fma_f32 v[184:185], v[200:201], v[192:193], v[184:185] op_sel_hi:[0,1,1] neg_lo:[0,0,1] neg_hi:[0,0,1]
v_pk_fma_f32 v[186:187], v[200:201], v[194:195], v[186:187] op_sel_hi:[0,1,1] neg_lo:[0,0,1] neg_hi:[0,0,1]
v_pk_fma_f32 v[188:189], v[200:201], v[196:197], v[188:189] op_sel_hi:[0,1,1] neg_lo:[0,0,1] neg_hi:[0,0,1]
v_pk_fma_f32 v[190:191], v[200:201], v[198:199], v[190:191] op_sel_hi:[0,1,1] neg_lo:[0,0,1] neg_hi:[0,0,1]
v_cvt_pk_bf16_f32 v80, v184, v185
v_cvt_pk_bf16_f32 v81, v186, v187
v_cvt_pk_bf16_f32 v82, v188, v189
v_cvt_pk_bf16_f32 v83, v190, v191
v_pk_fma_f32 v[192:193], v[200:201], v[184:185], v[192:193] op_sel_hi:[0,1,1] neg_lo:[0,0,1] neg_hi:[0,0,1]
v_pk_fma_f32 v[194:195], v[200:201], v[186:187], v[194:195] op_sel_hi:[0,1,1] neg_lo:[0,0,1] neg_hi:[0,0,1]
v_pk_fma_f32 v[196:197], v[200:201], v[188:189], v[196:197] op_sel_hi:[0,1,1] neg_lo:[0,0,1] neg_hi:[0,0,1]
v_pk_fma_f32 v[198:199], v[200:201], v[190:191], v[198:199] op_sel_hi:[0,1,1] neg_lo:[0,0,1] neg_hi:[0,0,1]
v_cvt_pk_bf16_f32 v84, v192, v193
v_cvt_pk_bf16_f32 v85, v194, v195
v_cvt_pk_bf16_f32 v86, v196, v197
v_cvt_pk_bf16_f32 v87, v198, v199
v_pk_fma_f32 v[184:185], v[200:201], v[192:193], v[184:185] op_sel_hi:[0,1,1] neg_lo:[0,0,1] neg_hi:[0,0,1]
v_pk_fma_f32 v[186:187], v[200:201], v[194:195], v[186:187] op_sel_hi:[0,1,1] neg_lo:[0,0,1] neg_hi:[0,0,1]
v_pk_fma_f32 v[188:189], v[200:201], v[196:197], v[188:189] op_sel_hi:[0,1,1] neg_lo:[0,0,1] neg_hi:[0,0,1]
v_pk_fma_f32 v[190:191], v[200:201], v[198:199], v[190:191] op_sel_hi:[0,1,1] neg_lo:[0,0,1] neg_hi:[0,0,1]
v_cvt_pk_bf16_f32 v88, v184, v185
v_cvt_pk_bf16_f32 v89, v186, v187
v_cvt_pk_bf16_f32 v90, v188, v189
v_cvt_pk_bf16_f32 v91, v190, v191
v_pk_fma_f32 v[192:193], v[200:201], v[184:185], v[192:193] op_sel_hi:[0,1,1] neg_lo:[0,0,1] neg_hi:[0,0,1]
v_pk_fma_f32 v[194:195], v[200:201], v[186:187], v[194:195] op_sel_hi:[0,1,1] neg_lo:[0,0,1] neg_hi:[0,0,1]
v_pk_fma_f32 v[196:197], v[200:201], v[188:189], v[196:197] op_sel_hi:[0,1,1] neg_lo:[0,0,1] neg_hi:[0,0,1]
v_pk_fma_f32 v[198:199], v[200:201], v[190:191], v[198:199] op_sel_hi:[0,1,1] neg_lo:[0,0,1] neg_hi:[0,0,1]
v_cvt_pk_bf16_f32 v92, v192, v193
v_cvt_pk_bf16_f32 v93, v194, v195
v_cvt_pk_bf16_f32 v94, v196, v197
v_cvt_pk_bf16_f32 v95, v198, v199
s_mov_b32 s20, 161
v_mad_u32_u24 v184, v204, s20, v205
v_cvt_f32_u32 v184, v184
v_mul_f32 v206, s19, v184
v_rndne_f32 v206, v206
v_fmac_f32 v184, 0xc4200000, v206
v_mul_f32 v184, s19, v184
v_sin_f32 v185, -v184
v_cos_f32 v184, v184
s_mov_b32 s20, 162
v_mad_u32_u24 v186, v204, s20, v205
v_cvt_f32_u32 v186, v186
v_mul_f32 v206, s19, v186
v_rndne_f32 v206, v206
v_fmac_f32 v186, 0xc4200000, v206
v_mul_f32 v186, s19, v186
v_sin_f32 v187, -v186
v_cos_f32 v186, v186
s_nop 0
v_pk_fma_f32 v[188:189], v[202:203], v[186:187], v[184:185] op_sel_hi:[0,1,1] neg_lo:[0,0,1] neg_hi:[0,0,1]
v_pk_fma_f32 v[190:191], v[202:203], v[188:189], v[186:187] op_sel_hi:[0,1,1] neg_lo:[0,0,1] neg_hi:[0,0,1]
v_cvt_pk_bf16_f32 v96, v184, v185
v_cvt_pk_bf16_f32 v97, v186, v187
v_cvt_pk_bf16_f32 v98, v188, v189
v_cvt_pk_bf16_f32 v99, v190, v191
s_mov_b32 s20, 169
v_mad_u32_u24 v192, v204, s20, v205
v_cvt_f32_u32 v192, v192
v_mul_f32 v206, s19, v192
v_rndne_f32 v206, v206
v_fmac_f32 v192, 0xc4200000, v206
v_mul_f32 v192, s19, v192
v_sin_f32 v193, -v192
v_cos_f32 v192, v192
s_mov_b32 s20, 170
v_mad_u32_u24 v194, v204, s20, v205
v_cvt_f32_u32 v194, v194
v_mul_f32 v206, s19, v194
v_rndne_f32 v206, v206
v_fmac_f32 v194, 0xc4200000, v206
v_mul_f32 v194, s19, v194
v_sin_f32 v195, -v194
v_cos_f32 v194, v194
s_nop 0
v_pk_fma_f32 v[196:197], v[202:203], v[194:195], v[192:193] op_sel_hi:[0,1,1] neg_lo:[0,0,1] neg_hi:[0,0,1]
v_pk_fma_f32 v[198:199], v[202:203], v[196:197], v[194:195] op_sel_hi:[0,1,1] neg_lo:[0,0,1] neg_hi:[0,0,1]
v_cvt_pk_bf16_f32 v100, v192, v193
v_cvt_pk_bf16_f32 v101, v194, v195
v_cvt_pk_bf16_f32 v102, v196, v197
v_cvt_pk_bf16_f32 v103, v198, v199
v_pk_fma_f32 v[184:185], v[200:201], v[192:193], v[184:185] op_sel_hi:[0,1,1] neg_lo:[0,0,1] neg_hi:[0,0,1]
v_pk_fma_f32 v[186:187], v[200:201], v[194:195], v[186:187] op_sel_hi:[0,1,1] neg_lo:[0,0,1] neg_hi:[0,0,1]
v_pk_fma_f32 v[188:189], v[200:201], v[196:197], v[188:189] op_sel_hi:[0,1,1] neg_lo:[0,0,1] neg_hi:[0,0,1]
v_pk_fma_f32 v[190:191], v[200:201], v[198:199], v[190:191] op_sel_hi:[0,1,1] neg_lo:[0,0,1] neg_hi:[0,0,1]
v_cvt_pk_bf16_f32 v104, v184, v185
v_cvt_pk_bf16_f32 v105, v186, v187
v_cvt_pk_bf16_f32 v106, v188, v189
v_cvt_pk_bf16_f32 v107, v190, v191
v_pk_fma_f32 v[192:193], v[200:201], v[184:185], v[192:193] op_sel_hi:[0,1,1] neg_lo:[0,0,1] neg_hi:[0,0,1]
v_pk_fma_f32 v[194:195], v[200:201], v[186:187], v[194:195] op_sel_hi:[0,1,1] neg_lo:[0,0,1] neg_hi:[0,0,1]
v_pk_fma_f32 v[196:197], v[200:201], v[188:189], v[196:197] op_sel_hi:[0,1,1] neg_lo:[0,0,1] neg_hi:[0,0,1]
v_pk_fma_f32 v[198:199], v[200:201], v[190:191], v[198:199] op_sel_hi:[0,1,1] neg_lo:[0,0,1] neg_hi:[0,0,1]
v_cvt_pk_bf16_f32 v108, v192, v193
v_cvt_pk_bf16_f32 v109, v194, v195
v_cvt_pk_bf16_f32 v110, v196, v197
v_cvt_pk_bf16_f32 v111, v198, v199
v_pk_fma_f32 v[184:185], v[200:201], v[192:193], v[184:185] op_sel_hi:[0,1,1] neg_lo:[0,0,1] neg_hi:[0,0,1]
v_pk_fma_f32 v[186:187], v[200:201], v[194:195], v[186:187] op_sel_hi:[0,1,1] neg_lo:[0,0,1] neg_hi:[0,0,1]
v_pk_fma_f32 v[188:189], v[200:201], v[196:197], v[188:189] op_sel_hi:[0,1,1] neg_lo:[0,0,1] neg_hi:[0,0,1]
v_pk_fma_f32 v[190:191], v[200:201], v[198:199], v[190:191] op_sel_hi:[0,1,1] neg_lo:[0,0,1] neg_hi:[0,0,1]
v_cvt_pk_bf16_f32 v112, v184, v185
v_cvt_pk_bf16_f32 v113, v186, v187
v_cvt_pk_bf16_f32 v114, v188, v189
v_cvt_pk_bf16_f32 v115, v190, v191
v_pk_fma_f32 v[192:193], v[200:201], v[184:185], v[192:193] op_sel_hi:[0,1,1] neg_lo:[0,0,1] neg_hi:[0,0,1]
v_pk_fma_f32 v[194:195], v[200:201], v[186:187], v[194:195] op_sel_hi:[0,1,1] neg_lo:[0,0,1] neg_hi:[0,0,1]
v_pk_fma_f32 v[196:197], v[200:201], v[188:189], v[196:197] op_sel_hi:[0,1,1] neg_lo:[0,0,1] neg_hi:[0,0,1]
v_pk_fma_f32 v[198:199], v[200:201], v[190:191], v[198:199] op_sel_hi:[0,1,1] neg_lo:[0,0,1] neg_hi:[0,0,1]
v_cvt_pk_bf16_f32 v116, v192, v193
v_cvt_pk_bf16_f32 v117, v194, v195
v_cvt_pk_bf16_f32 v118, v196, v197
v_cvt_pk_bf16_f32 v119, v198, v199
v_pk_fma_f32 v[184:185], v[200:201], v[192:193], v[184:185] op_sel_hi:[0,1,1] neg_lo:[0,0,1] neg_hi:[0,0,1]
v_pk_fma_f32 v[186:187], v[200:201], v[194:195], v[186:187] op_sel_hi:[0,1,1] neg_lo:[0,0,1] neg_hi:[0,0,1]
v_pk_fma_f32 v[188:189], v[200:201], v[196:197], v[188:189] op_sel_hi:[0,1,1] neg_lo:[0,0,1] neg_hi:[0,0,1]
v_pk_fma_f32 v[190:191], v[200:201], v[198:199], v[190:191] op_sel_hi:[0,1,1] neg_lo:[0,0,1] neg_hi:[0,0,1]
v_cvt_pk_bf16_f32 v120, v184, v185
v_cvt_pk_bf16_f32 v121, v186, v187
v_cvt_pk_bf16_f32 v122, v188, v189
v_cvt_pk_bf16_f32 v123, v190, v191
v_pk_fma_f32 v[192:193], v[200:201], v[184:185], v[192:193] op_sel_hi:[0,1,1] neg_lo:[0,0,1] neg_hi:[0,0,1]
v_pk_fma_f32 v[194:195], v[200:201], v[186:187], v[194:195] op_sel_hi:[0,1,1] neg_lo:[0,0,1] neg_hi:[0,0,1]
v_pk_fma_f32 v[196:197], v[200:201], v[188:189], v[196:197] op_sel_hi:[0,1,1] neg_lo:[0,0,1] neg_hi:[0,0,1]
v_pk_fma_f32 v[198:199], v[200:201], v[190:191], v[198:199] op_sel_hi:[0,1,1] neg_lo:[0,0,1] neg_hi:[0,0,1]
v_cvt_pk_bf16_f32 v124, v192, v193
v_cvt_pk_bf16_f32 v125, v194, v195
v_cvt_pk_bf16_f32 v126, v196, v197
v_cvt_pk_bf16_f32 v127, v198, v199
v_pk_fma_f32 v[184:185], v[200:201], v[192:193], v[184:185] op_sel_hi:[0,1,1] neg_lo:[0,0,1] neg_hi:[0,0,1]
v_pk_fma_f32 v[186:187], v[200:201], v[194:195], v[186:187] op_sel_hi:[0,1,1] neg_lo:[0,0,1] neg_hi:[0,0,1]
v_pk_fma_f32 v[188:189], v[200:201], v[196:197], v[188:189] op_sel_hi:[0,1,1] neg_lo:[0,0,1] neg_hi:[0,0,1]
v_pk_fma_f32 v[190:191], v[200:201], v[198:199], v[190:191] op_sel_hi:[0,1,1] neg_lo:[0,0,1] neg_hi:[0,0,1]
v_cvt_pk_bf16_f32 v128, v184, v185
v_cvt_pk_bf16_f32 v129, v186, v187
v_cvt_pk_bf16_f32 v130, v188, v189
v_cvt_pk_bf16_f32 v131, v190, v191
v_pk_fma_f32 v[192:193], v[200:201], v[184:185], v[192:193] op_sel_hi:[0,1,1] neg_lo:[0,0,1] neg_hi:[0,0,1]
v_pk_fma_f32 v[194:195], v[200:201], v[186:187], v[194:195] op_sel_hi:[0,1,1] neg_lo:[0,0,1] neg_hi:[0,0,1]
v_pk_fma_f32 v[196:197], v[200:201], v[188:189], v[196:197] op_sel_hi:[0,1,1] neg_lo:[0,0,1] neg_hi:[0,0,1]
v_pk_fma_f32 v[198:199], v[200:201], v[190:191], v[198:199] op_sel_hi:[0,1,1] neg_lo:[0,0,1] neg_hi:[0,0,1]
v_cvt_pk_bf16_f32 v132, v192, v193
v_cvt_pk_bf16_f32 v133, v194, v195
v_cvt_pk_bf16_f32 v134, v196, v197
v_cvt_pk_bf16_f32 v135, v198, v199
v_pk_fma_f32 v[184:185], v[200:201], v[192:193], v[184:185] op_sel_hi:[0,1,1] neg_lo:[0,0,1] neg_hi:[0,0,1]
v_pk_fma_f32 v[186:187], v[200:201], v[194:195], v[186:187] op_sel_hi:[0,1,1] neg_lo:[0,0,1] neg_hi:[0,0,1]
v_pk_fma_f32 v[188:189], v[200:201], v[196:197], v[188:189] op_sel_hi:[0,1,1] neg_lo:[0,0,1] neg_hi:[0,0,1]
v_pk_fma_f32 v[190:191], v[200:201], v[198:199], v[190:191] op_sel_hi:[0,1,1] neg_lo:[0,0,1] neg_hi:[0,0,1]
v_cvt_pk_bf16_f32 v136, v184, v185
v_cvt_pk_bf16_f32 v137, v186, v187
v_cvt_pk_bf16_f32 v138, v188, v189
v_cvt_pk_bf16_f32 v139, v190, v191
v_pk_fma_f32 v[192:193], v[200:201], v[184:185], v[192:193] op_sel_hi:[0,1,1] neg_lo:[0,0,1] neg_hi:[0,0,1]
v_pk_fma_f32 v[194:195], v[200:201], v[186:187], v[194:195] op_sel_hi:[0,1,1] neg_lo:[0,0,1] neg_hi:[0,0,1]
v_pk_fma_f32 v[196:197], v[200:201], v[188:189], v[196:197] op_sel_hi:[0,1,1] neg_lo:[0,0,1] neg_hi:[0,0,1]
v_pk_fma_f32 v[198:199], v[200:201], v[190:191], v[198:199] op_sel_hi:[0,1,1] neg_lo:[0,0,1] neg_hi:[0,0,1]
v_cvt_pk_bf16_f32 v140, v192, v193
v_cvt_pk_bf16_f32 v141, v194, v195
v_cvt_pk_bf16_f32 v142, v196, v197
v_cvt_pk_bf16_f32 v143, v198, v199
v_pk_fma_f32 v[184:185], v[200:201], v[192:193], v[184:185] op_sel_hi:[0,1,1] neg_lo:[0,0,1] neg_hi:[0,0,1]
v_pk_fma_f32 v[186:187], v[200:201], v[194:195], v[186:187] op_sel_hi:[0,1,1] neg_lo:[0,0,1] neg_hi:[0,0,1]
v_pk_fma_f32 v[188:189], v[200:201], v[196:197], v[188:189] op_sel_hi:[0,1,1] neg_lo:[0,0,1] neg_hi:[0,0,1]
v_pk_fma_f32 v[190:191], v[200:201], v[198:199], v[190:191] op_sel_hi:[0,1,1] neg_lo:[0,0,1] neg_hi:[0,0,1]
v_cvt_pk_bf16_f32 v144, v184, v185
v_cvt_pk_bf16_f32 v145, v186, v187
v_cvt_pk_bf16_f32 v146, v188, v189
v_cvt_pk_bf16_f32 v147, v190, v191
v_pk_fma_f32 v[192:193], v[200:201], v[184:185], v[192:193] op_sel_hi:[0,1,1] neg_lo:[0,0,1] neg_hi:[0,0,1]
v_pk_fma_f32 v[194:195], v[200:201], v[186:187], v[194:195] op_sel_hi:[0,1,1] neg_lo:[0,0,1] neg_hi:[0,0,1]
v_pk_fma_f32 v[196:197], v[200:201], v[188:189], v[196:197] op_sel_hi:[0,1,1] neg_lo:[0,0,1] neg_hi:[0,0,1]
v_pk_fma_f32 v[198:199], v[200:201], v[190:191], v[198:199] op_sel_hi:[0,1,1] neg_lo:[0,0,1] neg_hi:[0,0,1]
v_cvt_pk_bf16_f32 v148, v192, v193
v_cvt_pk_bf16_f32 v149, v194, v195
v_cvt_pk_bf16_f32 v150, v196, v197
v_cvt_pk_bf16_f32 v151, v198, v199
v_pk_fma_f32 v[184:185], v[200:201], v[192:193], v[184:185] op_sel_hi:[0,1,1] neg_lo:[0,0,1] neg_hi:[0,0,1]
v_pk_fma_f32 v[186:187], v[200:201], v[194:195], v[186:187] op_sel_hi:[0,1,1] neg_lo:[0,0,1] neg_hi:[0,0,1]
v_pk_fma_f32 v[188:189], v[200:201], v[196:197], v[188:189] op_sel_hi:[0,1,1] neg_lo:[0,0,1] neg_hi:[0,0,1]
v_pk_fma_f32 v[190:191], v[200:201], v[198:199], v[190:191] op_sel_hi:[0,1,1] neg_lo:[0,0,1] neg_hi:[0,0,1]
v_cvt_pk_bf16_f32 v152, v184, v185
v_cvt_pk_bf16_f32 v153, v186, v187
v_cvt_pk_bf16_f32 v154, v188, v189
v_cvt_pk_bf16_f32 v155, v190, v191
v_pk_fma_f32 v[192:193], v[200:201], v[184:185], v[192:193] op_sel_hi:[0,1,1] neg_lo:[0,0,1] neg_hi:[0,0,1]
v_pk_fma_f32 v[194:195], v[200:201], v[186:187], v[194:195] op_sel_hi:[0,1,1] neg_lo:[0,0,1] neg_hi:[0,0,1]
v_pk_fma_f32 v[196:197], v[200:201], v[188:189], v[196:197] op_sel_hi:[0,1,1] neg_lo:[0,0,1] neg_hi:[0,0,1]
v_pk_fma_f32 v[198:199], v[200:201], v[190:191], v[198:199] op_sel_hi:[0,1,1] neg_lo:[0,0,1] neg_hi:[0,0,1]
v_cvt_pk_bf16_f32 v156, v192, v193
v_cvt_pk_bf16_f32 v157, v194, v195
v_cvt_pk_bf16_f32 v158, v196, v197
v_cvt_pk_bf16_f32 v159, v198, v199
v_pk_fma_f32 v[184:185], v[200:201], v[192:193], v[184:185] op_sel_hi:[0,1,1] neg_lo:[0,0,1] neg_hi:[0,0,1]
v_pk_fma_f32 v[186:187], v[200:201], v[194:195], v[186:187] op_sel_hi:[0,1,1] neg_lo:[0,0,1] neg_hi:[0,0,1]
v_pk_fma_f32 v[188:189], v[200:201], v[196:197], v[188:189] op_sel_hi:[0,1,1] neg_lo:[0,0,1] neg_hi:[0,0,1]
v_pk_fma_f32 v[190:191], v[200:201], v[198:199], v[190:191] op_sel_hi:[0,1,1] neg_lo:[0,0,1] neg_hi:[0,0,1]
v_cvt_pk_bf16_f32 v160, v184, v185
v_cvt_pk_bf16_f32 v161, v186, v187
v_cvt_pk_bf16_f32 v162, v188, v189
v_cvt_pk_bf16_f32 v163, v190, v191
v_pk_fma_f32 v[192:193], v[200:201], v[184:185], v[192:193] op_sel_hi:[0,1,1] neg_lo:[0,0,1] neg_hi:[0,0,1]
v_pk_fma_f32 v[194:195], v[200:201], v[186:187], v[194:195] op_sel_hi:[0,1,1] neg_lo:[0,0,1] neg_hi:[0,0,1]
v_pk_fma_f32 v[196:197], v[200:201], v[188:189], v[196:197] op_sel_hi:[0,1,1] neg_lo:[0,0,1] neg_hi:[0,0,1]
v_pk_fma_f32 v[198:199], v[200:201], v[190:191], v[198:199] op_sel_hi:[0,1,1] neg_lo:[0,0,1] neg_hi:[0,0,1]
v_cvt_pk_bf16_f32 v164, v192, v193
v_cvt_pk_bf16_f32 v165, v194, v195
v_cvt_pk_bf16_f32 v166, v196, v197
v_cvt_pk_bf16_f32 v167, v198, v199
v_pk_fma_f32 v[184:185], v[200:201], v[192:193], v[184:185] op_sel_hi:[0,1,1] neg_lo:[0,0,1] neg_hi:[0,0,1]
v_pk_fma_f32 v[186:187], v[200:201], v[194:195], v[186:187] op_sel_hi:[0,1,1] neg_lo:[0,0,1] neg_hi:[0,0,1]
v_pk_fma_f32 v[188:189], v[200:201], v[196:197], v[188:189] op_sel_hi:[0,1,1] neg_lo:[0,0,1] neg_hi:[0,0,1]
v_pk_fma_f32 v[190:191], v[200:201], v[198:199], v[190:191] op_sel_hi:[0,1,1] neg_lo:[0,0,1] neg_hi:[0,0,1]
v_cvt_pk_bf16_f32 v168, v184, v185
v_cvt_pk_bf16_f32 v169, v186, v187
v_cvt_pk_bf16_f32 v170, v188, v189
v_cvt_pk_bf16_f32 v171, v190, v191
v_pk_fma_f32 v[192:193], v[200:201], v[184:185], v[192:193] op_sel_hi:[0,1,1] neg_lo:[0,0,1] neg_hi:[0,0,1]
v_pk_fma_f32 v[194:195], v[200:201], v[186:187], v[194:195] op_sel_hi:[0,1,1] neg_lo:[0,0,1] neg_hi:[0,0,1]
v_pk_fma_f32 v[196:197], v[200:201], v[188:189], v[196:197] op_sel_hi:[0,1,1] neg_lo:[0,0,1] neg_hi:[0,0,1]
v_pk_fma_f32 v[198:199], v[200:201], v[190:191], v[198:199] op_sel_hi:[0,1,1] neg_lo:[0,0,1] neg_hi:[0,0,1]
s_mov_b32 exec_lo, 0
v_mul_f32 v198, 0.5, v198
s_mov_b32 exec_lo, -1
v_cvt_pk_bf16_f32 v172, v192, v193
v_cvt_pk_bf16_f32 v173, v194, v195
v_cvt_pk_bf16_f32 v174, v196, v197
v_cvt_pk_bf16_f32 v175, v198, v199
v_and_b32 v1, 0x2f0, v0
v_bfe_u32 v3, v0, 8, 1
v_lshl_add_u32 v1, v3, 3, v1
s_mul_i32 s18, s46, 40960
s_mul_i32 s19, s16, 3145728
s_add_u32 s26, s18, s19
s_add_u32 s27, s26, s19
s_add_u32 s27, s27, s33
s_add_u32 s27, s27, 88080384
s_add_u32 s26, s26, s31
s_add_u32 s26, s26, 103809024
s_mov_b32 s39, 0x20000
s_cmp_lg_u32 s16, 0
s_cbranch_scc1 rs_45
s_mov_b64 s[36:37], s[40:41]
s_mov_b32 s38, s42
s_lshr_b32 s47, s33, 5
s_add_u32 s47, s47, s18
s_add_u32 s48, s47, 32
v_mov_b32 v13, v5
s_branch rs_46
rs_45:
s_mov_b64 s[36:37], s[4:5]
s_mov_b32 s38, s6
s_sub_u32 s47, s27, 3145728
s_add_u32 s48, s47, 1024
v_mov_b32 v13, v0
rs_46:
s_cmp_lg_u32 s13, 0
s_cbranch_scc1 polld_48
v_min_u32 v12, 624, v0
s_mov_b32 s21, 7168
s_mov_b32 s17, 0
poll_47:
buffer_load_dwordx4 v[8:11], v12, s[4:7], s21 offen offset:0 sc1
s_add_u32 s17, s17, 1
s_cmp_gt_u32 s17, 262144
s_cbranch_scc1 L_fail
s_waitcnt vmcnt(0)
v_min3_u32 v8, v8, v9, v10
v_min_u32 v8, v8, v11
v_cmp_gt_u32 vcc, s29, v8
s_cbranch_vccz polld_48
s_sleep 2
s_branch poll_47
polld_48:
s_barrier
s_add_u32 m0, s31, 2048
s_add_u32 s20, s26, 0
buffer_load_dwordx4 v0, s[4:7], s20 offen sc1 lds
s_add_u32 m0, s31, 3072
s_add_u32 s20, s26, 1024
buffer_load_dwordx4 v0, s[4:7], s20 offen sc1 lds
s_add_u32 m0, s31, 4096
s_add_u32 s20, s26, 2048
buffer_load_dwordx4 v0, s[4:7], s20 offen sc1 lds
s_add_u32 m0, s31, 5120
s_add_u32 s20, s26, 3072
buffer_load_dwordx4 v0, s[4:7], s20 offen sc1 lds
s_add_u32 m0, s31, 6144
s_add_u32 s20, s26, 4096
buffer_load_dwordx4 v0, s[4:7], s20 offen sc1 lds
s_add_u32 m0, s31, 7168
s_add_u32 s20, s26, 5120
buffer_load_dwordx4 v0, s[4:7], s20 offen sc1 lds
s_add_u32 m0, s31, 8192
s_add_u32 s20, s26, 6144
buffer_load_dwordx4 v0, s[4:7], s20 offen sc1 lds
s_add_u32 m0, s31, 9216
s_add_u32 s20, s26, 7168
buffer_load_dwordx4 v0, s[4:7], s20 offen sc1 lds
s_add_u32 m0, s31, 10240
s_add_u32 s20, s26, 8192
buffer_load_dwordx4 v0, s[4:7], s20 offen sc1 lds
s_add_u32 m0, s31, 11264
s_add_u32 s20, s26, 9216
buffer_load_dwordx4 v0, s[4:7], s20 offen sc1 lds
s_add_u32 s26, s26, 1310720
s_add_u32 s25, s31, 40960
s_mov_b32 s28, 0
s_waitcnt vmcnt(0)
p3_49:
s_barrier
buffer_load_dwordx4 v[176:179], v13, s[36:39], s47 offen sc1
ds_read_b64_tr_b16 v[202:203], v1 offset:2304
ds_read_b64_tr_b16 v[200:201], v1 offset:2048
ds_read_b64_tr_b16 v[204:205], v1 offset:3072
ds_read_b64_tr_b16 v[212:213], v1 offset:5120
buffer_load_dwordx4 v[180:183], v13, s[36:39], s48 offen sc1
ds_read_b64_tr_b16 v[214:215], v1 offset:5376
ds_read_b64_tr_b16 v[206:207], v1 offset:3328
ds_read_b64_tr_b16 v[210:211], v1 offset:4352
s_add_u32 m0, s25, 2048
s_add_u32 s20, s26, 0
buffer_load_dwordx4 v0, s[4:7], s20 offen sc1 lds
ds_read_b64_tr_b16 v[208:209], v1 offset:4096
s_add_u32 m0, s25, 3072
s_add_u32 s20, s26, 1024
buffer_load_dwordx4 v0, s[4:7], s20 offen sc1 lds
s_waitcnt lgkmcnt(6)
v_mfma_f32_32x32x16_bf16 v[184:199], v[16:19], v[200:203], 0
s_waitcnt lgkmcnt(5)
ds_read_b64_tr_b16 v[202:203], v1 offset:6400
ds_read_b64_tr_b16 v[200:201], v1 offset:6144
s_add_u32 m0, s25, 4096
s_add_u32 s20, s26, 2048
buffer_load_dwordx4 v0, s[4:7], s20 offen sc1 lds
s_waitcnt lgkmcnt(4)
v_mfma_f32_32x32x16_bf16 v[184:199], v[20:23], v[204:207], v[184:199]
s_waitcnt lgkmcnt(2)
ds_read_b64_tr_b16 v[204:205], v1 offset:7168
ds_read_b64_tr_b16 v[206:207], v1 offset:7424
v_mfma_f32_32x32x16_bf16 v[184:199], v[24:27], v[208:211], v[184:199]
ds_read_b64_tr_b16 v[208:209], v1 offset:8192
s_waitcnt lgkmcnt(3)
ds_read_b64_tr_b16 v[210:211], v1 offset:8448
v_mfma_f32_32x32x16_bf16 v[184:199], v[28:31], v[212:215], v[184:199]
ds_read_b64_tr_b16 v[214:215], v1 offset:9472
ds_read_b64_tr_b16 v[212:213], v1 offset:9216
v_mfma_f32_32x32x16_bf16 v[184:199], v[32:35], v[200:203], v[184:199]
s_waitcnt lgkmcnt(5)
s_waitcnt lgkmcnt(4)
ds_read_b64_tr_b16 v[200:201], v1 offset:10240
s_waitcnt lgkmcnt(4)
ds_read_b64_tr_b16 v[202:203], v1 offset:10496
v_mfma_f32_32x32x16_bf16 v[184:199], v[36:39], v[204:207], v[184:199]
s_waitcnt lgkmcnt(2)
ds_read_b64_tr_b16 v[206:207], v1 offset:11520
ds_read_b64_tr_b16 v[204:205], v1 offset:11264
v_mfma_f32_32x32x16_bf16 v[184:199], v[40:43], v[208:211], v[184:199]
ds_read_b64_tr_b16 v[210:211], v1 offset:12544
v_mfma_f32_32x32x16_bf16 v[184:199], v[44:47], v[212:215], v[184:199]
s_waitcnt lgkmcnt(3)
ds_read_b64_tr_b16 v[208:209], v1 offset:12288
ds_read_b64_tr_b16 v[212:213], v1 offset:13312
s_add_u32 m0, s25, 5120
s_add_u32 s20, s26, 3072
buffer_load_dwordx4 v0, s[4:7], s20 offen sc1 lds
v_mfma_f32_32x32x16_bf16 v[184:199], v[48:51], v[200:203], v[184:199]
s_waitcnt lgkmcnt(2)
ds_read_b64_tr_b16 v[214:215], v1 offset:13568
ds_read_b64_tr_b16 v[202:203], v1 offset:14592
s_add_u32 m0, s25, 6144
s_add_u32 s20, s26, 4096
buffer_load_dwordx4 v0, s[4:7], s20 offen sc1 lds
ds_read_b64_tr_b16 v[200:201], v1 offset:14336
v_mfma_f32_32x32x16_bf16 v[184:199], v[52:55], v[204:207], v[184:199]
s_add_u32 m0, s25, 7168
s_add_u32 s20, s26, 5120
buffer_load_dwordx4 v0, s[4:7], s20 offen sc1 lds
ds_read_b64_tr_b16 v[204:205], v1 offset:15360
s_waitcnt lgkmcnt(4)
ds_read_b64_tr_b16 v[206:207], v1 offset:15616
v_mfma_f32_32x32x16_bf16 v[184:199], v[56:59], v[208:211], v[184:199]
s_waitcnt lgkmcnt(2)
ds_read_b64_tr_b16 v[208:209], v1 offset:16384
v_mfma_f32_32x32x16_bf16 v[184:199], v[60:63], v[212:215], v[184:199]
ds_read_b64_tr_b16 v[210:211], v1 offset:16640
s_waitcnt lgkmcnt(3)
ds_read_b64_tr_b16 v[212:213], v1 offset:17408
v_mfma_f32_32x32x16_bf16 v[184:199], v[64:67], v[200:203], v[184:199]
ds_read_b64_tr_b16 v[200:201], v1 offset:18432
ds_read_b64_tr_b16 v[214:215], v1 offset:17664
s_waitcnt lgkmcnt(4)
ds_read_b64_tr_b16 v[202:203], v1 offset:18688
v_mfma_f32_32x32x16_bf16 v[184:199], v[68:71], v[204:207], v[184:199]
s_waitcnt lgkmcnt(4)
v_mfma_f32_32x32x16_bf16 v[184:199], v[72:75], v[208:211], v[184:199]
ds_read_b64_tr_b16 v[210:211], v1 offset:20736
s_waitcnt lgkmcnt(3)
ds_read_b64_tr_b16 v[208:209], v1 offset:20480
ds_read_b64_tr_b16 v[206:207], v1 offset:19712
s_waitcnt lgkmcnt(4)
ds_read_b64_tr_b16 v[204:205], v1 offset:19456
v_mfma_f32_32x32x16_bf16 v[184:199], v[76:79], v[212:215], v[184:199]
ds_read_b64_tr_b16 v[214:215], v1 offset:21760
s_waitcnt lgkmcnt(5)
v_mfma_f32_32x32x16_bf16 v[184:199], v[80:83], v[200:203], v[184:199]
ds_read_b64_tr_b16 v[212:213], v1 offset:21504
ds_read_b64_tr_b16 v[200:201], v1 offset:22528
s_waitcnt lgkmcnt(4)
ds_read_b64_tr_b16 v[202:203], v1 offset:22784
s_waitcnt lgkmcnt(4)
v_mfma_f32_32x32x16_bf16 v[184:199], v[84:87], v[204:207], v[184:199]
ds_read_b64_tr_b16 v[204:205], v1 offset:23552
s_waitcnt lgkmcnt(4)
v_mfma_f32_32x32x16_bf16 v[184:199], v[88:91], v[208:211], v[184:199]
ds_read_b64_tr_b16 v[206:207], v1 offset:23808
s_add_u32 m0, s25, 8192
s_add_u32 s20, s26, 6144
buffer_load_dwordx4 v0, s[4:7], s20 offen sc1 lds
s_waitcnt lgkmcnt(4)
v_mfma_f32_32x32x16_bf16 v[184:199], v[92:95], v[212:215], v[184:199]
s_waitcnt lgkmcnt(2)
ds_read_b64_tr_b16 v[210:211], v1 offset:24832
ds_read_b64_tr_b16 v[214:215], v1 offset:25856
ds_read_b64_tr_b16 v[208:209], v1 offset:24576
s_waitcnt lgkmcnt(4)
v_mfma_f32_32x32x16_bf16 v[184:199], v[96:99], v[200:203], v[184:199]
ds_read_b64_tr_b16 v[212:213], v1 offset:25600
s_waitcnt lgkmcnt(4)
ds_read_b64_tr_b16 v[200:201], v1 offset:26624
ds_read_b64_tr_b16 v[202:203], v1 offset:26880
v_mfma_f32_32x32x16_bf16 v[184:199], v[100:103], v[204:207], v[184:199]
s_waitcnt lgkmcnt(4)
ds_read_b64_tr_b16 v[206:207], v1 offset:27904
s_waitcnt lgkmcnt(4)
ds_read_b64_tr_b16 v[204:205], v1 offset:27648
v_mfma_f32_32x32x16_bf16 v[184:199], v[104:107], v[208:211], v[184:199]
s_waitcnt lgkmcnt(4)
ds_read_b64_tr_b16 v[208:209], v1 offset:28672
ds_read_b64_tr_b16 v[210:211], v1 offset:28928
v_mfma_f32_32x32x16_bf16 v[184:199], v[108:111], v[212:215], v[184:199]
s_waitcnt lgkmcnt(3)
s_add_u32 m0, s25, 9216
s_add_u32 s20, s26, 7168
buffer_load_dwordx4 v0, s[4:7], s20 offen sc1 lds
v_mfma_f32_32x32x16_bf16 v[184:199], v[112:115], v[200:203], v[184:199]
ds_read_b64_tr_b16 v[202:203], v1 offset:30976
s_waitcnt lgkmcnt(2)
ds_read_b64_tr_b16 v[212:213], v1 offset:29696
ds_read_b64_tr_b16 v[200:201], v1 offset:30720
ds_read_b64_tr_b16 v[214:215], v1 offset:29952
s_waitcnt lgkmcnt(4)
v_mfma_f32_32x32x16_bf16 v[184:199], v[116:119], v[204:207], v[184:199]
s_add_u32 m0, s25, 10240
s_add_u32 s20, s26, 8192
buffer_load_dwordx4 v0, s[4:7], s20 offen sc1 lds
v_mfma_f32_32x32x16_bf16 v[184:199], v[120:123], v[208:211], v[184:199]
ds_read_b64_tr_b16 v[206:207], v1 offset:32000
s_waitcnt lgkmcnt(2)
ds_read_b64_tr_b16 v[208:209], v1 offset:32768
s_waitcnt lgkmcnt(2)
ds_read_b64_tr_b16 v[204:205], v1 offset:31744
v_mfma_f32_32x32x16_bf16 v[184:199], v[124:127], v[212:215], v[184:199]
ds_read_b64_tr_b16 v[210:211], v1 offset:33024
ds_read_b64_tr_b16 v[212:213], v1 offset:33792
s_add_u32 m0, s25, 11264
s_add_u32 s20, s26, 9216
buffer_load_dwordx4 v0, s[4:7], s20 offen sc1 lds
v_mfma_f32_32x32x16_bf16 v[184:199], v[128:131], v[200:203], v[184:199]
s_waitcnt lgkmcnt(2)
ds_read_b64_tr_b16 v[214:215], v1 offset:34048
ds_read_b64_tr_b16 v[200:201], v1 offset:34816
v_mfma_f32_32x32x16_bf16 v[184:199], v[132:135], v[204:207], v[184:199]
ds_read_b64_tr_b16 v[206:207], v1 offset:36096
s_waitcnt lgkmcnt(4)
ds_read_b64_tr_b16 v[202:203], v1 offset:35072
v_mfma_f32_32x32x16_bf16 v[184:199], v[136:139], v[208:211], v[184:199]
ds_read_b64_tr_b16 v[204:205], v1 offset:35840
ds_read_b64_tr_b16 v[208:209], v1 offset:36864
s_waitcnt lgkmcnt(5)
s_waitcnt lgkmcnt(4)
ds_read_b64_tr_b16 v[210:211], v1 offset:37120
v_mfma_f32_32x32x16_bf16 v[184:199], v[140:143], v[212:215], v[184:199]
ds_read_b64_tr_b16 v[214:215], v1 offset:38144
s_waitcnt lgkmcnt(5)
ds_read_b64_tr_b16 v[212:213], v1 offset:37888
s_waitcnt lgkmcnt(5)
v_mfma_f32_32x32x16_bf16 v[184:199], v[144:147], v[200:203], v[184:199]
s_waitcnt vmcnt(10)
s_waitcnt lgkmcnt(4)
ds_read_b64_tr_b16 v[200:201], v1 offset:38912
v_mfma_f32_32x32x16_bf16 v[184:199], v[148:151], v[204:207], v[184:199]
ds_read_b64_tr_b16 v[204:205], v1 offset:39936
s_waitcnt lgkmcnt(3)
s_waitcnt lgkmcnt(2)
ds_read_b64_tr_b16 v[206:207], v1 offset:40192
ds_read_b64_tr_b16 v[202:203], v1 offset:39168
v_lshlrev_b32 v3, 16, v176
v_mfma_f32_32x32x16_bf16 v[184:199], v[152:155], v[208:211], v[184:199]
v_mfma_f32_32x32x16_bf16 v[184:199], v[156:159], v[212:215], v[184:199]
s_waitcnt lgkmcnt(2)
ds_read_b64_tr_b16 v[210:211], v1 offset:41216
ds_read_b64_tr_b16 v[214:215], v1 offset:42240
s_waitcnt lgkmcnt(3)
ds_read_b64_tr_b16 v[212:213], v1 offset:41984
ds_read_b64_tr_b16 v[208:209], v1 offset:40960
s_waitcnt lgkmcnt(4)
v_mfma_f32_32x32x16_bf16 v[184:199], v[160:163], v[200:203], v[184:199]
v_mfma_f32_32x32x16_bf16 v[184:199], v[164:167], v[204:207], v[184:199]
v_and_b32 v4, 0xffff0000, v176
s_waitcnt lgkmcnt(1)
s_waitcnt lgkmcnt(0)
v_mfma_f32_32x32x16_bf16 v[184:199], v[168:171], v[208:211], v[184:199]
v_mfma_f32_32x32x16_bf16 v[184:199], v[172:175], v[212:215], v[184:199]
s_nop 11
v_fmamk_f32 v184, v184, 0x3b4ccccd, v3
v_fmamk_f32 v185, v185, 0x3b4ccccd, v4
v_lshlrev_b32 v3, 16, v177
v_and_b32 v4, 0xffff0000, v177
v_fmamk_f32 v187, v187, 0x3b4ccccd, v4
v_fmamk_f32 v186, v186, 0x3b4ccccd, v3
v_and_b32 v4, 0xffff0000, v178
v_lshlrev_b32 v3, 16, v178
v_fmamk_f32 v188, v188, 0x3b4ccccd, v3
v_lshlrev_b32 v3, 16, v179
v_fmamk_f32 v190, v190, 0x3b4ccccd, v3
v_fmamk_f32 v189, v189, 0x3b4ccccd, v4
v_and_b32 v4, 0xffff0000, v179
v_fmamk_f32 v191, v191, 0x3b4ccccd, v4
v_and_b32 v4, 0xffff0000, v180
v_lshlrev_b32 v3, 16, v180
v_fmamk_f32 v192, v192, 0x3b4ccccd, v3
v_lshlrev_b32 v3, 16, v181
v_fmamk_f32 v194, v194, 0x3b4ccccd, v3
v_fmamk_f32 v193, v193, 0x3b4ccccd, v4
v_lshlrev_b32 v3, 16, v182
v_cvt_pk_bf16_f32 v201, v186, v187
v_fmamk_f32 v196, v196, 0x3b4ccccd, v3
v_and_b32 v4, 0xffff0000, v181
v_fmamk_f32 v195, v195, 0x3b4ccccd, v4
v_and_b32 v4, 0xffff0000, v182
v_fmamk_f32 v197, v197, 0x3b4ccccd, v4
v_cvt_pk_bf16_f32 v202, v188, v189
v_lshlrev_b32 v3, 16, v183
v_cvt_pk_bf16_f32 v200, v184, v185
v_cvt_pk_bf16_f32 v205, v194, v195
v_cvt_pk_bf16_f32 v203, v190, v191
v_and_b32 v4, 0xffff0000, v183
v_fmamk_f32 v198, v198, 0x3b4ccccd, v3
v_fmamk_f32 v199, v199, 0x3b4ccccd, v4
v_cvt_pk_bf16_f32 v206, v196, v197
v_cvt_pk_bf16_f32 v207, v198, v199
v_cvt_pk_bf16_f32 v204, v192, v193
buffer_store_dwordx4 v[200:203], v0, s[4:7], s27 offen offset:0 sc1
buffer_store_dwordx4 v[204:207], v0, s[4:7], s27 offen offset:1024 sc1
v_xor_b32 v1, 40960, v1
s_mov_b32 s26, s6
s_mov_b32 s25, s31
s_add_u32 s27, s27, 1310720
s_add_u32 s47, s47, 1310720
s_add_u32 s48, s48, 1310720
s_add_u32 s28, s28, 1
s_lshl_b32 s18, s35, 2
s_add_u32 s18, s18, 8192
s_lshl_b32 s19, s16, 1
s_add_u32 s19, s19, s28
s_cmp_eq_u32 s13, 0
s_cselect_b32 s22, s18, s6
s_mov_b32 s23, s19
s_waitcnt vmcnt(0)
s_barrier
v_mov_b32 v3, s23
s_mov_b64 exec, 1
buffer_store_dword v3, off, s[4:7], s22 sc1
s_mov_b64 exec, -1
s_mov_b32 s22, s6
s_cmp_lt_u32 s28, 2
s_cbranch_scc1 p3_49
s_cmp_ge_u32 s35, 144
s_cbranch_scc1 p1b_51
s_cmp_ge_u32 s35, 64
s_cbranch_scc1 wo_50
s_and_b32 s32, s35, 31
s_cmp_lg_u32 s16, 0
s_cbranch_scc1 qw_54
s_lshl_b32 s26, s32, 8
s_lshl_b32 s18, s13, 6
s_add_u32 s26, s26, s18
s_load_dwordx2 s[36:37], s[0:1], 40
s_mov_b32 s38, 5242880
s_mov_b32 s39, 0x20000
s_waitcnt lgkmcnt(0)
v_lshrrev_b32 v34, 6, v0
v_mul_u32_u24 v34, 8192, v34
v_and_b32 v35, 48, v0
v_add_u32 v32, v34, v35
v_bfe_u32 v34, v0, 6, 2
v_lshrrev_b32 v35, 9, v0
v_lshl_add_u32 v34, v35, 3, v34
v_lshlrev_b32 v33, 6, v34
v_and_b32 v34, 16, v0
v_add_u32 v33, v33, v34
v_bfe_u32 v34, v0, 5, 1
v_lshl_add_u32 v33, v34, 3, v33
v_bfe_u32 v34, v0, 8, 1
v_lshl_add_u32 v33, v34, 5, v33
s_mul_i32 s18, s13, 36864
v_add_u32 v33, s18, v33
s_barrier
s_add_u32 m0, s18, 0
s_add_u32 s19, s26, 0
buffer_load_dwordx4 v32, s[36:39], s19 offen lds
s_add_u32 m0, s18, 1024
s_add_u32 s19, s26, 131072
buffer_load_dwordx4 v32, s[36:39], s19 offen lds
s_add_u32 m0, s18, 2048
s_add_u32 s19, s26, 262144
buffer_load_dwordx4 v32, s[36:39], s19 offen lds
s_add_u32 m0, s18, 3072
s_add_u32 s19, s26, 393216
buffer_load_dwordx4 v32, s[36:39], s19 offen lds
s_add_u32 m0, s18, 4096
s_add_u32 s19, s26, 524288
buffer_load_dwordx4 v32, s[36:39], s19 offen lds
s_add_u32 m0, s18, 5120
s_add_u32 s19, s26, 655360
buffer_load_dwordx4 v32, s[36:39], s19 offen lds
s_add_u32 m0, s18, 6144
s_add_u32 s19, s26, 786432
buffer_load_dwordx4 v32, s[36:39], s19 offen lds
s_add_u32 m0, s18, 7168
s_add_u32 s19, s26, 917504
buffer_load_dwordx4 v32, s[36:39], s19 offen lds
s_add_u32 m0, s18, 8192
s_add_u32 s19, s26, 1048576
buffer_load_dwordx4 v32, s[36:39], s19 offen lds
s_add_u32 m0, s18, 9216
s_add_u32 s19, s26, 1179648
buffer_load_dwordx4 v32, s[36:39], s19 offen lds
s_add_u32 m0, s18, 10240
s_add_u32 s19, s26, 1310720
buffer_load_dwordx4 v32, s[36:39], s19 offen lds
s_add_u32 m0, s18, 11264
s_add_u32 s19, s26, 1441792
buffer_load_dwordx4 v32, s[36:39], s19 offen lds
s_add_u32 m0, s18, 12288
s_add_u32 s19, s26, 1572864
buffer_load_dwordx4 v32, s[36:39], s19 offen lds
s_add_u32 m0, s18, 13312
s_add_u32 s19, s26, 1703936
buffer_load_dwordx4 v32, s[36:39], s19 offen lds
s_add_u32 m0, s18, 14336
s_add_u32 s19, s26, 1835008
buffer_load_dwordx4 v32, s[36:39], s19 offen lds
s_add_u32 m0, s18, 15360
s_add_u32 s19, s26, 1966080
buffer_load_dwordx4 v32, s[36:39], s19 offen lds
s_add_u32 m0, s18, 16384
s_add_u32 s19, s26, 2097152
buffer_load_dwordx4 v32, s[36:39], s19 offen lds
s_add_u32 m0, s18, 17408
s_add_u32 s19, s26, 2228224
buffer_load_dwordx4 v32, s[36:39], s19 offen lds
s_add_u32 m0, s18, 18432
s_add_u32 s19, s26, 2359296
buffer_load_dwordx4 v32, s[36:39], s19 offen lds
s_add_u32 m0, s18, 19456
s_add_u32 s19, s26, 2490368
buffer_load_dwordx4 v32, s[36:39], s19 offen lds
s_add_u32 m0, s18, 20480
s_add_u32 s19, s26, 2621440
buffer_load_dwordx4 v32, s[36:39], s19 offen lds
s_add_u32 m0, s18, 21504
s_add_u32 s19, s26, 2752512
buffer_load_dwordx4 v32, s[36:39], s19 offen lds
s_add_u32 m0, s18, 22528
s_add_u32 s19, s26, 2883584
buffer_load_dwordx4 v32, s[36:39], s19 offen lds
s_add_u32 m0, s18, 23552
s_add_u32 s19, s26, 3014656
buffer_load_dwordx4 v32, s[36:39], s19 offen lds
s_add_u32 m0, s18, 24576
s_add_u32 s19, s26, 3145728
buffer_load_dwordx4 v32, s[36:39], s19 offen lds
s_add_u32 m0, s18, 25600
s_add_u32 s19, s26, 3276800
buffer_load_dwordx4 v32, s[36:39], s19 offen lds
s_add_u32 m0, s18, 26624
s_add_u32 s19, s26, 3407872
buffer_load_dwordx4 v32, s[36:39], s19 offen lds
s_add_u32 m0, s18, 27648
s_add_u32 s19, s26, 3538944
buffer_load_dwordx4 v32, s[36:39], s19 offen lds
s_add_u32 m0, s18, 28672
s_add_u32 s19, s26, 3670016
buffer_load_dwordx4 v32, s[36:39], s19 offen lds
s_add_u32 m0, s18, 29696
s_add_u32 s19, s26, 3801088
buffer_load_dwordx4 v32, s[36:39], s19 offen lds
s_add_u32 m0, s18, 30720
s_add_u32 s19, s26, 3932160
buffer_load_dwordx4 v32, s[36:39], s19 offen lds
s_add_u32 m0, s18, 31744
s_add_u32 s19, s26, 4063232
buffer_load_dwordx4 v32, s[36:39], s19 offen lds
s_add_u32 m0, s18, 32768
s_add_u32 s19, s26, 4194304
buffer_load_dwordx4 v32, s[36:39], s19 offen lds
s_add_u32 m0, s18, 33792
s_add_u32 s19, s26, 4325376
buffer_load_dwordx4 v32, s[36:39], s19 offen lds
s_add_u32 m0, s18, 34816
s_add_u32 s19, s26, 4456448
buffer_load_dwordx4 v32, s[36:39], s19 offen lds
s_add_u32 m0, s18, 35840
s_add_u32 s19, s26, 4587520
buffer_load_dwordx4 v32, s[36:39], s19 offen lds
s_waitcnt vmcnt(32)
ds_read_b64_tr_b16 a[0:1], v33 offset:0
ds_read_b64_tr_b16 a[2:3], v33 offset:256
ds_read_b64_tr_b16 a[4:5], v33 offset:1024
ds_read_b64_tr_b16 a[6:7], v33 offset:1280
ds_read_b64_tr_b16 a[8:9], v33 offset:2048
ds_read_b64_tr_b16 a[10:11], v33 offset:2304
ds_read_b64_tr_b16 a[12:13], v33 offset:3072
ds_read_b64_tr_b16 a[14:15], v33 offset:3328
s_waitcnt lgkmcnt(0)
s_add_u32 m0, s18, 0
s_add_u32 s19, s26, 4718592
buffer_load_dwordx4 v32, s[36:39], s19 offen lds
s_add_u32 m0, s18, 1024
s_add_u32 s19, s26, 4849664
buffer_load_dwordx4 v32, s[36:39], s19 offen lds
s_add_u32 m0, s18, 2048
s_add_u32 s19, s26, 4980736
buffer_load_dwordx4 v32, s[36:39], s19 offen lds
s_add_u32 m0, s18, 3072
s_add_u32 s19, s26, 5111808
buffer_load_dwordx4 v32, s[36:39], s19 offen lds
s_waitcnt vmcnt(32)
ds_read_b64_tr_b16 a[16:17], v33 offset:4096
ds_read_b64_tr_b16 a[18:19], v33 offset:4352
ds_read_b64_tr_b16 a[20:21], v33 offset:5120
ds_read_b64_tr_b16 a[22:23], v33 offset:5376
ds_read_b64_tr_b16 a[24:25], v33 offset:6144
ds_read_b64_tr_b16 a[26:27], v33 offset:6400
ds_read_b64_tr_b16 a[28:29], v33 offset:7168
ds_read_b64_tr_b16 a[30:31], v33 offset:7424
s_waitcnt vmcnt(28)
ds_read_b64_tr_b16 a[32:33], v33 offset:8192
ds_read_b64_tr_b16 a[34:35], v33 offset:8448
ds_read_b64_tr_b16 a[36:37], v33 offset:9216
ds_read_b64_tr_b16 a[38:39], v33 offset:9472
ds_read_b64_tr_b16 a[40:41], v33 offset:10240
ds_read_b64_tr_b16 a[42:43], v33 offset:10496
ds_read_b64_tr_b16 a[44:45], v33 offset:11264
ds_read_b64_tr_b16 a[46:47], v33 offset:11520
s_waitcnt vmcnt(24)
ds_read_b64_tr_b16 a[48:49], v33 offset:12288
ds_read_b64_tr_b16 a[50:51], v33 offset:12544
ds_read_b64_tr_b16 a[52:53], v33 offset:13312
ds_read_b64_tr_b16 a[54:55], v33 offset:13568
ds_read_b64_tr_b16 a[56:57], v33 offset:14336
ds_read_b64_tr_b16 a[58:59], v33 offset:14592
ds_read_b64_tr_b16 a[60:61], v33 offset:15360
ds_read_b64_tr_b16 a[62:63], v33 offset:15616
s_waitcnt vmcnt(20)
ds_read_b64_tr_b16 a[64:65], v33 offset:16384
ds_read_b64_tr_b16 a[66:67], v33 offset:16640
ds_read_b64_tr_b16 a[68:69], v33 offset:17408
ds_read_b64_tr_b16 a[70:71], v33 offset:17664
ds_read_b64_tr_b16 a[72:73], v33 offset:18432
ds_read_b64_tr_b16 a[74:75], v33 offset:18688
ds_read_b64_tr_b16 a[76:77], v33 offset:19456
ds_read_b64_tr_b16 a[78:79], v33 offset:19712
s_waitcnt vmcnt(16)
ds_read_b64_tr_b16 a[80:81], v33 offset:20480
ds_read_b64_tr_b16 a[82:83], v33 offset:20736
ds_read_b64_tr_b16 a[84:85], v33 offset:21504
ds_read_b64_tr_b16 a[86:87], v33 offset:21760
ds_read_b64_tr_b16 a[88:89], v33 offset:22528
ds_read_b64_tr_b16 a[90:91], v33 offset:22784
ds_read_b64_tr_b16 a[92:93], v33 offset:23552
ds_read_b64_tr_b16 a[94:95], v33 offset:23808
s_waitcnt vmcnt(12)
ds_read_b64_tr_b16 a[96:97], v33 offset:24576
ds_read_b64_tr_b16 a[98:99], v33 offset:24832
ds_read_b64_tr_b16 a[100:101], v33 offset:25600
ds_read_b64_tr_b16 a[102:103], v33 offset:25856
ds_read_b64_tr_b16 a[104:105], v33 offset:26624
ds_read_b64_tr_b16 a[106:107], v33 offset:26880
ds_read_b64_tr_b16 a[108:109], v33 offset:27648
ds_read_b64_tr_b16 a[110:111], v33 offset:27904
s_waitcnt vmcnt(8)
ds_read_b64_tr_b16 a[112:113], v33 offset:28672
ds_read_b64_tr_b16 a[114:115], v33 offset:28928
ds_read_b64_tr_b16 a[116:117], v33 offset:29696
ds_read_b64_tr_b16 a[118:119], v33 offset:29952
ds_read_b64_tr_b16 a[120:121], v33 offset:30720
ds_read_b64_tr_b16 a[122:123], v33 offset:30976
ds_read_b64_tr_b16 a[124:125], v33 offset:31744
ds_read_b64_tr_b16 a[126:127], v33 offset:32000
s_waitcnt vmcnt(4)
ds_read_b64_tr_b16 a[128:129], v33 offset:32768
ds_read_b64_tr_b16 a[130:131], v33 offset:33024
ds_read_b64_tr_b16 a[132:133], v33 offset:33792
ds_read_b64_tr_b16 a[134:135], v33 offset:34048
ds_read_b64_tr_b16 a[136:137], v33 offset:34816
ds_read_b64_tr_b16 a[138:139], v33 offset:35072
ds_read_b64_tr_b16 a[140:141], v33 offset:35840
ds_read_b64_tr_b16 a[142:143], v33 offset:36096
s_waitcnt vmcnt(0)
ds_read_b64_tr_b16 a[144:145], v33 offset:0
ds_read_b64_tr_b16 a[146:147], v33 offset:256
ds_read_b64_tr_b16 a[148:149], v33 offset:1024
ds_read_b64_tr_b16 a[150:151], v33 offset:1280
ds_read_b64_tr_b16 a[152:153], v33 offset:2048
ds_read_b64_tr_b16 a[154:155], v33 offset:2304
ds_read_b64_tr_b16 a[156:157], v33 offset:3072
ds_read_b64_tr_b16 a[158:159], v33 offset:3328
s_waitcnt lgkmcnt(0)
s_barrier
v_mov_b32 v32, s24
v_mov_b32 v33, s24
v_mov_b32 v34, s24
v_mov_b32 v35, s24
s_nop 1
v_mfma_f32_32x32x16_bf16 v[36:51], a[0:3], v[32:35], 0
v_mfma_f32_32x32x16_bf16 v[36:51], a[4:7], v[32:35], v[36:51]
v_mfma_f32_32x32x16_bf16 v[36:51], a[8:11], v[32:35], v[36:51]
v_mfma_f32_32x32x16_bf16 v[36:51], a[12:15], v[32:35], v[36:51]
v_mfma_f32_32x32x16_bf16 v[36:51], a[16:19], v[32:35], v[36:51]
v_mfma_f32_32x32x16_bf16 v[36:51], a[20:23], v[32:35], v[36:51]
v_mfma_f32_32x32x16_bf16 v[36:51], a[24:27], v[32:35], v[36:51]
v_mfma_f32_32x32x16_bf16 v[36:51], a[28:31], v[32:35], v[36:51]
v_mfma_f32_32x32x16_bf16 v[36:51], a[32:35], v[32:35], v[36:51]
v_mfma_f32_32x32x16_bf16 v[36:51], a[36:39], v[32:35], v[36:51]
v_mfma_f32_32x32x16_bf16 v[36:51], a[40:43], v[32:35], v[36:51]
v_mfma_f32_32x32x16_bf16 v[36:51], a[44:47], v[32:35], v[36:51]
v_mfma_f32_32x32x16_bf16 v[36:51], a[48:51], v[32:35], v[36:51]
v_mfma_f32_32x32x16_bf16 v[36:51], a[52:55], v[32:35], v[36:51]
v_mfma_f32_32x32x16_bf16 v[36:51], a[56:59], v[32:35], v[36:51]
v_mfma_f32_32x32x16_bf16 v[36:51], a[60:63], v[32:35], v[36:51]
v_mfma_f32_32x32x16_bf16 v[36:51], a[64:67], v[32:35], v[36:51]
v_mfma_f32_32x32x16_bf16 v[36:51], a[68:71], v[32:35], v[36:51]
v_mfma_f32_32x32x16_bf16 v[36:51], a[72:75], v[32:35], v[36:51]
v_mfma_f32_32x32x16_bf16 v[36:51], a[76:79], v[32:35], v[36:51]
v_mfma_f32_32x32x16_bf16 v[36:51], a[80:83], v[32:35], v[36:51]
v_mfma_f32_32x32x16_bf16 v[36:51], a[84:87], v[32:35], v[36:51]
v_mfma_f32_32x32x16_bf16 v[36:51], a[88:91], v[32:35], v[36:51]
v_mfma_f32_32x32x16_bf16 v[36:51], a[92:95], v[32:35], v[36:51]
v_mfma_f32_32x32x16_bf16 v[36:51], a[96:99], v[32:35], v[36:51]
v_mfma_f32_32x32x16_bf16 v[36:51], a[100:103], v[32:35], v[36:51]
v_mfma_f32_32x32x16_bf16 v[36:51], a[104:107], v[32:35], v[36:51]
v_mfma_f32_32x32x16_bf16 v[36:51], a[108:111], v[32:35], v[36:51]
v_mfma_f32_32x32x16_bf16 v[36:51], a[112:115], v[32:35], v[36:51]
v_mfma_f32_32x32x16_bf16 v[36:51], a[116:119], v[32:35], v[36:51]
v_mfma_f32_32x32x16_bf16 v[36:51], a[120:123], v[32:35], v[36:51]
v_mfma_f32_32x32x16_bf16 v[36:51], a[124:127], v[32:35], v[36:51]
v_mfma_f32_32x32x16_bf16 v[36:51], a[128:131], v[32:35], v[36:51]
v_mfma_f32_32x32x16_bf16 v[36:51], a[132:135], v[32:35], v[36:51]
v_mfma_f32_32x32x16_bf16 v[36:51], a[136:139], v[32:35], v[36:51]
v_mfma_f32_32x32x16_bf16 v[36:51], a[140:143], v[32:35], v[36:51]
v_mfma_f32_32x32x16_bf16 v[36:51], a[144:147], v[32:35], v[36:51]
v_mfma_f32_32x32x16_bf16 v[36:51], a[148:151], v[32:35], v[36:51]
v_mfma_f32_32x32x16_bf16 v[36:51], a[152:155], v[32:35], v[36:51]
v_mfma_f32_32x32x16_bf16 v[36:51], a[156:159], v[32:35], v[36:51]
s_nop 11
v_mov_b32 v16, v36
v_mov_b32 v17, v37
v_mov_b32 v18, v38
v_mov_b32 v19, v39
v_mov_b32 v20, v40
v_mov_b32 v21, v41
v_mov_b32 v22, v42
v_mov_b32 v23, v43
v_mov_b32 v24, v44
v_mov_b32 v25, v45
v_mov_b32 v26, v46
v_mov_b32 v27, v47
v_mov_b32 v28, v48
v_mov_b32 v29, v49
v_mov_b32 v30, v50
v_mov_b32 v31, v51
v_accvgpr_write_b32 a160, v16
v_accvgpr_write_b32 a161, v17
v_accvgpr_write_b32 a162, v18
v_accvgpr_write_b32 a163, v19
v_accvgpr_write_b32 a164, v20
v_accvgpr_write_b32 a165, v21
v_accvgpr_write_b32 a166, v22
v_accvgpr_write_b32 a167, v23
v_accvgpr_write_b32 a168, v24
v_accvgpr_write_b32 a169, v25
v_accvgpr_write_b32 a170, v26
v_accvgpr_write_b32 a171, v27
v_accvgpr_write_b32 a172, v28
v_accvgpr_write_b32 a173, v29
v_accvgpr_write_b32 a174, v30
v_accvgpr_write_b32 a175, v31
qw_54:
v_accvgpr_read_b32 v16, a160
v_accvgpr_read_b32 v17, a161
v_accvgpr_read_b32 v18, a162
v_accvgpr_read_b32 v19, a163
v_accvgpr_read_b32 v20, a164
v_accvgpr_read_b32 v21, a165
v_accvgpr_read_b32 v22, a166
v_accvgpr_read_b32 v23, a167
v_accvgpr_read_b32 v24, a168
v_accvgpr_read_b32 v25, a169
v_accvgpr_read_b32 v26, a170
v_accvgpr_read_b32 v27, a171
v_accvgpr_read_b32 v28, a172
v_accvgpr_read_b32 v29, a173
v_accvgpr_read_b32 v30, a174
v_accvgpr_read_b32 v31, a175
s_lshl_b32 s29, s16, 1
s_add_u32 s29, s29, 2
s_lshr_b32 s48, s35, 5
s_lshl_b32 s49, s32, 7
s_add_u32 s49, s49, 0
s_cmp_lg_u32 s13, 0
s_cbranch_scc1 polld_56
v_min_u32 v12, 624, v0
s_mov_b32 s21, 8192
s_mov_b32 s17, 0
poll_55:
buffer_load_dwordx4 v[8:11], v12, s[4:7], s21 offen offset:0 sc1
s_add_u32 s17, s17, 1
s_cmp_gt_u32 s17, 262144
s_cbranch_scc1 L_fail
s_waitcnt vmcnt(0)
v_min3_u32 v8, v8, v9, v10
v_min_u32 v8, v8, v11
v_cmp_gt_u32 vcc, s29, v8
s_cbranch_vccz polld_56
s_sleep 2
s_branch poll_55
polld_56:
s_barrier
qr_57:
s_mul_i32 s26, s16, 6291456
s_mul_i32 s18, s48, 163840
s_add_u32 s26, s26, s18
s_add_u32 s26, s26, s31
s_add_u32 s26, s26, 88080384
s_lshl_b32 s18, s13, 11
s_add_u32 s18, s18, 83968
v_add_u32 v13, s18, v0
s_mov_b32 s28, 0
v_xor_b32 v1, 40960, v0
s_mov_b32 s25, s31
s_add_u32 m0, s25, 2048
s_add_u32 s20, s26, 0
buffer_load_dwordx4 v0, s[4:7], s20 offen sc1 lds
s_add_u32 m0, s25, 3072
s_add_u32 s20, s26, 1024
buffer_load_dwordx4 v0, s[4:7], s20 offen sc1 lds
s_add_u32 m0, s25, 4096
s_add_u32 s20, s26, 2048
buffer_load_dwordx4 v0, s[4:7], s20 offen sc1 lds
s_add_u32 m0, s25, 5120
s_add_u32 s20, s26, 3072
buffer_load_dwordx4 v0, s[4:7], s20 offen sc1 lds
s_add_u32 m0, s25, 6144
s_add_u32 s20, s26, 4096
buffer_load_dwordx4 v0, s[4:7], s20 offen sc1 lds
s_add_u32 m0, s25, 7168
s_add_u32 s20, s26, 5120
buffer_load_dwordx4 v0, s[4:7], s20 offen sc1 lds
s_add_u32 m0, s25, 8192
s_add_u32 s20, s26, 6144
buffer_load_dwordx4 v0, s[4:7], s20 offen sc1 lds
s_add_u32 m0, s25, 9216
s_add_u32 s20, s26, 7168
buffer_load_dwordx4 v0, s[4:7], s20 offen sc1 lds
s_add_u32 m0, s25, 10240
s_add_u32 s20, s26, 8192
buffer_load_dwordx4 v0, s[4:7], s20 offen sc1 lds
s_add_u32 m0, s25, 11264
s_add_u32 s20, s26, 9216
buffer_load_dwordx4 v0, s[4:7], s20 offen sc1 lds
s_waitcnt vmcnt(0)
qu_58:
v_xor_b32 v1, 40960, v1
s_sub_u32 s25, s25, s31
s_xor_b32 s25, s25, 40960
s_add_u32 s25, s25, s31
s_add_u32 s26, s26, 40960
s_cmp_eq_u32 s28, 3
s_cselect_b32 s26, s6, s26
s_waitcnt vmcnt(0)
s_barrier
v_add_u32 v2, s31, v1
ds_read_b128 v[76:79], v2 offset:3072
ds_read_b128 v[72:75], v2 offset:2048
s_add_u32 m0, s25, 2048
s_add_u32 s20, s26, 0
buffer_load_dwordx4 v0, s[4:7], s20 offen sc1 lds
ds_read_b128 v[84:87], v2 offset:5120
s_add_u32 m0, s25, 3072
s_add_u32 s20, s26, 1024
buffer_load_dwordx4 v0, s[4:7], s20 offen sc1 lds
s_add_u32 m0, s25, 4096
s_add_u32 s20, s26, 2048
buffer_load_dwordx4 v0, s[4:7], s20 offen sc1 lds
s_add_u32 m0, s25, 5120
s_add_u32 s20, s26, 3072
buffer_load_dwordx4 v0, s[4:7], s20 offen sc1 lds
ds_read_b128 v[56:59], v1 offset:4096
ds_read_b128 v[60:63], v1 offset:5120
ds_read_b128 v[80:83], v2 offset:4096
ds_read_b128 v[52:55], v1 offset:3072
ds_read_b128 v[48:51], v1 offset:2048
s_waitcnt lgkmcnt(6)
v_mov_b64 v[64:65], 0
v_dot2c_f32_bf16 v64, s24, v72
v_dot2c_f32_bf16 v65, v72, v72
v_dot2c_f32_bf16 v64, s24, v73
v_dot2c_f32_bf16 v65, v73, v73
v_dot2c_f32_bf16 v64, s24, v74
v_dot2c_f32_bf16 v65, v74, v74
v_dot2c_f32_bf16 v64, s24, v75
v_dot2c_f32_bf16 v65, v75, v75
v_dot2c_f32_bf16 v64, s24, v76
v_dot2c_f32_bf16 v65, v76, v76
v_dot2c_f32_bf16 v64, s24, v77
v_dot2c_f32_bf16 v65, v77, v77
v_dot2c_f32_bf16 v64, s24, v78
v_dot2c_f32_bf16 v65, v78, v78
v_dot2c_f32_bf16 v64, s24, v79
v_dot2c_f32_bf16 v65, v79, v79
s_waitcnt lgkmcnt(2)
ds_read_b128 v[76:79], v2 offset:7168
ds_read_b128 v[72:75], v2 offset:6144
v_dot2c_f32_bf16 v64, s24, v80
v_dot2c_f32_bf16 v65, v80, v80
v_dot2c_f32_bf16 v64, s24, v81
v_dot2c_f32_bf16 v65, v81, v81
v_dot2c_f32_bf16 v64, s24, v82
v_dot2c_f32_bf16 v65, v82, v82
v_dot2c_f32_bf16 v64, s24, v83
v_dot2c_f32_bf16 v65, v83, v83
v_dot2c_f32_bf16 v64, s24, v84
v_dot2c_f32_bf16 v65, v84, v84
v_dot2c_f32_bf16 v64, s24, v85
v_dot2c_f32_bf16 v65, v85, v85
v_dot2c_f32_bf16 v64, s24, v86
v_dot2c_f32_bf16 v65, v86, v86
v_dot2c_f32_bf16 v64, s24, v87
v_dot2c_f32_bf16 v65, v87, v87
s_add_u32 m0, s25, 6144
s_add_u32 s20, s26, 4096
buffer_load_dwordx4 v0, s[4:7], s20 offen sc1 lds
ds_read_b128 v[84:87], v2 offset:9216
ds_read_b128 v[80:83], v2 offset:8192
s_waitcnt lgkmcnt(2)
v_dot2c_f32_bf16 v64, s24, v72
v_dot2c_f32_bf16 v65, v72, v72
v_dot2c_f32_bf16 v64, s24, v73
v_dot2c_f32_bf16 v65, v73, v73
v_dot2c_f32_bf16 v64, s24, v74
v_dot2c_f32_bf16 v65, v74, v74
v_dot2c_f32_bf16 v64, s24, v75
v_dot2c_f32_bf16 v65, v75, v75
v_dot2c_f32_bf16 v64, s24, v76
v_dot2c_f32_bf16 v65, v76, v76
v_dot2c_f32_bf16 v64, s24, v77
v_dot2c_f32_bf16 v65, v77, v77
v_dot2c_f32_bf16 v64, s24, v78
v_dot2c_f32_bf16 v65, v78, v78
v_dot2c_f32_bf16 v64, s24, v79
v_dot2c_f32_bf16 v65, v79, v79
s_waitcnt lgkmcnt(1)
s_waitcnt lgkmcnt(0)
ds_read_b128 v[72:75], v2 offset:10240
ds_read_b128 v[76:79], v2 offset:11264
v_dot2c_f32_bf16 v64, s24, v80
v_dot2c_f32_bf16 v65, v80, v80
v_dot2c_f32_bf16 v64, s24, v81
v_dot2c_f32_bf16 v65, v81, v81
v_dot2c_f32_bf16 v64, s24, v82
v_dot2c_f32_bf16 v65, v82, v82
v_dot2c_f32_bf16 v64, s24, v83
v_dot2c_f32_bf16 v65, v83, v83
v_dot2c_f32_bf16 v64, s24, v84
v_dot2c_f32_bf16 v65, v84, v84
v_dot2c_f32_bf16 v64, s24, v85
v_dot2c_f32_bf16 v65, v85, v85
v_dot2c_f32_bf16 v64, s24, v86
v_dot2c_f32_bf16 v65, v86, v86
v_dot2c_f32_bf16 v64, s24, v87
v_dot2c_f32_bf16 v65, v87, v87
s_waitcnt lgkmcnt(1)
v_dot2c_f32_bf16 v64, s24, v72
v_dot2c_f32_bf16 v65, v72, v72
v_dot2c_f32_bf16 v64, s24, v73
v_dot2c_f32_bf16 v65, v73, v73
v_dot2c_f32_bf16 v64, s24, v74
s_waitcnt lgkmcnt(0)
v_dot2c_f32_bf16 v65, v74, v74
v_dot2c_f32_bf16 v64, s24, v75
v_dot2c_f32_bf16 v65, v75, v75
v_dot2c_f32_bf16 v64, s24, v76
v_dot2c_f32_bf16 v65, v76, v76
v_dot2c_f32_bf16 v64, s24, v77
v_dot2c_f32_bf16 v65, v77, v77
v_dot2c_f32_bf16 v64, s24, v78
v_dot2c_f32_bf16 v65, v78, v78
v_dot2c_f32_bf16 v64, s24, v79
v_dot2c_f32_bf16 v65, v79, v79
v_mfma_f32_32x32x16_bf16 v[32:47], a[0:3], v[48:51], 0
ds_read_b128 v[48:51], v1 offset:6144
s_add_u32 m0, s25, 7168
s_add_u32 s20, s26, 5120
buffer_load_dwordx4 v0, s[4:7], s20 offen sc1 lds
v_and_b32 v2, 0x1ff, v0
v_mfma_f32_32x32x16_bf16 v[32:47], a[4:7], v[52:55], v[32:47]
v_permlane32_swap_b32 v64, v65
v_add_f32 v64, v64, v65
ds_read_b128 v[52:55], v1 offset:7168
v_mfma_f32_32x32x16_bf16 v[32:47], a[8:11], v[56:59], v[32:47]
ds_read_b128 v[56:59], v1 offset:8192
s_add_u32 m0, s25, 8192
s_add_u32 s20, s26, 6144
buffer_load_dwordx4 v0, s[4:7], s20 offen sc1 lds
v_lshl_add_u32 v65, s13, 2, v0
v_mfma_f32_32x32x16_bf16 v[32:47], a[12:15], v[60:63], v[32:47]
ds_write_b32 v65, v64 offset:0
ds_read_b128 v[60:63], v1 offset:9216
s_waitcnt lgkmcnt(4)
v_mfma_f32_32x32x16_bf16 v[32:47], a[16:19], v[48:51], v[32:47]
s_waitcnt lgkmcnt(2)
v_mfma_f32_32x32x16_bf16 v[32:47], a[20:23], v[52:55], v[32:47]
ds_read_b128 v[48:51], v1 offset:10240
s_waitcnt lgkmcnt(2)
ds_read_b128 v[52:55], v1 offset:11264
v_mfma_f32_32x32x16_bf16 v[32:47], a[24:27], v[56:59], v[32:47]
s_waitcnt lgkmcnt(2)
s_barrier
ds_read_b128 v[64:67], v2 offset:0
ds_read_b128 v[56:59], v1 offset:12288
v_mfma_f32_32x32x16_bf16 v[32:47], a[28:31], v[60:63], v[32:47]
ds_read_b128 v[68:71], v2 offset:512
s_waitcnt lgkmcnt(4)
ds_read_b128 v[60:63], v1 offset:13312
v_mfma_f32_32x32x16_bf16 v[32:47], a[32:35], v[48:51], v[32:47]
s_add_u32 m0, s25, 9216
s_add_u32 s20, s26, 7168
buffer_load_dwordx4 v0, s[4:7], s20 offen sc1 lds
ds_read_b128 v[48:51], v1 offset:14336
s_waitcnt lgkmcnt(5)
v_mfma_f32_32x32x16_bf16 v[32:47], a[36:39], v[52:55], v[32:47]
s_waitcnt lgkmcnt(3)
v_mfma_f32_32x32x16_bf16 v[32:47], a[40:43], v[56:59], v[32:47]
ds_read_b128 v[52:55], v1 offset:15360
ds_read_b128 v[56:59], v1 offset:16384
s_waitcnt lgkmcnt(3)
s_waitcnt lgkmcnt(2)
v_mfma_f32_32x32x16_bf16 v[32:47], a[44:47], v[60:63], v[32:47]
ds_read_b128 v[60:63], v1 offset:17408
v_mfma_f32_32x32x16_bf16 v[32:47], a[48:51], v[48:51], v[32:47]
s_waitcnt lgkmcnt(2)
s_add_u32 m0, s25, 10240
s_add_u32 s20, s26, 8192
buffer_load_dwordx4 v0, s[4:7], s20 offen sc1 lds
ds_read_b128 v[48:51], v1 offset:18432
v_add_f32 v64, v64, v65
v_mfma_f32_32x32x16_bf16 v[32:47], a[52:55], v[52:55], v[32:47]
v_add_f32 v70, v70, v71
ds_read_b128 v[52:55], v1 offset:19456
v_add_f32 v68, v68, v69
s_waitcnt lgkmcnt(3)
v_mfma_f32_32x32x16_bf16 v[32:47], a[56:59], v[56:59], v[32:47]
ds_read_b128 v[56:59], v1 offset:20480
s_waitcnt lgkmcnt(3)
s_add_u32 m0, s25, 11264
s_add_u32 s20, s26, 9216
buffer_load_dwordx4 v0, s[4:7], s20 offen sc1 lds
v_mfma_f32_32x32x16_bf16 v[32:47], a[60:63], v[60:63], v[32:47]
v_add_f32 v68, v68, v70
v_add_f32 v66, v66, v67
s_waitcnt lgkmcnt(1)
v_add_f32 v64, v64, v66
v_mfma_f32_32x32x16_bf16 v[32:47], a[64:67], v[48:51], v[32:47]
s_waitcnt lgkmcnt(0)
ds_read_b128 v[60:63], v1 offset:21504
ds_read_b128 v[48:51], v1 offset:22528
v_mfma_f32_32x32x16_bf16 v[32:47], a[68:71], v[52:55], v[32:47]
ds_read_b128 v[52:55], v1 offset:23552
v_mfma_f32_32x32x16_bf16 v[32:47], a[72:75], v[56:59], v[32:47]
v_mul_f32 v68, 0x3acccccd, v68
v_mul_f32 v64, 0x3acccccd, v64
v_fma_f32 v68, -v64, v64, v68
s_waitcnt lgkmcnt(2)
v_max_f32 v68, 0, v68
v_mfma_f32_32x32x16_bf16 v[32:47], a[76:79], v[60:63], v[32:47]
ds_read_b128 v[60:63], v1 offset:25600
s_waitcnt lgkmcnt(1)
ds_read_b128 v[56:59], v1 offset:24576
v_add_f32 v68, 0x3727c5ac, v68
v_mfma_f32_32x32x16_bf16 v[32:47], a[80:83], v[48:51], v[32:47]
v_rsq_f32 v68, v68
ds_read_b128 v[48:51], v1 offset:26624
v_mul_f32 v68, 0x3e0293ee, v68
v_mfma_f32_32x32x16_bf16 v[32:47], a[84:87], v[52:55], v[32:47]
s_waitcnt lgkmcnt(1)
v_mfma_f32_32x32x16_bf16 v[32:47], a[88:91], v[56:59], v[32:47]
ds_read_b128 v[56:59], v1 offset:28672
ds_read_b128 v[52:55], v1 offset:27648
v_mfma_f32_32x32x16_bf16 v[32:47], a[92:95], v[60:63], v[32:47]
s_waitcnt lgkmcnt(2)
v_mfma_f32_32x32x16_bf16 v[32:47], a[96:99], v[48:51], v[32:47]
s_waitcnt lgkmcnt(1)
ds_read_b128 v[60:63], v1 offset:29696
ds_read_b128 v[48:51], v1 offset:30720
s_waitcnt lgkmcnt(2)
v_mfma_f32_32x32x16_bf16 v[32:47], a[100:103], v[52:55], v[32:47]
v_mul_f32 v64, v68, v64
ds_read_b128 v[52:55], v1 offset:31744
v_mfma_f32_32x32x16_bf16 v[32:47], a[104:107], v[56:59], v[32:47]
ds_read_b128 v[56:59], v1 offset:32768
s_waitcnt lgkmcnt(3)
v_mfma_f32_32x32x16_bf16 v[32:47], a[108:111], v[60:63], v[32:47]
s_waitcnt lgkmcnt(1)
ds_read_b128 v[60:63], v1 offset:33792
v_mul_f32 v87, v64, v31
v_mfma_f32_32x32x16_bf16 v[32:47], a[112:115], v[48:51], v[32:47]
v_mul_f32 v79, v64, v23
v_mul_f32 v80, v64, v24
v_mul_f32 v76, v64, v20
v_mul_f32 v74, v64, v18
v_mul_f32 v83, v64, v27
s_waitcnt lgkmcnt(1)
v_mfma_f32_32x32x16_bf16 v[32:47], a[116:119], v[52:55], v[32:47]
ds_read_b128 v[52:55], v1 offset:35840
ds_read_b128 v[48:51], v1 offset:34816
v_mul_f32 v81, v64, v25
v_mfma_f32_32x32x16_bf16 v[32:47], a[120:123], v[56:59], v[32:47]
v_mul_f32 v72, v64, v16
s_waitcnt lgkmcnt(2)
ds_read_b128 v[56:59], v1 offset:36864
v_mfma_f32_32x32x16_bf16 v[32:47], a[124:127], v[60:63], v[32:47]
s_waitcnt lgkmcnt(1)
ds_read_b128 v[60:63], v1 offset:37888
v_mfma_f32_32x32x16_bf16 v[32:47], a[128:131], v[48:51], v[32:47]
v_mul_f32 v86, v64, v30
ds_read_b128 v[48:51], v1 offset:38912
v_mfma_f32_32x32x16_bf16 v[32:47], a[132:135], v[52:55], v[32:47]
v_mul_f32 v77, v64, v21
ds_read_b128 v[52:55], v1 offset:39936
s_waitcnt lgkmcnt(3)
v_mul_f32 v82, v64, v26
v_mfma_f32_32x32x16_bf16 v[32:47], a[136:139], v[56:59], v[32:47]
s_waitcnt lgkmcnt(2)
ds_read_b128 v[56:59], v1 offset:40960
v_mul_f32 v84, v64, v28
v_mul_f32 v73, v64, v17
v_mfma_f32_32x32x16_bf16 v[32:47], a[140:143], v[60:63], v[32:47]
s_waitcnt lgkmcnt(2)
v_mul_f32 v78, v64, v22
v_mul_f32 v75, v64, v19
ds_read_b128 v[60:63], v1 offset:41984
v_mfma_f32_32x32x16_bf16 v[32:47], a[144:147], v[48:51], v[32:47]
s_waitcnt lgkmcnt(2)
s_waitcnt lgkmcnt(1)
v_mfma_f32_32x32x16_bf16 v[32:47], a[148:151], v[52:55], v[32:47]
s_waitcnt lgkmcnt(0)
v_mfma_f32_32x32x16_bf16 v[32:47], a[152:155], v[56:59], v[32:47]
v_mfma_f32_32x32x16_bf16 v[32:47], a[156:159], v[60:63], v[32:47]
s_nop 11
v_fma_f32 v35, v35, v68, -v75
v_fma_f32 v37, v37, v68, -v77
v_fma_f32 v41, v41, v68, -v81
v_fma_f32 v32, v32, v68, -v72
v_fma_f32 v40, v40, v68, -v80
v_fma_f32 v34, v34, v68, -v74
v_fma_f32 v36, v36, v68, -v76
v_cvt_pk_bf16_f32 v49, v34, v35
v_fma_f32 v38, v38, v68, -v78
v_cvt_pk_bf16_f32 v52, v40, v41
v_fma_f32 v43, v43, v68, -v83
v_fma_f32 v42, v42, v68, -v82
v_mul_f32 v85, v64, v29
v_fma_f32 v45, v45, v68, -v85
v_fma_f32 v44, v44, v68, -v84
v_fma_f32 v39, v39, v68, -v79
v_fma_f32 v47, v47, v68, -v87
v_cvt_pk_bf16_f32 v54, v44, v45
v_fma_f32 v46, v46, v68, -v86
v_fma_f32 v33, v33, v68, -v73
v_cvt_pk_bf16_f32 v53, v42, v43
v_cvt_pk_bf16_f32 v55, v46, v47
v_cvt_pk_bf16_f32 v51, v38, v39
v_cvt_pk_bf16_f32 v48, v32, v33
v_cvt_pk_bf16_f32 v50, v36, v37
ds_write_b128 v13, v[52:55] offset:1024
ds_write_b128 v13, v[48:51] offset:0
v_add_u32 v13, 8192, v13
s_add_u32 s28, s28, 1
s_cmp_lt_u32 s28, 4
s_cbranch_scc1 qu_58
s_waitcnt lgkmcnt(0)
s_barrier
s_lshl_b32 s30, s48, 2
s_add_u32 s30, s30, s13
s_lshl_b32 s18, s16, 6
s_add_u32 s29, s18, s30
s_lshl_b32 s27, s29, 18
s_lshl_b32 s19, s32, 13
s_add_u32 s27, s27, s19
s_add_u32 s27, s27, 127926272
s_mul_i32 s18, s16, 34603008
s_lshl_b32 s19, s30, 19
s_add_u32 s18, s18, s19
s_lshl_b32 s19, s32, 14
s_add_u32 s18, s18, s19
s_lshl_b32 s30, s29, 7
s_add_u32 s29, s29, 1
s_lshl_b32 s19, s13, 13
s_add_u32 s19, s19, 83968
v_add_u32 v200, s19, v0
s_add_u32 s50, s18, 16777216
s_add_u32 s51, s18, 16781312
s_add_u32 s52, s18, 16785408
s_add_u32 s53, s18, 16789504
ds_read_b128 v[32:35], v200 offset:0
ds_read_b128 v[36:39], v200 offset:1024
ds_read_b128 v[40:43], v200 offset:2048
ds_read_b128 v[44:47], v200 offset:3072
ds_read_b128 v[48:51], v200 offset:4096
ds_read_b128 v[52:55], v200 offset:5120
ds_read_b128 v[56:59], v200 offset:6144
ds_read_b128 v[60:63], v200 offset:7168
v_and_b32 v14, 0x70, v0
v_lshrrev_b32 v200, 8, v0
v_lshl_add_u32 v14, v200, 7, v14
v_bfe_u32 v200, v0, 7, 1
v_lshl_add_u32 v14, v200, 12, v14
v_and_b32 v15, 0x70, v0
v_lshrrev_b32 v200, 8, v0
v_lshl_add_u32 v15, v200, 7, v15
v_bfe_u32 v200, v0, 7, 1
v_lshl_add_u32 v15, v200, 10, v15
v_bfe_u32 v200, v0, 4, 5
v_lshrrev_b32 v144, 9, v0
v_lshlrev_b32 v144, 2, v144
v_sub_u32 v200, v200, v144
v_mov_b32 v145, 0xf149f2ca
v_cmp_gt_i32 vcc, 0, v200
s_nop 1
v_cndmask_b32 v128, 0, v145, vcc
v_cmp_gt_i32 vcc, 1, v200
s_nop 1
v_cndmask_b32 v129, 0, v145, vcc
v_cmp_gt_i32 vcc, 2, v200
s_nop 1
v_cndmask_b32 v130, 0, v145, vcc
v_cmp_gt_i32 vcc, 3, v200
s_nop 1
v_cndmask_b32 v131, 0, v145, vcc
v_cmp_gt_i32 vcc, 8, v200
s_nop 1
v_cndmask_b32 v132, 0, v145, vcc
v_cmp_gt_i32 vcc, 9, v200
s_nop 1
v_cndmask_b32 v133, 0, v145, vcc
v_cmp_gt_i32 vcc, 10, v200
s_nop 1
v_cndmask_b32 v134, 0, v145, vcc
v_cmp_gt_i32 vcc, 11, v200
s_nop 1
v_cndmask_b32 v135, 0, v145, vcc
v_cmp_gt_i32 vcc, 16, v200
s_nop 1
v_cndmask_b32 v136, 0, v145, vcc
v_cmp_gt_i32 vcc, 17, v200
s_nop 1
v_cndmask_b32 v137, 0, v145, vcc
v_cmp_gt_i32 vcc, 18, v200
s_nop 1
v_cndmask_b32 v138, 0, v145, vcc
v_cmp_gt_i32 vcc, 19, v200
s_nop 1
v_cndmask_b32 v139, 0, v145, vcc
v_cmp_gt_i32 vcc, 24, v200
s_nop 1
v_cndmask_b32 v140, 0, v145, vcc
v_cmp_gt_i32 vcc, 25, v200
s_nop 1
v_cndmask_b32 v141, 0, v145, vcc
v_cmp_gt_i32 vcc, 26, v200
s_nop 1
v_cndmask_b32 v142, 0, v145, vcc
v_cmp_gt_i32 vcc, 27, v200
s_nop 1
v_cndmask_b32 v143, 0, v145, vcc
v_lshrrev_b32 v12, 2, v0
v_min_u32 v12, 4, v12
s_mov_b32 s17, 0
poll_59:
buffer_load_dword v8, v12, s[4:7], s49 offen offset:0 sc1
s_add_u32 s17, s17, 1
s_cmp_gt_u32 s17, 262144
s_cbranch_scc1 L_fail
s_waitcnt vmcnt(0)
v_cmp_gt_u32 vcc, s29, v8
s_cbranch_vccz polld_60
s_sleep 2
s_branch poll_59
polld_60:
buffer_load_dwordx4 v[64:67], v14, s[4:7], s50 offen offset:0 sc1
buffer_load_dwordx4 v[68:71], v14, s[4:7], s50 offen offset:512 sc1
buffer_load_dwordx4 v[72:75], v14, s[4:7], s50 offen offset:1024 sc1
buffer_load_dwordx4 v[76:79], v14, s[4:7], s50 offen offset:1536 sc1
buffer_load_dwordx4 v[80:83], v14, s[4:7], s52 offen offset:0 sc1
buffer_load_dwordx4 v[84:87], v14, s[4:7], s52 offen offset:512 sc1
buffer_load_dwordx4 v[88:91], v14, s[4:7], s52 offen offset:1024 sc1
buffer_load_dwordx4 v[92:95], v14, s[4:7], s52 offen offset:1536 sc1
buffer_load_dwordx4 v[96:99], v15, s[4:7], s50 offen offset:2048 sc1
buffer_load_dwordx4 v[100:103], v15, s[4:7], s50 offen offset:2560 sc1
buffer_load_dwordx4 v[104:107], v15, s[4:7], s51 offen offset:2048 sc1
buffer_load_dwordx4 v[108:111], v15, s[4:7], s51 offen offset:2560 sc1
buffer_load_dwordx4 v[112:115], v15, s[4:7], s52 offen offset:2048 sc1
buffer_load_dwordx4 v[116:119], v15, s[4:7], s52 offen offset:2560 sc1
buffer_load_dwordx4 v[120:123], v15, s[4:7], s53 offen offset:2048 sc1
buffer_load_dwordx4 v[124:127], v15, s[4:7], s53 offen offset:2560 sc1
s_waitcnt vmcnt(15) lgkmcnt(7)
v_mfma_f32_32x32x16_bf16 v[128:143], v[64:67], v[32:35], v[128:143]
s_waitcnt vmcnt(14) lgkmcnt(6)
v_mfma_f32_32x32x16_bf16 v[128:143], v[68:71], v[36:39], v[128:143]
s_waitcnt vmcnt(13) lgkmcnt(5)
v_mfma_f32_32x32x16_bf16 v[128:143], v[72:75], v[40:43], v[128:143]
s_waitcnt vmcnt(12) lgkmcnt(4)
v_mfma_f32_32x32x16_bf16 v[128:143], v[76:79], v[44:47], v[128:143]
s_waitcnt vmcnt(11) lgkmcnt(3)
v_mfma_f32_32x32x16_bf16 v[128:143], v[80:83], v[48:51], v[128:143]
s_waitcnt vmcnt(10) lgkmcnt(2)
v_mfma_f32_32x32x16_bf16 v[128:143], v[84:87], v[52:55], v[128:143]
s_waitcnt vmcnt(9) lgkmcnt(1)
v_mfma_f32_32x32x16_bf16 v[128:143], v[88:91], v[56:59], v[128:143]
s_waitcnt vmcnt(8) lgkmcnt(0)
v_mfma_f32_32x32x16_bf16 v[128:143], v[92:95], v[60:63], v[128:143]
s_lshl_b32 s18, s16, 4
s_add_u32 s29, s18, s48
s_lshl_b32 s18, s29, 19
s_lshl_b32 s19, s32, 14
s_add_u32 s18, s18, s19
s_add_u32 s29, s29, 1
s_and_b32 s19, s13, 1
s_lshr_b32 s20, s13, 1
v_and_b32 v14, 0x170, v14
v_lshl_add_u32 v14, s19, 12, v14
v_lshl_add_u32 v14, s20, 7, v14
v_lshl_add_u32 v15, s19, 3, v15
v_lshl_add_u32 v15, s20, 9, v15
s_add_u32 s50, s18, 110100480
s_add_u32 s51, s18, 110104576
s_add_u32 s52, s18, 110108672
s_add_u32 s53, s18, 110112768
v_max3_f32 v200, v128, v129, v130
v_max3_f32 v200, v200, v131, v132
v_max3_f32 v200, v200, v133, v134
v_max3_f32 v200, v200, v135, v136
v_max3_f32 v200, v200, v137, v138
v_max3_f32 v200, v200, v139, v140
v_max3_f32 v200, v200, v141, v142
v_max_f32 v200, v200, v143
v_lshrrev_b32 v12, 2, v0
v_min_u32 v12, 4, v12
s_mov_b32 s17, 0
poll_61:
buffer_load_dword v8, v12, s[4:7], s49 offen offset:8 sc1
s_add_u32 s17, s17, 1
s_cmp_gt_u32 s17, 262144
s_cbranch_scc1 L_fail
s_waitcnt vmcnt(0)
v_cmp_gt_u32 vcc, s29, v8
s_cbranch_vccz polld_62
s_sleep 2
s_branch poll_61
polld_62:
buffer_load_dwordx4 v[64:67], v14, s[4:7], s50 offen offset:0 sc1
buffer_load_dwordx4 v[68:71], v14, s[4:7], s50 offen offset:512 sc1
buffer_load_dwordx4 v[72:75], v14, s[4:7], s50 offen offset:1024 sc1
buffer_load_dwordx4 v[76:79], v14, s[4:7], s50 offen offset:1536 sc1
buffer_load_dwordx4 v[80:83], v14, s[4:7], s52 offen offset:0 sc1
buffer_load_dwordx4 v[84:87], v14, s[4:7], s52 offen offset:512 sc1
buffer_load_dwordx4 v[88:91], v14, s[4:7], s52 offen offset:1024 sc1
buffer_load_dwordx4 v[92:95], v14, s[4:7], s52 offen offset:1536 sc1
buffer_load_dwordx2 v[192:193], v15, s[4:7], s50 offen offset:2048 sc1
buffer_load_dwordx2 v[194:195], v15, s[4:7], s51 offen offset:2048 sc1
buffer_load_dwordx2 v[196:197], v15, s[4:7], s52 offen offset:2048 sc1
buffer_load_dwordx2 v[198:199], v15, s[4:7], s53 offen offset:2048 sc1
s_waitcnt vmcnt(11)
v_mfma_f32_32x32x16_bf16 v[144:159], v[64:67], v[32:35], 0
s_waitcnt vmcnt(10)
v_mfma_f32_32x32x16_bf16 v[144:159], v[68:71], v[36:39], v[144:159]
s_waitcnt vmcnt(9)
v_mfma_f32_32x32x16_bf16 v[144:159], v[72:75], v[40:43], v[144:159]
s_waitcnt vmcnt(8)
v_mfma_f32_32x32x16_bf16 v[144:159], v[76:79], v[44:47], v[144:159]
s_waitcnt vmcnt(7)
v_mfma_f32_32x32x16_bf16 v[144:159], v[80:83], v[48:51], v[144:159]
s_waitcnt vmcnt(6)
v_mfma_f32_32x32x16_bf16 v[144:159], v[84:87], v[52:55], v[144:159]
s_waitcnt vmcnt(5)
v_mfma_f32_32x32x16_bf16 v[144:159], v[88:91], v[56:59], v[144:159]
s_waitcnt vmcnt(4)
v_mfma_f32_32x32x16_bf16 v[144:159], v[92:95], v[60:63], v[144:159]
s_nop 11
v_max3_f32 v148, v200, v144, v145
v_max3_f32 v148, v148, v146, v147
v_mov_b32 v150, v148
s_nop 1
v_permlane32_swap_b32 v148, v150
v_max_f32 v148, v148, v150
v_sub_f32 v147, v147, v148
v_sub_f32 v144, v144, v148
v_exp_f32 v144, v144
v_sub_f32 v145, v145, v148
v_sub_f32 v146, v146, v148
v_exp_f32 v147, v147
v_exp_f32 v146, v146
v_exp_f32 v145, v145
v_cvt_pk_bf16_f32 v41, v146, v147
v_cvt_pk_bf16_f32 v40, v144, v145
v_sub_f32 v134, v134, v148
v_sub_f32 v133, v133, v148
s_waitcnt vmcnt(1)
v_mfma_f32_32x32x8_bf16 v[64:79], v[196:197], v[40:41], 0
v_sub_f32 v129, v129, v148
v_exp_f32 v133, v133
v_exp_f32 v129, v129
v_sub_f32 v131, v131, v148
v_mfma_f32_32x32x8_bf16 v[176:191], v[194:195], v[40:41], 0
v_sub_f32 v132, v132, v148
v_exp_f32 v132, v132
v_exp_f32 v134, v134
v_sub_f32 v128, v128, v148
s_waitcnt vmcnt(0)
v_mfma_f32_32x32x8_bf16 v[80:95], v[198:199], v[40:41], 0
v_sub_f32 v135, v135, v148
v_sub_f32 v130, v130, v148
v_exp_f32 v131, v131
v_exp_f32 v130, v130
v_mfma_f32_32x32x8_bf16 v[160:175], v[192:193], v[40:41], 0
v_exp_f32 v135, v135
v_cvt_pk_bf16_f32 v34, v132, v133
v_exp_f32 v128, v128
v_cvt_pk_bf16_f32 v33, v130, v131
v_cvt_pk_bf16_f32 v35, v134, v135
v_cvt_pk_bf16_f32 v32, v128, v129
v_sub_f32 v136, v136, v148
v_add_f32 v149, v128, v129
v_mfma_f32_32x32x16_bf16 v[80:95], v[120:123], v[32:35], v[80:95]
s_add_u32 s19, s27, 4096
v_sub_f32 v142, v142, v148
v_sub_f32 v138, v138, v148
v_sub_f32 v139, v139, v148
v_sub_f32 v143, v143, v148
v_exp_f32 v143, v143
v_mfma_f32_32x32x16_bf16 v[64:79], v[112:115], v[32:35], v[64:79]
v_exp_f32 v136, v136
v_sub_f32 v140, v140, v148
v_sub_f32 v141, v141, v148
v_exp_f32 v140, v140
v_mfma_f32_32x32x16_bf16 v[160:175], v[96:99], v[32:35], v[160:175]
v_exp_f32 v141, v141
v_sub_f32 v137, v137, v148
v_cvt_pk_bf16_f32 v38, v140, v141
v_exp_f32 v142, v142
v_mfma_f32_32x32x16_bf16 v[176:191], v[104:107], v[32:35], v[176:191]
v_cvt_pk_bf16_f32 v39, v142, v143
v_exp_f32 v137, v137
v_exp_f32 v139, v139
v_exp_f32 v138, v138
v_cvt_pk_bf16_f32 v36, v136, v137
v_cvt_pk_bf16_f32 v37, v138, v139
v_add_f32 v149, v149, v130
v_add_f32 v149, v149, v131
v_mfma_f32_32x32x16_bf16 v[160:175], v[100:103], v[36:39], v[160:175]
v_add_f32 v149, v149, v132
v_add_f32 v149, v149, v133
v_add_f32 v149, v149, v134
v_add_f32 v149, v149, v135
v_add_f32 v149, v149, v136
v_add_f32 v149, v149, v137
v_mfma_f32_32x32x16_bf16 v[64:79], v[116:119], v[36:39], v[64:79]
v_add_f32 v149, v149, v138
v_add_f32 v149, v149, v139
v_add_f32 v149, v149, v140
v_add_f32 v149, v149, v141
v_add_f32 v149, v149, v142
v_add_f32 v149, v149, v143
v_add_f32 v149, v149, v144
v_add_f32 v149, v149, v145
v_add_f32 v149, v149, v146
v_add_f32 v149, v149, v147
v_mov_b32 v150, v149
v_mfma_f32_32x32x16_bf16 v[80:95], v[124:127], v[36:39], v[80:95]
s_nop 0
v_permlane32_swap_b32 v149, v150
v_add_f32 v149, v149, v150
v_rcp_f32 v149, v149
v_mfma_f32_32x32x16_bf16 v[176:191], v[108:111], v[36:39], v[176:191]
s_nop 0
v_mul_f32 v161, v161, v149
v_mul_f32 v64, v64, v149
v_mul_f32 v167, v167, v149
v_mul_f32 v74, v74, v149
v_mul_f32 v66, v66, v149
v_mul_f32 v69, v69, v149
v_mul_f32 v67, v67, v149
v_mul_f32 v166, v166, v149
v_mul_f32 v65, v65, v149
v_mul_f32 v160, v160, v149
v_mul_f32 v71, v71, v149
v_mul_f32 v177, v177, v149
v_mul_f32 v165, v165, v149
v_mul_f32 v188, v188, v149
v_mul_f32 v170, v170, v149
v_mul_f32 v80, v80, v149
v_mul_f32 v85, v85, v149
v_cvt_pk_bf16_f32 v64, v64, v65
v_mul_f32 v178, v178, v149
v_mul_f32 v168, v168, v149
v_mul_f32 v162, v162, v149
v_mul_f32 v92, v92, v149
v_mul_f32 v84, v84, v149
v_mul_f32 v163, v163, v149
v_mul_f32 v185, v185, v149
v_cvt_pk_bf16_f32 v160, v160, v161
v_mul_f32 v73, v73, v149
v_mul_f32 v189, v189, v149
v_mul_f32 v169, v169, v149
v_mul_f32 v83, v83, v149
v_mul_f32 v172, v172, v149
v_mul_f32 v75, v75, v149
v_cvt_pk_bf16_f32 v161, v162, v163
v_mul_f32 v176, v176, v149
v_mul_f32 v91, v91, v149
v_mul_f32 v180, v180, v149
v_mul_f32 v181, v181, v149
v_cvt_pk_bf16_f32 v65, v66, v67
v_mul_f32 v164, v164, v149
v_cvt_pk_bf16_f32 v162, v164, v165
v_mul_f32 v173, v173, v149
v_mul_f32 v179, v179, v149
v_mul_f32 v190, v190, v149
v_mul_f32 v182, v182, v149
v_mul_f32 v90, v90, v149
v_mul_f32 v81, v81, v149
v_mul_f32 v89, v89, v149
v_mul_f32 v171, v171, v149
v_mul_f32 v88, v88, v149
v_mul_f32 v82, v82, v149
v_mul_f32 v68, v68, v149
v_cvt_pk_bf16_f32 v66, v68, v69
v_mul_f32 v174, v174, v149
v_mul_f32 v183, v183, v149
v_cvt_pk_bf16_f32 v164, v168, v169
v_cvt_pk_bf16_f32 v165, v170, v171
v_cvt_pk_bf16_f32 v176, v176, v177
v_mul_f32 v72, v72, v149
v_cvt_pk_bf16_f32 v177, v178, v179
v_cvt_pk_bf16_f32 v163, v166, v167
v_mul_f32 v95, v95, v149
v_mul_f32 v175, v175, v149
v_mul_f32 v79, v79, v149
v_cvt_pk_bf16_f32 v166, v172, v173
v_cvt_pk_bf16_f32 v167, v174, v175
v_cvt_pk_bf16_f32 v178, v180, v181
v_cvt_pk_bf16_f32 v179, v182, v183
v_mul_f32 v87, v87, v149
buffer_store_dwordx4 v[160:163], v0, s[4:7], s27 offen offset:0 sc1
buffer_store_dwordx4 v[164:167], v0, s[4:7], s27 offen offset:1024 sc1
buffer_store_dwordx4 v[176:179], v0, s[4:7], s27 offen offset:2048 sc1
v_mul_f32 v78, v78, v149
v_mul_f32 v76, v76, v149
v_mul_f32 v86, v86, v149
v_cvt_pk_bf16_f32 v80, v80, v81
v_mul_f32 v77, v77, v149
v_mul_f32 v70, v70, v149
v_mul_f32 v186, v186, v149
v_mul_f32 v184, v184, v149
v_mul_f32 v187, v187, v149
v_cvt_pk_bf16_f32 v81, v82, v83
v_cvt_pk_bf16_f32 v67, v70, v71
v_mul_f32 v191, v191, v149
v_cvt_pk_bf16_f32 v182, v188, v189
v_cvt_pk_bf16_f32 v83, v86, v87
v_cvt_pk_bf16_f32 v82, v84, v85
v_mul_f32 v94, v94, v149
v_cvt_pk_bf16_f32 v181, v186, v187
v_cvt_pk_bf16_f32 v180, v184, v185
v_cvt_pk_bf16_f32 v69, v74, v75
v_mul_f32 v93, v93, v149
v_cvt_pk_bf16_f32 v183, v190, v191
v_cvt_pk_bf16_f32 v68, v72, v73
v_cvt_pk_bf16_f32 v85, v90, v91
v_cvt_pk_bf16_f32 v86, v92, v93
v_cvt_pk_bf16_f32 v71, v78, v79
v_cvt_pk_bf16_f32 v87, v94, v95
v_cvt_pk_bf16_f32 v84, v88, v89
v_cvt_pk_bf16_f32 v70, v76, v77
buffer_store_dwordx4 v[180:183], v0, s[4:7], s27 offen offset:3072 sc1
buffer_store_dwordx4 v[64:67], v0, s[4:7], s19 offen offset:0 sc1
buffer_store_dwordx4 v[68:71], v0, s[4:7], s19 offen offset:1024 sc1
buffer_store_dwordx4 v[80:83], v0, s[4:7], s19 offen offset:2048 sc1
buffer_store_dwordx4 v[84:87], v0, s[4:7], s19 offen offset:3072 sc1
s_lshl_b32 s18, s32, 2
s_add_u32 s18, s18, s30
s_add_u32 s18, s18, 16384
s_waitcnt vmcnt(0)
v_mov_b32 v3, 1
s_mov_b64 exec, 1
buffer_store_dword v3, off, s[4:7], s18 sc1
s_mov_b64 exec, -1
s_add_u32 s48, s48, 2
s_cmp_lt_u32 s48, 16
s_cbranch_scc1 qr_57
s_barrier
s_cmp_ge_u32 s35, 20
s_cbranch_scc1 aend_52
s_add_u32 s30, s46, 60
s_add_u32 s47, s35, 15
s_branch p1c_53
wo_50:
s_sub_u32 s18, s35, 64
s_mul_i32 s30, s18, 3277
s_lshr_b32 s30, s30, 16
s_mul_i32 s19, s30, 20
s_sub_u32 s48, s18, s19
s_cmp_lg_u32 s16, 0
s_cbranch_scc1 ww_63
s_mul_i32 s26, s13, 1310720
s_lshl_b32 s18, s48, 6
s_add_u32 s26, s26, s18
s_load_dwordx2 s[36:37], s[0:1], 64
s_mov_b32 s38, 5242880
s_mov_b32 s39, 0x20000
s_waitcnt lgkmcnt(0)
v_lshrrev_b32 v214, 6, v0
v_mul_u32_u24 v214, 1280, v214
v_and_b32 v215, 48, v0
v_add_u32 v212, v214, v215
v_bfe_u32 v214, v0, 6, 2
v_lshrrev_b32 v215, 9, v0
v_lshl_add_u32 v214, v215, 3, v214
v_lshlrev_b32 v213, 6, v214
v_and_b32 v214, 16, v0
v_add_u32 v213, v213, v214
v_bfe_u32 v214, v0, 5, 1
v_lshl_add_u32 v213, v214, 3, v213
v_bfe_u32 v214, v0, 8, 1
v_lshl_add_u32 v213, v214, 5, v213
s_mul_i32 s18, s13, 36864
v_add_u32 v213, s18, v213
s_barrier
s_add_u32 m0, s18, 0
s_add_u32 s19, s26, 0
buffer_load_dwordx4 v212, s[36:39], s19 offen lds
s_add_u32 m0, s18, 1024
s_add_u32 s19, s26, 20480
buffer_load_dwordx4 v212, s[36:39], s19 offen lds
s_add_u32 m0, s18, 2048
s_add_u32 s19, s26, 40960
buffer_load_dwordx4 v212, s[36:39], s19 offen lds
s_add_u32 m0, s18, 3072
s_add_u32 s19, s26, 61440
buffer_load_dwordx4 v212, s[36:39], s19 offen lds
s_add_u32 m0, s18, 4096
s_add_u32 s19, s26, 81920
buffer_load_dwordx4 v212, s[36:39], s19 offen lds
s_add_u32 m0, s18, 5120
s_add_u32 s19, s26, 102400
buffer_load_dwordx4 v212, s[36:39], s19 offen lds
s_add_u32 m0, s18, 6144
s_add_u32 s19, s26, 122880
buffer_load_dwordx4 v212, s[36:39], s19 offen lds
s_add_u32 m0, s18, 7168
s_add_u32 s19, s26, 143360
buffer_load_dwordx4 v212, s[36:39], s19 offen lds
s_add_u32 m0, s18, 8192
s_add_u32 s19, s26, 163840
buffer_load_dwordx4 v212, s[36:39], s19 offen lds
s_add_u32 m0, s18, 9216
s_add_u32 s19, s26, 184320
buffer_load_dwordx4 v212, s[36:39], s19 offen lds
s_add_u32 m0, s18, 10240
s_add_u32 s19, s26, 204800
buffer_load_dwordx4 v212, s[36:39], s19 offen lds
s_add_u32 m0, s18, 11264
s_add_u32 s19, s26, 225280
buffer_load_dwordx4 v212, s[36:39], s19 offen lds
s_add_u32 m0, s18, 12288
s_add_u32 s19, s26, 245760
buffer_load_dwordx4 v212, s[36:39], s19 offen lds
s_add_u32 m0, s18, 13312
s_add_u32 s19, s26, 266240
buffer_load_dwordx4 v212, s[36:39], s19 offen lds
s_add_u32 m0, s18, 14336
s_add_u32 s19, s26, 286720
buffer_load_dwordx4 v212, s[36:39], s19 offen lds
s_add_u32 m0, s18, 15360
s_add_u32 s19, s26, 307200
buffer_load_dwordx4 v212, s[36:39], s19 offen lds
s_add_u32 m0, s18, 16384
s_add_u32 s19, s26, 327680
buffer_load_dwordx4 v212, s[36:39], s19 offen lds
s_add_u32 m0, s18, 17408
s_add_u32 s19, s26, 348160
buffer_load_dwordx4 v212, s[36:39], s19 offen lds
s_add_u32 m0, s18, 18432
s_add_u32 s19, s26, 368640
buffer_load_dwordx4 v212, s[36:39], s19 offen lds
s_add_u32 m0, s18, 19456
s_add_u32 s19, s26, 389120
buffer_load_dwordx4 v212, s[36:39], s19 offen lds
s_add_u32 m0, s18, 20480
s_add_u32 s19, s26, 409600
buffer_load_dwordx4 v212, s[36:39], s19 offen lds
s_add_u32 m0, s18, 21504
s_add_u32 s19, s26, 430080
buffer_load_dwordx4 v212, s[36:39], s19 offen lds
s_add_u32 m0, s18, 22528
s_add_u32 s19, s26, 450560
buffer_load_dwordx4 v212, s[36:39], s19 offen lds
s_add_u32 m0, s18, 23552
s_add_u32 s19, s26, 471040
buffer_load_dwordx4 v212, s[36:39], s19 offen lds
s_add_u32 m0, s18, 24576
s_add_u32 s19, s26, 491520
buffer_load_dwordx4 v212, s[36:39], s19 offen lds
s_add_u32 m0, s18, 25600
s_add_u32 s19, s26, 512000
buffer_load_dwordx4 v212, s[36:39], s19 offen lds
s_add_u32 m0, s18, 26624
s_add_u32 s19, s26, 532480
buffer_load_dwordx4 v212, s[36:39], s19 offen lds
s_add_u32 m0, s18, 27648
s_add_u32 s19, s26, 552960
buffer_load_dwordx4 v212, s[36:39], s19 offen lds
s_add_u32 m0, s18, 28672
s_add_u32 s19, s26, 573440
buffer_load_dwordx4 v212, s[36:39], s19 offen lds
s_add_u32 m0, s18, 29696
s_add_u32 s19, s26, 593920
buffer_load_dwordx4 v212, s[36:39], s19 offen lds
s_add_u32 m0, s18, 30720
s_add_u32 s19, s26, 614400
buffer_load_dwordx4 v212, s[36:39], s19 offen lds
s_add_u32 m0, s18, 31744
s_add_u32 s19, s26, 634880
buffer_load_dwordx4 v212, s[36:39], s19 offen lds
s_add_u32 m0, s18, 32768
s_add_u32 s19, s26, 655360
buffer_load_dwordx4 v212, s[36:39], s19 offen lds
s_add_u32 m0, s18, 33792
s_add_u32 s19, s26, 675840
buffer_load_dwordx4 v212, s[36:39], s19 offen lds
s_add_u32 m0, s18, 34816
s_add_u32 s19, s26, 696320
buffer_load_dwordx4 v212, s[36:39], s19 offen lds
s_add_u32 m0, s18, 35840
s_add_u32 s19, s26, 716800
buffer_load_dwordx4 v212, s[36:39], s19 offen lds
s_waitcnt vmcnt(32)
ds_read_b64_tr_b16 a[0:1], v213 offset:0
ds_read_b64_tr_b16 a[2:3], v213 offset:256
ds_read_b64_tr_b16 a[4:5], v213 offset:1024
ds_read_b64_tr_b16 a[6:7], v213 offset:1280
ds_read_b64_tr_b16 a[8:9], v213 offset:2048
ds_read_b64_tr_b16 a[10:11], v213 offset:2304
ds_read_b64_tr_b16 a[12:13], v213 offset:3072
ds_read_b64_tr_b16 a[14:15], v213 offset:3328
s_waitcnt lgkmcnt(0)
s_add_u32 m0, s18, 0
s_add_u32 s19, s26, 737280
buffer_load_dwordx4 v212, s[36:39], s19 offen lds
s_add_u32 m0, s18, 1024
s_add_u32 s19, s26, 757760
buffer_load_dwordx4 v212, s[36:39], s19 offen lds
s_add_u32 m0, s18, 2048
s_add_u32 s19, s26, 778240
buffer_load_dwordx4 v212, s[36:39], s19 offen lds
s_add_u32 m0, s18, 3072
s_add_u32 s19, s26, 798720
buffer_load_dwordx4 v212, s[36:39], s19 offen lds
s_waitcnt vmcnt(32)
ds_read_b64_tr_b16 a[16:17], v213 offset:4096
ds_read_b64_tr_b16 a[18:19], v213 offset:4352
ds_read_b64_tr_b16 a[20:21], v213 offset:5120
ds_read_b64_tr_b16 a[22:23], v213 offset:5376
ds_read_b64_tr_b16 a[24:25], v213 offset:6144
ds_read_b64_tr_b16 a[26:27], v213 offset:6400
ds_read_b64_tr_b16 a[28:29], v213 offset:7168
ds_read_b64_tr_b16 a[30:31], v213 offset:7424
s_waitcnt lgkmcnt(0)
s_add_u32 m0, s18, 4096
s_add_u32 s19, s26, 819200
buffer_load_dwordx4 v212, s[36:39], s19 offen lds
s_add_u32 m0, s18, 5120
s_add_u32 s19, s26, 839680
buffer_load_dwordx4 v212, s[36:39], s19 offen lds
s_add_u32 m0, s18, 6144
s_add_u32 s19, s26, 860160
buffer_load_dwordx4 v212, s[36:39], s19 offen lds
s_add_u32 m0, s18, 7168
s_add_u32 s19, s26, 880640
buffer_load_dwordx4 v212, s[36:39], s19 offen lds
s_waitcnt vmcnt(32)
ds_read_b64_tr_b16 a[32:33], v213 offset:8192
ds_read_b64_tr_b16 a[34:35], v213 offset:8448
ds_read_b64_tr_b16 a[36:37], v213 offset:9216
ds_read_b64_tr_b16 a[38:39], v213 offset:9472
ds_read_b64_tr_b16 a[40:41], v213 offset:10240
ds_read_b64_tr_b16 a[42:43], v213 offset:10496
ds_read_b64_tr_b16 a[44:45], v213 offset:11264
ds_read_b64_tr_b16 a[46:47], v213 offset:11520
s_waitcnt lgkmcnt(0)
s_add_u32 m0, s18, 8192
s_add_u32 s19, s26, 901120
buffer_load_dwordx4 v212, s[36:39], s19 offen lds
s_add_u32 m0, s18, 9216
s_add_u32 s19, s26, 921600
buffer_load_dwordx4 v212, s[36:39], s19 offen lds
s_add_u32 m0, s18, 10240
s_add_u32 s19, s26, 942080
buffer_load_dwordx4 v212, s[36:39], s19 offen lds
s_add_u32 m0, s18, 11264
s_add_u32 s19, s26, 962560
buffer_load_dwordx4 v212, s[36:39], s19 offen lds
s_waitcnt vmcnt(32)
ds_read_b64_tr_b16 a[48:49], v213 offset:12288
ds_read_b64_tr_b16 a[50:51], v213 offset:12544
ds_read_b64_tr_b16 a[52:53], v213 offset:13312
ds_read_b64_tr_b16 a[54:55], v213 offset:13568
ds_read_b64_tr_b16 a[56:57], v213 offset:14336
ds_read_b64_tr_b16 a[58:59], v213 offset:14592
ds_read_b64_tr_b16 a[60:61], v213 offset:15360
ds_read_b64_tr_b16 a[62:63], v213 offset:15616
s_waitcnt lgkmcnt(0)
s_add_u32 m0, s18, 12288
s_add_u32 s19, s26, 983040
buffer_load_dwordx4 v212, s[36:39], s19 offen lds
s_add_u32 m0, s18, 13312
s_add_u32 s19, s26, 1003520
buffer_load_dwordx4 v212, s[36:39], s19 offen lds
s_add_u32 m0, s18, 14336
s_add_u32 s19, s26, 1024000
buffer_load_dwordx4 v212, s[36:39], s19 offen lds
s_add_u32 m0, s18, 15360
s_add_u32 s19, s26, 1044480
buffer_load_dwordx4 v212, s[36:39], s19 offen lds
s_waitcnt vmcnt(32)
ds_read_b64_tr_b16 a[64:65], v213 offset:16384
ds_read_b64_tr_b16 a[66:67], v213 offset:16640
ds_read_b64_tr_b16 a[68:69], v213 offset:17408
ds_read_b64_tr_b16 a[70:71], v213 offset:17664
ds_read_b64_tr_b16 a[72:73], v213 offset:18432
ds_read_b64_tr_b16 a[74:75], v213 offset:18688
ds_read_b64_tr_b16 a[76:77], v213 offset:19456
ds_read_b64_tr_b16 a[78:79], v213 offset:19712
s_waitcnt lgkmcnt(0)
s_add_u32 m0, s18, 16384
s_add_u32 s19, s26, 1064960
buffer_load_dwordx4 v212, s[36:39], s19 offen lds
s_add_u32 m0, s18, 17408
s_add_u32 s19, s26, 1085440
buffer_load_dwordx4 v212, s[36:39], s19 offen lds
s_add_u32 m0, s18, 18432
s_add_u32 s19, s26, 1105920
buffer_load_dwordx4 v212, s[36:39], s19 offen lds
s_add_u32 m0, s18, 19456
s_add_u32 s19, s26, 1126400
buffer_load_dwordx4 v212, s[36:39], s19 offen lds
s_waitcnt vmcnt(32)
ds_read_b64_tr_b16 a[80:81], v213 offset:20480
ds_read_b64_tr_b16 a[82:83], v213 offset:20736
ds_read_b64_tr_b16 a[84:85], v213 offset:21504
ds_read_b64_tr_b16 a[86:87], v213 offset:21760
ds_read_b64_tr_b16 a[88:89], v213 offset:22528
ds_read_b64_tr_b16 a[90:91], v213 offset:22784
ds_read_b64_tr_b16 a[92:93], v213 offset:23552
ds_read_b64_tr_b16 a[94:95], v213 offset:23808
s_waitcnt lgkmcnt(0)
s_add_u32 m0, s18, 20480
s_add_u32 s19, s26, 1146880
buffer_load_dwordx4 v212, s[36:39], s19 offen lds
s_add_u32 m0, s18, 21504
s_add_u32 s19, s26, 1167360
buffer_load_dwordx4 v212, s[36:39], s19 offen lds
s_add_u32 m0, s18, 22528
s_add_u32 s19, s26, 1187840
buffer_load_dwordx4 v212, s[36:39], s19 offen lds
s_add_u32 m0, s18, 23552
s_add_u32 s19, s26, 1208320
buffer_load_dwordx4 v212, s[36:39], s19 offen lds
s_waitcnt vmcnt(32)
ds_read_b64_tr_b16 a[96:97], v213 offset:24576
ds_read_b64_tr_b16 a[98:99], v213 offset:24832
ds_read_b64_tr_b16 a[100:101], v213 offset:25600
ds_read_b64_tr_b16 a[102:103], v213 offset:25856
ds_read_b64_tr_b16 a[104:105], v213 offset:26624
ds_read_b64_tr_b16 a[106:107], v213 offset:26880
ds_read_b64_tr_b16 a[108:109], v213 offset:27648
ds_read_b64_tr_b16 a[110:111], v213 offset:27904
s_waitcnt lgkmcnt(0)
s_add_u32 m0, s18, 24576
s_add_u32 s19, s26, 1228800
buffer_load_dwordx4 v212, s[36:39], s19 offen lds
s_add_u32 m0, s18, 25600
s_add_u32 s19, s26, 1249280
buffer_load_dwordx4 v212, s[36:39], s19 offen lds
s_add_u32 m0, s18, 26624
s_add_u32 s19, s26, 1269760
buffer_load_dwordx4 v212, s[36:39], s19 offen lds
s_add_u32 m0, s18, 27648
s_add_u32 s19, s26, 1290240
buffer_load_dwordx4 v212, s[36:39], s19 offen lds
s_waitcnt vmcnt(32)
ds_read_b64_tr_b16 a[112:113], v213 offset:28672
ds_read_b64_tr_b16 a[114:115], v213 offset:28928
ds_read_b64_tr_b16 a[116:117], v213 offset:29696
ds_read_b64_tr_b16 a[118:119], v213 offset:29952
ds_read_b64_tr_b16 a[120:121], v213 offset:30720
ds_read_b64_tr_b16 a[122:123], v213 offset:30976
ds_read_b64_tr_b16 a[124:125], v213 offset:31744
ds_read_b64_tr_b16 a[126:127], v213 offset:32000
s_waitcnt vmcnt(28)
ds_read_b64_tr_b16 a[128:129], v213 offset:32768
ds_read_b64_tr_b16 a[130:131], v213 offset:33024
ds_read_b64_tr_b16 a[132:133], v213 offset:33792
ds_read_b64_tr_b16 a[134:135], v213 offset:34048
ds_read_b64_tr_b16 a[136:137], v213 offset:34816
ds_read_b64_tr_b16 a[138:139], v213 offset:35072
ds_read_b64_tr_b16 a[140:141], v213 offset:35840
ds_read_b64_tr_b16 a[142:143], v213 offset:36096
s_waitcnt vmcnt(24)
ds_read_b64_tr_b16 a[144:145], v213 offset:0
ds_read_b64_tr_b16 a[146:147], v213 offset:256
ds_read_b64_tr_b16 a[148:149], v213 offset:1024
ds_read_b64_tr_b16 a[150:151], v213 offset:1280
ds_read_b64_tr_b16 a[152:153], v213 offset:2048
ds_read_b64_tr_b16 a[154:155], v213 offset:2304
ds_read_b64_tr_b16 a[156:157], v213 offset:3072
ds_read_b64_tr_b16 a[158:159], v213 offset:3328
s_waitcnt vmcnt(20)
ds_read_b64_tr_b16 a[160:161], v213 offset:4096
ds_read_b64_tr_b16 a[162:163], v213 offset:4352
ds_read_b64_tr_b16 a[164:165], v213 offset:5120
ds_read_b64_tr_b16 a[166:167], v213 offset:5376
ds_read_b64_tr_b16 a[168:169], v213 offset:6144
ds_read_b64_tr_b16 a[170:171], v213 offset:6400
ds_read_b64_tr_b16 a[172:173], v213 offset:7168
ds_read_b64_tr_b16 a[174:175], v213 offset:7424
s_waitcnt vmcnt(16)
ds_read_b64_tr_b16 a[176:177], v213 offset:8192
ds_read_b64_tr_b16 a[178:179], v213 offset:8448
ds_read_b64_tr_b16 a[180:181], v213 offset:9216
ds_read_b64_tr_b16 a[182:183], v213 offset:9472
ds_read_b64_tr_b16 a[184:185], v213 offset:10240
ds_read_b64_tr_b16 a[186:187], v213 offset:10496
ds_read_b64_tr_b16 a[188:189], v213 offset:11264
ds_read_b64_tr_b16 a[190:191], v213 offset:11520
s_waitcnt vmcnt(12)
ds_read_b64_tr_b16 a[192:193], v213 offset:12288
ds_read_b64_tr_b16 a[194:195], v213 offset:12544
ds_read_b64_tr_b16 a[196:197], v213 offset:13312
ds_read_b64_tr_b16 a[198:199], v213 offset:13568
ds_read_b64_tr_b16 a[200:201], v213 offset:14336
ds_read_b64_tr_b16 a[202:203], v213 offset:14592
ds_read_b64_tr_b16 a[204:205], v213 offset:15360
ds_read_b64_tr_b16 a[206:207], v213 offset:15616
s_waitcnt vmcnt(8)
ds_read_b64_tr_b16 a[208:209], v213 offset:16384
ds_read_b64_tr_b16 a[210:211], v213 offset:16640
ds_read_b64_tr_b16 a[212:213], v213 offset:17408
ds_read_b64_tr_b16 a[214:215], v213 offset:17664
ds_read_b64_tr_b16 a[216:217], v213 offset:18432
ds_read_b64_tr_b16 a[218:219], v213 offset:18688
ds_read_b64_tr_b16 a[220:221], v213 offset:19456
ds_read_b64_tr_b16 a[222:223], v213 offset:19712
s_waitcnt vmcnt(4)
ds_read_b64_tr_b16 a[224:225], v213 offset:20480
ds_read_b64_tr_b16 a[226:227], v213 offset:20736
ds_read_b64_tr_b16 a[228:229], v213 offset:21504
ds_read_b64_tr_b16 a[230:231], v213 offset:21760
ds_read_b64_tr_b16 a[232:233], v213 offset:22528
ds_read_b64_tr_b16 a[234:235], v213 offset:22784
ds_read_b64_tr_b16 a[236:237], v213 offset:23552
ds_read_b64_tr_b16 a[238:239], v213 offset:23808
s_waitcnt vmcnt(0)
ds_read_b64_tr_b16 a[240:241], v213 offset:24576
ds_read_b64_tr_b16 a[242:243], v213 offset:24832
ds_read_b64_tr_b16 a[244:245], v213 offset:25600
ds_read_b64_tr_b16 a[246:247], v213 offset:25856
ds_read_b64_tr_b16 a[248:249], v213 offset:26624
ds_read_b64_tr_b16 a[250:251], v213 offset:26880
ds_read_b64_tr_b16 a[252:253], v213 offset:27648
ds_read_b64_tr_b16 a[254:255], v213 offset:27904
s_waitcnt lgkmcnt(0)
s_barrier
ww_63:
s_load_dwordx2 s[52:53], s[0:1], 80
s_mov_b32 s54, 2621440
s_mov_b32 s55, 0x20000
s_waitcnt lgkmcnt(0)
s_lshl_b32 s18, s13, 12
v_add_u32 v13, s18, v0
s_lshl_b32 s18, s13, 11
v_add_u32 v14, s18, v0
ws_64:
s_lshl_b32 s18, s16, 6
s_add_u32 s18, s18, s30
s_lshl_b32 s26, s18, 18
s_lshl_b32 s19, s13, 16
s_add_u32 s26, s26, s19
s_add_u32 s26, s26, 127926272
s_lshl_b32 s18, s18, 7
s_lshl_b32 s19, s13, 5
s_add_u32 s18, s18, s19
s_add_u32 s28, s18, 16384
s_mul_i32 s27, s30, 40960
s_and_b32 s18, s13, 1
s_lshl_b32 s19, s48, 1
s_add_u32 s29, s18, s19
v_lshrrev_b32 v12, 2, v0
v_min_u32 v12, 28, v12
s_mov_b32 s17, 0
poll_68:
buffer_load_dword v8, v12, s[4:7], s28 offen offset:0 sc1
s_add_u32 s17, s17, 1
s_cmp_gt_u32 s17, 262144
s_cbranch_scc1 L_fail
s_waitcnt vmcnt(0)
v_cmp_gt_u32 vcc, 1, v8
s_cbranch_vccz polld_69
s_sleep 2
s_branch poll_68
polld_69:
s_lshl_b32 s18, s29, 10
s_add_u32 s18, s18, s27
s_mul_i32 s19, s16, 6291456
s_add_u32 s18, s18, s19
s_add_u32 s18, s18, 88080384
s_add_u32 s19, s26, 0
buffer_load_dwordx4 v[16:19], v0, s[4:7], s19 offen offset:0 sc1
buffer_load_dwordx4 v[20:23], v0, s[4:7], s19 offen offset:1024 sc1
buffer_load_dwordx4 v[24:27], v0, s[4:7], s19 offen offset:2048 sc1
buffer_load_dwordx4 v[28:31], v0, s[4:7], s19 offen offset:3072 sc1
s_add_u32 s19, s26, 4096
buffer_load_dwordx4 v[32:35], v0, s[4:7], s19 offen offset:0 sc1
buffer_load_dwordx4 v[36:39], v0, s[4:7], s19 offen offset:1024 sc1
buffer_load_dwordx4 v[40:43], v0, s[4:7], s19 offen offset:2048 sc1
buffer_load_dwordx4 v[44:47], v0, s[4:7], s19 offen offset:3072 sc1
s_add_u32 s19, s26, 8192
buffer_load_dwordx4 v[48:51], v0, s[4:7], s19 offen offset:0 sc1
buffer_load_dwordx4 v[52:55], v0, s[4:7], s19 offen offset:1024 sc1
buffer_load_dwordx4 v[56:59], v0, s[4:7], s19 offen offset:2048 sc1
buffer_load_dwordx4 v[60:63], v0, s[4:7], s19 offen offset:3072 sc1
s_add_u32 s19, s26, 12288
buffer_load_dwordx4 v[64:67], v0, s[4:7], s19 offen offset:0 sc1
buffer_load_dwordx4 v[68:71], v0, s[4:7], s19 offen offset:1024 sc1
buffer_load_dwordx4 v[72:75], v0, s[4:7], s19 offen offset:2048 sc1
buffer_load_dwordx4 v[76:79], v0, s[4:7], s19 offen offset:3072 sc1
s_add_u32 s19, s26, 16384
buffer_load_dwordx4 v[80:83], v0, s[4:7], s19 offen offset:0 sc1
buffer_load_dwordx4 v[84:87], v0, s[4:7], s19 offen offset:1024 sc1
buffer_load_dwordx4 v[88:91], v0, s[4:7], s19 offen offset:2048 sc1
buffer_load_dwordx4 v[92:95], v0, s[4:7], s19 offen offset:3072 sc1
s_add_u32 s19, s26, 20480
buffer_load_dwordx4 v[96:99], v0, s[4:7], s19 offen offset:0 sc1
buffer_load_dwordx4 v[100:103], v0, s[4:7], s19 offen offset:1024 sc1
buffer_load_dwordx4 v[104:107], v0, s[4:7], s19 offen offset:2048 sc1
buffer_load_dwordx4 v[108:111], v0, s[4:7], s19 offen offset:3072 sc1
s_add_u32 s19, s26, 24576
buffer_load_dwordx4 v[112:115], v0, s[4:7], s19 offen offset:0 sc1
buffer_load_dwordx4 v[116:119], v0, s[4:7], s19 offen offset:1024 sc1
buffer_load_dwordx4 v[120:123], v0, s[4:7], s19 offen offset:2048 sc1
buffer_load_dwordx4 v[124:127], v0, s[4:7], s19 offen offset:3072 sc1
s_add_u32 s19, s26, 28672
buffer_load_dwordx4 v[128:131], v0, s[4:7], s19 offen offset:0 sc1
buffer_load_dwordx4 v[132:135], v0, s[4:7], s19 offen offset:1024 sc1
buffer_load_dwordx4 v[136:139], v0, s[4:7], s19 offen offset:2048 sc1
buffer_load_dwordx4 v[140:143], v0, s[4:7], s19 offen offset:3072 sc1
s_add_u32 s19, s26, 32768
buffer_load_dwordx4 v[144:147], v0, s[4:7], s19 offen offset:0 sc1
buffer_load_dwordx4 v[148:151], v0, s[4:7], s19 offen offset:1024 sc1
buffer_load_dwordx4 v[152:155], v0, s[4:7], s19 offen offset:2048 sc1
buffer_load_dwordx4 v[156:159], v0, s[4:7], s19 offen offset:3072 sc1
s_add_u32 s19, s26, 36864
buffer_load_dwordx4 v[160:163], v0, s[4:7], s19 offen offset:0 sc1
buffer_load_dwordx4 v[164:167], v0, s[4:7], s19 offen offset:1024 sc1
buffer_load_dwordx4 v[168:171], v0, s[4:7], s19 offen offset:2048 sc1
buffer_load_dwordx4 v[172:175], v0, s[4:7], s19 offen offset:3072 sc1
s_add_u32 s19, s26, 40960
buffer_load_dwordx4 v[176:179], v0, s[4:7], s19 offen offset:0 sc1
buffer_load_dwordx4 v[180:183], v0, s[4:7], s19 offen offset:1024 sc1
buffer_load_dwordx4 v[184:187], v0, s[4:7], s19 offen offset:2048 sc1
buffer_load_dwordx4 v[188:191], v0, s[4:7], s19 offen offset:3072 sc1
s_waitcnt vmcnt(43)
v_mfma_f32_32x32x16_bf16 v[192:207], a[0:3], v[16:19], 0
s_add_u32 s19, s26, 45056
buffer_load_dwordx4 v[16:19], v0, s[4:7], s19 offen offset:0 sc1
s_waitcnt vmcnt(43)
v_mfma_f32_32x32x16_bf16 v[192:207], a[4:7], v[20:23], v[192:207]
buffer_load_dwordx4 v[20:23], v0, s[4:7], s19 offen offset:1024 sc1
s_waitcnt vmcnt(43)
v_mfma_f32_32x32x16_bf16 v[192:207], a[8:11], v[24:27], v[192:207]
buffer_load_dwordx4 v[24:27], v0, s[4:7], s19 offen offset:2048 sc1
s_waitcnt vmcnt(43)
v_mfma_f32_32x32x16_bf16 v[192:207], a[12:15], v[28:31], v[192:207]
buffer_load_dwordx4 v[28:31], v0, s[4:7], s19 offen offset:3072 sc1
s_waitcnt vmcnt(43)
v_mfma_f32_32x32x16_bf16 v[192:207], a[16:19], v[32:35], v[192:207]
s_add_u32 s19, s26, 49152
buffer_load_dwordx4 v[32:35], v0, s[4:7], s19 offen offset:0 sc1
s_waitcnt vmcnt(43)
v_mfma_f32_32x32x16_bf16 v[192:207], a[20:23], v[36:39], v[192:207]
buffer_load_dwordx4 v[36:39], v0, s[4:7], s19 offen offset:1024 sc1
s_waitcnt vmcnt(43)
v_mfma_f32_32x32x16_bf16 v[192:207], a[24:27], v[40:43], v[192:207]
buffer_load_dwordx4 v[40:43], v0, s[4:7], s19 offen offset:2048 sc1
s_waitcnt vmcnt(43)
v_mfma_f32_32x32x16_bf16 v[192:207], a[28:31], v[44:47], v[192:207]
buffer_load_dwordx4 v[44:47], v0, s[4:7], s19 offen offset:3072 sc1
s_waitcnt vmcnt(43)
v_mfma_f32_32x32x16_bf16 v[192:207], a[32:35], v[48:51], v[192:207]
s_add_u32 s19, s26, 53248
buffer_load_dwordx4 v[48:51], v0, s[4:7], s19 offen offset:0 sc1
s_waitcnt vmcnt(43)
v_mfma_f32_32x32x16_bf16 v[192:207], a[36:39], v[52:55], v[192:207]
buffer_load_dwordx4 v[52:55], v0, s[4:7], s19 offen offset:1024 sc1
s_waitcnt vmcnt(43)
v_mfma_f32_32x32x16_bf16 v[192:207], a[40:43], v[56:59], v[192:207]
buffer_load_dwordx4 v[56:59], v0, s[4:7], s19 offen offset:2048 sc1
s_waitcnt vmcnt(43)
v_mfma_f32_32x32x16_bf16 v[192:207], a[44:47], v[60:63], v[192:207]
buffer_load_dwordx4 v[60:63], v0, s[4:7], s19 offen offset:3072 sc1
s_waitcnt vmcnt(43)
v_mfma_f32_32x32x16_bf16 v[192:207], a[48:51], v[64:67], v[192:207]
s_add_u32 s19, s26, 57344
buffer_load_dwordx4 v[64:67], v0, s[4:7], s19 offen offset:0 sc1
s_waitcnt vmcnt(43)
v_mfma_f32_32x32x16_bf16 v[192:207], a[52:55], v[68:71], v[192:207]
buffer_load_dwordx4 v[68:71], v0, s[4:7], s19 offen offset:1024 sc1
s_waitcnt vmcnt(43)
v_mfma_f32_32x32x16_bf16 v[192:207], a[56:59], v[72:75], v[192:207]
buffer_load_dwordx4 v[72:75], v0, s[4:7], s19 offen offset:2048 sc1
s_waitcnt vmcnt(43)
v_mfma_f32_32x32x16_bf16 v[192:207], a[60:63], v[76:79], v[192:207]
buffer_load_dwordx4 v[76:79], v0, s[4:7], s19 offen offset:3072 sc1
s_waitcnt vmcnt(43)
v_mfma_f32_32x32x16_bf16 v[192:207], a[64:67], v[80:83], v[192:207]
s_add_u32 s19, s26, 61440
buffer_load_dwordx4 v[80:83], v0, s[4:7], s19 offen offset:0 sc1
s_waitcnt vmcnt(43)
v_mfma_f32_32x32x16_bf16 v[192:207], a[68:71], v[84:87], v[192:207]
buffer_load_dwordx4 v[84:87], v0, s[4:7], s19 offen offset:1024 sc1
s_waitcnt vmcnt(43)
v_mfma_f32_32x32x16_bf16 v[192:207], a[72:75], v[88:91], v[192:207]
buffer_load_dwordx4 v[88:91], v0, s[4:7], s19 offen offset:2048 sc1
s_waitcnt vmcnt(43)
v_mfma_f32_32x32x16_bf16 v[192:207], a[76:79], v[92:95], v[192:207]
buffer_load_dwordx4 v[92:95], v0, s[4:7], s19 offen offset:3072 sc1
s_waitcnt vmcnt(43)
v_mfma_f32_32x32x16_bf16 v[192:207], a[80:83], v[96:99], v[192:207]
buffer_load_dwordx4 v[208:211], v0, s[4:7], s18 offen sc1
s_waitcnt vmcnt(43)
v_mfma_f32_32x32x16_bf16 v[192:207], a[84:87], v[100:103], v[192:207]
s_waitcnt vmcnt(42)
v_mfma_f32_32x32x16_bf16 v[192:207], a[88:91], v[104:107], v[192:207]
s_waitcnt vmcnt(41)
v_mfma_f32_32x32x16_bf16 v[192:207], a[92:95], v[108:111], v[192:207]
s_waitcnt vmcnt(40)
v_mfma_f32_32x32x16_bf16 v[192:207], a[96:99], v[112:115], v[192:207]
s_waitcnt vmcnt(39)
v_mfma_f32_32x32x16_bf16 v[192:207], a[100:103], v[116:119], v[192:207]
s_waitcnt vmcnt(38)
v_mfma_f32_32x32x16_bf16 v[192:207], a[104:107], v[120:123], v[192:207]
s_waitcnt vmcnt(37)
v_mfma_f32_32x32x16_bf16 v[192:207], a[108:111], v[124:127], v[192:207]
s_waitcnt vmcnt(36)
v_mfma_f32_32x32x16_bf16 v[192:207], a[112:115], v[128:131], v[192:207]
s_waitcnt vmcnt(35)
v_mfma_f32_32x32x16_bf16 v[192:207], a[116:119], v[132:135], v[192:207]
s_waitcnt vmcnt(34)
v_mfma_f32_32x32x16_bf16 v[192:207], a[120:123], v[136:139], v[192:207]
s_waitcnt vmcnt(33)
v_mfma_f32_32x32x16_bf16 v[192:207], a[124:127], v[140:143], v[192:207]
s_waitcnt vmcnt(32)
v_mfma_f32_32x32x16_bf16 v[192:207], a[128:131], v[144:147], v[192:207]
s_waitcnt vmcnt(31)
v_mfma_f32_32x32x16_bf16 v[192:207], a[132:135], v[148:151], v[192:207]
s_waitcnt vmcnt(30)
v_mfma_f32_32x32x16_bf16 v[192:207], a[136:139], v[152:155], v[192:207]
s_waitcnt vmcnt(29)
v_mfma_f32_32x32x16_bf16 v[192:207], a[140:143], v[156:159], v[192:207]
s_waitcnt vmcnt(28)
v_mfma_f32_32x32x16_bf16 v[192:207], a[144:147], v[160:163], v[192:207]
s_waitcnt vmcnt(27)
v_mfma_f32_32x32x16_bf16 v[192:207], a[148:151], v[164:167], v[192:207]
s_waitcnt vmcnt(26)
v_mfma_f32_32x32x16_bf16 v[192:207], a[152:155], v[168:171], v[192:207]
s_waitcnt vmcnt(25)
v_mfma_f32_32x32x16_bf16 v[192:207], a[156:159], v[172:175], v[192:207]
s_waitcnt vmcnt(24)
v_mfma_f32_32x32x16_bf16 v[192:207], a[160:163], v[176:179], v[192:207]
s_waitcnt vmcnt(23)
v_mfma_f32_32x32x16_bf16 v[192:207], a[164:167], v[180:183], v[192:207]
s_waitcnt vmcnt(22)
v_mfma_f32_32x32x16_bf16 v[192:207], a[168:171], v[184:187], v[192:207]
s_waitcnt vmcnt(21)
v_mfma_f32_32x32x16_bf16 v[192:207], a[172:175], v[188:191], v[192:207]
s_waitcnt vmcnt(20)
v_mfma_f32_32x32x16_bf16 v[192:207], a[176:179], v[16:19], v[192:207]
s_waitcnt vmcnt(19)
v_mfma_f32_32x32x16_bf16 v[192:207], a[180:183], v[20:23], v[192:207]
s_waitcnt vmcnt(18)
v_mfma_f32_32x32x16_bf16 v[192:207], a[184:187], v[24:27], v[192:207]
s_waitcnt vmcnt(17)
v_mfma_f32_32x32x16_bf16 v[192:207], a[188:191], v[28:31], v[192:207]
s_waitcnt vmcnt(16)
v_mfma_f32_32x32x16_bf16 v[192:207], a[192:195], v[32:35], v[192:207]
s_waitcnt vmcnt(15)
v_mfma_f32_32x32x16_bf16 v[192:207], a[196:199], v[36:39], v[192:207]
s_waitcnt vmcnt(14)
v_mfma_f32_32x32x16_bf16 v[192:207], a[200:203], v[40:43], v[192:207]
s_waitcnt vmcnt(13)
v_mfma_f32_32x32x16_bf16 v[192:207], a[204:207], v[44:47], v[192:207]
s_waitcnt vmcnt(12)
v_mfma_f32_32x32x16_bf16 v[192:207], a[208:211], v[48:51], v[192:207]
s_waitcnt vmcnt(11)
v_mfma_f32_32x32x16_bf16 v[192:207], a[212:215], v[52:55], v[192:207]
s_waitcnt vmcnt(10)
v_mfma_f32_32x32x16_bf16 v[192:207], a[216:219], v[56:59], v[192:207]
s_waitcnt vmcnt(9)
v_mfma_f32_32x32x16_bf16 v[192:207], a[220:223], v[60:63], v[192:207]
s_waitcnt vmcnt(8)
v_mfma_f32_32x32x16_bf16 v[192:207], a[224:227], v[64:67], v[192:207]
s_waitcnt vmcnt(7)
v_mfma_f32_32x32x16_bf16 v[192:207], a[228:231], v[68:71], v[192:207]
s_waitcnt vmcnt(6)
v_mfma_f32_32x32x16_bf16 v[192:207], a[232:235], v[72:75], v[192:207]
s_waitcnt vmcnt(5)
v_mfma_f32_32x32x16_bf16 v[192:207], a[236:239], v[76:79], v[192:207]
s_waitcnt vmcnt(4)
v_mfma_f32_32x32x16_bf16 v[192:207], a[240:243], v[80:83], v[192:207]
s_waitcnt vmcnt(3)
v_mfma_f32_32x32x16_bf16 v[192:207], a[244:247], v[84:87], v[192:207]
s_waitcnt vmcnt(2)
v_mfma_f32_32x32x16_bf16 v[192:207], a[248:251], v[88:91], v[192:207]
s_waitcnt vmcnt(1)
v_mfma_f32_32x32x16_bf16 v[192:207], a[252:255], v[92:95], v[192:207]
s_nop 11
ds_write_b128 v13, v[192:195] offset:0
ds_write_b128 v13, v[196:199] offset:1024
ds_write_b128 v13, v[200:203] offset:2048
ds_write_b128 v13, v[204:207] offset:3072
s_waitcnt lgkmcnt(0)
s_barrier
s_cmp_ge_u32 s13, 2
s_cbranch_scc1 wn_65
ds_read_b128 v[16:19], v14 offset:0
ds_read_b128 v[20:23], v14 offset:1024
ds_read_b128 v[24:27], v14 offset:4096
ds_read_b128 v[28:31], v14 offset:5120
ds_read_b128 v[32:35], v14 offset:8192
ds_read_b128 v[36:39], v14 offset:9216
ds_read_b128 v[40:43], v14 offset:12288
ds_read_b128 v[44:47], v14 offset:13312
s_waitcnt vmcnt(0)
v_lshlrev_b32 v192, 16, v208
v_and_b32 v193, 0xffff0000, v208
v_lshlrev_b32 v194, 16, v209
v_and_b32 v195, 0xffff0000, v209
v_lshlrev_b32 v196, 16, v210
v_and_b32 v197, 0xffff0000, v210
v_lshlrev_b32 v198, 16, v211
v_and_b32 v199, 0xffff0000, v211
s_waitcnt lgkmcnt(5)
v_add_f32 v16, v16, v24
s_waitcnt lgkmcnt(1)
v_add_f32 v32, v32, v40
v_add_f32 v17, v17, v25
v_add_f32 v33, v33, v41
v_add_f32 v18, v18, v26
v_add_f32 v34, v34, v42
v_add_f32 v19, v19, v27
v_add_f32 v35, v35, v43
v_add_f32 v20, v20, v28
s_waitcnt lgkmcnt(0)
v_add_f32 v36, v36, v44
v_add_f32 v21, v21, v29
v_add_f32 v37, v37, v45
v_add_f32 v22, v22, v30
v_add_f32 v38, v38, v46
v_add_f32 v23, v23, v31
v_add_f32 v39, v39, v47
v_add_f32 v16, v16, v32
v_add_f32 v17, v17, v33
v_add_f32 v18, v18, v34
v_add_f32 v19, v19, v35
v_add_f32 v20, v20, v36
v_add_f32 v21, v21, v37
v_add_f32 v22, v22, v38
v_add_f32 v23, v23, v39
v_add_f32 v16, v16, v192
v_add_f32 v17, v17, v193
v_add_f32 v18, v18, v194
v_add_f32 v19, v19, v195
v_add_f32 v20, v20, v196
v_add_f32 v21, v21, v197
v_add_f32 v22, v22, v198
v_add_f32 v23, v23, v199
v_cvt_pk_bf16_f32 v208, v16, v17
v_cvt_pk_bf16_f32 v209, v18, v19
v_cvt_pk_bf16_f32 v210, v20, v21
v_cvt_pk_bf16_f32 v211, v22, v23
s_cmp_lg_u32 s16, 0
s_cbranch_scc1 wo_66
s_add_u32 s18, s18, 3145728
buffer_store_dwordx4 v[208:211], v0, s[4:7], s18 offen sc1
s_branch wn_65
wo_66:
s_lshl_b32 s18, s29, 5
s_add_u32 s18, s18, s27
buffer_store_dwordx4 v[208:211], v5, s[52:55], s18 offen
wn_65:
s_lshl_b32 s18, s30, 7
s_lshl_b32 s19, s48, 2
s_add_u32 s18, s18, s19
s_add_u32 s18, s18, 32768
s_cmp_eq_u32 s13, 0
s_cselect_b32 s22, s18, s6
s_mov_b32 s23, 1
s_waitcnt vmcnt(0)
s_barrier
v_mov_b32 v3, s23
s_mov_b64 exec, 1
buffer_store_dword v3, off, s[4:7], s22 sc1
s_mov_b64 exec, -1
s_mov_b32 s22, s6
s_add_u32 s30, s30, 4
s_cmp_lt_u32 s30, 64
s_cbranch_scc1 ws_64
s_branch aend_52
p1b_51:
s_cmp_eq_u32 s35, 144
s_cbranch_scc1 aend_52
s_sub_u32 s30, s46, 29
s_sub_u32 s47, s35, 145
p1c_53:
s_cmp_lg_u32 s16, 0
s_cbranch_scc1 aend_52
s_lshl_b32 s18, s34, 7
s_lshl_b32 s19, s13, 5
s_add_u32 s18, s18, s19
s_mov_b32 s19, 0x3acccccd
v_bfe_u32 v198, v0, 4, 5
v_lshrrev_b32 v193, 9, v0
v_add_u32 v198, s18, v198
v_and_b32 v197, 1, v198
v_mul_u32_u24 v197, 160, v197
v_lshrrev_b32 v196, 1, v198
v_add_u32 v196, 1, v196
v_lshlrev_b32 v193, 3, v193
v_mad_u32_u24 v197, v193, v196, v197
v_mad_u32_u24 v192, v196, 16, 0
v_cvt_f32_u32 v192, v192
v_mul_f32 v198, s19, v192
v_rndne_f32 v198, v198
v_fmac_f32 v192, 0xc4200000, v198
v_mul_f32 v192, s19, v192
v_cos_f32 v192, v192
s_nop 0
v_add_f32 v192, v192, v192
v_mad_u32_u24 v194, v196, 1, 0
v_cvt_f32_u32 v194, v194
v_mul_f32 v198, s19, v194
v_rndne_f32 v198, v198
v_fmac_f32 v194, 0xc4200000, v198
v_mul_f32 v194, s19, v194
v_cos_f32 v194, v194
s_nop 0
v_add_f32 v194, v194, v194
v_mad_u32_u24 v179, v196, 3, v197
v_cvt_f32_u32 v179, v179
v_mul_f32 v198, s19, v179
v_rndne_f32 v198, v198
v_fmac_f32 v179, 0xc4200000, v198
v_mul_f32 v179, s19, v179
v_cos_f32 v179, v179
v_mad_u32_u24 v180, v196, 4, v197
v_cvt_f32_u32 v180, v180
v_mul_f32 v198, s19, v180
v_rndne_f32 v198, v198
v_fmac_f32 v180, 0xc4200000, v198
v_mul_f32 v180, s19, v180
v_cos_f32 v180, v180
s_nop 0
v_fma_f32 v181, v194, v180, -v179
v_fma_f32 v178, v194, v179, -v180
v_fma_f32 v182, v194, v181, -v180
v_fma_f32 v177, v194, v178, -v179
v_fma_f32 v183, v194, v182, -v181
v_fma_f32 v176, v194, v177, -v178
v_cvt_pk_bf16_f32 v16, v176, v177
v_cvt_pk_bf16_f32 v17, v178, v179
v_cvt_pk_bf16_f32 v18, v180, v181
v_cvt_pk_bf16_f32 v19, v182, v183
v_mad_u32_u24 v187, v196, 19, v197
v_cvt_f32_u32 v187, v187
v_mul_f32 v198, s19, v187
v_rndne_f32 v198, v198
v_fmac_f32 v187, 0xc4200000, v198
v_mul_f32 v187, s19, v187
v_cos_f32 v187, v187
v_mad_u32_u24 v188, v196, 20, v197
v_cvt_f32_u32 v188, v188
v_mul_f32 v198, s19, v188
v_rndne_f32 v198, v198
v_fmac_f32 v188, 0xc4200000, v198
v_mul_f32 v188, s19, v188
v_cos_f32 v188, v188
s_nop 0
v_fma_f32 v189, v194, v188, -v187
v_fma_f32 v186, v194, v187, -v188
v_fma_f32 v190, v194, v189, -v188
v_fma_f32 v185, v194, v186, -v187
v_fma_f32 v191, v194, v190, -v189
v_fma_f32 v184, v194, v185, -v186
v_cvt_pk_bf16_f32 v20, v184, v185
v_cvt_pk_bf16_f32 v21, v186, v187
v_cvt_pk_bf16_f32 v22, v188, v189
v_cvt_pk_bf16_f32 v23, v190, v191
v_pk_fma_f32 v[176:177], v[192:193], v[184:185], v[176:177] op_sel_hi:[0,1,1] neg_lo:[0,0,1] neg_hi:[0,0,1]
v_pk_fma_f32 v[178:179], v[192:193], v[186:187], v[178:179] op_sel_hi:[0,1,1] neg_lo:[0,0,1] neg_hi:[0,0,1]
v_pk_fma_f32 v[180:181], v[192:193], v[188:189], v[180:181] op_sel_hi:[0,1,1] neg_lo:[0,0,1] neg_hi:[0,0,1]
v_pk_fma_f32 v[182:183], v[192:193], v[190:191], v[182:183] op_sel_hi:[0,1,1] neg_lo:[0,0,1] neg_hi:[0,0,1]
v_cvt_pk_bf16_f32 v24, v176, v177
v_cvt_pk_bf16_f32 v25, v178, v179
v_cvt_pk_bf16_f32 v26, v180, v181
v_cvt_pk_bf16_f32 v27, v182, v183
v_pk_fma_f32 v[184:185], v[192:193], v[176:177], v[184:185] op_sel_hi:[0,1,1] neg_lo:[0,0,1] neg_hi:[0,0,1]
v_pk_fma_f32 v[186:187], v[192:193], v[178:179], v[186:187] op_sel_hi:[0,1,1] neg_lo:[0,0,1] neg_hi:[0,0,1]
v_pk_fma_f32 v[188:189], v[192:193], v[180:181], v[188:189] op_sel_hi:[0,1,1] neg_lo:[0,0,1] neg_hi:[0,0,1]
v_pk_fma_f32 v[190:191], v[192:193], v[182:183], v[190:191] op_sel_hi:[0,1,1] neg_lo:[0,0,1] neg_hi:[0,0,1]
v_cvt_pk_bf16_f32 v28, v184, v185
v_cvt_pk_bf16_f32 v29, v186, v187
v_cvt_pk_bf16_f32 v30, v188, v189
v_cvt_pk_bf16_f32 v31, v190, v191
v_pk_fma_f32 v[176:177], v[192:193], v[184:185], v[176:177] op_sel_hi:[0,1,1] neg_lo:[0,0,1] neg_hi:[0,0,1]
v_pk_fma_f32 v[178:179], v[192:193], v[186:187], v[178:179] op_sel_hi:[0,1,1] neg_lo:[0,0,1] neg_hi:[0,0,1]
v_pk_fma_f32 v[180:181], v[192:193], v[188:189], v[180:181] op_sel_hi:[0,1,1] neg_lo:[0,0,1] neg_hi:[0,0,1]
v_pk_fma_f32 v[182:183], v[192:193], v[190:191], v[182:183] op_sel_hi:[0,1,1] neg_lo:[0,0,1] neg_hi:[0,0,1]
v_cvt_pk_bf16_f32 v32, v176, v177
v_cvt_pk_bf16_f32 v33, v178, v179
v_cvt_pk_bf16_f32 v34, v180, v181
v_cvt_pk_bf16_f32 v35, v182, v183
v_pk_fma_f32 v[184:185], v[192:193], v[176:177], v[184:185] op_sel_hi:[0,1,1] neg_lo:[0,0,1] neg_hi:[0,0,1]
v_pk_fma_f32 v[186:187], v[192:193], v[178:179], v[186:187] op_sel_hi:[0,1,1] neg_lo:[0,0,1] neg_hi:[0,0,1]
v_pk_fma_f32 v[188:189], v[192:193], v[180:181], v[188:189] op_sel_hi:[0,1,1] neg_lo:[0,0,1] neg_hi:[0,0,1]
v_pk_fma_f32 v[190:191], v[192:193], v[182:183], v[190:191] op_sel_hi:[0,1,1] neg_lo:[0,0,1] neg_hi:[0,0,1]
v_cvt_pk_bf16_f32 v36, v184, v185
v_cvt_pk_bf16_f32 v37, v186, v187
v_cvt_pk_bf16_f32 v38, v188, v189
v_cvt_pk_bf16_f32 v39, v190, v191
v_pk_fma_f32 v[176:177], v[192:193], v[184:185], v[176:177] op_sel_hi:[0,1,1] neg_lo:[0,0,1] neg_hi:[0,0,1]
v_pk_fma_f32 v[178:179], v[192:193], v[186:187], v[178:179] op_sel_hi:[0,1,1] neg_lo:[0,0,1] neg_hi:[0,0,1]
v_pk_fma_f32 v[180:181], v[192:193], v[188:189], v[180:181] op_sel_hi:[0,1,1] neg_lo:[0,0,1] neg_hi:[0,0,1]
v_pk_fma_f32 v[182:183], v[192:193], v[190:191], v[182:183] op_sel_hi:[0,1,1] neg_lo:[0,0,1] neg_hi:[0,0,1]
v_cvt_pk_bf16_f32 v40, v176, v177
v_cvt_pk_bf16_f32 v41, v178, v179
v_cvt_pk_bf16_f32 v42, v180, v181
v_cvt_pk_bf16_f32 v43, v182, v183
v_pk_fma_f32 v[184:185], v[192:193], v[176:177], v[184:185] op_sel_hi:[0,1,1] neg_lo:[0,0,1] neg_hi:[0,0,1]
v_pk_fma_f32 v[186:187], v[192:193], v[178:179], v[186:187] op_sel_hi:[0,1,1] neg_lo:[0,0,1] neg_hi:[0,0,1]
v_pk_fma_f32 v[188:189], v[192:193], v[180:181], v[188:189] op_sel_hi:[0,1,1] neg_lo:[0,0,1] neg_hi:[0,0,1]
v_pk_fma_f32 v[190:191], v[192:193], v[182:183], v[190:191] op_sel_hi:[0,1,1] neg_lo:[0,0,1] neg_hi:[0,0,1]
v_cvt_pk_bf16_f32 v44, v184, v185
v_cvt_pk_bf16_f32 v45, v186, v187
v_cvt_pk_bf16_f32 v46, v188, v189
v_cvt_pk_bf16_f32 v47, v190, v191
v_pk_fma_f32 v[176:177], v[192:193], v[184:185], v[176:177] op_sel_hi:[0,1,1] neg_lo:[0,0,1] neg_hi:[0,0,1]
v_pk_fma_f32 v[178:179], v[192:193], v[186:187], v[178:179] op_sel_hi:[0,1,1] neg_lo:[0,0,1] neg_hi:[0,0,1]
v_pk_fma_f32 v[180:181], v[192:193], v[188:189], v[180:181] op_sel_hi:[0,1,1] neg_lo:[0,0,1] neg_hi:[0,0,1]
v_pk_fma_f32 v[182:183], v[192:193], v[190:191], v[182:183] op_sel_hi:[0,1,1] neg_lo:[0,0,1] neg_hi:[0,0,1]
v_cvt_pk_bf16_f32 v48, v176, v177
v_cvt_pk_bf16_f32 v49, v178, v179
v_cvt_pk_bf16_f32 v50, v180, v181
v_cvt_pk_bf16_f32 v51, v182, v183
v_pk_fma_f32 v[184:185], v[192:193], v[176:177], v[184:185] op_sel_hi:[0,1,1] neg_lo:[0,0,1] neg_hi:[0,0,1]
v_pk_fma_f32 v[186:187], v[192:193], v[178:179], v[186:187] op_sel_hi:[0,1,1] neg_lo:[0,0,1] neg_hi:[0,0,1]
v_pk_fma_f32 v[188:189], v[192:193], v[180:181], v[188:189] op_sel_hi:[0,1,1] neg_lo:[0,0,1] neg_hi:[0,0,1]
v_pk_fma_f32 v[190:191], v[192:193], v[182:183], v[190:191] op_sel_hi:[0,1,1] neg_lo:[0,0,1] neg_hi:[0,0,1]
v_cvt_pk_bf16_f32 v52, v184, v185
v_cvt_pk_bf16_f32 v53, v186, v187
v_cvt_pk_bf16_f32 v54, v188, v189
v_cvt_pk_bf16_f32 v55, v190, v191
v_pk_fma_f32 v[176:177], v[192:193], v[184:185], v[176:177] op_sel_hi:[0,1,1] neg_lo:[0,0,1] neg_hi:[0,0,1]
v_pk_fma_f32 v[178:179], v[192:193], v[186:187], v[178:179] op_sel_hi:[0,1,1] neg_lo:[0,0,1] neg_hi:[0,0,1]
v_pk_fma_f32 v[180:181], v[192:193], v[188:189], v[180:181] op_sel_hi:[0,1,1] neg_lo:[0,0,1] neg_hi:[0,0,1]
v_pk_fma_f32 v[182:183], v[192:193], v[190:191], v[182:183] op_sel_hi:[0,1,1] neg_lo:[0,0,1] neg_hi:[0,0,1]
v_cvt_pk_bf16_f32 v56, v176, v177
v_cvt_pk_bf16_f32 v57, v178, v179
v_cvt_pk_bf16_f32 v58, v180, v181
v_cvt_pk_bf16_f32 v59, v182, v183
v_pk_fma_f32 v[184:185], v[192:193], v[176:177], v[184:185] op_sel_hi:[0,1,1] neg_lo:[0,0,1] neg_hi:[0,0,1]
v_pk_fma_f32 v[186:187], v[192:193], v[178:179], v[186:187] op_sel_hi:[0,1,1] neg_lo:[0,0,1] neg_hi:[0,0,1]
v_pk_fma_f32 v[188:189], v[192:193], v[180:181], v[188:189] op_sel_hi:[0,1,1] neg_lo:[0,0,1] neg_hi:[0,0,1]
v_pk_fma_f32 v[190:191], v[192:193], v[182:183], v[190:191] op_sel_hi:[0,1,1] neg_lo:[0,0,1] neg_hi:[0,0,1]
v_cvt_pk_bf16_f32 v60, v184, v185
v_cvt_pk_bf16_f32 v61, v186, v187
v_cvt_pk_bf16_f32 v62, v188, v189
v_cvt_pk_bf16_f32 v63, v190, v191
v_pk_fma_f32 v[176:177], v[192:193], v[184:185], v[176:177] op_sel_hi:[0,1,1] neg_lo:[0,0,1] neg_hi:[0,0,1]
v_pk_fma_f32 v[178:179], v[192:193], v[186:187], v[178:179] op_sel_hi:[0,1,1] neg_lo:[0,0,1] neg_hi:[0,0,1]
v_pk_fma_f32 v[180:181], v[192:193], v[188:189], v[180:181] op_sel_hi:[0,1,1] neg_lo:[0,0,1] neg_hi:[0,0,1]
v_pk_fma_f32 v[182:183], v[192:193], v[190:191], v[182:183] op_sel_hi:[0,1,1] neg_lo:[0,0,1] neg_hi:[0,0,1]
v_cvt_pk_bf16_f32 v64, v176, v177
v_cvt_pk_bf16_f32 v65, v178, v179
v_cvt_pk_bf16_f32 v66, v180, v181
v_cvt_pk_bf16_f32 v67, v182, v183
v_pk_fma_f32 v[184:185], v[192:193], v[176:177], v[184:185] op_sel_hi:[0,1,1] neg_lo:[0,0,1] neg_hi:[0,0,1]
v_pk_fma_f32 v[186:187], v[192:193], v[178:179], v[186:187] op_sel_hi:[0,1,1] neg_lo:[0,0,1] neg_hi:[0,0,1]
v_pk_fma_f32 v[188:189], v[192:193], v[180:181], v[188:189] op_sel_hi:[0,1,1] neg_lo:[0,0,1] neg_hi:[0,0,1]
v_pk_fma_f32 v[190:191], v[192:193], v[182:183], v[190:191] op_sel_hi:[0,1,1] neg_lo:[0,0,1] neg_hi:[0,0,1]
v_cvt_pk_bf16_f32 v68, v184, v185
v_cvt_pk_bf16_f32 v69, v186, v187
v_cvt_pk_bf16_f32 v70, v188, v189
v_cvt_pk_bf16_f32 v71, v190, v191
v_pk_fma_f32 v[176:177], v[192:193], v[184:185], v[176:177] op_sel_hi:[0,1,1] neg_lo:[0,0,1] neg_hi:[0,0,1]
v_pk_fma_f32 v[178:179], v[192:193], v[186:187], v[178:179] op_sel_hi:[0,1,1] neg_lo:[0,0,1] neg_hi:[0,0,1]
v_pk_fma_f32 v[180:181], v[192:193], v[188:189], v[180:181] op_sel_hi:[0,1,1] neg_lo:[0,0,1] neg_hi:[0,0,1]
v_pk_fma_f32 v[182:183], v[192:193], v[190:191], v[182:183] op_sel_hi:[0,1,1] neg_lo:[0,0,1] neg_hi:[0,0,1]
v_cvt_pk_bf16_f32 v72, v176, v177
v_cvt_pk_bf16_f32 v73, v178, v179
v_cvt_pk_bf16_f32 v74, v180, v181
v_cvt_pk_bf16_f32 v75, v182, v183
v_pk_fma_f32 v[184:185], v[192:193], v[176:177], v[184:185] op_sel_hi:[0,1,1] neg_lo:[0,0,1] neg_hi:[0,0,1]
v_pk_fma_f32 v[186:187], v[192:193], v[178:179], v[186:187] op_sel_hi:[0,1,1] neg_lo:[0,0,1] neg_hi:[0,0,1]
v_pk_fma_f32 v[188:189], v[192:193], v[180:181], v[188:189] op_sel_hi:[0,1,1] neg_lo:[0,0,1] neg_hi:[0,0,1]
v_pk_fma_f32 v[190:191], v[192:193], v[182:183], v[190:191] op_sel_hi:[0,1,1] neg_lo:[0,0,1] neg_hi:[0,0,1]
v_cvt_pk_bf16_f32 v76, v184, v185
v_cvt_pk_bf16_f32 v77, v186, v187
v_cvt_pk_bf16_f32 v78, v188, v189
v_cvt_pk_bf16_f32 v79, v190, v191
v_pk_fma_f32 v[176:177], v[192:193], v[184:185], v[176:177] op_sel_hi:[0,1,1] neg_lo:[0,0,1] neg_hi:[0,0,1]
v_pk_fma_f32 v[178:179], v[192:193], v[186:187], v[178:179] op_sel_hi:[0,1,1] neg_lo:[0,0,1] neg_hi:[0,0,1]
v_pk_fma_f32 v[180:181], v[192:193], v[188:189], v[180:181] op_sel_hi:[0,1,1] neg_lo:[0,0,1] neg_hi:[0,0,1]
v_pk_fma_f32 v[182:183], v[192:193], v[190:191], v[182:183] op_sel_hi:[0,1,1] neg_lo:[0,0,1] neg_hi:[0,0,1]
v_cvt_pk_bf16_f32 v80, v176, v177
v_cvt_pk_bf16_f32 v81, v178, v179
v_cvt_pk_bf16_f32 v82, v180, v181
v_cvt_pk_bf16_f32 v83, v182, v183
v_pk_fma_f32 v[184:185], v[192:193], v[176:177], v[184:185] op_sel_hi:[0,1,1] neg_lo:[0,0,1] neg_hi:[0,0,1]
v_pk_fma_f32 v[186:187], v[192:193], v[178:179], v[186:187] op_sel_hi:[0,1,1] neg_lo:[0,0,1] neg_hi:[0,0,1]
v_pk_fma_f32 v[188:189], v[192:193], v[180:181], v[188:189] op_sel_hi:[0,1,1] neg_lo:[0,0,1] neg_hi:[0,0,1]
v_pk_fma_f32 v[190:191], v[192:193], v[182:183], v[190:191] op_sel_hi:[0,1,1] neg_lo:[0,0,1] neg_hi:[0,0,1]
v_cvt_pk_bf16_f32 v84, v184, v185
v_cvt_pk_bf16_f32 v85, v186, v187
v_cvt_pk_bf16_f32 v86, v188, v189
v_cvt_pk_bf16_f32 v87, v190, v191
v_pk_fma_f32 v[176:177], v[192:193], v[184:185], v[176:177] op_sel_hi:[0,1,1] neg_lo:[0,0,1] neg_hi:[0,0,1]
v_pk_fma_f32 v[178:179], v[192:193], v[186:187], v[178:179] op_sel_hi:[0,1,1] neg_lo:[0,0,1] neg_hi:[0,0,1]
v_pk_fma_f32 v[180:181], v[192:193], v[188:189], v[180:181] op_sel_hi:[0,1,1] neg_lo:[0,0,1] neg_hi:[0,0,1]
v_pk_fma_f32 v[182:183], v[192:193], v[190:191], v[182:183] op_sel_hi:[0,1,1] neg_lo:[0,0,1] neg_hi:[0,0,1]
v_cvt_pk_bf16_f32 v88, v176, v177
v_cvt_pk_bf16_f32 v89, v178, v179
v_cvt_pk_bf16_f32 v90, v180, v181
v_cvt_pk_bf16_f32 v91, v182, v183
v_pk_fma_f32 v[184:185], v[192:193], v[176:177], v[184:185] op_sel_hi:[0,1,1] neg_lo:[0,0,1] neg_hi:[0,0,1]
v_pk_fma_f32 v[186:187], v[192:193], v[178:179], v[186:187] op_sel_hi:[0,1,1] neg_lo:[0,0,1] neg_hi:[0,0,1]
v_pk_fma_f32 v[188:189], v[192:193], v[180:181], v[188:189] op_sel_hi:[0,1,1] neg_lo:[0,0,1] neg_hi:[0,0,1]
v_pk_fma_f32 v[190:191], v[192:193], v[182:183], v[190:191] op_sel_hi:[0,1,1] neg_lo:[0,0,1] neg_hi:[0,0,1]
v_cvt_pk_bf16_f32 v92, v184, v185
v_cvt_pk_bf16_f32 v93, v186, v187
v_cvt_pk_bf16_f32 v94, v188, v189
v_cvt_pk_bf16_f32 v95, v190, v191
s_mov_b32 s20, 323
v_mad_u32_u24 v179, v196, s20, v197
v_cvt_f32_u32 v179, v179
v_mul_f32 v198, s19, v179
v_rndne_f32 v198, v198
v_fmac_f32 v179, 0xc4200000, v198
v_mul_f32 v179, s19, v179
v_cos_f32 v179, v179
s_mov_b32 s20, 324
v_mad_u32_u24 v180, v196, s20, v197
v_cvt_f32_u32 v180, v180
v_mul_f32 v198, s19, v180
v_rndne_f32 v198, v198
v_fmac_f32 v180, 0xc4200000, v198
v_mul_f32 v180, s19, v180
v_cos_f32 v180, v180
s_nop 0
v_fma_f32 v181, v194, v180, -v179
v_fma_f32 v178, v194, v179, -v180
v_fma_f32 v182, v194, v181, -v180
v_fma_f32 v177, v194, v178, -v179
v_fma_f32 v183, v194, v182, -v181
v_fma_f32 v176, v194, v177, -v178
v_cvt_pk_bf16_f32 v96, v176, v177
v_cvt_pk_bf16_f32 v97, v178, v179
v_cvt_pk_bf16_f32 v98, v180, v181
v_cvt_pk_bf16_f32 v99, v182, v183
s_mov_b32 s20, 339
v_mad_u32_u24 v187, v196, s20, v197
v_cvt_f32_u32 v187, v187
v_mul_f32 v198, s19, v187
v_rndne_f32 v198, v198
v_fmac_f32 v187, 0xc4200000, v198
v_mul_f32 v187, s19, v187
v_cos_f32 v187, v187
s_mov_b32 s20, 340
v_mad_u32_u24 v188, v196, s20, v197
v_cvt_f32_u32 v188, v188
v_mul_f32 v198, s19, v188
v_rndne_f32 v198, v198
v_fmac_f32 v188, 0xc4200000, v198
v_mul_f32 v188, s19, v188
v_cos_f32 v188, v188
s_nop 0
v_fma_f32 v189, v194, v188, -v187
v_fma_f32 v186, v194, v187, -v188
v_fma_f32 v190, v194, v189, -v188
v_fma_f32 v185, v194, v186, -v187
v_fma_f32 v191, v194, v190, -v189
v_fma_f32 v184, v194, v185, -v186
v_cvt_pk_bf16_f32 v100, v184, v185
v_cvt_pk_bf16_f32 v101, v186, v187
v_cvt_pk_bf16_f32 v102, v188, v189
v_cvt_pk_bf16_f32 v103, v190, v191
v_pk_fma_f32 v[176:177], v[192:193], v[184:185], v[176:177] op_sel_hi:[0,1,1] neg_lo:[0,0,1] neg_hi:[0,0,1]
v_pk_fma_f32 v[178:179], v[192:193], v[186:187], v[178:179] op_sel_hi:[0,1,1] neg_lo:[0,0,1] neg_hi:[0,0,1]
v_pk_fma_f32 v[180:181], v[192:193], v[188:189], v[180:181] op_sel_hi:[0,1,1] neg_lo:[0,0,1] neg_hi:[0,0,1]
v_pk_fma_f32 v[182:183], v[192:193], v[190:191], v[182:183] op_sel_hi:[0,1,1] neg_lo:[0,0,1] neg_hi:[0,0,1]
v_cvt_pk_bf16_f32 v104, v176, v177
v_cvt_pk_bf16_f32 v105, v178, v179
v_cvt_pk_bf16_f32 v106, v180, v181
v_cvt_pk_bf16_f32 v107, v182, v183
v_pk_fma_f32 v[184:185], v[192:193], v[176:177], v[184:185] op_sel_hi:[0,1,1] neg_lo:[0,0,1] neg_hi:[0,0,1]
v_pk_fma_f32 v[186:187], v[192:193], v[178:179], v[186:187] op_sel_hi:[0,1,1] neg_lo:[0,0,1] neg_hi:[0,0,1]
v_pk_fma_f32 v[188:189], v[192:193], v[180:181], v[188:189] op_sel_hi:[0,1,1] neg_lo:[0,0,1] neg_hi:[0,0,1]
v_pk_fma_f32 v[190:191], v[192:193], v[182:183], v[190:191] op_sel_hi:[0,1,1] neg_lo:[0,0,1] neg_hi:[0,0,1]
v_cvt_pk_bf16_f32 v108, v184, v185
v_cvt_pk_bf16_f32 v109, v186, v187
v_cvt_pk_bf16_f32 v110, v188, v189
v_cvt_pk_bf16_f32 v111, v190, v191
v_pk_fma_f32 v[176:177], v[192:193], v[184:185], v[176:177] op_sel_hi:[0,1,1] neg_lo:[0,0,1] neg_hi:[0,0,1]
v_pk_fma_f32 v[178:179], v[192:193], v[186:187], v[178:179] op_sel_hi:[0,1,1] neg_lo:[0,0,1] neg_hi:[0,0,1]
v_pk_fma_f32 v[180:181], v[192:193], v[188:189], v[180:181] op_sel_hi:[0,1,1] neg_lo:[0,0,1] neg_hi:[0,0,1]
v_pk_fma_f32 v[182:183], v[192:193], v[190:191], v[182:183] op_sel_hi:[0,1,1] neg_lo:[0,0,1] neg_hi:[0,0,1]
v_cvt_pk_bf16_f32 v112, v176, v177
v_cvt_pk_bf16_f32 v113, v178, v179
v_cvt_pk_bf16_f32 v114, v180, v181
v_cvt_pk_bf16_f32 v115, v182, v183
v_pk_fma_f32 v[184:185], v[192:193], v[176:177], v[184:185] op_sel_hi:[0,1,1] neg_lo:[0,0,1] neg_hi:[0,0,1]
v_pk_fma_f32 v[186:187], v[192:193], v[178:179], v[186:187] op_sel_hi:[0,1,1] neg_lo:[0,0,1] neg_hi:[0,0,1]
v_pk_fma_f32 v[188:189], v[192:193], v[180:181], v[188:189] op_sel_hi:[0,1,1] neg_lo:[0,0,1] neg_hi:[0,0,1]
v_pk_fma_f32 v[190:191], v[192:193], v[182:183], v[190:191] op_sel_hi:[0,1,1] neg_lo:[0,0,1] neg_hi:[0,0,1]
v_cvt_pk_bf16_f32 v116, v184, v185
v_cvt_pk_bf16_f32 v117, v186, v187
v_cvt_pk_bf16_f32 v118, v188, v189
v_cvt_pk_bf16_f32 v119, v190, v191
v_pk_fma_f32 v[176:177], v[192:193], v[184:185], v[176:177] op_sel_hi:[0,1,1] neg_lo:[0,0,1] neg_hi:[0,0,1]
v_pk_fma_f32 v[178:179], v[192:193], v[186:187], v[178:179] op_sel_hi:[0,1,1] neg_lo:[0,0,1] neg_hi:[0,0,1]
v_pk_fma_f32 v[180:181], v[192:193], v[188:189], v[180:181] op_sel_hi:[0,1,1] neg_lo:[0,0,1] neg_hi:[0,0,1]
v_pk_fma_f32 v[182:183], v[192:193], v[190:191], v[182:183] op_sel_hi:[0,1,1] neg_lo:[0,0,1] neg_hi:[0,0,1]
v_cvt_pk_bf16_f32 v120, v176, v177
v_cvt_pk_bf16_f32 v121, v178, v179
v_cvt_pk_bf16_f32 v122, v180, v181
v_cvt_pk_bf16_f32 v123, v182, v183
v_pk_fma_f32 v[184:185], v[192:193], v[176:177], v[184:185] op_sel_hi:[0,1,1] neg_lo:[0,0,1] neg_hi:[0,0,1]
v_pk_fma_f32 v[186:187], v[192:193], v[178:179], v[186:187] op_sel_hi:[0,1,1] neg_lo:[0,0,1] neg_hi:[0,0,1]
v_pk_fma_f32 v[188:189], v[192:193], v[180:181], v[188:189] op_sel_hi:[0,1,1] neg_lo:[0,0,1] neg_hi:[0,0,1]
v_pk_fma_f32 v[190:191], v[192:193], v[182:183], v[190:191] op_sel_hi:[0,1,1] neg_lo:[0,0,1] neg_hi:[0,0,1]
v_cvt_pk_bf16_f32 v124, v184, v185
v_cvt_pk_bf16_f32 v125, v186, v187
v_cvt_pk_bf16_f32 v126, v188, v189
v_cvt_pk_bf16_f32 v127, v190, v191
v_pk_fma_f32 v[176:177], v[192:193], v[184:185], v[176:177] op_sel_hi:[0,1,1] neg_lo:[0,0,1] neg_hi:[0,0,1]
v_pk_fma_f32 v[178:179], v[192:193], v[186:187], v[178:179] op_sel_hi:[0,1,1] neg_lo:[0,0,1] neg_hi:[0,0,1]
v_pk_fma_f32 v[180:181], v[192:193], v[188:189], v[180:181] op_sel_hi:[0,1,1] neg_lo:[0,0,1] neg_hi:[0,0,1]
v_pk_fma_f32 v[182:183], v[192:193], v[190:191], v[182:183] op_sel_hi:[0,1,1] neg_lo:[0,0,1] neg_hi:[0,0,1]
v_cvt_pk_bf16_f32 v128, v176, v177
v_cvt_pk_bf16_f32 v129, v178, v179
v_cvt_pk_bf16_f32 v130, v180, v181
v_cvt_pk_bf16_f32 v131, v182, v183
v_pk_fma_f32 v[184:185], v[192:193], v[176:177], v[184:185] op_sel_hi:[0,1,1] neg_lo:[0,0,1] neg_hi:[0,0,1]
v_pk_fma_f32 v[186:187], v[192:193], v[178:179], v[186:187] op_sel_hi:[0,1,1] neg_lo:[0,0,1] neg_hi:[0,0,1]
v_pk_fma_f32 v[188:189], v[192:193], v[180:181], v[188:189] op_sel_hi:[0,1,1] neg_lo:[0,0,1] neg_hi:[0,0,1]
v_pk_fma_f32 v[190:191], v[192:193], v[182:183], v[190:191] op_sel_hi:[0,1,1] neg_lo:[0,0,1] neg_hi:[0,0,1]
v_cvt_pk_bf16_f32 v132, v184, v185
v_cvt_pk_bf16_f32 v133, v186, v187
v_cvt_pk_bf16_f32 v134, v188, v189
v_cvt_pk_bf16_f32 v135, v190, v191
v_pk_fma_f32 v[176:177], v[192:193], v[184:185], v[176:177] op_sel_hi:[0,1,1] neg_lo:[0,0,1] neg_hi:[0,0,1]
v_pk_fma_f32 v[178:179], v[192:193], v[186:187], v[178:179] op_sel_hi:[0,1,1] neg_lo:[0,0,1] neg_hi:[0,0,1]
v_pk_fma_f32 v[180:181], v[192:193], v[188:189], v[180:181] op_sel_hi:[0,1,1] neg_lo:[0,0,1] neg_hi:[0,0,1]
v_pk_fma_f32 v[182:183], v[192:193], v[190:191], v[182:183] op_sel_hi:[0,1,1] neg_lo:[0,0,1] neg_hi:[0,0,1]
v_cvt_pk_bf16_f32 v136, v176, v177
v_cvt_pk_bf16_f32 v137, v178, v179
v_cvt_pk_bf16_f32 v138, v180, v181
v_cvt_pk_bf16_f32 v139, v182, v183
v_pk_fma_f32 v[184:185], v[192:193], v[176:177], v[184:185] op_sel_hi:[0,1,1] neg_lo:[0,0,1] neg_hi:[0,0,1]
v_pk_fma_f32 v[186:187], v[192:193], v[178:179], v[186:187] op_sel_hi:[0,1,1] neg_lo:[0,0,1] neg_hi:[0,0,1]
v_pk_fma_f32 v[188:189], v[192:193], v[180:181], v[188:189] op_sel_hi:[0,1,1] neg_lo:[0,0,1] neg_hi:[0,0,1]
v_pk_fma_f32 v[190:191], v[192:193], v[182:183], v[190:191] op_sel_hi:[0,1,1] neg_lo:[0,0,1] neg_hi:[0,0,1]
v_cvt_pk_bf16_f32 v140, v184, v185
v_cvt_pk_bf16_f32 v141, v186, v187
v_cvt_pk_bf16_f32 v142, v188, v189
v_cvt_pk_bf16_f32 v143, v190, v191
v_pk_fma_f32 v[176:177], v[192:193], v[184:185], v[176:177] op_sel_hi:[0,1,1] neg_lo:[0,0,1] neg_hi:[0,0,1]
v_pk_fma_f32 v[178:179], v[192:193], v[186:187], v[178:179] op_sel_hi:[0,1,1] neg_lo:[0,0,1] neg_hi:[0,0,1]
v_pk_fma_f32 v[180:181], v[192:193], v[188:189], v[180:181] op_sel_hi:[0,1,1] neg_lo:[0,0,1] neg_hi:[0,0,1]
v_pk_fma_f32 v[182:183], v[192:193], v[190:191], v[182:183] op_sel_hi:[0,1,1] neg_lo:[0,0,1] neg_hi:[0,0,1]
v_cvt_pk_bf16_f32 v144, v176, v177
v_cvt_pk_bf16_f32 v145, v178, v179
v_cvt_pk_bf16_f32 v146, v180, v181
v_cvt_pk_bf16_f32 v147, v182, v183
v_pk_fma_f32 v[184:185], v[192:193], v[176:177], v[184:185] op_sel_hi:[0,1,1] neg_lo:[0,0,1] neg_hi:[0,0,1]
v_pk_fma_f32 v[186:187], v[192:193], v[178:179], v[186:187] op_sel_hi:[0,1,1] neg_lo:[0,0,1] neg_hi:[0,0,1]
v_pk_fma_f32 v[188:189], v[192:193], v[180:181], v[188:189] op_sel_hi:[0,1,1] neg_lo:[0,0,1] neg_hi:[0,0,1]
v_pk_fma_f32 v[190:191], v[192:193], v[182:183], v[190:191] op_sel_hi:[0,1,1] neg_lo:[0,0,1] neg_hi:[0,0,1]
v_cvt_pk_bf16_f32 v148, v184, v185
v_cvt_pk_bf16_f32 v149, v186, v187
v_cvt_pk_bf16_f32 v150, v188, v189
v_cvt_pk_bf16_f32 v151, v190, v191
v_pk_fma_f32 v[176:177], v[192:193], v[184:185], v[176:177] op_sel_hi:[0,1,1] neg_lo:[0,0,1] neg_hi:[0,0,1]
v_pk_fma_f32 v[178:179], v[192:193], v[186:187], v[178:179] op_sel_hi:[0,1,1] neg_lo:[0,0,1] neg_hi:[0,0,1]
v_pk_fma_f32 v[180:181], v[192:193], v[188:189], v[180:181] op_sel_hi:[0,1,1] neg_lo:[0,0,1] neg_hi:[0,0,1]
v_pk_fma_f32 v[182:183], v[192:193], v[190:191], v[182:183] op_sel_hi:[0,1,1] neg_lo:[0,0,1] neg_hi:[0,0,1]
v_cvt_pk_bf16_f32 v152, v176, v177
v_cvt_pk_bf16_f32 v153, v178, v179
v_cvt_pk_bf16_f32 v154, v180, v181
v_cvt_pk_bf16_f32 v155, v182, v183
v_pk_fma_f32 v[184:185], v[192:193], v[176:177], v[184:185] op_sel_hi:[0,1,1] neg_lo:[0,0,1] neg_hi:[0,0,1]
v_pk_fma_f32 v[186:187], v[192:193], v[178:179], v[186:187] op_sel_hi:[0,1,1] neg_lo:[0,0,1] neg_hi:[0,0,1]
v_pk_fma_f32 v[188:189], v[192:193], v[180:181], v[188:189] op_sel_hi:[0,1,1] neg_lo:[0,0,1] neg_hi:[0,0,1]
v_pk_fma_f32 v[190:191], v[192:193], v[182:183], v[190:191] op_sel_hi:[0,1,1] neg_lo:[0,0,1] neg_hi:[0,0,1]
v_cvt_pk_bf16_f32 v156, v184, v185
v_cvt_pk_bf16_f32 v157, v186, v187
v_cvt_pk_bf16_f32 v158, v188, v189
v_cvt_pk_bf16_f32 v159, v190, v191
v_pk_fma_f32 v[176:177], v[192:193], v[184:185], v[176:177] op_sel_hi:[0,1,1] neg_lo:[0,0,1] neg_hi:[0,0,1]
v_pk_fma_f32 v[178:179], v[192:193], v[186:187], v[178:179] op_sel_hi:[0,1,1] neg_lo:[0,0,1] neg_hi:[0,0,1]
v_pk_fma_f32 v[180:181], v[192:193], v[188:189], v[180:181] op_sel_hi:[0,1,1] neg_lo:[0,0,1] neg_hi:[0,0,1]
v_pk_fma_f32 v[182:183], v[192:193], v[190:191], v[182:183] op_sel_hi:[0,1,1] neg_lo:[0,0,1] neg_hi:[0,0,1]
v_cvt_pk_bf16_f32 v160, v176, v177
v_cvt_pk_bf16_f32 v161, v178, v179
v_cvt_pk_bf16_f32 v162, v180, v181
v_cvt_pk_bf16_f32 v163, v182, v183
v_pk_fma_f32 v[184:185], v[192:193], v[176:177], v[184:185] op_sel_hi:[0,1,1] neg_lo:[0,0,1] neg_hi:[0,0,1]
v_pk_fma_f32 v[186:187], v[192:193], v[178:179], v[186:187] op_sel_hi:[0,1,1] neg_lo:[0,0,1] neg_hi:[0,0,1]
v_pk_fma_f32 v[188:189], v[192:193], v[180:181], v[188:189] op_sel_hi:[0,1,1] neg_lo:[0,0,1] neg_hi:[0,0,1]
v_pk_fma_f32 v[190:191], v[192:193], v[182:183], v[190:191] op_sel_hi:[0,1,1] neg_lo:[0,0,1] neg_hi:[0,0,1]
v_cvt_pk_bf16_f32 v164, v184, v185
v_cvt_pk_bf16_f32 v165, v186, v187
v_cvt_pk_bf16_f32 v166, v188, v189
v_cvt_pk_bf16_f32 v167, v190, v191
v_pk_fma_f32 v[176:177], v[192:193], v[184:185], v[176:177] op_sel_hi:[0,1,1] neg_lo:[0,0,1] neg_hi:[0,0,1]
v_pk_fma_f32 v[178:179], v[192:193], v[186:187], v[178:179] op_sel_hi:[0,1,1] neg_lo:[0,0,1] neg_hi:[0,0,1]
v_pk_fma_f32 v[180:181], v[192:193], v[188:189], v[180:181] op_sel_hi:[0,1,1] neg_lo:[0,0,1] neg_hi:[0,0,1]
v_pk_fma_f32 v[182:183], v[192:193], v[190:191], v[182:183] op_sel_hi:[0,1,1] neg_lo:[0,0,1] neg_hi:[0,0,1]
v_cvt_pk_bf16_f32 v168, v176, v177
v_cvt_pk_bf16_f32 v169, v178, v179
v_cvt_pk_bf16_f32 v170, v180, v181
v_cvt_pk_bf16_f32 v171, v182, v183
v_pk_fma_f32 v[184:185], v[192:193], v[176:177], v[184:185] op_sel_hi:[0,1,1] neg_lo:[0,0,1] neg_hi:[0,0,1]
v_pk_fma_f32 v[186:187], v[192:193], v[178:179], v[186:187] op_sel_hi:[0,1,1] neg_lo:[0,0,1] neg_hi:[0,0,1]
v_pk_fma_f32 v[188:189], v[192:193], v[180:181], v[188:189] op_sel_hi:[0,1,1] neg_lo:[0,0,1] neg_hi:[0,0,1]
v_pk_fma_f32 v[190:191], v[192:193], v[182:183], v[190:191] op_sel_hi:[0,1,1] neg_lo:[0,0,1] neg_hi:[0,0,1]
v_cvt_pk_bf16_f32 v172, v184, v185
v_cvt_pk_bf16_f32 v173, v186, v187
v_cvt_pk_bf16_f32 v174, v188, v189
v_cvt_pk_bf16_f32 v175, v190, v191
p1q_70:
s_lshl_b32 s18, s30, 7
s_add_u32 s18, s18, 32768
s_cmp_lg_u32 s13, 0
s_cbranch_scc1 polld_72
v_lshrrev_b32 v12, 2, v0
v_min_u32 v12, 76, v12
s_mov_b32 s17, 0
poll_71:
buffer_load_dword v8, v12, s[4:7], s18 offen offset:0 sc1
s_add_u32 s17, s17, 1
s_cmp_gt_u32 s17, 262144
s_cbranch_scc1 L_fail
s_waitcnt vmcnt(0)
v_cmp_gt_u32 vcc, 1, v8
s_cbranch_vccz polld_72
s_sleep 2
s_branch poll_71
polld_72:
s_barrier
s_mul_i32 s18, s30, 40960
s_add_u32 s26, s18, 91226112
s_add_u32 s26, s26, s31
s_add_u32 s27, s18, 100663296
s_add_u32 s27, s27, s33
s_add_u32 m0, s31, 2048
s_add_u32 s20, s26, 0
buffer_load_dwordx4 v0, s[4:7], s20 offen sc1 lds
s_add_u32 m0, s31, 3072
s_add_u32 s20, s26, 1024
buffer_load_dwordx4 v0, s[4:7], s20 offen sc1 lds
s_add_u32 m0, s31, 4096
s_add_u32 s20, s26, 2048
buffer_load_dwordx4 v0, s[4:7], s20 offen sc1 lds
s_add_u32 m0, s31, 5120
s_add_u32 s20, s26, 3072
buffer_load_dwordx4 v0, s[4:7], s20 offen sc1 lds
s_add_u32 m0, s31, 6144
s_add_u32 s20, s26, 4096
buffer_load_dwordx4 v0, s[4:7], s20 offen sc1 lds
s_add_u32 m0, s31, 7168
s_add_u32 s20, s26, 5120
buffer_load_dwordx4 v0, s[4:7], s20 offen sc1 lds
s_add_u32 m0, s31, 8192
s_add_u32 s20, s26, 6144
buffer_load_dwordx4 v0, s[4:7], s20 offen sc1 lds
s_add_u32 m0, s31, 9216
s_add_u32 s20, s26, 7168
buffer_load_dwordx4 v0, s[4:7], s20 offen sc1 lds
s_add_u32 m0, s31, 10240
s_add_u32 s20, s26, 8192
buffer_load_dwordx4 v0, s[4:7], s20 offen sc1 lds
s_add_u32 m0, s31, 11264
s_add_u32 s20, s26, 9216
buffer_load_dwordx4 v0, s[4:7], s20 offen sc1 lds
s_waitcnt vmcnt(0)
s_barrier
v_add_u32 v2, s31, v0
ds_read_b128 v[216:219], v2 offset:2048
ds_read_b128 v[220:223], v2 offset:3072
ds_read_b128 v[196:199], v0 offset:3072
ds_read_b128 v[228:231], v2 offset:5120
ds_read_b128 v[224:227], v2 offset:4096
ds_read_b128 v[200:203], v0 offset:4096
v_mov_b64 v[208:209], 0
ds_read_b128 v[192:195], v0 offset:2048
ds_read_b128 v[204:207], v0 offset:5120
s_waitcnt lgkmcnt(7)
v_dot2c_f32_bf16 v208, s24, v216
v_dot2c_f32_bf16 v209, v216, v216
v_dot2c_f32_bf16 v208, s24, v217
v_dot2c_f32_bf16 v209, v217, v217
v_dot2c_f32_bf16 v208, s24, v218
v_dot2c_f32_bf16 v209, v218, v218
v_dot2c_f32_bf16 v208, s24, v219
s_waitcnt lgkmcnt(6)
v_dot2c_f32_bf16 v209, v219, v219
v_dot2c_f32_bf16 v208, s24, v220
v_dot2c_f32_bf16 v209, v220, v220
v_dot2c_f32_bf16 v208, s24, v221
v_dot2c_f32_bf16 v209, v221, v221
v_dot2c_f32_bf16 v208, s24, v222
v_dot2c_f32_bf16 v209, v222, v222
v_dot2c_f32_bf16 v208, s24, v223
v_dot2c_f32_bf16 v209, v223, v223
s_waitcnt lgkmcnt(3)
ds_read_b128 v[216:219], v2 offset:6144
ds_read_b128 v[220:223], v2 offset:7168
v_dot2c_f32_bf16 v208, s24, v224
v_dot2c_f32_bf16 v209, v224, v224
v_dot2c_f32_bf16 v208, s24, v225
v_dot2c_f32_bf16 v209, v225, v225
v_dot2c_f32_bf16 v208, s24, v226
v_dot2c_f32_bf16 v209, v226, v226
v_dot2c_f32_bf16 v208, s24, v227
v_dot2c_f32_bf16 v209, v227, v227
v_dot2c_f32_bf16 v208, s24, v228
v_dot2c_f32_bf16 v209, v228, v228
v_dot2c_f32_bf16 v208, s24, v229
v_dot2c_f32_bf16 v209, v229, v229
v_dot2c_f32_bf16 v208, s24, v230
v_dot2c_f32_bf16 v209, v230, v230
v_dot2c_f32_bf16 v208, s24, v231
v_dot2c_f32_bf16 v209, v231, v231
s_waitcnt lgkmcnt(1)
ds_read_b128 v[228:231], v2 offset:9216
s_waitcnt lgkmcnt(1)
ds_read_b128 v[224:227], v2 offset:8192
v_dot2c_f32_bf16 v208, s24, v216
v_dot2c_f32_bf16 v209, v216, v216
v_dot2c_f32_bf16 v208, s24, v217
v_dot2c_f32_bf16 v209, v217, v217
v_dot2c_f32_bf16 v208, s24, v218
v_dot2c_f32_bf16 v209, v218, v218
v_dot2c_f32_bf16 v208, s24, v219
v_dot2c_f32_bf16 v209, v219, v219
v_dot2c_f32_bf16 v208, s24, v220
v_dot2c_f32_bf16 v209, v220, v220
v_dot2c_f32_bf16 v208, s24, v221
v_dot2c_f32_bf16 v209, v221, v221
v_dot2c_f32_bf16 v208, s24, v222
v_dot2c_f32_bf16 v209, v222, v222
v_dot2c_f32_bf16 v208, s24, v223
v_dot2c_f32_bf16 v209, v223, v223
s_waitcnt lgkmcnt(0)
ds_read_b128 v[216:219], v2 offset:10240
ds_read_b128 v[220:223], v2 offset:11264
v_dot2c_f32_bf16 v208, s24, v224
v_dot2c_f32_bf16 v209, v224, v224
v_dot2c_f32_bf16 v208, s24, v225
v_dot2c_f32_bf16 v209, v225, v225
v_dot2c_f32_bf16 v208, s24, v226
v_dot2c_f32_bf16 v209, v226, v226
v_dot2c_f32_bf16 v208, s24, v227
v_dot2c_f32_bf16 v209, v227, v227
v_dot2c_f32_bf16 v208, s24, v228
v_dot2c_f32_bf16 v209, v228, v228
v_dot2c_f32_bf16 v208, s24, v229
v_dot2c_f32_bf16 v209, v229, v229
v_dot2c_f32_bf16 v208, s24, v230
v_dot2c_f32_bf16 v209, v230, v230
s_waitcnt lgkmcnt(1)
v_dot2c_f32_bf16 v208, s24, v231
v_dot2c_f32_bf16 v209, v231, v231
v_dot2c_f32_bf16 v208, s24, v216
v_dot2c_f32_bf16 v209, v216, v216
v_dot2c_f32_bf16 v208, s24, v217
v_dot2c_f32_bf16 v209, v217, v217
v_dot2c_f32_bf16 v208, s24, v218
v_dot2c_f32_bf16 v209, v218, v218
s_waitcnt lgkmcnt(0)
v_dot2c_f32_bf16 v208, s24, v219
v_dot2c_f32_bf16 v209, v219, v219
v_dot2c_f32_bf16 v208, s24, v220
v_dot2c_f32_bf16 v209, v220, v220
v_dot2c_f32_bf16 v208, s24, v221
v_dot2c_f32_bf16 v209, v221, v221
v_dot2c_f32_bf16 v208, s24, v222
v_dot2c_f32_bf16 v209, v222, v222
v_dot2c_f32_bf16 v208, s24, v223
v_dot2c_f32_bf16 v209, v223, v223
v_mfma_f32_32x32x16_bf16 v[176:191], v[192:195], v[16:19], 0
s_nop 1
v_permlane32_swap_b32 v208, v209
v_mfma_f32_32x32x16_bf16 v[176:191], v[196:199], v[20:23], v[176:191]
ds_read_b128 v[192:195], v0 offset:6144
ds_read_b128 v[196:199], v0 offset:7168
v_add_f32 v208, v208, v209
v_mfma_f32_32x32x16_bf16 v[176:191], v[200:203], v[24:27], v[176:191]
v_lshl_add_u32 v209, s13, 2, v0
ds_write_b32 v209, v208 offset:0
v_mfma_f32_32x32x16_bf16 v[176:191], v[204:207], v[28:31], v[176:191]
ds_read_b128 v[204:207], v0 offset:9216
ds_read_b128 v[200:203], v0 offset:8192
v_and_b32 v2, 0x1ff, v0
s_waitcnt lgkmcnt(4)
v_mfma_f32_32x32x16_bf16 v[176:191], v[192:195], v[32:35], v[176:191]
s_waitcnt lgkmcnt(3)
ds_read_b128 v[192:195], v0 offset:10240
s_waitcnt lgkmcnt(3)
v_mfma_f32_32x32x16_bf16 v[176:191], v[196:199], v[36:39], v[176:191]
s_barrier
ds_read_b128 v[208:211], v2 offset:0
s_waitcnt lgkmcnt(2)
v_mfma_f32_32x32x16_bf16 v[176:191], v[200:203], v[40:43], v[176:191]
ds_read_b128 v[212:215], v2 offset:512
ds_read_b128 v[196:199], v0 offset:11264
s_waitcnt lgkmcnt(3)
ds_read_b128 v[200:203], v0 offset:12288
v_mfma_f32_32x32x16_bf16 v[176:191], v[204:207], v[44:47], v[176:191]
s_waitcnt lgkmcnt(3)
v_mfma_f32_32x32x16_bf16 v[176:191], v[192:195], v[48:51], v[176:191]
ds_read_b128 v[204:207], v0 offset:13312
v_add_f32 v210, v210, v211
v_add_f32 v208, v208, v209
s_waitcnt lgkmcnt(2)
ds_read_b128 v[192:195], v0 offset:14336
v_mfma_f32_32x32x16_bf16 v[176:191], v[196:199], v[52:55], v[176:191]
v_add_f32 v208, v208, v210
s_waitcnt lgkmcnt(2)
v_lshrrev_b32 v209, 2, v0
v_add_f32 v212, v212, v213
v_mul_f32 v208, 0x3acccccd, v208
v_mfma_f32_32x32x16_bf16 v[176:191], v[200:203], v[56:59], v[176:191]
v_add_f32 v214, v214, v215
s_waitcnt lgkmcnt(1)
ds_read_b128 v[196:199], v0 offset:15360
v_add_f32 v212, v212, v214
v_lshl_add_u32 v209, s13, 8, v209
v_mfma_f32_32x32x16_bf16 v[176:191], v[204:207], v[60:63], v[176:191]
ds_read_b128 v[200:203], v0 offset:16384
ds_read_b128 v[204:207], v0 offset:17408
v_mul_f32 v212, 0x3acccccd, v212
s_waitcnt lgkmcnt(3)
v_mfma_f32_32x32x16_bf16 v[176:191], v[192:195], v[64:67], v[176:191]
v_fma_f32 v212, -v208, v208, v212
ds_read_b128 v[192:195], v0 offset:18432
s_waitcnt lgkmcnt(3)
v_max_f32 v212, 0, v212
v_mfma_f32_32x32x16_bf16 v[176:191], v[196:199], v[68:71], v[176:191]
s_waitcnt lgkmcnt(1)
v_add_f32 v212, 0x3727c5ac, v212
v_mfma_f32_32x32x16_bf16 v[176:191], v[200:203], v[72:75], v[176:191]
ds_read_b128 v[196:199], v0 offset:19456
ds_read_b128 v[200:203], v0 offset:20480
v_mfma_f32_32x32x16_bf16 v[176:191], v[204:207], v[76:79], v[176:191]
ds_read_b128 v[204:207], v0 offset:21504
v_bfe_u32 v210, v0, 5, 5
s_waitcnt lgkmcnt(3)
v_mfma_f32_32x32x16_bf16 v[176:191], v[192:195], v[80:83], v[176:191]
v_rsq_f32 v212, v212
v_and_b32 v210, 16, v210
s_waitcnt lgkmcnt(2)
v_mfma_f32_32x32x16_bf16 v[176:191], v[196:199], v[84:87], v[176:191]
ds_read_b128 v[196:199], v0 offset:23552
v_lshl_add_u32 v210, s13, 8, v210
v_mul_f32 v208, v212, v208
s_waitcnt lgkmcnt(1)
ds_read_b128 v[192:195], v0 offset:22528
v_mfma_f32_32x32x16_bf16 v[176:191], v[200:203], v[88:91], v[176:191]
v_permlane32_swap_b32 v212, v208
ds_write_b32 v209, v212 offset:1024
v_mfma_f32_32x32x16_bf16 v[176:191], v[204:207], v[92:95], v[176:191]
ds_read_b128 v[200:203], v0 offset:24576
ds_read_b128 v[204:207], v0 offset:25600
s_waitcnt lgkmcnt(3)
v_mfma_f32_32x32x16_bf16 v[176:191], v[192:195], v[96:99], v[176:191]
ds_read_b128 v[216:219], v210 offset:1024
v_mfma_f32_32x32x16_bf16 v[176:191], v[196:199], v[100:103], v[176:191]
ds_read_b128 v[192:195], v0 offset:26624
ds_read_b128 v[196:199], v0 offset:27648
s_waitcnt lgkmcnt(4)
v_mfma_f32_32x32x16_bf16 v[176:191], v[200:203], v[104:107], v[176:191]
ds_read_b128 v[240:243], v210 offset:1216
ds_read_b128 v[200:203], v0 offset:28672
ds_read_b128 v[236:239], v210 offset:1184
s_waitcnt lgkmcnt(6)
v_mfma_f32_32x32x16_bf16 v[176:191], v[204:207], v[108:111], v[176:191]
s_waitcnt lgkmcnt(4)
ds_read_b128 v[204:207], v0 offset:29696
s_waitcnt lgkmcnt(4)
v_mfma_f32_32x32x16_bf16 v[176:191], v[192:195], v[112:115], v[176:191]
ds_read_b128 v[192:195], v0 offset:30720
v_mfma_f32_32x32x16_bf16 v[176:191], v[196:199], v[116:119], v[176:191]
ds_read_b128 v[232:235], v210 offset:1152
s_waitcnt lgkmcnt(4)
s_waitcnt lgkmcnt(2)
v_mfma_f32_32x32x16_bf16 v[176:191], v[200:203], v[120:123], v[176:191]
ds_read_b128 v[196:199], v0 offset:31744
s_waitcnt lgkmcnt(2)
ds_read_b128 v[200:203], v0 offset:32768
v_mfma_f32_32x32x16_bf16 v[176:191], v[204:207], v[124:127], v[176:191]
s_waitcnt lgkmcnt(2)
ds_read_b128 v[204:207], v0 offset:33792
v_mfma_f32_32x32x16_bf16 v[176:191], v[192:195], v[128:131], v[176:191]
s_waitcnt lgkmcnt(2)
ds_read_b128 v[192:195], v0 offset:34816
v_mul_f32 v239, v239, v7
ds_read_b128 v[224:227], v210 offset:1088
v_mfma_f32_32x32x16_bf16 v[176:191], v[196:199], v[132:135], v[176:191]
ds_read_b128 v[196:199], v0 offset:35840
s_waitcnt lgkmcnt(4)
ds_read_b128 v[244:247], v210 offset:1248
s_waitcnt lgkmcnt(4)
v_mfma_f32_32x32x16_bf16 v[176:191], v[200:203], v[136:139], v[176:191]
s_waitcnt lgkmcnt(3)
v_mul_f32 v234, v234, v7
ds_read_b128 v[200:203], v0 offset:36864
v_mfma_f32_32x32x16_bf16 v[176:191], v[204:207], v[140:143], v[176:191]
ds_read_b128 v[228:231], v210 offset:1120
ds_read_b128 v[204:207], v0 offset:37888
s_waitcnt lgkmcnt(4)
v_mfma_f32_32x32x16_bf16 v[176:191], v[192:195], v[144:147], v[176:191]
ds_read_b128 v[192:195], v0 offset:38912
ds_read_b128 v[220:223], v210 offset:1056
s_waitcnt lgkmcnt(5)
v_mfma_f32_32x32x16_bf16 v[176:191], v[196:199], v[148:151], v[176:191]
ds_read_b128 v[196:199], v0 offset:39936
s_waitcnt lgkmcnt(5)
v_mul_f32 v247, v247, v7
v_mfma_f32_32x32x16_bf16 v[176:191], v[200:203], v[152:155], v[176:191]
s_waitcnt lgkmcnt(3)
v_mul_f32 v245, v245, v7
s_waitcnt lgkmcnt(2)
ds_read_b128 v[200:203], v0 offset:40960
v_mul_f32 v246, v246, v7
v_mfma_f32_32x32x16_bf16 v[176:191], v[204:207], v[156:159], v[176:191]
ds_read_b128 v[204:207], v0 offset:41984
v_mfma_f32_32x32x16_bf16 v[176:191], v[192:195], v[160:163], v[176:191]
v_mul_f32 v243, v243, v7
s_waitcnt lgkmcnt(3)
v_mul_f32 v238, v238, v7
s_waitcnt lgkmcnt(1)
v_mfma_f32_32x32x16_bf16 v[176:191], v[196:199], v[164:167], v[176:191]
v_mfma_f32_32x32x16_bf16 v[176:191], v[200:203], v[168:171], v[176:191]
s_waitcnt lgkmcnt(0)
v_mul_f32 v242, v242, v7
v_mul_f32 v233, v233, v7
v_mul_f32 v236, v236, v7
v_mul_f32 v237, v237, v7
v_mul_f32 v232, v232, v7
v_mfma_f32_32x32x16_bf16 v[176:191], v[204:207], v[172:175], v[176:191]
s_nop 0
v_mul_f32 v235, v235, v7
v_mul_f32 v241, v241, v7
v_mul_f32 v244, v244, v7
v_mul_f32 v240, v240, v7
s_nop 6
v_fma_f32 v191, v191, v231, -v247
v_fma_f32 v185, v185, v225, -v241
v_fma_f32 v176, v176, v216, -v232
v_fma_f32 v188, v188, v228, -v244
v_fma_f32 v181, v181, v221, -v237
v_fma_f32 v184, v184, v224, -v240
v_fma_f32 v186, v186, v226, -v242
v_fma_f32 v187, v187, v227, -v243
v_fma_f32 v189, v189, v229, -v245
v_fma_f32 v182, v182, v222, -v238
v_cvt_pk_bf16_f32 v196, v184, v185
v_fma_f32 v190, v190, v230, -v246
v_cvt_pk_bf16_f32 v197, v186, v187
v_fma_f32 v180, v180, v220, -v236
v_cvt_pk_bf16_f32 v198, v188, v189
v_fma_f32 v179, v179, v219, -v235
v_cvt_pk_bf16_f32 v199, v190, v191
v_fma_f32 v178, v178, v218, -v234
v_fma_f32 v183, v183, v223, -v239
v_cvt_pk_bf16_f32 v195, v182, v183
v_cvt_pk_bf16_f32 v194, v180, v181
v_fma_f32 v177, v177, v217, -v233
v_cvt_pk_bf16_f32 v192, v176, v177
v_cvt_pk_bf16_f32 v193, v178, v179
buffer_store_dwordx4 v[192:195], v6, s[4:7], s27 offen offset:0 sc1
buffer_store_dwordx4 v[196:199], v6, s[4:7], s27 offen offset:1024 sc1
s_add_u32 s30, s30, 3
s_cmp_lt_u32 s30, 60
s_cbranch_scc1 p1q_70
s_lshl_b32 s18, s47, 2
s_add_u32 s18, s18, 6144
s_cmp_eq_u32 s13, 0
s_cselect_b32 s22, s18, s6
s_mov_b32 s23, 1
s_waitcnt vmcnt(0)
s_barrier
v_mov_b32 v3, s23
s_mov_b64 exec, 1
buffer_store_dword v3, off, s[4:7], s22 sc1
s_mov_b64 exec, -1
s_mov_b32 s22, s6
aend_52:
s_add_u32 s16, s16, 1
s_cmp_lt_u32 s16, 2
s_cbranch_scc1 alay_38
s_endpgm
L_chain:
s_and_b32 s12, s14, 1
s_cmp_lg_u32 s12, 0
s_cbranch_scc1 grp_73
s_mov_b32 s15, s14
s_mov_b32 s16, s13
s_lshr_b32 s30, s14, 1
v_and_b32 v64, 63, v0
v_and_b32 v65, 15, v64
v_lshrrev_b32 v66, 4, v64
v_lshlrev_b32 v0, 4, v64
v_and_b32 v67, 2, v64
v_mov_b32 v68, 0x4444
v_mov_b32 v69, 0xeeee
v_cmp_eq_u32 vcc, 0, v67
s_nop 1
v_cndmask_b32 v1, v69, v68, vcc
s_mul_i32 s33, s16, 24576
s_add_u32 s33, s33, 65536
v_add_u32 v2, s33, v0
v_lshrrev_b32 v67, 2, v65
v_xor_b32 v68, v66, v67
v_lshlrev_b32 v68, 3, v68
v_lshl_add_u32 v68, v65, 5, v68
s_lshl_b32 s33, s16, 10
s_add_u32 s33, s33, 10240
s_waitcnt vmcnt(1)
v_add_u32 v3, s33, v68
v_lshl_add_u32 v68, v66, 2, v67
v_and_b32 v69, 3, v65
v_xor_b32 v69, v69, v66
v_lshlrev_b32 v69, 3, v69
v_lshl_add_u32 v68, v68, 5, v69
s_waitcnt vmcnt(0)
v_add_u32 v4, 10240, v68
v_and_b32 v69, 1, v65
v_lshl_add_u32 v68, v67, 1, v69
v_lshlrev_b32 v68, 4, v68
v_lshl_add_u32 v68, v66, 7, v68
v_add_u32 v5, 14336, v68
v_bfe_u32 v69, v65, 1, 1
v_mul_u32_u24 v69, 640, v69
v_xor_b32 v6, v69, v5
s_mov_b32 s54, 0x33333333
s_mov_b32 s55, 0x33333333
s_mov_b32 s56, 0x3f803f80
s_mov_b32 s57, 0x3f803f80
s_mov_b32 s58, 0x3f803f80
s_mov_b32 s59, 0
s_mov_b32 s46, 729808896
s_mov_b32 s47, 671088640
v_lshlrev_b32 v68, 3, v65
v_lshl_add_u32 v7, v66, 12, v68
s_lshl_b32 s33, s16, 14
s_lshl_b32 s34, s15, 7
s_add_u32 s33, s33, s34
s_add_u32 s26, s33, 65536
s_lshl_b32 s33, s16, 5
s_add_u32 s32, s33, s15
s_lshl_b32 s33, s32, 12
s_add_u32 s27, s33, 65536
s_lshr_b32 s33, s32, 2
s_lshl_b32 s33, s33, 9
s_and_b32 s34, s32, 3
s_lshl_b32 s34, s34, 6
s_add_u32 s33, s33, s34
s_add_u32 s40, s33, 393216
s_lshl_b32 s33, s15, 7
s_add_u32 s28, s33, 0
s_lshl_b32 s33, s30, 2
s_add_u32 s33, s33, 4096
s_cmp_lt_u32 s30, 10
s_cselect_b32 s29, s33, 268435456
s_cselect_b32 s30, s30, 0
s_cselect_b32 s31, 12582912, s29
s_lshl_b32 s30, s30, 10
s_and_b32 s33, s15, 3
s_lshl_b32 s33, s33, 7
s_add_u32 s41, s33, 425984
s_lshl_b32 s33, s15, 2
s_add_u32 s42, s33, 425984
s_mov_b32 s44, 0x3e0293ee
s_lshl_b32 s33, s15, 2
s_add_u32 s33, s33, s16
s_mul_i32 s34, s33, 18432
s_add_u32 s23, s34, 1048576
s_add_u32 s60, s26, 0
s_add_u32 s61, s26, 65536
s_add_u32 s62, s26, 131072
s_add_u32 s63, s26, 196608
s_add_u32 s64, s26, 262144
s_add_u32 s65, s23, 0
s_add_u32 s66, s23, 4096
s_add_u32 s67, s23, 8192
s_add_u32 s68, s23, 12288
s_add_u32 s69, s23, 16384
v_mov_b32 v72, 0
v_mov_b32 v73, 0
s_mov_b32 s33, s26
buffer_store_dwordx2 v[72:73], v7, s[4:7], s33 offen
s_add_u32 s33, s33, 65536
buffer_store_dwordx2 v[72:73], v7, s[4:7], s33 offen
s_add_u32 s33, s33, 65536
buffer_store_dwordx2 v[72:73], v7, s[4:7], s33 offen
s_add_u32 s33, s33, 65536
buffer_store_dwordx2 v[72:73], v7, s[4:7], s33 offen
s_add_u32 s33, s33, 65536
buffer_store_dwordx2 v[72:73], v7, s[4:7], s33 offen
s_add_u32 s33, s33, 65536
buffer_store_dword v72, off, s[4:7], s42 offset:0
buffer_store_dword v72, off, s[4:7], s42 offset:128
buffer_store_dword v72, off, s[4:7], s42 offset:256
buffer_store_dword v72, off, s[4:7], s42 offset:384
s_load_dwordx2 s[48:49], s[0:1], 32
s_mov_b32 s50, 10240
s_mov_b32 s51, 0x20000
s_cmp_ge_u32 s32, 80
s_cbranch_scc1 nm0_74
s_and_b32 s33, s32, 3
s_mul_i32 s33, s33, 2560
s_lshr_b32 s34, s32, 2
s_lshl_b32 s34, s34, 6
s_add_u32 s33, s33, s34
v_bfe_u32 v68, v65, 1, 2
v_lshlrev_b32 v68, 4, v68
v_and_b32 v69, 1, v65
v_lshl_add_u32 v68, v69, 2, v68
v_and_b32 v69, 1, v66
v_mul_u32_u24 v69, 1280, v69
v_add_u32 v68, v68, v69
s_waitcnt lgkmcnt(0)
buffer_load_dword v74, v68, s[48:51], s33 offen
buffer_load_dword v75, v68, s[48:51], s33 offen offset:8
v_and_b32 v68, 32, v0
v_bfe_u32 v69, v0, 6, 1
v_lshl_add_u32 v68, v69, 8, v68
v_bfe_u32 v69, v0, 8, 1
v_lshl_add_u32 v68, v69, 4, v68
v_bfe_u32 v69, v0, 4, 1
v_lshl_add_u32 v68, v69, 3, v68
s_add_u32 s34, s40, 16384
buffer_store_dwordx2 v[72:73], v68, s[4:7], s40 offen
s_waitcnt vmcnt(1)
buffer_store_dwordx2 v[74:75], v68, s[4:7], s34 offen
nm0_74:
s_waitcnt vmcnt(0) lgkmcnt(0)
v_lshrrev_b32 v67, 3, v64
v_and_b32 v68, 7, v64
v_lshlrev_b32 v68, 4, v68
v_lshl_add_u32 v32, v67, 13, v68
v_mul_u32_u24 v67, 1280, v67
v_add_u32 v36, v67, v68
v_lshrrev_b32 v67, 1, v66
v_lshlrev_b32 v67, 4, v67
v_and_b32 v68, 1, v66
v_lshl_add_u32 v67, v68, 1, v67
v_lshrrev_b32 v68, 3, v65
v_lshl_add_u32 v67, v68, 3, v67
v_bfe_u32 v68, v65, 2, 1
v_add_u32 v67, v67, v68
v_and_b32 v69, 3, v65
v_lshlrev_b32 v40, 4, v69
v_lshl_add_u32 v40, v67, 7, v40
v_lshl_add_u32 v67, v66, 2, v68
v_lshlrev_b32 v42, 4, v69
v_lshl_add_u32 v42, v67, 7, v42
v_lshrrev_b32 v68, 3, v65
v_lshl_add_u32 v42, v68, 3, v42
s_lshl_b32 s36, s16, 12
s_and_b32 s33, s16, 1
s_lshl_b32 s33, s33, 6
s_add_u32 s33, s33, s36
v_add_u32 v40, s33, v40
v_add_u32 v42, s33, v42
v_xor_b32 v41, 4096, v40
v_xor_b32 v43, 4096, v42
v_add_u32 v33, 64512, v32
v_add_u32 v37, 9216, v36
v_add_u32 v34, 129024, v32
v_add_u32 v38, 18432, v36
v_add_u32 v35, 193536, v32
v_add_u32 v39, 27648, v36
s_lshr_b32 s35, s16, 1
s_lshl_b32 s35, s35, 7
s_lshl_b32 s34, s15, 8
s_add_u32 s34, s34, s35
s_xor_b32 s33, s16, 0
s_lshl_b32 s70, s33, 19
s_add_u32 s70, s70, s34
s_lshl_b32 s73, s15, 2
s_add_u32 s73, s73, s33
s_mul_i32 s73, s73, 40960
s_add_u32 s73, s73, s35
s_xor_b32 s33, s16, 2
s_lshl_b32 s71, s33, 19
s_add_u32 s71, s71, s34
s_lshl_b32 s74, s15, 2
s_add_u32 s74, s74, s33
s_mul_i32 s74, s74, 40960
s_add_u32 s74, s74, s35
s_and_b32 s33, s16, 1
s_add_u32 s33, s33, 8
s_lshl_b32 s72, s33, 19
s_add_u32 s72, s72, s34
s_load_dwordx2 s[76:77], s[0:1], 40
s_mov_b32 s78, 5242880
s_mov_b32 s79, 0x20000
s_load_dwordx2 s[80:81], s[0:1], 48
s_mov_b32 s82, 5242880
s_mov_b32 s83, 0x20000
s_load_dwordx2 s[84:85], s[0:1], 56
s_mov_b32 s86, 5242880
s_mov_b32 s87, 0x20000
s_load_dwordx2 s[88:89], s[0:1], 64
s_mov_b32 s90, 5242880
s_mov_b32 s91, 0x20000
s_add_u32 m0, s36, 0
s_add_u32 s33, s70, 0
s_waitcnt lgkmcnt(0)
buffer_load_dwordx4 v32, s[80:83], s33 offen offset:0 lds
buffer_load_dwordx4 v33, s[80:83], s33 offen offset:1024 lds
buffer_load_dwordx4 v34, s[80:83], s33 offen offset:2048 lds
buffer_load_dwordx4 v35, s[80:83], s33 offen offset:3072 lds
s_add_u32 m0, s36, 16384
s_add_u32 s33, s70, 262144
buffer_load_dwordx4 v32, s[80:83], s33 offen offset:0 lds
buffer_load_dwordx4 v33, s[80:83], s33 offen offset:1024 lds
buffer_load_dwordx4 v34, s[80:83], s33 offen offset:2048 lds
buffer_load_dwordx4 v35, s[80:83], s33 offen offset:3072 lds
s_add_u32 m0, s36, 32768
s_add_u32 s33, s70, 2097152
buffer_load_dwordx4 v32, s[80:83], s33 offen offset:0 lds
buffer_load_dwordx4 v33, s[80:83], s33 offen offset:1024 lds
buffer_load_dwordx4 v34, s[80:83], s33 offen offset:2048 lds
buffer_load_dwordx4 v35, s[80:83], s33 offen offset:3072 lds
s_waitcnt vmcnt(8)
s_barrier
s_add_u32 m0, s36, 49152
s_add_u32 s33, s70, 2359296
buffer_load_dwordx4 v32, s[80:83], s33 offen offset:0 lds
buffer_load_dwordx4 v33, s[80:83], s33 offen offset:1024 lds
buffer_load_dwordx4 v34, s[80:83], s33 offen offset:2048 lds
buffer_load_dwordx4 v35, s[80:83], s33 offen offset:3072 lds
ds_read_b64_tr_b16 v[72:73], v40 offset:0
ds_read_b64_tr_b16 v[74:75], v40 offset:512
ds_read_b64_tr_b16 v[76:77], v40 offset:8
ds_read_b64_tr_b16 v[78:79], v40 offset:520
ds_read_b64_tr_b16 v[80:81], v41 offset:0
ds_read_b64_tr_b16 v[82:83], v41 offset:512
ds_read_b64_tr_b16 v[84:85], v41 offset:8
ds_read_b64_tr_b16 v[86:87], v41 offset:520
s_waitcnt lgkmcnt(6)
buffer_store_dwordx4 v[72:75], v0, s[4:7], s66 offen offset:0
s_waitcnt lgkmcnt(4)
buffer_store_dwordx4 v[76:79], v0, s[4:7], s66 offen offset:2048
s_waitcnt lgkmcnt(2)
buffer_store_dwordx4 v[80:83], v0, s[4:7], s67 offen offset:2048
s_waitcnt lgkmcnt(0)
ds_write_b128 v2, v[84:87] offset:10240
s_waitcnt vmcnt(11)
s_barrier
s_add_u32 m0, s36, 0
s_add_u32 s33, s71, 0
buffer_load_dwordx4 v32, s[80:83], s33 offen offset:0 lds
buffer_load_dwordx4 v33, s[80:83], s33 offen offset:1024 lds
buffer_load_dwordx4 v34, s[80:83], s33 offen offset:2048 lds
buffer_load_dwordx4 v35, s[80:83], s33 offen offset:3072 lds
ds_read_b64_tr_b16 v[72:73], v40 offset:16384
ds_read_b64_tr_b16 v[74:75], v40 offset:16896
ds_read_b64_tr_b16 v[76:77], v40 offset:16392
ds_read_b64_tr_b16 v[78:79], v40 offset:16904
ds_read_b64_tr_b16 v[80:81], v41 offset:16384
ds_read_b64_tr_b16 v[82:83], v41 offset:16896
ds_read_b64_tr_b16 v[84:85], v41 offset:16392
ds_read_b64_tr_b16 v[86:87], v41 offset:16904
s_waitcnt lgkmcnt(6)
buffer_store_dwordx4 v[72:75], v0, s[4:7], s66 offen offset:1024
s_waitcnt lgkmcnt(4)
buffer_store_dwordx4 v[76:79], v0, s[4:7], s66 offen offset:3072
s_waitcnt lgkmcnt(2)
buffer_store_dwordx4 v[80:83], v0, s[4:7], s67 offen offset:3072
s_waitcnt lgkmcnt(0)
ds_write_b128 v2, v[84:87] offset:11264
s_waitcnt vmcnt(14)
s_barrier
s_add_u32 m0, s36, 16384
s_add_u32 s33, s71, 262144
buffer_load_dwordx4 v32, s[80:83], s33 offen offset:0 lds
buffer_load_dwordx4 v33, s[80:83], s33 offen offset:1024 lds
buffer_load_dwordx4 v34, s[80:83], s33 offen offset:2048 lds
buffer_load_dwordx4 v35, s[80:83], s33 offen offset:3072 lds
ds_read_b64_tr_b16 a[24:25], v40 offset:32768
ds_read_b64_tr_b16 a[26:27], v40 offset:33280
ds_read_b64_tr_b16 a[32:33], v40 offset:32776
ds_read_b64_tr_b16 a[34:35], v40 offset:33288
ds_read_b64_tr_b16 a[144:145], v41 offset:32768
ds_read_b64_tr_b16 a[146:147], v41 offset:33280
ds_read_b64_tr_b16 a[152:153], v41 offset:32776
ds_read_b64_tr_b16 a[154:155], v41 offset:33288
s_waitcnt vmcnt(14) lgkmcnt(0)
s_barrier
s_add_u32 m0, s36, 32768
s_add_u32 s33, s71, 2097152
buffer_load_dwordx4 v32, s[80:83], s33 offen offset:0 lds
buffer_load_dwordx4 v33, s[80:83], s33 offen offset:1024 lds
buffer_load_dwordx4 v34, s[80:83], s33 offen offset:2048 lds
buffer_load_dwordx4 v35, s[80:83], s33 offen offset:3072 lds
ds_read_b64_tr_b16 a[28:29], v40 offset:49152
ds_read_b64_tr_b16 a[30:31], v40 offset:49664
ds_read_b64_tr_b16 a[36:37], v40 offset:49160
ds_read_b64_tr_b16 a[38:39], v40 offset:49672
ds_read_b64_tr_b16 a[148:149], v41 offset:49152
ds_read_b64_tr_b16 a[150:151], v41 offset:49664
ds_read_b64_tr_b16 a[156:157], v41 offset:49160
ds_read_b64_tr_b16 a[158:159], v41 offset:49672
s_waitcnt vmcnt(11) lgkmcnt(0)
s_barrier
s_add_u32 m0, s36, 49152
s_add_u32 s33, s71, 2359296
buffer_load_dwordx4 v32, s[80:83], s33 offen offset:0 lds
buffer_load_dwordx4 v33, s[80:83], s33 offen offset:1024 lds
buffer_load_dwordx4 v34, s[80:83], s33 offen offset:2048 lds
buffer_load_dwordx4 v35, s[80:83], s33 offen offset:3072 lds
ds_read_b64_tr_b16 a[160:161], v40 offset:0
ds_read_b64_tr_b16 a[162:163], v40 offset:512
ds_read_b64_tr_b16 v[76:77], v40 offset:8
ds_read_b64_tr_b16 v[78:79], v40 offset:520
ds_read_b64_tr_b16 a[184:185], v41 offset:0
ds_read_b64_tr_b16 a[186:187], v41 offset:512
ds_read_b64_tr_b16 v[84:85], v41 offset:8
ds_read_b64_tr_b16 v[86:87], v41 offset:520
s_waitcnt lgkmcnt(4)
ds_write_b128 v2, v[76:79] offset:12288
s_waitcnt lgkmcnt(1)
ds_write_b128 v2, v[84:87] offset:14336
s_waitcnt vmcnt(8)
s_barrier
s_add_u32 m0, s36, 0
s_add_u32 s33, s72, 0
buffer_load_dwordx4 v32, s[80:83], s33 offen offset:0 lds
buffer_load_dwordx4 v33, s[80:83], s33 offen offset:1024 lds
buffer_load_dwordx4 v34, s[80:83], s33 offen offset:2048 lds
buffer_load_dwordx4 v35, s[80:83], s33 offen offset:3072 lds
ds_read_b64_tr_b16 a[164:165], v40 offset:16384
ds_read_b64_tr_b16 a[166:167], v40 offset:16896
ds_read_b64_tr_b16 v[76:77], v40 offset:16392
ds_read_b64_tr_b16 v[78:79], v40 offset:16904
ds_read_b64_tr_b16 a[188:189], v41 offset:16384
ds_read_b64_tr_b16 a[190:191], v41 offset:16896
ds_read_b64_tr_b16 v[84:85], v41 offset:16392
ds_read_b64_tr_b16 v[86:87], v41 offset:16904
s_waitcnt lgkmcnt(4)
ds_write_b128 v2, v[76:79] offset:13312
s_waitcnt lgkmcnt(1)
ds_write_b128 v2, v[84:87] offset:15360
s_waitcnt vmcnt(8)
s_barrier
s_add_u32 m0, s36, 16384
s_add_u32 s33, s72, 262144
buffer_load_dwordx4 v32, s[80:83], s33 offen offset:0 lds
buffer_load_dwordx4 v33, s[80:83], s33 offen offset:1024 lds
buffer_load_dwordx4 v34, s[80:83], s33 offen offset:2048 lds
buffer_load_dwordx4 v35, s[80:83], s33 offen offset:3072 lds
ds_read_b64_tr_b16 a[168:169], v40 offset:32768
ds_read_b64_tr_b16 a[170:171], v40 offset:33280
ds_read_b64_tr_b16 a[176:177], v40 offset:32776
ds_read_b64_tr_b16 a[178:179], v40 offset:33288
ds_read_b64_tr_b16 a[192:193], v41 offset:32768
ds_read_b64_tr_b16 a[194:195], v41 offset:33280
ds_read_b64_tr_b16 a[200:201], v41 offset:32776
ds_read_b64_tr_b16 a[202:203], v41 offset:33288
s_waitcnt vmcnt(8) lgkmcnt(0)
s_barrier
s_add_u32 m0, s36, 32768
s_add_u32 s33, s70, 0
buffer_load_dwordx4 v32, s[84:87], s33 offen offset:0 lds
buffer_load_dwordx4 v33, s[84:87], s33 offen offset:1024 lds
buffer_load_dwordx4 v34, s[84:87], s33 offen offset:2048 lds
buffer_load_dwordx4 v35, s[84:87], s33 offen offset:3072 lds
ds_read_b64_tr_b16 a[172:173], v40 offset:49152
ds_read_b64_tr_b16 a[174:175], v40 offset:49664
ds_read_b64_tr_b16 a[180:181], v40 offset:49160
ds_read_b64_tr_b16 a[182:183], v40 offset:49672
ds_read_b64_tr_b16 a[196:197], v41 offset:49152
ds_read_b64_tr_b16 a[198:199], v41 offset:49664
ds_read_b64_tr_b16 a[204:205], v41 offset:49160
ds_read_b64_tr_b16 a[206:207], v41 offset:49672
s_waitcnt vmcnt(8) lgkmcnt(0)
s_barrier
s_add_u32 m0, s36, 49152
s_add_u32 s33, s70, 262144
buffer_load_dwordx4 v32, s[84:87], s33 offen offset:0 lds
buffer_load_dwordx4 v33, s[84:87], s33 offen offset:1024 lds
buffer_load_dwordx4 v34, s[84:87], s33 offen offset:2048 lds
buffer_load_dwordx4 v35, s[84:87], s33 offen offset:3072 lds
ds_read_b64_tr_b16 a[208:209], v40 offset:0
ds_read_b64_tr_b16 a[210:211], v40 offset:512
ds_read_b64_tr_b16 v[76:77], v40 offset:8
ds_read_b64_tr_b16 v[78:79], v40 offset:520
ds_read_b64_tr_b16 a[216:217], v41 offset:0
ds_read_b64_tr_b16 a[218:219], v41 offset:512
ds_read_b64_tr_b16 a[224:225], v41 offset:8
ds_read_b64_tr_b16 a[226:227], v41 offset:520
s_waitcnt lgkmcnt(4)
ds_write_b128 v2, v[76:79] offset:16384
s_waitcnt vmcnt(8) lgkmcnt(1)
s_barrier
s_add_u32 m0, s36, 0
s_add_u32 s33, s70, 2097152
buffer_load_dwordx4 v32, s[84:87], s33 offen offset:0 lds
buffer_load_dwordx4 v33, s[84:87], s33 offen offset:1024 lds
buffer_load_dwordx4 v34, s[84:87], s33 offen offset:2048 lds
buffer_load_dwordx4 v35, s[84:87], s33 offen offset:3072 lds
ds_read_b64_tr_b16 a[212:213], v40 offset:16384
ds_read_b64_tr_b16 a[214:215], v40 offset:16896
ds_read_b64_tr_b16 v[76:77], v40 offset:16392
ds_read_b64_tr_b16 v[78:79], v40 offset:16904
ds_read_b64_tr_b16 a[220:221], v41 offset:16384
ds_read_b64_tr_b16 a[222:223], v41 offset:16896
ds_read_b64_tr_b16 a[228:229], v41 offset:16392
ds_read_b64_tr_b16 a[230:231], v41 offset:16904
s_waitcnt lgkmcnt(4)
ds_write_b128 v2, v[76:79] offset:17408
s_waitcnt vmcnt(8) lgkmcnt(1)
s_barrier
s_add_u32 m0, s36, 16384
s_add_u32 s33, s70, 2359296
buffer_load_dwordx4 v32, s[84:87], s33 offen offset:0 lds
buffer_load_dwordx4 v33, s[84:87], s33 offen offset:1024 lds
buffer_load_dwordx4 v34, s[84:87], s33 offen offset:2048 lds
buffer_load_dwordx4 v35, s[84:87], s33 offen offset:3072 lds
ds_read_b64_tr_b16 v[72:73], v40 offset:32768
ds_read_b64_tr_b16 v[74:75], v40 offset:33280
ds_read_b64_tr_b16 a[0:1], v40 offset:32776
ds_read_b64_tr_b16 a[2:3], v40 offset:33288
ds_read_b64_tr_b16 v[80:81], v41 offset:32768
ds_read_b64_tr_b16 v[82:83], v41 offset:33280
ds_read_b64_tr_b16 a[232:233], v41 offset:32776
ds_read_b64_tr_b16 a[234:235], v41 offset:33288
s_waitcnt lgkmcnt(6)
ds_write_b128 v2, v[72:75] offset:0
s_waitcnt lgkmcnt(3)
ds_write_b128 v2, v[80:83] offset:18432
s_waitcnt vmcnt(8) lgkmcnt(2)
s_barrier
s_add_u32 m0, s36, 32768
s_add_u32 s33, s71, 0
buffer_load_dwordx4 v32, s[84:87], s33 offen offset:0 lds
buffer_load_dwordx4 v33, s[84:87], s33 offen offset:1024 lds
buffer_load_dwordx4 v34, s[84:87], s33 offen offset:2048 lds
buffer_load_dwordx4 v35, s[84:87], s33 offen offset:3072 lds
ds_read_b64_tr_b16 v[72:73], v40 offset:49152
ds_read_b64_tr_b16 v[74:75], v40 offset:49664
ds_read_b64_tr_b16 a[4:5], v40 offset:49160
ds_read_b64_tr_b16 a[6:7], v40 offset:49672
ds_read_b64_tr_b16 v[80:81], v41 offset:49152
ds_read_b64_tr_b16 v[82:83], v41 offset:49664
ds_read_b64_tr_b16 a[236:237], v41 offset:49160
ds_read_b64_tr_b16 a[238:239], v41 offset:49672
s_waitcnt lgkmcnt(6)
ds_write_b128 v2, v[72:75] offset:1024
s_waitcnt lgkmcnt(3)
ds_write_b128 v2, v[80:83] offset:19456
s_waitcnt vmcnt(8) lgkmcnt(2)
s_barrier
s_add_u32 m0, s36, 49152
s_add_u32 s33, s71, 262144
buffer_load_dwordx4 v32, s[84:87], s33 offen offset:0 lds
buffer_load_dwordx4 v33, s[84:87], s33 offen offset:1024 lds
buffer_load_dwordx4 v34, s[84:87], s33 offen offset:2048 lds
buffer_load_dwordx4 v35, s[84:87], s33 offen offset:3072 lds
ds_read_b64_tr_b16 v[72:73], v40 offset:0
ds_read_b64_tr_b16 v[74:75], v40 offset:512
ds_read_b64_tr_b16 a[40:41], v40 offset:8
ds_read_b64_tr_b16 a[42:43], v40 offset:520
ds_read_b64_tr_b16 a[240:241], v41 offset:0
ds_read_b64_tr_b16 a[242:243], v41 offset:512
ds_read_b64_tr_b16 v[84:85], v41 offset:8
ds_read_b64_tr_b16 v[86:87], v41 offset:520
s_waitcnt lgkmcnt(6)
ds_write_b128 v2, v[72:75] offset:2048
s_waitcnt lgkmcnt(1)
ds_write_b128 v2, v[84:87] offset:20480
s_waitcnt vmcnt(8)
s_barrier
s_add_u32 m0, s36, 0
s_add_u32 s33, s71, 2097152
buffer_load_dwordx4 v32, s[84:87], s33 offen offset:0 lds
buffer_load_dwordx4 v33, s[84:87], s33 offen offset:1024 lds
buffer_load_dwordx4 v34, s[84:87], s33 offen offset:2048 lds
buffer_load_dwordx4 v35, s[84:87], s33 offen offset:3072 lds
ds_read_b64_tr_b16 v[72:73], v40 offset:16384
ds_read_b64_tr_b16 v[74:75], v40 offset:16896
ds_read_b64_tr_b16 a[44:45], v40 offset:16392
ds_read_b64_tr_b16 a[46:47], v40 offset:16904
ds_read_b64_tr_b16 a[244:245], v41 offset:16384
ds_read_b64_tr_b16 a[246:247], v41 offset:16896
ds_read_b64_tr_b16 v[84:85], v41 offset:16392
ds_read_b64_tr_b16 v[86:87], v41 offset:16904
s_waitcnt lgkmcnt(6)
ds_write_b128 v2, v[72:75] offset:3072
s_waitcnt lgkmcnt(1)
ds_write_b128 v2, v[84:87] offset:21504
s_waitcnt vmcnt(8)
s_barrier
s_add_u32 m0, s36, 16384
s_add_u32 s33, s71, 2359296
buffer_load_dwordx4 v32, s[84:87], s33 offen offset:0 lds
buffer_load_dwordx4 v33, s[84:87], s33 offen offset:1024 lds
buffer_load_dwordx4 v34, s[84:87], s33 offen offset:2048 lds
buffer_load_dwordx4 v35, s[84:87], s33 offen offset:3072 lds
ds_read_b64_tr_b16 a[248:249], v40 offset:32768
ds_read_b64_tr_b16 a[250:251], v40 offset:33280
ds_read_b64_tr_b16 v[88:89], v40 offset:32776
ds_read_b64_tr_b16 v[90:91], v40 offset:33288
ds_read_b64_tr_b16 v[104:105], v41 offset:32768
ds_read_b64_tr_b16 v[106:107], v41 offset:33280
ds_read_b64_tr_b16 v[112:113], v41 offset:32776
ds_read_b64_tr_b16 v[114:115], v41 offset:33288
s_waitcnt vmcnt(8) lgkmcnt(0)
s_barrier
s_add_u32 m0, s36, 32768
s_add_u32 s33, s72, 0
buffer_load_dwordx4 v32, s[84:87], s33 offen offset:0 lds
buffer_load_dwordx4 v33, s[84:87], s33 offen offset:1024 lds
buffer_load_dwordx4 v34, s[84:87], s33 offen offset:2048 lds
buffer_load_dwordx4 v35, s[84:87], s33 offen offset:3072 lds
ds_read_b64_tr_b16 a[252:253], v40 offset:49152
ds_read_b64_tr_b16 a[254:255], v40 offset:49664
ds_read_b64_tr_b16 v[92:93], v40 offset:49160
ds_read_b64_tr_b16 v[94:95], v40 offset:49672
ds_read_b64_tr_b16 v[108:109], v41 offset:49152
ds_read_b64_tr_b16 v[110:111], v41 offset:49664
ds_read_b64_tr_b16 v[116:117], v41 offset:49160
ds_read_b64_tr_b16 v[118:119], v41 offset:49672
s_waitcnt vmcnt(8) lgkmcnt(0)
s_barrier
s_add_u32 m0, s36, 49152
s_add_u32 s33, s72, 262144
buffer_load_dwordx4 v32, s[84:87], s33 offen offset:0 lds
buffer_load_dwordx4 v33, s[84:87], s33 offen offset:1024 lds
buffer_load_dwordx4 v34, s[84:87], s33 offen offset:2048 lds
buffer_load_dwordx4 v35, s[84:87], s33 offen offset:3072 lds
ds_read_b64_tr_b16 v[96:97], v40 offset:0
ds_read_b64_tr_b16 v[98:99], v40 offset:512
ds_read_b64_tr_b16 v[76:77], v40 offset:8
ds_read_b64_tr_b16 v[78:79], v40 offset:520
ds_read_b64_tr_b16 v[120:121], v41 offset:0
ds_read_b64_tr_b16 v[122:123], v41 offset:512
ds_read_b64_tr_b16 v[128:129], v41 offset:8
ds_read_b64_tr_b16 v[130:131], v41 offset:520
s_waitcnt lgkmcnt(4)
ds_write_b128 v2, v[76:79] offset:22528
s_waitcnt vmcnt(8) lgkmcnt(1)
s_barrier
s_add_u32 m0, s36, 0
s_add_u32 s33, s70, 0
buffer_load_dwordx4 v32, s[76:79], s33 offen offset:0 lds
buffer_load_dwordx4 v33, s[76:79], s33 offen offset:1024 lds
buffer_load_dwordx4 v34, s[76:79], s33 offen offset:2048 lds
buffer_load_dwordx4 v35, s[76:79], s33 offen offset:3072 lds
ds_read_b64_tr_b16 v[100:101], v40 offset:16384
ds_read_b64_tr_b16 v[102:103], v40 offset:16896
ds_read_b64_tr_b16 v[76:77], v40 offset:16392
ds_read_b64_tr_b16 v[78:79], v40 offset:16904
ds_read_b64_tr_b16 v[124:125], v41 offset:16384
ds_read_b64_tr_b16 v[126:127], v41 offset:16896
ds_read_b64_tr_b16 v[132:133], v41 offset:16392
ds_read_b64_tr_b16 v[134:135], v41 offset:16904
s_waitcnt lgkmcnt(4)
ds_write_b128 v2, v[76:79] offset:23552
s_waitcnt vmcnt(8) lgkmcnt(1)
s_barrier
s_add_u32 m0, s36, 16384
s_add_u32 s33, s70, 262144
buffer_load_dwordx4 v32, s[76:79], s33 offen offset:0 lds
buffer_load_dwordx4 v33, s[76:79], s33 offen offset:1024 lds
buffer_load_dwordx4 v34, s[76:79], s33 offen offset:2048 lds
buffer_load_dwordx4 v35, s[76:79], s33 offen offset:3072 lds
ds_read_b64_tr_b16 v[136:137], v40 offset:32768
ds_read_b64_tr_b16 v[138:139], v40 offset:33280
ds_read_b64_tr_b16 v[144:145], v40 offset:32776
ds_read_b64_tr_b16 v[146:147], v40 offset:33288
ds_read_b64_tr_b16 v[152:153], v41 offset:32768
ds_read_b64_tr_b16 v[154:155], v41 offset:33280
ds_read_b64_tr_b16 v[160:161], v41 offset:32776
ds_read_b64_tr_b16 v[162:163], v41 offset:33288
s_waitcnt vmcnt(8) lgkmcnt(0)
s_barrier
s_add_u32 m0, s36, 32768
s_add_u32 s33, s70, 2097152
buffer_load_dwordx4 v32, s[76:79], s33 offen offset:0 lds
buffer_load_dwordx4 v33, s[76:79], s33 offen offset:1024 lds
buffer_load_dwordx4 v34, s[76:79], s33 offen offset:2048 lds
buffer_load_dwordx4 v35, s[76:79], s33 offen offset:3072 lds
ds_read_b64_tr_b16 v[140:141], v40 offset:49152
ds_read_b64_tr_b16 v[142:143], v40 offset:49664
ds_read_b64_tr_b16 v[148:149], v40 offset:49160
ds_read_b64_tr_b16 v[150:151], v40 offset:49672
ds_read_b64_tr_b16 v[156:157], v41 offset:49152
ds_read_b64_tr_b16 v[158:159], v41 offset:49664
ds_read_b64_tr_b16 v[164:165], v41 offset:49160
ds_read_b64_tr_b16 v[166:167], v41 offset:49672
s_waitcnt vmcnt(8) lgkmcnt(0)
s_barrier
s_add_u32 m0, s36, 49152
s_add_u32 s33, s70, 2359296
buffer_load_dwordx4 v32, s[76:79], s33 offen offset:0 lds
buffer_load_dwordx4 v33, s[76:79], s33 offen offset:1024 lds
buffer_load_dwordx4 v34, s[76:79], s33 offen offset:2048 lds
buffer_load_dwordx4 v35, s[76:79], s33 offen offset:3072 lds
ds_read_b64_tr_b16 v[72:73], v40 offset:0
ds_read_b64_tr_b16 v[74:75], v40 offset:512
ds_read_b64_tr_b16 v[76:77], v40 offset:8
ds_read_b64_tr_b16 v[78:79], v40 offset:520
ds_read_b64_tr_b16 a[48:49], v41 offset:0
ds_read_b64_tr_b16 a[50:51], v41 offset:512
ds_read_b64_tr_b16 a[56:57], v41 offset:8
ds_read_b64_tr_b16 a[58:59], v41 offset:520
s_waitcnt lgkmcnt(6)
buffer_store_dwordx4 v[72:75], v0, s[4:7], s65 offen offset:0
s_waitcnt lgkmcnt(4)
buffer_store_dwordx4 v[76:79], v0, s[4:7], s65 offen offset:2048
s_waitcnt vmcnt(10) lgkmcnt(0)
s_barrier
s_add_u32 m0, s36, 0
s_add_u32 s33, s71, 0
buffer_load_dwordx4 v32, s[76:79], s33 offen offset:0 lds
buffer_load_dwordx4 v33, s[76:79], s33 offen offset:1024 lds
buffer_load_dwordx4 v34, s[76:79], s33 offen offset:2048 lds
buffer_load_dwordx4 v35, s[76:79], s33 offen offset:3072 lds
ds_read_b64_tr_b16 v[72:73], v40 offset:16384
ds_read_b64_tr_b16 v[74:75], v40 offset:16896
ds_read_b64_tr_b16 v[76:77], v40 offset:16392
ds_read_b64_tr_b16 v[78:79], v40 offset:16904
ds_read_b64_tr_b16 a[52:53], v41 offset:16384
ds_read_b64_tr_b16 a[54:55], v41 offset:16896
ds_read_b64_tr_b16 a[60:61], v41 offset:16392
ds_read_b64_tr_b16 a[62:63], v41 offset:16904
s_waitcnt lgkmcnt(6)
buffer_store_dwordx4 v[72:75], v0, s[4:7], s65 offen offset:1024
s_waitcnt lgkmcnt(4)
buffer_store_dwordx4 v[76:79], v0, s[4:7], s65 offen offset:3072
s_waitcnt vmcnt(12) lgkmcnt(0)
s_barrier
s_add_u32 m0, s36, 16384
s_add_u32 s33, s71, 262144
buffer_load_dwordx4 v32, s[76:79], s33 offen offset:0 lds
buffer_load_dwordx4 v33, s[76:79], s33 offen offset:1024 lds
buffer_load_dwordx4 v34, s[76:79], s33 offen offset:2048 lds
buffer_load_dwordx4 v35, s[76:79], s33 offen offset:3072 lds
ds_read_b64_tr_b16 a[8:9], v40 offset:32768
ds_read_b64_tr_b16 a[10:11], v40 offset:33280
ds_read_b64_tr_b16 a[16:17], v40 offset:32776
ds_read_b64_tr_b16 a[18:19], v40 offset:33288
ds_read_b64_tr_b16 a[64:65], v41 offset:32768
ds_read_b64_tr_b16 a[66:67], v41 offset:33280
ds_read_b64_tr_b16 a[72:73], v41 offset:32776
ds_read_b64_tr_b16 a[74:75], v41 offset:33288
s_waitcnt vmcnt(12) lgkmcnt(0)
s_barrier
s_add_u32 m0, s36, 32768
s_add_u32 s33, s71, 2097152
buffer_load_dwordx4 v32, s[76:79], s33 offen offset:0 lds
buffer_load_dwordx4 v33, s[76:79], s33 offen offset:1024 lds
buffer_load_dwordx4 v34, s[76:79], s33 offen offset:2048 lds
buffer_load_dwordx4 v35, s[76:79], s33 offen offset:3072 lds
ds_read_b64_tr_b16 a[12:13], v40 offset:49152
ds_read_b64_tr_b16 a[14:15], v40 offset:49664
ds_read_b64_tr_b16 a[20:21], v40 offset:49160
ds_read_b64_tr_b16 a[22:23], v40 offset:49672
ds_read_b64_tr_b16 a[68:69], v41 offset:49152
ds_read_b64_tr_b16 a[70:71], v41 offset:49664
ds_read_b64_tr_b16 a[76:77], v41 offset:49160
ds_read_b64_tr_b16 a[78:79], v41 offset:49672
s_waitcnt vmcnt(10) lgkmcnt(0)
s_barrier
s_add_u32 m0, s36, 49152
s_add_u32 s33, s71, 2359296
buffer_load_dwordx4 v32, s[76:79], s33 offen offset:0 lds
buffer_load_dwordx4 v33, s[76:79], s33 offen offset:1024 lds
buffer_load_dwordx4 v34, s[76:79], s33 offen offset:2048 lds
buffer_load_dwordx4 v35, s[76:79], s33 offen offset:3072 lds
ds_read_b64_tr_b16 v[72:73], v40 offset:0
ds_read_b64_tr_b16 v[74:75], v40 offset:512
ds_read_b64_tr_b16 a[80:81], v40 offset:8
ds_read_b64_tr_b16 a[82:83], v40 offset:520
ds_read_b64_tr_b16 v[80:81], v41 offset:0
ds_read_b64_tr_b16 v[82:83], v41 offset:512
ds_read_b64_tr_b16 a[104:105], v41 offset:8
ds_read_b64_tr_b16 a[106:107], v41 offset:520
s_waitcnt lgkmcnt(6)
ds_write_b128 v2, v[72:75] offset:4096
s_waitcnt lgkmcnt(3)
buffer_store_dwordx4 v[80:83], v0, s[4:7], s67 offen offset:0
s_waitcnt vmcnt(9) lgkmcnt(1)
s_barrier
s_add_u32 m0, s36, 0
s_add_u32 s33, s72, 0
buffer_load_dwordx4 v32, s[76:79], s33 offen offset:0 lds
buffer_load_dwordx4 v33, s[76:79], s33 offen offset:1024 lds
buffer_load_dwordx4 v34, s[76:79], s33 offen offset:2048 lds
buffer_load_dwordx4 v35, s[76:79], s33 offen offset:3072 lds
ds_read_b64_tr_b16 v[72:73], v40 offset:16384
ds_read_b64_tr_b16 v[74:75], v40 offset:16896
ds_read_b64_tr_b16 a[84:85], v40 offset:16392
ds_read_b64_tr_b16 a[86:87], v40 offset:16904
ds_read_b64_tr_b16 v[80:81], v41 offset:16384
ds_read_b64_tr_b16 v[82:83], v41 offset:16896
ds_read_b64_tr_b16 a[108:109], v41 offset:16392
ds_read_b64_tr_b16 a[110:111], v41 offset:16904
s_waitcnt lgkmcnt(6)
ds_write_b128 v2, v[72:75] offset:5120
s_waitcnt lgkmcnt(3)
buffer_store_dwordx4 v[80:83], v0, s[4:7], s67 offen offset:1024
s_waitcnt vmcnt(10) lgkmcnt(1)
s_barrier
s_add_u32 m0, s36, 16384
s_add_u32 s33, s72, 262144
buffer_load_dwordx4 v32, s[76:79], s33 offen offset:0 lds
buffer_load_dwordx4 v33, s[76:79], s33 offen offset:1024 lds
buffer_load_dwordx4 v34, s[76:79], s33 offen offset:2048 lds
buffer_load_dwordx4 v35, s[76:79], s33 offen offset:3072 lds
ds_read_b64_tr_b16 a[88:89], v40 offset:32768
ds_read_b64_tr_b16 a[90:91], v40 offset:33280
ds_read_b64_tr_b16 a[96:97], v40 offset:32776
ds_read_b64_tr_b16 a[98:99], v40 offset:33288
ds_read_b64_tr_b16 v[80:81], v41 offset:32768
ds_read_b64_tr_b16 v[82:83], v41 offset:33280
ds_read_b64_tr_b16 a[112:113], v41 offset:32776
ds_read_b64_tr_b16 a[114:115], v41 offset:33288
s_waitcnt lgkmcnt(2)
ds_write_b128 v2, v[80:83] offset:6144
s_waitcnt vmcnt(10) lgkmcnt(1)
s_barrier
s_add_u32 m0, s36, 32768
s_add_u32 s33, s73, 0
buffer_load_dwordx4 v36, s[88:91], s33 offen offset:0 lds
buffer_load_dwordx4 v37, s[88:91], s33 offen offset:1024 lds
buffer_load_dwordx4 v38, s[88:91], s33 offen offset:2048 lds
buffer_load_dwordx4 v39, s[88:91], s33 offen offset:3072 lds
ds_read_b64_tr_b16 a[92:93], v40 offset:49152
ds_read_b64_tr_b16 a[94:95], v40 offset:49664
ds_read_b64_tr_b16 a[100:101], v40 offset:49160
ds_read_b64_tr_b16 a[102:103], v40 offset:49672
ds_read_b64_tr_b16 v[80:81], v41 offset:49152
ds_read_b64_tr_b16 v[82:83], v41 offset:49664
ds_read_b64_tr_b16 a[116:117], v41 offset:49160
ds_read_b64_tr_b16 a[118:119], v41 offset:49672
s_waitcnt lgkmcnt(2)
ds_write_b128 v2, v[80:83] offset:7168
s_waitcnt vmcnt(9) lgkmcnt(1)
s_barrier
s_add_u32 m0, s36, 49152
s_add_u32 s33, s74, 0
buffer_load_dwordx4 v36, s[88:91], s33 offen offset:0 lds
buffer_load_dwordx4 v37, s[88:91], s33 offen offset:1024 lds
buffer_load_dwordx4 v38, s[88:91], s33 offen offset:2048 lds
buffer_load_dwordx4 v39, s[88:91], s33 offen offset:3072 lds
ds_read_b64_tr_b16 a[120:121], v40 offset:0
ds_read_b64_tr_b16 a[122:123], v40 offset:512
ds_read_b64_tr_b16 a[128:129], v40 offset:8
ds_read_b64_tr_b16 a[130:131], v40 offset:520
ds_read_b64_tr_b16 v[80:81], v41 offset:0
ds_read_b64_tr_b16 v[82:83], v41 offset:512
ds_read_b64_tr_b16 a[136:137], v41 offset:8
ds_read_b64_tr_b16 a[138:139], v41 offset:520
s_waitcnt lgkmcnt(2)
ds_write_b128 v2, v[80:83] offset:8192
s_waitcnt vmcnt(8) lgkmcnt(1)
s_barrier
s_add_u32 m0, s36, 0
s_add_u32 s33, s73, 256
buffer_load_dwordx4 v36, s[88:91], s33 offen offset:0 lds
buffer_load_dwordx4 v37, s[88:91], s33 offen offset:1024 lds
buffer_load_dwordx4 v38, s[88:91], s33 offen offset:2048 lds
buffer_load_dwordx4 v39, s[88:91], s33 offen offset:3072 lds
ds_read_b64_tr_b16 a[124:125], v40 offset:16384
ds_read_b64_tr_b16 a[126:127], v40 offset:16896
ds_read_b64_tr_b16 a[132:133], v40 offset:16392
ds_read_b64_tr_b16 a[134:135], v40 offset:16904
ds_read_b64_tr_b16 v[80:81], v41 offset:16384
ds_read_b64_tr_b16 v[82:83], v41 offset:16896
ds_read_b64_tr_b16 a[140:141], v41 offset:16392
ds_read_b64_tr_b16 a[142:143], v41 offset:16904
s_waitcnt lgkmcnt(2)
ds_write_b128 v2, v[80:83] offset:9216
s_waitcnt vmcnt(8) lgkmcnt(1)
s_barrier
s_add_u32 m0, s36, 16384
s_add_u32 s33, s74, 256
buffer_load_dwordx4 v36, s[88:91], s33 offen offset:0 lds
buffer_load_dwordx4 v37, s[88:91], s33 offen offset:1024 lds
buffer_load_dwordx4 v38, s[88:91], s33 offen offset:2048 lds
buffer_load_dwordx4 v39, s[88:91], s33 offen offset:3072 lds
ds_read_b64_tr_b16 v[72:73], v42 offset:32768
ds_read_b64_tr_b16 v[74:75], v42 offset:33024
ds_read_b64_tr_b16 v[76:77], v42 offset:34816
ds_read_b64_tr_b16 v[78:79], v42 offset:35072
ds_read_b64_tr_b16 v[8:9], v43 offset:32768
ds_read_b64_tr_b16 v[10:11], v43 offset:33024
ds_read_b64_tr_b16 v[12:13], v43 offset:34816
ds_read_b64_tr_b16 v[14:15], v43 offset:35072
s_waitcnt lgkmcnt(6)
buffer_store_dwordx4 v[72:75], v0, s[4:7], s68 offen offset:0
s_waitcnt lgkmcnt(4)
buffer_store_dwordx4 v[76:79], v0, s[4:7], s68 offen offset:1024
s_waitcnt vmcnt(10) lgkmcnt(0)
s_barrier
s_add_u32 m0, s36, 32768
s_add_u32 s33, s73, 512
buffer_load_dwordx4 v36, s[88:91], s33 offen offset:0 lds
buffer_load_dwordx4 v37, s[88:91], s33 offen offset:1024 lds
buffer_load_dwordx4 v38, s[88:91], s33 offen offset:2048 lds
buffer_load_dwordx4 v39, s[88:91], s33 offen offset:3072 lds
ds_read_b64_tr_b16 v[16:17], v42 offset:49152
ds_read_b64_tr_b16 v[18:19], v42 offset:49408
ds_read_b64_tr_b16 v[20:21], v42 offset:51200
ds_read_b64_tr_b16 v[22:23], v42 offset:51456
ds_read_b64_tr_b16 v[184:185], v43 offset:49152
ds_read_b64_tr_b16 v[186:187], v43 offset:49408
ds_read_b64_tr_b16 v[188:189], v43 offset:51200
ds_read_b64_tr_b16 v[190:191], v43 offset:51456
s_waitcnt vmcnt(10) lgkmcnt(0)
s_barrier
s_add_u32 m0, s36, 49152
s_add_u32 s33, s74, 512
buffer_load_dwordx4 v36, s[88:91], s33 offen offset:0 lds
buffer_load_dwordx4 v37, s[88:91], s33 offen offset:1024 lds
buffer_load_dwordx4 v38, s[88:91], s33 offen offset:2048 lds
buffer_load_dwordx4 v39, s[88:91], s33 offen offset:3072 lds
ds_read_b64_tr_b16 v[72:73], v42 offset:0
ds_read_b64_tr_b16 v[74:75], v42 offset:256
ds_read_b64_tr_b16 v[76:77], v42 offset:2048
ds_read_b64_tr_b16 v[78:79], v42 offset:2304
ds_read_b64_tr_b16 v[192:193], v43 offset:0
ds_read_b64_tr_b16 v[194:195], v43 offset:256
ds_read_b64_tr_b16 v[196:197], v43 offset:2048
ds_read_b64_tr_b16 v[198:199], v43 offset:2304
s_waitcnt lgkmcnt(6)
buffer_store_dwordx4 v[72:75], v0, s[4:7], s68 offen offset:2048
s_waitcnt lgkmcnt(4)
buffer_store_dwordx4 v[76:79], v0, s[4:7], s68 offen offset:3072
s_waitcnt vmcnt(12) lgkmcnt(0)
s_barrier
s_add_u32 m0, s36, 0
s_add_u32 s33, s73, 768
buffer_load_dwordx4 v36, s[88:91], s33 offen offset:0 lds
buffer_load_dwordx4 v37, s[88:91], s33 offen offset:1024 lds
buffer_load_dwordx4 v38, s[88:91], s33 offen offset:2048 lds
buffer_load_dwordx4 v39, s[88:91], s33 offen offset:3072 lds
ds_read_b64_tr_b16 v[24:25], v42 offset:16384
ds_read_b64_tr_b16 v[26:27], v42 offset:16640
ds_read_b64_tr_b16 v[28:29], v42 offset:18432
ds_read_b64_tr_b16 v[30:31], v42 offset:18688
ds_read_b64_tr_b16 v[200:201], v43 offset:16384
ds_read_b64_tr_b16 v[202:203], v43 offset:16640
ds_read_b64_tr_b16 v[204:205], v43 offset:18432
ds_read_b64_tr_b16 v[206:207], v43 offset:18688
s_waitcnt vmcnt(10) lgkmcnt(0)
s_barrier
s_add_u32 m0, s36, 16384
s_add_u32 s33, s74, 768
buffer_load_dwordx4 v36, s[88:91], s33 offen offset:0 lds
buffer_load_dwordx4 v37, s[88:91], s33 offen offset:1024 lds
buffer_load_dwordx4 v38, s[88:91], s33 offen offset:2048 lds
buffer_load_dwordx4 v39, s[88:91], s33 offen offset:3072 lds
ds_read_b64_tr_b16 v[168:169], v42 offset:32768
ds_read_b64_tr_b16 v[170:171], v42 offset:33024
ds_read_b64_tr_b16 v[172:173], v42 offset:34816
ds_read_b64_tr_b16 v[174:175], v42 offset:35072
ds_read_b64_tr_b16 v[48:49], v43 offset:32768
ds_read_b64_tr_b16 v[50:51], v43 offset:33024
ds_read_b64_tr_b16 v[52:53], v43 offset:34816
ds_read_b64_tr_b16 v[54:55], v43 offset:35072
s_waitcnt vmcnt(10) lgkmcnt(0)
s_barrier
s_add_u32 m0, s36, 32768
s_add_u32 s33, s73, 1024
buffer_load_dwordx4 v36, s[88:91], s33 offen offset:0 lds
buffer_load_dwordx4 v37, s[88:91], s33 offen offset:1024 lds
buffer_load_dwordx4 v38, s[88:91], s33 offen offset:2048 lds
buffer_load_dwordx4 v39, s[88:91], s33 offen offset:3072 lds
ds_read_b64_tr_b16 v[56:57], v42 offset:49152
ds_read_b64_tr_b16 v[58:59], v42 offset:49408
ds_read_b64_tr_b16 v[60:61], v42 offset:51200
ds_read_b64_tr_b16 v[62:63], v42 offset:51456
ds_read_b64_tr_b16 v[208:209], v43 offset:49152
ds_read_b64_tr_b16 v[210:211], v43 offset:49408
ds_read_b64_tr_b16 v[212:213], v43 offset:51200
ds_read_b64_tr_b16 v[214:215], v43 offset:51456
s_waitcnt vmcnt(8) lgkmcnt(0)
s_barrier
s_add_u32 m0, s36, 49152
s_add_u32 s33, s74, 1024
buffer_load_dwordx4 v36, s[88:91], s33 offen offset:0 lds
buffer_load_dwordx4 v37, s[88:91], s33 offen offset:1024 lds
buffer_load_dwordx4 v38, s[88:91], s33 offen offset:2048 lds
buffer_load_dwordx4 v39, s[88:91], s33 offen offset:3072 lds
ds_read_b64_tr_b16 v[176:177], v42 offset:0
ds_read_b64_tr_b16 v[178:179], v42 offset:256
ds_read_b64_tr_b16 v[180:181], v42 offset:2048
ds_read_b64_tr_b16 v[182:183], v42 offset:2304
ds_read_b64_tr_b16 v[216:217], v43 offset:0
ds_read_b64_tr_b16 v[218:219], v43 offset:256
ds_read_b64_tr_b16 v[220:221], v43 offset:2048
ds_read_b64_tr_b16 v[222:223], v43 offset:2304
s_waitcnt vmcnt(8) lgkmcnt(0)
s_barrier
ds_read_b64_tr_b16 v[64:65], v42 offset:16384
ds_read_b64_tr_b16 v[66:67], v42 offset:16640
ds_read_b64_tr_b16 v[68:69], v42 offset:18432
ds_read_b64_tr_b16 v[70:71], v42 offset:18688
ds_read_b64_tr_b16 v[224:225], v43 offset:16384
ds_read_b64_tr_b16 v[226:227], v43 offset:16640
ds_read_b64_tr_b16 v[228:229], v43 offset:18432
ds_read_b64_tr_b16 v[230:231], v43 offset:18688
s_waitcnt vmcnt(4) lgkmcnt(0)
s_barrier
ds_read_b64_tr_b16 v[72:73], v42 offset:32768
ds_read_b64_tr_b16 v[74:75], v42 offset:33024
ds_read_b64_tr_b16 v[76:77], v42 offset:34816
ds_read_b64_tr_b16 v[78:79], v42 offset:35072
ds_read_b64_tr_b16 v[232:233], v43 offset:32768
ds_read_b64_tr_b16 v[234:235], v43 offset:33024
ds_read_b64_tr_b16 v[236:237], v43 offset:34816
ds_read_b64_tr_b16 v[238:239], v43 offset:35072
s_waitcnt lgkmcnt(6)
buffer_store_dwordx4 v[72:75], v0, s[4:7], s69 offen offset:0
s_waitcnt lgkmcnt(4)
buffer_store_dwordx4 v[76:79], v0, s[4:7], s69 offen offset:1024
s_waitcnt vmcnt(2) lgkmcnt(0)
s_barrier
ds_read_b64_tr_b16 v[240:241], v42 offset:49152
ds_read_b64_tr_b16 v[242:243], v42 offset:49408
ds_read_b64_tr_b16 v[244:245], v42 offset:51200
ds_read_b64_tr_b16 v[246:247], v42 offset:51456
ds_read_b64_tr_b16 v[248:249], v43 offset:49152
ds_read_b64_tr_b16 v[250:251], v43 offset:49408
ds_read_b64_tr_b16 v[252:253], v43 offset:51200
ds_read_b64_tr_b16 v[254:255], v43 offset:51456
s_waitcnt lgkmcnt(0)
s_barrier
s_mul_i32 s33, s16, 12288
v_add_u32 v44, s33, v0
ds_write_b128 v44, v[8:11] offset:16384
ds_write_b128 v44, v[12:15] offset:17408
ds_write_b128 v44, v[16:19] offset:18432
ds_write_b128 v44, v[20:23] offset:19456
ds_write_b128 v44, v[24:27] offset:20480
ds_write_b128 v44, v[28:31] offset:21504
ds_write_b128 v44, v[48:51] offset:22528
ds_write_b128 v44, v[52:55] offset:23552
ds_write_b128 v44, v[56:59] offset:24576
ds_write_b128 v44, v[60:63] offset:25600
ds_write_b128 v44, v[64:67] offset:26624
ds_write_b128 v44, v[68:71] offset:27648
s_waitcnt vmcnt(0) lgkmcnt(0)
s_barrier
s_cmp_lg_u32 s16, 0
s_cbranch_scc1 cb_76
v_mov_b32 v44, 4
v_mov_b32 v45, 1
s_mov_b64 exec, 1
buffer_atomic_add v45, v44, s[8:11], 0 offen
s_mov_b32 s37, 0
cb_75:
buffer_load_dword v45, v44, s[8:11], 0 offen sc1
s_add_u32 s37, s37, 1
s_cmp_gt_u32 s37, 262144
s_cbranch_scc1 L_fail
s_waitcnt vmcnt(0)
v_cmp_gt_u32 vcc, 32, v45
s_cbranch_vccnz cb_75
s_mov_b64 exec, -1
cb_76:
s_barrier
s_mov_b32 s18, 0
s_mov_b32 s45, 0
s_cmp_eq_u32 s16, 1
s_cbranch_scc1 wave_78
s_cmp_eq_u32 s16, 2
s_cbranch_scc1 wave_79
s_cmp_eq_u32 s16, 3
s_cbranch_scc1 wave_80
wave_77:
layer_81:
s_lshl_b32 s17, s45, 6
s_mul_i32 s34, s45, 34603008
s_lshl_b32 s35, s15, 14
s_add_u32 s34, s34, s35
s_add_u32 s24, s34, 16777216
s_mul_i32 s34, s17, 10240
s_add_u32 s34, s34, s30
s_add_u32 s25, s34, s31
s_mov_b32 s19, 0
s_add_u32 s43, s17, 1
s_add_u32 s38, s17, 63
s_add_u32 s39, s17, 64
s_mov_b32 s34, s24
v_mov_b32 v7, 0
s_mov_b32 s20, 409600
s_mov_b32 s21, 413696
s_mov_b32 s22, 417792
buffer_load_dwordx4 v[64:67], v0, s[4:7], s65 offen offset:0 sc1
buffer_load_dwordx4 v[68:71], v0, s[4:7], s65 offen offset:1024 sc1
buffer_load_dwordx4 v[72:75], v0, s[4:7], s65 offen offset:2048 sc1
buffer_load_dwordx4 v[76:79], v0, s[4:7], s65 offen offset:3072 sc1
ds_read_b128 v[80:83], v2 offset:0
ds_read_b128 v[84:87], v2 offset:1024
buffer_load_dwordx4 v[48:51], v0, s[4:7], s66 offen offset:0 sc1
buffer_load_dwordx4 v[52:55], v0, s[4:7], s66 offen offset:1024 sc1
buffer_load_dwordx4 v[56:59], v0, s[4:7], s66 offen offset:2048 sc1
buffer_load_dwordx4 v[60:63], v0, s[4:7], s66 offen offset:3072 sc1
v_mov_b64 v[8:9], 0
v_mov_b64 v[10:11], 0
v_mov_b64 v[12:13], 0
v_mov_b64 v[14:15], 0
v_mov_b64 v[16:17], 0
v_mov_b64 v[18:19], 0
v_mov_b64 v[20:21], 0
v_mov_b64 v[22:23], 0
v_mov_b64 v[24:25], 0
v_mov_b64 v[26:27], 0
v_mov_b64 v[28:29], 0
v_mov_b64 v[30:31], 0
v_cmp_gt_u32 vcc, s43, v7
s_cmp_eq_u32 vcc_hi, 0
s_cbranch_scc1 kv_88
s_mov_b32 s37, 0
kv_87:
v_bfe_u32 v7, v0, 2, 3
buffer_load_dword v7, v7, s[4:7], s28 offen sc1
s_add_u32 s37, s37, 1
s_cmp_gt_u32 s37, 262144
s_cbranch_scc1 L_fail
s_waitcnt vmcnt(0)
v_cmp_gt_u32 vcc, s43, v7
s_cbranch_vccnz kv_87
kv_88:
s_barrier
v_bfe_u32 v7, v0, 2, 3
v_add_u32 v7, s28, v7
s_mov_b32 exec_hi, 0
v_and_b32 v7, 255, v0
v_lshl_add_u32 v7, v7, 3, s34
s_mov_b32 exec_hi, -1
s_mov_b32 s37, 0
gather_82:
buffer_load_dwordx4 v[32:35], v0, s[4:7], s20 offen sc1
buffer_load_dwordx4 v[36:39], v0, s[4:7], s21 offen sc1
buffer_load_dwordx4 v[40:43], v0, s[4:7], s22 offen sc1
s_add_u32 s37, s37, 1
s_cmp_gt_u32 s37, 262144
s_cbranch_scc1 L_fail
s_waitcnt vmcnt(2)
v_bitop3_b32 v44, v32, v34, s18 bitop3:0x7e
s_waitcnt vmcnt(1)
v_bitop3_b32 v45, v36, v38, s18 bitop3:0x7e
v_or_b32 v44, v44, v45
s_waitcnt vmcnt(0)
v_bitop3_b32 v46, v40, v42, s18 bitop3:0x7e
v_bitop3_b32 v44, v44, v46, s19 bitop3:0xa8
v_cmp_ne_u32 vcc, 0, v44
s_cbranch_vccnz gather_82
v_smfmac_f32_16x16x64_bf16 v[8:11], v[32:35], v[64:71], v1
ds_write_b128 v0, v[32:35] offset:0
buffer_load_dwordx4 v[64:67], v0, s[4:7], s67 offen offset:0 sc1
v_smfmac_f32_16x16x64_bf16 v[12:15], v[32:35], v[72:79], v1
ds_write_b128 v0, v[36:39] offset:4096
v_smfmac_f32_16x16x64_bf16 v[20:23], v[32:35], v[56:63], v1
buffer_load_dwordx4 v[68:71], v0, s[4:7], s67 offen offset:1024 sc1
s_waitcnt lgkmcnt(2)
v_smfmac_f32_16x16x64_bf16 v[24:27], v[32:35], v[80:87], v1
ds_write_b128 v0, v[40:43] offset:8192
v_smfmac_f32_16x16x64_bf16 v[8:11], v[36:39], a[8:15], v1
ds_read_b128 v[80:83], v2 offset:2048
buffer_load_dwordx4 v[72:75], v0, s[4:7], s67 offen offset:2048 sc1
v_smfmac_f32_16x16x64_bf16 v[16:19], v[32:35], v[48:55], v1
s_waitcnt lgkmcnt(1)
ds_read_b128 v[84:87], v2 offset:3072
buffer_load_dwordx4 v[76:79], v0, s[4:7], s67 offen offset:3072 sc1
v_smfmac_f32_16x16x64_bf16 v[16:19], v[36:39], a[24:31], v1
buffer_load_dwordx4 v[48:51], v0, s[4:7], s24 offen offset:0 nt sc1
buffer_load_dwordx4 v[52:55], v0, s[4:7], s24 offen offset:1024 nt sc1
v_smfmac_f32_16x16x64_bf16 v[28:31], v[32:35], a[0:7], v1
s_barrier
ds_read_b128 v[40:43], v0 offset:1024
v_smfmac_f32_16x16x64_bf16 v[28:31], v[36:39], a[40:47], v1
s_waitcnt lgkmcnt(1)
ds_read_b128 v[44:47], v0 offset:5120
ds_read_b128 v[32:35], v0 offset:2048
v_smfmac_f32_16x16x64_bf16 v[24:27], v[36:39], v[80:87], v1
v_smfmac_f32_16x16x64_bf16 v[12:15], v[36:39], a[16:23], v1
ds_read_b128 v[84:87], v2 offset:5120
ds_read_b128 v[80:83], v2 offset:4096
v_smfmac_f32_16x16x64_bf16 v[20:23], v[36:39], a[32:39], v1
ds_read_b128 v[36:39], v0 offset:6144
s_waitcnt lgkmcnt(5)
v_smfmac_f32_16x16x64_bf16 v[8:11], v[40:43], a[48:55], v1
buffer_load_dwordx4 v[56:59], v0, s[4:7], s24 offen offset:2048 nt sc1
v_smfmac_f32_16x16x64_bf16 v[12:15], v[40:43], a[56:63], v1
s_waitcnt lgkmcnt(4)
ds_read_b128 v[40:43], v0 offset:3072
s_xor_b32 s18, s18, 1
v_smfmac_f32_16x16x64_bf16 v[12:15], v[44:47], a[72:79], v1
s_waitcnt lgkmcnt(4)
buffer_load_dwordx4 v[60:63], v0, s[4:7], s24 offen offset:3072 nt sc1
v_smfmac_f32_16x16x64_bf16 v[8:11], v[44:47], a[64:71], v1
s_waitcnt lgkmcnt(3)
s_waitcnt lgkmcnt(2)
v_smfmac_f32_16x16x64_bf16 v[8:11], v[32:35], v[80:87], v1
s_waitcnt vmcnt(7)
ds_read_b128 v[84:87], v2 offset:7168
s_add_u32 s24, s24, 524288
v_smfmac_f32_16x16x64_bf16 v[12:15], v[32:35], a[80:87], v1
ds_read_b128 v[32:35], v0 offset:7168
s_waitcnt lgkmcnt(2)
v_smfmac_f32_16x16x64_bf16 v[8:11], v[36:39], a[88:95], v1
ds_read_b128 v[80:83], v2 offset:6144
v_smfmac_f32_16x16x64_bf16 v[12:15], v[36:39], a[96:103], v1
s_waitcnt vmcnt(6)
ds_read_b128 v[36:39], v0 offset:8192
v_smfmac_f32_16x16x64_bf16 v[8:11], v[40:43], v[64:71], v1
ds_read_b128 v[64:67], v2 offset:8192
ds_read_b128 v[68:71], v2 offset:9216
v_smfmac_f32_16x16x64_bf16 v[12:15], v[40:43], a[104:111], v1
ds_read_b128 v[40:43], v0 offset:9216
s_waitcnt lgkmcnt(5)
v_smfmac_f32_16x16x64_bf16 v[12:15], v[32:35], a[112:119], v1
s_waitcnt lgkmcnt(4)
buffer_load_dword v7, v7, s[4:7], 0 offen sc1
v_smfmac_f32_16x16x64_bf16 v[8:11], v[32:35], v[80:87], v1
s_waitcnt lgkmcnt(3)
ds_read_b128 v[32:35], v0 offset:1024
ds_read_b128 v[84:87], v2 offset:11264
v_smfmac_f32_16x16x64_bf16 v[8:11], v[36:39], a[120:127], v1
ds_read_b128 v[80:83], v2 offset:10240
v_smfmac_f32_16x16x64_bf16 v[12:15], v[36:39], a[128:135], v1
s_waitcnt lgkmcnt(4)
ds_read_b128 v[36:39], v0 offset:5120
s_waitcnt lgkmcnt(4)
v_smfmac_f32_16x16x64_bf16 v[8:11], v[40:43], v[64:71], v1
s_waitcnt vmcnt(5)
ds_read_b128 v[64:67], v2 offset:12288
ds_read_b128 v[68:71], v2 offset:13312
v_smfmac_f32_16x16x64_bf16 v[12:15], v[40:43], a[136:143], v1
s_waitcnt lgkmcnt(5)
ds_read_b128 v[40:43], v0 offset:2048
v_smfmac_f32_16x16x64_bf16 v[16:19], v[32:35], v[72:79], v1
s_nop 0
ds_read_b128 v[72:75], v2 offset:14336
v_add_f32 v9, v9, v11
v_add_f32 v8, v8, v10
s_nop 0
v_add_f32 v13, v13, v15
v_add_f32 v12, v12, v14
v_mul_f32 v9, s44, v9
s_waitcnt lgkmcnt(4)
v_mul_f32 v8, s44, v8
v_mul_f32 v12, s44, v12
v_mul_f32 v13, s44, v13
v_cvt_pk_bf16_f32 v12, v12, v13
v_cvt_pk_bf16_f32 v8, v8, v9
v_smfmac_f32_16x16x64_bf16 v[20:23], v[32:35], v[80:87], v1
s_add_u32 s17, s17, 1
ds_read_b128 v[32:35], v0 offset:6144
ds_write2_b32 v3, v8, v12 offset0:0 offset1:128
v_smfmac_f32_16x16x64_bf16 v[16:19], v[36:39], a[144:151], v1
ds_read_b128 v[80:83], v2 offset:16384
v_smfmac_f32_16x16x64_bf16 v[20:23], v[36:39], a[152:159], v1
ds_read_b128 v[36:39], v0 offset:3072
ds_read_b128 v[76:79], v2 offset:15360
s_waitcnt vmcnt(3)
s_waitcnt lgkmcnt(4)
v_smfmac_f32_16x16x64_bf16 v[16:19], v[40:43], a[160:167], v1
ds_read_b128 v[84:87], v2 offset:17408
v_smfmac_f32_16x16x64_bf16 v[20:23], v[40:43], v[64:71], v1
s_waitcnt lgkmcnt(4)
ds_read_b128 v[40:43], v0 offset:7168
ds_read_b128 v[64:67], v2 offset:18432
v_smfmac_f32_16x16x64_bf16 v[16:19], v[32:35], a[168:175], v1
s_barrier
v_smfmac_f32_16x16x64_bf16 v[20:23], v[32:35], a[176:183], v1
s_waitcnt lgkmcnt(3)
ds_read_b128 v[32:35], v0 offset:8192
ds_read_b64_tr_b16 v[12:13], v4 offset:1024
v_smfmac_f32_16x16x64_bf16 v[16:19], v[36:39], a[184:191], v1
ds_read_b64_tr_b16 v[10:11], v4 offset:512
v_smfmac_f32_16x16x64_bf16 v[20:23], v[36:39], v[72:79], v1
s_waitcnt lgkmcnt(4)
ds_read_b128 v[36:39], v0 offset:9216
ds_read_b64_tr_b16 v[8:9], v4 offset:0
v_smfmac_f32_16x16x64_bf16 v[16:19], v[40:43], a[192:199], v1
ds_read_b64_tr_b16 v[14:15], v4 offset:1536
ds_read_b128 v[76:79], v2 offset:21504
v_smfmac_f32_16x16x64_bf16 v[20:23], v[40:43], a[200:207], v1
ds_read_b128 v[40:43], v0 offset:1024
s_waitcnt lgkmcnt(7)
v_smfmac_f32_16x16x64_bf16 v[20:23], v[32:35], v[80:87], v1
ds_read_b128 v[68:71], v2 offset:19456
ds_read_b128 v[84:87], v2 offset:23552
v_smfmac_f32_16x16x64_bf16 v[16:19], v[32:35], a[208:215], v1
s_waitcnt lgkmcnt(6)
ds_read_b128 v[72:75], v2 offset:20480
v_smfmac_f32_16x16x64_bf16 v[20:23], v[36:39], a[224:231], v1
s_waitcnt lgkmcnt(6)
ds_read_b128 v[32:35], v0 offset:5120
ds_read_b128 v[80:83], v2 offset:22528
v_smfmac_f32_16x16x64_bf16 v[16:19], v[36:39], a[216:223], v1
ds_read_b128 v[36:39], v0 offset:2048
s_waitcnt lgkmcnt(7)
v_mfma_f32_16x16x32_bf16 v[44:47], v[48:51], v[8:11], 0
s_nop 0
v_add_f32 v20, v20, v22
v_add_f32 v21, v21, v23
v_mfma_f32_16x16x32_bf16 v[44:47], v[52:55], v[12:15], v[44:47]
s_nop 0
v_add_f32 v17, v17, v19
v_add_f32 v16, v16, v18
s_waitcnt lgkmcnt(5)
v_cvt_pk_bf16_f32 v20, v20, v21
v_smfmac_f32_16x16x64_bf16 v[28:31], v[40:43], a[232:239], v1
s_mov_b64 exec, s[54:55]
s_nop 0
ds_write_b128 v5, v[44:47] offset:0
s_mov_b64 exec, -1
v_smfmac_f32_16x16x64_bf16 v[24:27], v[40:43], v[64:71], v1
s_waitcnt lgkmcnt(3)
ds_read_b128 v[40:43], v0 offset:6144
v_cvt_pk_bf16_f32 v16, v16, v17
v_smfmac_f32_16x16x64_bf16 v[24:27], v[32:35], a[240:247], v1
ds_write2_b32 v3, v16, v20 offset0:1 offset1:129
v_smfmac_f32_16x16x64_bf16 v[28:31], v[32:35], v[72:79], v1
s_waitcnt lgkmcnt(3)
ds_read_b128 v[32:35], v0 offset:3072
buffer_load_dwordx4 v[64:67], v0, s[4:7], s68 offen offset:0 sc1
v_smfmac_f32_16x16x64_bf16 v[24:27], v[36:39], a[248:255], v1
buffer_load_dwordx4 v[68:71], v0, s[4:7], s68 offen offset:1024 sc1
v_smfmac_f32_16x16x64_bf16 v[28:31], v[36:39], v[88:95], v1
ds_read_b128 v[36:39], v0 offset:7168
s_waitcnt lgkmcnt(3)
v_smfmac_f32_16x16x64_bf16 v[24:27], v[40:43], v[96:103], v1
s_mov_b32 s20, 393216
buffer_load_dwordx4 v[72:75], v0, s[4:7], s68 offen offset:2048 sc1
v_smfmac_f32_16x16x64_bf16 v[28:31], v[40:43], v[80:87], v1
s_waitcnt lgkmcnt(2)
ds_read_b128 v[40:43], v0 offset:8192
s_waitcnt lgkmcnt(2)
v_smfmac_f32_16x16x64_bf16 v[28:31], v[32:35], v[112:119], v1
s_barrier
ds_read_b128 v[52:55], v6 offset:1024
v_smfmac_f32_16x16x64_bf16 v[24:27], v[32:35], v[104:111], v1
s_waitcnt lgkmcnt(2)
ds_read_b128 v[32:35], v0 offset:9216
ds_read_b128 v[48:51], v6 offset:0
v_smfmac_f32_16x16x64_bf16 v[24:27], v[36:39], v[120:127], v1
ds_read_b64_tr_b16 v[8:9], v4 offset:0
ds_read_b64_tr_b16 v[10:11], v4 offset:512
v_smfmac_f32_16x16x64_bf16 v[28:31], v[36:39], v[128:135], v1
s_waitcnt lgkmcnt(5)
buffer_load_dwordx4 v[76:79], v0, s[4:7], s68 offen offset:3072 sc1
v_smfmac_f32_16x16x64_bf16 v[28:31], v[40:43], v[144:151], v1
buffer_load_dwordx4 v[80:83], v0, s[4:7], s69 offen offset:0 sc1
ds_read_b64_tr_b16 v[20:21], v4 offset:3072
ds_read_b64_tr_b16 v[18:19], v4 offset:2560
v_smfmac_f32_16x16x64_bf16 v[24:27], v[40:43], v[136:143], v1
s_waitcnt lgkmcnt(5)
ds_read_b64_tr_b16 v[12:13], v4 offset:1024
ds_read_b64_tr_b16 v[14:15], v4 offset:1536
v_smfmac_f32_16x16x64_bf16 v[28:31], v[32:35], v[160:167], v1
s_waitcnt lgkmcnt(6)
ds_read_b64_tr_b16 v[16:17], v4 offset:2048
v_add_f32 v48, v48, v52
v_smfmac_f32_16x16x64_bf16 v[24:27], v[32:35], v[152:159], v1
s_waitcnt lgkmcnt(5)
ds_read_b64_tr_b16 v[22:23], v4 offset:3584
v_add_f32 v51, v51, v55
v_exp_f32 v48, v48
v_add_f32 v50, v50, v54
v_exp_f32 v51, v51
v_exp_f32 v50, v50
v_mfma_f32_16x16x32_bf16 v[44:47], v[8:11], v[8:11], 0
s_waitcnt lgkmcnt(1)
v_cvt_pk_bf16_f32 v55, v50, v51
v_add_f32 v49, v49, v53
v_mfma_f32_16x16x32_bf16 v[44:47], v[12:15], v[12:15], v[44:47]
s_waitcnt vmcnt(6)
v_exp_f32 v49, v49
v_mfma_f32_16x16x32_bf16 v[44:47], v[16:19], v[16:19], v[44:47]
s_waitcnt lgkmcnt(0)
v_cvt_pk_bf16_f32 v54, v48, v49
v_mov_b32_dpp v51, v55 quad_perm:[2,3,2,3] row_mask:0xf bank_mask:0xf
v_mfma_f32_16x16x32_bf16 v[44:47], v[20:23], v[20:23], v[44:47]
v_mov_b32_dpp v50, v54 quad_perm:[2,3,2,3] row_mask:0xf bank_mask:0xf
v_mov_b32_dpp v48, v54 quad_perm:[0,1,0,1] row_mask:0xf bank_mask:0xf
v_mov_b32_dpp v49, v55 quad_perm:[0,1,0,1] row_mask:0xf bank_mask:0xf
v_mov_b64 v[22:23], s[56:57]
v_mov_b64 v[54:55], s[58:59]
v_mfma_f32_16x16x32_bf16 v[12:15], v[60:63], v[48:51], 0
s_nop 0
v_mov_b64 v[20:21], s[56:57]
v_exp_f32_dpp v44, v46 quad_perm:[0,1,0,1] row_mask:0xf bank_mask:0xf
v_mfma_f32_16x16x32_bf16 v[8:11], v[56:59], v[48:51], 0
v_exp_f32_dpp v45, v47 quad_perm:[0,1,0,1] row_mask:0xf bank_mask:0xf
v_mfma_f32_16x16x32_bf16 v[16:19], v[20:23], v[48:51], 0
s_nop 0
v_cvt_pk_bf16_f32 v53, v44, v45
v_cvt_pk_bf16_f32 v24, v24, v25
v_cvt_pk_bf16_f32 v52, v44, v45
v_cvt_pk_bf16_f32 v25, v26, v27
v_mov_b64 v[38:39], 0
v_mfma_f32_16x16x16_bf16 v[16:19], v[54:55], v[52:53], v[16:19]
s_nop 0
v_cvt_pk_bf16_f32 v27, v30, v31
v_cvt_pk_bf16_f32 v26, v28, v29
v_mfma_f32_16x16x16_bf16 v[8:11], v[24:25], v[52:53], v[8:11]
s_nop 0
buffer_load_dwordx4 v[84:87], v0, s[4:7], s69 offen offset:1024 sc1
v_mfma_f32_16x16x16_bf16 v[12:15], v[26:27], v[52:53], v[12:15]
s_barrier
v_rcp_f32 v18, v16
v_subrev_u32 v17, s46, v16
v_mov_b64 v[40:41], 0
v_mov_b64 v[34:35], 0
v_mul_f32 v8, v8, v18
v_mul_f32 v9, v9, v18
v_cvt_pk_bf16_f32 v8, v8, v9
v_mul_f32 v10, v10, v18
v_mul_f32 v13, v13, v18
v_mul_f32 v11, v11, v18
v_cvt_pk_bf16_f32 v9, v10, v11
v_mul_f32 v12, v12, v18
v_cmp_lt_u32 vcc, s47, v17
v_mul_f32 v14, v14, v18
v_mul_f32 v15, v15, v18
v_cvt_pk_bf16_f32 v11, v14, v15
v_mov_b64 v[32:33], 0
s_waitcnt vmcnt(4)
v_cvt_pk_bf16_f32 v10, v12, v13
s_cbranch_vccnz rare_83
back_84:
s_mov_b64 exec, s[54:55]
ds_write_b128 v5, v[8:11] offset:0
s_mov_b64 exec, -1
v_mov_b64 v[48:49], 0
v_mov_b64 v[50:51], 0
v_smfmac_f32_16x16x64_bf16 v[32:35], v[8:11], v[64:71], v1
s_add_u32 s25, s25, 10240
ds_read_b128 v[16:19], v0 offset:16384
v_mov_b64 v[36:37], 0
v_mov_b64 v[42:43], 0
v_smfmac_f32_16x16x64_bf16 v[48:51], v[8:11], v[176:183], v1
ds_read_b128 v[28:31], v0 offset:19456
buffer_load_dwordx4 v[64:67], v0, s[4:7], s65 offen offset:0 sc1
ds_read_b128 v[24:27], v0 offset:18432
v_smfmac_f32_16x16x64_bf16 v[40:43], v[8:11], v[168:175], v1
ds_read_b128 v[20:23], v0 offset:17408
s_add_u32 s43, s17, 2
s_waitcnt lgkmcnt(4)
s_barrier
ds_read_b128 v[56:59], v5 offset:512
buffer_load_dwordx4 v[68:71], v0, s[4:7], s65 offen offset:1024 sc1
s_waitcnt vmcnt(4)
ds_read_b128 v[12:15], v5 offset:1536
v_smfmac_f32_16x16x64_bf16 v[36:39], v[8:11], v[72:79], v1
s_waitcnt lgkmcnt(5)
ds_read_b128 v[60:63], v5 offset:1024
v_mov_b64 v[54:55], 0
s_waitcnt lgkmcnt(3)
s_mov_b32 s37, 0
s_mov_b32 s19, 1
buffer_load_dwordx4 v[72:75], v0, s[4:7], s65 offen offset:2048 sc1
v_bfe_u32 v45, v0, 1, 7
v_mov_b64 v[52:53], 0
s_waitcnt lgkmcnt(2)
v_smfmac_f32_16x16x64_bf16 v[32:35], v[56:59], v[16:23], v1
buffer_load_dwordx4 v[76:79], v0, s[4:7], s65 offen offset:3072 sc1
ds_read_b128 v[16:19], v0 offset:22528
v_smfmac_f32_16x16x64_bf16 v[48:51], v[56:59], v[216:223], v1
s_waitcnt lgkmcnt(2)
ds_read_b128 v[20:23], v0 offset:23552
v_lshrrev_b32 v44, 8, v0
s_waitcnt vmcnt(5)
s_waitcnt vmcnt(4)
v_smfmac_f32_16x16x64_bf16 v[52:55], v[8:11], v[80:87], v1
s_waitcnt lgkmcnt(2)
ds_read_b128 v[84:87], v0 offset:21504
s_mov_b32 s21, 397312
v_smfmac_f32_16x16x64_bf16 v[32:35], v[60:63], v[24:31], v1
ds_read_b128 v[80:83], v0 offset:20480
s_min_u32 s43, s43, s39
v_smfmac_f32_16x16x64_bf16 v[32:35], v[12:15], v[184:191], v1
s_waitcnt lgkmcnt(3)
ds_read_b128 v[24:27], v0 offset:24576
s_waitcnt lgkmcnt(3)
v_smfmac_f32_16x16x64_bf16 v[40:43], v[56:59], v[16:23], v1
ds_read_b128 v[28:31], v0 offset:25600
v_lshl_or_b32 v44, v44, 12, v45
v_smfmac_f32_16x16x64_bf16 v[36:39], v[56:59], v[192:199], v1
s_waitcnt lgkmcnt(3)
v_cvt_pk_bf16_f32 v32, v32, v33
v_cvt_pk_bf16_f32 v33, v34, v35
v_and_or_b32 v32, v32, -2, s18
s_waitcnt lgkmcnt(2)
v_smfmac_f32_16x16x64_bf16 v[36:39], v[60:63], v[80:87], v1
buffer_store_dwordx2 v[32:33], v44, s[4:7], s60 offen
v_smfmac_f32_16x16x64_bf16 v[36:39], v[12:15], v[200:207], v1
s_waitcnt lgkmcnt(1)
s_waitcnt lgkmcnt(0)
ds_read_b128 v[80:83], v0 offset:26624
v_smfmac_f32_16x16x64_bf16 v[40:43], v[60:63], v[24:31], v1
s_nop 0
ds_read_b128 v[84:87], v0 offset:27648
s_add_u32 s34, s24, 524288
s_nop 0
v_cvt_pk_bf16_f32 v36, v36, v37
v_and_or_b32 v36, v36, -2, s18
v_cvt_pk_bf16_f32 v37, v38, v39
v_smfmac_f32_16x16x64_bf16 v[40:43], v[12:15], v[208:215], v1
buffer_store_dwordx2 v[36:37], v44, s[4:7], s61 offen
v_smfmac_f32_16x16x64_bf16 v[52:55], v[56:59], v[232:239], v1
s_nop 2
v_smfmac_f32_16x16x64_bf16 v[52:55], v[60:63], v[240:247], v1
s_nop 0
s_waitcnt lgkmcnt(0)
v_cvt_pk_bf16_f32 v40, v40, v41
v_cvt_pk_bf16_f32 v41, v42, v43
v_and_or_b32 v40, v40, -2, s18
v_smfmac_f32_16x16x64_bf16 v[48:51], v[60:63], v[80:87], v1
s_mov_b32 s22, 401408
buffer_store_dwordx2 v[40:41], v44, s[4:7], s62 offen
v_smfmac_f32_16x16x64_bf16 v[48:51], v[12:15], v[224:231], v1
s_nop 2
v_smfmac_f32_16x16x64_bf16 v[52:55], v[12:15], v[248:255], v1
s_nop 3
v_cvt_pk_bf16_f32 v48, v48, v49
v_and_or_b32 v48, v48, -2, s18
v_cvt_pk_bf16_f32 v49, v50, v51
buffer_store_dwordx2 v[48:49], v44, s[4:7], s63 offen
v_cvt_pk_bf16_f32 v52, v52, v53
v_cvt_pk_bf16_f32 v53, v54, v55
v_and_or_b32 v52, v52, -2, s18
buffer_store_dwordx2 v[52:53], v44, s[4:7], s64 offen
v_bfe_u32 v34, v0, 6, 1
v_lshlrev_b32 v34, 4, v34
v_mov_b32 v35, 0x3f80
v_lshlrev_b32 v34, v34, v35
v_bfe_i32 v35, v0, 4, 1
v_and_b32 v45, v34, v35
v_and_b32 v47, v34, v35
v_xor_b32 v44, v34, v45
v_xor_b32 v46, v34, v45
v_and_b32 v36, 32, v0
v_bfe_u32 v37, v0, 6, 1
v_lshl_add_u32 v36, v37, 8, v36
v_bfe_u32 v37, v0, 8, 1
v_lshl_add_u32 v36, v37, 4, v36
v_bfe_u32 v37, v0, 4, 1
v_lshl_add_u32 v36, v37, 3, v36
ds_read_b128 v[80:83], v2 offset:0
ds_read_b128 v[84:87], v2 offset:1024
v_mov_b64 v[24:25], 0
v_mov_b64 v[26:27], 0
v_mov_b64 v[28:29], 0
v_mov_b64 v[30:31], 0
v_bfe_u32 v7, v0, 2, 3
v_add_u32 v7, s28, v7
s_mov_b32 exec_hi, 0
v_and_b32 v7, 255, v0
v_lshl_add_u32 v7, v7, 3, s34
s_mov_b32 exec_hi, -1
s_nop 15
s_nop 15
s_nop 14
buffer_load_dwordx4 v[8:11], v0, s[4:7], s27 offen offset:0 sc1
buffer_load_dwordx4 v[12:15], v0, s[4:7], s27 offen offset:1024 sc1
buffer_load_dwordx4 v[16:19], v0, s[4:7], s27 offen offset:2048 sc1
buffer_load_dwordx4 v[20:23], v0, s[4:7], s27 offen offset:3072 sc1
s_barrier
buffer_load_dwordx4 v[48:51], v0, s[4:7], s66 offen offset:0 sc1
buffer_load_dwordx4 v[52:55], v0, s[4:7], s66 offen offset:1024 sc1
buffer_load_dwordx4 v[56:59], v0, s[4:7], s66 offen offset:2048 sc1
buffer_load_dwordx4 v[60:63], v0, s[4:7], s66 offen offset:3072 sc1
v_mov_b64 v[40:41], 0
v_mov_b64 v[42:43], 0
s_waitcnt vmcnt(6)
s_nop 0
v_smfmac_f32_16x16x64_bf16 v[40:43], v[44:47], v[8:15], v1
v_bitop3_b32 v34, v8, v10, s18 bitop3:0x7e
v_bitop3_b32 v35, v12, v14, s18 bitop3:0x7e
s_waitcnt vmcnt(4)
v_smfmac_f32_16x16x64_bf16 v[40:43], v[44:47], v[16:23], v1
v_bitop3_b32 v32, v16, v18, s18 bitop3:0x7e
v_bitop3_b32 v33, v20, v22, s18 bitop3:0x7e
v_or3_b32 v34, v34, v35, v32
v_bitop3_b32 v34, v34, v33, 1 bitop3:0xa8
v_cmp_ne_u32 vcc, 0, v34
s_cbranch_vccnz red_89
red_89_ok:
s_nop 1
v_add_f32_dpp v40, v40, v40 row_ror:8 row_mask:0xf bank_mask:0xf
v_add_f32_dpp v41, v41, v41 row_ror:8 row_mask:0xf bank_mask:0xf
v_add_f32_dpp v42, v42, v42 row_ror:8 row_mask:0xf bank_mask:0xf
v_add_f32_dpp v43, v43, v43 row_ror:8 row_mask:0xf bank_mask:0xf
v_cvt_pk_bf16_f32 v40, v40, v41
v_cvt_pk_bf16_f32 v41, v42, v43
v_and_or_b32 v40, v40, -2, s18
s_mov_b64 exec, 0x00ff00ff
buffer_store_dwordx2 v[40:41], v36, s[4:7], s40 offen
s_mov_b64 exec, -1
g2_91:
v_mov_b64 v[8:9], 0
v_mov_b64 v[10:11], 0
v_mov_b64 v[12:13], 0
v_mov_b64 v[14:15], 0
v_mov_b64 v[16:17], 0
v_mov_b64 v[18:19], 0
v_mov_b64 v[20:21], 0
v_mov_b64 v[22:23], 0
s_mov_b32 s37, 0
s_cmp_eq_u32 s17, s38
s_barrier
s_nop 15
s_nop 7
s_cbranch_scc0 gather_82
s_branch exit_85
red_89:
buffer_load_dwordx4 v[8:11], v0, s[4:7], s27 offen offset:0 sc1
buffer_load_dwordx4 v[12:15], v0, s[4:7], s27 offen offset:1024 sc1
buffer_load_dwordx4 v[16:19], v0, s[4:7], s27 offen offset:2048 sc1
buffer_load_dwordx4 v[20:23], v0, s[4:7], s27 offen offset:3072 sc1
s_add_u32 s37, s37, 1
s_cmp_gt_u32 s37, 262144
s_cbranch_scc1 L_fail
v_mov_b64 v[40:41], 0
v_mov_b64 v[42:43], 0
s_waitcnt vmcnt(2)
s_nop 0
v_smfmac_f32_16x16x64_bf16 v[40:43], v[44:47], v[8:15], v1
v_bitop3_b32 v34, v8, v10, s18 bitop3:0x7e
v_bitop3_b32 v35, v12, v14, s18 bitop3:0x7e
s_waitcnt vmcnt(0)
v_smfmac_f32_16x16x64_bf16 v[40:43], v[44:47], v[16:23], v1
v_bitop3_b32 v32, v16, v18, s18 bitop3:0x7e
v_bitop3_b32 v33, v20, v22, s18 bitop3:0x7e
v_or3_b32 v34, v34, v35, v32
v_bitop3_b32 v34, v34, v33, 1 bitop3:0xa8
v_cmp_ne_u32 vcc, 0, v34
s_cbranch_vccnz red_89
s_branch red_89_ok
rare_83:
ds_read_b128 v[48:51], v6 offset:0
ds_read_b128 v[52:55], v6 offset:1024
s_waitcnt lgkmcnt(0)
s_barrier
v_add_f32 v48, v48, v52
v_add_f32 v49, v49, v53
v_add_f32 v50, v50, v54
v_add_f32 v51, v51, v55
v_mov_b32_dpp v46, v46 quad_perm:[0,1,0,1] row_mask:0xf bank_mask:0xf
v_mov_b32_dpp v47, v47 quad_perm:[0,1,0,1] row_mask:0xf bank_mask:0xf
v_max3_f32 v19, v48, v49, v50
v_max3_f32 v19, v19, v51, v46
v_max_f32 v19, v19, v47
s_nop 1
v_max_f32_dpp v19, v19, v19 quad_perm:[2,3,0,1] row_mask:0xf bank_mask:0xf
v_mov_b32 v44, v19
s_nop 1
v_permlane32_swap_b32 v19, v44
v_max_f32 v19, v19, v44
v_mov_b32 v44, v19
s_nop 1
v_permlane16_swap_b32 v19, v44
v_max_f32 v19, v19, v44
v_sub_f32 v48, v48, v19
v_sub_f32 v49, v49, v19
v_sub_f32 v50, v50, v19
v_sub_f32 v51, v51, v19
v_sub_f32 v46, v46, v19
v_sub_f32 v47, v47, v19
v_exp_f32 v48, v48
v_exp_f32 v49, v49
v_exp_f32 v50, v50
v_exp_f32 v51, v51
v_cvt_pk_bf16_f32 v54, v48, v49
v_cvt_pk_bf16_f32 v55, v50, v51
s_nop 0
v_mov_b32_dpp v48, v54 quad_perm:[0,1,0,1] row_mask:0xf bank_mask:0xf
v_mov_b32_dpp v49, v55 quad_perm:[0,1,0,1] row_mask:0xf bank_mask:0xf
v_mov_b32_dpp v50, v54 quad_perm:[2,3,2,3] row_mask:0xf bank_mask:0xf
v_mov_b32_dpp v51, v55 quad_perm:[2,3,2,3] row_mask:0xf bank_mask:0xf
v_mov_b64 v[20:21], s[56:57]
v_mov_b64 v[22:23], s[56:57]
v_mfma_f32_16x16x32_bf16 v[8:11], v[56:59], v[48:51], 0
v_mfma_f32_16x16x32_bf16 v[12:15], v[60:63], v[48:51], 0
v_mfma_f32_16x16x32_bf16 v[16:19], v[20:23], v[48:51], 0
v_mov_b64 v[54:55], s[58:59]
v_exp_f32_dpp v44, v46 quad_perm:[0,1,0,1] row_mask:0xf bank_mask:0xf
v_exp_f32_dpp v45, v47 quad_perm:[0,1,0,1] row_mask:0xf bank_mask:0xf
s_nop 0
v_cvt_pk_bf16_f32 v52, v44, v45
v_cvt_pk_bf16_f32 v53, v44, v45
s_nop 1
v_mfma_f32_16x16x16_bf16 v[16:19], v[54:55], v[52:53], v[16:19]
v_mfma_f32_16x16x16_bf16 v[8:11], v[24:25], v[52:53], v[8:11]
v_mfma_f32_16x16x16_bf16 v[12:15], v[26:27], v[52:53], v[12:15]
s_nop 5
v_rcp_f32 v18, v16
s_nop 0
v_mul_f32 v8, v8, v18
v_mul_f32 v9, v9, v18
v_mul_f32 v10, v10, v18
v_mul_f32 v11, v11, v18
v_mul_f32 v12, v12, v18
v_mul_f32 v13, v13, v18
v_mul_f32 v14, v14, v18
v_mul_f32 v15, v15, v18
v_cvt_pk_bf16_f32 v8, v8, v9
v_cvt_pk_bf16_f32 v9, v10, v11
v_cvt_pk_bf16_f32 v10, v12, v13
v_cvt_pk_bf16_f32 v11, v14, v15
s_branch back_84
exit_85:
buffer_load_dwordx4 v[32:35], v0, s[4:7], s20 offen sc1
buffer_load_dwordx4 v[36:39], v0, s[4:7], s21 offen sc1
buffer_load_dwordx4 v[40:43], v0, s[4:7], s22 offen sc1
s_add_u32 s37, s37, 1
s_cmp_gt_u32 s37, 262144
s_cbranch_scc1 L_fail
s_waitcnt vmcnt(2)
v_bitop3_b32 v44, v32, v34, s18 bitop3:0x7e
s_waitcnt vmcnt(1)
v_bitop3_b32 v45, v36, v38, s18 bitop3:0x7e
v_or_b32 v44, v44, v45
s_waitcnt vmcnt(0)
v_bitop3_b32 v46, v40, v42, s18 bitop3:0x7e
v_bitop3_b32 v44, v44, v46, s19 bitop3:0xa8
v_cmp_ne_u32 vcc, 0, v44
s_cbranch_vccnz exit_85
ds_write_b128 v0, v[32:35] offset:0
ds_write_b128 v0, v[36:39] offset:4096
ds_write_b128 v0, v[40:43] offset:8192
s_waitcnt lgkmcnt(0)
s_barrier
s_barrier
s_add_u32 s45, s45, 1
s_cmp_lt_u32 s45, 2
s_cbranch_scc1 layer_81
s_endpgm
wave_78:
layer_94:
s_lshl_b32 s17, s45, 6
s_mul_i32 s34, s45, 34603008
s_lshl_b32 s35, s15, 14
s_add_u32 s34, s34, s35
s_add_u32 s24, s34, 16781312
s_mul_i32 s34, s17, 10240
s_add_u32 s34, s34, s30
s_add_u32 s25, s34, s31
s_mov_b32 s19, 0
s_add_u32 s43, s17, 1
s_add_u32 s38, s17, 63
s_add_u32 s39, s17, 64
s_mov_b32 s34, s24
v_mov_b32 v7, 0
s_mov_b32 s20, 410624
s_mov_b32 s21, 414720
s_mov_b32 s22, 418816
buffer_load_dwordx4 v[64:67], v0, s[4:7], s65 offen offset:0 sc1
buffer_load_dwordx4 v[68:71], v0, s[4:7], s65 offen offset:1024 sc1
buffer_load_dwordx4 v[72:75], v0, s[4:7], s65 offen offset:2048 sc1
buffer_load_dwordx4 v[76:79], v0, s[4:7], s65 offen offset:3072 sc1
ds_read_b128 v[80:83], v2 offset:0
ds_read_b128 v[84:87], v2 offset:1024
buffer_load_dwordx4 v[48:51], v0, s[4:7], s66 offen offset:0 sc1
buffer_load_dwordx4 v[52:55], v0, s[4:7], s66 offen offset:1024 sc1
buffer_load_dwordx4 v[56:59], v0, s[4:7], s66 offen offset:2048 sc1
buffer_load_dwordx4 v[60:63], v0, s[4:7], s66 offen offset:3072 sc1
v_mov_b64 v[8:9], 0
v_mov_b64 v[10:11], 0
v_mov_b64 v[12:13], 0
v_mov_b64 v[14:15], 0
v_mov_b64 v[16:17], 0
v_mov_b64 v[18:19], 0
v_mov_b64 v[20:21], 0
v_mov_b64 v[22:23], 0
v_mov_b64 v[24:25], 0
v_mov_b64 v[26:27], 0
v_mov_b64 v[28:29], 0
v_mov_b64 v[30:31], 0
s_barrier
v_bfe_u32 v7, v0, 2, 3
v_add_u32 v7, s28, v7
s_mov_b32 exec_hi, 0
v_and_b32 v7, 255, v0
v_lshl_add_u32 v7, v7, 3, s34
s_mov_b32 exec_hi, -1
s_mov_b32 s37, 0
gather_95:
buffer_load_dwordx4 v[32:35], v0, s[4:7], s20 offen sc1
buffer_load_dwordx4 v[36:39], v0, s[4:7], s21 offen sc1
buffer_load_dwordx4 v[40:43], v0, s[4:7], s22 offen sc1
s_add_u32 s37, s37, 1
s_cmp_gt_u32 s37, 262144
s_cbranch_scc1 L_fail
s_waitcnt vmcnt(2)
v_bitop3_b32 v44, v32, v34, s18 bitop3:0x7e
s_waitcnt vmcnt(1)
v_bitop3_b32 v45, v36, v38, s18 bitop3:0x7e
v_or_b32 v44, v44, v45
s_waitcnt vmcnt(0)
v_bitop3_b32 v46, v40, v42, s18 bitop3:0x7e
v_bitop3_b32 v44, v44, v46, s19 bitop3:0xa8
v_cmp_ne_u32 vcc, 0, v44
s_cbranch_vccnz gather_95
v_smfmac_f32_16x16x64_bf16 v[8:11], v[32:35], v[64:71], v1
ds_write_b128 v0, v[32:35] offset:1024
buffer_load_dwordx4 v[64:67], v0, s[4:7], s67 offen offset:0 sc1
v_smfmac_f32_16x16x64_bf16 v[12:15], v[32:35], v[72:79], v1
ds_write_b128 v0, v[36:39] offset:5120
v_smfmac_f32_16x16x64_bf16 v[20:23], v[32:35], v[56:63], v1
buffer_load_dwordx4 v[68:71], v0, s[4:7], s67 offen offset:1024 sc1
s_waitcnt lgkmcnt(2)
v_smfmac_f32_16x16x64_bf16 v[24:27], v[32:35], v[80:87], v1
ds_write_b128 v0, v[40:43] offset:9216
v_smfmac_f32_16x16x64_bf16 v[8:11], v[36:39], a[8:15], v1
ds_read_b128 v[80:83], v2 offset:2048
buffer_load_dwordx4 v[72:75], v0, s[4:7], s67 offen offset:2048 sc1
v_smfmac_f32_16x16x64_bf16 v[16:19], v[32:35], v[48:55], v1
s_waitcnt lgkmcnt(1)
ds_read_b128 v[84:87], v2 offset:3072
buffer_load_dwordx4 v[76:79], v0, s[4:7], s67 offen offset:3072 sc1
v_smfmac_f32_16x16x64_bf16 v[16:19], v[36:39], a[24:31], v1
buffer_load_dwordx4 v[48:51], v0, s[4:7], s24 offen offset:0 nt sc1
buffer_load_dwordx4 v[52:55], v0, s[4:7], s24 offen offset:1024 nt sc1
v_smfmac_f32_16x16x64_bf16 v[28:31], v[32:35], a[0:7], v1
s_barrier
ds_read_b128 v[40:43], v0 offset:0
v_smfmac_f32_16x16x64_bf16 v[28:31], v[36:39], a[40:47], v1
s_waitcnt lgkmcnt(1)
ds_read_b128 v[44:47], v0 offset:4096
ds_read_b128 v[32:35], v0 offset:3072
v_smfmac_f32_16x16x64_bf16 v[24:27], v[36:39], v[80:87], v1
v_smfmac_f32_16x16x64_bf16 v[12:15], v[36:39], a[16:23], v1
ds_read_b128 v[84:87], v2 offset:5120
ds_read_b128 v[80:83], v2 offset:4096
v_smfmac_f32_16x16x64_bf16 v[20:23], v[36:39], a[32:39], v1
ds_read_b128 v[36:39], v0 offset:7168
s_waitcnt lgkmcnt(5)
v_smfmac_f32_16x16x64_bf16 v[8:11], v[40:43], a[48:55], v1
buffer_load_dwordx4 v[56:59], v0, s[4:7], s24 offen offset:2048 nt sc1
v_smfmac_f32_16x16x64_bf16 v[12:15], v[40:43], a[56:63], v1
s_waitcnt lgkmcnt(4)
ds_read_b128 v[40:43], v0 offset:2048
s_xor_b32 s18, s18, 1
v_smfmac_f32_16x16x64_bf16 v[12:15], v[44:47], a[72:79], v1
s_waitcnt lgkmcnt(4)
buffer_load_dwordx4 v[60:63], v0, s[4:7], s24 offen offset:3072 nt sc1
v_smfmac_f32_16x16x64_bf16 v[8:11], v[44:47], a[64:71], v1
s_waitcnt lgkmcnt(3)
s_waitcnt lgkmcnt(2)
v_smfmac_f32_16x16x64_bf16 v[8:11], v[32:35], v[80:87], v1
s_waitcnt vmcnt(7)
ds_read_b128 v[84:87], v2 offset:7168
s_add_u32 s24, s24, 524288
v_smfmac_f32_16x16x64_bf16 v[12:15], v[32:35], a[80:87], v1
ds_read_b128 v[32:35], v0 offset:6144
s_waitcnt lgkmcnt(2)
v_smfmac_f32_16x16x64_bf16 v[8:11], v[36:39], a[88:95], v1
ds_read_b128 v[80:83], v2 offset:6144
v_smfmac_f32_16x16x64_bf16 v[12:15], v[36:39], a[96:103], v1
s_waitcnt vmcnt(6)
ds_read_b128 v[36:39], v0 offset:9216
v_smfmac_f32_16x16x64_bf16 v[8:11], v[40:43], v[64:71], v1
ds_read_b128 v[64:67], v2 offset:8192
ds_read_b128 v[68:71], v2 offset:9216
v_smfmac_f32_16x16x64_bf16 v[12:15], v[40:43], a[104:111], v1
ds_read_b128 v[40:43], v0 offset:8192
s_waitcnt lgkmcnt(5)
v_smfmac_f32_16x16x64_bf16 v[12:15], v[32:35], a[112:119], v1
s_waitcnt lgkmcnt(4)
buffer_load_dword v7, v7, s[4:7], 0 offen sc1
v_smfmac_f32_16x16x64_bf16 v[8:11], v[32:35], v[80:87], v1
s_waitcnt lgkmcnt(3)
ds_read_b128 v[32:35], v0 offset:0
ds_read_b128 v[84:87], v2 offset:11264
v_smfmac_f32_16x16x64_bf16 v[8:11], v[36:39], a[120:127], v1
ds_read_b128 v[80:83], v2 offset:10240
v_smfmac_f32_16x16x64_bf16 v[12:15], v[36:39], a[128:135], v1
s_waitcnt lgkmcnt(4)
ds_read_b128 v[36:39], v0 offset:4096
s_waitcnt lgkmcnt(4)
v_smfmac_f32_16x16x64_bf16 v[8:11], v[40:43], v[64:71], v1
s_waitcnt vmcnt(5)
ds_read_b128 v[64:67], v2 offset:12288
ds_read_b128 v[68:71], v2 offset:13312
v_smfmac_f32_16x16x64_bf16 v[12:15], v[40:43], a[136:143], v1
s_waitcnt lgkmcnt(5)
ds_read_b128 v[40:43], v0 offset:3072
v_smfmac_f32_16x16x64_bf16 v[16:19], v[32:35], v[72:79], v1
s_nop 0
ds_read_b128 v[72:75], v2 offset:14336
v_add_f32 v9, v9, v11
v_add_f32 v8, v8, v10
s_nop 0
v_add_f32 v13, v13, v15
v_add_f32 v12, v12, v14
v_mul_f32 v9, s44, v9
s_waitcnt lgkmcnt(4)
v_mul_f32 v8, s44, v8
v_mul_f32 v12, s44, v12
v_mul_f32 v13, s44, v13
v_cvt_pk_bf16_f32 v12, v12, v13
v_cvt_pk_bf16_f32 v8, v8, v9
v_smfmac_f32_16x16x64_bf16 v[20:23], v[32:35], v[80:87], v1
s_add_u32 s17, s17, 1
ds_read_b128 v[32:35], v0 offset:7168
ds_write2_b32 v3, v8, v12 offset0:0 offset1:128
v_smfmac_f32_16x16x64_bf16 v[16:19], v[36:39], a[144:151], v1
ds_read_b128 v[80:83], v2 offset:16384
v_smfmac_f32_16x16x64_bf16 v[20:23], v[36:39], a[152:159], v1
ds_read_b128 v[36:39], v0 offset:2048
ds_read_b128 v[76:79], v2 offset:15360
s_waitcnt vmcnt(3)
s_waitcnt lgkmcnt(4)
v_smfmac_f32_16x16x64_bf16 v[16:19], v[40:43], a[160:167], v1
ds_read_b128 v[84:87], v2 offset:17408
v_smfmac_f32_16x16x64_bf16 v[20:23], v[40:43], v[64:71], v1
s_waitcnt lgkmcnt(4)
ds_read_b128 v[40:43], v0 offset:6144
ds_read_b128 v[64:67], v2 offset:18432
v_smfmac_f32_16x16x64_bf16 v[16:19], v[32:35], a[168:175], v1
s_barrier
v_smfmac_f32_16x16x64_bf16 v[20:23], v[32:35], a[176:183], v1
s_waitcnt lgkmcnt(3)
ds_read_b128 v[32:35], v0 offset:9216
ds_read_b64_tr_b16 v[12:13], v4 offset:1024
v_smfmac_f32_16x16x64_bf16 v[16:19], v[36:39], a[184:191], v1
ds_read_b64_tr_b16 v[10:11], v4 offset:512
v_smfmac_f32_16x16x64_bf16 v[20:23], v[36:39], v[72:79], v1
s_waitcnt lgkmcnt(4)
ds_read_b128 v[36:39], v0 offset:8192
ds_read_b64_tr_b16 v[8:9], v4 offset:0
v_smfmac_f32_16x16x64_bf16 v[16:19], v[40:43], a[192:199], v1
ds_read_b64_tr_b16 v[14:15], v4 offset:1536
ds_read_b128 v[76:79], v2 offset:21504
v_smfmac_f32_16x16x64_bf16 v[20:23], v[40:43], a[200:207], v1
ds_read_b128 v[40:43], v0 offset:0
s_waitcnt lgkmcnt(7)
v_smfmac_f32_16x16x64_bf16 v[20:23], v[32:35], v[80:87], v1
ds_read_b128 v[68:71], v2 offset:19456
ds_read_b128 v[84:87], v2 offset:23552
v_smfmac_f32_16x16x64_bf16 v[16:19], v[32:35], a[208:215], v1
s_waitcnt lgkmcnt(6)
ds_read_b128 v[72:75], v2 offset:20480
v_smfmac_f32_16x16x64_bf16 v[20:23], v[36:39], a[224:231], v1
s_waitcnt lgkmcnt(6)
ds_read_b128 v[32:35], v0 offset:4096
ds_read_b128 v[80:83], v2 offset:22528
v_smfmac_f32_16x16x64_bf16 v[16:19], v[36:39], a[216:223], v1
ds_read_b128 v[36:39], v0 offset:3072
s_waitcnt lgkmcnt(7)
v_mfma_f32_16x16x32_bf16 v[44:47], v[48:51], v[8:11], 0
s_nop 0
v_add_f32 v20, v20, v22
v_add_f32 v21, v21, v23
v_mfma_f32_16x16x32_bf16 v[44:47], v[52:55], v[12:15], v[44:47]
s_nop 0
v_add_f32 v17, v17, v19
v_add_f32 v16, v16, v18
v_xor_b32 v48, 128, v5
s_waitcnt lgkmcnt(5)
v_cvt_pk_bf16_f32 v20, v20, v21
v_smfmac_f32_16x16x64_bf16 v[28:31], v[40:43], a[232:239], v1
s_mov_b64 exec, s[54:55]
ds_write_b128 v48, v[44:47] offset:512
s_mov_b64 exec, -1
v_smfmac_f32_16x16x64_bf16 v[24:27], v[40:43], v[64:71], v1
s_waitcnt lgkmcnt(3)
ds_read_b128 v[40:43], v0 offset:7168
v_cvt_pk_bf16_f32 v16, v16, v17
v_smfmac_f32_16x16x64_bf16 v[24:27], v[32:35], a[240:247], v1
ds_write2_b32 v3, v16, v20 offset0:1 offset1:129
v_smfmac_f32_16x16x64_bf16 v[28:31], v[32:35], v[72:79], v1
s_waitcnt lgkmcnt(3)
ds_read_b128 v[32:35], v0 offset:2048
buffer_load_dwordx4 v[64:67], v0, s[4:7], s68 offen offset:0 sc1
v_smfmac_f32_16x16x64_bf16 v[24:27], v[36:39], a[248:255], v1
buffer_load_dwordx4 v[68:71], v0, s[4:7], s68 offen offset:1024 sc1
v_smfmac_f32_16x16x64_bf16 v[28:31], v[36:39], v[88:95], v1
ds_read_b128 v[36:39], v0 offset:6144
s_waitcnt lgkmcnt(3)
v_smfmac_f32_16x16x64_bf16 v[24:27], v[40:43], v[96:103], v1
s_mov_b32 s20, 394240
buffer_load_dwordx4 v[72:75], v0, s[4:7], s68 offen offset:2048 sc1
v_smfmac_f32_16x16x64_bf16 v[28:31], v[40:43], v[80:87], v1
s_waitcnt lgkmcnt(2)
ds_read_b128 v[40:43], v0 offset:9216
s_waitcnt lgkmcnt(2)
v_smfmac_f32_16x16x64_bf16 v[28:31], v[32:35], v[112:119], v1
s_barrier
ds_read_b128 v[52:55], v6 offset:1024
v_smfmac_f32_16x16x64_bf16 v[24:27], v[32:35], v[104:111], v1
s_waitcnt lgkmcnt(2)
ds_read_b128 v[32:35], v0 offset:8192
ds_read_b128 v[48:51], v6 offset:0
v_smfmac_f32_16x16x64_bf16 v[24:27], v[36:39], v[120:127], v1
ds_read_b64_tr_b16 v[8:9], v4 offset:0
ds_read_b64_tr_b16 v[10:11], v4 offset:512
v_smfmac_f32_16x16x64_bf16 v[28:31], v[36:39], v[128:135], v1
s_waitcnt lgkmcnt(5)
buffer_load_dwordx4 v[76:79], v0, s[4:7], s68 offen offset:3072 sc1
v_smfmac_f32_16x16x64_bf16 v[28:31], v[40:43], v[144:151], v1
buffer_load_dwordx4 v[80:83], v0, s[4:7], s69 offen offset:0 sc1
ds_read_b64_tr_b16 v[20:21], v4 offset:3072
ds_read_b64_tr_b16 v[18:19], v4 offset:2560
v_smfmac_f32_16x16x64_bf16 v[24:27], v[40:43], v[136:143], v1
s_waitcnt lgkmcnt(5)
ds_read_b64_tr_b16 v[12:13], v4 offset:1024
ds_read_b64_tr_b16 v[14:15], v4 offset:1536
v_smfmac_f32_16x16x64_bf16 v[28:31], v[32:35], v[160:167], v1
s_waitcnt lgkmcnt(6)
ds_read_b64_tr_b16 v[16:17], v4 offset:2048
v_add_f32 v48, v48, v52
v_smfmac_f32_16x16x64_bf16 v[24:27], v[32:35], v[152:159], v1
s_waitcnt lgkmcnt(5)
ds_read_b64_tr_b16 v[22:23], v4 offset:3584
v_add_f32 v51, v51, v55
v_exp_f32 v48, v48
v_add_f32 v50, v50, v54
v_exp_f32 v51, v51
v_exp_f32 v50, v50
v_mfma_f32_16x16x32_bf16 v[44:47], v[8:11], v[8:11], 0
s_waitcnt lgkmcnt(1)
v_cvt_pk_bf16_f32 v55, v50, v51
v_add_f32 v49, v49, v53
v_mfma_f32_16x16x32_bf16 v[44:47], v[12:15], v[12:15], v[44:47]
s_waitcnt vmcnt(6)
v_exp_f32 v49, v49
v_mfma_f32_16x16x32_bf16 v[44:47], v[16:19], v[16:19], v[44:47]
s_waitcnt lgkmcnt(0)
v_cvt_pk_bf16_f32 v54, v48, v49
v_mov_b32_dpp v51, v55 quad_perm:[2,3,2,3] row_mask:0xf bank_mask:0xf
v_mfma_f32_16x16x32_bf16 v[44:47], v[20:23], v[20:23], v[44:47]
v_mov_b32_dpp v50, v54 quad_perm:[2,3,2,3] row_mask:0xf bank_mask:0xf
v_mov_b32_dpp v48, v54 quad_perm:[0,1,0,1] row_mask:0xf bank_mask:0xf
v_mov_b32_dpp v49, v55 quad_perm:[0,1,0,1] row_mask:0xf bank_mask:0xf
v_mov_b64 v[22:23], s[56:57]
v_mov_b64 v[54:55], s[58:59]
v_mfma_f32_16x16x32_bf16 v[12:15], v[60:63], v[48:51], 0
s_nop 0
v_mov_b64 v[20:21], s[56:57]
v_exp_f32_dpp v44, v46 quad_perm:[0,1,0,1] row_mask:0xf bank_mask:0xf
v_mfma_f32_16x16x32_bf16 v[8:11], v[56:59], v[48:51], 0
v_exp_f32_dpp v45, v47 quad_perm:[0,1,0,1] row_mask:0xf bank_mask:0xf
v_mfma_f32_16x16x32_bf16 v[16:19], v[20:23], v[48:51], 0
s_nop 0
v_cvt_pk_bf16_f32 v53, v44, v45
v_cvt_pk_bf16_f32 v24, v24, v25
v_cvt_pk_bf16_f32 v52, v44, v45
v_cvt_pk_bf16_f32 v25, v26, v27
v_mov_b64 v[38:39], 0
v_mfma_f32_16x16x16_bf16 v[16:19], v[54:55], v[52:53], v[16:19]
s_nop 0
v_cvt_pk_bf16_f32 v27, v30, v31
v_cvt_pk_bf16_f32 v26, v28, v29
v_mfma_f32_16x16x16_bf16 v[8:11], v[24:25], v[52:53], v[8:11]
s_nop 0
buffer_load_dwordx4 v[84:87], v0, s[4:7], s69 offen offset:1024 sc1
v_mfma_f32_16x16x16_bf16 v[12:15], v[26:27], v[52:53], v[12:15]
s_barrier
v_rcp_f32 v18, v16
v_subrev_u32 v17, s46, v16
v_mov_b64 v[40:41], 0
v_mov_b64 v[34:35], 0
v_mul_f32 v8, v8, v18
v_mul_f32 v9, v9, v18
v_cvt_pk_bf16_f32 v8, v8, v9
v_mul_f32 v10, v10, v18
v_mul_f32 v13, v13, v18
v_mul_f32 v11, v11, v18
v_cvt_pk_bf16_f32 v9, v10, v11
v_mul_f32 v12, v12, v18
v_cmp_lt_u32 vcc, s47, v17
v_mul_f32 v14, v14, v18
v_mul_f32 v15, v15, v18
v_cvt_pk_bf16_f32 v11, v14, v15
v_mov_b64 v[32:33], 0
s_waitcnt vmcnt(4)
v_cvt_pk_bf16_f32 v10, v12, v13
s_cbranch_vccnz rare_96
back_97:
s_mov_b64 exec, s[54:55]
ds_write_b128 v5, v[8:11] offset:512
s_mov_b64 exec, -1
v_mov_b64 v[48:49], 0
v_mov_b64 v[50:51], 0
v_smfmac_f32_16x16x64_bf16 v[32:35], v[8:11], v[64:71], v1
s_add_u32 s25, s25, 10240
ds_read_b128 v[16:19], v0 offset:28672
v_mov_b64 v[36:37], 0
v_mov_b64 v[42:43], 0
v_smfmac_f32_16x16x64_bf16 v[48:51], v[8:11], v[176:183], v1
ds_read_b128 v[28:31], v0 offset:31744
buffer_load_dwordx4 v[64:67], v0, s[4:7], s65 offen offset:0 sc1
ds_read_b128 v[24:27], v0 offset:30720
v_smfmac_f32_16x16x64_bf16 v[40:43], v[8:11], v[168:175], v1
ds_read_b128 v[20:23], v0 offset:29696
s_add_u32 s43, s17, 2
s_waitcnt lgkmcnt(4)
s_barrier
ds_read_b128 v[56:59], v5 offset:0
buffer_load_dwordx4 v[68:71], v0, s[4:7], s65 offen offset:1024 sc1
s_waitcnt vmcnt(4)
ds_read_b128 v[12:15], v5 offset:1024
v_smfmac_f32_16x16x64_bf16 v[36:39], v[8:11], v[72:79], v1
s_waitcnt lgkmcnt(5)
ds_read_b128 v[60:63], v5 offset:1536
v_mov_b64 v[54:55], 0
s_waitcnt lgkmcnt(3)
s_mov_b32 s37, 0
s_mov_b32 s19, 1
buffer_load_dwordx4 v[72:75], v0, s[4:7], s65 offen offset:2048 sc1
v_bfe_u32 v45, v0, 1, 7
v_mov_b64 v[52:53], 0
s_waitcnt lgkmcnt(2)
v_smfmac_f32_16x16x64_bf16 v[32:35], v[56:59], v[16:23], v1
buffer_load_dwordx4 v[76:79], v0, s[4:7], s65 offen offset:3072 sc1
ds_read_b128 v[16:19], v0 offset:34816
v_smfmac_f32_16x16x64_bf16 v[48:51], v[56:59], v[216:223], v1
s_waitcnt lgkmcnt(2)
ds_read_b128 v[20:23], v0 offset:35840
v_lshrrev_b32 v44, 8, v0
s_waitcnt vmcnt(5)
s_waitcnt vmcnt(4)
v_smfmac_f32_16x16x64_bf16 v[52:55], v[8:11], v[80:87], v1
s_waitcnt lgkmcnt(2)
ds_read_b128 v[84:87], v0 offset:33792
s_mov_b32 s21, 398336
v_smfmac_f32_16x16x64_bf16 v[32:35], v[60:63], v[24:31], v1
ds_read_b128 v[80:83], v0 offset:32768
s_min_u32 s43, s43, s39
v_smfmac_f32_16x16x64_bf16 v[32:35], v[12:15], v[184:191], v1
s_waitcnt lgkmcnt(3)
ds_read_b128 v[24:27], v0 offset:36864
s_waitcnt lgkmcnt(3)
v_smfmac_f32_16x16x64_bf16 v[40:43], v[56:59], v[16:23], v1
ds_read_b128 v[28:31], v0 offset:37888
v_lshl_or_b32 v44, v44, 12, v45
v_smfmac_f32_16x16x64_bf16 v[36:39], v[56:59], v[192:199], v1
s_waitcnt lgkmcnt(3)
v_cvt_pk_bf16_f32 v32, v32, v33
v_cvt_pk_bf16_f32 v33, v34, v35
v_and_or_b32 v32, v32, -2, s18
s_waitcnt lgkmcnt(2)
v_smfmac_f32_16x16x64_bf16 v[36:39], v[60:63], v[80:87], v1
buffer_store_dwordx2 v[32:33], v44, s[4:7], s60 offen
v_smfmac_f32_16x16x64_bf16 v[36:39], v[12:15], v[200:207], v1
s_waitcnt lgkmcnt(1)
s_waitcnt lgkmcnt(0)
ds_read_b128 v[80:83], v0 offset:38912
v_smfmac_f32_16x16x64_bf16 v[40:43], v[60:63], v[24:31], v1
s_nop 0
ds_read_b128 v[84:87], v0 offset:39936
s_add_u32 s34, s24, 524288
s_nop 0
v_cvt_pk_bf16_f32 v36, v36, v37
v_and_or_b32 v36, v36, -2, s18
v_cvt_pk_bf16_f32 v37, v38, v39
v_smfmac_f32_16x16x64_bf16 v[40:43], v[12:15], v[208:215], v1
buffer_store_dwordx2 v[36:37], v44, s[4:7], s61 offen
v_smfmac_f32_16x16x64_bf16 v[52:55], v[56:59], v[232:239], v1
s_nop 2
v_smfmac_f32_16x16x64_bf16 v[52:55], v[60:63], v[240:247], v1
s_nop 0
s_waitcnt lgkmcnt(0)
v_cvt_pk_bf16_f32 v40, v40, v41
v_cvt_pk_bf16_f32 v41, v42, v43
v_and_or_b32 v40, v40, -2, s18
v_smfmac_f32_16x16x64_bf16 v[48:51], v[60:63], v[80:87], v1
s_mov_b32 s22, 402432
buffer_store_dwordx2 v[40:41], v44, s[4:7], s62 offen
v_smfmac_f32_16x16x64_bf16 v[48:51], v[12:15], v[224:231], v1
s_nop 2
v_smfmac_f32_16x16x64_bf16 v[52:55], v[12:15], v[248:255], v1
s_nop 3
v_cvt_pk_bf16_f32 v48, v48, v49
v_and_or_b32 v48, v48, -2, s18
v_cvt_pk_bf16_f32 v49, v50, v51
buffer_store_dwordx2 v[48:49], v44, s[4:7], s63 offen
v_cvt_pk_bf16_f32 v52, v52, v53
v_cvt_pk_bf16_f32 v53, v54, v55
v_and_or_b32 v52, v52, -2, s18
buffer_store_dwordx2 v[52:53], v44, s[4:7], s64 offen
v_bfe_u32 v34, v0, 6, 1
v_lshlrev_b32 v34, 4, v34
v_mov_b32 v35, 0x3f80
v_lshlrev_b32 v34, v34, v35
v_bfe_i32 v35, v0, 4, 1
v_and_b32 v45, v34, v35
v_and_b32 v47, v34, v35
v_xor_b32 v44, v34, v45
v_xor_b32 v46, v34, v45
v_and_b32 v36, 32, v0
v_bfe_u32 v37, v0, 6, 1
v_lshl_add_u32 v36, v37, 8, v36
v_bfe_u32 v37, v0, 8, 1
v_lshl_add_u32 v36, v37, 4, v36
v_bfe_u32 v37, v0, 4, 1
v_lshl_add_u32 v36, v37, 3, v36
ds_read_b128 v[80:83], v2 offset:0
ds_read_b128 v[84:87], v2 offset:1024
v_mov_b64 v[24:25], 0
v_mov_b64 v[26:27], 0
v_mov_b64 v[28:29], 0
v_mov_b64 v[30:31], 0
v_bfe_u32 v7, v0, 2, 3
v_add_u32 v7, s28, v7
s_mov_b32 exec_hi, 0
v_and_b32 v7, 255, v0
v_lshl_add_u32 v7, v7, 3, s34
s_mov_b32 exec_hi, -1
s_nop 15
s_nop 15
s_nop 15
s_nop 10
buffer_load_dwordx4 v[8:11], v0, s[4:7], s27 offen offset:0 sc1
buffer_load_dwordx4 v[12:15], v0, s[4:7], s27 offen offset:1024 sc1
buffer_load_dwordx4 v[16:19], v0, s[4:7], s27 offen offset:2048 sc1
buffer_load_dwordx4 v[20:23], v0, s[4:7], s27 offen offset:3072 sc1
s_barrier
buffer_load_dwordx4 v[48:51], v0, s[4:7], s66 offen offset:0 sc1
buffer_load_dwordx4 v[52:55], v0, s[4:7], s66 offen offset:1024 sc1
buffer_load_dwordx4 v[56:59], v0, s[4:7], s66 offen offset:2048 sc1
buffer_load_dwordx4 v[60:63], v0, s[4:7], s66 offen offset:3072 sc1
v_mov_b64 v[40:41], 0
v_mov_b64 v[42:43], 0
s_waitcnt vmcnt(6)
s_nop 0
v_smfmac_f32_16x16x64_bf16 v[40:43], v[44:47], v[8:15], v1
v_bitop3_b32 v34, v8, v10, s18 bitop3:0x7e
v_bitop3_b32 v35, v12, v14, s18 bitop3:0x7e
s_waitcnt vmcnt(4)
v_smfmac_f32_16x16x64_bf16 v[40:43], v[44:47], v[16:23], v1
v_bitop3_b32 v32, v16, v18, s18 bitop3:0x7e
v_bitop3_b32 v33, v20, v22, s18 bitop3:0x7e
v_or3_b32 v34, v34, v35, v32
v_bitop3_b32 v34, v34, v33, 1 bitop3:0xa8
v_cmp_ne_u32 vcc, 0, v34
s_cbranch_vccnz red_99
red_99_ok:
s_nop 1
v_add_f32_dpp v40, v40, v40 row_ror:8 row_mask:0xf bank_mask:0xf
v_add_f32_dpp v41, v41, v41 row_ror:8 row_mask:0xf bank_mask:0xf
v_add_f32_dpp v42, v42, v42 row_ror:8 row_mask:0xf bank_mask:0xf
v_add_f32_dpp v43, v43, v43 row_ror:8 row_mask:0xf bank_mask:0xf
v_cvt_pk_bf16_f32 v40, v40, v41
v_cvt_pk_bf16_f32 v41, v42, v43
v_and_or_b32 v40, v40, -2, s18
s_mov_b64 exec, 0x00ff00ff
buffer_store_dwordx2 v[40:41], v36, s[4:7], s40 offen
s_mov_b64 exec, -1
g2_101:
v_mov_b64 v[8:9], 0
v_mov_b64 v[10:11], 0
v_mov_b64 v[12:13], 0
v_mov_b64 v[14:15], 0
v_mov_b64 v[16:17], 0
v_mov_b64 v[18:19], 0
v_mov_b64 v[20:21], 0
v_mov_b64 v[22:23], 0
s_mov_b32 s37, 0
s_cmp_eq_u32 s17, s38
s_barrier
s_nop 15
s_nop 7
s_cbranch_scc0 gather_95
s_branch exit_98
red_99:
buffer_load_dwordx4 v[8:11], v0, s[4:7], s27 offen offset:0 sc1
buffer_load_dwordx4 v[12:15], v0, s[4:7], s27 offen offset:1024 sc1
buffer_load_dwordx4 v[16:19], v0, s[4:7], s27 offen offset:2048 sc1
buffer_load_dwordx4 v[20:23], v0, s[4:7], s27 offen offset:3072 sc1
s_add_u32 s37, s37, 1
s_cmp_gt_u32 s37, 262144
s_cbranch_scc1 L_fail
v_mov_b64 v[40:41], 0
v_mov_b64 v[42:43], 0
s_waitcnt vmcnt(2)
s_nop 0
v_smfmac_f32_16x16x64_bf16 v[40:43], v[44:47], v[8:15], v1
v_bitop3_b32 v34, v8, v10, s18 bitop3:0x7e
v_bitop3_b32 v35, v12, v14, s18 bitop3:0x7e
s_waitcnt vmcnt(0)
v_smfmac_f32_16x16x64_bf16 v[40:43], v[44:47], v[16:23], v1
v_bitop3_b32 v32, v16, v18, s18 bitop3:0x7e
v_bitop3_b32 v33, v20, v22, s18 bitop3:0x7e
v_or3_b32 v34, v34, v35, v32
v_bitop3_b32 v34, v34, v33, 1 bitop3:0xa8
v_cmp_ne_u32 vcc, 0, v34
s_cbranch_vccnz red_99
s_branch red_99_ok
rare_96:
ds_read_b128 v[48:51], v6 offset:0
ds_read_b128 v[52:55], v6 offset:1024
s_waitcnt lgkmcnt(0)
s_barrier
v_add_f32 v48, v48, v52
v_add_f32 v49, v49, v53
v_add_f32 v50, v50, v54
v_add_f32 v51, v51, v55
v_mov_b32_dpp v46, v46 quad_perm:[0,1,0,1] row_mask:0xf bank_mask:0xf
v_mov_b32_dpp v47, v47 quad_perm:[0,1,0,1] row_mask:0xf bank_mask:0xf
v_max3_f32 v19, v48, v49, v50
v_max3_f32 v19, v19, v51, v46
v_max_f32 v19, v19, v47
s_nop 1
v_max_f32_dpp v19, v19, v19 quad_perm:[2,3,0,1] row_mask:0xf bank_mask:0xf
v_mov_b32 v44, v19
s_nop 1
v_permlane32_swap_b32 v19, v44
v_max_f32 v19, v19, v44
v_mov_b32 v44, v19
s_nop 1
v_permlane16_swap_b32 v19, v44
v_max_f32 v19, v19, v44
v_sub_f32 v48, v48, v19
v_sub_f32 v49, v49, v19
v_sub_f32 v50, v50, v19
v_sub_f32 v51, v51, v19
v_sub_f32 v46, v46, v19
v_sub_f32 v47, v47, v19
v_exp_f32 v48, v48
v_exp_f32 v49, v49
v_exp_f32 v50, v50
v_exp_f32 v51, v51
v_cvt_pk_bf16_f32 v54, v48, v49
v_cvt_pk_bf16_f32 v55, v50, v51
s_nop 0
v_mov_b32_dpp v48, v54 quad_perm:[0,1,0,1] row_mask:0xf bank_mask:0xf
v_mov_b32_dpp v49, v55 quad_perm:[0,1,0,1] row_mask:0xf bank_mask:0xf
v_mov_b32_dpp v50, v54 quad_perm:[2,3,2,3] row_mask:0xf bank_mask:0xf
v_mov_b32_dpp v51, v55 quad_perm:[2,3,2,3] row_mask:0xf bank_mask:0xf
v_mov_b64 v[20:21], s[56:57]
v_mov_b64 v[22:23], s[56:57]
v_mfma_f32_16x16x32_bf16 v[8:11], v[56:59], v[48:51], 0
v_mfma_f32_16x16x32_bf16 v[12:15], v[60:63], v[48:51], 0
v_mfma_f32_16x16x32_bf16 v[16:19], v[20:23], v[48:51], 0
v_mov_b64 v[54:55], s[58:59]
v_exp_f32_dpp v44, v46 quad_perm:[0,1,0,1] row_mask:0xf bank_mask:0xf
v_exp_f32_dpp v45, v47 quad_perm:[0,1,0,1] row_mask:0xf bank_mask:0xf
s_nop 0
v_cvt_pk_bf16_f32 v52, v44, v45
v_cvt_pk_bf16_f32 v53, v44, v45
s_nop 1
v_mfma_f32_16x16x16_bf16 v[16:19], v[54:55], v[52:53], v[16:19]
v_mfma_f32_16x16x16_bf16 v[8:11], v[24:25], v[52:53], v[8:11]
v_mfma_f32_16x16x16_bf16 v[12:15], v[26:27], v[52:53], v[12:15]
s_nop 5
v_rcp_f32 v18, v16
s_nop 0
v_mul_f32 v8, v8, v18
v_mul_f32 v9, v9, v18
v_mul_f32 v10, v10, v18
v_mul_f32 v11, v11, v18
v_mul_f32 v12, v12, v18
v_mul_f32 v13, v13, v18
v_mul_f32 v14, v14, v18
v_mul_f32 v15, v15, v18
v_cvt_pk_bf16_f32 v8, v8, v9
v_cvt_pk_bf16_f32 v9, v10, v11
v_cvt_pk_bf16_f32 v10, v12, v13
v_cvt_pk_bf16_f32 v11, v14, v15
s_branch back_97
exit_98:
buffer_load_dwordx4 v[32:35], v0, s[4:7], s20 offen sc1
buffer_load_dwordx4 v[36:39], v0, s[4:7], s21 offen sc1
buffer_load_dwordx4 v[40:43], v0, s[4:7], s22 offen sc1
s_add_u32 s37, s37, 1
s_cmp_gt_u32 s37, 262144
s_cbranch_scc1 L_fail
s_waitcnt vmcnt(2)
v_bitop3_b32 v44, v32, v34, s18 bitop3:0x7e
s_waitcnt vmcnt(1)
v_bitop3_b32 v45, v36, v38, s18 bitop3:0x7e
v_or_b32 v44, v44, v45
s_waitcnt vmcnt(0)
v_bitop3_b32 v46, v40, v42, s18 bitop3:0x7e
v_bitop3_b32 v44, v44, v46, s19 bitop3:0xa8
v_cmp_ne_u32 vcc, 0, v44
s_cbranch_vccnz exit_98
ds_write_b128 v0, v[32:35] offset:1024
ds_write_b128 v0, v[36:39] offset:5120
ds_write_b128 v0, v[40:43] offset:9216
s_waitcnt lgkmcnt(0)
s_barrier
s_barrier
s_add_u32 s45, s45, 1
s_cmp_lt_u32 s45, 2
s_cbranch_scc1 layer_94
s_endpgm
wave_79:
layer_104:
s_lshl_b32 s17, s45, 6
s_mul_i32 s34, s45, 34603008
s_lshl_b32 s35, s15, 14
s_add_u32 s34, s34, s35
s_add_u32 s24, s34, 16785408
s_mul_i32 s34, s17, 10240
s_add_u32 s34, s34, s30
s_add_u32 s25, s34, s31
s_mov_b32 s19, 0
s_add_u32 s43, s17, 1
s_add_u32 s38, s17, 63
s_add_u32 s39, s17, 64
s_mov_b32 s34, s24
v_mov_b32 v7, 0
s_mov_b32 s20, 411648
s_mov_b32 s21, 415744
buffer_load_dwordx4 v[64:67], v0, s[4:7], s65 offen offset:0 sc1
buffer_load_dwordx4 v[68:71], v0, s[4:7], s65 offen offset:1024 sc1
buffer_load_dwordx4 v[72:75], v0, s[4:7], s65 offen offset:2048 sc1
buffer_load_dwordx4 v[76:79], v0, s[4:7], s65 offen offset:3072 sc1
ds_read_b128 v[80:83], v2 offset:0
ds_read_b128 v[84:87], v2 offset:1024
buffer_load_dwordx4 v[48:51], v0, s[4:7], s66 offen offset:0 sc1
buffer_load_dwordx4 v[52:55], v0, s[4:7], s66 offen offset:1024 sc1
buffer_load_dwordx4 v[56:59], v0, s[4:7], s66 offen offset:2048 sc1
buffer_load_dwordx4 v[60:63], v0, s[4:7], s66 offen offset:3072 sc1
v_mov_b64 v[8:9], 0
v_mov_b64 v[10:11], 0
v_mov_b64 v[12:13], 0
v_mov_b64 v[14:15], 0
v_mov_b64 v[16:17], 0
v_mov_b64 v[18:19], 0
v_mov_b64 v[20:21], 0
v_mov_b64 v[22:23], 0
v_mov_b64 v[24:25], 0
v_mov_b64 v[26:27], 0
v_mov_b64 v[28:29], 0
v_mov_b64 v[30:31], 0
s_barrier
v_bfe_u32 v7, v0, 2, 3
v_add_u32 v7, s28, v7
s_mov_b32 exec_hi, 0
v_and_b32 v7, 255, v0
v_lshl_add_u32 v7, v7, 3, s34
s_mov_b32 exec_hi, -1
s_mov_b32 s37, 0
gather_105:
buffer_load_dwordx4 v[32:35], v0, s[4:7], s20 offen sc1
buffer_load_dwordx4 v[36:39], v0, s[4:7], s21 offen sc1
s_add_u32 s37, s37, 1
s_cmp_gt_u32 s37, 262144
s_cbranch_scc1 L_fail
s_waitcnt vmcnt(1)
v_bitop3_b32 v44, v32, v34, s18 bitop3:0x7e
s_waitcnt vmcnt(0)
v_bitop3_b32 v45, v36, v38, s18 bitop3:0x7e
v_bitop3_b32 v44, v44, v45, s19 bitop3:0xa8
v_cmp_ne_u32 vcc, 0, v44
s_cbranch_vccnz gather_105
v_smfmac_f32_16x16x64_bf16 v[8:11], v[32:35], v[64:71], v1
ds_write_b128 v0, v[32:35] offset:2048
buffer_load_dwordx4 v[64:67], v0, s[4:7], s67 offen offset:0 sc1
v_smfmac_f32_16x16x64_bf16 v[12:15], v[32:35], v[72:79], v1
ds_write_b128 v0, v[36:39] offset:6144
v_smfmac_f32_16x16x64_bf16 v[20:23], v[32:35], v[56:63], v1
buffer_load_dwordx4 v[68:71], v0, s[4:7], s67 offen offset:1024 sc1
s_waitcnt lgkmcnt(2)
v_smfmac_f32_16x16x64_bf16 v[24:27], v[32:35], v[80:87], v1
v_smfmac_f32_16x16x64_bf16 v[8:11], v[36:39], a[8:15], v1
ds_read_b128 v[80:83], v2 offset:2048
buffer_load_dwordx4 v[72:75], v0, s[4:7], s67 offen offset:2048 sc1
v_smfmac_f32_16x16x64_bf16 v[16:19], v[32:35], v[48:55], v1
s_waitcnt lgkmcnt(1)
ds_read_b128 v[84:87], v2 offset:3072
buffer_load_dwordx4 v[76:79], v0, s[4:7], s67 offen offset:3072 sc1
v_smfmac_f32_16x16x64_bf16 v[16:19], v[36:39], a[24:31], v1
buffer_load_dwordx4 v[48:51], v0, s[4:7], s24 offen offset:0 nt sc1
buffer_load_dwordx4 v[52:55], v0, s[4:7], s24 offen offset:1024 nt sc1
v_smfmac_f32_16x16x64_bf16 v[28:31], v[32:35], a[0:7], v1
s_barrier
ds_read_b128 v[40:43], v0 offset:3072
v_smfmac_f32_16x16x64_bf16 v[28:31], v[36:39], a[40:47], v1
s_waitcnt lgkmcnt(1)
ds_read_b128 v[44:47], v0 offset:7168
ds_read_b128 v[32:35], v0 offset:0
v_smfmac_f32_16x16x64_bf16 v[24:27], v[36:39], v[80:87], v1
v_smfmac_f32_16x16x64_bf16 v[12:15], v[36:39], a[16:23], v1
ds_read_b128 v[84:87], v2 offset:5120
ds_read_b128 v[80:83], v2 offset:4096
v_smfmac_f32_16x16x64_bf16 v[20:23], v[36:39], a[32:39], v1
ds_read_b128 v[36:39], v0 offset:4096
s_waitcnt lgkmcnt(5)
v_smfmac_f32_16x16x64_bf16 v[8:11], v[40:43], a[48:55], v1
buffer_load_dwordx4 v[56:59], v0, s[4:7], s24 offen offset:2048 nt sc1
v_smfmac_f32_16x16x64_bf16 v[12:15], v[40:43], a[56:63], v1
s_waitcnt lgkmcnt(4)
ds_read_b128 v[40:43], v0 offset:1024
s_xor_b32 s18, s18, 1
v_smfmac_f32_16x16x64_bf16 v[12:15], v[44:47], a[72:79], v1
s_waitcnt lgkmcnt(4)
buffer_load_dwordx4 v[60:63], v0, s[4:7], s24 offen offset:3072 nt sc1
v_smfmac_f32_16x16x64_bf16 v[8:11], v[44:47], a[64:71], v1
s_waitcnt lgkmcnt(3)
s_waitcnt lgkmcnt(2)
v_smfmac_f32_16x16x64_bf16 v[8:11], v[32:35], v[80:87], v1
s_waitcnt vmcnt(7)
ds_read_b128 v[84:87], v2 offset:7168
s_add_u32 s24, s24, 524288
v_smfmac_f32_16x16x64_bf16 v[12:15], v[32:35], a[80:87], v1
ds_read_b128 v[32:35], v0 offset:5120
s_waitcnt lgkmcnt(2)
v_smfmac_f32_16x16x64_bf16 v[8:11], v[36:39], a[88:95], v1
ds_read_b128 v[80:83], v2 offset:6144
v_smfmac_f32_16x16x64_bf16 v[12:15], v[36:39], a[96:103], v1
s_waitcnt vmcnt(6)
ds_read_b128 v[36:39], v0 offset:8192
v_smfmac_f32_16x16x64_bf16 v[8:11], v[40:43], v[64:71], v1
ds_read_b128 v[64:67], v2 offset:8192
ds_read_b128 v[68:71], v2 offset:9216
v_smfmac_f32_16x16x64_bf16 v[12:15], v[40:43], a[104:111], v1
ds_read_b128 v[40:43], v0 offset:9216
s_waitcnt lgkmcnt(5)
v_smfmac_f32_16x16x64_bf16 v[12:15], v[32:35], a[112:119], v1
s_waitcnt lgkmcnt(4)
buffer_load_dword v7, v7, s[4:7], 0 offen sc1
v_smfmac_f32_16x16x64_bf16 v[8:11], v[32:35], v[80:87], v1
s_waitcnt lgkmcnt(3)
ds_read_b128 v[32:35], v0 offset:3072
ds_read_b128 v[84:87], v2 offset:11264
v_smfmac_f32_16x16x64_bf16 v[8:11], v[36:39], a[120:127], v1
ds_read_b128 v[80:83], v2 offset:10240
v_smfmac_f32_16x16x64_bf16 v[12:15], v[36:39], a[128:135], v1
s_waitcnt lgkmcnt(4)
ds_read_b128 v[36:39], v0 offset:7168
s_waitcnt lgkmcnt(4)
v_smfmac_f32_16x16x64_bf16 v[8:11], v[40:43], v[64:71], v1
s_waitcnt vmcnt(5)
ds_read_b128 v[64:67], v2 offset:12288
ds_read_b128 v[68:71], v2 offset:13312
v_smfmac_f32_16x16x64_bf16 v[12:15], v[40:43], a[136:143], v1
s_waitcnt lgkmcnt(5)
ds_read_b128 v[40:43], v0 offset:0
v_smfmac_f32_16x16x64_bf16 v[16:19], v[32:35], v[72:79], v1
s_nop 0
ds_read_b128 v[72:75], v2 offset:14336
v_add_f32 v9, v9, v11
v_add_f32 v8, v8, v10
s_nop 0
v_add_f32 v13, v13, v15
v_add_f32 v12, v12, v14
v_mul_f32 v9, s44, v9
s_waitcnt lgkmcnt(4)
v_mul_f32 v8, s44, v8
v_mul_f32 v12, s44, v12
v_mul_f32 v13, s44, v13
v_cvt_pk_bf16_f32 v12, v12, v13
v_cvt_pk_bf16_f32 v8, v8, v9
v_smfmac_f32_16x16x64_bf16 v[20:23], v[32:35], v[80:87], v1
s_add_u32 s17, s17, 1
ds_read_b128 v[32:35], v0 offset:4096
ds_write2_b32 v3, v8, v12 offset0:0 offset1:128
v_smfmac_f32_16x16x64_bf16 v[16:19], v[36:39], a[144:151], v1
ds_read_b128 v[80:83], v2 offset:16384
v_smfmac_f32_16x16x64_bf16 v[20:23], v[36:39], a[152:159], v1
ds_read_b128 v[36:39], v0 offset:1024
ds_read_b128 v[76:79], v2 offset:15360
s_waitcnt vmcnt(3)
s_waitcnt lgkmcnt(4)
v_smfmac_f32_16x16x64_bf16 v[16:19], v[40:43], a[160:167], v1
ds_read_b128 v[84:87], v2 offset:17408
v_smfmac_f32_16x16x64_bf16 v[20:23], v[40:43], v[64:71], v1
s_waitcnt lgkmcnt(4)
ds_read_b128 v[40:43], v0 offset:5120
ds_read_b128 v[64:67], v2 offset:18432
v_smfmac_f32_16x16x64_bf16 v[16:19], v[32:35], a[168:175], v1
s_barrier
v_smfmac_f32_16x16x64_bf16 v[20:23], v[32:35], a[176:183], v1
s_waitcnt lgkmcnt(3)
ds_read_b128 v[32:35], v0 offset:8192
ds_read_b64_tr_b16 v[12:13], v4 offset:3072
v_smfmac_f32_16x16x64_bf16 v[16:19], v[36:39], a[184:191], v1
ds_read_b64_tr_b16 v[10:11], v4 offset:2560
v_smfmac_f32_16x16x64_bf16 v[20:23], v[36:39], v[72:79], v1
s_waitcnt lgkmcnt(4)
ds_read_b128 v[36:39], v0 offset:9216
ds_read_b64_tr_b16 v[8:9], v4 offset:2048
v_smfmac_f32_16x16x64_bf16 v[16:19], v[40:43], a[192:199], v1
ds_read_b64_tr_b16 v[14:15], v4 offset:3584
ds_read_b128 v[76:79], v2 offset:21504
v_smfmac_f32_16x16x64_bf16 v[20:23], v[40:43], a[200:207], v1
ds_read_b128 v[40:43], v0 offset:3072
s_waitcnt lgkmcnt(7)
v_smfmac_f32_16x16x64_bf16 v[20:23], v[32:35], v[80:87], v1
ds_read_b128 v[68:71], v2 offset:19456
ds_read_b128 v[84:87], v2 offset:23552
v_smfmac_f32_16x16x64_bf16 v[16:19], v[32:35], a[208:215], v1
s_waitcnt lgkmcnt(6)
ds_read_b128 v[72:75], v2 offset:20480
v_smfmac_f32_16x16x64_bf16 v[20:23], v[36:39], a[224:231], v1
s_waitcnt lgkmcnt(6)
ds_read_b128 v[32:35], v0 offset:7168
ds_read_b128 v[80:83], v2 offset:22528
v_smfmac_f32_16x16x64_bf16 v[16:19], v[36:39], a[216:223], v1
ds_read_b128 v[36:39], v0 offset:0
s_waitcnt lgkmcnt(7)
v_mfma_f32_16x16x32_bf16 v[44:47], v[48:51], v[8:11], 0
s_nop 0
v_add_f32 v20, v20, v22
v_add_f32 v21, v21, v23
v_mfma_f32_16x16x32_bf16 v[44:47], v[52:55], v[12:15], v[44:47]
s_nop 0
v_add_f32 v17, v17, v19
v_add_f32 v16, v16, v18
s_waitcnt lgkmcnt(5)
v_cvt_pk_bf16_f32 v20, v20, v21
v_smfmac_f32_16x16x64_bf16 v[28:31], v[40:43], a[232:239], v1
s_mov_b64 exec, s[54:55]
s_nop 0
ds_write_b128 v5, v[44:47] offset:1024
s_mov_b64 exec, -1
v_smfmac_f32_16x16x64_bf16 v[24:27], v[40:43], v[64:71], v1
s_waitcnt lgkmcnt(3)
ds_read_b128 v[40:43], v0 offset:4096
v_cvt_pk_bf16_f32 v16, v16, v17
v_smfmac_f32_16x16x64_bf16 v[24:27], v[32:35], a[240:247], v1
ds_write2_b32 v3, v16, v20 offset0:1 offset1:129
v_smfmac_f32_16x16x64_bf16 v[28:31], v[32:35], v[72:79], v1
s_waitcnt lgkmcnt(3)
ds_read_b128 v[32:35], v0 offset:1024
buffer_load_dwordx4 v[64:67], v0, s[4:7], s68 offen offset:0 sc1
v_smfmac_f32_16x16x64_bf16 v[24:27], v[36:39], a[248:255], v1
buffer_load_dwordx4 v[68:71], v0, s[4:7], s68 offen offset:1024 sc1
v_smfmac_f32_16x16x64_bf16 v[28:31], v[36:39], v[88:95], v1
ds_read_b128 v[36:39], v0 offset:5120
s_waitcnt lgkmcnt(3)
v_smfmac_f32_16x16x64_bf16 v[24:27], v[40:43], v[96:103], v1
s_mov_b32 s20, 395264
buffer_load_dwordx4 v[72:75], v0, s[4:7], s68 offen offset:2048 sc1
v_smfmac_f32_16x16x64_bf16 v[28:31], v[40:43], v[80:87], v1
s_waitcnt lgkmcnt(2)
ds_read_b128 v[40:43], v0 offset:8192
s_waitcnt lgkmcnt(2)
v_smfmac_f32_16x16x64_bf16 v[28:31], v[32:35], v[112:119], v1
s_barrier
ds_read_b128 v[52:55], v6 offset:1024
v_smfmac_f32_16x16x64_bf16 v[24:27], v[32:35], v[104:111], v1
s_waitcnt lgkmcnt(2)
ds_read_b128 v[32:35], v0 offset:9216
ds_read_b128 v[48:51], v6 offset:0
v_smfmac_f32_16x16x64_bf16 v[24:27], v[36:39], v[120:127], v1
ds_read_b64_tr_b16 v[8:9], v4 offset:0
ds_read_b64_tr_b16 v[10:11], v4 offset:512
v_smfmac_f32_16x16x64_bf16 v[28:31], v[36:39], v[128:135], v1
s_waitcnt lgkmcnt(5)
buffer_load_dwordx4 v[76:79], v0, s[4:7], s68 offen offset:3072 sc1
v_smfmac_f32_16x16x64_bf16 v[28:31], v[40:43], v[144:151], v1
buffer_load_dwordx4 v[80:83], v0, s[4:7], s69 offen offset:0 sc1
ds_read_b64_tr_b16 v[20:21], v4 offset:3072
ds_read_b64_tr_b16 v[18:19], v4 offset:2560
v_smfmac_f32_16x16x64_bf16 v[24:27], v[40:43], v[136:143], v1
s_waitcnt lgkmcnt(5)
ds_read_b64_tr_b16 v[12:13], v4 offset:1024
ds_read_b64_tr_b16 v[14:15], v4 offset:1536
v_smfmac_f32_16x16x64_bf16 v[28:31], v[32:35], v[160:167], v1
s_waitcnt lgkmcnt(6)
ds_read_b64_tr_b16 v[16:17], v4 offset:2048
v_add_f32 v48, v48, v52
v_smfmac_f32_16x16x64_bf16 v[24:27], v[32:35], v[152:159], v1
s_waitcnt lgkmcnt(5)
ds_read_b64_tr_b16 v[22:23], v4 offset:3584
v_add_f32 v51, v51, v55
v_exp_f32 v48, v48
v_add_f32 v50, v50, v54
v_exp_f32 v51, v51
v_exp_f32 v50, v50
v_mfma_f32_16x16x32_bf16 v[44:47], v[8:11], v[8:11], 0
s_waitcnt lgkmcnt(1)
v_cvt_pk_bf16_f32 v55, v50, v51
v_add_f32 v49, v49, v53
v_mfma_f32_16x16x32_bf16 v[44:47], v[12:15], v[12:15], v[44:47]
s_waitcnt vmcnt(6)
v_exp_f32 v49, v49
v_mfma_f32_16x16x32_bf16 v[44:47], v[16:19], v[16:19], v[44:47]
s_waitcnt lgkmcnt(0)
v_cvt_pk_bf16_f32 v54, v48, v49
v_mov_b32_dpp v51, v55 quad_perm:[2,3,2,3] row_mask:0xf bank_mask:0xf
v_mfma_f32_16x16x32_bf16 v[44:47], v[20:23], v[20:23], v[44:47]
v_mov_b32_dpp v50, v54 quad_perm:[2,3,2,3] row_mask:0xf bank_mask:0xf
v_mov_b32_dpp v48, v54 quad_perm:[0,1,0,1] row_mask:0xf bank_mask:0xf
v_mov_b32_dpp v49, v55 quad_perm:[0,1,0,1] row_mask:0xf bank_mask:0xf
v_mov_b64 v[22:23], s[56:57]
v_mov_b64 v[54:55], s[58:59]
v_mfma_f32_16x16x32_bf16 v[12:15], v[60:63], v[48:51], 0
s_nop 0
v_mov_b64 v[20:21], s[56:57]
v_exp_f32_dpp v44, v46 quad_perm:[0,1,0,1] row_mask:0xf bank_mask:0xf
v_mfma_f32_16x16x32_bf16 v[8:11], v[56:59], v[48:51], 0
v_exp_f32_dpp v45, v47 quad_perm:[0,1,0,1] row_mask:0xf bank_mask:0xf
v_mfma_f32_16x16x32_bf16 v[16:19], v[20:23], v[48:51], 0
s_nop 0
v_cvt_pk_bf16_f32 v53, v44, v45
v_cvt_pk_bf16_f32 v24, v24, v25
v_cvt_pk_bf16_f32 v52, v44, v45
v_cvt_pk_bf16_f32 v25, v26, v27
v_mov_b64 v[38:39], 0
v_mfma_f32_16x16x16_bf16 v[16:19], v[54:55], v[52:53], v[16:19]
s_nop 0
v_cvt_pk_bf16_f32 v27, v30, v31
v_cvt_pk_bf16_f32 v26, v28, v29
v_mfma_f32_16x16x16_bf16 v[8:11], v[24:25], v[52:53], v[8:11]
s_nop 0
buffer_load_dwordx4 v[84:87], v0, s[4:7], s69 offen offset:1024 sc1
v_mfma_f32_16x16x16_bf16 v[12:15], v[26:27], v[52:53], v[12:15]
s_barrier
v_rcp_f32 v18, v16
v_subrev_u32 v17, s46, v16
v_mov_b64 v[40:41], 0
v_mov_b64 v[34:35], 0
v_mul_f32 v8, v8, v18
v_mul_f32 v9, v9, v18
v_cvt_pk_bf16_f32 v8, v8, v9
v_mul_f32 v10, v10, v18
v_mul_f32 v13, v13, v18
v_mul_f32 v11, v11, v18
v_cvt_pk_bf16_f32 v9, v10, v11
v_mul_f32 v12, v12, v18
v_cmp_lt_u32 vcc, s47, v17
v_mul_f32 v14, v14, v18
v_mul_f32 v15, v15, v18
v_cvt_pk_bf16_f32 v11, v14, v15
v_mov_b64 v[32:33], 0
s_waitcnt vmcnt(4)
v_cvt_pk_bf16_f32 v10, v12, v13
s_cbranch_vccnz rare_106
back_107:
s_mov_b64 exec, s[54:55]
ds_write_b128 v5, v[8:11] offset:1024
s_mov_b64 exec, -1
v_mov_b64 v[48:49], 0
v_mov_b64 v[50:51], 0
v_smfmac_f32_16x16x64_bf16 v[32:35], v[8:11], v[64:71], v1
s_add_u32 s25, s25, 10240
ds_read_b128 v[16:19], v0 offset:40960
v_mov_b64 v[36:37], 0
v_mov_b64 v[42:43], 0
v_smfmac_f32_16x16x64_bf16 v[48:51], v[8:11], v[176:183], v1
ds_read_b128 v[28:31], v0 offset:44032
buffer_load_dwordx4 v[64:67], v0, s[4:7], s65 offen offset:0 sc1
ds_read_b128 v[24:27], v0 offset:43008
v_smfmac_f32_16x16x64_bf16 v[40:43], v[8:11], v[168:175], v1
ds_read_b128 v[20:23], v0 offset:41984
s_add_u32 s43, s17, 2
s_waitcnt lgkmcnt(4)
s_barrier
ds_read_b128 v[56:59], v5 offset:1536
buffer_load_dwordx4 v[68:71], v0, s[4:7], s65 offen offset:1024 sc1
s_waitcnt vmcnt(4)
ds_read_b128 v[12:15], v5 offset:512
v_smfmac_f32_16x16x64_bf16 v[36:39], v[8:11], v[72:79], v1
s_waitcnt lgkmcnt(5)
ds_read_b128 v[60:63], v5 offset:0
v_mov_b64 v[54:55], 0
s_waitcnt lgkmcnt(3)
s_mov_b32 s37, 0
s_mov_b32 s19, 1
buffer_load_dwordx4 v[72:75], v0, s[4:7], s65 offen offset:2048 sc1
v_bfe_u32 v45, v0, 1, 7
v_mov_b64 v[52:53], 0
s_waitcnt lgkmcnt(2)
v_smfmac_f32_16x16x64_bf16 v[32:35], v[56:59], v[16:23], v1
buffer_load_dwordx4 v[76:79], v0, s[4:7], s65 offen offset:3072 sc1
ds_read_b128 v[16:19], v0 offset:47104
v_smfmac_f32_16x16x64_bf16 v[48:51], v[56:59], v[216:223], v1
s_waitcnt lgkmcnt(2)
ds_read_b128 v[20:23], v0 offset:48128
v_lshrrev_b32 v44, 8, v0
s_waitcnt vmcnt(5)
s_waitcnt vmcnt(4)
v_smfmac_f32_16x16x64_bf16 v[52:55], v[8:11], v[80:87], v1
s_waitcnt lgkmcnt(2)
ds_read_b128 v[84:87], v0 offset:46080
s_mov_b32 s21, 399360
v_smfmac_f32_16x16x64_bf16 v[32:35], v[60:63], v[24:31], v1
ds_read_b128 v[80:83], v0 offset:45056
s_min_u32 s43, s43, s39
v_smfmac_f32_16x16x64_bf16 v[32:35], v[12:15], v[184:191], v1
s_waitcnt lgkmcnt(3)
ds_read_b128 v[24:27], v0 offset:49152
s_waitcnt lgkmcnt(3)
v_smfmac_f32_16x16x64_bf16 v[40:43], v[56:59], v[16:23], v1
ds_read_b128 v[28:31], v0 offset:50176
v_lshl_or_b32 v44, v44, 12, v45
v_smfmac_f32_16x16x64_bf16 v[36:39], v[56:59], v[192:199], v1
s_waitcnt lgkmcnt(3)
v_cvt_pk_bf16_f32 v32, v32, v33
v_cvt_pk_bf16_f32 v33, v34, v35
v_and_or_b32 v32, v32, -2, s18
s_waitcnt lgkmcnt(2)
v_smfmac_f32_16x16x64_bf16 v[36:39], v[60:63], v[80:87], v1
buffer_store_dwordx2 v[32:33], v44, s[4:7], s60 offen
v_smfmac_f32_16x16x64_bf16 v[36:39], v[12:15], v[200:207], v1
s_waitcnt lgkmcnt(1)
s_waitcnt lgkmcnt(0)
ds_read_b128 v[80:83], v0 offset:51200
v_smfmac_f32_16x16x64_bf16 v[40:43], v[60:63], v[24:31], v1
s_nop 0
ds_read_b128 v[84:87], v0 offset:52224
s_add_u32 s34, s24, 524288
s_nop 0
v_cvt_pk_bf16_f32 v36, v36, v37
v_and_or_b32 v36, v36, -2, s18
v_cvt_pk_bf16_f32 v37, v38, v39
v_smfmac_f32_16x16x64_bf16 v[40:43], v[12:15], v[208:215], v1
buffer_store_dwordx2 v[36:37], v44, s[4:7], s61 offen
v_smfmac_f32_16x16x64_bf16 v[52:55], v[56:59], v[232:239], v1
s_nop 2
v_smfmac_f32_16x16x64_bf16 v[52:55], v[60:63], v[240:247], v1
s_nop 0
s_waitcnt lgkmcnt(0)
v_cvt_pk_bf16_f32 v40, v40, v41
v_cvt_pk_bf16_f32 v41, v42, v43
v_and_or_b32 v40, v40, -2, s18
v_smfmac_f32_16x16x64_bf16 v[48:51], v[60:63], v[80:87], v1
buffer_store_dwordx2 v[40:41], v44, s[4:7], s62 offen
v_smfmac_f32_16x16x64_bf16 v[48:51], v[12:15], v[224:231], v1
s_nop 2
v_smfmac_f32_16x16x64_bf16 v[52:55], v[12:15], v[248:255], v1
s_nop 3
v_cvt_pk_bf16_f32 v48, v48, v49
v_and_or_b32 v48, v48, -2, s18
v_cvt_pk_bf16_f32 v49, v50, v51
buffer_store_dwordx2 v[48:49], v44, s[4:7], s63 offen
v_cvt_pk_bf16_f32 v52, v52, v53
v_cvt_pk_bf16_f32 v53, v54, v55
v_and_or_b32 v52, v52, -2, s18
buffer_store_dwordx2 v[52:53], v44, s[4:7], s64 offen
v_bfe_u32 v34, v0, 6, 1
v_lshlrev_b32 v34, 4, v34
v_mov_b32 v35, 0x3f80
v_lshlrev_b32 v34, v34, v35
v_bfe_i32 v35, v0, 4, 1
v_and_b32 v45, v34, v35
v_and_b32 v47, v34, v35
v_xor_b32 v44, v34, v45
v_xor_b32 v46, v34, v45
v_and_b32 v36, 32, v0
v_bfe_u32 v37, v0, 6, 1
v_lshl_add_u32 v36, v37, 8, v36
v_bfe_u32 v37, v0, 8, 1
v_lshl_add_u32 v36, v37, 4, v36
v_bfe_u32 v37, v0, 4, 1
v_lshl_add_u32 v36, v37, 3, v36
ds_read_b128 v[80:83], v2 offset:0
ds_read_b128 v[84:87], v2 offset:1024
v_mov_b64 v[24:25], 0
v_mov_b64 v[26:27], 0
v_mov_b64 v[28:29], 0
v_mov_b64 v[30:31], 0
v_cmp_gt_u32 vcc, s43, v7
s_cmp_eq_u32 vcc_hi, 0
s_cbranch_scc1 kv_116
s_mov_b32 s37, 0
kv_115:
v_bfe_u32 v7, v0, 2, 3
buffer_load_dword v7, v7, s[4:7], s28 offen sc1
s_add_u32 s37, s37, 1
s_cmp_gt_u32 s37, 262144
s_cbranch_scc1 L_fail
s_waitcnt vmcnt(0)
v_cmp_gt_u32 vcc, s43, v7
s_cbranch_vccnz kv_115
kv_116:
s_mov_b32 s37, 0
v_bfe_u32 v7, v0, 2, 3
v_add_u32 v7, s28, v7
s_mov_b32 exec_hi, 0
v_and_b32 v7, 255, v0
v_lshl_add_u32 v7, v7, 3, s34
s_mov_b32 exec_hi, -1
s_nop 15
s_nop 15
s_nop 15
s_nop 9
s_cmp_ge_u32 s15, 16
s_cbranch_scc1 nored_110
buffer_load_dwordx4 v[8:11], v0, s[4:7], s27 offen offset:0 sc1
buffer_load_dwordx4 v[12:15], v0, s[4:7], s27 offen offset:1024 sc1
buffer_load_dwordx4 v[16:19], v0, s[4:7], s27 offen offset:2048 sc1
buffer_load_dwordx4 v[20:23], v0, s[4:7], s27 offen offset:3072 sc1
s_barrier
buffer_load_dwordx4 v[48:51], v0, s[4:7], s66 offen offset:0 sc1
buffer_load_dwordx4 v[52:55], v0, s[4:7], s66 offen offset:1024 sc1
buffer_load_dwordx4 v[56:59], v0, s[4:7], s66 offen offset:2048 sc1
buffer_load_dwordx4 v[60:63], v0, s[4:7], s66 offen offset:3072 sc1
v_mov_b64 v[40:41], 0
v_mov_b64 v[42:43], 0
s_waitcnt vmcnt(6)
s_nop 0
v_smfmac_f32_16x16x64_bf16 v[40:43], v[44:47], v[8:15], v1
v_bitop3_b32 v34, v8, v10, s18 bitop3:0x7e
v_bitop3_b32 v35, v12, v14, s18 bitop3:0x7e
s_waitcnt vmcnt(4)
v_smfmac_f32_16x16x64_bf16 v[40:43], v[44:47], v[16:23], v1
v_bitop3_b32 v32, v16, v18, s18 bitop3:0x7e
v_bitop3_b32 v33, v20, v22, s18 bitop3:0x7e
v_or3_b32 v34, v34, v35, v32
v_bitop3_b32 v34, v34, v33, 1 bitop3:0xa8
v_cmp_ne_u32 vcc, 0, v34
s_cbranch_vccnz red_109
red_109_ok:
s_nop 1
v_add_f32_dpp v40, v40, v40 row_ror:8 row_mask:0xf bank_mask:0xf
v_add_f32_dpp v41, v41, v41 row_ror:8 row_mask:0xf bank_mask:0xf
v_add_f32_dpp v42, v42, v42 row_ror:8 row_mask:0xf bank_mask:0xf
v_add_f32_dpp v43, v43, v43 row_ror:8 row_mask:0xf bank_mask:0xf
v_cvt_pk_bf16_f32 v40, v40, v41
v_cvt_pk_bf16_f32 v41, v42, v43
v_and_or_b32 v40, v40, -2, s18
s_mov_b64 exec, 0x00ff00ff
buffer_store_dwordx2 v[40:41], v36, s[4:7], s40 offen
s_mov_b64 exec, -1
s_branch g2_111
nored_110:
s_barrier
buffer_load_dwordx4 v[48:51], v0, s[4:7], s66 offen offset:0 sc1
buffer_load_dwordx4 v[52:55], v0, s[4:7], s66 offen offset:1024 sc1
buffer_load_dwordx4 v[56:59], v0, s[4:7], s66 offen offset:2048 sc1
buffer_load_dwordx4 v[60:63], v0, s[4:7], s66 offen offset:3072 sc1
g2_111:
v_mov_b64 v[8:9], 0
v_mov_b64 v[10:11], 0
v_mov_b64 v[12:13], 0
v_mov_b64 v[14:15], 0
v_mov_b64 v[16:17], 0
v_mov_b64 v[18:19], 0
v_mov_b64 v[20:21], 0
v_mov_b64 v[22:23], 0
s_mov_b32 s37, 0
s_cmp_eq_u32 s17, s38
s_barrier
s_nop 15
s_nop 7
s_cbranch_scc0 gather_105
s_branch exit_108
red_109:
buffer_load_dwordx4 v[8:11], v0, s[4:7], s27 offen offset:0 sc1
buffer_load_dwordx4 v[12:15], v0, s[4:7], s27 offen offset:1024 sc1
buffer_load_dwordx4 v[16:19], v0, s[4:7], s27 offen offset:2048 sc1
buffer_load_dwordx4 v[20:23], v0, s[4:7], s27 offen offset:3072 sc1
s_add_u32 s37, s37, 1
s_cmp_gt_u32 s37, 262144
s_cbranch_scc1 L_fail
v_mov_b64 v[40:41], 0
v_mov_b64 v[42:43], 0
s_waitcnt vmcnt(2)
s_nop 0
v_smfmac_f32_16x16x64_bf16 v[40:43], v[44:47], v[8:15], v1
v_bitop3_b32 v34, v8, v10, s18 bitop3:0x7e
v_bitop3_b32 v35, v12, v14, s18 bitop3:0x7e
s_waitcnt vmcnt(0)
v_smfmac_f32_16x16x64_bf16 v[40:43], v[44:47], v[16:23], v1
v_bitop3_b32 v32, v16, v18, s18 bitop3:0x7e
v_bitop3_b32 v33, v20, v22, s18 bitop3:0x7e
v_or3_b32 v34, v34, v35, v32
v_bitop3_b32 v34, v34, v33, 1 bitop3:0xa8
v_cmp_ne_u32 vcc, 0, v34
s_cbranch_vccnz red_109
s_branch red_109_ok
rare_106:
ds_read_b128 v[48:51], v6 offset:0
ds_read_b128 v[52:55], v6 offset:1024
s_waitcnt lgkmcnt(0)
s_barrier
v_add_f32 v48, v48, v52
v_add_f32 v49, v49, v53
v_add_f32 v50, v50, v54
v_add_f32 v51, v51, v55
v_mov_b32_dpp v46, v46 quad_perm:[0,1,0,1] row_mask:0xf bank_mask:0xf
v_mov_b32_dpp v47, v47 quad_perm:[0,1,0,1] row_mask:0xf bank_mask:0xf
v_max3_f32 v19, v48, v49, v50
v_max3_f32 v19, v19, v51, v46
v_max_f32 v19, v19, v47
s_nop 1
v_max_f32_dpp v19, v19, v19 quad_perm:[2,3,0,1] row_mask:0xf bank_mask:0xf
v_mov_b32 v44, v19
s_nop 1
v_permlane32_swap_b32 v19, v44
v_max_f32 v19, v19, v44
v_mov_b32 v44, v19
s_nop 1
v_permlane16_swap_b32 v19, v44
v_max_f32 v19, v19, v44
v_sub_f32 v48, v48, v19
v_sub_f32 v49, v49, v19
v_sub_f32 v50, v50, v19
v_sub_f32 v51, v51, v19
v_sub_f32 v46, v46, v19
v_sub_f32 v47, v47, v19
v_exp_f32 v48, v48
v_exp_f32 v49, v49
v_exp_f32 v50, v50
v_exp_f32 v51, v51
v_cvt_pk_bf16_f32 v54, v48, v49
v_cvt_pk_bf16_f32 v55, v50, v51
s_nop 0
v_mov_b32_dpp v48, v54 quad_perm:[0,1,0,1] row_mask:0xf bank_mask:0xf
v_mov_b32_dpp v49, v55 quad_perm:[0,1,0,1] row_mask:0xf bank_mask:0xf
v_mov_b32_dpp v50, v54 quad_perm:[2,3,2,3] row_mask:0xf bank_mask:0xf
v_mov_b32_dpp v51, v55 quad_perm:[2,3,2,3] row_mask:0xf bank_mask:0xf
v_mov_b64 v[20:21], s[56:57]
v_mov_b64 v[22:23], s[56:57]
v_mfma_f32_16x16x32_bf16 v[8:11], v[56:59], v[48:51], 0
v_mfma_f32_16x16x32_bf16 v[12:15], v[60:63], v[48:51], 0
v_mfma_f32_16x16x32_bf16 v[16:19], v[20:23], v[48:51], 0
v_mov_b64 v[54:55], s[58:59]
v_exp_f32_dpp v44, v46 quad_perm:[0,1,0,1] row_mask:0xf bank_mask:0xf
v_exp_f32_dpp v45, v47 quad_perm:[0,1,0,1] row_mask:0xf bank_mask:0xf
s_nop 0
v_cvt_pk_bf16_f32 v52, v44, v45
v_cvt_pk_bf16_f32 v53, v44, v45
s_nop 1
v_mfma_f32_16x16x16_bf16 v[16:19], v[54:55], v[52:53], v[16:19]
v_mfma_f32_16x16x16_bf16 v[8:11], v[24:25], v[52:53], v[8:11]
v_mfma_f32_16x16x16_bf16 v[12:15], v[26:27], v[52:53], v[12:15]
s_nop 5
v_rcp_f32 v18, v16
s_nop 0
v_mul_f32 v8, v8, v18
v_mul_f32 v9, v9, v18
v_mul_f32 v10, v10, v18
v_mul_f32 v11, v11, v18
v_mul_f32 v12, v12, v18
v_mul_f32 v13, v13, v18
v_mul_f32 v14, v14, v18
v_mul_f32 v15, v15, v18
v_cvt_pk_bf16_f32 v8, v8, v9
v_cvt_pk_bf16_f32 v9, v10, v11
v_cvt_pk_bf16_f32 v10, v12, v13
v_cvt_pk_bf16_f32 v11, v14, v15
s_branch back_107
exit_108:
buffer_load_dwordx4 v[32:35], v0, s[4:7], s20 offen sc1
buffer_load_dwordx4 v[36:39], v0, s[4:7], s21 offen sc1
s_add_u32 s37, s37, 1
s_cmp_gt_u32 s37, 262144
s_cbranch_scc1 L_fail
s_waitcnt vmcnt(1)
v_bitop3_b32 v44, v32, v34, s18 bitop3:0x7e
s_waitcnt vmcnt(0)
v_bitop3_b32 v45, v36, v38, s18 bitop3:0x7e
v_bitop3_b32 v44, v44, v45, s19 bitop3:0xa8
v_cmp_ne_u32 vcc, 0, v44
s_cbranch_vccnz exit_108
ds_write_b128 v0, v[32:35] offset:2048
ds_write_b128 v0, v[36:39] offset:6144
s_waitcnt lgkmcnt(0)
s_barrier
s_barrier
s_add_u32 s45, s45, 1
s_cmp_lt_u32 s45, 2
s_cbranch_scc1 layer_104
s_endpgm
wave_80:
layer_117:
s_lshl_b32 s17, s45, 6
s_mul_i32 s34, s45, 34603008
s_lshl_b32 s35, s15, 14
s_add_u32 s34, s34, s35
s_add_u32 s24, s34, 16789504
s_mul_i32 s34, s17, 10240
s_add_u32 s34, s34, s30
s_add_u32 s25, s34, s31
s_mov_b32 s19, 0
s_add_u32 s43, s17, 1
s_add_u32 s38, s17, 63
s_add_u32 s39, s17, 64
s_mov_b32 s34, s24
v_mov_b32 v7, 0
s_mov_b32 s20, 412672
s_mov_b32 s21, 416768
buffer_load_dwordx4 v[64:67], v0, s[4:7], s65 offen offset:0 sc1
buffer_load_dwordx4 v[68:71], v0, s[4:7], s65 offen offset:1024 sc1
buffer_load_dwordx4 v[72:75], v0, s[4:7], s65 offen offset:2048 sc1
buffer_load_dwordx4 v[76:79], v0, s[4:7], s65 offen offset:3072 sc1
ds_read_b128 v[80:83], v2 offset:0
ds_read_b128 v[84:87], v2 offset:1024
buffer_load_dwordx4 v[48:51], v0, s[4:7], s66 offen offset:0 sc1
buffer_load_dwordx4 v[52:55], v0, s[4:7], s66 offen offset:1024 sc1
buffer_load_dwordx4 v[56:59], v0, s[4:7], s66 offen offset:2048 sc1
buffer_load_dwordx4 v[60:63], v0, s[4:7], s66 offen offset:3072 sc1
v_mov_b64 v[8:9], 0
v_mov_b64 v[10:11], 0
v_mov_b64 v[12:13], 0
v_mov_b64 v[14:15], 0
v_mov_b64 v[16:17], 0
v_mov_b64 v[18:19], 0
v_mov_b64 v[20:21], 0
v_mov_b64 v[22:23], 0
v_mov_b64 v[24:25], 0
v_mov_b64 v[26:27], 0
v_mov_b64 v[28:29], 0
v_mov_b64 v[30:31], 0
s_barrier
v_bfe_u32 v7, v0, 2, 3
v_add_u32 v7, s28, v7
s_mov_b32 exec_hi, 0
v_and_b32 v7, 255, v0
v_lshl_add_u32 v7, v7, 3, s34
s_mov_b32 exec_hi, -1
s_mov_b32 s37, 0
gather_118:
buffer_load_dwordx4 v[32:35], v0, s[4:7], s20 offen sc1
buffer_load_dwordx4 v[36:39], v0, s[4:7], s21 offen sc1
s_add_u32 s37, s37, 1
s_cmp_gt_u32 s37, 262144
s_cbranch_scc1 L_fail
s_waitcnt vmcnt(1)
v_bitop3_b32 v44, v32, v34, s18 bitop3:0x7e
s_waitcnt vmcnt(0)
v_bitop3_b32 v45, v36, v38, s18 bitop3:0x7e
v_bitop3_b32 v44, v44, v45, s19 bitop3:0xa8
v_cmp_ne_u32 vcc, 0, v44
s_cbranch_vccnz gather_118
v_smfmac_f32_16x16x64_bf16 v[8:11], v[32:35], v[64:71], v1
ds_write_b128 v0, v[32:35] offset:3072
buffer_load_dwordx4 v[64:67], v0, s[4:7], s67 offen offset:0 sc1
v_smfmac_f32_16x16x64_bf16 v[12:15], v[32:35], v[72:79], v1
ds_write_b128 v0, v[36:39] offset:7168
v_smfmac_f32_16x16x64_bf16 v[20:23], v[32:35], v[56:63], v1
buffer_load_dwordx4 v[68:71], v0, s[4:7], s67 offen offset:1024 sc1
s_waitcnt lgkmcnt(2)
v_smfmac_f32_16x16x64_bf16 v[24:27], v[32:35], v[80:87], v1
v_smfmac_f32_16x16x64_bf16 v[8:11], v[36:39], a[8:15], v1
ds_read_b128 v[80:83], v2 offset:2048
buffer_load_dwordx4 v[72:75], v0, s[4:7], s67 offen offset:2048 sc1
v_smfmac_f32_16x16x64_bf16 v[16:19], v[32:35], v[48:55], v1
s_waitcnt lgkmcnt(1)
ds_read_b128 v[84:87], v2 offset:3072
buffer_load_dwordx4 v[76:79], v0, s[4:7], s67 offen offset:3072 sc1
v_smfmac_f32_16x16x64_bf16 v[16:19], v[36:39], a[24:31], v1
buffer_load_dwordx4 v[48:51], v0, s[4:7], s24 offen offset:0 nt sc1
buffer_load_dwordx4 v[52:55], v0, s[4:7], s24 offen offset:1024 nt sc1
v_smfmac_f32_16x16x64_bf16 v[28:31], v[32:35], a[0:7], v1
s_barrier
ds_read_b128 v[40:43], v0 offset:2048
v_smfmac_f32_16x16x64_bf16 v[28:31], v[36:39], a[40:47], v1
s_waitcnt lgkmcnt(1)
ds_read_b128 v[44:47], v0 offset:6144
ds_read_b128 v[32:35], v0 offset:1024
v_smfmac_f32_16x16x64_bf16 v[24:27], v[36:39], v[80:87], v1
v_smfmac_f32_16x16x64_bf16 v[12:15], v[36:39], a[16:23], v1
ds_read_b128 v[84:87], v2 offset:5120
ds_read_b128 v[80:83], v2 offset:4096
v_smfmac_f32_16x16x64_bf16 v[20:23], v[36:39], a[32:39], v1
ds_read_b128 v[36:39], v0 offset:5120
s_waitcnt lgkmcnt(5)
v_smfmac_f32_16x16x64_bf16 v[8:11], v[40:43], a[48:55], v1
buffer_load_dwordx4 v[56:59], v0, s[4:7], s24 offen offset:2048 nt sc1
v_smfmac_f32_16x16x64_bf16 v[12:15], v[40:43], a[56:63], v1
s_waitcnt lgkmcnt(4)
ds_read_b128 v[40:43], v0 offset:0
s_xor_b32 s18, s18, 1
v_smfmac_f32_16x16x64_bf16 v[12:15], v[44:47], a[72:79], v1
s_waitcnt lgkmcnt(4)
buffer_load_dwordx4 v[60:63], v0, s[4:7], s24 offen offset:3072 nt sc1
v_smfmac_f32_16x16x64_bf16 v[8:11], v[44:47], a[64:71], v1
s_waitcnt lgkmcnt(3)
s_waitcnt lgkmcnt(2)
v_smfmac_f32_16x16x64_bf16 v[8:11], v[32:35], v[80:87], v1
s_waitcnt vmcnt(7)
ds_read_b128 v[84:87], v2 offset:7168
s_add_u32 s24, s24, 524288
v_smfmac_f32_16x16x64_bf16 v[12:15], v[32:35], a[80:87], v1
ds_read_b128 v[32:35], v0 offset:4096
s_waitcnt lgkmcnt(2)
v_smfmac_f32_16x16x64_bf16 v[8:11], v[36:39], a[88:95], v1
ds_read_b128 v[80:83], v2 offset:6144
v_smfmac_f32_16x16x64_bf16 v[12:15], v[36:39], a[96:103], v1
s_waitcnt vmcnt(6)
ds_read_b128 v[36:39], v0 offset:9216
v_add_u32 v44, s30, v0
v_smfmac_f32_16x16x64_bf16 v[8:11], v[40:43], v[64:71], v1
ds_read_b128 v[64:67], v2 offset:8192
ds_read_b128 v[68:71], v2 offset:9216
v_mov_b32 v47, s17
v_smfmac_f32_16x16x64_bf16 v[12:15], v[40:43], a[104:111], v1
ds_read_b128 v[40:43], v0 offset:8192
s_waitcnt lgkmcnt(5)
v_smfmac_f32_16x16x64_bf16 v[12:15], v[32:35], a[112:119], v1
s_waitcnt lgkmcnt(4)
buffer_load_dword v7, v7, s[4:7], 0 offen sc1
v_smfmac_f32_16x16x64_bf16 v[8:11], v[32:35], v[80:87], v1
s_waitcnt lgkmcnt(3)
ds_read_b128 v[32:35], v0 offset:2048
ds_read_b128 v[84:87], v2 offset:11264
v_smfmac_f32_16x16x64_bf16 v[8:11], v[36:39], a[120:127], v1
s_mov_b64 exec, 1
buffer_store_dword v47, off, s[4:7], s29 sc1
s_mov_b64 exec, -1
ds_read_b128 v[80:83], v2 offset:10240
v_smfmac_f32_16x16x64_bf16 v[12:15], v[36:39], a[128:135], v1
s_waitcnt lgkmcnt(4)
ds_read_b128 v[36:39], v0 offset:6144
s_waitcnt lgkmcnt(4)
v_smfmac_f32_16x16x64_bf16 v[8:11], v[40:43], v[64:71], v1
s_waitcnt vmcnt(6)
ds_read_b128 v[64:67], v2 offset:12288
ds_read_b128 v[68:71], v2 offset:13312
v_smfmac_f32_16x16x64_bf16 v[12:15], v[40:43], a[136:143], v1
s_waitcnt lgkmcnt(5)
ds_read_b128 v[44:47], v44
ds_read_b128 v[40:43], v0 offset:1024
v_smfmac_f32_16x16x64_bf16 v[16:19], v[32:35], v[72:79], v1
s_nop 0
ds_read_b128 v[72:75], v2 offset:14336
v_add_f32 v9, v9, v11
v_add_f32 v8, v8, v10
v_add_f32 v13, v13, v15
v_add_f32 v12, v12, v14
v_mul_f32 v9, s44, v9
s_waitcnt lgkmcnt(5)
v_mul_f32 v8, s44, v8
v_mul_f32 v12, s44, v12
v_mul_f32 v13, s44, v13
v_cvt_pk_bf16_f32 v12, v12, v13
v_cvt_pk_bf16_f32 v8, v8, v9
v_smfmac_f32_16x16x64_bf16 v[20:23], v[32:35], v[80:87], v1
s_add_u32 s17, s17, 1
ds_read_b128 v[32:35], v0 offset:5120
ds_write2_b32 v3, v8, v12 offset0:0 offset1:128
v_smfmac_f32_16x16x64_bf16 v[16:19], v[36:39], a[144:151], v1
s_waitcnt lgkmcnt(4)
ds_read_b128 v[80:83], v2 offset:16384
v_swap_b32 v45, v46
v_smfmac_f32_16x16x64_bf16 v[20:23], v[36:39], a[152:159], v1
ds_read_b128 v[36:39], v0 offset:0
ds_read_b128 v[76:79], v2 offset:15360
buffer_store_dwordx4 v[44:47], v0, s[4:7], s25 offen sc1
s_waitcnt vmcnt(5)
s_waitcnt lgkmcnt(4)
v_smfmac_f32_16x16x64_bf16 v[16:19], v[40:43], a[160:167], v1
ds_read_b128 v[84:87], v2 offset:17408
v_smfmac_f32_16x16x64_bf16 v[20:23], v[40:43], v[64:71], v1
s_waitcnt lgkmcnt(4)
ds_read_b128 v[40:43], v0 offset:4096
ds_read_b128 v[64:67], v2 offset:18432
v_smfmac_f32_16x16x64_bf16 v[16:19], v[32:35], a[168:175], v1
s_barrier
v_smfmac_f32_16x16x64_bf16 v[20:23], v[32:35], a[176:183], v1
s_waitcnt lgkmcnt(3)
ds_read_b128 v[32:35], v0 offset:9216
ds_read_b64_tr_b16 v[12:13], v4 offset:3072
v_smfmac_f32_16x16x64_bf16 v[16:19], v[36:39], a[184:191], v1
ds_read_b64_tr_b16 v[10:11], v4 offset:2560
v_smfmac_f32_16x16x64_bf16 v[20:23], v[36:39], v[72:79], v1
s_waitcnt lgkmcnt(4)
ds_read_b128 v[36:39], v0 offset:8192
ds_read_b64_tr_b16 v[8:9], v4 offset:2048
v_smfmac_f32_16x16x64_bf16 v[16:19], v[40:43], a[192:199], v1
ds_read_b64_tr_b16 v[14:15], v4 offset:3584
ds_read_b128 v[76:79], v2 offset:21504
v_smfmac_f32_16x16x64_bf16 v[20:23], v[40:43], a[200:207], v1
ds_read_b128 v[40:43], v0 offset:2048
s_waitcnt lgkmcnt(7)
v_smfmac_f32_16x16x64_bf16 v[20:23], v[32:35], v[80:87], v1
ds_read_b128 v[68:71], v2 offset:19456
ds_read_b128 v[84:87], v2 offset:23552
v_smfmac_f32_16x16x64_bf16 v[16:19], v[32:35], a[208:215], v1
s_waitcnt lgkmcnt(6)
ds_read_b128 v[72:75], v2 offset:20480
v_smfmac_f32_16x16x64_bf16 v[20:23], v[36:39], a[224:231], v1
s_waitcnt lgkmcnt(6)
ds_read_b128 v[32:35], v0 offset:6144
ds_read_b128 v[80:83], v2 offset:22528
v_smfmac_f32_16x16x64_bf16 v[16:19], v[36:39], a[216:223], v1
ds_read_b128 v[36:39], v0 offset:1024
s_waitcnt lgkmcnt(7)
v_mfma_f32_16x16x32_bf16 v[44:47], v[48:51], v[8:11], 0
s_nop 0
v_add_f32 v20, v20, v22
v_add_f32 v21, v21, v23
v_mfma_f32_16x16x32_bf16 v[44:47], v[52:55], v[12:15], v[44:47]
s_nop 0
v_add_f32 v17, v17, v19
v_add_f32 v16, v16, v18
v_xor_b32 v48, 128, v5
s_waitcnt lgkmcnt(5)
v_cvt_pk_bf16_f32 v20, v20, v21
v_smfmac_f32_16x16x64_bf16 v[28:31], v[40:43], a[232:239], v1
s_mov_b64 exec, s[54:55]
ds_write_b128 v48, v[44:47] offset:1536
s_mov_b64 exec, -1
v_smfmac_f32_16x16x64_bf16 v[24:27], v[40:43], v[64:71], v1
s_waitcnt lgkmcnt(3)
ds_read_b128 v[40:43], v0 offset:5120
v_cvt_pk_bf16_f32 v16, v16, v17
v_smfmac_f32_16x16x64_bf16 v[24:27], v[32:35], a[240:247], v1
ds_write2_b32 v3, v16, v20 offset0:1 offset1:129
v_smfmac_f32_16x16x64_bf16 v[28:31], v[32:35], v[72:79], v1
s_waitcnt lgkmcnt(3)
ds_read_b128 v[32:35], v0 offset:0
buffer_load_dwordx4 v[64:67], v0, s[4:7], s68 offen offset:0 sc1
v_smfmac_f32_16x16x64_bf16 v[24:27], v[36:39], a[248:255], v1
buffer_load_dwordx4 v[68:71], v0, s[4:7], s68 offen offset:1024 sc1
v_smfmac_f32_16x16x64_bf16 v[28:31], v[36:39], v[88:95], v1
ds_read_b128 v[36:39], v0 offset:4096
s_waitcnt lgkmcnt(3)
v_smfmac_f32_16x16x64_bf16 v[24:27], v[40:43], v[96:103], v1
s_mov_b32 s20, 396288
buffer_load_dwordx4 v[72:75], v0, s[4:7], s68 offen offset:2048 sc1
v_smfmac_f32_16x16x64_bf16 v[28:31], v[40:43], v[80:87], v1
s_waitcnt lgkmcnt(2)
ds_read_b128 v[40:43], v0 offset:9216
s_waitcnt lgkmcnt(2)
v_smfmac_f32_16x16x64_bf16 v[28:31], v[32:35], v[112:119], v1
s_barrier
ds_read_b128 v[52:55], v6 offset:1024
v_smfmac_f32_16x16x64_bf16 v[24:27], v[32:35], v[104:111], v1
s_waitcnt lgkmcnt(2)
ds_read_b128 v[32:35], v0 offset:8192
ds_read_b128 v[48:51], v6 offset:0
v_smfmac_f32_16x16x64_bf16 v[24:27], v[36:39], v[120:127], v1
ds_read_b64_tr_b16 v[8:9], v4 offset:0
ds_read_b64_tr_b16 v[10:11], v4 offset:512
v_smfmac_f32_16x16x64_bf16 v[28:31], v[36:39], v[128:135], v1
s_waitcnt lgkmcnt(5)
buffer_load_dwordx4 v[76:79], v0, s[4:7], s68 offen offset:3072 sc1
v_smfmac_f32_16x16x64_bf16 v[28:31], v[40:43], v[144:151], v1
buffer_load_dwordx4 v[80:83], v0, s[4:7], s69 offen offset:0 sc1
ds_read_b64_tr_b16 v[20:21], v4 offset:3072
ds_read_b64_tr_b16 v[18:19], v4 offset:2560
v_smfmac_f32_16x16x64_bf16 v[24:27], v[40:43], v[136:143], v1
s_waitcnt lgkmcnt(5)
ds_read_b64_tr_b16 v[12:13], v4 offset:1024
ds_read_b64_tr_b16 v[14:15], v4 offset:1536
v_smfmac_f32_16x16x64_bf16 v[28:31], v[32:35], v[160:167], v1
s_waitcnt lgkmcnt(6)
ds_read_b64_tr_b16 v[16:17], v4 offset:2048
v_add_f32 v48, v48, v52
v_smfmac_f32_16x16x64_bf16 v[24:27], v[32:35], v[152:159], v1
s_waitcnt lgkmcnt(5)
ds_read_b64_tr_b16 v[22:23], v4 offset:3584
v_add_f32 v51, v51, v55
v_exp_f32 v48, v48
v_add_f32 v50, v50, v54
v_exp_f32 v51, v51
v_exp_f32 v50, v50
v_mfma_f32_16x16x32_bf16 v[44:47], v[8:11], v[8:11], 0
s_waitcnt lgkmcnt(1)
v_cvt_pk_bf16_f32 v55, v50, v51
v_add_f32 v49, v49, v53
v_mfma_f32_16x16x32_bf16 v[44:47], v[12:15], v[12:15], v[44:47]
s_waitcnt vmcnt(8)
v_exp_f32 v49, v49
v_mfma_f32_16x16x32_bf16 v[44:47], v[16:19], v[16:19], v[44:47]
s_waitcnt lgkmcnt(0)
v_cvt_pk_bf16_f32 v54, v48, v49
v_mov_b32_dpp v51, v55 quad_perm:[2,3,2,3] row_mask:0xf bank_mask:0xf
v_mfma_f32_16x16x32_bf16 v[44:47], v[20:23], v[20:23], v[44:47]
v_mov_b32_dpp v50, v54 quad_perm:[2,3,2,3] row_mask:0xf bank_mask:0xf
v_mov_b32_dpp v48, v54 quad_perm:[0,1,0,1] row_mask:0xf bank_mask:0xf
v_mov_b32_dpp v49, v55 quad_perm:[0,1,0,1] row_mask:0xf bank_mask:0xf
v_mov_b64 v[22:23], s[56:57]
v_mov_b64 v[54:55], s[58:59]
v_mfma_f32_16x16x32_bf16 v[12:15], v[60:63], v[48:51], 0
s_nop 0
v_mov_b64 v[20:21], s[56:57]
v_exp_f32_dpp v44, v46 quad_perm:[0,1,0,1] row_mask:0xf bank_mask:0xf
v_mfma_f32_16x16x32_bf16 v[8:11], v[56:59], v[48:51], 0
v_exp_f32_dpp v45, v47 quad_perm:[0,1,0,1] row_mask:0xf bank_mask:0xf
v_mfma_f32_16x16x32_bf16 v[16:19], v[20:23], v[48:51], 0
s_nop 0
v_cvt_pk_bf16_f32 v53, v44, v45
v_cvt_pk_bf16_f32 v24, v24, v25
v_cvt_pk_bf16_f32 v52, v44, v45
v_cvt_pk_bf16_f32 v25, v26, v27
v_mov_b64 v[38:39], 0
v_mfma_f32_16x16x16_bf16 v[16:19], v[54:55], v[52:53], v[16:19]
s_nop 0
v_cvt_pk_bf16_f32 v27, v30, v31
v_cvt_pk_bf16_f32 v26, v28, v29
v_mfma_f32_16x16x16_bf16 v[8:11], v[24:25], v[52:53], v[8:11]
s_nop 0
buffer_load_dwordx4 v[84:87], v0, s[4:7], s69 offen offset:1024 sc1
v_mfma_f32_16x16x16_bf16 v[12:15], v[26:27], v[52:53], v[12:15]
s_barrier
v_rcp_f32 v18, v16
v_subrev_u32 v17, s46, v16
v_mov_b64 v[40:41], 0
v_mov_b64 v[34:35], 0
v_mul_f32 v8, v8, v18
v_mul_f32 v9, v9, v18
v_cvt_pk_bf16_f32 v8, v8, v9
v_mul_f32 v10, v10, v18
v_mul_f32 v13, v13, v18
v_mul_f32 v11, v11, v18
v_cvt_pk_bf16_f32 v9, v10, v11
v_mul_f32 v12, v12, v18
v_cmp_lt_u32 vcc, s47, v17
v_mul_f32 v14, v14, v18
v_mul_f32 v15, v15, v18
v_cvt_pk_bf16_f32 v11, v14, v15
v_mov_b64 v[32:33], 0
s_waitcnt vmcnt(4)
v_cvt_pk_bf16_f32 v10, v12, v13
s_cbranch_vccnz rare_119
back_120:
s_mov_b64 exec, s[54:55]
ds_write_b128 v5, v[8:11] offset:1536
s_mov_b64 exec, -1
v_mov_b64 v[48:49], 0
v_mov_b64 v[50:51], 0
v_smfmac_f32_16x16x64_bf16 v[32:35], v[8:11], v[64:71], v1
s_add_u32 s25, s25, 10240
ds_read_b128 v[16:19], v0 offset:53248
v_mov_b64 v[36:37], 0
v_mov_b64 v[42:43], 0
v_smfmac_f32_16x16x64_bf16 v[48:51], v[8:11], v[176:183], v1
ds_read_b128 v[28:31], v0 offset:56320
buffer_load_dwordx4 v[64:67], v0, s[4:7], s65 offen offset:0 sc1
ds_read_b128 v[24:27], v0 offset:55296
v_smfmac_f32_16x16x64_bf16 v[40:43], v[8:11], v[168:175], v1
ds_read_b128 v[20:23], v0 offset:54272
s_add_u32 s43, s17, 2
s_waitcnt lgkmcnt(4)
s_barrier
ds_read_b128 v[56:59], v5 offset:1024
buffer_load_dwordx4 v[68:71], v0, s[4:7], s65 offen offset:1024 sc1
s_waitcnt vmcnt(4)
ds_read_b128 v[12:15], v5 offset:0
v_smfmac_f32_16x16x64_bf16 v[36:39], v[8:11], v[72:79], v1
s_waitcnt lgkmcnt(5)
ds_read_b128 v[60:63], v5 offset:512
v_mov_b64 v[54:55], 0
s_waitcnt lgkmcnt(3)
s_mov_b32 s37, 0
s_mov_b32 s19, 1
buffer_load_dwordx4 v[72:75], v0, s[4:7], s65 offen offset:2048 sc1
v_bfe_u32 v45, v0, 1, 7
v_mov_b64 v[52:53], 0
s_waitcnt lgkmcnt(2)
v_smfmac_f32_16x16x64_bf16 v[32:35], v[56:59], v[16:23], v1
buffer_load_dwordx4 v[76:79], v0, s[4:7], s65 offen offset:3072 sc1
ds_read_b128 v[16:19], v0 offset:59392
v_smfmac_f32_16x16x64_bf16 v[48:51], v[56:59], v[216:223], v1
s_waitcnt lgkmcnt(2)
ds_read_b128 v[20:23], v0 offset:60416
v_lshrrev_b32 v44, 8, v0
s_waitcnt vmcnt(5)
s_waitcnt vmcnt(4)
v_smfmac_f32_16x16x64_bf16 v[52:55], v[8:11], v[80:87], v1
s_waitcnt lgkmcnt(2)
ds_read_b128 v[84:87], v0 offset:58368
s_mov_b32 s21, 400384
v_smfmac_f32_16x16x64_bf16 v[32:35], v[60:63], v[24:31], v1
ds_read_b128 v[80:83], v0 offset:57344
s_min_u32 s43, s43, s39
v_smfmac_f32_16x16x64_bf16 v[32:35], v[12:15], v[184:191], v1
s_waitcnt lgkmcnt(3)
ds_read_b128 v[24:27], v0 offset:61440
s_waitcnt lgkmcnt(3)
v_smfmac_f32_16x16x64_bf16 v[40:43], v[56:59], v[16:23], v1
ds_read_b128 v[28:31], v0 offset:62464
v_lshl_or_b32 v44, v44, 12, v45
v_smfmac_f32_16x16x64_bf16 v[36:39], v[56:59], v[192:199], v1
s_waitcnt lgkmcnt(3)
v_cvt_pk_bf16_f32 v32, v32, v33
v_cvt_pk_bf16_f32 v33, v34, v35
v_and_or_b32 v32, v32, -2, s18
s_waitcnt lgkmcnt(2)
v_smfmac_f32_16x16x64_bf16 v[36:39], v[60:63], v[80:87], v1
buffer_store_dwordx2 v[32:33], v44, s[4:7], s60 offen
v_smfmac_f32_16x16x64_bf16 v[36:39], v[12:15], v[200:207], v1
s_waitcnt lgkmcnt(1)
s_waitcnt lgkmcnt(0)
ds_read_b128 v[80:83], v0 offset:63488
v_smfmac_f32_16x16x64_bf16 v[40:43], v[60:63], v[24:31], v1
s_nop 0
ds_read_b128 v[84:87], v0 offset:64512
s_add_u32 s34, s24, 524288
s_nop 0
v_cvt_pk_bf16_f32 v36, v36, v37
v_and_or_b32 v36, v36, -2, s18
v_cvt_pk_bf16_f32 v37, v38, v39
v_smfmac_f32_16x16x64_bf16 v[40:43], v[12:15], v[208:215], v1
buffer_store_dwordx2 v[36:37], v44, s[4:7], s61 offen
v_smfmac_f32_16x16x64_bf16 v[52:55], v[56:59], v[232:239], v1
s_nop 2
v_smfmac_f32_16x16x64_bf16 v[52:55], v[60:63], v[240:247], v1
s_nop 0
s_waitcnt lgkmcnt(0)
v_cvt_pk_bf16_f32 v40, v40, v41
v_cvt_pk_bf16_f32 v41, v42, v43
v_and_or_b32 v40, v40, -2, s18
v_smfmac_f32_16x16x64_bf16 v[48:51], v[60:63], v[80:87], v1
buffer_store_dwordx2 v[40:41], v44, s[4:7], s62 offen
v_smfmac_f32_16x16x64_bf16 v[48:51], v[12:15], v[224:231], v1
s_nop 2
v_smfmac_f32_16x16x64_bf16 v[52:55], v[12:15], v[248:255], v1
s_nop 3
v_cvt_pk_bf16_f32 v48, v48, v49
v_and_or_b32 v48, v48, -2, s18
v_cvt_pk_bf16_f32 v49, v50, v51
buffer_store_dwordx2 v[48:49], v44, s[4:7], s63 offen
v_cvt_pk_bf16_f32 v52, v52, v53
v_cvt_pk_bf16_f32 v53, v54, v55
v_and_or_b32 v52, v52, -2, s18
buffer_store_dwordx2 v[52:53], v44, s[4:7], s64 offen
ds_read_b128 v[80:83], v2 offset:0
ds_read_b128 v[84:87], v2 offset:1024
v_mov_b64 v[24:25], 0
v_mov_b64 v[26:27], 0
v_mov_b64 v[28:29], 0
v_mov_b64 v[30:31], 0
v_bfe_u32 v7, v0, 2, 3
v_add_u32 v7, s28, v7
s_mov_b32 exec_hi, 0
v_and_b32 v7, 255, v0
v_lshl_add_u32 v7, v7, 3, s34
s_mov_b32 exec_hi, -1
v_mov_b64 v[8:9], 0
v_mov_b64 v[10:11], 0
v_mov_b64 v[12:13], 0
v_mov_b64 v[14:15], 0
v_mov_b64 v[16:17], 0
v_mov_b64 v[18:19], 0
v_mov_b64 v[20:21], 0
v_mov_b64 v[22:23], 0
s_nop 15
s_nop 15
s_nop 15
s_nop 15
s_nop 15
s_nop 7
s_barrier
buffer_load_dwordx4 v[48:51], v0, s[4:7], s66 offen offset:0 sc1
buffer_load_dwordx4 v[52:55], v0, s[4:7], s66 offen offset:1024 sc1
buffer_load_dwordx4 v[56:59], v0, s[4:7], s66 offen offset:2048 sc1
buffer_load_dwordx4 v[60:63], v0, s[4:7], s66 offen offset:3072 sc1
s_nop 15
s_nop 15
s_nop 15
s_nop 13
s_mov_b32 s37, 0
s_cmp_eq_u32 s17, s38
s_barrier
s_nop 15
s_nop 7
s_cbranch_scc0 gather_118
s_branch exit_121
rare_119:
ds_read_b128 v[48:51], v6 offset:0
ds_read_b128 v[52:55], v6 offset:1024
s_waitcnt lgkmcnt(0)
s_barrier
v_add_f32 v48, v48, v52
v_add_f32 v49, v49, v53
v_add_f32 v50, v50, v54
v_add_f32 v51, v51, v55
v_mov_b32_dpp v46, v46 quad_perm:[0,1,0,1] row_mask:0xf bank_mask:0xf
v_mov_b32_dpp v47, v47 quad_perm:[0,1,0,1] row_mask:0xf bank_mask:0xf
v_max3_f32 v19, v48, v49, v50
v_max3_f32 v19, v19, v51, v46
v_max_f32 v19, v19, v47
s_nop 1
v_max_f32_dpp v19, v19, v19 quad_perm:[2,3,0,1] row_mask:0xf bank_mask:0xf
v_mov_b32 v44, v19
s_nop 1
v_permlane32_swap_b32 v19, v44
v_max_f32 v19, v19, v44
v_mov_b32 v44, v19
s_nop 1
v_permlane16_swap_b32 v19, v44
v_max_f32 v19, v19, v44
v_sub_f32 v48, v48, v19
v_sub_f32 v49, v49, v19
v_sub_f32 v50, v50, v19
v_sub_f32 v51, v51, v19
v_sub_f32 v46, v46, v19
v_sub_f32 v47, v47, v19
v_exp_f32 v48, v48
v_exp_f32 v49, v49
v_exp_f32 v50, v50
v_exp_f32 v51, v51
v_cvt_pk_bf16_f32 v54, v48, v49
v_cvt_pk_bf16_f32 v55, v50, v51
s_nop 0
v_mov_b32_dpp v48, v54 quad_perm:[0,1,0,1] row_mask:0xf bank_mask:0xf
v_mov_b32_dpp v49, v55 quad_perm:[0,1,0,1] row_mask:0xf bank_mask:0xf
v_mov_b32_dpp v50, v54 quad_perm:[2,3,2,3] row_mask:0xf bank_mask:0xf
v_mov_b32_dpp v51, v55 quad_perm:[2,3,2,3] row_mask:0xf bank_mask:0xf
v_mov_b64 v[20:21], s[56:57]
v_mov_b64 v[22:23], s[56:57]
v_mfma_f32_16x16x32_bf16 v[8:11], v[56:59], v[48:51], 0
v_mfma_f32_16x16x32_bf16 v[12:15], v[60:63], v[48:51], 0
v_mfma_f32_16x16x32_bf16 v[16:19], v[20:23], v[48:51], 0
v_mov_b64 v[54:55], s[58:59]
v_exp_f32_dpp v44, v46 quad_perm:[0,1,0,1] row_mask:0xf bank_mask:0xf
v_exp_f32_dpp v45, v47 quad_perm:[0,1,0,1] row_mask:0xf bank_mask:0xf
s_nop 0
v_cvt_pk_bf16_f32 v52, v44, v45
v_cvt_pk_bf16_f32 v53, v44, v45
s_nop 1
v_mfma_f32_16x16x16_bf16 v[16:19], v[54:55], v[52:53], v[16:19]
v_mfma_f32_16x16x16_bf16 v[8:11], v[24:25], v[52:53], v[8:11]
v_mfma_f32_16x16x16_bf16 v[12:15], v[26:27], v[52:53], v[12:15]
s_nop 5
v_rcp_f32 v18, v16
s_nop 0
v_mul_f32 v8, v8, v18
v_mul_f32 v9, v9, v18
v_mul_f32 v10, v10, v18
v_mul_f32 v11, v11, v18
v_mul_f32 v12, v12, v18
v_mul_f32 v13, v13, v18
v_mul_f32 v14, v14, v18
v_mul_f32 v15, v15, v18
v_cvt_pk_bf16_f32 v8, v8, v9
v_cvt_pk_bf16_f32 v9, v10, v11
v_cvt_pk_bf16_f32 v10, v12, v13
v_cvt_pk_bf16_f32 v11, v14, v15
s_branch back_120
exit_121:
buffer_load_dwordx4 v[32:35], v0, s[4:7], s20 offen sc1
buffer_load_dwordx4 v[36:39], v0, s[4:7], s21 offen sc1
s_add_u32 s37, s37, 1
s_cmp_gt_u32 s37, 262144
s_cbranch_scc1 L_fail
s_waitcnt vmcnt(1)
v_bitop3_b32 v44, v32, v34, s18 bitop3:0x7e
s_waitcnt vmcnt(0)
v_bitop3_b32 v45, v36, v38, s18 bitop3:0x7e
v_bitop3_b32 v44, v44, v45, s19 bitop3:0xa8
v_cmp_ne_u32 vcc, 0, v44
s_cbranch_vccnz exit_121
ds_write_b128 v0, v[32:35] offset:3072
ds_write_b128 v0, v[36:39] offset:7168
s_waitcnt lgkmcnt(0)
s_barrier
v_add_u32 v44, s30, v0
ds_read_b128 v[44:47], v44
s_waitcnt lgkmcnt(0)
v_swap_b32 v45, v46
buffer_store_dwordx4 v[44:47], v0, s[4:7], s25 offen sc1
s_add_u32 s33, s17, 1
s_waitcnt vmcnt(0)
v_mov_b32 v44, s33
s_mov_b64 exec, 1
buffer_store_dword v44, off, s[4:7], s29 sc1
s_mov_b64 exec, -1
s_barrier
s_add_u32 s45, s45, 1
s_cmp_lt_u32 s45, 2
s_cbranch_scc1 layer_117
s_endpgm
grp_73:
s_mov_b32 s15, s14
s_mov_b32 s16, s13
s_lshr_b32 s30, s14, 1
v_and_b32 v64, 63, v0
v_and_b32 v65, 15, v64
v_lshrrev_b32 v66, 4, v64
v_lshlrev_b32 v0, 4, v64
v_and_b32 v67, 2, v64
v_mov_b32 v68, 0x4444
v_mov_b32 v69, 0xeeee
v_cmp_eq_u32 vcc, 0, v67
s_nop 1
v_cndmask_b32 v1, v69, v68, vcc
s_mul_i32 s33, s16, 24576
s_add_u32 s33, s33, 65536
v_add_u32 v2, s33, v0
v_lshrrev_b32 v67, 2, v65
v_xor_b32 v68, v66, v67
v_lshlrev_b32 v68, 3, v68
v_lshl_add_u32 v68, v65, 5, v68
s_lshl_b32 s33, s16, 10
s_add_u32 s33, s33, 10240
s_waitcnt vmcnt(1)
v_add_u32 v3, s33, v68
v_lshl_add_u32 v68, v66, 2, v67
v_and_b32 v69, 3, v65
v_xor_b32 v69, v69, v66
v_lshlrev_b32 v69, 3, v69
v_lshl_add_u32 v68, v68, 5, v69
s_waitcnt vmcnt(0)
v_add_u32 v4, 10240, v68
v_and_b32 v69, 1, v65
v_lshl_add_u32 v68, v67, 1, v69
v_lshlrev_b32 v68, 4, v68
v_lshl_add_u32 v68, v66, 7, v68
v_add_u32 v5, 14336, v68
v_bfe_u32 v69, v65, 1, 1
v_mul_u32_u24 v69, 640, v69
v_xor_b32 v6, v69, v5
s_mov_b32 s54, 0x33333333
s_mov_b32 s55, 0x33333333
s_mov_b32 s56, 0x3f803f80
s_mov_b32 s57, 0x3f803f80
s_mov_b32 s58, 0x3f803f80
s_mov_b32 s59, 0
s_mov_b32 s46, 729808896
s_mov_b32 s47, 671088640
v_lshlrev_b32 v68, 3, v65
v_lshl_add_u32 v7, v66, 12, v68
s_lshl_b32 s33, s16, 14
s_lshl_b32 s34, s15, 7
s_add_u32 s33, s33, s34
s_add_u32 s26, s33, 65536
s_lshl_b32 s33, s16, 5
s_add_u32 s32, s33, s15
s_lshl_b32 s33, s32, 12
s_add_u32 s27, s33, 65536
s_lshr_b32 s33, s32, 2
s_lshl_b32 s33, s33, 9
s_and_b32 s34, s32, 3
s_lshl_b32 s34, s34, 6
s_add_u32 s33, s33, s34
s_add_u32 s40, s33, 393216
s_lshl_b32 s33, s15, 7
s_add_u32 s28, s33, 0
s_lshl_b32 s33, s30, 2
s_add_u32 s33, s33, 4096
s_cmp_lt_u32 s30, 10
s_cselect_b32 s29, s33, 268435456
s_cselect_b32 s30, s30, 0
s_cselect_b32 s31, 12582912, s29
s_lshl_b32 s30, s30, 10
s_and_b32 s33, s15, 3
s_lshl_b32 s33, s33, 7
s_add_u32 s41, s33, 425984
s_lshl_b32 s33, s15, 2
s_add_u32 s42, s33, 425984
s_mov_b32 s44, 0x3e0293ee
s_lshl_b32 s33, s15, 2
s_add_u32 s33, s33, s16
s_mul_i32 s34, s33, 18432
s_add_u32 s23, s34, 1048576
s_add_u32 s60, s26, 0
s_add_u32 s61, s26, 65536
s_add_u32 s62, s26, 131072
s_add_u32 s63, s26, 196608
s_add_u32 s64, s26, 262144
s_add_u32 s65, s23, 0
s_add_u32 s66, s23, 4096
s_add_u32 s67, s23, 8192
s_add_u32 s68, s23, 12288
s_add_u32 s69, s23, 16384
v_mov_b32 v72, 0
v_mov_b32 v73, 0
s_mov_b32 s33, s26
buffer_store_dwordx2 v[72:73], v7, s[4:7], s33 offen
s_add_u32 s33, s33, 65536
buffer_store_dwordx2 v[72:73], v7, s[4:7], s33 offen
s_add_u32 s33, s33, 65536
buffer_store_dwordx2 v[72:73], v7, s[4:7], s33 offen
s_add_u32 s33, s33, 65536
buffer_store_dwordx2 v[72:73], v7, s[4:7], s33 offen
s_add_u32 s33, s33, 65536
buffer_store_dwordx2 v[72:73], v7, s[4:7], s33 offen
s_add_u32 s33, s33, 65536
buffer_store_dword v72, off, s[4:7], s42 offset:0
buffer_store_dword v72, off, s[4:7], s42 offset:128
buffer_store_dword v72, off, s[4:7], s42 offset:256
buffer_store_dword v72, off, s[4:7], s42 offset:384
s_load_dwordx2 s[48:49], s[0:1], 32
s_mov_b32 s50, 10240
s_mov_b32 s51, 0x20000
s_cmp_ge_u32 s32, 80
s_cbranch_scc1 nm0_128
s_and_b32 s33, s32, 3
s_mul_i32 s33, s33, 2560
s_lshr_b32 s34, s32, 2
s_lshl_b32 s34, s34, 6
s_add_u32 s33, s33, s34
v_bfe_u32 v68, v65, 1, 2
v_lshlrev_b32 v68, 4, v68
v_and_b32 v69, 1, v65
v_lshl_add_u32 v68, v69, 2, v68
v_and_b32 v69, 1, v66
v_mul_u32_u24 v69, 1280, v69
v_add_u32 v68, v68, v69
s_waitcnt lgkmcnt(0)
buffer_load_dword v74, v68, s[48:51], s33 offen
buffer_load_dword v75, v68, s[48:51], s33 offen offset:8
v_and_b32 v68, 32, v0
v_bfe_u32 v69, v0, 6, 1
v_lshl_add_u32 v68, v69, 8, v68
v_bfe_u32 v69, v0, 8, 1
v_lshl_add_u32 v68, v69, 4, v68
v_bfe_u32 v69, v0, 4, 1
v_lshl_add_u32 v68, v69, 3, v68
s_add_u32 s34, s40, 16384
buffer_store_dwordx2 v[72:73], v68, s[4:7], s40 offen
s_waitcnt vmcnt(1)
buffer_store_dwordx2 v[74:75], v68, s[4:7], s34 offen
nm0_128:
s_waitcnt vmcnt(0) lgkmcnt(0)
v_lshrrev_b32 v67, 3, v64
v_and_b32 v68, 7, v64
v_lshlrev_b32 v68, 4, v68
v_lshl_add_u32 v32, v67, 13, v68
v_mul_u32_u24 v67, 1280, v67
v_add_u32 v36, v67, v68
v_lshrrev_b32 v67, 1, v66
v_lshlrev_b32 v67, 4, v67
v_and_b32 v68, 1, v66
v_lshl_add_u32 v67, v68, 1, v67
v_lshrrev_b32 v68, 3, v65
v_lshl_add_u32 v67, v68, 3, v67
v_bfe_u32 v68, v65, 2, 1
v_add_u32 v67, v67, v68
v_and_b32 v69, 3, v65
v_lshlrev_b32 v40, 4, v69
v_lshl_add_u32 v40, v67, 7, v40
v_lshl_add_u32 v67, v66, 2, v68
v_lshlrev_b32 v42, 4, v69
v_lshl_add_u32 v42, v67, 7, v42
v_lshrrev_b32 v68, 3, v65
v_lshl_add_u32 v42, v68, 3, v42
s_lshl_b32 s36, s16, 12
s_and_b32 s33, s16, 1
s_lshl_b32 s33, s33, 6
s_add_u32 s33, s33, s36
v_add_u32 v40, s33, v40
v_add_u32 v42, s33, v42
v_xor_b32 v41, 4096, v40
v_xor_b32 v43, 4096, v42
v_add_u32 v33, 64512, v32
v_add_u32 v37, 9216, v36
v_add_u32 v34, 129024, v32
v_add_u32 v38, 18432, v36
v_add_u32 v35, 193536, v32
v_add_u32 v39, 27648, v36
s_lshr_b32 s35, s16, 1
s_lshl_b32 s35, s35, 7
s_lshl_b32 s34, s15, 8
s_add_u32 s34, s34, s35
s_xor_b32 s33, s16, 0
s_lshl_b32 s70, s33, 19
s_add_u32 s70, s70, s34
s_lshl_b32 s73, s15, 2
s_add_u32 s73, s73, s33
s_mul_i32 s73, s73, 40960
s_add_u32 s73, s73, s35
s_xor_b32 s33, s16, 2
s_lshl_b32 s71, s33, 19
s_add_u32 s71, s71, s34
s_lshl_b32 s74, s15, 2
s_add_u32 s74, s74, s33
s_mul_i32 s74, s74, 40960
s_add_u32 s74, s74, s35
s_and_b32 s33, s16, 1
s_add_u32 s33, s33, 8
s_lshl_b32 s72, s33, 19
s_add_u32 s72, s72, s34
s_load_dwordx2 s[76:77], s[0:1], 40
s_mov_b32 s78, 5242880
s_mov_b32 s79, 0x20000
s_load_dwordx2 s[80:81], s[0:1], 48
s_mov_b32 s82, 5242880
s_mov_b32 s83, 0x20000
s_load_dwordx2 s[84:85], s[0:1], 56
s_mov_b32 s86, 5242880
s_mov_b32 s87, 0x20000
s_load_dwordx2 s[88:89], s[0:1], 64
s_mov_b32 s90, 5242880
s_mov_b32 s91, 0x20000
s_add_u32 m0, s36, 0
s_add_u32 s33, s70, 0
s_waitcnt lgkmcnt(0)
buffer_load_dwordx4 v32, s[80:83], s33 offen offset:0 lds
buffer_load_dwordx4 v33, s[80:83], s33 offen offset:1024 lds
buffer_load_dwordx4 v34, s[80:83], s33 offen offset:2048 lds
buffer_load_dwordx4 v35, s[80:83], s33 offen offset:3072 lds
s_add_u32 m0, s36, 16384
s_add_u32 s33, s70, 262144
buffer_load_dwordx4 v32, s[80:83], s33 offen offset:0 lds
buffer_load_dwordx4 v33, s[80:83], s33 offen offset:1024 lds
buffer_load_dwordx4 v34, s[80:83], s33 offen offset:2048 lds
buffer_load_dwordx4 v35, s[80:83], s33 offen offset:3072 lds
s_add_u32 m0, s36, 32768
s_add_u32 s33, s70, 2097152
buffer_load_dwordx4 v32, s[80:83], s33 offen offset:0 lds
buffer_load_dwordx4 v33, s[80:83], s33 offen offset:1024 lds
buffer_load_dwordx4 v34, s[80:83], s33 offen offset:2048 lds
buffer_load_dwordx4 v35, s[80:83], s33 offen offset:3072 lds
s_waitcnt vmcnt(8)
s_barrier
s_add_u32 m0, s36, 49152
s_add_u32 s33, s70, 2359296
buffer_load_dwordx4 v32, s[80:83], s33 offen offset:0 lds
buffer_load_dwordx4 v33, s[80:83], s33 offen offset:1024 lds
buffer_load_dwordx4 v34, s[80:83], s33 offen offset:2048 lds
buffer_load_dwordx4 v35, s[80:83], s33 offen offset:3072 lds
ds_read_b64_tr_b16 v[72:73], v40 offset:0
ds_read_b64_tr_b16 v[74:75], v40 offset:512
ds_read_b64_tr_b16 v[76:77], v40 offset:8
ds_read_b64_tr_b16 v[78:79], v40 offset:520
ds_read_b64_tr_b16 v[80:81], v41 offset:0
ds_read_b64_tr_b16 v[82:83], v41 offset:512
ds_read_b64_tr_b16 v[84:85], v41 offset:8
ds_read_b64_tr_b16 v[86:87], v41 offset:520
s_waitcnt lgkmcnt(6)
buffer_store_dwordx4 v[72:75], v0, s[4:7], s66 offen offset:0
s_waitcnt lgkmcnt(4)
buffer_store_dwordx4 v[76:79], v0, s[4:7], s66 offen offset:2048
s_waitcnt lgkmcnt(2)
buffer_store_dwordx4 v[80:83], v0, s[4:7], s67 offen offset:2048
s_waitcnt lgkmcnt(0)
ds_write_b128 v2, v[84:87] offset:14336
s_waitcnt vmcnt(11)
s_barrier
s_add_u32 m0, s36, 0
s_add_u32 s33, s71, 0
buffer_load_dwordx4 v32, s[80:83], s33 offen offset:0 lds
buffer_load_dwordx4 v33, s[80:83], s33 offen offset:1024 lds
buffer_load_dwordx4 v34, s[80:83], s33 offen offset:2048 lds
buffer_load_dwordx4 v35, s[80:83], s33 offen offset:3072 lds
ds_read_b64_tr_b16 v[72:73], v40 offset:16384
ds_read_b64_tr_b16 v[74:75], v40 offset:16896
ds_read_b64_tr_b16 v[76:77], v40 offset:16392
ds_read_b64_tr_b16 v[78:79], v40 offset:16904
ds_read_b64_tr_b16 v[80:81], v41 offset:16384
ds_read_b64_tr_b16 v[82:83], v41 offset:16896
ds_read_b64_tr_b16 v[84:85], v41 offset:16392
ds_read_b64_tr_b16 v[86:87], v41 offset:16904
s_waitcnt lgkmcnt(6)
buffer_store_dwordx4 v[72:75], v0, s[4:7], s66 offen offset:1024
s_waitcnt lgkmcnt(4)
buffer_store_dwordx4 v[76:79], v0, s[4:7], s66 offen offset:3072
s_waitcnt lgkmcnt(2)
buffer_store_dwordx4 v[80:83], v0, s[4:7], s67 offen offset:3072
s_waitcnt lgkmcnt(0)
ds_write_b128 v2, v[84:87] offset:15360
s_waitcnt vmcnt(14)
s_barrier
s_add_u32 m0, s36, 16384
s_add_u32 s33, s71, 262144
buffer_load_dwordx4 v32, s[80:83], s33 offen offset:0 lds
buffer_load_dwordx4 v33, s[80:83], s33 offen offset:1024 lds
buffer_load_dwordx4 v34, s[80:83], s33 offen offset:2048 lds
buffer_load_dwordx4 v35, s[80:83], s33 offen offset:3072 lds
ds_read_b64_tr_b16 a[24:25], v40 offset:32768
ds_read_b64_tr_b16 a[26:27], v40 offset:33280
ds_read_b64_tr_b16 v[76:77], v40 offset:32776
ds_read_b64_tr_b16 v[78:79], v40 offset:33288
ds_read_b64_tr_b16 a[128:129], v41 offset:32768
ds_read_b64_tr_b16 a[130:131], v41 offset:33280
ds_read_b64_tr_b16 a[136:137], v41 offset:32776
ds_read_b64_tr_b16 a[138:139], v41 offset:33288
s_waitcnt lgkmcnt(4)
ds_write_b128 v2, v[76:79] offset:2048
s_waitcnt vmcnt(14) lgkmcnt(1)
s_barrier
s_add_u32 m0, s36, 32768
s_add_u32 s33, s71, 2097152
buffer_load_dwordx4 v32, s[80:83], s33 offen offset:0 lds
buffer_load_dwordx4 v33, s[80:83], s33 offen offset:1024 lds
buffer_load_dwordx4 v34, s[80:83], s33 offen offset:2048 lds
buffer_load_dwordx4 v35, s[80:83], s33 offen offset:3072 lds
ds_read_b64_tr_b16 a[28:29], v40 offset:49152
ds_read_b64_tr_b16 a[30:31], v40 offset:49664
ds_read_b64_tr_b16 v[76:77], v40 offset:49160
ds_read_b64_tr_b16 v[78:79], v40 offset:49672
ds_read_b64_tr_b16 a[132:133], v41 offset:49152
ds_read_b64_tr_b16 a[134:135], v41 offset:49664
ds_read_b64_tr_b16 a[140:141], v41 offset:49160
ds_read_b64_tr_b16 a[142:143], v41 offset:49672
s_waitcnt lgkmcnt(4)
ds_write_b128 v2, v[76:79] offset:3072
s_waitcnt vmcnt(11) lgkmcnt(1)
s_barrier
s_add_u32 m0, s36, 49152
s_add_u32 s33, s71, 2359296
buffer_load_dwordx4 v32, s[80:83], s33 offen offset:0 lds
buffer_load_dwordx4 v33, s[80:83], s33 offen offset:1024 lds
buffer_load_dwordx4 v34, s[80:83], s33 offen offset:2048 lds
buffer_load_dwordx4 v35, s[80:83], s33 offen offset:3072 lds
ds_read_b64_tr_b16 v[72:73], v40 offset:0
ds_read_b64_tr_b16 v[74:75], v40 offset:512
ds_read_b64_tr_b16 a[144:145], v40 offset:8
ds_read_b64_tr_b16 a[146:147], v40 offset:520
ds_read_b64_tr_b16 v[80:81], v41 offset:0
ds_read_b64_tr_b16 v[82:83], v41 offset:512
ds_read_b64_tr_b16 a[168:169], v41 offset:8
ds_read_b64_tr_b16 a[170:171], v41 offset:520
s_waitcnt lgkmcnt(6)
ds_write_b128 v2, v[72:75] offset:16384
s_waitcnt lgkmcnt(3)
buffer_store_dwordx4 v[80:83], v0, s[4:7], s68 offen offset:0
s_waitcnt vmcnt(9) lgkmcnt(1)
s_barrier
s_add_u32 m0, s36, 0
s_add_u32 s33, s72, 0
buffer_load_dwordx4 v32, s[80:83], s33 offen offset:0 lds
buffer_load_dwordx4 v33, s[80:83], s33 offen offset:1024 lds
buffer_load_dwordx4 v34, s[80:83], s33 offen offset:2048 lds
buffer_load_dwordx4 v35, s[80:83], s33 offen offset:3072 lds
ds_read_b64_tr_b16 v[72:73], v40 offset:16384
ds_read_b64_tr_b16 v[74:75], v40 offset:16896
ds_read_b64_tr_b16 a[148:149], v40 offset:16392
ds_read_b64_tr_b16 a[150:151], v40 offset:16904
ds_read_b64_tr_b16 v[80:81], v41 offset:16384
ds_read_b64_tr_b16 v[82:83], v41 offset:16896
ds_read_b64_tr_b16 a[172:173], v41 offset:16392
ds_read_b64_tr_b16 a[174:175], v41 offset:16904
s_waitcnt lgkmcnt(6)
ds_write_b128 v2, v[72:75] offset:17408
s_waitcnt lgkmcnt(3)
buffer_store_dwordx4 v[80:83], v0, s[4:7], s68 offen offset:1024
s_waitcnt vmcnt(10) lgkmcnt(1)
s_barrier
s_add_u32 m0, s36, 16384
s_add_u32 s33, s72, 262144
buffer_load_dwordx4 v32, s[80:83], s33 offen offset:0 lds
buffer_load_dwordx4 v33, s[80:83], s33 offen offset:1024 lds
buffer_load_dwordx4 v34, s[80:83], s33 offen offset:2048 lds
buffer_load_dwordx4 v35, s[80:83], s33 offen offset:3072 lds
ds_read_b64_tr_b16 a[152:153], v40 offset:32768
ds_read_b64_tr_b16 a[154:155], v40 offset:33280
ds_read_b64_tr_b16 a[160:161], v40 offset:32776
ds_read_b64_tr_b16 a[162:163], v40 offset:33288
ds_read_b64_tr_b16 a[176:177], v41 offset:32768
ds_read_b64_tr_b16 a[178:179], v41 offset:33280
ds_read_b64_tr_b16 v[84:85], v41 offset:32776
ds_read_b64_tr_b16 v[86:87], v41 offset:33288
s_waitcnt lgkmcnt(0)
ds_write_b128 v2, v[84:87] offset:18432
s_waitcnt vmcnt(10)
s_barrier
s_add_u32 m0, s36, 32768
s_add_u32 s33, s70, 0
buffer_load_dwordx4 v32, s[84:87], s33 offen offset:0 lds
buffer_load_dwordx4 v33, s[84:87], s33 offen offset:1024 lds
buffer_load_dwordx4 v34, s[84:87], s33 offen offset:2048 lds
buffer_load_dwordx4 v35, s[84:87], s33 offen offset:3072 lds
ds_read_b64_tr_b16 a[156:157], v40 offset:49152
ds_read_b64_tr_b16 a[158:159], v40 offset:49664
ds_read_b64_tr_b16 a[164:165], v40 offset:49160
ds_read_b64_tr_b16 a[166:167], v40 offset:49672
ds_read_b64_tr_b16 a[180:181], v41 offset:49152
ds_read_b64_tr_b16 a[182:183], v41 offset:49664
ds_read_b64_tr_b16 v[84:85], v41 offset:49160
ds_read_b64_tr_b16 v[86:87], v41 offset:49672
s_waitcnt lgkmcnt(0)
ds_write_b128 v2, v[84:87] offset:19456
s_waitcnt vmcnt(9)
s_barrier
s_add_u32 m0, s36, 49152
s_add_u32 s33, s70, 262144
buffer_load_dwordx4 v32, s[84:87], s33 offen offset:0 lds
buffer_load_dwordx4 v33, s[84:87], s33 offen offset:1024 lds
buffer_load_dwordx4 v34, s[84:87], s33 offen offset:2048 lds
buffer_load_dwordx4 v35, s[84:87], s33 offen offset:3072 lds
ds_read_b64_tr_b16 a[184:185], v40 offset:0
ds_read_b64_tr_b16 a[186:187], v40 offset:512
ds_read_b64_tr_b16 a[192:193], v40 offset:8
ds_read_b64_tr_b16 a[194:195], v40 offset:520
ds_read_b64_tr_b16 a[200:201], v41 offset:0
ds_read_b64_tr_b16 a[202:203], v41 offset:512
ds_read_b64_tr_b16 a[208:209], v41 offset:8
ds_read_b64_tr_b16 a[210:211], v41 offset:520
s_waitcnt vmcnt(8) lgkmcnt(0)
s_barrier
s_add_u32 m0, s36, 0
s_add_u32 s33, s70, 2097152
buffer_load_dwordx4 v32, s[84:87], s33 offen offset:0 lds
buffer_load_dwordx4 v33, s[84:87], s33 offen offset:1024 lds
buffer_load_dwordx4 v34, s[84:87], s33 offen offset:2048 lds
buffer_load_dwordx4 v35, s[84:87], s33 offen offset:3072 lds
ds_read_b64_tr_b16 a[188:189], v40 offset:16384
ds_read_b64_tr_b16 a[190:191], v40 offset:16896
ds_read_b64_tr_b16 a[196:197], v40 offset:16392
ds_read_b64_tr_b16 a[198:199], v40 offset:16904
ds_read_b64_tr_b16 a[204:205], v41 offset:16384
ds_read_b64_tr_b16 a[206:207], v41 offset:16896
ds_read_b64_tr_b16 a[212:213], v41 offset:16392
ds_read_b64_tr_b16 a[214:215], v41 offset:16904
s_waitcnt vmcnt(8) lgkmcnt(0)
s_barrier
s_add_u32 m0, s36, 16384
s_add_u32 s33, s70, 2359296
buffer_load_dwordx4 v32, s[84:87], s33 offen offset:0 lds
buffer_load_dwordx4 v33, s[84:87], s33 offen offset:1024 lds
buffer_load_dwordx4 v34, s[84:87], s33 offen offset:2048 lds
buffer_load_dwordx4 v35, s[84:87], s33 offen offset:3072 lds
ds_read_b64_tr_b16 v[72:73], v40 offset:32768
ds_read_b64_tr_b16 v[74:75], v40 offset:33280
ds_read_b64_tr_b16 a[0:1], v40 offset:32776
ds_read_b64_tr_b16 a[2:3], v40 offset:33288
ds_read_b64_tr_b16 a[216:217], v41 offset:32768
ds_read_b64_tr_b16 a[218:219], v41 offset:33280
ds_read_b64_tr_b16 v[84:85], v41 offset:32776
ds_read_b64_tr_b16 v[86:87], v41 offset:33288
s_waitcnt lgkmcnt(6)
ds_write_b128 v2, v[72:75] offset:0
s_waitcnt lgkmcnt(1)
ds_write_b128 v2, v[84:87] offset:20480
s_waitcnt vmcnt(8)
s_barrier
s_add_u32 m0, s36, 32768
s_add_u32 s33, s71, 0
buffer_load_dwordx4 v32, s[84:87], s33 offen offset:0 lds
buffer_load_dwordx4 v33, s[84:87], s33 offen offset:1024 lds
buffer_load_dwordx4 v34, s[84:87], s33 offen offset:2048 lds
buffer_load_dwordx4 v35, s[84:87], s33 offen offset:3072 lds
ds_read_b64_tr_b16 v[72:73], v40 offset:49152
ds_read_b64_tr_b16 v[74:75], v40 offset:49664
ds_read_b64_tr_b16 a[4:5], v40 offset:49160
ds_read_b64_tr_b16 a[6:7], v40 offset:49672
ds_read_b64_tr_b16 a[220:221], v41 offset:49152
ds_read_b64_tr_b16 a[222:223], v41 offset:49664
ds_read_b64_tr_b16 v[84:85], v41 offset:49160
ds_read_b64_tr_b16 v[86:87], v41 offset:49672
s_waitcnt lgkmcnt(6)
ds_write_b128 v2, v[72:75] offset:1024
s_waitcnt lgkmcnt(1)
ds_write_b128 v2, v[84:87] offset:21504
s_waitcnt vmcnt(8)
s_barrier
s_add_u32 m0, s36, 49152
s_add_u32 s33, s71, 262144
buffer_load_dwordx4 v32, s[84:87], s33 offen offset:0 lds
buffer_load_dwordx4 v33, s[84:87], s33 offen offset:1024 lds
buffer_load_dwordx4 v34, s[84:87], s33 offen offset:2048 lds
buffer_load_dwordx4 v35, s[84:87], s33 offen offset:3072 lds
ds_read_b64_tr_b16 v[72:73], v40 offset:0
ds_read_b64_tr_b16 v[74:75], v40 offset:512
ds_read_b64_tr_b16 a[32:33], v40 offset:8
ds_read_b64_tr_b16 a[34:35], v40 offset:520
ds_read_b64_tr_b16 a[224:225], v41 offset:0
ds_read_b64_tr_b16 a[226:227], v41 offset:512
ds_read_b64_tr_b16 a[232:233], v41 offset:8
ds_read_b64_tr_b16 a[234:235], v41 offset:520
s_waitcnt lgkmcnt(6)
ds_write_b128 v2, v[72:75] offset:4096
s_waitcnt vmcnt(8) lgkmcnt(1)
s_barrier
s_add_u32 m0, s36, 0
s_add_u32 s33, s71, 2097152
buffer_load_dwordx4 v32, s[84:87], s33 offen offset:0 lds
buffer_load_dwordx4 v33, s[84:87], s33 offen offset:1024 lds
buffer_load_dwordx4 v34, s[84:87], s33 offen offset:2048 lds
buffer_load_dwordx4 v35, s[84:87], s33 offen offset:3072 lds
ds_read_b64_tr_b16 v[72:73], v40 offset:16384
ds_read_b64_tr_b16 v[74:75], v40 offset:16896
ds_read_b64_tr_b16 a[36:37], v40 offset:16392
ds_read_b64_tr_b16 a[38:39], v40 offset:16904
ds_read_b64_tr_b16 a[228:229], v41 offset:16384
ds_read_b64_tr_b16 a[230:231], v41 offset:16896
ds_read_b64_tr_b16 a[236:237], v41 offset:16392
ds_read_b64_tr_b16 a[238:239], v41 offset:16904
s_waitcnt lgkmcnt(6)
ds_write_b128 v2, v[72:75] offset:5120
s_waitcnt vmcnt(8) lgkmcnt(1)
s_barrier
s_add_u32 m0, s36, 16384
s_add_u32 s33, s71, 2359296
buffer_load_dwordx4 v32, s[84:87], s33 offen offset:0 lds
buffer_load_dwordx4 v33, s[84:87], s33 offen offset:1024 lds
buffer_load_dwordx4 v34, s[84:87], s33 offen offset:2048 lds
buffer_load_dwordx4 v35, s[84:87], s33 offen offset:3072 lds
ds_read_b64_tr_b16 a[240:241], v40 offset:32768
ds_read_b64_tr_b16 a[242:243], v40 offset:33280
ds_read_b64_tr_b16 a[248:249], v40 offset:32776
ds_read_b64_tr_b16 a[250:251], v40 offset:33288
ds_read_b64_tr_b16 v[96:97], v41 offset:32768
ds_read_b64_tr_b16 v[98:99], v41 offset:33280
ds_read_b64_tr_b16 v[104:105], v41 offset:32776
ds_read_b64_tr_b16 v[106:107], v41 offset:33288
s_waitcnt vmcnt(8) lgkmcnt(0)
s_barrier
s_add_u32 m0, s36, 32768
s_add_u32 s33, s72, 0
buffer_load_dwordx4 v32, s[84:87], s33 offen offset:0 lds
buffer_load_dwordx4 v33, s[84:87], s33 offen offset:1024 lds
buffer_load_dwordx4 v34, s[84:87], s33 offen offset:2048 lds
buffer_load_dwordx4 v35, s[84:87], s33 offen offset:3072 lds
ds_read_b64_tr_b16 a[244:245], v40 offset:49152
ds_read_b64_tr_b16 a[246:247], v40 offset:49664
ds_read_b64_tr_b16 a[252:253], v40 offset:49160
ds_read_b64_tr_b16 a[254:255], v40 offset:49672
ds_read_b64_tr_b16 v[100:101], v41 offset:49152
ds_read_b64_tr_b16 v[102:103], v41 offset:49664
ds_read_b64_tr_b16 v[108:109], v41 offset:49160
ds_read_b64_tr_b16 v[110:111], v41 offset:49672
s_waitcnt vmcnt(8) lgkmcnt(0)
s_barrier
s_add_u32 m0, s36, 49152
s_add_u32 s33, s72, 262144
buffer_load_dwordx4 v32, s[84:87], s33 offen offset:0 lds
buffer_load_dwordx4 v33, s[84:87], s33 offen offset:1024 lds
buffer_load_dwordx4 v34, s[84:87], s33 offen offset:2048 lds
buffer_load_dwordx4 v35, s[84:87], s33 offen offset:3072 lds
ds_read_b64_tr_b16 v[72:73], v40 offset:0
ds_read_b64_tr_b16 v[74:75], v40 offset:512
ds_read_b64_tr_b16 v[88:89], v40 offset:8
ds_read_b64_tr_b16 v[90:91], v40 offset:520
ds_read_b64_tr_b16 v[112:113], v41 offset:0
ds_read_b64_tr_b16 v[114:115], v41 offset:512
ds_read_b64_tr_b16 v[120:121], v41 offset:8
ds_read_b64_tr_b16 v[122:123], v41 offset:520
s_waitcnt lgkmcnt(6)
buffer_store_dwordx4 v[72:75], v0, s[4:7], s68 offen offset:2048
s_waitcnt vmcnt(9) lgkmcnt(0)
s_barrier
s_add_u32 m0, s36, 0
s_add_u32 s33, s70, 0
buffer_load_dwordx4 v32, s[76:79], s33 offen offset:0 lds
buffer_load_dwordx4 v33, s[76:79], s33 offen offset:1024 lds
buffer_load_dwordx4 v34, s[76:79], s33 offen offset:2048 lds
buffer_load_dwordx4 v35, s[76:79], s33 offen offset:3072 lds
ds_read_b64_tr_b16 v[72:73], v40 offset:16384
ds_read_b64_tr_b16 v[74:75], v40 offset:16896
ds_read_b64_tr_b16 v[92:93], v40 offset:16392
ds_read_b64_tr_b16 v[94:95], v40 offset:16904
ds_read_b64_tr_b16 v[116:117], v41 offset:16384
ds_read_b64_tr_b16 v[118:119], v41 offset:16896
ds_read_b64_tr_b16 v[124:125], v41 offset:16392
ds_read_b64_tr_b16 v[126:127], v41 offset:16904
s_waitcnt lgkmcnt(6)
buffer_store_dwordx4 v[72:75], v0, s[4:7], s68 offen offset:3072
s_waitcnt vmcnt(10) lgkmcnt(0)
s_barrier
s_add_u32 m0, s36, 16384
s_add_u32 s33, s70, 262144
buffer_load_dwordx4 v32, s[76:79], s33 offen offset:0 lds
buffer_load_dwordx4 v33, s[76:79], s33 offen offset:1024 lds
buffer_load_dwordx4 v34, s[76:79], s33 offen offset:2048 lds
buffer_load_dwordx4 v35, s[76:79], s33 offen offset:3072 lds
ds_read_b64_tr_b16 v[128:129], v40 offset:32768
ds_read_b64_tr_b16 v[130:131], v40 offset:33280
ds_read_b64_tr_b16 v[136:137], v40 offset:32776
ds_read_b64_tr_b16 v[138:139], v40 offset:33288
ds_read_b64_tr_b16 v[144:145], v41 offset:32768
ds_read_b64_tr_b16 v[146:147], v41 offset:33280
ds_read_b64_tr_b16 v[84:85], v41 offset:32776
ds_read_b64_tr_b16 v[86:87], v41 offset:33288
s_waitcnt lgkmcnt(0)
buffer_store_dwordx4 v[84:87], v0, s[4:7], s69 offen offset:0
s_waitcnt vmcnt(11)
s_barrier
s_add_u32 m0, s36, 32768
s_add_u32 s33, s70, 2097152
buffer_load_dwordx4 v32, s[76:79], s33 offen offset:0 lds
buffer_load_dwordx4 v33, s[76:79], s33 offen offset:1024 lds
buffer_load_dwordx4 v34, s[76:79], s33 offen offset:2048 lds
buffer_load_dwordx4 v35, s[76:79], s33 offen offset:3072 lds
ds_read_b64_tr_b16 v[132:133], v40 offset:49152
ds_read_b64_tr_b16 v[134:135], v40 offset:49664
ds_read_b64_tr_b16 v[140:141], v40 offset:49160
ds_read_b64_tr_b16 v[142:143], v40 offset:49672
ds_read_b64_tr_b16 v[148:149], v41 offset:49152
ds_read_b64_tr_b16 v[150:151], v41 offset:49664
ds_read_b64_tr_b16 v[84:85], v41 offset:49160
ds_read_b64_tr_b16 v[86:87], v41 offset:49672
s_waitcnt lgkmcnt(0)
buffer_store_dwordx4 v[84:87], v0, s[4:7], s69 offen offset:1024
s_waitcnt vmcnt(11)
s_barrier
s_add_u32 m0, s36, 49152
s_add_u32 s33, s70, 2359296
buffer_load_dwordx4 v32, s[76:79], s33 offen offset:0 lds
buffer_load_dwordx4 v33, s[76:79], s33 offen offset:1024 lds
buffer_load_dwordx4 v34, s[76:79], s33 offen offset:2048 lds
buffer_load_dwordx4 v35, s[76:79], s33 offen offset:3072 lds
ds_read_b64_tr_b16 v[72:73], v40 offset:0
ds_read_b64_tr_b16 v[74:75], v40 offset:512
ds_read_b64_tr_b16 v[76:77], v40 offset:8
ds_read_b64_tr_b16 v[78:79], v40 offset:520
ds_read_b64_tr_b16 a[40:41], v41 offset:0
ds_read_b64_tr_b16 a[42:43], v41 offset:512
ds_read_b64_tr_b16 a[48:49], v41 offset:8
ds_read_b64_tr_b16 a[50:51], v41 offset:520
s_waitcnt lgkmcnt(6)
buffer_store_dwordx4 v[72:75], v0, s[4:7], s65 offen offset:0
s_waitcnt lgkmcnt(4)
buffer_store_dwordx4 v[76:79], v0, s[4:7], s65 offen offset:2048
s_waitcnt vmcnt(12) lgkmcnt(0)
s_barrier
s_add_u32 m0, s36, 0
s_add_u32 s33, s71, 0
buffer_load_dwordx4 v32, s[76:79], s33 offen offset:0 lds
buffer_load_dwordx4 v33, s[76:79], s33 offen offset:1024 lds
buffer_load_dwordx4 v34, s[76:79], s33 offen offset:2048 lds
buffer_load_dwordx4 v35, s[76:79], s33 offen offset:3072 lds
ds_read_b64_tr_b16 v[72:73], v40 offset:16384
ds_read_b64_tr_b16 v[74:75], v40 offset:16896
ds_read_b64_tr_b16 v[76:77], v40 offset:16392
ds_read_b64_tr_b16 v[78:79], v40 offset:16904
ds_read_b64_tr_b16 a[44:45], v41 offset:16384
ds_read_b64_tr_b16 a[46:47], v41 offset:16896
ds_read_b64_tr_b16 a[52:53], v41 offset:16392
ds_read_b64_tr_b16 a[54:55], v41 offset:16904
s_waitcnt lgkmcnt(6)
buffer_store_dwordx4 v[72:75], v0, s[4:7], s65 offen offset:1024
s_waitcnt lgkmcnt(4)
buffer_store_dwordx4 v[76:79], v0, s[4:7], s65 offen offset:3072
s_waitcnt vmcnt(13) lgkmcnt(0)
s_barrier
s_add_u32 m0, s36, 16384
s_add_u32 s33, s71, 262144
buffer_load_dwordx4 v32, s[76:79], s33 offen offset:0 lds
buffer_load_dwordx4 v33, s[76:79], s33 offen offset:1024 lds
buffer_load_dwordx4 v34, s[76:79], s33 offen offset:2048 lds
buffer_load_dwordx4 v35, s[76:79], s33 offen offset:3072 lds
ds_read_b64_tr_b16 a[8:9], v40 offset:32768
ds_read_b64_tr_b16 a[10:11], v40 offset:33280
ds_read_b64_tr_b16 a[16:17], v40 offset:32776
ds_read_b64_tr_b16 a[18:19], v40 offset:33288
ds_read_b64_tr_b16 a[56:57], v41 offset:32768
ds_read_b64_tr_b16 a[58:59], v41 offset:33280
ds_read_b64_tr_b16 v[84:85], v41 offset:32776
ds_read_b64_tr_b16 v[86:87], v41 offset:33288
s_waitcnt lgkmcnt(0)
ds_write_b128 v2, v[84:87] offset:6144
s_waitcnt vmcnt(12)
s_barrier
s_add_u32 m0, s36, 32768
s_add_u32 s33, s71, 2097152
buffer_load_dwordx4 v32, s[76:79], s33 offen offset:0 lds
buffer_load_dwordx4 v33, s[76:79], s33 offen offset:1024 lds
buffer_load_dwordx4 v34, s[76:79], s33 offen offset:2048 lds
buffer_load_dwordx4 v35, s[76:79], s33 offen offset:3072 lds
ds_read_b64_tr_b16 a[12:13], v40 offset:49152
ds_read_b64_tr_b16 a[14:15], v40 offset:49664
ds_read_b64_tr_b16 a[20:21], v40 offset:49160
ds_read_b64_tr_b16 a[22:23], v40 offset:49672
ds_read_b64_tr_b16 a[60:61], v41 offset:49152
ds_read_b64_tr_b16 a[62:63], v41 offset:49664
ds_read_b64_tr_b16 v[84:85], v41 offset:49160
ds_read_b64_tr_b16 v[86:87], v41 offset:49672
s_waitcnt lgkmcnt(0)
ds_write_b128 v2, v[84:87] offset:7168
s_waitcnt vmcnt(10)
s_barrier
s_add_u32 m0, s36, 49152
s_add_u32 s33, s71, 2359296
buffer_load_dwordx4 v32, s[76:79], s33 offen offset:0 lds
buffer_load_dwordx4 v33, s[76:79], s33 offen offset:1024 lds
buffer_load_dwordx4 v34, s[76:79], s33 offen offset:2048 lds
buffer_load_dwordx4 v35, s[76:79], s33 offen offset:3072 lds
ds_read_b64_tr_b16 a[64:65], v40 offset:0
ds_read_b64_tr_b16 a[66:67], v40 offset:512
ds_read_b64_tr_b16 a[72:73], v40 offset:8
ds_read_b64_tr_b16 a[74:75], v40 offset:520
ds_read_b64_tr_b16 v[80:81], v41 offset:0
ds_read_b64_tr_b16 v[82:83], v41 offset:512
ds_read_b64_tr_b16 v[84:85], v41 offset:8
ds_read_b64_tr_b16 v[86:87], v41 offset:520
s_waitcnt lgkmcnt(2)
buffer_store_dwordx4 v[80:83], v0, s[4:7], s67 offen offset:0
s_waitcnt lgkmcnt(0)
ds_write_b128 v2, v[84:87] offset:10240
s_waitcnt vmcnt(9)
s_barrier
s_add_u32 m0, s36, 0
s_add_u32 s33, s72, 0
buffer_load_dwordx4 v32, s[76:79], s33 offen offset:0 lds
buffer_load_dwordx4 v33, s[76:79], s33 offen offset:1024 lds
buffer_load_dwordx4 v34, s[76:79], s33 offen offset:2048 lds
buffer_load_dwordx4 v35, s[76:79], s33 offen offset:3072 lds
ds_read_b64_tr_b16 a[68:69], v40 offset:16384
ds_read_b64_tr_b16 a[70:71], v40 offset:16896
ds_read_b64_tr_b16 a[76:77], v40 offset:16392
ds_read_b64_tr_b16 a[78:79], v40 offset:16904
ds_read_b64_tr_b16 v[80:81], v41 offset:16384
ds_read_b64_tr_b16 v[82:83], v41 offset:16896
ds_read_b64_tr_b16 v[84:85], v41 offset:16392
ds_read_b64_tr_b16 v[86:87], v41 offset:16904
s_waitcnt lgkmcnt(2)
buffer_store_dwordx4 v[80:83], v0, s[4:7], s67 offen offset:1024
s_waitcnt lgkmcnt(0)
ds_write_b128 v2, v[84:87] offset:11264
s_waitcnt vmcnt(10)
s_barrier
s_add_u32 m0, s36, 16384
s_add_u32 s33, s72, 262144
buffer_load_dwordx4 v32, s[76:79], s33 offen offset:0 lds
buffer_load_dwordx4 v33, s[76:79], s33 offen offset:1024 lds
buffer_load_dwordx4 v34, s[76:79], s33 offen offset:2048 lds
buffer_load_dwordx4 v35, s[76:79], s33 offen offset:3072 lds
ds_read_b64_tr_b16 v[72:73], v40 offset:32768
ds_read_b64_tr_b16 v[74:75], v40 offset:33280
ds_read_b64_tr_b16 a[80:81], v40 offset:32776
ds_read_b64_tr_b16 a[82:83], v40 offset:33288
ds_read_b64_tr_b16 a[88:89], v41 offset:32768
ds_read_b64_tr_b16 a[90:91], v41 offset:33280
ds_read_b64_tr_b16 a[96:97], v41 offset:32776
ds_read_b64_tr_b16 a[98:99], v41 offset:33288
s_waitcnt lgkmcnt(6)
ds_write_b128 v2, v[72:75] offset:8192
s_waitcnt vmcnt(10) lgkmcnt(1)
s_barrier
s_add_u32 m0, s36, 32768
s_add_u32 s33, s73, 0
buffer_load_dwordx4 v36, s[88:91], s33 offen offset:0 lds
buffer_load_dwordx4 v37, s[88:91], s33 offen offset:1024 lds
buffer_load_dwordx4 v38, s[88:91], s33 offen offset:2048 lds
buffer_load_dwordx4 v39, s[88:91], s33 offen offset:3072 lds
ds_read_b64_tr_b16 v[72:73], v40 offset:49152
ds_read_b64_tr_b16 v[74:75], v40 offset:49664
ds_read_b64_tr_b16 a[84:85], v40 offset:49160
ds_read_b64_tr_b16 a[86:87], v40 offset:49672
ds_read_b64_tr_b16 a[92:93], v41 offset:49152
ds_read_b64_tr_b16 a[94:95], v41 offset:49664
ds_read_b64_tr_b16 a[100:101], v41 offset:49160
ds_read_b64_tr_b16 a[102:103], v41 offset:49672
s_waitcnt lgkmcnt(6)
ds_write_b128 v2, v[72:75] offset:9216
s_waitcnt vmcnt(9) lgkmcnt(1)
s_barrier
s_add_u32 m0, s36, 49152
s_add_u32 s33, s74, 0
buffer_load_dwordx4 v36, s[88:91], s33 offen offset:0 lds
buffer_load_dwordx4 v37, s[88:91], s33 offen offset:1024 lds
buffer_load_dwordx4 v38, s[88:91], s33 offen offset:2048 lds
buffer_load_dwordx4 v39, s[88:91], s33 offen offset:3072 lds
ds_read_b64_tr_b16 v[72:73], v40 offset:0
ds_read_b64_tr_b16 v[74:75], v40 offset:512
ds_read_b64_tr_b16 a[104:105], v40 offset:8
ds_read_b64_tr_b16 a[106:107], v40 offset:520
ds_read_b64_tr_b16 a[112:113], v41 offset:0
ds_read_b64_tr_b16 a[114:115], v41 offset:512
ds_read_b64_tr_b16 a[120:121], v41 offset:8
ds_read_b64_tr_b16 a[122:123], v41 offset:520
s_waitcnt lgkmcnt(6)
ds_write_b128 v2, v[72:75] offset:12288
s_waitcnt vmcnt(8) lgkmcnt(1)
s_barrier
s_add_u32 m0, s36, 0
s_add_u32 s33, s73, 256
buffer_load_dwordx4 v36, s[88:91], s33 offen offset:0 lds
buffer_load_dwordx4 v37, s[88:91], s33 offen offset:1024 lds
buffer_load_dwordx4 v38, s[88:91], s33 offen offset:2048 lds
buffer_load_dwordx4 v39, s[88:91], s33 offen offset:3072 lds
ds_read_b64_tr_b16 v[72:73], v40 offset:16384
ds_read_b64_tr_b16 v[74:75], v40 offset:16896
ds_read_b64_tr_b16 a[108:109], v40 offset:16392
ds_read_b64_tr_b16 a[110:111], v40 offset:16904
ds_read_b64_tr_b16 a[116:117], v41 offset:16384
ds_read_b64_tr_b16 a[118:119], v41 offset:16896
ds_read_b64_tr_b16 a[124:125], v41 offset:16392
ds_read_b64_tr_b16 a[126:127], v41 offset:16904
s_waitcnt lgkmcnt(6)
ds_write_b128 v2, v[72:75] offset:13312
s_waitcnt vmcnt(8) lgkmcnt(1)
s_barrier
s_add_u32 m0, s36, 16384
s_add_u32 s33, s74, 256
buffer_load_dwordx4 v36, s[88:91], s33 offen offset:0 lds
buffer_load_dwordx4 v37, s[88:91], s33 offen offset:1024 lds
buffer_load_dwordx4 v38, s[88:91], s33 offen offset:2048 lds
buffer_load_dwordx4 v39, s[88:91], s33 offen offset:3072 lds
ds_read_b64_tr_b16 v[72:73], v42 offset:32768
ds_read_b64_tr_b16 v[74:75], v42 offset:33024
ds_read_b64_tr_b16 v[76:77], v42 offset:34816
ds_read_b64_tr_b16 v[78:79], v42 offset:35072
ds_read_b64_tr_b16 v[8:9], v43 offset:32768
ds_read_b64_tr_b16 v[10:11], v43 offset:33024
ds_read_b64_tr_b16 v[12:13], v43 offset:34816
ds_read_b64_tr_b16 v[14:15], v43 offset:35072
s_waitcnt lgkmcnt(6)
ds_write_b128 v2, v[72:75] offset:22528
s_waitcnt lgkmcnt(5)
ds_write_b128 v2, v[76:79] offset:23552
s_waitcnt vmcnt(8) lgkmcnt(2)
s_barrier
s_add_u32 m0, s36, 32768
s_add_u32 s33, s73, 512
buffer_load_dwordx4 v36, s[88:91], s33 offen offset:0 lds
buffer_load_dwordx4 v37, s[88:91], s33 offen offset:1024 lds
buffer_load_dwordx4 v38, s[88:91], s33 offen offset:2048 lds
buffer_load_dwordx4 v39, s[88:91], s33 offen offset:3072 lds
ds_read_b64_tr_b16 v[16:17], v42 offset:49152
ds_read_b64_tr_b16 v[18:19], v42 offset:49408
ds_read_b64_tr_b16 v[20:21], v42 offset:51200
ds_read_b64_tr_b16 v[22:23], v42 offset:51456
ds_read_b64_tr_b16 v[184:185], v43 offset:49152
ds_read_b64_tr_b16 v[186:187], v43 offset:49408
ds_read_b64_tr_b16 v[188:189], v43 offset:51200
ds_read_b64_tr_b16 v[190:191], v43 offset:51456
s_waitcnt vmcnt(8) lgkmcnt(0)
s_barrier
s_add_u32 m0, s36, 49152
s_add_u32 s33, s74, 512
buffer_load_dwordx4 v36, s[88:91], s33 offen offset:0 lds
buffer_load_dwordx4 v37, s[88:91], s33 offen offset:1024 lds
buffer_load_dwordx4 v38, s[88:91], s33 offen offset:2048 lds
buffer_load_dwordx4 v39, s[88:91], s33 offen offset:3072 lds
ds_read_b64_tr_b16 v[152:153], v42 offset:0
ds_read_b64_tr_b16 v[154:155], v42 offset:256
ds_read_b64_tr_b16 v[156:157], v42 offset:2048
ds_read_b64_tr_b16 v[158:159], v42 offset:2304
ds_read_b64_tr_b16 v[24:25], v43 offset:0
ds_read_b64_tr_b16 v[26:27], v43 offset:256
ds_read_b64_tr_b16 v[28:29], v43 offset:2048
ds_read_b64_tr_b16 v[30:31], v43 offset:2304
s_waitcnt vmcnt(8) lgkmcnt(0)
s_barrier
s_add_u32 m0, s36, 0
s_add_u32 s33, s73, 768
buffer_load_dwordx4 v36, s[88:91], s33 offen offset:0 lds
buffer_load_dwordx4 v37, s[88:91], s33 offen offset:1024 lds
buffer_load_dwordx4 v38, s[88:91], s33 offen offset:2048 lds
buffer_load_dwordx4 v39, s[88:91], s33 offen offset:3072 lds
ds_read_b64_tr_b16 v[192:193], v42 offset:16384
ds_read_b64_tr_b16 v[194:195], v42 offset:16640
ds_read_b64_tr_b16 v[196:197], v42 offset:18432
ds_read_b64_tr_b16 v[198:199], v42 offset:18688
ds_read_b64_tr_b16 v[200:201], v43 offset:16384
ds_read_b64_tr_b16 v[202:203], v43 offset:16640
ds_read_b64_tr_b16 v[204:205], v43 offset:18432
ds_read_b64_tr_b16 v[206:207], v43 offset:18688
s_waitcnt vmcnt(8) lgkmcnt(0)
s_barrier
s_add_u32 m0, s36, 16384
s_add_u32 s33, s74, 768
buffer_load_dwordx4 v36, s[88:91], s33 offen offset:0 lds
buffer_load_dwordx4 v37, s[88:91], s33 offen offset:1024 lds
buffer_load_dwordx4 v38, s[88:91], s33 offen offset:2048 lds
buffer_load_dwordx4 v39, s[88:91], s33 offen offset:3072 lds
ds_read_b64_tr_b16 v[160:161], v42 offset:32768
ds_read_b64_tr_b16 v[162:163], v42 offset:33024
ds_read_b64_tr_b16 v[164:165], v42 offset:34816
ds_read_b64_tr_b16 v[166:167], v42 offset:35072
ds_read_b64_tr_b16 v[48:49], v43 offset:32768
ds_read_b64_tr_b16 v[50:51], v43 offset:33024
ds_read_b64_tr_b16 v[52:53], v43 offset:34816
ds_read_b64_tr_b16 v[54:55], v43 offset:35072
s_waitcnt vmcnt(8) lgkmcnt(0)
s_barrier
s_add_u32 m0, s36, 32768
s_add_u32 s33, s73, 1024
buffer_load_dwordx4 v36, s[88:91], s33 offen offset:0 lds
buffer_load_dwordx4 v37, s[88:91], s33 offen offset:1024 lds
buffer_load_dwordx4 v38, s[88:91], s33 offen offset:2048 lds
buffer_load_dwordx4 v39, s[88:91], s33 offen offset:3072 lds
ds_read_b64_tr_b16 v[56:57], v42 offset:49152
ds_read_b64_tr_b16 v[58:59], v42 offset:49408
ds_read_b64_tr_b16 v[60:61], v42 offset:51200
ds_read_b64_tr_b16 v[62:63], v42 offset:51456
ds_read_b64_tr_b16 v[208:209], v43 offset:49152
ds_read_b64_tr_b16 v[210:211], v43 offset:49408
ds_read_b64_tr_b16 v[212:213], v43 offset:51200
ds_read_b64_tr_b16 v[214:215], v43 offset:51456
s_waitcnt vmcnt(8) lgkmcnt(0)
s_barrier
s_add_u32 m0, s36, 49152
s_add_u32 s33, s74, 1024
buffer_load_dwordx4 v36, s[88:91], s33 offen offset:0 lds
buffer_load_dwordx4 v37, s[88:91], s33 offen offset:1024 lds
buffer_load_dwordx4 v38, s[88:91], s33 offen offset:2048 lds
buffer_load_dwordx4 v39, s[88:91], s33 offen offset:3072 lds
ds_read_b64_tr_b16 v[168:169], v42 offset:0
ds_read_b64_tr_b16 v[170:171], v42 offset:256
ds_read_b64_tr_b16 v[172:173], v42 offset:2048
ds_read_b64_tr_b16 v[174:175], v42 offset:2304
ds_read_b64_tr_b16 v[64:65], v43 offset:0
ds_read_b64_tr_b16 v[66:67], v43 offset:256
ds_read_b64_tr_b16 v[68:69], v43 offset:2048
ds_read_b64_tr_b16 v[70:71], v43 offset:2304
s_waitcnt vmcnt(8) lgkmcnt(0)
s_barrier
ds_read_b64_tr_b16 v[216:217], v42 offset:16384
ds_read_b64_tr_b16 v[218:219], v42 offset:16640
ds_read_b64_tr_b16 v[220:221], v42 offset:18432
ds_read_b64_tr_b16 v[222:223], v42 offset:18688
ds_read_b64_tr_b16 v[224:225], v43 offset:16384
ds_read_b64_tr_b16 v[226:227], v43 offset:16640
ds_read_b64_tr_b16 v[228:229], v43 offset:18432
ds_read_b64_tr_b16 v[230:231], v43 offset:18688
s_waitcnt vmcnt(4) lgkmcnt(0)
s_barrier
ds_read_b64_tr_b16 v[176:177], v42 offset:32768
ds_read_b64_tr_b16 v[178:179], v42 offset:33024
ds_read_b64_tr_b16 v[180:181], v42 offset:34816
ds_read_b64_tr_b16 v[182:183], v42 offset:35072
ds_read_b64_tr_b16 v[232:233], v43 offset:32768
ds_read_b64_tr_b16 v[234:235], v43 offset:33024
ds_read_b64_tr_b16 v[236:237], v43 offset:34816
ds_read_b64_tr_b16 v[238:239], v43 offset:35072
s_waitcnt vmcnt(0) lgkmcnt(0)
s_barrier
ds_read_b64_tr_b16 v[240:241], v42 offset:49152
ds_read_b64_tr_b16 v[242:243], v42 offset:49408
ds_read_b64_tr_b16 v[244:245], v42 offset:51200
ds_read_b64_tr_b16 v[246:247], v42 offset:51456
ds_read_b64_tr_b16 v[248:249], v43 offset:49152
ds_read_b64_tr_b16 v[250:251], v43 offset:49408
ds_read_b64_tr_b16 v[252:253], v43 offset:51200
ds_read_b64_tr_b16 v[254:255], v43 offset:51456
s_waitcnt lgkmcnt(0)
s_barrier
s_mul_i32 s33, s16, 12288
v_add_u32 v44, s33, v0
ds_write_b128 v44, v[8:11] offset:16384
ds_write_b128 v44, v[12:15] offset:17408
ds_write_b128 v44, v[16:19] offset:18432
ds_write_b128 v44, v[20:23] offset:19456
ds_write_b128 v44, v[24:27] offset:20480
ds_write_b128 v44, v[28:31] offset:21504
ds_write_b128 v44, v[48:51] offset:22528
ds_write_b128 v44, v[52:55] offset:23552
ds_write_b128 v44, v[56:59] offset:24576
ds_write_b128 v44, v[60:63] offset:25600
ds_write_b128 v44, v[64:67] offset:26624
ds_write_b128 v44, v[68:71] offset:27648
s_waitcnt vmcnt(0) lgkmcnt(0)
s_barrier
s_cmp_lg_u32 s16, 0
s_cbranch_scc1 cb_130
v_mov_b32 v44, 4
v_mov_b32 v45, 1
s_mov_b64 exec, 1
buffer_atomic_add v45, v44, s[8:11], 0 offen
s_mov_b32 s37, 0
cb_129:
buffer_load_dword v45, v44, s[8:11], 0 offen sc1
s_add_u32 s37, s37, 1
s_cmp_gt_u32 s37, 262144
s_cbranch_scc1 L_fail
s_waitcnt vmcnt(0)
v_cmp_gt_u32 vcc, 32, v45
s_cbranch_vccnz cb_129
s_mov_b64 exec, -1
cb_130:
s_barrier
s_mov_b32 s18, 0
s_mov_b32 s45, 0
s_cmp_eq_u32 s16, 1
s_cbranch_scc1 wave_132
s_cmp_eq_u32 s16, 2
s_cbranch_scc1 wave_133
s_cmp_eq_u32 s16, 3
s_cbranch_scc1 wave_134
wave_131:
layer_135:
s_lshl_b32 s17, s45, 6
s_mul_i32 s34, s45, 34603008
s_lshl_b32 s35, s15, 14
s_add_u32 s34, s34, s35
s_add_u32 s24, s34, 16777216
s_mul_i32 s34, s17, 10240
s_add_u32 s34, s34, s30
s_add_u32 s25, s34, s31
s_mov_b32 s19, 0
s_add_u32 s43, s17, 1
s_add_u32 s38, s17, 63
s_add_u32 s39, s17, 64
s_mov_b32 s34, s24
v_mov_b32 v7, 0
s_mov_b32 s20, 409600
s_mov_b32 s21, 413696
s_mov_b32 s22, 417792
buffer_load_dwordx4 v[64:67], v0, s[4:7], s65 offen offset:0 sc1
buffer_load_dwordx4 v[68:71], v0, s[4:7], s65 offen offset:1024 sc1
buffer_load_dwordx4 v[72:75], v0, s[4:7], s65 offen offset:2048 sc1
buffer_load_dwordx4 v[76:79], v0, s[4:7], s65 offen offset:3072 sc1
ds_read_b128 v[80:83], v2 offset:0
ds_read_b128 v[84:87], v2 offset:1024
buffer_load_dwordx4 v[48:51], v0, s[4:7], s66 offen offset:0 sc1
buffer_load_dwordx4 v[52:55], v0, s[4:7], s66 offen offset:1024 sc1
buffer_load_dwordx4 v[56:59], v0, s[4:7], s66 offen offset:2048 sc1
buffer_load_dwordx4 v[60:63], v0, s[4:7], s66 offen offset:3072 sc1
v_mov_b64 v[8:9], 0
v_mov_b64 v[10:11], 0
v_mov_b64 v[12:13], 0
v_mov_b64 v[14:15], 0
v_mov_b64 v[16:17], 0
v_mov_b64 v[18:19], 0
v_mov_b64 v[20:21], 0
v_mov_b64 v[22:23], 0
v_mov_b64 v[24:25], 0
v_mov_b64 v[26:27], 0
v_mov_b64 v[28:29], 0
v_mov_b64 v[30:31], 0
v_cmp_gt_u32 vcc, s43, v7
s_cmp_eq_u32 vcc_hi, 0
s_cbranch_scc1 kv_142
s_mov_b32 s37, 0
kv_141:
v_bfe_u32 v7, v0, 2, 3
buffer_load_dword v7, v7, s[4:7], s28 offen sc1
s_add_u32 s37, s37, 1
s_cmp_gt_u32 s37, 262144
s_cbranch_scc1 L_fail
s_waitcnt vmcnt(0)
v_cmp_gt_u32 vcc, s43, v7
s_cbranch_vccnz kv_141
kv_142:
s_barrier
v_bfe_u32 v7, v0, 2, 3
v_add_u32 v7, s28, v7
s_mov_b32 exec_hi, 0
v_and_b32 v7, 511, v0
v_lshl_add_u32 v7, v7, 3, s34
s_mov_b32 exec_hi, -1
s_mov_b32 s37, 0
gather_136:
buffer_load_dwordx4 v[32:35], v0, s[4:7], s20 offen sc1
buffer_load_dwordx4 v[36:39], v0, s[4:7], s21 offen sc1
buffer_load_dwordx4 v[40:43], v0, s[4:7], s22 offen sc1
s_add_u32 s37, s37, 1
s_cmp_gt_u32 s37, 262144
s_cbranch_scc1 L_fail
s_waitcnt vmcnt(2)
v_bitop3_b32 v44, v32, v34, s18 bitop3:0x7e
s_waitcnt vmcnt(1)
v_bitop3_b32 v45, v36, v38, s18 bitop3:0x7e
v_or_b32 v44, v44, v45
s_waitcnt vmcnt(0)
v_bitop3_b32 v46, v40, v42, s18 bitop3:0x7e
v_bitop3_b32 v44, v44, v46, s19 bitop3:0xa8
v_cmp_ne_u32 vcc, 0, v44
s_cbranch_vccnz gather_136
v_smfmac_f32_16x16x64_bf16 v[8:11], v[32:35], v[64:71], v1
buffer_load_dwordx4 v[64:67], v0, s[4:7], s67 offen offset:0 sc1
ds_write_b128 v0, v[36:39] offset:4096
v_smfmac_f32_16x16x64_bf16 v[20:23], v[32:35], v[56:63], v1
ds_read_b128 v[56:59], v2 offset:2048
buffer_load_dwordx4 v[68:71], v0, s[4:7], s67 offen offset:1024 sc1
ds_read_b128 v[60:63], v2 offset:3072
ds_write_b128 v0, v[32:35] offset:0
v_smfmac_f32_16x16x64_bf16 v[12:15], v[32:35], v[72:79], v1
buffer_load_dwordx4 v[72:75], v0, s[4:7], s67 offen offset:2048 sc1
s_waitcnt lgkmcnt(4)
v_smfmac_f32_16x16x64_bf16 v[24:27], v[32:35], v[80:87], v1
ds_write_b128 v0, v[40:43] offset:8192
v_smfmac_f32_16x16x64_bf16 v[16:19], v[32:35], v[48:55], v1
ds_read_b128 v[80:83], v2 offset:4096
ds_read_b128 v[84:87], v2 offset:5120
v_smfmac_f32_16x16x64_bf16 v[28:31], v[32:35], a[0:7], v1
s_waitcnt lgkmcnt(5)
s_waitcnt lgkmcnt(4)
v_smfmac_f32_16x16x64_bf16 v[20:23], v[36:39], v[56:63], v1
buffer_load_dwordx4 v[76:79], v0, s[4:7], s67 offen offset:3072 sc1
ds_read_b128 v[60:63], v2 offset:7168
ds_read_b128 v[56:59], v2 offset:6144
v_smfmac_f32_16x16x64_bf16 v[8:11], v[36:39], a[8:15], v1
s_waitcnt lgkmcnt(4)
s_barrier
ds_read_b128 v[40:43], v0 offset:1024
v_smfmac_f32_16x16x64_bf16 v[12:15], v[36:39], a[16:23], v1
s_waitcnt lgkmcnt(3)
ds_read_b128 v[44:47], v0 offset:5120
ds_read_b128 v[32:35], v0 offset:2048
v_smfmac_f32_16x16x64_bf16 v[24:27], v[36:39], v[80:87], v1
ds_read_b128 v[80:83], v2 offset:8192
v_smfmac_f32_16x16x64_bf16 v[28:31], v[36:39], a[32:39], v1
buffer_load_dwordx4 v[48:51], v0, s[4:7], s24 offen offset:0 nt sc1
v_smfmac_f32_16x16x64_bf16 v[16:19], v[36:39], a[24:31], v1
ds_read_b128 v[36:39], v0 offset:6144
s_waitcnt lgkmcnt(4)
v_smfmac_f32_16x16x64_bf16 v[8:11], v[40:43], a[40:47], v1
ds_read_b128 v[84:87], v2 offset:9216
s_waitcnt lgkmcnt(4)
v_smfmac_f32_16x16x64_bf16 v[12:15], v[40:43], a[48:55], v1
s_waitcnt vmcnt(4)
ds_read_b128 v[40:43], v0 offset:3072
v_smfmac_f32_16x16x64_bf16 v[12:15], v[44:47], v[56:63], v1
s_waitcnt lgkmcnt(4)
ds_read_b128 v[60:63], v2 offset:11264
ds_read_b128 v[56:59], v2 offset:10240
v_smfmac_f32_16x16x64_bf16 v[8:11], v[44:47], a[56:63], v1
buffer_load_dwordx4 v[52:55], v0, s[4:7], s24 offen offset:1024 nt sc1
v_smfmac_f32_16x16x64_bf16 v[8:11], v[32:35], a[64:71], v1
s_waitcnt lgkmcnt(4)
ds_read_b128 v[44:47], v0 offset:7168
s_waitcnt lgkmcnt(4)
v_smfmac_f32_16x16x64_bf16 v[12:15], v[32:35], a[72:79], v1
s_waitcnt vmcnt(4)
ds_read_b128 v[32:35], v0 offset:8192
s_waitcnt lgkmcnt(4)
v_smfmac_f32_16x16x64_bf16 v[8:11], v[36:39], v[80:87], v1
ds_read_b128 v[80:83], v2 offset:12288
ds_read_b128 v[84:87], v2 offset:13312
v_smfmac_f32_16x16x64_bf16 v[8:11], v[40:43], v[64:71], v1
buffer_load_dwordx4 v[64:67], v0, s[4:7], s68 offen offset:0 sc1
v_smfmac_f32_16x16x64_bf16 v[12:15], v[36:39], a[80:87], v1
s_waitcnt lgkmcnt(4)
ds_read_b128 v[36:39], v0 offset:9216
v_smfmac_f32_16x16x64_bf16 v[12:15], v[40:43], v[56:63], v1
ds_read_b128 v[40:43], v0 offset:1024
s_waitcnt lgkmcnt(5)
v_smfmac_f32_16x16x64_bf16 v[8:11], v[44:47], a[88:95], v1
buffer_load_dwordx4 v[68:71], v0, s[4:7], s68 offen offset:1024 sc1
v_smfmac_f32_16x16x64_bf16 v[12:15], v[44:47], a[96:103], v1
s_waitcnt lgkmcnt(4)
ds_read_b128 v[60:63], v2 offset:15360
s_waitcnt lgkmcnt(3)
v_smfmac_f32_16x16x64_bf16 v[12:15], v[32:35], a[104:111], v1
ds_read_b128 v[56:59], v2 offset:14336
s_waitcnt vmcnt(5)
v_smfmac_f32_16x16x64_bf16 v[8:11], v[32:35], v[80:87], v1
s_waitcnt vmcnt(4)
ds_read_b128 v[32:35], v0 offset:5120
s_waitcnt lgkmcnt(4)
v_smfmac_f32_16x16x64_bf16 v[8:11], v[36:39], a[112:119], v1
s_waitcnt lgkmcnt(3)
ds_read_b128 v[80:83], v2 offset:16384
ds_read_b128 v[84:87], v2 offset:17408
v_smfmac_f32_16x16x64_bf16 v[16:19], v[40:43], v[72:79], v1
s_mov_b32 s22, 401408
buffer_load_dwordx4 v[72:75], v0, s[4:7], s68 offen offset:2048 sc1
v_smfmac_f32_16x16x64_bf16 v[12:15], v[36:39], a[120:127], v1
s_waitcnt lgkmcnt(4)
ds_read_b128 v[36:39], v0 offset:2048
s_waitcnt lgkmcnt(4)
v_add_f32 v8, v8, v10
v_smfmac_f32_16x16x64_bf16 v[20:23], v[40:43], v[56:63], v1
s_waitcnt lgkmcnt(3)
buffer_load_dwordx4 v[76:79], v0, s[4:7], s68 offen offset:3072 sc1
v_smfmac_f32_16x16x64_bf16 v[20:23], v[32:35], a[136:143], v1
s_waitcnt lgkmcnt(2)
ds_read_b128 v[40:43], v0 offset:6144
v_mul_f32 v8, s44, v8
v_add_f32 v9, v9, v11
v_smfmac_f32_16x16x64_bf16 v[16:19], v[32:35], a[128:135], v1
buffer_load_dwordx4 v[56:59], v0, s[4:7], s24 offen offset:2048 nt sc1
ds_read_b128 v[32:35], v0 offset:3072
s_waitcnt lgkmcnt(2)
v_mul_f32 v9, s44, v9
v_add_f32 v12, v12, v14
v_smfmac_f32_16x16x64_bf16 v[16:19], v[36:39], v[80:87], v1
ds_read_b128 v[80:83], v2 offset:18432
v_cvt_pk_bf16_f32 v8, v8, v9
v_smfmac_f32_16x16x64_bf16 v[20:23], v[36:39], a[144:151], v1
s_waitcnt lgkmcnt(2)
ds_read_b128 v[84:87], v2 offset:19456
v_add_f32 v13, v13, v15
v_smfmac_f32_16x16x64_bf16 v[20:23], v[40:43], a[160:167], v1
s_xor_b32 s18, s18, 1
ds_read_b128 v[36:39], v0 offset:7168
v_mul_f32 v12, s44, v12
v_mul_f32 v13, s44, v13
v_cvt_pk_bf16_f32 v12, v12, v13
v_smfmac_f32_16x16x64_bf16 v[16:19], v[40:43], a[152:159], v1
s_waitcnt lgkmcnt(3)
ds_write2_b32 v3, v8, v12 offset0:0 offset1:128
v_smfmac_f32_16x16x64_bf16 v[20:23], v[32:35], a[168:175], v1
ds_read_b128 v[40:43], v0 offset:8192
buffer_load_dwordx4 v[60:63], v0, s[4:7], s24 offen offset:3072 nt sc1
s_mov_b32 s19, 1
s_waitcnt lgkmcnt(3)
s_waitcnt lgkmcnt(2)
v_smfmac_f32_16x16x64_bf16 v[20:23], v[36:39], v[80:87], v1
s_waitcnt vmcnt(7)
s_waitcnt vmcnt(5)
ds_read_b128 v[84:87], v2 offset:21504
s_waitcnt vmcnt(4)
v_smfmac_f32_16x16x64_bf16 v[16:19], v[32:35], v[64:71], v1
ds_read_b128 v[32:35], v0 offset:9216
buffer_load_dwordx4 v[64:67], v0, s[4:7], s69 offen offset:0 sc1
v_smfmac_f32_16x16x64_bf16 v[16:19], v[36:39], a[176:183], v1
s_waitcnt lgkmcnt(2)
ds_read_b128 v[36:39], v0 offset:1024
ds_read_b128 v[80:83], v2 offset:20480
buffer_load_dwordx4 v[68:71], v0, s[4:7], s69 offen offset:1024 sc1
v_smfmac_f32_16x16x64_bf16 v[16:19], v[40:43], a[184:191], v1
s_barrier
ds_read_b64_tr_b16 v[8:9], v4 offset:0
ds_read_b64_tr_b16 v[10:11], v4 offset:512
v_smfmac_f32_16x16x64_bf16 v[20:23], v[40:43], a[192:199], v1
s_waitcnt lgkmcnt(4)
ds_read_b64_tr_b16 v[14:15], v4 offset:1536
ds_read_b64_tr_b16 v[12:13], v4 offset:1024
v_smfmac_f32_16x16x64_bf16 v[16:19], v[32:35], a[200:207], v1
buffer_load_dword v7, v7, s[4:7], 0 offen sc1
v_smfmac_f32_16x16x64_bf16 v[20:23], v[32:35], a[208:215], v1
s_waitcnt lgkmcnt(5)
ds_read_b128 v[40:43], v0 offset:5120
ds_read_b128 v[32:35], v0 offset:2048
v_smfmac_f32_16x16x64_bf16 v[24:27], v[36:39], a[216:223], v1
s_waitcnt vmcnt(5)
s_waitcnt lgkmcnt(4)
v_add_f32 v16, v16, v18
v_add_f32 v17, v17, v19
v_mfma_f32_16x16x32_bf16 v[44:47], v[48:51], v[8:11], 0
s_waitcnt lgkmcnt(2)
v_cvt_pk_bf16_f32 v16, v16, v17
v_add_f32 v21, v21, v23
v_add_f32 v20, v20, v22
v_cvt_pk_bf16_f32 v20, v20, v21
v_mfma_f32_16x16x32_bf16 v[44:47], v[52:55], v[12:15], v[44:47]
s_nop 0
ds_write2_b32 v3, v16, v20 offset0:1 offset1:129
v_smfmac_f32_16x16x64_bf16 v[28:31], v[36:39], v[80:87], v1
s_waitcnt lgkmcnt(2)
ds_read_b128 v[36:39], v0 offset:6144
v_smfmac_f32_16x16x64_bf16 v[24:27], v[40:43], a[224:231], v1
s_mov_b64 exec, s[54:55]
s_nop 0
ds_write_b128 v5, v[44:47] offset:0
s_mov_b64 exec, -1
v_smfmac_f32_16x16x64_bf16 v[28:31], v[40:43], a[232:239], v1
ds_read_b128 v[40:43], v0 offset:3072
s_waitcnt lgkmcnt(4)
v_smfmac_f32_16x16x64_bf16 v[24:27], v[32:35], a[240:247], v1
s_waitcnt lgkmcnt(2)
v_smfmac_f32_16x16x64_bf16 v[28:31], v[32:35], a[248:255], v1
s_mov_b32 s37, 0
ds_read_b128 v[32:35], v0 offset:7168
ds_read_b128 v[80:83], v2 offset:22528
v_smfmac_f32_16x16x64_bf16 v[24:27], v[36:39], v[72:79], v1
buffer_load_dwordx4 v[72:75], v0, s[4:7], s65 offen offset:2048 sc1
v_smfmac_f32_16x16x64_bf16 v[28:31], v[36:39], v[88:95], v1
ds_read_b128 v[36:39], v0 offset:8192
s_waitcnt lgkmcnt(4)
s_barrier
ds_read_b128 v[52:55], v6 offset:1024
s_waitcnt lgkmcnt(4)
v_smfmac_f32_16x16x64_bf16 v[28:31], v[40:43], v[104:111], v1
s_waitcnt lgkmcnt(3)
ds_read_b128 v[48:51], v6 offset:0
v_smfmac_f32_16x16x64_bf16 v[24:27], v[40:43], v[96:103], v1
s_add_u32 s24, s24, 524288
ds_read_b128 v[40:43], v0 offset:9216
ds_read_b64_tr_b16 v[10:11], v4 offset:512
v_smfmac_f32_16x16x64_bf16 v[24:27], v[32:35], v[112:119], v1
s_waitcnt lgkmcnt(4)
ds_read_b64_tr_b16 v[12:13], v4 offset:1024
ds_read_b64_tr_b16 v[8:9], v4 offset:0
ds_read_b64_tr_b16 v[14:15], v4 offset:1536
v_smfmac_f32_16x16x64_bf16 v[28:31], v[32:35], v[120:127], v1
s_waitcnt vmcnt(2)
ds_read_b64_tr_b16 v[20:21], v4 offset:3072
ds_read_b64_tr_b16 v[16:17], v4 offset:2048
v_smfmac_f32_16x16x64_bf16 v[24:27], v[36:39], v[128:135], v1
s_waitcnt lgkmcnt(7)
ds_read_b64_tr_b16 v[18:19], v4 offset:2560
v_add_f32 v49, v49, v53
v_smfmac_f32_16x16x64_bf16 v[28:31], v[36:39], v[136:143], v1
s_waitcnt lgkmcnt(7)
ds_read_b64_tr_b16 v[22:23], v4 offset:3584
v_add_f32 v51, v51, v55
v_smfmac_f32_16x16x64_bf16 v[28:31], v[40:43], v[64:71], v1
s_barrier
v_smfmac_f32_16x16x64_bf16 v[24:27], v[40:43], v[144:151], v1
s_waitcnt lgkmcnt(4)
ds_read_b128 v[84:87], v2 offset:23552
v_add_f32 v50, v50, v54
v_mfma_f32_16x16x32_bf16 v[44:47], v[8:11], v[8:11], 0
s_waitcnt lgkmcnt(4)
v_exp_f32 v51, v51
v_mfma_f32_16x16x32_bf16 v[44:47], v[12:15], v[12:15], v[44:47]
s_waitcnt lgkmcnt(1)
v_add_f32 v48, v48, v52
v_exp_f32 v49, v49
v_mfma_f32_16x16x32_bf16 v[44:47], v[16:19], v[16:19], v[44:47]
v_exp_f32 v48, v48
v_exp_f32 v50, v50
v_cvt_pk_bf16_f32 v54, v48, v49
v_cvt_pk_bf16_f32 v55, v50, v51
v_mfma_f32_16x16x32_bf16 v[44:47], v[20:23], v[20:23], v[44:47]
s_add_u32 s17, s17, 1
v_mov_b32_dpp v48, v54 quad_perm:[0,1,0,1] row_mask:0xf bank_mask:0xf
v_mov_b32_dpp v51, v55 quad_perm:[2,3,2,3] row_mask:0xf bank_mask:0xf
v_mov_b32_dpp v50, v54 quad_perm:[2,3,2,3] row_mask:0xf bank_mask:0xf
v_mov_b32_dpp v49, v55 quad_perm:[0,1,0,1] row_mask:0xf bank_mask:0xf
v_mov_b64 v[22:23], s[56:57]
v_mov_b64 v[20:21], s[56:57]
v_mfma_f32_16x16x32_bf16 v[8:11], v[56:59], v[48:51], 0
v_exp_f32_dpp v44, v46 quad_perm:[0,1,0,1] row_mask:0xf bank_mask:0xf
v_mfma_f32_16x16x32_bf16 v[16:19], v[20:23], v[48:51], 0
v_exp_f32_dpp v45, v47 quad_perm:[0,1,0,1] row_mask:0xf bank_mask:0xf
v_mfma_f32_16x16x32_bf16 v[12:15], v[60:63], v[48:51], 0
s_waitcnt lgkmcnt(0)
v_cvt_pk_bf16_f32 v24, v24, v25
v_cvt_pk_bf16_f32 v53, v44, v45
v_mov_b64 v[54:55], s[58:59]
v_cvt_pk_bf16_f32 v52, v44, v45
v_cvt_pk_bf16_f32 v25, v26, v27
v_cvt_pk_bf16_f32 v26, v28, v29
v_mfma_f32_16x16x16_bf16 v[16:19], v[54:55], v[52:53], v[16:19]
v_cvt_pk_bf16_f32 v27, v30, v31
v_mov_b64 v[32:33], 0
v_mfma_f32_16x16x16_bf16 v[8:11], v[24:25], v[52:53], v[8:11]
s_nop 0
ds_read_b128 v[28:31], v0 offset:19456
v_mov_b64 v[34:35], 0
v_mfma_f32_16x16x16_bf16 v[12:15], v[26:27], v[52:53], v[12:15]
s_add_u32 s25, s25, 10240
v_subrev_u32 v17, s46, v16
v_rcp_f32 v18, v16
v_cmp_lt_u32 vcc, s47, v17
v_mul_f32 v10, v10, v18
v_mul_f32 v9, v9, v18
v_mul_f32 v8, v8, v18
v_cvt_pk_bf16_f32 v8, v8, v9
v_mul_f32 v12, v12, v18
v_mul_f32 v11, v11, v18
v_mul_f32 v15, v15, v18
v_cvt_pk_bf16_f32 v9, v10, v11
v_mul_f32 v14, v14, v18
v_mul_f32 v13, v13, v18
v_cvt_pk_bf16_f32 v11, v14, v15
v_cvt_pk_bf16_f32 v10, v12, v13
s_cbranch_vccnz rare_137
back_138:
s_mov_b64 exec, s[54:55]
ds_write_b128 v5, v[8:11] offset:0
s_mov_b64 exec, -1
v_mov_b64 v[50:51], 0
v_smfmac_f32_16x16x64_bf16 v[32:35], v[8:11], v[80:87], v1
ds_read_b128 v[80:83], v0 offset:20480
ds_read_b128 v[24:27], v0 offset:18432
ds_read_b128 v[84:87], v0 offset:21504
v_mov_b64 v[54:55], 0
v_mov_b64 v[52:53], 0
v_mov_b64 v[40:41], 0
v_mov_b64 v[38:39], 0
v_mov_b64 v[48:49], 0
v_smfmac_f32_16x16x64_bf16 v[52:55], v[8:11], v[176:183], v1
s_mov_b32 s20, 393216
ds_read_b128 v[16:19], v0 offset:16384
buffer_load_dwordx4 v[76:79], v0, s[4:7], s65 offen offset:3072 sc1
v_mov_b64 v[36:37], 0
v_mov_b64 v[42:43], 0
v_smfmac_f32_16x16x64_bf16 v[48:51], v[8:11], v[168:175], v1
s_waitcnt lgkmcnt(4)
ds_read_b128 v[20:23], v0 offset:17408
s_barrier
ds_read_b128 v[56:59], v5 offset:512
v_smfmac_f32_16x16x64_bf16 v[40:43], v[8:11], v[160:167], v1
s_waitcnt lgkmcnt(4)
ds_read_b128 v[60:63], v5 offset:1024
ds_read_b128 v[12:15], v5 offset:1536
v_bfe_u32 v45, v0, 1, 7
v_smfmac_f32_16x16x64_bf16 v[36:39], v[8:11], v[152:159], v1
buffer_load_dwordx4 v[64:67], v0, s[4:7], s65 offen offset:0 sc1
v_lshrrev_b32 v44, 8, v0
s_waitcnt lgkmcnt(3)
buffer_load_dwordx4 v[68:71], v0, s[4:7], s65 offen offset:1024 sc1
v_lshl_or_b32 v44, v44, 12, v45
s_waitcnt lgkmcnt(2)
v_smfmac_f32_16x16x64_bf16 v[32:35], v[56:59], v[16:23], v1
ds_read_b128 v[16:19], v0 offset:22528
s_waitcnt lgkmcnt(2)
v_smfmac_f32_16x16x64_bf16 v[32:35], v[60:63], v[24:31], v1
s_add_u32 s43, s17, 2
ds_read_b128 v[24:27], v0 offset:24576
s_waitcnt lgkmcnt(2)
v_smfmac_f32_16x16x64_bf16 v[32:35], v[12:15], v[184:191], v1
ds_read_b128 v[20:23], v0 offset:23552
ds_read_b128 v[28:31], v0 offset:25600
v_smfmac_f32_16x16x64_bf16 v[36:39], v[56:59], v[80:87], v1
ds_read_b128 v[84:87], v0 offset:27648
ds_read_b128 v[80:83], v0 offset:26624
v_smfmac_f32_16x16x64_bf16 v[36:39], v[60:63], v[192:199], v1
s_nop 1
v_cvt_pk_bf16_f32 v32, v32, v33
v_cvt_pk_bf16_f32 v33, v34, v35
v_smfmac_f32_16x16x64_bf16 v[36:39], v[12:15], v[200:207], v1
s_min_u32 s43, s43, s39
s_waitcnt lgkmcnt(5)
v_and_or_b32 v32, v32, -2, s18
v_smfmac_f32_16x16x64_bf16 v[52:55], v[56:59], v[232:239], v1
s_waitcnt lgkmcnt(3)
buffer_store_dwordx2 v[32:33], v44, s[4:7], s60 offen
v_smfmac_f32_16x16x64_bf16 v[40:43], v[56:59], v[16:23], v1
s_waitcnt lgkmcnt(2)
v_cvt_pk_bf16_f32 v36, v36, v37
v_smfmac_f32_16x16x64_bf16 v[40:43], v[60:63], v[24:31], v1
v_cvt_pk_bf16_f32 v37, v38, v39
v_smfmac_f32_16x16x64_bf16 v[40:43], v[12:15], v[208:215], v1
v_and_or_b32 v36, v36, -2, s18
v_smfmac_f32_16x16x64_bf16 v[52:55], v[60:63], v[240:247], v1
s_nop 0
buffer_store_dwordx2 v[36:37], v44, s[4:7], s61 offen
s_nop 0
v_smfmac_f32_16x16x64_bf16 v[52:55], v[12:15], v[248:255], v1
s_waitcnt lgkmcnt(0)
s_add_u32 s34, s24, 524288
v_cvt_pk_bf16_f32 v40, v40, v41
v_smfmac_f32_16x16x64_bf16 v[48:51], v[56:59], v[80:87], v1
v_cvt_pk_bf16_f32 v41, v42, v43
v_and_or_b32 v40, v40, -2, s18
v_smfmac_f32_16x16x64_bf16 v[48:51], v[60:63], v[216:223], v1
buffer_store_dwordx2 v[40:41], v44, s[4:7], s62 offen
v_smfmac_f32_16x16x64_bf16 v[48:51], v[12:15], v[224:231], v1
s_nop 1
v_cvt_pk_bf16_f32 v52, v52, v53
v_cvt_pk_bf16_f32 v53, v54, v55
s_nop 3
v_cvt_pk_bf16_f32 v48, v48, v49
v_and_or_b32 v48, v48, -2, s18
v_cvt_pk_bf16_f32 v49, v50, v51
buffer_store_dwordx2 v[48:49], v44, s[4:7], s63 offen
s_mov_b32 s21, 397312
v_and_or_b32 v52, v52, -2, s18
buffer_store_dwordx2 v[52:53], v44, s[4:7], s64 offen
v_bfe_u32 v34, v0, 6, 1
v_lshlrev_b32 v34, 4, v34
v_mov_b32 v35, 0x3f80
v_lshlrev_b32 v34, v34, v35
v_bfe_i32 v35, v0, 4, 1
v_and_b32 v45, v34, v35
v_and_b32 v47, v34, v35
v_xor_b32 v44, v34, v45
v_xor_b32 v46, v34, v45
v_and_b32 v36, 32, v0
v_bfe_u32 v37, v0, 6, 1
v_lshl_add_u32 v36, v37, 8, v36
v_bfe_u32 v37, v0, 8, 1
v_lshl_add_u32 v36, v37, 4, v36
v_bfe_u32 v37, v0, 4, 1
v_lshl_add_u32 v36, v37, 3, v36
ds_read_b128 v[80:83], v2 offset:0
ds_read_b128 v[84:87], v2 offset:1024
v_mov_b64 v[24:25], 0
v_mov_b64 v[26:27], 0
v_mov_b64 v[28:29], 0
v_mov_b64 v[30:31], 0
s_waitcnt vmcnt(9)
v_bfe_u32 v7, v0, 2, 3
v_add_u32 v7, s28, v7
s_mov_b32 exec_hi, 0
v_and_b32 v7, 511, v0
v_lshl_add_u32 v7, v7, 3, s34
s_mov_b32 exec_hi, -1
s_nop 15
s_nop 15
s_nop 14
buffer_load_dwordx4 v[8:11], v0, s[4:7], s27 offen offset:0 sc1
buffer_load_dwordx4 v[12:15], v0, s[4:7], s27 offen offset:1024 sc1
buffer_load_dwordx4 v[16:19], v0, s[4:7], s27 offen offset:2048 sc1
buffer_load_dwordx4 v[20:23], v0, s[4:7], s27 offen offset:3072 sc1
s_barrier
buffer_load_dwordx4 v[48:51], v0, s[4:7], s66 offen offset:0 sc1
buffer_load_dwordx4 v[52:55], v0, s[4:7], s66 offen offset:1024 sc1
buffer_load_dwordx4 v[56:59], v0, s[4:7], s66 offen offset:2048 sc1
buffer_load_dwordx4 v[60:63], v0, s[4:7], s66 offen offset:3072 sc1
v_mov_b64 v[40:41], 0
v_mov_b64 v[42:43], 0
s_waitcnt vmcnt(6)
s_nop 0
v_smfmac_f32_16x16x64_bf16 v[40:43], v[44:47], v[8:15], v1
v_bitop3_b32 v34, v8, v10, s18 bitop3:0x7e
v_bitop3_b32 v35, v12, v14, s18 bitop3:0x7e
s_waitcnt vmcnt(4)
v_smfmac_f32_16x16x64_bf16 v[40:43], v[44:47], v[16:23], v1
v_bitop3_b32 v32, v16, v18, s18 bitop3:0x7e
v_bitop3_b32 v33, v20, v22, s18 bitop3:0x7e
v_or3_b32 v34, v34, v35, v32
v_bitop3_b32 v34, v34, v33, 1 bitop3:0xa8
v_cmp_ne_u32 vcc, 0, v34
s_cbranch_vccnz red_143
red_143_ok:
s_nop 1
v_add_f32_dpp v40, v40, v40 row_ror:8 row_mask:0xf bank_mask:0xf
v_add_f32_dpp v41, v41, v41 row_ror:8 row_mask:0xf bank_mask:0xf
v_add_f32_dpp v42, v42, v42 row_ror:8 row_mask:0xf bank_mask:0xf
v_add_f32_dpp v43, v43, v43 row_ror:8 row_mask:0xf bank_mask:0xf
v_cvt_pk_bf16_f32 v40, v40, v41
v_cvt_pk_bf16_f32 v41, v42, v43
v_and_or_b32 v40, v40, -2, s18
s_mov_b64 exec, 0x00ff00ff
buffer_store_dwordx2 v[40:41], v36, s[4:7], s40 offen
s_mov_b64 exec, -1
g2_145:
v_mov_b64 v[8:9], 0
v_mov_b64 v[10:11], 0
v_mov_b64 v[12:13], 0
v_mov_b64 v[14:15], 0
v_mov_b64 v[16:17], 0
v_mov_b64 v[18:19], 0
v_mov_b64 v[20:21], 0
v_mov_b64 v[22:23], 0
s_mov_b32 s37, 0
s_cmp_eq_u32 s17, s38
s_barrier
s_nop 15
s_nop 7
s_cbranch_scc0 gather_136
s_branch exit_139
red_143:
buffer_load_dwordx4 v[8:11], v0, s[4:7], s27 offen offset:0 sc1
buffer_load_dwordx4 v[12:15], v0, s[4:7], s27 offen offset:1024 sc1
buffer_load_dwordx4 v[16:19], v0, s[4:7], s27 offen offset:2048 sc1
buffer_load_dwordx4 v[20:23], v0, s[4:7], s27 offen offset:3072 sc1
s_add_u32 s37, s37, 1
s_cmp_gt_u32 s37, 262144
s_cbranch_scc1 L_fail
v_mov_b64 v[40:41], 0
v_mov_b64 v[42:43], 0
s_waitcnt vmcnt(2)
s_nop 0
v_smfmac_f32_16x16x64_bf16 v[40:43], v[44:47], v[8:15], v1
v_bitop3_b32 v34, v8, v10, s18 bitop3:0x7e
v_bitop3_b32 v35, v12, v14, s18 bitop3:0x7e
s_waitcnt vmcnt(0)
v_smfmac_f32_16x16x64_bf16 v[40:43], v[44:47], v[16:23], v1
v_bitop3_b32 v32, v16, v18, s18 bitop3:0x7e
v_bitop3_b32 v33, v20, v22, s18 bitop3:0x7e
v_or3_b32 v34, v34, v35, v32
v_bitop3_b32 v34, v34, v33, 1 bitop3:0xa8
v_cmp_ne_u32 vcc, 0, v34
s_cbranch_vccnz red_143
s_branch red_143_ok
rare_137:
ds_read_b128 v[48:51], v6 offset:0
ds_read_b128 v[52:55], v6 offset:1024
s_waitcnt lgkmcnt(0)
s_barrier
v_add_f32 v48, v48, v52
v_add_f32 v49, v49, v53
v_add_f32 v50, v50, v54
v_add_f32 v51, v51, v55
v_mov_b32_dpp v46, v46 quad_perm:[0,1,0,1] row_mask:0xf bank_mask:0xf
v_mov_b32_dpp v47, v47 quad_perm:[0,1,0,1] row_mask:0xf bank_mask:0xf
v_max3_f32 v19, v48, v49, v50
v_max3_f32 v19, v19, v51, v46
v_max_f32 v19, v19, v47
s_nop 1
v_max_f32_dpp v19, v19, v19 quad_perm:[2,3,0,1] row_mask:0xf bank_mask:0xf
v_mov_b32 v44, v19
s_nop 1
v_permlane32_swap_b32 v19, v44
v_max_f32 v19, v19, v44
v_mov_b32 v44, v19
s_nop 1
v_permlane16_swap_b32 v19, v44
v_max_f32 v19, v19, v44
v_sub_f32 v48, v48, v19
v_sub_f32 v49, v49, v19
v_sub_f32 v50, v50, v19
v_sub_f32 v51, v51, v19
v_sub_f32 v46, v46, v19
v_sub_f32 v47, v47, v19
v_exp_f32 v48, v48
v_exp_f32 v49, v49
v_exp_f32 v50, v50
v_exp_f32 v51, v51
v_cvt_pk_bf16_f32 v54, v48, v49
v_cvt_pk_bf16_f32 v55, v50, v51
s_nop 0
v_mov_b32_dpp v48, v54 quad_perm:[0,1,0,1] row_mask:0xf bank_mask:0xf
v_mov_b32_dpp v49, v55 quad_perm:[0,1,0,1] row_mask:0xf bank_mask:0xf
v_mov_b32_dpp v50, v54 quad_perm:[2,3,2,3] row_mask:0xf bank_mask:0xf
v_mov_b32_dpp v51, v55 quad_perm:[2,3,2,3] row_mask:0xf bank_mask:0xf
v_mov_b64 v[20:21], s[56:57]
v_mov_b64 v[22:23], s[56:57]
v_mfma_f32_16x16x32_bf16 v[8:11], v[56:59], v[48:51], 0
v_mfma_f32_16x16x32_bf16 v[12:15], v[60:63], v[48:51], 0
v_mfma_f32_16x16x32_bf16 v[16:19], v[20:23], v[48:51], 0
v_mov_b64 v[54:55], s[58:59]
v_exp_f32_dpp v44, v46 quad_perm:[0,1,0,1] row_mask:0xf bank_mask:0xf
v_exp_f32_dpp v45, v47 quad_perm:[0,1,0,1] row_mask:0xf bank_mask:0xf
s_nop 0
v_cvt_pk_bf16_f32 v52, v44, v45
v_cvt_pk_bf16_f32 v53, v44, v45
s_nop 1
v_mfma_f32_16x16x16_bf16 v[16:19], v[54:55], v[52:53], v[16:19]
v_mfma_f32_16x16x16_bf16 v[8:11], v[24:25], v[52:53], v[8:11]
v_mfma_f32_16x16x16_bf16 v[12:15], v[26:27], v[52:53], v[12:15]
s_nop 5
v_rcp_f32 v18, v16
s_nop 0
v_mul_f32 v8, v8, v18
v_mul_f32 v9, v9, v18
v_mul_f32 v10, v10, v18
v_mul_f32 v11, v11, v18
v_mul_f32 v12, v12, v18
v_mul_f32 v13, v13, v18
v_mul_f32 v14, v14, v18
v_mul_f32 v15, v15, v18
v_cvt_pk_bf16_f32 v8, v8, v9
v_cvt_pk_bf16_f32 v9, v10, v11
v_cvt_pk_bf16_f32 v10, v12, v13
v_cvt_pk_bf16_f32 v11, v14, v15
s_branch back_138
exit_139:
buffer_load_dwordx4 v[32:35], v0, s[4:7], s20 offen sc1
buffer_load_dwordx4 v[36:39], v0, s[4:7], s21 offen sc1
buffer_load_dwordx4 v[40:43], v0, s[4:7], s22 offen sc1
s_add_u32 s37, s37, 1
s_cmp_gt_u32 s37, 262144
s_cbranch_scc1 L_fail
s_waitcnt vmcnt(2)
v_bitop3_b32 v44, v32, v34, s18 bitop3:0x7e
s_waitcnt vmcnt(1)
v_bitop3_b32 v45, v36, v38, s18 bitop3:0x7e
v_or_b32 v44, v44, v45
s_waitcnt vmcnt(0)
v_bitop3_b32 v46, v40, v42, s18 bitop3:0x7e
v_bitop3_b32 v44, v44, v46, s19 bitop3:0xa8
v_cmp_ne_u32 vcc, 0, v44
s_cbranch_vccnz exit_139
s_add_u32 s45, s45, 1
s_cmp_lt_u32 s45, 2
s_cbranch_scc1 layer_135
s_endpgm
wave_132:
layer_148:
s_lshl_b32 s17, s45, 6
s_mul_i32 s34, s45, 34603008
s_lshl_b32 s35, s15, 14
s_add_u32 s34, s34, s35
s_add_u32 s24, s34, 16781312
s_mul_i32 s34, s17, 10240
s_add_u32 s34, s34, s30
s_add_u32 s25, s34, s31
s_mov_b32 s19, 0
s_add_u32 s43, s17, 1
s_add_u32 s38, s17, 63
s_add_u32 s39, s17, 64
s_mov_b32 s34, s24
v_mov_b32 v7, 0
s_mov_b32 s20, 410624
s_mov_b32 s21, 414720
s_mov_b32 s22, 418816
buffer_load_dwordx4 v[64:67], v0, s[4:7], s65 offen offset:0 sc1
buffer_load_dwordx4 v[68:71], v0, s[4:7], s65 offen offset:1024 sc1
buffer_load_dwordx4 v[72:75], v0, s[4:7], s65 offen offset:2048 sc1
buffer_load_dwordx4 v[76:79], v0, s[4:7], s65 offen offset:3072 sc1
ds_read_b128 v[80:83], v2 offset:0
ds_read_b128 v[84:87], v2 offset:1024
buffer_load_dwordx4 v[48:51], v0, s[4:7], s66 offen offset:0 sc1
buffer_load_dwordx4 v[52:55], v0, s[4:7], s66 offen offset:1024 sc1
buffer_load_dwordx4 v[56:59], v0, s[4:7], s66 offen offset:2048 sc1
buffer_load_dwordx4 v[60:63], v0, s[4:7], s66 offen offset:3072 sc1
v_mov_b64 v[8:9], 0
v_mov_b64 v[10:11], 0
v_mov_b64 v[12:13], 0
v_mov_b64 v[14:15], 0
v_mov_b64 v[16:17], 0
v_mov_b64 v[18:19], 0
v_mov_b64 v[20:21], 0
v_mov_b64 v[22:23], 0
v_mov_b64 v[24:25], 0
v_mov_b64 v[26:27], 0
v_mov_b64 v[28:29], 0
v_mov_b64 v[30:31], 0
s_barrier
v_bfe_u32 v7, v0, 2, 3
v_add_u32 v7, s28, v7
s_mov_b32 exec_hi, 0
v_and_b32 v7, 511, v0
v_lshl_add_u32 v7, v7, 3, s34
s_mov_b32 exec_hi, -1
s_mov_b32 s37, 0
gather_149:
buffer_load_dwordx4 v[32:35], v0, s[4:7], s20 offen sc1
buffer_load_dwordx4 v[36:39], v0, s[4:7], s21 offen sc1
buffer_load_dwordx4 v[40:43], v0, s[4:7], s22 offen sc1
s_add_u32 s37, s37, 1
s_cmp_gt_u32 s37, 262144
s_cbranch_scc1 L_fail
s_waitcnt vmcnt(2)
v_bitop3_b32 v44, v32, v34, s18 bitop3:0x7e
s_waitcnt vmcnt(1)
v_bitop3_b32 v45, v36, v38, s18 bitop3:0x7e
v_or_b32 v44, v44, v45
s_waitcnt vmcnt(0)
v_bitop3_b32 v46, v40, v42, s18 bitop3:0x7e
v_bitop3_b32 v44, v44, v46, s19 bitop3:0xa8
v_cmp_ne_u32 vcc, 0, v44
s_cbranch_vccnz gather_149
v_smfmac_f32_16x16x64_bf16 v[8:11], v[32:35], v[64:71], v1
buffer_load_dwordx4 v[64:67], v0, s[4:7], s67 offen offset:0 sc1
ds_write_b128 v0, v[36:39] offset:5120
v_smfmac_f32_16x16x64_bf16 v[20:23], v[32:35], v[56:63], v1
ds_read_b128 v[56:59], v2 offset:2048
buffer_load_dwordx4 v[68:71], v0, s[4:7], s67 offen offset:1024 sc1
ds_read_b128 v[60:63], v2 offset:3072
ds_write_b128 v0, v[32:35] offset:1024
v_smfmac_f32_16x16x64_bf16 v[12:15], v[32:35], v[72:79], v1
buffer_load_dwordx4 v[72:75], v0, s[4:7], s67 offen offset:2048 sc1
s_waitcnt lgkmcnt(4)
v_smfmac_f32_16x16x64_bf16 v[24:27], v[32:35], v[80:87], v1
ds_write_b128 v0, v[40:43] offset:9216
v_smfmac_f32_16x16x64_bf16 v[16:19], v[32:35], v[48:55], v1
ds_read_b128 v[80:83], v2 offset:4096
ds_read_b128 v[84:87], v2 offset:5120
v_smfmac_f32_16x16x64_bf16 v[28:31], v[32:35], a[0:7], v1
s_waitcnt lgkmcnt(5)
s_waitcnt lgkmcnt(4)
v_smfmac_f32_16x16x64_bf16 v[20:23], v[36:39], v[56:63], v1
buffer_load_dwordx4 v[76:79], v0, s[4:7], s67 offen offset:3072 sc1
ds_read_b128 v[60:63], v2 offset:7168
ds_read_b128 v[56:59], v2 offset:6144
v_smfmac_f32_16x16x64_bf16 v[8:11], v[36:39], a[8:15], v1
s_waitcnt lgkmcnt(4)
s_barrier
ds_read_b128 v[40:43], v0 offset:0
v_smfmac_f32_16x16x64_bf16 v[12:15], v[36:39], a[16:23], v1
s_waitcnt lgkmcnt(3)
ds_read_b128 v[44:47], v0 offset:4096
ds_read_b128 v[32:35], v0 offset:3072
v_smfmac_f32_16x16x64_bf16 v[24:27], v[36:39], v[80:87], v1
ds_read_b128 v[80:83], v2 offset:8192
v_smfmac_f32_16x16x64_bf16 v[28:31], v[36:39], a[32:39], v1
buffer_load_dwordx4 v[48:51], v0, s[4:7], s24 offen offset:0 nt sc1
v_smfmac_f32_16x16x64_bf16 v[16:19], v[36:39], a[24:31], v1
ds_read_b128 v[36:39], v0 offset:7168
s_waitcnt lgkmcnt(4)
v_smfmac_f32_16x16x64_bf16 v[8:11], v[40:43], a[40:47], v1
ds_read_b128 v[84:87], v2 offset:9216
s_waitcnt lgkmcnt(4)
v_smfmac_f32_16x16x64_bf16 v[12:15], v[40:43], a[48:55], v1
s_waitcnt vmcnt(4)
ds_read_b128 v[40:43], v0 offset:2048
v_smfmac_f32_16x16x64_bf16 v[12:15], v[44:47], v[56:63], v1
s_waitcnt lgkmcnt(4)
ds_read_b128 v[60:63], v2 offset:11264
ds_read_b128 v[56:59], v2 offset:10240
v_smfmac_f32_16x16x64_bf16 v[8:11], v[44:47], a[56:63], v1
buffer_load_dwordx4 v[52:55], v0, s[4:7], s24 offen offset:1024 nt sc1
v_smfmac_f32_16x16x64_bf16 v[8:11], v[32:35], a[64:71], v1
s_waitcnt lgkmcnt(4)
ds_read_b128 v[44:47], v0 offset:6144
s_waitcnt lgkmcnt(4)
v_smfmac_f32_16x16x64_bf16 v[12:15], v[32:35], a[72:79], v1
s_waitcnt vmcnt(4)
ds_read_b128 v[32:35], v0 offset:9216
s_waitcnt lgkmcnt(4)
v_smfmac_f32_16x16x64_bf16 v[8:11], v[36:39], v[80:87], v1
ds_read_b128 v[80:83], v2 offset:12288
ds_read_b128 v[84:87], v2 offset:13312
v_smfmac_f32_16x16x64_bf16 v[8:11], v[40:43], v[64:71], v1
buffer_load_dwordx4 v[64:67], v0, s[4:7], s68 offen offset:0 sc1
v_smfmac_f32_16x16x64_bf16 v[12:15], v[36:39], a[80:87], v1
s_waitcnt lgkmcnt(4)
ds_read_b128 v[36:39], v0 offset:8192
v_smfmac_f32_16x16x64_bf16 v[12:15], v[40:43], v[56:63], v1
ds_read_b128 v[40:43], v0 offset:0
s_waitcnt lgkmcnt(5)
v_smfmac_f32_16x16x64_bf16 v[8:11], v[44:47], a[88:95], v1
buffer_load_dwordx4 v[68:71], v0, s[4:7], s68 offen offset:1024 sc1
v_smfmac_f32_16x16x64_bf16 v[12:15], v[44:47], a[96:103], v1
s_waitcnt lgkmcnt(4)
ds_read_b128 v[60:63], v2 offset:15360
s_waitcnt lgkmcnt(3)
v_smfmac_f32_16x16x64_bf16 v[12:15], v[32:35], a[104:111], v1
ds_read_b128 v[56:59], v2 offset:14336
s_waitcnt vmcnt(5)
v_smfmac_f32_16x16x64_bf16 v[8:11], v[32:35], v[80:87], v1
s_waitcnt vmcnt(4)
ds_read_b128 v[32:35], v0 offset:4096
s_waitcnt lgkmcnt(4)
v_smfmac_f32_16x16x64_bf16 v[8:11], v[36:39], a[112:119], v1
s_waitcnt lgkmcnt(3)
ds_read_b128 v[80:83], v2 offset:16384
ds_read_b128 v[84:87], v2 offset:17408
v_smfmac_f32_16x16x64_bf16 v[16:19], v[40:43], v[72:79], v1
s_mov_b32 s22, 402432
buffer_load_dwordx4 v[72:75], v0, s[4:7], s68 offen offset:2048 sc1
v_smfmac_f32_16x16x64_bf16 v[12:15], v[36:39], a[120:127], v1
s_waitcnt lgkmcnt(4)
ds_read_b128 v[36:39], v0 offset:3072
s_waitcnt lgkmcnt(4)
v_add_f32 v8, v8, v10
v_smfmac_f32_16x16x64_bf16 v[20:23], v[40:43], v[56:63], v1
s_waitcnt lgkmcnt(3)
buffer_load_dwordx4 v[76:79], v0, s[4:7], s68 offen offset:3072 sc1
v_smfmac_f32_16x16x64_bf16 v[20:23], v[32:35], a[136:143], v1
s_waitcnt lgkmcnt(2)
ds_read_b128 v[40:43], v0 offset:7168
v_mul_f32 v8, s44, v8
v_add_f32 v9, v9, v11
v_smfmac_f32_16x16x64_bf16 v[16:19], v[32:35], a[128:135], v1
buffer_load_dwordx4 v[56:59], v0, s[4:7], s24 offen offset:2048 nt sc1
ds_read_b128 v[32:35], v0 offset:2048
s_waitcnt lgkmcnt(2)
v_mul_f32 v9, s44, v9
v_add_f32 v12, v12, v14
v_smfmac_f32_16x16x64_bf16 v[16:19], v[36:39], v[80:87], v1
ds_read_b128 v[80:83], v2 offset:18432
v_cvt_pk_bf16_f32 v8, v8, v9
v_smfmac_f32_16x16x64_bf16 v[20:23], v[36:39], a[144:151], v1
s_waitcnt lgkmcnt(2)
ds_read_b128 v[84:87], v2 offset:19456
v_add_f32 v13, v13, v15
v_smfmac_f32_16x16x64_bf16 v[20:23], v[40:43], a[160:167], v1
s_xor_b32 s18, s18, 1
ds_read_b128 v[36:39], v0 offset:6144
v_mul_f32 v12, s44, v12
v_mul_f32 v13, s44, v13
v_cvt_pk_bf16_f32 v12, v12, v13
v_smfmac_f32_16x16x64_bf16 v[16:19], v[40:43], a[152:159], v1
s_waitcnt lgkmcnt(3)
ds_write2_b32 v3, v8, v12 offset0:0 offset1:128
v_smfmac_f32_16x16x64_bf16 v[20:23], v[32:35], a[168:175], v1
ds_read_b128 v[40:43], v0 offset:9216
buffer_load_dwordx4 v[60:63], v0, s[4:7], s24 offen offset:3072 nt sc1
s_mov_b32 s19, 1
s_waitcnt lgkmcnt(3)
s_waitcnt lgkmcnt(2)
v_smfmac_f32_16x16x64_bf16 v[20:23], v[36:39], v[80:87], v1
s_waitcnt vmcnt(7)
s_waitcnt vmcnt(5)
ds_read_b128 v[84:87], v2 offset:21504
s_waitcnt vmcnt(4)
v_smfmac_f32_16x16x64_bf16 v[16:19], v[32:35], v[64:71], v1
ds_read_b128 v[32:35], v0 offset:8192
buffer_load_dwordx4 v[64:67], v0, s[4:7], s69 offen offset:0 sc1
v_smfmac_f32_16x16x64_bf16 v[16:19], v[36:39], a[176:183], v1
s_waitcnt lgkmcnt(2)
ds_read_b128 v[36:39], v0 offset:0
ds_read_b128 v[80:83], v2 offset:20480
buffer_load_dwordx4 v[68:71], v0, s[4:7], s69 offen offset:1024 sc1
v_smfmac_f32_16x16x64_bf16 v[16:19], v[40:43], a[184:191], v1
s_barrier
ds_read_b64_tr_b16 v[8:9], v4 offset:0
ds_read_b64_tr_b16 v[10:11], v4 offset:512
v_smfmac_f32_16x16x64_bf16 v[20:23], v[40:43], a[192:199], v1
s_waitcnt lgkmcnt(4)
ds_read_b64_tr_b16 v[14:15], v4 offset:1536
ds_read_b64_tr_b16 v[12:13], v4 offset:1024
v_smfmac_f32_16x16x64_bf16 v[16:19], v[32:35], a[200:207], v1
buffer_load_dword v7, v7, s[4:7], 0 offen sc1
v_smfmac_f32_16x16x64_bf16 v[20:23], v[32:35], a[208:215], v1
s_waitcnt lgkmcnt(5)
ds_read_b128 v[40:43], v0 offset:4096
ds_read_b128 v[32:35], v0 offset:3072
v_smfmac_f32_16x16x64_bf16 v[24:27], v[36:39], a[216:223], v1
s_waitcnt vmcnt(5)
s_waitcnt lgkmcnt(4)
v_add_f32 v16, v16, v18
v_add_f32 v17, v17, v19
v_mfma_f32_16x16x32_bf16 v[44:47], v[48:51], v[8:11], 0
s_waitcnt lgkmcnt(2)
v_cvt_pk_bf16_f32 v16, v16, v17
v_add_f32 v21, v21, v23
v_add_f32 v20, v20, v22
v_cvt_pk_bf16_f32 v20, v20, v21
v_mfma_f32_16x16x32_bf16 v[44:47], v[52:55], v[12:15], v[44:47]
s_nop 0
ds_write2_b32 v3, v16, v20 offset0:1 offset1:129
v_smfmac_f32_16x16x64_bf16 v[28:31], v[36:39], v[80:87], v1
s_waitcnt lgkmcnt(2)
ds_read_b128 v[36:39], v0 offset:7168
v_xor_b32 v48, 128, v5
v_smfmac_f32_16x16x64_bf16 v[24:27], v[40:43], a[224:231], v1
s_mov_b64 exec, s[54:55]
ds_write_b128 v48, v[44:47] offset:512
s_mov_b64 exec, -1
v_smfmac_f32_16x16x64_bf16 v[28:31], v[40:43], a[232:239], v1
ds_read_b128 v[40:43], v0 offset:2048
s_waitcnt lgkmcnt(4)
v_smfmac_f32_16x16x64_bf16 v[24:27], v[32:35], a[240:247], v1
s_waitcnt lgkmcnt(2)
v_smfmac_f32_16x16x64_bf16 v[28:31], v[32:35], a[248:255], v1
s_mov_b32 s37, 0
ds_read_b128 v[32:35], v0 offset:6144
ds_read_b128 v[80:83], v2 offset:22528
v_smfmac_f32_16x16x64_bf16 v[24:27], v[36:39], v[72:79], v1
buffer_load_dwordx4 v[72:75], v0, s[4:7], s65 offen offset:2048 sc1
v_smfmac_f32_16x16x64_bf16 v[28:31], v[36:39], v[88:95], v1
ds_read_b128 v[36:39], v0 offset:9216
s_waitcnt lgkmcnt(4)
s_barrier
ds_read_b128 v[52:55], v6 offset:1024
s_waitcnt lgkmcnt(4)
v_smfmac_f32_16x16x64_bf16 v[28:31], v[40:43], v[104:111], v1
s_waitcnt lgkmcnt(3)
ds_read_b128 v[48:51], v6 offset:0
v_smfmac_f32_16x16x64_bf16 v[24:27], v[40:43], v[96:103], v1
s_add_u32 s24, s24, 524288
ds_read_b128 v[40:43], v0 offset:8192
ds_read_b64_tr_b16 v[10:11], v4 offset:512
v_smfmac_f32_16x16x64_bf16 v[24:27], v[32:35], v[112:119], v1
s_waitcnt lgkmcnt(4)
ds_read_b64_tr_b16 v[12:13], v4 offset:1024
ds_read_b64_tr_b16 v[8:9], v4 offset:0
ds_read_b64_tr_b16 v[14:15], v4 offset:1536
v_smfmac_f32_16x16x64_bf16 v[28:31], v[32:35], v[120:127], v1
s_waitcnt vmcnt(2)
ds_read_b64_tr_b16 v[20:21], v4 offset:3072
ds_read_b64_tr_b16 v[16:17], v4 offset:2048
v_smfmac_f32_16x16x64_bf16 v[24:27], v[36:39], v[128:135], v1
s_waitcnt lgkmcnt(7)
ds_read_b64_tr_b16 v[18:19], v4 offset:2560
v_add_f32 v49, v49, v53
v_smfmac_f32_16x16x64_bf16 v[28:31], v[36:39], v[136:143], v1
s_waitcnt lgkmcnt(7)
ds_read_b64_tr_b16 v[22:23], v4 offset:3584
v_add_f32 v51, v51, v55
v_smfmac_f32_16x16x64_bf16 v[28:31], v[40:43], v[64:71], v1
s_barrier
v_smfmac_f32_16x16x64_bf16 v[24:27], v[40:43], v[144:151], v1
s_waitcnt lgkmcnt(4)
ds_read_b128 v[84:87], v2 offset:23552
v_add_f32 v50, v50, v54
v_mfma_f32_16x16x32_bf16 v[44:47], v[8:11], v[8:11], 0
s_waitcnt lgkmcnt(4)
v_exp_f32 v51, v51
v_mfma_f32_16x16x32_bf16 v[44:47], v[12:15], v[12:15], v[44:47]
s_waitcnt lgkmcnt(1)
v_add_f32 v48, v48, v52
v_exp_f32 v49, v49
v_mfma_f32_16x16x32_bf16 v[44:47], v[16:19], v[16:19], v[44:47]
v_exp_f32 v48, v48
v_exp_f32 v50, v50
v_cvt_pk_bf16_f32 v54, v48, v49
v_cvt_pk_bf16_f32 v55, v50, v51
v_mfma_f32_16x16x32_bf16 v[44:47], v[20:23], v[20:23], v[44:47]
s_add_u32 s17, s17, 1
v_mov_b32_dpp v48, v54 quad_perm:[0,1,0,1] row_mask:0xf bank_mask:0xf
v_mov_b32_dpp v51, v55 quad_perm:[2,3,2,3] row_mask:0xf bank_mask:0xf
v_mov_b32_dpp v50, v54 quad_perm:[2,3,2,3] row_mask:0xf bank_mask:0xf
v_mov_b32_dpp v49, v55 quad_perm:[0,1,0,1] row_mask:0xf bank_mask:0xf
v_mov_b64 v[22:23], s[56:57]
v_mov_b64 v[20:21], s[56:57]
v_mfma_f32_16x16x32_bf16 v[8:11], v[56:59], v[48:51], 0
v_exp_f32_dpp v44, v46 quad_perm:[0,1,0,1] row_mask:0xf bank_mask:0xf
v_mfma_f32_16x16x32_bf16 v[16:19], v[20:23], v[48:51], 0
v_exp_f32_dpp v45, v47 quad_perm:[0,1,0,1] row_mask:0xf bank_mask:0xf
v_mfma_f32_16x16x32_bf16 v[12:15], v[60:63], v[48:51], 0
s_waitcnt lgkmcnt(0)
v_cvt_pk_bf16_f32 v24, v24, v25
v_cvt_pk_bf16_f32 v53, v44, v45
v_mov_b64 v[54:55], s[58:59]
v_cvt_pk_bf16_f32 v52, v44, v45
v_cvt_pk_bf16_f32 v25, v26, v27
v_cvt_pk_bf16_f32 v26, v28, v29
v_mfma_f32_16x16x16_bf16 v[16:19], v[54:55], v[52:53], v[16:19]
v_cvt_pk_bf16_f32 v27, v30, v31
v_mov_b64 v[32:33], 0
v_mfma_f32_16x16x16_bf16 v[8:11], v[24:25], v[52:53], v[8:11]
s_nop 0
ds_read_b128 v[28:31], v0 offset:31744
v_mov_b64 v[34:35], 0
v_mfma_f32_16x16x16_bf16 v[12:15], v[26:27], v[52:53], v[12:15]
s_add_u32 s25, s25, 10240
v_subrev_u32 v17, s46, v16
v_rcp_f32 v18, v16
v_cmp_lt_u32 vcc, s47, v17
v_mul_f32 v10, v10, v18
v_mul_f32 v9, v9, v18
v_mul_f32 v8, v8, v18
v_cvt_pk_bf16_f32 v8, v8, v9
v_mul_f32 v12, v12, v18
v_mul_f32 v11, v11, v18
v_mul_f32 v15, v15, v18
v_cvt_pk_bf16_f32 v9, v10, v11
v_mul_f32 v14, v14, v18
v_mul_f32 v13, v13, v18
v_cvt_pk_bf16_f32 v11, v14, v15
v_cvt_pk_bf16_f32 v10, v12, v13
s_cbranch_vccnz rare_150
back_151:
s_mov_b64 exec, s[54:55]
ds_write_b128 v5, v[8:11] offset:512
s_mov_b64 exec, -1
v_mov_b64 v[50:51], 0
v_smfmac_f32_16x16x64_bf16 v[32:35], v[8:11], v[80:87], v1
ds_read_b128 v[80:83], v0 offset:32768
ds_read_b128 v[24:27], v0 offset:30720
ds_read_b128 v[84:87], v0 offset:33792
v_mov_b64 v[54:55], 0
v_mov_b64 v[52:53], 0
v_mov_b64 v[40:41], 0
v_mov_b64 v[38:39], 0
v_mov_b64 v[48:49], 0
v_smfmac_f32_16x16x64_bf16 v[52:55], v[8:11], v[176:183], v1
s_mov_b32 s20, 394240
ds_read_b128 v[16:19], v0 offset:28672
buffer_load_dwordx4 v[76:79], v0, s[4:7], s65 offen offset:3072 sc1
v_mov_b64 v[36:37], 0
v_mov_b64 v[42:43], 0
v_smfmac_f32_16x16x64_bf16 v[48:51], v[8:11], v[168:175], v1
s_waitcnt lgkmcnt(4)
ds_read_b128 v[20:23], v0 offset:29696
s_barrier
ds_read_b128 v[56:59], v5 offset:0
v_smfmac_f32_16x16x64_bf16 v[40:43], v[8:11], v[160:167], v1
s_waitcnt lgkmcnt(4)
ds_read_b128 v[60:63], v5 offset:1536
ds_read_b128 v[12:15], v5 offset:1024
v_bfe_u32 v45, v0, 1, 7
v_smfmac_f32_16x16x64_bf16 v[36:39], v[8:11], v[152:159], v1
buffer_load_dwordx4 v[64:67], v0, s[4:7], s65 offen offset:0 sc1
v_lshrrev_b32 v44, 8, v0
s_waitcnt lgkmcnt(3)
buffer_load_dwordx4 v[68:71], v0, s[4:7], s65 offen offset:1024 sc1
v_lshl_or_b32 v44, v44, 12, v45
s_waitcnt lgkmcnt(2)
v_smfmac_f32_16x16x64_bf16 v[32:35], v[56:59], v[16:23], v1
ds_read_b128 v[16:19], v0 offset:34816
s_waitcnt lgkmcnt(2)
v_smfmac_f32_16x16x64_bf16 v[32:35], v[60:63], v[24:31], v1
s_add_u32 s43, s17, 2
ds_read_b128 v[24:27], v0 offset:36864
s_waitcnt lgkmcnt(2)
v_smfmac_f32_16x16x64_bf16 v[32:35], v[12:15], v[184:191], v1
ds_read_b128 v[20:23], v0 offset:35840
ds_read_b128 v[28:31], v0 offset:37888
v_smfmac_f32_16x16x64_bf16 v[36:39], v[56:59], v[80:87], v1
ds_read_b128 v[84:87], v0 offset:39936
ds_read_b128 v[80:83], v0 offset:38912
v_smfmac_f32_16x16x64_bf16 v[36:39], v[60:63], v[192:199], v1
s_nop 1
v_cvt_pk_bf16_f32 v32, v32, v33
v_cvt_pk_bf16_f32 v33, v34, v35
v_smfmac_f32_16x16x64_bf16 v[36:39], v[12:15], v[200:207], v1
s_min_u32 s43, s43, s39
s_waitcnt lgkmcnt(5)
v_and_or_b32 v32, v32, -2, s18
v_smfmac_f32_16x16x64_bf16 v[52:55], v[56:59], v[232:239], v1
s_waitcnt lgkmcnt(3)
buffer_store_dwordx2 v[32:33], v44, s[4:7], s60 offen
v_smfmac_f32_16x16x64_bf16 v[40:43], v[56:59], v[16:23], v1
s_waitcnt lgkmcnt(2)
v_cvt_pk_bf16_f32 v36, v36, v37
v_smfmac_f32_16x16x64_bf16 v[40:43], v[60:63], v[24:31], v1
v_cvt_pk_bf16_f32 v37, v38, v39
v_smfmac_f32_16x16x64_bf16 v[40:43], v[12:15], v[208:215], v1
v_and_or_b32 v36, v36, -2, s18
v_smfmac_f32_16x16x64_bf16 v[52:55], v[60:63], v[240:247], v1
s_nop 0
buffer_store_dwordx2 v[36:37], v44, s[4:7], s61 offen
s_nop 0
v_smfmac_f32_16x16x64_bf16 v[52:55], v[12:15], v[248:255], v1
s_waitcnt lgkmcnt(0)
s_add_u32 s34, s24, 524288
v_cvt_pk_bf16_f32 v40, v40, v41
v_smfmac_f32_16x16x64_bf16 v[48:51], v[56:59], v[80:87], v1
v_cvt_pk_bf16_f32 v41, v42, v43
v_and_or_b32 v40, v40, -2, s18
v_smfmac_f32_16x16x64_bf16 v[48:51], v[60:63], v[216:223], v1
buffer_store_dwordx2 v[40:41], v44, s[4:7], s62 offen
v_smfmac_f32_16x16x64_bf16 v[48:51], v[12:15], v[224:231], v1
s_nop 1
v_cvt_pk_bf16_f32 v52, v52, v53
v_cvt_pk_bf16_f32 v53, v54, v55
s_nop 3
v_cvt_pk_bf16_f32 v48, v48, v49
v_and_or_b32 v48, v48, -2, s18
v_cvt_pk_bf16_f32 v49, v50, v51
buffer_store_dwordx2 v[48:49], v44, s[4:7], s63 offen
s_mov_b32 s21, 398336
v_and_or_b32 v52, v52, -2, s18
buffer_store_dwordx2 v[52:53], v44, s[4:7], s64 offen
v_bfe_u32 v34, v0, 6, 1
v_lshlrev_b32 v34, 4, v34
v_mov_b32 v35, 0x3f80
v_lshlrev_b32 v34, v34, v35
v_bfe_i32 v35, v0, 4, 1
v_and_b32 v45, v34, v35
v_and_b32 v47, v34, v35
v_xor_b32 v44, v34, v45
v_xor_b32 v46, v34, v45
v_and_b32 v36, 32, v0
v_bfe_u32 v37, v0, 6, 1
v_lshl_add_u32 v36, v37, 8, v36
v_bfe_u32 v37, v0, 8, 1
v_lshl_add_u32 v36, v37, 4, v36
v_bfe_u32 v37, v0, 4, 1
v_lshl_add_u32 v36, v37, 3, v36
ds_read_b128 v[80:83], v2 offset:0
ds_read_b128 v[84:87], v2 offset:1024
v_mov_b64 v[24:25], 0
v_mov_b64 v[26:27], 0
v_mov_b64 v[28:29], 0
v_mov_b64 v[30:31], 0
s_waitcnt vmcnt(9)
v_bfe_u32 v7, v0, 2, 3
v_add_u32 v7, s28, v7
s_mov_b32 exec_hi, 0
v_and_b32 v7, 511, v0
v_lshl_add_u32 v7, v7, 3, s34
s_mov_b32 exec_hi, -1
s_nop 15
s_nop 15
s_nop 15
s_nop 10
buffer_load_dwordx4 v[8:11], v0, s[4:7], s27 offen offset:0 sc1
buffer_load_dwordx4 v[12:15], v0, s[4:7], s27 offen offset:1024 sc1
buffer_load_dwordx4 v[16:19], v0, s[4:7], s27 offen offset:2048 sc1
buffer_load_dwordx4 v[20:23], v0, s[4:7], s27 offen offset:3072 sc1
s_barrier
buffer_load_dwordx4 v[48:51], v0, s[4:7], s66 offen offset:0 sc1
buffer_load_dwordx4 v[52:55], v0, s[4:7], s66 offen offset:1024 sc1
buffer_load_dwordx4 v[56:59], v0, s[4:7], s66 offen offset:2048 sc1
buffer_load_dwordx4 v[60:63], v0, s[4:7], s66 offen offset:3072 sc1
v_mov_b64 v[40:41], 0
v_mov_b64 v[42:43], 0
s_waitcnt vmcnt(6)
s_nop 0
v_smfmac_f32_16x16x64_bf16 v[40:43], v[44:47], v[8:15], v1
v_bitop3_b32 v34, v8, v10, s18 bitop3:0x7e
v_bitop3_b32 v35, v12, v14, s18 bitop3:0x7e
s_waitcnt vmcnt(4)
v_smfmac_f32_16x16x64_bf16 v[40:43], v[44:47], v[16:23], v1
v_bitop3_b32 v32, v16, v18, s18 bitop3:0x7e
v_bitop3_b32 v33, v20, v22, s18 bitop3:0x7e
v_or3_b32 v34, v34, v35, v32
v_bitop3_b32 v34, v34, v33, 1 bitop3:0xa8
v_cmp_ne_u32 vcc, 0, v34
s_cbranch_vccnz red_153
red_153_ok:
s_nop 1
v_add_f32_dpp v40, v40, v40 row_ror:8 row_mask:0xf bank_mask:0xf
v_add_f32_dpp v41, v41, v41 row_ror:8 row_mask:0xf bank_mask:0xf
v_add_f32_dpp v42, v42, v42 row_ror:8 row_mask:0xf bank_mask:0xf
v_add_f32_dpp v43, v43, v43 row_ror:8 row_mask:0xf bank_mask:0xf
v_cvt_pk_bf16_f32 v40, v40, v41
v_cvt_pk_bf16_f32 v41, v42, v43
v_and_or_b32 v40, v40, -2, s18
s_mov_b64 exec, 0x00ff00ff
buffer_store_dwordx2 v[40:41], v36, s[4:7], s40 offen
s_mov_b64 exec, -1
g2_155:
v_mov_b64 v[8:9], 0
v_mov_b64 v[10:11], 0
v_mov_b64 v[12:13], 0
v_mov_b64 v[14:15], 0
v_mov_b64 v[16:17], 0
v_mov_b64 v[18:19], 0
v_mov_b64 v[20:21], 0
v_mov_b64 v[22:23], 0
s_mov_b32 s37, 0
s_cmp_eq_u32 s17, s38
s_barrier
s_nop 15
s_nop 7
s_cbranch_scc0 gather_149
s_branch exit_152
red_153:
buffer_load_dwordx4 v[8:11], v0, s[4:7], s27 offen offset:0 sc1
buffer_load_dwordx4 v[12:15], v0, s[4:7], s27 offen offset:1024 sc1
buffer_load_dwordx4 v[16:19], v0, s[4:7], s27 offen offset:2048 sc1
buffer_load_dwordx4 v[20:23], v0, s[4:7], s27 offen offset:3072 sc1
s_add_u32 s37, s37, 1
s_cmp_gt_u32 s37, 262144
s_cbranch_scc1 L_fail
v_mov_b64 v[40:41], 0
v_mov_b64 v[42:43], 0
s_waitcnt vmcnt(2)
s_nop 0
v_smfmac_f32_16x16x64_bf16 v[40:43], v[44:47], v[8:15], v1
v_bitop3_b32 v34, v8, v10, s18 bitop3:0x7e
v_bitop3_b32 v35, v12, v14, s18 bitop3:0x7e
s_waitcnt vmcnt(0)
v_smfmac_f32_16x16x64_bf16 v[40:43], v[44:47], v[16:23], v1
v_bitop3_b32 v32, v16, v18, s18 bitop3:0x7e
v_bitop3_b32 v33, v20, v22, s18 bitop3:0x7e
v_or3_b32 v34, v34, v35, v32
v_bitop3_b32 v34, v34, v33, 1 bitop3:0xa8
v_cmp_ne_u32 vcc, 0, v34
s_cbranch_vccnz red_153
s_branch red_153_ok
rare_150:
ds_read_b128 v[48:51], v6 offset:0
ds_read_b128 v[52:55], v6 offset:1024
s_waitcnt lgkmcnt(0)
s_barrier
v_add_f32 v48, v48, v52
v_add_f32 v49, v49, v53
v_add_f32 v50, v50, v54
v_add_f32 v51, v51, v55
v_mov_b32_dpp v46, v46 quad_perm:[0,1,0,1] row_mask:0xf bank_mask:0xf
v_mov_b32_dpp v47, v47 quad_perm:[0,1,0,1] row_mask:0xf bank_mask:0xf
v_max3_f32 v19, v48, v49, v50
v_max3_f32 v19, v19, v51, v46
v_max_f32 v19, v19, v47
s_nop 1
v_max_f32_dpp v19, v19, v19 quad_perm:[2,3,0,1] row_mask:0xf bank_mask:0xf
v_mov_b32 v44, v19
s_nop 1
v_permlane32_swap_b32 v19, v44
v_max_f32 v19, v19, v44
v_mov_b32 v44, v19
s_nop 1
v_permlane16_swap_b32 v19, v44
v_max_f32 v19, v19, v44
v_sub_f32 v48, v48, v19
v_sub_f32 v49, v49, v19
v_sub_f32 v50, v50, v19
v_sub_f32 v51, v51, v19
v_sub_f32 v46, v46, v19
v_sub_f32 v47, v47, v19
v_exp_f32 v48, v48
v_exp_f32 v49, v49
v_exp_f32 v50, v50
v_exp_f32 v51, v51
v_cvt_pk_bf16_f32 v54, v48, v49
v_cvt_pk_bf16_f32 v55, v50, v51
s_nop 0
v_mov_b32_dpp v48, v54 quad_perm:[0,1,0,1] row_mask:0xf bank_mask:0xf
v_mov_b32_dpp v49, v55 quad_perm:[0,1,0,1] row_mask:0xf bank_mask:0xf
v_mov_b32_dpp v50, v54 quad_perm:[2,3,2,3] row_mask:0xf bank_mask:0xf
v_mov_b32_dpp v51, v55 quad_perm:[2,3,2,3] row_mask:0xf bank_mask:0xf
v_mov_b64 v[20:21], s[56:57]
v_mov_b64 v[22:23], s[56:57]
v_mfma_f32_16x16x32_bf16 v[8:11], v[56:59], v[48:51], 0
v_mfma_f32_16x16x32_bf16 v[12:15], v[60:63], v[48:51], 0
v_mfma_f32_16x16x32_bf16 v[16:19], v[20:23], v[48:51], 0
v_mov_b64 v[54:55], s[58:59]
v_exp_f32_dpp v44, v46 quad_perm:[0,1,0,1] row_mask:0xf bank_mask:0xf
v_exp_f32_dpp v45, v47 quad_perm:[0,1,0,1] row_mask:0xf bank_mask:0xf
s_nop 0
v_cvt_pk_bf16_f32 v52, v44, v45
v_cvt_pk_bf16_f32 v53, v44, v45
s_nop 1
v_mfma_f32_16x16x16_bf16 v[16:19], v[54:55], v[52:53], v[16:19]
v_mfma_f32_16x16x16_bf16 v[8:11], v[24:25], v[52:53], v[8:11]
v_mfma_f32_16x16x16_bf16 v[12:15], v[26:27], v[52:53], v[12:15]
s_nop 5
v_rcp_f32 v18, v16
s_nop 0
v_mul_f32 v8, v8, v18
v_mul_f32 v9, v9, v18
v_mul_f32 v10, v10, v18
v_mul_f32 v11, v11, v18
v_mul_f32 v12, v12, v18
v_mul_f32 v13, v13, v18
v_mul_f32 v14, v14, v18
v_mul_f32 v15, v15, v18
v_cvt_pk_bf16_f32 v8, v8, v9
v_cvt_pk_bf16_f32 v9, v10, v11
v_cvt_pk_bf16_f32 v10, v12, v13
v_cvt_pk_bf16_f32 v11, v14, v15
s_branch back_151
exit_152:
buffer_load_dwordx4 v[32:35], v0, s[4:7], s20 offen sc1
buffer_load_dwordx4 v[36:39], v0, s[4:7], s21 offen sc1
buffer_load_dwordx4 v[40:43], v0, s[4:7], s22 offen sc1
s_add_u32 s37, s37, 1
s_cmp_gt_u32 s37, 262144
s_cbranch_scc1 L_fail
s_waitcnt vmcnt(2)
v_bitop3_b32 v44, v32, v34, s18 bitop3:0x7e
s_waitcnt vmcnt(1)
v_bitop3_b32 v45, v36, v38, s18 bitop3:0x7e
v_or_b32 v44, v44, v45
s_waitcnt vmcnt(0)
v_bitop3_b32 v46, v40, v42, s18 bitop3:0x7e
v_bitop3_b32 v44, v44, v46, s19 bitop3:0xa8
v_cmp_ne_u32 vcc, 0, v44
s_cbranch_vccnz exit_152
s_add_u32 s45, s45, 1
s_cmp_lt_u32 s45, 2
s_cbranch_scc1 layer_148
s_endpgm
wave_133:
layer_158:
s_lshl_b32 s17, s45, 6
s_mul_i32 s34, s45, 34603008
s_lshl_b32 s35, s15, 14
s_add_u32 s34, s34, s35
s_add_u32 s24, s34, 16785408
s_mul_i32 s34, s17, 10240
s_add_u32 s34, s34, s30
s_add_u32 s25, s34, s31
s_mov_b32 s19, 0
s_add_u32 s43, s17, 1
s_add_u32 s38, s17, 63
s_add_u32 s39, s17, 64
s_mov_b32 s34, s24
v_mov_b32 v7, 0
s_mov_b32 s20, 411648
s_mov_b32 s21, 415744
buffer_load_dwordx4 v[64:67], v0, s[4:7], s65 offen offset:0 sc1
buffer_load_dwordx4 v[68:71], v0, s[4:7], s65 offen offset:1024 sc1
buffer_load_dwordx4 v[72:75], v0, s[4:7], s65 offen offset:2048 sc1
buffer_load_dwordx4 v[76:79], v0, s[4:7], s65 offen offset:3072 sc1
ds_read_b128 v[80:83], v2 offset:0
ds_read_b128 v[84:87], v2 offset:1024
buffer_load_dwordx4 v[48:51], v0, s[4:7], s66 offen offset:0 sc1
buffer_load_dwordx4 v[52:55], v0, s[4:7], s66 offen offset:1024 sc1
buffer_load_dwordx4 v[56:59], v0, s[4:7], s66 offen offset:2048 sc1
buffer_load_dwordx4 v[60:63], v0, s[4:7], s66 offen offset:3072 sc1
v_mov_b64 v[8:9], 0
v_mov_b64 v[10:11], 0
v_mov_b64 v[12:13], 0
v_mov_b64 v[14:15], 0
v_mov_b64 v[16:17], 0
v_mov_b64 v[18:19], 0
v_mov_b64 v[20:21], 0
v_mov_b64 v[22:23], 0
v_mov_b64 v[24:25], 0
v_mov_b64 v[26:27], 0
v_mov_b64 v[28:29], 0
v_mov_b64 v[30:31], 0
s_barrier
v_bfe_u32 v7, v0, 2, 3
v_add_u32 v7, s28, v7
s_mov_b32 exec_hi, 0
v_and_b32 v7, 511, v0
v_lshl_add_u32 v7, v7, 3, s34
s_mov_b32 exec_hi, -1
s_mov_b32 s37, 0
gather_159:
buffer_load_dwordx4 v[32:35], v0, s[4:7], s20 offen sc1
buffer_load_dwordx4 v[36:39], v0, s[4:7], s21 offen sc1
s_add_u32 s37, s37, 1
s_cmp_gt_u32 s37, 262144
s_cbranch_scc1 L_fail
s_waitcnt vmcnt(1)
v_bitop3_b32 v44, v32, v34, s18 bitop3:0x7e
s_waitcnt vmcnt(0)
v_bitop3_b32 v45, v36, v38, s18 bitop3:0x7e
v_bitop3_b32 v44, v44, v45, s19 bitop3:0xa8
v_cmp_ne_u32 vcc, 0, v44
s_cbranch_vccnz gather_159
v_smfmac_f32_16x16x64_bf16 v[8:11], v[32:35], v[64:71], v1
buffer_load_dwordx4 v[64:67], v0, s[4:7], s67 offen offset:0 sc1
ds_write_b128 v0, v[36:39] offset:6144
v_smfmac_f32_16x16x64_bf16 v[20:23], v[32:35], v[56:63], v1
ds_read_b128 v[56:59], v2 offset:2048
buffer_load_dwordx4 v[68:71], v0, s[4:7], s67 offen offset:1024 sc1
ds_read_b128 v[60:63], v2 offset:3072
ds_write_b128 v0, v[32:35] offset:2048
v_smfmac_f32_16x16x64_bf16 v[12:15], v[32:35], v[72:79], v1
buffer_load_dwordx4 v[72:75], v0, s[4:7], s67 offen offset:2048 sc1
s_waitcnt lgkmcnt(4)
v_smfmac_f32_16x16x64_bf16 v[24:27], v[32:35], v[80:87], v1
v_smfmac_f32_16x16x64_bf16 v[16:19], v[32:35], v[48:55], v1
ds_read_b128 v[80:83], v2 offset:4096
ds_read_b128 v[84:87], v2 offset:5120
v_smfmac_f32_16x16x64_bf16 v[28:31], v[32:35], a[0:7], v1
s_waitcnt lgkmcnt(4)
s_waitcnt lgkmcnt(3)
v_smfmac_f32_16x16x64_bf16 v[20:23], v[36:39], v[56:63], v1
buffer_load_dwordx4 v[76:79], v0, s[4:7], s67 offen offset:3072 sc1
ds_read_b128 v[60:63], v2 offset:7168
ds_read_b128 v[56:59], v2 offset:6144
v_smfmac_f32_16x16x64_bf16 v[8:11], v[36:39], a[8:15], v1
s_waitcnt lgkmcnt(4)
s_barrier
ds_read_b128 v[40:43], v0 offset:3072
v_smfmac_f32_16x16x64_bf16 v[12:15], v[36:39], a[16:23], v1
s_waitcnt lgkmcnt(3)
ds_read_b128 v[44:47], v0 offset:7168
ds_read_b128 v[32:35], v0 offset:0
v_smfmac_f32_16x16x64_bf16 v[24:27], v[36:39], v[80:87], v1
ds_read_b128 v[80:83], v2 offset:8192
v_smfmac_f32_16x16x64_bf16 v[28:31], v[36:39], a[32:39], v1
buffer_load_dwordx4 v[48:51], v0, s[4:7], s24 offen offset:0 nt sc1
v_smfmac_f32_16x16x64_bf16 v[16:19], v[36:39], a[24:31], v1
ds_read_b128 v[36:39], v0 offset:4096
s_waitcnt lgkmcnt(4)
v_smfmac_f32_16x16x64_bf16 v[8:11], v[40:43], a[40:47], v1
ds_read_b128 v[84:87], v2 offset:9216
s_waitcnt lgkmcnt(4)
v_smfmac_f32_16x16x64_bf16 v[12:15], v[40:43], a[48:55], v1
s_waitcnt vmcnt(4)
ds_read_b128 v[40:43], v0 offset:1024
v_smfmac_f32_16x16x64_bf16 v[12:15], v[44:47], v[56:63], v1
s_waitcnt lgkmcnt(4)
ds_read_b128 v[60:63], v2 offset:11264
ds_read_b128 v[56:59], v2 offset:10240
v_smfmac_f32_16x16x64_bf16 v[8:11], v[44:47], a[56:63], v1
buffer_load_dwordx4 v[52:55], v0, s[4:7], s24 offen offset:1024 nt sc1
v_smfmac_f32_16x16x64_bf16 v[8:11], v[32:35], a[64:71], v1
s_waitcnt lgkmcnt(4)
ds_read_b128 v[44:47], v0 offset:5120
s_waitcnt lgkmcnt(4)
v_smfmac_f32_16x16x64_bf16 v[12:15], v[32:35], a[72:79], v1
s_waitcnt vmcnt(4)
ds_read_b128 v[32:35], v0 offset:8192
s_waitcnt lgkmcnt(4)
v_smfmac_f32_16x16x64_bf16 v[8:11], v[36:39], v[80:87], v1
ds_read_b128 v[80:83], v2 offset:12288
ds_read_b128 v[84:87], v2 offset:13312
v_smfmac_f32_16x16x64_bf16 v[8:11], v[40:43], v[64:71], v1
buffer_load_dwordx4 v[64:67], v0, s[4:7], s68 offen offset:0 sc1
v_smfmac_f32_16x16x64_bf16 v[12:15], v[36:39], a[80:87], v1
s_waitcnt lgkmcnt(4)
ds_read_b128 v[36:39], v0 offset:9216
v_smfmac_f32_16x16x64_bf16 v[12:15], v[40:43], v[56:63], v1
ds_read_b128 v[40:43], v0 offset:3072
s_waitcnt lgkmcnt(5)
v_smfmac_f32_16x16x64_bf16 v[8:11], v[44:47], a[88:95], v1
buffer_load_dwordx4 v[68:71], v0, s[4:7], s68 offen offset:1024 sc1
v_smfmac_f32_16x16x64_bf16 v[12:15], v[44:47], a[96:103], v1
s_waitcnt lgkmcnt(4)
ds_read_b128 v[60:63], v2 offset:15360
s_waitcnt lgkmcnt(3)
v_smfmac_f32_16x16x64_bf16 v[12:15], v[32:35], a[104:111], v1
ds_read_b128 v[56:59], v2 offset:14336
s_waitcnt vmcnt(5)
v_smfmac_f32_16x16x64_bf16 v[8:11], v[32:35], v[80:87], v1
s_waitcnt vmcnt(4)
ds_read_b128 v[32:35], v0 offset:7168
s_waitcnt lgkmcnt(4)
v_smfmac_f32_16x16x64_bf16 v[8:11], v[36:39], a[112:119], v1
s_waitcnt lgkmcnt(3)
ds_read_b128 v[80:83], v2 offset:16384
ds_read_b128 v[84:87], v2 offset:17408
v_smfmac_f32_16x16x64_bf16 v[16:19], v[40:43], v[72:79], v1
buffer_load_dwordx4 v[72:75], v0, s[4:7], s68 offen offset:2048 sc1
v_smfmac_f32_16x16x64_bf16 v[12:15], v[36:39], a[120:127], v1
s_waitcnt lgkmcnt(4)
ds_read_b128 v[36:39], v0 offset:0
s_waitcnt lgkmcnt(4)
v_add_f32 v8, v8, v10
v_smfmac_f32_16x16x64_bf16 v[20:23], v[40:43], v[56:63], v1
s_waitcnt lgkmcnt(3)
buffer_load_dwordx4 v[76:79], v0, s[4:7], s68 offen offset:3072 sc1
v_smfmac_f32_16x16x64_bf16 v[20:23], v[32:35], a[136:143], v1
s_waitcnt lgkmcnt(2)
ds_read_b128 v[40:43], v0 offset:4096
v_mul_f32 v8, s44, v8
v_add_f32 v9, v9, v11
v_smfmac_f32_16x16x64_bf16 v[16:19], v[32:35], a[128:135], v1
buffer_load_dwordx4 v[56:59], v0, s[4:7], s24 offen offset:2048 nt sc1
ds_read_b128 v[32:35], v0 offset:1024
s_waitcnt lgkmcnt(2)
v_mul_f32 v9, s44, v9
v_add_f32 v12, v12, v14
v_smfmac_f32_16x16x64_bf16 v[16:19], v[36:39], v[80:87], v1
ds_read_b128 v[80:83], v2 offset:18432
v_cvt_pk_bf16_f32 v8, v8, v9
v_smfmac_f32_16x16x64_bf16 v[20:23], v[36:39], a[144:151], v1
s_waitcnt lgkmcnt(2)
ds_read_b128 v[84:87], v2 offset:19456
v_add_f32 v13, v13, v15
v_smfmac_f32_16x16x64_bf16 v[20:23], v[40:43], a[160:167], v1
s_xor_b32 s18, s18, 1
ds_read_b128 v[36:39], v0 offset:5120
v_mul_f32 v12, s44, v12
v_mul_f32 v13, s44, v13
v_cvt_pk_bf16_f32 v12, v12, v13
v_smfmac_f32_16x16x64_bf16 v[16:19], v[40:43], a[152:159], v1
s_waitcnt lgkmcnt(3)
ds_write2_b32 v3, v8, v12 offset0:0 offset1:128
v_smfmac_f32_16x16x64_bf16 v[20:23], v[32:35], a[168:175], v1
ds_read_b128 v[40:43], v0 offset:8192
buffer_load_dwordx4 v[60:63], v0, s[4:7], s24 offen offset:3072 nt sc1
s_mov_b32 s19, 1
s_waitcnt lgkmcnt(3)
s_waitcnt lgkmcnt(2)
v_smfmac_f32_16x16x64_bf16 v[20:23], v[36:39], v[80:87], v1
s_waitcnt vmcnt(7)
s_waitcnt vmcnt(5)
ds_read_b128 v[84:87], v2 offset:21504
s_waitcnt vmcnt(4)
v_smfmac_f32_16x16x64_bf16 v[16:19], v[32:35], v[64:71], v1
ds_read_b128 v[32:35], v0 offset:9216
buffer_load_dwordx4 v[64:67], v0, s[4:7], s69 offen offset:0 sc1
v_smfmac_f32_16x16x64_bf16 v[16:19], v[36:39], a[176:183], v1
s_waitcnt lgkmcnt(2)
ds_read_b128 v[36:39], v0 offset:3072
ds_read_b128 v[80:83], v2 offset:20480
buffer_load_dwordx4 v[68:71], v0, s[4:7], s69 offen offset:1024 sc1
v_smfmac_f32_16x16x64_bf16 v[16:19], v[40:43], a[184:191], v1
s_barrier
ds_read_b64_tr_b16 v[8:9], v4 offset:2048
ds_read_b64_tr_b16 v[10:11], v4 offset:2560
v_smfmac_f32_16x16x64_bf16 v[20:23], v[40:43], a[192:199], v1
s_waitcnt lgkmcnt(4)
ds_read_b64_tr_b16 v[14:15], v4 offset:3584
ds_read_b64_tr_b16 v[12:13], v4 offset:3072
v_smfmac_f32_16x16x64_bf16 v[16:19], v[32:35], a[200:207], v1
buffer_load_dword v7, v7, s[4:7], 0 offen sc1
v_smfmac_f32_16x16x64_bf16 v[20:23], v[32:35], a[208:215], v1
s_waitcnt lgkmcnt(5)
ds_read_b128 v[40:43], v0 offset:7168
ds_read_b128 v[32:35], v0 offset:0
v_smfmac_f32_16x16x64_bf16 v[24:27], v[36:39], a[216:223], v1
s_waitcnt vmcnt(5)
s_waitcnt lgkmcnt(4)
v_add_f32 v16, v16, v18
v_add_f32 v17, v17, v19
v_mfma_f32_16x16x32_bf16 v[44:47], v[48:51], v[8:11], 0
s_waitcnt lgkmcnt(2)
v_cvt_pk_bf16_f32 v16, v16, v17
v_add_f32 v21, v21, v23
v_add_f32 v20, v20, v22
v_cvt_pk_bf16_f32 v20, v20, v21
v_mfma_f32_16x16x32_bf16 v[44:47], v[52:55], v[12:15], v[44:47]
s_nop 0
ds_write2_b32 v3, v16, v20 offset0:1 offset1:129
v_smfmac_f32_16x16x64_bf16 v[28:31], v[36:39], v[80:87], v1
s_waitcnt lgkmcnt(2)
ds_read_b128 v[36:39], v0 offset:4096
v_smfmac_f32_16x16x64_bf16 v[24:27], v[40:43], a[224:231], v1
s_mov_b64 exec, s[54:55]
s_nop 0
ds_write_b128 v5, v[44:47] offset:1024
s_mov_b64 exec, -1
v_smfmac_f32_16x16x64_bf16 v[28:31], v[40:43], a[232:239], v1
ds_read_b128 v[40:43], v0 offset:1024
s_waitcnt lgkmcnt(4)
v_smfmac_f32_16x16x64_bf16 v[24:27], v[32:35], a[240:247], v1
s_waitcnt lgkmcnt(2)
v_smfmac_f32_16x16x64_bf16 v[28:31], v[32:35], a[248:255], v1
s_mov_b32 s37, 0
ds_read_b128 v[32:35], v0 offset:5120
ds_read_b128 v[80:83], v2 offset:22528
v_smfmac_f32_16x16x64_bf16 v[24:27], v[36:39], v[72:79], v1
buffer_load_dwordx4 v[72:75], v0, s[4:7], s65 offen offset:2048 sc1
v_smfmac_f32_16x16x64_bf16 v[28:31], v[36:39], v[88:95], v1
ds_read_b128 v[36:39], v0 offset:8192
s_waitcnt lgkmcnt(4)
s_barrier
ds_read_b128 v[52:55], v6 offset:1024
s_waitcnt lgkmcnt(4)
v_smfmac_f32_16x16x64_bf16 v[28:31], v[40:43], v[104:111], v1
s_waitcnt lgkmcnt(3)
ds_read_b128 v[48:51], v6 offset:0
v_smfmac_f32_16x16x64_bf16 v[24:27], v[40:43], v[96:103], v1
s_add_u32 s24, s24, 524288
ds_read_b128 v[40:43], v0 offset:9216
ds_read_b64_tr_b16 v[10:11], v4 offset:512
v_smfmac_f32_16x16x64_bf16 v[24:27], v[32:35], v[112:119], v1
s_waitcnt lgkmcnt(4)
ds_read_b64_tr_b16 v[12:13], v4 offset:1024
ds_read_b64_tr_b16 v[8:9], v4 offset:0
ds_read_b64_tr_b16 v[14:15], v4 offset:1536
v_smfmac_f32_16x16x64_bf16 v[28:31], v[32:35], v[120:127], v1
s_waitcnt vmcnt(2)
ds_read_b64_tr_b16 v[20:21], v4 offset:3072
ds_read_b64_tr_b16 v[16:17], v4 offset:2048
v_smfmac_f32_16x16x64_bf16 v[24:27], v[36:39], v[128:135], v1
s_waitcnt lgkmcnt(7)
ds_read_b64_tr_b16 v[18:19], v4 offset:2560
v_add_f32 v49, v49, v53
v_smfmac_f32_16x16x64_bf16 v[28:31], v[36:39], v[136:143], v1
s_waitcnt lgkmcnt(7)
ds_read_b64_tr_b16 v[22:23], v4 offset:3584
v_add_f32 v51, v51, v55
v_smfmac_f32_16x16x64_bf16 v[28:31], v[40:43], v[64:71], v1
s_barrier
v_smfmac_f32_16x16x64_bf16 v[24:27], v[40:43], v[144:151], v1
s_waitcnt lgkmcnt(4)
ds_read_b128 v[84:87], v2 offset:23552
v_add_f32 v50, v50, v54
v_mfma_f32_16x16x32_bf16 v[44:47], v[8:11], v[8:11], 0
s_waitcnt lgkmcnt(4)
v_exp_f32 v51, v51
v_mfma_f32_16x16x32_bf16 v[44:47], v[12:15], v[12:15], v[44:47]
s_waitcnt lgkmcnt(1)
v_add_f32 v48, v48, v52
v_exp_f32 v49, v49
v_mfma_f32_16x16x32_bf16 v[44:47], v[16:19], v[16:19], v[44:47]
v_exp_f32 v48, v48
v_exp_f32 v50, v50
v_cvt_pk_bf16_f32 v54, v48, v49
v_cvt_pk_bf16_f32 v55, v50, v51
v_mfma_f32_16x16x32_bf16 v[44:47], v[20:23], v[20:23], v[44:47]
s_add_u32 s17, s17, 1
v_mov_b32_dpp v48, v54 quad_perm:[0,1,0,1] row_mask:0xf bank_mask:0xf
v_mov_b32_dpp v51, v55 quad_perm:[2,3,2,3] row_mask:0xf bank_mask:0xf
v_mov_b32_dpp v50, v54 quad_perm:[2,3,2,3] row_mask:0xf bank_mask:0xf
v_mov_b32_dpp v49, v55 quad_perm:[0,1,0,1] row_mask:0xf bank_mask:0xf
v_mov_b64 v[22:23], s[56:57]
v_mov_b64 v[20:21], s[56:57]
v_mfma_f32_16x16x32_bf16 v[8:11], v[56:59], v[48:51], 0
v_exp_f32_dpp v44, v46 quad_perm:[0,1,0,1] row_mask:0xf bank_mask:0xf
v_mfma_f32_16x16x32_bf16 v[16:19], v[20:23], v[48:51], 0
v_exp_f32_dpp v45, v47 quad_perm:[0,1,0,1] row_mask:0xf bank_mask:0xf
v_mfma_f32_16x16x32_bf16 v[12:15], v[60:63], v[48:51], 0
s_waitcnt lgkmcnt(0)
v_cvt_pk_bf16_f32 v24, v24, v25
v_cvt_pk_bf16_f32 v53, v44, v45
v_mov_b64 v[54:55], s[58:59]
v_cvt_pk_bf16_f32 v52, v44, v45
v_cvt_pk_bf16_f32 v25, v26, v27
v_cvt_pk_bf16_f32 v26, v28, v29
v_mfma_f32_16x16x16_bf16 v[16:19], v[54:55], v[52:53], v[16:19]
v_cvt_pk_bf16_f32 v27, v30, v31
v_mov_b64 v[32:33], 0
v_mfma_f32_16x16x16_bf16 v[8:11], v[24:25], v[52:53], v[8:11]
s_nop 0
ds_read_b128 v[28:31], v0 offset:44032
v_mov_b64 v[34:35], 0
v_mfma_f32_16x16x16_bf16 v[12:15], v[26:27], v[52:53], v[12:15]
s_add_u32 s25, s25, 10240
v_subrev_u32 v17, s46, v16
v_rcp_f32 v18, v16
v_cmp_lt_u32 vcc, s47, v17
v_mul_f32 v10, v10, v18
v_mul_f32 v9, v9, v18
v_mul_f32 v8, v8, v18
v_cvt_pk_bf16_f32 v8, v8, v9
v_mul_f32 v12, v12, v18
v_mul_f32 v11, v11, v18
v_mul_f32 v15, v15, v18
v_cvt_pk_bf16_f32 v9, v10, v11
v_mul_f32 v14, v14, v18
v_mul_f32 v13, v13, v18
v_cvt_pk_bf16_f32 v11, v14, v15
v_cvt_pk_bf16_f32 v10, v12, v13
s_cbranch_vccnz rare_160
back_161:
s_mov_b64 exec, s[54:55]
ds_write_b128 v5, v[8:11] offset:1024
s_mov_b64 exec, -1
v_mov_b64 v[50:51], 0
v_smfmac_f32_16x16x64_bf16 v[32:35], v[8:11], v[80:87], v1
ds_read_b128 v[80:83], v0 offset:45056
ds_read_b128 v[24:27], v0 offset:43008
ds_read_b128 v[84:87], v0 offset:46080
v_mov_b64 v[54:55], 0
v_mov_b64 v[52:53], 0
v_mov_b64 v[40:41], 0
v_mov_b64 v[38:39], 0
v_mov_b64 v[48:49], 0
v_smfmac_f32_16x16x64_bf16 v[52:55], v[8:11], v[176:183], v1
s_mov_b32 s20, 395264
ds_read_b128 v[16:19], v0 offset:40960
buffer_load_dwordx4 v[76:79], v0, s[4:7], s65 offen offset:3072 sc1
v_mov_b64 v[36:37], 0
v_mov_b64 v[42:43], 0
v_smfmac_f32_16x16x64_bf16 v[48:51], v[8:11], v[168:175], v1
s_waitcnt lgkmcnt(4)
ds_read_b128 v[20:23], v0 offset:41984
s_barrier
ds_read_b128 v[56:59], v5 offset:1536
v_smfmac_f32_16x16x64_bf16 v[40:43], v[8:11], v[160:167], v1
s_waitcnt lgkmcnt(4)
ds_read_b128 v[60:63], v5 offset:0
ds_read_b128 v[12:15], v5 offset:512
v_bfe_u32 v45, v0, 1, 7
v_smfmac_f32_16x16x64_bf16 v[36:39], v[8:11], v[152:159], v1
buffer_load_dwordx4 v[64:67], v0, s[4:7], s65 offen offset:0 sc1
v_lshrrev_b32 v44, 8, v0
s_waitcnt lgkmcnt(3)
buffer_load_dwordx4 v[68:71], v0, s[4:7], s65 offen offset:1024 sc1
v_lshl_or_b32 v44, v44, 12, v45
s_waitcnt lgkmcnt(2)
v_smfmac_f32_16x16x64_bf16 v[32:35], v[56:59], v[16:23], v1
ds_read_b128 v[16:19], v0 offset:47104
s_waitcnt lgkmcnt(2)
v_smfmac_f32_16x16x64_bf16 v[32:35], v[60:63], v[24:31], v1
s_add_u32 s43, s17, 2
ds_read_b128 v[24:27], v0 offset:49152
s_waitcnt lgkmcnt(2)
v_smfmac_f32_16x16x64_bf16 v[32:35], v[12:15], v[184:191], v1
ds_read_b128 v[20:23], v0 offset:48128
ds_read_b128 v[28:31], v0 offset:50176
v_smfmac_f32_16x16x64_bf16 v[36:39], v[56:59], v[80:87], v1
ds_read_b128 v[84:87], v0 offset:52224
ds_read_b128 v[80:83], v0 offset:51200
v_smfmac_f32_16x16x64_bf16 v[36:39], v[60:63], v[192:199], v1
s_nop 1
v_cvt_pk_bf16_f32 v32, v32, v33
v_cvt_pk_bf16_f32 v33, v34, v35
v_smfmac_f32_16x16x64_bf16 v[36:39], v[12:15], v[200:207], v1
s_min_u32 s43, s43, s39
s_waitcnt lgkmcnt(5)
v_and_or_b32 v32, v32, -2, s18
v_smfmac_f32_16x16x64_bf16 v[52:55], v[56:59], v[232:239], v1
s_waitcnt lgkmcnt(3)
buffer_store_dwordx2 v[32:33], v44, s[4:7], s60 offen
v_smfmac_f32_16x16x64_bf16 v[40:43], v[56:59], v[16:23], v1
s_waitcnt lgkmcnt(2)
v_cvt_pk_bf16_f32 v36, v36, v37
v_smfmac_f32_16x16x64_bf16 v[40:43], v[60:63], v[24:31], v1
v_cvt_pk_bf16_f32 v37, v38, v39
v_smfmac_f32_16x16x64_bf16 v[40:43], v[12:15], v[208:215], v1
v_and_or_b32 v36, v36, -2, s18
v_smfmac_f32_16x16x64_bf16 v[52:55], v[60:63], v[240:247], v1
s_nop 0
buffer_store_dwordx2 v[36:37], v44, s[4:7], s61 offen
s_nop 0
v_smfmac_f32_16x16x64_bf16 v[52:55], v[12:15], v[248:255], v1
s_waitcnt lgkmcnt(0)
s_add_u32 s34, s24, 524288
v_cvt_pk_bf16_f32 v40, v40, v41
v_smfmac_f32_16x16x64_bf16 v[48:51], v[56:59], v[80:87], v1
v_cvt_pk_bf16_f32 v41, v42, v43
v_and_or_b32 v40, v40, -2, s18
v_smfmac_f32_16x16x64_bf16 v[48:51], v[60:63], v[216:223], v1
buffer_store_dwordx2 v[40:41], v44, s[4:7], s62 offen
v_smfmac_f32_16x16x64_bf16 v[48:51], v[12:15], v[224:231], v1
s_nop 1
v_cvt_pk_bf16_f32 v52, v52, v53
v_cvt_pk_bf16_f32 v53, v54, v55
s_nop 3
v_cvt_pk_bf16_f32 v48, v48, v49
v_and_or_b32 v48, v48, -2, s18
v_cvt_pk_bf16_f32 v49, v50, v51
buffer_store_dwordx2 v[48:49], v44, s[4:7], s63 offen
s_mov_b32 s21, 399360
v_and_or_b32 v52, v52, -2, s18
buffer_store_dwordx2 v[52:53], v44, s[4:7], s64 offen
v_bfe_u32 v34, v0, 6, 1
v_lshlrev_b32 v34, 4, v34
v_mov_b32 v35, 0x3f80
v_lshlrev_b32 v34, v34, v35
v_bfe_i32 v35, v0, 4, 1
v_and_b32 v45, v34, v35
v_and_b32 v47, v34, v35
v_xor_b32 v44, v34, v45
v_xor_b32 v46, v34, v45
v_and_b32 v36, 32, v0
v_bfe_u32 v37, v0, 6, 1
v_lshl_add_u32 v36, v37, 8, v36
v_bfe_u32 v37, v0, 8, 1
v_lshl_add_u32 v36, v37, 4, v36
v_bfe_u32 v37, v0, 4, 1
v_lshl_add_u32 v36, v37, 3, v36
ds_read_b128 v[80:83], v2 offset:0
ds_read_b128 v[84:87], v2 offset:1024
v_mov_b64 v[24:25], 0
v_mov_b64 v[26:27], 0
v_mov_b64 v[28:29], 0
v_mov_b64 v[30:31], 0
s_waitcnt vmcnt(9)
v_cmp_gt_u32 vcc, s43, v7
s_cmp_eq_u32 vcc_hi, 0
s_cbranch_scc1 kv_170
s_mov_b32 s37, 0
kv_169:
v_bfe_u32 v7, v0, 2, 3
buffer_load_dword v7, v7, s[4:7], s28 offen sc1
s_add_u32 s37, s37, 1
s_cmp_gt_u32 s37, 262144
s_cbranch_scc1 L_fail
s_waitcnt vmcnt(0)
v_cmp_gt_u32 vcc, s43, v7
s_cbranch_vccnz kv_169
kv_170:
s_mov_b32 s37, 0
v_bfe_u32 v7, v0, 2, 3
v_add_u32 v7, s28, v7
s_mov_b32 exec_hi, 0
v_and_b32 v7, 511, v0
v_lshl_add_u32 v7, v7, 3, s34
s_mov_b32 exec_hi, -1
s_nop 15
s_nop 15
s_nop 15
s_nop 9
s_cmp_ge_u32 s15, 16
s_cbranch_scc1 nored_164
buffer_load_dwordx4 v[8:11], v0, s[4:7], s27 offen offset:0 sc1
buffer_load_dwordx4 v[12:15], v0, s[4:7], s27 offen offset:1024 sc1
buffer_load_dwordx4 v[16:19], v0, s[4:7], s27 offen offset:2048 sc1
buffer_load_dwordx4 v[20:23], v0, s[4:7], s27 offen offset:3072 sc1
s_barrier
buffer_load_dwordx4 v[48:51], v0, s[4:7], s66 offen offset:0 sc1
buffer_load_dwordx4 v[52:55], v0, s[4:7], s66 offen offset:1024 sc1
buffer_load_dwordx4 v[56:59], v0, s[4:7], s66 offen offset:2048 sc1
buffer_load_dwordx4 v[60:63], v0, s[4:7], s66 offen offset:3072 sc1
v_mov_b64 v[40:41], 0
v_mov_b64 v[42:43], 0
s_waitcnt vmcnt(6)
s_nop 0
v_smfmac_f32_16x16x64_bf16 v[40:43], v[44:47], v[8:15], v1
v_bitop3_b32 v34, v8, v10, s18 bitop3:0x7e
v_bitop3_b32 v35, v12, v14, s18 bitop3:0x7e
s_waitcnt vmcnt(4)
v_smfmac_f32_16x16x64_bf16 v[40:43], v[44:47], v[16:23], v1
v_bitop3_b32 v32, v16, v18, s18 bitop3:0x7e
v_bitop3_b32 v33, v20, v22, s18 bitop3:0x7e
v_or3_b32 v34, v34, v35, v32
v_bitop3_b32 v34, v34, v33, 1 bitop3:0xa8
v_cmp_ne_u32 vcc, 0, v34
s_cbranch_vccnz red_163
red_163_ok:
s_nop 1
v_add_f32_dpp v40, v40, v40 row_ror:8 row_mask:0xf bank_mask:0xf
v_add_f32_dpp v41, v41, v41 row_ror:8 row_mask:0xf bank_mask:0xf
v_add_f32_dpp v42, v42, v42 row_ror:8 row_mask:0xf bank_mask:0xf
v_add_f32_dpp v43, v43, v43 row_ror:8 row_mask:0xf bank_mask:0xf
v_cvt_pk_bf16_f32 v40, v40, v41
v_cvt_pk_bf16_f32 v41, v42, v43
v_and_or_b32 v40, v40, -2, s18
s_mov_b64 exec, 0x00ff00ff
buffer_store_dwordx2 v[40:41], v36, s[4:7], s40 offen
s_mov_b64 exec, -1
s_branch g2_165
nored_164:
s_barrier
buffer_load_dwordx4 v[48:51], v0, s[4:7], s66 offen offset:0 sc1
buffer_load_dwordx4 v[52:55], v0, s[4:7], s66 offen offset:1024 sc1
buffer_load_dwordx4 v[56:59], v0, s[4:7], s66 offen offset:2048 sc1
buffer_load_dwordx4 v[60:63], v0, s[4:7], s66 offen offset:3072 sc1
g2_165:
v_mov_b64 v[8:9], 0
v_mov_b64 v[10:11], 0
v_mov_b64 v[12:13], 0
v_mov_b64 v[14:15], 0
v_mov_b64 v[16:17], 0
v_mov_b64 v[18:19], 0
v_mov_b64 v[20:21], 0
v_mov_b64 v[22:23], 0
s_mov_b32 s37, 0
s_cmp_eq_u32 s17, s38
s_barrier
s_nop 15
s_nop 7
s_cbranch_scc0 gather_159
s_branch exit_162
red_163:
buffer_load_dwordx4 v[8:11], v0, s[4:7], s27 offen offset:0 sc1
buffer_load_dwordx4 v[12:15], v0, s[4:7], s27 offen offset:1024 sc1
buffer_load_dwordx4 v[16:19], v0, s[4:7], s27 offen offset:2048 sc1
buffer_load_dwordx4 v[20:23], v0, s[4:7], s27 offen offset:3072 sc1
s_add_u32 s37, s37, 1
s_cmp_gt_u32 s37, 262144
s_cbranch_scc1 L_fail
v_mov_b64 v[40:41], 0
v_mov_b64 v[42:43], 0
s_waitcnt vmcnt(2)
s_nop 0
v_smfmac_f32_16x16x64_bf16 v[40:43], v[44:47], v[8:15], v1
v_bitop3_b32 v34, v8, v10, s18 bitop3:0x7e
v_bitop3_b32 v35, v12, v14, s18 bitop3:0x7e
s_waitcnt vmcnt(0)
v_smfmac_f32_16x16x64_bf16 v[40:43], v[44:47], v[16:23], v1
v_bitop3_b32 v32, v16, v18, s18 bitop3:0x7e
v_bitop3_b32 v33, v20, v22, s18 bitop3:0x7e
v_or3_b32 v34, v34, v35, v32
v_bitop3_b32 v34, v34, v33, 1 bitop3:0xa8
v_cmp_ne_u32 vcc, 0, v34
s_cbranch_vccnz red_163
s_branch red_163_ok
rare_160:
ds_read_b128 v[48:51], v6 offset:0
ds_read_b128 v[52:55], v6 offset:1024
s_waitcnt lgkmcnt(0)
s_barrier
v_add_f32 v48, v48, v52
v_add_f32 v49, v49, v53
v_add_f32 v50, v50, v54
v_add_f32 v51, v51, v55
v_mov_b32_dpp v46, v46 quad_perm:[0,1,0,1] row_mask:0xf bank_mask:0xf
v_mov_b32_dpp v47, v47 quad_perm:[0,1,0,1] row_mask:0xf bank_mask:0xf
v_max3_f32 v19, v48, v49, v50
v_max3_f32 v19, v19, v51, v46
v_max_f32 v19, v19, v47
s_nop 1
v_max_f32_dpp v19, v19, v19 quad_perm:[2,3,0,1] row_mask:0xf bank_mask:0xf
v_mov_b32 v44, v19
s_nop 1
v_permlane32_swap_b32 v19, v44
v_max_f32 v19, v19, v44
v_mov_b32 v44, v19
s_nop 1
v_permlane16_swap_b32 v19, v44
v_max_f32 v19, v19, v44
v_sub_f32 v48, v48, v19
v_sub_f32 v49, v49, v19
v_sub_f32 v50, v50, v19
v_sub_f32 v51, v51, v19
v_sub_f32 v46, v46, v19
v_sub_f32 v47, v47, v19
v_exp_f32 v48, v48
v_exp_f32 v49, v49
v_exp_f32 v50, v50
v_exp_f32 v51, v51
v_cvt_pk_bf16_f32 v54, v48, v49
v_cvt_pk_bf16_f32 v55, v50, v51
s_nop 0
v_mov_b32_dpp v48, v54 quad_perm:[0,1,0,1] row_mask:0xf bank_mask:0xf
v_mov_b32_dpp v49, v55 quad_perm:[0,1,0,1] row_mask:0xf bank_mask:0xf
v_mov_b32_dpp v50, v54 quad_perm:[2,3,2,3] row_mask:0xf bank_mask:0xf
v_mov_b32_dpp v51, v55 quad_perm:[2,3,2,3] row_mask:0xf bank_mask:0xf
v_mov_b64 v[20:21], s[56:57]
v_mov_b64 v[22:23], s[56:57]
v_mfma_f32_16x16x32_bf16 v[8:11], v[56:59], v[48:51], 0
v_mfma_f32_16x16x32_bf16 v[12:15], v[60:63], v[48:51], 0
v_mfma_f32_16x16x32_bf16 v[16:19], v[20:23], v[48:51], 0
v_mov_b64 v[54:55], s[58:59]
v_exp_f32_dpp v44, v46 quad_perm:[0,1,0,1] row_mask:0xf bank_mask:0xf
v_exp_f32_dpp v45, v47 quad_perm:[0,1,0,1] row_mask:0xf bank_mask:0xf
s_nop 0
v_cvt_pk_bf16_f32 v52, v44, v45
v_cvt_pk_bf16_f32 v53, v44, v45
s_nop 1
v_mfma_f32_16x16x16_bf16 v[16:19], v[54:55], v[52:53], v[16:19]
v_mfma_f32_16x16x16_bf16 v[8:11], v[24:25], v[52:53], v[8:11]
v_mfma_f32_16x16x16_bf16 v[12:15], v[26:27], v[52:53], v[12:15]
s_nop 5
v_rcp_f32 v18, v16
s_nop 0
v_mul_f32 v8, v8, v18
v_mul_f32 v9, v9, v18
v_mul_f32 v10, v10, v18
v_mul_f32 v11, v11, v18
v_mul_f32 v12, v12, v18
v_mul_f32 v13, v13, v18
v_mul_f32 v14, v14, v18
v_mul_f32 v15, v15, v18
v_cvt_pk_bf16_f32 v8, v8, v9
v_cvt_pk_bf16_f32 v9, v10, v11
v_cvt_pk_bf16_f32 v10, v12, v13
v_cvt_pk_bf16_f32 v11, v14, v15
s_branch back_161
exit_162:
buffer_load_dwordx4 v[32:35], v0, s[4:7], s20 offen sc1
buffer_load_dwordx4 v[36:39], v0, s[4:7], s21 offen sc1
s_add_u32 s37, s37, 1
s_cmp_gt_u32 s37, 262144
s_cbranch_scc1 L_fail
s_waitcnt vmcnt(1)
v_bitop3_b32 v44, v32, v34, s18 bitop3:0x7e
s_waitcnt vmcnt(0)
v_bitop3_b32 v45, v36, v38, s18 bitop3:0x7e
v_bitop3_b32 v44, v44, v45, s19 bitop3:0xa8
v_cmp_ne_u32 vcc, 0, v44
s_cbranch_vccnz exit_162
s_add_u32 s45, s45, 1
s_cmp_lt_u32 s45, 2
s_cbranch_scc1 layer_158
s_endpgm
wave_134:
layer_171:
s_lshl_b32 s17, s45, 6
s_mul_i32 s34, s45, 34603008
s_lshl_b32 s35, s15, 14
s_add_u32 s34, s34, s35
s_add_u32 s24, s34, 16789504
s_mul_i32 s34, s17, 10240
s_add_u32 s34, s34, s30
s_add_u32 s25, s34, s31
s_mov_b32 s19, 0
s_add_u32 s43, s17, 1
s_add_u32 s38, s17, 63
s_add_u32 s39, s17, 64
s_mov_b32 s34, s24
v_mov_b32 v7, 0
s_mov_b32 s20, 412672
s_mov_b32 s21, 416768
buffer_load_dwordx4 v[64:67], v0, s[4:7], s65 offen offset:0 sc1
buffer_load_dwordx4 v[68:71], v0, s[4:7], s65 offen offset:1024 sc1
buffer_load_dwordx4 v[72:75], v0, s[4:7], s65 offen offset:2048 sc1
buffer_load_dwordx4 v[76:79], v0, s[4:7], s65 offen offset:3072 sc1
ds_read_b128 v[80:83], v2 offset:0
ds_read_b128 v[84:87], v2 offset:1024
buffer_load_dwordx4 v[48:51], v0, s[4:7], s66 offen offset:0 sc1
buffer_load_dwordx4 v[52:55], v0, s[4:7], s66 offen offset:1024 sc1
buffer_load_dwordx4 v[56:59], v0, s[4:7], s66 offen offset:2048 sc1
buffer_load_dwordx4 v[60:63], v0, s[4:7], s66 offen offset:3072 sc1
v_mov_b64 v[8:9], 0
v_mov_b64 v[10:11], 0
v_mov_b64 v[12:13], 0
v_mov_b64 v[14:15], 0
v_mov_b64 v[16:17], 0
v_mov_b64 v[18:19], 0
v_mov_b64 v[20:21], 0
v_mov_b64 v[22:23], 0
v_mov_b64 v[24:25], 0
v_mov_b64 v[26:27], 0
v_mov_b64 v[28:29], 0
v_mov_b64 v[30:31], 0
s_barrier
v_bfe_u32 v7, v0, 2, 3
v_add_u32 v7, s28, v7
s_mov_b32 exec_hi, 0
v_and_b32 v7, 511, v0
v_lshl_add_u32 v7, v7, 3, s34
s_mov_b32 exec_hi, -1
s_mov_b32 s37, 0
gather_172:
buffer_load_dwordx4 v[32:35], v0, s[4:7], s20 offen sc1
buffer_load_dwordx4 v[36:39], v0, s[4:7], s21 offen sc1
s_add_u32 s37, s37, 1
s_cmp_gt_u32 s37, 262144
s_cbranch_scc1 L_fail
s_waitcnt vmcnt(1)
v_bitop3_b32 v44, v32, v34, s18 bitop3:0x7e
s_waitcnt vmcnt(0)
v_bitop3_b32 v45, v36, v38, s18 bitop3:0x7e
v_bitop3_b32 v44, v44, v45, s19 bitop3:0xa8
v_cmp_ne_u32 vcc, 0, v44
s_cbranch_vccnz gather_172
v_smfmac_f32_16x16x64_bf16 v[8:11], v[32:35], v[64:71], v1
buffer_load_dwordx4 v[64:67], v0, s[4:7], s67 offen offset:0 sc1
ds_write_b128 v0, v[36:39] offset:7168
v_smfmac_f32_16x16x64_bf16 v[20:23], v[32:35], v[56:63], v1
ds_read_b128 v[56:59], v2 offset:2048
buffer_load_dwordx4 v[68:71], v0, s[4:7], s67 offen offset:1024 sc1
ds_read_b128 v[60:63], v2 offset:3072
ds_write_b128 v0, v[32:35] offset:3072
v_smfmac_f32_16x16x64_bf16 v[12:15], v[32:35], v[72:79], v1
buffer_load_dwordx4 v[72:75], v0, s[4:7], s67 offen offset:2048 sc1
s_waitcnt lgkmcnt(4)
v_smfmac_f32_16x16x64_bf16 v[24:27], v[32:35], v[80:87], v1
v_smfmac_f32_16x16x64_bf16 v[16:19], v[32:35], v[48:55], v1
ds_read_b128 v[80:83], v2 offset:4096
ds_read_b128 v[84:87], v2 offset:5120
v_smfmac_f32_16x16x64_bf16 v[28:31], v[32:35], a[0:7], v1
s_waitcnt lgkmcnt(4)
s_waitcnt lgkmcnt(3)
v_smfmac_f32_16x16x64_bf16 v[20:23], v[36:39], v[56:63], v1
buffer_load_dwordx4 v[76:79], v0, s[4:7], s67 offen offset:3072 sc1
ds_read_b128 v[60:63], v2 offset:7168
ds_read_b128 v[56:59], v2 offset:6144
v_smfmac_f32_16x16x64_bf16 v[8:11], v[36:39], a[8:15], v1
s_waitcnt lgkmcnt(4)
s_barrier
ds_read_b128 v[40:43], v0 offset:2048
v_smfmac_f32_16x16x64_bf16 v[12:15], v[36:39], a[16:23], v1
s_waitcnt lgkmcnt(3)
ds_read_b128 v[44:47], v0 offset:6144
ds_read_b128 v[32:35], v0 offset:1024
v_smfmac_f32_16x16x64_bf16 v[24:27], v[36:39], v[80:87], v1
ds_read_b128 v[80:83], v2 offset:8192
v_smfmac_f32_16x16x64_bf16 v[28:31], v[36:39], a[32:39], v1
buffer_load_dwordx4 v[48:51], v0, s[4:7], s24 offen offset:0 nt sc1
v_smfmac_f32_16x16x64_bf16 v[16:19], v[36:39], a[24:31], v1
ds_read_b128 v[36:39], v0 offset:5120
s_waitcnt lgkmcnt(4)
v_smfmac_f32_16x16x64_bf16 v[8:11], v[40:43], a[40:47], v1
ds_read_b128 v[84:87], v2 offset:9216
s_waitcnt lgkmcnt(4)
v_smfmac_f32_16x16x64_bf16 v[12:15], v[40:43], a[48:55], v1
s_waitcnt vmcnt(4)
ds_read_b128 v[40:43], v0 offset:0
v_smfmac_f32_16x16x64_bf16 v[12:15], v[44:47], v[56:63], v1
s_waitcnt lgkmcnt(4)
ds_read_b128 v[60:63], v2 offset:11264
ds_read_b128 v[56:59], v2 offset:10240
v_smfmac_f32_16x16x64_bf16 v[8:11], v[44:47], a[56:63], v1
buffer_load_dwordx4 v[52:55], v0, s[4:7], s24 offen offset:1024 nt sc1
v_smfmac_f32_16x16x64_bf16 v[8:11], v[32:35], a[64:71], v1
s_waitcnt lgkmcnt(4)
ds_read_b128 v[44:47], v0 offset:4096
s_waitcnt lgkmcnt(4)
v_smfmac_f32_16x16x64_bf16 v[12:15], v[32:35], a[72:79], v1
s_waitcnt vmcnt(4)
ds_read_b128 v[32:35], v0 offset:9216
s_waitcnt lgkmcnt(4)
v_smfmac_f32_16x16x64_bf16 v[8:11], v[36:39], v[80:87], v1
ds_read_b128 v[80:83], v2 offset:12288
ds_read_b128 v[84:87], v2 offset:13312
v_smfmac_f32_16x16x64_bf16 v[8:11], v[40:43], v[64:71], v1
buffer_load_dwordx4 v[64:67], v0, s[4:7], s68 offen offset:0 sc1
v_smfmac_f32_16x16x64_bf16 v[12:15], v[36:39], a[80:87], v1
s_waitcnt lgkmcnt(4)
ds_read_b128 v[36:39], v0 offset:8192
v_smfmac_f32_16x16x64_bf16 v[12:15], v[40:43], v[56:63], v1
ds_read_b128 v[40:43], v0 offset:2048
s_waitcnt lgkmcnt(5)
v_smfmac_f32_16x16x64_bf16 v[8:11], v[44:47], a[88:95], v1
buffer_load_dwordx4 v[68:71], v0, s[4:7], s68 offen offset:1024 sc1
v_smfmac_f32_16x16x64_bf16 v[12:15], v[44:47], a[96:103], v1
s_waitcnt lgkmcnt(4)
ds_read_b128 v[60:63], v2 offset:15360
s_waitcnt lgkmcnt(3)
v_smfmac_f32_16x16x64_bf16 v[12:15], v[32:35], a[104:111], v1
ds_read_b128 v[56:59], v2 offset:14336
s_waitcnt vmcnt(5)
v_smfmac_f32_16x16x64_bf16 v[8:11], v[32:35], v[80:87], v1
s_waitcnt vmcnt(4)
ds_read_b128 v[32:35], v0 offset:6144
s_waitcnt lgkmcnt(4)
v_smfmac_f32_16x16x64_bf16 v[8:11], v[36:39], a[112:119], v1
s_waitcnt lgkmcnt(3)
ds_read_b128 v[80:83], v2 offset:16384
ds_read_b128 v[84:87], v2 offset:17408
v_smfmac_f32_16x16x64_bf16 v[16:19], v[40:43], v[72:79], v1
buffer_load_dwordx4 v[72:75], v0, s[4:7], s68 offen offset:2048 sc1
v_smfmac_f32_16x16x64_bf16 v[12:15], v[36:39], a[120:127], v1
s_waitcnt lgkmcnt(4)
ds_read_b128 v[36:39], v0 offset:1024
s_waitcnt lgkmcnt(4)
v_add_f32 v8, v8, v10
v_smfmac_f32_16x16x64_bf16 v[20:23], v[40:43], v[56:63], v1
s_waitcnt lgkmcnt(3)
buffer_load_dwordx4 v[76:79], v0, s[4:7], s68 offen offset:3072 sc1
v_smfmac_f32_16x16x64_bf16 v[20:23], v[32:35], a[136:143], v1
s_waitcnt lgkmcnt(2)
ds_read_b128 v[40:43], v0 offset:5120
v_mul_f32 v8, s44, v8
v_add_f32 v9, v9, v11
v_smfmac_f32_16x16x64_bf16 v[16:19], v[32:35], a[128:135], v1
buffer_load_dwordx4 v[56:59], v0, s[4:7], s24 offen offset:2048 nt sc1
ds_read_b128 v[32:35], v0 offset:0
s_waitcnt lgkmcnt(2)
v_mul_f32 v9, s44, v9
v_add_f32 v12, v12, v14
v_smfmac_f32_16x16x64_bf16 v[16:19], v[36:39], v[80:87], v1
ds_read_b128 v[80:83], v2 offset:18432
v_cvt_pk_bf16_f32 v8, v8, v9
v_smfmac_f32_16x16x64_bf16 v[20:23], v[36:39], a[144:151], v1
s_waitcnt lgkmcnt(2)
ds_read_b128 v[84:87], v2 offset:19456
v_add_f32 v13, v13, v15
v_smfmac_f32_16x16x64_bf16 v[20:23], v[40:43], a[160:167], v1
s_xor_b32 s18, s18, 1
ds_read_b128 v[36:39], v0 offset:4096
v_mul_f32 v12, s44, v12
v_mul_f32 v13, s44, v13
v_cvt_pk_bf16_f32 v12, v12, v13
v_smfmac_f32_16x16x64_bf16 v[16:19], v[40:43], a[152:159], v1
s_waitcnt lgkmcnt(3)
ds_write2_b32 v3, v8, v12 offset0:0 offset1:128
v_smfmac_f32_16x16x64_bf16 v[20:23], v[32:35], a[168:175], v1
ds_read_b128 v[40:43], v0 offset:9216
buffer_load_dwordx4 v[60:63], v0, s[4:7], s24 offen offset:3072 nt sc1
s_mov_b32 s19, 1
s_waitcnt lgkmcnt(3)
s_waitcnt lgkmcnt(2)
v_smfmac_f32_16x16x64_bf16 v[20:23], v[36:39], v[80:87], v1
s_waitcnt vmcnt(7)
s_waitcnt vmcnt(5)
ds_read_b128 v[84:87], v2 offset:21504
s_waitcnt vmcnt(4)
v_smfmac_f32_16x16x64_bf16 v[16:19], v[32:35], v[64:71], v1
ds_read_b128 v[32:35], v0 offset:8192
buffer_load_dwordx4 v[64:67], v0, s[4:7], s69 offen offset:0 sc1
v_smfmac_f32_16x16x64_bf16 v[16:19], v[36:39], a[176:183], v1
s_waitcnt lgkmcnt(2)
ds_read_b128 v[36:39], v0 offset:2048
ds_read_b128 v[80:83], v2 offset:20480
buffer_load_dwordx4 v[68:71], v0, s[4:7], s69 offen offset:1024 sc1
v_smfmac_f32_16x16x64_bf16 v[16:19], v[40:43], a[184:191], v1
s_barrier
ds_read_b64_tr_b16 v[8:9], v4 offset:2048
ds_read_b64_tr_b16 v[10:11], v4 offset:2560
v_smfmac_f32_16x16x64_bf16 v[20:23], v[40:43], a[192:199], v1
s_waitcnt lgkmcnt(4)
ds_read_b64_tr_b16 v[14:15], v4 offset:3584
ds_read_b64_tr_b16 v[12:13], v4 offset:3072
v_smfmac_f32_16x16x64_bf16 v[16:19], v[32:35], a[200:207], v1
buffer_load_dword v7, v7, s[4:7], 0 offen sc1
v_smfmac_f32_16x16x64_bf16 v[20:23], v[32:35], a[208:215], v1
s_waitcnt lgkmcnt(5)
ds_read_b128 v[40:43], v0 offset:6144
ds_read_b128 v[32:35], v0 offset:1024
v_smfmac_f32_16x16x64_bf16 v[24:27], v[36:39], a[216:223], v1
s_waitcnt vmcnt(5)
s_waitcnt lgkmcnt(4)
v_add_f32 v16, v16, v18
v_add_f32 v17, v17, v19
v_mfma_f32_16x16x32_bf16 v[44:47], v[48:51], v[8:11], 0
s_waitcnt lgkmcnt(2)
v_cvt_pk_bf16_f32 v16, v16, v17
v_add_f32 v21, v21, v23
v_add_f32 v20, v20, v22
v_cvt_pk_bf16_f32 v20, v20, v21
v_mfma_f32_16x16x32_bf16 v[44:47], v[52:55], v[12:15], v[44:47]
s_nop 0
ds_write2_b32 v3, v16, v20 offset0:1 offset1:129
v_smfmac_f32_16x16x64_bf16 v[28:31], v[36:39], v[80:87], v1
s_waitcnt lgkmcnt(2)
ds_read_b128 v[36:39], v0 offset:5120
v_xor_b32 v48, 128, v5
v_smfmac_f32_16x16x64_bf16 v[24:27], v[40:43], a[224:231], v1
s_mov_b64 exec, s[54:55]
ds_write_b128 v48, v[44:47] offset:1536
s_mov_b64 exec, -1
v_smfmac_f32_16x16x64_bf16 v[28:31], v[40:43], a[232:239], v1
ds_read_b128 v[40:43], v0 offset:0
s_waitcnt lgkmcnt(4)
v_smfmac_f32_16x16x64_bf16 v[24:27], v[32:35], a[240:247], v1
s_waitcnt lgkmcnt(2)
v_smfmac_f32_16x16x64_bf16 v[28:31], v[32:35], a[248:255], v1
s_mov_b32 s37, 0
ds_read_b128 v[32:35], v0 offset:4096
ds_read_b128 v[80:83], v2 offset:22528
v_smfmac_f32_16x16x64_bf16 v[24:27], v[36:39], v[72:79], v1
buffer_load_dwordx4 v[72:75], v0, s[4:7], s65 offen offset:2048 sc1
v_smfmac_f32_16x16x64_bf16 v[28:31], v[36:39], v[88:95], v1
ds_read_b128 v[36:39], v0 offset:9216
s_waitcnt lgkmcnt(4)
s_barrier
ds_read_b128 v[52:55], v6 offset:1024
s_waitcnt lgkmcnt(4)
v_smfmac_f32_16x16x64_bf16 v[28:31], v[40:43], v[104:111], v1
s_waitcnt lgkmcnt(3)
ds_read_b128 v[48:51], v6 offset:0
v_smfmac_f32_16x16x64_bf16 v[24:27], v[40:43], v[96:103], v1
s_add_u32 s24, s24, 524288
ds_read_b128 v[40:43], v0 offset:8192
ds_read_b64_tr_b16 v[10:11], v4 offset:512
v_smfmac_f32_16x16x64_bf16 v[24:27], v[32:35], v[112:119], v1
s_waitcnt lgkmcnt(4)
ds_read_b64_tr_b16 v[12:13], v4 offset:1024
ds_read_b64_tr_b16 v[8:9], v4 offset:0
ds_read_b64_tr_b16 v[14:15], v4 offset:1536
v_smfmac_f32_16x16x64_bf16 v[28:31], v[32:35], v[120:127], v1
s_waitcnt vmcnt(2)
ds_read_b64_tr_b16 v[20:21], v4 offset:3072
ds_read_b64_tr_b16 v[16:17], v4 offset:2048
v_smfmac_f32_16x16x64_bf16 v[24:27], v[36:39], v[128:135], v1
s_waitcnt lgkmcnt(7)
ds_read_b64_tr_b16 v[18:19], v4 offset:2560
v_add_f32 v49, v49, v53
v_smfmac_f32_16x16x64_bf16 v[28:31], v[36:39], v[136:143], v1
s_waitcnt lgkmcnt(7)
ds_read_b64_tr_b16 v[22:23], v4 offset:3584
v_add_f32 v51, v51, v55
v_smfmac_f32_16x16x64_bf16 v[28:31], v[40:43], v[64:71], v1
s_barrier
v_smfmac_f32_16x16x64_bf16 v[24:27], v[40:43], v[144:151], v1
s_waitcnt lgkmcnt(4)
ds_read_b128 v[84:87], v2 offset:23552
v_add_f32 v50, v50, v54
v_mfma_f32_16x16x32_bf16 v[44:47], v[8:11], v[8:11], 0
s_waitcnt lgkmcnt(4)
v_exp_f32 v51, v51
v_mfma_f32_16x16x32_bf16 v[44:47], v[12:15], v[12:15], v[44:47]
s_waitcnt lgkmcnt(1)
v_add_f32 v48, v48, v52
v_exp_f32 v49, v49
v_mfma_f32_16x16x32_bf16 v[44:47], v[16:19], v[16:19], v[44:47]
v_exp_f32 v48, v48
v_exp_f32 v50, v50
v_cvt_pk_bf16_f32 v54, v48, v49
v_cvt_pk_bf16_f32 v55, v50, v51
v_mfma_f32_16x16x32_bf16 v[44:47], v[20:23], v[20:23], v[44:47]
s_add_u32 s17, s17, 1
v_mov_b32_dpp v48, v54 quad_perm:[0,1,0,1] row_mask:0xf bank_mask:0xf
v_mov_b32_dpp v51, v55 quad_perm:[2,3,2,3] row_mask:0xf bank_mask:0xf
v_mov_b32_dpp v50, v54 quad_perm:[2,3,2,3] row_mask:0xf bank_mask:0xf
v_mov_b32_dpp v49, v55 quad_perm:[0,1,0,1] row_mask:0xf bank_mask:0xf
v_mov_b64 v[22:23], s[56:57]
v_mov_b64 v[20:21], s[56:57]
v_mfma_f32_16x16x32_bf16 v[8:11], v[56:59], v[48:51], 0
v_exp_f32_dpp v44, v46 quad_perm:[0,1,0,1] row_mask:0xf bank_mask:0xf
v_mfma_f32_16x16x32_bf16 v[16:19], v[20:23], v[48:51], 0
v_exp_f32_dpp v45, v47 quad_perm:[0,1,0,1] row_mask:0xf bank_mask:0xf
v_mfma_f32_16x16x32_bf16 v[12:15], v[60:63], v[48:51], 0
s_waitcnt lgkmcnt(0)
v_cvt_pk_bf16_f32 v24, v24, v25
v_cvt_pk_bf16_f32 v53, v44, v45
v_mov_b64 v[54:55], s[58:59]
v_cvt_pk_bf16_f32 v52, v44, v45
v_cvt_pk_bf16_f32 v25, v26, v27
v_cvt_pk_bf16_f32 v26, v28, v29
v_mfma_f32_16x16x16_bf16 v[16:19], v[54:55], v[52:53], v[16:19]
v_cvt_pk_bf16_f32 v27, v30, v31
v_mov_b64 v[32:33], 0
v_mfma_f32_16x16x16_bf16 v[8:11], v[24:25], v[52:53], v[8:11]
s_nop 0
ds_read_b128 v[28:31], v0 offset:56320
v_mov_b64 v[34:35], 0
v_mfma_f32_16x16x16_bf16 v[12:15], v[26:27], v[52:53], v[12:15]
s_add_u32 s25, s25, 10240
v_subrev_u32 v17, s46, v16
v_rcp_f32 v18, v16
v_cmp_lt_u32 vcc, s47, v17
v_mul_f32 v10, v10, v18
v_mul_f32 v9, v9, v18
v_mul_f32 v8, v8, v18
v_cvt_pk_bf16_f32 v8, v8, v9
v_mul_f32 v12, v12, v18
v_mul_f32 v11, v11, v18
v_mul_f32 v15, v15, v18
v_cvt_pk_bf16_f32 v9, v10, v11
v_mul_f32 v14, v14, v18
v_mul_f32 v13, v13, v18
v_cvt_pk_bf16_f32 v11, v14, v15
v_cvt_pk_bf16_f32 v10, v12, v13
s_cbranch_vccnz rare_173
back_174:
s_mov_b64 exec, s[54:55]
ds_write_b128 v5, v[8:11] offset:1536
s_mov_b64 exec, -1
v_mov_b64 v[50:51], 0
v_smfmac_f32_16x16x64_bf16 v[32:35], v[8:11], v[80:87], v1
ds_read_b128 v[80:83], v0 offset:57344
ds_read_b128 v[24:27], v0 offset:55296
ds_read_b128 v[84:87], v0 offset:58368
v_mov_b64 v[54:55], 0
v_mov_b64 v[52:53], 0
v_mov_b64 v[40:41], 0
v_mov_b64 v[38:39], 0
v_mov_b64 v[48:49], 0
v_smfmac_f32_16x16x64_bf16 v[52:55], v[8:11], v[176:183], v1
s_mov_b32 s20, 396288
ds_read_b128 v[16:19], v0 offset:53248
buffer_load_dwordx4 v[76:79], v0, s[4:7], s65 offen offset:3072 sc1
v_mov_b64 v[36:37], 0
v_mov_b64 v[42:43], 0
v_smfmac_f32_16x16x64_bf16 v[48:51], v[8:11], v[168:175], v1
s_waitcnt lgkmcnt(4)
ds_read_b128 v[20:23], v0 offset:54272
s_barrier
ds_read_b128 v[56:59], v5 offset:1024
v_smfmac_f32_16x16x64_bf16 v[40:43], v[8:11], v[160:167], v1
s_waitcnt lgkmcnt(4)
ds_read_b128 v[60:63], v5 offset:512
ds_read_b128 v[12:15], v5 offset:0
v_bfe_u32 v45, v0, 1, 7
v_smfmac_f32_16x16x64_bf16 v[36:39], v[8:11], v[152:159], v1
buffer_load_dwordx4 v[64:67], v0, s[4:7], s65 offen offset:0 sc1
v_lshrrev_b32 v44, 8, v0
s_waitcnt lgkmcnt(3)
buffer_load_dwordx4 v[68:71], v0, s[4:7], s65 offen offset:1024 sc1
v_lshl_or_b32 v44, v44, 12, v45
s_waitcnt lgkmcnt(2)
v_smfmac_f32_16x16x64_bf16 v[32:35], v[56:59], v[16:23], v1
ds_read_b128 v[16:19], v0 offset:59392
s_waitcnt lgkmcnt(2)
v_smfmac_f32_16x16x64_bf16 v[32:35], v[60:63], v[24:31], v1
s_add_u32 s43, s17, 2
ds_read_b128 v[24:27], v0 offset:61440
s_waitcnt lgkmcnt(2)
v_smfmac_f32_16x16x64_bf16 v[32:35], v[12:15], v[184:191], v1
ds_read_b128 v[20:23], v0 offset:60416
ds_read_b128 v[28:31], v0 offset:62464
v_smfmac_f32_16x16x64_bf16 v[36:39], v[56:59], v[80:87], v1
ds_read_b128 v[84:87], v0 offset:64512
ds_read_b128 v[80:83], v0 offset:63488
v_smfmac_f32_16x16x64_bf16 v[36:39], v[60:63], v[192:199], v1
s_nop 1
v_cvt_pk_bf16_f32 v32, v32, v33
v_cvt_pk_bf16_f32 v33, v34, v35
v_smfmac_f32_16x16x64_bf16 v[36:39], v[12:15], v[200:207], v1
s_min_u32 s43, s43, s39
s_waitcnt lgkmcnt(5)
v_and_or_b32 v32, v32, -2, s18
v_smfmac_f32_16x16x64_bf16 v[52:55], v[56:59], v[232:239], v1
s_waitcnt lgkmcnt(3)
buffer_store_dwordx2 v[32:33], v44, s[4:7], s60 offen
v_smfmac_f32_16x16x64_bf16 v[40:43], v[56:59], v[16:23], v1
s_waitcnt lgkmcnt(2)
v_cvt_pk_bf16_f32 v36, v36, v37
v_smfmac_f32_16x16x64_bf16 v[40:43], v[60:63], v[24:31], v1
v_cvt_pk_bf16_f32 v37, v38, v39
v_smfmac_f32_16x16x64_bf16 v[40:43], v[12:15], v[208:215], v1
v_and_or_b32 v36, v36, -2, s18
v_smfmac_f32_16x16x64_bf16 v[52:55], v[60:63], v[240:247], v1
s_nop 0
buffer_store_dwordx2 v[36:37], v44, s[4:7], s61 offen
s_nop 0
v_smfmac_f32_16x16x64_bf16 v[52:55], v[12:15], v[248:255], v1
s_waitcnt lgkmcnt(0)
s_add_u32 s34, s24, 524288
v_cvt_pk_bf16_f32 v40, v40, v41
v_smfmac_f32_16x16x64_bf16 v[48:51], v[56:59], v[80:87], v1
v_cvt_pk_bf16_f32 v41, v42, v43
v_and_or_b32 v40, v40, -2, s18
v_smfmac_f32_16x16x64_bf16 v[48:51], v[60:63], v[216:223], v1
buffer_store_dwordx2 v[40:41], v44, s[4:7], s62 offen
v_smfmac_f32_16x16x64_bf16 v[48:51], v[12:15], v[224:231], v1
s_nop 1
v_cvt_pk_bf16_f32 v52, v52, v53
v_cvt_pk_bf16_f32 v53, v54, v55
s_nop 3
v_cvt_pk_bf16_f32 v48, v48, v49
v_and_or_b32 v48, v48, -2, s18
v_cvt_pk_bf16_f32 v49, v50, v51
buffer_store_dwordx2 v[48:49], v44, s[4:7], s63 offen
s_mov_b32 s21, 400384
v_and_or_b32 v52, v52, -2, s18
buffer_store_dwordx2 v[52:53], v44, s[4:7], s64 offen
ds_read_b128 v[80:83], v2 offset:0
ds_read_b128 v[84:87], v2 offset:1024
v_mov_b64 v[24:25], 0
v_mov_b64 v[26:27], 0
v_mov_b64 v[28:29], 0
v_mov_b64 v[30:31], 0
s_waitcnt vmcnt(9)
v_bfe_u32 v7, v0, 2, 3
v_add_u32 v7, s28, v7
s_mov_b32 exec_hi, 0
v_and_b32 v7, 511, v0
v_lshl_add_u32 v7, v7, 3, s34
s_mov_b32 exec_hi, -1
v_mov_b64 v[8:9], 0
v_mov_b64 v[10:11], 0
v_mov_b64 v[12:13], 0
v_mov_b64 v[14:15], 0
v_mov_b64 v[16:17], 0
v_mov_b64 v[18:19], 0
v_mov_b64 v[20:21], 0
v_mov_b64 v[22:23], 0
s_nop 15
s_nop 15
s_nop 15
s_nop 15
s_nop 15
s_nop 7
s_barrier
buffer_load_dwordx4 v[48:51], v0, s[4:7], s66 offen offset:0 sc1
buffer_load_dwordx4 v[52:55], v0, s[4:7], s66 offen offset:1024 sc1
buffer_load_dwordx4 v[56:59], v0, s[4:7], s66 offen offset:2048 sc1
buffer_load_dwordx4 v[60:63], v0, s[4:7], s66 offen offset:3072 sc1
s_nop 15
s_nop 15
s_nop 15
s_nop 13
s_mov_b32 s37, 0
s_cmp_eq_u32 s17, s38
s_barrier
s_nop 15
s_nop 7
s_cbranch_scc0 gather_172
s_branch exit_175
rare_173:
ds_read_b128 v[48:51], v6 offset:0
ds_read_b128 v[52:55], v6 offset:1024
s_waitcnt lgkmcnt(0)
s_barrier
v_add_f32 v48, v48, v52
v_add_f32 v49, v49, v53
v_add_f32 v50, v50, v54
v_add_f32 v51, v51, v55
v_mov_b32_dpp v46, v46 quad_perm:[0,1,0,1] row_mask:0xf bank_mask:0xf
v_mov_b32_dpp v47, v47 quad_perm:[0,1,0,1] row_mask:0xf bank_mask:0xf
v_max3_f32 v19, v48, v49, v50
v_max3_f32 v19, v19, v51, v46
v_max_f32 v19, v19, v47
s_nop 1
v_max_f32_dpp v19, v19, v19 quad_perm:[2,3,0,1] row_mask:0xf bank_mask:0xf
v_mov_b32 v44, v19
s_nop 1
v_permlane32_swap_b32 v19, v44
v_max_f32 v19, v19, v44
v_mov_b32 v44, v19
s_nop 1
v_permlane16_swap_b32 v19, v44
v_max_f32 v19, v19, v44
v_sub_f32 v48, v48, v19
v_sub_f32 v49, v49, v19
v_sub_f32 v50, v50, v19
v_sub_f32 v51, v51, v19
v_sub_f32 v46, v46, v19
v_sub_f32 v47, v47, v19
v_exp_f32 v48, v48
v_exp_f32 v49, v49
v_exp_f32 v50, v50
v_exp_f32 v51, v51
v_cvt_pk_bf16_f32 v54, v48, v49
v_cvt_pk_bf16_f32 v55, v50, v51
s_nop 0
v_mov_b32_dpp v48, v54 quad_perm:[0,1,0,1] row_mask:0xf bank_mask:0xf
v_mov_b32_dpp v49, v55 quad_perm:[0,1,0,1] row_mask:0xf bank_mask:0xf
v_mov_b32_dpp v50, v54 quad_perm:[2,3,2,3] row_mask:0xf bank_mask:0xf
v_mov_b32_dpp v51, v55 quad_perm:[2,3,2,3] row_mask:0xf bank_mask:0xf
v_mov_b64 v[20:21], s[56:57]
v_mov_b64 v[22:23], s[56:57]
v_mfma_f32_16x16x32_bf16 v[8:11], v[56:59], v[48:51], 0
v_mfma_f32_16x16x32_bf16 v[12:15], v[60:63], v[48:51], 0
v_mfma_f32_16x16x32_bf16 v[16:19], v[20:23], v[48:51], 0
v_mov_b64 v[54:55], s[58:59]
v_exp_f32_dpp v44, v46 quad_perm:[0,1,0,1] row_mask:0xf bank_mask:0xf
v_exp_f32_dpp v45, v47 quad_perm:[0,1,0,1] row_mask:0xf bank_mask:0xf
s_nop 0
v_cvt_pk_bf16_f32 v52, v44, v45
v_cvt_pk_bf16_f32 v53, v44, v45
s_nop 1
v_mfma_f32_16x16x16_bf16 v[16:19], v[54:55], v[52:53], v[16:19]
v_mfma_f32_16x16x16_bf16 v[8:11], v[24:25], v[52:53], v[8:11]
v_mfma_f32_16x16x16_bf16 v[12:15], v[26:27], v[52:53], v[12:15]
s_nop 5
v_rcp_f32 v18, v16
s_nop 0
v_mul_f32 v8, v8, v18
v_mul_f32 v9, v9, v18
v_mul_f32 v10, v10, v18
v_mul_f32 v11, v11, v18
v_mul_f32 v12, v12, v18
v_mul_f32 v13, v13, v18
v_mul_f32 v14, v14, v18
v_mul_f32 v15, v15, v18
v_cvt_pk_bf16_f32 v8, v8, v9
v_cvt_pk_bf16_f32 v9, v10, v11
v_cvt_pk_bf16_f32 v10, v12, v13
v_cvt_pk_bf16_f32 v11, v14, v15
s_branch back_174
exit_175:
buffer_load_dwordx4 v[32:35], v0, s[4:7], s20 offen sc1
buffer_load_dwordx4 v[36:39], v0, s[4:7], s21 offen sc1
s_add_u32 s37, s37, 1
s_cmp_gt_u32 s37, 262144
s_cbranch_scc1 L_fail
s_waitcnt vmcnt(1)
v_bitop3_b32 v44, v32, v34, s18 bitop3:0x7e
s_waitcnt vmcnt(0)
v_bitop3_b32 v45, v36, v38, s18 bitop3:0x7e
v_bitop3_b32 v44, v44, v45, s19 bitop3:0xa8
v_cmp_ne_u32 vcc, 0, v44
s_cbranch_vccnz exit_175
s_add_u32 s45, s45, 1
s_cmp_lt_u32 s45, 2
s_cbranch_scc1 layer_171
s_endpgm
grp_127:
L_fail:
s_mov_b64 exec, 1
v_mov_b32 v1, 0xdead
buffer_store_dword v1, off, s[8:11], 0 offset:8 sc1
L_end:
s_endpgm

.section .rodata,"a"
.p2align 6
.amdhsa_kernel interleave_layers__spectral_gfnet__memory_aug_recurrent_mem_tr__prompt_kernel
  .amdhsa_next_free_vgpr 512
  .amdhsa_next_free_sgpr 102
  .amdhsa_accum_offset 256
  .amdhsa_group_segment_fixed_size 0
  .amdhsa_kernarg_size 104
  .amdhsa_user_sgpr_count 2
  .amdhsa_user_sgpr_kernarg_segment_ptr 1
  .amdhsa_system_sgpr_workgroup_id_x 1
  .amdhsa_float_denorm_mode_32 3
  .amdhsa_ieee_mode 0
.end_amdhsa_kernel
```

```asm
; @launch grid=(256,1,1) block=(256,1,1) lds=163840
.amdgcn_target "amdgcn-amd-amdhsa--gfx950"
.text
.globl interleave_layers__spectral_gfnet__memory_aug_recurrent_mem_tr__prompt_kernel
.p2align 8
.type interleave_layers__spectral_gfnet__memory_aug_recurrent_mem_tr__prompt_kernel,@function
interleave_layers__spectral_gfnet__memory_aug_recurrent_mem_tr__prompt_kernel:
s_cmp_ge_u32 s2, 256
s_cbranch_scc1 L_end
s_load_dwordx2 s[4:5], s[0:1], 96
s_load_dwordx2 s[8:9], s[0:1], 88
s_mov_b32 s6, 268435456
s_mov_b32 s7, 0x20000
s_mov_b32 s10, 256
s_mov_b32 s11, 0x20000
s_getreg_b32 s12, hwreg(HW_REG_XCC_ID, 0, 3)
v_lshrrev_b32 v1, 6, v0
s_nop 0
v_readfirstlane_b32 s13, v1
s_waitcnt lgkmcnt(0)
s_cmp_lg_u32 s13, 0
s_cbranch_scc1 reg_3
s_cmp_ge_u32 s2, 16
s_cbranch_scc1 reg_4
v_lshlrev_b32 v1, 4, v0
s_lshl_b32 s15, s2, 12
v_mov_b64 v[4:5], 0
v_mov_b64 v[6:7], 0
buffer_store_dwordx4 v[4:7], v1, s[4:7], s15 offen offset:0 sc1
buffer_store_dwordx4 v[4:7], v1, s[4:7], s15 offen offset:1024 sc1
buffer_store_dwordx4 v[4:7], v1, s[4:7], s15 offen offset:2048 sc1
buffer_store_dwordx4 v[4:7], v1, s[4:7], s15 offen offset:3072 sc1
s_waitcnt vmcnt(0)
reg_4:
s_lshl_b32 s15, s12, 5
v_mov_b32 v2, 1
s_mov_b64 exec, 1
buffer_atomic_add v2, off, s[8:11], s15 sc0
s_mov_b64 exec, -1
v_and_b32 v1, 7, v0
v_lshlrev_b32 v1, 5, v1
s_mov_b32 s16, 0
reg_1:
buffer_load_dword v3, v1, s[8:11], 0 offen sc1
s_add_u32 s16, s16, 1
s_cmp_gt_u32 s16, 262144
s_cbranch_scc1 L_fail
s_waitcnt vmcnt(0)
v_add_u32_dpp v4, v3, v3 quad_perm:[1,0,3,2] row_mask:0xf bank_mask:0xf
s_nop 1
v_add_u32_dpp v4, v4, v4 quad_perm:[2,3,0,1] row_mask:0xf bank_mask:0xf
s_nop 1
v_add_u32_dpp v4, v4, v4 row_ror:4 row_mask:0xf bank_mask:0xf
v_cmp_ne_u32 vcc, 0x100, v4
s_cbranch_vccnz reg_1
v_readfirstlane_b32 s17, v2
v_readlane_b32 s20, v3, 0
v_readlane_b32 s21, v3, 1
v_readlane_b32 s22, v3, 2
v_readlane_b32 s23, v3, 3
v_readlane_b32 s24, v3, 4
v_readlane_b32 s25, v3, 5
v_readlane_b32 s26, v3, 6
v_readlane_b32 s27, v3, 7
s_mov_b32 s15, 7
s_cmp_ge_u32 s26, 32
s_cselect_b32 s15, 6, s15
s_cmp_ge_u32 s25, 32
s_cselect_b32 s15, 5, s15
s_cmp_ge_u32 s24, 32
s_cselect_b32 s15, 4, s15
s_cmp_ge_u32 s23, 32
s_cselect_b32 s15, 3, s15
s_cmp_ge_u32 s22, 32
s_cselect_b32 s15, 2, s15
s_cmp_ge_u32 s21, 32
s_cselect_b32 s15, 1, s15
s_cmp_ge_u32 s20, 32
s_cselect_b32 s15, 0, s15
s_mov_b32 s16, s17
s_cmp_gt_u32 s12, 0
s_cselect_b32 s18, s20, 0
s_add_u32 s16, s16, s18
s_cmp_gt_u32 s12, 1
s_cselect_b32 s18, s21, 0
s_add_u32 s16, s16, s18
s_cmp_gt_u32 s12, 2
s_cselect_b32 s18, s22, 0
s_add_u32 s16, s16, s18
s_cmp_gt_u32 s12, 3
s_cselect_b32 s18, s23, 0
s_add_u32 s16, s16, s18
s_cmp_gt_u32 s12, 4
s_cselect_b32 s18, s24, 0
s_add_u32 s16, s16, s18
s_cmp_gt_u32 s12, 5
s_cselect_b32 s18, s25, 0
s_add_u32 s16, s16, s18
s_cmp_gt_u32 s12, 6
s_cselect_b32 s18, s26, 0
s_add_u32 s16, s16, s18
s_add_u32 s18, s16, 32
s_cmp_lt_u32 s12, s15
s_cselect_b32 s16, s18, s16
s_cmp_eq_u32 s12, s15
s_cselect_b32 s18, s17, 32
s_cmp_lt_u32 s18, 32
s_cselect_b32 s16, s18, s16
v_mov_b32 v1, 0
v_mov_b32 v2, s16
ds_write_b32 v1, v2
s_waitcnt lgkmcnt(0)
s_branch reg_2
reg_3:
s_lshl_b32 s15, s13, 3
s_sub_u32 s15, s15, 8
s_load_dwordx2 s[20:21], s[0:1], s15
s_mov_b32 s16, 1314816
s_cmp_eq_u32 s13, 1
s_cselect_b32 s22, 2621440, s16
s_cselect_b32 s16, 80, 41
s_mov_b32 s23, 0x20000
s_mul_i32 s17, s16, s2
s_lshl_b32 s17, s17, 7
s_sub_u32 s16, s16, 1
v_and_b32 v1, 63, v0
v_add_u32 v2, 64, v1
v_min_u32 v1, s16, v1
v_min_u32 v2, s16, v2
v_lshlrev_b32 v1, 7, v1
v_lshlrev_b32 v2, 7, v2
s_waitcnt lgkmcnt(0)
buffer_load_dword v3, v1, s[20:23], s17 offen
buffer_load_dword v4, v2, s[20:23], s17 offen
reg_2:
s_barrier
v_mov_b32 v1, 0
ds_read_b32 v2, v1
s_waitcnt lgkmcnt(0)
v_readfirstlane_b32 s14, v2
s_barrier
s_cmp_lt_u32 s14, 32
s_cbranch_scc1 L_chain
s_sub_u32 s15, s14, 32
v_and_b32 v0, 63, v0
v_lshlrev_b32 v0, 4, v0
s_mov_b32 s24, 0x3f803f80
s_mul_i32 s31, s13, 10240
s_lshl_b32 s37, s13, 10
s_mov_b32 s22, s6
s_mov_b32 s23, 0
s_mov_b32 s16, 0
s_cmp_ge_u32 s15, 64
s_cbranch_scc1 roleA_6
s_and_b32 s32, s15, 31
s_cmp_ge_u32 s15, 32
s_cbranch_scc1 roleV_5
s_lshl_b32 s26, s32, 8
s_lshl_b32 s18, s13, 6
s_add_u32 s26, s26, s18
s_load_dwordx2 s[40:41], s[0:1], 48
s_mov_b32 s42, 5242880
s_mov_b32 s43, 0x20000
s_waitcnt lgkmcnt(0)
v_lshrrev_b32 v32, 6, v0
v_mul_u32_u24 v32, 8192, v32
v_and_b32 v33, 48, v0
v_add_u32 v30, v32, v33
v_bfe_u32 v32, v0, 6, 2
v_lshrrev_b32 v33, 9, v0
v_lshl_add_u32 v32, v33, 3, v32
v_lshlrev_b32 v31, 6, v32
v_and_b32 v32, 16, v0
v_add_u32 v31, v31, v32
v_bfe_u32 v32, v0, 5, 1
v_lshl_add_u32 v31, v32, 3, v31
v_bfe_u32 v32, v0, 8, 1
v_lshl_add_u32 v31, v32, 5, v31
s_mul_i32 s18, s13, 36864
v_add_u32 v31, s18, v31
s_barrier
s_add_u32 m0, s18, 0
s_add_u32 s19, s26, 0
buffer_load_dwordx4 v30, s[40:43], s19 offen lds
s_add_u32 m0, s18, 1024
s_add_u32 s19, s26, 131072
buffer_load_dwordx4 v30, s[40:43], s19 offen lds
s_add_u32 m0, s18, 2048
s_add_u32 s19, s26, 262144
buffer_load_dwordx4 v30, s[40:43], s19 offen lds
s_add_u32 m0, s18, 3072
s_add_u32 s19, s26, 393216
buffer_load_dwordx4 v30, s[40:43], s19 offen lds
s_add_u32 m0, s18, 4096
s_add_u32 s19, s26, 524288
buffer_load_dwordx4 v30, s[40:43], s19 offen lds
s_add_u32 m0, s18, 5120
s_add_u32 s19, s26, 655360
buffer_load_dwordx4 v30, s[40:43], s19 offen lds
s_add_u32 m0, s18, 6144
s_add_u32 s19, s26, 786432
buffer_load_dwordx4 v30, s[40:43], s19 offen lds
s_add_u32 m0, s18, 7168
s_add_u32 s19, s26, 917504
buffer_load_dwordx4 v30, s[40:43], s19 offen lds
s_add_u32 m0, s18, 8192
s_add_u32 s19, s26, 1048576
buffer_load_dwordx4 v30, s[40:43], s19 offen lds
s_add_u32 m0, s18, 9216
s_add_u32 s19, s26, 1179648
buffer_load_dwordx4 v30, s[40:43], s19 offen lds
s_add_u32 m0, s18, 10240
s_add_u32 s19, s26, 1310720
buffer_load_dwordx4 v30, s[40:43], s19 offen lds
s_add_u32 m0, s18, 11264
s_add_u32 s19, s26, 1441792
buffer_load_dwordx4 v30, s[40:43], s19 offen lds
s_add_u32 m0, s18, 12288
s_add_u32 s19, s26, 1572864
buffer_load_dwordx4 v30, s[40:43], s19 offen lds
s_add_u32 m0, s18, 13312
s_add_u32 s19, s26, 1703936
buffer_load_dwordx4 v30, s[40:43], s19 offen lds
s_add_u32 m0, s18, 14336
s_add_u32 s19, s26, 1835008
buffer_load_dwordx4 v30, s[40:43], s19 offen lds
s_add_u32 m0, s18, 15360
s_add_u32 s19, s26, 1966080
buffer_load_dwordx4 v30, s[40:43], s19 offen lds
s_add_u32 m0, s18, 16384
s_add_u32 s19, s26, 2097152
buffer_load_dwordx4 v30, s[40:43], s19 offen lds
s_add_u32 m0, s18, 17408
s_add_u32 s19, s26, 2228224
buffer_load_dwordx4 v30, s[40:43], s19 offen lds
s_add_u32 m0, s18, 18432
s_add_u32 s19, s26, 2359296
buffer_load_dwordx4 v30, s[40:43], s19 offen lds
s_add_u32 m0, s18, 19456
s_add_u32 s19, s26, 2490368
buffer_load_dwordx4 v30, s[40:43], s19 offen lds
s_add_u32 m0, s18, 20480
s_add_u32 s19, s26, 2621440
buffer_load_dwordx4 v30, s[40:43], s19 offen lds
s_add_u32 m0, s18, 21504
s_add_u32 s19, s26, 2752512
buffer_load_dwordx4 v30, s[40:43], s19 offen lds
s_add_u32 m0, s18, 22528
s_add_u32 s19, s26, 2883584
buffer_load_dwordx4 v30, s[40:43], s19 offen lds
s_add_u32 m0, s18, 23552
s_add_u32 s19, s26, 3014656
buffer_load_dwordx4 v30, s[40:43], s19 offen lds
s_add_u32 m0, s18, 24576
s_add_u32 s19, s26, 3145728
buffer_load_dwordx4 v30, s[40:43], s19 offen lds
s_add_u32 m0, s18, 25600
s_add_u32 s19, s26, 3276800
buffer_load_dwordx4 v30, s[40:43], s19 offen lds
s_add_u32 m0, s18, 26624
s_add_u32 s19, s26, 3407872
buffer_load_dwordx4 v30, s[40:43], s19 offen lds
s_add_u32 m0, s18, 27648
s_add_u32 s19, s26, 3538944
buffer_load_dwordx4 v30, s[40:43], s19 offen lds
s_add_u32 m0, s18, 28672
s_add_u32 s19, s26, 3670016
buffer_load_dwordx4 v30, s[40:43], s19 offen lds
s_add_u32 m0, s18, 29696
s_add_u32 s19, s26, 3801088
buffer_load_dwordx4 v30, s[40:43], s19 offen lds
s_add_u32 m0, s18, 30720
s_add_u32 s19, s26, 3932160
buffer_load_dwordx4 v30, s[40:43], s19 offen lds
s_add_u32 m0, s18, 31744
s_add_u32 s19, s26, 4063232
buffer_load_dwordx4 v30, s[40:43], s19 offen lds
s_add_u32 m0, s18, 32768
s_add_u32 s19, s26, 4194304
buffer_load_dwordx4 v30, s[40:43], s19 offen lds
s_add_u32 m0, s18, 33792
s_add_u32 s19, s26, 4325376
buffer_load_dwordx4 v30, s[40:43], s19 offen lds
s_add_u32 m0, s18, 34816
s_add_u32 s19, s26, 4456448
buffer_load_dwordx4 v30, s[40:43], s19 offen lds
s_add_u32 m0, s18, 35840
s_add_u32 s19, s26, 4587520
buffer_load_dwordx4 v30, s[40:43], s19 offen lds
s_waitcnt vmcnt(32)
ds_read_b64_tr_b16 a[0:1], v31 offset:0
ds_read_b64_tr_b16 a[2:3], v31 offset:256
ds_read_b64_tr_b16 a[4:5], v31 offset:1024
ds_read_b64_tr_b16 a[6:7], v31 offset:1280
ds_read_b64_tr_b16 a[8:9], v31 offset:2048
ds_read_b64_tr_b16 a[10:11], v31 offset:2304
ds_read_b64_tr_b16 a[12:13], v31 offset:3072
ds_read_b64_tr_b16 a[14:15], v31 offset:3328
s_waitcnt lgkmcnt(0)
s_add_u32 m0, s18, 0
s_add_u32 s19, s26, 4718592
buffer_load_dwordx4 v30, s[40:43], s19 offen lds
s_add_u32 m0, s18, 1024
s_add_u32 s19, s26, 4849664
buffer_load_dwordx4 v30, s[40:43], s19 offen lds
s_add_u32 m0, s18, 2048
s_add_u32 s19, s26, 4980736
buffer_load_dwordx4 v30, s[40:43], s19 offen lds
s_add_u32 m0, s18, 3072
s_add_u32 s19, s26, 5111808
buffer_load_dwordx4 v30, s[40:43], s19 offen lds
s_waitcnt vmcnt(32)
ds_read_b64_tr_b16 a[16:17], v31 offset:4096
ds_read_b64_tr_b16 a[18:19], v31 offset:4352
ds_read_b64_tr_b16 a[20:21], v31 offset:5120
ds_read_b64_tr_b16 a[22:23], v31 offset:5376
ds_read_b64_tr_b16 a[24:25], v31 offset:6144
ds_read_b64_tr_b16 a[26:27], v31 offset:6400
ds_read_b64_tr_b16 a[28:29], v31 offset:7168
ds_read_b64_tr_b16 a[30:31], v31 offset:7424
s_waitcnt vmcnt(28)
ds_read_b64_tr_b16 a[32:33], v31 offset:8192
ds_read_b64_tr_b16 a[34:35], v31 offset:8448
ds_read_b64_tr_b16 a[36:37], v31 offset:9216
ds_read_b64_tr_b16 a[38:39], v31 offset:9472
ds_read_b64_tr_b16 a[40:41], v31 offset:10240
ds_read_b64_tr_b16 a[42:43], v31 offset:10496
ds_read_b64_tr_b16 a[44:45], v31 offset:11264
ds_read_b64_tr_b16 a[46:47], v31 offset:11520
s_waitcnt vmcnt(24)
ds_read_b64_tr_b16 a[48:49], v31 offset:12288
ds_read_b64_tr_b16 a[50:51], v31 offset:12544
ds_read_b64_tr_b16 a[52:53], v31 offset:13312
ds_read_b64_tr_b16 a[54:55], v31 offset:13568
ds_read_b64_tr_b16 a[56:57], v31 offset:14336
ds_read_b64_tr_b16 a[58:59], v31 offset:14592
ds_read_b64_tr_b16 a[60:61], v31 offset:15360
ds_read_b64_tr_b16 a[62:63], v31 offset:15616
s_waitcnt vmcnt(20)
ds_read_b64_tr_b16 a[64:65], v31 offset:16384
ds_read_b64_tr_b16 a[66:67], v31 offset:16640
ds_read_b64_tr_b16 a[68:69], v31 offset:17408
ds_read_b64_tr_b16 a[70:71], v31 offset:17664
ds_read_b64_tr_b16 a[72:73], v31 offset:18432
ds_read_b64_tr_b16 a[74:75], v31 offset:18688
ds_read_b64_tr_b16 a[76:77], v31 offset:19456
ds_read_b64_tr_b16 a[78:79], v31 offset:19712
s_waitcnt vmcnt(16)
ds_read_b64_tr_b16 a[80:81], v31 offset:20480
ds_read_b64_tr_b16 a[82:83], v31 offset:20736
ds_read_b64_tr_b16 a[84:85], v31 offset:21504
ds_read_b64_tr_b16 a[86:87], v31 offset:21760
ds_read_b64_tr_b16 a[88:89], v31 offset:22528
ds_read_b64_tr_b16 a[90:91], v31 offset:22784
ds_read_b64_tr_b16 a[92:93], v31 offset:23552
ds_read_b64_tr_b16 a[94:95], v31 offset:23808
s_waitcnt vmcnt(12)
ds_read_b64_tr_b16 a[96:97], v31 offset:24576
ds_read_b64_tr_b16 a[98:99], v31 offset:24832
ds_read_b64_tr_b16 a[100:101], v31 offset:25600
ds_read_b64_tr_b16 a[102:103], v31 offset:25856
ds_read_b64_tr_b16 a[104:105], v31 offset:26624
ds_read_b64_tr_b16 a[106:107], v31 offset:26880
ds_read_b64_tr_b16 a[108:109], v31 offset:27648
ds_read_b64_tr_b16 a[110:111], v31 offset:27904
s_waitcnt vmcnt(8)
ds_read_b64_tr_b16 a[112:113], v31 offset:28672
ds_read_b64_tr_b16 a[114:115], v31 offset:28928
ds_read_b64_tr_b16 a[116:117], v31 offset:29696
ds_read_b64_tr_b16 a[118:119], v31 offset:29952
ds_read_b64_tr_b16 a[120:121], v31 offset:30720
ds_read_b64_tr_b16 a[122:123], v31 offset:30976
ds_read_b64_tr_b16 a[124:125], v31 offset:31744
ds_read_b64_tr_b16 a[126:127], v31 offset:32000
s_waitcnt vmcnt(4)
ds_read_b64_tr_b16 a[128:129], v31 offset:32768
ds_read_b64_tr_b16 a[130:131], v31 offset:33024
ds_read_b64_tr_b16 a[132:133], v31 offset:33792
ds_read_b64_tr_b16 a[134:135], v31 offset:34048
ds_read_b64_tr_b16 a[136:137], v31 offset:34816
ds_read_b64_tr_b16 a[138:139], v31 offset:35072
ds_read_b64_tr_b16 a[140:141], v31 offset:35840
ds_read_b64_tr_b16 a[142:143], v31 offset:36096
s_waitcnt vmcnt(0)
ds_read_b64_tr_b16 a[144:145], v31 offset:0
ds_read_b64_tr_b16 a[146:147], v31 offset:256
ds_read_b64_tr_b16 a[148:149], v31 offset:1024
ds_read_b64_tr_b16 a[150:151], v31 offset:1280
ds_read_b64_tr_b16 a[152:153], v31 offset:2048
ds_read_b64_tr_b16 a[154:155], v31 offset:2304
ds_read_b64_tr_b16 a[156:157], v31 offset:3072
ds_read_b64_tr_b16 a[158:159], v31 offset:3328
s_waitcnt lgkmcnt(0)
s_barrier
s_load_dwordx2 s[40:41], s[0:1], 40
s_mov_b32 s42, 5242880
s_mov_b32 s43, 0x20000
s_waitcnt lgkmcnt(0)
v_lshrrev_b32 v5, 5, v0
v_lshlrev_b32 v5, 13, v5
v_bfe_u32 v6, v0, 4, 1
v_lshl_add_u32 v5, v6, 7, v5
s_lshl_b32 s18, s32, 8
s_mul_i32 s19, s13, 1310720
s_add_u32 s18, s18, s19
buffer_load_dword v24, v5, s[40:43], s18 offen
s_add_u32 s18, s18, 262144
buffer_load_dword v25, v5, s[40:43], s18 offen
s_add_u32 s18, s18, 262144
buffer_load_dword v26, v5, s[40:43], s18 offen
s_add_u32 s18, s18, 262144
buffer_load_dword v27, v5, s[40:43], s18 offen
s_add_u32 s18, s18, 262144
buffer_load_dword v28, v5, s[40:43], s18 offen
s_add_u32 s18, s18, 262144
v_mov_b32 v32, s24
v_mov_b32 v33, s24
v_mov_b32 v34, s24
v_mov_b32 v35, s24
s_nop 1
v_mfma_f32_32x32x16_bf16 v[36:51], a[0:3], v[32:35], 0
v_mfma_f32_32x32x16_bf16 v[36:51], a[4:7], v[32:35], v[36:51]
v_mfma_f32_32x32x16_bf16 v[36:51], a[8:11], v[32:35], v[36:51]
v_mfma_f32_32x32x16_bf16 v[36:51], a[12:15], v[32:35], v[36:51]
v_mfma_f32_32x32x16_bf16 v[36:51], a[16:19], v[32:35], v[36:51]
v_mfma_f32_32x32x16_bf16 v[36:51], a[20:23], v[32:35], v[36:51]
v_mfma_f32_32x32x16_bf16 v[36:51], a[24:27], v[32:35], v[36:51]
v_mfma_f32_32x32x16_bf16 v[36:51], a[28:31], v[32:35], v[36:51]
v_mfma_f32_32x32x16_bf16 v[36:51], a[32:35], v[32:35], v[36:51]
v_mfma_f32_32x32x16_bf16 v[36:51], a[36:39], v[32:35], v[36:51]
v_mfma_f32_32x32x16_bf16 v[36:51], a[40:43], v[32:35], v[36:51]
v_mfma_f32_32x32x16_bf16 v[36:51], a[44:47], v[32:35], v[36:51]
v_mfma_f32_32x32x16_bf16 v[36:51], a[48:51], v[32:35], v[36:51]
v_mfma_f32_32x32x16_bf16 v[36:51], a[52:55], v[32:35], v[36:51]
v_mfma_f32_32x32x16_bf16 v[36:51], a[56:59], v[32:35], v[36:51]
v_mfma_f32_32x32x16_bf16 v[36:51], a[60:63], v[32:35], v[36:51]
v_mfma_f32_32x32x16_bf16 v[36:51], a[64:67], v[32:35], v[36:51]
v_mfma_f32_32x32x16_bf16 v[36:51], a[68:71], v[32:35], v[36:51]
v_mfma_f32_32x32x16_bf16 v[36:51], a[72:75], v[32:35], v[36:51]
v_mfma_f32_32x32x16_bf16 v[36:51], a[76:79], v[32:35], v[36:51]
v_mfma_f32_32x32x16_bf16 v[36:51], a[80:83], v[32:35], v[36:51]
v_mfma_f32_32x32x16_bf16 v[36:51], a[84:87], v[32:35], v[36:51]
v_mfma_f32_32x32x16_bf16 v[36:51], a[88:91], v[32:35], v[36:51]
v_mfma_f32_32x32x16_bf16 v[36:51], a[92:95], v[32:35], v[36:51]
v_mfma_f32_32x32x16_bf16 v[36:51], a[96:99], v[32:35], v[36:51]
v_mfma_f32_32x32x16_bf16 v[36:51], a[100:103], v[32:35], v[36:51]
v_mfma_f32_32x32x16_bf16 v[36:51], a[104:107], v[32:35], v[36:51]
v_mfma_f32_32x32x16_bf16 v[36:51], a[108:111], v[32:35], v[36:51]
v_mfma_f32_32x32x16_bf16 v[36:51], a[112:115], v[32:35], v[36:51]
v_mfma_f32_32x32x16_bf16 v[36:51], a[116:119], v[32:35], v[36:51]
v_mfma_f32_32x32x16_bf16 v[36:51], a[120:123], v[32:35], v[36:51]
v_mfma_f32_32x32x16_bf16 v[36:51], a[124:127], v[32:35], v[36:51]
v_mfma_f32_32x32x16_bf16 v[36:51], a[128:131], v[32:35], v[36:51]
v_mfma_f32_32x32x16_bf16 v[36:51], a[132:135], v[32:35], v[36:51]
v_mfma_f32_32x32x16_bf16 v[36:51], a[136:139], v[32:35], v[36:51]
v_mfma_f32_32x32x16_bf16 v[36:51], a[140:143], v[32:35], v[36:51]
v_mfma_f32_32x32x16_bf16 v[36:51], a[144:147], v[32:35], v[36:51]
v_mfma_f32_32x32x16_bf16 v[36:51], a[148:151], v[32:35], v[36:51]
v_mfma_f32_32x32x16_bf16 v[36:51], a[152:155], v[32:35], v[36:51]
v_mfma_f32_32x32x16_bf16 v[36:51], a[156:159], v[32:35], v[36:51]
s_nop 11
v_mov_b32 v8, v36
v_mov_b32 v9, v37
v_mov_b32 v10, v38
v_mov_b32 v11, v39
v_mov_b32 v12, v40
v_mov_b32 v13, v41
v_mov_b32 v14, v42
v_mov_b32 v15, v43
v_mov_b32 v16, v44
v_mov_b32 v17, v45
v_mov_b32 v18, v46
v_mov_b32 v19, v47
v_mov_b32 v20, v48
v_mov_b32 v21, v49
v_mov_b32 v22, v50
v_mov_b32 v23, v51
v_and_b32 v5, 0x70, v0
s_waitcnt vmcnt(4)
v_lshrrev_b32 v24, 8, v0
v_lshl_add_u32 v5, v24, 7, v5
v_bfe_u32 v24, v0, 7, 1
v_lshl_add_u32 v5, v24, 12, v5
s_lshr_b32 s34, s13, 1
s_lshl_b32 s34, s34, 13
s_and_b32 s18, s13, 1
s_lshl_b32 s18, s18, 10
s_add_u32 s34, s34, s18
s_lshl_b32 s18, s32, 14
s_add_u32 s34, s34, s18
v_bfe_u32 v6, v0, 7, 2
v_mul_u32_u24 v6, 10240, v6
v_bfe_u32 v24, v0, 5, 2
v_lshl_add_u32 v6, v24, 6, v6
v_lshrrev_b32 v24, 9, v0
v_lshl_add_u32 v6, v24, 5, v6
v_and_b32 v24, 16, v0
v_add_u32 v6, v24, v6
s_lshl_b32 s51, s32, 7
s_add_u32 s51, s51, 0
s_mul_i32 s52, s13, 2560
s_add_u32 s52, s52, 12582912
s_add_u32 s50, s34, 110100480
s_mov_b32 s39, 0
kvlay_7:
s_mul_i32 s26, s16, 6291456
s_add_u32 s26, s26, 88080384
s_add_u32 s26, s26, s31
s_mul_i32 s54, s16, 327680
s_add_u32 s54, s54, 163577856
s_mul_i32 s27, s16, 34603008
s_add_u32 s27, s27, 16777216
s_add_u32 s27, s27, s34
s_lshl_b32 s29, s16, 1
s_add_u32 s29, s29, 1
s_mov_b32 s28, 0
s_mov_b32 s30, 0
s_cmp_lt_u32 s30, 64
s_cselect_b32 s53, s26, s6
s_cselect_b32 s36, s54, s6
s_mov_b32 s38, 1024
v_mov_b32 v7, v0
s_add_u32 s26, s26, 40960
s_add_u32 s54, s54, 5120
s_add_u32 s30, s30, 1
v_xor_b32 v1, 40960, v0
s_mov_b32 s25, s31
s_mov_b32 s35, 131072
s_cmp_lg_u32 s13, 0
s_cbranch_scc1 polld_16
s_waitcnt vmcnt(0)
v_lshrrev_b32 v28, 2, v0
v_min_u32 v28, 36, v28
s_mov_b32 s21, 8192
s_mov_b32 s17, 0
poll_15:
buffer_load_dword v24, v28, s[4:7], s21 offen offset:0 sc1
s_add_u32 s17, s17, 1
s_cmp_gt_u32 s17, 262144
s_cbranch_scc1 L_fail
s_waitcnt vmcnt(0)
v_cmp_gt_u32 vcc, s29, v24
s_cbranch_vccz polld_16
s_sleep 2
s_branch poll_15
polld_16:
s_barrier
s_add_u32 m0, s25, 2048
s_mov_b32 s20, s53
buffer_load_dwordx4 v7, s[4:7], s20 offen sc1 lds
s_add_u32 m0, s25, 3072
s_add_u32 s20, s20, s38
buffer_load_dwordx4 v7, s[4:7], s20 offen sc1 lds
s_add_u32 m0, s25, 4096
s_add_u32 s20, s20, s38
buffer_load_dwordx4 v7, s[4:7], s20 offen sc1 lds
s_add_u32 m0, s25, 5120
s_add_u32 s20, s20, s38
buffer_load_dwordx4 v7, s[4:7], s20 offen sc1 lds
s_add_u32 m0, s25, 6144
s_add_u32 s20, s20, s38
buffer_load_dwordx4 v7, s[4:7], s20 offen sc1 lds
s_add_u32 m0, s25, 7168
s_add_u32 s20, s20, s38
buffer_load_dwordx4 v7, s[4:7], s20 offen sc1 lds
s_add_u32 m0, s25, 8192
s_add_u32 s20, s20, s38
buffer_load_dwordx4 v7, s[4:7], s20 offen sc1 lds
s_add_u32 m0, s25, 9216
s_add_u32 s20, s20, s38
buffer_load_dwordx4 v7, s[4:7], s20 offen sc1 lds
s_add_u32 m0, s25, 10240
s_add_u32 s20, s20, s38
buffer_load_dwordx4 v7, s[4:7], s20 offen sc1 lds
s_add_u32 m0, s25, 11264
s_add_u32 s20, s20, s38
buffer_load_dwordx4 v7, s[4:7], s20 offen sc1 lds
s_add_u32 m0, s35, s37
s_add_u32 s20, s36, s37
buffer_load_dwordx4 v0, s[4:7], s20 offen sc1 lds
s_add_u32 m0, s35, 4096
s_add_u32 s20, s36, 4096
buffer_load_dwordx4 v0, s[4:7], s20 offen sc1 lds
s_waitcnt vmcnt(0)
kvx_8:
v_xor_b32 v1, 40960, v1
s_sub_u32 s25, s25, s31
s_xor_b32 s25, s25, 40960
s_add_u32 s25, s25, s31
s_xor_b32 s35, s35, 8192
s_cmp_eq_u32 s28, 1
s_cbranch_scc1 kv_10
s_cmp_eq_u32 s28, 30
s_cbranch_scc0 kv_11
s_add_u32 s29, s29, 1
kv_10:
s_waitcnt vmcnt(0)
s_barrier
v_mov_b32 v3, s23
s_mov_b64 exec, 1
buffer_store_dword v3, off, s[4:7], s22 sc1
s_mov_b64 exec, -1
s_mov_b32 s22, s6
s_cmp_lg_u32 s13, 0
s_cbranch_scc1 polld_18
v_min_u32 v28, 624, v0
s_mov_b32 s21, 8192
s_mov_b32 s17, 0
poll_17:
buffer_load_dwordx4 v[24:27], v28, s[4:7], s21 offen offset:0 sc1
s_add_u32 s17, s17, 1
s_cmp_gt_u32 s17, 262144
s_cbranch_scc1 L_fail
s_waitcnt vmcnt(0)
v_min3_u32 v24, v24, v25, v26
v_min_u32 v24, v24, v27
v_cmp_gt_u32 vcc, s29, v24
s_cbranch_vccz polld_18
s_sleep 2
s_branch poll_17
polld_18:
s_barrier
kv_11:
s_add_u32 s28, s28, 1
s_and_b32 s33, s28, 3
s_cmp_lt_u32 s28, 12
s_cselect_b32 s33, 1, s33
s_cmp_eq_u32 s33, 0
s_cbranch_scc1 kv_12
s_cmp_lt_u32 s30, 64
s_cselect_b32 s53, s26, s6
s_cselect_b32 s36, s54, s6
s_mov_b32 s38, 1024
v_mov_b32 v7, v0
s_add_u32 s26, s26, 40960
s_add_u32 s54, s54, 5120
s_add_u32 s30, s30, 1
kvn_9:
s_waitcnt vmcnt(3)
s_barrier
ds_read_b128 v[48:51], v1 offset:2048
s_add_u32 m0, s25, 2048
s_mov_b32 s20, s53
buffer_load_dwordx4 v7, s[4:7], s20 offen sc1 lds
ds_read_b128 v[52:55], v1 offset:3072
ds_read_b128 v[60:63], v1 offset:5120
ds_read_b128 v[56:59], v1 offset:4096
s_xor_b32 s18, s35, 8192
v_lshrrev_b32 v2, 2, v0
s_add_u32 m0, s25, 3072
s_add_u32 s20, s20, s38
buffer_load_dwordx4 v7, s[4:7], s20 offen sc1 lds
v_add_u32 v2, s18, v2
s_waitcnt lgkmcnt(3)
v_mfma_f32_32x32x16_bf16 v[32:47], a[0:3], v[48:51], 0
ds_read2st64_b32 v[78:79], v2 offset0:10 offset1:11
ds_read2st64_b32 v[76:77], v2 offset0:8 offset1:9
ds_read2st64_b32 v[72:73], v2 offset0:4 offset1:5
s_waitcnt lgkmcnt(5)
v_mfma_f32_32x32x16_bf16 v[32:47], a[4:7], v[52:55], v[32:47]
ds_read_b128 v[52:55], v1 offset:7168
ds_read_b128 v[48:51], v1 offset:6144
s_waitcnt lgkmcnt(5)
v_mfma_f32_32x32x16_bf16 v[32:47], a[8:11], v[56:59], v[32:47]
s_add_u32 m0, s25, 4096
s_add_u32 s20, s20, s38
buffer_load_dwordx4 v7, s[4:7], s20 offen sc1 lds
ds_read2st64_b32 v[84:85], v2 offset0:16 offset1:17
ds_read2st64_b32 v[64:65], v2 offset0:0 offset1:1
s_waitcnt lgkmcnt(5)
ds_read_b128 v[56:59], v1 offset:8192
v_mfma_f32_32x32x16_bf16 v[32:47], a[12:15], v[60:63], v[32:47]
ds_read2st64_b32 v[66:67], v2 offset0:2 offset1:3
ds_read2st64_b32 v[74:75], v2 offset0:6 offset1:7
ds_read_b128 v[60:63], v1 offset:9216
s_waitcnt lgkmcnt(7)
s_waitcnt lgkmcnt(6)
v_mfma_f32_32x32x16_bf16 v[32:47], a[16:19], v[48:51], v[32:47]
s_add_u32 m0, s25, 5120
s_add_u32 s20, s20, s38
buffer_load_dwordx4 v7, s[4:7], s20 offen sc1 lds
s_add_u32 m0, s25, 6144
s_add_u32 s20, s20, s38
buffer_load_dwordx4 v7, s[4:7], s20 offen sc1 lds
ds_read2st64_b32 v[86:87], v2 offset0:18 offset1:19
v_mfma_f32_32x32x16_bf16 v[32:47], a[20:23], v[52:55], v[32:47]
s_waitcnt lgkmcnt(3)
ds_read2st64_b32 v[82:83], v2 offset0:14 offset1:15
ds_read_b128 v[48:51], v1 offset:10240
s_waitcnt lgkmcnt(4)
v_mfma_f32_32x32x16_bf16 v[32:47], a[24:27], v[56:59], v[32:47]
ds_read_b128 v[56:59], v1 offset:12288
ds_read_b128 v[52:55], v1 offset:11264
ds_read2st64_b32 v[80:81], v2 offset0:12 offset1:13
s_waitcnt lgkmcnt(6)
v_mfma_f32_32x32x16_bf16 v[32:47], a[28:31], v[60:63], v[32:47]
s_waitcnt lgkmcnt(5)
ds_read_b128 v[60:63], v1 offset:13312
s_waitcnt lgkmcnt(4)
v_add_f32 v65, v65, v67
v_mfma_f32_32x32x16_bf16 v[32:47], a[32:35], v[48:51], v[32:47]
v_add_f32 v64, v64, v66
v_mov_b32 v3, s23
v_add_f32 v64, v64, v72
s_waitcnt lgkmcnt(2)
v_add_f32 v64, v64, v74
v_mfma_f32_32x32x16_bf16 v[32:47], a[36:39], v[52:55], v[32:47]
s_add_u32 m0, s25, 7168
s_add_u32 s20, s20, s38
buffer_load_dwordx4 v7, s[4:7], s20 offen sc1 lds
v_add_f32 v64, v64, v76
ds_read_b128 v[48:51], v1 offset:14336
v_mfma_f32_32x32x16_bf16 v[32:47], a[40:43], v[56:59], v[32:47]
s_waitcnt lgkmcnt(1)
ds_read_b128 v[56:59], v1 offset:16384
ds_read_b128 v[52:55], v1 offset:15360
v_mfma_f32_32x32x16_bf16 v[32:47], a[44:47], v[60:63], v[32:47]
v_add_f32 v65, v65, v73
s_waitcnt lgkmcnt(2)
v_mfma_f32_32x32x16_bf16 v[32:47], a[48:51], v[48:51], v[32:47]
s_add_u32 m0, s25, 8192
s_add_u32 s20, s20, s38
buffer_load_dwordx4 v7, s[4:7], s20 offen sc1 lds
ds_read_b128 v[60:63], v1 offset:17408
v_add_f32 v64, v64, v78
s_waitcnt lgkmcnt(1)
v_mfma_f32_32x32x16_bf16 v[32:47], a[52:55], v[52:55], v[32:47]
ds_read_b128 v[48:51], v1 offset:18432
ds_read_b128 v[52:55], v1 offset:19456
s_add_u32 m0, s25, 9216
s_add_u32 s20, s20, s38
buffer_load_dwordx4 v7, s[4:7], s20 offen sc1 lds
v_mfma_f32_32x32x16_bf16 v[32:47], a[56:59], v[56:59], v[32:47]
ds_read_b128 v[56:59], v1 offset:20480
s_add_u32 m0, s25, 10240
s_add_u32 s20, s20, s38
buffer_load_dwordx4 v7, s[4:7], s20 offen sc1 lds
s_waitcnt lgkmcnt(3)
v_mfma_f32_32x32x16_bf16 v[32:47], a[60:63], v[60:63], v[32:47]
ds_read_b128 v[60:63], v1 offset:21504
v_add_f32 v65, v65, v75
v_add_f32 v65, v65, v77
s_waitcnt lgkmcnt(3)
v_mfma_f32_32x32x16_bf16 v[32:47], a[64:67], v[48:51], v[32:47]
v_add_f32 v64, v64, v80
s_waitcnt lgkmcnt(2)
ds_read_b128 v[48:51], v1 offset:22528
v_mfma_f32_32x32x16_bf16 v[32:47], a[68:71], v[52:55], v[32:47]
ds_read_b128 v[52:55], v1 offset:23552
s_waitcnt lgkmcnt(3)
v_add_f32 v65, v65, v79
v_add_f32 v64, v64, v82
v_mfma_f32_32x32x16_bf16 v[32:47], a[72:75], v[56:59], v[32:47]
s_waitcnt lgkmcnt(2)
ds_read_b128 v[56:59], v1 offset:24576
v_add_f32 v65, v65, v81
v_add_f32 v64, v64, v84
v_mfma_f32_32x32x16_bf16 v[32:47], a[76:79], v[60:63], v[32:47]
v_add_f32 v65, v65, v83
ds_read_b128 v[60:63], v1 offset:25600
s_waitcnt lgkmcnt(3)
v_mfma_f32_32x32x16_bf16 v[32:47], a[80:83], v[48:51], v[32:47]
ds_read_b128 v[48:51], v1 offset:26624
v_add_f32 v65, v65, v85
s_waitcnt lgkmcnt(2)
v_add_f32 v64, v64, v86
v_mfma_f32_32x32x16_bf16 v[32:47], a[84:87], v[52:55], v[32:47]
s_add_u32 m0, s25, 11264
s_add_u32 s20, s20, s38
buffer_load_dwordx4 v7, s[4:7], s20 offen sc1 lds
s_waitcnt lgkmcnt(1)
ds_read_b128 v[52:55], v1 offset:27648
v_mfma_f32_32x32x16_bf16 v[32:47], a[88:91], v[56:59], v[32:47]
v_add_f32 v65, v65, v87
ds_read_b128 v[56:59], v1 offset:28672
v_add_f32 v64, v64, v65
v_mov_b32 v68, v64
v_mfma_f32_32x32x16_bf16 v[32:47], a[92:95], v[60:63], v[32:47]
s_waitcnt lgkmcnt(2)
s_add_u32 m0, s35, s37
s_add_u32 s20, s36, s37
buffer_load_dwordx4 v0, s[4:7], s20 offen sc1 lds
v_permlane32_swap_b32 v64, v68
v_mfma_f32_32x32x16_bf16 v[32:47], a[96:99], v[48:51], v[32:47]
ds_read_b128 v[48:51], v1 offset:30720
ds_read_b128 v[60:63], v1 offset:29696
s_waitcnt lgkmcnt(3)
v_mul_f32 v68, 0x3acccccd, v68
s_waitcnt lgkmcnt(2)
v_mul_f32 v64, 0x3acccccd, v64
v_mfma_f32_32x32x16_bf16 v[32:47], a[100:103], v[52:55], v[32:47]
s_add_u32 m0, s35, 4096
s_add_u32 s20, s36, 4096
buffer_load_dwordx4 v0, s[4:7], s20 offen sc1 lds
ds_read_b128 v[52:55], v1 offset:31744
v_mfma_f32_32x32x16_bf16 v[32:47], a[104:107], v[56:59], v[32:47]
ds_read_b128 v[56:59], v1 offset:32768
v_fma_f32 v68, -v64, v64, v68
s_waitcnt lgkmcnt(3)
v_max_f32 v68, 0, v68
s_waitcnt lgkmcnt(2)
v_add_f32 v68, 0x3727c5ac, v68
v_mfma_f32_32x32x16_bf16 v[32:47], a[108:111], v[60:63], v[32:47]
ds_read_b128 v[60:63], v1 offset:33792
v_mfma_f32_32x32x16_bf16 v[32:47], a[112:115], v[48:51], v[32:47]
s_waitcnt lgkmcnt(1)
ds_read_b128 v[48:51], v1 offset:34816
v_rsq_f32 v68, v68
v_mfma_f32_32x32x16_bf16 v[32:47], a[116:119], v[52:55], v[32:47]
ds_read_b128 v[52:55], v1 offset:35840
s_waitcnt lgkmcnt(2)
s_waitcnt vmcnt(12)
s_barrier
v_mfma_f32_32x32x16_bf16 v[32:47], a[120:123], v[56:59], v[32:47]
ds_read_b128 v[56:59], v1 offset:36864
s_waitcnt lgkmcnt(2)
s_mov_b64 exec, 1
buffer_store_dword v3, off, s[4:7], s22 sc1
s_mov_b64 exec, -1
v_mfma_f32_32x32x16_bf16 v[32:47], a[124:127], v[60:63], v[32:47]
ds_read_b128 v[60:63], v1 offset:37888
v_mfma_f32_32x32x16_bf16 v[32:47], a[128:131], v[48:51], v[32:47]
ds_read_b128 v[48:51], v1 offset:38912
s_waitcnt lgkmcnt(2)
v_mul_f32 v64, v68, v64
v_mul_f32 v83, v64, v19
v_mfma_f32_32x32x16_bf16 v[32:47], a[132:135], v[52:55], v[32:47]
s_waitcnt lgkmcnt(1)
v_mfma_f32_32x32x16_bf16 v[32:47], a[136:139], v[56:59], v[32:47]
v_mul_f32 v77, v64, v13
v_mul_f32 v86, v64, v22
ds_read_b128 v[52:55], v1 offset:39936
v_mfma_f32_32x32x16_bf16 v[32:47], a[140:143], v[60:63], v[32:47]
s_waitcnt lgkmcnt(1)
ds_read_b128 v[56:59], v1 offset:40960
v_mul_f32 v73, v64, v9
ds_read_b128 v[60:63], v1 offset:41984
v_mfma_f32_32x32x16_bf16 v[32:47], a[144:147], v[48:51], v[32:47]
v_mul_f32 v75, v64, v11
s_waitcnt lgkmcnt(2)
v_mul_f32 v84, v64, v20
v_mfma_f32_32x32x16_bf16 v[32:47], a[148:151], v[52:55], v[32:47]
v_mul_f32 v81, v64, v17
s_waitcnt lgkmcnt(1)
v_mfma_f32_32x32x16_bf16 v[32:47], a[152:155], v[56:59], v[32:47]
s_waitcnt lgkmcnt(0)
v_mul_f32 v87, v64, v23
v_mul_f32 v85, v64, v21
v_mul_f32 v80, v64, v16
v_mul_f32 v82, v64, v18
v_mul_f32 v74, v64, v10
v_mfma_f32_32x32x16_bf16 v[32:47], a[156:159], v[60:63], v[32:47]
s_nop 0
v_mul_f32 v79, v64, v15
s_nop 9
v_pk_fma_f32 v[34:35], v[34:35], v[68:69], v[74:75] op_sel_hi:[1,0,1] neg_lo:[0,0,1] neg_hi:[0,0,1]
v_pk_fma_f32 v[44:45], v[44:45], v[68:69], v[84:85] op_sel_hi:[1,0,1] neg_lo:[0,0,1] neg_hi:[0,0,1]
v_pk_fma_f32 v[40:41], v[40:41], v[68:69], v[80:81] op_sel_hi:[1,0,1] neg_lo:[0,0,1] neg_hi:[0,0,1]
v_mul_f32 v78, v64, v14
v_mul_f32 v72, v64, v8
v_cvt_pk_bf16_f32 v54, v44, v45
v_pk_fma_f32 v[42:43], v[42:43], v[68:69], v[82:83] op_sel_hi:[1,0,1] neg_lo:[0,0,1] neg_hi:[0,0,1]
v_mul_f32 v76, v64, v12
v_pk_fma_f32 v[32:33], v[32:33], v[68:69], v[72:73] op_sel_hi:[1,0,1] neg_lo:[0,0,1] neg_hi:[0,0,1]
v_pk_fma_f32 v[46:47], v[46:47], v[68:69], v[86:87] op_sel_hi:[1,0,1] neg_lo:[0,0,1] neg_hi:[0,0,1]
v_pk_fma_f32 v[38:39], v[38:39], v[68:69], v[78:79] op_sel_hi:[1,0,1] neg_lo:[0,0,1] neg_hi:[0,0,1]
v_cvt_pk_bf16_f32 v48, v32, v33
v_cvt_pk_bf16_f32 v55, v46, v47
v_cvt_pk_bf16_f32 v52, v40, v41
v_pk_fma_f32 v[36:37], v[36:37], v[68:69], v[76:77] op_sel_hi:[1,0,1] neg_lo:[0,0,1] neg_hi:[0,0,1]
v_cvt_pk_bf16_f32 v49, v34, v35
v_cvt_pk_bf16_f32 v53, v42, v43
v_cvt_pk_bf16_f32 v50, v36, v37
v_cvt_pk_bf16_f32 v51, v38, v39
buffer_store_dwordx4 v[48:51], v5, s[4:7], s27 offen offset:0 sc1
buffer_store_dwordx4 v[52:55], v5, s[4:7], s27 offen offset:512 sc1
s_lshl_b32 s18, s16, 6
s_add_u32 s18, s18, s28
s_add_u32 s27, s27, 524288
s_cmp_eq_u32 s13, 0
s_cselect_b32 s22, s51, s6
s_mov_b32 s23, s18
s_cmp_lg_u32 s33, 0
s_cbranch_scc1 kvx_8
kvm_13:
v_xor_b32 v1, 40960, v1
s_sub_u32 s25, s25, s31
s_xor_b32 s25, s25, 40960
s_add_u32 s25, s25, s31
s_xor_b32 s35, s35, 8192
s_cmp_lt_u32 s30, 64
s_cselect_b32 s53, s26, s6
s_cselect_b32 s36, s54, s6
s_mov_b32 s38, 1024
v_mov_b32 v7, v0
s_add_u32 s26, s26, 40960
s_add_u32 s54, s54, 5120
s_add_u32 s30, s30, 1
s_waitcnt vmcnt(3)
s_barrier
ds_read_b128 v[48:51], v1 offset:2048
s_add_u32 m0, s25, 2048
s_mov_b32 s20, s53
buffer_load_dwordx4 v7, s[4:7], s20 offen sc1 lds
ds_read_b128 v[52:55], v1 offset:3072
ds_read_b128 v[56:59], v1 offset:4096
s_add_u32 m0, s25, 3072
s_add_u32 s20, s20, s38
buffer_load_dwordx4 v7, s[4:7], s20 offen sc1 lds
s_waitcnt lgkmcnt(2)
v_mfma_f32_32x32x16_bf16 v[32:47], a[0:3], v[48:51], 0
ds_read_b128 v[60:63], v1 offset:5120
s_waitcnt lgkmcnt(2)
s_add_u32 m0, s25, 4096
s_add_u32 s20, s20, s38
buffer_load_dwordx4 v7, s[4:7], s20 offen sc1 lds
s_waitcnt lgkmcnt(1)
v_mfma_f32_32x32x16_bf16 v[32:47], a[4:7], v[52:55], v[32:47]
s_add_u32 m0, s25, 5120
s_add_u32 s20, s20, s38
buffer_load_dwordx4 v7, s[4:7], s20 offen sc1 lds
ds_read_b128 v[48:51], v1 offset:6144
ds_read_b128 v[52:55], v1 offset:7168
v_mfma_f32_32x32x16_bf16 v[32:47], a[8:11], v[56:59], v[32:47]
ds_read_b128 v[56:59], v1 offset:8192
s_waitcnt lgkmcnt(3)
v_mfma_f32_32x32x16_bf16 v[32:47], a[12:15], v[60:63], v[32:47]
s_waitcnt lgkmcnt(2)
v_mfma_f32_32x32x16_bf16 v[32:47], a[16:19], v[48:51], v[32:47]
ds_read_b128 v[60:63], v1 offset:9216
ds_read_b128 v[48:51], v1 offset:10240
s_waitcnt lgkmcnt(2)
v_mfma_f32_32x32x16_bf16 v[32:47], a[20:23], v[52:55], v[32:47]
v_mfma_f32_32x32x16_bf16 v[32:47], a[24:27], v[56:59], v[32:47]
ds_read_b128 v[56:59], v1 offset:12288
s_waitcnt lgkmcnt(2)
ds_read_b128 v[52:55], v1 offset:11264
v_mfma_f32_32x32x16_bf16 v[32:47], a[28:31], v[60:63], v[32:47]
s_waitcnt lgkmcnt(2)
s_add_u32 m0, s25, 6144
s_add_u32 s20, s20, s38
buffer_load_dwordx4 v7, s[4:7], s20 offen sc1 lds
ds_read_b128 v[60:63], v1 offset:13312
v_mfma_f32_32x32x16_bf16 v[32:47], a[32:35], v[48:51], v[32:47]
s_waitcnt lgkmcnt(2)
s_add_u32 m0, s25, 7168
s_add_u32 s20, s20, s38
buffer_load_dwordx4 v7, s[4:7], s20 offen sc1 lds
s_waitcnt lgkmcnt(1)
v_mfma_f32_32x32x16_bf16 v[32:47], a[36:39], v[52:55], v[32:47]
ds_read_b128 v[48:51], v1 offset:14336
s_add_u32 m0, s25, 8192
s_add_u32 s20, s20, s38
buffer_load_dwordx4 v7, s[4:7], s20 offen sc1 lds
s_waitcnt lgkmcnt(1)
ds_read_b128 v[52:55], v1 offset:15360
v_mfma_f32_32x32x16_bf16 v[32:47], a[40:43], v[56:59], v[32:47]
ds_read_b128 v[56:59], v1 offset:16384
v_mfma_f32_32x32x16_bf16 v[32:47], a[44:47], v[60:63], v[32:47]
s_waitcnt lgkmcnt(2)
ds_read_b128 v[60:63], v1 offset:17408
v_mfma_f32_32x32x16_bf16 v[32:47], a[48:51], v[48:51], v[32:47]
ds_read_b128 v[48:51], v1 offset:18432
s_waitcnt lgkmcnt(2)
v_mfma_f32_32x32x16_bf16 v[32:47], a[52:55], v[52:55], v[32:47]
ds_read_b128 v[52:55], v1 offset:19456
s_add_u32 m0, s25, 9216
s_add_u32 s20, s20, s38
buffer_load_dwordx4 v7, s[4:7], s20 offen sc1 lds
s_waitcnt lgkmcnt(2)
v_mfma_f32_32x32x16_bf16 v[32:47], a[56:59], v[56:59], v[32:47]
v_mfma_f32_32x32x16_bf16 v[32:47], a[60:63], v[60:63], v[32:47]
ds_read_b128 v[60:63], v1 offset:21504
ds_read_b128 v[56:59], v1 offset:20480
s_waitcnt lgkmcnt(3)
v_mov_b32 v3, s23
v_mfma_f32_32x32x16_bf16 v[32:47], a[64:67], v[48:51], v[32:47]
s_waitcnt lgkmcnt(2)
s_add_u32 m0, s25, 10240
s_add_u32 s20, s20, s38
buffer_load_dwordx4 v7, s[4:7], s20 offen sc1 lds
ds_read_b128 v[48:51], v1 offset:22528
v_mfma_f32_32x32x16_bf16 v[32:47], a[68:71], v[52:55], v[32:47]
ds_read_b128 v[52:55], v1 offset:23552
s_waitcnt lgkmcnt(2)
v_mfma_f32_32x32x16_bf16 v[32:47], a[72:75], v[56:59], v[32:47]
v_mfma_f32_32x32x16_bf16 v[32:47], a[76:79], v[60:63], v[32:47]
s_waitcnt lgkmcnt(0)
ds_read_b128 v[56:59], v1 offset:24576
v_mfma_f32_32x32x16_bf16 v[32:47], a[80:83], v[48:51], v[32:47]
ds_read_b128 v[60:63], v1 offset:25600
s_add_u32 m0, s25, 11264
s_add_u32 s20, s20, s38
buffer_load_dwordx4 v7, s[4:7], s20 offen sc1 lds
v_mfma_f32_32x32x16_bf16 v[32:47], a[84:87], v[52:55], v[32:47]
ds_read_b128 v[48:51], v1 offset:26624
s_waitcnt lgkmcnt(2)
ds_read_b128 v[52:55], v1 offset:27648
v_mfma_f32_32x32x16_bf16 v[32:47], a[88:91], v[56:59], v[32:47]
s_waitcnt lgkmcnt(2)
ds_read_b128 v[56:59], v1 offset:28672
s_add_u32 m0, s35, s37
s_add_u32 s20, s36, s37
buffer_load_dwordx4 v0, s[4:7], s20 offen sc1 lds
v_mfma_f32_32x32x16_bf16 v[32:47], a[92:95], v[60:63], v[32:47]
ds_read_b128 v[60:63], v1 offset:29696
s_waitcnt lgkmcnt(3)
v_mfma_f32_32x32x16_bf16 v[32:47], a[96:99], v[48:51], v[32:47]
s_waitcnt lgkmcnt(1)
ds_read_b128 v[48:51], v1 offset:30720
s_add_u32 m0, s35, 4096
s_add_u32 s20, s36, 4096
buffer_load_dwordx4 v0, s[4:7], s20 offen sc1 lds
v_mfma_f32_32x32x16_bf16 v[32:47], a[100:103], v[52:55], v[32:47]
ds_read_b128 v[52:55], v1 offset:31744
v_mfma_f32_32x32x16_bf16 v[32:47], a[104:107], v[56:59], v[32:47]
s_waitcnt lgkmcnt(2)
s_waitcnt lgkmcnt(1)
v_mfma_f32_32x32x16_bf16 v[32:47], a[108:111], v[60:63], v[32:47]
ds_read_b128 v[56:59], v1 offset:32768
ds_read_b128 v[60:63], v1 offset:33792
v_mfma_f32_32x32x16_bf16 v[32:47], a[112:115], v[48:51], v[32:47]
ds_read_b128 v[48:51], v1 offset:34816
s_waitcnt lgkmcnt(3)
v_mfma_f32_32x32x16_bf16 v[32:47], a[116:119], v[52:55], v[32:47]
s_waitcnt vmcnt(12)
s_barrier
ds_read_b128 v[52:55], v1 offset:35840
s_waitcnt lgkmcnt(3)
v_mfma_f32_32x32x16_bf16 v[32:47], a[120:123], v[56:59], v[32:47]
s_mov_b64 exec, 1
buffer_store_dword v3, off, s[4:7], s22 sc1
s_mov_b64 exec, -1
s_waitcnt lgkmcnt(1)
v_mfma_f32_32x32x16_bf16 v[32:47], a[124:127], v[60:63], v[32:47]
ds_read_b128 v[56:59], v1 offset:36864
s_waitcnt lgkmcnt(1)
ds_read_b128 v[60:63], v1 offset:37888
v_mfma_f32_32x32x16_bf16 v[32:47], a[128:131], v[48:51], v[32:47]
v_mfma_f32_32x32x16_bf16 v[32:47], a[132:135], v[52:55], v[32:47]
s_waitcnt lgkmcnt(1)
ds_read_b128 v[52:55], v1 offset:39936
ds_read_b128 v[48:51], v1 offset:38912
v_mfma_f32_32x32x16_bf16 v[32:47], a[136:139], v[56:59], v[32:47]
s_waitcnt lgkmcnt(2)
v_mfma_f32_32x32x16_bf16 v[32:47], a[140:143], v[60:63], v[32:47]
ds_read_b128 v[56:59], v1 offset:40960
ds_read_b128 v[60:63], v1 offset:41984
s_waitcnt lgkmcnt(2)
v_mfma_f32_32x32x16_bf16 v[32:47], a[144:147], v[48:51], v[32:47]
v_mfma_f32_32x32x16_bf16 v[32:47], a[148:151], v[52:55], v[32:47]
s_waitcnt lgkmcnt(1)
v_mfma_f32_32x32x16_bf16 v[32:47], a[152:155], v[56:59], v[32:47]
s_waitcnt lgkmcnt(0)
v_mfma_f32_32x32x16_bf16 v[32:47], a[156:159], v[60:63], v[32:47]
s_nop 11
v_cvt_pk_bf16_f32 v49, v34, v35
v_cvt_pk_bf16_f32 v48, v32, v33
v_cvt_pk_bf16_f32 v53, v42, v43
v_cvt_pk_bf16_f32 v51, v38, v39
v_cvt_pk_bf16_f32 v54, v44, v45
v_cvt_pk_bf16_f32 v50, v36, v37
v_cvt_pk_bf16_f32 v52, v40, v41
v_cvt_pk_bf16_f32 v55, v46, v47
buffer_store_dwordx4 v[48:51], v5, s[4:7], s50 offen offset:0 sc1
buffer_store_dwordx4 v[52:55], v5, s[4:7], s50 offen offset:512 sc1
s_add_u32 s39, s39, 1
s_add_u32 s50, s50, 524288
s_add_u32 s18, s51, 8
s_cmp_eq_u32 s13, 0
s_cselect_b32 s22, s18, s6
s_mov_b32 s23, s39
s_cmp_lt_u32 s28, 64
s_cbranch_scc1 kvx_8
s_and_b32 s18, s39, 15
s_cbranch_scc0 kvt_14
s_waitcnt vmcnt(0)
s_barrier
v_mov_b32 v3, s23
s_mov_b64 exec, 1
buffer_store_dword v3, off, s[4:7], s22 sc1
s_mov_b64 exec, -1
s_mov_b32 s22, s6
s_lshl_b32 s18, s39, 2
s_add_u32 s18, s18, 4
s_cmp_lg_u32 s13, 0
s_cbranch_scc1 polld_20
v_lshrrev_b32 v28, 2, v0
v_min_u32 v28, 36, v28
s_mov_b32 s21, 4096
s_mov_b32 s17, 0
poll_19:
buffer_load_dword v24, v28, s[4:7], s21 offen offset:0 sc1
s_add_u32 s17, s17, 1
s_cmp_gt_u32 s17, 262144
s_cbranch_scc1 L_fail
s_waitcnt vmcnt(0)
v_cmp_gt_u32 vcc, s18, v24
s_cbranch_vccz polld_20
s_sleep 2
s_branch poll_19
polld_20:
s_barrier
s_mov_b32 s53, s52
s_mov_b32 s36, s6
s_mov_b32 s38, 256
v_mov_b32 v7, v6
s_add_u32 s52, s52, 40960
s_add_u32 m0, s25, 2048
s_mov_b32 s20, s53
buffer_load_dwordx4 v7, s[4:7], s20 offen sc1 lds
s_add_u32 m0, s25, 3072
s_add_u32 s20, s20, s38
buffer_load_dwordx4 v7, s[4:7], s20 offen sc1 lds
s_add_u32 m0, s25, 4096
s_add_u32 s20, s20, s38
buffer_load_dwordx4 v7, s[4:7], s20 offen sc1 lds
s_add_u32 m0, s25, 5120
s_add_u32 s20, s20, s38
buffer_load_dwordx4 v7, s[4:7], s20 offen sc1 lds
s_add_u32 m0, s25, 6144
s_add_u32 s20, s20, s38
buffer_load_dwordx4 v7, s[4:7], s20 offen sc1 lds
s_add_u32 m0, s25, 7168
s_add_u32 s20, s20, s38
buffer_load_dwordx4 v7, s[4:7], s20 offen sc1 lds
s_add_u32 m0, s25, 8192
s_add_u32 s20, s20, s38
buffer_load_dwordx4 v7, s[4:7], s20 offen sc1 lds
s_add_u32 m0, s25, 9216
s_add_u32 s20, s20, s38
buffer_load_dwordx4 v7, s[4:7], s20 offen sc1 lds
s_add_u32 m0, s25, 10240
s_add_u32 s20, s20, s38
buffer_load_dwordx4 v7, s[4:7], s20 offen sc1 lds
s_add_u32 m0, s25, 11264
s_add_u32 s20, s20, s38
buffer_load_dwordx4 v7, s[4:7], s20 offen sc1 lds
s_waitcnt vmcnt(0)
s_branch kvm_13
kv_12:
s_lshl_b32 s18, s39, 2
s_add_u32 s18, s18, 4
s_cmp_lg_u32 s13, 0
s_cbranch_scc1 polld_22
v_lshrrev_b32 v28, 2, v0
v_min_u32 v28, 36, v28
s_mov_b32 s21, 4096
s_mov_b32 s17, 0
poll_21:
buffer_load_dword v24, v28, s[4:7], s21 offen offset:0 sc1
s_add_u32 s17, s17, 1
s_cmp_gt_u32 s17, 262144
s_cbranch_scc1 L_fail
s_waitcnt vmcnt(0)
v_cmp_gt_u32 vcc, s18, v24
s_cbranch_vccz polld_22
s_sleep 2
s_branch poll_21
polld_22:
s_barrier
s_mov_b32 s53, s52
s_mov_b32 s36, s6
s_mov_b32 s38, 256
v_mov_b32 v7, v6
s_add_u32 s52, s52, 40960
s_branch kvn_9
kvt_14:
s_waitcnt vmcnt(0)
s_barrier
v_mov_b32 v3, s23
s_mov_b64 exec, 1
buffer_store_dword v3, off, s[4:7], s22 sc1
s_mov_b64 exec, -1
s_mov_b32 s22, s6
s_add_u32 s16, s16, 1
s_cmp_lt_u32 s16, 2
s_cbranch_scc1 kvlay_7
s_endpgm
roleV_5:
s_lshl_b32 s26, s32, 8
s_lshl_b32 s18, s13, 6
s_add_u32 s26, s26, s18
s_load_dwordx2 s[40:41], s[0:1], 56
s_mov_b32 s42, 5242880
s_mov_b32 s43, 0x20000
s_waitcnt lgkmcnt(0)
v_lshrrev_b32 v20, 6, v0
v_mul_u32_u24 v20, 8192, v20
v_and_b32 v21, 48, v0
v_add_u32 v18, v20, v21
v_bfe_u32 v20, v0, 6, 2
v_lshrrev_b32 v21, 9, v0
v_lshl_add_u32 v20, v21, 3, v20
v_lshlrev_b32 v19, 6, v20
v_and_b32 v20, 48, v0
v_add_u32 v19, v19, v20
v_bfe_u32 v20, v0, 8, 1
v_lshl_add_u32 v19, v20, 3, v19
s_mul_i32 s18, s13, 36864
v_add_u32 v19, s18, v19
s_barrier
s_add_u32 m0, s18, 0
s_add_u32 s19, s26, 0
buffer_load_dwordx4 v18, s[40:43], s19 offen lds
s_add_u32 m0, s18, 1024
s_add_u32 s19, s26, 131072
buffer_load_dwordx4 v18, s[40:43], s19 offen lds
s_add_u32 m0, s18, 2048
s_add_u32 s19, s26, 262144
buffer_load_dwordx4 v18, s[40:43], s19 offen lds
s_add_u32 m0, s18, 3072
s_add_u32 s19, s26, 393216
buffer_load_dwordx4 v18, s[40:43], s19 offen lds
s_add_u32 m0, s18, 4096
s_add_u32 s19, s26, 524288
buffer_load_dwordx4 v18, s[40:43], s19 offen lds
s_add_u32 m0, s18, 5120
s_add_u32 s19, s26, 655360
buffer_load_dwordx4 v18, s[40:43], s19 offen lds
s_add_u32 m0, s18, 6144
s_add_u32 s19, s26, 786432
buffer_load_dwordx4 v18, s[40:43], s19 offen lds
s_add_u32 m0, s18, 7168
s_add_u32 s19, s26, 917504
buffer_load_dwordx4 v18, s[40:43], s19 offen lds
s_add_u32 m0, s18, 8192
s_add_u32 s19, s26, 1048576
buffer_load_dwordx4 v18, s[40:43], s19 offen lds
s_add_u32 m0, s18, 9216
s_add_u32 s19, s26, 1179648
buffer_load_dwordx4 v18, s[40:43], s19 offen lds
s_add_u32 m0, s18, 10240
s_add_u32 s19, s26, 1310720
buffer_load_dwordx4 v18, s[40:43], s19 offen lds
s_add_u32 m0, s18, 11264
s_add_u32 s19, s26, 1441792
buffer_load_dwordx4 v18, s[40:43], s19 offen lds
s_add_u32 m0, s18, 12288
s_add_u32 s19, s26, 1572864
buffer_load_dwordx4 v18, s[40:43], s19 offen lds
s_add_u32 m0, s18, 13312
s_add_u32 s19, s26, 1703936
buffer_load_dwordx4 v18, s[40:43], s19 offen lds
s_add_u32 m0, s18, 14336
s_add_u32 s19, s26, 1835008
buffer_load_dwordx4 v18, s[40:43], s19 offen lds
s_add_u32 m0, s18, 15360
s_add_u32 s19, s26, 1966080
buffer_load_dwordx4 v18, s[40:43], s19 offen lds
s_add_u32 m0, s18, 16384
s_add_u32 s19, s26, 2097152
buffer_load_dwordx4 v18, s[40:43], s19 offen lds
s_add_u32 m0, s18, 17408
s_add_u32 s19, s26, 2228224
buffer_load_dwordx4 v18, s[40:43], s19 offen lds
s_add_u32 m0, s18, 18432
s_add_u32 s19, s26, 2359296
buffer_load_dwordx4 v18, s[40:43], s19 offen lds
s_add_u32 m0, s18, 19456
s_add_u32 s19, s26, 2490368
buffer_load_dwordx4 v18, s[40:43], s19 offen lds
s_add_u32 m0, s18, 20480
s_add_u32 s19, s26, 2621440
buffer_load_dwordx4 v18, s[40:43], s19 offen lds
s_add_u32 m0, s18, 21504
s_add_u32 s19, s26, 2752512
buffer_load_dwordx4 v18, s[40:43], s19 offen lds
s_add_u32 m0, s18, 22528
s_add_u32 s19, s26, 2883584
buffer_load_dwordx4 v18, s[40:43], s19 offen lds
s_add_u32 m0, s18, 23552
s_add_u32 s19, s26, 3014656
buffer_load_dwordx4 v18, s[40:43], s19 offen lds
s_add_u32 m0, s18, 24576
s_add_u32 s19, s26, 3145728
buffer_load_dwordx4 v18, s[40:43], s19 offen lds
s_add_u32 m0, s18, 25600
s_add_u32 s19, s26, 3276800
buffer_load_dwordx4 v18, s[40:43], s19 offen lds
s_add_u32 m0, s18, 26624
s_add_u32 s19, s26, 3407872
buffer_load_dwordx4 v18, s[40:43], s19 offen lds
s_add_u32 m0, s18, 27648
s_add_u32 s19, s26, 3538944
buffer_load_dwordx4 v18, s[40:43], s19 offen lds
s_add_u32 m0, s18, 28672
s_add_u32 s19, s26, 3670016
buffer_load_dwordx4 v18, s[40:43], s19 offen lds
s_add_u32 m0, s18, 29696
s_add_u32 s19, s26, 3801088
buffer_load_dwordx4 v18, s[40:43], s19 offen lds
s_add_u32 m0, s18, 30720
s_add_u32 s19, s26, 3932160
buffer_load_dwordx4 v18, s[40:43], s19 offen lds
s_add_u32 m0, s18, 31744
s_add_u32 s19, s26, 4063232
buffer_load_dwordx4 v18, s[40:43], s19 offen lds
s_add_u32 m0, s18, 32768
s_add_u32 s19, s26, 4194304
buffer_load_dwordx4 v18, s[40:43], s19 offen lds
s_add_u32 m0, s18, 33792
s_add_u32 s19, s26, 4325376
buffer_load_dwordx4 v18, s[40:43], s19 offen lds
s_add_u32 m0, s18, 34816
s_add_u32 s19, s26, 4456448
buffer_load_dwordx4 v18, s[40:43], s19 offen lds
s_add_u32 m0, s18, 35840
s_add_u32 s19, s26, 4587520
buffer_load_dwordx4 v18, s[40:43], s19 offen lds
s_waitcnt vmcnt(32)
ds_read_b64_tr_b16 a[0:1], v19 offset:0
ds_read_b64_tr_b16 a[2:3], v19 offset:256
ds_read_b64_tr_b16 a[4:5], v19 offset:1024
ds_read_b64_tr_b16 a[6:7], v19 offset:1280
ds_read_b64_tr_b16 a[8:9], v19 offset:2048
ds_read_b64_tr_b16 a[10:11], v19 offset:2304
ds_read_b64_tr_b16 a[12:13], v19 offset:3072
ds_read_b64_tr_b16 a[14:15], v19 offset:3328
s_waitcnt lgkmcnt(0)
s_add_u32 m0, s18, 0
s_add_u32 s19, s26, 4718592
buffer_load_dwordx4 v18, s[40:43], s19 offen lds
s_add_u32 m0, s18, 1024
s_add_u32 s19, s26, 4849664
buffer_load_dwordx4 v18, s[40:43], s19 offen lds
s_add_u32 m0, s18, 2048
s_add_u32 s19, s26, 4980736
buffer_load_dwordx4 v18, s[40:43], s19 offen lds
s_add_u32 m0, s18, 3072
s_add_u32 s19, s26, 5111808
buffer_load_dwordx4 v18, s[40:43], s19 offen lds
s_waitcnt vmcnt(32)
ds_read_b64_tr_b16 a[16:17], v19 offset:4096
ds_read_b64_tr_b16 a[18:19], v19 offset:4352
ds_read_b64_tr_b16 a[20:21], v19 offset:5120
ds_read_b64_tr_b16 a[22:23], v19 offset:5376
ds_read_b64_tr_b16 a[24:25], v19 offset:6144
ds_read_b64_tr_b16 a[26:27], v19 offset:6400
ds_read_b64_tr_b16 a[28:29], v19 offset:7168
ds_read_b64_tr_b16 a[30:31], v19 offset:7424
s_waitcnt vmcnt(28)
ds_read_b64_tr_b16 a[32:33], v19 offset:8192
ds_read_b64_tr_b16 a[34:35], v19 offset:8448
ds_read_b64_tr_b16 a[36:37], v19 offset:9216
ds_read_b64_tr_b16 a[38:39], v19 offset:9472
ds_read_b64_tr_b16 a[40:41], v19 offset:10240
ds_read_b64_tr_b16 a[42:43], v19 offset:10496
ds_read_b64_tr_b16 a[44:45], v19 offset:11264
ds_read_b64_tr_b16 a[46:47], v19 offset:11520
s_waitcnt vmcnt(24)
ds_read_b64_tr_b16 a[48:49], v19 offset:12288
ds_read_b64_tr_b16 a[50:51], v19 offset:12544
ds_read_b64_tr_b16 a[52:53], v19 offset:13312
ds_read_b64_tr_b16 a[54:55], v19 offset:13568
ds_read_b64_tr_b16 a[56:57], v19 offset:14336
ds_read_b64_tr_b16 a[58:59], v19 offset:14592
ds_read_b64_tr_b16 a[60:61], v19 offset:15360
ds_read_b64_tr_b16 a[62:63], v19 offset:15616
s_waitcnt vmcnt(20)
ds_read_b64_tr_b16 a[64:65], v19 offset:16384
ds_read_b64_tr_b16 a[66:67], v19 offset:16640
ds_read_b64_tr_b16 a[68:69], v19 offset:17408
ds_read_b64_tr_b16 a[70:71], v19 offset:17664
ds_read_b64_tr_b16 a[72:73], v19 offset:18432
ds_read_b64_tr_b16 a[74:75], v19 offset:18688
ds_read_b64_tr_b16 a[76:77], v19 offset:19456
ds_read_b64_tr_b16 a[78:79], v19 offset:19712
s_waitcnt vmcnt(16)
ds_read_b64_tr_b16 a[80:81], v19 offset:20480
ds_read_b64_tr_b16 a[82:83], v19 offset:20736
ds_read_b64_tr_b16 a[84:85], v19 offset:21504
ds_read_b64_tr_b16 a[86:87], v19 offset:21760
ds_read_b64_tr_b16 a[88:89], v19 offset:22528
ds_read_b64_tr_b16 a[90:91], v19 offset:22784
ds_read_b64_tr_b16 a[92:93], v19 offset:23552
ds_read_b64_tr_b16 a[94:95], v19 offset:23808
s_waitcnt vmcnt(12)
ds_read_b64_tr_b16 a[96:97], v19 offset:24576
ds_read_b64_tr_b16 a[98:99], v19 offset:24832
ds_read_b64_tr_b16 a[100:101], v19 offset:25600
ds_read_b64_tr_b16 a[102:103], v19 offset:25856
ds_read_b64_tr_b16 a[104:105], v19 offset:26624
ds_read_b64_tr_b16 a[106:107], v19 offset:26880
ds_read_b64_tr_b16 a[108:109], v19 offset:27648
ds_read_b64_tr_b16 a[110:111], v19 offset:27904
s_waitcnt vmcnt(8)
ds_read_b64_tr_b16 a[112:113], v19 offset:28672
ds_read_b64_tr_b16 a[114:115], v19 offset:28928
ds_read_b64_tr_b16 a[116:117], v19 offset:29696
ds_read_b64_tr_b16 a[118:119], v19 offset:29952
ds_read_b64_tr_b16 a[120:121], v19 offset:30720
ds_read_b64_tr_b16 a[122:123], v19 offset:30976
ds_read_b64_tr_b16 a[124:125], v19 offset:31744
ds_read_b64_tr_b16 a[126:127], v19 offset:32000
s_waitcnt vmcnt(4)
ds_read_b64_tr_b16 a[128:129], v19 offset:32768
ds_read_b64_tr_b16 a[130:131], v19 offset:33024
ds_read_b64_tr_b16 a[132:133], v19 offset:33792
ds_read_b64_tr_b16 a[134:135], v19 offset:34048
ds_read_b64_tr_b16 a[136:137], v19 offset:34816
ds_read_b64_tr_b16 a[138:139], v19 offset:35072
ds_read_b64_tr_b16 a[140:141], v19 offset:35840
ds_read_b64_tr_b16 a[142:143], v19 offset:36096
s_waitcnt vmcnt(0)
ds_read_b64_tr_b16 a[144:145], v19 offset:0
ds_read_b64_tr_b16 a[146:147], v19 offset:256
ds_read_b64_tr_b16 a[148:149], v19 offset:1024
ds_read_b64_tr_b16 a[150:151], v19 offset:1280
ds_read_b64_tr_b16 a[152:153], v19 offset:2048
ds_read_b64_tr_b16 a[154:155], v19 offset:2304
ds_read_b64_tr_b16 a[156:157], v19 offset:3072
ds_read_b64_tr_b16 a[158:159], v19 offset:3328
s_waitcnt lgkmcnt(0)
s_barrier
s_load_dwordx2 s[40:41], s[0:1], 64
s_mov_b32 s42, 5242880
s_mov_b32 s43, 0x20000
s_waitcnt lgkmcnt(0)
v_lshlrev_b32 v6, 3, v0
s_mul_i32 s18, s32, 163840
s_mul_i32 s19, s13, 40960
s_add_u32 s18, s18, s19
buffer_load_dword v12, v6, s[40:43], s18 offen
s_add_u32 s18, s18, 8192
buffer_load_dword v13, v6, s[40:43], s18 offen
s_add_u32 s18, s18, 8192
buffer_load_dword v14, v6, s[40:43], s18 offen
s_add_u32 s18, s18, 8192
buffer_load_dword v15, v6, s[40:43], s18 offen
s_add_u32 s18, s18, 8192
buffer_load_dword v16, v6, s[40:43], s18 offen
s_add_u32 s18, s18, 8192
v_mov_b32 v20, s24
v_mov_b32 v21, s24
v_mov_b32 v22, s24
v_mov_b32 v23, s24
s_nop 1
v_mfma_f32_32x32x16_bf16 v[24:39], v[20:23], a[0:3], 0
v_mfma_f32_32x32x16_bf16 v[24:39], v[20:23], a[4:7], v[24:39]
v_mfma_f32_32x32x16_bf16 v[24:39], v[20:23], a[8:11], v[24:39]
v_mfma_f32_32x32x16_bf16 v[24:39], v[20:23], a[12:15], v[24:39]
v_mfma_f32_32x32x16_bf16 v[24:39], v[20:23], a[16:19], v[24:39]
v_mfma_f32_32x32x16_bf16 v[24:39], v[20:23], a[20:23], v[24:39]
v_mfma_f32_32x32x16_bf16 v[24:39], v[20:23], a[24:27], v[24:39]
v_mfma_f32_32x32x16_bf16 v[24:39], v[20:23], a[28:31], v[24:39]
v_mfma_f32_32x32x16_bf16 v[24:39], v[20:23], a[32:35], v[24:39]
v_mfma_f32_32x32x16_bf16 v[24:39], v[20:23], a[36:39], v[24:39]
v_mfma_f32_32x32x16_bf16 v[24:39], v[20:23], a[40:43], v[24:39]
v_mfma_f32_32x32x16_bf16 v[24:39], v[20:23], a[44:47], v[24:39]
v_mfma_f32_32x32x16_bf16 v[24:39], v[20:23], a[48:51], v[24:39]
v_mfma_f32_32x32x16_bf16 v[24:39], v[20:23], a[52:55], v[24:39]
v_mfma_f32_32x32x16_bf16 v[24:39], v[20:23], a[56:59], v[24:39]
v_mfma_f32_32x32x16_bf16 v[24:39], v[20:23], a[60:63], v[24:39]
v_mfma_f32_32x32x16_bf16 v[24:39], v[20:23], a[64:67], v[24:39]
v_mfma_f32_32x32x16_bf16 v[24:39], v[20:23], a[68:71], v[24:39]
v_mfma_f32_32x32x16_bf16 v[24:39], v[20:23], a[72:75], v[24:39]
v_mfma_f32_32x32x16_bf16 v[24:39], v[20:23], a[76:79], v[24:39]
v_mfma_f32_32x32x16_bf16 v[24:39], v[20:23], a[80:83], v[24:39]
v_mfma_f32_32x32x16_bf16 v[24:39], v[20:23], a[84:87], v[24:39]
v_mfma_f32_32x32x16_bf16 v[24:39], v[20:23], a[88:91], v[24:39]
v_mfma_f32_32x32x16_bf16 v[24:39], v[20:23], a[92:95], v[24:39]
v_mfma_f32_32x32x16_bf16 v[24:39], v[20:23], a[96:99], v[24:39]
v_mfma_f32_32x32x16_bf16 v[24:39], v[20:23], a[100:103], v[24:39]
v_mfma_f32_32x32x16_bf16 v[24:39], v[20:23], a[104:107], v[24:39]
v_mfma_f32_32x32x16_bf16 v[24:39], v[20:23], a[108:111], v[24:39]
v_mfma_f32_32x32x16_bf16 v[24:39], v[20:23], a[112:115], v[24:39]
v_mfma_f32_32x32x16_bf16 v[24:39], v[20:23], a[116:119], v[24:39]
v_mfma_f32_32x32x16_bf16 v[24:39], v[20:23], a[120:123], v[24:39]
v_mfma_f32_32x32x16_bf16 v[24:39], v[20:23], a[124:127], v[24:39]
v_mfma_f32_32x32x16_bf16 v[24:39], v[20:23], a[128:131], v[24:39]
v_mfma_f32_32x32x16_bf16 v[24:39], v[20:23], a[132:135], v[24:39]
v_mfma_f32_32x32x16_bf16 v[24:39], v[20:23], a[136:139], v[24:39]
v_mfma_f32_32x32x16_bf16 v[24:39], v[20:23], a[140:143], v[24:39]
v_mfma_f32_32x32x16_bf16 v[24:39], v[20:23], a[144:147], v[24:39]
v_mfma_f32_32x32x16_bf16 v[24:39], v[20:23], a[148:151], v[24:39]
v_mfma_f32_32x32x16_bf16 v[24:39], v[20:23], a[152:155], v[24:39]
v_mfma_f32_32x32x16_bf16 v[24:39], v[20:23], a[156:159], v[24:39]
s_nop 11
v_mov_b32 v5, v24
v_and_b32 v6, 0xf0, v0
s_waitcnt vmcnt(4)
v_bfe_u32 v12, v0, 8, 1
v_lshl_add_u32 v6, v12, 10, v6
v_lshrrev_b32 v12, 9, v0
v_lshl_add_u32 v6, v12, 8, v6
s_lshl_b32 s34, s13, 12
s_add_u32 s34, s34, 2048
s_lshl_b32 s18, s32, 14
s_add_u32 s34, s34, s18
v_bfe_u32 v7, v0, 7, 2
v_mul_u32_u24 v7, 10240, v7
v_bfe_u32 v12, v0, 5, 2
v_lshl_add_u32 v7, v12, 6, v7
v_lshrrev_b32 v12, 9, v0
v_lshl_add_u32 v7, v12, 5, v7
v_and_b32 v12, 16, v0
v_add_u32 v7, v12, v7
s_lshl_b32 s51, s32, 7
s_add_u32 s51, s51, 4
s_mul_i32 s52, s13, 2560
s_add_u32 s52, s52, 12582912
s_add_u32 s50, s34, 110100480
s_mov_b32 s39, 0
kvlay_23:
s_mul_i32 s26, s16, 6291456
s_add_u32 s26, s26, 88080384
s_add_u32 s26, s26, s31
s_mul_i32 s54, s16, 327680
s_add_u32 s54, s54, 163577856
s_mul_i32 s27, s16, 34603008
s_add_u32 s27, s27, 16777216
s_add_u32 s27, s27, s34
s_lshl_b32 s29, s16, 1
s_add_u32 s29, s29, 1
s_mov_b32 s28, 0
s_mov_b32 s30, 0
s_cmp_lt_u32 s30, 64
s_cselect_b32 s53, s26, s6
s_cselect_b32 s36, s54, s6
s_mov_b32 s38, 1024
v_mov_b32 v8, v0
s_add_u32 s26, s26, 40960
s_add_u32 s54, s54, 5120
s_add_u32 s30, s30, 1
v_xor_b32 v1, 40960, v0
s_mov_b32 s25, s31
s_mov_b32 s35, 131072
s_cmp_lg_u32 s13, 0
s_cbranch_scc1 polld_32
s_waitcnt vmcnt(0)
v_lshrrev_b32 v16, 2, v0
v_min_u32 v16, 36, v16
s_mov_b32 s21, 8192
s_mov_b32 s17, 0
poll_31:
buffer_load_dword v12, v16, s[4:7], s21 offen offset:0 sc1
s_add_u32 s17, s17, 1
s_cmp_gt_u32 s17, 262144
s_cbranch_scc1 L_fail
s_waitcnt vmcnt(0)
v_cmp_gt_u32 vcc, s29, v12
s_cbranch_vccz polld_32
s_sleep 2
s_branch poll_31
polld_32:
s_barrier
s_add_u32 m0, s25, 2048
s_mov_b32 s20, s53
buffer_load_dwordx4 v8, s[4:7], s20 offen sc1 lds
s_add_u32 m0, s25, 3072
s_add_u32 s20, s20, s38
buffer_load_dwordx4 v8, s[4:7], s20 offen sc1 lds
s_add_u32 m0, s25, 4096
s_add_u32 s20, s20, s38
buffer_load_dwordx4 v8, s[4:7], s20 offen sc1 lds
s_add_u32 m0, s25, 5120
s_add_u32 s20, s20, s38
buffer_load_dwordx4 v8, s[4:7], s20 offen sc1 lds
s_add_u32 m0, s25, 6144
s_add_u32 s20, s20, s38
buffer_load_dwordx4 v8, s[4:7], s20 offen sc1 lds
s_add_u32 m0, s25, 7168
s_add_u32 s20, s20, s38
buffer_load_dwordx4 v8, s[4:7], s20 offen sc1 lds
s_add_u32 m0, s25, 8192
s_add_u32 s20, s20, s38
buffer_load_dwordx4 v8, s[4:7], s20 offen sc1 lds
s_add_u32 m0, s25, 9216
s_add_u32 s20, s20, s38
buffer_load_dwordx4 v8, s[4:7], s20 offen sc1 lds
s_add_u32 m0, s25, 10240
s_add_u32 s20, s20, s38
buffer_load_dwordx4 v8, s[4:7], s20 offen sc1 lds
s_add_u32 m0, s25, 11264
s_add_u32 s20, s20, s38
buffer_load_dwordx4 v8, s[4:7], s20 offen sc1 lds
s_add_u32 m0, s35, s37
s_add_u32 s20, s36, s37
buffer_load_dwordx4 v0, s[4:7], s20 offen sc1 lds
s_add_u32 m0, s35, 4096
s_add_u32 s20, s36, 4096
buffer_load_dwordx4 v0, s[4:7], s20 offen sc1 lds
s_waitcnt vmcnt(0)
kvx_24:
v_xor_b32 v1, 40960, v1
s_sub_u32 s25, s25, s31
s_xor_b32 s25, s25, 40960
s_add_u32 s25, s25, s31
s_xor_b32 s35, s35, 8192
s_cmp_eq_u32 s28, 1
s_cbranch_scc1 kv_26
s_cmp_eq_u32 s28, 30
s_cbranch_scc0 kv_27
s_add_u32 s29, s29, 1
kv_26:
s_waitcnt vmcnt(0)
s_barrier
v_mov_b32 v3, s23
s_mov_b64 exec, 1
buffer_store_dword v3, off, s[4:7], s22 sc1
s_mov_b64 exec, -1
s_mov_b32 s22, s6
s_cmp_lg_u32 s13, 0
s_cbranch_scc1 polld_34
v_min_u32 v16, 624, v0
s_mov_b32 s21, 8192
s_mov_b32 s17, 0
poll_33:
buffer_load_dwordx4 v[12:15], v16, s[4:7], s21 offen offset:0 sc1
s_add_u32 s17, s17, 1
s_cmp_gt_u32 s17, 262144
s_cbranch_scc1 L_fail
s_waitcnt vmcnt(0)
v_min3_u32 v12, v12, v13, v14
v_min_u32 v12, v12, v15
v_cmp_gt_u32 vcc, s29, v12
s_cbranch_vccz polld_34
s_sleep 2
s_branch poll_33
polld_34:
s_barrier
kv_27:
s_add_u32 s28, s28, 1
s_and_b32 s33, s28, 3
s_cmp_lt_u32 s28, 12
s_cselect_b32 s33, 1, s33
s_cmp_eq_u32 s33, 0
s_cbranch_scc1 kv_28
s_cmp_lt_u32 s30, 64
s_cselect_b32 s53, s26, s6
s_cselect_b32 s36, s54, s6
s_mov_b32 s38, 1024
v_mov_b32 v8, v0
s_add_u32 s26, s26, 40960
s_add_u32 s54, s54, 5120
s_add_u32 s30, s30, 1
kvn_25:
s_waitcnt vmcnt(3)
s_barrier
ds_read_b128 v[36:39], v1 offset:2048
s_add_u32 m0, s25, 2048
s_mov_b32 s20, s53
buffer_load_dwordx4 v8, s[4:7], s20 offen sc1 lds
ds_read_b128 v[40:43], v1 offset:3072
s_xor_b32 s18, s35, 8192
v_lshrrev_b32 v2, 2, v0
v_add_u32 v2, s18, v2
ds_read_b128 v[48:51], v1 offset:5120
s_add_u32 m0, s25, 3072
s_add_u32 s20, s20, s38
buffer_load_dwordx4 v8, s[4:7], s20 offen sc1 lds
ds_read_b128 v[44:47], v1 offset:4096
s_waitcnt lgkmcnt(3)
v_mfma_f32_32x32x16_bf16 v[20:35], v[36:39], a[0:3], 0
ds_read2st64_b32 v[62:63], v2 offset0:6 offset1:7
s_waitcnt lgkmcnt(3)
ds_read2st64_b32 v[72:73], v2 offset0:16 offset1:17
ds_read2st64_b32 v[74:75], v2 offset0:18 offset1:19
ds_read_b128 v[36:39], v1 offset:6144
v_mfma_f32_32x32x16_bf16 v[20:35], v[40:43], a[4:7], v[20:35]
s_add_u32 m0, s25, 4096
s_add_u32 s20, s20, s38
buffer_load_dwordx4 v8, s[4:7], s20 offen sc1 lds
ds_read2st64_b32 v[54:55], v2 offset0:2 offset1:3
s_waitcnt lgkmcnt(5)
ds_read2st64_b32 v[52:53], v2 offset0:0 offset1:1
v_mfma_f32_32x32x16_bf16 v[20:35], v[44:47], a[8:11], v[20:35]
ds_read_b128 v[40:43], v1 offset:7168
ds_read2st64_b32 v[60:61], v2 offset0:4 offset1:5
ds_read2st64_b32 v[66:67], v2 offset0:10 offset1:11
s_add_u32 m0, s25, 5120
s_add_u32 s20, s20, s38
buffer_load_dwordx4 v8, s[4:7], s20 offen sc1 lds
v_mfma_f32_32x32x16_bf16 v[20:35], v[48:51], a[12:15], v[20:35]
ds_read_b128 v[48:51], v1 offset:9216
s_waitcnt lgkmcnt(6)
ds_read_b128 v[44:47], v1 offset:8192
s_waitcnt lgkmcnt(5)
ds_read2st64_b32 v[70:71], v2 offset0:14 offset1:15
v_mfma_f32_32x32x16_bf16 v[20:35], v[36:39], a[16:19], v[20:35]
s_add_u32 m0, s25, 6144
s_add_u32 s20, s20, s38
buffer_load_dwordx4 v8, s[4:7], s20 offen sc1 lds
s_waitcnt lgkmcnt(3)
ds_read2st64_b32 v[68:69], v2 offset0:12 offset1:13
v_mfma_f32_32x32x16_bf16 v[20:35], v[40:43], a[20:23], v[20:35]
s_waitcnt lgkmcnt(3)
ds_read_b128 v[36:39], v1 offset:10240
s_waitcnt lgkmcnt(3)
ds_read_b128 v[40:43], v1 offset:11264
v_mfma_f32_32x32x16_bf16 v[20:35], v[44:47], a[24:27], v[20:35]
ds_read_b128 v[44:47], v1 offset:12288
v_add_f32 v52, v52, v54
ds_read2st64_b32 v[64:65], v2 offset0:8 offset1:9
v_mfma_f32_32x32x16_bf16 v[20:35], v[48:51], a[28:31], v[20:35]
s_add_u32 m0, s25, 7168
s_add_u32 s20, s20, s38
buffer_load_dwordx4 v8, s[4:7], s20 offen sc1 lds
v_add_f32 v53, v53, v55
v_add_f32 v52, v52, v60
s_waitcnt lgkmcnt(3)
v_mfma_f32_32x32x16_bf16 v[20:35], v[36:39], a[32:35], v[20:35]
ds_read_b128 v[48:51], v1 offset:13312
s_waitcnt lgkmcnt(3)
s_waitcnt lgkmcnt(2)
ds_read_b128 v[36:39], v1 offset:14336
v_mfma_f32_32x32x16_bf16 v[20:35], v[40:43], a[36:39], v[20:35]
ds_read_b128 v[40:43], v1 offset:15360
s_add_u32 m0, s25, 8192
s_add_u32 s20, s20, s38
buffer_load_dwordx4 v8, s[4:7], s20 offen sc1 lds
v_mfma_f32_32x32x16_bf16 v[20:35], v[44:47], a[40:43], v[20:35]
s_add_u32 m0, s25, 9216
s_add_u32 s20, s20, s38
buffer_load_dwordx4 v8, s[4:7], s20 offen sc1 lds
v_mov_b32 v3, s23
v_add_f32 v53, v53, v61
s_waitcnt lgkmcnt(1)
v_add_f32 v53, v53, v63
v_mfma_f32_32x32x16_bf16 v[20:35], v[48:51], a[44:47], v[20:35]
v_add_f32 v52, v52, v62
v_add_f32 v52, v52, v64
ds_read_b128 v[44:47], v1 offset:16384
v_add_f32 v53, v53, v65
v_mfma_f32_32x32x16_bf16 v[20:35], v[36:39], a[48:51], v[20:35]
s_waitcnt lgkmcnt(1)
ds_read_b128 v[48:51], v1 offset:17408
ds_read_b128 v[36:39], v1 offset:18432
v_bfe_u32 v54, v0, 5, 5
v_add_f32 v53, v53, v67
v_and_b32 v54, 16, v54
v_add_f32 v53, v53, v69
v_mfma_f32_32x32x16_bf16 v[20:35], v[40:43], a[52:55], v[20:35]
v_add_f32 v52, v52, v66
ds_read_b128 v[40:43], v1 offset:19456
s_waitcnt lgkmcnt(3)
v_mfma_f32_32x32x16_bf16 v[20:35], v[44:47], a[56:59], v[20:35]
s_waitcnt lgkmcnt(2)
v_add_f32 v52, v52, v68
s_add_u32 m0, s25, 10240
s_add_u32 s20, s20, s38
buffer_load_dwordx4 v8, s[4:7], s20 offen sc1 lds
v_mfma_f32_32x32x16_bf16 v[20:35], v[48:51], a[60:63], v[20:35]
ds_read_b128 v[44:47], v1 offset:20480
v_add_f32 v53, v53, v71
s_waitcnt lgkmcnt(2)
v_add_f32 v52, v52, v70
v_add_f32 v52, v52, v72
v_add_f32 v53, v53, v73
v_mfma_f32_32x32x16_bf16 v[20:35], v[36:39], a[64:67], v[20:35]
ds_read_b128 v[48:51], v1 offset:21504
v_add_f32 v52, v52, v74
s_waitcnt lgkmcnt(2)
v_mfma_f32_32x32x16_bf16 v[20:35], v[40:43], a[68:71], v[20:35]
ds_read_b128 v[40:43], v1 offset:23552
ds_read_b128 v[36:39], v1 offset:22528
v_add_f32 v53, v53, v75
s_waitcnt lgkmcnt(3)
v_add_f32 v52, v52, v53
v_mfma_f32_32x32x16_bf16 v[20:35], v[44:47], a[72:75], v[20:35]
v_mov_b32 v56, v52
s_nop 1
v_permlane32_swap_b32 v52, v56
s_waitcnt lgkmcnt(2)
v_mfma_f32_32x32x16_bf16 v[20:35], v[48:51], a[76:79], v[20:35]
ds_read_b128 v[44:47], v1 offset:24576
s_waitcnt lgkmcnt(1)
ds_read_b128 v[48:51], v1 offset:25600
v_mfma_f32_32x32x16_bf16 v[20:35], v[36:39], a[80:83], v[20:35]
ds_read_b128 v[36:39], v1 offset:26624
v_mul_f32 v52, 0x3acccccd, v52
v_lshrrev_b32 v53, 2, v0
v_mul_f32 v56, 0x3acccccd, v56
s_add_u32 m0, s25, 11264
s_add_u32 s20, s20, s38
buffer_load_dwordx4 v8, s[4:7], s20 offen sc1 lds
v_mfma_f32_32x32x16_bf16 v[20:35], v[40:43], a[84:87], v[20:35]
s_waitcnt lgkmcnt(2)
ds_read_b128 v[40:43], v1 offset:27648
v_fma_f32 v56, -v52, v52, v56
v_max_f32 v56, 0, v56
s_waitcnt lgkmcnt(2)
v_lshl_add_u32 v53, s13, 8, v53
v_add_f32 v56, 0x3727c5ac, v56
v_mfma_f32_32x32x16_bf16 v[20:35], v[44:47], a[88:91], v[20:35]
ds_read_b128 v[44:47], v1 offset:28672
s_add_u32 m0, s35, s37
s_add_u32 s20, s36, s37
buffer_load_dwordx4 v0, s[4:7], s20 offen sc1 lds
v_mfma_f32_32x32x16_bf16 v[20:35], v[48:51], a[92:95], v[20:35]
s_waitcnt lgkmcnt(2)
v_rsq_f32 v56, v56
ds_read_b128 v[48:51], v1 offset:29696
v_mul_f32 v52, v56, v52
v_mfma_f32_32x32x16_bf16 v[20:35], v[36:39], a[96:99], v[20:35]
ds_read_b128 v[36:39], v1 offset:30720
s_waitcnt lgkmcnt(3)
s_add_u32 m0, s35, 4096
s_add_u32 s20, s36, 4096
buffer_load_dwordx4 v0, s[4:7], s20 offen sc1 lds
v_mfma_f32_32x32x16_bf16 v[20:35], v[40:43], a[100:103], v[20:35]
ds_read_b128 v[40:43], v1 offset:31744
s_waitcnt lgkmcnt(3)
v_permlane32_swap_b32 v56, v52
v_lshl_add_u32 v54, s13, 8, v54
v_mfma_f32_32x32x16_bf16 v[20:35], v[44:47], a[104:107], v[20:35]
s_waitcnt lgkmcnt(1)
ds_read_b128 v[44:47], v1 offset:32768
ds_write_b32 v53, v56 offset:1024
ds_read_b128 v[80:83], v54 offset:1184
ds_read_b128 v[76:79], v54 offset:1152
v_mfma_f32_32x32x16_bf16 v[20:35], v[48:51], a[108:111], v[20:35]
v_mfma_f32_32x32x16_bf16 v[20:35], v[36:39], a[112:115], v[20:35]
s_waitcnt lgkmcnt(4)
ds_read_b128 v[48:51], v1 offset:33792
ds_read_b128 v[88:91], v54 offset:1248
ds_read_b128 v[36:39], v1 offset:34816
s_waitcnt lgkmcnt(6)
ds_read_b128 v[84:87], v54 offset:1216
v_mfma_f32_32x32x16_bf16 v[20:35], v[40:43], a[116:119], v[20:35]
s_waitcnt vmcnt(12)
s_barrier
s_mov_b64 exec, 1
buffer_store_dword v3, off, s[4:7], s22 sc1
s_mov_b64 exec, -1
v_mfma_f32_32x32x16_bf16 v[20:35], v[44:47], a[120:123], v[20:35]
ds_read_b128 v[40:43], v1 offset:35840
s_waitcnt lgkmcnt(4)
ds_read_b128 v[44:47], v1 offset:36864
v_mfma_f32_32x32x16_bf16 v[20:35], v[48:51], a[124:127], v[20:35]
ds_read_b128 v[48:51], v1 offset:37888
ds_read_b128 v[72:75], v54 offset:1120
s_waitcnt lgkmcnt(4)
v_mul_f32 v79, v79, v5
v_mul_f32 v86, v86, v5
v_mfma_f32_32x32x16_bf16 v[20:35], v[36:39], a[128:131], v[20:35]
s_waitcnt lgkmcnt(3)
v_mfma_f32_32x32x16_bf16 v[20:35], v[40:43], a[132:135], v[20:35]
v_mul_f32 v89, v89, v5
v_mul_f32 v90, v90, v5
s_waitcnt lgkmcnt(2)
s_waitcnt lgkmcnt(1)
ds_read_b128 v[36:39], v1 offset:38912
ds_read_b128 v[60:63], v54 offset:1024
v_mfma_f32_32x32x16_bf16 v[20:35], v[44:47], a[136:139], v[20:35]
ds_read_b128 v[40:43], v1 offset:39936
ds_read_b128 v[44:47], v1 offset:40960
ds_read_b128 v[64:67], v54 offset:1056
v_mul_f32 v87, v87, v5
v_mfma_f32_32x32x16_bf16 v[20:35], v[48:51], a[140:143], v[20:35]
ds_read_b128 v[48:51], v1 offset:41984
ds_read_b128 v[68:71], v54 offset:1088
s_waitcnt lgkmcnt(6)
v_mfma_f32_32x32x16_bf16 v[20:35], v[36:39], a[144:147], v[20:35]
s_waitcnt lgkmcnt(4)
v_mul_f32 v78, v78, v5
v_mfma_f32_32x32x16_bf16 v[20:35], v[40:43], a[148:151], v[20:35]
v_mul_f32 v76, v76, v5
v_mul_f32 v85, v85, v5
v_mul_f32 v91, v91, v5
v_mul_f32 v77, v77, v5
s_waitcnt lgkmcnt(3)
v_mul_f32 v84, v84, v5
v_mfma_f32_32x32x16_bf16 v[20:35], v[44:47], a[152:155], v[20:35]
s_waitcnt lgkmcnt(1)
v_mul_f32 v88, v88, v5
v_mul_f32 v80, v80, v5
v_mfma_f32_32x32x16_bf16 v[20:35], v[48:51], a[156:159], v[20:35]
s_waitcnt lgkmcnt(0)
v_mul_f32 v83, v83, v5
v_mul_f32 v82, v82, v5
v_mul_f32 v81, v81, v5
s_nop 7
v_pk_fma_f32 v[26:27], v[26:27], v[66:67], v[82:83] neg_lo:[0,0,1] neg_hi:[0,0,1]
v_pk_fma_f32 v[24:25], v[24:25], v[64:65], v[80:81] neg_lo:[0,0,1] neg_hi:[0,0,1]
v_pk_fma_f32 v[34:35], v[34:35], v[74:75], v[90:91] neg_lo:[0,0,1] neg_hi:[0,0,1]
v_pk_fma_f32 v[22:23], v[22:23], v[62:63], v[78:79] neg_lo:[0,0,1] neg_hi:[0,0,1]
v_cvt_pk_bf16_f32 v37, v22, v23
v_pk_fma_f32 v[30:31], v[30:31], v[70:71], v[86:87] neg_lo:[0,0,1] neg_hi:[0,0,1]
v_cvt_pk_bf16_f32 v39, v26, v27
v_pk_fma_f32 v[32:33], v[32:33], v[72:73], v[88:89] neg_lo:[0,0,1] neg_hi:[0,0,1]
v_pk_fma_f32 v[20:21], v[20:21], v[60:61], v[76:77] neg_lo:[0,0,1] neg_hi:[0,0,1]
v_pk_fma_f32 v[28:29], v[28:29], v[68:69], v[84:85] neg_lo:[0,0,1] neg_hi:[0,0,1]
v_cvt_pk_bf16_f32 v38, v24, v25
v_cvt_pk_bf16_f32 v42, v32, v33
v_cvt_pk_bf16_f32 v40, v28, v29
v_cvt_pk_bf16_f32 v41, v30, v31
v_cvt_pk_bf16_f32 v43, v34, v35
v_cvt_pk_bf16_f32 v36, v20, v21
buffer_store_dwordx4 v[36:39], v6, s[4:7], s27 offen offset:0 sc1
buffer_store_dwordx4 v[40:43], v6, s[4:7], s27 offen offset:512 sc1
s_lshl_b32 s18, s16, 6
s_add_u32 s18, s18, s28
s_add_u32 s27, s27, 524288
s_cmp_eq_u32 s13, 0
s_cselect_b32 s22, s51, s6
s_mov_b32 s23, s18
s_cmp_lg_u32 s33, 0
s_cbranch_scc1 kvx_24
kvm_29:
v_xor_b32 v1, 40960, v1
s_sub_u32 s25, s25, s31
s_xor_b32 s25, s25, 40960
s_add_u32 s25, s25, s31
s_xor_b32 s35, s35, 8192
s_cmp_lt_u32 s30, 64
s_cselect_b32 s53, s26, s6
s_cselect_b32 s36, s54, s6
s_mov_b32 s38, 1024
v_mov_b32 v8, v0
s_add_u32 s26, s26, 40960
s_add_u32 s54, s54, 5120
s_add_u32 s30, s30, 1
s_waitcnt vmcnt(3)
s_barrier
ds_read_b128 v[36:39], v1 offset:2048
s_add_u32 m0, s25, 2048
s_mov_b32 s20, s53
buffer_load_dwordx4 v8, s[4:7], s20 offen sc1 lds
ds_read_b128 v[40:43], v1 offset:3072
ds_read_b128 v[44:47], v1 offset:4096
s_add_u32 m0, s25, 3072
s_add_u32 s20, s20, s38
buffer_load_dwordx4 v8, s[4:7], s20 offen sc1 lds
s_waitcnt lgkmcnt(2)
v_mfma_f32_32x32x16_bf16 v[20:35], v[36:39], a[0:3], 0
ds_read_b128 v[48:51], v1 offset:5120
s_waitcnt lgkmcnt(2)
s_add_u32 m0, s25, 4096
s_add_u32 s20, s20, s38
buffer_load_dwordx4 v8, s[4:7], s20 offen sc1 lds
s_waitcnt lgkmcnt(1)
v_mfma_f32_32x32x16_bf16 v[20:35], v[40:43], a[4:7], v[20:35]
s_add_u32 m0, s25, 5120
s_add_u32 s20, s20, s38
buffer_load_dwordx4 v8, s[4:7], s20 offen sc1 lds
ds_read_b128 v[36:39], v1 offset:6144
ds_read_b128 v[40:43], v1 offset:7168
v_mfma_f32_32x32x16_bf16 v[20:35], v[44:47], a[8:11], v[20:35]
ds_read_b128 v[44:47], v1 offset:8192
s_waitcnt lgkmcnt(3)
v_mfma_f32_32x32x16_bf16 v[20:35], v[48:51], a[12:15], v[20:35]
s_waitcnt lgkmcnt(2)
v_mfma_f32_32x32x16_bf16 v[20:35], v[36:39], a[16:19], v[20:35]
ds_read_b128 v[48:51], v1 offset:9216
ds_read_b128 v[36:39], v1 offset:10240
s_waitcnt lgkmcnt(2)
v_mfma_f32_32x32x16_bf16 v[20:35], v[40:43], a[20:23], v[20:35]
v_mfma_f32_32x32x16_bf16 v[20:35], v[44:47], a[24:27], v[20:35]
ds_read_b128 v[44:47], v1 offset:12288
s_waitcnt lgkmcnt(2)
ds_read_b128 v[40:43], v1 offset:11264
v_mfma_f32_32x32x16_bf16 v[20:35], v[48:51], a[28:31], v[20:35]
s_waitcnt lgkmcnt(2)
s_add_u32 m0, s25, 6144
s_add_u32 s20, s20, s38
buffer_load_dwordx4 v8, s[4:7], s20 offen sc1 lds
ds_read_b128 v[48:51], v1 offset:13312
v_mfma_f32_32x32x16_bf16 v[20:35], v[36:39], a[32:35], v[20:35]
s_waitcnt lgkmcnt(2)
s_add_u32 m0, s25, 7168
s_add_u32 s20, s20, s38
buffer_load_dwordx4 v8, s[4:7], s20 offen sc1 lds
s_waitcnt lgkmcnt(1)
v_mfma_f32_32x32x16_bf16 v[20:35], v[40:43], a[36:39], v[20:35]
ds_read_b128 v[36:39], v1 offset:14336
s_add_u32 m0, s25, 8192
s_add_u32 s20, s20, s38
buffer_load_dwordx4 v8, s[4:7], s20 offen sc1 lds
s_waitcnt lgkmcnt(1)
ds_read_b128 v[40:43], v1 offset:15360
v_mfma_f32_32x32x16_bf16 v[20:35], v[44:47], a[40:43], v[20:35]
ds_read_b128 v[44:47], v1 offset:16384
v_mfma_f32_32x32x16_bf16 v[20:35], v[48:51], a[44:47], v[20:35]
s_waitcnt lgkmcnt(2)
ds_read_b128 v[48:51], v1 offset:17408
v_mfma_f32_32x32x16_bf16 v[20:35], v[36:39], a[48:51], v[20:35]
ds_read_b128 v[36:39], v1 offset:18432
s_waitcnt lgkmcnt(2)
v_mfma_f32_32x32x16_bf16 v[20:35], v[40:43], a[52:55], v[20:35]
ds_read_b128 v[40:43], v1 offset:19456
s_add_u32 m0, s25, 9216
s_add_u32 s20, s20, s38
buffer_load_dwordx4 v8, s[4:7], s20 offen sc1 lds
s_waitcnt lgkmcnt(2)
v_mfma_f32_32x32x16_bf16 v[20:35], v[44:47], a[56:59], v[20:35]
v_mfma_f32_32x32x16_bf16 v[20:35], v[48:51], a[60:63], v[20:35]
ds_read_b128 v[48:51], v1 offset:21504
ds_read_b128 v[44:47], v1 offset:20480
s_waitcnt lgkmcnt(3)
v_mov_b32 v3, s23
v_mfma_f32_32x32x16_bf16 v[20:35], v[36:39], a[64:67], v[20:35]
s_waitcnt lgkmcnt(2)
s_add_u32 m0, s25, 10240
s_add_u32 s20, s20, s38
buffer_load_dwordx4 v8, s[4:7], s20 offen sc1 lds
ds_read_b128 v[36:39], v1 offset:22528
v_mfma_f32_32x32x16_bf16 v[20:35], v[40:43], a[68:71], v[20:35]
ds_read_b128 v[40:43], v1 offset:23552
s_waitcnt lgkmcnt(2)
v_mfma_f32_32x32x16_bf16 v[20:35], v[44:47], a[72:75], v[20:35]
v_mfma_f32_32x32x16_bf16 v[20:35], v[48:51], a[76:79], v[20:35]
s_waitcnt lgkmcnt(0)
ds_read_b128 v[44:47], v1 offset:24576
v_mfma_f32_32x32x16_bf16 v[20:35], v[36:39], a[80:83], v[20:35]
ds_read_b128 v[48:51], v1 offset:25600
s_add_u32 m0, s25, 11264
s_add_u32 s20, s20, s38
buffer_load_dwordx4 v8, s[4:7], s20 offen sc1 lds
v_mfma_f32_32x32x16_bf16 v[20:35], v[40:43], a[84:87], v[20:35]
ds_read_b128 v[36:39], v1 offset:26624
s_waitcnt lgkmcnt(2)
ds_read_b128 v[40:43], v1 offset:27648
v_mfma_f32_32x32x16_bf16 v[20:35], v[44:47], a[88:91], v[20:35]
s_waitcnt lgkmcnt(2)
ds_read_b128 v[44:47], v1 offset:28672
s_add_u32 m0, s35, s37
s_add_u32 s20, s36, s37
buffer_load_dwordx4 v0, s[4:7], s20 offen sc1 lds
v_mfma_f32_32x32x16_bf16 v[20:35], v[48:51], a[92:95], v[20:35]
ds_read_b128 v[48:51], v1 offset:29696
s_waitcnt lgkmcnt(3)
v_mfma_f32_32x32x16_bf16 v[20:35], v[36:39], a[96:99], v[20:35]
s_waitcnt lgkmcnt(1)
ds_read_b128 v[36:39], v1 offset:30720
s_add_u32 m0, s35, 4096
s_add_u32 s20, s36, 4096
buffer_load_dwordx4 v0, s[4:7], s20 offen sc1 lds
v_mfma_f32_32x32x16_bf16 v[20:35], v[40:43], a[100:103], v[20:35]
ds_read_b128 v[40:43], v1 offset:31744
v_mfma_f32_32x32x16_bf16 v[20:35], v[44:47], a[104:107], v[20:35]
s_waitcnt lgkmcnt(2)
s_waitcnt lgkmcnt(1)
v_mfma_f32_32x32x16_bf16 v[20:35], v[48:51], a[108:111], v[20:35]
ds_read_b128 v[44:47], v1 offset:32768
ds_read_b128 v[48:51], v1 offset:33792
v_mfma_f32_32x32x16_bf16 v[20:35], v[36:39], a[112:115], v[20:35]
ds_read_b128 v[36:39], v1 offset:34816
s_waitcnt lgkmcnt(3)
v_mfma_f32_32x32x16_bf16 v[20:35], v[40:43], a[116:119], v[20:35]
s_waitcnt vmcnt(12)
s_barrier
ds_read_b128 v[40:43], v1 offset:35840
s_waitcnt lgkmcnt(3)
v_mfma_f32_32x32x16_bf16 v[20:35], v[44:47], a[120:123], v[20:35]
s_mov_b64 exec, 1
buffer_store_dword v3, off, s[4:7], s22 sc1
s_mov_b64 exec, -1
s_waitcnt lgkmcnt(1)
v_mfma_f32_32x32x16_bf16 v[20:35], v[48:51], a[124:127], v[20:35]
ds_read_b128 v[44:47], v1 offset:36864
s_waitcnt lgkmcnt(1)
ds_read_b128 v[48:51], v1 offset:37888
v_mfma_f32_32x32x16_bf16 v[20:35], v[36:39], a[128:131], v[20:35]
v_mfma_f32_32x32x16_bf16 v[20:35], v[40:43], a[132:135], v[20:35]
s_waitcnt lgkmcnt(1)
ds_read_b128 v[40:43], v1 offset:39936
ds_read_b128 v[36:39], v1 offset:38912
v_mfma_f32_32x32x16_bf16 v[20:35], v[44:47], a[136:139], v[20:35]
s_waitcnt lgkmcnt(2)
v_mfma_f32_32x32x16_bf16 v[20:35], v[48:51], a[140:143], v[20:35]
ds_read_b128 v[44:47], v1 offset:40960
ds_read_b128 v[48:51], v1 offset:41984
s_waitcnt lgkmcnt(2)
v_mfma_f32_32x32x16_bf16 v[20:35], v[36:39], a[144:147], v[20:35]
v_mfma_f32_32x32x16_bf16 v[20:35], v[40:43], a[148:151], v[20:35]
s_waitcnt lgkmcnt(1)
v_mfma_f32_32x32x16_bf16 v[20:35], v[44:47], a[152:155], v[20:35]
s_waitcnt lgkmcnt(0)
v_mfma_f32_32x32x16_bf16 v[20:35], v[48:51], a[156:159], v[20:35]
s_nop 11
v_cvt_pk_bf16_f32 v37, v22, v23
v_cvt_pk_bf16_f32 v36, v20, v21
v_cvt_pk_bf16_f32 v41, v30, v31
v_cvt_pk_bf16_f32 v39, v26, v27
v_cvt_pk_bf16_f32 v42, v32, v33
v_cvt_pk_bf16_f32 v38, v24, v25
v_cvt_pk_bf16_f32 v40, v28, v29
v_cvt_pk_bf16_f32 v43, v34, v35
buffer_store_dwordx4 v[36:39], v6, s[4:7], s50 offen offset:0 sc1
buffer_store_dwordx4 v[40:43], v6, s[4:7], s50 offen offset:512 sc1
s_add_u32 s39, s39, 1
s_add_u32 s50, s50, 524288
s_add_u32 s18, s51, 8
s_cmp_eq_u32 s13, 0
s_cselect_b32 s22, s18, s6
s_mov_b32 s23, s39
s_cmp_lt_u32 s28, 64
s_cbranch_scc1 kvx_24
s_and_b32 s18, s39, 15
s_cbranch_scc0 kvt_30
s_waitcnt vmcnt(0)
s_barrier
v_mov_b32 v3, s23
s_mov_b64 exec, 1
buffer_store_dword v3, off, s[4:7], s22 sc1
s_mov_b64 exec, -1
s_mov_b32 s22, s6
s_lshl_b32 s18, s39, 2
s_add_u32 s18, s18, 4
s_cmp_lg_u32 s13, 0
s_cbranch_scc1 polld_36
v_lshrrev_b32 v16, 2, v0
v_min_u32 v16, 36, v16
s_mov_b32 s21, 4096
s_mov_b32 s17, 0
poll_35:
buffer_load_dword v12, v16, s[4:7], s21 offen offset:0 sc1
s_add_u32 s17, s17, 1
s_cmp_gt_u32 s17, 262144
s_cbranch_scc1 L_fail
s_waitcnt vmcnt(0)
v_cmp_gt_u32 vcc, s18, v12
s_cbranch_vccz polld_36
s_sleep 2
s_branch poll_35
polld_36:
s_barrier
s_mov_b32 s53, s52
s_mov_b32 s36, s6
s_mov_b32 s38, 256
v_mov_b32 v8, v7
s_add_u32 s52, s52, 40960
s_add_u32 m0, s25, 2048
s_mov_b32 s20, s53
buffer_load_dwordx4 v8, s[4:7], s20 offen sc1 lds
s_add_u32 m0, s25, 3072
s_add_u32 s20, s20, s38
buffer_load_dwordx4 v8, s[4:7], s20 offen sc1 lds
s_add_u32 m0, s25, 4096
s_add_u32 s20, s20, s38
buffer_load_dwordx4 v8, s[4:7], s20 offen sc1 lds
s_add_u32 m0, s25, 5120
s_add_u32 s20, s20, s38
buffer_load_dwordx4 v8, s[4:7], s20 offen sc1 lds
s_add_u32 m0, s25, 6144
s_add_u32 s20, s20, s38
buffer_load_dwordx4 v8, s[4:7], s20 offen sc1 lds
s_add_u32 m0, s25, 7168
s_add_u32 s20, s20, s38
buffer_load_dwordx4 v8, s[4:7], s20 offen sc1 lds
s_add_u32 m0, s25, 8192
s_add_u32 s20, s20, s38
buffer_load_dwordx4 v8, s[4:7], s20 offen sc1 lds
s_add_u32 m0, s25, 9216
s_add_u32 s20, s20, s38
buffer_load_dwordx4 v8, s[4:7], s20 offen sc1 lds
s_add_u32 m0, s25, 10240
s_add_u32 s20, s20, s38
buffer_load_dwordx4 v8, s[4:7], s20 offen sc1 lds
s_add_u32 m0, s25, 11264
s_add_u32 s20, s20, s38
buffer_load_dwordx4 v8, s[4:7], s20 offen sc1 lds
s_waitcnt vmcnt(0)
s_branch kvm_29
kv_28:
s_lshl_b32 s18, s39, 2
s_add_u32 s18, s18, 4
s_cmp_lg_u32 s13, 0
s_cbranch_scc1 polld_38
v_lshrrev_b32 v16, 2, v0
v_min_u32 v16, 36, v16
s_mov_b32 s21, 4096
s_mov_b32 s17, 0
poll_37:
buffer_load_dword v12, v16, s[4:7], s21 offen offset:0 sc1
s_add_u32 s17, s17, 1
s_cmp_gt_u32 s17, 262144
s_cbranch_scc1 L_fail
s_waitcnt vmcnt(0)
v_cmp_gt_u32 vcc, s18, v12
s_cbranch_vccz polld_38
s_sleep 2
s_branch poll_37
polld_38:
s_barrier
s_mov_b32 s53, s52
s_mov_b32 s36, s6
s_mov_b32 s38, 256
v_mov_b32 v8, v7
s_add_u32 s52, s52, 40960
s_branch kvn_25
kvt_30:
s_waitcnt vmcnt(0)
s_barrier
v_mov_b32 v3, s23
s_mov_b64 exec, 1
buffer_store_dword v3, off, s[4:7], s22 sc1
s_mov_b64 exec, -1
s_mov_b32 s22, s6
s_add_u32 s16, s16, 1
s_cmp_lt_u32 s16, 2
s_cbranch_scc1 kvlay_23
s_endpgm
roleA_6:
s_sub_u32 s39, s15, 64
s_mul_i32 s50, s39, 13108
s_lshr_b32 s50, s50, 16
s_mul_i32 s18, s50, 5
s_sub_u32 s34, s39, s18
v_bfe_u32 v5, v0, 4, 5
v_mul_u32_u24 v5, 1280, v5
v_lshrrev_b32 v8, 9, v0
v_lshl_add_u32 v5, v8, 4, v5
v_and_b32 v6, 0x1ff, v0
v_lshlrev_b32 v6, 1, v6
v_lshl_add_u32 v6, v8, 4, v6
s_load_dwordx2 s[44:45], s[0:1], 0
s_mov_b32 s46, 2621440
s_mov_b32 s47, 0x20000
s_waitcnt lgkmcnt(0)
s_load_dwordx2 s[40:41], s[0:1], 8
s_mov_b32 s42, 1314816
s_mov_b32 s43, 0x20000
s_waitcnt lgkmcnt(0)
s_load_dwordx2 s[52:53], s[0:1], 16
s_mov_b32 s54, 1314816
s_mov_b32 s55, 0x20000
s_waitcnt lgkmcnt(0)
v_lshrrev_b32 v8, 7, v0
v_lshl_add_u32 v8, s13, 3, v8
v_bfe_u32 v9, v8, 1, 3
v_lshlrev_b32 v9, 4, v9
v_xor_b32 v9, v9, v0
v_and_b32 v9, 0x70, v9
v_mul_u32_u24 v8, 1280, v8
v_add_u32 v8, v8, v9
s_mul_i32 s26, s50, 40960
s_lshl_b32 s25, s13, 10
s_add_u32 m0, s25, 2048
s_add_u32 s20, s26, 0
buffer_load_dwordx4 v8, s[44:47], s20 offen sc1 lds
s_add_u32 m0, s25, 6144
s_add_u32 s20, s26, 128
buffer_load_dwordx4 v8, s[44:47], s20 offen sc1 lds
s_add_u32 m0, s25, 10240
s_add_u32 s20, s26, 256
buffer_load_dwordx4 v8, s[44:47], s20 offen sc1 lds
s_add_u32 m0, s25, 14336
s_add_u32 s20, s26, 384
buffer_load_dwordx4 v8, s[44:47], s20 offen sc1 lds
s_add_u32 m0, s25, 18432
s_add_u32 s20, s26, 512
buffer_load_dwordx4 v8, s[44:47], s20 offen sc1 lds
s_add_u32 m0, s25, 22528
s_add_u32 s20, s26, 640
buffer_load_dwordx4 v8, s[44:47], s20 offen sc1 lds
s_add_u32 m0, s25, 26624
s_add_u32 s20, s26, 768
buffer_load_dwordx4 v8, s[44:47], s20 offen sc1 lds
s_add_u32 m0, s25, 30720
s_add_u32 s20, s26, 896
buffer_load_dwordx4 v8, s[44:47], s20 offen sc1 lds
s_add_u32 m0, s25, 34816
s_add_u32 s20, s26, 1024
buffer_load_dwordx4 v8, s[44:47], s20 offen sc1 lds
s_add_u32 m0, s25, 38912
s_add_u32 s20, s26, 1152
buffer_load_dwordx4 v8, s[44:47], s20 offen sc1 lds
s_add_u32 s26, s26, 1310720
s_add_u32 s25, s25, 40960
v_bfe_u32 v1, v0, 4, 4
v_and_b32 v9, 0x300, v0
v_add_u32 v1, v1, v9
v_lshl_add_u32 v1, s13, 4, v1
v_mul_u32_u24 v1, 642, v1
s_lshl_b32 s30, s39, 2
s_add_u32 s30, s30, 2
s_lshl_b32 s18, s13, 12
s_add_u32 s18, s18, 147456
s_waitcnt vmcnt(10)
v_add_u32 v4, s18, v0
v_bfe_u32 v176, v0, 5, 3
v_lshrrev_b32 v9, 9, v0
v_xor_b32 v176, v176, v9
v_lshlrev_b32 v176, 4, v176
v_and_b32 v9, 0x1f0, v0
v_lshl_add_u32 v176, v9, 3, v176
v_xor_b32 v177, 32, v176
v_xor_b32 v178, 64, v176
v_xor_b32 v179, 96, v176
s_lshl_b32 s18, s34, 7
s_lshl_b32 s19, s13, 5
s_add_u32 s18, s18, s19
s_mov_b32 s19, 0x3acccccd
v_bfe_u32 v202, v0, 4, 5
v_lshrrev_b32 v197, 9, v0
v_add_u32 v202, s18, v202
v_and_b32 v201, 1, v202
v_mul_u32_u24 v201, 160, v201
v_lshrrev_b32 v200, 1, v202
v_add_u32 v200, 1, v200
v_lshlrev_b32 v197, 3, v197
v_mad_u32_u24 v201, v197, v200, v201
v_mad_u32_u24 v196, v200, 16, 0
v_cvt_f32_u32 v196, v196
v_mul_f32 v202, s19, v196
v_rndne_f32 v202, v202
v_fmac_f32 v196, 0xc4200000, v202
v_mul_f32 v196, s19, v196
v_cos_f32 v196, v196
s_nop 0
v_add_f32 v196, v196, v196
v_mad_u32_u24 v198, v200, 1, 0
v_cvt_f32_u32 v198, v198
v_mul_f32 v202, s19, v198
v_rndne_f32 v202, v202
v_fmac_f32 v198, 0xc4200000, v202
v_mul_f32 v198, s19, v198
v_cos_f32 v198, v198
s_nop 0
v_add_f32 v198, v198, v198
v_mad_u32_u24 v183, v200, 3, v201
v_cvt_f32_u32 v183, v183
v_mul_f32 v202, s19, v183
v_rndne_f32 v202, v202
v_fmac_f32 v183, 0xc4200000, v202
v_mul_f32 v183, s19, v183
v_cos_f32 v183, v183
v_mad_u32_u24 v184, v200, 4, v201
v_cvt_f32_u32 v184, v184
v_mul_f32 v202, s19, v184
v_rndne_f32 v202, v202
v_fmac_f32 v184, 0xc4200000, v202
v_mul_f32 v184, s19, v184
v_cos_f32 v184, v184
s_nop 0
v_fma_f32 v185, v198, v184, -v183
v_fma_f32 v182, v198, v183, -v184
v_fma_f32 v186, v198, v185, -v184
v_fma_f32 v181, v198, v182, -v183
v_fma_f32 v187, v198, v186, -v185
v_fma_f32 v180, v198, v181, -v182
v_cvt_pk_bf16_f32 v16, v180, v181
v_cvt_pk_bf16_f32 v17, v182, v183
v_cvt_pk_bf16_f32 v18, v184, v185
v_cvt_pk_bf16_f32 v19, v186, v187
v_mad_u32_u24 v191, v200, 19, v201
v_cvt_f32_u32 v191, v191
v_mul_f32 v202, s19, v191
v_rndne_f32 v202, v202
v_fmac_f32 v191, 0xc4200000, v202
v_mul_f32 v191, s19, v191
v_cos_f32 v191, v191
v_mad_u32_u24 v192, v200, 20, v201
v_cvt_f32_u32 v192, v192
v_mul_f32 v202, s19, v192
v_rndne_f32 v202, v202
v_fmac_f32 v192, 0xc4200000, v202
v_mul_f32 v192, s19, v192
v_cos_f32 v192, v192
s_nop 0
v_fma_f32 v193, v198, v192, -v191
v_fma_f32 v190, v198, v191, -v192
v_fma_f32 v194, v198, v193, -v192
v_fma_f32 v189, v198, v190, -v191
v_fma_f32 v195, v198, v194, -v193
v_fma_f32 v188, v198, v189, -v190
v_cvt_pk_bf16_f32 v20, v188, v189
v_cvt_pk_bf16_f32 v21, v190, v191
v_cvt_pk_bf16_f32 v22, v192, v193
v_cvt_pk_bf16_f32 v23, v194, v195
v_pk_fma_f32 v[180:181], v[196:197], v[188:189], v[180:181] op_sel_hi:[0,1,1] neg_lo:[0,0,1] neg_hi:[0,0,1]
v_pk_fma_f32 v[182:183], v[196:197], v[190:191], v[182:183] op_sel_hi:[0,1,1] neg_lo:[0,0,1] neg_hi:[0,0,1]
v_pk_fma_f32 v[184:185], v[196:197], v[192:193], v[184:185] op_sel_hi:[0,1,1] neg_lo:[0,0,1] neg_hi:[0,0,1]
v_pk_fma_f32 v[186:187], v[196:197], v[194:195], v[186:187] op_sel_hi:[0,1,1] neg_lo:[0,0,1] neg_hi:[0,0,1]
v_cvt_pk_bf16_f32 v24, v180, v181
v_cvt_pk_bf16_f32 v25, v182, v183
v_cvt_pk_bf16_f32 v26, v184, v185
v_cvt_pk_bf16_f32 v27, v186, v187
v_pk_fma_f32 v[188:189], v[196:197], v[180:181], v[188:189] op_sel_hi:[0,1,1] neg_lo:[0,0,1] neg_hi:[0,0,1]
v_pk_fma_f32 v[190:191], v[196:197], v[182:183], v[190:191] op_sel_hi:[0,1,1] neg_lo:[0,0,1] neg_hi:[0,0,1]
v_pk_fma_f32 v[192:193], v[196:197], v[184:185], v[192:193] op_sel_hi:[0,1,1] neg_lo:[0,0,1] neg_hi:[0,0,1]
v_pk_fma_f32 v[194:195], v[196:197], v[186:187], v[194:195] op_sel_hi:[0,1,1] neg_lo:[0,0,1] neg_hi:[0,0,1]
v_cvt_pk_bf16_f32 v28, v188, v189
v_cvt_pk_bf16_f32 v29, v190, v191
v_cvt_pk_bf16_f32 v30, v192, v193
v_cvt_pk_bf16_f32 v31, v194, v195
v_pk_fma_f32 v[180:181], v[196:197], v[188:189], v[180:181] op_sel_hi:[0,1,1] neg_lo:[0,0,1] neg_hi:[0,0,1]
v_pk_fma_f32 v[182:183], v[196:197], v[190:191], v[182:183] op_sel_hi:[0,1,1] neg_lo:[0,0,1] neg_hi:[0,0,1]
v_pk_fma_f32 v[184:185], v[196:197], v[192:193], v[184:185] op_sel_hi:[0,1,1] neg_lo:[0,0,1] neg_hi:[0,0,1]
v_pk_fma_f32 v[186:187], v[196:197], v[194:195], v[186:187] op_sel_hi:[0,1,1] neg_lo:[0,0,1] neg_hi:[0,0,1]
v_cvt_pk_bf16_f32 v32, v180, v181
v_cvt_pk_bf16_f32 v33, v182, v183
v_cvt_pk_bf16_f32 v34, v184, v185
v_cvt_pk_bf16_f32 v35, v186, v187
v_pk_fma_f32 v[188:189], v[196:197], v[180:181], v[188:189] op_sel_hi:[0,1,1] neg_lo:[0,0,1] neg_hi:[0,0,1]
v_pk_fma_f32 v[190:191], v[196:197], v[182:183], v[190:191] op_sel_hi:[0,1,1] neg_lo:[0,0,1] neg_hi:[0,0,1]
v_pk_fma_f32 v[192:193], v[196:197], v[184:185], v[192:193] op_sel_hi:[0,1,1] neg_lo:[0,0,1] neg_hi:[0,0,1]
v_pk_fma_f32 v[194:195], v[196:197], v[186:187], v[194:195] op_sel_hi:[0,1,1] neg_lo:[0,0,1] neg_hi:[0,0,1]
v_cvt_pk_bf16_f32 v36, v188, v189
v_cvt_pk_bf16_f32 v37, v190, v191
v_cvt_pk_bf16_f32 v38, v192, v193
v_cvt_pk_bf16_f32 v39, v194, v195
v_pk_fma_f32 v[180:181], v[196:197], v[188:189], v[180:181] op_sel_hi:[0,1,1] neg_lo:[0,0,1] neg_hi:[0,0,1]
v_pk_fma_f32 v[182:183], v[196:197], v[190:191], v[182:183] op_sel_hi:[0,1,1] neg_lo:[0,0,1] neg_hi:[0,0,1]
v_pk_fma_f32 v[184:185], v[196:197], v[192:193], v[184:185] op_sel_hi:[0,1,1] neg_lo:[0,0,1] neg_hi:[0,0,1]
v_pk_fma_f32 v[186:187], v[196:197], v[194:195], v[186:187] op_sel_hi:[0,1,1] neg_lo:[0,0,1] neg_hi:[0,0,1]
v_cvt_pk_bf16_f32 v40, v180, v181
v_cvt_pk_bf16_f32 v41, v182, v183
v_cvt_pk_bf16_f32 v42, v184, v185
v_cvt_pk_bf16_f32 v43, v186, v187
v_pk_fma_f32 v[188:189], v[196:197], v[180:181], v[188:189] op_sel_hi:[0,1,1] neg_lo:[0,0,1] neg_hi:[0,0,1]
v_pk_fma_f32 v[190:191], v[196:197], v[182:183], v[190:191] op_sel_hi:[0,1,1] neg_lo:[0,0,1] neg_hi:[0,0,1]
v_pk_fma_f32 v[192:193], v[196:197], v[184:185], v[192:193] op_sel_hi:[0,1,1] neg_lo:[0,0,1] neg_hi:[0,0,1]
v_pk_fma_f32 v[194:195], v[196:197], v[186:187], v[194:195] op_sel_hi:[0,1,1] neg_lo:[0,0,1] neg_hi:[0,0,1]
v_cvt_pk_bf16_f32 v44, v188, v189
v_cvt_pk_bf16_f32 v45, v190, v191
v_cvt_pk_bf16_f32 v46, v192, v193
v_cvt_pk_bf16_f32 v47, v194, v195
v_pk_fma_f32 v[180:181], v[196:197], v[188:189], v[180:181] op_sel_hi:[0,1,1] neg_lo:[0,0,1] neg_hi:[0,0,1]
v_pk_fma_f32 v[182:183], v[196:197], v[190:191], v[182:183] op_sel_hi:[0,1,1] neg_lo:[0,0,1] neg_hi:[0,0,1]
v_pk_fma_f32 v[184:185], v[196:197], v[192:193], v[184:185] op_sel_hi:[0,1,1] neg_lo:[0,0,1] neg_hi:[0,0,1]
v_pk_fma_f32 v[186:187], v[196:197], v[194:195], v[186:187] op_sel_hi:[0,1,1] neg_lo:[0,0,1] neg_hi:[0,0,1]
v_cvt_pk_bf16_f32 v48, v180, v181
v_cvt_pk_bf16_f32 v49, v182, v183
v_cvt_pk_bf16_f32 v50, v184, v185
v_cvt_pk_bf16_f32 v51, v186, v187
v_pk_fma_f32 v[188:189], v[196:197], v[180:181], v[188:189] op_sel_hi:[0,1,1] neg_lo:[0,0,1] neg_hi:[0,0,1]
v_pk_fma_f32 v[190:191], v[196:197], v[182:183], v[190:191] op_sel_hi:[0,1,1] neg_lo:[0,0,1] neg_hi:[0,0,1]
v_pk_fma_f32 v[192:193], v[196:197], v[184:185], v[192:193] op_sel_hi:[0,1,1] neg_lo:[0,0,1] neg_hi:[0,0,1]
v_pk_fma_f32 v[194:195], v[196:197], v[186:187], v[194:195] op_sel_hi:[0,1,1] neg_lo:[0,0,1] neg_hi:[0,0,1]
v_cvt_pk_bf16_f32 v52, v188, v189
v_cvt_pk_bf16_f32 v53, v190, v191
v_cvt_pk_bf16_f32 v54, v192, v193
v_cvt_pk_bf16_f32 v55, v194, v195
v_pk_fma_f32 v[180:181], v[196:197], v[188:189], v[180:181] op_sel_hi:[0,1,1] neg_lo:[0,0,1] neg_hi:[0,0,1]
v_pk_fma_f32 v[182:183], v[196:197], v[190:191], v[182:183] op_sel_hi:[0,1,1] neg_lo:[0,0,1] neg_hi:[0,0,1]
v_pk_fma_f32 v[184:185], v[196:197], v[192:193], v[184:185] op_sel_hi:[0,1,1] neg_lo:[0,0,1] neg_hi:[0,0,1]
v_pk_fma_f32 v[186:187], v[196:197], v[194:195], v[186:187] op_sel_hi:[0,1,1] neg_lo:[0,0,1] neg_hi:[0,0,1]
v_cvt_pk_bf16_f32 v56, v180, v181
v_cvt_pk_bf16_f32 v57, v182, v183
v_cvt_pk_bf16_f32 v58, v184, v185
v_cvt_pk_bf16_f32 v59, v186, v187
s_add_u32 m0, s25, 2048
s_add_u32 s21, s26, 0
buffer_load_dwordx4 v8, s[44:47], s21 offen lds
v_pk_fma_f32 v[188:189], v[196:197], v[180:181], v[188:189] op_sel_hi:[0,1,1] neg_lo:[0,0,1] neg_hi:[0,0,1]
v_pk_fma_f32 v[190:191], v[196:197], v[182:183], v[190:191] op_sel_hi:[0,1,1] neg_lo:[0,0,1] neg_hi:[0,0,1]
v_pk_fma_f32 v[192:193], v[196:197], v[184:185], v[192:193] op_sel_hi:[0,1,1] neg_lo:[0,0,1] neg_hi:[0,0,1]
v_pk_fma_f32 v[194:195], v[196:197], v[186:187], v[194:195] op_sel_hi:[0,1,1] neg_lo:[0,0,1] neg_hi:[0,0,1]
v_cvt_pk_bf16_f32 v60, v188, v189
v_cvt_pk_bf16_f32 v61, v190, v191
v_cvt_pk_bf16_f32 v62, v192, v193
v_cvt_pk_bf16_f32 v63, v194, v195
s_add_u32 m0, s25, 6144
s_add_u32 s21, s26, 128
buffer_load_dwordx4 v8, s[44:47], s21 offen lds
v_pk_fma_f32 v[180:181], v[196:197], v[188:189], v[180:181] op_sel_hi:[0,1,1] neg_lo:[0,0,1] neg_hi:[0,0,1]
v_pk_fma_f32 v[182:183], v[196:197], v[190:191], v[182:183] op_sel_hi:[0,1,1] neg_lo:[0,0,1] neg_hi:[0,0,1]
v_pk_fma_f32 v[184:185], v[196:197], v[192:193], v[184:185] op_sel_hi:[0,1,1] neg_lo:[0,0,1] neg_hi:[0,0,1]
v_pk_fma_f32 v[186:187], v[196:197], v[194:195], v[186:187] op_sel_hi:[0,1,1] neg_lo:[0,0,1] neg_hi:[0,0,1]
v_cvt_pk_bf16_f32 v64, v180, v181
v_cvt_pk_bf16_f32 v65, v182, v183
v_cvt_pk_bf16_f32 v66, v184, v185
v_cvt_pk_bf16_f32 v67, v186, v187
s_add_u32 m0, s25, 10240
s_add_u32 s21, s26, 256
buffer_load_dwordx4 v8, s[44:47], s21 offen lds
v_pk_fma_f32 v[188:189], v[196:197], v[180:181], v[188:189] op_sel_hi:[0,1,1] neg_lo:[0,0,1] neg_hi:[0,0,1]
v_pk_fma_f32 v[190:191], v[196:197], v[182:183], v[190:191] op_sel_hi:[0,1,1] neg_lo:[0,0,1] neg_hi:[0,0,1]
v_pk_fma_f32 v[192:193], v[196:197], v[184:185], v[192:193] op_sel_hi:[0,1,1] neg_lo:[0,0,1] neg_hi:[0,0,1]
v_pk_fma_f32 v[194:195], v[196:197], v[186:187], v[194:195] op_sel_hi:[0,1,1] neg_lo:[0,0,1] neg_hi:[0,0,1]
v_cvt_pk_bf16_f32 v68, v188, v189
v_cvt_pk_bf16_f32 v69, v190, v191
v_cvt_pk_bf16_f32 v70, v192, v193
v_cvt_pk_bf16_f32 v71, v194, v195
s_add_u32 m0, s25, 14336
s_add_u32 s21, s26, 384
buffer_load_dwordx4 v8, s[44:47], s21 offen lds
v_pk_fma_f32 v[180:181], v[196:197], v[188:189], v[180:181] op_sel_hi:[0,1,1] neg_lo:[0,0,1] neg_hi:[0,0,1]
v_pk_fma_f32 v[182:183], v[196:197], v[190:191], v[182:183] op_sel_hi:[0,1,1] neg_lo:[0,0,1] neg_hi:[0,0,1]
v_pk_fma_f32 v[184:185], v[196:197], v[192:193], v[184:185] op_sel_hi:[0,1,1] neg_lo:[0,0,1] neg_hi:[0,0,1]
v_pk_fma_f32 v[186:187], v[196:197], v[194:195], v[186:187] op_sel_hi:[0,1,1] neg_lo:[0,0,1] neg_hi:[0,0,1]
v_cvt_pk_bf16_f32 v72, v180, v181
v_cvt_pk_bf16_f32 v73, v182, v183
v_cvt_pk_bf16_f32 v74, v184, v185
v_cvt_pk_bf16_f32 v75, v186, v187
s_add_u32 m0, s25, 18432
s_add_u32 s21, s26, 512
buffer_load_dwordx4 v8, s[44:47], s21 offen lds
v_pk_fma_f32 v[188:189], v[196:197], v[180:181], v[188:189] op_sel_hi:[0,1,1] neg_lo:[0,0,1] neg_hi:[0,0,1]
v_pk_fma_f32 v[190:191], v[196:197], v[182:183], v[190:191] op_sel_hi:[0,1,1] neg_lo:[0,0,1] neg_hi:[0,0,1]
v_pk_fma_f32 v[192:193], v[196:197], v[184:185], v[192:193] op_sel_hi:[0,1,1] neg_lo:[0,0,1] neg_hi:[0,0,1]
v_pk_fma_f32 v[194:195], v[196:197], v[186:187], v[194:195] op_sel_hi:[0,1,1] neg_lo:[0,0,1] neg_hi:[0,0,1]
v_cvt_pk_bf16_f32 v76, v188, v189
v_cvt_pk_bf16_f32 v77, v190, v191
v_cvt_pk_bf16_f32 v78, v192, v193
v_cvt_pk_bf16_f32 v79, v194, v195
s_add_u32 m0, s25, 22528
s_add_u32 s21, s26, 640
buffer_load_dwordx4 v8, s[44:47], s21 offen lds
v_pk_fma_f32 v[180:181], v[196:197], v[188:189], v[180:181] op_sel_hi:[0,1,1] neg_lo:[0,0,1] neg_hi:[0,0,1]
v_pk_fma_f32 v[182:183], v[196:197], v[190:191], v[182:183] op_sel_hi:[0,1,1] neg_lo:[0,0,1] neg_hi:[0,0,1]
v_pk_fma_f32 v[184:185], v[196:197], v[192:193], v[184:185] op_sel_hi:[0,1,1] neg_lo:[0,0,1] neg_hi:[0,0,1]
v_pk_fma_f32 v[186:187], v[196:197], v[194:195], v[186:187] op_sel_hi:[0,1,1] neg_lo:[0,0,1] neg_hi:[0,0,1]
v_cvt_pk_bf16_f32 v80, v180, v181
v_cvt_pk_bf16_f32 v81, v182, v183
v_cvt_pk_bf16_f32 v82, v184, v185
v_cvt_pk_bf16_f32 v83, v186, v187
s_add_u32 m0, s25, 26624
s_add_u32 s21, s26, 768
buffer_load_dwordx4 v8, s[44:47], s21 offen lds
v_pk_fma_f32 v[188:189], v[196:197], v[180:181], v[188:189] op_sel_hi:[0,1,1] neg_lo:[0,0,1] neg_hi:[0,0,1]
v_pk_fma_f32 v[190:191], v[196:197], v[182:183], v[190:191] op_sel_hi:[0,1,1] neg_lo:[0,0,1] neg_hi:[0,0,1]
v_pk_fma_f32 v[192:193], v[196:197], v[184:185], v[192:193] op_sel_hi:[0,1,1] neg_lo:[0,0,1] neg_hi:[0,0,1]
v_pk_fma_f32 v[194:195], v[196:197], v[186:187], v[194:195] op_sel_hi:[0,1,1] neg_lo:[0,0,1] neg_hi:[0,0,1]
v_cvt_pk_bf16_f32 v84, v188, v189
v_cvt_pk_bf16_f32 v85, v190, v191
v_cvt_pk_bf16_f32 v86, v192, v193
v_cvt_pk_bf16_f32 v87, v194, v195
s_add_u32 m0, s25, 30720
s_add_u32 s21, s26, 896
buffer_load_dwordx4 v8, s[44:47], s21 offen lds
v_pk_fma_f32 v[180:181], v[196:197], v[188:189], v[180:181] op_sel_hi:[0,1,1] neg_lo:[0,0,1] neg_hi:[0,0,1]
v_pk_fma_f32 v[182:183], v[196:197], v[190:191], v[182:183] op_sel_hi:[0,1,1] neg_lo:[0,0,1] neg_hi:[0,0,1]
v_pk_fma_f32 v[184:185], v[196:197], v[192:193], v[184:185] op_sel_hi:[0,1,1] neg_lo:[0,0,1] neg_hi:[0,0,1]
v_pk_fma_f32 v[186:187], v[196:197], v[194:195], v[186:187] op_sel_hi:[0,1,1] neg_lo:[0,0,1] neg_hi:[0,0,1]
v_cvt_pk_bf16_f32 v88, v180, v181
v_cvt_pk_bf16_f32 v89, v182, v183
v_cvt_pk_bf16_f32 v90, v184, v185
v_cvt_pk_bf16_f32 v91, v186, v187
s_add_u32 m0, s25, 34816
s_add_u32 s21, s26, 1024
buffer_load_dwordx4 v8, s[44:47], s21 offen lds
v_pk_fma_f32 v[188:189], v[196:197], v[180:181], v[188:189] op_sel_hi:[0,1,1] neg_lo:[0,0,1] neg_hi:[0,0,1]
v_pk_fma_f32 v[190:191], v[196:197], v[182:183], v[190:191] op_sel_hi:[0,1,1] neg_lo:[0,0,1] neg_hi:[0,0,1]
v_pk_fma_f32 v[192:193], v[196:197], v[184:185], v[192:193] op_sel_hi:[0,1,1] neg_lo:[0,0,1] neg_hi:[0,0,1]
v_pk_fma_f32 v[194:195], v[196:197], v[186:187], v[194:195] op_sel_hi:[0,1,1] neg_lo:[0,0,1] neg_hi:[0,0,1]
v_cvt_pk_bf16_f32 v92, v188, v189
v_cvt_pk_bf16_f32 v93, v190, v191
v_cvt_pk_bf16_f32 v94, v192, v193
v_cvt_pk_bf16_f32 v95, v194, v195
s_add_u32 m0, s25, 38912
s_add_u32 s21, s26, 1152
buffer_load_dwordx4 v8, s[44:47], s21 offen lds
s_mov_b32 s20, 323
v_mad_u32_u24 v183, v200, s20, v201
v_cvt_f32_u32 v183, v183
v_mul_f32 v202, s19, v183
v_rndne_f32 v202, v202
v_fmac_f32 v183, 0xc4200000, v202
v_mul_f32 v183, s19, v183
v_cos_f32 v183, v183
s_mov_b32 s20, 324
v_mad_u32_u24 v184, v200, s20, v201
v_cvt_f32_u32 v184, v184
v_mul_f32 v202, s19, v184
v_rndne_f32 v202, v202
v_fmac_f32 v184, 0xc4200000, v202
v_mul_f32 v184, s19, v184
v_cos_f32 v184, v184
s_nop 0
v_fma_f32 v185, v198, v184, -v183
v_fma_f32 v182, v198, v183, -v184
v_fma_f32 v186, v198, v185, -v184
v_fma_f32 v181, v198, v182, -v183
v_fma_f32 v187, v198, v186, -v185
v_fma_f32 v180, v198, v181, -v182
v_cvt_pk_bf16_f32 v96, v180, v181
v_cvt_pk_bf16_f32 v97, v182, v183
v_cvt_pk_bf16_f32 v98, v184, v185
v_cvt_pk_bf16_f32 v99, v186, v187
s_mov_b32 s20, 339
v_mad_u32_u24 v191, v200, s20, v201
v_cvt_f32_u32 v191, v191
v_mul_f32 v202, s19, v191
v_rndne_f32 v202, v202
v_fmac_f32 v191, 0xc4200000, v202
v_mul_f32 v191, s19, v191
v_cos_f32 v191, v191
s_mov_b32 s20, 340
v_mad_u32_u24 v192, v200, s20, v201
v_cvt_f32_u32 v192, v192
v_mul_f32 v202, s19, v192
v_rndne_f32 v202, v202
v_fmac_f32 v192, 0xc4200000, v202
v_mul_f32 v192, s19, v192
v_cos_f32 v192, v192
s_nop 0
v_fma_f32 v193, v198, v192, -v191
v_fma_f32 v190, v198, v191, -v192
v_fma_f32 v194, v198, v193, -v192
v_fma_f32 v189, v198, v190, -v191
v_fma_f32 v195, v198, v194, -v193
v_fma_f32 v188, v198, v189, -v190
v_cvt_pk_bf16_f32 v100, v188, v189
v_cvt_pk_bf16_f32 v101, v190, v191
v_cvt_pk_bf16_f32 v102, v192, v193
v_cvt_pk_bf16_f32 v103, v194, v195
v_pk_fma_f32 v[180:181], v[196:197], v[188:189], v[180:181] op_sel_hi:[0,1,1] neg_lo:[0,0,1] neg_hi:[0,0,1]
v_pk_fma_f32 v[182:183], v[196:197], v[190:191], v[182:183] op_sel_hi:[0,1,1] neg_lo:[0,0,1] neg_hi:[0,0,1]
v_pk_fma_f32 v[184:185], v[196:197], v[192:193], v[184:185] op_sel_hi:[0,1,1] neg_lo:[0,0,1] neg_hi:[0,0,1]
v_pk_fma_f32 v[186:187], v[196:197], v[194:195], v[186:187] op_sel_hi:[0,1,1] neg_lo:[0,0,1] neg_hi:[0,0,1]
v_cvt_pk_bf16_f32 v104, v180, v181
v_cvt_pk_bf16_f32 v105, v182, v183
v_cvt_pk_bf16_f32 v106, v184, v185
v_cvt_pk_bf16_f32 v107, v186, v187
v_pk_fma_f32 v[188:189], v[196:197], v[180:181], v[188:189] op_sel_hi:[0,1,1] neg_lo:[0,0,1] neg_hi:[0,0,1]
v_pk_fma_f32 v[190:191], v[196:197], v[182:183], v[190:191] op_sel_hi:[0,1,1] neg_lo:[0,0,1] neg_hi:[0,0,1]
v_pk_fma_f32 v[192:193], v[196:197], v[184:185], v[192:193] op_sel_hi:[0,1,1] neg_lo:[0,0,1] neg_hi:[0,0,1]
v_pk_fma_f32 v[194:195], v[196:197], v[186:187], v[194:195] op_sel_hi:[0,1,1] neg_lo:[0,0,1] neg_hi:[0,0,1]
v_cvt_pk_bf16_f32 v108, v188, v189
v_cvt_pk_bf16_f32 v109, v190, v191
v_cvt_pk_bf16_f32 v110, v192, v193
v_cvt_pk_bf16_f32 v111, v194, v195
v_pk_fma_f32 v[180:181], v[196:197], v[188:189], v[180:181] op_sel_hi:[0,1,1] neg_lo:[0,0,1] neg_hi:[0,0,1]
v_pk_fma_f32 v[182:183], v[196:197], v[190:191], v[182:183] op_sel_hi:[0,1,1] neg_lo:[0,0,1] neg_hi:[0,0,1]
v_pk_fma_f32 v[184:185], v[196:197], v[192:193], v[184:185] op_sel_hi:[0,1,1] neg_lo:[0,0,1] neg_hi:[0,0,1]
v_pk_fma_f32 v[186:187], v[196:197], v[194:195], v[186:187] op_sel_hi:[0,1,1] neg_lo:[0,0,1] neg_hi:[0,0,1]
v_cvt_pk_bf16_f32 v112, v180, v181
v_cvt_pk_bf16_f32 v113, v182, v183
v_cvt_pk_bf16_f32 v114, v184, v185
v_cvt_pk_bf16_f32 v115, v186, v187
v_pk_fma_f32 v[188:189], v[196:197], v[180:181], v[188:189] op_sel_hi:[0,1,1] neg_lo:[0,0,1] neg_hi:[0,0,1]
v_pk_fma_f32 v[190:191], v[196:197], v[182:183], v[190:191] op_sel_hi:[0,1,1] neg_lo:[0,0,1] neg_hi:[0,0,1]
v_pk_fma_f32 v[192:193], v[196:197], v[184:185], v[192:193] op_sel_hi:[0,1,1] neg_lo:[0,0,1] neg_hi:[0,0,1]
v_pk_fma_f32 v[194:195], v[196:197], v[186:187], v[194:195] op_sel_hi:[0,1,1] neg_lo:[0,0,1] neg_hi:[0,0,1]
v_cvt_pk_bf16_f32 v116, v188, v189
v_cvt_pk_bf16_f32 v117, v190, v191
v_cvt_pk_bf16_f32 v118, v192, v193
v_cvt_pk_bf16_f32 v119, v194, v195
v_pk_fma_f32 v[180:181], v[196:197], v[188:189], v[180:181] op_sel_hi:[0,1,1] neg_lo:[0,0,1] neg_hi:[0,0,1]
v_pk_fma_f32 v[182:183], v[196:197], v[190:191], v[182:183] op_sel_hi:[0,1,1] neg_lo:[0,0,1] neg_hi:[0,0,1]
v_pk_fma_f32 v[184:185], v[196:197], v[192:193], v[184:185] op_sel_hi:[0,1,1] neg_lo:[0,0,1] neg_hi:[0,0,1]
v_pk_fma_f32 v[186:187], v[196:197], v[194:195], v[186:187] op_sel_hi:[0,1,1] neg_lo:[0,0,1] neg_hi:[0,0,1]
v_cvt_pk_bf16_f32 v120, v180, v181
v_cvt_pk_bf16_f32 v121, v182, v183
v_cvt_pk_bf16_f32 v122, v184, v185
v_cvt_pk_bf16_f32 v123, v186, v187
v_pk_fma_f32 v[188:189], v[196:197], v[180:181], v[188:189] op_sel_hi:[0,1,1] neg_lo:[0,0,1] neg_hi:[0,0,1]
v_pk_fma_f32 v[190:191], v[196:197], v[182:183], v[190:191] op_sel_hi:[0,1,1] neg_lo:[0,0,1] neg_hi:[0,0,1]
v_pk_fma_f32 v[192:193], v[196:197], v[184:185], v[192:193] op_sel_hi:[0,1,1] neg_lo:[0,0,1] neg_hi:[0,0,1]
v_pk_fma_f32 v[194:195], v[196:197], v[186:187], v[194:195] op_sel_hi:[0,1,1] neg_lo:[0,0,1] neg_hi:[0,0,1]
v_cvt_pk_bf16_f32 v124, v188, v189
v_cvt_pk_bf16_f32 v125, v190, v191
v_cvt_pk_bf16_f32 v126, v192, v193
v_cvt_pk_bf16_f32 v127, v194, v195
v_pk_fma_f32 v[180:181], v[196:197], v[188:189], v[180:181] op_sel_hi:[0,1,1] neg_lo:[0,0,1] neg_hi:[0,0,1]
v_pk_fma_f32 v[182:183], v[196:197], v[190:191], v[182:183] op_sel_hi:[0,1,1] neg_lo:[0,0,1] neg_hi:[0,0,1]
v_pk_fma_f32 v[184:185], v[196:197], v[192:193], v[184:185] op_sel_hi:[0,1,1] neg_lo:[0,0,1] neg_hi:[0,0,1]
v_pk_fma_f32 v[186:187], v[196:197], v[194:195], v[186:187] op_sel_hi:[0,1,1] neg_lo:[0,0,1] neg_hi:[0,0,1]
v_cvt_pk_bf16_f32 v128, v180, v181
v_cvt_pk_bf16_f32 v129, v182, v183
v_cvt_pk_bf16_f32 v130, v184, v185
v_cvt_pk_bf16_f32 v131, v186, v187
v_pk_fma_f32 v[188:189], v[196:197], v[180:181], v[188:189] op_sel_hi:[0,1,1] neg_lo:[0,0,1] neg_hi:[0,0,1]
v_pk_fma_f32 v[190:191], v[196:197], v[182:183], v[190:191] op_sel_hi:[0,1,1] neg_lo:[0,0,1] neg_hi:[0,0,1]
v_pk_fma_f32 v[192:193], v[196:197], v[184:185], v[192:193] op_sel_hi:[0,1,1] neg_lo:[0,0,1] neg_hi:[0,0,1]
v_pk_fma_f32 v[194:195], v[196:197], v[186:187], v[194:195] op_sel_hi:[0,1,1] neg_lo:[0,0,1] neg_hi:[0,0,1]
v_cvt_pk_bf16_f32 v132, v188, v189
v_cvt_pk_bf16_f32 v133, v190, v191
v_cvt_pk_bf16_f32 v134, v192, v193
v_cvt_pk_bf16_f32 v135, v194, v195
v_pk_fma_f32 v[180:181], v[196:197], v[188:189], v[180:181] op_sel_hi:[0,1,1] neg_lo:[0,0,1] neg_hi:[0,0,1]
v_pk_fma_f32 v[182:183], v[196:197], v[190:191], v[182:183] op_sel_hi:[0,1,1] neg_lo:[0,0,1] neg_hi:[0,0,1]
v_pk_fma_f32 v[184:185], v[196:197], v[192:193], v[184:185] op_sel_hi:[0,1,1] neg_lo:[0,0,1] neg_hi:[0,0,1]
v_pk_fma_f32 v[186:187], v[196:197], v[194:195], v[186:187] op_sel_hi:[0,1,1] neg_lo:[0,0,1] neg_hi:[0,0,1]
v_cvt_pk_bf16_f32 v136, v180, v181
v_cvt_pk_bf16_f32 v137, v182, v183
v_cvt_pk_bf16_f32 v138, v184, v185
v_cvt_pk_bf16_f32 v139, v186, v187
v_pk_fma_f32 v[188:189], v[196:197], v[180:181], v[188:189] op_sel_hi:[0,1,1] neg_lo:[0,0,1] neg_hi:[0,0,1]
v_pk_fma_f32 v[190:191], v[196:197], v[182:183], v[190:191] op_sel_hi:[0,1,1] neg_lo:[0,0,1] neg_hi:[0,0,1]
v_pk_fma_f32 v[192:193], v[196:197], v[184:185], v[192:193] op_sel_hi:[0,1,1] neg_lo:[0,0,1] neg_hi:[0,0,1]
v_pk_fma_f32 v[194:195], v[196:197], v[186:187], v[194:195] op_sel_hi:[0,1,1] neg_lo:[0,0,1] neg_hi:[0,0,1]
v_cvt_pk_bf16_f32 v140, v188, v189
v_cvt_pk_bf16_f32 v141, v190, v191
v_cvt_pk_bf16_f32 v142, v192, v193
v_cvt_pk_bf16_f32 v143, v194, v195
v_pk_fma_f32 v[180:181], v[196:197], v[188:189], v[180:181] op_sel_hi:[0,1,1] neg_lo:[0,0,1] neg_hi:[0,0,1]
v_pk_fma_f32 v[182:183], v[196:197], v[190:191], v[182:183] op_sel_hi:[0,1,1] neg_lo:[0,0,1] neg_hi:[0,0,1]
v_pk_fma_f32 v[184:185], v[196:197], v[192:193], v[184:185] op_sel_hi:[0,1,1] neg_lo:[0,0,1] neg_hi:[0,0,1]
v_pk_fma_f32 v[186:187], v[196:197], v[194:195], v[186:187] op_sel_hi:[0,1,1] neg_lo:[0,0,1] neg_hi:[0,0,1]
v_cvt_pk_bf16_f32 v144, v180, v181
v_cvt_pk_bf16_f32 v145, v182, v183
v_cvt_pk_bf16_f32 v146, v184, v185
v_cvt_pk_bf16_f32 v147, v186, v187
v_pk_fma_f32 v[188:189], v[196:197], v[180:181], v[188:189] op_sel_hi:[0,1,1] neg_lo:[0,0,1] neg_hi:[0,0,1]
v_pk_fma_f32 v[190:191], v[196:197], v[182:183], v[190:191] op_sel_hi:[0,1,1] neg_lo:[0,0,1] neg_hi:[0,0,1]
v_pk_fma_f32 v[192:193], v[196:197], v[184:185], v[192:193] op_sel_hi:[0,1,1] neg_lo:[0,0,1] neg_hi:[0,0,1]
v_pk_fma_f32 v[194:195], v[196:197], v[186:187], v[194:195] op_sel_hi:[0,1,1] neg_lo:[0,0,1] neg_hi:[0,0,1]
v_cvt_pk_bf16_f32 v148, v188, v189
v_cvt_pk_bf16_f32 v149, v190, v191
v_cvt_pk_bf16_f32 v150, v192, v193
v_cvt_pk_bf16_f32 v151, v194, v195
v_pk_fma_f32 v[180:181], v[196:197], v[188:189], v[180:181] op_sel_hi:[0,1,1] neg_lo:[0,0,1] neg_hi:[0,0,1]
v_pk_fma_f32 v[182:183], v[196:197], v[190:191], v[182:183] op_sel_hi:[0,1,1] neg_lo:[0,0,1] neg_hi:[0,0,1]
v_pk_fma_f32 v[184:185], v[196:197], v[192:193], v[184:185] op_sel_hi:[0,1,1] neg_lo:[0,0,1] neg_hi:[0,0,1]
v_pk_fma_f32 v[186:187], v[196:197], v[194:195], v[186:187] op_sel_hi:[0,1,1] neg_lo:[0,0,1] neg_hi:[0,0,1]
v_cvt_pk_bf16_f32 v152, v180, v181
v_cvt_pk_bf16_f32 v153, v182, v183
v_cvt_pk_bf16_f32 v154, v184, v185
v_cvt_pk_bf16_f32 v155, v186, v187
v_pk_fma_f32 v[188:189], v[196:197], v[180:181], v[188:189] op_sel_hi:[0,1,1] neg_lo:[0,0,1] neg_hi:[0,0,1]
v_pk_fma_f32 v[190:191], v[196:197], v[182:183], v[190:191] op_sel_hi:[0,1,1] neg_lo:[0,0,1] neg_hi:[0,0,1]
v_pk_fma_f32 v[192:193], v[196:197], v[184:185], v[192:193] op_sel_hi:[0,1,1] neg_lo:[0,0,1] neg_hi:[0,0,1]
v_pk_fma_f32 v[194:195], v[196:197], v[186:187], v[194:195] op_sel_hi:[0,1,1] neg_lo:[0,0,1] neg_hi:[0,0,1]
v_cvt_pk_bf16_f32 v156, v188, v189
v_cvt_pk_bf16_f32 v157, v190, v191
v_cvt_pk_bf16_f32 v158, v192, v193
v_cvt_pk_bf16_f32 v159, v194, v195
v_pk_fma_f32 v[180:181], v[196:197], v[188:189], v[180:181] op_sel_hi:[0,1,1] neg_lo:[0,0,1] neg_hi:[0,0,1]
v_pk_fma_f32 v[182:183], v[196:197], v[190:191], v[182:183] op_sel_hi:[0,1,1] neg_lo:[0,0,1] neg_hi:[0,0,1]
v_pk_fma_f32 v[184:185], v[196:197], v[192:193], v[184:185] op_sel_hi:[0,1,1] neg_lo:[0,0,1] neg_hi:[0,0,1]
v_pk_fma_f32 v[186:187], v[196:197], v[194:195], v[186:187] op_sel_hi:[0,1,1] neg_lo:[0,0,1] neg_hi:[0,0,1]
v_cvt_pk_bf16_f32 v160, v180, v181
v_cvt_pk_bf16_f32 v161, v182, v183
v_cvt_pk_bf16_f32 v162, v184, v185
v_cvt_pk_bf16_f32 v163, v186, v187
v_pk_fma_f32 v[188:189], v[196:197], v[180:181], v[188:189] op_sel_hi:[0,1,1] neg_lo:[0,0,1] neg_hi:[0,0,1]
v_pk_fma_f32 v[190:191], v[196:197], v[182:183], v[190:191] op_sel_hi:[0,1,1] neg_lo:[0,0,1] neg_hi:[0,0,1]
v_pk_fma_f32 v[192:193], v[196:197], v[184:185], v[192:193] op_sel_hi:[0,1,1] neg_lo:[0,0,1] neg_hi:[0,0,1]
v_pk_fma_f32 v[194:195], v[196:197], v[186:187], v[194:195] op_sel_hi:[0,1,1] neg_lo:[0,0,1] neg_hi:[0,0,1]
v_cvt_pk_bf16_f32 v164, v188, v189
v_cvt_pk_bf16_f32 v165, v190, v191
v_cvt_pk_bf16_f32 v166, v192, v193
v_cvt_pk_bf16_f32 v167, v194, v195
v_pk_fma_f32 v[180:181], v[196:197], v[188:189], v[180:181] op_sel_hi:[0,1,1] neg_lo:[0,0,1] neg_hi:[0,0,1]
v_pk_fma_f32 v[182:183], v[196:197], v[190:191], v[182:183] op_sel_hi:[0,1,1] neg_lo:[0,0,1] neg_hi:[0,0,1]
v_pk_fma_f32 v[184:185], v[196:197], v[192:193], v[184:185] op_sel_hi:[0,1,1] neg_lo:[0,0,1] neg_hi:[0,0,1]
v_pk_fma_f32 v[186:187], v[196:197], v[194:195], v[186:187] op_sel_hi:[0,1,1] neg_lo:[0,0,1] neg_hi:[0,0,1]
v_cvt_pk_bf16_f32 v168, v180, v181
v_cvt_pk_bf16_f32 v169, v182, v183
v_cvt_pk_bf16_f32 v170, v184, v185
v_cvt_pk_bf16_f32 v171, v186, v187
v_pk_fma_f32 v[188:189], v[196:197], v[180:181], v[188:189] op_sel_hi:[0,1,1] neg_lo:[0,0,1] neg_hi:[0,0,1]
v_pk_fma_f32 v[190:191], v[196:197], v[182:183], v[190:191] op_sel_hi:[0,1,1] neg_lo:[0,0,1] neg_hi:[0,0,1]
v_pk_fma_f32 v[192:193], v[196:197], v[184:185], v[192:193] op_sel_hi:[0,1,1] neg_lo:[0,0,1] neg_hi:[0,0,1]
v_pk_fma_f32 v[194:195], v[196:197], v[186:187], v[194:195] op_sel_hi:[0,1,1] neg_lo:[0,0,1] neg_hi:[0,0,1]
v_cvt_pk_bf16_f32 v172, v188, v189
v_cvt_pk_bf16_f32 v173, v190, v191
v_cvt_pk_bf16_f32 v174, v192, v193
v_cvt_pk_bf16_f32 v175, v194, v195
v_mov_b32 v180, s24
v_mov_b32 v181, s24
v_mov_b32 v182, s24
v_mov_b32 v183, s24
s_nop 1
v_mfma_f32_32x32x16_bf16 v[184:199], v[180:183], v[16:19], 0
v_mfma_f32_32x32x16_bf16 v[184:199], v[180:183], v[20:23], v[184:199]
v_mfma_f32_32x32x16_bf16 v[184:199], v[180:183], v[24:27], v[184:199]
v_mfma_f32_32x32x16_bf16 v[184:199], v[180:183], v[28:31], v[184:199]
v_mfma_f32_32x32x16_bf16 v[184:199], v[180:183], v[32:35], v[184:199]
v_mfma_f32_32x32x16_bf16 v[184:199], v[180:183], v[36:39], v[184:199]
v_mfma_f32_32x32x16_bf16 v[184:199], v[180:183], v[40:43], v[184:199]
v_mfma_f32_32x32x16_bf16 v[184:199], v[180:183], v[44:47], v[184:199]
v_mfma_f32_32x32x16_bf16 v[184:199], v[180:183], v[48:51], v[184:199]
v_mfma_f32_32x32x16_bf16 v[184:199], v[180:183], v[52:55], v[184:199]
v_mfma_f32_32x32x16_bf16 v[184:199], v[180:183], v[56:59], v[184:199]
v_mfma_f32_32x32x16_bf16 v[184:199], v[180:183], v[60:63], v[184:199]
v_mfma_f32_32x32x16_bf16 v[184:199], v[180:183], v[64:67], v[184:199]
v_mfma_f32_32x32x16_bf16 v[184:199], v[180:183], v[68:71], v[184:199]
v_mfma_f32_32x32x16_bf16 v[184:199], v[180:183], v[72:75], v[184:199]
v_mfma_f32_32x32x16_bf16 v[184:199], v[180:183], v[76:79], v[184:199]
v_mfma_f32_32x32x16_bf16 v[184:199], v[180:183], v[80:83], v[184:199]
v_mfma_f32_32x32x16_bf16 v[184:199], v[180:183], v[84:87], v[184:199]
v_mfma_f32_32x32x16_bf16 v[184:199], v[180:183], v[88:91], v[184:199]
v_mfma_f32_32x32x16_bf16 v[184:199], v[180:183], v[92:95], v[184:199]
v_mfma_f32_32x32x16_bf16 v[184:199], v[180:183], v[96:99], v[184:199]
v_mfma_f32_32x32x16_bf16 v[184:199], v[180:183], v[100:103], v[184:199]
v_mfma_f32_32x32x16_bf16 v[184:199], v[180:183], v[104:107], v[184:199]
v_mfma_f32_32x32x16_bf16 v[184:199], v[180:183], v[108:111], v[184:199]
v_mfma_f32_32x32x16_bf16 v[184:199], v[180:183], v[112:115], v[184:199]
v_mfma_f32_32x32x16_bf16 v[184:199], v[180:183], v[116:119], v[184:199]
v_mfma_f32_32x32x16_bf16 v[184:199], v[180:183], v[120:123], v[184:199]
v_mfma_f32_32x32x16_bf16 v[184:199], v[180:183], v[124:127], v[184:199]
v_mfma_f32_32x32x16_bf16 v[184:199], v[180:183], v[128:131], v[184:199]
v_mfma_f32_32x32x16_bf16 v[184:199], v[180:183], v[132:135], v[184:199]
v_mfma_f32_32x32x16_bf16 v[184:199], v[180:183], v[136:139], v[184:199]
v_mfma_f32_32x32x16_bf16 v[184:199], v[180:183], v[140:143], v[184:199]
v_mfma_f32_32x32x16_bf16 v[184:199], v[180:183], v[144:147], v[184:199]
v_mfma_f32_32x32x16_bf16 v[184:199], v[180:183], v[148:151], v[184:199]
v_mfma_f32_32x32x16_bf16 v[184:199], v[180:183], v[152:155], v[184:199]
v_mfma_f32_32x32x16_bf16 v[184:199], v[180:183], v[156:159], v[184:199]
v_mfma_f32_32x32x16_bf16 v[184:199], v[180:183], v[160:163], v[184:199]
v_mfma_f32_32x32x16_bf16 v[184:199], v[180:183], v[164:167], v[184:199]
v_mfma_f32_32x32x16_bf16 v[184:199], v[180:183], v[168:171], v[184:199]
v_mfma_f32_32x32x16_bf16 v[184:199], v[180:183], v[172:175], v[184:199]
s_nop 11
v_mov_b32 v7, v184
s_lshl_b32 s18, s34, 2
s_add_u32 s18, s18, s13
s_lshl_b32 s33, s18, 11
s_mul_i32 s27, s50, 40960
s_add_u32 s27, s27, s33
s_add_u32 s27, s27, 97517568
s_mov_b32 s28, 0
s_waitcnt vmcnt(0)
p1_39:
s_barrier
s_lshl_b32 s18, s13, 5
v_xor_b32 v2, s18, v176
ds_read_b128 v[220:223], v2 offset:2048
ds_read_b128 v[228:231], v2 offset:10240
ds_read_b128 v[224:227], v2 offset:6144
ds_read_b128 v[204:207], v178 offset:2048
v_mov_b64 v[212:213], 0
s_add_u32 s19, s30, 0
buffer_load_dword a0, v1, s[40:43], s19 offen
ds_read_b128 v[232:235], v2 offset:14336
ds_read_b128 v[196:199], v176 offset:2048
ds_read_b128 v[208:211], v179 offset:2048
ds_read_b128 v[200:203], v177 offset:2048
s_waitcnt lgkmcnt(7)
v_dot2c_f32_bf16 v212, s24, v220
v_dot2c_f32_bf16 v213, v220, v220
v_dot2c_f32_bf16 v212, s24, v221
v_dot2c_f32_bf16 v213, v221, v221
v_dot2c_f32_bf16 v212, s24, v222
v_dot2c_f32_bf16 v213, v222, v222
v_dot2c_f32_bf16 v212, s24, v223
s_waitcnt lgkmcnt(5)
v_dot2c_f32_bf16 v213, v223, v223
v_dot2c_f32_bf16 v212, s24, v224
v_dot2c_f32_bf16 v213, v224, v224
v_dot2c_f32_bf16 v212, s24, v225
v_dot2c_f32_bf16 v213, v225, v225
v_dot2c_f32_bf16 v212, s24, v226
v_dot2c_f32_bf16 v213, v226, v226
v_dot2c_f32_bf16 v212, s24, v227
v_dot2c_f32_bf16 v213, v227, v227
v_dot2c_f32_bf16 v212, s24, v228
s_waitcnt lgkmcnt(3)
ds_read_b128 v[220:223], v2 offset:18432
ds_read_b128 v[224:227], v2 offset:22528
v_dot2c_f32_bf16 v213, v228, v228
v_dot2c_f32_bf16 v212, s24, v229
v_dot2c_f32_bf16 v213, v229, v229
v_dot2c_f32_bf16 v212, s24, v230
v_dot2c_f32_bf16 v213, v230, v230
v_dot2c_f32_bf16 v212, s24, v231
v_dot2c_f32_bf16 v213, v231, v231
v_dot2c_f32_bf16 v212, s24, v232
v_dot2c_f32_bf16 v213, v232, v232
v_dot2c_f32_bf16 v212, s24, v233
v_dot2c_f32_bf16 v213, v233, v233
v_dot2c_f32_bf16 v212, s24, v234
v_dot2c_f32_bf16 v213, v234, v234
v_dot2c_f32_bf16 v212, s24, v235
v_dot2c_f32_bf16 v213, v235, v235
s_waitcnt lgkmcnt(3)
s_add_u32 s19, s30, 41088
buffer_load_dword a1, v1, s[40:43], s19 offen
ds_read_b128 v[228:231], v2 offset:26624
s_waitcnt lgkmcnt(1)
ds_read_b128 v[232:235], v2 offset:30720
v_dot2c_f32_bf16 v212, s24, v220
v_dot2c_f32_bf16 v213, v220, v220
v_dot2c_f32_bf16 v212, s24, v221
v_dot2c_f32_bf16 v213, v221, v221
v_dot2c_f32_bf16 v212, s24, v222
v_dot2c_f32_bf16 v213, v222, v222
v_dot2c_f32_bf16 v212, s24, v223
v_dot2c_f32_bf16 v213, v223, v223
v_dot2c_f32_bf16 v212, s24, v224
v_dot2c_f32_bf16 v213, v224, v224
v_dot2c_f32_bf16 v212, s24, v225
v_dot2c_f32_bf16 v213, v225, v225
v_dot2c_f32_bf16 v212, s24, v226
v_dot2c_f32_bf16 v213, v226, v226
v_dot2c_f32_bf16 v212, s24, v227
v_dot2c_f32_bf16 v213, v227, v227
s_waitcnt lgkmcnt(0)
ds_read_b128 v[220:223], v2 offset:34816
ds_read_b128 v[224:227], v2 offset:38912
v_dot2c_f32_bf16 v212, s24, v228
v_dot2c_f32_bf16 v213, v228, v228
v_dot2c_f32_bf16 v212, s24, v229
v_dot2c_f32_bf16 v213, v229, v229
v_dot2c_f32_bf16 v212, s24, v230
v_dot2c_f32_bf16 v213, v230, v230
v_dot2c_f32_bf16 v212, s24, v231
v_dot2c_f32_bf16 v213, v231, v231
v_dot2c_f32_bf16 v212, s24, v232
v_dot2c_f32_bf16 v213, v232, v232
v_dot2c_f32_bf16 v212, s24, v233
v_dot2c_f32_bf16 v213, v233, v233
v_dot2c_f32_bf16 v212, s24, v234
v_dot2c_f32_bf16 v213, v234, v234
v_dot2c_f32_bf16 v212, s24, v235
v_dot2c_f32_bf16 v213, v235, v235
s_waitcnt lgkmcnt(1)
v_dot2c_f32_bf16 v212, s24, v220
v_dot2c_f32_bf16 v213, v220, v220
v_dot2c_f32_bf16 v212, s24, v221
v_dot2c_f32_bf16 v213, v221, v221
v_dot2c_f32_bf16 v212, s24, v222
v_dot2c_f32_bf16 v213, v222, v222
v_dot2c_f32_bf16 v212, s24, v223
v_dot2c_f32_bf16 v213, v223, v223
s_waitcnt lgkmcnt(0)
v_dot2c_f32_bf16 v212, s24, v224
v_dot2c_f32_bf16 v213, v224, v224
v_dot2c_f32_bf16 v212, s24, v225
v_dot2c_f32_bf16 v213, v225, v225
v_dot2c_f32_bf16 v212, s24, v226
v_dot2c_f32_bf16 v213, v226, v226
v_dot2c_f32_bf16 v212, s24, v227
v_dot2c_f32_bf16 v213, v227, v227
v_mfma_f32_32x32x16_bf16 v[180:195], v[196:199], v[16:19], 0
ds_read_b128 v[196:199], v176 offset:6144
s_add_u32 s19, s30, 82176
buffer_load_dword a2, v1, s[40:43], s19 offen
v_permlane32_swap_b32 v212, v213
v_mfma_f32_32x32x16_bf16 v[180:195], v[200:203], v[20:23], v[180:195]
v_add_f32 v212, v212, v213
v_lshl_add_u32 v213, s13, 2, v0
ds_read_b128 v[200:203], v177 offset:6144
v_and_b32 v2, 0x1ff, v0
v_mfma_f32_32x32x16_bf16 v[180:195], v[204:207], v[24:27], v[180:195]
ds_write_b32 v213, v212 offset:0
ds_read_b128 v[204:207], v178 offset:6144
s_waitcnt lgkmcnt(3)
v_mfma_f32_32x32x16_bf16 v[180:195], v[208:211], v[28:31], v[180:195]
ds_read_b128 v[208:211], v179 offset:6144
v_mfma_f32_32x32x16_bf16 v[180:195], v[196:199], v[32:35], v[180:195]
ds_read_b128 v[196:199], v176 offset:10240
s_add_u32 s19, s30, 123264
buffer_load_dword a3, v1, s[40:43], s19 offen
s_waitcnt lgkmcnt(4)
v_mfma_f32_32x32x16_bf16 v[180:195], v[200:203], v[36:39], v[180:195]
s_waitcnt lgkmcnt(1)
ds_read_b128 v[200:203], v177 offset:10240
v_mfma_f32_32x32x16_bf16 v[180:195], v[204:207], v[40:43], v[180:195]
s_barrier
ds_read_b128 v[204:207], v178 offset:10240
ds_read_b128 v[216:219], v2 offset:512
v_mfma_f32_32x32x16_bf16 v[180:195], v[208:211], v[44:47], v[180:195]
ds_read_b128 v[208:211], v179 offset:10240
s_waitcnt lgkmcnt(4)
v_mfma_f32_32x32x16_bf16 v[180:195], v[196:199], v[48:51], v[180:195]
ds_read_b128 v[212:215], v2 offset:0
s_waitcnt lgkmcnt(4)
ds_read_b128 v[196:199], v176 offset:14336
v_mfma_f32_32x32x16_bf16 v[180:195], v[200:203], v[52:55], v[180:195]
ds_read_b128 v[200:203], v177 offset:14336
s_waitcnt lgkmcnt(3)
v_mfma_f32_32x32x16_bf16 v[180:195], v[204:207], v[56:59], v[180:195]
s_waitcnt lgkmcnt(1)
ds_read_b128 v[204:207], v178 offset:14336
v_mfma_f32_32x32x16_bf16 v[180:195], v[208:211], v[60:63], v[180:195]
ds_read_b128 v[208:211], v179 offset:14336
v_add_f32 v212, v212, v213
v_mfma_f32_32x32x16_bf16 v[180:195], v[196:199], v[64:67], v[180:195]
v_add_f32 v216, v216, v217
v_add_f32 v218, v218, v219
s_waitcnt lgkmcnt(2)
ds_read_b128 v[196:199], v176 offset:18432
s_waitcnt lgkmcnt(2)
v_mfma_f32_32x32x16_bf16 v[180:195], v[200:203], v[68:71], v[180:195]
s_add_u32 s19, s30, 657408
buffer_load_dword a4, v1, s[40:43], s19 offen
ds_read_b128 v[200:203], v177 offset:18432
v_add_f32 v214, v214, v215
v_mfma_f32_32x32x16_bf16 v[180:195], v[204:207], v[72:75], v[180:195]
v_add_f32 v216, v216, v218
ds_read_b128 v[204:207], v178 offset:18432
v_add_f32 v212, v212, v214
s_waitcnt lgkmcnt(3)
v_mfma_f32_32x32x16_bf16 v[180:195], v[208:211], v[76:79], v[180:195]
ds_read_b128 v[208:211], v179 offset:18432
v_mul_f32 v212, 0x3acccccd, v212
s_waitcnt lgkmcnt(2)
v_bfe_u32 v214, v0, 5, 5
v_mul_f32 v216, 0x3acccccd, v216
v_mfma_f32_32x32x16_bf16 v[180:195], v[196:199], v[80:83], v[180:195]
v_fma_f32 v216, -v212, v212, v216
v_max_f32 v216, 0, v216
v_and_b32 v214, 16, v214
s_waitcnt lgkmcnt(1)
v_add_f32 v216, 0x3727c5ac, v216
v_lshrrev_b32 v213, 2, v0
v_mfma_f32_32x32x16_bf16 v[180:195], v[200:203], v[84:87], v[180:195]
ds_read_b128 v[196:199], v176 offset:22528
s_waitcnt lgkmcnt(1)
s_add_u32 s19, s30, 698496
buffer_load_dword a5, v1, s[40:43], s19 offen
v_lshl_add_u32 v213, s13, 8, v213
v_mfma_f32_32x32x16_bf16 v[180:195], v[204:207], v[88:91], v[180:195]
v_rsq_f32 v216, v216
ds_read_b128 v[200:203], v177 offset:22528
v_mul_f32 v212, v216, v212
v_mfma_f32_32x32x16_bf16 v[180:195], v[208:211], v[92:95], v[180:195]
s_waitcnt lgkmcnt(1)
ds_read_b128 v[208:211], v179 offset:22528
ds_read_b128 v[204:207], v178 offset:22528
v_permlane32_swap_b32 v216, v212
v_lshl_add_u32 v214, s13, 8, v214
v_mfma_f32_32x32x16_bf16 v[180:195], v[196:199], v[96:99], v[180:195]
ds_read_b128 v[196:199], v176 offset:26624
ds_write_b32 v213, v216 offset:1024
s_waitcnt lgkmcnt(4)
v_mfma_f32_32x32x16_bf16 v[180:195], v[200:203], v[100:103], v[180:195]
ds_read_b128 v[200:203], v177 offset:26624
ds_read_b128 v[236:239], v214 offset:1152
s_waitcnt lgkmcnt(5)
s_waitcnt lgkmcnt(4)
v_mfma_f32_32x32x16_bf16 v[180:195], v[204:207], v[104:107], v[180:195]
ds_read_b128 v[204:207], v178 offset:26624
v_mfma_f32_32x32x16_bf16 v[180:195], v[208:211], v[108:111], v[180:195]
s_waitcnt lgkmcnt(4)
ds_read_b128 v[208:211], v179 offset:26624
s_add_u32 s19, s30, 739584
buffer_load_dword a6, v1, s[40:43], s19 offen
s_waitcnt lgkmcnt(2)
v_mfma_f32_32x32x16_bf16 v[180:195], v[196:199], v[112:115], v[180:195]
ds_read_b128 v[248:251], v214 offset:1248
ds_read_b128 v[240:243], v214 offset:1184
ds_read_b128 v[196:199], v176 offset:30720
v_mfma_f32_32x32x16_bf16 v[180:195], v[200:203], v[116:119], v[180:195]
s_waitcnt lgkmcnt(4)
v_mul_f32 v239, v239, v7
ds_read_b128 v[244:247], v214 offset:1216
v_mul_f32 v236, v236, v7
v_mfma_f32_32x32x16_bf16 v[180:195], v[204:207], v[120:123], v[180:195]
ds_read_b128 v[200:203], v177 offset:30720
s_waitcnt lgkmcnt(5)
s_waitcnt lgkmcnt(4)
ds_read_b128 v[204:207], v178 offset:30720
ds_read_b128 v[232:235], v214 offset:1120
v_mfma_f32_32x32x16_bf16 v[180:195], v[208:211], v[124:127], v[180:195]
ds_read_b128 v[228:231], v214 offset:1088
ds_read_b128 v[208:211], v179 offset:30720
s_waitcnt lgkmcnt(6)
v_mfma_f32_32x32x16_bf16 v[180:195], v[196:199], v[128:131], v[180:195]
ds_read_b128 v[196:199], v176 offset:34816
s_waitcnt lgkmcnt(5)
ds_read_b128 v[220:223], v214 offset:1024
v_mul_f32 v238, v238, v7
v_mfma_f32_32x32x16_bf16 v[180:195], v[200:203], v[132:135], v[180:195]
ds_read_b128 v[200:203], v177 offset:34816
s_waitcnt lgkmcnt(6)
v_mfma_f32_32x32x16_bf16 v[180:195], v[204:207], v[136:139], v[180:195]
v_mul_f32 v243, v243, v7
s_waitcnt lgkmcnt(3)
s_add_u32 s19, s30, 780672
buffer_load_dword a7, v1, s[40:43], s19 offen
v_mul_f32 v246, v246, v7
v_mfma_f32_32x32x16_bf16 v[180:195], v[208:211], v[140:143], v[180:195]
ds_read_b128 v[208:211], v179 offset:34816
ds_read_b128 v[204:207], v178 offset:34816
v_mul_f32 v237, v237, v7
v_mul_f32 v251, v251, v7
s_waitcnt lgkmcnt(4)
v_mul_f32 v248, v248, v7
v_mfma_f32_32x32x16_bf16 v[180:195], v[196:199], v[144:147], v[180:195]
ds_read_b128 v[196:199], v176 offset:38912
s_waitcnt lgkmcnt(3)
v_mfma_f32_32x32x16_bf16 v[180:195], v[200:203], v[148:151], v[180:195]
s_waitcnt lgkmcnt(1)
ds_read_b128 v[200:203], v177 offset:38912
ds_read_b128 v[224:227], v214 offset:1056
v_mfma_f32_32x32x16_bf16 v[180:195], v[204:207], v[152:155], v[180:195]
v_mul_f32 v250, v250, v7
ds_read_b128 v[204:207], v178 offset:38912
v_mul_f32 v244, v244, v7
s_waitcnt lgkmcnt(3)
v_mfma_f32_32x32x16_bf16 v[180:195], v[208:211], v[156:159], v[180:195]
ds_read_b128 v[208:211], v179 offset:38912
s_waitcnt lgkmcnt(3)
v_mfma_f32_32x32x16_bf16 v[180:195], v[196:199], v[160:163], v[180:195]
v_mul_f32 v240, v240, v7
v_mfma_f32_32x32x16_bf16 v[180:195], v[200:203], v[164:167], v[180:195]
s_waitcnt lgkmcnt(1)
v_mul_f32 v241, v241, v7
v_mul_f32 v245, v245, v7
v_mfma_f32_32x32x16_bf16 v[180:195], v[204:207], v[168:171], v[180:195]
v_mul_f32 v249, v249, v7
s_waitcnt lgkmcnt(0)
v_mfma_f32_32x32x16_bf16 v[180:195], v[208:211], v[172:175], v[180:195]
s_nop 0
v_mul_f32 v247, v247, v7
v_mul_f32 v242, v242, v7
s_nop 8
v_pk_fma_f32 v[192:193], v[192:193], v[232:233], v[248:249] neg_lo:[0,0,1] neg_hi:[0,0,1]
v_pk_fma_f32 v[180:181], v[180:181], v[220:221], v[236:237] neg_lo:[0,0,1] neg_hi:[0,0,1]
v_pk_fma_f32 v[184:185], v[184:185], v[224:225], v[240:241] neg_lo:[0,0,1] neg_hi:[0,0,1]
v_pk_fma_f32 v[188:189], v[188:189], v[228:229], v[244:245] neg_lo:[0,0,1] neg_hi:[0,0,1]
v_pk_fma_f32 v[186:187], v[186:187], v[226:227], v[242:243] neg_lo:[0,0,1] neg_hi:[0,0,1]
v_pk_fma_f32 v[190:191], v[190:191], v[230:231], v[246:247] neg_lo:[0,0,1] neg_hi:[0,0,1]
v_cvt_pk_bf16_f32 v202, v192, v193
v_pk_fma_f32 v[182:183], v[182:183], v[222:223], v[238:239] neg_lo:[0,0,1] neg_hi:[0,0,1]
v_pk_fma_f32 v[194:195], v[194:195], v[234:235], v[250:251] neg_lo:[0,0,1] neg_hi:[0,0,1]
v_cvt_pk_bf16_f32 v196, v180, v181
v_cvt_pk_bf16_f32 v198, v184, v185
v_cvt_pk_bf16_f32 v200, v188, v189
v_cvt_pk_bf16_f32 v203, v194, v195
v_cvt_pk_bf16_f32 v197, v182, v183
v_cvt_pk_bf16_f32 v201, v190, v191
v_cvt_pk_bf16_f32 v199, v186, v187
buffer_store_dwordx4 v[196:199], v6, s[4:7], s27 offen offset:0 sc1
buffer_store_dwordx4 v[200:203], v6, s[4:7], s27 offen offset:1024 sc1
s_waitcnt vmcnt(6)
ds_write_b128 v4, a[0:3] offset:0
s_waitcnt vmcnt(2)
ds_write_b128 v4, a[4:7] offset:1024
v_add_u32 v4, 2048, v4
s_mov_b64 s[40:41], s[52:53]
v_add_u32 v176, 40960, v176
v_add_u32 v177, 40960, v177
v_add_u32 v178, 40960, v178
v_add_u32 v179, 40960, v179
s_add_u32 s27, s27, 1310720
s_add_u32 s28, s28, 1
s_cmp_lt_u32 s28, 2
s_cbranch_scc1 p1_39
s_lshl_b32 s18, s39, 2
s_add_u32 s18, s18, 5120
s_cmp_eq_u32 s13, 0
s_cselect_b32 s22, s18, s6
s_mov_b32 s23, 1
s_waitcnt vmcnt(0)
s_barrier
v_mov_b32 v3, s23
s_mov_b64 exec, 1
buffer_store_dword v3, off, s[4:7], s22 sc1
s_mov_b64 exec, -1
s_mov_b32 s22, s6
alay_40:
v_bfe_u32 v96, v0, 4, 4
v_lshrrev_b32 v97, 8, v0
v_lshlrev_b32 v97, 2, v97
v_lshl_add_u32 v98, s13, 4, v96
v_add_u32 v99, 0, v97
v_mul_u32_u24 v99, v99, v98
v_and_b32 v99, 63, v99
v_cvt_f32_u32 v99, v99
v_mul_f32 v99, 0x3c800000, v99
v_cos_f32 v104, v99
v_sin_f32 v112, v99
v_add_u32 v99, 1, v97
v_mul_u32_u24 v99, v99, v98
v_and_b32 v99, 63, v99
v_cvt_f32_u32 v99, v99
v_mul_f32 v99, 0x3c800000, v99
v_cos_f32 v105, v99
v_sin_f32 v113, v99
v_add_u32 v99, 2, v97
v_mul_u32_u24 v99, v99, v98
v_and_b32 v99, 63, v99
v_cvt_f32_u32 v99, v99
v_mul_f32 v99, 0x3c800000, v99
v_cos_f32 v106, v99
v_sin_f32 v114, v99
v_add_u32 v99, 3, v97
v_mul_u32_u24 v99, v99, v98
v_and_b32 v99, 63, v99
v_cvt_f32_u32 v99, v99
v_mul_f32 v99, 0x3c800000, v99
v_cos_f32 v107, v99
v_sin_f32 v115, v99
v_add_u32 v99, 16, v97
v_mul_u32_u24 v99, v99, v98
v_and_b32 v99, 63, v99
v_cvt_f32_u32 v99, v99
v_mul_f32 v99, 0x3c800000, v99
v_cos_f32 v108, v99
v_sin_f32 v116, v99
v_add_u32 v99, 17, v97
v_mul_u32_u24 v99, v99, v98
v_and_b32 v99, 63, v99
v_cvt_f32_u32 v99, v99
v_mul_f32 v99, 0x3c800000, v99
v_cos_f32 v109, v99
v_sin_f32 v117, v99
v_add_u32 v99, 18, v97
v_mul_u32_u24 v99, v99, v98
v_and_b32 v99, 63, v99
v_cvt_f32_u32 v99, v99
v_mul_f32 v99, 0x3c800000, v99
v_cos_f32 v110, v99
v_sin_f32 v118, v99
v_add_u32 v99, 19, v97
v_mul_u32_u24 v99, v99, v98
v_and_b32 v99, 63, v99
v_cvt_f32_u32 v99, v99
v_mul_f32 v99, 0x3c800000, v99
v_cos_f32 v111, v99
v_sin_f32 v119, v99
v_cvt_pk_bf16_f32 v16, v104, v105
v_cvt_pk_bf16_f32 v24, v112, v113
v_xor_b32 v32, 0x80008000, v24
v_cvt_pk_bf16_f32 v17, v106, v107
v_cvt_pk_bf16_f32 v25, v114, v115
v_xor_b32 v33, 0x80008000, v25
v_cvt_pk_bf16_f32 v18, v108, v109
v_cvt_pk_bf16_f32 v26, v116, v117
v_xor_b32 v34, 0x80008000, v26
v_cvt_pk_bf16_f32 v19, v110, v111
v_cvt_pk_bf16_f32 v27, v118, v119
v_xor_b32 v35, 0x80008000, v27
v_add_u32 v99, 32, v97
v_mul_u32_u24 v99, v99, v98
v_and_b32 v99, 63, v99
v_cvt_f32_u32 v99, v99
v_mul_f32 v99, 0x3c800000, v99
v_cos_f32 v104, v99
v_sin_f32 v112, v99
v_add_u32 v99, 33, v97
v_mul_u32_u24 v99, v99, v98
v_and_b32 v99, 63, v99
v_cvt_f32_u32 v99, v99
v_mul_f32 v99, 0x3c800000, v99
v_cos_f32 v105, v99
v_sin_f32 v113, v99
v_add_u32 v99, 34, v97
v_mul_u32_u24 v99, v99, v98
v_and_b32 v99, 63, v99
v_cvt_f32_u32 v99, v99
v_mul_f32 v99, 0x3c800000, v99
v_cos_f32 v106, v99
v_sin_f32 v114, v99
v_add_u32 v99, 35, v97
v_mul_u32_u24 v99, v99, v98
v_and_b32 v99, 63, v99
v_cvt_f32_u32 v99, v99
v_mul_f32 v99, 0x3c800000, v99
v_cos_f32 v107, v99
v_sin_f32 v115, v99
v_add_u32 v99, 48, v97
v_mul_u32_u24 v99, v99, v98
v_and_b32 v99, 63, v99
v_cvt_f32_u32 v99, v99
v_mul_f32 v99, 0x3c800000, v99
v_cos_f32 v108, v99
v_sin_f32 v116, v99
v_add_u32 v99, 49, v97
v_mul_u32_u24 v99, v99, v98
v_and_b32 v99, 63, v99
v_cvt_f32_u32 v99, v99
v_mul_f32 v99, 0x3c800000, v99
v_cos_f32 v109, v99
v_sin_f32 v117, v99
v_add_u32 v99, 50, v97
v_mul_u32_u24 v99, v99, v98
v_and_b32 v99, 63, v99
v_cvt_f32_u32 v99, v99
v_mul_f32 v99, 0x3c800000, v99
v_cos_f32 v110, v99
v_sin_f32 v118, v99
v_add_u32 v99, 51, v97
v_mul_u32_u24 v99, v99, v98
v_and_b32 v99, 63, v99
v_cvt_f32_u32 v99, v99
v_mul_f32 v99, 0x3c800000, v99
v_cos_f32 v111, v99
v_sin_f32 v119, v99
v_cvt_pk_bf16_f32 v20, v104, v105
v_cvt_pk_bf16_f32 v28, v112, v113
v_xor_b32 v36, 0x80008000, v28
v_cvt_pk_bf16_f32 v21, v106, v107
v_cvt_pk_bf16_f32 v29, v114, v115
v_xor_b32 v37, 0x80008000, v29
v_cvt_pk_bf16_f32 v22, v108, v109
v_cvt_pk_bf16_f32 v30, v116, v117
v_xor_b32 v38, 0x80008000, v30
v_cvt_pk_bf16_f32 v23, v110, v111
v_cvt_pk_bf16_f32 v31, v118, v119
v_xor_b32 v39, 0x80008000, v31
v_add_u32 v99, 0, v97
v_mul_u32_u24 v99, v99, v98
v_and_b32 v99, 2047, v99
v_cvt_f32_u32 v99, v99
v_mul_f32 v99, 0x3a000000, v99
v_cos_f32 v64, v99
v_sin_f32 v72, v99
v_add_u32 v99, 1, v97
v_mul_u32_u24 v99, v99, v98
v_and_b32 v99, 2047, v99
v_cvt_f32_u32 v99, v99
v_mul_f32 v99, 0x3a000000, v99
v_cos_f32 v65, v99
v_sin_f32 v73, v99
v_add_u32 v99, 2, v97
v_mul_u32_u24 v99, v99, v98
v_and_b32 v99, 2047, v99
v_cvt_f32_u32 v99, v99
v_mul_f32 v99, 0x3a000000, v99
v_cos_f32 v66, v99
v_sin_f32 v74, v99
v_add_u32 v99, 3, v97
v_mul_u32_u24 v99, v99, v98
v_and_b32 v99, 2047, v99
v_cvt_f32_u32 v99, v99
v_mul_f32 v99, 0x3a000000, v99
v_cos_f32 v67, v99
v_sin_f32 v75, v99
v_add_u32 v99, 16, v97
v_mul_u32_u24 v99, v99, v98
v_and_b32 v99, 2047, v99
v_cvt_f32_u32 v99, v99
v_mul_f32 v99, 0x3a000000, v99
v_cos_f32 v68, v99
v_sin_f32 v76, v99
v_add_u32 v99, 17, v97
v_mul_u32_u24 v99, v99, v98
v_and_b32 v99, 2047, v99
v_cvt_f32_u32 v99, v99
v_mul_f32 v99, 0x3a000000, v99
v_cos_f32 v69, v99
v_sin_f32 v77, v99
v_add_u32 v99, 18, v97
v_mul_u32_u24 v99, v99, v98
v_and_b32 v99, 2047, v99
v_cvt_f32_u32 v99, v99
v_mul_f32 v99, 0x3a000000, v99
v_cos_f32 v70, v99
v_sin_f32 v78, v99
v_add_u32 v99, 19, v97
v_mul_u32_u24 v99, v99, v98
v_and_b32 v99, 2047, v99
v_cvt_f32_u32 v99, v99
v_mul_f32 v99, 0x3a000000, v99
v_cos_f32 v71, v99
v_sin_f32 v79, v99
v_lshl_add_u32 v100, s13, 4, v97
v_add_u32 v98, 0, v96
v_add_u32 v99, 0, v97
v_mul_u32_u24 v99, v99, v98
v_and_b32 v99, 31, v99
v_cvt_f32_u32 v99, v99
v_mul_f32 v99, 0x3d000000, v99
v_cos_f32 v104, v99
v_sin_f32 v112, v99
v_add_u32 v99, 1, v97
v_mul_u32_u24 v99, v99, v98
v_and_b32 v99, 31, v99
v_cvt_f32_u32 v99, v99
v_mul_f32 v99, 0x3d000000, v99
v_cos_f32 v105, v99
v_sin_f32 v113, v99
v_add_u32 v99, 2, v97
v_mul_u32_u24 v99, v99, v98
v_and_b32 v99, 31, v99
v_cvt_f32_u32 v99, v99
v_mul_f32 v99, 0x3d000000, v99
v_cos_f32 v106, v99
v_sin_f32 v114, v99
v_add_u32 v99, 3, v97
v_mul_u32_u24 v99, v99, v98
v_and_b32 v99, 31, v99
v_cvt_f32_u32 v99, v99
v_mul_f32 v99, 0x3d000000, v99
v_cos_f32 v107, v99
v_sin_f32 v115, v99
v_add_u32 v99, 16, v97
v_mul_u32_u24 v99, v99, v98
v_and_b32 v99, 31, v99
v_cvt_f32_u32 v99, v99
v_mul_f32 v99, 0x3d000000, v99
v_cos_f32 v108, v99
v_sin_f32 v116, v99
v_add_u32 v99, 17, v97
v_mul_u32_u24 v99, v99, v98
v_and_b32 v99, 31, v99
v_cvt_f32_u32 v99, v99
v_mul_f32 v99, 0x3d000000, v99
v_cos_f32 v109, v99
v_sin_f32 v117, v99
v_add_u32 v99, 18, v97
v_mul_u32_u24 v99, v99, v98
v_and_b32 v99, 31, v99
v_cvt_f32_u32 v99, v99
v_mul_f32 v99, 0x3d000000, v99
v_cos_f32 v110, v99
v_sin_f32 v118, v99
v_add_u32 v99, 19, v97
v_mul_u32_u24 v99, v99, v98
v_and_b32 v99, 31, v99
v_cvt_f32_u32 v99, v99
v_mul_f32 v99, 0x3d000000, v99
v_cos_f32 v111, v99
v_sin_f32 v119, v99
v_cvt_pk_bf16_f32 v40, v104, v105
v_cvt_pk_bf16_f32 v48, v112, v113
v_xor_b32 v56, 0x80008000, v48
v_cvt_pk_bf16_f32 v41, v106, v107
v_cvt_pk_bf16_f32 v49, v114, v115
v_xor_b32 v57, 0x80008000, v49
v_cvt_pk_bf16_f32 v42, v108, v109
v_cvt_pk_bf16_f32 v50, v116, v117
v_xor_b32 v58, 0x80008000, v50
v_cvt_pk_bf16_f32 v43, v110, v111
v_cvt_pk_bf16_f32 v51, v118, v119
v_xor_b32 v59, 0x80008000, v51
v_add_u32 v99, 0, v100
v_mul_u32_u24 v99, v99, v98
v_and_b32 v99, 2047, v99
v_cvt_f32_u32 v99, v99
v_mul_f32 v99, 0x3a000000, v99
v_cos_f32 v80, v99
v_sin_f32 v88, v99
v_mul_f32 v80, 0x3a000000, v80
v_mul_f32 v88, 0x3a000000, v88
v_add_u32 v99, 1, v100
v_mul_u32_u24 v99, v99, v98
v_and_b32 v99, 2047, v99
v_cvt_f32_u32 v99, v99
v_mul_f32 v99, 0x3a000000, v99
v_cos_f32 v81, v99
v_sin_f32 v89, v99
v_mul_f32 v81, 0x3a000000, v81
v_mul_f32 v89, 0x3a000000, v89
v_add_u32 v99, 2, v100
v_mul_u32_u24 v99, v99, v98
v_and_b32 v99, 2047, v99
v_cvt_f32_u32 v99, v99
v_mul_f32 v99, 0x3a000000, v99
v_cos_f32 v82, v99
v_sin_f32 v90, v99
v_mul_f32 v82, 0x3a000000, v82
v_mul_f32 v90, 0x3a000000, v90
v_add_u32 v99, 3, v100
v_mul_u32_u24 v99, v99, v98
v_and_b32 v99, 2047, v99
v_cvt_f32_u32 v99, v99
v_mul_f32 v99, 0x3a000000, v99
v_cos_f32 v83, v99
v_sin_f32 v91, v99
v_mul_f32 v83, 0x3a000000, v83
v_mul_f32 v91, 0x3a000000, v91
v_add_u32 v98, 16, v96
v_add_u32 v99, 0, v97
v_mul_u32_u24 v99, v99, v98
v_and_b32 v99, 31, v99
v_cvt_f32_u32 v99, v99
v_mul_f32 v99, 0x3d000000, v99
v_cos_f32 v104, v99
v_sin_f32 v112, v99
v_add_u32 v99, 1, v97
v_mul_u32_u24 v99, v99, v98
v_and_b32 v99, 31, v99
v_cvt_f32_u32 v99, v99
v_mul_f32 v99, 0x3d000000, v99
v_cos_f32 v105, v99
v_sin_f32 v113, v99
v_add_u32 v99, 2, v97
v_mul_u32_u24 v99, v99, v98
v_and_b32 v99, 31, v99
v_cvt_f32_u32 v99, v99
v_mul_f32 v99, 0x3d000000, v99
v_cos_f32 v106, v99
v_sin_f32 v114, v99
v_add_u32 v99, 3, v97
v_mul_u32_u24 v99, v99, v98
v_and_b32 v99, 31, v99
v_cvt_f32_u32 v99, v99
v_mul_f32 v99, 0x3d000000, v99
v_cos_f32 v107, v99
v_sin_f32 v115, v99
v_add_u32 v99, 16, v97
v_mul_u32_u24 v99, v99, v98
v_and_b32 v99, 31, v99
v_cvt_f32_u32 v99, v99
v_mul_f32 v99, 0x3d000000, v99
v_cos_f32 v108, v99
v_sin_f32 v116, v99
v_add_u32 v99, 17, v97
v_mul_u32_u24 v99, v99, v98
v_and_b32 v99, 31, v99
v_cvt_f32_u32 v99, v99
v_mul_f32 v99, 0x3d000000, v99
v_cos_f32 v109, v99
v_sin_f32 v117, v99
v_add_u32 v99, 18, v97
v_mul_u32_u24 v99, v99, v98
v_and_b32 v99, 31, v99
v_cvt_f32_u32 v99, v99
v_mul_f32 v99, 0x3d000000, v99
v_cos_f32 v110, v99
v_sin_f32 v118, v99
v_add_u32 v99, 19, v97
v_mul_u32_u24 v99, v99, v98
v_and_b32 v99, 31, v99
v_cvt_f32_u32 v99, v99
v_mul_f32 v99, 0x3d000000, v99
v_cos_f32 v111, v99
v_sin_f32 v119, v99
v_cvt_pk_bf16_f32 v44, v104, v105
v_cvt_pk_bf16_f32 v52, v112, v113
v_xor_b32 v60, 0x80008000, v52
v_cvt_pk_bf16_f32 v45, v106, v107
v_cvt_pk_bf16_f32 v53, v114, v115
v_xor_b32 v61, 0x80008000, v53
v_cvt_pk_bf16_f32 v46, v108, v109
v_cvt_pk_bf16_f32 v54, v116, v117
v_xor_b32 v62, 0x80008000, v54
v_cvt_pk_bf16_f32 v47, v110, v111
v_cvt_pk_bf16_f32 v55, v118, v119
v_xor_b32 v63, 0x80008000, v55
v_add_u32 v99, 0, v100
v_mul_u32_u24 v99, v99, v98
v_and_b32 v99, 2047, v99
v_cvt_f32_u32 v99, v99
v_mul_f32 v99, 0x3a000000, v99
v_cos_f32 v84, v99
v_sin_f32 v92, v99
v_mul_f32 v84, 0x3a000000, v84
v_mul_f32 v92, 0x3a000000, v92
v_add_u32 v99, 1, v100
v_mul_u32_u24 v99, v99, v98
v_and_b32 v99, 2047, v99
v_cvt_f32_u32 v99, v99
v_mul_f32 v99, 0x3a000000, v99
v_cos_f32 v85, v99
v_sin_f32 v93, v99
v_mul_f32 v85, 0x3a000000, v85
v_mul_f32 v93, 0x3a000000, v93
v_add_u32 v99, 2, v100
v_mul_u32_u24 v99, v99, v98
v_and_b32 v99, 2047, v99
v_cvt_f32_u32 v99, v99
v_mul_f32 v99, 0x3a000000, v99
v_cos_f32 v86, v99
v_sin_f32 v94, v99
v_mul_f32 v86, 0x3a000000, v86
v_mul_f32 v94, 0x3a000000, v94
v_add_u32 v99, 3, v100
v_mul_u32_u24 v99, v99, v98
v_and_b32 v99, 2047, v99
v_cvt_f32_u32 v99, v99
v_mul_f32 v99, 0x3a000000, v99
v_cos_f32 v87, v99
v_sin_f32 v95, v99
v_mul_f32 v87, 0x3a000000, v87
v_mul_f32 v95, 0x3a000000, v95
v_lshrrev_b32 v98, 6, v0
v_and_b32 v99, 7, v98
v_lshlrev_b32 v99, 5, v99
v_lshl_add_u32 v98, v98, 8, v99
v_and_b32 v99, 16, v0
v_add_u32 v98, v98, v99
v_bfe_u32 v99, v0, 5, 1
v_lshl_add_u32 v224, v99, 3, v98
v_xor_b32 v225, 32, v224
v_xor_b32 v226, 64, v224
v_xor_b32 v227, 96, v224
v_xor_b32 v228, 128, v224
v_xor_b32 v229, 160, v224
v_xor_b32 v230, 192, v224
v_xor_b32 v231, 224, v224
v_lshrrev_b32 v98, 8, v0
v_bfe_u32 v99, v0, 5, 3
v_xor_b32 v99, v99, v98
v_mul_u32_u24 v98, 40960, v98
v_and_b32 v96, 16, v0
v_add_u32 v98, v98, v96
v_and_b32 v96, 3, v99
v_lshl_add_u32 v98, v96, 5, v98
v_lshrrev_b32 v99, 2, v99
v_lshl_add_u32 v232, v99, 10, v98
v_xor_b32 v99, 1, v99
v_lshl_add_u32 v233, v99, 10, v98
s_lshl_b32 s18, s13, 12
s_add_u32 s19, s18, 147456
v_add_u32 v99, s19, v0
ds_read_b128 v[208:211], v99 offset:0
ds_read_b128 v[212:215], v99 offset:1024
ds_read_b128 v[216:219], v99 offset:2048
ds_read_b128 v[220:223], v99 offset:3072
s_mov_b32 s25, s18
s_mul_i32 s26, s16, 3145728
s_mul_i32 s19, s13, 655360
s_add_u32 s26, s26, s19
s_lshl_b32 s19, s39, 8
s_add_u32 s27, s26, s19
s_add_u32 s27, s27, 103809024
s_lshr_b32 s19, s39, 3
s_lshl_b32 s19, s19, 11
s_add_u32 s26, s26, s19
s_and_b32 s19, s39, 7
s_lshl_b32 s19, s19, 7
s_add_u32 s26, s26, s19
s_add_u32 s26, s26, 97517568
s_cmp_lg_u32 s16, 0
s_cbranch_scc1 cw_41
s_cmp_lg_u32 s13, 0
s_cbranch_scc1 polld_44
v_min_u32 v12, 624, v0
s_mov_b32 s21, 5120
s_mov_b32 s17, 0
poll_43:
buffer_load_dwordx4 v[8:11], v12, s[4:7], s21 offen offset:0 sc1
s_add_u32 s17, s17, 1
s_cmp_gt_u32 s17, 262144
s_cbranch_scc1 L_fail
s_waitcnt vmcnt(0)
v_min3_u32 v8, v8, v9, v10
v_min_u32 v8, v8, v11
v_cmp_gt_u32 vcc, 1, v8
s_cbranch_vccz polld_44
s_sleep 2
s_branch poll_43
polld_44:
s_barrier
s_branch cw_42
cw_41:
s_cmp_lg_u32 s13, 0
s_cbranch_scc1 polld_46
v_lshrrev_b32 v12, 2, v0
v_min_u32 v12, 136, v12
s_mov_b32 s21, 6144
s_mov_b32 s17, 0
poll_45:
buffer_load_dword v8, v12, s[4:7], s21 offen offset:0 sc1
s_add_u32 s17, s17, 1
s_cmp_gt_u32 s17, 262144
s_cbranch_scc1 L_fail
s_waitcnt vmcnt(0)
v_cmp_gt_u32 vcc, 1, v8
s_cbranch_vccz polld_46
s_sleep 2
s_branch poll_45
polld_46:
s_barrier
cw_42:
s_add_u32 m0, s25, 0
s_add_u32 s20, s26, 0
buffer_load_dwordx4 v232, s[4:7], s20 offen sc1 lds
s_add_u32 m0, s25, 1024
s_add_u32 s20, s26, 163840
buffer_load_dwordx4 v233, s[4:7], s20 offen sc1 lds
s_add_u32 m0, s25, 2048
s_add_u32 s20, s26, 327680
buffer_load_dwordx4 v232, s[4:7], s20 offen sc1 lds
s_add_u32 m0, s25, 3072
s_add_u32 s20, s26, 491520
buffer_load_dwordx4 v233, s[4:7], s20 offen sc1 lds
s_lshr_b32 s18, s13, 1
s_lshl_b32 s18, s18, 10
s_and_b32 s19, s13, 1
s_lshl_b32 s19, s19, 3
s_add_u32 s18, s18, s19
v_add_u32 v234, s18, v0
v_bfe_u32 v235, v0, 4, 4
v_mul_u32_u24 v235, 40960, v235
v_lshrrev_b32 v99, 8, v0
v_lshl_add_u32 v235, v99, 4, v235
s_waitcnt vmcnt(0)
s_barrier
ds_read_b64_tr_b16 v[96:97], v224 offset:0
ds_read_b64_tr_b16 v[98:99], v224 offset:4096
ds_read_b64_tr_b16 v[114:115], v225 offset:4096
ds_read_b64_tr_b16 v[112:113], v225 offset:0
ds_read_b64_tr_b16 v[118:119], v225 offset:12288
ds_read_b64_tr_b16 v[102:103], v224 offset:12288
ds_read_b64_tr_b16 v[124:125], v229 offset:8192
ds_read_b64_tr_b16 v[100:101], v224 offset:8192
ds_read_b64_tr_b16 v[116:117], v225 offset:8192
ds_read_b64_tr_b16 v[120:121], v229 offset:0
ds_read_b64_tr_b16 v[122:123], v229 offset:4096
ds_read_b64_tr_b16 v[106:107], v228 offset:4096
ds_read_b64_tr_b16 v[142:143], v230 offset:12288
ds_read_b64_tr_b16 v[110:111], v228 offset:12288
ds_read_b64_tr_b16 v[104:105], v228 offset:0
ds_read_b64_tr_b16 v[156:157], v231 offset:8192
s_waitcnt lgkmcnt(14)
v_mfma_f32_16x16x32_bf16 v[160:163], v[96:99], v[16:19], 0
s_waitcnt lgkmcnt(13)
ds_read_b64_tr_b16 v[126:127], v229 offset:12288
s_waitcnt lgkmcnt(13)
v_mfma_f32_16x16x32_bf16 v[168:171], v[112:115], v[16:19], 0
s_waitcnt lgkmcnt(12)
ds_read_b64_tr_b16 v[108:109], v228 offset:8192
ds_read_b64_tr_b16 v[132:133], v226 offset:8192
v_mfma_f32_16x16x32_bf16 v[160:163], v[112:115], v[24:27], v[160:163]
ds_read_b64_tr_b16 v[146:147], v227 offset:4096
ds_read_b64_tr_b16 v[138:139], v230 offset:4096
v_mfma_f32_16x16x32_bf16 v[168:171], v[96:99], v[32:35], v[168:171]
s_waitcnt lgkmcnt(13)
ds_read_b64_tr_b16 v[154:155], v231 offset:4096
ds_read_b64_tr_b16 v[136:137], v230 offset:0
v_mfma_f32_16x16x32_bf16 v[160:163], v[100:103], v[20:23], v[160:163]
s_waitcnt lgkmcnt(12)
ds_read_b64_tr_b16 v[128:129], v226 offset:0
v_and_b32 v112, 0xffff0000, v208
v_mfma_f32_16x16x32_bf16 v[160:163], v[116:119], v[28:31], v[160:163]
ds_read_b64_tr_b16 v[158:159], v231 offset:12288
ds_read_b64_tr_b16 v[130:131], v226 offset:4096
v_mfma_f32_16x16x32_bf16 v[168:171], v[116:119], v[20:23], v[168:171]
ds_read_b64_tr_b16 v[150:151], v227 offset:12288
v_lshlrev_b32 v98, 16, v209
v_mfma_f32_16x16x32_bf16 v[168:171], v[100:103], v[36:39], v[168:171]
s_waitcnt lgkmcnt(12)
ds_read_b64_tr_b16 v[144:145], v227 offset:0
v_mul_f32 v232, v160, v72
v_mfma_f32_16x16x32_bf16 v[172:175], v[120:123], v[16:19], 0
s_waitcnt lgkmcnt(9)
ds_read_b64_tr_b16 v[148:149], v227 offset:8192
ds_read_b64_tr_b16 v[134:135], v226 offset:12288
v_mfma_f32_16x16x32_bf16 v[172:175], v[104:107], v[32:35], v[172:175]
v_and_b32 v113, 0xffff0000, v216
v_mul_f32 v160, v160, v64
v_mfma_f32_16x16x32_bf16 v[164:167], v[104:107], v[16:19], 0
s_waitcnt lgkmcnt(7)
v_mul_f32 v233, v161, v73
v_fma_f32 v160, v168, v72, v160
v_mfma_f32_16x16x32_bf16 v[172:175], v[124:127], v[20:23], v[172:175]
s_waitcnt lgkmcnt(6)
ds_read_b64_tr_b16 v[140:141], v230 offset:8192
v_fma_f32 v168, v168, v64, -v232
v_mfma_f32_16x16x32_bf16 v[172:175], v[108:111], v[36:39], v[172:175]
v_mul_f32 v232, v162, v74
v_mul_f32 v161, v161, v65
v_mfma_f32_16x16x32_bf16 v[164:167], v[120:123], v[24:27], v[164:167]
ds_read_b64_tr_b16 v[152:153], v231 offset:0
v_fma_f32 v161, v169, v73, v161
v_mfma_f32_16x16x32_bf16 v[164:167], v[108:111], v[20:23], v[164:167]
v_fma_f32 v169, v169, v65, -v233
v_mul_f32 v233, v163, v75
v_mfma_f32_16x16x32_bf16 v[164:167], v[124:127], v[28:31], v[164:167]
s_waitcnt lgkmcnt(4)
v_mul_f32 v162, v162, v66
v_mul_f32 v163, v163, v67
v_mfma_f32_16x16x32_bf16 v[180:183], v[136:139], v[16:19], 0
s_waitcnt lgkmcnt(2)
v_fma_f32 v163, v171, v75, v163
v_fma_f32 v162, v170, v74, v162
v_mfma_f32_16x16x32_bf16 v[184:187], v[144:147], v[16:19], 0
s_waitcnt lgkmcnt(0)
v_fma_f32 v171, v171, v67, -v233
v_mul_f32 v233, v165, v77
v_mfma_f32_16x16x32_bf16 v[188:191], v[152:155], v[16:19], 0
v_fma_f32 v170, v170, v66, -v232
v_cvt_pk_bf16_f32 v193, v162, v163
v_mfma_f32_16x16x32_bf16 v[176:179], v[128:131], v[16:19], 0
v_mul_f32 v232, v164, v76
v_mul_f32 v164, v164, v68
v_mfma_f32_16x16x32_bf16 v[184:187], v[128:131], v[32:35], v[184:187]
v_fma_f32 v164, v172, v76, v164
v_fma_f32 v172, v172, v68, -v232
v_mfma_f32_16x16x32_bf16 v[184:187], v[148:151], v[20:23], v[184:187]
v_mul_f32 v165, v165, v69
v_fma_f32 v165, v173, v77, v165
v_mfma_f32_16x16x32_bf16 v[176:179], v[144:147], v[24:27], v[176:179]
v_mul_f32 v232, v166, v78
v_lshlrev_b32 v100, 16, v210
v_mfma_f32_16x16x32_bf16 v[176:179], v[132:135], v[20:23], v[176:179]
v_fma_f32 v173, v173, v69, -v233
v_mul_f32 v233, v167, v79
v_mfma_f32_16x16x32_bf16 v[176:179], v[148:151], v[28:31], v[176:179]
v_cvt_pk_bf16_f32 v194, v164, v165
v_mul_f32 v166, v166, v70
v_mfma_f32_16x16x32_bf16 v[180:183], v[152:155], v[24:27], v[180:183]
v_mul_f32 v167, v167, v71
v_fma_f32 v166, v174, v78, v166
v_mfma_f32_16x16x32_bf16 v[180:183], v[140:143], v[20:23], v[180:183]
v_fma_f32 v167, v175, v79, v167
v_cvt_pk_bf16_f32 v196, v168, v169
v_mfma_f32_16x16x32_bf16 v[184:187], v[132:135], v[36:39], v[184:187]
v_cvt_pk_bf16_f32 v192, v160, v161
v_fma_f32 v174, v174, v70, -v232
v_mfma_f32_16x16x32_bf16 v[188:191], v[136:139], v[32:35], v[188:191]
v_cvt_pk_bf16_f32 v198, v172, v173
v_fma_f32 v175, v175, v71, -v233
v_mfma_f32_16x16x32_bf16 v[180:183], v[156:159], v[28:31], v[180:183]
v_cvt_pk_bf16_f32 v197, v170, v171
v_cvt_pk_bf16_f32 v199, v174, v175
v_mfma_f32_16x16x32_bf16 v[188:191], v[156:159], v[20:23], v[188:191]
v_mul_f32 v233, v177, v73
v_mul_f32 v177, v177, v65
v_mfma_f32_16x16x32_bf16 v[168:171], v[40:43], v[196:199], 0
v_cvt_pk_bf16_f32 v195, v166, v167
v_mul_f32 v232, v176, v72
v_mfma_f32_16x16x32_bf16 v[172:175], v[44:47], v[196:199], 0
v_mul_f32 v176, v176, v64
v_fma_f32 v177, v185, v73, v177
v_mfma_f32_16x16x32_bf16 v[188:191], v[140:143], v[36:39], v[188:191]
v_lshlrev_b32 v97, 16, v216
v_fma_f32 v176, v184, v72, v176
v_mfma_f32_16x16x32_bf16 v[168:171], v[56:59], v[192:195], v[168:171]
v_fma_f32 v184, v184, v64, -v232
v_mul_f32 v232, v178, v74
v_mfma_f32_16x16x32_bf16 v[160:163], v[40:43], v[192:195], 0
v_fma_f32 v185, v185, v65, -v233
v_mul_f32 v178, v178, v66
v_mfma_f32_16x16x32_bf16 v[160:163], v[48:51], v[196:199], v[160:163]
v_fma_f32 v178, v186, v74, v178
v_fma_f32 v186, v186, v66, -v232
v_mfma_f32_16x16x32_bf16 v[164:167], v[44:47], v[192:195], 0
v_mul_f32 v232, v180, v76
v_mul_f32 v180, v180, v68
v_mul_f32 v233, v179, v75
v_mfma_f32_16x16x32_bf16 v[172:175], v[60:63], v[192:195], v[172:175]
v_mul_f32 v179, v179, v67
v_cvt_pk_bf16_f32 v200, v176, v177
v_mfma_f32_16x16x32_bf16 v[164:167], v[52:55], v[196:199], v[164:167]
v_fma_f32 v179, v187, v75, v179
v_fma_f32 v187, v187, v67, -v233
v_fma_f32 v180, v188, v76, v180
v_mul_f32 v233, v181, v77
v_cvt_pk_bf16_f32 v204, v184, v185
v_mul_f32 v181, v181, v69
v_lshlrev_b32 v102, 16, v211
v_fma_f32 v188, v188, v68, -v232
v_cvt_pk_bf16_f32 v205, v186, v187
v_mul_f32 v232, v182, v78
v_cvt_pk_bf16_f32 v201, v178, v179
v_mul_f32 v182, v182, v70
v_fma_f32 v181, v189, v77, v181
v_fma_f32 v189, v189, v69, -v233
v_mul_f32 v233, v183, v79
v_fma_f32 v182, v190, v78, v182
v_cvt_pk_bf16_f32 v202, v180, v181
v_lshlrev_b32 v99, 16, v217
v_mul_f32 v183, v183, v71
v_fma_f32 v183, v191, v79, v183
v_cvt_pk_bf16_f32 v203, v182, v183
v_lshlrev_b32 v106, 16, v213
v_fma_f32 v191, v191, v71, -v233
v_fma_f32 v190, v190, v70, -v232
v_lshlrev_b32 v96, 16, v208
v_mfma_f32_16x16x32_bf16 v[176:179], v[40:43], v[200:203], 0
v_cvt_pk_bf16_f32 v207, v190, v191
v_lshlrev_b32 v103, 16, v219
v_mfma_f32_16x16x32_bf16 v[180:183], v[44:47], v[200:203], 0
v_mul_f32 v232, v160, v97
v_cvt_pk_bf16_f32 v206, v188, v189
v_mul_f32 v233, v161, v99
v_mul_f32 v161, v161, v98
v_mfma_f32_16x16x32_bf16 v[188:191], v[44:47], v[204:207], 0
v_and_b32 v117, 0xffff0000, v218
v_lshlrev_b32 v105, 16, v220
v_mfma_f32_16x16x32_bf16 v[184:187], v[40:43], v[204:207], 0
v_lshlrev_b32 v104, 16, v212
v_lshlrev_b32 v109, 16, v222
v_mfma_f32_16x16x32_bf16 v[180:183], v[52:55], v[204:207], v[180:183]
v_lshlrev_b32 v101, 16, v218
v_lshlrev_b32 v107, 16, v221
v_fma_f32 v161, v169, -v99, v161
v_mfma_f32_16x16x32_bf16 v[184:187], v[56:59], v[200:203], v[184:187]
v_lshlrev_b32 v108, 16, v214
v_lshlrev_b32 v111, 16, v223
v_fma_f32 v169, v169, v98, v233
v_mul_f32 v160, v160, v96
v_fma_f32 v160, v168, -v97, v160
v_fma_f32 v168, v168, v96, v232
v_mul_f32 v233, v163, v103
v_mul_f32 v232, v162, v101
v_mfma_f32_16x16x32_bf16 v[176:179], v[48:51], v[204:207], v[176:179]
v_mul_f32 v162, v162, v100
v_fma_f32 v162, v170, -v101, v162
v_mul_f32 v163, v163, v102
v_fma_f32 v163, v171, -v103, v163
v_cvt_pk_bf16_f32 v193, v162, v163
v_mfma_f32_16x16x32_bf16 v[188:191], v[60:63], v[200:203], v[188:191]
v_fma_f32 v170, v170, v100, v232
v_fma_f32 v171, v171, v102, v233
v_mul_f32 v233, v165, v107
v_mul_f32 v232, v164, v105
v_lshlrev_b32 v110, 16, v215
v_cvt_pk_bf16_f32 v192, v160, v161
v_cvt_pk_bf16_f32 v197, v170, v171
v_mul_f32 v165, v165, v106
v_mul_f32 v164, v164, v104
v_fma_f32 v164, v172, -v105, v164
v_fma_f32 v165, v173, -v107, v165
v_fma_f32 v172, v172, v104, v232
v_fma_f32 v173, v173, v106, v233
v_mul_f32 v232, v166, v109
v_cvt_pk_bf16_f32 v194, v164, v165
v_mul_f32 v233, v167, v111
v_mul_f32 v167, v167, v110
v_fma_f32 v167, v175, -v111, v167
v_mul_f32 v166, v166, v108
v_fma_f32 v166, v174, -v109, v166
v_cvt_pk_bf16_f32 v195, v166, v167
v_fma_f32 v175, v175, v110, v233
v_cvt_pk_bf16_f32 v198, v172, v173
v_mfma_f32_16x16x32_bf16 v[160:163], v[192:195], v[40:43], 0
v_fma_f32 v174, v174, v108, v232
v_cvt_pk_bf16_f32 v196, v168, v169
v_cvt_pk_bf16_f32 v199, v174, v175
v_and_b32 v115, 0xffff0000, v217
v_and_b32 v114, 0xffff0000, v209
v_mfma_f32_16x16x32_bf16 v[164:167], v[192:195], v[44:47], 0
v_and_b32 v119, 0xffff0000, v219
v_mul_f32 v232, v176, v113
v_and_b32 v127, 0xffff0000, v223
v_mul_f32 v233, v177, v115
v_mfma_f32_16x16x32_bf16 v[172:175], v[196:199], v[44:47], 0
v_mul_f32 v176, v176, v112
v_and_b32 v118, 0xffff0000, v211
v_mfma_f32_16x16x32_bf16 v[160:163], v[196:199], v[56:59], v[160:163]
v_and_b32 v121, 0xffff0000, v220
v_and_b32 v116, 0xffff0000, v210
v_and_b32 v124, 0xffff0000, v214
v_mul_f32 v177, v177, v114
v_fma_f32 v176, v184, -v113, v176
v_mfma_f32_16x16x32_bf16 v[168:171], v[196:199], v[40:43], 0
v_fma_f32 v177, v185, -v115, v177
v_fma_f32 v184, v184, v112, v232
v_mfma_f32_16x16x32_bf16 v[172:175], v[192:195], v[52:55], v[172:175]
v_fma_f32 v185, v185, v114, v233
v_mul_f32 v232, v178, v117
v_mfma_f32_16x16x32_bf16 v[164:167], v[196:199], v[60:63], v[164:167]
v_mul_f32 v178, v178, v116
v_cvt_pk_bf16_f32 v200, v176, v177
v_mfma_f32_16x16x32_bf16 v[168:171], v[192:195], v[48:51], v[168:171]
v_and_b32 v123, 0xffff0000, v221
v_mul_f32 v233, v179, v119
v_mul_f32 v179, v179, v118
v_and_b32 v122, 0xffff0000, v213
v_fma_f32 v179, v187, -v119, v179
v_fma_f32 v187, v187, v118, v233
v_fma_f32 v178, v186, -v117, v178
v_mul_f32 v233, v181, v123
v_and_b32 v126, 0xffff0000, v215
v_and_b32 v120, 0xffff0000, v212
v_fma_f32 v186, v186, v116, v232
v_and_b32 v125, 0xffff0000, v222
v_cvt_pk_bf16_f32 v205, v186, v187
v_mul_f32 v181, v181, v122
v_fma_f32 v181, v189, -v123, v181
v_fma_f32 v189, v189, v122, v233
v_mul_f32 v232, v180, v121
v_mul_f32 v180, v180, v120
v_mul_f32 v233, v183, v127
v_mul_f32 v183, v183, v126
v_fma_f32 v183, v191, -v127, v183
v_fma_f32 v180, v188, -v121, v180
v_fma_f32 v191, v191, v126, v233
v_fma_f32 v188, v188, v120, v232
v_mul_f32 v232, v182, v125
v_mul_f32 v233, v161, v89
v_mul_f32 v182, v182, v124
v_fma_f32 v182, v190, -v125, v182
v_cvt_pk_bf16_f32 v206, v188, v189
v_cvt_pk_bf16_f32 v204, v184, v185
v_cvt_pk_bf16_f32 v201, v178, v179
v_fma_f32 v190, v190, v124, v232
v_cvt_pk_bf16_f32 v207, v190, v191
v_mul_f32 v232, v160, v88
v_mul_f32 v160, v160, v80
v_mfma_f32_16x16x32_bf16 v[188:191], v[204:207], v[44:47], 0
v_fma_f32 v160, v168, -v88, v160
v_fma_f32 v168, v168, v80, v232
v_mul_f32 v232, v162, v90
v_mul_f32 v161, v161, v81
v_cvt_pk_bf16_f32 v203, v182, v183
v_mfma_f32_16x16x32_bf16 v[184:187], v[204:207], v[40:43], 0
v_fma_f32 v161, v169, -v89, v161
v_cvt_pk_bf16_f32 v202, v180, v181
v_fma_f32 v169, v169, v81, v233
v_mul_f32 v162, v162, v82
v_mfma_f32_16x16x32_bf16 v[180:183], v[200:203], v[44:47], 0
v_fma_f32 v162, v170, -v90, v162
v_mul_f32 v233, v163, v91
v_mfma_f32_16x16x32_bf16 v[176:179], v[200:203], v[40:43], 0
v_fma_f32 v170, v170, v82, v232
v_mul_f32 v163, v163, v83
v_mfma_f32_16x16x32_bf16 v[184:187], v[200:203], v[48:51], v[184:187]
v_fma_f32 v163, v171, -v91, v163
v_mul_f32 v232, v164, v92
v_mul_f32 v164, v164, v84
v_mfma_f32_16x16x32_bf16 v[176:179], v[204:207], v[56:59], v[176:179]
v_fma_f32 v171, v171, v83, v233
v_fma_f32 v164, v172, -v92, v164
v_mul_f32 v233, v165, v93
v_mul_f32 v165, v165, v85
v_fma_f32 v165, v173, -v93, v165
v_cvt_pk_bf16_f32 v192, v160, v161
v_mfma_f32_16x16x32_bf16 v[188:191], v[200:203], v[52:55], v[188:191]
v_fma_f32 v173, v173, v85, v233
v_mul_f32 v233, v167, v95
v_mul_f32 v167, v167, v87
v_fma_f32 v172, v172, v84, v232
v_cvt_pk_bf16_f32 v196, v168, v169
v_mul_f32 v232, v166, v94
v_cvt_pk_bf16_f32 v193, v162, v163
v_fma_f32 v167, v175, -v95, v167
v_mul_f32 v166, v166, v86
v_fma_f32 v166, v174, -v94, v166
v_fma_f32 v174, v174, v86, v232
v_mul_f32 v232, v176, v88
v_mul_f32 v176, v176, v80
v_cvt_pk_bf16_f32 v197, v170, v171
v_cvt_pk_bf16_f32 v195, v166, v167
v_fma_f32 v175, v175, v87, v233
v_mul_f32 v233, v177, v89
v_cvt_pk_bf16_f32 v199, v174, v175
v_cvt_pk_bf16_f32 v198, v172, v173
v_fma_f32 v176, v184, -v88, v176
v_mul_f32 v177, v177, v81
v_fma_f32 v177, v185, -v89, v177
v_mfma_f32_16x16x32_bf16 v[180:183], v[204:207], v[60:63], v[180:183]
ds_write_b64 v234, v[198:199] offset:22528
ds_write_b64 v234, v[192:193] offset:16384
ds_write_b64 v234, v[196:197] offset:20480
v_fma_f32 v185, v185, v81, v233
v_fma_f32 v184, v184, v80, v232
v_cvt_pk_bf16_f32 v200, v176, v177
v_mul_f32 v232, v178, v90
v_mul_f32 v233, v179, v91
v_mul_f32 v179, v179, v83
v_mul_f32 v178, v178, v82
v_fma_f32 v179, v187, -v91, v179
v_fma_f32 v178, v186, -v90, v178
v_fma_f32 v186, v186, v82, v232
v_cvt_pk_bf16_f32 v194, v164, v165
v_fma_f32 v187, v187, v83, v233
v_mul_f32 v233, v181, v93
v_mul_f32 v181, v181, v85
v_mul_f32 v232, v180, v92
v_fma_f32 v181, v189, -v93, v181
v_cvt_pk_bf16_f32 v204, v184, v185
v_cvt_pk_bf16_f32 v201, v178, v179
v_fma_f32 v189, v189, v85, v233
v_mul_f32 v180, v180, v84
v_fma_f32 v180, v188, -v92, v180
v_cvt_pk_bf16_f32 v205, v186, v187
s_waitcnt lgkmcnt(0)
ds_write_b64 v234, v[204:205] offset:28672
ds_write_b64 v234, v[200:201] offset:24576
ds_write_b64 v234, v[194:195] offset:18432
v_fma_f32 v188, v188, v84, v232
v_mul_f32 v233, v183, v95
v_mul_f32 v183, v183, v87
v_mul_f32 v232, v182, v94
v_fma_f32 v183, v191, -v95, v183
v_fma_f32 v191, v191, v87, v233
v_mul_f32 v182, v182, v86
v_cvt_pk_bf16_f32 v206, v188, v189
v_fma_f32 v182, v190, -v94, v182
v_fma_f32 v190, v190, v86, v232
v_cvt_pk_bf16_f32 v202, v180, v181
v_cvt_pk_bf16_f32 v207, v190, v191
ds_write_b64 v234, v[206:207] offset:30720
v_cvt_pk_bf16_f32 v203, v182, v183
s_waitcnt lgkmcnt(0)
ds_write_b64 v234, v[202:203] offset:26624
s_waitcnt lgkmcnt(0)
s_barrier
ds_read_b128 v[96:99], v0 offset:16384
ds_read_b128 v[112:115], v0 offset:20480
ds_read_b128 v[128:131], v0 offset:24576
ds_read_b128 v[124:127], v0 offset:23552
ds_read_b128 v[144:147], v0 offset:28672
ds_read_b128 v[120:123], v0 offset:22528
s_waitcnt lgkmcnt(5)
v_mfma_f32_16x16x32_bf16 v[160:163], v[96:99], v[16:19], 0
ds_read_b128 v[100:103], v0 offset:17408
s_waitcnt lgkmcnt(5)
v_mfma_f32_16x16x32_bf16 v[168:171], v[112:115], v[16:19], 0
ds_read_b128 v[136:139], v0 offset:26624
v_mfma_f32_16x16x32_bf16 v[160:163], v[112:115], v[32:35], v[160:163]
ds_read_b128 v[148:151], v0 offset:29696
s_waitcnt lgkmcnt(6)
v_mfma_f32_16x16x32_bf16 v[176:179], v[128:131], v[16:19], 0
v_mfma_f32_16x16x32_bf16 v[168:171], v[96:99], v[24:27], v[168:171]
s_waitcnt lgkmcnt(4)
ds_read_b128 v[116:119], v0 offset:21504
ds_read_b128 v[132:135], v0 offset:25600
v_mfma_f32_16x16x32_bf16 v[176:179], v[144:147], v[32:35], v[176:179]
ds_read_b128 v[156:159], v0 offset:31744
v_mfma_f32_16x16x32_bf16 v[184:187], v[144:147], v[16:19], 0
s_waitcnt lgkmcnt(5)
ds_read_b128 v[104:107], v0 offset:18432
v_mfma_f32_16x16x32_bf16 v[184:187], v[128:131], v[24:27], v[184:187]
ds_read_b128 v[152:155], v0 offset:30720
s_waitcnt lgkmcnt(5)
v_mfma_f32_16x16x32_bf16 v[184:187], v[148:151], v[20:23], v[184:187]
s_waitcnt lgkmcnt(4)
v_mfma_f32_16x16x32_bf16 v[160:163], v[100:103], v[20:23], v[160:163]
v_mfma_f32_16x16x32_bf16 v[168:171], v[116:119], v[20:23], v[168:171]
ds_read_b128 v[108:111], v0 offset:19456
v_mfma_f32_16x16x32_bf16 v[172:175], v[120:123], v[16:19], 0
ds_read_b128 v[140:143], v0 offset:27648
s_waitcnt lgkmcnt(3)
v_mfma_f32_16x16x32_bf16 v[164:167], v[104:107], v[16:19], 0
v_mfma_f32_16x16x32_bf16 v[164:167], v[120:123], v[32:35], v[164:167]
v_mfma_f32_16x16x32_bf16 v[180:183], v[136:139], v[16:19], 0
v_mfma_f32_16x16x32_bf16 v[160:163], v[116:119], v[36:39], v[160:163]
s_waitcnt lgkmcnt(1)
s_nop 0
v_mfma_f32_16x16x32_bf16 v[180:183], v[152:155], v[32:35], v[180:183]
s_nop 2
v_mfma_f32_16x16x32_bf16 v[176:179], v[132:135], v[20:23], v[176:179]
s_nop 0
v_cvt_pk_bf16_f32 v193, v162, v163
v_mfma_f32_16x16x32_bf16 v[168:171], v[100:103], v[28:31], v[168:171]
v_mfma_f32_16x16x32_bf16 v[164:167], v[108:111], v[20:23], v[164:167]
v_mfma_f32_16x16x32_bf16 v[176:179], v[148:151], v[36:39], v[176:179]
v_cvt_pk_bf16_f32 v192, v160, v161
s_nop 0
v_mfma_f32_16x16x32_bf16 v[164:167], v[124:127], v[36:39], v[164:167]
s_nop 2
v_mfma_f32_16x16x32_bf16 v[172:175], v[104:107], v[24:27], v[172:175]
s_nop 0
v_cvt_pk_bf16_f32 v200, v176, v177
v_mfma_f32_16x16x32_bf16 v[172:175], v[124:127], v[20:23], v[172:175]
s_nop 0
v_cvt_pk_bf16_f32 v194, v164, v165
s_waitcnt lgkmcnt(0)
v_mfma_f32_16x16x32_bf16 v[180:183], v[140:143], v[20:23], v[180:183]
v_cvt_pk_bf16_f32 v195, v166, v167
v_mfma_f32_16x16x32_bf16 v[180:183], v[156:159], v[36:39], v[180:183]
v_cvt_pk_bf16_f32 v196, v168, v169
v_cvt_pk_bf16_f32 v201, v178, v179
v_mfma_f32_16x16x32_bf16 v[172:175], v[108:111], v[28:31], v[172:175]
buffer_store_dwordx4 v[192:195], v235, s[4:7], s27 offen offset:0 sc1
s_nop 1
v_mfma_f32_16x16x32_bf16 v[184:187], v[132:135], v[28:31], v[184:187]
s_nop 0
v_cvt_pk_bf16_f32 v202, v180, v181
v_mfma_f32_16x16x32_bf16 v[188:191], v[152:155], v[16:19], 0
s_nop 0
v_cvt_pk_bf16_f32 v198, v172, v173
v_cvt_pk_bf16_f32 v203, v182, v183
v_mfma_f32_16x16x32_bf16 v[188:191], v[136:139], v[24:27], v[188:191]
s_nop 0
v_cvt_pk_bf16_f32 v205, v186, v187
v_cvt_pk_bf16_f32 v204, v184, v185
v_mfma_f32_16x16x32_bf16 v[188:191], v[156:159], v[20:23], v[188:191]
v_cvt_pk_bf16_f32 v199, v174, v175
v_cvt_pk_bf16_f32 v197, v170, v171
v_mfma_f32_16x16x32_bf16 v[188:191], v[140:143], v[28:31], v[188:191]
buffer_store_dwordx4 v[196:199], v235, s[4:7], s27 offen offset:64 sc1
s_nop 2
buffer_store_dwordx4 v[200:203], v235, s[4:7], s27 offen offset:128 sc1
s_nop 2
v_cvt_pk_bf16_f32 v207, v190, v191
v_cvt_pk_bf16_f32 v206, v188, v189
buffer_store_dwordx4 v[204:207], v235, s[4:7], s27 offen offset:192 sc1
s_lshl_b32 s18, s39, 2
s_add_u32 s18, s18, 7168
s_add_u32 s29, s16, 1
s_cmp_eq_u32 s13, 0
s_cselect_b32 s22, s18, s6
s_mov_b32 s23, s29
s_lshl_b32 s18, s34, 7
s_lshl_b32 s19, s13, 5
s_add_u32 s18, s18, s19
s_mov_b32 s19, 0x3acccccd
v_bfe_u32 v222, v0, 4, 5
v_lshrrev_b32 v217, 9, v0
v_and_b32 v220, 19, v222
v_bfe_u32 v223, v222, 2, 1
v_lshl_add_u32 v220, v223, 3, v220
v_bfe_u32 v223, v222, 3, 1
v_lshl_add_u32 v220, v223, 2, v220
v_add_u32 v220, s18, v220
v_lshlrev_b32 v217, 2, v217
v_mov_b32 v221, 0
v_mad_u32_u24 v221, v217, v220, v221
v_mad_u32_u24 v216, v220, 8, 0
v_cvt_f32_u32 v216, v216
v_mul_f32 v222, s19, v216
v_rndne_f32 v222, v222
v_fmac_f32 v216, 0xc4200000, v222
v_mul_f32 v216, s19, v216
v_cos_f32 v216, v216
s_nop 0
v_add_f32 v216, v216, v216
v_mad_u32_u24 v218, v220, 1, 0
v_cvt_f32_u32 v218, v218
v_mul_f32 v222, s19, v218
v_rndne_f32 v222, v222
v_fmac_f32 v218, 0xc4200000, v222
v_mul_f32 v218, s19, v218
v_cos_f32 v218, v218
s_nop 0
v_add_f32 v218, v218, v218
v_mad_u32_u24 v200, v220, 1, v221
v_cvt_f32_u32 v200, v200
v_mul_f32 v222, s19, v200
v_rndne_f32 v222, v222
v_fmac_f32 v200, 0xc4200000, v222
v_mul_f32 v200, s19, v200
v_sin_f32 v201, -v200
v_cos_f32 v200, v200
v_mad_u32_u24 v202, v220, 2, v221
v_cvt_f32_u32 v202, v202
v_mul_f32 v222, s19, v202
v_rndne_f32 v222, v222
v_fmac_f32 v202, 0xc4200000, v222
v_mul_f32 v202, s19, v202
v_sin_f32 v203, -v202
v_cos_f32 v202, v202
s_nop 0
v_pk_fma_f32 v[204:205], v[218:219], v[202:203], v[200:201] op_sel_hi:[0,1,1] neg_lo:[0,0,1] neg_hi:[0,0,1]
v_pk_fma_f32 v[206:207], v[218:219], v[204:205], v[202:203] op_sel_hi:[0,1,1] neg_lo:[0,0,1] neg_hi:[0,0,1]
v_cvt_pk_bf16_f32 v16, v200, v201
v_cvt_pk_bf16_f32 v17, v202, v203
v_cvt_pk_bf16_f32 v18, v204, v205
v_cvt_pk_bf16_f32 v19, v206, v207
v_mad_u32_u24 v208, v220, 9, v221
v_cvt_f32_u32 v208, v208
v_mul_f32 v222, s19, v208
v_rndne_f32 v222, v222
v_fmac_f32 v208, 0xc4200000, v222
v_mul_f32 v208, s19, v208
v_sin_f32 v209, -v208
v_cos_f32 v208, v208
v_mad_u32_u24 v210, v220, 10, v221
v_cvt_f32_u32 v210, v210
v_mul_f32 v222, s19, v210
v_rndne_f32 v222, v222
v_fmac_f32 v210, 0xc4200000, v222
v_mul_f32 v210, s19, v210
v_sin_f32 v211, -v210
v_cos_f32 v210, v210
s_nop 0
v_pk_fma_f32 v[212:213], v[218:219], v[210:211], v[208:209] op_sel_hi:[0,1,1] neg_lo:[0,0,1] neg_hi:[0,0,1]
v_pk_fma_f32 v[214:215], v[218:219], v[212:213], v[210:211] op_sel_hi:[0,1,1] neg_lo:[0,0,1] neg_hi:[0,0,1]
v_cvt_pk_bf16_f32 v20, v208, v209
v_cvt_pk_bf16_f32 v21, v210, v211
v_cvt_pk_bf16_f32 v22, v212, v213
v_cvt_pk_bf16_f32 v23, v214, v215
v_pk_fma_f32 v[200:201], v[216:217], v[208:209], v[200:201] op_sel_hi:[0,1,1] neg_lo:[0,0,1] neg_hi:[0,0,1]
v_pk_fma_f32 v[202:203], v[216:217], v[210:211], v[202:203] op_sel_hi:[0,1,1] neg_lo:[0,0,1] neg_hi:[0,0,1]
v_pk_fma_f32 v[204:205], v[216:217], v[212:213], v[204:205] op_sel_hi:[0,1,1] neg_lo:[0,0,1] neg_hi:[0,0,1]
v_pk_fma_f32 v[206:207], v[216:217], v[214:215], v[206:207] op_sel_hi:[0,1,1] neg_lo:[0,0,1] neg_hi:[0,0,1]
v_cvt_pk_bf16_f32 v24, v200, v201
v_cvt_pk_bf16_f32 v25, v202, v203
v_cvt_pk_bf16_f32 v26, v204, v205
v_cvt_pk_bf16_f32 v27, v206, v207
v_pk_fma_f32 v[208:209], v[216:217], v[200:201], v[208:209] op_sel_hi:[0,1,1] neg_lo:[0,0,1] neg_hi:[0,0,1]
v_pk_fma_f32 v[210:211], v[216:217], v[202:203], v[210:211] op_sel_hi:[0,1,1] neg_lo:[0,0,1] neg_hi:[0,0,1]
v_pk_fma_f32 v[212:213], v[216:217], v[204:205], v[212:213] op_sel_hi:[0,1,1] neg_lo:[0,0,1] neg_hi:[0,0,1]
v_pk_fma_f32 v[214:215], v[216:217], v[206:207], v[214:215] op_sel_hi:[0,1,1] neg_lo:[0,0,1] neg_hi:[0,0,1]
v_cvt_pk_bf16_f32 v28, v208, v209
v_cvt_pk_bf16_f32 v29, v210, v211
v_cvt_pk_bf16_f32 v30, v212, v213
v_cvt_pk_bf16_f32 v31, v214, v215
v_pk_fma_f32 v[200:201], v[216:217], v[208:209], v[200:201] op_sel_hi:[0,1,1] neg_lo:[0,0,1] neg_hi:[0,0,1]
v_pk_fma_f32 v[202:203], v[216:217], v[210:211], v[202:203] op_sel_hi:[0,1,1] neg_lo:[0,0,1] neg_hi:[0,0,1]
v_pk_fma_f32 v[204:205], v[216:217], v[212:213], v[204:205] op_sel_hi:[0,1,1] neg_lo:[0,0,1] neg_hi:[0,0,1]
v_pk_fma_f32 v[206:207], v[216:217], v[214:215], v[206:207] op_sel_hi:[0,1,1] neg_lo:[0,0,1] neg_hi:[0,0,1]
v_cvt_pk_bf16_f32 v32, v200, v201
v_cvt_pk_bf16_f32 v33, v202, v203
v_cvt_pk_bf16_f32 v34, v204, v205
v_cvt_pk_bf16_f32 v35, v206, v207
v_pk_fma_f32 v[208:209], v[216:217], v[200:201], v[208:209] op_sel_hi:[0,1,1] neg_lo:[0,0,1] neg_hi:[0,0,1]
v_pk_fma_f32 v[210:211], v[216:217], v[202:203], v[210:211] op_sel_hi:[0,1,1] neg_lo:[0,0,1] neg_hi:[0,0,1]
v_pk_fma_f32 v[212:213], v[216:217], v[204:205], v[212:213] op_sel_hi:[0,1,1] neg_lo:[0,0,1] neg_hi:[0,0,1]
v_pk_fma_f32 v[214:215], v[216:217], v[206:207], v[214:215] op_sel_hi:[0,1,1] neg_lo:[0,0,1] neg_hi:[0,0,1]
v_cvt_pk_bf16_f32 v36, v208, v209
v_cvt_pk_bf16_f32 v37, v210, v211
v_cvt_pk_bf16_f32 v38, v212, v213
v_cvt_pk_bf16_f32 v39, v214, v215
v_pk_fma_f32 v[200:201], v[216:217], v[208:209], v[200:201] op_sel_hi:[0,1,1] neg_lo:[0,0,1] neg_hi:[0,0,1]
v_pk_fma_f32 v[202:203], v[216:217], v[210:211], v[202:203] op_sel_hi:[0,1,1] neg_lo:[0,0,1] neg_hi:[0,0,1]
v_pk_fma_f32 v[204:205], v[216:217], v[212:213], v[204:205] op_sel_hi:[0,1,1] neg_lo:[0,0,1] neg_hi:[0,0,1]
v_pk_fma_f32 v[206:207], v[216:217], v[214:215], v[206:207] op_sel_hi:[0,1,1] neg_lo:[0,0,1] neg_hi:[0,0,1]
v_cvt_pk_bf16_f32 v40, v200, v201
v_cvt_pk_bf16_f32 v41, v202, v203
v_cvt_pk_bf16_f32 v42, v204, v205
v_cvt_pk_bf16_f32 v43, v206, v207
v_pk_fma_f32 v[208:209], v[216:217], v[200:201], v[208:209] op_sel_hi:[0,1,1] neg_lo:[0,0,1] neg_hi:[0,0,1]
v_pk_fma_f32 v[210:211], v[216:217], v[202:203], v[210:211] op_sel_hi:[0,1,1] neg_lo:[0,0,1] neg_hi:[0,0,1]
v_pk_fma_f32 v[212:213], v[216:217], v[204:205], v[212:213] op_sel_hi:[0,1,1] neg_lo:[0,0,1] neg_hi:[0,0,1]
v_pk_fma_f32 v[214:215], v[216:217], v[206:207], v[214:215] op_sel_hi:[0,1,1] neg_lo:[0,0,1] neg_hi:[0,0,1]
v_cvt_pk_bf16_f32 v44, v208, v209
v_cvt_pk_bf16_f32 v45, v210, v211
v_cvt_pk_bf16_f32 v46, v212, v213
v_cvt_pk_bf16_f32 v47, v214, v215
v_pk_fma_f32 v[200:201], v[216:217], v[208:209], v[200:201] op_sel_hi:[0,1,1] neg_lo:[0,0,1] neg_hi:[0,0,1]
v_pk_fma_f32 v[202:203], v[216:217], v[210:211], v[202:203] op_sel_hi:[0,1,1] neg_lo:[0,0,1] neg_hi:[0,0,1]
v_pk_fma_f32 v[204:205], v[216:217], v[212:213], v[204:205] op_sel_hi:[0,1,1] neg_lo:[0,0,1] neg_hi:[0,0,1]
v_pk_fma_f32 v[206:207], v[216:217], v[214:215], v[206:207] op_sel_hi:[0,1,1] neg_lo:[0,0,1] neg_hi:[0,0,1]
v_cvt_pk_bf16_f32 v48, v200, v201
v_cvt_pk_bf16_f32 v49, v202, v203
v_cvt_pk_bf16_f32 v50, v204, v205
v_cvt_pk_bf16_f32 v51, v206, v207
v_pk_fma_f32 v[208:209], v[216:217], v[200:201], v[208:209] op_sel_hi:[0,1,1] neg_lo:[0,0,1] neg_hi:[0,0,1]
v_pk_fma_f32 v[210:211], v[216:217], v[202:203], v[210:211] op_sel_hi:[0,1,1] neg_lo:[0,0,1] neg_hi:[0,0,1]
v_pk_fma_f32 v[212:213], v[216:217], v[204:205], v[212:213] op_sel_hi:[0,1,1] neg_lo:[0,0,1] neg_hi:[0,0,1]
v_pk_fma_f32 v[214:215], v[216:217], v[206:207], v[214:215] op_sel_hi:[0,1,1] neg_lo:[0,0,1] neg_hi:[0,0,1]
v_cvt_pk_bf16_f32 v52, v208, v209
v_cvt_pk_bf16_f32 v53, v210, v211
v_cvt_pk_bf16_f32 v54, v212, v213
v_cvt_pk_bf16_f32 v55, v214, v215
v_pk_fma_f32 v[200:201], v[216:217], v[208:209], v[200:201] op_sel_hi:[0,1,1] neg_lo:[0,0,1] neg_hi:[0,0,1]
v_pk_fma_f32 v[202:203], v[216:217], v[210:211], v[202:203] op_sel_hi:[0,1,1] neg_lo:[0,0,1] neg_hi:[0,0,1]
v_pk_fma_f32 v[204:205], v[216:217], v[212:213], v[204:205] op_sel_hi:[0,1,1] neg_lo:[0,0,1] neg_hi:[0,0,1]
v_pk_fma_f32 v[206:207], v[216:217], v[214:215], v[206:207] op_sel_hi:[0,1,1] neg_lo:[0,0,1] neg_hi:[0,0,1]
v_cvt_pk_bf16_f32 v56, v200, v201
v_cvt_pk_bf16_f32 v57, v202, v203
v_cvt_pk_bf16_f32 v58, v204, v205
v_cvt_pk_bf16_f32 v59, v206, v207
v_pk_fma_f32 v[208:209], v[216:217], v[200:201], v[208:209] op_sel_hi:[0,1,1] neg_lo:[0,0,1] neg_hi:[0,0,1]
v_pk_fma_f32 v[210:211], v[216:217], v[202:203], v[210:211] op_sel_hi:[0,1,1] neg_lo:[0,0,1] neg_hi:[0,0,1]
v_pk_fma_f32 v[212:213], v[216:217], v[204:205], v[212:213] op_sel_hi:[0,1,1] neg_lo:[0,0,1] neg_hi:[0,0,1]
v_pk_fma_f32 v[214:215], v[216:217], v[206:207], v[214:215] op_sel_hi:[0,1,1] neg_lo:[0,0,1] neg_hi:[0,0,1]
v_cvt_pk_bf16_f32 v60, v208, v209
v_cvt_pk_bf16_f32 v61, v210, v211
v_cvt_pk_bf16_f32 v62, v212, v213
v_cvt_pk_bf16_f32 v63, v214, v215
v_pk_fma_f32 v[200:201], v[216:217], v[208:209], v[200:201] op_sel_hi:[0,1,1] neg_lo:[0,0,1] neg_hi:[0,0,1]
v_pk_fma_f32 v[202:203], v[216:217], v[210:211], v[202:203] op_sel_hi:[0,1,1] neg_lo:[0,0,1] neg_hi:[0,0,1]
v_pk_fma_f32 v[204:205], v[216:217], v[212:213], v[204:205] op_sel_hi:[0,1,1] neg_lo:[0,0,1] neg_hi:[0,0,1]
v_pk_fma_f32 v[206:207], v[216:217], v[214:215], v[206:207] op_sel_hi:[0,1,1] neg_lo:[0,0,1] neg_hi:[0,0,1]
v_cvt_pk_bf16_f32 v64, v200, v201
v_cvt_pk_bf16_f32 v65, v202, v203
v_cvt_pk_bf16_f32 v66, v204, v205
v_cvt_pk_bf16_f32 v67, v206, v207
s_waitcnt vmcnt(0)
s_barrier
v_mov_b32 v3, s23
s_mov_b64 exec, 1
buffer_store_dword v3, off, s[4:7], s22 sc1
s_mov_b64 exec, -1
s_mov_b32 s22, s6
v_pk_fma_f32 v[208:209], v[216:217], v[200:201], v[208:209] op_sel_hi:[0,1,1] neg_lo:[0,0,1] neg_hi:[0,0,1]
v_pk_fma_f32 v[210:211], v[216:217], v[202:203], v[210:211] op_sel_hi:[0,1,1] neg_lo:[0,0,1] neg_hi:[0,0,1]
v_pk_fma_f32 v[212:213], v[216:217], v[204:205], v[212:213] op_sel_hi:[0,1,1] neg_lo:[0,0,1] neg_hi:[0,0,1]
v_pk_fma_f32 v[214:215], v[216:217], v[206:207], v[214:215] op_sel_hi:[0,1,1] neg_lo:[0,0,1] neg_hi:[0,0,1]
v_cvt_pk_bf16_f32 v68, v208, v209
v_cvt_pk_bf16_f32 v69, v210, v211
v_cvt_pk_bf16_f32 v70, v212, v213
v_cvt_pk_bf16_f32 v71, v214, v215
v_pk_fma_f32 v[200:201], v[216:217], v[208:209], v[200:201] op_sel_hi:[0,1,1] neg_lo:[0,0,1] neg_hi:[0,0,1]
v_pk_fma_f32 v[202:203], v[216:217], v[210:211], v[202:203] op_sel_hi:[0,1,1] neg_lo:[0,0,1] neg_hi:[0,0,1]
v_pk_fma_f32 v[204:205], v[216:217], v[212:213], v[204:205] op_sel_hi:[0,1,1] neg_lo:[0,0,1] neg_hi:[0,0,1]
v_pk_fma_f32 v[206:207], v[216:217], v[214:215], v[206:207] op_sel_hi:[0,1,1] neg_lo:[0,0,1] neg_hi:[0,0,1]
v_cvt_pk_bf16_f32 v72, v200, v201
v_cvt_pk_bf16_f32 v73, v202, v203
v_cvt_pk_bf16_f32 v74, v204, v205
v_cvt_pk_bf16_f32 v75, v206, v207
v_pk_fma_f32 v[208:209], v[216:217], v[200:201], v[208:209] op_sel_hi:[0,1,1] neg_lo:[0,0,1] neg_hi:[0,0,1]
v_pk_fma_f32 v[210:211], v[216:217], v[202:203], v[210:211] op_sel_hi:[0,1,1] neg_lo:[0,0,1] neg_hi:[0,0,1]
v_pk_fma_f32 v[212:213], v[216:217], v[204:205], v[212:213] op_sel_hi:[0,1,1] neg_lo:[0,0,1] neg_hi:[0,0,1]
v_pk_fma_f32 v[214:215], v[216:217], v[206:207], v[214:215] op_sel_hi:[0,1,1] neg_lo:[0,0,1] neg_hi:[0,0,1]
v_cvt_pk_bf16_f32 v76, v208, v209
v_cvt_pk_bf16_f32 v77, v210, v211
v_cvt_pk_bf16_f32 v78, v212, v213
v_cvt_pk_bf16_f32 v79, v214, v215
v_pk_fma_f32 v[200:201], v[216:217], v[208:209], v[200:201] op_sel_hi:[0,1,1] neg_lo:[0,0,1] neg_hi:[0,0,1]
v_pk_fma_f32 v[202:203], v[216:217], v[210:211], v[202:203] op_sel_hi:[0,1,1] neg_lo:[0,0,1] neg_hi:[0,0,1]
v_pk_fma_f32 v[204:205], v[216:217], v[212:213], v[204:205] op_sel_hi:[0,1,1] neg_lo:[0,0,1] neg_hi:[0,0,1]
v_pk_fma_f32 v[206:207], v[216:217], v[214:215], v[206:207] op_sel_hi:[0,1,1] neg_lo:[0,0,1] neg_hi:[0,0,1]
v_cvt_pk_bf16_f32 v80, v200, v201
v_cvt_pk_bf16_f32 v81, v202, v203
v_cvt_pk_bf16_f32 v82, v204, v205
v_cvt_pk_bf16_f32 v83, v206, v207
v_pk_fma_f32 v[208:209], v[216:217], v[200:201], v[208:209] op_sel_hi:[0,1,1] neg_lo:[0,0,1] neg_hi:[0,0,1]
v_pk_fma_f32 v[210:211], v[216:217], v[202:203], v[210:211] op_sel_hi:[0,1,1] neg_lo:[0,0,1] neg_hi:[0,0,1]
v_pk_fma_f32 v[212:213], v[216:217], v[204:205], v[212:213] op_sel_hi:[0,1,1] neg_lo:[0,0,1] neg_hi:[0,0,1]
v_pk_fma_f32 v[214:215], v[216:217], v[206:207], v[214:215] op_sel_hi:[0,1,1] neg_lo:[0,0,1] neg_hi:[0,0,1]
v_cvt_pk_bf16_f32 v84, v208, v209
v_cvt_pk_bf16_f32 v85, v210, v211
v_cvt_pk_bf16_f32 v86, v212, v213
v_cvt_pk_bf16_f32 v87, v214, v215
v_pk_fma_f32 v[200:201], v[216:217], v[208:209], v[200:201] op_sel_hi:[0,1,1] neg_lo:[0,0,1] neg_hi:[0,0,1]
v_pk_fma_f32 v[202:203], v[216:217], v[210:211], v[202:203] op_sel_hi:[0,1,1] neg_lo:[0,0,1] neg_hi:[0,0,1]
v_pk_fma_f32 v[204:205], v[216:217], v[212:213], v[204:205] op_sel_hi:[0,1,1] neg_lo:[0,0,1] neg_hi:[0,0,1]
v_pk_fma_f32 v[206:207], v[216:217], v[214:215], v[206:207] op_sel_hi:[0,1,1] neg_lo:[0,0,1] neg_hi:[0,0,1]
v_cvt_pk_bf16_f32 v88, v200, v201
v_cvt_pk_bf16_f32 v89, v202, v203
v_cvt_pk_bf16_f32 v90, v204, v205
v_cvt_pk_bf16_f32 v91, v206, v207
v_pk_fma_f32 v[208:209], v[216:217], v[200:201], v[208:209] op_sel_hi:[0,1,1] neg_lo:[0,0,1] neg_hi:[0,0,1]
v_pk_fma_f32 v[210:211], v[216:217], v[202:203], v[210:211] op_sel_hi:[0,1,1] neg_lo:[0,0,1] neg_hi:[0,0,1]
v_pk_fma_f32 v[212:213], v[216:217], v[204:205], v[212:213] op_sel_hi:[0,1,1] neg_lo:[0,0,1] neg_hi:[0,0,1]
v_pk_fma_f32 v[214:215], v[216:217], v[206:207], v[214:215] op_sel_hi:[0,1,1] neg_lo:[0,0,1] neg_hi:[0,0,1]
v_cvt_pk_bf16_f32 v92, v208, v209
v_cvt_pk_bf16_f32 v93, v210, v211
v_cvt_pk_bf16_f32 v94, v212, v213
v_cvt_pk_bf16_f32 v95, v214, v215
s_mov_b32 s20, 161
v_mad_u32_u24 v200, v220, s20, v221
v_cvt_f32_u32 v200, v200
v_mul_f32 v222, s19, v200
v_rndne_f32 v222, v222
v_fmac_f32 v200, 0xc4200000, v222
v_mul_f32 v200, s19, v200
v_sin_f32 v201, -v200
v_cos_f32 v200, v200
s_mov_b32 s20, 162
v_mad_u32_u24 v202, v220, s20, v221
v_cvt_f32_u32 v202, v202
v_mul_f32 v222, s19, v202
v_rndne_f32 v222, v222
v_fmac_f32 v202, 0xc4200000, v222
v_mul_f32 v202, s19, v202
v_sin_f32 v203, -v202
v_cos_f32 v202, v202
s_nop 0
v_pk_fma_f32 v[204:205], v[218:219], v[202:203], v[200:201] op_sel_hi:[0,1,1] neg_lo:[0,0,1] neg_hi:[0,0,1]
v_pk_fma_f32 v[206:207], v[218:219], v[204:205], v[202:203] op_sel_hi:[0,1,1] neg_lo:[0,0,1] neg_hi:[0,0,1]
v_cvt_pk_bf16_f32 v96, v200, v201
v_cvt_pk_bf16_f32 v97, v202, v203
v_cvt_pk_bf16_f32 v98, v204, v205
v_cvt_pk_bf16_f32 v99, v206, v207
s_mov_b32 s20, 169
v_mad_u32_u24 v208, v220, s20, v221
v_cvt_f32_u32 v208, v208
v_mul_f32 v222, s19, v208
v_rndne_f32 v222, v222
v_fmac_f32 v208, 0xc4200000, v222
v_mul_f32 v208, s19, v208
v_sin_f32 v209, -v208
v_cos_f32 v208, v208
s_mov_b32 s20, 170
v_mad_u32_u24 v210, v220, s20, v221
v_cvt_f32_u32 v210, v210
v_mul_f32 v222, s19, v210
v_rndne_f32 v222, v222
v_fmac_f32 v210, 0xc4200000, v222
v_mul_f32 v210, s19, v210
v_sin_f32 v211, -v210
v_cos_f32 v210, v210
s_nop 0
v_pk_fma_f32 v[212:213], v[218:219], v[210:211], v[208:209] op_sel_hi:[0,1,1] neg_lo:[0,0,1] neg_hi:[0,0,1]
v_pk_fma_f32 v[214:215], v[218:219], v[212:213], v[210:211] op_sel_hi:[0,1,1] neg_lo:[0,0,1] neg_hi:[0,0,1]
v_cvt_pk_bf16_f32 v100, v208, v209
v_cvt_pk_bf16_f32 v101, v210, v211
v_cvt_pk_bf16_f32 v102, v212, v213
v_cvt_pk_bf16_f32 v103, v214, v215
v_pk_fma_f32 v[200:201], v[216:217], v[208:209], v[200:201] op_sel_hi:[0,1,1] neg_lo:[0,0,1] neg_hi:[0,0,1]
v_pk_fma_f32 v[202:203], v[216:217], v[210:211], v[202:203] op_sel_hi:[0,1,1] neg_lo:[0,0,1] neg_hi:[0,0,1]
v_pk_fma_f32 v[204:205], v[216:217], v[212:213], v[204:205] op_sel_hi:[0,1,1] neg_lo:[0,0,1] neg_hi:[0,0,1]
v_pk_fma_f32 v[206:207], v[216:217], v[214:215], v[206:207] op_sel_hi:[0,1,1] neg_lo:[0,0,1] neg_hi:[0,0,1]
v_cvt_pk_bf16_f32 v104, v200, v201
v_cvt_pk_bf16_f32 v105, v202, v203
v_cvt_pk_bf16_f32 v106, v204, v205
v_cvt_pk_bf16_f32 v107, v206, v207
v_pk_fma_f32 v[208:209], v[216:217], v[200:201], v[208:209] op_sel_hi:[0,1,1] neg_lo:[0,0,1] neg_hi:[0,0,1]
v_pk_fma_f32 v[210:211], v[216:217], v[202:203], v[210:211] op_sel_hi:[0,1,1] neg_lo:[0,0,1] neg_hi:[0,0,1]
v_pk_fma_f32 v[212:213], v[216:217], v[204:205], v[212:213] op_sel_hi:[0,1,1] neg_lo:[0,0,1] neg_hi:[0,0,1]
v_pk_fma_f32 v[214:215], v[216:217], v[206:207], v[214:215] op_sel_hi:[0,1,1] neg_lo:[0,0,1] neg_hi:[0,0,1]
v_cvt_pk_bf16_f32 v108, v208, v209
v_cvt_pk_bf16_f32 v109, v210, v211
v_cvt_pk_bf16_f32 v110, v212, v213
v_cvt_pk_bf16_f32 v111, v214, v215
v_pk_fma_f32 v[200:201], v[216:217], v[208:209], v[200:201] op_sel_hi:[0,1,1] neg_lo:[0,0,1] neg_hi:[0,0,1]
v_pk_fma_f32 v[202:203], v[216:217], v[210:211], v[202:203] op_sel_hi:[0,1,1] neg_lo:[0,0,1] neg_hi:[0,0,1]
v_pk_fma_f32 v[204:205], v[216:217], v[212:213], v[204:205] op_sel_hi:[0,1,1] neg_lo:[0,0,1] neg_hi:[0,0,1]
v_pk_fma_f32 v[206:207], v[216:217], v[214:215], v[206:207] op_sel_hi:[0,1,1] neg_lo:[0,0,1] neg_hi:[0,0,1]
v_cvt_pk_bf16_f32 v112, v200, v201
v_cvt_pk_bf16_f32 v113, v202, v203
v_cvt_pk_bf16_f32 v114, v204, v205
v_cvt_pk_bf16_f32 v115, v206, v207
v_pk_fma_f32 v[208:209], v[216:217], v[200:201], v[208:209] op_sel_hi:[0,1,1] neg_lo:[0,0,1] neg_hi:[0,0,1]
v_pk_fma_f32 v[210:211], v[216:217], v[202:203], v[210:211] op_sel_hi:[0,1,1] neg_lo:[0,0,1] neg_hi:[0,0,1]
v_pk_fma_f32 v[212:213], v[216:217], v[204:205], v[212:213] op_sel_hi:[0,1,1] neg_lo:[0,0,1] neg_hi:[0,0,1]
v_pk_fma_f32 v[214:215], v[216:217], v[206:207], v[214:215] op_sel_hi:[0,1,1] neg_lo:[0,0,1] neg_hi:[0,0,1]
v_cvt_pk_bf16_f32 v116, v208, v209
v_cvt_pk_bf16_f32 v117, v210, v211
v_cvt_pk_bf16_f32 v118, v212, v213
v_cvt_pk_bf16_f32 v119, v214, v215
v_pk_fma_f32 v[200:201], v[216:217], v[208:209], v[200:201] op_sel_hi:[0,1,1] neg_lo:[0,0,1] neg_hi:[0,0,1]
v_pk_fma_f32 v[202:203], v[216:217], v[210:211], v[202:203] op_sel_hi:[0,1,1] neg_lo:[0,0,1] neg_hi:[0,0,1]
v_pk_fma_f32 v[204:205], v[216:217], v[212:213], v[204:205] op_sel_hi:[0,1,1] neg_lo:[0,0,1] neg_hi:[0,0,1]
v_pk_fma_f32 v[206:207], v[216:217], v[214:215], v[206:207] op_sel_hi:[0,1,1] neg_lo:[0,0,1] neg_hi:[0,0,1]
v_cvt_pk_bf16_f32 v120, v200, v201
v_cvt_pk_bf16_f32 v121, v202, v203
v_cvt_pk_bf16_f32 v122, v204, v205
v_cvt_pk_bf16_f32 v123, v206, v207
v_pk_fma_f32 v[208:209], v[216:217], v[200:201], v[208:209] op_sel_hi:[0,1,1] neg_lo:[0,0,1] neg_hi:[0,0,1]
v_pk_fma_f32 v[210:211], v[216:217], v[202:203], v[210:211] op_sel_hi:[0,1,1] neg_lo:[0,0,1] neg_hi:[0,0,1]
v_pk_fma_f32 v[212:213], v[216:217], v[204:205], v[212:213] op_sel_hi:[0,1,1] neg_lo:[0,0,1] neg_hi:[0,0,1]
v_pk_fma_f32 v[214:215], v[216:217], v[206:207], v[214:215] op_sel_hi:[0,1,1] neg_lo:[0,0,1] neg_hi:[0,0,1]
v_cvt_pk_bf16_f32 v124, v208, v209
v_cvt_pk_bf16_f32 v125, v210, v211
v_cvt_pk_bf16_f32 v126, v212, v213
v_cvt_pk_bf16_f32 v127, v214, v215
v_pk_fma_f32 v[200:201], v[216:217], v[208:209], v[200:201] op_sel_hi:[0,1,1] neg_lo:[0,0,1] neg_hi:[0,0,1]
v_pk_fma_f32 v[202:203], v[216:217], v[210:211], v[202:203] op_sel_hi:[0,1,1] neg_lo:[0,0,1] neg_hi:[0,0,1]
v_pk_fma_f32 v[204:205], v[216:217], v[212:213], v[204:205] op_sel_hi:[0,1,1] neg_lo:[0,0,1] neg_hi:[0,0,1]
v_pk_fma_f32 v[206:207], v[216:217], v[214:215], v[206:207] op_sel_hi:[0,1,1] neg_lo:[0,0,1] neg_hi:[0,0,1]
v_cvt_pk_bf16_f32 v128, v200, v201
v_cvt_pk_bf16_f32 v129, v202, v203
v_cvt_pk_bf16_f32 v130, v204, v205
v_cvt_pk_bf16_f32 v131, v206, v207
v_pk_fma_f32 v[208:209], v[216:217], v[200:201], v[208:209] op_sel_hi:[0,1,1] neg_lo:[0,0,1] neg_hi:[0,0,1]
v_pk_fma_f32 v[210:211], v[216:217], v[202:203], v[210:211] op_sel_hi:[0,1,1] neg_lo:[0,0,1] neg_hi:[0,0,1]
v_pk_fma_f32 v[212:213], v[216:217], v[204:205], v[212:213] op_sel_hi:[0,1,1] neg_lo:[0,0,1] neg_hi:[0,0,1]
v_pk_fma_f32 v[214:215], v[216:217], v[206:207], v[214:215] op_sel_hi:[0,1,1] neg_lo:[0,0,1] neg_hi:[0,0,1]
v_cvt_pk_bf16_f32 v132, v208, v209
v_cvt_pk_bf16_f32 v133, v210, v211
v_cvt_pk_bf16_f32 v134, v212, v213
v_cvt_pk_bf16_f32 v135, v214, v215
v_pk_fma_f32 v[200:201], v[216:217], v[208:209], v[200:201] op_sel_hi:[0,1,1] neg_lo:[0,0,1] neg_hi:[0,0,1]
v_pk_fma_f32 v[202:203], v[216:217], v[210:211], v[202:203] op_sel_hi:[0,1,1] neg_lo:[0,0,1] neg_hi:[0,0,1]
v_pk_fma_f32 v[204:205], v[216:217], v[212:213], v[204:205] op_sel_hi:[0,1,1] neg_lo:[0,0,1] neg_hi:[0,0,1]
v_pk_fma_f32 v[206:207], v[216:217], v[214:215], v[206:207] op_sel_hi:[0,1,1] neg_lo:[0,0,1] neg_hi:[0,0,1]
v_cvt_pk_bf16_f32 v136, v200, v201
v_cvt_pk_bf16_f32 v137, v202, v203
v_cvt_pk_bf16_f32 v138, v204, v205
v_cvt_pk_bf16_f32 v139, v206, v207
v_pk_fma_f32 v[208:209], v[216:217], v[200:201], v[208:209] op_sel_hi:[0,1,1] neg_lo:[0,0,1] neg_hi:[0,0,1]
v_pk_fma_f32 v[210:211], v[216:217], v[202:203], v[210:211] op_sel_hi:[0,1,1] neg_lo:[0,0,1] neg_hi:[0,0,1]
v_pk_fma_f32 v[212:213], v[216:217], v[204:205], v[212:213] op_sel_hi:[0,1,1] neg_lo:[0,0,1] neg_hi:[0,0,1]
v_pk_fma_f32 v[214:215], v[216:217], v[206:207], v[214:215] op_sel_hi:[0,1,1] neg_lo:[0,0,1] neg_hi:[0,0,1]
v_cvt_pk_bf16_f32 v140, v208, v209
v_cvt_pk_bf16_f32 v141, v210, v211
v_cvt_pk_bf16_f32 v142, v212, v213
v_cvt_pk_bf16_f32 v143, v214, v215
v_pk_fma_f32 v[200:201], v[216:217], v[208:209], v[200:201] op_sel_hi:[0,1,1] neg_lo:[0,0,1] neg_hi:[0,0,1]
v_pk_fma_f32 v[202:203], v[216:217], v[210:211], v[202:203] op_sel_hi:[0,1,1] neg_lo:[0,0,1] neg_hi:[0,0,1]
v_pk_fma_f32 v[204:205], v[216:217], v[212:213], v[204:205] op_sel_hi:[0,1,1] neg_lo:[0,0,1] neg_hi:[0,0,1]
v_pk_fma_f32 v[206:207], v[216:217], v[214:215], v[206:207] op_sel_hi:[0,1,1] neg_lo:[0,0,1] neg_hi:[0,0,1]
v_cvt_pk_bf16_f32 v144, v200, v201
v_cvt_pk_bf16_f32 v145, v202, v203
v_cvt_pk_bf16_f32 v146, v204, v205
v_cvt_pk_bf16_f32 v147, v206, v207
v_pk_fma_f32 v[208:209], v[216:217], v[200:201], v[208:209] op_sel_hi:[0,1,1] neg_lo:[0,0,1] neg_hi:[0,0,1]
v_pk_fma_f32 v[210:211], v[216:217], v[202:203], v[210:211] op_sel_hi:[0,1,1] neg_lo:[0,0,1] neg_hi:[0,0,1]
v_pk_fma_f32 v[212:213], v[216:217], v[204:205], v[212:213] op_sel_hi:[0,1,1] neg_lo:[0,0,1] neg_hi:[0,0,1]
v_pk_fma_f32 v[214:215], v[216:217], v[206:207], v[214:215] op_sel_hi:[0,1,1] neg_lo:[0,0,1] neg_hi:[0,0,1]
v_cvt_pk_bf16_f32 v148, v208, v209
v_cvt_pk_bf16_f32 v149, v210, v211
v_cvt_pk_bf16_f32 v150, v212, v213
v_cvt_pk_bf16_f32 v151, v214, v215
v_pk_fma_f32 v[200:201], v[216:217], v[208:209], v[200:201] op_sel_hi:[0,1,1] neg_lo:[0,0,1] neg_hi:[0,0,1]
v_pk_fma_f32 v[202:203], v[216:217], v[210:211], v[202:203] op_sel_hi:[0,1,1] neg_lo:[0,0,1] neg_hi:[0,0,1]
v_pk_fma_f32 v[204:205], v[216:217], v[212:213], v[204:205] op_sel_hi:[0,1,1] neg_lo:[0,0,1] neg_hi:[0,0,1]
v_pk_fma_f32 v[206:207], v[216:217], v[214:215], v[206:207] op_sel_hi:[0,1,1] neg_lo:[0,0,1] neg_hi:[0,0,1]
v_cvt_pk_bf16_f32 v152, v200, v201
v_cvt_pk_bf16_f32 v153, v202, v203
v_cvt_pk_bf16_f32 v154, v204, v205
v_cvt_pk_bf16_f32 v155, v206, v207
v_pk_fma_f32 v[208:209], v[216:217], v[200:201], v[208:209] op_sel_hi:[0,1,1] neg_lo:[0,0,1] neg_hi:[0,0,1]
v_pk_fma_f32 v[210:211], v[216:217], v[202:203], v[210:211] op_sel_hi:[0,1,1] neg_lo:[0,0,1] neg_hi:[0,0,1]
v_pk_fma_f32 v[212:213], v[216:217], v[204:205], v[212:213] op_sel_hi:[0,1,1] neg_lo:[0,0,1] neg_hi:[0,0,1]
v_pk_fma_f32 v[214:215], v[216:217], v[206:207], v[214:215] op_sel_hi:[0,1,1] neg_lo:[0,0,1] neg_hi:[0,0,1]
v_cvt_pk_bf16_f32 v156, v208, v209
v_cvt_pk_bf16_f32 v157, v210, v211
v_cvt_pk_bf16_f32 v158, v212, v213
v_cvt_pk_bf16_f32 v159, v214, v215
v_pk_fma_f32 v[200:201], v[216:217], v[208:209], v[200:201] op_sel_hi:[0,1,1] neg_lo:[0,0,1] neg_hi:[0,0,1]
v_pk_fma_f32 v[202:203], v[216:217], v[210:211], v[202:203] op_sel_hi:[0,1,1] neg_lo:[0,0,1] neg_hi:[0,0,1]
v_pk_fma_f32 v[204:205], v[216:217], v[212:213], v[204:205] op_sel_hi:[0,1,1] neg_lo:[0,0,1] neg_hi:[0,0,1]
v_pk_fma_f32 v[206:207], v[216:217], v[214:215], v[206:207] op_sel_hi:[0,1,1] neg_lo:[0,0,1] neg_hi:[0,0,1]
v_cvt_pk_bf16_f32 v160, v200, v201
v_cvt_pk_bf16_f32 v161, v202, v203
v_cvt_pk_bf16_f32 v162, v204, v205
v_cvt_pk_bf16_f32 v163, v206, v207
v_pk_fma_f32 v[208:209], v[216:217], v[200:201], v[208:209] op_sel_hi:[0,1,1] neg_lo:[0,0,1] neg_hi:[0,0,1]
v_pk_fma_f32 v[210:211], v[216:217], v[202:203], v[210:211] op_sel_hi:[0,1,1] neg_lo:[0,0,1] neg_hi:[0,0,1]
v_pk_fma_f32 v[212:213], v[216:217], v[204:205], v[212:213] op_sel_hi:[0,1,1] neg_lo:[0,0,1] neg_hi:[0,0,1]
v_pk_fma_f32 v[214:215], v[216:217], v[206:207], v[214:215] op_sel_hi:[0,1,1] neg_lo:[0,0,1] neg_hi:[0,0,1]
v_cvt_pk_bf16_f32 v164, v208, v209
v_cvt_pk_bf16_f32 v165, v210, v211
v_cvt_pk_bf16_f32 v166, v212, v213
v_cvt_pk_bf16_f32 v167, v214, v215
v_pk_fma_f32 v[200:201], v[216:217], v[208:209], v[200:201] op_sel_hi:[0,1,1] neg_lo:[0,0,1] neg_hi:[0,0,1]
v_pk_fma_f32 v[202:203], v[216:217], v[210:211], v[202:203] op_sel_hi:[0,1,1] neg_lo:[0,0,1] neg_hi:[0,0,1]
v_pk_fma_f32 v[204:205], v[216:217], v[212:213], v[204:205] op_sel_hi:[0,1,1] neg_lo:[0,0,1] neg_hi:[0,0,1]
v_pk_fma_f32 v[206:207], v[216:217], v[214:215], v[206:207] op_sel_hi:[0,1,1] neg_lo:[0,0,1] neg_hi:[0,0,1]
v_cvt_pk_bf16_f32 v168, v200, v201
v_cvt_pk_bf16_f32 v169, v202, v203
v_cvt_pk_bf16_f32 v170, v204, v205
v_cvt_pk_bf16_f32 v171, v206, v207
v_pk_fma_f32 v[208:209], v[216:217], v[200:201], v[208:209] op_sel_hi:[0,1,1] neg_lo:[0,0,1] neg_hi:[0,0,1]
v_pk_fma_f32 v[210:211], v[216:217], v[202:203], v[210:211] op_sel_hi:[0,1,1] neg_lo:[0,0,1] neg_hi:[0,0,1]
v_pk_fma_f32 v[212:213], v[216:217], v[204:205], v[212:213] op_sel_hi:[0,1,1] neg_lo:[0,0,1] neg_hi:[0,0,1]
v_pk_fma_f32 v[214:215], v[216:217], v[206:207], v[214:215] op_sel_hi:[0,1,1] neg_lo:[0,0,1] neg_hi:[0,0,1]
s_mov_b32 exec_lo, 0
v_mul_f32 v214, 0.5, v214
s_mov_b32 exec_lo, -1
v_cvt_pk_bf16_f32 v172, v208, v209
v_cvt_pk_bf16_f32 v173, v210, v211
v_cvt_pk_bf16_f32 v174, v212, v213
v_cvt_pk_bf16_f32 v175, v214, v215
v_and_b32 v1, 0x2f0, v0
v_bfe_u32 v3, v0, 8, 1
v_lshl_add_u32 v1, v3, 3, v1
s_mul_i32 s18, s50, 40960
s_mul_i32 s19, s16, 3145728
s_add_u32 s26, s18, s19
s_add_u32 s27, s26, s19
s_add_u32 s27, s27, s33
s_add_u32 s27, s27, 88080384
s_add_u32 s26, s26, s31
s_add_u32 s26, s26, 103809024
s_lshl_b32 s19, s16, 6
s_add_u32 s19, s19, s50
s_mul_i32 s19, s19, 5120
s_lshr_b32 s36, s33, 3
s_add_u32 s36, s36, s19
s_add_u32 s36, s36, 163577856
s_mov_b32 s43, 0x20000
s_cmp_lg_u32 s16, 0
s_cbranch_scc1 rs_47
s_mov_b64 s[40:41], s[44:45]
s_mov_b32 s42, s46
s_lshr_b32 s51, s33, 5
s_add_u32 s51, s51, s18
s_add_u32 s52, s51, 32
v_mov_b32 v13, v5
s_branch rs_48
rs_47:
s_mov_b64 s[40:41], s[4:5]
s_mov_b32 s42, s6
s_sub_u32 s51, s27, 3145728
s_add_u32 s52, s51, 1024
v_mov_b32 v13, v0
rs_48:
s_cmp_lg_u32 s13, 0
s_cbranch_scc1 polld_50
v_min_u32 v12, 624, v0
s_mov_b32 s21, 7168
s_mov_b32 s17, 0
poll_49:
buffer_load_dwordx4 v[8:11], v12, s[4:7], s21 offen offset:0 sc1
s_add_u32 s17, s17, 1
s_cmp_gt_u32 s17, 262144
s_cbranch_scc1 L_fail
s_waitcnt vmcnt(0)
v_min3_u32 v8, v8, v9, v10
v_min_u32 v8, v8, v11
v_cmp_gt_u32 vcc, s29, v8
s_cbranch_vccz polld_50
s_sleep 2
s_branch poll_49
polld_50:
s_barrier
s_add_u32 m0, s31, 2048
s_add_u32 s20, s26, 0
buffer_load_dwordx4 v0, s[4:7], s20 offen sc1 lds
s_add_u32 m0, s31, 3072
s_add_u32 s20, s26, 1024
buffer_load_dwordx4 v0, s[4:7], s20 offen sc1 lds
s_add_u32 m0, s31, 4096
s_add_u32 s20, s26, 2048
buffer_load_dwordx4 v0, s[4:7], s20 offen sc1 lds
s_add_u32 m0, s31, 5120
s_add_u32 s20, s26, 3072
buffer_load_dwordx4 v0, s[4:7], s20 offen sc1 lds
s_add_u32 m0, s31, 6144
s_add_u32 s20, s26, 4096
buffer_load_dwordx4 v0, s[4:7], s20 offen sc1 lds
s_add_u32 m0, s31, 7168
s_add_u32 s20, s26, 5120
buffer_load_dwordx4 v0, s[4:7], s20 offen sc1 lds
s_add_u32 m0, s31, 8192
s_add_u32 s20, s26, 6144
buffer_load_dwordx4 v0, s[4:7], s20 offen sc1 lds
s_add_u32 m0, s31, 9216
s_add_u32 s20, s26, 7168
buffer_load_dwordx4 v0, s[4:7], s20 offen sc1 lds
s_add_u32 m0, s31, 10240
s_add_u32 s20, s26, 8192
buffer_load_dwordx4 v0, s[4:7], s20 offen sc1 lds
s_add_u32 m0, s31, 11264
s_add_u32 s20, s26, 9216
buffer_load_dwordx4 v0, s[4:7], s20 offen sc1 lds
s_add_u32 s26, s26, 1310720
s_add_u32 s25, s31, 40960
s_mov_b32 s28, 0
s_waitcnt vmcnt(0)
p3_51:
s_barrier
ds_read_b64_tr_b16 v[216:217], v1 offset:2048
ds_read_b64_tr_b16 v[218:219], v1 offset:2304
ds_read_b64_tr_b16 v[222:223], v1 offset:3328
ds_read_b64_tr_b16 v[220:221], v1 offset:3072
buffer_load_dwordx4 v[176:179], v13, s[40:43], s51 offen sc1
ds_read_b64_tr_b16 v[224:225], v1 offset:4096
buffer_load_dwordx4 v[180:183], v13, s[40:43], s52 offen sc1
ds_read_b64_tr_b16 v[230:231], v1 offset:5376
ds_read_b64_tr_b16 v[226:227], v1 offset:4352
s_add_u32 m0, s25, 2048
s_add_u32 s20, s26, 0
buffer_load_dwordx4 v0, s[4:7], s20 offen sc1 lds
s_waitcnt lgkmcnt(5)
v_mfma_f32_32x32x16_bf16 v[200:215], v[16:19], v[216:219], 0
s_waitcnt lgkmcnt(4)
ds_read_b64_tr_b16 v[228:229], v1 offset:5120
ds_read_b64_tr_b16 v[218:219], v1 offset:6400
s_add_u32 m0, s25, 3072
s_add_u32 s20, s26, 1024
buffer_load_dwordx4 v0, s[4:7], s20 offen sc1 lds
s_waitcnt lgkmcnt(4)
v_mfma_f32_32x32x16_bf16 v[200:215], v[20:23], v[220:223], v[200:215]
s_add_u32 m0, s25, 4096
s_add_u32 s20, s26, 2048
buffer_load_dwordx4 v0, s[4:7], s20 offen sc1 lds
ds_read_b64_tr_b16 v[216:217], v1 offset:6144
s_waitcnt lgkmcnt(3)
ds_read_b64_tr_b16 v[222:223], v1 offset:7424
v_mfma_f32_32x32x16_bf16 v[200:215], v[24:27], v[224:227], v[200:215]
s_waitcnt lgkmcnt(3)
ds_read_b64_tr_b16 v[220:221], v1 offset:7168
ds_read_b64_tr_b16 v[224:225], v1 offset:8192
s_waitcnt lgkmcnt(4)
v_mfma_f32_32x32x16_bf16 v[200:215], v[28:31], v[228:231], v[200:215]
s_add_u32 m0, s25, 5120
s_add_u32 s20, s26, 3072
buffer_load_dwordx4 v0, s[4:7], s20 offen sc1 lds
s_waitcnt lgkmcnt(3)
ds_read_b64_tr_b16 v[226:227], v1 offset:8448
ds_read_b64_tr_b16 v[230:231], v1 offset:9472
ds_read_b64_tr_b16 v[228:229], v1 offset:9216
v_mfma_f32_32x32x16_bf16 v[200:215], v[32:35], v[216:219], v[200:215]
ds_read_b64_tr_b16 v[216:217], v1 offset:10240
s_waitcnt lgkmcnt(5)
v_mfma_f32_32x32x16_bf16 v[200:215], v[36:39], v[220:223], v[200:215]
ds_read_b64_tr_b16 v[220:221], v1 offset:11264
s_waitcnt lgkmcnt(4)
ds_read_b64_tr_b16 v[218:219], v1 offset:10496
v_mfma_f32_32x32x16_bf16 v[200:215], v[40:43], v[224:227], v[200:215]
ds_read_b64_tr_b16 v[222:223], v1 offset:11520
ds_read_b64_tr_b16 v[224:225], v1 offset:12288
s_waitcnt lgkmcnt(5)
v_mfma_f32_32x32x16_bf16 v[200:215], v[44:47], v[228:231], v[200:215]
ds_read_b64_tr_b16 v[228:229], v1 offset:13312
ds_read_b64_tr_b16 v[226:227], v1 offset:12544
s_waitcnt lgkmcnt(6)
s_waitcnt lgkmcnt(4)
ds_read_b64_tr_b16 v[230:231], v1 offset:13568
v_mfma_f32_32x32x16_bf16 v[200:215], v[48:51], v[216:219], v[200:215]
ds_read_b64_tr_b16 v[218:219], v1 offset:14592
s_add_u32 m0, s25, 6144
s_add_u32 s20, s26, 4096
buffer_load_dwordx4 v0, s[4:7], s20 offen sc1 lds
s_waitcnt lgkmcnt(5)
ds_read_b64_tr_b16 v[216:217], v1 offset:14336
v_mfma_f32_32x32x16_bf16 v[200:215], v[52:55], v[220:223], v[200:215]
ds_read_b64_tr_b16 v[222:223], v1 offset:15616
s_waitcnt lgkmcnt(4)
s_add_u32 m0, s25, 7168
s_add_u32 s20, s26, 5120
buffer_load_dwordx4 v0, s[4:7], s20 offen sc1 lds
ds_read_b64_tr_b16 v[220:221], v1 offset:15360
v_mfma_f32_32x32x16_bf16 v[200:215], v[56:59], v[224:227], v[200:215]
s_waitcnt lgkmcnt(4)
ds_read_b64_tr_b16 v[226:227], v1 offset:16640
ds_read_b64_tr_b16 v[224:225], v1 offset:16384
s_waitcnt lgkmcnt(5)
s_waitcnt lgkmcnt(4)
v_mfma_f32_32x32x16_bf16 v[200:215], v[60:63], v[228:231], v[200:215]
v_mfma_f32_32x32x16_bf16 v[200:215], v[64:67], v[216:219], v[200:215]
s_waitcnt lgkmcnt(2)
ds_read_b64_tr_b16 v[218:219], v1 offset:18688
s_waitcnt lgkmcnt(1)
ds_read_b64_tr_b16 v[230:231], v1 offset:17664
ds_read_b64_tr_b16 v[228:229], v1 offset:17408
ds_read_b64_tr_b16 v[216:217], v1 offset:18432
v_mfma_f32_32x32x16_bf16 v[200:215], v[68:71], v[220:223], v[200:215]
v_mfma_f32_32x32x16_bf16 v[200:215], v[72:75], v[224:227], v[200:215]
s_waitcnt lgkmcnt(3)
ds_read_b64_tr_b16 v[224:225], v1 offset:20480
ds_read_b64_tr_b16 v[226:227], v1 offset:20736
ds_read_b64_tr_b16 v[222:223], v1 offset:19712
s_waitcnt lgkmcnt(4)
ds_read_b64_tr_b16 v[220:221], v1 offset:19456
v_mfma_f32_32x32x16_bf16 v[200:215], v[76:79], v[228:231], v[200:215]
ds_read_b64_tr_b16 v[230:231], v1 offset:21760
s_waitcnt lgkmcnt(5)
ds_read_b64_tr_b16 v[228:229], v1 offset:21504
v_mfma_f32_32x32x16_bf16 v[200:215], v[80:83], v[216:219], v[200:215]
ds_read_b64_tr_b16 v[218:219], v1 offset:22784
s_waitcnt lgkmcnt(3)
ds_read_b64_tr_b16 v[216:217], v1 offset:22528
v_mfma_f32_32x32x16_bf16 v[200:215], v[84:87], v[220:223], v[200:215]
ds_read_b64_tr_b16 v[220:221], v1 offset:23552
s_waitcnt lgkmcnt(4)
ds_read_b64_tr_b16 v[222:223], v1 offset:23808
v_mfma_f32_32x32x16_bf16 v[200:215], v[88:91], v[224:227], v[200:215]
s_add_u32 m0, s25, 8192
s_add_u32 s20, s26, 6144
buffer_load_dwordx4 v0, s[4:7], s20 offen sc1 lds
s_waitcnt lgkmcnt(2)
ds_read_b64_tr_b16 v[224:225], v1 offset:24576
ds_read_b64_tr_b16 v[226:227], v1 offset:24832
v_mfma_f32_32x32x16_bf16 v[200:215], v[92:95], v[228:231], v[200:215]
s_waitcnt lgkmcnt(3)
ds_read_b64_tr_b16 v[230:231], v1 offset:25856
s_waitcnt lgkmcnt(3)
v_mfma_f32_32x32x16_bf16 v[200:215], v[96:99], v[216:219], v[200:215]
s_waitcnt lgkmcnt(2)
ds_read_b64_tr_b16 v[228:229], v1 offset:25600
ds_read_b64_tr_b16 v[218:219], v1 offset:26880
v_mfma_f32_32x32x16_bf16 v[200:215], v[100:103], v[220:223], v[200:215]
ds_read_b64_tr_b16 v[216:217], v1 offset:26624
ds_read_b64_tr_b16 v[222:223], v1 offset:27904
ds_read_b64_tr_b16 v[220:221], v1 offset:27648
s_waitcnt lgkmcnt(6)
v_mfma_f32_32x32x16_bf16 v[200:215], v[104:107], v[224:227], v[200:215]
s_waitcnt lgkmcnt(4)
ds_read_b64_tr_b16 v[224:225], v1 offset:28672
ds_read_b64_tr_b16 v[226:227], v1 offset:28928
s_waitcnt lgkmcnt(5)
v_mfma_f32_32x32x16_bf16 v[200:215], v[108:111], v[228:231], v[200:215]
ds_read_b64_tr_b16 v[228:229], v1 offset:29696
s_waitcnt lgkmcnt(5)
v_mfma_f32_32x32x16_bf16 v[200:215], v[112:115], v[216:219], v[200:215]
s_waitcnt lgkmcnt(4)
s_waitcnt lgkmcnt(1)
ds_read_b64_tr_b16 v[218:219], v1 offset:30976
ds_read_b64_tr_b16 v[230:231], v1 offset:29952
v_mfma_f32_32x32x16_bf16 v[200:215], v[116:119], v[220:223], v[200:215]
s_add_u32 m0, s25, 9216
s_add_u32 s20, s26, 7168
buffer_load_dwordx4 v0, s[4:7], s20 offen sc1 lds
ds_read_b64_tr_b16 v[216:217], v1 offset:30720
ds_read_b64_tr_b16 v[220:221], v1 offset:31744
s_waitcnt lgkmcnt(4)
v_mfma_f32_32x32x16_bf16 v[200:215], v[120:123], v[224:227], v[200:215]
ds_read_b64_tr_b16 v[226:227], v1 offset:33024
ds_read_b64_tr_b16 v[222:223], v1 offset:32000
ds_read_b64_tr_b16 v[224:225], v1 offset:32768
s_waitcnt lgkmcnt(5)
v_lshrrev_b32 v2, 2, v0
v_mfma_f32_32x32x16_bf16 v[200:215], v[124:127], v[228:231], v[200:215]
s_add_u32 m0, s25, 10240
s_add_u32 s20, s26, 8192
buffer_load_dwordx4 v0, s[4:7], s20 offen sc1 lds
s_waitcnt lgkmcnt(4)
ds_read_b64_tr_b16 v[228:229], v1 offset:33792
s_waitcnt lgkmcnt(4)
v_mfma_f32_32x32x16_bf16 v[200:215], v[128:131], v[216:219], v[200:215]
s_waitcnt lgkmcnt(3)
s_waitcnt lgkmcnt(2)
ds_read_b64_tr_b16 v[230:231], v1 offset:34048
ds_read_b64_tr_b16 v[216:217], v1 offset:34816
ds_read_b64_tr_b16 v[218:219], v1 offset:35072
v_mfma_f32_32x32x16_bf16 v[200:215], v[132:135], v[220:223], v[200:215]
s_waitcnt vmcnt(10)
s_waitcnt lgkmcnt(4)
ds_read_b64_tr_b16 v[220:221], v1 offset:35840
s_add_u32 m0, s25, 11264
s_add_u32 s20, s26, 9216
buffer_load_dwordx4 v0, s[4:7], s20 offen sc1 lds
v_mfma_f32_32x32x16_bf16 v[200:215], v[136:139], v[224:227], v[200:215]
ds_read_b64_tr_b16 v[222:223], v1 offset:36096
ds_read_b64_tr_b16 v[226:227], v1 offset:37120
v_and_b32 v187, 0xffff0000, v177
s_waitcnt lgkmcnt(5)
v_lshlrev_b32 v184, 16, v176
s_waitcnt vmcnt(10)
v_mfma_f32_32x32x16_bf16 v[200:215], v[140:143], v[228:231], v[200:215]
s_waitcnt lgkmcnt(3)
ds_read_b64_tr_b16 v[230:231], v1 offset:38144
ds_read_b64_tr_b16 v[224:225], v1 offset:36864
s_waitcnt lgkmcnt(4)
ds_read_b64_tr_b16 v[228:229], v1 offset:37888
v_mfma_f32_32x32x16_bf16 v[200:215], v[144:147], v[216:219], v[200:215]
s_waitcnt lgkmcnt(3)
ds_read_b64_tr_b16 v[218:219], v1 offset:39168
ds_read_b64_tr_b16 v[216:217], v1 offset:38912
v_and_b32 v199, 0xffff0000, v183
v_mfma_f32_32x32x16_bf16 v[200:215], v[148:151], v[220:223], v[200:215]
s_waitcnt lgkmcnt(4)
s_waitcnt lgkmcnt(3)
s_waitcnt lgkmcnt(2)
v_lshlrev_b32 v198, 16, v183
v_and_b32 v189, 0xffff0000, v178
v_and_b32 v197, 0xffff0000, v182
v_mfma_f32_32x32x16_bf16 v[200:215], v[152:155], v[224:227], v[200:215]
ds_read_b64_tr_b16 v[220:221], v1 offset:39936
s_waitcnt lgkmcnt(2)
ds_read_b64_tr_b16 v[224:225], v1 offset:40960
ds_read_b64_tr_b16 v[222:223], v1 offset:40192
v_mfma_f32_32x32x16_bf16 v[200:215], v[156:159], v[228:231], v[200:215]
s_waitcnt lgkmcnt(3)
ds_read_b64_tr_b16 v[230:231], v1 offset:42240
ds_read_b64_tr_b16 v[226:227], v1 offset:41216
v_mfma_f32_32x32x16_bf16 v[200:215], v[160:163], v[216:219], v[200:215]
ds_read_b64_tr_b16 v[228:229], v1 offset:41984
s_waitcnt lgkmcnt(3)
v_and_b32 v193, 0xffff0000, v180
v_lshlrev_b32 v186, 16, v177
v_and_b32 v191, 0xffff0000, v179
v_mfma_f32_32x32x16_bf16 v[200:215], v[164:167], v[220:223], v[200:215]
s_waitcnt lgkmcnt(1)
v_lshlrev_b32 v196, 16, v182
v_mfma_f32_32x32x16_bf16 v[200:215], v[168:171], v[224:227], v[200:215]
v_lshlrev_b32 v188, 16, v178
s_waitcnt lgkmcnt(0)
v_lshlrev_b32 v194, 16, v181
v_mfma_f32_32x32x16_bf16 v[200:215], v[172:175], v[228:231], v[200:215]
s_nop 0
v_lshlrev_b32 v190, 16, v179
v_lshlrev_b32 v192, 16, v180
v_and_b32 v185, 0xffff0000, v176
v_and_b32 v195, 0xffff0000, v181
v_mov_b32 v176, 0x3b4ccccd
s_nop 5
v_pk_fma_f32 v[200:201], v[200:201], v[176:177], v[184:185] op_sel_hi:[1,0,1]
v_pk_fma_f32 v[202:203], v[202:203], v[176:177], v[186:187] op_sel_hi:[1,0,1]
v_pk_fma_f32 v[204:205], v[204:205], v[176:177], v[188:189] op_sel_hi:[1,0,1]
v_pk_mul_f32 v[180:181], v[200:201], v[200:201]
v_pk_fma_f32 v[206:207], v[206:207], v[176:177], v[190:191] op_sel_hi:[1,0,1]
v_pk_add_f32 v[178:179], v[200:201], v[202:203]
v_pk_fma_f32 v[208:209], v[208:209], v[176:177], v[192:193] op_sel_hi:[1,0,1]
v_pk_add_f32 v[178:179], v[178:179], v[204:205]
v_pk_add_f32 v[178:179], v[178:179], v[206:207]
v_pk_fma_f32 v[180:181], v[202:203], v[202:203], v[180:181]
v_pk_fma_f32 v[180:181], v[204:205], v[204:205], v[180:181]
v_pk_fma_f32 v[210:211], v[210:211], v[176:177], v[194:195] op_sel_hi:[1,0,1]
v_pk_fma_f32 v[180:181], v[206:207], v[206:207], v[180:181]
v_pk_add_f32 v[178:179], v[178:179], v[208:209]
v_pk_fma_f32 v[180:181], v[208:209], v[208:209], v[180:181]
v_pk_add_f32 v[178:179], v[178:179], v[210:211]
v_pk_fma_f32 v[180:181], v[210:211], v[210:211], v[180:181]
v_pk_fma_f32 v[214:215], v[214:215], v[176:177], v[198:199] op_sel_hi:[1,0,1]
v_pk_fma_f32 v[212:213], v[212:213], v[176:177], v[196:197] op_sel_hi:[1,0,1]
v_pk_add_f32 v[178:179], v[178:179], v[212:213]
v_pk_add_f32 v[178:179], v[178:179], v[214:215]
v_pk_fma_f32 v[180:181], v[212:213], v[212:213], v[180:181]
v_add_f32 v178, v178, v179
v_pk_fma_f32 v[180:181], v[214:215], v[214:215], v[180:181]
v_add_f32 v180, v180, v181
v_cvt_pk_bf16_f32 v220, v208, v209
v_cvt_pk_bf16_f32 v221, v210, v211
v_permlane32_swap_b32 v178, v180
v_cvt_pk_bf16_f32 v223, v214, v215
v_cvt_pk_bf16_f32 v222, v212, v213
v_cvt_pk_bf16_f32 v219, v206, v207
v_cvt_pk_bf16_f32 v216, v200, v201
v_cvt_pk_bf16_f32 v218, v204, v205
v_add_f32 v178, v178, v180
v_cvt_pk_bf16_f32 v217, v202, v203
buffer_store_dwordx4 v[216:219], v0, s[4:7], s27 offen offset:0 sc1
buffer_store_dwordx4 v[220:223], v0, s[4:7], s27 offen offset:1024 sc1
buffer_store_dword v178, v2, s[4:7], s36 offen sc1
v_xor_b32 v1, 40960, v1
s_mov_b32 s26, s6
s_mov_b32 s25, s31
s_add_u32 s27, s27, 1310720
s_add_u32 s36, s36, 163840
s_add_u32 s51, s51, 1310720
s_add_u32 s52, s52, 1310720
s_add_u32 s28, s28, 1
s_lshl_b32 s18, s39, 2
s_add_u32 s18, s18, 8192
s_lshl_b32 s19, s16, 1
s_add_u32 s19, s19, s28
s_cmp_eq_u32 s13, 0
s_cselect_b32 s22, s18, s6
s_mov_b32 s23, s19
s_waitcnt vmcnt(0)
s_barrier
v_mov_b32 v3, s23
s_mov_b64 exec, 1
buffer_store_dword v3, off, s[4:7], s22 sc1
s_mov_b64 exec, -1
s_mov_b32 s22, s6
s_cmp_lt_u32 s28, 2
s_cbranch_scc1 p3_51
s_cmp_ge_u32 s39, 144
s_cbranch_scc1 p1b_53
s_cmp_ge_u32 s39, 64
s_cbranch_scc1 wo_52
s_and_b32 s32, s39, 31
s_cmp_lg_u32 s16, 0
s_cbranch_scc1 qw_56
s_lshl_b32 s26, s32, 8
s_lshl_b32 s18, s13, 6
s_add_u32 s26, s26, s18
s_load_dwordx2 s[40:41], s[0:1], 40
s_mov_b32 s42, 5242880
s_mov_b32 s43, 0x20000
s_waitcnt lgkmcnt(0)
v_lshrrev_b32 v34, 6, v0
v_mul_u32_u24 v34, 8192, v34
v_and_b32 v35, 48, v0
v_add_u32 v32, v34, v35
v_bfe_u32 v34, v0, 6, 2
v_lshrrev_b32 v35, 9, v0
v_lshl_add_u32 v34, v35, 3, v34
v_lshlrev_b32 v33, 6, v34
v_and_b32 v34, 16, v0
v_add_u32 v33, v33, v34
v_bfe_u32 v34, v0, 5, 1
v_lshl_add_u32 v33, v34, 3, v33
v_bfe_u32 v34, v0, 8, 1
v_lshl_add_u32 v33, v34, 5, v33
s_mul_i32 s18, s13, 36864
v_add_u32 v33, s18, v33
s_barrier
s_add_u32 m0, s18, 0
s_add_u32 s19, s26, 0
buffer_load_dwordx4 v32, s[40:43], s19 offen lds
s_add_u32 m0, s18, 1024
s_add_u32 s19, s26, 131072
buffer_load_dwordx4 v32, s[40:43], s19 offen lds
s_add_u32 m0, s18, 2048
s_add_u32 s19, s26, 262144
buffer_load_dwordx4 v32, s[40:43], s19 offen lds
s_add_u32 m0, s18, 3072
s_add_u32 s19, s26, 393216
buffer_load_dwordx4 v32, s[40:43], s19 offen lds
s_add_u32 m0, s18, 4096
s_add_u32 s19, s26, 524288
buffer_load_dwordx4 v32, s[40:43], s19 offen lds
s_add_u32 m0, s18, 5120
s_add_u32 s19, s26, 655360
buffer_load_dwordx4 v32, s[40:43], s19 offen lds
s_add_u32 m0, s18, 6144
s_add_u32 s19, s26, 786432
buffer_load_dwordx4 v32, s[40:43], s19 offen lds
s_add_u32 m0, s18, 7168
s_add_u32 s19, s26, 917504
buffer_load_dwordx4 v32, s[40:43], s19 offen lds
s_add_u32 m0, s18, 8192
s_add_u32 s19, s26, 1048576
buffer_load_dwordx4 v32, s[40:43], s19 offen lds
s_add_u32 m0, s18, 9216
s_add_u32 s19, s26, 1179648
buffer_load_dwordx4 v32, s[40:43], s19 offen lds
s_add_u32 m0, s18, 10240
s_add_u32 s19, s26, 1310720
buffer_load_dwordx4 v32, s[40:43], s19 offen lds
s_add_u32 m0, s18, 11264
s_add_u32 s19, s26, 1441792
buffer_load_dwordx4 v32, s[40:43], s19 offen lds
s_add_u32 m0, s18, 12288
s_add_u32 s19, s26, 1572864
buffer_load_dwordx4 v32, s[40:43], s19 offen lds
s_add_u32 m0, s18, 13312
s_add_u32 s19, s26, 1703936
buffer_load_dwordx4 v32, s[40:43], s19 offen lds
s_add_u32 m0, s18, 14336
s_add_u32 s19, s26, 1835008
buffer_load_dwordx4 v32, s[40:43], s19 offen lds
s_add_u32 m0, s18, 15360
s_add_u32 s19, s26, 1966080
buffer_load_dwordx4 v32, s[40:43], s19 offen lds
s_add_u32 m0, s18, 16384
s_add_u32 s19, s26, 2097152
buffer_load_dwordx4 v32, s[40:43], s19 offen lds
s_add_u32 m0, s18, 17408
s_add_u32 s19, s26, 2228224
buffer_load_dwordx4 v32, s[40:43], s19 offen lds
s_add_u32 m0, s18, 18432
s_add_u32 s19, s26, 2359296
buffer_load_dwordx4 v32, s[40:43], s19 offen lds
s_add_u32 m0, s18, 19456
s_add_u32 s19, s26, 2490368
buffer_load_dwordx4 v32, s[40:43], s19 offen lds
s_add_u32 m0, s18, 20480
s_add_u32 s19, s26, 2621440
buffer_load_dwordx4 v32, s[40:43], s19 offen lds
s_add_u32 m0, s18, 21504
s_add_u32 s19, s26, 2752512
buffer_load_dwordx4 v32, s[40:43], s19 offen lds
s_add_u32 m0, s18, 22528
s_add_u32 s19, s26, 2883584
buffer_load_dwordx4 v32, s[40:43], s19 offen lds
s_add_u32 m0, s18, 23552
s_add_u32 s19, s26, 3014656
buffer_load_dwordx4 v32, s[40:43], s19 offen lds
s_add_u32 m0, s18, 24576
s_add_u32 s19, s26, 3145728
buffer_load_dwordx4 v32, s[40:43], s19 offen lds
s_add_u32 m0, s18, 25600
s_add_u32 s19, s26, 3276800
buffer_load_dwordx4 v32, s[40:43], s19 offen lds
s_add_u32 m0, s18, 26624
s_add_u32 s19, s26, 3407872
buffer_load_dwordx4 v32, s[40:43], s19 offen lds
s_add_u32 m0, s18, 27648
s_add_u32 s19, s26, 3538944
buffer_load_dwordx4 v32, s[40:43], s19 offen lds
s_add_u32 m0, s18, 28672
s_add_u32 s19, s26, 3670016
buffer_load_dwordx4 v32, s[40:43], s19 offen lds
s_add_u32 m0, s18, 29696
s_add_u32 s19, s26, 3801088
buffer_load_dwordx4 v32, s[40:43], s19 offen lds
s_add_u32 m0, s18, 30720
s_add_u32 s19, s26, 3932160
buffer_load_dwordx4 v32, s[40:43], s19 offen lds
s_add_u32 m0, s18, 31744
s_add_u32 s19, s26, 4063232
buffer_load_dwordx4 v32, s[40:43], s19 offen lds
s_add_u32 m0, s18, 32768
s_add_u32 s19, s26, 4194304
buffer_load_dwordx4 v32, s[40:43], s19 offen lds
s_add_u32 m0, s18, 33792
s_add_u32 s19, s26, 4325376
buffer_load_dwordx4 v32, s[40:43], s19 offen lds
s_add_u32 m0, s18, 34816
s_add_u32 s19, s26, 4456448
buffer_load_dwordx4 v32, s[40:43], s19 offen lds
s_add_u32 m0, s18, 35840
s_add_u32 s19, s26, 4587520
buffer_load_dwordx4 v32, s[40:43], s19 offen lds
s_waitcnt vmcnt(32)
ds_read_b64_tr_b16 a[0:1], v33 offset:0
ds_read_b64_tr_b16 a[2:3], v33 offset:256
ds_read_b64_tr_b16 a[4:5], v33 offset:1024
ds_read_b64_tr_b16 a[6:7], v33 offset:1280
ds_read_b64_tr_b16 a[8:9], v33 offset:2048
ds_read_b64_tr_b16 a[10:11], v33 offset:2304
ds_read_b64_tr_b16 a[12:13], v33 offset:3072
ds_read_b64_tr_b16 a[14:15], v33 offset:3328
s_waitcnt lgkmcnt(0)
s_add_u32 m0, s18, 0
s_add_u32 s19, s26, 4718592
buffer_load_dwordx4 v32, s[40:43], s19 offen lds
s_add_u32 m0, s18, 1024
s_add_u32 s19, s26, 4849664
buffer_load_dwordx4 v32, s[40:43], s19 offen lds
s_add_u32 m0, s18, 2048
s_add_u32 s19, s26, 4980736
buffer_load_dwordx4 v32, s[40:43], s19 offen lds
s_add_u32 m0, s18, 3072
s_add_u32 s19, s26, 5111808
buffer_load_dwordx4 v32, s[40:43], s19 offen lds
s_waitcnt vmcnt(32)
ds_read_b64_tr_b16 a[16:17], v33 offset:4096
ds_read_b64_tr_b16 a[18:19], v33 offset:4352
ds_read_b64_tr_b16 a[20:21], v33 offset:5120
ds_read_b64_tr_b16 a[22:23], v33 offset:5376
ds_read_b64_tr_b16 a[24:25], v33 offset:6144
ds_read_b64_tr_b16 a[26:27], v33 offset:6400
ds_read_b64_tr_b16 a[28:29], v33 offset:7168
ds_read_b64_tr_b16 a[30:31], v33 offset:7424
s_waitcnt vmcnt(28)
ds_read_b64_tr_b16 a[32:33], v33 offset:8192
ds_read_b64_tr_b16 a[34:35], v33 offset:8448
ds_read_b64_tr_b16 a[36:37], v33 offset:9216
ds_read_b64_tr_b16 a[38:39], v33 offset:9472
ds_read_b64_tr_b16 a[40:41], v33 offset:10240
ds_read_b64_tr_b16 a[42:43], v33 offset:10496
ds_read_b64_tr_b16 a[44:45], v33 offset:11264
ds_read_b64_tr_b16 a[46:47], v33 offset:11520
s_waitcnt vmcnt(24)
ds_read_b64_tr_b16 a[48:49], v33 offset:12288
ds_read_b64_tr_b16 a[50:51], v33 offset:12544
ds_read_b64_tr_b16 a[52:53], v33 offset:13312
ds_read_b64_tr_b16 a[54:55], v33 offset:13568
ds_read_b64_tr_b16 a[56:57], v33 offset:14336
ds_read_b64_tr_b16 a[58:59], v33 offset:14592
ds_read_b64_tr_b16 a[60:61], v33 offset:15360
ds_read_b64_tr_b16 a[62:63], v33 offset:15616
s_waitcnt vmcnt(20)
ds_read_b64_tr_b16 a[64:65], v33 offset:16384
ds_read_b64_tr_b16 a[66:67], v33 offset:16640
ds_read_b64_tr_b16 a[68:69], v33 offset:17408
ds_read_b64_tr_b16 a[70:71], v33 offset:17664
ds_read_b64_tr_b16 a[72:73], v33 offset:18432
ds_read_b64_tr_b16 a[74:75], v33 offset:18688
ds_read_b64_tr_b16 a[76:77], v33 offset:19456
ds_read_b64_tr_b16 a[78:79], v33 offset:19712
s_waitcnt vmcnt(16)
ds_read_b64_tr_b16 a[80:81], v33 offset:20480
ds_read_b64_tr_b16 a[82:83], v33 offset:20736
ds_read_b64_tr_b16 a[84:85], v33 offset:21504
ds_read_b64_tr_b16 a[86:87], v33 offset:21760
ds_read_b64_tr_b16 a[88:89], v33 offset:22528
ds_read_b64_tr_b16 a[90:91], v33 offset:22784
ds_read_b64_tr_b16 a[92:93], v33 offset:23552
ds_read_b64_tr_b16 a[94:95], v33 offset:23808
s_waitcnt vmcnt(12)
ds_read_b64_tr_b16 a[96:97], v33 offset:24576
ds_read_b64_tr_b16 a[98:99], v33 offset:24832
ds_read_b64_tr_b16 a[100:101], v33 offset:25600
ds_read_b64_tr_b16 a[102:103], v33 offset:25856
ds_read_b64_tr_b16 a[104:105], v33 offset:26624
ds_read_b64_tr_b16 a[106:107], v33 offset:26880
ds_read_b64_tr_b16 a[108:109], v33 offset:27648
ds_read_b64_tr_b16 a[110:111], v33 offset:27904
s_waitcnt vmcnt(8)
ds_read_b64_tr_b16 a[112:113], v33 offset:28672
ds_read_b64_tr_b16 a[114:115], v33 offset:28928
ds_read_b64_tr_b16 a[116:117], v33 offset:29696
ds_read_b64_tr_b16 a[118:119], v33 offset:29952
ds_read_b64_tr_b16 a[120:121], v33 offset:30720
ds_read_b64_tr_b16 a[122:123], v33 offset:30976
ds_read_b64_tr_b16 a[124:125], v33 offset:31744
ds_read_b64_tr_b16 a[126:127], v33 offset:32000
s_waitcnt vmcnt(4)
ds_read_b64_tr_b16 a[128:129], v33 offset:32768
ds_read_b64_tr_b16 a[130:131], v33 offset:33024
ds_read_b64_tr_b16 a[132:133], v33 offset:33792
ds_read_b64_tr_b16 a[134:135], v33 offset:34048
ds_read_b64_tr_b16 a[136:137], v33 offset:34816
ds_read_b64_tr_b16 a[138:139], v33 offset:35072
ds_read_b64_tr_b16 a[140:141], v33 offset:35840
ds_read_b64_tr_b16 a[142:143], v33 offset:36096
s_waitcnt vmcnt(0)
ds_read_b64_tr_b16 a[144:145], v33 offset:0
ds_read_b64_tr_b16 a[146:147], v33 offset:256
ds_read_b64_tr_b16 a[148:149], v33 offset:1024
ds_read_b64_tr_b16 a[150:151], v33 offset:1280
ds_read_b64_tr_b16 a[152:153], v33 offset:2048
ds_read_b64_tr_b16 a[154:155], v33 offset:2304
ds_read_b64_tr_b16 a[156:157], v33 offset:3072
ds_read_b64_tr_b16 a[158:159], v33 offset:3328
s_waitcnt lgkmcnt(0)
s_barrier
v_mov_b32 v32, s24
v_mov_b32 v33, s24
v_mov_b32 v34, s24
v_mov_b32 v35, s24
s_nop 1
v_mfma_f32_32x32x16_bf16 v[36:51], a[0:3], v[32:35], 0
v_mfma_f32_32x32x16_bf16 v[36:51], a[4:7], v[32:35], v[36:51]
v_mfma_f32_32x32x16_bf16 v[36:51], a[8:11], v[32:35], v[36:51]
v_mfma_f32_32x32x16_bf16 v[36:51], a[12:15], v[32:35], v[36:51]
v_mfma_f32_32x32x16_bf16 v[36:51], a[16:19], v[32:35], v[36:51]
v_mfma_f32_32x32x16_bf16 v[36:51], a[20:23], v[32:35], v[36:51]
v_mfma_f32_32x32x16_bf16 v[36:51], a[24:27], v[32:35], v[36:51]
v_mfma_f32_32x32x16_bf16 v[36:51], a[28:31], v[32:35], v[36:51]
v_mfma_f32_32x32x16_bf16 v[36:51], a[32:35], v[32:35], v[36:51]
v_mfma_f32_32x32x16_bf16 v[36:51], a[36:39], v[32:35], v[36:51]
v_mfma_f32_32x32x16_bf16 v[36:51], a[40:43], v[32:35], v[36:51]
v_mfma_f32_32x32x16_bf16 v[36:51], a[44:47], v[32:35], v[36:51]
v_mfma_f32_32x32x16_bf16 v[36:51], a[48:51], v[32:35], v[36:51]
v_mfma_f32_32x32x16_bf16 v[36:51], a[52:55], v[32:35], v[36:51]
v_mfma_f32_32x32x16_bf16 v[36:51], a[56:59], v[32:35], v[36:51]
v_mfma_f32_32x32x16_bf16 v[36:51], a[60:63], v[32:35], v[36:51]
v_mfma_f32_32x32x16_bf16 v[36:51], a[64:67], v[32:35], v[36:51]
v_mfma_f32_32x32x16_bf16 v[36:51], a[68:71], v[32:35], v[36:51]
v_mfma_f32_32x32x16_bf16 v[36:51], a[72:75], v[32:35], v[36:51]
v_mfma_f32_32x32x16_bf16 v[36:51], a[76:79], v[32:35], v[36:51]
v_mfma_f32_32x32x16_bf16 v[36:51], a[80:83], v[32:35], v[36:51]
v_mfma_f32_32x32x16_bf16 v[36:51], a[84:87], v[32:35], v[36:51]
v_mfma_f32_32x32x16_bf16 v[36:51], a[88:91], v[32:35], v[36:51]
v_mfma_f32_32x32x16_bf16 v[36:51], a[92:95], v[32:35], v[36:51]
v_mfma_f32_32x32x16_bf16 v[36:51], a[96:99], v[32:35], v[36:51]
v_mfma_f32_32x32x16_bf16 v[36:51], a[100:103], v[32:35], v[36:51]
v_mfma_f32_32x32x16_bf16 v[36:51], a[104:107], v[32:35], v[36:51]
v_mfma_f32_32x32x16_bf16 v[36:51], a[108:111], v[32:35], v[36:51]
v_mfma_f32_32x32x16_bf16 v[36:51], a[112:115], v[32:35], v[36:51]
v_mfma_f32_32x32x16_bf16 v[36:51], a[116:119], v[32:35], v[36:51]
v_mfma_f32_32x32x16_bf16 v[36:51], a[120:123], v[32:35], v[36:51]
v_mfma_f32_32x32x16_bf16 v[36:51], a[124:127], v[32:35], v[36:51]
v_mfma_f32_32x32x16_bf16 v[36:51], a[128:131], v[32:35], v[36:51]
v_mfma_f32_32x32x16_bf16 v[36:51], a[132:135], v[32:35], v[36:51]
v_mfma_f32_32x32x16_bf16 v[36:51], a[136:139], v[32:35], v[36:51]
v_mfma_f32_32x32x16_bf16 v[36:51], a[140:143], v[32:35], v[36:51]
v_mfma_f32_32x32x16_bf16 v[36:51], a[144:147], v[32:35], v[36:51]
v_mfma_f32_32x32x16_bf16 v[36:51], a[148:151], v[32:35], v[36:51]
v_mfma_f32_32x32x16_bf16 v[36:51], a[152:155], v[32:35], v[36:51]
v_mfma_f32_32x32x16_bf16 v[36:51], a[156:159], v[32:35], v[36:51]
s_nop 11
v_mov_b32 v16, v36
v_mov_b32 v17, v37
v_mov_b32 v18, v38
v_mov_b32 v19, v39
v_mov_b32 v20, v40
v_mov_b32 v21, v41
v_mov_b32 v22, v42
v_mov_b32 v23, v43
v_mov_b32 v24, v44
v_mov_b32 v25, v45
v_mov_b32 v26, v46
v_mov_b32 v27, v47
v_mov_b32 v28, v48
v_mov_b32 v29, v49
v_mov_b32 v30, v50
v_mov_b32 v31, v51
v_accvgpr_write_b32 a160, v16
v_accvgpr_write_b32 a161, v17
v_accvgpr_write_b32 a162, v18
v_accvgpr_write_b32 a163, v19
v_accvgpr_write_b32 a164, v20
v_accvgpr_write_b32 a165, v21
v_accvgpr_write_b32 a166, v22
v_accvgpr_write_b32 a167, v23
v_accvgpr_write_b32 a168, v24
v_accvgpr_write_b32 a169, v25
v_accvgpr_write_b32 a170, v26
v_accvgpr_write_b32 a171, v27
v_accvgpr_write_b32 a172, v28
v_accvgpr_write_b32 a173, v29
v_accvgpr_write_b32 a174, v30
v_accvgpr_write_b32 a175, v31
qw_56:
v_accvgpr_read_b32 v16, a160
v_accvgpr_read_b32 v17, a161
v_accvgpr_read_b32 v18, a162
v_accvgpr_read_b32 v19, a163
v_accvgpr_read_b32 v20, a164
v_accvgpr_read_b32 v21, a165
v_accvgpr_read_b32 v22, a166
v_accvgpr_read_b32 v23, a167
v_accvgpr_read_b32 v24, a168
v_accvgpr_read_b32 v25, a169
v_accvgpr_read_b32 v26, a170
v_accvgpr_read_b32 v27, a171
v_accvgpr_read_b32 v28, a172
v_accvgpr_read_b32 v29, a173
v_accvgpr_read_b32 v30, a174
v_accvgpr_read_b32 v31, a175
s_lshl_b32 s29, s16, 1
s_add_u32 s29, s29, 2
s_lshr_b32 s52, s39, 5
s_lshl_b32 s53, s32, 7
s_add_u32 s53, s53, 0
s_cmp_lg_u32 s13, 0
s_cbranch_scc1 polld_58
v_min_u32 v12, 624, v0
s_mov_b32 s21, 8192
s_mov_b32 s17, 0
poll_57:
buffer_load_dwordx4 v[8:11], v12, s[4:7], s21 offen offset:0 sc1
s_add_u32 s17, s17, 1
s_cmp_gt_u32 s17, 262144
s_cbranch_scc1 L_fail
s_waitcnt vmcnt(0)
v_min3_u32 v8, v8, v9, v10
v_min_u32 v8, v8, v11
v_cmp_gt_u32 vcc, s29, v8
s_cbranch_vccz polld_58
s_sleep 2
s_branch poll_57
polld_58:
s_barrier
qr_59:
s_mul_i32 s26, s16, 6291456
s_mul_i32 s18, s52, 163840
s_add_u32 s26, s26, s18
s_add_u32 s26, s26, s31
s_add_u32 s26, s26, 88080384
s_lshl_b32 s18, s16, 4
s_add_u32 s18, s18, s52
s_mul_i32 s18, s18, 20480
s_add_u32 s36, s18, 163577856
s_lshl_b32 s18, s13, 11
s_add_u32 s18, s18, 83968
v_add_u32 v13, s18, v0
s_mov_b32 s28, 0
v_xor_b32 v1, 40960, v0
s_mov_b32 s25, s31
s_mov_b32 s35, 131072
s_add_u32 m0, s25, 2048
s_add_u32 s20, s26, 0
buffer_load_dwordx4 v0, s[4:7], s20 offen sc1 lds
s_add_u32 m0, s25, 3072
s_add_u32 s20, s26, 1024
buffer_load_dwordx4 v0, s[4:7], s20 offen sc1 lds
s_add_u32 m0, s25, 4096
s_add_u32 s20, s26, 2048
buffer_load_dwordx4 v0, s[4:7], s20 offen sc1 lds
s_add_u32 m0, s25, 5120
s_add_u32 s20, s26, 3072
buffer_load_dwordx4 v0, s[4:7], s20 offen sc1 lds
s_add_u32 m0, s25, 6144
s_add_u32 s20, s26, 4096
buffer_load_dwordx4 v0, s[4:7], s20 offen sc1 lds
s_add_u32 m0, s25, 7168
s_add_u32 s20, s26, 5120
buffer_load_dwordx4 v0, s[4:7], s20 offen sc1 lds
s_add_u32 m0, s25, 8192
s_add_u32 s20, s26, 6144
buffer_load_dwordx4 v0, s[4:7], s20 offen sc1 lds
s_add_u32 m0, s25, 9216
s_add_u32 s20, s26, 7168
buffer_load_dwordx4 v0, s[4:7], s20 offen sc1 lds
s_add_u32 m0, s25, 10240
s_add_u32 s20, s26, 8192
buffer_load_dwordx4 v0, s[4:7], s20 offen sc1 lds
s_add_u32 m0, s25, 11264
s_add_u32 s20, s26, 9216
buffer_load_dwordx4 v0, s[4:7], s20 offen sc1 lds
s_add_u32 m0, s35, s37
s_add_u32 s20, s36, s37
buffer_load_dwordx4 v0, s[4:7], s20 offen sc1 lds
s_add_u32 m0, s35, 4096
s_add_u32 s20, s36, 4096
buffer_load_dwordx4 v0, s[4:7], s20 offen sc1 lds
s_waitcnt vmcnt(0)
qu_60:
v_xor_b32 v1, 40960, v1
s_sub_u32 s25, s25, s31
s_xor_b32 s25, s25, 40960
s_add_u32 s25, s25, s31
s_xor_b32 s35, s35, 8192
s_add_u32 s26, s26, 40960
s_add_u32 s36, s36, 5120
s_cmp_eq_u32 s28, 3
s_cselect_b32 s26, s6, s26
s_cselect_b32 s36, s6, s36
s_waitcnt vmcnt(0)
s_barrier
ds_read_b128 v[48:51], v1 offset:2048
ds_read_b128 v[52:55], v1 offset:3072
s_add_u32 m0, s25, 2048
s_add_u32 s20, s26, 0
buffer_load_dwordx4 v0, s[4:7], s20 offen sc1 lds
v_lshrrev_b32 v2, 2, v0
ds_read_b128 v[56:59], v1 offset:4096
ds_read_b128 v[60:63], v1 offset:5120
s_xor_b32 s18, s35, 8192
v_add_u32 v2, s18, v2
ds_read2st64_b32 v[72:73], v2 offset0:4 offset1:5
s_waitcnt lgkmcnt(4)
v_mfma_f32_32x32x16_bf16 v[32:47], a[0:3], v[48:51], 0
s_add_u32 m0, s25, 3072
s_add_u32 s20, s26, 1024
buffer_load_dwordx4 v0, s[4:7], s20 offen sc1 lds
ds_read_b128 v[48:51], v1 offset:6144
ds_read2st64_b32 v[66:67], v2 offset0:2 offset1:3
s_waitcnt lgkmcnt(4)
v_mfma_f32_32x32x16_bf16 v[32:47], a[4:7], v[52:55], v[32:47]
ds_read_b128 v[52:55], v1 offset:7168
ds_read2st64_b32 v[78:79], v2 offset0:10 offset1:11
s_add_u32 m0, s25, 4096
s_add_u32 s20, s26, 2048
buffer_load_dwordx4 v0, s[4:7], s20 offen sc1 lds
v_mfma_f32_32x32x16_bf16 v[32:47], a[8:11], v[56:59], v[32:47]
s_waitcnt lgkmcnt(3)
ds_read_b128 v[56:59], v1 offset:8192
ds_read2st64_b32 v[86:87], v2 offset0:18 offset1:19
v_mfma_f32_32x32x16_bf16 v[32:47], a[12:15], v[60:63], v[32:47]
ds_read_b128 v[60:63], v1 offset:9216
ds_read2st64_b32 v[64:65], v2 offset0:0 offset1:1
s_waitcnt lgkmcnt(5)
ds_read2st64_b32 v[74:75], v2 offset0:6 offset1:7
v_mfma_f32_32x32x16_bf16 v[32:47], a[16:19], v[48:51], v[32:47]
ds_read2st64_b32 v[80:81], v2 offset0:12 offset1:13
ds_read_b128 v[48:51], v1 offset:10240
ds_read2st64_b32 v[82:83], v2 offset0:14 offset1:15
ds_read2st64_b32 v[76:77], v2 offset0:8 offset1:9
v_mfma_f32_32x32x16_bf16 v[32:47], a[20:23], v[52:55], v[32:47]
ds_read_b128 v[52:55], v1 offset:11264
s_waitcnt lgkmcnt(9)
s_add_u32 m0, s25, 5120
s_add_u32 s20, s26, 3072
buffer_load_dwordx4 v0, s[4:7], s20 offen sc1 lds
v_mfma_f32_32x32x16_bf16 v[32:47], a[24:27], v[56:59], v[32:47]
s_waitcnt lgkmcnt(7)
s_add_u32 m0, s25, 6144
s_add_u32 s20, s26, 4096
buffer_load_dwordx4 v0, s[4:7], s20 offen sc1 lds
s_waitcnt lgkmcnt(6)
v_add_f32 v64, v64, v66
v_mfma_f32_32x32x16_bf16 v[32:47], a[28:31], v[60:63], v[32:47]
ds_read_b128 v[56:59], v1 offset:12288
ds_read_b128 v[60:63], v1 offset:13312
v_add_f32 v65, v65, v67
s_waitcnt lgkmcnt(5)
v_mfma_f32_32x32x16_bf16 v[32:47], a[32:35], v[48:51], v[32:47]
ds_read_b128 v[48:51], v1 offset:14336
v_add_f32 v65, v65, v73
s_waitcnt lgkmcnt(3)
v_add_f32 v65, v65, v75
v_mfma_f32_32x32x16_bf16 v[32:47], a[36:39], v[52:55], v[32:47]
s_add_u32 m0, s25, 7168
s_add_u32 s20, s26, 5120
buffer_load_dwordx4 v0, s[4:7], s20 offen sc1 lds
ds_read2st64_b32 v[84:85], v2 offset0:16 offset1:17
v_add_f32 v64, v64, v72
s_waitcnt lgkmcnt(3)
v_add_f32 v65, v65, v77
v_mfma_f32_32x32x16_bf16 v[32:47], a[40:43], v[56:59], v[32:47]
s_waitcnt lgkmcnt(2)
ds_read_b128 v[56:59], v1 offset:16384
ds_read_b128 v[52:55], v1 offset:15360
v_add_f32 v64, v64, v74
v_add_f32 v64, v64, v76
v_mfma_f32_32x32x16_bf16 v[32:47], a[44:47], v[60:63], v[32:47]
s_waitcnt lgkmcnt(3)
ds_read_b128 v[60:63], v1 offset:17408
v_add_f32 v65, v65, v79
v_mfma_f32_32x32x16_bf16 v[32:47], a[48:51], v[48:51], v[32:47]
v_add_f32 v64, v64, v78
s_add_u32 m0, s25, 8192
s_add_u32 s20, s26, 6144
buffer_load_dwordx4 v0, s[4:7], s20 offen sc1 lds
s_waitcnt lgkmcnt(1)
v_mfma_f32_32x32x16_bf16 v[32:47], a[52:55], v[52:55], v[32:47]
ds_read_b128 v[48:51], v1 offset:18432
v_add_f32 v65, v65, v81
s_waitcnt lgkmcnt(1)
ds_read_b128 v[52:55], v1 offset:19456
v_mfma_f32_32x32x16_bf16 v[32:47], a[56:59], v[56:59], v[32:47]
s_add_u32 m0, s25, 9216
s_add_u32 s20, s26, 7168
buffer_load_dwordx4 v0, s[4:7], s20 offen sc1 lds
v_mfma_f32_32x32x16_bf16 v[32:47], a[60:63], v[60:63], v[32:47]
ds_read_b128 v[60:63], v1 offset:21504
s_waitcnt lgkmcnt(2)
ds_read_b128 v[56:59], v1 offset:20480
v_mfma_f32_32x32x16_bf16 v[32:47], a[64:67], v[48:51], v[32:47]
v_add_f32 v65, v65, v83
s_waitcnt lgkmcnt(2)
ds_read_b128 v[48:51], v1 offset:22528
v_mfma_f32_32x32x16_bf16 v[32:47], a[68:71], v[52:55], v[32:47]
v_add_f32 v65, v65, v85
v_add_f32 v64, v64, v80
v_add_f32 v64, v64, v82
s_waitcnt lgkmcnt(2)
s_waitcnt lgkmcnt(1)
v_mfma_f32_32x32x16_bf16 v[32:47], a[72:75], v[56:59], v[32:47]
s_add_u32 m0, s25, 10240
s_add_u32 s20, s26, 8192
buffer_load_dwordx4 v0, s[4:7], s20 offen sc1 lds
ds_read_b128 v[52:55], v1 offset:23552
v_add_f32 v64, v64, v84
v_add_f32 v65, v65, v87
s_waitcnt lgkmcnt(1)
v_mfma_f32_32x32x16_bf16 v[32:47], a[76:79], v[60:63], v[32:47]
v_add_f32 v64, v64, v86
ds_read_b128 v[56:59], v1 offset:24576
v_mfma_f32_32x32x16_bf16 v[32:47], a[80:83], v[48:51], v[32:47]
ds_read_b128 v[60:63], v1 offset:25600
ds_read_b128 v[48:51], v1 offset:26624
v_add_f32 v64, v64, v65
v_mov_b32 v68, v64
s_waitcnt lgkmcnt(3)
v_mfma_f32_32x32x16_bf16 v[32:47], a[84:87], v[52:55], v[32:47]
s_add_u32 m0, s25, 11264
s_add_u32 s20, s26, 9216
buffer_load_dwordx4 v0, s[4:7], s20 offen sc1 lds
s_waitcnt lgkmcnt(2)
v_permlane32_swap_b32 v64, v68
v_mfma_f32_32x32x16_bf16 v[32:47], a[88:91], v[56:59], v[32:47]
ds_read_b128 v[56:59], v1 offset:28672
ds_read_b128 v[52:55], v1 offset:27648
v_mul_f32 v68, 0x3acccccd, v68
s_waitcnt lgkmcnt(3)
v_mul_f32 v64, 0x3acccccd, v64
v_fma_f32 v68, -v64, v64, v68
v_mfma_f32_32x32x16_bf16 v[32:47], a[92:95], v[60:63], v[32:47]
s_add_u32 m0, s35, s37
s_add_u32 s20, s36, s37
buffer_load_dwordx4 v0, s[4:7], s20 offen sc1 lds
ds_read_b128 v[60:63], v1 offset:29696
s_waitcnt lgkmcnt(3)
v_max_f32 v68, 0, v68
v_add_f32 v68, 0x3727c5ac, v68
v_mfma_f32_32x32x16_bf16 v[32:47], a[96:99], v[48:51], v[32:47]
ds_read_b128 v[48:51], v1 offset:30720
v_rsq_f32 v68, v68
s_waitcnt lgkmcnt(2)
v_mul_f32 v68, 0x3e0293ee, v68
v_mfma_f32_32x32x16_bf16 v[32:47], a[100:103], v[52:55], v[32:47]
s_add_u32 m0, s35, 4096
s_add_u32 s20, s36, 4096
buffer_load_dwordx4 v0, s[4:7], s20 offen sc1 lds
v_mul_f32 v64, v68, v64
s_waitcnt lgkmcnt(1)
v_mfma_f32_32x32x16_bf16 v[32:47], a[104:107], v[56:59], v[32:47]
v_mul_f32 v82, v64, v26
s_waitcnt lgkmcnt(0)
ds_read_b128 v[52:55], v1 offset:31744
ds_read_b128 v[56:59], v1 offset:32768
v_mfma_f32_32x32x16_bf16 v[32:47], a[108:111], v[60:63], v[32:47]
ds_read_b128 v[60:63], v1 offset:33792
v_mfma_f32_32x32x16_bf16 v[32:47], a[112:115], v[48:51], v[32:47]
s_waitcnt lgkmcnt(2)
v_mul_f32 v84, v64, v28
v_mul_f32 v73, v64, v17
v_mfma_f32_32x32x16_bf16 v[32:47], a[116:119], v[52:55], v[32:47]
ds_read_b128 v[52:55], v1 offset:35840
s_waitcnt lgkmcnt(2)
ds_read_b128 v[48:51], v1 offset:34816
v_mfma_f32_32x32x16_bf16 v[32:47], a[120:123], v[56:59], v[32:47]
v_mul_f32 v87, v64, v31
v_mul_f32 v77, v64, v21
v_mul_f32 v81, v64, v25
s_waitcnt lgkmcnt(2)
v_mfma_f32_32x32x16_bf16 v[32:47], a[124:127], v[60:63], v[32:47]
ds_read_b128 v[60:63], v1 offset:37888
s_waitcnt lgkmcnt(2)
s_waitcnt lgkmcnt(1)
ds_read_b128 v[56:59], v1 offset:36864
v_mfma_f32_32x32x16_bf16 v[32:47], a[128:131], v[48:51], v[32:47]
ds_read_b128 v[48:51], v1 offset:38912
v_mul_f32 v75, v64, v19
v_mfma_f32_32x32x16_bf16 v[32:47], a[132:135], v[52:55], v[32:47]
s_waitcnt lgkmcnt(1)
v_mfma_f32_32x32x16_bf16 v[32:47], a[136:139], v[56:59], v[32:47]
ds_read_b128 v[56:59], v1 offset:40960
ds_read_b128 v[52:55], v1 offset:39936
v_mul_f32 v79, v64, v23
v_mul_f32 v85, v64, v29
v_mul_f32 v76, v64, v20
v_mfma_f32_32x32x16_bf16 v[32:47], a[140:143], v[60:63], v[32:47]
s_waitcnt lgkmcnt(2)
ds_read_b128 v[60:63], v1 offset:41984
v_mul_f32 v74, v64, v18
v_mul_f32 v86, v64, v30
v_mfma_f32_32x32x16_bf16 v[32:47], a[144:147], v[48:51], v[32:47]
s_waitcnt lgkmcnt(1)
v_mfma_f32_32x32x16_bf16 v[32:47], a[148:151], v[52:55], v[32:47]
s_waitcnt lgkmcnt(0)
v_mfma_f32_32x32x16_bf16 v[32:47], a[152:155], v[56:59], v[32:47]
v_mfma_f32_32x32x16_bf16 v[32:47], a[156:159], v[60:63], v[32:47]
s_nop 0
v_mul_f32 v72, v64, v16
v_mul_f32 v78, v64, v22
v_mul_f32 v83, v64, v27
v_mul_f32 v80, v64, v24
s_nop 6
v_pk_fma_f32 v[44:45], v[44:45], v[68:69], v[84:85] op_sel_hi:[1,0,1] neg_lo:[0,0,1] neg_hi:[0,0,1]
v_pk_fma_f32 v[38:39], v[38:39], v[68:69], v[78:79] op_sel_hi:[1,0,1] neg_lo:[0,0,1] neg_hi:[0,0,1]
v_pk_fma_f32 v[42:43], v[42:43], v[68:69], v[82:83] op_sel_hi:[1,0,1] neg_lo:[0,0,1] neg_hi:[0,0,1]
v_pk_fma_f32 v[46:47], v[46:47], v[68:69], v[86:87] op_sel_hi:[1,0,1] neg_lo:[0,0,1] neg_hi:[0,0,1]
v_pk_fma_f32 v[34:35], v[34:35], v[68:69], v[74:75] op_sel_hi:[1,0,1] neg_lo:[0,0,1] neg_hi:[0,0,1]
v_pk_fma_f32 v[32:33], v[32:33], v[68:69], v[72:73] op_sel_hi:[1,0,1] neg_lo:[0,0,1] neg_hi:[0,0,1]
v_cvt_pk_bf16_f32 v51, v38, v39
v_cvt_pk_bf16_f32 v49, v34, v35
v_pk_fma_f32 v[36:37], v[36:37], v[68:69], v[76:77] op_sel_hi:[1,0,1] neg_lo:[0,0,1] neg_hi:[0,0,1]
v_cvt_pk_bf16_f32 v54, v44, v45
v_cvt_pk_bf16_f32 v50, v36, v37
v_cvt_pk_bf16_f32 v48, v32, v33
v_pk_fma_f32 v[40:41], v[40:41], v[68:69], v[80:81] op_sel_hi:[1,0,1] neg_lo:[0,0,1] neg_hi:[0,0,1]
v_cvt_pk_bf16_f32 v55, v46, v47
v_cvt_pk_bf16_f32 v53, v42, v43
v_cvt_pk_bf16_f32 v52, v40, v41
ds_write_b128 v13, v[48:51] offset:0
ds_write_b128 v13, v[52:55] offset:1024
v_add_u32 v13, 8192, v13
s_add_u32 s28, s28, 1
s_cmp_lt_u32 s28, 4
s_cbranch_scc1 qu_60
s_waitcnt lgkmcnt(0)
s_barrier
s_lshl_b32 s30, s52, 2
s_add_u32 s30, s30, s13
s_lshl_b32 s18, s16, 6
s_add_u32 s29, s18, s30
s_lshl_b32 s27, s29, 18
s_lshl_b32 s19, s32, 13
s_add_u32 s27, s27, s19
s_add_u32 s27, s27, 127926272
s_mul_i32 s18, s16, 34603008
s_lshl_b32 s19, s30, 19
s_add_u32 s18, s18, s19
s_lshl_b32 s19, s32, 14
s_add_u32 s18, s18, s19
s_lshl_b32 s30, s29, 7
s_add_u32 s29, s29, 1
s_lshl_b32 s19, s13, 13
s_add_u32 s19, s19, 83968
v_add_u32 v200, s19, v0
s_add_u32 s54, s18, 16777216
s_add_u32 s55, s18, 16781312
s_add_u32 s56, s18, 16785408
s_add_u32 s57, s18, 16789504
ds_read_b128 v[32:35], v200 offset:0
ds_read_b128 v[36:39], v200 offset:1024
ds_read_b128 v[40:43], v200 offset:2048
ds_read_b128 v[44:47], v200 offset:3072
ds_read_b128 v[48:51], v200 offset:4096
ds_read_b128 v[52:55], v200 offset:5120
ds_read_b128 v[56:59], v200 offset:6144
ds_read_b128 v[60:63], v200 offset:7168
v_and_b32 v14, 0x70, v0
v_lshrrev_b32 v200, 8, v0
v_lshl_add_u32 v14, v200, 7, v14
v_bfe_u32 v200, v0, 7, 1
v_lshl_add_u32 v14, v200, 12, v14
v_and_b32 v15, 0x70, v0
v_lshrrev_b32 v200, 8, v0
v_lshl_add_u32 v15, v200, 7, v15
v_bfe_u32 v200, v0, 7, 1
v_lshl_add_u32 v15, v200, 10, v15
v_bfe_u32 v200, v0, 4, 5
v_lshrrev_b32 v144, 9, v0
v_lshlrev_b32 v144, 2, v144
v_sub_u32 v200, v200, v144
v_mov_b32 v145, 0xf149f2ca
v_cmp_gt_i32 vcc, 0, v200
s_nop 1
v_cndmask_b32 v128, 0, v145, vcc
v_cmp_gt_i32 vcc, 1, v200
s_nop 1
v_cndmask_b32 v129, 0, v145, vcc
v_cmp_gt_i32 vcc, 2, v200
s_nop 1
v_cndmask_b32 v130, 0, v145, vcc
v_cmp_gt_i32 vcc, 3, v200
s_nop 1
v_cndmask_b32 v131, 0, v145, vcc
v_cmp_gt_i32 vcc, 8, v200
s_nop 1
v_cndmask_b32 v132, 0, v145, vcc
v_cmp_gt_i32 vcc, 9, v200
s_nop 1
v_cndmask_b32 v133, 0, v145, vcc
v_cmp_gt_i32 vcc, 10, v200
s_nop 1
v_cndmask_b32 v134, 0, v145, vcc
v_cmp_gt_i32 vcc, 11, v200
s_nop 1
v_cndmask_b32 v135, 0, v145, vcc
v_cmp_gt_i32 vcc, 16, v200
s_nop 1
v_cndmask_b32 v136, 0, v145, vcc
v_cmp_gt_i32 vcc, 17, v200
s_nop 1
v_cndmask_b32 v137, 0, v145, vcc
v_cmp_gt_i32 vcc, 18, v200
s_nop 1
v_cndmask_b32 v138, 0, v145, vcc
v_cmp_gt_i32 vcc, 19, v200
s_nop 1
v_cndmask_b32 v139, 0, v145, vcc
v_cmp_gt_i32 vcc, 24, v200
s_nop 1
v_cndmask_b32 v140, 0, v145, vcc
v_cmp_gt_i32 vcc, 25, v200
s_nop 1
v_cndmask_b32 v141, 0, v145, vcc
v_cmp_gt_i32 vcc, 26, v200
s_nop 1
v_cndmask_b32 v142, 0, v145, vcc
v_cmp_gt_i32 vcc, 27, v200
s_nop 1
v_cndmask_b32 v143, 0, v145, vcc
v_lshrrev_b32 v12, 2, v0
v_min_u32 v12, 4, v12
s_mov_b32 s17, 0
poll_61:
buffer_load_dword v8, v12, s[4:7], s53 offen offset:0 sc1
s_add_u32 s17, s17, 1
s_cmp_gt_u32 s17, 262144
s_cbranch_scc1 L_fail
s_waitcnt vmcnt(0)
v_cmp_gt_u32 vcc, s29, v8
s_cbranch_vccz polld_62
s_sleep 2
s_branch poll_61
polld_62:
buffer_load_dwordx4 v[64:67], v14, s[4:7], s54 offen offset:0 sc1
buffer_load_dwordx4 v[68:71], v14, s[4:7], s54 offen offset:512 sc1
buffer_load_dwordx4 v[72:75], v14, s[4:7], s54 offen offset:1024 sc1
buffer_load_dwordx4 v[76:79], v14, s[4:7], s54 offen offset:1536 sc1
buffer_load_dwordx4 v[80:83], v14, s[4:7], s56 offen offset:0 sc1
buffer_load_dwordx4 v[84:87], v14, s[4:7], s56 offen offset:512 sc1
buffer_load_dwordx4 v[88:91], v14, s[4:7], s56 offen offset:1024 sc1
buffer_load_dwordx4 v[92:95], v14, s[4:7], s56 offen offset:1536 sc1
buffer_load_dwordx4 v[96:99], v15, s[4:7], s54 offen offset:2048 sc1
buffer_load_dwordx4 v[100:103], v15, s[4:7], s54 offen offset:2560 sc1
buffer_load_dwordx4 v[104:107], v15, s[4:7], s55 offen offset:2048 sc1
buffer_load_dwordx4 v[108:111], v15, s[4:7], s55 offen offset:2560 sc1
buffer_load_dwordx4 v[112:115], v15, s[4:7], s56 offen offset:2048 sc1
buffer_load_dwordx4 v[116:119], v15, s[4:7], s56 offen offset:2560 sc1
buffer_load_dwordx4 v[120:123], v15, s[4:7], s57 offen offset:2048 sc1
buffer_load_dwordx4 v[124:127], v15, s[4:7], s57 offen offset:2560 sc1
s_waitcnt vmcnt(15) lgkmcnt(7)
v_mfma_f32_32x32x16_bf16 v[128:143], v[64:67], v[32:35], v[128:143]
s_waitcnt vmcnt(14) lgkmcnt(6)
v_mfma_f32_32x32x16_bf16 v[128:143], v[68:71], v[36:39], v[128:143]
s_waitcnt vmcnt(13) lgkmcnt(5)
v_mfma_f32_32x32x16_bf16 v[128:143], v[72:75], v[40:43], v[128:143]
s_waitcnt vmcnt(12) lgkmcnt(4)
v_mfma_f32_32x32x16_bf16 v[128:143], v[76:79], v[44:47], v[128:143]
s_waitcnt vmcnt(11) lgkmcnt(3)
v_mfma_f32_32x32x16_bf16 v[128:143], v[80:83], v[48:51], v[128:143]
s_waitcnt vmcnt(10) lgkmcnt(2)
v_mfma_f32_32x32x16_bf16 v[128:143], v[84:87], v[52:55], v[128:143]
s_waitcnt vmcnt(9) lgkmcnt(1)
v_mfma_f32_32x32x16_bf16 v[128:143], v[88:91], v[56:59], v[128:143]
s_waitcnt vmcnt(8) lgkmcnt(0)
v_mfma_f32_32x32x16_bf16 v[128:143], v[92:95], v[60:63], v[128:143]
s_lshl_b32 s18, s16, 4
s_add_u32 s29, s18, s52
s_lshl_b32 s18, s29, 19
s_lshl_b32 s19, s32, 14
s_add_u32 s18, s18, s19
s_add_u32 s29, s29, 1
s_and_b32 s19, s13, 1
s_lshr_b32 s20, s13, 1
v_and_b32 v14, 0x170, v14
v_lshl_add_u32 v14, s19, 12, v14
v_lshl_add_u32 v14, s20, 7, v14
v_lshl_add_u32 v15, s19, 3, v15
v_lshl_add_u32 v15, s20, 9, v15
s_add_u32 s54, s18, 110100480
s_add_u32 s55, s18, 110104576
s_add_u32 s56, s18, 110108672
s_add_u32 s57, s18, 110112768
v_max3_f32 v200, v128, v129, v130
v_max3_f32 v200, v200, v131, v132
v_max3_f32 v200, v200, v133, v134
v_max3_f32 v200, v200, v135, v136
v_max3_f32 v200, v200, v137, v138
v_max3_f32 v200, v200, v139, v140
v_max3_f32 v200, v200, v141, v142
v_max_f32 v200, v200, v143
v_lshrrev_b32 v12, 2, v0
v_min_u32 v12, 4, v12
s_mov_b32 s17, 0
poll_63:
buffer_load_dword v8, v12, s[4:7], s53 offen offset:8 sc1
s_add_u32 s17, s17, 1
s_cmp_gt_u32 s17, 262144
s_cbranch_scc1 L_fail
s_waitcnt vmcnt(0)
v_cmp_gt_u32 vcc, s29, v8
s_cbranch_vccz polld_64
s_sleep 2
s_branch poll_63
polld_64:
buffer_load_dwordx4 v[64:67], v14, s[4:7], s54 offen offset:0 sc1
buffer_load_dwordx4 v[68:71], v14, s[4:7], s54 offen offset:512 sc1
buffer_load_dwordx4 v[72:75], v14, s[4:7], s54 offen offset:1024 sc1
buffer_load_dwordx4 v[76:79], v14, s[4:7], s54 offen offset:1536 sc1
buffer_load_dwordx4 v[80:83], v14, s[4:7], s56 offen offset:0 sc1
buffer_load_dwordx4 v[84:87], v14, s[4:7], s56 offen offset:512 sc1
buffer_load_dwordx4 v[88:91], v14, s[4:7], s56 offen offset:1024 sc1
buffer_load_dwordx4 v[92:95], v14, s[4:7], s56 offen offset:1536 sc1
buffer_load_dwordx2 v[192:193], v15, s[4:7], s54 offen offset:2048 sc1
buffer_load_dwordx2 v[194:195], v15, s[4:7], s55 offen offset:2048 sc1
buffer_load_dwordx2 v[196:197], v15, s[4:7], s56 offen offset:2048 sc1
buffer_load_dwordx2 v[198:199], v15, s[4:7], s57 offen offset:2048 sc1
s_waitcnt vmcnt(11)
v_mfma_f32_32x32x16_bf16 v[144:159], v[64:67], v[32:35], 0
s_waitcnt vmcnt(10)
v_mfma_f32_32x32x16_bf16 v[144:159], v[68:71], v[36:39], v[144:159]
s_waitcnt vmcnt(9)
v_mfma_f32_32x32x16_bf16 v[144:159], v[72:75], v[40:43], v[144:159]
s_waitcnt vmcnt(8)
v_mfma_f32_32x32x16_bf16 v[144:159], v[76:79], v[44:47], v[144:159]
s_waitcnt vmcnt(7)
v_mfma_f32_32x32x16_bf16 v[144:159], v[80:83], v[48:51], v[144:159]
s_waitcnt vmcnt(6)
v_mfma_f32_32x32x16_bf16 v[144:159], v[84:87], v[52:55], v[144:159]
s_waitcnt vmcnt(5)
v_mfma_f32_32x32x16_bf16 v[144:159], v[88:91], v[56:59], v[144:159]
s_waitcnt vmcnt(4)
v_mfma_f32_32x32x16_bf16 v[144:159], v[92:95], v[60:63], v[144:159]
s_nop 11
v_max3_f32 v148, v200, v144, v145
v_max3_f32 v148, v148, v146, v147
v_mov_b32 v150, v148
s_nop 1
v_permlane32_swap_b32 v148, v150
v_max_f32 v148, v148, v150
v_sub_f32 v147, v147, v148
v_sub_f32 v144, v144, v148
v_exp_f32 v144, v144
v_sub_f32 v145, v145, v148
v_sub_f32 v146, v146, v148
v_exp_f32 v147, v147
v_exp_f32 v146, v146
v_exp_f32 v145, v145
v_cvt_pk_bf16_f32 v41, v146, v147
v_cvt_pk_bf16_f32 v40, v144, v145
v_sub_f32 v134, v134, v148
v_sub_f32 v133, v133, v148
s_waitcnt vmcnt(1)
v_mfma_f32_32x32x8_bf16 v[64:79], v[196:197], v[40:41], 0
v_sub_f32 v129, v129, v148
v_exp_f32 v133, v133
v_exp_f32 v129, v129
v_sub_f32 v131, v131, v148
v_mfma_f32_32x32x8_bf16 v[176:191], v[194:195], v[40:41], 0
v_sub_f32 v132, v132, v148
v_exp_f32 v132, v132
v_exp_f32 v134, v134
v_sub_f32 v128, v128, v148
s_waitcnt vmcnt(0)
v_mfma_f32_32x32x8_bf16 v[80:95], v[198:199], v[40:41], 0
v_sub_f32 v135, v135, v148
v_sub_f32 v130, v130, v148
v_exp_f32 v131, v131
v_exp_f32 v130, v130
v_mfma_f32_32x32x8_bf16 v[160:175], v[192:193], v[40:41], 0
v_exp_f32 v135, v135
v_cvt_pk_bf16_f32 v34, v132, v133
v_exp_f32 v128, v128
v_cvt_pk_bf16_f32 v33, v130, v131
v_cvt_pk_bf16_f32 v35, v134, v135
v_cvt_pk_bf16_f32 v32, v128, v129
v_sub_f32 v136, v136, v148
v_add_f32 v149, v128, v129
v_mfma_f32_32x32x16_bf16 v[80:95], v[120:123], v[32:35], v[80:95]
s_add_u32 s19, s27, 4096
v_sub_f32 v142, v142, v148
v_sub_f32 v138, v138, v148
v_sub_f32 v139, v139, v148
v_sub_f32 v143, v143, v148
v_exp_f32 v143, v143
v_mfma_f32_32x32x16_bf16 v[64:79], v[112:115], v[32:35], v[64:79]
v_exp_f32 v136, v136
v_sub_f32 v140, v140, v148
v_sub_f32 v141, v141, v148
v_exp_f32 v140, v140
v_mfma_f32_32x32x16_bf16 v[160:175], v[96:99], v[32:35], v[160:175]
v_exp_f32 v141, v141
v_sub_f32 v137, v137, v148
v_cvt_pk_bf16_f32 v38, v140, v141
v_exp_f32 v142, v142
v_mfma_f32_32x32x16_bf16 v[176:191], v[104:107], v[32:35], v[176:191]
v_cvt_pk_bf16_f32 v39, v142, v143
v_exp_f32 v137, v137
v_exp_f32 v139, v139
v_exp_f32 v138, v138
v_cvt_pk_bf16_f32 v36, v136, v137
v_cvt_pk_bf16_f32 v37, v138, v139
v_add_f32 v149, v149, v130
v_add_f32 v149, v149, v131
v_mfma_f32_32x32x16_bf16 v[160:175], v[100:103], v[36:39], v[160:175]
v_add_f32 v149, v149, v132
v_add_f32 v149, v149, v133
v_add_f32 v149, v149, v134
v_add_f32 v149, v149, v135
v_add_f32 v149, v149, v136
v_add_f32 v149, v149, v137
v_mfma_f32_32x32x16_bf16 v[64:79], v[116:119], v[36:39], v[64:79]
v_add_f32 v149, v149, v138
v_add_f32 v149, v149, v139
v_add_f32 v149, v149, v140
v_add_f32 v149, v149, v141
v_add_f32 v149, v149, v142
v_add_f32 v149, v149, v143
v_add_f32 v149, v149, v144
v_add_f32 v149, v149, v145
v_add_f32 v149, v149, v146
v_add_f32 v149, v149, v147
v_mov_b32 v150, v149
v_mfma_f32_32x32x16_bf16 v[80:95], v[124:127], v[36:39], v[80:95]
s_nop 0
v_permlane32_swap_b32 v149, v150
v_add_f32 v149, v149, v150
v_rcp_f32 v149, v149
v_mfma_f32_32x32x16_bf16 v[176:191], v[108:111], v[36:39], v[176:191]
s_nop 0
v_mul_f32 v161, v161, v149
v_mul_f32 v64, v64, v149
v_mul_f32 v167, v167, v149
v_mul_f32 v74, v74, v149
v_mul_f32 v66, v66, v149
v_mul_f32 v69, v69, v149
v_mul_f32 v67, v67, v149
v_mul_f32 v166, v166, v149
v_mul_f32 v65, v65, v149
v_mul_f32 v160, v160, v149
v_mul_f32 v71, v71, v149
v_mul_f32 v177, v177, v149
v_mul_f32 v165, v165, v149
v_mul_f32 v188, v188, v149
v_mul_f32 v170, v170, v149
v_mul_f32 v80, v80, v149
v_mul_f32 v85, v85, v149
v_cvt_pk_bf16_f32 v64, v64, v65
v_mul_f32 v178, v178, v149
v_mul_f32 v168, v168, v149
v_mul_f32 v162, v162, v149
v_mul_f32 v92, v92, v149
v_mul_f32 v84, v84, v149
v_mul_f32 v163, v163, v149
v_mul_f32 v185, v185, v149
v_cvt_pk_bf16_f32 v160, v160, v161
v_mul_f32 v73, v73, v149
v_mul_f32 v189, v189, v149
v_mul_f32 v169, v169, v149
v_mul_f32 v83, v83, v149
v_mul_f32 v172, v172, v149
v_mul_f32 v75, v75, v149
v_cvt_pk_bf16_f32 v161, v162, v163
v_mul_f32 v176, v176, v149
v_mul_f32 v91, v91, v149
v_mul_f32 v180, v180, v149
v_mul_f32 v181, v181, v149
v_cvt_pk_bf16_f32 v65, v66, v67
v_mul_f32 v164, v164, v149
v_cvt_pk_bf16_f32 v162, v164, v165
v_mul_f32 v173, v173, v149
v_mul_f32 v179, v179, v149
v_mul_f32 v190, v190, v149
v_mul_f32 v182, v182, v149
v_mul_f32 v90, v90, v149
v_mul_f32 v81, v81, v149
v_mul_f32 v89, v89, v149
v_mul_f32 v171, v171, v149
v_mul_f32 v88, v88, v149
v_mul_f32 v82, v82, v149
v_mul_f32 v68, v68, v149
v_cvt_pk_bf16_f32 v66, v68, v69
v_mul_f32 v174, v174, v149
v_mul_f32 v183, v183, v149
v_cvt_pk_bf16_f32 v164, v168, v169
v_cvt_pk_bf16_f32 v165, v170, v171
v_cvt_pk_bf16_f32 v176, v176, v177
v_mul_f32 v72, v72, v149
v_cvt_pk_bf16_f32 v177, v178, v179
v_cvt_pk_bf16_f32 v163, v166, v167
v_mul_f32 v95, v95, v149
v_mul_f32 v175, v175, v149
v_mul_f32 v79, v79, v149
v_cvt_pk_bf16_f32 v166, v172, v173
v_cvt_pk_bf16_f32 v167, v174, v175
v_cvt_pk_bf16_f32 v178, v180, v181
v_cvt_pk_bf16_f32 v179, v182, v183
v_mul_f32 v87, v87, v149
buffer_store_dwordx4 v[160:163], v0, s[4:7], s27 offen offset:0 sc1
buffer_store_dwordx4 v[164:167], v0, s[4:7], s27 offen offset:1024 sc1
buffer_store_dwordx4 v[176:179], v0, s[4:7], s27 offen offset:2048 sc1
v_mul_f32 v78, v78, v149
v_mul_f32 v76, v76, v149
v_mul_f32 v86, v86, v149
v_cvt_pk_bf16_f32 v80, v80, v81
v_mul_f32 v77, v77, v149
v_mul_f32 v70, v70, v149
v_mul_f32 v186, v186, v149
v_mul_f32 v184, v184, v149
v_mul_f32 v187, v187, v149
v_cvt_pk_bf16_f32 v81, v82, v83
v_cvt_pk_bf16_f32 v67, v70, v71
v_mul_f32 v191, v191, v149
v_cvt_pk_bf16_f32 v182, v188, v189
v_cvt_pk_bf16_f32 v83, v86, v87
v_cvt_pk_bf16_f32 v82, v84, v85
v_mul_f32 v94, v94, v149
v_cvt_pk_bf16_f32 v181, v186, v187
v_cvt_pk_bf16_f32 v180, v184, v185
v_cvt_pk_bf16_f32 v69, v74, v75
v_mul_f32 v93, v93, v149
v_cvt_pk_bf16_f32 v183, v190, v191
v_cvt_pk_bf16_f32 v68, v72, v73
v_cvt_pk_bf16_f32 v85, v90, v91
v_cvt_pk_bf16_f32 v86, v92, v93
v_cvt_pk_bf16_f32 v71, v78, v79
v_cvt_pk_bf16_f32 v87, v94, v95
v_cvt_pk_bf16_f32 v84, v88, v89
v_cvt_pk_bf16_f32 v70, v76, v77
buffer_store_dwordx4 v[180:183], v0, s[4:7], s27 offen offset:3072 sc1
buffer_store_dwordx4 v[64:67], v0, s[4:7], s19 offen offset:0 sc1
buffer_store_dwordx4 v[68:71], v0, s[4:7], s19 offen offset:1024 sc1
buffer_store_dwordx4 v[80:83], v0, s[4:7], s19 offen offset:2048 sc1
buffer_store_dwordx4 v[84:87], v0, s[4:7], s19 offen offset:3072 sc1
s_lshl_b32 s18, s32, 2
s_add_u32 s18, s18, s30
s_add_u32 s18, s18, 16384
s_waitcnt vmcnt(0)
v_mov_b32 v3, 1
s_mov_b64 exec, 1
buffer_store_dword v3, off, s[4:7], s18 sc1
s_mov_b64 exec, -1
s_add_u32 s52, s52, 2
s_cmp_lt_u32 s52, 16
s_cbranch_scc1 qr_59
s_barrier
s_cmp_ge_u32 s39, 20
s_cbranch_scc1 aend_54
s_add_u32 s30, s50, 60
s_add_u32 s51, s39, 15
s_branch p1c_55
wo_52:
s_sub_u32 s18, s39, 64
s_mul_i32 s30, s18, 3277
s_lshr_b32 s30, s30, 16
s_mul_i32 s19, s30, 20
s_sub_u32 s52, s18, s19
s_cmp_lg_u32 s16, 0
s_cbranch_scc1 ww_65
s_mul_i32 s26, s13, 1310720
s_lshl_b32 s18, s52, 6
s_add_u32 s26, s26, s18
s_load_dwordx2 s[40:41], s[0:1], 64
s_mov_b32 s42, 5242880
s_mov_b32 s43, 0x20000
s_waitcnt lgkmcnt(0)
v_lshrrev_b32 v214, 6, v0
v_mul_u32_u24 v214, 1280, v214
v_and_b32 v215, 48, v0
v_add_u32 v212, v214, v215
v_bfe_u32 v214, v0, 6, 2
v_lshrrev_b32 v215, 9, v0
v_lshl_add_u32 v214, v215, 3, v214
v_lshlrev_b32 v213, 6, v214
v_and_b32 v214, 16, v0
v_add_u32 v213, v213, v214
v_bfe_u32 v214, v0, 5, 1
v_lshl_add_u32 v213, v214, 3, v213
v_bfe_u32 v214, v0, 8, 1
v_lshl_add_u32 v213, v214, 5, v213
s_mul_i32 s18, s13, 36864
v_add_u32 v213, s18, v213
s_barrier
s_add_u32 m0, s18, 0
s_add_u32 s19, s26, 0
buffer_load_dwordx4 v212, s[40:43], s19 offen lds
s_add_u32 m0, s18, 1024
s_add_u32 s19, s26, 20480
buffer_load_dwordx4 v212, s[40:43], s19 offen lds
s_add_u32 m0, s18, 2048
s_add_u32 s19, s26, 40960
buffer_load_dwordx4 v212, s[40:43], s19 offen lds
s_add_u32 m0, s18, 3072
s_add_u32 s19, s26, 61440
buffer_load_dwordx4 v212, s[40:43], s19 offen lds
s_add_u32 m0, s18, 4096
s_add_u32 s19, s26, 81920
buffer_load_dwordx4 v212, s[40:43], s19 offen lds
s_add_u32 m0, s18, 5120
s_add_u32 s19, s26, 102400
buffer_load_dwordx4 v212, s[40:43], s19 offen lds
s_add_u32 m0, s18, 6144
s_add_u32 s19, s26, 122880
buffer_load_dwordx4 v212, s[40:43], s19 offen lds
s_add_u32 m0, s18, 7168
s_add_u32 s19, s26, 143360
buffer_load_dwordx4 v212, s[40:43], s19 offen lds
s_add_u32 m0, s18, 8192
s_add_u32 s19, s26, 163840
buffer_load_dwordx4 v212, s[40:43], s19 offen lds
s_add_u32 m0, s18, 9216
s_add_u32 s19, s26, 184320
buffer_load_dwordx4 v212, s[40:43], s19 offen lds
s_add_u32 m0, s18, 10240
s_add_u32 s19, s26, 204800
buffer_load_dwordx4 v212, s[40:43], s19 offen lds
s_add_u32 m0, s18, 11264
s_add_u32 s19, s26, 225280
buffer_load_dwordx4 v212, s[40:43], s19 offen lds
s_add_u32 m0, s18, 12288
s_add_u32 s19, s26, 245760
buffer_load_dwordx4 v212, s[40:43], s19 offen lds
s_add_u32 m0, s18, 13312
s_add_u32 s19, s26, 266240
buffer_load_dwordx4 v212, s[40:43], s19 offen lds
s_add_u32 m0, s18, 14336
s_add_u32 s19, s26, 286720
buffer_load_dwordx4 v212, s[40:43], s19 offen lds
s_add_u32 m0, s18, 15360
s_add_u32 s19, s26, 307200
buffer_load_dwordx4 v212, s[40:43], s19 offen lds
s_add_u32 m0, s18, 16384
s_add_u32 s19, s26, 327680
buffer_load_dwordx4 v212, s[40:43], s19 offen lds
s_add_u32 m0, s18, 17408
s_add_u32 s19, s26, 348160
buffer_load_dwordx4 v212, s[40:43], s19 offen lds
s_add_u32 m0, s18, 18432
s_add_u32 s19, s26, 368640
buffer_load_dwordx4 v212, s[40:43], s19 offen lds
s_add_u32 m0, s18, 19456
s_add_u32 s19, s26, 389120
buffer_load_dwordx4 v212, s[40:43], s19 offen lds
s_add_u32 m0, s18, 20480
s_add_u32 s19, s26, 409600
buffer_load_dwordx4 v212, s[40:43], s19 offen lds
s_add_u32 m0, s18, 21504
s_add_u32 s19, s26, 430080
buffer_load_dwordx4 v212, s[40:43], s19 offen lds
s_add_u32 m0, s18, 22528
s_add_u32 s19, s26, 450560
buffer_load_dwordx4 v212, s[40:43], s19 offen lds
s_add_u32 m0, s18, 23552
s_add_u32 s19, s26, 471040
buffer_load_dwordx4 v212, s[40:43], s19 offen lds
s_add_u32 m0, s18, 24576
s_add_u32 s19, s26, 491520
buffer_load_dwordx4 v212, s[40:43], s19 offen lds
s_add_u32 m0, s18, 25600
s_add_u32 s19, s26, 512000
buffer_load_dwordx4 v212, s[40:43], s19 offen lds
s_add_u32 m0, s18, 26624
s_add_u32 s19, s26, 532480
buffer_load_dwordx4 v212, s[40:43], s19 offen lds
s_add_u32 m0, s18, 27648
s_add_u32 s19, s26, 552960
buffer_load_dwordx4 v212, s[40:43], s19 offen lds
s_add_u32 m0, s18, 28672
s_add_u32 s19, s26, 573440
buffer_load_dwordx4 v212, s[40:43], s19 offen lds
s_add_u32 m0, s18, 29696
s_add_u32 s19, s26, 593920
buffer_load_dwordx4 v212, s[40:43], s19 offen lds
s_add_u32 m0, s18, 30720
s_add_u32 s19, s26, 614400
buffer_load_dwordx4 v212, s[40:43], s19 offen lds
s_add_u32 m0, s18, 31744
s_add_u32 s19, s26, 634880
buffer_load_dwordx4 v212, s[40:43], s19 offen lds
s_add_u32 m0, s18, 32768
s_add_u32 s19, s26, 655360
buffer_load_dwordx4 v212, s[40:43], s19 offen lds
s_add_u32 m0, s18, 33792
s_add_u32 s19, s26, 675840
buffer_load_dwordx4 v212, s[40:43], s19 offen lds
s_add_u32 m0, s18, 34816
s_add_u32 s19, s26, 696320
buffer_load_dwordx4 v212, s[40:43], s19 offen lds
s_add_u32 m0, s18, 35840
s_add_u32 s19, s26, 716800
buffer_load_dwordx4 v212, s[40:43], s19 offen lds
s_waitcnt vmcnt(32)
ds_read_b64_tr_b16 a[0:1], v213 offset:0
ds_read_b64_tr_b16 a[2:3], v213 offset:256
ds_read_b64_tr_b16 a[4:5], v213 offset:1024
ds_read_b64_tr_b16 a[6:7], v213 offset:1280
ds_read_b64_tr_b16 a[8:9], v213 offset:2048
ds_read_b64_tr_b16 a[10:11], v213 offset:2304
ds_read_b64_tr_b16 a[12:13], v213 offset:3072
ds_read_b64_tr_b16 a[14:15], v213 offset:3328
s_waitcnt lgkmcnt(0)
s_add_u32 m0, s18, 0
s_add_u32 s19, s26, 737280
buffer_load_dwordx4 v212, s[40:43], s19 offen lds
s_add_u32 m0, s18, 1024
s_add_u32 s19, s26, 757760
buffer_load_dwordx4 v212, s[40:43], s19 offen lds
s_add_u32 m0, s18, 2048
s_add_u32 s19, s26, 778240
buffer_load_dwordx4 v212, s[40:43], s19 offen lds
s_add_u32 m0, s18, 3072
s_add_u32 s19, s26, 798720
buffer_load_dwordx4 v212, s[40:43], s19 offen lds
s_waitcnt vmcnt(32)
ds_read_b64_tr_b16 a[16:17], v213 offset:4096
ds_read_b64_tr_b16 a[18:19], v213 offset:4352
ds_read_b64_tr_b16 a[20:21], v213 offset:5120
ds_read_b64_tr_b16 a[22:23], v213 offset:5376
ds_read_b64_tr_b16 a[24:25], v213 offset:6144
ds_read_b64_tr_b16 a[26:27], v213 offset:6400
ds_read_b64_tr_b16 a[28:29], v213 offset:7168
ds_read_b64_tr_b16 a[30:31], v213 offset:7424
s_waitcnt lgkmcnt(0)
s_add_u32 m0, s18, 4096
s_add_u32 s19, s26, 819200
buffer_load_dwordx4 v212, s[40:43], s19 offen lds
s_add_u32 m0, s18, 5120
s_add_u32 s19, s26, 839680
buffer_load_dwordx4 v212, s[40:43], s19 offen lds
s_add_u32 m0, s18, 6144
s_add_u32 s19, s26, 860160
buffer_load_dwordx4 v212, s[40:43], s19 offen lds
s_add_u32 m0, s18, 7168
s_add_u32 s19, s26, 880640
buffer_load_dwordx4 v212, s[40:43], s19 offen lds
s_waitcnt vmcnt(32)
ds_read_b64_tr_b16 a[32:33], v213 offset:8192
ds_read_b64_tr_b16 a[34:35], v213 offset:8448
ds_read_b64_tr_b16 a[36:37], v213 offset:9216
ds_read_b64_tr_b16 a[38:39], v213 offset:9472
ds_read_b64_tr_b16 a[40:41], v213 offset:10240
ds_read_b64_tr_b16 a[42:43], v213 offset:10496
ds_read_b64_tr_b16 a[44:45], v213 offset:11264
ds_read_b64_tr_b16 a[46:47], v213 offset:11520
s_waitcnt lgkmcnt(0)
s_add_u32 m0, s18, 8192
s_add_u32 s19, s26, 901120
buffer_load_dwordx4 v212, s[40:43], s19 offen lds
s_add_u32 m0, s18, 9216
s_add_u32 s19, s26, 921600
buffer_load_dwordx4 v212, s[40:43], s19 offen lds
s_add_u32 m0, s18, 10240
s_add_u32 s19, s26, 942080
buffer_load_dwordx4 v212, s[40:43], s19 offen lds
s_add_u32 m0, s18, 11264
s_add_u32 s19, s26, 962560
buffer_load_dwordx4 v212, s[40:43], s19 offen lds
s_waitcnt vmcnt(32)
ds_read_b64_tr_b16 a[48:49], v213 offset:12288
ds_read_b64_tr_b16 a[50:51], v213 offset:12544
ds_read_b64_tr_b16 a[52:53], v213 offset:13312
ds_read_b64_tr_b16 a[54:55], v213 offset:13568
ds_read_b64_tr_b16 a[56:57], v213 offset:14336
ds_read_b64_tr_b16 a[58:59], v213 offset:14592
ds_read_b64_tr_b16 a[60:61], v213 offset:15360
ds_read_b64_tr_b16 a[62:63], v213 offset:15616
s_waitcnt lgkmcnt(0)
s_add_u32 m0, s18, 12288
s_add_u32 s19, s26, 983040
buffer_load_dwordx4 v212, s[40:43], s19 offen lds
s_add_u32 m0, s18, 13312
s_add_u32 s19, s26, 1003520
buffer_load_dwordx4 v212, s[40:43], s19 offen lds
s_add_u32 m0, s18, 14336
s_add_u32 s19, s26, 1024000
buffer_load_dwordx4 v212, s[40:43], s19 offen lds
s_add_u32 m0, s18, 15360
s_add_u32 s19, s26, 1044480
buffer_load_dwordx4 v212, s[40:43], s19 offen lds
s_waitcnt vmcnt(32)
ds_read_b64_tr_b16 a[64:65], v213 offset:16384
ds_read_b64_tr_b16 a[66:67], v213 offset:16640
ds_read_b64_tr_b16 a[68:69], v213 offset:17408
ds_read_b64_tr_b16 a[70:71], v213 offset:17664
ds_read_b64_tr_b16 a[72:73], v213 offset:18432
ds_read_b64_tr_b16 a[74:75], v213 offset:18688
ds_read_b64_tr_b16 a[76:77], v213 offset:19456
ds_read_b64_tr_b16 a[78:79], v213 offset:19712
s_waitcnt lgkmcnt(0)
s_add_u32 m0, s18, 16384
s_add_u32 s19, s26, 1064960
buffer_load_dwordx4 v212, s[40:43], s19 offen lds
s_add_u32 m0, s18, 17408
s_add_u32 s19, s26, 1085440
buffer_load_dwordx4 v212, s[40:43], s19 offen lds
s_add_u32 m0, s18, 18432
s_add_u32 s19, s26, 1105920
buffer_load_dwordx4 v212, s[40:43], s19 offen lds
s_add_u32 m0, s18, 19456
s_add_u32 s19, s26, 1126400
buffer_load_dwordx4 v212, s[40:43], s19 offen lds
s_waitcnt vmcnt(32)
ds_read_b64_tr_b16 a[80:81], v213 offset:20480
ds_read_b64_tr_b16 a[82:83], v213 offset:20736
ds_read_b64_tr_b16 a[84:85], v213 offset:21504
ds_read_b64_tr_b16 a[86:87], v213 offset:21760
ds_read_b64_tr_b16 a[88:89], v213 offset:22528
ds_read_b64_tr_b16 a[90:91], v213 offset:22784
ds_read_b64_tr_b16 a[92:93], v213 offset:23552
ds_read_b64_tr_b16 a[94:95], v213 offset:23808
s_waitcnt lgkmcnt(0)
s_add_u32 m0, s18, 20480
s_add_u32 s19, s26, 1146880
buffer_load_dwordx4 v212, s[40:43], s19 offen lds
s_add_u32 m0, s18, 21504
s_add_u32 s19, s26, 1167360
buffer_load_dwordx4 v212, s[40:43], s19 offen lds
s_add_u32 m0, s18, 22528
s_add_u32 s19, s26, 1187840
buffer_load_dwordx4 v212, s[40:43], s19 offen lds
s_add_u32 m0, s18, 23552
s_add_u32 s19, s26, 1208320
buffer_load_dwordx4 v212, s[40:43], s19 offen lds
s_waitcnt vmcnt(32)
ds_read_b64_tr_b16 a[96:97], v213 offset:24576
ds_read_b64_tr_b16 a[98:99], v213 offset:24832
ds_read_b64_tr_b16 a[100:101], v213 offset:25600
ds_read_b64_tr_b16 a[102:103], v213 offset:25856
ds_read_b64_tr_b16 a[104:105], v213 offset:26624
ds_read_b64_tr_b16 a[106:107], v213 offset:26880
ds_read_b64_tr_b16 a[108:109], v213 offset:27648
ds_read_b64_tr_b16 a[110:111], v213 offset:27904
s_waitcnt lgkmcnt(0)
s_add_u32 m0, s18, 24576
s_add_u32 s19, s26, 1228800
buffer_load_dwordx4 v212, s[40:43], s19 offen lds
s_add_u32 m0, s18, 25600
s_add_u32 s19, s26, 1249280
buffer_load_dwordx4 v212, s[40:43], s19 offen lds
s_add_u32 m0, s18, 26624
s_add_u32 s19, s26, 1269760
buffer_load_dwordx4 v212, s[40:43], s19 offen lds
s_add_u32 m0, s18, 27648
s_add_u32 s19, s26, 1290240
buffer_load_dwordx4 v212, s[40:43], s19 offen lds
s_waitcnt vmcnt(32)
ds_read_b64_tr_b16 a[112:113], v213 offset:28672
ds_read_b64_tr_b16 a[114:115], v213 offset:28928
ds_read_b64_tr_b16 a[116:117], v213 offset:29696
ds_read_b64_tr_b16 a[118:119], v213 offset:29952
ds_read_b64_tr_b16 a[120:121], v213 offset:30720
ds_read_b64_tr_b16 a[122:123], v213 offset:30976
ds_read_b64_tr_b16 a[124:125], v213 offset:31744
ds_read_b64_tr_b16 a[126:127], v213 offset:32000
s_waitcnt vmcnt(28)
ds_read_b64_tr_b16 a[128:129], v213 offset:32768
ds_read_b64_tr_b16 a[130:131], v213 offset:33024
ds_read_b64_tr_b16 a[132:133], v213 offset:33792
ds_read_b64_tr_b16 a[134:135], v213 offset:34048
ds_read_b64_tr_b16 a[136:137], v213 offset:34816
ds_read_b64_tr_b16 a[138:139], v213 offset:35072
ds_read_b64_tr_b16 a[140:141], v213 offset:35840
ds_read_b64_tr_b16 a[142:143], v213 offset:36096
s_waitcnt vmcnt(24)
ds_read_b64_tr_b16 a[144:145], v213 offset:0
ds_read_b64_tr_b16 a[146:147], v213 offset:256
ds_read_b64_tr_b16 a[148:149], v213 offset:1024
ds_read_b64_tr_b16 a[150:151], v213 offset:1280
ds_read_b64_tr_b16 a[152:153], v213 offset:2048
ds_read_b64_tr_b16 a[154:155], v213 offset:2304
ds_read_b64_tr_b16 a[156:157], v213 offset:3072
ds_read_b64_tr_b16 a[158:159], v213 offset:3328
s_waitcnt vmcnt(20)
ds_read_b64_tr_b16 a[160:161], v213 offset:4096
ds_read_b64_tr_b16 a[162:163], v213 offset:4352
ds_read_b64_tr_b16 a[164:165], v213 offset:5120
ds_read_b64_tr_b16 a[166:167], v213 offset:5376
ds_read_b64_tr_b16 a[168:169], v213 offset:6144
ds_read_b64_tr_b16 a[170:171], v213 offset:6400
ds_read_b64_tr_b16 a[172:173], v213 offset:7168
ds_read_b64_tr_b16 a[174:175], v213 offset:7424
s_waitcnt vmcnt(16)
ds_read_b64_tr_b16 a[176:177], v213 offset:8192
ds_read_b64_tr_b16 a[178:179], v213 offset:8448
ds_read_b64_tr_b16 a[180:181], v213 offset:9216
ds_read_b64_tr_b16 a[182:183], v213 offset:9472
ds_read_b64_tr_b16 a[184:185], v213 offset:10240
ds_read_b64_tr_b16 a[186:187], v213 offset:10496
ds_read_b64_tr_b16 a[188:189], v213 offset:11264
ds_read_b64_tr_b16 a[190:191], v213 offset:11520
s_waitcnt vmcnt(12)
ds_read_b64_tr_b16 a[192:193], v213 offset:12288
ds_read_b64_tr_b16 a[194:195], v213 offset:12544
ds_read_b64_tr_b16 a[196:197], v213 offset:13312
ds_read_b64_tr_b16 a[198:199], v213 offset:13568
ds_read_b64_tr_b16 a[200:201], v213 offset:14336
ds_read_b64_tr_b16 a[202:203], v213 offset:14592
ds_read_b64_tr_b16 a[204:205], v213 offset:15360
ds_read_b64_tr_b16 a[206:207], v213 offset:15616
s_waitcnt vmcnt(8)
ds_read_b64_tr_b16 a[208:209], v213 offset:16384
ds_read_b64_tr_b16 a[210:211], v213 offset:16640
ds_read_b64_tr_b16 a[212:213], v213 offset:17408
ds_read_b64_tr_b16 a[214:215], v213 offset:17664
ds_read_b64_tr_b16 a[216:217], v213 offset:18432
ds_read_b64_tr_b16 a[218:219], v213 offset:18688
ds_read_b64_tr_b16 a[220:221], v213 offset:19456
ds_read_b64_tr_b16 a[222:223], v213 offset:19712
s_waitcnt vmcnt(4)
ds_read_b64_tr_b16 a[224:225], v213 offset:20480
ds_read_b64_tr_b16 a[226:227], v213 offset:20736
ds_read_b64_tr_b16 a[228:229], v213 offset:21504
ds_read_b64_tr_b16 a[230:231], v213 offset:21760
ds_read_b64_tr_b16 a[232:233], v213 offset:22528
ds_read_b64_tr_b16 a[234:235], v213 offset:22784
ds_read_b64_tr_b16 a[236:237], v213 offset:23552
ds_read_b64_tr_b16 a[238:239], v213 offset:23808
s_waitcnt vmcnt(0)
ds_read_b64_tr_b16 a[240:241], v213 offset:24576
ds_read_b64_tr_b16 a[242:243], v213 offset:24832
ds_read_b64_tr_b16 a[244:245], v213 offset:25600
ds_read_b64_tr_b16 a[246:247], v213 offset:25856
ds_read_b64_tr_b16 a[248:249], v213 offset:26624
ds_read_b64_tr_b16 a[250:251], v213 offset:26880
ds_read_b64_tr_b16 a[252:253], v213 offset:27648
ds_read_b64_tr_b16 a[254:255], v213 offset:27904
s_waitcnt lgkmcnt(0)
s_barrier
ww_65:
s_load_dwordx2 s[56:57], s[0:1], 80
s_mov_b32 s58, 2621440
s_mov_b32 s59, 0x20000
s_waitcnt lgkmcnt(0)
s_lshl_b32 s18, s13, 12
v_add_u32 v13, s18, v0
s_lshl_b32 s18, s13, 11
v_add_u32 v14, s18, v0
ws_66:
s_lshl_b32 s18, s16, 6
s_add_u32 s18, s18, s30
s_lshl_b32 s26, s18, 18
s_lshl_b32 s19, s13, 16
s_add_u32 s26, s26, s19
s_add_u32 s26, s26, 127926272
s_lshl_b32 s18, s18, 7
s_lshl_b32 s19, s13, 5
s_add_u32 s18, s18, s19
s_add_u32 s28, s18, 16384
s_mul_i32 s27, s30, 40960
s_and_b32 s18, s13, 1
s_lshl_b32 s19, s52, 1
s_add_u32 s29, s18, s19
v_lshrrev_b32 v12, 2, v0
v_min_u32 v12, 28, v12
s_mov_b32 s17, 0
poll_70:
buffer_load_dword v8, v12, s[4:7], s28 offen offset:0 sc1
s_add_u32 s17, s17, 1
s_cmp_gt_u32 s17, 262144
s_cbranch_scc1 L_fail
s_waitcnt vmcnt(0)
v_cmp_gt_u32 vcc, 1, v8
s_cbranch_vccz polld_71
s_sleep 2
s_branch poll_70
polld_71:
s_lshl_b32 s18, s29, 10
s_add_u32 s18, s18, s27
s_mul_i32 s19, s16, 6291456
s_add_u32 s18, s18, s19
s_add_u32 s18, s18, 88080384
s_add_u32 s19, s26, 0
buffer_load_dwordx4 v[16:19], v0, s[4:7], s19 offen offset:0 sc1
buffer_load_dwordx4 v[20:23], v0, s[4:7], s19 offen offset:1024 sc1
buffer_load_dwordx4 v[24:27], v0, s[4:7], s19 offen offset:2048 sc1
buffer_load_dwordx4 v[28:31], v0, s[4:7], s19 offen offset:3072 sc1
s_add_u32 s19, s26, 4096
buffer_load_dwordx4 v[32:35], v0, s[4:7], s19 offen offset:0 sc1
buffer_load_dwordx4 v[36:39], v0, s[4:7], s19 offen offset:1024 sc1
buffer_load_dwordx4 v[40:43], v0, s[4:7], s19 offen offset:2048 sc1
buffer_load_dwordx4 v[44:47], v0, s[4:7], s19 offen offset:3072 sc1
s_add_u32 s19, s26, 8192
buffer_load_dwordx4 v[48:51], v0, s[4:7], s19 offen offset:0 sc1
buffer_load_dwordx4 v[52:55], v0, s[4:7], s19 offen offset:1024 sc1
buffer_load_dwordx4 v[56:59], v0, s[4:7], s19 offen offset:2048 sc1
buffer_load_dwordx4 v[60:63], v0, s[4:7], s19 offen offset:3072 sc1
s_add_u32 s19, s26, 12288
buffer_load_dwordx4 v[64:67], v0, s[4:7], s19 offen offset:0 sc1
buffer_load_dwordx4 v[68:71], v0, s[4:7], s19 offen offset:1024 sc1
buffer_load_dwordx4 v[72:75], v0, s[4:7], s19 offen offset:2048 sc1
buffer_load_dwordx4 v[76:79], v0, s[4:7], s19 offen offset:3072 sc1
s_add_u32 s19, s26, 16384
buffer_load_dwordx4 v[80:83], v0, s[4:7], s19 offen offset:0 sc1
buffer_load_dwordx4 v[84:87], v0, s[4:7], s19 offen offset:1024 sc1
buffer_load_dwordx4 v[88:91], v0, s[4:7], s19 offen offset:2048 sc1
buffer_load_dwordx4 v[92:95], v0, s[4:7], s19 offen offset:3072 sc1
s_add_u32 s19, s26, 20480
buffer_load_dwordx4 v[96:99], v0, s[4:7], s19 offen offset:0 sc1
buffer_load_dwordx4 v[100:103], v0, s[4:7], s19 offen offset:1024 sc1
buffer_load_dwordx4 v[104:107], v0, s[4:7], s19 offen offset:2048 sc1
buffer_load_dwordx4 v[108:111], v0, s[4:7], s19 offen offset:3072 sc1
s_add_u32 s19, s26, 24576
buffer_load_dwordx4 v[112:115], v0, s[4:7], s19 offen offset:0 sc1
buffer_load_dwordx4 v[116:119], v0, s[4:7], s19 offen offset:1024 sc1
buffer_load_dwordx4 v[120:123], v0, s[4:7], s19 offen offset:2048 sc1
buffer_load_dwordx4 v[124:127], v0, s[4:7], s19 offen offset:3072 sc1
s_add_u32 s19, s26, 28672
buffer_load_dwordx4 v[128:131], v0, s[4:7], s19 offen offset:0 sc1
buffer_load_dwordx4 v[132:135], v0, s[4:7], s19 offen offset:1024 sc1
buffer_load_dwordx4 v[136:139], v0, s[4:7], s19 offen offset:2048 sc1
buffer_load_dwordx4 v[140:143], v0, s[4:7], s19 offen offset:3072 sc1
s_add_u32 s19, s26, 32768
buffer_load_dwordx4 v[144:147], v0, s[4:7], s19 offen offset:0 sc1
buffer_load_dwordx4 v[148:151], v0, s[4:7], s19 offen offset:1024 sc1
buffer_load_dwordx4 v[152:155], v0, s[4:7], s19 offen offset:2048 sc1
buffer_load_dwordx4 v[156:159], v0, s[4:7], s19 offen offset:3072 sc1
s_add_u32 s19, s26, 36864
buffer_load_dwordx4 v[160:163], v0, s[4:7], s19 offen offset:0 sc1
buffer_load_dwordx4 v[164:167], v0, s[4:7], s19 offen offset:1024 sc1
buffer_load_dwordx4 v[168:171], v0, s[4:7], s19 offen offset:2048 sc1
buffer_load_dwordx4 v[172:175], v0, s[4:7], s19 offen offset:3072 sc1
s_add_u32 s19, s26, 40960
buffer_load_dwordx4 v[176:179], v0, s[4:7], s19 offen offset:0 sc1
buffer_load_dwordx4 v[180:183], v0, s[4:7], s19 offen offset:1024 sc1
buffer_load_dwordx4 v[184:187], v0, s[4:7], s19 offen offset:2048 sc1
buffer_load_dwordx4 v[188:191], v0, s[4:7], s19 offen offset:3072 sc1
s_waitcnt vmcnt(43)
v_mfma_f32_32x32x16_bf16 v[192:207], a[0:3], v[16:19], 0
s_add_u32 s19, s26, 45056
buffer_load_dwordx4 v[16:19], v0, s[4:7], s19 offen offset:0 sc1
s_waitcnt vmcnt(43)
v_mfma_f32_32x32x16_bf16 v[192:207], a[4:7], v[20:23], v[192:207]
buffer_load_dwordx4 v[20:23], v0, s[4:7], s19 offen offset:1024 sc1
s_waitcnt vmcnt(43)
v_mfma_f32_32x32x16_bf16 v[192:207], a[8:11], v[24:27], v[192:207]
buffer_load_dwordx4 v[24:27], v0, s[4:7], s19 offen offset:2048 sc1
s_waitcnt vmcnt(43)
v_mfma_f32_32x32x16_bf16 v[192:207], a[12:15], v[28:31], v[192:207]
buffer_load_dwordx4 v[28:31], v0, s[4:7], s19 offen offset:3072 sc1
s_waitcnt vmcnt(43)
v_mfma_f32_32x32x16_bf16 v[192:207], a[16:19], v[32:35], v[192:207]
s_add_u32 s19, s26, 49152
buffer_load_dwordx4 v[32:35], v0, s[4:7], s19 offen offset:0 sc1
s_waitcnt vmcnt(43)
v_mfma_f32_32x32x16_bf16 v[192:207], a[20:23], v[36:39], v[192:207]
buffer_load_dwordx4 v[36:39], v0, s[4:7], s19 offen offset:1024 sc1
s_waitcnt vmcnt(43)
v_mfma_f32_32x32x16_bf16 v[192:207], a[24:27], v[40:43], v[192:207]
buffer_load_dwordx4 v[40:43], v0, s[4:7], s19 offen offset:2048 sc1
s_waitcnt vmcnt(43)
v_mfma_f32_32x32x16_bf16 v[192:207], a[28:31], v[44:47], v[192:207]
buffer_load_dwordx4 v[44:47], v0, s[4:7], s19 offen offset:3072 sc1
s_waitcnt vmcnt(43)
v_mfma_f32_32x32x16_bf16 v[192:207], a[32:35], v[48:51], v[192:207]
s_add_u32 s19, s26, 53248
buffer_load_dwordx4 v[48:51], v0, s[4:7], s19 offen offset:0 sc1
s_waitcnt vmcnt(43)
v_mfma_f32_32x32x16_bf16 v[192:207], a[36:39], v[52:55], v[192:207]
buffer_load_dwordx4 v[52:55], v0, s[4:7], s19 offen offset:1024 sc1
s_waitcnt vmcnt(43)
v_mfma_f32_32x32x16_bf16 v[192:207], a[40:43], v[56:59], v[192:207]
buffer_load_dwordx4 v[56:59], v0, s[4:7], s19 offen offset:2048 sc1
s_waitcnt vmcnt(43)
v_mfma_f32_32x32x16_bf16 v[192:207], a[44:47], v[60:63], v[192:207]
buffer_load_dwordx4 v[60:63], v0, s[4:7], s19 offen offset:3072 sc1
s_waitcnt vmcnt(43)
v_mfma_f32_32x32x16_bf16 v[192:207], a[48:51], v[64:67], v[192:207]
s_add_u32 s19, s26, 57344
buffer_load_dwordx4 v[64:67], v0, s[4:7], s19 offen offset:0 sc1
s_waitcnt vmcnt(43)
v_mfma_f32_32x32x16_bf16 v[192:207], a[52:55], v[68:71], v[192:207]
buffer_load_dwordx4 v[68:71], v0, s[4:7], s19 offen offset:1024 sc1
s_waitcnt vmcnt(43)
v_mfma_f32_32x32x16_bf16 v[192:207], a[56:59], v[72:75], v[192:207]
buffer_load_dwordx4 v[72:75], v0, s[4:7], s19 offen offset:2048 sc1
s_waitcnt vmcnt(43)
v_mfma_f32_32x32x16_bf16 v[192:207], a[60:63], v[76:79], v[192:207]
buffer_load_dwordx4 v[76:79], v0, s[4:7], s19 offen offset:3072 sc1
s_waitcnt vmcnt(43)
v_mfma_f32_32x32x16_bf16 v[192:207], a[64:67], v[80:83], v[192:207]
s_add_u32 s19, s26, 61440
buffer_load_dwordx4 v[80:83], v0, s[4:7], s19 offen offset:0 sc1
s_waitcnt vmcnt(43)
v_mfma_f32_32x32x16_bf16 v[192:207], a[68:71], v[84:87], v[192:207]
buffer_load_dwordx4 v[84:87], v0, s[4:7], s19 offen offset:1024 sc1
s_waitcnt vmcnt(43)
v_mfma_f32_32x32x16_bf16 v[192:207], a[72:75], v[88:91], v[192:207]
buffer_load_dwordx4 v[88:91], v0, s[4:7], s19 offen offset:2048 sc1
s_waitcnt vmcnt(43)
v_mfma_f32_32x32x16_bf16 v[192:207], a[76:79], v[92:95], v[192:207]
buffer_load_dwordx4 v[92:95], v0, s[4:7], s19 offen offset:3072 sc1
s_waitcnt vmcnt(43)
v_mfma_f32_32x32x16_bf16 v[192:207], a[80:83], v[96:99], v[192:207]
buffer_load_dwordx4 v[208:211], v0, s[4:7], s18 offen sc1
s_waitcnt vmcnt(43)
v_mfma_f32_32x32x16_bf16 v[192:207], a[84:87], v[100:103], v[192:207]
s_waitcnt vmcnt(42)
v_mfma_f32_32x32x16_bf16 v[192:207], a[88:91], v[104:107], v[192:207]
s_waitcnt vmcnt(41)
v_mfma_f32_32x32x16_bf16 v[192:207], a[92:95], v[108:111], v[192:207]
s_waitcnt vmcnt(40)
v_mfma_f32_32x32x16_bf16 v[192:207], a[96:99], v[112:115], v[192:207]
s_waitcnt vmcnt(39)
v_mfma_f32_32x32x16_bf16 v[192:207], a[100:103], v[116:119], v[192:207]
s_waitcnt vmcnt(38)
v_mfma_f32_32x32x16_bf16 v[192:207], a[104:107], v[120:123], v[192:207]
s_waitcnt vmcnt(37)
v_mfma_f32_32x32x16_bf16 v[192:207], a[108:111], v[124:127], v[192:207]
s_waitcnt vmcnt(36)
v_mfma_f32_32x32x16_bf16 v[192:207], a[112:115], v[128:131], v[192:207]
s_waitcnt vmcnt(35)
v_mfma_f32_32x32x16_bf16 v[192:207], a[116:119], v[132:135], v[192:207]
s_waitcnt vmcnt(34)
v_mfma_f32_32x32x16_bf16 v[192:207], a[120:123], v[136:139], v[192:207]
s_waitcnt vmcnt(33)
v_mfma_f32_32x32x16_bf16 v[192:207], a[124:127], v[140:143], v[192:207]
s_waitcnt vmcnt(32)
v_mfma_f32_32x32x16_bf16 v[192:207], a[128:131], v[144:147], v[192:207]
s_waitcnt vmcnt(31)
v_mfma_f32_32x32x16_bf16 v[192:207], a[132:135], v[148:151], v[192:207]
s_waitcnt vmcnt(30)
v_mfma_f32_32x32x16_bf16 v[192:207], a[136:139], v[152:155], v[192:207]
s_waitcnt vmcnt(29)
v_mfma_f32_32x32x16_bf16 v[192:207], a[140:143], v[156:159], v[192:207]
s_waitcnt vmcnt(28)
v_mfma_f32_32x32x16_bf16 v[192:207], a[144:147], v[160:163], v[192:207]
s_waitcnt vmcnt(27)
v_mfma_f32_32x32x16_bf16 v[192:207], a[148:151], v[164:167], v[192:207]
s_waitcnt vmcnt(26)
v_mfma_f32_32x32x16_bf16 v[192:207], a[152:155], v[168:171], v[192:207]
s_waitcnt vmcnt(25)
v_mfma_f32_32x32x16_bf16 v[192:207], a[156:159], v[172:175], v[192:207]
s_waitcnt vmcnt(24)
v_mfma_f32_32x32x16_bf16 v[192:207], a[160:163], v[176:179], v[192:207]
s_waitcnt vmcnt(23)
v_mfma_f32_32x32x16_bf16 v[192:207], a[164:167], v[180:183], v[192:207]
s_waitcnt vmcnt(22)
v_mfma_f32_32x32x16_bf16 v[192:207], a[168:171], v[184:187], v[192:207]
s_waitcnt vmcnt(21)
v_mfma_f32_32x32x16_bf16 v[192:207], a[172:175], v[188:191], v[192:207]
s_waitcnt vmcnt(20)
v_mfma_f32_32x32x16_bf16 v[192:207], a[176:179], v[16:19], v[192:207]
s_waitcnt vmcnt(19)
v_mfma_f32_32x32x16_bf16 v[192:207], a[180:183], v[20:23], v[192:207]
s_waitcnt vmcnt(18)
v_mfma_f32_32x32x16_bf16 v[192:207], a[184:187], v[24:27], v[192:207]
s_waitcnt vmcnt(17)
v_mfma_f32_32x32x16_bf16 v[192:207], a[188:191], v[28:31], v[192:207]
s_waitcnt vmcnt(16)
v_mfma_f32_32x32x16_bf16 v[192:207], a[192:195], v[32:35], v[192:207]
s_waitcnt vmcnt(15)
v_mfma_f32_32x32x16_bf16 v[192:207], a[196:199], v[36:39], v[192:207]
s_waitcnt vmcnt(14)
v_mfma_f32_32x32x16_bf16 v[192:207], a[200:203], v[40:43], v[192:207]
s_waitcnt vmcnt(13)
v_mfma_f32_32x32x16_bf16 v[192:207], a[204:207], v[44:47], v[192:207]
s_waitcnt vmcnt(12)
v_mfma_f32_32x32x16_bf16 v[192:207], a[208:211], v[48:51], v[192:207]
s_waitcnt vmcnt(11)
v_mfma_f32_32x32x16_bf16 v[192:207], a[212:215], v[52:55], v[192:207]
s_waitcnt vmcnt(10)
v_mfma_f32_32x32x16_bf16 v[192:207], a[216:219], v[56:59], v[192:207]
s_waitcnt vmcnt(9)
v_mfma_f32_32x32x16_bf16 v[192:207], a[220:223], v[60:63], v[192:207]
s_waitcnt vmcnt(8)
v_mfma_f32_32x32x16_bf16 v[192:207], a[224:227], v[64:67], v[192:207]
s_waitcnt vmcnt(7)
v_mfma_f32_32x32x16_bf16 v[192:207], a[228:231], v[68:71], v[192:207]
s_waitcnt vmcnt(6)
v_mfma_f32_32x32x16_bf16 v[192:207], a[232:235], v[72:75], v[192:207]
s_waitcnt vmcnt(5)
v_mfma_f32_32x32x16_bf16 v[192:207], a[236:239], v[76:79], v[192:207]
s_waitcnt vmcnt(4)
v_mfma_f32_32x32x16_bf16 v[192:207], a[240:243], v[80:83], v[192:207]
s_waitcnt vmcnt(3)
v_mfma_f32_32x32x16_bf16 v[192:207], a[244:247], v[84:87], v[192:207]
s_waitcnt vmcnt(2)
v_mfma_f32_32x32x16_bf16 v[192:207], a[248:251], v[88:91], v[192:207]
s_waitcnt vmcnt(1)
v_mfma_f32_32x32x16_bf16 v[192:207], a[252:255], v[92:95], v[192:207]
s_nop 11
ds_write_b128 v13, v[192:195] offset:0
ds_write_b128 v13, v[196:199] offset:1024
ds_write_b128 v13, v[200:203] offset:2048
ds_write_b128 v13, v[204:207] offset:3072
s_waitcnt lgkmcnt(0)
s_barrier
s_cmp_ge_u32 s13, 2
s_cbranch_scc1 wn_67
ds_read_b128 v[16:19], v14 offset:0
ds_read_b128 v[20:23], v14 offset:1024
ds_read_b128 v[24:27], v14 offset:4096
ds_read_b128 v[28:31], v14 offset:5120
ds_read_b128 v[32:35], v14 offset:8192
ds_read_b128 v[36:39], v14 offset:9216
ds_read_b128 v[40:43], v14 offset:12288
ds_read_b128 v[44:47], v14 offset:13312
s_waitcnt vmcnt(0)
v_lshlrev_b32 v192, 16, v208
v_and_b32 v193, 0xffff0000, v208
v_lshlrev_b32 v194, 16, v209
v_and_b32 v195, 0xffff0000, v209
v_lshlrev_b32 v196, 16, v210
v_and_b32 v197, 0xffff0000, v210
v_lshlrev_b32 v198, 16, v211
v_and_b32 v199, 0xffff0000, v211
s_waitcnt lgkmcnt(5)
v_add_f32 v16, v16, v24
s_waitcnt lgkmcnt(1)
v_add_f32 v32, v32, v40
v_add_f32 v17, v17, v25
v_add_f32 v33, v33, v41
v_add_f32 v18, v18, v26
v_add_f32 v34, v34, v42
v_add_f32 v19, v19, v27
v_add_f32 v35, v35, v43
v_add_f32 v20, v20, v28
s_waitcnt lgkmcnt(0)
v_add_f32 v36, v36, v44
v_add_f32 v21, v21, v29
v_add_f32 v37, v37, v45
v_add_f32 v22, v22, v30
v_add_f32 v38, v38, v46
v_add_f32 v23, v23, v31
v_add_f32 v39, v39, v47
v_add_f32 v16, v16, v32
v_add_f32 v17, v17, v33
v_add_f32 v18, v18, v34
v_add_f32 v19, v19, v35
v_add_f32 v20, v20, v36
v_add_f32 v21, v21, v37
v_add_f32 v22, v22, v38
v_add_f32 v23, v23, v39
v_add_f32 v16, v16, v192
v_add_f32 v17, v17, v193
v_add_f32 v18, v18, v194
v_add_f32 v19, v19, v195
v_add_f32 v20, v20, v196
v_add_f32 v21, v21, v197
v_add_f32 v22, v22, v198
v_add_f32 v23, v23, v199
v_cvt_pk_bf16_f32 v208, v16, v17
v_cvt_pk_bf16_f32 v209, v18, v19
v_cvt_pk_bf16_f32 v210, v20, v21
v_cvt_pk_bf16_f32 v211, v22, v23
s_cmp_lg_u32 s16, 0
s_cbranch_scc1 wo_68
s_add_u32 s18, s18, 3145728
buffer_store_dwordx4 v[208:211], v0, s[4:7], s18 offen sc1
s_branch wn_67
wo_68:
s_lshl_b32 s18, s29, 5
s_add_u32 s18, s18, s27
buffer_store_dwordx4 v[208:211], v5, s[56:59], s18 offen
wn_67:
s_lshl_b32 s18, s30, 7
s_lshl_b32 s19, s52, 2
s_add_u32 s18, s18, s19
s_add_u32 s18, s18, 32768
s_cmp_eq_u32 s13, 0
s_cselect_b32 s22, s18, s6
s_mov_b32 s23, 1
s_waitcnt vmcnt(0)
s_barrier
v_mov_b32 v3, s23
s_mov_b64 exec, 1
buffer_store_dword v3, off, s[4:7], s22 sc1
s_mov_b64 exec, -1
s_mov_b32 s22, s6
s_add_u32 s30, s30, 4
s_cmp_lt_u32 s30, 64
s_cbranch_scc1 ws_66
s_branch aend_54
p1b_53:
s_cmp_eq_u32 s39, 144
s_cbranch_scc1 aend_54
s_sub_u32 s30, s50, 29
s_sub_u32 s51, s39, 145
p1c_55:
s_cmp_lg_u32 s16, 0
s_cbranch_scc1 aend_54
s_lshl_b32 s18, s34, 7
s_lshl_b32 s19, s13, 5
s_add_u32 s18, s18, s19
s_mov_b32 s19, 0x3acccccd
v_bfe_u32 v198, v0, 4, 5
v_lshrrev_b32 v193, 9, v0
v_add_u32 v198, s18, v198
v_and_b32 v197, 1, v198
v_mul_u32_u24 v197, 160, v197
v_lshrrev_b32 v196, 1, v198
v_add_u32 v196, 1, v196
v_lshlrev_b32 v193, 3, v193
v_mad_u32_u24 v197, v193, v196, v197
v_mad_u32_u24 v192, v196, 16, 0
v_cvt_f32_u32 v192, v192
v_mul_f32 v198, s19, v192
v_rndne_f32 v198, v198
v_fmac_f32 v192, 0xc4200000, v198
v_mul_f32 v192, s19, v192
v_cos_f32 v192, v192
s_nop 0
v_add_f32 v192, v192, v192
v_mad_u32_u24 v194, v196, 1, 0
v_cvt_f32_u32 v194, v194
v_mul_f32 v198, s19, v194
v_rndne_f32 v198, v198
v_fmac_f32 v194, 0xc4200000, v198
v_mul_f32 v194, s19, v194
v_cos_f32 v194, v194
s_nop 0
v_add_f32 v194, v194, v194
v_mad_u32_u24 v179, v196, 3, v197
v_cvt_f32_u32 v179, v179
v_mul_f32 v198, s19, v179
v_rndne_f32 v198, v198
v_fmac_f32 v179, 0xc4200000, v198
v_mul_f32 v179, s19, v179
v_cos_f32 v179, v179
v_mad_u32_u24 v180, v196, 4, v197
v_cvt_f32_u32 v180, v180
v_mul_f32 v198, s19, v180
v_rndne_f32 v198, v198
v_fmac_f32 v180, 0xc4200000, v198
v_mul_f32 v180, s19, v180
v_cos_f32 v180, v180
s_nop 0
v_fma_f32 v181, v194, v180, -v179
v_fma_f32 v178, v194, v179, -v180
v_fma_f32 v182, v194, v181, -v180
v_fma_f32 v177, v194, v178, -v179
v_fma_f32 v183, v194, v182, -v181
v_fma_f32 v176, v194, v177, -v178
v_cvt_pk_bf16_f32 v16, v176, v177
v_cvt_pk_bf16_f32 v17, v178, v179
v_cvt_pk_bf16_f32 v18, v180, v181
v_cvt_pk_bf16_f32 v19, v182, v183
v_mad_u32_u24 v187, v196, 19, v197
v_cvt_f32_u32 v187, v187
v_mul_f32 v198, s19, v187
v_rndne_f32 v198, v198
v_fmac_f32 v187, 0xc4200000, v198
v_mul_f32 v187, s19, v187
v_cos_f32 v187, v187
v_mad_u32_u24 v188, v196, 20, v197
v_cvt_f32_u32 v188, v188
v_mul_f32 v198, s19, v188
v_rndne_f32 v198, v198
v_fmac_f32 v188, 0xc4200000, v198
v_mul_f32 v188, s19, v188
v_cos_f32 v188, v188
s_nop 0
v_fma_f32 v189, v194, v188, -v187
v_fma_f32 v186, v194, v187, -v188
v_fma_f32 v190, v194, v189, -v188
v_fma_f32 v185, v194, v186, -v187
v_fma_f32 v191, v194, v190, -v189
v_fma_f32 v184, v194, v185, -v186
v_cvt_pk_bf16_f32 v20, v184, v185
v_cvt_pk_bf16_f32 v21, v186, v187
v_cvt_pk_bf16_f32 v22, v188, v189
v_cvt_pk_bf16_f32 v23, v190, v191
v_pk_fma_f32 v[176:177], v[192:193], v[184:185], v[176:177] op_sel_hi:[0,1,1] neg_lo:[0,0,1] neg_hi:[0,0,1]
v_pk_fma_f32 v[178:179], v[192:193], v[186:187], v[178:179] op_sel_hi:[0,1,1] neg_lo:[0,0,1] neg_hi:[0,0,1]
v_pk_fma_f32 v[180:181], v[192:193], v[188:189], v[180:181] op_sel_hi:[0,1,1] neg_lo:[0,0,1] neg_hi:[0,0,1]
v_pk_fma_f32 v[182:183], v[192:193], v[190:191], v[182:183] op_sel_hi:[0,1,1] neg_lo:[0,0,1] neg_hi:[0,0,1]
v_cvt_pk_bf16_f32 v24, v176, v177
v_cvt_pk_bf16_f32 v25, v178, v179
v_cvt_pk_bf16_f32 v26, v180, v181
v_cvt_pk_bf16_f32 v27, v182, v183
v_pk_fma_f32 v[184:185], v[192:193], v[176:177], v[184:185] op_sel_hi:[0,1,1] neg_lo:[0,0,1] neg_hi:[0,0,1]
v_pk_fma_f32 v[186:187], v[192:193], v[178:179], v[186:187] op_sel_hi:[0,1,1] neg_lo:[0,0,1] neg_hi:[0,0,1]
v_pk_fma_f32 v[188:189], v[192:193], v[180:181], v[188:189] op_sel_hi:[0,1,1] neg_lo:[0,0,1] neg_hi:[0,0,1]
v_pk_fma_f32 v[190:191], v[192:193], v[182:183], v[190:191] op_sel_hi:[0,1,1] neg_lo:[0,0,1] neg_hi:[0,0,1]
v_cvt_pk_bf16_f32 v28, v184, v185
v_cvt_pk_bf16_f32 v29, v186, v187
v_cvt_pk_bf16_f32 v30, v188, v189
v_cvt_pk_bf16_f32 v31, v190, v191
v_pk_fma_f32 v[176:177], v[192:193], v[184:185], v[176:177] op_sel_hi:[0,1,1] neg_lo:[0,0,1] neg_hi:[0,0,1]
v_pk_fma_f32 v[178:179], v[192:193], v[186:187], v[178:179] op_sel_hi:[0,1,1] neg_lo:[0,0,1] neg_hi:[0,0,1]
v_pk_fma_f32 v[180:181], v[192:193], v[188:189], v[180:181] op_sel_hi:[0,1,1] neg_lo:[0,0,1] neg_hi:[0,0,1]
v_pk_fma_f32 v[182:183], v[192:193], v[190:191], v[182:183] op_sel_hi:[0,1,1] neg_lo:[0,0,1] neg_hi:[0,0,1]
v_cvt_pk_bf16_f32 v32, v176, v177
v_cvt_pk_bf16_f32 v33, v178, v179
v_cvt_pk_bf16_f32 v34, v180, v181
v_cvt_pk_bf16_f32 v35, v182, v183
v_pk_fma_f32 v[184:185], v[192:193], v[176:177], v[184:185] op_sel_hi:[0,1,1] neg_lo:[0,0,1] neg_hi:[0,0,1]
v_pk_fma_f32 v[186:187], v[192:193], v[178:179], v[186:187] op_sel_hi:[0,1,1] neg_lo:[0,0,1] neg_hi:[0,0,1]
v_pk_fma_f32 v[188:189], v[192:193], v[180:181], v[188:189] op_sel_hi:[0,1,1] neg_lo:[0,0,1] neg_hi:[0,0,1]
v_pk_fma_f32 v[190:191], v[192:193], v[182:183], v[190:191] op_sel_hi:[0,1,1] neg_lo:[0,0,1] neg_hi:[0,0,1]
v_cvt_pk_bf16_f32 v36, v184, v185
v_cvt_pk_bf16_f32 v37, v186, v187
v_cvt_pk_bf16_f32 v38, v188, v189
v_cvt_pk_bf16_f32 v39, v190, v191
v_pk_fma_f32 v[176:177], v[192:193], v[184:185], v[176:177] op_sel_hi:[0,1,1] neg_lo:[0,0,1] neg_hi:[0,0,1]
v_pk_fma_f32 v[178:179], v[192:193], v[186:187], v[178:179] op_sel_hi:[0,1,1] neg_lo:[0,0,1] neg_hi:[0,0,1]
v_pk_fma_f32 v[180:181], v[192:193], v[188:189], v[180:181] op_sel_hi:[0,1,1] neg_lo:[0,0,1] neg_hi:[0,0,1]
v_pk_fma_f32 v[182:183], v[192:193], v[190:191], v[182:183] op_sel_hi:[0,1,1] neg_lo:[0,0,1] neg_hi:[0,0,1]
v_cvt_pk_bf16_f32 v40, v176, v177
v_cvt_pk_bf16_f32 v41, v178, v179
v_cvt_pk_bf16_f32 v42, v180, v181
v_cvt_pk_bf16_f32 v43, v182, v183
v_pk_fma_f32 v[184:185], v[192:193], v[176:177], v[184:185] op_sel_hi:[0,1,1] neg_lo:[0,0,1] neg_hi:[0,0,1]
v_pk_fma_f32 v[186:187], v[192:193], v[178:179], v[186:187] op_sel_hi:[0,1,1] neg_lo:[0,0,1] neg_hi:[0,0,1]
v_pk_fma_f32 v[188:189], v[192:193], v[180:181], v[188:189] op_sel_hi:[0,1,1] neg_lo:[0,0,1] neg_hi:[0,0,1]
v_pk_fma_f32 v[190:191], v[192:193], v[182:183], v[190:191] op_sel_hi:[0,1,1] neg_lo:[0,0,1] neg_hi:[0,0,1]
v_cvt_pk_bf16_f32 v44, v184, v185
v_cvt_pk_bf16_f32 v45, v186, v187
v_cvt_pk_bf16_f32 v46, v188, v189
v_cvt_pk_bf16_f32 v47, v190, v191
v_pk_fma_f32 v[176:177], v[192:193], v[184:185], v[176:177] op_sel_hi:[0,1,1] neg_lo:[0,0,1] neg_hi:[0,0,1]
v_pk_fma_f32 v[178:179], v[192:193], v[186:187], v[178:179] op_sel_hi:[0,1,1] neg_lo:[0,0,1] neg_hi:[0,0,1]
v_pk_fma_f32 v[180:181], v[192:193], v[188:189], v[180:181] op_sel_hi:[0,1,1] neg_lo:[0,0,1] neg_hi:[0,0,1]
v_pk_fma_f32 v[182:183], v[192:193], v[190:191], v[182:183] op_sel_hi:[0,1,1] neg_lo:[0,0,1] neg_hi:[0,0,1]
v_cvt_pk_bf16_f32 v48, v176, v177
v_cvt_pk_bf16_f32 v49, v178, v179
v_cvt_pk_bf16_f32 v50, v180, v181
v_cvt_pk_bf16_f32 v51, v182, v183
v_pk_fma_f32 v[184:185], v[192:193], v[176:177], v[184:185] op_sel_hi:[0,1,1] neg_lo:[0,0,1] neg_hi:[0,0,1]
v_pk_fma_f32 v[186:187], v[192:193], v[178:179], v[186:187] op_sel_hi:[0,1,1] neg_lo:[0,0,1] neg_hi:[0,0,1]
v_pk_fma_f32 v[188:189], v[192:193], v[180:181], v[188:189] op_sel_hi:[0,1,1] neg_lo:[0,0,1] neg_hi:[0,0,1]
v_pk_fma_f32 v[190:191], v[192:193], v[182:183], v[190:191] op_sel_hi:[0,1,1] neg_lo:[0,0,1] neg_hi:[0,0,1]
v_cvt_pk_bf16_f32 v52, v184, v185
v_cvt_pk_bf16_f32 v53, v186, v187
v_cvt_pk_bf16_f32 v54, v188, v189
v_cvt_pk_bf16_f32 v55, v190, v191
v_pk_fma_f32 v[176:177], v[192:193], v[184:185], v[176:177] op_sel_hi:[0,1,1] neg_lo:[0,0,1] neg_hi:[0,0,1]
v_pk_fma_f32 v[178:179], v[192:193], v[186:187], v[178:179] op_sel_hi:[0,1,1] neg_lo:[0,0,1] neg_hi:[0,0,1]
v_pk_fma_f32 v[180:181], v[192:193], v[188:189], v[180:181] op_sel_hi:[0,1,1] neg_lo:[0,0,1] neg_hi:[0,0,1]
v_pk_fma_f32 v[182:183], v[192:193], v[190:191], v[182:183] op_sel_hi:[0,1,1] neg_lo:[0,0,1] neg_hi:[0,0,1]
v_cvt_pk_bf16_f32 v56, v176, v177
v_cvt_pk_bf16_f32 v57, v178, v179
v_cvt_pk_bf16_f32 v58, v180, v181
v_cvt_pk_bf16_f32 v59, v182, v183
v_pk_fma_f32 v[184:185], v[192:193], v[176:177], v[184:185] op_sel_hi:[0,1,1] neg_lo:[0,0,1] neg_hi:[0,0,1]
v_pk_fma_f32 v[186:187], v[192:193], v[178:179], v[186:187] op_sel_hi:[0,1,1] neg_lo:[0,0,1] neg_hi:[0,0,1]
v_pk_fma_f32 v[188:189], v[192:193], v[180:181], v[188:189] op_sel_hi:[0,1,1] neg_lo:[0,0,1] neg_hi:[0,0,1]
v_pk_fma_f32 v[190:191], v[192:193], v[182:183], v[190:191] op_sel_hi:[0,1,1] neg_lo:[0,0,1] neg_hi:[0,0,1]
v_cvt_pk_bf16_f32 v60, v184, v185
v_cvt_pk_bf16_f32 v61, v186, v187
v_cvt_pk_bf16_f32 v62, v188, v189
v_cvt_pk_bf16_f32 v63, v190, v191
v_pk_fma_f32 v[176:177], v[192:193], v[184:185], v[176:177] op_sel_hi:[0,1,1] neg_lo:[0,0,1] neg_hi:[0,0,1]
v_pk_fma_f32 v[178:179], v[192:193], v[186:187], v[178:179] op_sel_hi:[0,1,1] neg_lo:[0,0,1] neg_hi:[0,0,1]
v_pk_fma_f32 v[180:181], v[192:193], v[188:189], v[180:181] op_sel_hi:[0,1,1] neg_lo:[0,0,1] neg_hi:[0,0,1]
v_pk_fma_f32 v[182:183], v[192:193], v[190:191], v[182:183] op_sel_hi:[0,1,1] neg_lo:[0,0,1] neg_hi:[0,0,1]
v_cvt_pk_bf16_f32 v64, v176, v177
v_cvt_pk_bf16_f32 v65, v178, v179
v_cvt_pk_bf16_f32 v66, v180, v181
v_cvt_pk_bf16_f32 v67, v182, v183
v_pk_fma_f32 v[184:185], v[192:193], v[176:177], v[184:185] op_sel_hi:[0,1,1] neg_lo:[0,0,1] neg_hi:[0,0,1]
v_pk_fma_f32 v[186:187], v[192:193], v[178:179], v[186:187] op_sel_hi:[0,1,1] neg_lo:[0,0,1] neg_hi:[0,0,1]
v_pk_fma_f32 v[188:189], v[192:193], v[180:181], v[188:189] op_sel_hi:[0,1,1] neg_lo:[0,0,1] neg_hi:[0,0,1]
v_pk_fma_f32 v[190:191], v[192:193], v[182:183], v[190:191] op_sel_hi:[0,1,1] neg_lo:[0,0,1] neg_hi:[0,0,1]
v_cvt_pk_bf16_f32 v68, v184, v185
v_cvt_pk_bf16_f32 v69, v186, v187
v_cvt_pk_bf16_f32 v70, v188, v189
v_cvt_pk_bf16_f32 v71, v190, v191
v_pk_fma_f32 v[176:177], v[192:193], v[184:185], v[176:177] op_sel_hi:[0,1,1] neg_lo:[0,0,1] neg_hi:[0,0,1]
v_pk_fma_f32 v[178:179], v[192:193], v[186:187], v[178:179] op_sel_hi:[0,1,1] neg_lo:[0,0,1] neg_hi:[0,0,1]
v_pk_fma_f32 v[180:181], v[192:193], v[188:189], v[180:181] op_sel_hi:[0,1,1] neg_lo:[0,0,1] neg_hi:[0,0,1]
v_pk_fma_f32 v[182:183], v[192:193], v[190:191], v[182:183] op_sel_hi:[0,1,1] neg_lo:[0,0,1] neg_hi:[0,0,1]
v_cvt_pk_bf16_f32 v72, v176, v177
v_cvt_pk_bf16_f32 v73, v178, v179
v_cvt_pk_bf16_f32 v74, v180, v181
v_cvt_pk_bf16_f32 v75, v182, v183
v_pk_fma_f32 v[184:185], v[192:193], v[176:177], v[184:185] op_sel_hi:[0,1,1] neg_lo:[0,0,1] neg_hi:[0,0,1]
v_pk_fma_f32 v[186:187], v[192:193], v[178:179], v[186:187] op_sel_hi:[0,1,1] neg_lo:[0,0,1] neg_hi:[0,0,1]
v_pk_fma_f32 v[188:189], v[192:193], v[180:181], v[188:189] op_sel_hi:[0,1,1] neg_lo:[0,0,1] neg_hi:[0,0,1]
v_pk_fma_f32 v[190:191], v[192:193], v[182:183], v[190:191] op_sel_hi:[0,1,1] neg_lo:[0,0,1] neg_hi:[0,0,1]
v_cvt_pk_bf16_f32 v76, v184, v185
v_cvt_pk_bf16_f32 v77, v186, v187
v_cvt_pk_bf16_f32 v78, v188, v189
v_cvt_pk_bf16_f32 v79, v190, v191
v_pk_fma_f32 v[176:177], v[192:193], v[184:185], v[176:177] op_sel_hi:[0,1,1] neg_lo:[0,0,1] neg_hi:[0,0,1]
v_pk_fma_f32 v[178:179], v[192:193], v[186:187], v[178:179] op_sel_hi:[0,1,1] neg_lo:[0,0,1] neg_hi:[0,0,1]
v_pk_fma_f32 v[180:181], v[192:193], v[188:189], v[180:181] op_sel_hi:[0,1,1] neg_lo:[0,0,1] neg_hi:[0,0,1]
v_pk_fma_f32 v[182:183], v[192:193], v[190:191], v[182:183] op_sel_hi:[0,1,1] neg_lo:[0,0,1] neg_hi:[0,0,1]
v_cvt_pk_bf16_f32 v80, v176, v177
v_cvt_pk_bf16_f32 v81, v178, v179
v_cvt_pk_bf16_f32 v82, v180, v181
v_cvt_pk_bf16_f32 v83, v182, v183
v_pk_fma_f32 v[184:185], v[192:193], v[176:177], v[184:185] op_sel_hi:[0,1,1] neg_lo:[0,0,1] neg_hi:[0,0,1]
v_pk_fma_f32 v[186:187], v[192:193], v[178:179], v[186:187] op_sel_hi:[0,1,1] neg_lo:[0,0,1] neg_hi:[0,0,1]
v_pk_fma_f32 v[188:189], v[192:193], v[180:181], v[188:189] op_sel_hi:[0,1,1] neg_lo:[0,0,1] neg_hi:[0,0,1]
v_pk_fma_f32 v[190:191], v[192:193], v[182:183], v[190:191] op_sel_hi:[0,1,1] neg_lo:[0,0,1] neg_hi:[0,0,1]
v_cvt_pk_bf16_f32 v84, v184, v185
v_cvt_pk_bf16_f32 v85, v186, v187
v_cvt_pk_bf16_f32 v86, v188, v189
v_cvt_pk_bf16_f32 v87, v190, v191
v_pk_fma_f32 v[176:177], v[192:193], v[184:185], v[176:177] op_sel_hi:[0,1,1] neg_lo:[0,0,1] neg_hi:[0,0,1]
v_pk_fma_f32 v[178:179], v[192:193], v[186:187], v[178:179] op_sel_hi:[0,1,1] neg_lo:[0,0,1] neg_hi:[0,0,1]
v_pk_fma_f32 v[180:181], v[192:193], v[188:189], v[180:181] op_sel_hi:[0,1,1] neg_lo:[0,0,1] neg_hi:[0,0,1]
v_pk_fma_f32 v[182:183], v[192:193], v[190:191], v[182:183] op_sel_hi:[0,1,1] neg_lo:[0,0,1] neg_hi:[0,0,1]
v_cvt_pk_bf16_f32 v88, v176, v177
v_cvt_pk_bf16_f32 v89, v178, v179
v_cvt_pk_bf16_f32 v90, v180, v181
v_cvt_pk_bf16_f32 v91, v182, v183
v_pk_fma_f32 v[184:185], v[192:193], v[176:177], v[184:185] op_sel_hi:[0,1,1] neg_lo:[0,0,1] neg_hi:[0,0,1]
v_pk_fma_f32 v[186:187], v[192:193], v[178:179], v[186:187] op_sel_hi:[0,1,1] neg_lo:[0,0,1] neg_hi:[0,0,1]
v_pk_fma_f32 v[188:189], v[192:193], v[180:181], v[188:189] op_sel_hi:[0,1,1] neg_lo:[0,0,1] neg_hi:[0,0,1]
v_pk_fma_f32 v[190:191], v[192:193], v[182:183], v[190:191] op_sel_hi:[0,1,1] neg_lo:[0,0,1] neg_hi:[0,0,1]
v_cvt_pk_bf16_f32 v92, v184, v185
v_cvt_pk_bf16_f32 v93, v186, v187
v_cvt_pk_bf16_f32 v94, v188, v189
v_cvt_pk_bf16_f32 v95, v190, v191
s_mov_b32 s20, 323
v_mad_u32_u24 v179, v196, s20, v197
v_cvt_f32_u32 v179, v179
v_mul_f32 v198, s19, v179
v_rndne_f32 v198, v198
v_fmac_f32 v179, 0xc4200000, v198
v_mul_f32 v179, s19, v179
v_cos_f32 v179, v179
s_mov_b32 s20, 324
v_mad_u32_u24 v180, v196, s20, v197
v_cvt_f32_u32 v180, v180
v_mul_f32 v198, s19, v180
v_rndne_f32 v198, v198
v_fmac_f32 v180, 0xc4200000, v198
v_mul_f32 v180, s19, v180
v_cos_f32 v180, v180
s_nop 0
v_fma_f32 v181, v194, v180, -v179
v_fma_f32 v178, v194, v179, -v180
v_fma_f32 v182, v194, v181, -v180
v_fma_f32 v177, v194, v178, -v179
v_fma_f32 v183, v194, v182, -v181
v_fma_f32 v176, v194, v177, -v178
v_cvt_pk_bf16_f32 v96, v176, v177
v_cvt_pk_bf16_f32 v97, v178, v179
v_cvt_pk_bf16_f32 v98, v180, v181
v_cvt_pk_bf16_f32 v99, v182, v183
s_mov_b32 s20, 339
v_mad_u32_u24 v187, v196, s20, v197
v_cvt_f32_u32 v187, v187
v_mul_f32 v198, s19, v187
v_rndne_f32 v198, v198
v_fmac_f32 v187, 0xc4200000, v198
v_mul_f32 v187, s19, v187
v_cos_f32 v187, v187
s_mov_b32 s20, 340
v_mad_u32_u24 v188, v196, s20, v197
v_cvt_f32_u32 v188, v188
v_mul_f32 v198, s19, v188
v_rndne_f32 v198, v198
v_fmac_f32 v188, 0xc4200000, v198
v_mul_f32 v188, s19, v188
v_cos_f32 v188, v188
s_nop 0
v_fma_f32 v189, v194, v188, -v187
v_fma_f32 v186, v194, v187, -v188
v_fma_f32 v190, v194, v189, -v188
v_fma_f32 v185, v194, v186, -v187
v_fma_f32 v191, v194, v190, -v189
v_fma_f32 v184, v194, v185, -v186
v_cvt_pk_bf16_f32 v100, v184, v185
v_cvt_pk_bf16_f32 v101, v186, v187
v_cvt_pk_bf16_f32 v102, v188, v189
v_cvt_pk_bf16_f32 v103, v190, v191
v_pk_fma_f32 v[176:177], v[192:193], v[184:185], v[176:177] op_sel_hi:[0,1,1] neg_lo:[0,0,1] neg_hi:[0,0,1]
v_pk_fma_f32 v[178:179], v[192:193], v[186:187], v[178:179] op_sel_hi:[0,1,1] neg_lo:[0,0,1] neg_hi:[0,0,1]
v_pk_fma_f32 v[180:181], v[192:193], v[188:189], v[180:181] op_sel_hi:[0,1,1] neg_lo:[0,0,1] neg_hi:[0,0,1]
v_pk_fma_f32 v[182:183], v[192:193], v[190:191], v[182:183] op_sel_hi:[0,1,1] neg_lo:[0,0,1] neg_hi:[0,0,1]
v_cvt_pk_bf16_f32 v104, v176, v177
v_cvt_pk_bf16_f32 v105, v178, v179
v_cvt_pk_bf16_f32 v106, v180, v181
v_cvt_pk_bf16_f32 v107, v182, v183
v_pk_fma_f32 v[184:185], v[192:193], v[176:177], v[184:185] op_sel_hi:[0,1,1] neg_lo:[0,0,1] neg_hi:[0,0,1]
v_pk_fma_f32 v[186:187], v[192:193], v[178:179], v[186:187] op_sel_hi:[0,1,1] neg_lo:[0,0,1] neg_hi:[0,0,1]
v_pk_fma_f32 v[188:189], v[192:193], v[180:181], v[188:189] op_sel_hi:[0,1,1] neg_lo:[0,0,1] neg_hi:[0,0,1]
v_pk_fma_f32 v[190:191], v[192:193], v[182:183], v[190:191] op_sel_hi:[0,1,1] neg_lo:[0,0,1] neg_hi:[0,0,1]
v_cvt_pk_bf16_f32 v108, v184, v185
v_cvt_pk_bf16_f32 v109, v186, v187
v_cvt_pk_bf16_f32 v110, v188, v189
v_cvt_pk_bf16_f32 v111, v190, v191
v_pk_fma_f32 v[176:177], v[192:193], v[184:185], v[176:177] op_sel_hi:[0,1,1] neg_lo:[0,0,1] neg_hi:[0,0,1]
v_pk_fma_f32 v[178:179], v[192:193], v[186:187], v[178:179] op_sel_hi:[0,1,1] neg_lo:[0,0,1] neg_hi:[0,0,1]
v_pk_fma_f32 v[180:181], v[192:193], v[188:189], v[180:181] op_sel_hi:[0,1,1] neg_lo:[0,0,1] neg_hi:[0,0,1]
v_pk_fma_f32 v[182:183], v[192:193], v[190:191], v[182:183] op_sel_hi:[0,1,1] neg_lo:[0,0,1] neg_hi:[0,0,1]
v_cvt_pk_bf16_f32 v112, v176, v177
v_cvt_pk_bf16_f32 v113, v178, v179
v_cvt_pk_bf16_f32 v114, v180, v181
v_cvt_pk_bf16_f32 v115, v182, v183
v_pk_fma_f32 v[184:185], v[192:193], v[176:177], v[184:185] op_sel_hi:[0,1,1] neg_lo:[0,0,1] neg_hi:[0,0,1]
v_pk_fma_f32 v[186:187], v[192:193], v[178:179], v[186:187] op_sel_hi:[0,1,1] neg_lo:[0,0,1] neg_hi:[0,0,1]
v_pk_fma_f32 v[188:189], v[192:193], v[180:181], v[188:189] op_sel_hi:[0,1,1] neg_lo:[0,0,1] neg_hi:[0,0,1]
v_pk_fma_f32 v[190:191], v[192:193], v[182:183], v[190:191] op_sel_hi:[0,1,1] neg_lo:[0,0,1] neg_hi:[0,0,1]
v_cvt_pk_bf16_f32 v116, v184, v185
v_cvt_pk_bf16_f32 v117, v186, v187
v_cvt_pk_bf16_f32 v118, v188, v189
v_cvt_pk_bf16_f32 v119, v190, v191
v_pk_fma_f32 v[176:177], v[192:193], v[184:185], v[176:177] op_sel_hi:[0,1,1] neg_lo:[0,0,1] neg_hi:[0,0,1]
v_pk_fma_f32 v[178:179], v[192:193], v[186:187], v[178:179] op_sel_hi:[0,1,1] neg_lo:[0,0,1] neg_hi:[0,0,1]
v_pk_fma_f32 v[180:181], v[192:193], v[188:189], v[180:181] op_sel_hi:[0,1,1] neg_lo:[0,0,1] neg_hi:[0,0,1]
v_pk_fma_f32 v[182:183], v[192:193], v[190:191], v[182:183] op_sel_hi:[0,1,1] neg_lo:[0,0,1] neg_hi:[0,0,1]
v_cvt_pk_bf16_f32 v120, v176, v177
v_cvt_pk_bf16_f32 v121, v178, v179
v_cvt_pk_bf16_f32 v122, v180, v181
v_cvt_pk_bf16_f32 v123, v182, v183
v_pk_fma_f32 v[184:185], v[192:193], v[176:177], v[184:185] op_sel_hi:[0,1,1] neg_lo:[0,0,1] neg_hi:[0,0,1]
v_pk_fma_f32 v[186:187], v[192:193], v[178:179], v[186:187] op_sel_hi:[0,1,1] neg_lo:[0,0,1] neg_hi:[0,0,1]
v_pk_fma_f32 v[188:189], v[192:193], v[180:181], v[188:189] op_sel_hi:[0,1,1] neg_lo:[0,0,1] neg_hi:[0,0,1]
v_pk_fma_f32 v[190:191], v[192:193], v[182:183], v[190:191] op_sel_hi:[0,1,1] neg_lo:[0,0,1] neg_hi:[0,0,1]
v_cvt_pk_bf16_f32 v124, v184, v185
v_cvt_pk_bf16_f32 v125, v186, v187
v_cvt_pk_bf16_f32 v126, v188, v189
v_cvt_pk_bf16_f32 v127, v190, v191
v_pk_fma_f32 v[176:177], v[192:193], v[184:185], v[176:177] op_sel_hi:[0,1,1] neg_lo:[0,0,1] neg_hi:[0,0,1]
v_pk_fma_f32 v[178:179], v[192:193], v[186:187], v[178:179] op_sel_hi:[0,1,1] neg_lo:[0,0,1] neg_hi:[0,0,1]
v_pk_fma_f32 v[180:181], v[192:193], v[188:189], v[180:181] op_sel_hi:[0,1,1] neg_lo:[0,0,1] neg_hi:[0,0,1]
v_pk_fma_f32 v[182:183], v[192:193], v[190:191], v[182:183] op_sel_hi:[0,1,1] neg_lo:[0,0,1] neg_hi:[0,0,1]
v_cvt_pk_bf16_f32 v128, v176, v177
v_cvt_pk_bf16_f32 v129, v178, v179
v_cvt_pk_bf16_f32 v130, v180, v181
v_cvt_pk_bf16_f32 v131, v182, v183
v_pk_fma_f32 v[184:185], v[192:193], v[176:177], v[184:185] op_sel_hi:[0,1,1] neg_lo:[0,0,1] neg_hi:[0,0,1]
v_pk_fma_f32 v[186:187], v[192:193], v[178:179], v[186:187] op_sel_hi:[0,1,1] neg_lo:[0,0,1] neg_hi:[0,0,1]
v_pk_fma_f32 v[188:189], v[192:193], v[180:181], v[188:189] op_sel_hi:[0,1,1] neg_lo:[0,0,1] neg_hi:[0,0,1]
v_pk_fma_f32 v[190:191], v[192:193], v[182:183], v[190:191] op_sel_hi:[0,1,1] neg_lo:[0,0,1] neg_hi:[0,0,1]
v_cvt_pk_bf16_f32 v132, v184, v185
v_cvt_pk_bf16_f32 v133, v186, v187
v_cvt_pk_bf16_f32 v134, v188, v189
v_cvt_pk_bf16_f32 v135, v190, v191
v_pk_fma_f32 v[176:177], v[192:193], v[184:185], v[176:177] op_sel_hi:[0,1,1] neg_lo:[0,0,1] neg_hi:[0,0,1]
v_pk_fma_f32 v[178:179], v[192:193], v[186:187], v[178:179] op_sel_hi:[0,1,1] neg_lo:[0,0,1] neg_hi:[0,0,1]
v_pk_fma_f32 v[180:181], v[192:193], v[188:189], v[180:181] op_sel_hi:[0,1,1] neg_lo:[0,0,1] neg_hi:[0,0,1]
v_pk_fma_f32 v[182:183], v[192:193], v[190:191], v[182:183] op_sel_hi:[0,1,1] neg_lo:[0,0,1] neg_hi:[0,0,1]
v_cvt_pk_bf16_f32 v136, v176, v177
v_cvt_pk_bf16_f32 v137, v178, v179
v_cvt_pk_bf16_f32 v138, v180, v181
v_cvt_pk_bf16_f32 v139, v182, v183
v_pk_fma_f32 v[184:185], v[192:193], v[176:177], v[184:185] op_sel_hi:[0,1,1] neg_lo:[0,0,1] neg_hi:[0,0,1]
v_pk_fma_f32 v[186:187], v[192:193], v[178:179], v[186:187] op_sel_hi:[0,1,1] neg_lo:[0,0,1] neg_hi:[0,0,1]
v_pk_fma_f32 v[188:189], v[192:193], v[180:181], v[188:189] op_sel_hi:[0,1,1] neg_lo:[0,0,1] neg_hi:[0,0,1]
v_pk_fma_f32 v[190:191], v[192:193], v[182:183], v[190:191] op_sel_hi:[0,1,1] neg_lo:[0,0,1] neg_hi:[0,0,1]
v_cvt_pk_bf16_f32 v140, v184, v185
v_cvt_pk_bf16_f32 v141, v186, v187
v_cvt_pk_bf16_f32 v142, v188, v189
v_cvt_pk_bf16_f32 v143, v190, v191
v_pk_fma_f32 v[176:177], v[192:193], v[184:185], v[176:177] op_sel_hi:[0,1,1] neg_lo:[0,0,1] neg_hi:[0,0,1]
v_pk_fma_f32 v[178:179], v[192:193], v[186:187], v[178:179] op_sel_hi:[0,1,1] neg_lo:[0,0,1] neg_hi:[0,0,1]
v_pk_fma_f32 v[180:181], v[192:193], v[188:189], v[180:181] op_sel_hi:[0,1,1] neg_lo:[0,0,1] neg_hi:[0,0,1]
v_pk_fma_f32 v[182:183], v[192:193], v[190:191], v[182:183] op_sel_hi:[0,1,1] neg_lo:[0,0,1] neg_hi:[0,0,1]
v_cvt_pk_bf16_f32 v144, v176, v177
v_cvt_pk_bf16_f32 v145, v178, v179
v_cvt_pk_bf16_f32 v146, v180, v181
v_cvt_pk_bf16_f32 v147, v182, v183
v_pk_fma_f32 v[184:185], v[192:193], v[176:177], v[184:185] op_sel_hi:[0,1,1] neg_lo:[0,0,1] neg_hi:[0,0,1]
v_pk_fma_f32 v[186:187], v[192:193], v[178:179], v[186:187] op_sel_hi:[0,1,1] neg_lo:[0,0,1] neg_hi:[0,0,1]
v_pk_fma_f32 v[188:189], v[192:193], v[180:181], v[188:189] op_sel_hi:[0,1,1] neg_lo:[0,0,1] neg_hi:[0,0,1]
v_pk_fma_f32 v[190:191], v[192:193], v[182:183], v[190:191] op_sel_hi:[0,1,1] neg_lo:[0,0,1] neg_hi:[0,0,1]
v_cvt_pk_bf16_f32 v148, v184, v185
v_cvt_pk_bf16_f32 v149, v186, v187
v_cvt_pk_bf16_f32 v150, v188, v189
v_cvt_pk_bf16_f32 v151, v190, v191
v_pk_fma_f32 v[176:177], v[192:193], v[184:185], v[176:177] op_sel_hi:[0,1,1] neg_lo:[0,0,1] neg_hi:[0,0,1]
v_pk_fma_f32 v[178:179], v[192:193], v[186:187], v[178:179] op_sel_hi:[0,1,1] neg_lo:[0,0,1] neg_hi:[0,0,1]
v_pk_fma_f32 v[180:181], v[192:193], v[188:189], v[180:181] op_sel_hi:[0,1,1] neg_lo:[0,0,1] neg_hi:[0,0,1]
v_pk_fma_f32 v[182:183], v[192:193], v[190:191], v[182:183] op_sel_hi:[0,1,1] neg_lo:[0,0,1] neg_hi:[0,0,1]
v_cvt_pk_bf16_f32 v152, v176, v177
v_cvt_pk_bf16_f32 v153, v178, v179
v_cvt_pk_bf16_f32 v154, v180, v181
v_cvt_pk_bf16_f32 v155, v182, v183
v_pk_fma_f32 v[184:185], v[192:193], v[176:177], v[184:185] op_sel_hi:[0,1,1] neg_lo:[0,0,1] neg_hi:[0,0,1]
v_pk_fma_f32 v[186:187], v[192:193], v[178:179], v[186:187] op_sel_hi:[0,1,1] neg_lo:[0,0,1] neg_hi:[0,0,1]
v_pk_fma_f32 v[188:189], v[192:193], v[180:181], v[188:189] op_sel_hi:[0,1,1] neg_lo:[0,0,1] neg_hi:[0,0,1]
v_pk_fma_f32 v[190:191], v[192:193], v[182:183], v[190:191] op_sel_hi:[0,1,1] neg_lo:[0,0,1] neg_hi:[0,0,1]
v_cvt_pk_bf16_f32 v156, v184, v185
v_cvt_pk_bf16_f32 v157, v186, v187
v_cvt_pk_bf16_f32 v158, v188, v189
v_cvt_pk_bf16_f32 v159, v190, v191
v_pk_fma_f32 v[176:177], v[192:193], v[184:185], v[176:177] op_sel_hi:[0,1,1] neg_lo:[0,0,1] neg_hi:[0,0,1]
v_pk_fma_f32 v[178:179], v[192:193], v[186:187], v[178:179] op_sel_hi:[0,1,1] neg_lo:[0,0,1] neg_hi:[0,0,1]
v_pk_fma_f32 v[180:181], v[192:193], v[188:189], v[180:181] op_sel_hi:[0,1,1] neg_lo:[0,0,1] neg_hi:[0,0,1]
v_pk_fma_f32 v[182:183], v[192:193], v[190:191], v[182:183] op_sel_hi:[0,1,1] neg_lo:[0,0,1] neg_hi:[0,0,1]
v_cvt_pk_bf16_f32 v160, v176, v177
v_cvt_pk_bf16_f32 v161, v178, v179
v_cvt_pk_bf16_f32 v162, v180, v181
v_cvt_pk_bf16_f32 v163, v182, v183
v_pk_fma_f32 v[184:185], v[192:193], v[176:177], v[184:185] op_sel_hi:[0,1,1] neg_lo:[0,0,1] neg_hi:[0,0,1]
v_pk_fma_f32 v[186:187], v[192:193], v[178:179], v[186:187] op_sel_hi:[0,1,1] neg_lo:[0,0,1] neg_hi:[0,0,1]
v_pk_fma_f32 v[188:189], v[192:193], v[180:181], v[188:189] op_sel_hi:[0,1,1] neg_lo:[0,0,1] neg_hi:[0,0,1]
v_pk_fma_f32 v[190:191], v[192:193], v[182:183], v[190:191] op_sel_hi:[0,1,1] neg_lo:[0,0,1] neg_hi:[0,0,1]
v_cvt_pk_bf16_f32 v164, v184, v185
v_cvt_pk_bf16_f32 v165, v186, v187
v_cvt_pk_bf16_f32 v166, v188, v189
v_cvt_pk_bf16_f32 v167, v190, v191
v_pk_fma_f32 v[176:177], v[192:193], v[184:185], v[176:177] op_sel_hi:[0,1,1] neg_lo:[0,0,1] neg_hi:[0,0,1]
v_pk_fma_f32 v[178:179], v[192:193], v[186:187], v[178:179] op_sel_hi:[0,1,1] neg_lo:[0,0,1] neg_hi:[0,0,1]
v_pk_fma_f32 v[180:181], v[192:193], v[188:189], v[180:181] op_sel_hi:[0,1,1] neg_lo:[0,0,1] neg_hi:[0,0,1]
v_pk_fma_f32 v[182:183], v[192:193], v[190:191], v[182:183] op_sel_hi:[0,1,1] neg_lo:[0,0,1] neg_hi:[0,0,1]
v_cvt_pk_bf16_f32 v168, v176, v177
v_cvt_pk_bf16_f32 v169, v178, v179
v_cvt_pk_bf16_f32 v170, v180, v181
v_cvt_pk_bf16_f32 v171, v182, v183
v_pk_fma_f32 v[184:185], v[192:193], v[176:177], v[184:185] op_sel_hi:[0,1,1] neg_lo:[0,0,1] neg_hi:[0,0,1]
v_pk_fma_f32 v[186:187], v[192:193], v[178:179], v[186:187] op_sel_hi:[0,1,1] neg_lo:[0,0,1] neg_hi:[0,0,1]
v_pk_fma_f32 v[188:189], v[192:193], v[180:181], v[188:189] op_sel_hi:[0,1,1] neg_lo:[0,0,1] neg_hi:[0,0,1]
v_pk_fma_f32 v[190:191], v[192:193], v[182:183], v[190:191] op_sel_hi:[0,1,1] neg_lo:[0,0,1] neg_hi:[0,0,1]
v_cvt_pk_bf16_f32 v172, v184, v185
v_cvt_pk_bf16_f32 v173, v186, v187
v_cvt_pk_bf16_f32 v174, v188, v189
v_cvt_pk_bf16_f32 v175, v190, v191
p1q_72:
s_lshl_b32 s18, s30, 7
s_add_u32 s18, s18, 32768
s_cmp_lg_u32 s13, 0
s_cbranch_scc1 polld_74
v_lshrrev_b32 v12, 2, v0
v_min_u32 v12, 76, v12
s_mov_b32 s17, 0
poll_73:
buffer_load_dword v8, v12, s[4:7], s18 offen offset:0 sc1
s_add_u32 s17, s17, 1
s_cmp_gt_u32 s17, 262144
s_cbranch_scc1 L_fail
s_waitcnt vmcnt(0)
v_cmp_gt_u32 vcc, 1, v8
s_cbranch_vccz polld_74
s_sleep 2
s_branch poll_73
polld_74:
s_barrier
s_mul_i32 s18, s30, 40960
s_add_u32 s26, s18, 91226112
s_add_u32 s26, s26, s31
s_add_u32 s27, s18, 100663296
s_add_u32 s27, s27, s33
s_add_u32 m0, s31, 2048
s_add_u32 s20, s26, 0
buffer_load_dwordx4 v0, s[4:7], s20 offen sc1 lds
s_add_u32 m0, s31, 3072
s_add_u32 s20, s26, 1024
buffer_load_dwordx4 v0, s[4:7], s20 offen sc1 lds
s_add_u32 m0, s31, 4096
s_add_u32 s20, s26, 2048
buffer_load_dwordx4 v0, s[4:7], s20 offen sc1 lds
s_add_u32 m0, s31, 5120
s_add_u32 s20, s26, 3072
buffer_load_dwordx4 v0, s[4:7], s20 offen sc1 lds
s_add_u32 m0, s31, 6144
s_add_u32 s20, s26, 4096
buffer_load_dwordx4 v0, s[4:7], s20 offen sc1 lds
s_add_u32 m0, s31, 7168
s_add_u32 s20, s26, 5120
buffer_load_dwordx4 v0, s[4:7], s20 offen sc1 lds
s_add_u32 m0, s31, 8192
s_add_u32 s20, s26, 6144
buffer_load_dwordx4 v0, s[4:7], s20 offen sc1 lds
s_add_u32 m0, s31, 9216
s_add_u32 s20, s26, 7168
buffer_load_dwordx4 v0, s[4:7], s20 offen sc1 lds
s_add_u32 m0, s31, 10240
s_add_u32 s20, s26, 8192
buffer_load_dwordx4 v0, s[4:7], s20 offen sc1 lds
s_add_u32 m0, s31, 11264
s_add_u32 s20, s26, 9216
buffer_load_dwordx4 v0, s[4:7], s20 offen sc1 lds
s_waitcnt vmcnt(0)
s_barrier
v_add_u32 v2, s31, v0
ds_read_b128 v[216:219], v2 offset:2048
ds_read_b128 v[220:223], v2 offset:3072
ds_read_b128 v[224:227], v2 offset:4096
ds_read_b128 v[196:199], v0 offset:3072
ds_read_b128 v[228:231], v2 offset:5120
ds_read_b128 v[192:195], v0 offset:2048
v_mov_b64 v[208:209], 0
ds_read_b128 v[200:203], v0 offset:4096
ds_read_b128 v[204:207], v0 offset:5120
s_waitcnt lgkmcnt(7)
v_dot2c_f32_bf16 v208, s24, v216
v_dot2c_f32_bf16 v209, v216, v216
v_dot2c_f32_bf16 v208, s24, v217
v_dot2c_f32_bf16 v209, v217, v217
v_dot2c_f32_bf16 v208, s24, v218
v_dot2c_f32_bf16 v209, v218, v218
v_dot2c_f32_bf16 v208, s24, v219
s_waitcnt lgkmcnt(5)
v_dot2c_f32_bf16 v209, v219, v219
v_dot2c_f32_bf16 v208, s24, v220
v_dot2c_f32_bf16 v209, v220, v220
v_dot2c_f32_bf16 v208, s24, v221
v_dot2c_f32_bf16 v209, v221, v221
v_dot2c_f32_bf16 v208, s24, v222
v_dot2c_f32_bf16 v209, v222, v222
v_dot2c_f32_bf16 v208, s24, v223
v_dot2c_f32_bf16 v209, v223, v223
v_dot2c_f32_bf16 v208, s24, v224
v_dot2c_f32_bf16 v209, v224, v224
s_waitcnt lgkmcnt(3)
ds_read_b128 v[216:219], v2 offset:6144
ds_read_b128 v[220:223], v2 offset:7168
v_dot2c_f32_bf16 v208, s24, v225
v_dot2c_f32_bf16 v209, v225, v225
v_dot2c_f32_bf16 v208, s24, v226
v_dot2c_f32_bf16 v209, v226, v226
v_dot2c_f32_bf16 v208, s24, v227
v_dot2c_f32_bf16 v209, v227, v227
v_dot2c_f32_bf16 v208, s24, v228
v_dot2c_f32_bf16 v209, v228, v228
v_dot2c_f32_bf16 v208, s24, v229
v_dot2c_f32_bf16 v209, v229, v229
v_dot2c_f32_bf16 v208, s24, v230
v_dot2c_f32_bf16 v209, v230, v230
v_dot2c_f32_bf16 v208, s24, v231
v_dot2c_f32_bf16 v209, v231, v231
s_waitcnt lgkmcnt(1)
ds_read_b128 v[228:231], v2 offset:9216
ds_read_b128 v[224:227], v2 offset:8192
v_dot2c_f32_bf16 v208, s24, v216
v_dot2c_f32_bf16 v209, v216, v216
v_dot2c_f32_bf16 v208, s24, v217
s_waitcnt lgkmcnt(2)
v_dot2c_f32_bf16 v209, v217, v217
v_dot2c_f32_bf16 v208, s24, v218
v_dot2c_f32_bf16 v209, v218, v218
v_dot2c_f32_bf16 v208, s24, v219
v_dot2c_f32_bf16 v209, v219, v219
v_dot2c_f32_bf16 v208, s24, v220
v_dot2c_f32_bf16 v209, v220, v220
v_dot2c_f32_bf16 v208, s24, v221
v_dot2c_f32_bf16 v209, v221, v221
v_dot2c_f32_bf16 v208, s24, v222
v_dot2c_f32_bf16 v209, v222, v222
v_dot2c_f32_bf16 v208, s24, v223
v_dot2c_f32_bf16 v209, v223, v223
s_waitcnt lgkmcnt(0)
ds_read_b128 v[216:219], v2 offset:10240
ds_read_b128 v[220:223], v2 offset:11264
v_dot2c_f32_bf16 v208, s24, v224
v_dot2c_f32_bf16 v209, v224, v224
v_dot2c_f32_bf16 v208, s24, v225
v_dot2c_f32_bf16 v209, v225, v225
v_dot2c_f32_bf16 v208, s24, v226
v_dot2c_f32_bf16 v209, v226, v226
v_dot2c_f32_bf16 v208, s24, v227
v_dot2c_f32_bf16 v209, v227, v227
v_dot2c_f32_bf16 v208, s24, v228
v_dot2c_f32_bf16 v209, v228, v228
v_dot2c_f32_bf16 v208, s24, v229
v_dot2c_f32_bf16 v209, v229, v229
v_dot2c_f32_bf16 v208, s24, v230
v_dot2c_f32_bf16 v209, v230, v230
s_waitcnt lgkmcnt(1)
v_dot2c_f32_bf16 v208, s24, v231
v_dot2c_f32_bf16 v209, v231, v231
v_dot2c_f32_bf16 v208, s24, v216
s_waitcnt lgkmcnt(0)
v_dot2c_f32_bf16 v209, v216, v216
v_dot2c_f32_bf16 v208, s24, v217
v_dot2c_f32_bf16 v209, v217, v217
v_dot2c_f32_bf16 v208, s24, v218
v_dot2c_f32_bf16 v209, v218, v218
v_dot2c_f32_bf16 v208, s24, v219
v_dot2c_f32_bf16 v209, v219, v219
v_dot2c_f32_bf16 v208, s24, v220
v_dot2c_f32_bf16 v209, v220, v220
v_dot2c_f32_bf16 v208, s24, v221
v_dot2c_f32_bf16 v209, v221, v221
v_dot2c_f32_bf16 v208, s24, v222
v_dot2c_f32_bf16 v209, v222, v222
v_dot2c_f32_bf16 v208, s24, v223
v_dot2c_f32_bf16 v209, v223, v223
v_mfma_f32_32x32x16_bf16 v[176:191], v[192:195], v[16:19], 0
s_nop 1
v_permlane32_swap_b32 v208, v209
ds_read_b128 v[192:195], v0 offset:6144
v_mfma_f32_32x32x16_bf16 v[176:191], v[196:199], v[20:23], v[176:191]
v_and_b32 v2, 0x1ff, v0
v_add_f32 v208, v208, v209
v_mfma_f32_32x32x16_bf16 v[176:191], v[200:203], v[24:27], v[176:191]
v_lshl_add_u32 v209, s13, 2, v0
ds_read_b128 v[196:199], v0 offset:7168
ds_write_b32 v209, v208 offset:0
v_mfma_f32_32x32x16_bf16 v[176:191], v[204:207], v[28:31], v[176:191]
s_waitcnt lgkmcnt(2)
ds_read_b128 v[200:203], v0 offset:8192
ds_read_b128 v[204:207], v0 offset:9216
v_mfma_f32_32x32x16_bf16 v[176:191], v[192:195], v[32:35], v[176:191]
s_waitcnt lgkmcnt(3)
v_mfma_f32_32x32x16_bf16 v[176:191], v[196:199], v[36:39], v[176:191]
s_waitcnt lgkmcnt(2)
ds_read_b128 v[192:195], v0 offset:10240
s_waitcnt lgkmcnt(2)
s_waitcnt lgkmcnt(1)
v_mfma_f32_32x32x16_bf16 v[176:191], v[200:203], v[40:43], v[176:191]
ds_read_b128 v[196:199], v0 offset:11264
s_barrier
ds_read_b128 v[208:211], v2 offset:0
v_mfma_f32_32x32x16_bf16 v[176:191], v[204:207], v[44:47], v[176:191]
ds_read_b128 v[204:207], v0 offset:13312
ds_read_b128 v[200:203], v0 offset:12288
s_waitcnt lgkmcnt(4)
v_mfma_f32_32x32x16_bf16 v[176:191], v[192:195], v[48:51], v[176:191]
s_waitcnt lgkmcnt(3)
ds_read_b128 v[212:215], v2 offset:512
ds_read_b128 v[192:195], v0 offset:14336
v_mfma_f32_32x32x16_bf16 v[176:191], v[196:199], v[52:55], v[176:191]
s_waitcnt lgkmcnt(2)
v_mfma_f32_32x32x16_bf16 v[176:191], v[200:203], v[56:59], v[176:191]
ds_read_b128 v[196:199], v0 offset:15360
ds_read_b128 v[200:203], v0 offset:16384
v_add_f32 v208, v208, v209
v_add_f32 v210, v210, v211
s_waitcnt lgkmcnt(3)
v_mfma_f32_32x32x16_bf16 v[176:191], v[204:207], v[60:63], v[176:191]
s_waitcnt lgkmcnt(2)
ds_read_b128 v[204:207], v0 offset:17408
v_add_f32 v212, v212, v213
v_add_f32 v208, v208, v210
v_mfma_f32_32x32x16_bf16 v[176:191], v[192:195], v[64:67], v[176:191]
s_waitcnt lgkmcnt(2)
v_mfma_f32_32x32x16_bf16 v[176:191], v[196:199], v[68:71], v[176:191]
v_mul_f32 v208, 0x3acccccd, v208
s_waitcnt lgkmcnt(1)
ds_read_b128 v[192:195], v0 offset:18432
v_add_f32 v214, v214, v215
s_waitcnt lgkmcnt(1)
v_mfma_f32_32x32x16_bf16 v[176:191], v[200:203], v[72:75], v[176:191]
v_lshrrev_b32 v209, 2, v0
ds_read_b128 v[196:199], v0 offset:19456
v_mfma_f32_32x32x16_bf16 v[176:191], v[204:207], v[76:79], v[176:191]
ds_read_b128 v[200:203], v0 offset:20480
ds_read_b128 v[204:207], v0 offset:21504
v_add_f32 v212, v212, v214
v_mul_f32 v212, 0x3acccccd, v212
s_waitcnt lgkmcnt(3)
v_mfma_f32_32x32x16_bf16 v[176:191], v[192:195], v[80:83], v[176:191]
v_fma_f32 v212, -v208, v208, v212
s_waitcnt lgkmcnt(2)
v_max_f32 v212, 0, v212
v_add_f32 v212, 0x3727c5ac, v212
v_mfma_f32_32x32x16_bf16 v[176:191], v[196:199], v[84:87], v[176:191]
ds_read_b128 v[192:195], v0 offset:22528
s_waitcnt lgkmcnt(2)
v_bfe_u32 v210, v0, 5, 5
v_lshl_add_u32 v209, s13, 8, v209
v_mfma_f32_32x32x16_bf16 v[176:191], v[200:203], v[88:91], v[176:191]
ds_read_b128 v[196:199], v0 offset:23552
ds_read_b128 v[200:203], v0 offset:24576
v_rsq_f32 v212, v212
s_waitcnt lgkmcnt(3)
v_and_b32 v210, 16, v210
v_mfma_f32_32x32x16_bf16 v[176:191], v[204:207], v[92:95], v[176:191]
ds_read_b128 v[204:207], v0 offset:25600
s_waitcnt lgkmcnt(3)
v_mul_f32 v208, v212, v208
v_mfma_f32_32x32x16_bf16 v[176:191], v[192:195], v[96:99], v[176:191]
v_lshl_add_u32 v210, s13, 8, v210
v_permlane32_swap_b32 v212, v208
s_waitcnt lgkmcnt(2)
ds_read_b128 v[192:195], v0 offset:26624
v_mfma_f32_32x32x16_bf16 v[176:191], v[196:199], v[100:103], v[176:191]
ds_write_b32 v209, v212 offset:1024
s_waitcnt lgkmcnt(3)
s_waitcnt lgkmcnt(2)
v_mfma_f32_32x32x16_bf16 v[176:191], v[200:203], v[104:107], v[176:191]
ds_read_b128 v[240:243], v210 offset:1216
ds_read_b128 v[196:199], v0 offset:27648
v_mfma_f32_32x32x16_bf16 v[176:191], v[204:207], v[108:111], v[176:191]
ds_read_b128 v[200:203], v0 offset:28672
s_waitcnt lgkmcnt(4)
ds_read_b128 v[232:235], v210 offset:1152
v_mfma_f32_32x32x16_bf16 v[176:191], v[192:195], v[112:115], v[176:191]
ds_read_b128 v[204:207], v0 offset:29696
ds_read_b128 v[192:195], v0 offset:30720
s_waitcnt lgkmcnt(4)
v_mfma_f32_32x32x16_bf16 v[176:191], v[196:199], v[116:119], v[176:191]
ds_read_b128 v[228:231], v210 offset:1120
s_waitcnt lgkmcnt(4)
ds_read_b128 v[216:219], v210 offset:1024
ds_read_b128 v[196:199], v0 offset:31744
v_mfma_f32_32x32x16_bf16 v[176:191], v[200:203], v[120:123], v[176:191]
v_mul_f32 v241, v241, v7
s_waitcnt lgkmcnt(3)
ds_read_b128 v[200:203], v0 offset:32768
v_mfma_f32_32x32x16_bf16 v[176:191], v[204:207], v[124:127], v[176:191]
ds_read_b128 v[220:223], v210 offset:1056
v_mfma_f32_32x32x16_bf16 v[176:191], v[192:195], v[128:131], v[176:191]
ds_read_b128 v[204:207], v0 offset:33792
s_waitcnt lgkmcnt(3)
v_mfma_f32_32x32x16_bf16 v[176:191], v[196:199], v[132:135], v[176:191]
s_waitcnt lgkmcnt(2)
ds_read_b128 v[192:195], v0 offset:34816
ds_read_b128 v[224:227], v210 offset:1088
ds_read_b128 v[196:199], v0 offset:35840
ds_read_b128 v[244:247], v210 offset:1248
v_mfma_f32_32x32x16_bf16 v[176:191], v[200:203], v[136:139], v[176:191]
s_waitcnt lgkmcnt(4)
ds_read_b128 v[200:203], v0 offset:36864
v_mfma_f32_32x32x16_bf16 v[176:191], v[204:207], v[140:143], v[176:191]
v_mul_f32 v242, v242, v7
ds_read_b128 v[236:239], v210 offset:1184
s_waitcnt lgkmcnt(5)
v_mfma_f32_32x32x16_bf16 v[176:191], v[192:195], v[144:147], v[176:191]
ds_read_b128 v[204:207], v0 offset:37888
s_waitcnt lgkmcnt(3)
ds_read_b128 v[192:195], v0 offset:38912
v_mfma_f32_32x32x16_bf16 v[176:191], v[196:199], v[148:151], v[176:191]
ds_read_b128 v[196:199], v0 offset:39936
s_waitcnt lgkmcnt(4)
s_waitcnt lgkmcnt(3)
v_mul_f32 v240, v240, v7
v_mfma_f32_32x32x16_bf16 v[176:191], v[200:203], v[152:155], v[176:191]
v_mul_f32 v247, v247, v7
v_mul_f32 v245, v245, v7
v_mul_f32 v233, v233, v7
s_waitcnt lgkmcnt(2)
v_mfma_f32_32x32x16_bf16 v[176:191], v[204:207], v[156:159], v[176:191]
ds_read_b128 v[200:203], v0 offset:40960
s_waitcnt lgkmcnt(1)
ds_read_b128 v[204:207], v0 offset:41984
v_mul_f32 v232, v232, v7
v_mfma_f32_32x32x16_bf16 v[176:191], v[192:195], v[160:163], v[176:191]
v_mul_f32 v246, v246, v7
v_mul_f32 v244, v244, v7
v_mul_f32 v236, v236, v7
v_mfma_f32_32x32x16_bf16 v[176:191], v[196:199], v[164:167], v[176:191]
s_waitcnt lgkmcnt(0)
v_mul_f32 v239, v239, v7
v_mfma_f32_32x32x16_bf16 v[176:191], v[200:203], v[168:171], v[176:191]
v_mul_f32 v238, v238, v7
v_mfma_f32_32x32x16_bf16 v[176:191], v[204:207], v[172:175], v[176:191]
s_nop 0
v_mul_f32 v237, v237, v7
v_mul_f32 v235, v235, v7
v_mul_f32 v234, v234, v7
v_mul_f32 v243, v243, v7
s_nop 6
v_pk_fma_f32 v[184:185], v[184:185], v[224:225], v[240:241] neg_lo:[0,0,1] neg_hi:[0,0,1]
v_pk_fma_f32 v[182:183], v[182:183], v[222:223], v[238:239] neg_lo:[0,0,1] neg_hi:[0,0,1]
v_pk_fma_f32 v[180:181], v[180:181], v[220:221], v[236:237] neg_lo:[0,0,1] neg_hi:[0,0,1]
v_pk_fma_f32 v[188:189], v[188:189], v[228:229], v[244:245] neg_lo:[0,0,1] neg_hi:[0,0,1]
v_pk_fma_f32 v[176:177], v[176:177], v[216:217], v[232:233] neg_lo:[0,0,1] neg_hi:[0,0,1]
v_cvt_pk_bf16_f32 v194, v180, v181
v_pk_fma_f32 v[178:179], v[178:179], v[218:219], v[234:235] neg_lo:[0,0,1] neg_hi:[0,0,1]
v_cvt_pk_bf16_f32 v198, v188, v189
v_pk_fma_f32 v[190:191], v[190:191], v[230:231], v[246:247] neg_lo:[0,0,1] neg_hi:[0,0,1]
v_cvt_pk_bf16_f32 v199, v190, v191
v_cvt_pk_bf16_f32 v195, v182, v183
v_pk_fma_f32 v[186:187], v[186:187], v[226:227], v[242:243] neg_lo:[0,0,1] neg_hi:[0,0,1]
v_cvt_pk_bf16_f32 v193, v178, v179
v_cvt_pk_bf16_f32 v196, v184, v185
v_cvt_pk_bf16_f32 v197, v186, v187
v_cvt_pk_bf16_f32 v192, v176, v177
buffer_store_dwordx4 v[192:195], v6, s[4:7], s27 offen offset:0 sc1
buffer_store_dwordx4 v[196:199], v6, s[4:7], s27 offen offset:1024 sc1
s_add_u32 s30, s30, 3
s_cmp_lt_u32 s30, 60
s_cbranch_scc1 p1q_72
s_lshl_b32 s18, s51, 2
s_add_u32 s18, s18, 6144
s_cmp_eq_u32 s13, 0
s_cselect_b32 s22, s18, s6
s_mov_b32 s23, 1
s_waitcnt vmcnt(0)
s_barrier
v_mov_b32 v3, s23
s_mov_b64 exec, 1
buffer_store_dword v3, off, s[4:7], s22 sc1
s_mov_b64 exec, -1
s_mov_b32 s22, s6
aend_54:
s_add_u32 s16, s16, 1
s_cmp_lt_u32 s16, 2
s_cbranch_scc1 alay_40
s_endpgm
L_fail:
s_mov_b64 exec, 1
v_mov_b32 v1, 0xdead
buffer_store_dword v1, off, s[8:11], 0 offset:8 sc1
L_end:
s_endpgm
L_chain:
s_waitcnt vmcnt(0)
s_nop 4
s_and_b32 s12, s14, 1
s_cmp_lg_u32 s12, 0
s_cbranch_scc1 grp_10001
s_lshr_b32 s24, s14, 1
v_and_b32 v64, 63, v0
v_and_b32 v65, 15, v64
v_lshrrev_b32 v66, 4, v64
v_lshlrev_b32 v0, 4, v64
v_and_b32 v67, 2, v64
v_mov_b32 v68, 0x4444
v_mov_b32 v69, 0xeeee
v_cmp_eq_u32 vcc, 0, v67
s_nop 1
v_cndmask_b32 v1, v69, v68, vcc
s_mul_i32 s26, s13, 24576
s_add_u32 s26, s26, 65536
v_add_u32 v2, s26, v0
v_lshrrev_b32 v67, 2, v65
v_xor_b32 v68, v66, v67
v_lshlrev_b32 v68, 3, v68
v_lshl_add_u32 v68, v65, 5, v68
s_lshl_b32 s26, s13, 10
s_add_u32 s26, s26, 10240
v_add_u32 v3, s26, v68
v_lshl_add_u32 v68, v66, 2, v67
v_and_b32 v69, 3, v65
v_xor_b32 v69, v69, v66
v_lshlrev_b32 v69, 3, v69
v_lshl_add_u32 v68, v68, 5, v69
v_add_u32 v4, 10240, v68
v_and_b32 v69, 1, v65
v_lshl_add_u32 v68, v67, 1, v69
v_lshlrev_b32 v68, 4, v68
v_lshl_add_u32 v68, v66, 7, v68
v_add_u32 v5, 8192, v68
v_bfe_u32 v69, v65, 1, 1
v_mul_u32_u24 v69, 640, v69
v_xor_b32 v6, v69, v5
s_mov_b32 s40, 0x33333333
s_mov_b32 s41, 0x33333333
s_mov_b32 s44, 0x3f803f80
s_mov_b32 s45, 0x3f803f80
s_mov_b32 s46, 0x3f803f80
s_mov_b32 s47, 0
s_mov_b32 s36, 729808896
s_mov_b32 s37, 671088640
v_lshlrev_b32 v68, 3, v65
v_lshl_add_u32 v7, v66, 12, v68
s_lshl_b32 s26, s13, 14
s_lshl_b32 s27, s14, 7
s_add_u32 s26, s26, s27
s_add_u32 s90, s26, 65536
s_lshl_b32 s26, s13, 5
s_add_u32 s93, s26, s14
s_lshl_b32 s26, s93, 12
s_add_u32 s91, s26, 65536
s_lshr_b32 s26, s93, 2
s_lshl_b32 s26, s26, 9
s_and_b32 s27, s93, 3
s_lshl_b32 s27, s27, 6
s_add_u32 s26, s26, s27
s_add_u32 s92, s26, 393216
s_lshl_b32 s26, s14, 7
s_add_u32 s22, s26, 0
s_lshl_b32 s26, s24, 2
s_add_u32 s26, s26, 4096
s_cmp_lt_u32 s24, 10
s_cselect_b32 s23, s26, 268435456
s_cselect_b32 s24, s24, 0
s_cselect_b32 s25, 12582912, s23
s_lshl_b32 s24, s24, 10
s_and_b32 s26, s14, 1
s_lshl_b32 s26, s26, 10
s_add_u32 s94, s26, 425984
s_lshl_b32 s26, s14, 5
s_add_u32 s95, s26, 425984
s_mov_b32 s34, 0x3e0293ee
s_lshl_b32 s26, s14, 2
s_add_u32 s26, s26, s13
s_mul_i32 s27, s26, 18432
s_add_u32 s89, s27, 1048576
s_add_u32 s48, s4, s90
s_addc_u32 s49, s5, 0
s_add_u32 s50, s90, 65536
s_add_u32 s50, s4, s50
s_addc_u32 s51, s5, 0
s_add_u32 s52, s90, 131072
s_add_u32 s52, s4, s52
s_addc_u32 s53, s5, 0
s_add_u32 s54, s90, 196608
s_add_u32 s54, s4, s54
s_addc_u32 s55, s5, 0
s_add_u32 s56, s90, 262144
s_add_u32 s56, s4, s56
s_addc_u32 s57, s5, 0
s_add_u32 s74, s89, 4096
s_add_u32 s74, s4, s74
s_addc_u32 s75, s5, 0
s_add_u32 s76, s89, 12288
s_add_u32 s76, s4, s76
s_addc_u32 s77, s5, 0
s_add_u32 s78, s89, 20480
s_add_u32 s78, s4, s78
s_addc_u32 s79, s5, 0
s_add_u32 s58, s4, s94
s_addc_u32 s59, s5, 0
s_add_u32 s60, s4, s95
s_addc_u32 s61, s5, 0
s_add_u32 s62, s4, s91
s_addc_u32 s63, s5, 0
s_add_u32 s64, s4, s92
s_addc_u32 s65, s5, 0
v_mov_b32 v72, 0
v_mov_b32 v73, 0
s_mov_b32 s26, s90
buffer_store_dwordx2 v[72:73], v7, s[4:7], s26 offen
s_add_u32 s26, s26, 65536
buffer_store_dwordx2 v[72:73], v7, s[4:7], s26 offen
s_add_u32 s26, s26, 65536
buffer_store_dwordx2 v[72:73], v7, s[4:7], s26 offen
s_add_u32 s26, s26, 65536
buffer_store_dwordx2 v[72:73], v7, s[4:7], s26 offen
s_add_u32 s26, s26, 65536
buffer_store_dwordx2 v[72:73], v7, s[4:7], s26 offen
s_add_u32 s26, s26, 65536
buffer_store_dword v72, off, s[4:7], s95 offset:0
buffer_store_dword v72, off, s[4:7], s95 offset:1024
s_load_dwordx2 s[96:97], s[0:1], 32
s_mov_b32 s98, 10240
s_mov_b32 s99, 0x20000
s_cmp_ge_u32 s93, 80
s_cbranch_scc1 nm0_10002
s_and_b32 s26, s93, 3
s_mul_i32 s26, s26, 2560
s_lshr_b32 s27, s93, 2
s_lshl_b32 s27, s27, 6
s_add_u32 s26, s26, s27
v_bfe_u32 v68, v65, 1, 2
v_lshlrev_b32 v68, 4, v68
v_and_b32 v69, 1, v65
v_lshl_add_u32 v68, v69, 2, v68
v_and_b32 v69, 1, v66
v_mul_u32_u24 v69, 1280, v69
v_add_u32 v68, v68, v69
s_waitcnt lgkmcnt(0)
buffer_load_dword v74, v68, s[96:99], s26 offen
buffer_load_dword v75, v68, s[96:99], s26 offen offset:8
v_and_b32 v68, 32, v0
v_bfe_u32 v69, v0, 6, 1
v_lshl_add_u32 v68, v69, 8, v68
v_bfe_u32 v69, v0, 8, 1
v_lshl_add_u32 v68, v69, 4, v68
v_bfe_u32 v69, v0, 4, 1
v_lshl_add_u32 v68, v69, 3, v68
s_add_u32 s27, s92, 16384
buffer_store_dwordx2 v[72:73], v68, s[4:7], s92 offen
s_waitcnt vmcnt(1)
buffer_store_dwordx2 v[74:75], v68, s[4:7], s27 offen
nm0_10002:
s_waitcnt vmcnt(0) lgkmcnt(0)
v_lshrrev_b32 v67, 3, v64
v_and_b32 v68, 7, v64
v_lshlrev_b32 v68, 4, v68
v_lshl_add_u32 v32, v67, 13, v68
v_mul_u32_u24 v67, 1280, v67
v_add_u32 v36, v67, v68
v_lshrrev_b32 v67, 1, v66
v_lshlrev_b32 v67, 4, v67
v_and_b32 v68, 1, v66
v_lshl_add_u32 v67, v68, 1, v67
v_lshrrev_b32 v68, 3, v65
v_lshl_add_u32 v67, v68, 3, v67
v_bfe_u32 v68, v65, 2, 1
v_add_u32 v67, v67, v68
v_and_b32 v69, 3, v65
v_lshlrev_b32 v40, 4, v69
v_lshl_add_u32 v40, v67, 7, v40
v_lshl_add_u32 v67, v66, 2, v68
v_lshlrev_b32 v42, 4, v69
v_lshl_add_u32 v42, v67, 7, v42
v_lshrrev_b32 v68, 3, v65
v_lshl_add_u32 v42, v68, 3, v42
s_lshl_b32 s29, s13, 12
s_and_b32 s26, s13, 1
s_lshl_b32 s26, s26, 6
s_add_u32 s26, s26, s29
v_add_u32 v40, s26, v40
v_add_u32 v42, s26, v42
v_xor_b32 v41, 4096, v40
v_xor_b32 v43, 4096, v42
v_add_u32 v33, 64512, v32
v_add_u32 v37, 9216, v36
v_add_u32 v34, 129024, v32
v_add_u32 v38, 18432, v36
v_add_u32 v35, 193536, v32
v_add_u32 v39, 27648, v36
s_lshr_b32 s28, s13, 1
s_lshl_b32 s28, s28, 7
s_lshl_b32 s27, s14, 8
s_add_u32 s27, s27, s28
s_xor_b32 s26, s13, 0
s_lshl_b32 s80, s26, 19
s_add_u32 s80, s80, s27
s_lshl_b32 s83, s14, 2
s_add_u32 s83, s83, s26
s_mul_i32 s83, s83, 40960
s_add_u32 s83, s83, s28
s_xor_b32 s26, s13, 2
s_lshl_b32 s81, s26, 19
s_add_u32 s81, s81, s27
s_lshl_b32 s84, s14, 2
s_add_u32 s84, s84, s26
s_mul_i32 s84, s84, 40960
s_add_u32 s84, s84, s28
s_and_b32 s26, s13, 1
s_add_u32 s26, s26, 8
s_lshl_b32 s82, s26, 19
s_add_u32 s82, s82, s27
s_load_dwordx2 s[66:67], s[0:1], 40
s_load_dwordx2 s[68:69], s[0:1], 48
s_load_dwordx2 s[70:71], s[0:1], 56
s_load_dwordx2 s[72:73], s[0:1], 64
s_mov_b32 s98, 5242880
s_waitcnt lgkmcnt(0)
s_mov_b64 s[96:97], s[68:69]
s_add_u32 m0, s29, 0
s_add_u32 s26, s80, 0
buffer_load_dwordx4 v32, s[96:99], s26 offen offset:0 lds
buffer_load_dwordx4 v33, s[96:99], s26 offen offset:1024 lds
buffer_load_dwordx4 v34, s[96:99], s26 offen offset:2048 lds
buffer_load_dwordx4 v35, s[96:99], s26 offen offset:3072 lds
s_add_u32 m0, s29, 16384
s_add_u32 s26, s80, 262144
buffer_load_dwordx4 v32, s[96:99], s26 offen offset:0 lds
buffer_load_dwordx4 v33, s[96:99], s26 offen offset:1024 lds
buffer_load_dwordx4 v34, s[96:99], s26 offen offset:2048 lds
buffer_load_dwordx4 v35, s[96:99], s26 offen offset:3072 lds
s_add_u32 m0, s29, 32768
s_add_u32 s26, s80, 2097152
buffer_load_dwordx4 v32, s[96:99], s26 offen offset:0 lds
buffer_load_dwordx4 v33, s[96:99], s26 offen offset:1024 lds
buffer_load_dwordx4 v34, s[96:99], s26 offen offset:2048 lds
buffer_load_dwordx4 v35, s[96:99], s26 offen offset:3072 lds
s_waitcnt vmcnt(8)
s_barrier
s_add_u32 m0, s29, 49152
s_add_u32 s26, s80, 2359296
buffer_load_dwordx4 v32, s[96:99], s26 offen offset:0 lds
buffer_load_dwordx4 v33, s[96:99], s26 offen offset:1024 lds
buffer_load_dwordx4 v34, s[96:99], s26 offen offset:2048 lds
buffer_load_dwordx4 v35, s[96:99], s26 offen offset:3072 lds
ds_read_b64_tr_b16 v[72:73], v40 offset:0
ds_read_b64_tr_b16 v[74:75], v40 offset:512
ds_read_b64_tr_b16 v[76:77], v40 offset:8
ds_read_b64_tr_b16 v[78:79], v40 offset:520
ds_read_b64_tr_b16 a[160:161], v41 offset:0
ds_read_b64_tr_b16 a[162:163], v41 offset:512
ds_read_b64_tr_b16 v[84:85], v41 offset:8
ds_read_b64_tr_b16 v[86:87], v41 offset:520
s_waitcnt lgkmcnt(6)
global_store_dwordx4 v0, v[72:75], s[74:75] offset:0
s_waitcnt lgkmcnt(4)
global_store_dwordx4 v0, v[76:79], s[74:75] offset:2048
s_waitcnt lgkmcnt(0)
ds_write_b128 v2, v[84:87] offset:6144
s_waitcnt vmcnt(10)
s_barrier
s_add_u32 m0, s29, 0
s_add_u32 s26, s81, 0
buffer_load_dwordx4 v32, s[96:99], s26 offen offset:0 lds
buffer_load_dwordx4 v33, s[96:99], s26 offen offset:1024 lds
buffer_load_dwordx4 v34, s[96:99], s26 offen offset:2048 lds
buffer_load_dwordx4 v35, s[96:99], s26 offen offset:3072 lds
ds_read_b64_tr_b16 v[72:73], v40 offset:16384
ds_read_b64_tr_b16 v[74:75], v40 offset:16896
ds_read_b64_tr_b16 v[76:77], v40 offset:16392
ds_read_b64_tr_b16 v[78:79], v40 offset:16904
ds_read_b64_tr_b16 a[164:165], v41 offset:16384
ds_read_b64_tr_b16 a[166:167], v41 offset:16896
ds_read_b64_tr_b16 v[84:85], v41 offset:16392
ds_read_b64_tr_b16 v[86:87], v41 offset:16904
s_waitcnt lgkmcnt(6)
global_store_dwordx4 v0, v[72:75], s[74:75] offset:1024
s_waitcnt lgkmcnt(4)
global_store_dwordx4 v0, v[76:79], s[74:75] offset:3072
s_waitcnt lgkmcnt(0)
ds_write_b128 v2, v[84:87] offset:7168
s_waitcnt vmcnt(12)
s_barrier
s_add_u32 m0, s29, 16384
s_add_u32 s26, s81, 262144
buffer_load_dwordx4 v32, s[96:99], s26 offen offset:0 lds
buffer_load_dwordx4 v33, s[96:99], s26 offen offset:1024 lds
buffer_load_dwordx4 v34, s[96:99], s26 offen offset:2048 lds
buffer_load_dwordx4 v35, s[96:99], s26 offen offset:3072 lds
ds_read_b64_tr_b16 a[32:33], v40 offset:32768
ds_read_b64_tr_b16 a[34:35], v40 offset:33280
ds_read_b64_tr_b16 a[40:41], v40 offset:32776
ds_read_b64_tr_b16 a[42:43], v40 offset:33288
ds_read_b64_tr_b16 a[168:169], v41 offset:32768
ds_read_b64_tr_b16 a[170:171], v41 offset:33280
ds_read_b64_tr_b16 a[176:177], v41 offset:32776
ds_read_b64_tr_b16 a[178:179], v41 offset:33288
s_waitcnt vmcnt(12) lgkmcnt(0)
s_barrier
s_add_u32 m0, s29, 32768
s_add_u32 s26, s81, 2097152
buffer_load_dwordx4 v32, s[96:99], s26 offen offset:0 lds
buffer_load_dwordx4 v33, s[96:99], s26 offen offset:1024 lds
buffer_load_dwordx4 v34, s[96:99], s26 offen offset:2048 lds
buffer_load_dwordx4 v35, s[96:99], s26 offen offset:3072 lds
ds_read_b64_tr_b16 a[36:37], v40 offset:49152
ds_read_b64_tr_b16 a[38:39], v40 offset:49664
ds_read_b64_tr_b16 a[44:45], v40 offset:49160
ds_read_b64_tr_b16 a[46:47], v40 offset:49672
ds_read_b64_tr_b16 a[172:173], v41 offset:49152
ds_read_b64_tr_b16 a[174:175], v41 offset:49664
ds_read_b64_tr_b16 a[180:181], v41 offset:49160
ds_read_b64_tr_b16 a[182:183], v41 offset:49672
s_waitcnt vmcnt(10) lgkmcnt(0)
s_barrier
s_add_u32 m0, s29, 49152
s_add_u32 s26, s81, 2359296
buffer_load_dwordx4 v32, s[96:99], s26 offen offset:0 lds
buffer_load_dwordx4 v33, s[96:99], s26 offen offset:1024 lds
buffer_load_dwordx4 v34, s[96:99], s26 offen offset:2048 lds
buffer_load_dwordx4 v35, s[96:99], s26 offen offset:3072 lds
ds_read_b64_tr_b16 v[72:73], v40 offset:0
ds_read_b64_tr_b16 v[74:75], v40 offset:512
ds_read_b64_tr_b16 a[184:185], v40 offset:8
ds_read_b64_tr_b16 a[186:187], v40 offset:520
ds_read_b64_tr_b16 a[192:193], v41 offset:0
ds_read_b64_tr_b16 a[194:195], v41 offset:512
ds_read_b64_tr_b16 a[200:201], v41 offset:8
ds_read_b64_tr_b16 a[202:203], v41 offset:520
s_waitcnt lgkmcnt(6)
ds_write_b128 v2, v[72:75] offset:8192
s_waitcnt vmcnt(8) lgkmcnt(1)
s_barrier
s_add_u32 m0, s29, 0
s_add_u32 s26, s82, 0
buffer_load_dwordx4 v32, s[96:99], s26 offen offset:0 lds
buffer_load_dwordx4 v33, s[96:99], s26 offen offset:1024 lds
buffer_load_dwordx4 v34, s[96:99], s26 offen offset:2048 lds
buffer_load_dwordx4 v35, s[96:99], s26 offen offset:3072 lds
ds_read_b64_tr_b16 v[72:73], v40 offset:16384
ds_read_b64_tr_b16 v[74:75], v40 offset:16896
ds_read_b64_tr_b16 a[188:189], v40 offset:16392
ds_read_b64_tr_b16 a[190:191], v40 offset:16904
ds_read_b64_tr_b16 a[196:197], v41 offset:16384
ds_read_b64_tr_b16 a[198:199], v41 offset:16896
ds_read_b64_tr_b16 a[204:205], v41 offset:16392
ds_read_b64_tr_b16 a[206:207], v41 offset:16904
s_waitcnt lgkmcnt(6)
ds_write_b128 v2, v[72:75] offset:9216
s_waitcnt vmcnt(8) lgkmcnt(1)
s_barrier
s_add_u32 m0, s29, 16384
s_add_u32 s26, s82, 262144
buffer_load_dwordx4 v32, s[96:99], s26 offen offset:0 lds
buffer_load_dwordx4 v33, s[96:99], s26 offen offset:1024 lds
buffer_load_dwordx4 v34, s[96:99], s26 offen offset:2048 lds
buffer_load_dwordx4 v35, s[96:99], s26 offen offset:3072 lds
ds_read_b64_tr_b16 v[72:73], v40 offset:32768
ds_read_b64_tr_b16 v[74:75], v40 offset:33280
ds_read_b64_tr_b16 v[76:77], v40 offset:32776
ds_read_b64_tr_b16 v[78:79], v40 offset:33288
ds_read_b64_tr_b16 v[80:81], v41 offset:32768
ds_read_b64_tr_b16 v[82:83], v41 offset:33280
ds_read_b64_tr_b16 a[208:209], v41 offset:32776
ds_read_b64_tr_b16 a[210:211], v41 offset:33288
s_waitcnt lgkmcnt(6)
global_store_dwordx4 v0, v[72:75], s[76:77] offset:-2048
s_waitcnt lgkmcnt(4)
ds_write_b128 v2, v[76:79] offset:10240
s_waitcnt lgkmcnt(3)
ds_write_b128 v2, v[80:83] offset:12288
s_waitcnt vmcnt(9) lgkmcnt(2)
s_barrier
s_mov_b64 s[96:97], s[70:71]
s_add_u32 m0, s29, 32768
s_add_u32 s26, s80, 0
buffer_load_dwordx4 v32, s[96:99], s26 offen offset:0 lds
buffer_load_dwordx4 v33, s[96:99], s26 offen offset:1024 lds
buffer_load_dwordx4 v34, s[96:99], s26 offen offset:2048 lds
buffer_load_dwordx4 v35, s[96:99], s26 offen offset:3072 lds
ds_read_b64_tr_b16 v[72:73], v40 offset:49152
ds_read_b64_tr_b16 v[74:75], v40 offset:49664
ds_read_b64_tr_b16 v[76:77], v40 offset:49160
ds_read_b64_tr_b16 v[78:79], v40 offset:49672
ds_read_b64_tr_b16 v[80:81], v41 offset:49152
ds_read_b64_tr_b16 v[82:83], v41 offset:49664
ds_read_b64_tr_b16 a[212:213], v41 offset:49160
ds_read_b64_tr_b16 a[214:215], v41 offset:49672
s_waitcnt lgkmcnt(6)
global_store_dwordx4 v0, v[72:75], s[76:77] offset:-1024
s_waitcnt lgkmcnt(4)
ds_write_b128 v2, v[76:79] offset:11264
s_waitcnt lgkmcnt(3)
ds_write_b128 v2, v[80:83] offset:13312
s_waitcnt vmcnt(10) lgkmcnt(2)
s_barrier
s_add_u32 m0, s29, 49152
s_add_u32 s26, s80, 262144
buffer_load_dwordx4 v32, s[96:99], s26 offen offset:0 lds
buffer_load_dwordx4 v33, s[96:99], s26 offen offset:1024 lds
buffer_load_dwordx4 v34, s[96:99], s26 offen offset:2048 lds
buffer_load_dwordx4 v35, s[96:99], s26 offen offset:3072 lds
ds_read_b64_tr_b16 v[72:73], v40 offset:0
ds_read_b64_tr_b16 v[74:75], v40 offset:512
ds_read_b64_tr_b16 a[216:217], v40 offset:8
ds_read_b64_tr_b16 a[218:219], v40 offset:520
ds_read_b64_tr_b16 a[224:225], v41 offset:0
ds_read_b64_tr_b16 a[226:227], v41 offset:512
ds_read_b64_tr_b16 v[84:85], v41 offset:8
ds_read_b64_tr_b16 v[86:87], v41 offset:520
s_waitcnt lgkmcnt(6)
ds_write_b128 v2, v[72:75] offset:14336
s_waitcnt lgkmcnt(1)
ds_write_b128 v2, v[84:87] offset:16384
s_waitcnt vmcnt(10)
s_barrier
s_add_u32 m0, s29, 0
s_add_u32 s26, s80, 2097152
buffer_load_dwordx4 v32, s[96:99], s26 offen offset:0 lds
buffer_load_dwordx4 v33, s[96:99], s26 offen offset:1024 lds
buffer_load_dwordx4 v34, s[96:99], s26 offen offset:2048 lds
buffer_load_dwordx4 v35, s[96:99], s26 offen offset:3072 lds
ds_read_b64_tr_b16 v[72:73], v40 offset:16384
ds_read_b64_tr_b16 v[74:75], v40 offset:16896
ds_read_b64_tr_b16 a[220:221], v40 offset:16392
ds_read_b64_tr_b16 a[222:223], v40 offset:16904
ds_read_b64_tr_b16 a[228:229], v41 offset:16384
ds_read_b64_tr_b16 a[230:231], v41 offset:16896
ds_read_b64_tr_b16 v[84:85], v41 offset:16392
ds_read_b64_tr_b16 v[86:87], v41 offset:16904
s_waitcnt lgkmcnt(6)
ds_write_b128 v2, v[72:75] offset:15360
s_waitcnt lgkmcnt(1)
ds_write_b128 v2, v[84:87] offset:17408
s_waitcnt vmcnt(9)
s_barrier
s_add_u32 m0, s29, 16384
s_add_u32 s26, s80, 2359296
buffer_load_dwordx4 v32, s[96:99], s26 offen offset:0 lds
buffer_load_dwordx4 v33, s[96:99], s26 offen offset:1024 lds
buffer_load_dwordx4 v34, s[96:99], s26 offen offset:2048 lds
buffer_load_dwordx4 v35, s[96:99], s26 offen offset:3072 lds
ds_read_b64_tr_b16 a[0:1], v40 offset:32768
ds_read_b64_tr_b16 a[2:3], v40 offset:33280
ds_read_b64_tr_b16 a[8:9], v40 offset:32776
ds_read_b64_tr_b16 a[10:11], v40 offset:33288
ds_read_b64_tr_b16 a[248:249], v41 offset:32768
ds_read_b64_tr_b16 a[250:251], v41 offset:33280
ds_read_b64_tr_b16 v[88:89], v41 offset:32776
ds_read_b64_tr_b16 v[90:91], v41 offset:33288
s_waitcnt vmcnt(8) lgkmcnt(0)
s_barrier
s_add_u32 m0, s29, 32768
s_add_u32 s26, s81, 0
buffer_load_dwordx4 v32, s[96:99], s26 offen offset:0 lds
buffer_load_dwordx4 v33, s[96:99], s26 offen offset:1024 lds
buffer_load_dwordx4 v34, s[96:99], s26 offen offset:2048 lds
buffer_load_dwordx4 v35, s[96:99], s26 offen offset:3072 lds
ds_read_b64_tr_b16 a[4:5], v40 offset:49152
ds_read_b64_tr_b16 a[6:7], v40 offset:49664
ds_read_b64_tr_b16 a[12:13], v40 offset:49160
ds_read_b64_tr_b16 a[14:15], v40 offset:49672
ds_read_b64_tr_b16 a[252:253], v41 offset:49152
ds_read_b64_tr_b16 a[254:255], v41 offset:49664
ds_read_b64_tr_b16 v[92:93], v41 offset:49160
ds_read_b64_tr_b16 v[94:95], v41 offset:49672
s_waitcnt vmcnt(8) lgkmcnt(0)
s_barrier
s_add_u32 m0, s29, 49152
s_add_u32 s26, s81, 262144
buffer_load_dwordx4 v32, s[96:99], s26 offen offset:0 lds
buffer_load_dwordx4 v33, s[96:99], s26 offen offset:1024 lds
buffer_load_dwordx4 v34, s[96:99], s26 offen offset:2048 lds
buffer_load_dwordx4 v35, s[96:99], s26 offen offset:3072 lds
ds_read_b64_tr_b16 a[48:49], v40 offset:0
ds_read_b64_tr_b16 a[50:51], v40 offset:512
ds_read_b64_tr_b16 v[76:77], v40 offset:8
ds_read_b64_tr_b16 v[78:79], v40 offset:520
ds_read_b64_tr_b16 v[80:81], v41 offset:0
ds_read_b64_tr_b16 v[82:83], v41 offset:512
ds_read_b64_tr_b16 v[96:97], v41 offset:8
ds_read_b64_tr_b16 v[98:99], v41 offset:520
s_waitcnt lgkmcnt(4)
ds_write_b128 v2, v[76:79] offset:0
s_waitcnt lgkmcnt(3)
ds_write_b128 v2, v[80:83] offset:22528
s_waitcnt vmcnt(8) lgkmcnt(2)
s_barrier
s_add_u32 m0, s29, 0
s_add_u32 s26, s81, 2097152
buffer_load_dwordx4 v32, s[96:99], s26 offen offset:0 lds
buffer_load_dwordx4 v33, s[96:99], s26 offen offset:1024 lds
buffer_load_dwordx4 v34, s[96:99], s26 offen offset:2048 lds
buffer_load_dwordx4 v35, s[96:99], s26 offen offset:3072 lds
ds_read_b64_tr_b16 a[52:53], v40 offset:16384
ds_read_b64_tr_b16 a[54:55], v40 offset:16896
ds_read_b64_tr_b16 v[76:77], v40 offset:16392
ds_read_b64_tr_b16 v[78:79], v40 offset:16904
ds_read_b64_tr_b16 v[80:81], v41 offset:16384
ds_read_b64_tr_b16 v[82:83], v41 offset:16896
ds_read_b64_tr_b16 v[100:101], v41 offset:16392
ds_read_b64_tr_b16 v[102:103], v41 offset:16904
s_waitcnt lgkmcnt(4)
ds_write_b128 v2, v[76:79] offset:1024
s_waitcnt lgkmcnt(3)
ds_write_b128 v2, v[80:83] offset:23552
s_waitcnt vmcnt(8) lgkmcnt(2)
s_barrier
s_add_u32 m0, s29, 16384
s_add_u32 s26, s81, 2359296
buffer_load_dwordx4 v32, s[96:99], s26 offen offset:0 lds
buffer_load_dwordx4 v33, s[96:99], s26 offen offset:1024 lds
buffer_load_dwordx4 v34, s[96:99], s26 offen offset:2048 lds
buffer_load_dwordx4 v35, s[96:99], s26 offen offset:3072 lds
ds_read_b64_tr_b16 v[104:105], v40 offset:32768
ds_read_b64_tr_b16 v[106:107], v40 offset:33280
ds_read_b64_tr_b16 v[112:113], v40 offset:32776
ds_read_b64_tr_b16 v[114:115], v40 offset:33288
ds_read_b64_tr_b16 v[136:137], v41 offset:32768
ds_read_b64_tr_b16 v[138:139], v41 offset:33280
ds_read_b64_tr_b16 v[144:145], v41 offset:32776
ds_read_b64_tr_b16 v[146:147], v41 offset:33288
s_waitcnt vmcnt(8) lgkmcnt(0)
s_barrier
s_add_u32 m0, s29, 32768
s_add_u32 s26, s82, 0
buffer_load_dwordx4 v32, s[96:99], s26 offen offset:0 lds
buffer_load_dwordx4 v33, s[96:99], s26 offen offset:1024 lds
buffer_load_dwordx4 v34, s[96:99], s26 offen offset:2048 lds
buffer_load_dwordx4 v35, s[96:99], s26 offen offset:3072 lds
ds_read_b64_tr_b16 v[108:109], v40 offset:49152
ds_read_b64_tr_b16 v[110:111], v40 offset:49664
ds_read_b64_tr_b16 v[116:117], v40 offset:49160
ds_read_b64_tr_b16 v[118:119], v40 offset:49672
ds_read_b64_tr_b16 v[140:141], v41 offset:49152
ds_read_b64_tr_b16 v[142:143], v41 offset:49664
ds_read_b64_tr_b16 v[148:149], v41 offset:49160
ds_read_b64_tr_b16 v[150:151], v41 offset:49672
s_waitcnt vmcnt(8) lgkmcnt(0)
s_barrier
s_add_u32 m0, s29, 49152
s_add_u32 s26, s82, 262144
buffer_load_dwordx4 v32, s[96:99], s26 offen offset:0 lds
buffer_load_dwordx4 v33, s[96:99], s26 offen offset:1024 lds
buffer_load_dwordx4 v34, s[96:99], s26 offen offset:2048 lds
buffer_load_dwordx4 v35, s[96:99], s26 offen offset:3072 lds
ds_read_b64_tr_b16 v[120:121], v40 offset:0
ds_read_b64_tr_b16 v[122:123], v40 offset:512
ds_read_b64_tr_b16 v[128:129], v40 offset:8
ds_read_b64_tr_b16 v[130:131], v40 offset:520
ds_read_b64_tr_b16 v[152:153], v41 offset:0
ds_read_b64_tr_b16 v[154:155], v41 offset:512
ds_read_b64_tr_b16 v[160:161], v41 offset:8
ds_read_b64_tr_b16 v[162:163], v41 offset:520
s_waitcnt vmcnt(8) lgkmcnt(0)
s_barrier
s_mov_b64 s[96:97], s[66:67]
s_add_u32 m0, s29, 0
s_add_u32 s26, s80, 0
buffer_load_dwordx4 v32, s[96:99], s26 offen offset:0 lds
buffer_load_dwordx4 v33, s[96:99], s26 offen offset:1024 lds
buffer_load_dwordx4 v34, s[96:99], s26 offen offset:2048 lds
buffer_load_dwordx4 v35, s[96:99], s26 offen offset:3072 lds
ds_read_b64_tr_b16 v[124:125], v40 offset:16384
ds_read_b64_tr_b16 v[126:127], v40 offset:16896
ds_read_b64_tr_b16 v[132:133], v40 offset:16392
ds_read_b64_tr_b16 v[134:135], v40 offset:16904
ds_read_b64_tr_b16 v[156:157], v41 offset:16384
ds_read_b64_tr_b16 v[158:159], v41 offset:16896
ds_read_b64_tr_b16 v[164:165], v41 offset:16392
ds_read_b64_tr_b16 v[166:167], v41 offset:16904
s_waitcnt vmcnt(8) lgkmcnt(0)
s_barrier
s_add_u32 m0, s29, 16384
s_add_u32 s26, s80, 262144
buffer_load_dwordx4 v32, s[96:99], s26 offen offset:0 lds
buffer_load_dwordx4 v33, s[96:99], s26 offen offset:1024 lds
buffer_load_dwordx4 v34, s[96:99], s26 offen offset:2048 lds
buffer_load_dwordx4 v35, s[96:99], s26 offen offset:3072 lds
ds_read_b64_tr_b16 v[72:73], v40 offset:32768
ds_read_b64_tr_b16 v[74:75], v40 offset:33280
ds_read_b64_tr_b16 a[232:233], v40 offset:32776
ds_read_b64_tr_b16 a[234:235], v40 offset:33288
ds_read_b64_tr_b16 a[240:241], v41 offset:32768
ds_read_b64_tr_b16 a[242:243], v41 offset:33280
ds_read_b64_tr_b16 v[84:85], v41 offset:32776
ds_read_b64_tr_b16 v[86:87], v41 offset:33288
s_waitcnt lgkmcnt(6)
ds_write_b128 v2, v[72:75] offset:18432
s_waitcnt lgkmcnt(1)
ds_write_b128 v2, v[84:87] offset:20480
s_waitcnt vmcnt(8)
s_barrier
s_add_u32 m0, s29, 32768
s_add_u32 s26, s80, 2097152
buffer_load_dwordx4 v32, s[96:99], s26 offen offset:0 lds
buffer_load_dwordx4 v33, s[96:99], s26 offen offset:1024 lds
buffer_load_dwordx4 v34, s[96:99], s26 offen offset:2048 lds
buffer_load_dwordx4 v35, s[96:99], s26 offen offset:3072 lds
ds_read_b64_tr_b16 v[72:73], v40 offset:49152
ds_read_b64_tr_b16 v[74:75], v40 offset:49664
ds_read_b64_tr_b16 a[236:237], v40 offset:49160
ds_read_b64_tr_b16 a[238:239], v40 offset:49672
ds_read_b64_tr_b16 a[244:245], v41 offset:49152
ds_read_b64_tr_b16 a[246:247], v41 offset:49664
ds_read_b64_tr_b16 v[84:85], v41 offset:49160
ds_read_b64_tr_b16 v[86:87], v41 offset:49672
s_waitcnt lgkmcnt(6)
ds_write_b128 v2, v[72:75] offset:19456
s_waitcnt lgkmcnt(1)
ds_write_b128 v2, v[84:87] offset:21504
s_waitcnt vmcnt(8)
s_barrier
s_add_u32 m0, s29, 49152
s_add_u32 s26, s80, 2359296
buffer_load_dwordx4 v32, s[96:99], s26 offen offset:0 lds
buffer_load_dwordx4 v33, s[96:99], s26 offen offset:1024 lds
buffer_load_dwordx4 v34, s[96:99], s26 offen offset:2048 lds
buffer_load_dwordx4 v35, s[96:99], s26 offen offset:3072 lds
ds_read_b64_tr_b16 v[72:73], v40 offset:0
ds_read_b64_tr_b16 v[74:75], v40 offset:512
ds_read_b64_tr_b16 v[76:77], v40 offset:8
ds_read_b64_tr_b16 v[78:79], v40 offset:520
ds_read_b64_tr_b16 a[56:57], v41 offset:0
ds_read_b64_tr_b16 a[58:59], v41 offset:512
ds_read_b64_tr_b16 a[64:65], v41 offset:8
ds_read_b64_tr_b16 a[66:67], v41 offset:520
s_waitcnt lgkmcnt(6)
global_store_dwordx4 v0, v[72:75], s[74:75] offset:-4096
s_waitcnt lgkmcnt(4)
global_store_dwordx4 v0, v[76:79], s[74:75] offset:-2048
s_waitcnt vmcnt(10) lgkmcnt(0)
s_barrier
s_add_u32 m0, s29, 0
s_add_u32 s26, s81, 0
buffer_load_dwordx4 v32, s[96:99], s26 offen offset:0 lds
buffer_load_dwordx4 v33, s[96:99], s26 offen offset:1024 lds
buffer_load_dwordx4 v34, s[96:99], s26 offen offset:2048 lds
buffer_load_dwordx4 v35, s[96:99], s26 offen offset:3072 lds
ds_read_b64_tr_b16 v[72:73], v40 offset:16384
ds_read_b64_tr_b16 v[74:75], v40 offset:16896
ds_read_b64_tr_b16 v[76:77], v40 offset:16392
ds_read_b64_tr_b16 v[78:79], v40 offset:16904
ds_read_b64_tr_b16 a[60:61], v41 offset:16384
ds_read_b64_tr_b16 a[62:63], v41 offset:16896
ds_read_b64_tr_b16 a[68:69], v41 offset:16392
ds_read_b64_tr_b16 a[70:71], v41 offset:16904
s_waitcnt lgkmcnt(6)
global_store_dwordx4 v0, v[72:75], s[74:75] offset:-3072
s_waitcnt lgkmcnt(4)
global_store_dwordx4 v0, v[76:79], s[74:75] offset:-1024
s_waitcnt vmcnt(12) lgkmcnt(0)
s_barrier
s_add_u32 m0, s29, 16384
s_add_u32 s26, s81, 262144
buffer_load_dwordx4 v32, s[96:99], s26 offen offset:0 lds
buffer_load_dwordx4 v33, s[96:99], s26 offen offset:1024 lds
buffer_load_dwordx4 v34, s[96:99], s26 offen offset:2048 lds
buffer_load_dwordx4 v35, s[96:99], s26 offen offset:3072 lds
ds_read_b64_tr_b16 a[16:17], v40 offset:32768
ds_read_b64_tr_b16 a[18:19], v40 offset:33280
ds_read_b64_tr_b16 a[24:25], v40 offset:32776
ds_read_b64_tr_b16 a[26:27], v40 offset:33288
ds_read_b64_tr_b16 a[72:73], v41 offset:32768
ds_read_b64_tr_b16 a[74:75], v41 offset:33280
ds_read_b64_tr_b16 a[80:81], v41 offset:32776
ds_read_b64_tr_b16 a[82:83], v41 offset:33288
s_waitcnt vmcnt(12) lgkmcnt(0)
s_barrier
s_add_u32 m0, s29, 32768
s_add_u32 s26, s81, 2097152
buffer_load_dwordx4 v32, s[96:99], s26 offen offset:0 lds
buffer_load_dwordx4 v33, s[96:99], s26 offen offset:1024 lds
buffer_load_dwordx4 v34, s[96:99], s26 offen offset:2048 lds
buffer_load_dwordx4 v35, s[96:99], s26 offen offset:3072 lds
ds_read_b64_tr_b16 a[20:21], v40 offset:49152
ds_read_b64_tr_b16 a[22:23], v40 offset:49664
ds_read_b64_tr_b16 a[28:29], v40 offset:49160
ds_read_b64_tr_b16 a[30:31], v40 offset:49672
ds_read_b64_tr_b16 a[76:77], v41 offset:49152
ds_read_b64_tr_b16 a[78:79], v41 offset:49664
ds_read_b64_tr_b16 a[84:85], v41 offset:49160
ds_read_b64_tr_b16 a[86:87], v41 offset:49672
s_waitcnt vmcnt(10) lgkmcnt(0)
s_barrier
s_add_u32 m0, s29, 49152
s_add_u32 s26, s81, 2359296
buffer_load_dwordx4 v32, s[96:99], s26 offen offset:0 lds
buffer_load_dwordx4 v33, s[96:99], s26 offen offset:1024 lds
buffer_load_dwordx4 v34, s[96:99], s26 offen offset:2048 lds
buffer_load_dwordx4 v35, s[96:99], s26 offen offset:3072 lds
ds_read_b64_tr_b16 a[88:89], v40 offset:0
ds_read_b64_tr_b16 a[90:91], v40 offset:512
ds_read_b64_tr_b16 v[76:77], v40 offset:8
ds_read_b64_tr_b16 v[78:79], v40 offset:520
ds_read_b64_tr_b16 a[112:113], v41 offset:0
ds_read_b64_tr_b16 a[114:115], v41 offset:512
ds_read_b64_tr_b16 a[120:121], v41 offset:8
ds_read_b64_tr_b16 a[122:123], v41 offset:520
s_waitcnt lgkmcnt(4)
ds_write_b128 v2, v[76:79] offset:2048
s_waitcnt vmcnt(8) lgkmcnt(1)
s_barrier
s_add_u32 m0, s29, 0
s_add_u32 s26, s82, 0
buffer_load_dwordx4 v32, s[96:99], s26 offen offset:0 lds
buffer_load_dwordx4 v33, s[96:99], s26 offen offset:1024 lds
buffer_load_dwordx4 v34, s[96:99], s26 offen offset:2048 lds
buffer_load_dwordx4 v35, s[96:99], s26 offen offset:3072 lds
ds_read_b64_tr_b16 a[92:93], v40 offset:16384
ds_read_b64_tr_b16 a[94:95], v40 offset:16896
ds_read_b64_tr_b16 v[76:77], v40 offset:16392
ds_read_b64_tr_b16 v[78:79], v40 offset:16904
ds_read_b64_tr_b16 a[116:117], v41 offset:16384
ds_read_b64_tr_b16 a[118:119], v41 offset:16896
ds_read_b64_tr_b16 a[124:125], v41 offset:16392
ds_read_b64_tr_b16 a[126:127], v41 offset:16904
s_waitcnt lgkmcnt(4)
ds_write_b128 v2, v[76:79] offset:3072
s_waitcnt vmcnt(8) lgkmcnt(1)
s_barrier
s_add_u32 m0, s29, 16384
s_add_u32 s26, s82, 262144
buffer_load_dwordx4 v32, s[96:99], s26 offen offset:0 lds
buffer_load_dwordx4 v33, s[96:99], s26 offen offset:1024 lds
buffer_load_dwordx4 v34, s[96:99], s26 offen offset:2048 lds
buffer_load_dwordx4 v35, s[96:99], s26 offen offset:3072 lds
ds_read_b64_tr_b16 a[96:97], v40 offset:32768
ds_read_b64_tr_b16 a[98:99], v40 offset:33280
ds_read_b64_tr_b16 a[104:105], v40 offset:32776
ds_read_b64_tr_b16 a[106:107], v40 offset:33288
ds_read_b64_tr_b16 a[128:129], v41 offset:32768
ds_read_b64_tr_b16 a[130:131], v41 offset:33280
ds_read_b64_tr_b16 v[84:85], v41 offset:32776
ds_read_b64_tr_b16 v[86:87], v41 offset:33288
s_waitcnt lgkmcnt(0)
ds_write_b128 v2, v[84:87] offset:4096
s_waitcnt vmcnt(8)
s_barrier
s_mov_b64 s[96:97], s[72:73]
s_add_u32 m0, s29, 32768
s_add_u32 s26, s83, 0
buffer_load_dwordx4 v36, s[96:99], s26 offen offset:0 lds
buffer_load_dwordx4 v37, s[96:99], s26 offen offset:1024 lds
buffer_load_dwordx4 v38, s[96:99], s26 offen offset:2048 lds
buffer_load_dwordx4 v39, s[96:99], s26 offen offset:3072 lds
ds_read_b64_tr_b16 a[100:101], v40 offset:49152
ds_read_b64_tr_b16 a[102:103], v40 offset:49664
ds_read_b64_tr_b16 a[108:109], v40 offset:49160
ds_read_b64_tr_b16 a[110:111], v40 offset:49672
ds_read_b64_tr_b16 a[132:133], v41 offset:49152
ds_read_b64_tr_b16 a[134:135], v41 offset:49664
ds_read_b64_tr_b16 v[84:85], v41 offset:49160
ds_read_b64_tr_b16 v[86:87], v41 offset:49672
s_waitcnt lgkmcnt(0)
ds_write_b128 v2, v[84:87] offset:5120
s_waitcnt vmcnt(8)
s_barrier
s_add_u32 m0, s29, 49152
s_add_u32 s26, s84, 0
buffer_load_dwordx4 v36, s[96:99], s26 offen offset:0 lds
buffer_load_dwordx4 v37, s[96:99], s26 offen offset:1024 lds
buffer_load_dwordx4 v38, s[96:99], s26 offen offset:2048 lds
buffer_load_dwordx4 v39, s[96:99], s26 offen offset:3072 lds
ds_read_b64_tr_b16 a[136:137], v40 offset:0
ds_read_b64_tr_b16 a[138:139], v40 offset:512
ds_read_b64_tr_b16 a[144:145], v40 offset:8
ds_read_b64_tr_b16 a[146:147], v40 offset:520
ds_read_b64_tr_b16 v[80:81], v41 offset:0
ds_read_b64_tr_b16 v[82:83], v41 offset:512
ds_read_b64_tr_b16 a[152:153], v41 offset:8
ds_read_b64_tr_b16 a[154:155], v41 offset:520
s_waitcnt lgkmcnt(2)
global_store_dwordx4 v0, v[80:83], s[76:77] offset:-4096
s_waitcnt vmcnt(9) lgkmcnt(0)
s_barrier
s_add_u32 m0, s29, 0
s_add_u32 s26, s83, 256
buffer_load_dwordx4 v36, s[96:99], s26 offen offset:0 lds
buffer_load_dwordx4 v37, s[96:99], s26 offen offset:1024 lds
buffer_load_dwordx4 v38, s[96:99], s26 offen offset:2048 lds
buffer_load_dwordx4 v39, s[96:99], s26 offen offset:3072 lds
ds_read_b64_tr_b16 a[140:141], v40 offset:16384
ds_read_b64_tr_b16 a[142:143], v40 offset:16896
ds_read_b64_tr_b16 a[148:149], v40 offset:16392
ds_read_b64_tr_b16 a[150:151], v40 offset:16904
ds_read_b64_tr_b16 v[80:81], v41 offset:16384
ds_read_b64_tr_b16 v[82:83], v41 offset:16896
ds_read_b64_tr_b16 a[156:157], v41 offset:16392
ds_read_b64_tr_b16 a[158:159], v41 offset:16904
s_waitcnt lgkmcnt(2)
global_store_dwordx4 v0, v[80:83], s[76:77] offset:-3072
s_waitcnt vmcnt(10) lgkmcnt(0)
s_barrier
s_add_u32 m0, s29, 16384
s_add_u32 s26, s84, 256
buffer_load_dwordx4 v36, s[96:99], s26 offen offset:0 lds
buffer_load_dwordx4 v37, s[96:99], s26 offen offset:1024 lds
buffer_load_dwordx4 v38, s[96:99], s26 offen offset:2048 lds
buffer_load_dwordx4 v39, s[96:99], s26 offen offset:3072 lds
ds_read_b64_tr_b16 v[72:73], v42 offset:32768
ds_read_b64_tr_b16 v[74:75], v42 offset:33024
ds_read_b64_tr_b16 v[76:77], v42 offset:34816
ds_read_b64_tr_b16 v[78:79], v42 offset:35072
ds_read_b64_tr_b16 v[8:9], v43 offset:32768
ds_read_b64_tr_b16 v[10:11], v43 offset:33024
ds_read_b64_tr_b16 v[12:13], v43 offset:34816
ds_read_b64_tr_b16 v[14:15], v43 offset:35072
s_waitcnt lgkmcnt(6)
global_store_dwordx4 v0, v[72:75], s[76:77] offset:0
s_waitcnt lgkmcnt(4)
global_store_dwordx4 v0, v[76:79], s[76:77] offset:1024
s_waitcnt vmcnt(12) lgkmcnt(0)
s_barrier
s_add_u32 m0, s29, 32768
s_add_u32 s26, s83, 512
buffer_load_dwordx4 v36, s[96:99], s26 offen offset:0 lds
buffer_load_dwordx4 v37, s[96:99], s26 offen offset:1024 lds
buffer_load_dwordx4 v38, s[96:99], s26 offen offset:2048 lds
buffer_load_dwordx4 v39, s[96:99], s26 offen offset:3072 lds
ds_read_b64_tr_b16 v[16:17], v42 offset:49152
ds_read_b64_tr_b16 v[18:19], v42 offset:49408
ds_read_b64_tr_b16 v[20:21], v42 offset:51200
ds_read_b64_tr_b16 v[22:23], v42 offset:51456
ds_read_b64_tr_b16 v[184:185], v43 offset:49152
ds_read_b64_tr_b16 v[186:187], v43 offset:49408
ds_read_b64_tr_b16 v[188:189], v43 offset:51200
ds_read_b64_tr_b16 v[190:191], v43 offset:51456
s_waitcnt vmcnt(11) lgkmcnt(0)
s_barrier
s_add_u32 m0, s29, 49152
s_add_u32 s26, s84, 512
buffer_load_dwordx4 v36, s[96:99], s26 offen offset:0 lds
buffer_load_dwordx4 v37, s[96:99], s26 offen offset:1024 lds
buffer_load_dwordx4 v38, s[96:99], s26 offen offset:2048 lds
buffer_load_dwordx4 v39, s[96:99], s26 offen offset:3072 lds
ds_read_b64_tr_b16 v[72:73], v42 offset:0
ds_read_b64_tr_b16 v[74:75], v42 offset:256
ds_read_b64_tr_b16 v[76:77], v42 offset:2048
ds_read_b64_tr_b16 v[78:79], v42 offset:2304
ds_read_b64_tr_b16 v[192:193], v43 offset:0
ds_read_b64_tr_b16 v[194:195], v43 offset:256
ds_read_b64_tr_b16 v[196:197], v43 offset:2048
ds_read_b64_tr_b16 v[198:199], v43 offset:2304
s_waitcnt lgkmcnt(6)
global_store_dwordx4 v0, v[72:75], s[76:77] offset:2048
s_waitcnt lgkmcnt(4)
global_store_dwordx4 v0, v[76:79], s[76:77] offset:3072
s_waitcnt vmcnt(12) lgkmcnt(0)
s_barrier
s_add_u32 m0, s29, 0
s_add_u32 s26, s83, 768
buffer_load_dwordx4 v36, s[96:99], s26 offen offset:0 lds
buffer_load_dwordx4 v37, s[96:99], s26 offen offset:1024 lds
buffer_load_dwordx4 v38, s[96:99], s26 offen offset:2048 lds
buffer_load_dwordx4 v39, s[96:99], s26 offen offset:3072 lds
ds_read_b64_tr_b16 v[24:25], v42 offset:16384
ds_read_b64_tr_b16 v[26:27], v42 offset:16640
ds_read_b64_tr_b16 v[28:29], v42 offset:18432
ds_read_b64_tr_b16 v[30:31], v42 offset:18688
ds_read_b64_tr_b16 v[200:201], v43 offset:16384
ds_read_b64_tr_b16 v[202:203], v43 offset:16640
ds_read_b64_tr_b16 v[204:205], v43 offset:18432
ds_read_b64_tr_b16 v[206:207], v43 offset:18688
s_waitcnt vmcnt(10) lgkmcnt(0)
s_barrier
s_add_u32 m0, s29, 16384
s_add_u32 s26, s84, 768
buffer_load_dwordx4 v36, s[96:99], s26 offen offset:0 lds
buffer_load_dwordx4 v37, s[96:99], s26 offen offset:1024 lds
buffer_load_dwordx4 v38, s[96:99], s26 offen offset:2048 lds
buffer_load_dwordx4 v39, s[96:99], s26 offen offset:3072 lds
ds_read_b64_tr_b16 v[168:169], v42 offset:32768
ds_read_b64_tr_b16 v[170:171], v42 offset:33024
ds_read_b64_tr_b16 v[172:173], v42 offset:34816
ds_read_b64_tr_b16 v[174:175], v42 offset:35072
ds_read_b64_tr_b16 v[48:49], v43 offset:32768
ds_read_b64_tr_b16 v[50:51], v43 offset:33024
ds_read_b64_tr_b16 v[52:53], v43 offset:34816
ds_read_b64_tr_b16 v[54:55], v43 offset:35072
s_waitcnt vmcnt(10) lgkmcnt(0)
s_barrier
s_add_u32 m0, s29, 32768
s_add_u32 s26, s83, 1024
buffer_load_dwordx4 v36, s[96:99], s26 offen offset:0 lds
buffer_load_dwordx4 v37, s[96:99], s26 offen offset:1024 lds
buffer_load_dwordx4 v38, s[96:99], s26 offen offset:2048 lds
buffer_load_dwordx4 v39, s[96:99], s26 offen offset:3072 lds
ds_read_b64_tr_b16 v[56:57], v42 offset:49152
ds_read_b64_tr_b16 v[58:59], v42 offset:49408
ds_read_b64_tr_b16 v[60:61], v42 offset:51200
ds_read_b64_tr_b16 v[62:63], v42 offset:51456
ds_read_b64_tr_b16 v[208:209], v43 offset:49152
ds_read_b64_tr_b16 v[210:211], v43 offset:49408
ds_read_b64_tr_b16 v[212:213], v43 offset:51200
ds_read_b64_tr_b16 v[214:215], v43 offset:51456
s_waitcnt vmcnt(8) lgkmcnt(0)
s_barrier
s_add_u32 m0, s29, 49152
s_add_u32 s26, s84, 1024
buffer_load_dwordx4 v36, s[96:99], s26 offen offset:0 lds
buffer_load_dwordx4 v37, s[96:99], s26 offen offset:1024 lds
buffer_load_dwordx4 v38, s[96:99], s26 offen offset:2048 lds
buffer_load_dwordx4 v39, s[96:99], s26 offen offset:3072 lds
ds_read_b64_tr_b16 v[176:177], v42 offset:0
ds_read_b64_tr_b16 v[178:179], v42 offset:256
ds_read_b64_tr_b16 v[180:181], v42 offset:2048
ds_read_b64_tr_b16 v[182:183], v42 offset:2304
ds_read_b64_tr_b16 v[216:217], v43 offset:0
ds_read_b64_tr_b16 v[218:219], v43 offset:256
ds_read_b64_tr_b16 v[220:221], v43 offset:2048
ds_read_b64_tr_b16 v[222:223], v43 offset:2304
s_waitcnt vmcnt(8) lgkmcnt(0)
s_barrier
ds_read_b64_tr_b16 v[64:65], v42 offset:16384
ds_read_b64_tr_b16 v[66:67], v42 offset:16640
ds_read_b64_tr_b16 v[68:69], v42 offset:18432
ds_read_b64_tr_b16 v[70:71], v42 offset:18688
ds_read_b64_tr_b16 v[224:225], v43 offset:16384
ds_read_b64_tr_b16 v[226:227], v43 offset:16640
ds_read_b64_tr_b16 v[228:229], v43 offset:18432
ds_read_b64_tr_b16 v[230:231], v43 offset:18688
s_waitcnt vmcnt(4) lgkmcnt(0)
s_barrier
ds_read_b64_tr_b16 v[72:73], v42 offset:32768
ds_read_b64_tr_b16 v[74:75], v42 offset:33024
ds_read_b64_tr_b16 v[76:77], v42 offset:34816
ds_read_b64_tr_b16 v[78:79], v42 offset:35072
ds_read_b64_tr_b16 v[232:233], v43 offset:32768
ds_read_b64_tr_b16 v[234:235], v43 offset:33024
ds_read_b64_tr_b16 v[236:237], v43 offset:34816
ds_read_b64_tr_b16 v[238:239], v43 offset:35072
s_waitcnt lgkmcnt(6)
global_store_dwordx4 v0, v[72:75], s[78:79] offset:-4096
s_waitcnt lgkmcnt(4)
global_store_dwordx4 v0, v[76:79], s[78:79] offset:-3072
s_waitcnt vmcnt(2) lgkmcnt(0)
s_barrier
ds_read_b64_tr_b16 v[240:241], v42 offset:49152
ds_read_b64_tr_b16 v[242:243], v42 offset:49408
ds_read_b64_tr_b16 v[244:245], v42 offset:51200
ds_read_b64_tr_b16 v[246:247], v42 offset:51456
ds_read_b64_tr_b16 v[248:249], v43 offset:49152
ds_read_b64_tr_b16 v[250:251], v43 offset:49408
ds_read_b64_tr_b16 v[252:253], v43 offset:51200
ds_read_b64_tr_b16 v[254:255], v43 offset:51456
s_waitcnt lgkmcnt(0)
s_barrier
s_mul_i32 s26, s13, 12288
v_add_u32 v44, s26, v0
ds_write_b128 v44, v[8:11] offset:16384
ds_write_b128 v44, v[12:15] offset:17408
ds_write_b128 v44, v[16:19] offset:18432
ds_write_b128 v44, v[20:23] offset:19456
ds_write_b128 v44, v[24:27] offset:20480
ds_write_b128 v44, v[28:31] offset:21504
ds_write_b128 v44, v[48:51] offset:22528
ds_write_b128 v44, v[52:55] offset:23552
ds_write_b128 v44, v[56:59] offset:24576
ds_write_b128 v44, v[60:63] offset:25600
ds_write_b128 v44, v[64:67] offset:26624
ds_write_b128 v44, v[68:71] offset:27648
s_waitcnt vmcnt(0) lgkmcnt(0)
s_barrier
s_cmp_lg_u32 s13, 0
s_cbranch_scc1 cb_10004
v_mov_b32 v44, 4
v_mov_b32 v45, 1
s_mov_b64 exec, 1
buffer_atomic_add v45, v44, s[8:11], 0 offen
s_mov_b32 s30, 0
cb_10003:
buffer_load_dword v45, v44, s[8:11], 0 offen sc1
s_add_u32 s30, s30, 1
s_cmp_gt_u32 s30, 262144
s_cbranch_scc1 L_fail
s_waitcnt vmcnt(0)
v_cmp_gt_u32 vcc, 32, v45
s_cbranch_vccnz cb_10003
s_mov_b64 exec, -1
cb_10004:
s_barrier
s_mov_b32 s18, 0
s_mov_b32 s35, 0
s_cmp_eq_u32 s13, 1
s_cbranch_scc1 wave_10006
s_cmp_eq_u32 s13, 2
s_cbranch_scc1 wave_10007
s_cmp_eq_u32 s13, 3
s_cbranch_scc1 wave_10008
wave_10005:
layer_10009:
s_lshl_b32 s17, s35, 6
s_mul_i32 s27, s35, 34603008
s_lshl_b32 s28, s14, 14
s_add_u32 s27, s27, s28
s_add_u32 s20, s27, 16777216
s_mul_i32 s27, s17, 10240
s_add_u32 s27, s27, s24
s_add_u32 s21, s27, s25
s_mov_b32 s19, 0
s_add_u32 s33, s17, 1
s_add_u32 s31, s17, 63
s_add_u32 s32, s17, 64
s_mov_b32 s27, s20
v_mov_b32 v7, 0
s_add_u32 s66, s4, 413696
s_addc_u32 s67, s5, 0
s_add_u32 s70, s4, 397312
s_addc_u32 s71, s5, 0
s_add_u32 s68, s4, 417792
s_addc_u32 s69, s5, 0
s_add_u32 s72, s4, 401408
s_addc_u32 s73, s5, 0
s_add_u32 s42, s4, s20
s_addc_u32 s43, s5, 0
global_load_dwordx4 v[64:67], v0, s[74:75] offset:-4096 sc1
global_load_dwordx4 v[68:71], v0, s[74:75] offset:-3072 sc1
global_load_dwordx4 v[72:75], v0, s[74:75] offset:-2048 sc1
global_load_dwordx4 v[76:79], v0, s[74:75] offset:-1024 sc1
global_load_dwordx4 v[80:83], v0, s[74:75] offset:2048 sc1
global_load_dwordx4 v[84:87], v0, s[74:75] offset:3072 sc1
global_load_dwordx4 v[56:59], v0, s[74:75] offset:0 sc1
global_load_dwordx4 v[60:63], v0, s[74:75] offset:1024 sc1
v_mov_b64 v[8:9], 0
v_mov_b64 v[10:11], 0
v_mov_b64 v[12:13], 0
v_mov_b64 v[14:15], 0
v_mov_b64 v[16:17], 0
v_mov_b64 v[18:19], 0
v_mov_b64 v[20:21], 0
v_mov_b64 v[22:23], 0
v_mov_b64 v[24:25], 0
v_mov_b64 v[26:27], 0
v_mov_b64 v[28:29], 0
v_mov_b64 v[30:31], 0
v_cmp_gt_u32 vcc, s33, v7
s_cmp_eq_u32 vcc_hi, 0
s_cbranch_scc1 kv_10020
s_mov_b32 s30, 0
kv_10019:
v_bfe_u32 v7, v0, 2, 3
buffer_load_dword v7, v7, s[4:7], s22 offen sc1
s_add_u32 s30, s30, 1
s_cmp_gt_u32 s30, 262144
s_cbranch_scc1 L_fail
s_waitcnt vmcnt(0)
v_cmp_gt_u32 vcc, s33, v7
s_cbranch_vccnz kv_10019
kv_10020:
s_barrier
global_load_dwordx4 v[48:51], v0, s[42:43] offset:0 nt sc1
global_load_dwordx4 v[52:55], v0, s[42:43] offset:1024 nt sc1
v_bfe_u32 v7, v0, 2, 3
v_add_u32 v7, s22, v7
s_mov_b32 exec_hi, 0
v_and_b32 v7, 255, v0
v_lshl_add_u32 v7, v7, 3, s27
s_mov_b32 exec_hi, -1
global_load_dwordx4 v[32:35], v0, s[66:67] offset:-4096 sc1
global_load_dwordx4 v[36:39], v0, s[66:67] offset:0 sc1
global_load_dwordx4 v[40:43], v0, s[68:69] offset:0 sc1
s_mov_b32 s30, 0
s_waitcnt vmcnt(0)
.p2align 6
gather_10010:
s_waitcnt vmcnt(4)
rt_10015_b:
v_smfmac_f32_16x16x64_bf16 v[16:19], v[32:35], v[56:63], v1
ds_write_b128 v0, v[32:35] offset:0
v_smfmac_f32_16x16x64_bf16 v[8:11], v[32:35], v[64:71], v1
v_bitop3_b32 v44, v32, v34, s18 bitop3:0x7e
v_smfmac_f32_16x16x64_bf16 v[12:15], v[32:35], v[72:79], v1
s_waitcnt vmcnt(3)
ds_write_b128 v0, v[36:39] offset:4096
v_bitop3_b32 v45, v36, v38, s18 bitop3:0x7e
v_or_b32 v44, v44, v45
s_waitcnt vmcnt(2)
v_bitop3_b32 v45, v40, v42, s18 bitop3:0x7e
v_bitop3_b32 v44, v44, v45, s19 bitop3:0xa8
v_smfmac_f32_16x16x64_bf16 v[20:23], v[32:35], v[80:87], v1
ds_write_b128 v0, v[40:43] offset:8192
v_cmp_ne_u32 vcc, 0, v44
v_smfmac_f32_16x16x64_bf16 v[20:23], v[36:39], a[40:47], v1
s_cbranch_vccnz rt_10015
global_load_dwordx4 v[64:67], v0, s[76:77] offset:-4096 sc1
v_smfmac_f32_16x16x64_bf16 v[24:27], v[32:35], a[0:7], v1
ds_read_b128 v[84:87], v2 offset:1024
global_load_dwordx4 v[68:71], v0, s[76:77] offset:-3072 sc1
v_smfmac_f32_16x16x64_bf16 v[16:19], v[36:39], a[32:39], v1
s_waitcnt lgkmcnt(1)
global_load_dwordx4 v[72:75], v0, s[76:77] offset:-2048 sc1
ds_read_b128 v[80:83], v2 offset:0
global_load_dwordx4 v[76:79], v0, s[76:77] offset:-1024 sc1
v_smfmac_f32_16x16x64_bf16 v[28:31], v[32:35], a[8:15], v1
s_barrier
ds_read_b128 v[40:43], v0 offset:1024
v_smfmac_f32_16x16x64_bf16 v[12:15], v[36:39], a[24:31], v1
s_waitcnt lgkmcnt(2)
ds_read_b128 v[44:47], v0 offset:5120
v_smfmac_f32_16x16x64_bf16 v[24:27], v[36:39], a[48:55], v1
ds_read_b128 v[32:35], v0 offset:2048
s_waitcnt lgkmcnt(3)
v_smfmac_f32_16x16x64_bf16 v[28:31], v[36:39], v[80:87], v1
s_xor_b32 s18, s18, 1
ds_read_b128 v[80:83], v2 offset:2048
s_mov_b32 s19, 1
v_smfmac_f32_16x16x64_bf16 v[8:11], v[36:39], a[16:23], v1
ds_read_b128 v[84:87], v2 offset:3072
s_waitcnt lgkmcnt(4)
v_smfmac_f32_16x16x64_bf16 v[8:11], v[40:43], a[56:63], v1
ds_read_b128 v[36:39], v0 offset:6144
s_waitcnt lgkmcnt(4)
v_smfmac_f32_16x16x64_bf16 v[8:11], v[44:47], a[72:79], v1
global_load_dwordx4 v[56:59], v0, s[42:43] offset:2048 nt sc1
v_smfmac_f32_16x16x64_bf16 v[12:15], v[40:43], a[64:71], v1
ds_read_b128 v[40:43], v0 offset:3072
s_waitcnt lgkmcnt(4)
v_smfmac_f32_16x16x64_bf16 v[12:15], v[44:47], a[80:87], v1
ds_read_b128 v[44:47], v0 offset:7168
s_waitcnt lgkmcnt(3)
v_smfmac_f32_16x16x64_bf16 v[12:15], v[32:35], v[80:87], v1
ds_read_b128 v[84:87], v2 offset:5120
s_mov_b64 s[68:69], s[72:73]
v_smfmac_f32_16x16x64_bf16 v[8:11], v[32:35], a[88:95], v1
ds_read_b128 v[80:83], v2 offset:4096
s_waitcnt lgkmcnt(4)
v_smfmac_f32_16x16x64_bf16 v[12:15], v[36:39], a[104:111], v1
ds_read_b128 v[32:35], v0 offset:8192
s_waitcnt lgkmcnt(4)
v_smfmac_f32_16x16x64_bf16 v[8:11], v[36:39], a[96:103], v1
s_add_u32 s20, s20, 524288
ds_read_b128 v[36:39], v0 offset:9216
v_smfmac_f32_16x16x64_bf16 v[12:15], v[40:43], a[120:127], v1
s_waitcnt lgkmcnt(4)
global_load_dwordx4 v[60:63], v0, s[42:43] offset:3072 nt sc1
v_smfmac_f32_16x16x64_bf16 v[8:11], v[40:43], a[112:119], v1
s_waitcnt lgkmcnt(3)
s_waitcnt lgkmcnt(2)
ds_read_b128 v[40:43], v0 offset:1024
v_smfmac_f32_16x16x64_bf16 v[12:15], v[44:47], v[80:87], v1
ds_read_b128 v[84:87], v2 offset:7168
s_waitcnt lgkmcnt(3)
v_smfmac_f32_16x16x64_bf16 v[12:15], v[32:35], a[144:151], v1
ds_read_b128 v[80:83], v2 offset:6144
s_waitcnt lgkmcnt(3)
v_smfmac_f32_16x16x64_bf16 v[8:11], v[44:47], a[128:135], v1
s_waitcnt vmcnt(5)
global_load_dword v7, v7, s[4:5] sc1
v_smfmac_f32_16x16x64_bf16 v[8:11], v[32:35], a[136:143], v1
s_waitcnt vmcnt(5)
ds_read_b128 v[32:35], v0 offset:5120
v_smfmac_f32_16x16x64_bf16 v[8:11], v[36:39], v[64:71], v1
s_waitcnt lgkmcnt(3)
ds_read_b128 v[64:67], v2 offset:8192
s_waitcnt lgkmcnt(3)
v_smfmac_f32_16x16x64_bf16 v[12:15], v[36:39], a[152:159], v1
ds_read_b128 v[68:71], v2 offset:9216
s_waitcnt lgkmcnt(3)
ds_read_b128 v[36:39], v0 offset:2048
v_smfmac_f32_16x16x64_bf16 v[20:23], v[40:43], v[80:87], v1
s_add_u32 s17, s17, 1
ds_read_b128 v[84:87], v2 offset:11264
v_add_f32 v8, v8, v10
v_smfmac_f32_16x16x64_bf16 v[16:19], v[40:43], a[160:167], v1
s_waitcnt lgkmcnt(4)
ds_read_b128 v[80:83], v2 offset:10240
v_add_f32 v9, v9, v11
v_add_f32 v13, v13, v15
v_add_f32 v12, v12, v14
v_mul_f32 v13, s34, v13
v_mul_f32 v8, s34, v8
v_smfmac_f32_16x16x64_bf16 v[16:19], v[32:35], a[168:175], v1
s_add_u32 s21, s21, 10240
ds_read_b128 v[40:43], v0 offset:6144
v_mul_f32 v9, s34, v9
v_smfmac_f32_16x16x64_bf16 v[20:23], v[32:35], a[176:183], v1
s_waitcnt lgkmcnt(3)
ds_read_b128 v[32:35], v0 offset:3072
v_mul_f32 v12, s34, v12
v_smfmac_f32_16x16x64_bf16 v[16:19], v[36:39], v[64:71], v1
s_add_u32 s33, s17, 2
ds_read_b128 v[64:67], v2 offset:12288
s_waitcnt vmcnt(3)
ds_read_b128 v[68:71], v2 offset:13312
v_cvt_pk_bf16_f32 v8, v8, v9
v_cvt_pk_bf16_f32 v12, v12, v13
v_smfmac_f32_16x16x64_bf16 v[20:23], v[36:39], a[184:191], v1
s_waitcnt lgkmcnt(4)
ds_read_b128 v[36:39], v0 offset:7168
ds_write2_b32 v3, v8, v12 offset0:0 offset1:128
s_waitcnt lgkmcnt(5)
v_smfmac_f32_16x16x64_bf16 v[16:19], v[40:43], v[72:79], v1
s_mov_b64 vcc, s[40:41]
ds_read_b128 v[72:75], v2 offset:14336
v_smfmac_f32_16x16x64_bf16 v[20:23], v[40:43], v[80:87], v1
s_waitcnt lgkmcnt(5)
ds_read_b128 v[40:43], v0 offset:8192
s_waitcnt lgkmcnt(5)
ds_read_b128 v[76:79], v2 offset:15360
v_smfmac_f32_16x16x64_bf16 v[16:19], v[32:35], a[192:199], v1
s_waitcnt lgkmcnt(4)
ds_read_b128 v[84:87], v2 offset:17408
v_smfmac_f32_16x16x64_bf16 v[20:23], v[32:35], a[200:207], v1
ds_read_b128 v[32:35], v0 offset:9216
s_waitcnt lgkmcnt(5)
ds_read_b128 v[80:83], v2 offset:16384
v_smfmac_f32_16x16x64_bf16 v[16:19], v[36:39], v[64:71], v1
s_barrier
ds_read_b64_tr_b16 v[10:11], v4 offset:512
v_smfmac_f32_16x16x64_bf16 v[20:23], v[36:39], a[208:215], v1
s_waitcnt lgkmcnt(4)
ds_read_b64_tr_b16 v[8:9], v4 offset:0
ds_read_b64_tr_b16 v[12:13], v4 offset:1024
v_smfmac_f32_16x16x64_bf16 v[20:23], v[40:43], a[216:223], v1
ds_read_b64_tr_b16 v[14:15], v4 offset:1536
ds_read_b128 v[36:39], v0 offset:8192
v_smfmac_f32_16x16x64_bf16 v[16:19], v[40:43], v[72:79], v1
s_waitcnt lgkmcnt(6)
ds_read_b128 v[64:67], v2 offset:18432
ds_read_b128 v[68:71], v2 offset:19456
v_smfmac_f32_16x16x64_bf16 v[16:19], v[32:35], a[224:231], v1
s_waitcnt lgkmcnt(7)
ds_read_b128 v[76:79], v2 offset:21504
ds_read_b128 v[40:43], v0 offset:9216
v_smfmac_f32_16x16x64_bf16 v[20:23], v[32:35], v[80:87], v1
s_waitcnt lgkmcnt(7)
ds_read_b128 v[72:75], v2 offset:20480
ds_read_b128 v[32:35], v0 offset:1024
v_mfma_f32_16x16x32_bf16 v[44:47], v[48:51], v[8:11], 0
s_waitcnt lgkmcnt(7)
ds_read_b128 v[84:87], v2 offset:23552
v_add_f32 v16, v16, v18
v_add_f32 v17, v17, v19
v_mfma_f32_16x16x32_bf16 v[44:47], v[52:55], v[12:15], v[44:47]
s_waitcnt lgkmcnt(7)
v_bfe_u32 v48, v0, 5, 1
v_cvt_pk_bf16_f32 v16, v16, v17
v_add_f32 v20, v20, v22
v_add_f32 v21, v21, v23
v_cvt_pk_bf16_f32 v20, v20, v21
v_lshl_add_u32 v48, v48, 3, v5
v_smfmac_f32_16x16x64_bf16 v[28:31], v[36:39], a[232:239], v1
s_waitcnt lgkmcnt(5)
ds_write2_b32 v3, v16, v20 offset0:1 offset1:129
v_cndmask_b32_dpp v44, v46, v44, vcc quad_perm:[0,1,0,1] row_mask:0xf bank_mask:0xf
v_cndmask_b32_dpp v45, v47, v45, vcc quad_perm:[0,1,0,1] row_mask:0xf bank_mask:0xf
v_smfmac_f32_16x16x64_bf16 v[24:27], v[36:39], v[64:71], v1
s_waitcnt lgkmcnt(4)
ds_write_b64 v48, v[44:45] offset:6144
v_smfmac_f32_16x16x64_bf16 v[24:27], v[40:43], a[240:247], v1
s_waitcnt lgkmcnt(3)
global_load_dwordx4 v[64:67], v0, s[76:77] offset:0 sc1
ds_read_b128 v[80:83], v2 offset:22528
v_smfmac_f32_16x16x64_bf16 v[28:31], v[40:43], v[72:79], v1
ds_read_b128 v[36:39], v0 offset:5120
global_load_dwordx4 v[68:71], v0, s[76:77] offset:1024 sc1
v_smfmac_f32_16x16x64_bf16 v[24:27], v[32:35], a[248:255], v1
global_load_dwordx4 v[72:75], v0, s[76:77] offset:2048 sc1
ds_read_b128 v[40:43], v0 offset:2048
v_smfmac_f32_16x16x64_bf16 v[28:31], v[32:35], v[88:95], v1
s_waitcnt lgkmcnt(3)
ds_read_b128 v[32:35], v0 offset:6144
s_barrier
ds_read_b128 v[48:51], v6 offset:6144
s_waitcnt lgkmcnt(3)
v_smfmac_f32_16x16x64_bf16 v[28:31], v[36:39], v[96:103], v1
ds_read_b128 v[52:55], v6 offset:7168
v_smfmac_f32_16x16x64_bf16 v[24:27], v[36:39], v[80:87], v1
s_waitcnt lgkmcnt(3)
ds_read_b128 v[36:39], v0 offset:3072
ds_read_b64_tr_b16 v[8:9], v4 offset:0
v_smfmac_f32_16x16x64_bf16 v[24:27], v[40:43], v[104:111], v1
s_waitcnt lgkmcnt(4)
ds_read_b64_tr_b16 v[10:11], v4 offset:512
global_load_dwordx4 v[76:79], v0, s[76:77] offset:3072 sc1
v_smfmac_f32_16x16x64_bf16 v[28:31], v[40:43], v[112:119], v1
s_waitcnt lgkmcnt(4)
ds_read_b128 v[40:43], v0 offset:7168
global_load_dwordx4 v[80:83], v0, s[78:79] offset:-4096 sc1
v_smfmac_f32_16x16x64_bf16 v[24:27], v[32:35], v[120:127], v1
ds_read_b64_tr_b16 v[20:21], v4 offset:3072
global_load_dwordx4 v[84:87], v0, s[78:79] offset:-3072 sc1
v_smfmac_f32_16x16x64_bf16 v[28:31], v[32:35], v[128:135], v1
s_waitcnt lgkmcnt(4)
ds_read_b64_tr_b16 v[12:13], v4 offset:1024
v_add_f32 v50, v50, v54
v_smfmac_f32_16x16x64_bf16 v[28:31], v[36:39], v[144:151], v1
s_waitcnt vmcnt(7)
ds_read_b64_tr_b16 v[16:17], v4 offset:2048
v_add_f32 v48, v48, v52
v_smfmac_f32_16x16x64_bf16 v[24:27], v[36:39], v[136:143], v1
s_waitcnt lgkmcnt(3)
ds_read_b64_tr_b16 v[14:15], v4 offset:1536
v_add_f32 v49, v49, v53
v_smfmac_f32_16x16x64_bf16 v[28:31], v[40:43], v[160:167], v1
s_min_u32 s33, s33, s32
ds_read_b64_tr_b16 v[18:19], v4 offset:2560
v_add_f32 v51, v51, v55
v_smfmac_f32_16x16x64_bf16 v[24:27], v[40:43], v[152:159], v1
s_waitcnt lgkmcnt(3)
ds_read_b64_tr_b16 v[22:23], v4 offset:3584
v_exp_f32 v51, v51
v_exp_f32 v50, v50
v_mfma_f32_16x16x32_bf16 v[44:47], v[8:11], v[8:11], 0
s_waitcnt lgkmcnt(2)
v_exp_f32 v49, v49
v_exp_f32 v48, v48
v_mfma_f32_16x16x32_bf16 v[44:47], v[12:15], v[12:15], v[44:47]
s_waitcnt lgkmcnt(1)
v_cvt_pk_bf16_f32 v54, v48, v49
v_cvt_pk_bf16_f32 v55, v50, v51
v_mfma_f32_16x16x32_bf16 v[44:47], v[16:19], v[16:19], v[44:47]
s_waitcnt lgkmcnt(0)
v_mov_b32_dpp v49, v55 quad_perm:[0,1,0,1] row_mask:0xf bank_mask:0xf
v_mov_b32_dpp v50, v54 quad_perm:[2,3,2,3] row_mask:0xf bank_mask:0xf
v_mfma_f32_16x16x32_bf16 v[44:47], v[20:23], v[20:23], v[44:47]
s_nop 0
v_mov_b32_dpp v48, v54 quad_perm:[0,1,0,1] row_mask:0xf bank_mask:0xf
v_mov_b32_dpp v51, v55 quad_perm:[2,3,2,3] row_mask:0xf bank_mask:0xf
v_mov_b64 v[20:21], s[44:45]
v_mov_b64 v[22:23], s[44:45]
v_cvt_pk_bf16_f32 v24, v24, v25
v_mfma_f32_16x16x32_bf16 v[12:15], v[60:63], v[48:51], 0
s_add_u32 s27, s20, 524288
v_exp_f32_dpp v45, v47 quad_perm:[0,1,0,1] row_mask:0xf bank_mask:0xf
v_mfma_f32_16x16x32_bf16 v[8:11], v[56:59], v[48:51], 0
v_exp_f32_dpp v44, v46 quad_perm:[0,1,0,1] row_mask:0xf bank_mask:0xf
v_mfma_f32_16x16x32_bf16 v[16:19], v[20:23], v[48:51], 0
v_cvt_pk_bf16_f32 v53, v44, v45
v_cvt_pk_bf16_f32 v25, v26, v27
v_cvt_pk_bf16_f32 v52, v44, v45
v_cvt_pk_bf16_f32 v26, v28, v29
v_cvt_pk_bf16_f32 v27, v30, v31
v_mfma_f32_16x16x16_bf16 v[8:11], v[24:25], v[52:53], v[8:11]
v_mov_b64 v[54:55], s[46:47]
v_mov_b64 v[42:43], 0
v_mfma_f32_16x16x16_bf16 v[12:15], v[26:27], v[52:53], v[12:15]
s_waitcnt vmcnt(4)
ds_read_b128 v[28:31], v0 offset:19456
v_bfe_u32 v32, v0, 5, 1
v_mfma_f32_16x16x16_bf16 v[16:19], v[54:55], v[52:53], v[16:19]
s_nop 0
v_mov_b64 v[36:37], 0
v_lshl_add_u32 v32, v32, 3, v5
v_mov_b64 v[38:39], 0
v_cndmask_b32 v9, v13, v9, s[40:41]
v_cndmask_b32 v11, v15, v11, s[40:41]
v_cndmask_b32 v8, v12, v8, s[40:41]
v_cndmask_b32 v10, v14, v10, s[40:41]
v_rcp_f32 v18, v16
v_subrev_u32 v17, s36, v16
v_mul_f32 v9, v9, v18
v_mul_f32 v10, v10, v18
v_mul_f32 v8, v8, v18
v_mul_f32 v11, v11, v18
v_cvt_pk_bf16_f32 v13, v10, v11
v_cvt_pk_bf16_f32 v12, v8, v9
v_cmp_lt_u32 vcc, s37, v17
s_cbranch_vccnz rare_10011
back_10012:
ds_write_b64 v32, v[12:13] offset:0
v_mov_b32_dpp v9, v13 quad_perm:[0,1,0,1] row_mask:0xf bank_mask:0xf
v_mov_b32_dpp v8, v12 quad_perm:[0,1,0,1] row_mask:0xf bank_mask:0xf
v_mov_b32_dpp v11, v13 quad_perm:[2,3,2,3] row_mask:0xf bank_mask:0xf
v_mov_b32_dpp v10, v12 quad_perm:[2,3,2,3] row_mask:0xf bank_mask:0xf
v_mov_b64 v[32:33], 0
v_mov_b64 v[54:55], 0
v_smfmac_f32_16x16x64_bf16 v[36:39], v[8:11], v[64:71], v1
s_waitcnt vmcnt(2)
global_load_dwordx4 v[64:67], v0, s[74:75] offset:-4096 sc1
ds_read_b128 v[24:27], v0 offset:18432
global_load_dwordx4 v[68:71], v0, s[74:75] offset:-3072 sc1
ds_read_b128 v[20:23], v0 offset:17408
s_waitcnt lgkmcnt(3)
ds_read_b128 v[16:19], v0 offset:16384
s_waitcnt lgkmcnt(3)
v_mov_b64 v[40:41], 0
v_mov_b64 v[52:53], 0
s_barrier
ds_read_b128 v[56:59], v5 offset:512
v_smfmac_f32_16x16x64_bf16 v[40:43], v[8:11], v[72:79], v1
s_add_u32 s42, s4, s20
ds_read_b128 v[60:63], v5 offset:1024
v_mov_b64 v[34:35], 0
v_smfmac_f32_16x16x64_bf16 v[52:55], v[8:11], v[176:183], v1
s_waitcnt vmcnt(2)
ds_read_b128 v[12:15], v5 offset:1536
v_mov_b64 v[48:49], 0
v_mov_b64 v[50:51], 0
v_smfmac_f32_16x16x64_bf16 v[32:35], v[8:11], v[80:87], v1
s_waitcnt lgkmcnt(3)
ds_read_b128 v[80:83], v0 offset:20480
global_load_dwordx4 v[72:75], v0, s[74:75] offset:-2048 sc1
v_smfmac_f32_16x16x64_bf16 v[48:51], v[8:11], v[168:175], v1
s_waitcnt lgkmcnt(3)
ds_read_b128 v[84:87], v0 offset:21504
global_load_dwordx4 v[76:79], v0, s[74:75] offset:-1024 sc1
v_smfmac_f32_16x16x64_bf16 v[36:39], v[56:59], v[16:23], v1
s_waitcnt lgkmcnt(3)
ds_read_b128 v[20:23], v0 offset:23552
v_bfe_u32 v45, v0, 1, 7
v_smfmac_f32_16x16x64_bf16 v[36:39], v[60:63], v[24:31], v1
s_waitcnt lgkmcnt(3)
ds_read_b128 v[24:27], v0 offset:24576
v_lshrrev_b32 v44, 8, v0
v_smfmac_f32_16x16x64_bf16 v[36:39], v[12:15], v[184:191], v1
ds_read_b128 v[16:19], v0 offset:22528
v_smfmac_f32_16x16x64_bf16 v[40:43], v[56:59], v[192:199], v1
s_waitcnt lgkmcnt(3)
ds_read_b128 v[28:31], v0 offset:25600
v_lshl_or_b32 v44, v44, 12, v45
v_smfmac_f32_16x16x64_bf16 v[40:43], v[60:63], v[80:87], v1
s_nop 0
ds_read_b128 v[80:83], v0 offset:26624
v_cvt_pk_bf16_f32 v36, v36, v37
v_and_or_b32 v36, v36, -2, s18
v_smfmac_f32_16x16x64_bf16 v[40:43], v[12:15], v[200:207], v1
s_waitcnt lgkmcnt(3)
ds_read_b128 v[84:87], v0 offset:27648
v_cvt_pk_bf16_f32 v37, v38, v39
v_smfmac_f32_16x16x64_bf16 v[52:55], v[56:59], v[216:223], v1
s_waitcnt lgkmcnt(3)
global_store_dwordx2 v44, v[36:37], s[48:49]
v_smfmac_f32_16x16x64_bf16 v[48:51], v[56:59], v[16:23], v1
s_waitcnt lgkmcnt(2)
v_cvt_pk_bf16_f32 v40, v40, v41
v_smfmac_f32_16x16x64_bf16 v[48:51], v[60:63], v[24:31], v1
v_cvt_pk_bf16_f32 v41, v42, v43
v_smfmac_f32_16x16x64_bf16 v[48:51], v[12:15], v[208:215], v1
v_and_or_b32 v40, v40, -2, s18
v_smfmac_f32_16x16x64_bf16 v[32:35], v[56:59], v[232:239], v1
s_waitcnt lgkmcnt(0)
global_store_dwordx2 v44, v[40:41], s[50:51]
s_nop 0
v_smfmac_f32_16x16x64_bf16 v[32:35], v[60:63], v[240:247], v1
s_nop 1
v_cvt_pk_bf16_f32 v48, v48, v49
v_smfmac_f32_16x16x64_bf16 v[32:35], v[12:15], v[248:255], v1
s_mov_b64 s[66:67], s[70:71]
v_and_or_b32 v48, v48, -2, s18
v_cvt_pk_bf16_f32 v49, v50, v51
v_smfmac_f32_16x16x64_bf16 v[52:55], v[60:63], v[80:87], v1
global_store_dwordx2 v44, v[48:49], s[52:53]
v_smfmac_f32_16x16x64_bf16 v[52:55], v[12:15], v[224:231], v1
s_nop 1
v_cvt_pk_bf16_f32 v32, v32, v33
s_addc_u32 s43, s5, 0
v_and_or_b32 v32, v32, -2, s18
v_cvt_pk_bf16_f32 v33, v34, v35
s_nop 1
v_cvt_pk_bf16_f32 v52, v52, v53
v_and_or_b32 v52, v52, -2, s18
s_mov_b32 s30, 0
v_cvt_pk_bf16_f32 v53, v54, v55
global_store_dwordx2 v44, v[52:53], s[54:55]
global_store_dwordx2 v44, v[32:33], s[56:57]
v_bfe_u32 v24, v0, 6, 1
v_lshlrev_b32 v24, 4, v24
v_mov_b32 v25, 0x3f80
v_lshlrev_b32 v24, v24, v25
v_bfe_i32 v25, v0, 4, 1
v_and_b32 v45, v24, v25
v_and_b32 v47, v24, v25
v_xor_b32 v44, v24, v45
v_xor_b32 v46, v24, v45
v_and_b32 v28, 32, v0
v_bfe_u32 v29, v0, 6, 1
v_lshl_add_u32 v28, v29, 8, v28
v_bfe_u32 v29, v0, 8, 1
v_lshl_add_u32 v28, v29, 4, v28
v_bfe_u32 v29, v0, 4, 1
v_lshl_add_u32 v28, v29, 3, v28
v_bfe_u32 v7, v0, 2, 3
v_add_u32 v7, s22, v7
s_mov_b32 exec_hi, 0
v_and_b32 v7, 255, v0
v_lshl_add_u32 v7, v7, 3, s27
s_mov_b32 exec_hi, -1
s_nop 15
s_nop 15
s_nop 15
s_nop 4
global_load_dwordx4 v[8:11], v0, s[62:63] offset:0 sc1
global_load_dwordx4 v[12:15], v0, s[62:63] offset:1024 sc1
global_load_dwordx4 v[16:19], v0, s[62:63] offset:2048 sc1
global_load_dwordx4 v[20:23], v0, s[62:63] offset:3072 sc1
s_nop 15
s_nop 14
global_load_dwordx4 v[56:59], v0, s[74:75] offset:0 sc1
global_load_dwordx4 v[60:63], v0, s[74:75] offset:1024 sc1
global_load_dwordx4 v[80:83], v0, s[74:75] offset:2048 sc1
global_load_dwordx4 v[84:87], v0, s[74:75] offset:3072 sc1
v_mov_b64 v[40:41], 0
v_mov_b64 v[42:43], 0
s_waitcnt vmcnt(6)
s_nop 0
v_smfmac_f32_16x16x64_bf16 v[40:43], v[44:47], v[8:15], v1
v_bitop3_b32 v24, v8, v10, s18 bitop3:0x7e
v_bitop3_b32 v25, v12, v14, s18 bitop3:0x7e
s_waitcnt vmcnt(4)
v_smfmac_f32_16x16x64_bf16 v[40:43], v[44:47], v[16:23], v1
v_bitop3_b32 v26, v16, v18, s18 bitop3:0x7e
v_bitop3_b32 v27, v20, v22, s18 bitop3:0x7e
v_or3_b32 v24, v24, v25, v26
v_bitop3_b32 v24, v24, v27, 1 bitop3:0xa8
v_cmp_ne_u32 vcc, 0, v24
s_cbranch_vccnz red_10021
red_10021_ok:
s_nop 1
v_add_f32_dpp v40, v40, v40 row_ror:8 row_mask:0xf bank_mask:0xf
v_add_f32_dpp v41, v41, v41 row_ror:8 row_mask:0xf bank_mask:0xf
v_add_f32_dpp v42, v42, v42 row_ror:8 row_mask:0xf bank_mask:0xf
v_add_f32_dpp v43, v43, v43 row_ror:8 row_mask:0xf bank_mask:0xf
v_cvt_pk_bf16_f32 v40, v40, v41
v_cvt_pk_bf16_f32 v41, v42, v43
v_and_or_b32 v40, v40, -2, s18
s_mov_b64 exec, 0x00ff00ff
global_store_dwordx2 v28, v[40:41], s[64:65]
s_mov_b64 exec, -1
v_mov_b64 v[8:9], 0
v_mov_b64 v[10:11], 0
v_mov_b64 v[12:13], 0
v_mov_b64 v[14:15], 0
v_mov_b64 v[16:17], 0
v_mov_b64 v[18:19], 0
v_mov_b64 v[20:21], 0
v_mov_b64 v[22:23], 0
v_mov_b64 v[24:25], 0
v_mov_b64 v[26:27], 0
v_mov_b64 v[28:29], 0
v_mov_b64 v[30:31], 0
s_nop 15
s_nop 6
s_barrier
global_load_dwordx4 v[32:35], v0, s[66:67] offset:-4096 sc1
s_nop 10
global_load_dwordx4 v[36:39], v0, s[66:67] offset:0 sc1
s_nop 10
global_load_dwordx4 v[40:43], v0, s[68:69] offset:0 sc1
s_barrier
global_load_dwordx4 v[48:51], v0, s[42:43] offset:0 nt sc1
global_load_dwordx4 v[52:55], v0, s[42:43] offset:1024 nt sc1
s_mov_b32 s30, 0
s_cmp_eq_u32 s17, s31
s_cbranch_scc0 gather_10010
s_branch exit_10013
rt_10015:
global_load_dwordx4 v[32:35], v0, s[66:67] offset:-4096 sc1
global_load_dwordx4 v[36:39], v0, s[66:67] offset:0 sc1
global_load_dwordx4 v[40:43], v0, s[68:69] offset:0 sc1
s_add_u32 s30, s30, 1
s_cmp_gt_u32 s30, 262144
s_cbranch_scc1 L_fail
v_mov_b64 v[8:9], 0
v_mov_b64 v[10:11], 0
v_mov_b64 v[12:13], 0
v_mov_b64 v[14:15], 0
v_mov_b64 v[16:17], 0
v_mov_b64 v[18:19], 0
v_mov_b64 v[20:21], 0
v_mov_b64 v[22:23], 0
v_mov_b64 v[24:25], 0
v_mov_b64 v[26:27], 0
v_mov_b64 v[28:29], 0
v_mov_b64 v[30:31], 0
s_waitcnt vmcnt(2)
v_bitop3_b32 v44, v32, v34, s18 bitop3:0x7e
s_waitcnt vmcnt(1)
v_bitop3_b32 v45, v36, v38, s18 bitop3:0x7e
v_or_b32 v44, v44, v45
s_waitcnt vmcnt(0)
v_bitop3_b32 v45, v40, v42, s18 bitop3:0x7e
v_bitop3_b32 v44, v44, v45, s19 bitop3:0xa8
v_cmp_ne_u32 vcc, 0, v44
s_cbranch_vccnz rt_10015
s_branch rt_10015_b
red_10021:
global_load_dwordx4 v[8:11], v0, s[62:63] offset:0 sc1
global_load_dwordx4 v[12:15], v0, s[62:63] offset:1024 sc1
global_load_dwordx4 v[16:19], v0, s[62:63] offset:2048 sc1
global_load_dwordx4 v[20:23], v0, s[62:63] offset:3072 sc1
s_add_u32 s30, s30, 1
s_cmp_gt_u32 s30, 262144
s_cbranch_scc1 L_fail
v_mov_b64 v[40:41], 0
v_mov_b64 v[42:43], 0
s_waitcnt vmcnt(2)
s_nop 0
v_smfmac_f32_16x16x64_bf16 v[40:43], v[44:47], v[8:15], v1
v_bitop3_b32 v24, v8, v10, s18 bitop3:0x7e
v_bitop3_b32 v25, v12, v14, s18 bitop3:0x7e
s_waitcnt vmcnt(0)
v_smfmac_f32_16x16x64_bf16 v[40:43], v[44:47], v[16:23], v1
v_bitop3_b32 v26, v16, v18, s18 bitop3:0x7e
v_bitop3_b32 v27, v20, v22, s18 bitop3:0x7e
v_or3_b32 v24, v24, v25, v26
v_bitop3_b32 v24, v24, v27, 1 bitop3:0xa8
v_cmp_ne_u32 vcc, 0, v24
s_cbranch_vccnz red_10021
s_branch red_10021_ok
rare_10011:
ds_read_b128 v[48:51], v6 offset:6144
ds_read_b128 v[52:55], v6 offset:7168
s_waitcnt lgkmcnt(0)
v_add_f32 v48, v48, v52
v_add_f32 v49, v49, v53
v_add_f32 v50, v50, v54
v_add_f32 v51, v51, v55
v_mov_b32_dpp v46, v46 quad_perm:[0,1,0,1] row_mask:0xf bank_mask:0xf
v_mov_b32_dpp v47, v47 quad_perm:[0,1,0,1] row_mask:0xf bank_mask:0xf
v_max3_f32 v19, v48, v49, v50
v_max3_f32 v19, v19, v51, v46
v_max_f32 v19, v19, v47
s_nop 1
v_max_f32_dpp v19, v19, v19 quad_perm:[2,3,0,1] row_mask:0xf bank_mask:0xf
v_mov_b32 v44, v19
s_nop 1
v_permlane32_swap_b32 v19, v44
v_max_f32 v19, v19, v44
v_mov_b32 v44, v19
s_nop 1
v_permlane16_swap_b32 v19, v44
v_max_f32 v19, v19, v44
v_sub_f32 v48, v48, v19
v_sub_f32 v49, v49, v19
v_sub_f32 v50, v50, v19
v_sub_f32 v51, v51, v19
v_sub_f32 v46, v46, v19
v_sub_f32 v47, v47, v19
v_exp_f32 v48, v48
v_exp_f32 v49, v49
v_exp_f32 v50, v50
v_exp_f32 v51, v51
v_cvt_pk_bf16_f32 v54, v48, v49
v_cvt_pk_bf16_f32 v55, v50, v51
s_nop 0
v_mov_b32_dpp v48, v54 quad_perm:[0,1,0,1] row_mask:0xf bank_mask:0xf
v_mov_b32_dpp v49, v55 quad_perm:[0,1,0,1] row_mask:0xf bank_mask:0xf
v_mov_b32_dpp v50, v54 quad_perm:[2,3,2,3] row_mask:0xf bank_mask:0xf
v_mov_b32_dpp v51, v55 quad_perm:[2,3,2,3] row_mask:0xf bank_mask:0xf
v_mov_b64 v[20:21], s[44:45]
v_mov_b64 v[22:23], s[44:45]
v_mfma_f32_16x16x32_bf16 v[8:11], v[56:59], v[48:51], 0
v_mfma_f32_16x16x32_bf16 v[12:15], v[60:63], v[48:51], 0
v_mfma_f32_16x16x32_bf16 v[16:19], v[20:23], v[48:51], 0
v_mov_b64 v[54:55], s[46:47]
v_exp_f32_dpp v44, v46 quad_perm:[0,1,0,1] row_mask:0xf bank_mask:0xf
v_exp_f32_dpp v45, v47 quad_perm:[0,1,0,1] row_mask:0xf bank_mask:0xf
s_nop 0
v_cvt_pk_bf16_f32 v52, v44, v45
v_cvt_pk_bf16_f32 v53, v44, v45
s_nop 1
v_mfma_f32_16x16x16_bf16 v[16:19], v[54:55], v[52:53], v[16:19]
v_mfma_f32_16x16x16_bf16 v[8:11], v[24:25], v[52:53], v[8:11]
v_mfma_f32_16x16x16_bf16 v[12:15], v[26:27], v[52:53], v[12:15]
s_nop 5
v_rcp_f32 v18, v16
s_nop 0
v_cndmask_b32 v8, v12, v8, s[40:41]
v_mul_f32 v8, v8, v18
v_cndmask_b32 v9, v13, v9, s[40:41]
v_mul_f32 v9, v9, v18
v_cndmask_b32 v10, v14, v10, s[40:41]
v_mul_f32 v10, v10, v18
v_cndmask_b32 v11, v15, v11, s[40:41]
v_mul_f32 v11, v11, v18
v_cvt_pk_bf16_f32 v12, v8, v9
v_cvt_pk_bf16_f32 v13, v10, v11
s_branch back_10012
exit_10013:
global_load_dwordx4 v[32:35], v0, s[66:67] offset:-4096 sc1
global_load_dwordx4 v[36:39], v0, s[66:67] offset:0 sc1
global_load_dwordx4 v[40:43], v0, s[68:69] offset:0 sc1
s_add_u32 s30, s30, 1
s_cmp_gt_u32 s30, 262144
s_cbranch_scc1 L_fail
s_waitcnt vmcnt(2)
v_bitop3_b32 v44, v32, v34, s18 bitop3:0x7e
s_waitcnt vmcnt(1)
v_bitop3_b32 v45, v36, v38, s18 bitop3:0x7e
v_or_b32 v44, v44, v45
s_waitcnt vmcnt(0)
v_bitop3_b32 v46, v40, v42, s18 bitop3:0x7e
v_bitop3_b32 v44, v44, v46, s19 bitop3:0xa8
v_cmp_ne_u32 vcc, 0, v44
s_cbranch_vccnz exit_10013
s_add_u32 s35, s35, 1
s_cmp_lt_u32 s35, 2
s_cbranch_scc1 layer_10009
s_endpgm
wave_10006:
layer_10026:
s_lshl_b32 s17, s35, 6
s_mul_i32 s27, s35, 34603008
s_lshl_b32 s28, s14, 14
s_add_u32 s27, s27, s28
s_add_u32 s20, s27, 16781312
s_mul_i32 s27, s17, 10240
s_add_u32 s27, s27, s24
s_add_u32 s21, s27, s25
s_mov_b32 s19, 0
s_add_u32 s33, s17, 1
s_add_u32 s31, s17, 63
s_add_u32 s32, s17, 64
s_mov_b32 s27, s20
v_mov_b32 v7, 0
s_add_u32 s66, s4, 414720
s_addc_u32 s67, s5, 0
s_add_u32 s70, s4, 398336
s_addc_u32 s71, s5, 0
s_add_u32 s68, s4, 418816
s_addc_u32 s69, s5, 0
s_add_u32 s72, s4, 402432
s_addc_u32 s73, s5, 0
s_add_u32 s42, s4, s20
s_addc_u32 s43, s5, 0
global_load_dwordx4 v[64:67], v0, s[74:75] offset:-4096 sc1
global_load_dwordx4 v[68:71], v0, s[74:75] offset:-3072 sc1
global_load_dwordx4 v[72:75], v0, s[74:75] offset:-2048 sc1
global_load_dwordx4 v[76:79], v0, s[74:75] offset:-1024 sc1
global_load_dwordx4 v[80:83], v0, s[74:75] offset:2048 sc1
global_load_dwordx4 v[84:87], v0, s[74:75] offset:3072 sc1
global_load_dwordx4 v[56:59], v0, s[74:75] offset:0 sc1
global_load_dwordx4 v[60:63], v0, s[74:75] offset:1024 sc1
v_mov_b64 v[8:9], 0
v_mov_b64 v[10:11], 0
v_mov_b64 v[12:13], 0
v_mov_b64 v[14:15], 0
v_mov_b64 v[16:17], 0
v_mov_b64 v[18:19], 0
v_mov_b64 v[20:21], 0
v_mov_b64 v[22:23], 0
v_mov_b64 v[24:25], 0
v_mov_b64 v[26:27], 0
v_mov_b64 v[28:29], 0
v_mov_b64 v[30:31], 0
s_barrier
global_load_dwordx4 v[48:51], v0, s[42:43] offset:0 nt sc1
global_load_dwordx4 v[52:55], v0, s[42:43] offset:1024 nt sc1
v_bfe_u32 v7, v0, 2, 3
v_add_u32 v7, s22, v7
s_mov_b32 exec_hi, 0
v_and_b32 v7, 255, v0
v_lshl_add_u32 v7, v7, 3, s27
s_mov_b32 exec_hi, -1
global_load_dwordx4 v[32:35], v0, s[66:67] offset:-4096 sc1
global_load_dwordx4 v[36:39], v0, s[66:67] offset:0 sc1
global_load_dwordx4 v[40:43], v0, s[68:69] offset:0 sc1
s_mov_b32 s30, 0
s_waitcnt vmcnt(0)
.p2align 6
gather_10027:
s_waitcnt vmcnt(4)
rt_10032_b:
v_smfmac_f32_16x16x64_bf16 v[16:19], v[32:35], v[56:63], v1
ds_write_b128 v0, v[32:35] offset:1024
v_smfmac_f32_16x16x64_bf16 v[8:11], v[32:35], v[64:71], v1
v_bitop3_b32 v44, v32, v34, s18 bitop3:0x7e
v_smfmac_f32_16x16x64_bf16 v[12:15], v[32:35], v[72:79], v1
s_waitcnt vmcnt(3)
ds_write_b128 v0, v[36:39] offset:5120
v_bitop3_b32 v45, v36, v38, s18 bitop3:0x7e
v_or_b32 v44, v44, v45
s_waitcnt vmcnt(2)
v_bitop3_b32 v45, v40, v42, s18 bitop3:0x7e
v_bitop3_b32 v44, v44, v45, s19 bitop3:0xa8
v_smfmac_f32_16x16x64_bf16 v[20:23], v[32:35], v[80:87], v1
ds_write_b128 v0, v[40:43] offset:9216
v_cmp_ne_u32 vcc, 0, v44
v_smfmac_f32_16x16x64_bf16 v[20:23], v[36:39], a[40:47], v1
s_cbranch_vccnz rt_10032
global_load_dwordx4 v[64:67], v0, s[76:77] offset:-4096 sc1
v_smfmac_f32_16x16x64_bf16 v[24:27], v[32:35], a[0:7], v1
ds_read_b128 v[84:87], v2 offset:1024
global_load_dwordx4 v[68:71], v0, s[76:77] offset:-3072 sc1
v_smfmac_f32_16x16x64_bf16 v[16:19], v[36:39], a[32:39], v1
s_waitcnt lgkmcnt(1)
global_load_dwordx4 v[72:75], v0, s[76:77] offset:-2048 sc1
ds_read_b128 v[80:83], v2 offset:0
global_load_dwordx4 v[76:79], v0, s[76:77] offset:-1024 sc1
v_smfmac_f32_16x16x64_bf16 v[28:31], v[32:35], a[8:15], v1
s_barrier
ds_read_b128 v[40:43], v0 offset:0
v_smfmac_f32_16x16x64_bf16 v[12:15], v[36:39], a[24:31], v1
s_waitcnt lgkmcnt(2)
ds_read_b128 v[44:47], v0 offset:4096
v_smfmac_f32_16x16x64_bf16 v[24:27], v[36:39], a[48:55], v1
ds_read_b128 v[32:35], v0 offset:3072
s_waitcnt lgkmcnt(3)
v_smfmac_f32_16x16x64_bf16 v[28:31], v[36:39], v[80:87], v1
s_xor_b32 s18, s18, 1
ds_read_b128 v[80:83], v2 offset:2048
s_mov_b32 s19, 1
v_smfmac_f32_16x16x64_bf16 v[8:11], v[36:39], a[16:23], v1
ds_read_b128 v[84:87], v2 offset:3072
s_waitcnt lgkmcnt(4)
v_smfmac_f32_16x16x64_bf16 v[8:11], v[40:43], a[56:63], v1
ds_read_b128 v[36:39], v0 offset:7168
s_waitcnt lgkmcnt(4)
v_smfmac_f32_16x16x64_bf16 v[8:11], v[44:47], a[72:79], v1
global_load_dwordx4 v[56:59], v0, s[42:43] offset:2048 nt sc1
v_smfmac_f32_16x16x64_bf16 v[12:15], v[40:43], a[64:71], v1
ds_read_b128 v[40:43], v0 offset:2048
s_waitcnt lgkmcnt(4)
v_smfmac_f32_16x16x64_bf16 v[12:15], v[44:47], a[80:87], v1
ds_read_b128 v[44:47], v0 offset:6144
s_waitcnt lgkmcnt(3)
v_smfmac_f32_16x16x64_bf16 v[12:15], v[32:35], v[80:87], v1
ds_read_b128 v[84:87], v2 offset:5120
s_mov_b64 s[68:69], s[72:73]
v_smfmac_f32_16x16x64_bf16 v[8:11], v[32:35], a[88:95], v1
ds_read_b128 v[80:83], v2 offset:4096
s_waitcnt lgkmcnt(4)
v_smfmac_f32_16x16x64_bf16 v[12:15], v[36:39], a[104:111], v1
ds_read_b128 v[32:35], v0 offset:9216
s_waitcnt lgkmcnt(4)
v_smfmac_f32_16x16x64_bf16 v[8:11], v[36:39], a[96:103], v1
s_add_u32 s20, s20, 524288
ds_read_b128 v[36:39], v0 offset:8192
v_smfmac_f32_16x16x64_bf16 v[12:15], v[40:43], a[120:127], v1
s_waitcnt lgkmcnt(4)
global_load_dwordx4 v[60:63], v0, s[42:43] offset:3072 nt sc1
v_smfmac_f32_16x16x64_bf16 v[8:11], v[40:43], a[112:119], v1
s_waitcnt lgkmcnt(3)
s_waitcnt lgkmcnt(2)
ds_read_b128 v[40:43], v0 offset:0
v_smfmac_f32_16x16x64_bf16 v[12:15], v[44:47], v[80:87], v1
ds_read_b128 v[84:87], v2 offset:7168
s_waitcnt lgkmcnt(3)
v_smfmac_f32_16x16x64_bf16 v[12:15], v[32:35], a[144:151], v1
ds_read_b128 v[80:83], v2 offset:6144
s_waitcnt lgkmcnt(3)
v_smfmac_f32_16x16x64_bf16 v[8:11], v[44:47], a[128:135], v1
s_waitcnt vmcnt(5)
global_load_dword v7, v7, s[4:5] sc1
v_smfmac_f32_16x16x64_bf16 v[8:11], v[32:35], a[136:143], v1
s_waitcnt vmcnt(5)
ds_read_b128 v[32:35], v0 offset:4096
v_smfmac_f32_16x16x64_bf16 v[8:11], v[36:39], v[64:71], v1
s_waitcnt lgkmcnt(3)
ds_read_b128 v[64:67], v2 offset:8192
s_waitcnt lgkmcnt(3)
v_smfmac_f32_16x16x64_bf16 v[12:15], v[36:39], a[152:159], v1
ds_read_b128 v[68:71], v2 offset:9216
s_waitcnt lgkmcnt(3)
ds_read_b128 v[36:39], v0 offset:3072
v_smfmac_f32_16x16x64_bf16 v[20:23], v[40:43], v[80:87], v1
s_add_u32 s17, s17, 1
ds_read_b128 v[84:87], v2 offset:11264
v_add_f32 v8, v8, v10
v_smfmac_f32_16x16x64_bf16 v[16:19], v[40:43], a[160:167], v1
s_waitcnt lgkmcnt(4)
ds_read_b128 v[80:83], v2 offset:10240
v_add_f32 v9, v9, v11
v_add_f32 v13, v13, v15
v_add_f32 v12, v12, v14
v_mul_f32 v13, s34, v13
v_mul_f32 v8, s34, v8
v_smfmac_f32_16x16x64_bf16 v[16:19], v[32:35], a[168:175], v1
s_add_u32 s21, s21, 10240
ds_read_b128 v[40:43], v0 offset:7168
v_mul_f32 v9, s34, v9
v_smfmac_f32_16x16x64_bf16 v[20:23], v[32:35], a[176:183], v1
s_waitcnt lgkmcnt(3)
ds_read_b128 v[32:35], v0 offset:2048
v_mul_f32 v12, s34, v12
v_smfmac_f32_16x16x64_bf16 v[16:19], v[36:39], v[64:71], v1
s_add_u32 s33, s17, 2
ds_read_b128 v[64:67], v2 offset:12288
s_waitcnt vmcnt(3)
ds_read_b128 v[68:71], v2 offset:13312
v_cvt_pk_bf16_f32 v8, v8, v9
v_cvt_pk_bf16_f32 v12, v12, v13
v_smfmac_f32_16x16x64_bf16 v[20:23], v[36:39], a[184:191], v1
s_waitcnt lgkmcnt(4)
ds_read_b128 v[36:39], v0 offset:6144
ds_write2_b32 v3, v8, v12 offset0:0 offset1:128
s_waitcnt lgkmcnt(5)
v_smfmac_f32_16x16x64_bf16 v[16:19], v[40:43], v[72:79], v1
s_mov_b64 vcc, s[40:41]
ds_read_b128 v[72:75], v2 offset:14336
v_smfmac_f32_16x16x64_bf16 v[20:23], v[40:43], v[80:87], v1
s_waitcnt lgkmcnt(5)
ds_read_b128 v[40:43], v0 offset:9216
s_waitcnt lgkmcnt(5)
ds_read_b128 v[76:79], v2 offset:15360
v_smfmac_f32_16x16x64_bf16 v[16:19], v[32:35], a[192:199], v1
s_waitcnt lgkmcnt(4)
ds_read_b128 v[84:87], v2 offset:17408
v_smfmac_f32_16x16x64_bf16 v[20:23], v[32:35], a[200:207], v1
ds_read_b128 v[32:35], v0 offset:8192
s_waitcnt lgkmcnt(5)
ds_read_b128 v[80:83], v2 offset:16384
v_smfmac_f32_16x16x64_bf16 v[16:19], v[36:39], v[64:71], v1
s_barrier
ds_read_b64_tr_b16 v[10:11], v4 offset:512
v_smfmac_f32_16x16x64_bf16 v[20:23], v[36:39], a[208:215], v1
s_waitcnt lgkmcnt(4)
ds_read_b64_tr_b16 v[8:9], v4 offset:0
ds_read_b64_tr_b16 v[12:13], v4 offset:1024
v_smfmac_f32_16x16x64_bf16 v[20:23], v[40:43], a[216:223], v1
ds_read_b64_tr_b16 v[14:15], v4 offset:1536
ds_read_b128 v[36:39], v0 offset:9216
v_smfmac_f32_16x16x64_bf16 v[16:19], v[40:43], v[72:79], v1
s_waitcnt lgkmcnt(6)
ds_read_b128 v[64:67], v2 offset:18432
ds_read_b128 v[68:71], v2 offset:19456
v_smfmac_f32_16x16x64_bf16 v[16:19], v[32:35], a[224:231], v1
s_waitcnt lgkmcnt(7)
ds_read_b128 v[76:79], v2 offset:21504
ds_read_b128 v[40:43], v0 offset:8192
v_smfmac_f32_16x16x64_bf16 v[20:23], v[32:35], v[80:87], v1
s_waitcnt lgkmcnt(7)
ds_read_b128 v[72:75], v2 offset:20480
ds_read_b128 v[32:35], v0 offset:0
v_mfma_f32_16x16x32_bf16 v[44:47], v[48:51], v[8:11], 0
s_waitcnt lgkmcnt(7)
ds_read_b128 v[84:87], v2 offset:23552
v_add_f32 v16, v16, v18
v_add_f32 v17, v17, v19
v_mfma_f32_16x16x32_bf16 v[44:47], v[52:55], v[12:15], v[44:47]
s_waitcnt lgkmcnt(7)
v_bfe_u32 v48, v0, 5, 1
v_cvt_pk_bf16_f32 v16, v16, v17
v_add_f32 v20, v20, v22
v_add_f32 v21, v21, v23
v_cvt_pk_bf16_f32 v20, v20, v21
v_lshl_add_u32 v48, v48, 3, v5
v_smfmac_f32_16x16x64_bf16 v[28:31], v[36:39], a[232:239], v1
s_waitcnt lgkmcnt(5)
ds_write2_b32 v3, v16, v20 offset0:1 offset1:129
v_cndmask_b32_dpp v44, v46, v44, vcc quad_perm:[0,1,0,1] row_mask:0xf bank_mask:0xf
v_cndmask_b32_dpp v45, v47, v45, vcc quad_perm:[0,1,0,1] row_mask:0xf bank_mask:0xf
v_xor_b32 v48, 128, v48
v_smfmac_f32_16x16x64_bf16 v[24:27], v[36:39], v[64:71], v1
s_waitcnt lgkmcnt(4)
ds_write_b64 v48, v[44:45] offset:6656
v_smfmac_f32_16x16x64_bf16 v[24:27], v[40:43], a[240:247], v1
s_waitcnt lgkmcnt(3)
global_load_dwordx4 v[64:67], v0, s[76:77] offset:0 sc1
ds_read_b128 v[80:83], v2 offset:22528
v_smfmac_f32_16x16x64_bf16 v[28:31], v[40:43], v[72:79], v1
ds_read_b128 v[36:39], v0 offset:4096
global_load_dwordx4 v[68:71], v0, s[76:77] offset:1024 sc1
v_smfmac_f32_16x16x64_bf16 v[24:27], v[32:35], a[248:255], v1
global_load_dwordx4 v[72:75], v0, s[76:77] offset:2048 sc1
ds_read_b128 v[40:43], v0 offset:3072
v_smfmac_f32_16x16x64_bf16 v[28:31], v[32:35], v[88:95], v1
s_waitcnt lgkmcnt(3)
ds_read_b128 v[32:35], v0 offset:7168
s_barrier
ds_read_b128 v[48:51], v6 offset:6144
s_waitcnt lgkmcnt(3)
v_smfmac_f32_16x16x64_bf16 v[28:31], v[36:39], v[96:103], v1
ds_read_b128 v[52:55], v6 offset:7168
v_smfmac_f32_16x16x64_bf16 v[24:27], v[36:39], v[80:87], v1
s_waitcnt lgkmcnt(3)
ds_read_b128 v[36:39], v0 offset:2048
ds_read_b64_tr_b16 v[8:9], v4 offset:0
v_smfmac_f32_16x16x64_bf16 v[24:27], v[40:43], v[104:111], v1
s_waitcnt lgkmcnt(4)
ds_read_b64_tr_b16 v[10:11], v4 offset:512
global_load_dwordx4 v[76:79], v0, s[76:77] offset:3072 sc1
v_smfmac_f32_16x16x64_bf16 v[28:31], v[40:43], v[112:119], v1
s_waitcnt lgkmcnt(4)
ds_read_b128 v[40:43], v0 offset:6144
global_load_dwordx4 v[80:83], v0, s[78:79] offset:-4096 sc1
v_smfmac_f32_16x16x64_bf16 v[24:27], v[32:35], v[120:127], v1
ds_read_b64_tr_b16 v[20:21], v4 offset:3072
global_load_dwordx4 v[84:87], v0, s[78:79] offset:-3072 sc1
v_smfmac_f32_16x16x64_bf16 v[28:31], v[32:35], v[128:135], v1
s_waitcnt lgkmcnt(4)
ds_read_b64_tr_b16 v[12:13], v4 offset:1024
v_add_f32 v50, v50, v54
v_smfmac_f32_16x16x64_bf16 v[28:31], v[36:39], v[144:151], v1
s_waitcnt vmcnt(7)
ds_read_b64_tr_b16 v[16:17], v4 offset:2048
v_add_f32 v48, v48, v52
v_smfmac_f32_16x16x64_bf16 v[24:27], v[36:39], v[136:143], v1
s_waitcnt lgkmcnt(3)
ds_read_b64_tr_b16 v[14:15], v4 offset:1536
v_add_f32 v49, v49, v53
v_smfmac_f32_16x16x64_bf16 v[28:31], v[40:43], v[160:167], v1
s_min_u32 s33, s33, s32
ds_read_b64_tr_b16 v[18:19], v4 offset:2560
v_add_f32 v51, v51, v55
v_smfmac_f32_16x16x64_bf16 v[24:27], v[40:43], v[152:159], v1
s_waitcnt lgkmcnt(3)
ds_read_b64_tr_b16 v[22:23], v4 offset:3584
v_exp_f32 v51, v51
v_exp_f32 v50, v50
v_mfma_f32_16x16x32_bf16 v[44:47], v[8:11], v[8:11], 0
s_waitcnt lgkmcnt(2)
v_exp_f32 v49, v49
v_exp_f32 v48, v48
v_mfma_f32_16x16x32_bf16 v[44:47], v[12:15], v[12:15], v[44:47]
s_waitcnt lgkmcnt(1)
v_cvt_pk_bf16_f32 v54, v48, v49
v_cvt_pk_bf16_f32 v55, v50, v51
v_mfma_f32_16x16x32_bf16 v[44:47], v[16:19], v[16:19], v[44:47]
s_waitcnt lgkmcnt(0)
v_mov_b32_dpp v49, v55 quad_perm:[0,1,0,1] row_mask:0xf bank_mask:0xf
v_mov_b32_dpp v50, v54 quad_perm:[2,3,2,3] row_mask:0xf bank_mask:0xf
v_mfma_f32_16x16x32_bf16 v[44:47], v[20:23], v[20:23], v[44:47]
s_nop 0
v_mov_b32_dpp v48, v54 quad_perm:[0,1,0,1] row_mask:0xf bank_mask:0xf
v_mov_b32_dpp v51, v55 quad_perm:[2,3,2,3] row_mask:0xf bank_mask:0xf
v_mov_b64 v[20:21], s[44:45]
v_mov_b64 v[22:23], s[44:45]
v_cvt_pk_bf16_f32 v24, v24, v25
v_mfma_f32_16x16x32_bf16 v[12:15], v[60:63], v[48:51], 0
s_add_u32 s27, s20, 524288
v_exp_f32_dpp v45, v47 quad_perm:[0,1,0,1] row_mask:0xf bank_mask:0xf
v_mfma_f32_16x16x32_bf16 v[8:11], v[56:59], v[48:51], 0
v_exp_f32_dpp v44, v46 quad_perm:[0,1,0,1] row_mask:0xf bank_mask:0xf
v_mfma_f32_16x16x32_bf16 v[16:19], v[20:23], v[48:51], 0
v_cvt_pk_bf16_f32 v53, v44, v45
v_cvt_pk_bf16_f32 v25, v26, v27
v_cvt_pk_bf16_f32 v52, v44, v45
v_cvt_pk_bf16_f32 v26, v28, v29
v_cvt_pk_bf16_f32 v27, v30, v31
v_mfma_f32_16x16x16_bf16 v[8:11], v[24:25], v[52:53], v[8:11]
v_mov_b64 v[54:55], s[46:47]
v_mov_b64 v[42:43], 0
v_mfma_f32_16x16x16_bf16 v[12:15], v[26:27], v[52:53], v[12:15]
s_waitcnt vmcnt(4)
ds_read_b128 v[28:31], v0 offset:31744
v_bfe_u32 v32, v0, 5, 1
v_mfma_f32_16x16x16_bf16 v[16:19], v[54:55], v[52:53], v[16:19]
s_nop 0
v_mov_b64 v[36:37], 0
v_lshl_add_u32 v32, v32, 3, v5
v_mov_b64 v[38:39], 0
v_cndmask_b32 v9, v13, v9, s[40:41]
v_cndmask_b32 v11, v15, v11, s[40:41]
v_cndmask_b32 v8, v12, v8, s[40:41]
v_cndmask_b32 v10, v14, v10, s[40:41]
v_rcp_f32 v18, v16
v_subrev_u32 v17, s36, v16
v_mul_f32 v9, v9, v18
v_mul_f32 v10, v10, v18
v_mul_f32 v8, v8, v18
v_mul_f32 v11, v11, v18
v_cvt_pk_bf16_f32 v13, v10, v11
v_cvt_pk_bf16_f32 v12, v8, v9
v_cmp_lt_u32 vcc, s37, v17
s_cbranch_vccnz rare_10028
back_10029:
ds_write_b64 v32, v[12:13] offset:512
v_mov_b32_dpp v9, v13 quad_perm:[0,1,0,1] row_mask:0xf bank_mask:0xf
v_mov_b32_dpp v8, v12 quad_perm:[0,1,0,1] row_mask:0xf bank_mask:0xf
v_mov_b32_dpp v11, v13 quad_perm:[2,3,2,3] row_mask:0xf bank_mask:0xf
v_mov_b32_dpp v10, v12 quad_perm:[2,3,2,3] row_mask:0xf bank_mask:0xf
v_mov_b64 v[32:33], 0
v_mov_b64 v[54:55], 0
v_smfmac_f32_16x16x64_bf16 v[36:39], v[8:11], v[64:71], v1
s_waitcnt vmcnt(2)
global_load_dwordx4 v[64:67], v0, s[74:75] offset:-4096 sc1
ds_read_b128 v[24:27], v0 offset:30720
global_load_dwordx4 v[68:71], v0, s[74:75] offset:-3072 sc1
ds_read_b128 v[20:23], v0 offset:29696
s_waitcnt lgkmcnt(3)
ds_read_b128 v[16:19], v0 offset:28672
s_waitcnt lgkmcnt(3)
v_mov_b64 v[40:41], 0
v_mov_b64 v[52:53], 0
s_barrier
ds_read_b128 v[56:59], v5 offset:0
v_smfmac_f32_16x16x64_bf16 v[40:43], v[8:11], v[72:79], v1
s_add_u32 s42, s4, s20
ds_read_b128 v[60:63], v5 offset:1536
v_mov_b64 v[34:35], 0
v_smfmac_f32_16x16x64_bf16 v[52:55], v[8:11], v[176:183], v1
s_waitcnt vmcnt(2)
ds_read_b128 v[12:15], v5 offset:1024
v_mov_b64 v[48:49], 0
v_mov_b64 v[50:51], 0
v_smfmac_f32_16x16x64_bf16 v[32:35], v[8:11], v[80:87], v1
s_waitcnt lgkmcnt(3)
ds_read_b128 v[80:83], v0 offset:32768
global_load_dwordx4 v[72:75], v0, s[74:75] offset:-2048 sc1
v_smfmac_f32_16x16x64_bf16 v[48:51], v[8:11], v[168:175], v1
s_waitcnt lgkmcnt(3)
ds_read_b128 v[84:87], v0 offset:33792
global_load_dwordx4 v[76:79], v0, s[74:75] offset:-1024 sc1
v_smfmac_f32_16x16x64_bf16 v[36:39], v[56:59], v[16:23], v1
s_waitcnt lgkmcnt(3)
ds_read_b128 v[20:23], v0 offset:35840
v_bfe_u32 v45, v0, 1, 7
v_smfmac_f32_16x16x64_bf16 v[36:39], v[60:63], v[24:31], v1
s_waitcnt lgkmcnt(3)
ds_read_b128 v[24:27], v0 offset:36864
v_lshrrev_b32 v44, 8, v0
v_smfmac_f32_16x16x64_bf16 v[36:39], v[12:15], v[184:191], v1
ds_read_b128 v[16:19], v0 offset:34816
v_smfmac_f32_16x16x64_bf16 v[40:43], v[56:59], v[192:199], v1
s_waitcnt lgkmcnt(3)
ds_read_b128 v[28:31], v0 offset:37888
v_lshl_or_b32 v44, v44, 12, v45
v_smfmac_f32_16x16x64_bf16 v[40:43], v[60:63], v[80:87], v1
s_nop 0
ds_read_b128 v[80:83], v0 offset:38912
v_cvt_pk_bf16_f32 v36, v36, v37
v_and_or_b32 v36, v36, -2, s18
v_smfmac_f32_16x16x64_bf16 v[40:43], v[12:15], v[200:207], v1
s_waitcnt lgkmcnt(3)
ds_read_b128 v[84:87], v0 offset:39936
v_cvt_pk_bf16_f32 v37, v38, v39
v_smfmac_f32_16x16x64_bf16 v[52:55], v[56:59], v[216:223], v1
s_waitcnt lgkmcnt(3)
global_store_dwordx2 v44, v[36:37], s[48:49]
v_smfmac_f32_16x16x64_bf16 v[48:51], v[56:59], v[16:23], v1
s_waitcnt lgkmcnt(2)
v_cvt_pk_bf16_f32 v40, v40, v41
v_smfmac_f32_16x16x64_bf16 v[48:51], v[60:63], v[24:31], v1
v_cvt_pk_bf16_f32 v41, v42, v43
v_smfmac_f32_16x16x64_bf16 v[48:51], v[12:15], v[208:215], v1
v_and_or_b32 v40, v40, -2, s18
v_smfmac_f32_16x16x64_bf16 v[32:35], v[56:59], v[232:239], v1
s_waitcnt lgkmcnt(0)
global_store_dwordx2 v44, v[40:41], s[50:51]
s_nop 0
v_smfmac_f32_16x16x64_bf16 v[32:35], v[60:63], v[240:247], v1
s_nop 1
v_cvt_pk_bf16_f32 v48, v48, v49
v_smfmac_f32_16x16x64_bf16 v[32:35], v[12:15], v[248:255], v1
s_mov_b64 s[66:67], s[70:71]
v_and_or_b32 v48, v48, -2, s18
v_cvt_pk_bf16_f32 v49, v50, v51
v_smfmac_f32_16x16x64_bf16 v[52:55], v[60:63], v[80:87], v1
global_store_dwordx2 v44, v[48:49], s[52:53]
v_smfmac_f32_16x16x64_bf16 v[52:55], v[12:15], v[224:231], v1
s_nop 1
v_cvt_pk_bf16_f32 v32, v32, v33
s_addc_u32 s43, s5, 0
v_and_or_b32 v32, v32, -2, s18
v_cvt_pk_bf16_f32 v33, v34, v35
s_nop 1
v_cvt_pk_bf16_f32 v52, v52, v53
v_and_or_b32 v52, v52, -2, s18
s_mov_b32 s30, 0
v_cvt_pk_bf16_f32 v53, v54, v55
global_store_dwordx2 v44, v[52:53], s[54:55]
global_store_dwordx2 v44, v[32:33], s[56:57]
v_bfe_u32 v24, v0, 6, 1
v_lshlrev_b32 v24, 4, v24
v_mov_b32 v25, 0x3f80
v_lshlrev_b32 v24, v24, v25
v_bfe_i32 v25, v0, 4, 1
v_and_b32 v45, v24, v25
v_and_b32 v47, v24, v25
v_xor_b32 v44, v24, v45
v_xor_b32 v46, v24, v45
v_and_b32 v28, 32, v0
v_bfe_u32 v29, v0, 6, 1
v_lshl_add_u32 v28, v29, 8, v28
v_bfe_u32 v29, v0, 8, 1
v_lshl_add_u32 v28, v29, 4, v28
v_bfe_u32 v29, v0, 4, 1
v_lshl_add_u32 v28, v29, 3, v28
v_bfe_u32 v7, v0, 2, 3
v_add_u32 v7, s22, v7
s_mov_b32 exec_hi, 0
v_and_b32 v7, 255, v0
v_lshl_add_u32 v7, v7, 3, s27
s_mov_b32 exec_hi, -1
s_nop 15
s_nop 15
s_nop 15
s_nop 15
s_nop 0
global_load_dwordx4 v[8:11], v0, s[62:63] offset:0 sc1
global_load_dwordx4 v[12:15], v0, s[62:63] offset:1024 sc1
global_load_dwordx4 v[16:19], v0, s[62:63] offset:2048 sc1
global_load_dwordx4 v[20:23], v0, s[62:63] offset:3072 sc1
s_nop 15
s_nop 1
global_load_dwordx4 v[56:59], v0, s[74:75] offset:0 sc1
global_load_dwordx4 v[60:63], v0, s[74:75] offset:1024 sc1
global_load_dwordx4 v[80:83], v0, s[74:75] offset:2048 sc1
global_load_dwordx4 v[84:87], v0, s[74:75] offset:3072 sc1
v_mov_b64 v[40:41], 0
v_mov_b64 v[42:43], 0
s_waitcnt vmcnt(6)
s_nop 0
v_smfmac_f32_16x16x64_bf16 v[40:43], v[44:47], v[8:15], v1
v_bitop3_b32 v24, v8, v10, s18 bitop3:0x7e
v_bitop3_b32 v25, v12, v14, s18 bitop3:0x7e
s_waitcnt vmcnt(4)
v_smfmac_f32_16x16x64_bf16 v[40:43], v[44:47], v[16:23], v1
v_bitop3_b32 v26, v16, v18, s18 bitop3:0x7e
v_bitop3_b32 v27, v20, v22, s18 bitop3:0x7e
v_or3_b32 v24, v24, v25, v26
v_bitop3_b32 v24, v24, v27, 1 bitop3:0xa8
v_cmp_ne_u32 vcc, 0, v24
s_cbranch_vccnz red_10035
red_10035_ok:
s_nop 1
v_add_f32_dpp v40, v40, v40 row_ror:8 row_mask:0xf bank_mask:0xf
v_add_f32_dpp v41, v41, v41 row_ror:8 row_mask:0xf bank_mask:0xf
v_add_f32_dpp v42, v42, v42 row_ror:8 row_mask:0xf bank_mask:0xf
v_add_f32_dpp v43, v43, v43 row_ror:8 row_mask:0xf bank_mask:0xf
v_cvt_pk_bf16_f32 v40, v40, v41
v_cvt_pk_bf16_f32 v41, v42, v43
v_and_or_b32 v40, v40, -2, s18
s_mov_b64 exec, 0x00ff00ff
global_store_dwordx2 v28, v[40:41], s[64:65]
s_mov_b64 exec, -1
v_mov_b64 v[8:9], 0
v_mov_b64 v[10:11], 0
v_mov_b64 v[12:13], 0
v_mov_b64 v[14:15], 0
v_mov_b64 v[16:17], 0
v_mov_b64 v[18:19], 0
v_mov_b64 v[20:21], 0
v_mov_b64 v[22:23], 0
v_mov_b64 v[24:25], 0
v_mov_b64 v[26:27], 0
v_mov_b64 v[28:29], 0
v_mov_b64 v[30:31], 0
s_nop 15
s_nop 6
s_barrier
global_load_dwordx4 v[32:35], v0, s[66:67] offset:-4096 sc1
s_nop 10
global_load_dwordx4 v[36:39], v0, s[66:67] offset:0 sc1
s_nop 10
global_load_dwordx4 v[40:43], v0, s[68:69] offset:0 sc1
s_barrier
global_load_dwordx4 v[48:51], v0, s[42:43] offset:0 nt sc1
global_load_dwordx4 v[52:55], v0, s[42:43] offset:1024 nt sc1
s_mov_b32 s30, 0
s_cmp_eq_u32 s17, s31
s_cbranch_scc0 gather_10027
s_branch exit_10030
rt_10032:
global_load_dwordx4 v[32:35], v0, s[66:67] offset:-4096 sc1
global_load_dwordx4 v[36:39], v0, s[66:67] offset:0 sc1
global_load_dwordx4 v[40:43], v0, s[68:69] offset:0 sc1
s_add_u32 s30, s30, 1
s_cmp_gt_u32 s30, 262144
s_cbranch_scc1 L_fail
v_mov_b64 v[8:9], 0
v_mov_b64 v[10:11], 0
v_mov_b64 v[12:13], 0
v_mov_b64 v[14:15], 0
v_mov_b64 v[16:17], 0
v_mov_b64 v[18:19], 0
v_mov_b64 v[20:21], 0
v_mov_b64 v[22:23], 0
v_mov_b64 v[24:25], 0
v_mov_b64 v[26:27], 0
v_mov_b64 v[28:29], 0
v_mov_b64 v[30:31], 0
s_waitcnt vmcnt(2)
v_bitop3_b32 v44, v32, v34, s18 bitop3:0x7e
s_waitcnt vmcnt(1)
v_bitop3_b32 v45, v36, v38, s18 bitop3:0x7e
v_or_b32 v44, v44, v45
s_waitcnt vmcnt(0)
v_bitop3_b32 v45, v40, v42, s18 bitop3:0x7e
v_bitop3_b32 v44, v44, v45, s19 bitop3:0xa8
v_cmp_ne_u32 vcc, 0, v44
s_cbranch_vccnz rt_10032
s_branch rt_10032_b
red_10035:
global_load_dwordx4 v[8:11], v0, s[62:63] offset:0 sc1
global_load_dwordx4 v[12:15], v0, s[62:63] offset:1024 sc1
global_load_dwordx4 v[16:19], v0, s[62:63] offset:2048 sc1
global_load_dwordx4 v[20:23], v0, s[62:63] offset:3072 sc1
s_add_u32 s30, s30, 1
s_cmp_gt_u32 s30, 262144
s_cbranch_scc1 L_fail
v_mov_b64 v[40:41], 0
v_mov_b64 v[42:43], 0
s_waitcnt vmcnt(2)
s_nop 0
v_smfmac_f32_16x16x64_bf16 v[40:43], v[44:47], v[8:15], v1
v_bitop3_b32 v24, v8, v10, s18 bitop3:0x7e
v_bitop3_b32 v25, v12, v14, s18 bitop3:0x7e
s_waitcnt vmcnt(0)
v_smfmac_f32_16x16x64_bf16 v[40:43], v[44:47], v[16:23], v1
v_bitop3_b32 v26, v16, v18, s18 bitop3:0x7e
v_bitop3_b32 v27, v20, v22, s18 bitop3:0x7e
v_or3_b32 v24, v24, v25, v26
v_bitop3_b32 v24, v24, v27, 1 bitop3:0xa8
v_cmp_ne_u32 vcc, 0, v24
s_cbranch_vccnz red_10035
s_branch red_10035_ok
rare_10028:
ds_read_b128 v[48:51], v6 offset:6144
ds_read_b128 v[52:55], v6 offset:7168
s_waitcnt lgkmcnt(0)
v_add_f32 v48, v48, v52
v_add_f32 v49, v49, v53
v_add_f32 v50, v50, v54
v_add_f32 v51, v51, v55
v_mov_b32_dpp v46, v46 quad_perm:[0,1,0,1] row_mask:0xf bank_mask:0xf
v_mov_b32_dpp v47, v47 quad_perm:[0,1,0,1] row_mask:0xf bank_mask:0xf
v_max3_f32 v19, v48, v49, v50
v_max3_f32 v19, v19, v51, v46
v_max_f32 v19, v19, v47
s_nop 1
v_max_f32_dpp v19, v19, v19 quad_perm:[2,3,0,1] row_mask:0xf bank_mask:0xf
v_mov_b32 v44, v19
s_nop 1
v_permlane32_swap_b32 v19, v44
v_max_f32 v19, v19, v44
v_mov_b32 v44, v19
s_nop 1
v_permlane16_swap_b32 v19, v44
v_max_f32 v19, v19, v44
v_sub_f32 v48, v48, v19
v_sub_f32 v49, v49, v19
v_sub_f32 v50, v50, v19
v_sub_f32 v51, v51, v19
v_sub_f32 v46, v46, v19
v_sub_f32 v47, v47, v19
v_exp_f32 v48, v48
v_exp_f32 v49, v49
v_exp_f32 v50, v50
v_exp_f32 v51, v51
v_cvt_pk_bf16_f32 v54, v48, v49
v_cvt_pk_bf16_f32 v55, v50, v51
s_nop 0
v_mov_b32_dpp v48, v54 quad_perm:[0,1,0,1] row_mask:0xf bank_mask:0xf
v_mov_b32_dpp v49, v55 quad_perm:[0,1,0,1] row_mask:0xf bank_mask:0xf
v_mov_b32_dpp v50, v54 quad_perm:[2,3,2,3] row_mask:0xf bank_mask:0xf
v_mov_b32_dpp v51, v55 quad_perm:[2,3,2,3] row_mask:0xf bank_mask:0xf
v_mov_b64 v[20:21], s[44:45]
v_mov_b64 v[22:23], s[44:45]
v_mfma_f32_16x16x32_bf16 v[8:11], v[56:59], v[48:51], 0
v_mfma_f32_16x16x32_bf16 v[12:15], v[60:63], v[48:51], 0
v_mfma_f32_16x16x32_bf16 v[16:19], v[20:23], v[48:51], 0
v_mov_b64 v[54:55], s[46:47]
v_exp_f32_dpp v44, v46 quad_perm:[0,1,0,1] row_mask:0xf bank_mask:0xf
v_exp_f32_dpp v45, v47 quad_perm:[0,1,0,1] row_mask:0xf bank_mask:0xf
s_nop 0
v_cvt_pk_bf16_f32 v52, v44, v45
v_cvt_pk_bf16_f32 v53, v44, v45
s_nop 1
v_mfma_f32_16x16x16_bf16 v[16:19], v[54:55], v[52:53], v[16:19]
v_mfma_f32_16x16x16_bf16 v[8:11], v[24:25], v[52:53], v[8:11]
v_mfma_f32_16x16x16_bf16 v[12:15], v[26:27], v[52:53], v[12:15]
s_nop 5
v_rcp_f32 v18, v16
s_nop 0
v_cndmask_b32 v8, v12, v8, s[40:41]
v_mul_f32 v8, v8, v18
v_cndmask_b32 v9, v13, v9, s[40:41]
v_mul_f32 v9, v9, v18
v_cndmask_b32 v10, v14, v10, s[40:41]
v_mul_f32 v10, v10, v18
v_cndmask_b32 v11, v15, v11, s[40:41]
v_mul_f32 v11, v11, v18
v_cvt_pk_bf16_f32 v12, v8, v9
v_cvt_pk_bf16_f32 v13, v10, v11
s_branch back_10029
exit_10030:
global_load_dwordx4 v[32:35], v0, s[66:67] offset:-4096 sc1
global_load_dwordx4 v[36:39], v0, s[66:67] offset:0 sc1
global_load_dwordx4 v[40:43], v0, s[68:69] offset:0 sc1
s_add_u32 s30, s30, 1
s_cmp_gt_u32 s30, 262144
s_cbranch_scc1 L_fail
s_waitcnt vmcnt(2)
v_bitop3_b32 v44, v32, v34, s18 bitop3:0x7e
s_waitcnt vmcnt(1)
v_bitop3_b32 v45, v36, v38, s18 bitop3:0x7e
v_or_b32 v44, v44, v45
s_waitcnt vmcnt(0)
v_bitop3_b32 v46, v40, v42, s18 bitop3:0x7e
v_bitop3_b32 v44, v44, v46, s19 bitop3:0xa8
v_cmp_ne_u32 vcc, 0, v44
s_cbranch_vccnz exit_10030
s_add_u32 s35, s35, 1
s_cmp_lt_u32 s35, 2
s_cbranch_scc1 layer_10026
s_endpgm
wave_10007:
layer_10040:
s_lshl_b32 s17, s35, 6
s_mul_i32 s27, s35, 34603008
s_lshl_b32 s28, s14, 14
s_add_u32 s27, s27, s28
s_add_u32 s20, s27, 16785408
s_mul_i32 s27, s17, 10240
s_add_u32 s27, s27, s24
s_add_u32 s21, s27, s25
s_mov_b32 s19, 0
s_add_u32 s33, s17, 1
s_add_u32 s31, s17, 63
s_add_u32 s32, s17, 64
s_mov_b32 s27, s20
v_mov_b32 v7, 0
s_add_u32 s66, s4, 415744
s_addc_u32 s67, s5, 0
s_add_u32 s70, s4, 399360
s_addc_u32 s71, s5, 0
s_add_u32 s68, s4, 419840
s_addc_u32 s69, s5, 0
s_add_u32 s72, s4, 403456
s_addc_u32 s73, s5, 0
s_add_u32 s42, s4, s20
s_addc_u32 s43, s5, 0
global_load_dwordx4 v[64:67], v0, s[74:75] offset:-4096 sc1
global_load_dwordx4 v[68:71], v0, s[74:75] offset:-3072 sc1
global_load_dwordx4 v[72:75], v0, s[74:75] offset:-2048 sc1
global_load_dwordx4 v[76:79], v0, s[74:75] offset:-1024 sc1
global_load_dwordx4 v[80:83], v0, s[74:75] offset:2048 sc1
global_load_dwordx4 v[84:87], v0, s[74:75] offset:3072 sc1
global_load_dwordx4 v[56:59], v0, s[74:75] offset:0 sc1
global_load_dwordx4 v[60:63], v0, s[74:75] offset:1024 sc1
v_mov_b64 v[8:9], 0
v_mov_b64 v[10:11], 0
v_mov_b64 v[12:13], 0
v_mov_b64 v[14:15], 0
v_mov_b64 v[16:17], 0
v_mov_b64 v[18:19], 0
v_mov_b64 v[20:21], 0
v_mov_b64 v[22:23], 0
v_mov_b64 v[24:25], 0
v_mov_b64 v[26:27], 0
v_mov_b64 v[28:29], 0
v_mov_b64 v[30:31], 0
s_barrier
global_load_dwordx4 v[48:51], v0, s[42:43] offset:0 nt sc1
global_load_dwordx4 v[52:55], v0, s[42:43] offset:1024 nt sc1
v_bfe_u32 v7, v0, 2, 3
v_add_u32 v7, s22, v7
s_mov_b32 exec_hi, 0
v_and_b32 v7, 255, v0
v_lshl_add_u32 v7, v7, 3, s27
s_mov_b32 exec_hi, -1
global_load_dwordx4 v[32:35], v0, s[66:67] offset:-4096 sc1
global_load_dwordx4 v[36:39], v0, s[66:67] offset:0 sc1
v_mov_b32 v45, -1
s_mov_b32 s30, 0
s_waitcnt vmcnt(0)
.p2align 6
gather_10041:
s_waitcnt vmcnt(3)
rt_10046_b:
v_smfmac_f32_16x16x64_bf16 v[16:19], v[32:35], v[56:63], v1
ds_write_b128 v0, v[32:35] offset:2048
v_smfmac_f32_16x16x64_bf16 v[8:11], v[32:35], v[64:71], v1
v_bitop3_b32 v44, v32, v34, s18 bitop3:0x7e
v_smfmac_f32_16x16x64_bf16 v[12:15], v[32:35], v[72:79], v1
s_waitcnt vmcnt(2)
ds_write_b128 v0, v[36:39] offset:6144
v_bitop3_b32 v45, v36, v38, s18 bitop3:0x7e
v_bitop3_b32 v44, v44, v45, s19 bitop3:0xa8
v_smfmac_f32_16x16x64_bf16 v[20:23], v[32:35], v[80:87], v1
v_cmp_ne_u32 vcc, 0, v44
v_smfmac_f32_16x16x64_bf16 v[20:23], v[36:39], a[40:47], v1
s_cbranch_vccnz rt_10046
global_load_dwordx4 v[64:67], v0, s[76:77] offset:-4096 sc1
v_smfmac_f32_16x16x64_bf16 v[24:27], v[32:35], a[0:7], v1
ds_read_b128 v[84:87], v2 offset:1024
global_load_dwordx4 v[68:71], v0, s[76:77] offset:-3072 sc1
v_smfmac_f32_16x16x64_bf16 v[16:19], v[36:39], a[32:39], v1
global_load_dwordx4 v[72:75], v0, s[76:77] offset:-2048 sc1
ds_read_b128 v[80:83], v2 offset:0
global_load_dwordx4 v[76:79], v0, s[76:77] offset:-1024 sc1
v_smfmac_f32_16x16x64_bf16 v[28:31], v[32:35], a[8:15], v1
s_waitcnt lgkmcnt(2)
s_barrier
ds_read_b128 v[40:43], v0 offset:3072
v_smfmac_f32_16x16x64_bf16 v[12:15], v[36:39], a[24:31], v1
s_waitcnt lgkmcnt(2)
ds_read_b128 v[44:47], v0 offset:7168
v_smfmac_f32_16x16x64_bf16 v[24:27], v[36:39], a[48:55], v1
ds_read_b128 v[32:35], v0 offset:0
s_waitcnt lgkmcnt(3)
v_smfmac_f32_16x16x64_bf16 v[28:31], v[36:39], v[80:87], v1
s_xor_b32 s18, s18, 1
ds_read_b128 v[80:83], v2 offset:2048
s_mov_b32 s19, 1
v_smfmac_f32_16x16x64_bf16 v[8:11], v[36:39], a[16:23], v1
ds_read_b128 v[84:87], v2 offset:3072
s_waitcnt lgkmcnt(4)
v_smfmac_f32_16x16x64_bf16 v[8:11], v[40:43], a[56:63], v1
ds_read_b128 v[36:39], v0 offset:4096
s_waitcnt lgkmcnt(4)
v_smfmac_f32_16x16x64_bf16 v[8:11], v[44:47], a[72:79], v1
global_load_dwordx4 v[56:59], v0, s[42:43] offset:2048 nt sc1
v_smfmac_f32_16x16x64_bf16 v[12:15], v[40:43], a[64:71], v1
ds_read_b128 v[40:43], v0 offset:1024
s_waitcnt lgkmcnt(4)
v_smfmac_f32_16x16x64_bf16 v[12:15], v[44:47], a[80:87], v1
ds_read_b128 v[44:47], v0 offset:5120
s_waitcnt lgkmcnt(3)
v_smfmac_f32_16x16x64_bf16 v[12:15], v[32:35], v[80:87], v1
ds_read_b128 v[84:87], v2 offset:5120
v_smfmac_f32_16x16x64_bf16 v[8:11], v[32:35], a[88:95], v1
ds_read_b128 v[80:83], v2 offset:4096
s_waitcnt lgkmcnt(4)
v_smfmac_f32_16x16x64_bf16 v[12:15], v[36:39], a[104:111], v1
ds_read_b128 v[32:35], v0 offset:8192
s_waitcnt lgkmcnt(4)
v_smfmac_f32_16x16x64_bf16 v[8:11], v[36:39], a[96:103], v1
s_add_u32 s20, s20, 524288
ds_read_b128 v[36:39], v0 offset:9216
v_smfmac_f32_16x16x64_bf16 v[12:15], v[40:43], a[120:127], v1
s_waitcnt lgkmcnt(4)
global_load_dwordx4 v[60:63], v0, s[42:43] offset:3072 nt sc1
v_smfmac_f32_16x16x64_bf16 v[8:11], v[40:43], a[112:119], v1
s_waitcnt lgkmcnt(3)
s_waitcnt lgkmcnt(2)
ds_read_b128 v[40:43], v0 offset:3072
v_smfmac_f32_16x16x64_bf16 v[12:15], v[44:47], v[80:87], v1
ds_read_b128 v[84:87], v2 offset:7168
s_waitcnt lgkmcnt(3)
v_smfmac_f32_16x16x64_bf16 v[12:15], v[32:35], a[144:151], v1
ds_read_b128 v[80:83], v2 offset:6144
s_waitcnt lgkmcnt(3)
v_smfmac_f32_16x16x64_bf16 v[8:11], v[44:47], a[128:135], v1
s_waitcnt vmcnt(5)
global_load_dword v7, v7, s[4:5] sc1
v_smfmac_f32_16x16x64_bf16 v[8:11], v[32:35], a[136:143], v1
s_waitcnt vmcnt(5)
ds_read_b128 v[32:35], v0 offset:7168
v_smfmac_f32_16x16x64_bf16 v[8:11], v[36:39], v[64:71], v1
s_waitcnt lgkmcnt(3)
ds_read_b128 v[64:67], v2 offset:8192
s_waitcnt lgkmcnt(3)
v_smfmac_f32_16x16x64_bf16 v[12:15], v[36:39], a[152:159], v1
ds_read_b128 v[68:71], v2 offset:9216
s_waitcnt lgkmcnt(3)
ds_read_b128 v[36:39], v0 offset:0
v_smfmac_f32_16x16x64_bf16 v[20:23], v[40:43], v[80:87], v1
s_add_u32 s17, s17, 1
ds_read_b128 v[84:87], v2 offset:11264
v_add_f32 v8, v8, v10
v_smfmac_f32_16x16x64_bf16 v[16:19], v[40:43], a[160:167], v1
s_waitcnt lgkmcnt(4)
ds_read_b128 v[80:83], v2 offset:10240
v_add_f32 v9, v9, v11
v_add_f32 v13, v13, v15
v_add_f32 v12, v12, v14
v_mul_f32 v13, s34, v13
v_mul_f32 v8, s34, v8
v_smfmac_f32_16x16x64_bf16 v[16:19], v[32:35], a[168:175], v1
s_add_u32 s21, s21, 10240
ds_read_b128 v[40:43], v0 offset:4096
v_mul_f32 v9, s34, v9
v_smfmac_f32_16x16x64_bf16 v[20:23], v[32:35], a[176:183], v1
s_waitcnt lgkmcnt(3)
ds_read_b128 v[32:35], v0 offset:1024
v_mul_f32 v12, s34, v12
v_smfmac_f32_16x16x64_bf16 v[16:19], v[36:39], v[64:71], v1
s_add_u32 s33, s17, 2
ds_read_b128 v[64:67], v2 offset:12288
s_waitcnt vmcnt(3)
ds_read_b128 v[68:71], v2 offset:13312
v_cvt_pk_bf16_f32 v8, v8, v9
v_cvt_pk_bf16_f32 v12, v12, v13
v_smfmac_f32_16x16x64_bf16 v[20:23], v[36:39], a[184:191], v1
s_waitcnt lgkmcnt(4)
ds_read_b128 v[36:39], v0 offset:5120
ds_write2_b32 v3, v8, v12 offset0:0 offset1:128
s_waitcnt lgkmcnt(5)
v_smfmac_f32_16x16x64_bf16 v[16:19], v[40:43], v[72:79], v1
s_mov_b64 vcc, s[40:41]
ds_read_b128 v[72:75], v2 offset:14336
v_smfmac_f32_16x16x64_bf16 v[20:23], v[40:43], v[80:87], v1
s_waitcnt lgkmcnt(5)
ds_read_b128 v[40:43], v0 offset:8192
s_waitcnt lgkmcnt(5)
ds_read_b128 v[76:79], v2 offset:15360
v_smfmac_f32_16x16x64_bf16 v[16:19], v[32:35], a[192:199], v1
s_waitcnt lgkmcnt(4)
ds_read_b128 v[84:87], v2 offset:17408
v_smfmac_f32_16x16x64_bf16 v[20:23], v[32:35], a[200:207], v1
ds_read_b128 v[32:35], v0 offset:9216
s_waitcnt lgkmcnt(5)
ds_read_b128 v[80:83], v2 offset:16384
v_smfmac_f32_16x16x64_bf16 v[16:19], v[36:39], v[64:71], v1
s_barrier
ds_read_b64_tr_b16 v[10:11], v4 offset:2560
v_smfmac_f32_16x16x64_bf16 v[20:23], v[36:39], a[208:215], v1
s_waitcnt lgkmcnt(4)
ds_read_b64_tr_b16 v[8:9], v4 offset:2048
ds_read_b64_tr_b16 v[12:13], v4 offset:3072
v_smfmac_f32_16x16x64_bf16 v[20:23], v[40:43], a[216:223], v1
ds_read_b64_tr_b16 v[14:15], v4 offset:3584
ds_read_b128 v[36:39], v0 offset:8192
v_smfmac_f32_16x16x64_bf16 v[16:19], v[40:43], v[72:79], v1
s_waitcnt lgkmcnt(6)
ds_read_b128 v[64:67], v2 offset:18432
ds_read_b128 v[68:71], v2 offset:19456
v_smfmac_f32_16x16x64_bf16 v[16:19], v[32:35], a[224:231], v1
s_waitcnt lgkmcnt(7)
ds_read_b128 v[76:79], v2 offset:21504
ds_read_b128 v[40:43], v0 offset:9216
v_smfmac_f32_16x16x64_bf16 v[20:23], v[32:35], v[80:87], v1
s_waitcnt lgkmcnt(7)
ds_read_b128 v[72:75], v2 offset:20480
ds_read_b128 v[32:35], v0 offset:3072
v_mfma_f32_16x16x32_bf16 v[44:47], v[48:51], v[8:11], 0
s_waitcnt lgkmcnt(7)
ds_read_b128 v[84:87], v2 offset:23552
v_add_f32 v16, v16, v18
v_add_f32 v17, v17, v19
v_mfma_f32_16x16x32_bf16 v[44:47], v[52:55], v[12:15], v[44:47]
s_waitcnt lgkmcnt(7)
v_bfe_u32 v48, v0, 5, 1
v_cvt_pk_bf16_f32 v16, v16, v17
v_add_f32 v20, v20, v22
v_add_f32 v21, v21, v23
v_cvt_pk_bf16_f32 v20, v20, v21
v_lshl_add_u32 v48, v48, 3, v5
v_smfmac_f32_16x16x64_bf16 v[28:31], v[36:39], a[232:239], v1
s_waitcnt lgkmcnt(5)
ds_write2_b32 v3, v16, v20 offset0:1 offset1:129
v_cndmask_b32_dpp v44, v46, v44, vcc quad_perm:[0,1,0,1] row_mask:0xf bank_mask:0xf
v_cndmask_b32_dpp v45, v47, v45, vcc quad_perm:[0,1,0,1] row_mask:0xf bank_mask:0xf
v_smfmac_f32_16x16x64_bf16 v[24:27], v[36:39], v[64:71], v1
s_waitcnt lgkmcnt(4)
ds_write_b64 v48, v[44:45] offset:7168
v_smfmac_f32_16x16x64_bf16 v[24:27], v[40:43], a[240:247], v1
s_waitcnt lgkmcnt(3)
global_load_dwordx4 v[64:67], v0, s[76:77] offset:0 sc1
ds_read_b128 v[80:83], v2 offset:22528
v_smfmac_f32_16x16x64_bf16 v[28:31], v[40:43], v[72:79], v1
ds_read_b128 v[36:39], v0 offset:7168
global_load_dwordx4 v[68:71], v0, s[76:77] offset:1024 sc1
v_smfmac_f32_16x16x64_bf16 v[24:27], v[32:35], a[248:255], v1
global_load_dwordx4 v[72:75], v0, s[76:77] offset:2048 sc1
ds_read_b128 v[40:43], v0 offset:0
v_smfmac_f32_16x16x64_bf16 v[28:31], v[32:35], v[88:95], v1
s_waitcnt lgkmcnt(3)
ds_read_b128 v[32:35], v0 offset:4096
s_barrier
ds_read_b128 v[48:51], v6 offset:6144
s_waitcnt lgkmcnt(3)
v_smfmac_f32_16x16x64_bf16 v[28:31], v[36:39], v[96:103], v1
ds_read_b128 v[52:55], v6 offset:7168
v_smfmac_f32_16x16x64_bf16 v[24:27], v[36:39], v[80:87], v1
s_waitcnt lgkmcnt(3)
ds_read_b128 v[36:39], v0 offset:1024
ds_read_b64_tr_b16 v[8:9], v4 offset:0
v_smfmac_f32_16x16x64_bf16 v[24:27], v[40:43], v[104:111], v1
s_waitcnt lgkmcnt(4)
ds_read_b64_tr_b16 v[10:11], v4 offset:512
global_load_dwordx4 v[76:79], v0, s[76:77] offset:3072 sc1
v_smfmac_f32_16x16x64_bf16 v[28:31], v[40:43], v[112:119], v1
s_waitcnt lgkmcnt(4)
ds_read_b128 v[40:43], v0 offset:5120
global_load_dwordx4 v[80:83], v0, s[78:79] offset:-4096 sc1
v_smfmac_f32_16x16x64_bf16 v[24:27], v[32:35], v[120:127], v1
ds_read_b64_tr_b16 v[20:21], v4 offset:3072
global_load_dwordx4 v[84:87], v0, s[78:79] offset:-3072 sc1
v_smfmac_f32_16x16x64_bf16 v[28:31], v[32:35], v[128:135], v1
s_waitcnt lgkmcnt(4)
ds_read_b64_tr_b16 v[12:13], v4 offset:1024
v_add_f32 v50, v50, v54
v_smfmac_f32_16x16x64_bf16 v[28:31], v[36:39], v[144:151], v1
s_waitcnt vmcnt(7)
ds_read_b64_tr_b16 v[16:17], v4 offset:2048
v_add_f32 v48, v48, v52
v_smfmac_f32_16x16x64_bf16 v[24:27], v[36:39], v[136:143], v1
s_waitcnt lgkmcnt(3)
ds_read_b64_tr_b16 v[14:15], v4 offset:1536
v_add_f32 v49, v49, v53
v_smfmac_f32_16x16x64_bf16 v[28:31], v[40:43], v[160:167], v1
s_min_u32 s33, s33, s32
ds_read_b64_tr_b16 v[18:19], v4 offset:2560
v_add_f32 v51, v51, v55
v_smfmac_f32_16x16x64_bf16 v[24:27], v[40:43], v[152:159], v1
s_waitcnt lgkmcnt(3)
ds_read_b64_tr_b16 v[22:23], v4 offset:3584
v_exp_f32 v51, v51
v_exp_f32 v50, v50
v_mfma_f32_16x16x32_bf16 v[44:47], v[8:11], v[8:11], 0
s_waitcnt lgkmcnt(2)
v_exp_f32 v49, v49
v_exp_f32 v48, v48
v_mfma_f32_16x16x32_bf16 v[44:47], v[12:15], v[12:15], v[44:47]
s_waitcnt lgkmcnt(1)
v_cvt_pk_bf16_f32 v54, v48, v49
v_cvt_pk_bf16_f32 v55, v50, v51
v_mfma_f32_16x16x32_bf16 v[44:47], v[16:19], v[16:19], v[44:47]
s_waitcnt lgkmcnt(0)
v_mov_b32_dpp v49, v55 quad_perm:[0,1,0,1] row_mask:0xf bank_mask:0xf
v_mov_b32_dpp v50, v54 quad_perm:[2,3,2,3] row_mask:0xf bank_mask:0xf
v_mfma_f32_16x16x32_bf16 v[44:47], v[20:23], v[20:23], v[44:47]
s_nop 0
v_mov_b32_dpp v48, v54 quad_perm:[0,1,0,1] row_mask:0xf bank_mask:0xf
v_mov_b32_dpp v51, v55 quad_perm:[2,3,2,3] row_mask:0xf bank_mask:0xf
v_mov_b64 v[20:21], s[44:45]
v_mov_b64 v[22:23], s[44:45]
v_cvt_pk_bf16_f32 v24, v24, v25
v_mfma_f32_16x16x32_bf16 v[12:15], v[60:63], v[48:51], 0
s_add_u32 s27, s20, 524288
v_exp_f32_dpp v45, v47 quad_perm:[0,1,0,1] row_mask:0xf bank_mask:0xf
v_mfma_f32_16x16x32_bf16 v[8:11], v[56:59], v[48:51], 0
v_exp_f32_dpp v44, v46 quad_perm:[0,1,0,1] row_mask:0xf bank_mask:0xf
v_mfma_f32_16x16x32_bf16 v[16:19], v[20:23], v[48:51], 0
v_cvt_pk_bf16_f32 v53, v44, v45
v_cvt_pk_bf16_f32 v25, v26, v27
v_cvt_pk_bf16_f32 v52, v44, v45
v_cvt_pk_bf16_f32 v26, v28, v29
v_cvt_pk_bf16_f32 v27, v30, v31
v_mfma_f32_16x16x16_bf16 v[8:11], v[24:25], v[52:53], v[8:11]
v_mov_b64 v[54:55], s[46:47]
v_mov_b64 v[42:43], 0
v_mfma_f32_16x16x16_bf16 v[12:15], v[26:27], v[52:53], v[12:15]
s_waitcnt vmcnt(4)
ds_read_b128 v[28:31], v0 offset:44032
v_bfe_u32 v32, v0, 5, 1
v_mfma_f32_16x16x16_bf16 v[16:19], v[54:55], v[52:53], v[16:19]
s_nop 0
v_mov_b64 v[36:37], 0
v_lshl_add_u32 v32, v32, 3, v5
v_mov_b64 v[38:39], 0
v_cndmask_b32 v9, v13, v9, s[40:41]
v_cndmask_b32 v11, v15, v11, s[40:41]
v_cndmask_b32 v8, v12, v8, s[40:41]
v_cndmask_b32 v10, v14, v10, s[40:41]
v_rcp_f32 v18, v16
v_subrev_u32 v17, s36, v16
v_mul_f32 v9, v9, v18
v_mul_f32 v10, v10, v18
v_mul_f32 v8, v8, v18
v_mul_f32 v11, v11, v18
v_cvt_pk_bf16_f32 v13, v10, v11
v_cvt_pk_bf16_f32 v12, v8, v9
v_cmp_lt_u32 vcc, s37, v17
s_cbranch_vccnz rare_10042
back_10043:
ds_write_b64 v32, v[12:13] offset:1024
v_mov_b32_dpp v9, v13 quad_perm:[0,1,0,1] row_mask:0xf bank_mask:0xf
v_mov_b32_dpp v8, v12 quad_perm:[0,1,0,1] row_mask:0xf bank_mask:0xf
v_mov_b32_dpp v11, v13 quad_perm:[2,3,2,3] row_mask:0xf bank_mask:0xf
v_mov_b32_dpp v10, v12 quad_perm:[2,3,2,3] row_mask:0xf bank_mask:0xf
v_mov_b64 v[32:33], 0
v_mov_b64 v[54:55], 0
v_smfmac_f32_16x16x64_bf16 v[36:39], v[8:11], v[64:71], v1
s_waitcnt vmcnt(2)
global_load_dwordx4 v[64:67], v0, s[74:75] offset:-4096 sc1
ds_read_b128 v[24:27], v0 offset:43008
global_load_dwordx4 v[68:71], v0, s[74:75] offset:-3072 sc1
ds_read_b128 v[20:23], v0 offset:41984
s_waitcnt lgkmcnt(3)
ds_read_b128 v[16:19], v0 offset:40960
s_waitcnt lgkmcnt(3)
v_mov_b64 v[40:41], 0
v_mov_b64 v[52:53], 0
s_barrier
ds_read_b128 v[56:59], v5 offset:1536
v_smfmac_f32_16x16x64_bf16 v[40:43], v[8:11], v[72:79], v1
s_add_u32 s42, s4, s20
ds_read_b128 v[60:63], v5 offset:0
v_mov_b64 v[34:35], 0
v_smfmac_f32_16x16x64_bf16 v[52:55], v[8:11], v[176:183], v1
s_waitcnt vmcnt(2)
ds_read_b128 v[12:15], v5 offset:512
v_mov_b64 v[48:49], 0
v_mov_b64 v[50:51], 0
v_smfmac_f32_16x16x64_bf16 v[32:35], v[8:11], v[80:87], v1
s_waitcnt lgkmcnt(3)
ds_read_b128 v[80:83], v0 offset:45056
global_load_dwordx4 v[72:75], v0, s[74:75] offset:-2048 sc1
v_smfmac_f32_16x16x64_bf16 v[48:51], v[8:11], v[168:175], v1
s_waitcnt lgkmcnt(3)
ds_read_b128 v[84:87], v0 offset:46080
global_load_dwordx4 v[76:79], v0, s[74:75] offset:-1024 sc1
v_smfmac_f32_16x16x64_bf16 v[36:39], v[56:59], v[16:23], v1
s_waitcnt lgkmcnt(3)
ds_read_b128 v[20:23], v0 offset:48128
v_bfe_u32 v45, v0, 1, 7
v_smfmac_f32_16x16x64_bf16 v[36:39], v[60:63], v[24:31], v1
s_waitcnt lgkmcnt(3)
ds_read_b128 v[24:27], v0 offset:49152
v_lshrrev_b32 v44, 8, v0
v_smfmac_f32_16x16x64_bf16 v[36:39], v[12:15], v[184:191], v1
ds_read_b128 v[16:19], v0 offset:47104
v_smfmac_f32_16x16x64_bf16 v[40:43], v[56:59], v[192:199], v1
s_waitcnt lgkmcnt(3)
ds_read_b128 v[28:31], v0 offset:50176
v_lshl_or_b32 v44, v44, 12, v45
v_smfmac_f32_16x16x64_bf16 v[40:43], v[60:63], v[80:87], v1
s_nop 0
ds_read_b128 v[80:83], v0 offset:51200
v_cvt_pk_bf16_f32 v36, v36, v37
v_and_or_b32 v36, v36, -2, s18
v_smfmac_f32_16x16x64_bf16 v[40:43], v[12:15], v[200:207], v1
s_waitcnt lgkmcnt(3)
ds_read_b128 v[84:87], v0 offset:52224
v_cvt_pk_bf16_f32 v37, v38, v39
v_smfmac_f32_16x16x64_bf16 v[52:55], v[56:59], v[216:223], v1
s_waitcnt lgkmcnt(3)
global_store_dwordx2 v44, v[36:37], s[48:49]
v_smfmac_f32_16x16x64_bf16 v[48:51], v[56:59], v[16:23], v1
s_waitcnt lgkmcnt(2)
v_cvt_pk_bf16_f32 v40, v40, v41
v_smfmac_f32_16x16x64_bf16 v[48:51], v[60:63], v[24:31], v1
v_cvt_pk_bf16_f32 v41, v42, v43
v_smfmac_f32_16x16x64_bf16 v[48:51], v[12:15], v[208:215], v1
v_and_or_b32 v40, v40, -2, s18
v_smfmac_f32_16x16x64_bf16 v[32:35], v[56:59], v[232:239], v1
s_waitcnt lgkmcnt(0)
global_store_dwordx2 v44, v[40:41], s[50:51]
s_nop 0
v_smfmac_f32_16x16x64_bf16 v[32:35], v[60:63], v[240:247], v1
s_nop 1
v_cvt_pk_bf16_f32 v48, v48, v49
v_smfmac_f32_16x16x64_bf16 v[32:35], v[12:15], v[248:255], v1
s_mov_b64 s[66:67], s[70:71]
v_and_or_b32 v48, v48, -2, s18
v_cvt_pk_bf16_f32 v49, v50, v51
v_smfmac_f32_16x16x64_bf16 v[52:55], v[60:63], v[80:87], v1
global_store_dwordx2 v44, v[48:49], s[52:53]
v_smfmac_f32_16x16x64_bf16 v[52:55], v[12:15], v[224:231], v1
s_nop 1
v_cvt_pk_bf16_f32 v32, v32, v33
s_addc_u32 s43, s5, 0
v_and_or_b32 v32, v32, -2, s18
v_cvt_pk_bf16_f32 v33, v34, v35
s_nop 1
v_cvt_pk_bf16_f32 v52, v52, v53
v_and_or_b32 v52, v52, -2, s18
s_mov_b32 s30, 0
v_cvt_pk_bf16_f32 v53, v54, v55
global_store_dwordx2 v44, v[52:53], s[54:55]
global_store_dwordx2 v44, v[32:33], s[56:57]
s_cmp_ge_u32 s14, 16
s_cbranch_scc1 nored_10050
v_bfe_u32 v24, v0, 6, 1
v_lshlrev_b32 v24, 4, v24
v_mov_b32 v25, 0x3f80
v_lshlrev_b32 v24, v24, v25
v_bfe_i32 v25, v0, 4, 1
v_and_b32 v45, v24, v25
v_and_b32 v47, v24, v25
v_xor_b32 v44, v24, v45
v_xor_b32 v46, v24, v45
v_and_b32 v28, 32, v0
v_bfe_u32 v29, v0, 6, 1
v_lshl_add_u32 v28, v29, 8, v28
v_bfe_u32 v29, v0, 8, 1
v_lshl_add_u32 v28, v29, 4, v28
v_bfe_u32 v29, v0, 4, 1
v_lshl_add_u32 v28, v29, 3, v28
v_bfe_u32 v7, v0, 2, 3
v_add_u32 v7, s22, v7
s_mov_b32 exec_hi, 0
v_and_b32 v7, 255, v0
v_lshl_add_u32 v7, v7, 3, s27
s_mov_b32 exec_hi, -1
s_nop 15
s_nop 15
s_nop 15
s_nop 15
s_nop 13
global_load_dwordx4 v[8:11], v0, s[62:63] offset:0 sc1
global_load_dwordx4 v[12:15], v0, s[62:63] offset:1024 sc1
global_load_dwordx4 v[16:19], v0, s[62:63] offset:2048 sc1
global_load_dwordx4 v[20:23], v0, s[62:63] offset:3072 sc1
s_nop 5
global_load_dwordx4 v[56:59], v0, s[74:75] offset:0 sc1
global_load_dwordx4 v[60:63], v0, s[74:75] offset:1024 sc1
global_load_dwordx4 v[80:83], v0, s[74:75] offset:2048 sc1
global_load_dwordx4 v[84:87], v0, s[74:75] offset:3072 sc1
v_mov_b64 v[40:41], 0
v_mov_b64 v[42:43], 0
s_waitcnt vmcnt(6)
s_nop 0
v_smfmac_f32_16x16x64_bf16 v[40:43], v[44:47], v[8:15], v1
v_bitop3_b32 v24, v8, v10, s18 bitop3:0x7e
v_bitop3_b32 v25, v12, v14, s18 bitop3:0x7e
s_waitcnt vmcnt(4)
v_smfmac_f32_16x16x64_bf16 v[40:43], v[44:47], v[16:23], v1
v_bitop3_b32 v26, v16, v18, s18 bitop3:0x7e
v_bitop3_b32 v27, v20, v22, s18 bitop3:0x7e
v_or3_b32 v24, v24, v25, v26
v_bitop3_b32 v24, v24, v27, 1 bitop3:0xa8
v_cmp_ne_u32 vcc, 0, v24
s_cbranch_vccnz red_10049
red_10049_ok:
s_nop 1
v_add_f32_dpp v40, v40, v40 row_ror:8 row_mask:0xf bank_mask:0xf
v_add_f32_dpp v41, v41, v41 row_ror:8 row_mask:0xf bank_mask:0xf
v_add_f32_dpp v42, v42, v42 row_ror:8 row_mask:0xf bank_mask:0xf
v_add_f32_dpp v43, v43, v43 row_ror:8 row_mask:0xf bank_mask:0xf
v_cvt_pk_bf16_f32 v40, v40, v41
v_cvt_pk_bf16_f32 v41, v42, v43
v_and_or_b32 v40, v40, -2, s18
s_mov_b64 exec, 0x00ff00ff
global_store_dwordx2 v28, v[40:41], s[64:65]
s_mov_b64 exec, -1
v_mov_b64 v[8:9], 0
v_mov_b64 v[10:11], 0
v_mov_b64 v[12:13], 0
v_mov_b64 v[14:15], 0
v_mov_b64 v[16:17], 0
v_mov_b64 v[18:19], 0
v_mov_b64 v[20:21], 0
v_mov_b64 v[22:23], 0
v_mov_b64 v[24:25], 0
v_mov_b64 v[26:27], 0
v_mov_b64 v[28:29], 0
v_mov_b64 v[30:31], 0
s_nop 15
s_nop 6
s_barrier
global_load_dwordx4 v[32:35], v0, s[66:67] offset:-4096 sc1
s_nop 10
global_load_dwordx4 v[36:39], v0, s[66:67] offset:0 sc1
s_barrier
global_load_dwordx4 v[48:51], v0, s[42:43] offset:0 nt sc1
global_load_dwordx4 v[52:55], v0, s[42:43] offset:1024 nt sc1
s_mov_b32 s30, 0
s_cmp_eq_u32 s17, s31
s_cbranch_scc0 gather_10041
s_branch exit_10044
nored_10050:
v_bfe_u32 v7, v0, 2, 3
v_add_u32 v7, s22, v7
s_mov_b32 exec_hi, 0
v_and_b32 v7, 255, v0
v_lshl_add_u32 v7, v7, 3, s27
s_mov_b32 exec_hi, -1
v_mov_b64 v[8:9], 0
v_mov_b64 v[10:11], 0
v_mov_b64 v[12:13], 0
v_mov_b64 v[14:15], 0
v_mov_b64 v[16:17], 0
v_mov_b64 v[18:19], 0
v_mov_b64 v[20:21], 0
v_mov_b64 v[22:23], 0
v_mov_b64 v[24:25], 0
v_mov_b64 v[26:27], 0
v_mov_b64 v[28:29], 0
v_mov_b64 v[30:31], 0
s_nop 15
s_nop 15
s_nop 15
s_nop 15
s_nop 15
s_nop 11
global_load_dwordx4 v[56:59], v0, s[74:75] offset:0 sc1
global_load_dwordx4 v[60:63], v0, s[74:75] offset:1024 sc1
global_load_dwordx4 v[80:83], v0, s[74:75] offset:2048 sc1
global_load_dwordx4 v[84:87], v0, s[74:75] offset:3072 sc1
s_barrier
global_load_dwordx4 v[32:35], v0, s[66:67] offset:-4096 sc1
s_nop 10
global_load_dwordx4 v[36:39], v0, s[66:67] offset:0 sc1
s_barrier
global_load_dwordx4 v[48:51], v0, s[42:43] offset:0 nt sc1
global_load_dwordx4 v[52:55], v0, s[42:43] offset:1024 nt sc1
s_mov_b32 s30, 0
s_cmp_eq_u32 s17, s31
s_cbranch_scc0 gather_10041
s_branch exit_10044
rt_10046:
global_load_dwordx4 v[32:35], v0, s[66:67] offset:-4096 sc1
global_load_dwordx4 v[36:39], v0, s[66:67] offset:0 sc1
s_add_u32 s30, s30, 1
s_cmp_gt_u32 s30, 262144
s_cbranch_scc1 L_fail
v_mov_b64 v[8:9], 0
v_mov_b64 v[10:11], 0
v_mov_b64 v[12:13], 0
v_mov_b64 v[14:15], 0
v_mov_b64 v[16:17], 0
v_mov_b64 v[18:19], 0
v_mov_b64 v[20:21], 0
v_mov_b64 v[22:23], 0
v_mov_b64 v[24:25], 0
v_mov_b64 v[26:27], 0
v_mov_b64 v[28:29], 0
v_mov_b64 v[30:31], 0
s_waitcnt vmcnt(1)
v_bitop3_b32 v40, v32, v34, s18 bitop3:0x7e
s_waitcnt vmcnt(0)
v_bitop3_b32 v41, v36, v38, s18 bitop3:0x7e
v_bitop3_b32 v40, v40, v41, s19 bitop3:0xa8
v_cmp_ne_u32 vcc, 0, v40
s_cbranch_vccnz rt_10046
s_branch rt_10046_b
red_10049:
global_load_dwordx4 v[8:11], v0, s[62:63] offset:0 sc1
global_load_dwordx4 v[12:15], v0, s[62:63] offset:1024 sc1
global_load_dwordx4 v[16:19], v0, s[62:63] offset:2048 sc1
global_load_dwordx4 v[20:23], v0, s[62:63] offset:3072 sc1
s_add_u32 s30, s30, 1
s_cmp_gt_u32 s30, 262144
s_cbranch_scc1 L_fail
v_mov_b64 v[40:41], 0
v_mov_b64 v[42:43], 0
s_waitcnt vmcnt(2)
s_nop 0
v_smfmac_f32_16x16x64_bf16 v[40:43], v[44:47], v[8:15], v1
v_bitop3_b32 v24, v8, v10, s18 bitop3:0x7e
v_bitop3_b32 v25, v12, v14, s18 bitop3:0x7e
s_waitcnt vmcnt(0)
v_smfmac_f32_16x16x64_bf16 v[40:43], v[44:47], v[16:23], v1
v_bitop3_b32 v26, v16, v18, s18 bitop3:0x7e
v_bitop3_b32 v27, v20, v22, s18 bitop3:0x7e
v_or3_b32 v24, v24, v25, v26
v_bitop3_b32 v24, v24, v27, 1 bitop3:0xa8
v_cmp_ne_u32 vcc, 0, v24
s_cbranch_vccnz red_10049
s_branch red_10049_ok
rare_10042:
ds_read_b128 v[48:51], v6 offset:6144
ds_read_b128 v[52:55], v6 offset:7168
s_waitcnt lgkmcnt(0)
v_add_f32 v48, v48, v52
v_add_f32 v49, v49, v53
v_add_f32 v50, v50, v54
v_add_f32 v51, v51, v55
v_mov_b32_dpp v46, v46 quad_perm:[0,1,0,1] row_mask:0xf bank_mask:0xf
v_mov_b32_dpp v47, v47 quad_perm:[0,1,0,1] row_mask:0xf bank_mask:0xf
v_max3_f32 v19, v48, v49, v50
v_max3_f32 v19, v19, v51, v46
v_max_f32 v19, v19, v47
s_nop 1
v_max_f32_dpp v19, v19, v19 quad_perm:[2,3,0,1] row_mask:0xf bank_mask:0xf
v_mov_b32 v44, v19
s_nop 1
v_permlane32_swap_b32 v19, v44
v_max_f32 v19, v19, v44
v_mov_b32 v44, v19
s_nop 1
v_permlane16_swap_b32 v19, v44
v_max_f32 v19, v19, v44
v_sub_f32 v48, v48, v19
v_sub_f32 v49, v49, v19
v_sub_f32 v50, v50, v19
v_sub_f32 v51, v51, v19
v_sub_f32 v46, v46, v19
v_sub_f32 v47, v47, v19
v_exp_f32 v48, v48
v_exp_f32 v49, v49
v_exp_f32 v50, v50
v_exp_f32 v51, v51
v_cvt_pk_bf16_f32 v54, v48, v49
v_cvt_pk_bf16_f32 v55, v50, v51
s_nop 0
v_mov_b32_dpp v48, v54 quad_perm:[0,1,0,1] row_mask:0xf bank_mask:0xf
v_mov_b32_dpp v49, v55 quad_perm:[0,1,0,1] row_mask:0xf bank_mask:0xf
v_mov_b32_dpp v50, v54 quad_perm:[2,3,2,3] row_mask:0xf bank_mask:0xf
v_mov_b32_dpp v51, v55 quad_perm:[2,3,2,3] row_mask:0xf bank_mask:0xf
v_mov_b64 v[20:21], s[44:45]
v_mov_b64 v[22:23], s[44:45]
v_mfma_f32_16x16x32_bf16 v[8:11], v[56:59], v[48:51], 0
v_mfma_f32_16x16x32_bf16 v[12:15], v[60:63], v[48:51], 0
v_mfma_f32_16x16x32_bf16 v[16:19], v[20:23], v[48:51], 0
v_mov_b64 v[54:55], s[46:47]
v_exp_f32_dpp v44, v46 quad_perm:[0,1,0,1] row_mask:0xf bank_mask:0xf
v_exp_f32_dpp v45, v47 quad_perm:[0,1,0,1] row_mask:0xf bank_mask:0xf
s_nop 0
v_cvt_pk_bf16_f32 v52, v44, v45
v_cvt_pk_bf16_f32 v53, v44, v45
s_nop 1
v_mfma_f32_16x16x16_bf16 v[16:19], v[54:55], v[52:53], v[16:19]
v_mfma_f32_16x16x16_bf16 v[8:11], v[24:25], v[52:53], v[8:11]
v_mfma_f32_16x16x16_bf16 v[12:15], v[26:27], v[52:53], v[12:15]
s_nop 5
v_rcp_f32 v18, v16
s_nop 0
v_cndmask_b32 v8, v12, v8, s[40:41]
v_mul_f32 v8, v8, v18
v_cndmask_b32 v9, v13, v9, s[40:41]
v_mul_f32 v9, v9, v18
v_cndmask_b32 v10, v14, v10, s[40:41]
v_mul_f32 v10, v10, v18
v_cndmask_b32 v11, v15, v11, s[40:41]
v_mul_f32 v11, v11, v18
v_cvt_pk_bf16_f32 v12, v8, v9
v_cvt_pk_bf16_f32 v13, v10, v11
s_branch back_10043
exit_10044:
global_load_dwordx4 v[32:35], v0, s[66:67] offset:-4096 sc1
global_load_dwordx4 v[36:39], v0, s[66:67] offset:0 sc1
s_add_u32 s30, s30, 1
s_cmp_gt_u32 s30, 262144
s_cbranch_scc1 L_fail
s_waitcnt vmcnt(1)
v_bitop3_b32 v44, v32, v34, s18 bitop3:0x7e
s_waitcnt vmcnt(0)
v_bitop3_b32 v45, v36, v38, s18 bitop3:0x7e
v_bitop3_b32 v44, v44, v45, s19 bitop3:0xa8
v_cmp_ne_u32 vcc, 0, v44
s_cbranch_vccnz exit_10044
s_add_u32 s35, s35, 1
s_cmp_lt_u32 s35, 2
s_cbranch_scc1 layer_10040
s_endpgm
wave_10008:
layer_10054:
s_lshl_b32 s17, s35, 6
s_mul_i32 s27, s35, 34603008
s_lshl_b32 s28, s14, 14
s_add_u32 s27, s27, s28
s_add_u32 s20, s27, 16789504
s_mul_i32 s27, s17, 10240
s_add_u32 s27, s27, s24
s_add_u32 s21, s27, s25
s_mov_b32 s19, 0
s_add_u32 s33, s17, 1
s_add_u32 s31, s17, 63
s_add_u32 s32, s17, 64
s_mov_b32 s27, s20
v_mov_b32 v7, 0
s_add_u32 s66, s4, 416768
s_addc_u32 s67, s5, 0
s_add_u32 s70, s4, 400384
s_addc_u32 s71, s5, 0
s_add_u32 s68, s4, 420864
s_addc_u32 s69, s5, 0
s_add_u32 s72, s4, 404480
s_addc_u32 s73, s5, 0
s_add_u32 s42, s4, s20
s_addc_u32 s43, s5, 0
global_load_dwordx4 v[64:67], v0, s[74:75] offset:-4096 sc1
global_load_dwordx4 v[68:71], v0, s[74:75] offset:-3072 sc1
global_load_dwordx4 v[72:75], v0, s[74:75] offset:-2048 sc1
global_load_dwordx4 v[76:79], v0, s[74:75] offset:-1024 sc1
global_load_dwordx4 v[80:83], v0, s[74:75] offset:2048 sc1
global_load_dwordx4 v[84:87], v0, s[74:75] offset:3072 sc1
global_load_dwordx4 v[56:59], v0, s[74:75] offset:0 sc1
global_load_dwordx4 v[60:63], v0, s[74:75] offset:1024 sc1
v_mov_b64 v[8:9], 0
v_mov_b64 v[10:11], 0
v_mov_b64 v[12:13], 0
v_mov_b64 v[14:15], 0
v_mov_b64 v[16:17], 0
v_mov_b64 v[18:19], 0
v_mov_b64 v[20:21], 0
v_mov_b64 v[22:23], 0
v_mov_b64 v[24:25], 0
v_mov_b64 v[26:27], 0
v_mov_b64 v[28:29], 0
v_mov_b64 v[30:31], 0
s_barrier
global_load_dwordx4 v[48:51], v0, s[42:43] offset:0 nt sc1
global_load_dwordx4 v[52:55], v0, s[42:43] offset:1024 nt sc1
v_bfe_u32 v7, v0, 2, 3
v_add_u32 v7, s22, v7
s_mov_b32 exec_hi, 0
v_and_b32 v7, 255, v0
v_lshl_add_u32 v7, v7, 3, s27
s_mov_b32 exec_hi, -1
global_load_dwordx4 v[32:35], v0, s[66:67] offset:-4096 sc1
global_load_dwordx4 v[36:39], v0, s[66:67] offset:0 sc1
s_mov_b32 s30, 0
s_waitcnt vmcnt(0)
.p2align 6
gather_10055:
s_waitcnt vmcnt(3)
rt_10060_b:
v_smfmac_f32_16x16x64_bf16 v[16:19], v[32:35], v[56:63], v1
ds_write_b128 v0, v[32:35] offset:3072
v_smfmac_f32_16x16x64_bf16 v[8:11], v[32:35], v[64:71], v1
v_bitop3_b32 v44, v32, v34, s18 bitop3:0x7e
v_smfmac_f32_16x16x64_bf16 v[12:15], v[32:35], v[72:79], v1
s_waitcnt vmcnt(2)
ds_write_b128 v0, v[36:39] offset:7168
v_bitop3_b32 v45, v36, v38, s18 bitop3:0x7e
v_bitop3_b32 v44, v44, v45, s19 bitop3:0xa8
v_smfmac_f32_16x16x64_bf16 v[20:23], v[32:35], v[80:87], v1
v_cmp_ne_u32 vcc, 0, v44
v_smfmac_f32_16x16x64_bf16 v[20:23], v[36:39], a[40:47], v1
s_cbranch_vccnz rt_10060
global_load_dwordx4 v[64:67], v0, s[76:77] offset:-4096 sc1
v_smfmac_f32_16x16x64_bf16 v[24:27], v[32:35], a[0:7], v1
ds_read_b128 v[84:87], v2 offset:1024
global_load_dwordx4 v[68:71], v0, s[76:77] offset:-3072 sc1
v_smfmac_f32_16x16x64_bf16 v[16:19], v[36:39], a[32:39], v1
global_load_dwordx4 v[72:75], v0, s[76:77] offset:-2048 sc1
ds_read_b128 v[80:83], v2 offset:0
global_load_dwordx4 v[76:79], v0, s[76:77] offset:-1024 sc1
v_smfmac_f32_16x16x64_bf16 v[28:31], v[32:35], a[8:15], v1
s_waitcnt lgkmcnt(2)
s_barrier
ds_read_b128 v[40:43], v0 offset:2048
v_smfmac_f32_16x16x64_bf16 v[12:15], v[36:39], a[24:31], v1
s_waitcnt lgkmcnt(2)
ds_read_b128 v[44:47], v0 offset:6144
v_smfmac_f32_16x16x64_bf16 v[24:27], v[36:39], a[48:55], v1
ds_read_b128 v[32:35], v0 offset:1024
s_waitcnt lgkmcnt(3)
v_smfmac_f32_16x16x64_bf16 v[28:31], v[36:39], v[80:87], v1
s_xor_b32 s18, s18, 1
ds_read_b128 v[80:83], v2 offset:2048
s_mov_b32 s19, 1
v_smfmac_f32_16x16x64_bf16 v[8:11], v[36:39], a[16:23], v1
ds_read_b128 v[84:87], v2 offset:3072
s_waitcnt lgkmcnt(4)
v_smfmac_f32_16x16x64_bf16 v[8:11], v[40:43], a[56:63], v1
ds_read_b128 v[36:39], v0 offset:5120
s_waitcnt lgkmcnt(4)
v_smfmac_f32_16x16x64_bf16 v[8:11], v[44:47], a[72:79], v1
global_load_dwordx4 v[56:59], v0, s[42:43] offset:2048 nt sc1
v_smfmac_f32_16x16x64_bf16 v[12:15], v[40:43], a[64:71], v1
ds_read_b128 v[40:43], v0 offset:0
s_waitcnt lgkmcnt(4)
v_smfmac_f32_16x16x64_bf16 v[12:15], v[44:47], a[80:87], v1
ds_read_b128 v[44:47], v0 offset:4096
s_waitcnt lgkmcnt(3)
v_smfmac_f32_16x16x64_bf16 v[12:15], v[32:35], v[80:87], v1
ds_read_b128 v[84:87], v2 offset:5120
v_smfmac_f32_16x16x64_bf16 v[8:11], v[32:35], a[88:95], v1
ds_read_b128 v[80:83], v2 offset:4096
s_waitcnt lgkmcnt(4)
v_smfmac_f32_16x16x64_bf16 v[12:15], v[36:39], a[104:111], v1
ds_read_b128 v[32:35], v0 offset:9216
s_waitcnt lgkmcnt(4)
v_smfmac_f32_16x16x64_bf16 v[8:11], v[36:39], a[96:103], v1
s_add_u32 s20, s20, 524288
ds_read_b128 v[36:39], v0 offset:8192
v_smfmac_f32_16x16x64_bf16 v[12:15], v[40:43], a[120:127], v1
s_waitcnt lgkmcnt(4)
global_load_dwordx4 v[60:63], v0, s[42:43] offset:3072 nt sc1
v_smfmac_f32_16x16x64_bf16 v[8:11], v[40:43], a[112:119], v1
s_waitcnt lgkmcnt(3)
s_waitcnt lgkmcnt(2)
ds_read_b128 v[40:43], v0 offset:2048
v_smfmac_f32_16x16x64_bf16 v[12:15], v[44:47], v[80:87], v1
ds_read_b128 v[84:87], v2 offset:7168
s_waitcnt lgkmcnt(3)
v_smfmac_f32_16x16x64_bf16 v[12:15], v[32:35], a[144:151], v1
ds_read_b128 v[80:83], v2 offset:6144
s_waitcnt lgkmcnt(3)
v_smfmac_f32_16x16x64_bf16 v[8:11], v[44:47], a[128:135], v1
s_waitcnt vmcnt(5)
global_load_dword v7, v7, s[4:5] sc1
v_smfmac_f32_16x16x64_bf16 v[8:11], v[32:35], a[136:143], v1
s_waitcnt vmcnt(5)
ds_read_b128 v[32:35], v0 offset:6144
v_smfmac_f32_16x16x64_bf16 v[8:11], v[36:39], v[64:71], v1
s_waitcnt lgkmcnt(3)
ds_read_b128 v[64:67], v2 offset:8192
s_waitcnt lgkmcnt(3)
v_smfmac_f32_16x16x64_bf16 v[12:15], v[36:39], a[152:159], v1
ds_read_b128 v[68:71], v2 offset:9216
s_waitcnt lgkmcnt(3)
ds_read_b128 v[36:39], v0 offset:1024
v_smfmac_f32_16x16x64_bf16 v[20:23], v[40:43], v[80:87], v1
s_add_u32 s17, s17, 1
ds_read_b128 v[84:87], v2 offset:11264
v_add_f32 v8, v8, v10
v_smfmac_f32_16x16x64_bf16 v[16:19], v[40:43], a[160:167], v1
s_waitcnt lgkmcnt(4)
ds_read_b128 v[80:83], v2 offset:10240
v_add_f32 v9, v9, v11
v_add_f32 v13, v13, v15
v_add_f32 v12, v12, v14
v_mul_f32 v13, s34, v13
v_mul_f32 v8, s34, v8
v_smfmac_f32_16x16x64_bf16 v[16:19], v[32:35], a[168:175], v1
s_add_u32 s21, s21, 10240
ds_read_b128 v[40:43], v0 offset:5120
v_mul_f32 v9, s34, v9
v_smfmac_f32_16x16x64_bf16 v[20:23], v[32:35], a[176:183], v1
s_waitcnt lgkmcnt(3)
ds_read_b128 v[32:35], v0 offset:0
v_mul_f32 v12, s34, v12
v_smfmac_f32_16x16x64_bf16 v[16:19], v[36:39], v[64:71], v1
s_add_u32 s33, s17, 2
ds_read_b128 v[64:67], v2 offset:12288
s_waitcnt vmcnt(3)
ds_read_b128 v[68:71], v2 offset:13312
v_cvt_pk_bf16_f32 v8, v8, v9
v_cvt_pk_bf16_f32 v12, v12, v13
v_smfmac_f32_16x16x64_bf16 v[20:23], v[36:39], a[184:191], v1
s_waitcnt lgkmcnt(4)
ds_read_b128 v[36:39], v0 offset:4096
ds_write2_b32 v3, v8, v12 offset0:0 offset1:128
s_waitcnt lgkmcnt(5)
v_smfmac_f32_16x16x64_bf16 v[16:19], v[40:43], v[72:79], v1
s_mov_b64 vcc, s[40:41]
ds_read_b128 v[72:75], v2 offset:14336
v_smfmac_f32_16x16x64_bf16 v[20:23], v[40:43], v[80:87], v1
s_waitcnt lgkmcnt(5)
ds_read_b128 v[40:43], v0 offset:9216
s_waitcnt lgkmcnt(5)
ds_read_b128 v[76:79], v2 offset:15360
v_smfmac_f32_16x16x64_bf16 v[16:19], v[32:35], a[192:199], v1
s_waitcnt lgkmcnt(4)
ds_read_b128 v[84:87], v2 offset:17408
v_smfmac_f32_16x16x64_bf16 v[20:23], v[32:35], a[200:207], v1
ds_read_b128 v[32:35], v0 offset:8192
s_waitcnt lgkmcnt(5)
ds_read_b128 v[80:83], v2 offset:16384
v_smfmac_f32_16x16x64_bf16 v[16:19], v[36:39], v[64:71], v1
s_barrier
ds_read_b64_tr_b16 v[10:11], v4 offset:2560
v_smfmac_f32_16x16x64_bf16 v[20:23], v[36:39], a[208:215], v1
s_waitcnt lgkmcnt(4)
ds_read_b64_tr_b16 v[8:9], v4 offset:2048
ds_read_b64_tr_b16 v[12:13], v4 offset:3072
v_smfmac_f32_16x16x64_bf16 v[20:23], v[40:43], a[216:223], v1
ds_read_b64_tr_b16 v[14:15], v4 offset:3584
ds_read_b128 v[36:39], v0 offset:9216
v_smfmac_f32_16x16x64_bf16 v[16:19], v[40:43], v[72:79], v1
s_waitcnt lgkmcnt(6)
ds_read_b128 v[64:67], v2 offset:18432
ds_read_b128 v[68:71], v2 offset:19456
v_smfmac_f32_16x16x64_bf16 v[16:19], v[32:35], a[224:231], v1
s_waitcnt lgkmcnt(7)
ds_read_b128 v[76:79], v2 offset:21504
ds_read_b128 v[40:43], v0 offset:8192
v_smfmac_f32_16x16x64_bf16 v[20:23], v[32:35], v[80:87], v1
s_waitcnt lgkmcnt(7)
ds_read_b128 v[72:75], v2 offset:20480
ds_read_b128 v[32:35], v0 offset:2048
v_mfma_f32_16x16x32_bf16 v[44:47], v[48:51], v[8:11], 0
s_waitcnt lgkmcnt(7)
ds_read_b128 v[84:87], v2 offset:23552
v_add_f32 v16, v16, v18
v_add_f32 v17, v17, v19
v_mfma_f32_16x16x32_bf16 v[44:47], v[52:55], v[12:15], v[44:47]
s_waitcnt lgkmcnt(7)
v_bfe_u32 v48, v0, 5, 1
v_cvt_pk_bf16_f32 v16, v16, v17
v_add_f32 v20, v20, v22
v_add_f32 v21, v21, v23
v_cvt_pk_bf16_f32 v20, v20, v21
v_lshl_add_u32 v48, v48, 3, v5
v_smfmac_f32_16x16x64_bf16 v[28:31], v[36:39], a[232:239], v1
s_waitcnt lgkmcnt(5)
ds_write2_b32 v3, v16, v20 offset0:1 offset1:129
v_cndmask_b32_dpp v44, v46, v44, vcc quad_perm:[0,1,0,1] row_mask:0xf bank_mask:0xf
v_cndmask_b32_dpp v45, v47, v45, vcc quad_perm:[0,1,0,1] row_mask:0xf bank_mask:0xf
v_xor_b32 v48, 128, v48
v_smfmac_f32_16x16x64_bf16 v[24:27], v[36:39], v[64:71], v1
s_waitcnt lgkmcnt(4)
ds_write_b64 v48, v[44:45] offset:7680
v_smfmac_f32_16x16x64_bf16 v[24:27], v[40:43], a[240:247], v1
s_waitcnt lgkmcnt(3)
global_load_dwordx4 v[64:67], v0, s[76:77] offset:0 sc1
ds_read_b128 v[80:83], v2 offset:22528
v_smfmac_f32_16x16x64_bf16 v[28:31], v[40:43], v[72:79], v1
ds_read_b128 v[36:39], v0 offset:6144
global_load_dwordx4 v[68:71], v0, s[76:77] offset:1024 sc1
v_smfmac_f32_16x16x64_bf16 v[24:27], v[32:35], a[248:255], v1
global_load_dwordx4 v[72:75], v0, s[76:77] offset:2048 sc1
ds_read_b128 v[40:43], v0 offset:1024
v_smfmac_f32_16x16x64_bf16 v[28:31], v[32:35], v[88:95], v1
s_waitcnt lgkmcnt(3)
ds_read_b128 v[32:35], v0 offset:5120
s_barrier
ds_read_b128 v[48:51], v6 offset:6144
s_waitcnt lgkmcnt(3)
v_smfmac_f32_16x16x64_bf16 v[28:31], v[36:39], v[96:103], v1
ds_read_b128 v[52:55], v6 offset:7168
v_smfmac_f32_16x16x64_bf16 v[24:27], v[36:39], v[80:87], v1
s_waitcnt lgkmcnt(3)
ds_read_b128 v[36:39], v0 offset:0
ds_read_b64_tr_b16 v[8:9], v4 offset:0
v_smfmac_f32_16x16x64_bf16 v[24:27], v[40:43], v[104:111], v1
s_waitcnt lgkmcnt(4)
ds_read_b64_tr_b16 v[10:11], v4 offset:512
global_load_dwordx4 v[76:79], v0, s[76:77] offset:3072 sc1
v_smfmac_f32_16x16x64_bf16 v[28:31], v[40:43], v[112:119], v1
s_waitcnt lgkmcnt(4)
ds_read_b128 v[40:43], v0 offset:4096
global_load_dwordx4 v[80:83], v0, s[78:79] offset:-4096 sc1
v_smfmac_f32_16x16x64_bf16 v[24:27], v[32:35], v[120:127], v1
ds_read_b64_tr_b16 v[20:21], v4 offset:3072
global_load_dwordx4 v[84:87], v0, s[78:79] offset:-3072 sc1
v_smfmac_f32_16x16x64_bf16 v[28:31], v[32:35], v[128:135], v1
s_waitcnt lgkmcnt(4)
ds_read_b64_tr_b16 v[12:13], v4 offset:1024
v_add_f32 v50, v50, v54
v_smfmac_f32_16x16x64_bf16 v[28:31], v[36:39], v[144:151], v1
s_waitcnt vmcnt(7)
ds_read_b64_tr_b16 v[16:17], v4 offset:2048
v_add_f32 v48, v48, v52
v_smfmac_f32_16x16x64_bf16 v[24:27], v[36:39], v[136:143], v1
s_waitcnt lgkmcnt(3)
ds_read_b64_tr_b16 v[14:15], v4 offset:1536
v_add_f32 v49, v49, v53
v_smfmac_f32_16x16x64_bf16 v[28:31], v[40:43], v[160:167], v1
s_min_u32 s33, s33, s32
ds_read_b64_tr_b16 v[18:19], v4 offset:2560
v_add_f32 v51, v51, v55
v_smfmac_f32_16x16x64_bf16 v[24:27], v[40:43], v[152:159], v1
s_waitcnt lgkmcnt(3)
ds_read_b64_tr_b16 v[22:23], v4 offset:3584
v_exp_f32 v51, v51
v_exp_f32 v50, v50
v_mfma_f32_16x16x32_bf16 v[44:47], v[8:11], v[8:11], 0
s_waitcnt lgkmcnt(2)
v_exp_f32 v49, v49
v_exp_f32 v48, v48
v_mfma_f32_16x16x32_bf16 v[44:47], v[12:15], v[12:15], v[44:47]
s_waitcnt lgkmcnt(1)
v_cvt_pk_bf16_f32 v54, v48, v49
v_cvt_pk_bf16_f32 v55, v50, v51
v_mfma_f32_16x16x32_bf16 v[44:47], v[16:19], v[16:19], v[44:47]
s_waitcnt lgkmcnt(0)
v_mov_b32_dpp v49, v55 quad_perm:[0,1,0,1] row_mask:0xf bank_mask:0xf
v_mov_b32_dpp v50, v54 quad_perm:[2,3,2,3] row_mask:0xf bank_mask:0xf
v_mfma_f32_16x16x32_bf16 v[44:47], v[20:23], v[20:23], v[44:47]
s_nop 0
v_mov_b32_dpp v48, v54 quad_perm:[0,1,0,1] row_mask:0xf bank_mask:0xf
v_mov_b32_dpp v51, v55 quad_perm:[2,3,2,3] row_mask:0xf bank_mask:0xf
v_mov_b64 v[20:21], s[44:45]
v_mov_b64 v[22:23], s[44:45]
v_cvt_pk_bf16_f32 v24, v24, v25
v_mfma_f32_16x16x32_bf16 v[12:15], v[60:63], v[48:51], 0
s_add_u32 s27, s20, 524288
v_exp_f32_dpp v45, v47 quad_perm:[0,1,0,1] row_mask:0xf bank_mask:0xf
v_mfma_f32_16x16x32_bf16 v[8:11], v[56:59], v[48:51], 0
v_exp_f32_dpp v44, v46 quad_perm:[0,1,0,1] row_mask:0xf bank_mask:0xf
v_mfma_f32_16x16x32_bf16 v[16:19], v[20:23], v[48:51], 0
v_cvt_pk_bf16_f32 v53, v44, v45
v_cvt_pk_bf16_f32 v25, v26, v27
v_cvt_pk_bf16_f32 v52, v44, v45
v_cvt_pk_bf16_f32 v26, v28, v29
v_cvt_pk_bf16_f32 v27, v30, v31
v_mfma_f32_16x16x16_bf16 v[8:11], v[24:25], v[52:53], v[8:11]
v_mov_b64 v[54:55], s[46:47]
v_mov_b64 v[42:43], 0
v_mfma_f32_16x16x16_bf16 v[12:15], v[26:27], v[52:53], v[12:15]
s_waitcnt vmcnt(4)
ds_read_b128 v[28:31], v0 offset:56320
v_bfe_u32 v32, v0, 5, 1
v_mfma_f32_16x16x16_bf16 v[16:19], v[54:55], v[52:53], v[16:19]
s_nop 0
v_mov_b64 v[36:37], 0
v_lshl_add_u32 v32, v32, 3, v5
v_mov_b64 v[38:39], 0
v_cndmask_b32 v9, v13, v9, s[40:41]
v_cndmask_b32 v11, v15, v11, s[40:41]
v_cndmask_b32 v8, v12, v8, s[40:41]
v_cndmask_b32 v10, v14, v10, s[40:41]
v_rcp_f32 v18, v16
v_subrev_u32 v17, s36, v16
v_mul_f32 v9, v9, v18
v_mul_f32 v10, v10, v18
v_mul_f32 v8, v8, v18
v_mul_f32 v11, v11, v18
v_cvt_pk_bf16_f32 v13, v10, v11
v_cvt_pk_bf16_f32 v12, v8, v9
v_cmp_lt_u32 vcc, s37, v17
s_cbranch_vccnz rare_10056
back_10057:
ds_write_b64 v32, v[12:13] offset:1536
v_mov_b32_dpp v9, v13 quad_perm:[0,1,0,1] row_mask:0xf bank_mask:0xf
v_mov_b32_dpp v8, v12 quad_perm:[0,1,0,1] row_mask:0xf bank_mask:0xf
v_mov_b32_dpp v11, v13 quad_perm:[2,3,2,3] row_mask:0xf bank_mask:0xf
v_mov_b32_dpp v10, v12 quad_perm:[2,3,2,3] row_mask:0xf bank_mask:0xf
v_mov_b64 v[32:33], 0
v_mov_b64 v[54:55], 0
v_smfmac_f32_16x16x64_bf16 v[36:39], v[8:11], v[64:71], v1
s_waitcnt vmcnt(2)
global_load_dwordx4 v[64:67], v0, s[74:75] offset:-4096 sc1
ds_read_b128 v[24:27], v0 offset:55296
global_load_dwordx4 v[68:71], v0, s[74:75] offset:-3072 sc1
ds_read_b128 v[20:23], v0 offset:54272
s_waitcnt lgkmcnt(3)
ds_read_b128 v[16:19], v0 offset:53248
s_waitcnt lgkmcnt(3)
v_mov_b64 v[40:41], 0
v_mov_b64 v[52:53], 0
s_barrier
ds_read_b128 v[56:59], v5 offset:1024
v_smfmac_f32_16x16x64_bf16 v[40:43], v[8:11], v[72:79], v1
s_add_u32 s42, s4, s20
ds_read_b128 v[60:63], v5 offset:512
v_mov_b64 v[34:35], 0
v_smfmac_f32_16x16x64_bf16 v[52:55], v[8:11], v[176:183], v1
s_waitcnt vmcnt(2)
ds_read_b128 v[12:15], v5 offset:0
v_mov_b64 v[48:49], 0
v_mov_b64 v[50:51], 0
v_smfmac_f32_16x16x64_bf16 v[32:35], v[8:11], v[80:87], v1
s_waitcnt lgkmcnt(3)
ds_read_b128 v[80:83], v0 offset:57344
global_load_dwordx4 v[72:75], v0, s[74:75] offset:-2048 sc1
v_smfmac_f32_16x16x64_bf16 v[48:51], v[8:11], v[168:175], v1
s_waitcnt lgkmcnt(3)
ds_read_b128 v[84:87], v0 offset:58368
global_load_dwordx4 v[76:79], v0, s[74:75] offset:-1024 sc1
v_smfmac_f32_16x16x64_bf16 v[36:39], v[56:59], v[16:23], v1
s_waitcnt lgkmcnt(3)
ds_read_b128 v[20:23], v0 offset:60416
v_bfe_u32 v45, v0, 1, 7
v_smfmac_f32_16x16x64_bf16 v[36:39], v[60:63], v[24:31], v1
s_waitcnt lgkmcnt(3)
ds_read_b128 v[24:27], v0 offset:61440
v_lshrrev_b32 v44, 8, v0
v_smfmac_f32_16x16x64_bf16 v[36:39], v[12:15], v[184:191], v1
ds_read_b128 v[16:19], v0 offset:59392
v_smfmac_f32_16x16x64_bf16 v[40:43], v[56:59], v[192:199], v1
s_waitcnt lgkmcnt(3)
ds_read_b128 v[28:31], v0 offset:62464
v_lshl_or_b32 v44, v44, 12, v45
v_smfmac_f32_16x16x64_bf16 v[40:43], v[60:63], v[80:87], v1
s_nop 0
ds_read_b128 v[80:83], v0 offset:63488
v_cvt_pk_bf16_f32 v36, v36, v37
v_and_or_b32 v36, v36, -2, s18
v_smfmac_f32_16x16x64_bf16 v[40:43], v[12:15], v[200:207], v1
s_waitcnt lgkmcnt(3)
ds_read_b128 v[84:87], v0 offset:64512
v_cvt_pk_bf16_f32 v37, v38, v39
v_smfmac_f32_16x16x64_bf16 v[52:55], v[56:59], v[216:223], v1
s_waitcnt lgkmcnt(3)
global_store_dwordx2 v44, v[36:37], s[48:49]
v_smfmac_f32_16x16x64_bf16 v[48:51], v[56:59], v[16:23], v1
s_waitcnt lgkmcnt(2)
v_cvt_pk_bf16_f32 v40, v40, v41
v_smfmac_f32_16x16x64_bf16 v[48:51], v[60:63], v[24:31], v1
v_cvt_pk_bf16_f32 v41, v42, v43
v_smfmac_f32_16x16x64_bf16 v[48:51], v[12:15], v[208:215], v1
v_and_or_b32 v40, v40, -2, s18
v_smfmac_f32_16x16x64_bf16 v[32:35], v[56:59], v[232:239], v1
s_waitcnt lgkmcnt(0)
global_store_dwordx2 v44, v[40:41], s[50:51]
s_nop 0
v_smfmac_f32_16x16x64_bf16 v[32:35], v[60:63], v[240:247], v1
s_nop 1
v_cvt_pk_bf16_f32 v48, v48, v49
v_smfmac_f32_16x16x64_bf16 v[32:35], v[12:15], v[248:255], v1
s_mov_b64 s[66:67], s[70:71]
v_and_or_b32 v48, v48, -2, s18
v_cvt_pk_bf16_f32 v49, v50, v51
v_smfmac_f32_16x16x64_bf16 v[52:55], v[60:63], v[80:87], v1
global_store_dwordx2 v44, v[48:49], s[52:53]
v_smfmac_f32_16x16x64_bf16 v[52:55], v[12:15], v[224:231], v1
s_nop 1
v_cvt_pk_bf16_f32 v32, v32, v33
s_addc_u32 s43, s5, 0
v_and_or_b32 v32, v32, -2, s18
v_cvt_pk_bf16_f32 v33, v34, v35
s_nop 1
v_cvt_pk_bf16_f32 v52, v52, v53
v_and_or_b32 v52, v52, -2, s18
s_mov_b32 s30, 0
v_cvt_pk_bf16_f32 v53, v54, v55
global_store_dwordx2 v44, v[52:53], s[54:55]
global_store_dwordx2 v44, v[32:33], s[56:57]
v_cmp_gt_u32 vcc, s33, v7
s_cmp_eq_u32 vcc_hi, 0
s_cbranch_scc1 kv_10070
s_mov_b32 s30, 0
kv_10069:
v_bfe_u32 v7, v0, 2, 3
buffer_load_dword v7, v7, s[4:7], s22 offen sc1
s_add_u32 s30, s30, 1
s_cmp_gt_u32 s30, 262144
s_cbranch_scc1 L_fail
s_waitcnt vmcnt(0)
v_cmp_gt_u32 vcc, s33, v7
s_cbranch_vccnz kv_10069
kv_10070:
s_mov_b32 s30, 0
v_bfe_u32 v7, v0, 2, 3
v_add_u32 v7, s22, v7
s_mov_b32 exec_hi, 0
v_and_b32 v7, 255, v0
v_lshl_add_u32 v7, v7, 3, s27
s_mov_b32 exec_hi, -1
v_mov_b64 v[8:9], 0
v_mov_b64 v[10:11], 0
v_mov_b64 v[12:13], 0
v_mov_b64 v[14:15], 0
v_mov_b64 v[16:17], 0
v_mov_b64 v[18:19], 0
v_mov_b64 v[20:21], 0
v_mov_b64 v[22:23], 0
v_mov_b64 v[24:25], 0
v_mov_b64 v[26:27], 0
v_mov_b64 v[28:29], 0
v_mov_b64 v[30:31], 0
s_nop 15
s_nop 15
s_nop 15
s_nop 15
s_nop 14
global_load_dwordx4 v[56:59], v0, s[74:75] offset:0 sc1
global_load_dwordx4 v[60:63], v0, s[74:75] offset:1024 sc1
global_load_dwordx4 v[80:83], v0, s[74:75] offset:2048 sc1
global_load_dwordx4 v[84:87], v0, s[74:75] offset:3072 sc1
s_nop 15
s_nop 15
s_nop 15
s_nop 15
s_nop 15
s_nop 6
s_barrier
global_load_dwordx4 v[32:35], v0, s[66:67] offset:-4096 sc1
s_nop 10
global_load_dwordx4 v[36:39], v0, s[66:67] offset:0 sc1
s_barrier
global_load_dwordx4 v[48:51], v0, s[42:43] offset:0 nt sc1
global_load_dwordx4 v[52:55], v0, s[42:43] offset:1024 nt sc1
s_mov_b32 s30, 0
s_cmp_eq_u32 s17, s31
s_cbranch_scc0 gather_10055
s_branch exit_10058
rt_10060:
global_load_dwordx4 v[32:35], v0, s[66:67] offset:-4096 sc1
global_load_dwordx4 v[36:39], v0, s[66:67] offset:0 sc1
s_add_u32 s30, s30, 1
s_cmp_gt_u32 s30, 262144
s_cbranch_scc1 L_fail
v_mov_b64 v[8:9], 0
v_mov_b64 v[10:11], 0
v_mov_b64 v[12:13], 0
v_mov_b64 v[14:15], 0
v_mov_b64 v[16:17], 0
v_mov_b64 v[18:19], 0
v_mov_b64 v[20:21], 0
v_mov_b64 v[22:23], 0
v_mov_b64 v[24:25], 0
v_mov_b64 v[26:27], 0
v_mov_b64 v[28:29], 0
v_mov_b64 v[30:31], 0
s_waitcnt vmcnt(1)
v_bitop3_b32 v40, v32, v34, s18 bitop3:0x7e
s_waitcnt vmcnt(0)
v_bitop3_b32 v41, v36, v38, s18 bitop3:0x7e
v_bitop3_b32 v40, v40, v41, s19 bitop3:0xa8
v_cmp_ne_u32 vcc, 0, v40
s_cbranch_vccnz rt_10060
s_branch rt_10060_b
rare_10056:
ds_read_b128 v[48:51], v6 offset:6144
ds_read_b128 v[52:55], v6 offset:7168
s_waitcnt lgkmcnt(0)
v_add_f32 v48, v48, v52
v_add_f32 v49, v49, v53
v_add_f32 v50, v50, v54
v_add_f32 v51, v51, v55
v_mov_b32_dpp v46, v46 quad_perm:[0,1,0,1] row_mask:0xf bank_mask:0xf
v_mov_b32_dpp v47, v47 quad_perm:[0,1,0,1] row_mask:0xf bank_mask:0xf
v_max3_f32 v19, v48, v49, v50
v_max3_f32 v19, v19, v51, v46
v_max_f32 v19, v19, v47
s_nop 1
v_max_f32_dpp v19, v19, v19 quad_perm:[2,3,0,1] row_mask:0xf bank_mask:0xf
v_mov_b32 v44, v19
s_nop 1
v_permlane32_swap_b32 v19, v44
v_max_f32 v19, v19, v44
v_mov_b32 v44, v19
s_nop 1
v_permlane16_swap_b32 v19, v44
v_max_f32 v19, v19, v44
v_sub_f32 v48, v48, v19
v_sub_f32 v49, v49, v19
v_sub_f32 v50, v50, v19
v_sub_f32 v51, v51, v19
v_sub_f32 v46, v46, v19
v_sub_f32 v47, v47, v19
v_exp_f32 v48, v48
v_exp_f32 v49, v49
v_exp_f32 v50, v50
v_exp_f32 v51, v51
v_cvt_pk_bf16_f32 v54, v48, v49
v_cvt_pk_bf16_f32 v55, v50, v51
s_nop 0
v_mov_b32_dpp v48, v54 quad_perm:[0,1,0,1] row_mask:0xf bank_mask:0xf
v_mov_b32_dpp v49, v55 quad_perm:[0,1,0,1] row_mask:0xf bank_mask:0xf
v_mov_b32_dpp v50, v54 quad_perm:[2,3,2,3] row_mask:0xf bank_mask:0xf
v_mov_b32_dpp v51, v55 quad_perm:[2,3,2,3] row_mask:0xf bank_mask:0xf
v_mov_b64 v[20:21], s[44:45]
v_mov_b64 v[22:23], s[44:45]
v_mfma_f32_16x16x32_bf16 v[8:11], v[56:59], v[48:51], 0
v_mfma_f32_16x16x32_bf16 v[12:15], v[60:63], v[48:51], 0
v_mfma_f32_16x16x32_bf16 v[16:19], v[20:23], v[48:51], 0
v_mov_b64 v[54:55], s[46:47]
v_exp_f32_dpp v44, v46 quad_perm:[0,1,0,1] row_mask:0xf bank_mask:0xf
v_exp_f32_dpp v45, v47 quad_perm:[0,1,0,1] row_mask:0xf bank_mask:0xf
s_nop 0
v_cvt_pk_bf16_f32 v52, v44, v45
v_cvt_pk_bf16_f32 v53, v44, v45
s_nop 1
v_mfma_f32_16x16x16_bf16 v[16:19], v[54:55], v[52:53], v[16:19]
v_mfma_f32_16x16x16_bf16 v[8:11], v[24:25], v[52:53], v[8:11]
v_mfma_f32_16x16x16_bf16 v[12:15], v[26:27], v[52:53], v[12:15]
s_nop 5
v_rcp_f32 v18, v16
s_nop 0
v_cndmask_b32 v8, v12, v8, s[40:41]
v_mul_f32 v8, v8, v18
v_cndmask_b32 v9, v13, v9, s[40:41]
v_mul_f32 v9, v9, v18
v_cndmask_b32 v10, v14, v10, s[40:41]
v_mul_f32 v10, v10, v18
v_cndmask_b32 v11, v15, v11, s[40:41]
v_mul_f32 v11, v11, v18
v_cvt_pk_bf16_f32 v12, v8, v9
v_cvt_pk_bf16_f32 v13, v10, v11
s_branch back_10057
exit_10058:
global_load_dwordx4 v[32:35], v0, s[66:67] offset:-4096 sc1
global_load_dwordx4 v[36:39], v0, s[66:67] offset:0 sc1
s_add_u32 s30, s30, 1
s_cmp_gt_u32 s30, 262144
s_cbranch_scc1 L_fail
s_waitcnt vmcnt(1)
v_bitop3_b32 v44, v32, v34, s18 bitop3:0x7e
s_waitcnt vmcnt(0)
v_bitop3_b32 v45, v36, v38, s18 bitop3:0x7e
v_bitop3_b32 v44, v44, v45, s19 bitop3:0xa8
v_cmp_ne_u32 vcc, 0, v44
s_cbranch_vccnz exit_10058
s_add_u32 s35, s35, 1
s_cmp_lt_u32 s35, 2
s_cbranch_scc1 layer_10054
s_endpgm
grp_10001:
s_lshr_b32 s24, s14, 1
v_and_b32 v64, 63, v0
v_and_b32 v65, 15, v64
v_lshrrev_b32 v66, 4, v64
v_lshlrev_b32 v0, 4, v64
v_and_b32 v67, 2, v64
v_mov_b32 v68, 0x4444
v_mov_b32 v69, 0xeeee
v_cmp_eq_u32 vcc, 0, v67
s_nop 1
v_cndmask_b32 v1, v69, v68, vcc
s_mul_i32 s26, s13, 24576
s_add_u32 s26, s26, 65536
v_add_u32 v2, s26, v0
v_lshrrev_b32 v67, 2, v65
v_xor_b32 v68, v66, v67
v_lshlrev_b32 v68, 3, v68
v_lshl_add_u32 v68, v65, 5, v68
s_lshl_b32 s26, s13, 10
s_add_u32 s26, s26, 10240
v_add_u32 v3, s26, v68
v_lshl_add_u32 v68, v66, 2, v67
v_and_b32 v69, 3, v65
v_xor_b32 v69, v69, v66
v_lshlrev_b32 v69, 3, v69
v_lshl_add_u32 v68, v68, 5, v69
v_add_u32 v4, 10240, v68
v_and_b32 v69, 1, v65
v_lshl_add_u32 v68, v67, 1, v69
v_lshlrev_b32 v68, 4, v68
v_lshl_add_u32 v68, v66, 7, v68
v_add_u32 v5, 8192, v68
v_bfe_u32 v69, v65, 1, 1
v_mul_u32_u24 v69, 640, v69
v_xor_b32 v6, v69, v5
s_mov_b32 s40, 0x33333333
s_mov_b32 s41, 0x33333333
s_mov_b32 s44, 0x3f803f80
s_mov_b32 s45, 0x3f803f80
s_mov_b32 s46, 0x3f803f80
s_mov_b32 s47, 0
s_mov_b32 s36, 729808896
s_mov_b32 s37, 671088640
v_lshlrev_b32 v68, 3, v65
v_lshl_add_u32 v7, v66, 12, v68
s_lshl_b32 s26, s13, 14
s_lshl_b32 s27, s14, 7
s_add_u32 s26, s26, s27
s_add_u32 s90, s26, 65536
s_lshl_b32 s26, s13, 5
s_add_u32 s93, s26, s14
s_lshl_b32 s26, s93, 12
s_add_u32 s91, s26, 65536
s_lshr_b32 s26, s93, 2
s_lshl_b32 s26, s26, 9
s_and_b32 s27, s93, 3
s_lshl_b32 s27, s27, 6
s_add_u32 s26, s26, s27
s_add_u32 s92, s26, 393216
s_lshl_b32 s26, s14, 7
s_add_u32 s22, s26, 0
s_lshl_b32 s26, s24, 2
s_add_u32 s26, s26, 4096
s_cmp_lt_u32 s24, 10
s_cselect_b32 s23, s26, 268435456
s_cselect_b32 s24, s24, 0
s_cselect_b32 s25, 12582912, s23
s_lshl_b32 s24, s24, 10
s_and_b32 s26, s14, 1
s_lshl_b32 s26, s26, 10
s_add_u32 s94, s26, 425984
s_lshl_b32 s26, s14, 5
s_add_u32 s95, s26, 425984
s_mov_b32 s34, 0x3e0293ee
s_lshl_b32 s26, s14, 2
s_add_u32 s26, s26, s13
s_mul_i32 s27, s26, 18432
s_add_u32 s89, s27, 1048576
s_add_u32 s48, s4, s90
s_addc_u32 s49, s5, 0
s_add_u32 s50, s90, 65536
s_add_u32 s50, s4, s50
s_addc_u32 s51, s5, 0
s_add_u32 s52, s90, 131072
s_add_u32 s52, s4, s52
s_addc_u32 s53, s5, 0
s_add_u32 s54, s90, 196608
s_add_u32 s54, s4, s54
s_addc_u32 s55, s5, 0
s_add_u32 s56, s90, 262144
s_add_u32 s56, s4, s56
s_addc_u32 s57, s5, 0
s_add_u32 s74, s89, 4096
s_add_u32 s74, s4, s74
s_addc_u32 s75, s5, 0
s_add_u32 s76, s89, 12288
s_add_u32 s76, s4, s76
s_addc_u32 s77, s5, 0
s_add_u32 s78, s89, 20480
s_add_u32 s78, s4, s78
s_addc_u32 s79, s5, 0
s_add_u32 s58, s4, s94
s_addc_u32 s59, s5, 0
s_add_u32 s60, s4, s95
s_addc_u32 s61, s5, 0
s_add_u32 s62, s4, s91
s_addc_u32 s63, s5, 0
s_add_u32 s64, s4, s92
s_addc_u32 s65, s5, 0
v_mov_b32 v72, 0
v_mov_b32 v73, 0
s_mov_b32 s26, s90
buffer_store_dwordx2 v[72:73], v7, s[4:7], s26 offen
s_add_u32 s26, s26, 65536
buffer_store_dwordx2 v[72:73], v7, s[4:7], s26 offen
s_add_u32 s26, s26, 65536
buffer_store_dwordx2 v[72:73], v7, s[4:7], s26 offen
s_add_u32 s26, s26, 65536
buffer_store_dwordx2 v[72:73], v7, s[4:7], s26 offen
s_add_u32 s26, s26, 65536
buffer_store_dwordx2 v[72:73], v7, s[4:7], s26 offen
s_add_u32 s26, s26, 65536
buffer_store_dword v72, off, s[4:7], s95 offset:0
buffer_store_dword v72, off, s[4:7], s95 offset:1024
s_load_dwordx2 s[96:97], s[0:1], 32
s_mov_b32 s98, 10240
s_mov_b32 s99, 0x20000
s_cmp_ge_u32 s93, 80
s_cbranch_scc1 nm0_10072
s_and_b32 s26, s93, 3
s_mul_i32 s26, s26, 2560
s_lshr_b32 s27, s93, 2
s_lshl_b32 s27, s27, 6
s_add_u32 s26, s26, s27
v_bfe_u32 v68, v65, 1, 2
v_lshlrev_b32 v68, 4, v68
v_and_b32 v69, 1, v65
v_lshl_add_u32 v68, v69, 2, v68
v_and_b32 v69, 1, v66
v_mul_u32_u24 v69, 1280, v69
v_add_u32 v68, v68, v69
s_waitcnt lgkmcnt(0)
buffer_load_dword v74, v68, s[96:99], s26 offen
buffer_load_dword v75, v68, s[96:99], s26 offen offset:8
v_and_b32 v68, 32, v0
v_bfe_u32 v69, v0, 6, 1
v_lshl_add_u32 v68, v69, 8, v68
v_bfe_u32 v69, v0, 8, 1
v_lshl_add_u32 v68, v69, 4, v68
v_bfe_u32 v69, v0, 4, 1
v_lshl_add_u32 v68, v69, 3, v68
s_add_u32 s27, s92, 16384
buffer_store_dwordx2 v[72:73], v68, s[4:7], s92 offen
s_waitcnt vmcnt(1)
buffer_store_dwordx2 v[74:75], v68, s[4:7], s27 offen
nm0_10072:
s_waitcnt vmcnt(0) lgkmcnt(0)
v_lshrrev_b32 v67, 3, v64
v_and_b32 v68, 7, v64
v_lshlrev_b32 v68, 4, v68
v_lshl_add_u32 v32, v67, 13, v68
v_mul_u32_u24 v67, 1280, v67
v_add_u32 v36, v67, v68
v_lshrrev_b32 v67, 1, v66
v_lshlrev_b32 v67, 4, v67
v_and_b32 v68, 1, v66
v_lshl_add_u32 v67, v68, 1, v67
v_lshrrev_b32 v68, 3, v65
v_lshl_add_u32 v67, v68, 3, v67
v_bfe_u32 v68, v65, 2, 1
v_add_u32 v67, v67, v68
v_and_b32 v69, 3, v65
v_lshlrev_b32 v40, 4, v69
v_lshl_add_u32 v40, v67, 7, v40
v_lshl_add_u32 v67, v66, 2, v68
v_lshlrev_b32 v42, 4, v69
v_lshl_add_u32 v42, v67, 7, v42
v_lshrrev_b32 v68, 3, v65
v_lshl_add_u32 v42, v68, 3, v42
s_lshl_b32 s29, s13, 12
s_and_b32 s26, s13, 1
s_lshl_b32 s26, s26, 6
s_add_u32 s26, s26, s29
v_add_u32 v40, s26, v40
v_add_u32 v42, s26, v42
v_xor_b32 v41, 4096, v40
v_xor_b32 v43, 4096, v42
v_add_u32 v33, 64512, v32
v_add_u32 v37, 9216, v36
v_add_u32 v34, 129024, v32
v_add_u32 v38, 18432, v36
v_add_u32 v35, 193536, v32
v_add_u32 v39, 27648, v36
s_lshr_b32 s28, s13, 1
s_lshl_b32 s28, s28, 7
s_lshl_b32 s27, s14, 8
s_add_u32 s27, s27, s28
s_xor_b32 s26, s13, 0
s_lshl_b32 s80, s26, 19
s_add_u32 s80, s80, s27
s_lshl_b32 s83, s14, 2
s_add_u32 s83, s83, s26
s_mul_i32 s83, s83, 40960
s_add_u32 s83, s83, s28
s_xor_b32 s26, s13, 2
s_lshl_b32 s81, s26, 19
s_add_u32 s81, s81, s27
s_lshl_b32 s84, s14, 2
s_add_u32 s84, s84, s26
s_mul_i32 s84, s84, 40960
s_add_u32 s84, s84, s28
s_and_b32 s26, s13, 1
s_add_u32 s26, s26, 8
s_lshl_b32 s82, s26, 19
s_add_u32 s82, s82, s27
s_load_dwordx2 s[66:67], s[0:1], 40
s_load_dwordx2 s[68:69], s[0:1], 48
s_load_dwordx2 s[70:71], s[0:1], 56
s_load_dwordx2 s[72:73], s[0:1], 64
s_mov_b32 s98, 5242880
s_waitcnt lgkmcnt(0)
s_mov_b64 s[96:97], s[68:69]
s_add_u32 m0, s29, 0
s_add_u32 s26, s80, 0
buffer_load_dwordx4 v32, s[96:99], s26 offen offset:0 lds
buffer_load_dwordx4 v33, s[96:99], s26 offen offset:1024 lds
buffer_load_dwordx4 v34, s[96:99], s26 offen offset:2048 lds
buffer_load_dwordx4 v35, s[96:99], s26 offen offset:3072 lds
s_add_u32 m0, s29, 16384
s_add_u32 s26, s80, 262144
buffer_load_dwordx4 v32, s[96:99], s26 offen offset:0 lds
buffer_load_dwordx4 v33, s[96:99], s26 offen offset:1024 lds
buffer_load_dwordx4 v34, s[96:99], s26 offen offset:2048 lds
buffer_load_dwordx4 v35, s[96:99], s26 offen offset:3072 lds
s_add_u32 m0, s29, 32768
s_add_u32 s26, s80, 2097152
buffer_load_dwordx4 v32, s[96:99], s26 offen offset:0 lds
buffer_load_dwordx4 v33, s[96:99], s26 offen offset:1024 lds
buffer_load_dwordx4 v34, s[96:99], s26 offen offset:2048 lds
buffer_load_dwordx4 v35, s[96:99], s26 offen offset:3072 lds
s_waitcnt vmcnt(8)
s_barrier
s_add_u32 m0, s29, 49152
s_add_u32 s26, s80, 2359296
buffer_load_dwordx4 v32, s[96:99], s26 offen offset:0 lds
buffer_load_dwordx4 v33, s[96:99], s26 offen offset:1024 lds
buffer_load_dwordx4 v34, s[96:99], s26 offen offset:2048 lds
buffer_load_dwordx4 v35, s[96:99], s26 offen offset:3072 lds
ds_read_b64_tr_b16 v[72:73], v40 offset:0
ds_read_b64_tr_b16 v[74:75], v40 offset:512
ds_read_b64_tr_b16 v[76:77], v40 offset:8
ds_read_b64_tr_b16 v[78:79], v40 offset:520
ds_read_b64_tr_b16 v[80:81], v41 offset:0
ds_read_b64_tr_b16 v[82:83], v41 offset:512
ds_read_b64_tr_b16 a[128:129], v41 offset:8
ds_read_b64_tr_b16 a[130:131], v41 offset:520
s_waitcnt lgkmcnt(6)
global_store_dwordx4 v0, v[72:75], s[74:75] offset:0
s_waitcnt lgkmcnt(4)
global_store_dwordx4 v0, v[76:79], s[74:75] offset:2048
s_waitcnt lgkmcnt(2)
ds_write_b128 v2, v[80:83] offset:12288
s_waitcnt vmcnt(10) lgkmcnt(1)
s_barrier
s_add_u32 m0, s29, 0
s_add_u32 s26, s81, 0
buffer_load_dwordx4 v32, s[96:99], s26 offen offset:0 lds
buffer_load_dwordx4 v33, s[96:99], s26 offen offset:1024 lds
buffer_load_dwordx4 v34, s[96:99], s26 offen offset:2048 lds
buffer_load_dwordx4 v35, s[96:99], s26 offen offset:3072 lds
ds_read_b64_tr_b16 v[72:73], v40 offset:16384
ds_read_b64_tr_b16 v[74:75], v40 offset:16896
ds_read_b64_tr_b16 v[76:77], v40 offset:16392
ds_read_b64_tr_b16 v[78:79], v40 offset:16904
ds_read_b64_tr_b16 v[80:81], v41 offset:16384
ds_read_b64_tr_b16 v[82:83], v41 offset:16896
ds_read_b64_tr_b16 a[132:133], v41 offset:16392
ds_read_b64_tr_b16 a[134:135], v41 offset:16904
s_waitcnt lgkmcnt(6)
global_store_dwordx4 v0, v[72:75], s[74:75] offset:1024
s_waitcnt lgkmcnt(4)
global_store_dwordx4 v0, v[76:79], s[74:75] offset:3072
s_waitcnt lgkmcnt(2)
ds_write_b128 v2, v[80:83] offset:13312
s_waitcnt vmcnt(12) lgkmcnt(1)
s_barrier
s_add_u32 m0, s29, 16384
s_add_u32 s26, s81, 262144
buffer_load_dwordx4 v32, s[96:99], s26 offen offset:0 lds
buffer_load_dwordx4 v33, s[96:99], s26 offen offset:1024 lds
buffer_load_dwordx4 v34, s[96:99], s26 offen offset:2048 lds
buffer_load_dwordx4 v35, s[96:99], s26 offen offset:3072 lds
ds_read_b64_tr_b16 a[32:33], v40 offset:32768
ds_read_b64_tr_b16 a[34:35], v40 offset:33280
ds_read_b64_tr_b16 a[40:41], v40 offset:32776
ds_read_b64_tr_b16 a[42:43], v40 offset:33288
ds_read_b64_tr_b16 a[136:137], v41 offset:32768
ds_read_b64_tr_b16 a[138:139], v41 offset:33280
ds_read_b64_tr_b16 v[84:85], v41 offset:32776
ds_read_b64_tr_b16 v[86:87], v41 offset:33288
s_waitcnt lgkmcnt(0)
ds_write_b128 v2, v[84:87] offset:14336
s_waitcnt vmcnt(12)
s_barrier
s_add_u32 m0, s29, 32768
s_add_u32 s26, s81, 2097152
buffer_load_dwordx4 v32, s[96:99], s26 offen offset:0 lds
buffer_load_dwordx4 v33, s[96:99], s26 offen offset:1024 lds
buffer_load_dwordx4 v34, s[96:99], s26 offen offset:2048 lds
buffer_load_dwordx4 v35, s[96:99], s26 offen offset:3072 lds
ds_read_b64_tr_b16 a[36:37], v40 offset:49152
ds_read_b64_tr_b16 a[38:39], v40 offset:49664
ds_read_b64_tr_b16 a[44:45], v40 offset:49160
ds_read_b64_tr_b16 a[46:47], v40 offset:49672
ds_read_b64_tr_b16 a[140:141], v41 offset:49152
ds_read_b64_tr_b16 a[142:143], v41 offset:49664
ds_read_b64_tr_b16 v[84:85], v41 offset:49160
ds_read_b64_tr_b16 v[86:87], v41 offset:49672
s_waitcnt lgkmcnt(0)
ds_write_b128 v2, v[84:87] offset:15360
s_waitcnt vmcnt(10)
s_barrier
s_add_u32 m0, s29, 49152
s_add_u32 s26, s81, 2359296
buffer_load_dwordx4 v32, s[96:99], s26 offen offset:0 lds
buffer_load_dwordx4 v33, s[96:99], s26 offen offset:1024 lds
buffer_load_dwordx4 v34, s[96:99], s26 offen offset:2048 lds
buffer_load_dwordx4 v35, s[96:99], s26 offen offset:3072 lds
ds_read_b64_tr_b16 a[144:145], v40 offset:0
ds_read_b64_tr_b16 a[146:147], v40 offset:512
ds_read_b64_tr_b16 a[152:153], v40 offset:8
ds_read_b64_tr_b16 a[154:155], v40 offset:520
ds_read_b64_tr_b16 a[160:161], v41 offset:0
ds_read_b64_tr_b16 a[162:163], v41 offset:512
ds_read_b64_tr_b16 a[168:169], v41 offset:8
ds_read_b64_tr_b16 a[170:171], v41 offset:520
s_waitcnt vmcnt(8) lgkmcnt(0)
s_barrier
s_add_u32 m0, s29, 0
s_add_u32 s26, s82, 0
buffer_load_dwordx4 v32, s[96:99], s26 offen offset:0 lds
buffer_load_dwordx4 v33, s[96:99], s26 offen offset:1024 lds
buffer_load_dwordx4 v34, s[96:99], s26 offen offset:2048 lds
buffer_load_dwordx4 v35, s[96:99], s26 offen offset:3072 lds
ds_read_b64_tr_b16 a[148:149], v40 offset:16384
ds_read_b64_tr_b16 a[150:151], v40 offset:16896
ds_read_b64_tr_b16 a[156:157], v40 offset:16392
ds_read_b64_tr_b16 a[158:159], v40 offset:16904
ds_read_b64_tr_b16 a[164:165], v41 offset:16384
ds_read_b64_tr_b16 a[166:167], v41 offset:16896
ds_read_b64_tr_b16 a[172:173], v41 offset:16392
ds_read_b64_tr_b16 a[174:175], v41 offset:16904
s_waitcnt vmcnt(8) lgkmcnt(0)
s_barrier
s_add_u32 m0, s29, 16384
s_add_u32 s26, s82, 262144
buffer_load_dwordx4 v32, s[96:99], s26 offen offset:0 lds
buffer_load_dwordx4 v33, s[96:99], s26 offen offset:1024 lds
buffer_load_dwordx4 v34, s[96:99], s26 offen offset:2048 lds
buffer_load_dwordx4 v35, s[96:99], s26 offen offset:3072 lds
ds_read_b64_tr_b16 v[72:73], v40 offset:32768
ds_read_b64_tr_b16 v[74:75], v40 offset:33280
ds_read_b64_tr_b16 v[76:77], v40 offset:32776
ds_read_b64_tr_b16 v[78:79], v40 offset:33288
ds_read_b64_tr_b16 a[176:177], v41 offset:32768
ds_read_b64_tr_b16 a[178:179], v41 offset:33280
ds_read_b64_tr_b16 v[84:85], v41 offset:32776
ds_read_b64_tr_b16 v[86:87], v41 offset:33288
s_waitcnt lgkmcnt(6)
global_store_dwordx4 v0, v[72:75], s[76:77] offset:0
s_waitcnt lgkmcnt(4)
ds_write_b128 v2, v[76:79] offset:16384
s_waitcnt lgkmcnt(1)
ds_write_b128 v2, v[84:87] offset:18432
s_waitcnt vmcnt(9)
s_barrier
s_mov_b64 s[96:97], s[70:71]
s_add_u32 m0, s29, 32768
s_add_u32 s26, s80, 0
buffer_load_dwordx4 v32, s[96:99], s26 offen offset:0 lds
buffer_load_dwordx4 v33, s[96:99], s26 offen offset:1024 lds
buffer_load_dwordx4 v34, s[96:99], s26 offen offset:2048 lds
buffer_load_dwordx4 v35, s[96:99], s26 offen offset:3072 lds
ds_read_b64_tr_b16 v[72:73], v40 offset:49152
ds_read_b64_tr_b16 v[74:75], v40 offset:49664
ds_read_b64_tr_b16 v[76:77], v40 offset:49160
ds_read_b64_tr_b16 v[78:79], v40 offset:49672
ds_read_b64_tr_b16 a[180:181], v41 offset:49152
ds_read_b64_tr_b16 a[182:183], v41 offset:49664
ds_read_b64_tr_b16 v[84:85], v41 offset:49160
ds_read_b64_tr_b16 v[86:87], v41 offset:49672
s_waitcnt lgkmcnt(6)
global_store_dwordx4 v0, v[72:75], s[76:77] offset:1024
s_waitcnt lgkmcnt(4)
ds_write_b128 v2, v[76:79] offset:17408
s_waitcnt lgkmcnt(1)
ds_write_b128 v2, v[84:87] offset:19456
s_waitcnt vmcnt(10)
s_barrier
s_add_u32 m0, s29, 49152
s_add_u32 s26, s80, 262144
buffer_load_dwordx4 v32, s[96:99], s26 offen offset:0 lds
buffer_load_dwordx4 v33, s[96:99], s26 offen offset:1024 lds
buffer_load_dwordx4 v34, s[96:99], s26 offen offset:2048 lds
buffer_load_dwordx4 v35, s[96:99], s26 offen offset:3072 lds
ds_read_b64_tr_b16 a[184:185], v40 offset:0
ds_read_b64_tr_b16 a[186:187], v40 offset:512
ds_read_b64_tr_b16 a[192:193], v40 offset:8
ds_read_b64_tr_b16 a[194:195], v40 offset:520
ds_read_b64_tr_b16 a[200:201], v41 offset:0
ds_read_b64_tr_b16 a[202:203], v41 offset:512
ds_read_b64_tr_b16 a[208:209], v41 offset:8
ds_read_b64_tr_b16 a[210:211], v41 offset:520
s_waitcnt vmcnt(10) lgkmcnt(0)
s_barrier
s_add_u32 m0, s29, 0
s_add_u32 s26, s80, 2097152
buffer_load_dwordx4 v32, s[96:99], s26 offen offset:0 lds
buffer_load_dwordx4 v33, s[96:99], s26 offen offset:1024 lds
buffer_load_dwordx4 v34, s[96:99], s26 offen offset:2048 lds
buffer_load_dwordx4 v35, s[96:99], s26 offen offset:3072 lds
ds_read_b64_tr_b16 a[188:189], v40 offset:16384
ds_read_b64_tr_b16 a[190:191], v40 offset:16896
ds_read_b64_tr_b16 a[196:197], v40 offset:16392
ds_read_b64_tr_b16 a[198:199], v40 offset:16904
ds_read_b64_tr_b16 a[204:205], v41 offset:16384
ds_read_b64_tr_b16 a[206:207], v41 offset:16896
ds_read_b64_tr_b16 a[212:213], v41 offset:16392
ds_read_b64_tr_b16 a[214:215], v41 offset:16904
s_waitcnt vmcnt(9) lgkmcnt(0)
s_barrier
s_add_u32 m0, s29, 16384
s_add_u32 s26, s80, 2359296
buffer_load_dwordx4 v32, s[96:99], s26 offen offset:0 lds
buffer_load_dwordx4 v33, s[96:99], s26 offen offset:1024 lds
buffer_load_dwordx4 v34, s[96:99], s26 offen offset:2048 lds
buffer_load_dwordx4 v35, s[96:99], s26 offen offset:3072 lds
ds_read_b64_tr_b16 a[0:1], v40 offset:32768
ds_read_b64_tr_b16 a[2:3], v40 offset:33280
ds_read_b64_tr_b16 a[8:9], v40 offset:32776
ds_read_b64_tr_b16 a[10:11], v40 offset:33288
ds_read_b64_tr_b16 a[240:241], v41 offset:32768
ds_read_b64_tr_b16 a[242:243], v41 offset:33280
ds_read_b64_tr_b16 a[248:249], v41 offset:32776
ds_read_b64_tr_b16 a[250:251], v41 offset:33288
s_waitcnt vmcnt(8) lgkmcnt(0)
s_barrier
s_add_u32 m0, s29, 32768
s_add_u32 s26, s81, 0
buffer_load_dwordx4 v32, s[96:99], s26 offen offset:0 lds
buffer_load_dwordx4 v33, s[96:99], s26 offen offset:1024 lds
buffer_load_dwordx4 v34, s[96:99], s26 offen offset:2048 lds
buffer_load_dwordx4 v35, s[96:99], s26 offen offset:3072 lds
ds_read_b64_tr_b16 a[4:5], v40 offset:49152
ds_read_b64_tr_b16 a[6:7], v40 offset:49664
ds_read_b64_tr_b16 a[12:13], v40 offset:49160
ds_read_b64_tr_b16 a[14:15], v40 offset:49672
ds_read_b64_tr_b16 a[244:245], v41 offset:49152
ds_read_b64_tr_b16 a[246:247], v41 offset:49664
ds_read_b64_tr_b16 a[252:253], v41 offset:49160
ds_read_b64_tr_b16 a[254:255], v41 offset:49672
s_waitcnt vmcnt(8) lgkmcnt(0)
s_barrier
s_add_u32 m0, s29, 49152
s_add_u32 s26, s81, 262144
buffer_load_dwordx4 v32, s[96:99], s26 offen offset:0 lds
buffer_load_dwordx4 v33, s[96:99], s26 offen offset:1024 lds
buffer_load_dwordx4 v34, s[96:99], s26 offen offset:2048 lds
buffer_load_dwordx4 v35, s[96:99], s26 offen offset:3072 lds
ds_read_b64_tr_b16 v[72:73], v40 offset:0
ds_read_b64_tr_b16 v[74:75], v40 offset:512
ds_read_b64_tr_b16 v[76:77], v40 offset:8
ds_read_b64_tr_b16 v[78:79], v40 offset:520
ds_read_b64_tr_b16 v[80:81], v41 offset:0
ds_read_b64_tr_b16 v[82:83], v41 offset:512
ds_read_b64_tr_b16 v[88:89], v41 offset:8
ds_read_b64_tr_b16 v[90:91], v41 offset:520
s_waitcnt lgkmcnt(6)
ds_write_b128 v2, v[72:75] offset:0
s_waitcnt lgkmcnt(5)
ds_write_b128 v2, v[76:79] offset:2048
s_waitcnt lgkmcnt(4)
global_store_dwordx4 v0, v[80:83], s[76:77] offset:2048
s_waitcnt vmcnt(9) lgkmcnt(2)
s_barrier
s_add_u32 m0, s29, 0
s_add_u32 s26, s81, 2097152
buffer_load_dwordx4 v32, s[96:99], s26 offen offset:0 lds
buffer_load_dwordx4 v33, s[96:99], s26 offen offset:1024 lds
buffer_load_dwordx4 v34, s[96:99], s26 offen offset:2048 lds
buffer_load_dwordx4 v35, s[96:99], s26 offen offset:3072 lds
ds_read_b64_tr_b16 v[72:73], v40 offset:16384
ds_read_b64_tr_b16 v[74:75], v40 offset:16896
ds_read_b64_tr_b16 v[76:77], v40 offset:16392
ds_read_b64_tr_b16 v[78:79], v40 offset:16904
ds_read_b64_tr_b16 v[80:81], v41 offset:16384
ds_read_b64_tr_b16 v[82:83], v41 offset:16896
ds_read_b64_tr_b16 v[92:93], v41 offset:16392
ds_read_b64_tr_b16 v[94:95], v41 offset:16904
s_waitcnt lgkmcnt(6)
ds_write_b128 v2, v[72:75] offset:1024
s_waitcnt lgkmcnt(5)
ds_write_b128 v2, v[76:79] offset:3072
s_waitcnt lgkmcnt(4)
global_store_dwordx4 v0, v[80:83], s[76:77] offset:3072
s_waitcnt vmcnt(10) lgkmcnt(2)
s_barrier
s_add_u32 m0, s29, 16384
s_add_u32 s26, s81, 2359296
buffer_load_dwordx4 v32, s[96:99], s26 offen offset:0 lds
buffer_load_dwordx4 v33, s[96:99], s26 offen offset:1024 lds
buffer_load_dwordx4 v34, s[96:99], s26 offen offset:2048 lds
buffer_load_dwordx4 v35, s[96:99], s26 offen offset:3072 lds
ds_read_b64_tr_b16 v[96:97], v40 offset:32768
ds_read_b64_tr_b16 v[98:99], v40 offset:33280
ds_read_b64_tr_b16 v[104:105], v40 offset:32776
ds_read_b64_tr_b16 v[106:107], v40 offset:33288
ds_read_b64_tr_b16 v[128:129], v41 offset:32768
ds_read_b64_tr_b16 v[130:131], v41 offset:33280
ds_read_b64_tr_b16 v[136:137], v41 offset:32776
ds_read_b64_tr_b16 v[138:139], v41 offset:33288
s_waitcnt vmcnt(10) lgkmcnt(0)
s_barrier
s_add_u32 m0, s29, 32768
s_add_u32 s26, s82, 0
buffer_load_dwordx4 v32, s[96:99], s26 offen offset:0 lds
buffer_load_dwordx4 v33, s[96:99], s26 offen offset:1024 lds
buffer_load_dwordx4 v34, s[96:99], s26 offen offset:2048 lds
buffer_load_dwordx4 v35, s[96:99], s26 offen offset:3072 lds
ds_read_b64_tr_b16 v[100:101], v40 offset:49152
ds_read_b64_tr_b16 v[102:103], v40 offset:49664
ds_read_b64_tr_b16 v[108:109], v40 offset:49160
ds_read_b64_tr_b16 v[110:111], v40 offset:49672
ds_read_b64_tr_b16 v[132:133], v41 offset:49152
ds_read_b64_tr_b16 v[134:135], v41 offset:49664
ds_read_b64_tr_b16 v[140:141], v41 offset:49160
ds_read_b64_tr_b16 v[142:143], v41 offset:49672
s_waitcnt vmcnt(9) lgkmcnt(0)
s_barrier
s_add_u32 m0, s29, 49152
s_add_u32 s26, s82, 262144
buffer_load_dwordx4 v32, s[96:99], s26 offen offset:0 lds
buffer_load_dwordx4 v33, s[96:99], s26 offen offset:1024 lds
buffer_load_dwordx4 v34, s[96:99], s26 offen offset:2048 lds
buffer_load_dwordx4 v35, s[96:99], s26 offen offset:3072 lds
ds_read_b64_tr_b16 v[112:113], v40 offset:0
ds_read_b64_tr_b16 v[114:115], v40 offset:512
ds_read_b64_tr_b16 v[120:121], v40 offset:8
ds_read_b64_tr_b16 v[122:123], v40 offset:520
ds_read_b64_tr_b16 v[80:81], v41 offset:0
ds_read_b64_tr_b16 v[82:83], v41 offset:512
ds_read_b64_tr_b16 v[144:145], v41 offset:8
ds_read_b64_tr_b16 v[146:147], v41 offset:520
s_waitcnt lgkmcnt(2)
global_store_dwordx4 v0, v[80:83], s[78:79] offset:-4096
s_waitcnt vmcnt(9) lgkmcnt(0)
s_barrier
s_mov_b64 s[96:97], s[66:67]
s_add_u32 m0, s29, 0
s_add_u32 s26, s80, 0
buffer_load_dwordx4 v32, s[96:99], s26 offen offset:0 lds
buffer_load_dwordx4 v33, s[96:99], s26 offen offset:1024 lds
buffer_load_dwordx4 v34, s[96:99], s26 offen offset:2048 lds
buffer_load_dwordx4 v35, s[96:99], s26 offen offset:3072 lds
ds_read_b64_tr_b16 v[116:117], v40 offset:16384
ds_read_b64_tr_b16 v[118:119], v40 offset:16896
ds_read_b64_tr_b16 v[124:125], v40 offset:16392
ds_read_b64_tr_b16 v[126:127], v40 offset:16904
ds_read_b64_tr_b16 v[80:81], v41 offset:16384
ds_read_b64_tr_b16 v[82:83], v41 offset:16896
ds_read_b64_tr_b16 v[148:149], v41 offset:16392
ds_read_b64_tr_b16 v[150:151], v41 offset:16904
s_waitcnt lgkmcnt(2)
global_store_dwordx4 v0, v[80:83], s[78:79] offset:-3072
s_waitcnt vmcnt(10) lgkmcnt(0)
s_barrier
s_add_u32 m0, s29, 16384
s_add_u32 s26, s80, 262144
buffer_load_dwordx4 v32, s[96:99], s26 offen offset:0 lds
buffer_load_dwordx4 v33, s[96:99], s26 offen offset:1024 lds
buffer_load_dwordx4 v34, s[96:99], s26 offen offset:2048 lds
buffer_load_dwordx4 v35, s[96:99], s26 offen offset:3072 lds
ds_read_b64_tr_b16 a[216:217], v40 offset:32768
ds_read_b64_tr_b16 a[218:219], v40 offset:33280
ds_read_b64_tr_b16 a[224:225], v40 offset:32776
ds_read_b64_tr_b16 a[226:227], v40 offset:33288
ds_read_b64_tr_b16 a[232:233], v41 offset:32768
ds_read_b64_tr_b16 a[234:235], v41 offset:33280
ds_read_b64_tr_b16 v[84:85], v41 offset:32776
ds_read_b64_tr_b16 v[86:87], v41 offset:33288
s_waitcnt lgkmcnt(0)
ds_write_b128 v2, v[84:87] offset:20480
s_waitcnt vmcnt(10)
s_barrier
s_add_u32 m0, s29, 32768
s_add_u32 s26, s80, 2097152
buffer_load_dwordx4 v32, s[96:99], s26 offen offset:0 lds
buffer_load_dwordx4 v33, s[96:99], s26 offen offset:1024 lds
buffer_load_dwordx4 v34, s[96:99], s26 offen offset:2048 lds
buffer_load_dwordx4 v35, s[96:99], s26 offen offset:3072 lds
ds_read_b64_tr_b16 a[220:221], v40 offset:49152
ds_read_b64_tr_b16 a[222:223], v40 offset:49664
ds_read_b64_tr_b16 a[228:229], v40 offset:49160
ds_read_b64_tr_b16 a[230:231], v40 offset:49672
ds_read_b64_tr_b16 a[236:237], v41 offset:49152
ds_read_b64_tr_b16 a[238:239], v41 offset:49664
ds_read_b64_tr_b16 v[84:85], v41 offset:49160
ds_read_b64_tr_b16 v[86:87], v41 offset:49672
s_waitcnt lgkmcnt(0)
ds_write_b128 v2, v[84:87] offset:21504
s_waitcnt vmcnt(9)
s_barrier
s_add_u32 m0, s29, 49152
s_add_u32 s26, s80, 2359296
buffer_load_dwordx4 v32, s[96:99], s26 offen offset:0 lds
buffer_load_dwordx4 v33, s[96:99], s26 offen offset:1024 lds
buffer_load_dwordx4 v34, s[96:99], s26 offen offset:2048 lds
buffer_load_dwordx4 v35, s[96:99], s26 offen offset:3072 lds
ds_read_b64_tr_b16 v[72:73], v40 offset:0
ds_read_b64_tr_b16 v[74:75], v40 offset:512
ds_read_b64_tr_b16 v[76:77], v40 offset:8
ds_read_b64_tr_b16 v[78:79], v40 offset:520
ds_read_b64_tr_b16 a[48:49], v41 offset:0
ds_read_b64_tr_b16 a[50:51], v41 offset:512
ds_read_b64_tr_b16 v[84:85], v41 offset:8
ds_read_b64_tr_b16 v[86:87], v41 offset:520
s_waitcnt lgkmcnt(6)
global_store_dwordx4 v0, v[72:75], s[74:75] offset:-4096
s_waitcnt lgkmcnt(4)
global_store_dwordx4 v0, v[76:79], s[74:75] offset:-2048
s_waitcnt lgkmcnt(0)
global_store_dwordx4 v0, v[84:87], s[76:77] offset:-4096
s_waitcnt vmcnt(11)
s_barrier
s_add_u32 m0, s29, 0
s_add_u32 s26, s81, 0
buffer_load_dwordx4 v32, s[96:99], s26 offen offset:0 lds
buffer_load_dwordx4 v33, s[96:99], s26 offen offset:1024 lds
buffer_load_dwordx4 v34, s[96:99], s26 offen offset:2048 lds
buffer_load_dwordx4 v35, s[96:99], s26 offen offset:3072 lds
ds_read_b64_tr_b16 v[72:73], v40 offset:16384
ds_read_b64_tr_b16 v[74:75], v40 offset:16896
ds_read_b64_tr_b16 v[76:77], v40 offset:16392
ds_read_b64_tr_b16 v[78:79], v40 offset:16904
ds_read_b64_tr_b16 a[52:53], v41 offset:16384
ds_read_b64_tr_b16 a[54:55], v41 offset:16896
ds_read_b64_tr_b16 v[84:85], v41 offset:16392
ds_read_b64_tr_b16 v[86:87], v41 offset:16904
s_waitcnt lgkmcnt(6)
global_store_dwordx4 v0, v[72:75], s[74:75] offset:-3072
s_waitcnt lgkmcnt(4)
global_store_dwordx4 v0, v[76:79], s[74:75] offset:-1024
s_waitcnt lgkmcnt(0)
global_store_dwordx4 v0, v[84:87], s[76:77] offset:-3072
s_waitcnt vmcnt(14)
s_barrier
s_add_u32 m0, s29, 16384
s_add_u32 s26, s81, 262144
buffer_load_dwordx4 v32, s[96:99], s26 offen offset:0 lds
buffer_load_dwordx4 v33, s[96:99], s26 offen offset:1024 lds
buffer_load_dwordx4 v34, s[96:99], s26 offen offset:2048 lds
buffer_load_dwordx4 v35, s[96:99], s26 offen offset:3072 lds
ds_read_b64_tr_b16 a[16:17], v40 offset:32768
ds_read_b64_tr_b16 a[18:19], v40 offset:33280
ds_read_b64_tr_b16 a[24:25], v40 offset:32776
ds_read_b64_tr_b16 a[26:27], v40 offset:33288
ds_read_b64_tr_b16 a[56:57], v41 offset:32768
ds_read_b64_tr_b16 a[58:59], v41 offset:33280
ds_read_b64_tr_b16 a[64:65], v41 offset:32776
ds_read_b64_tr_b16 a[66:67], v41 offset:33288
s_waitcnt vmcnt(14) lgkmcnt(0)
s_barrier
s_add_u32 m0, s29, 32768
s_add_u32 s26, s81, 2097152
buffer_load_dwordx4 v32, s[96:99], s26 offen offset:0 lds
buffer_load_dwordx4 v33, s[96:99], s26 offen offset:1024 lds
buffer_load_dwordx4 v34, s[96:99], s26 offen offset:2048 lds
buffer_load_dwordx4 v35, s[96:99], s26 offen offset:3072 lds
ds_read_b64_tr_b16 a[20:21], v40 offset:49152
ds_read_b64_tr_b16 a[22:23], v40 offset:49664
ds_read_b64_tr_b16 a[28:29], v40 offset:49160
ds_read_b64_tr_b16 a[30:31], v40 offset:49672
ds_read_b64_tr_b16 a[60:61], v41 offset:49152
ds_read_b64_tr_b16 a[62:63], v41 offset:49664
ds_read_b64_tr_b16 a[68:69], v41 offset:49160
ds_read_b64_tr_b16 a[70:71], v41 offset:49672
s_waitcnt vmcnt(11) lgkmcnt(0)
s_barrier
s_add_u32 m0, s29, 49152
s_add_u32 s26, s81, 2359296
buffer_load_dwordx4 v32, s[96:99], s26 offen offset:0 lds
buffer_load_dwordx4 v33, s[96:99], s26 offen offset:1024 lds
buffer_load_dwordx4 v34, s[96:99], s26 offen offset:2048 lds
buffer_load_dwordx4 v35, s[96:99], s26 offen offset:3072 lds
ds_read_b64_tr_b16 v[72:73], v40 offset:0
ds_read_b64_tr_b16 v[74:75], v40 offset:512
ds_read_b64_tr_b16 a[72:73], v40 offset:8
ds_read_b64_tr_b16 a[74:75], v40 offset:520
ds_read_b64_tr_b16 a[88:89], v41 offset:0
ds_read_b64_tr_b16 a[90:91], v41 offset:512
ds_read_b64_tr_b16 a[96:97], v41 offset:8
ds_read_b64_tr_b16 a[98:99], v41 offset:520
s_waitcnt lgkmcnt(6)
ds_write_b128 v2, v[72:75] offset:4096
s_waitcnt vmcnt(8) lgkmcnt(1)
s_barrier
s_add_u32 m0, s29, 0
s_add_u32 s26, s82, 0
buffer_load_dwordx4 v32, s[96:99], s26 offen offset:0 lds
buffer_load_dwordx4 v33, s[96:99], s26 offen offset:1024 lds
buffer_load_dwordx4 v34, s[96:99], s26 offen offset:2048 lds
buffer_load_dwordx4 v35, s[96:99], s26 offen offset:3072 lds
ds_read_b64_tr_b16 v[72:73], v40 offset:16384
ds_read_b64_tr_b16 v[74:75], v40 offset:16896
ds_read_b64_tr_b16 a[76:77], v40 offset:16392
ds_read_b64_tr_b16 a[78:79], v40 offset:16904
ds_read_b64_tr_b16 a[92:93], v41 offset:16384
ds_read_b64_tr_b16 a[94:95], v41 offset:16896
ds_read_b64_tr_b16 a[100:101], v41 offset:16392
ds_read_b64_tr_b16 a[102:103], v41 offset:16904
s_waitcnt lgkmcnt(6)
ds_write_b128 v2, v[72:75] offset:5120
s_waitcnt vmcnt(8) lgkmcnt(1)
s_barrier
s_add_u32 m0, s29, 16384
s_add_u32 s26, s82, 262144
buffer_load_dwordx4 v32, s[96:99], s26 offen offset:0 lds
buffer_load_dwordx4 v33, s[96:99], s26 offen offset:1024 lds
buffer_load_dwordx4 v34, s[96:99], s26 offen offset:2048 lds
buffer_load_dwordx4 v35, s[96:99], s26 offen offset:3072 lds
ds_read_b64_tr_b16 a[80:81], v40 offset:32768
ds_read_b64_tr_b16 a[82:83], v40 offset:33280
ds_read_b64_tr_b16 v[76:77], v40 offset:32776
ds_read_b64_tr_b16 v[78:79], v40 offset:33288
ds_read_b64_tr_b16 v[80:81], v41 offset:32768
ds_read_b64_tr_b16 v[82:83], v41 offset:33280
ds_read_b64_tr_b16 a[104:105], v41 offset:32776
ds_read_b64_tr_b16 a[106:107], v41 offset:33288
s_waitcnt lgkmcnt(4)
ds_write_b128 v2, v[76:79] offset:6144
s_waitcnt lgkmcnt(3)
ds_write_b128 v2, v[80:83] offset:8192
s_waitcnt vmcnt(8) lgkmcnt(2)
s_barrier
s_mov_b64 s[96:97], s[72:73]
s_add_u32 m0, s29, 32768
s_add_u32 s26, s83, 0
buffer_load_dwordx4 v36, s[96:99], s26 offen offset:0 lds
buffer_load_dwordx4 v37, s[96:99], s26 offen offset:1024 lds
buffer_load_dwordx4 v38, s[96:99], s26 offen offset:2048 lds
buffer_load_dwordx4 v39, s[96:99], s26 offen offset:3072 lds
ds_read_b64_tr_b16 a[84:85], v40 offset:49152
ds_read_b64_tr_b16 a[86:87], v40 offset:49664
ds_read_b64_tr_b16 v[76:77], v40 offset:49160
ds_read_b64_tr_b16 v[78:79], v40 offset:49672
ds_read_b64_tr_b16 v[80:81], v41 offset:49152
ds_read_b64_tr_b16 v[82:83], v41 offset:49664
ds_read_b64_tr_b16 a[108:109], v41 offset:49160
ds_read_b64_tr_b16 a[110:111], v41 offset:49672
s_waitcnt lgkmcnt(4)
ds_write_b128 v2, v[76:79] offset:7168
s_waitcnt lgkmcnt(3)
ds_write_b128 v2, v[80:83] offset:9216
s_waitcnt vmcnt(8) lgkmcnt(2)
s_barrier
s_add_u32 m0, s29, 49152
s_add_u32 s26, s84, 0
buffer_load_dwordx4 v36, s[96:99], s26 offen offset:0 lds
buffer_load_dwordx4 v37, s[96:99], s26 offen offset:1024 lds
buffer_load_dwordx4 v38, s[96:99], s26 offen offset:2048 lds
buffer_load_dwordx4 v39, s[96:99], s26 offen offset:3072 lds
ds_read_b64_tr_b16 a[112:113], v40 offset:0
ds_read_b64_tr_b16 a[114:115], v40 offset:512
ds_read_b64_tr_b16 v[76:77], v40 offset:8
ds_read_b64_tr_b16 v[78:79], v40 offset:520
ds_read_b64_tr_b16 v[80:81], v41 offset:0
ds_read_b64_tr_b16 v[82:83], v41 offset:512
ds_read_b64_tr_b16 a[120:121], v41 offset:8
ds_read_b64_tr_b16 a[122:123], v41 offset:520
s_waitcnt lgkmcnt(4)
ds_write_b128 v2, v[76:79] offset:10240
s_waitcnt lgkmcnt(3)
global_store_dwordx4 v0, v[80:83], s[76:77] offset:-2048
s_waitcnt vmcnt(9) lgkmcnt(1)
s_barrier
s_add_u32 m0, s29, 0
s_add_u32 s26, s83, 256
buffer_load_dwordx4 v36, s[96:99], s26 offen offset:0 lds
buffer_load_dwordx4 v37, s[96:99], s26 offen offset:1024 lds
buffer_load_dwordx4 v38, s[96:99], s26 offen offset:2048 lds
buffer_load_dwordx4 v39, s[96:99], s26 offen offset:3072 lds
ds_read_b64_tr_b16 a[116:117], v40 offset:16384
ds_read_b64_tr_b16 a[118:119], v40 offset:16896
ds_read_b64_tr_b16 v[76:77], v40 offset:16392
ds_read_b64_tr_b16 v[78:79], v40 offset:16904
ds_read_b64_tr_b16 v[80:81], v41 offset:16384
ds_read_b64_tr_b16 v[82:83], v41 offset:16896
ds_read_b64_tr_b16 a[124:125], v41 offset:16392
ds_read_b64_tr_b16 a[126:127], v41 offset:16904
s_waitcnt lgkmcnt(4)
ds_write_b128 v2, v[76:79] offset:11264
s_waitcnt lgkmcnt(3)
global_store_dwordx4 v0, v[80:83], s[76:77] offset:-1024
s_waitcnt vmcnt(10) lgkmcnt(1)
s_barrier
s_add_u32 m0, s29, 16384
s_add_u32 s26, s84, 256
buffer_load_dwordx4 v36, s[96:99], s26 offen offset:0 lds
buffer_load_dwordx4 v37, s[96:99], s26 offen offset:1024 lds
buffer_load_dwordx4 v38, s[96:99], s26 offen offset:2048 lds
buffer_load_dwordx4 v39, s[96:99], s26 offen offset:3072 lds
ds_read_b64_tr_b16 v[72:73], v42 offset:32768
ds_read_b64_tr_b16 v[74:75], v42 offset:33024
ds_read_b64_tr_b16 v[76:77], v42 offset:34816
ds_read_b64_tr_b16 v[78:79], v42 offset:35072
ds_read_b64_tr_b16 v[8:9], v43 offset:32768
ds_read_b64_tr_b16 v[10:11], v43 offset:33024
ds_read_b64_tr_b16 v[12:13], v43 offset:34816
ds_read_b64_tr_b16 v[14:15], v43 offset:35072
s_waitcnt lgkmcnt(6)
ds_write_b128 v2, v[72:75] offset:22528
s_waitcnt lgkmcnt(5)
ds_write_b128 v2, v[76:79] offset:23552
s_waitcnt vmcnt(10) lgkmcnt(2)
s_barrier
s_add_u32 m0, s29, 32768
s_add_u32 s26, s83, 512
buffer_load_dwordx4 v36, s[96:99], s26 offen offset:0 lds
buffer_load_dwordx4 v37, s[96:99], s26 offen offset:1024 lds
buffer_load_dwordx4 v38, s[96:99], s26 offen offset:2048 lds
buffer_load_dwordx4 v39, s[96:99], s26 offen offset:3072 lds
ds_read_b64_tr_b16 v[16:17], v42 offset:49152
ds_read_b64_tr_b16 v[18:19], v42 offset:49408
ds_read_b64_tr_b16 v[20:21], v42 offset:51200
ds_read_b64_tr_b16 v[22:23], v42 offset:51456
ds_read_b64_tr_b16 v[184:185], v43 offset:49152
ds_read_b64_tr_b16 v[186:187], v43 offset:49408
ds_read_b64_tr_b16 v[188:189], v43 offset:51200
ds_read_b64_tr_b16 v[190:191], v43 offset:51456
s_waitcnt vmcnt(9) lgkmcnt(0)
s_barrier
s_add_u32 m0, s29, 49152
s_add_u32 s26, s84, 512
buffer_load_dwordx4 v36, s[96:99], s26 offen offset:0 lds
buffer_load_dwordx4 v37, s[96:99], s26 offen offset:1024 lds
buffer_load_dwordx4 v38, s[96:99], s26 offen offset:2048 lds
buffer_load_dwordx4 v39, s[96:99], s26 offen offset:3072 lds
ds_read_b64_tr_b16 v[152:153], v42 offset:0
ds_read_b64_tr_b16 v[154:155], v42 offset:256
ds_read_b64_tr_b16 v[156:157], v42 offset:2048
ds_read_b64_tr_b16 v[158:159], v42 offset:2304
ds_read_b64_tr_b16 v[24:25], v43 offset:0
ds_read_b64_tr_b16 v[26:27], v43 offset:256
ds_read_b64_tr_b16 v[28:29], v43 offset:2048
ds_read_b64_tr_b16 v[30:31], v43 offset:2304
s_waitcnt vmcnt(8) lgkmcnt(0)
s_barrier
s_add_u32 m0, s29, 0
s_add_u32 s26, s83, 768
buffer_load_dwordx4 v36, s[96:99], s26 offen offset:0 lds
buffer_load_dwordx4 v37, s[96:99], s26 offen offset:1024 lds
buffer_load_dwordx4 v38, s[96:99], s26 offen offset:2048 lds
buffer_load_dwordx4 v39, s[96:99], s26 offen offset:3072 lds
ds_read_b64_tr_b16 v[192:193], v42 offset:16384
ds_read_b64_tr_b16 v[194:195], v42 offset:16640
ds_read_b64_tr_b16 v[196:197], v42 offset:18432
ds_read_b64_tr_b16 v[198:199], v42 offset:18688
ds_read_b64_tr_b16 v[200:201], v43 offset:16384
ds_read_b64_tr_b16 v[202:203], v43 offset:16640
ds_read_b64_tr_b16 v[204:205], v43 offset:18432
ds_read_b64_tr_b16 v[206:207], v43 offset:18688
s_waitcnt vmcnt(8) lgkmcnt(0)
s_barrier
s_add_u32 m0, s29, 16384
s_add_u32 s26, s84, 768
buffer_load_dwordx4 v36, s[96:99], s26 offen offset:0 lds
buffer_load_dwordx4 v37, s[96:99], s26 offen offset:1024 lds
buffer_load_dwordx4 v38, s[96:99], s26 offen offset:2048 lds
buffer_load_dwordx4 v39, s[96:99], s26 offen offset:3072 lds
ds_read_b64_tr_b16 v[160:161], v42 offset:32768
ds_read_b64_tr_b16 v[162:163], v42 offset:33024
ds_read_b64_tr_b16 v[164:165], v42 offset:34816
ds_read_b64_tr_b16 v[166:167], v42 offset:35072
ds_read_b64_tr_b16 v[48:49], v43 offset:32768
ds_read_b64_tr_b16 v[50:51], v43 offset:33024
ds_read_b64_tr_b16 v[52:53], v43 offset:34816
ds_read_b64_tr_b16 v[54:55], v43 offset:35072
s_waitcnt vmcnt(8) lgkmcnt(0)
s_barrier
s_add_u32 m0, s29, 32768
s_add_u32 s26, s83, 1024
buffer_load_dwordx4 v36, s[96:99], s26 offen offset:0 lds
buffer_load_dwordx4 v37, s[96:99], s26 offen offset:1024 lds
buffer_load_dwordx4 v38, s[96:99], s26 offen offset:2048 lds
buffer_load_dwordx4 v39, s[96:99], s26 offen offset:3072 lds
ds_read_b64_tr_b16 v[56:57], v42 offset:49152
ds_read_b64_tr_b16 v[58:59], v42 offset:49408
ds_read_b64_tr_b16 v[60:61], v42 offset:51200
ds_read_b64_tr_b16 v[62:63], v42 offset:51456
ds_read_b64_tr_b16 v[208:209], v43 offset:49152
ds_read_b64_tr_b16 v[210:211], v43 offset:49408
ds_read_b64_tr_b16 v[212:213], v43 offset:51200
ds_read_b64_tr_b16 v[214:215], v43 offset:51456
s_waitcnt vmcnt(8) lgkmcnt(0)
s_barrier
s_add_u32 m0, s29, 49152
s_add_u32 s26, s84, 1024
buffer_load_dwordx4 v36, s[96:99], s26 offen offset:0 lds
buffer_load_dwordx4 v37, s[96:99], s26 offen offset:1024 lds
buffer_load_dwordx4 v38, s[96:99], s26 offen offset:2048 lds
buffer_load_dwordx4 v39, s[96:99], s26 offen offset:3072 lds
ds_read_b64_tr_b16 v[168:169], v42 offset:0
ds_read_b64_tr_b16 v[170:171], v42 offset:256
ds_read_b64_tr_b16 v[172:173], v42 offset:2048
ds_read_b64_tr_b16 v[174:175], v42 offset:2304
ds_read_b64_tr_b16 v[64:65], v43 offset:0
ds_read_b64_tr_b16 v[66:67], v43 offset:256
ds_read_b64_tr_b16 v[68:69], v43 offset:2048
ds_read_b64_tr_b16 v[70:71], v43 offset:2304
s_waitcnt vmcnt(8) lgkmcnt(0)
s_barrier
ds_read_b64_tr_b16 v[216:217], v42 offset:16384
ds_read_b64_tr_b16 v[218:219], v42 offset:16640
ds_read_b64_tr_b16 v[220:221], v42 offset:18432
ds_read_b64_tr_b16 v[222:223], v42 offset:18688
ds_read_b64_tr_b16 v[224:225], v43 offset:16384
ds_read_b64_tr_b16 v[226:227], v43 offset:16640
ds_read_b64_tr_b16 v[228:229], v43 offset:18432
ds_read_b64_tr_b16 v[230:231], v43 offset:18688
s_waitcnt vmcnt(4) lgkmcnt(0)
s_barrier
ds_read_b64_tr_b16 v[176:177], v42 offset:32768
ds_read_b64_tr_b16 v[178:179], v42 offset:33024
ds_read_b64_tr_b16 v[180:181], v42 offset:34816
ds_read_b64_tr_b16 v[182:183], v42 offset:35072
ds_read_b64_tr_b16 v[232:233], v43 offset:32768
ds_read_b64_tr_b16 v[234:235], v43 offset:33024
ds_read_b64_tr_b16 v[236:237], v43 offset:34816
ds_read_b64_tr_b16 v[238:239], v43 offset:35072
s_waitcnt vmcnt(0) lgkmcnt(0)
s_barrier
ds_read_b64_tr_b16 v[240:241], v42 offset:49152
ds_read_b64_tr_b16 v[242:243], v42 offset:49408
ds_read_b64_tr_b16 v[244:245], v42 offset:51200
ds_read_b64_tr_b16 v[246:247], v42 offset:51456
ds_read_b64_tr_b16 v[248:249], v43 offset:49152
ds_read_b64_tr_b16 v[250:251], v43 offset:49408
ds_read_b64_tr_b16 v[252:253], v43 offset:51200
ds_read_b64_tr_b16 v[254:255], v43 offset:51456
s_waitcnt lgkmcnt(0)
s_barrier
s_mul_i32 s26, s13, 12288
v_add_u32 v44, s26, v0
ds_write_b128 v44, v[8:11] offset:16384
ds_write_b128 v44, v[12:15] offset:17408
ds_write_b128 v44, v[16:19] offset:18432
ds_write_b128 v44, v[20:23] offset:19456
ds_write_b128 v44, v[24:27] offset:20480
ds_write_b128 v44, v[28:31] offset:21504
ds_write_b128 v44, v[48:51] offset:22528
ds_write_b128 v44, v[52:55] offset:23552
ds_write_b128 v44, v[56:59] offset:24576
ds_write_b128 v44, v[60:63] offset:25600
ds_write_b128 v44, v[64:67] offset:26624
ds_write_b128 v44, v[68:71] offset:27648
s_waitcnt vmcnt(0) lgkmcnt(0)
s_barrier
s_cmp_lg_u32 s13, 0
s_cbranch_scc1 cb_10074
v_mov_b32 v44, 4
v_mov_b32 v45, 1
s_mov_b64 exec, 1
buffer_atomic_add v45, v44, s[8:11], 0 offen
s_mov_b32 s30, 0
cb_10073:
buffer_load_dword v45, v44, s[8:11], 0 offen sc1
s_add_u32 s30, s30, 1
s_cmp_gt_u32 s30, 262144
s_cbranch_scc1 L_fail
s_waitcnt vmcnt(0)
v_cmp_gt_u32 vcc, 32, v45
s_cbranch_vccnz cb_10073
s_mov_b64 exec, -1
cb_10074:
s_barrier
s_mov_b32 s18, 0
s_mov_b32 s35, 0
s_cmp_eq_u32 s13, 1
s_cbranch_scc1 wave_10076
s_cmp_eq_u32 s13, 2
s_cbranch_scc1 wave_10077
s_cmp_eq_u32 s13, 3
s_cbranch_scc1 wave_10078
wave_10075:
layer_10079:
s_lshl_b32 s17, s35, 6
s_mul_i32 s27, s35, 34603008
s_lshl_b32 s28, s14, 14
s_add_u32 s27, s27, s28
s_add_u32 s20, s27, 16777216
s_mul_i32 s27, s17, 10240
s_add_u32 s27, s27, s24
s_add_u32 s21, s27, s25
s_mov_b32 s19, 0
s_add_u32 s33, s17, 1
s_add_u32 s31, s17, 63
s_add_u32 s32, s17, 64
s_mov_b32 s27, s20
v_mov_b32 v7, 0
s_add_u32 s66, s4, 413696
s_addc_u32 s67, s5, 0
s_add_u32 s70, s4, 397312
s_addc_u32 s71, s5, 0
s_add_u32 s68, s4, 417792
s_addc_u32 s69, s5, 0
s_add_u32 s72, s4, 401408
s_addc_u32 s73, s5, 0
s_add_u32 s42, s4, s20
s_addc_u32 s43, s5, 0
global_load_dwordx4 v[64:67], v0, s[74:75] offset:-4096 sc1
global_load_dwordx4 v[68:71], v0, s[74:75] offset:-3072 sc1
global_load_dwordx4 v[72:75], v0, s[74:75] offset:-2048 sc1
global_load_dwordx4 v[76:79], v0, s[74:75] offset:-1024 sc1
global_load_dwordx4 v[80:83], v0, s[76:77] offset:-4096 sc1
global_load_dwordx4 v[84:87], v0, s[76:77] offset:-3072 sc1
global_load_dwordx4 v[48:51], v0, s[74:75] offset:2048 sc1
global_load_dwordx4 v[52:55], v0, s[74:75] offset:3072 sc1
global_load_dwordx4 v[56:59], v0, s[74:75] offset:0 sc1
global_load_dwordx4 v[60:63], v0, s[74:75] offset:1024 sc1
v_mov_b64 v[8:9], 0
v_mov_b64 v[10:11], 0
v_mov_b64 v[12:13], 0
v_mov_b64 v[14:15], 0
v_mov_b64 v[16:17], 0
v_mov_b64 v[18:19], 0
v_mov_b64 v[20:21], 0
v_mov_b64 v[22:23], 0
v_mov_b64 v[24:25], 0
v_mov_b64 v[26:27], 0
v_mov_b64 v[28:29], 0
v_mov_b64 v[30:31], 0
v_cmp_gt_u32 vcc, s33, v7
s_cmp_eq_u32 vcc_hi, 0
s_cbranch_scc1 kv_10090
s_mov_b32 s30, 0
kv_10089:
v_bfe_u32 v7, v0, 2, 3
buffer_load_dword v7, v7, s[4:7], s22 offen sc1
s_add_u32 s30, s30, 1
s_cmp_gt_u32 s30, 262144
s_cbranch_scc1 L_fail
s_waitcnt vmcnt(0)
v_cmp_gt_u32 vcc, s33, v7
s_cbranch_vccnz kv_10089
kv_10090:
s_barrier
v_bfe_u32 v7, v0, 2, 3
v_add_u32 v7, s22, v7
s_mov_b32 exec_hi, 0
v_and_b32 v7, 511, v0
v_lshl_add_u32 v7, v7, 3, s27
s_mov_b32 exec_hi, -1
global_load_dwordx4 v[32:35], v0, s[66:67] offset:-4096 sc1
global_load_dwordx4 v[36:39], v0, s[66:67] offset:0 sc1
global_load_dwordx4 v[40:43], v0, s[68:69] offset:0 sc1
s_mov_b32 s30, 0
s_waitcnt vmcnt(0)
.p2align 6
gather_10080:
s_waitcnt vmcnt(4)
rt_10085_b:
v_smfmac_f32_16x16x64_bf16 v[20:23], v[32:35], v[48:55], v1
ds_write_b128 v0, v[32:35] offset:0
v_smfmac_f32_16x16x64_bf16 v[28:31], v[32:35], a[8:15], v1
v_bitop3_b32 v44, v32, v34, s18 bitop3:0x7e
v_smfmac_f32_16x16x64_bf16 v[16:19], v[32:35], v[56:63], v1
s_waitcnt vmcnt(3)
ds_write_b128 v0, v[36:39] offset:4096
v_bitop3_b32 v45, v36, v38, s18 bitop3:0x7e
v_or_b32 v44, v44, v45
s_waitcnt vmcnt(2)
v_bitop3_b32 v45, v40, v42, s18 bitop3:0x7e
v_smfmac_f32_16x16x64_bf16 v[20:23], v[36:39], a[40:47], v1
ds_write_b128 v0, v[40:43] offset:8192
v_bitop3_b32 v44, v44, v45, s19 bitop3:0xa8
v_cmp_ne_u32 vcc, 0, v44
v_smfmac_f32_16x16x64_bf16 v[8:11], v[32:35], v[64:71], v1
s_cbranch_vccnz rt_10085
ds_read_b128 v[56:59], v2 offset:0
v_smfmac_f32_16x16x64_bf16 v[24:27], v[32:35], a[0:7], v1
s_waitcnt lgkmcnt(2)
ds_read_b128 v[60:63], v2 offset:1024
global_load_dwordx4 v[64:67], v0, s[76:77] offset:-2048 sc1
v_smfmac_f32_16x16x64_bf16 v[8:11], v[36:39], a[16:23], v1
s_waitcnt lgkmcnt(2)
ds_read_b128 v[52:55], v2 offset:3072
ds_read_b128 v[48:51], v2 offset:2048
v_smfmac_f32_16x16x64_bf16 v[16:19], v[36:39], a[32:39], v1
s_barrier
ds_read_b128 v[40:43], v0 offset:1024
v_smfmac_f32_16x16x64_bf16 v[12:15], v[32:35], v[72:79], v1
ds_read_b128 v[44:47], v0 offset:5120
global_load_dwordx4 v[68:71], v0, s[76:77] offset:-1024 sc1
v_smfmac_f32_16x16x64_bf16 v[12:15], v[36:39], a[24:31], v1
s_waitcnt lgkmcnt(4)
ds_read_b128 v[32:35], v0 offset:2048
global_load_dwordx4 v[72:75], v0, s[76:77] offset:0 sc1
v_smfmac_f32_16x16x64_bf16 v[24:27], v[36:39], v[56:63], v1
s_waitcnt lgkmcnt(3)
ds_read_b128 v[56:59], v2 offset:4096
s_xor_b32 s18, s18, 1
v_smfmac_f32_16x16x64_bf16 v[28:31], v[36:39], v[48:55], v1
s_waitcnt lgkmcnt(3)
ds_read_b128 v[60:63], v2 offset:5120
s_waitcnt vmcnt(3)
v_smfmac_f32_16x16x64_bf16 v[12:15], v[40:43], v[80:87], v1
s_waitcnt lgkmcnt(3)
ds_read_b128 v[84:87], v2 offset:7168
v_smfmac_f32_16x16x64_bf16 v[8:11], v[40:43], a[48:55], v1
ds_read_b128 v[36:39], v0 offset:6144
ds_read_b128 v[80:83], v2 offset:6144
v_smfmac_f32_16x16x64_bf16 v[12:15], v[44:47], a[64:71], v1
s_mov_b64 s[68:69], s[72:73]
global_load_dwordx4 v[76:79], v0, s[76:77] offset:1024 sc1
v_smfmac_f32_16x16x64_bf16 v[8:11], v[44:47], a[56:63], v1
s_waitcnt lgkmcnt(5)
ds_read_b128 v[40:43], v0 offset:3072
v_smfmac_f32_16x16x64_bf16 v[12:15], v[32:35], a[72:79], v1
ds_read_b128 v[44:47], v0 offset:7168
s_waitcnt lgkmcnt(5)
v_smfmac_f32_16x16x64_bf16 v[8:11], v[32:35], v[56:63], v1
s_waitcnt lgkmcnt(4)
ds_read_b128 v[56:59], v2 offset:8192
s_waitcnt lgkmcnt(4)
v_smfmac_f32_16x16x64_bf16 v[8:11], v[36:39], a[80:87], v1
ds_read_b128 v[60:63], v2 offset:9216
s_waitcnt lgkmcnt(4)
ds_read_b128 v[32:35], v0 offset:8192
v_smfmac_f32_16x16x64_bf16 v[12:15], v[36:39], v[80:87], v1
s_waitcnt lgkmcnt(4)
ds_read_b128 v[80:83], v2 offset:10240
v_smfmac_f32_16x16x64_bf16 v[12:15], v[40:43], a[96:103], v1
s_waitcnt lgkmcnt(4)
ds_read_b128 v[84:87], v2 offset:11264
global_load_dwordx4 v[48:51], v0, s[42:43] offset:0 nt sc1
v_smfmac_f32_16x16x64_bf16 v[12:15], v[44:47], a[104:111], v1
ds_read_b128 v[36:39], v0 offset:9216
global_load_dwordx4 v[52:55], v0, s[42:43] offset:1024 nt sc1
v_smfmac_f32_16x16x64_bf16 v[8:11], v[40:43], a[88:95], v1
s_mov_b64 vcc, s[40:41]
ds_read_b128 v[40:43], v0 offset:1024
s_waitcnt lgkmcnt(4)
v_smfmac_f32_16x16x64_bf16 v[8:11], v[44:47], v[56:63], v1
ds_read_b128 v[56:59], v2 offset:12288
s_waitcnt lgkmcnt(4)
v_smfmac_f32_16x16x64_bf16 v[8:11], v[32:35], a[112:119], v1
ds_read_b128 v[60:63], v2 offset:13312
s_waitcnt lgkmcnt(4)
v_smfmac_f32_16x16x64_bf16 v[12:15], v[32:35], v[80:87], v1
s_waitcnt vmcnt(4)
ds_read_b128 v[32:35], v0 offset:5120
s_waitcnt lgkmcnt(4)
v_smfmac_f32_16x16x64_bf16 v[8:11], v[36:39], v[64:71], v1
s_add_u32 s20, s20, 524288
ds_read_b128 v[80:83], v2 offset:14336
v_smfmac_f32_16x16x64_bf16 v[12:15], v[36:39], a[120:127], v1
s_waitcnt lgkmcnt(4)
ds_read_b128 v[84:87], v2 offset:15360
global_load_dwordx4 v[64:67], v0, s[76:77] offset:2048 sc1
ds_read_b128 v[36:39], v0 offset:2048
v_smfmac_f32_16x16x64_bf16 v[20:23], v[40:43], a[128:135], v1
s_waitcnt lgkmcnt(4)
v_add_f32 v8, v8, v10
v_smfmac_f32_16x16x64_bf16 v[16:19], v[40:43], v[56:63], v1
s_waitcnt lgkmcnt(3)
ds_read_b128 v[56:59], v2 offset:16384
global_load_dwordx4 v[68:71], v0, s[76:77] offset:3072 sc1
ds_read_b128 v[40:43], v0 offset:6144
v_add_f32 v9, v9, v11
v_add_f32 v12, v12, v14
v_smfmac_f32_16x16x64_bf16 v[16:19], v[32:35], a[136:143], v1
s_waitcnt lgkmcnt(3)
ds_read_b128 v[60:63], v2 offset:17408
v_mul_f32 v12, s34, v12
v_smfmac_f32_16x16x64_bf16 v[20:23], v[32:35], v[80:87], v1
s_waitcnt lgkmcnt(3)
ds_read_b128 v[32:35], v0 offset:3072
ds_read_b128 v[84:87], v2 offset:19456
v_smfmac_f32_16x16x64_bf16 v[16:19], v[36:39], a[144:151], v1
s_waitcnt vmcnt(4)
ds_read_b128 v[80:83], v2 offset:18432
v_mul_f32 v8, s34, v8
v_add_f32 v13, v13, v15
v_mul_f32 v9, s34, v9
v_mul_f32 v13, s34, v13
v_cvt_pk_bf16_f32 v8, v8, v9
v_smfmac_f32_16x16x64_bf16 v[20:23], v[36:39], a[152:159], v1
s_waitcnt lgkmcnt(4)
ds_read_b128 v[36:39], v0 offset:7168
v_cvt_pk_bf16_f32 v12, v12, v13
v_smfmac_f32_16x16x64_bf16 v[16:19], v[40:43], v[72:79], v1
s_waitcnt lgkmcnt(4)
ds_write2_b32 v3, v8, v12 offset0:0 offset1:128
global_load_dwordx4 v[72:75], v0, s[78:79] offset:-4096 sc1
v_smfmac_f32_16x16x64_bf16 v[20:23], v[40:43], v[56:63], v1
s_waitcnt lgkmcnt(4)
global_load_dwordx4 v[76:79], v0, s[78:79] offset:-3072 sc1
v_smfmac_f32_16x16x64_bf16 v[16:19], v[32:35], a[160:167], v1
ds_read_b128 v[40:43], v0 offset:8192
global_load_dwordx4 v[56:59], v0, s[42:43] offset:2048 nt sc1
v_smfmac_f32_16x16x64_bf16 v[20:23], v[32:35], a[168:175], v1
s_waitcnt lgkmcnt(2)
global_load_dwordx4 v[60:63], v0, s[42:43] offset:3072 nt sc1
ds_read_b128 v[32:35], v0 offset:9216
v_smfmac_f32_16x16x64_bf16 v[16:19], v[36:39], a[176:183], v1
s_waitcnt lgkmcnt(2)
s_barrier
ds_read_b64_tr_b16 v[8:9], v4 offset:0
v_smfmac_f32_16x16x64_bf16 v[20:23], v[36:39], v[80:87], v1
s_waitcnt lgkmcnt(2)
ds_read_b64_tr_b16 v[10:11], v4 offset:512
ds_read_b128 v[36:39], v0 offset:8192
v_smfmac_f32_16x16x64_bf16 v[16:19], v[40:43], a[184:191], v1
s_waitcnt vmcnt(7)
ds_read_b64_tr_b16 v[14:15], v4 offset:1536
v_smfmac_f32_16x16x64_bf16 v[20:23], v[40:43], a[192:199], v1
s_waitcnt lgkmcnt(4)
ds_read_b128 v[40:43], v0 offset:9216
ds_read_b128 v[84:87], v2 offset:21504
v_smfmac_f32_16x16x64_bf16 v[16:19], v[32:35], a[200:207], v1
ds_read_b128 v[80:83], v2 offset:20480
s_waitcnt lgkmcnt(5)
s_waitcnt vmcnt(6)
ds_read_b64_tr_b16 v[12:13], v4 offset:1024
v_smfmac_f32_16x16x64_bf16 v[20:23], v[32:35], a[208:215], v1
s_waitcnt lgkmcnt(5)
ds_read_b128 v[32:35], v0 offset:1024
v_smfmac_f32_16x16x64_bf16 v[28:31], v[36:39], a[224:231], v1
v_add_f32 v17, v17, v19
v_smfmac_f32_16x16x64_bf16 v[24:27], v[36:39], a[216:223], v1
s_mov_b32 s30, 0
ds_read_b128 v[36:39], v0 offset:5120
s_nop 0
v_add_f32 v20, v20, v22
v_mfma_f32_16x16x32_bf16 v[44:47], v[48:51], v[8:11], 0
s_waitcnt lgkmcnt(2)
global_load_dword v7, v7, s[4:5] sc1
v_mfma_f32_16x16x32_bf16 v[44:47], v[52:55], v[12:15], v[44:47]
s_waitcnt lgkmcnt(1)
v_add_f32 v16, v16, v18
v_cvt_pk_bf16_f32 v16, v16, v17
v_bfe_u32 v48, v0, 5, 1
v_add_f32 v21, v21, v23
v_cvt_pk_bf16_f32 v20, v20, v21
v_smfmac_f32_16x16x64_bf16 v[28:31], v[40:43], v[80:87], v1
ds_write2_b32 v3, v16, v20 offset0:1 offset1:129
v_cndmask_b32_dpp v45, v47, v45, vcc quad_perm:[0,1,0,1] row_mask:0xf bank_mask:0xf
v_lshl_add_u32 v48, v48, 3, v5
v_cndmask_b32_dpp v44, v46, v44, vcc quad_perm:[0,1,0,1] row_mask:0xf bank_mask:0xf
v_smfmac_f32_16x16x64_bf16 v[24:27], v[40:43], a[232:239], v1
s_waitcnt vmcnt(5)
ds_write_b64 v48, v[44:45] offset:6144
v_smfmac_f32_16x16x64_bf16 v[28:31], v[32:35], a[248:255], v1
s_waitcnt lgkmcnt(2)
s_add_u32 s17, s17, 1
ds_read_b128 v[40:43], v0 offset:2048
v_smfmac_f32_16x16x64_bf16 v[24:27], v[32:35], a[240:247], v1
s_waitcnt lgkmcnt(1)
ds_read_b128 v[84:87], v2 offset:23552
v_smfmac_f32_16x16x64_bf16 v[24:27], v[36:39], v[64:71], v1
global_load_dwordx4 v[64:67], v0, s[74:75] offset:-4096 sc1
ds_read_b128 v[32:35], v0 offset:6144
v_smfmac_f32_16x16x64_bf16 v[28:31], v[36:39], v[88:95], v1
s_waitcnt vmcnt(4)
ds_read_b128 v[36:39], v0 offset:3072
s_barrier
ds_read_b128 v[52:55], v6 offset:7168
s_waitcnt lgkmcnt(4)
v_smfmac_f32_16x16x64_bf16 v[28:31], v[40:43], v[104:111], v1
ds_read_b128 v[48:51], v6 offset:6144
ds_read_b64_tr_b16 v[12:13], v4 offset:1024
v_smfmac_f32_16x16x64_bf16 v[24:27], v[40:43], v[96:103], v1
s_waitcnt vmcnt(3)
ds_read_b128 v[40:43], v0 offset:7168
s_waitcnt lgkmcnt(5)
ds_read_b64_tr_b16 v[10:11], v4 offset:512
v_smfmac_f32_16x16x64_bf16 v[24:27], v[32:35], v[112:119], v1
s_waitcnt vmcnt(2)
ds_read_b64_tr_b16 v[8:9], v4 offset:0
ds_read_b64_tr_b16 v[16:17], v4 offset:2048
v_smfmac_f32_16x16x64_bf16 v[28:31], v[32:35], v[120:127], v1
s_waitcnt lgkmcnt(7)
ds_read_b64_tr_b16 v[18:19], v4 offset:2560
v_mov_b64 v[34:35], 0
v_smfmac_f32_16x16x64_bf16 v[24:27], v[36:39], v[128:135], v1
s_waitcnt lgkmcnt(6)
ds_read_b64_tr_b16 v[22:23], v4 offset:3584
v_add_f32 v48, v48, v52
v_add_f32 v49, v49, v53
v_add_f32 v51, v51, v55
v_smfmac_f32_16x16x64_bf16 v[28:31], v[36:39], v[136:143], v1
s_waitcnt lgkmcnt(5)
ds_read_b64_tr_b16 v[14:15], v4 offset:1536
v_add_f32 v50, v50, v54
v_smfmac_f32_16x16x64_bf16 v[24:27], v[40:43], v[72:79], v1
s_waitcnt lgkmcnt(4)
ds_read_b64_tr_b16 v[20:21], v4 offset:3072
v_exp_f32 v51, v51
v_mfma_f32_16x16x32_bf16 v[44:47], v[8:11], v[8:11], 0
v_exp_f32 v50, v50
v_exp_f32 v48, v48
v_smfmac_f32_16x16x64_bf16 v[28:31], v[40:43], v[144:151], v1
s_waitcnt lgkmcnt(1)
ds_read_b128 v[80:83], v2 offset:22528
v_cvt_pk_bf16_f32 v55, v50, v51
v_mfma_f32_16x16x32_bf16 v[44:47], v[12:15], v[12:15], v[44:47]
s_waitcnt lgkmcnt(1)
v_exp_f32 v49, v49
v_mfma_f32_16x16x32_bf16 v[44:47], v[16:19], v[16:19], v[44:47]
v_cvt_pk_bf16_f32 v54, v48, v49
v_mov_b32_dpp v49, v55 quad_perm:[0,1,0,1] row_mask:0xf bank_mask:0xf
v_mfma_f32_16x16x32_bf16 v[44:47], v[20:23], v[20:23], v[44:47]
v_mov_b32_dpp v50, v54 quad_perm:[2,3,2,3] row_mask:0xf bank_mask:0xf
v_mov_b32_dpp v51, v55 quad_perm:[2,3,2,3] row_mask:0xf bank_mask:0xf
v_mov_b32_dpp v48, v54 quad_perm:[0,1,0,1] row_mask:0xf bank_mask:0xf
v_mov_b64 v[22:23], s[44:45]
v_cvt_pk_bf16_f32 v24, v24, v25
v_cvt_pk_bf16_f32 v25, v26, v27
v_mov_b64 v[20:21], s[44:45]
v_mfma_f32_16x16x32_bf16 v[8:11], v[56:59], v[48:51], 0
s_mov_b32 s19, 1
v_exp_f32_dpp v45, v47 quad_perm:[0,1,0,1] row_mask:0xf bank_mask:0xf
v_mfma_f32_16x16x32_bf16 v[12:15], v[60:63], v[48:51], 0
v_exp_f32_dpp v44, v46 quad_perm:[0,1,0,1] row_mask:0xf bank_mask:0xf
v_mfma_f32_16x16x32_bf16 v[16:19], v[20:23], v[48:51], 0
s_waitcnt lgkmcnt(0)
v_cvt_pk_bf16_f32 v52, v44, v45
v_cvt_pk_bf16_f32 v53, v44, v45
v_cvt_pk_bf16_f32 v26, v28, v29
v_cvt_pk_bf16_f32 v27, v30, v31
v_mfma_f32_16x16x16_bf16 v[8:11], v[24:25], v[52:53], v[8:11]
v_bfe_u32 v32, v0, 5, 1
v_mov_b64 v[54:55], s[46:47]
v_mfma_f32_16x16x16_bf16 v[12:15], v[26:27], v[52:53], v[12:15]
s_nop 0
ds_read_b128 v[28:31], v0 offset:19456
v_mov_b64 v[42:43], 0
v_mfma_f32_16x16x16_bf16 v[16:19], v[54:55], v[52:53], v[16:19]
s_add_u32 s21, s21, 10240
v_lshl_add_u32 v32, v32, 3, v5
v_mov_b64 v[40:41], 0
v_mov_b64 v[36:37], 0
v_cndmask_b32 v9, v13, v9, s[40:41]
v_cndmask_b32 v11, v15, v11, s[40:41]
v_cndmask_b32 v10, v14, v10, s[40:41]
v_cndmask_b32 v8, v12, v8, s[40:41]
v_rcp_f32 v18, v16
v_subrev_u32 v17, s36, v16
v_mul_f32 v9, v9, v18
v_mul_f32 v8, v8, v18
v_cvt_pk_bf16_f32 v12, v8, v9
v_mul_f32 v10, v10, v18
v_mul_f32 v11, v11, v18
v_cmp_lt_u32 vcc, s37, v17
v_cvt_pk_bf16_f32 v13, v10, v11
s_cbranch_vccnz rare_10081
back_10082:
ds_write_b64 v32, v[12:13] offset:0
v_mov_b64 v[50:51], 0
v_mov_b32_dpp v8, v12 quad_perm:[0,1,0,1] row_mask:0xf bank_mask:0xf
v_mov_b32_dpp v9, v13 quad_perm:[0,1,0,1] row_mask:0xf bank_mask:0xf
v_mov_b32_dpp v10, v12 quad_perm:[2,3,2,3] row_mask:0xf bank_mask:0xf
v_mov_b32_dpp v11, v13 quad_perm:[2,3,2,3] row_mask:0xf bank_mask:0xf
v_mov_b64 v[48:49], 0
v_mov_b64 v[38:39], 0
v_smfmac_f32_16x16x64_bf16 v[40:43], v[8:11], v[152:159], v1
ds_read_b128 v[16:19], v0 offset:16384
global_load_dwordx4 v[68:71], v0, s[74:75] offset:-3072 sc1
ds_read_b128 v[20:23], v0 offset:17408
v_smfmac_f32_16x16x64_bf16 v[48:51], v[8:11], v[160:167], v1
s_waitcnt lgkmcnt(3)
ds_read_b128 v[24:27], v0 offset:18432
s_waitcnt lgkmcnt(3)
s_barrier
ds_read_b128 v[56:59], v5 offset:512
global_load_dwordx4 v[72:75], v0, s[74:75] offset:-2048 sc1
ds_read_b128 v[60:63], v5 offset:1024
v_smfmac_f32_16x16x64_bf16 v[36:39], v[8:11], v[80:87], v1
ds_read_b128 v[12:15], v5 offset:1536
v_mov_b64 v[32:33], 0
v_mov_b64 v[54:55], 0
v_bfe_u32 v45, v0, 1, 7
v_smfmac_f32_16x16x64_bf16 v[32:35], v[8:11], v[176:183], v1
s_waitcnt lgkmcnt(4)
ds_read_b128 v[84:87], v0 offset:21504
global_load_dwordx4 v[76:79], v0, s[74:75] offset:-1024 sc1
ds_read_b128 v[80:83], v0 offset:20480
s_waitcnt lgkmcnt(4)
v_smfmac_f32_16x16x64_bf16 v[36:39], v[56:59], v[16:23], v1
ds_read_b128 v[20:23], v0 offset:23552
s_waitcnt lgkmcnt(4)
v_smfmac_f32_16x16x64_bf16 v[36:39], v[60:63], v[24:31], v1
ds_read_b128 v[28:31], v0 offset:25600
s_waitcnt lgkmcnt(4)
v_smfmac_f32_16x16x64_bf16 v[36:39], v[12:15], v[184:191], v1
ds_read_b128 v[24:27], v0 offset:24576
v_lshrrev_b32 v44, 8, v0
v_smfmac_f32_16x16x64_bf16 v[32:35], v[56:59], v[232:239], v1
s_waitcnt lgkmcnt(4)
ds_read_b128 v[16:19], v0 offset:22528
s_waitcnt lgkmcnt(4)
v_smfmac_f32_16x16x64_bf16 v[40:43], v[56:59], v[80:87], v1
s_add_u32 s33, s17, 2
ds_read_b128 v[80:83], v0 offset:26624
v_cvt_pk_bf16_f32 v36, v36, v37
v_smfmac_f32_16x16x64_bf16 v[40:43], v[60:63], v[192:199], v1
ds_read_b128 v[84:87], v0 offset:27648
v_lshl_or_b32 v44, v44, 12, v45
v_and_or_b32 v36, v36, -2, s18
v_cvt_pk_bf16_f32 v37, v38, v39
v_smfmac_f32_16x16x64_bf16 v[40:43], v[12:15], v[200:207], v1
s_nop 0
global_store_dwordx2 v44, v[36:37], s[48:49]
s_waitcnt lgkmcnt(5)
s_waitcnt lgkmcnt(2)
v_smfmac_f32_16x16x64_bf16 v[48:51], v[56:59], v[16:23], v1
s_min_u32 s33, s33, s32
s_nop 0
v_mov_b64 v[52:53], 0
v_cvt_pk_bf16_f32 v40, v40, v41
v_smfmac_f32_16x16x64_bf16 v[48:51], v[60:63], v[24:31], v1
s_waitcnt lgkmcnt(1)
v_and_or_b32 v40, v40, -2, s18
v_cvt_pk_bf16_f32 v41, v42, v43
v_smfmac_f32_16x16x64_bf16 v[48:51], v[12:15], v[208:215], v1
s_add_u32 s27, s20, 524288
global_store_dwordx2 v44, v[40:41], s[50:51]
s_add_u32 s42, s4, s20
v_smfmac_f32_16x16x64_bf16 v[52:55], v[8:11], v[168:175], v1
s_addc_u32 s43, s5, 0
s_waitcnt lgkmcnt(0)
v_smfmac_f32_16x16x64_bf16 v[52:55], v[56:59], v[80:87], v1
s_nop 0
v_cvt_pk_bf16_f32 v48, v48, v49
v_and_or_b32 v48, v48, -2, s18
v_cvt_pk_bf16_f32 v49, v50, v51
v_smfmac_f32_16x16x64_bf16 v[52:55], v[60:63], v[216:223], v1
s_mov_b64 s[66:67], s[70:71]
global_store_dwordx2 v44, v[48:49], s[52:53]
v_smfmac_f32_16x16x64_bf16 v[52:55], v[12:15], v[224:231], v1
s_nop 2
v_smfmac_f32_16x16x64_bf16 v[32:35], v[60:63], v[240:247], v1
s_nop 3
v_cvt_pk_bf16_f32 v52, v52, v53
v_and_or_b32 v52, v52, -2, s18
v_cvt_pk_bf16_f32 v53, v54, v55
v_smfmac_f32_16x16x64_bf16 v[32:35], v[12:15], v[248:255], v1
s_nop 0
global_store_dwordx2 v44, v[52:53], s[54:55]
s_nop 5
v_cvt_pk_bf16_f32 v32, v32, v33
v_cvt_pk_bf16_f32 v33, v34, v35
v_and_or_b32 v32, v32, -2, s18
global_store_dwordx2 v44, v[32:33], s[56:57]
v_bfe_u32 v24, v0, 6, 1
v_lshlrev_b32 v24, 4, v24
v_mov_b32 v25, 0x3f80
v_lshlrev_b32 v24, v24, v25
v_bfe_i32 v25, v0, 4, 1
v_and_b32 v45, v24, v25
v_and_b32 v47, v24, v25
v_xor_b32 v44, v24, v45
v_xor_b32 v46, v24, v45
v_and_b32 v28, 32, v0
v_bfe_u32 v29, v0, 6, 1
v_lshl_add_u32 v28, v29, 8, v28
v_bfe_u32 v29, v0, 8, 1
v_lshl_add_u32 v28, v29, 4, v28
v_bfe_u32 v29, v0, 4, 1
v_lshl_add_u32 v28, v29, 3, v28
s_waitcnt vmcnt(9)
v_bfe_u32 v7, v0, 2, 3
v_add_u32 v7, s22, v7
s_mov_b32 exec_hi, 0
v_and_b32 v7, 511, v0
v_lshl_add_u32 v7, v7, 3, s27
s_mov_b32 exec_hi, -1
s_nop 15
s_nop 15
s_nop 15
s_nop 4
global_load_dwordx4 v[8:11], v0, s[62:63] offset:0 sc1
global_load_dwordx4 v[12:15], v0, s[62:63] offset:1024 sc1
global_load_dwordx4 v[16:19], v0, s[62:63] offset:2048 sc1
global_load_dwordx4 v[20:23], v0, s[62:63] offset:3072 sc1
s_nop 15
s_nop 14
global_load_dwordx4 v[56:59], v0, s[74:75] offset:0 sc1
global_load_dwordx4 v[60:63], v0, s[74:75] offset:1024 sc1
global_load_dwordx4 v[48:51], v0, s[74:75] offset:2048 sc1
global_load_dwordx4 v[52:55], v0, s[74:75] offset:3072 sc1
v_mov_b64 v[40:41], 0
v_mov_b64 v[42:43], 0
s_waitcnt vmcnt(6)
s_nop 0
v_smfmac_f32_16x16x64_bf16 v[40:43], v[44:47], v[8:15], v1
v_bitop3_b32 v24, v8, v10, s18 bitop3:0x7e
v_bitop3_b32 v25, v12, v14, s18 bitop3:0x7e
s_waitcnt vmcnt(4)
v_smfmac_f32_16x16x64_bf16 v[40:43], v[44:47], v[16:23], v1
v_bitop3_b32 v26, v16, v18, s18 bitop3:0x7e
v_bitop3_b32 v27, v20, v22, s18 bitop3:0x7e
v_or3_b32 v24, v24, v25, v26
v_bitop3_b32 v24, v24, v27, 1 bitop3:0xa8
v_cmp_ne_u32 vcc, 0, v24
s_cbranch_vccnz red_10091
red_10091_ok:
s_nop 1
v_add_f32_dpp v40, v40, v40 row_ror:8 row_mask:0xf bank_mask:0xf
v_add_f32_dpp v41, v41, v41 row_ror:8 row_mask:0xf bank_mask:0xf
v_add_f32_dpp v42, v42, v42 row_ror:8 row_mask:0xf bank_mask:0xf
v_add_f32_dpp v43, v43, v43 row_ror:8 row_mask:0xf bank_mask:0xf
v_cvt_pk_bf16_f32 v40, v40, v41
v_cvt_pk_bf16_f32 v41, v42, v43
v_and_or_b32 v40, v40, -2, s18
s_mov_b64 exec, 0x00ff00ff
global_store_dwordx2 v28, v[40:41], s[64:65]
s_mov_b64 exec, -1
v_mov_b64 v[8:9], 0
v_mov_b64 v[10:11], 0
v_mov_b64 v[12:13], 0
v_mov_b64 v[14:15], 0
v_mov_b64 v[16:17], 0
v_mov_b64 v[18:19], 0
v_mov_b64 v[20:21], 0
v_mov_b64 v[22:23], 0
v_mov_b64 v[24:25], 0
v_mov_b64 v[26:27], 0
v_mov_b64 v[28:29], 0
v_mov_b64 v[30:31], 0
s_nop 15
s_nop 6
s_barrier
global_load_dwordx4 v[32:35], v0, s[66:67] offset:-4096 sc1
s_nop 10
global_load_dwordx4 v[36:39], v0, s[66:67] offset:0 sc1
s_nop 10
global_load_dwordx4 v[40:43], v0, s[68:69] offset:0 sc1
s_barrier
global_load_dwordx4 v[80:83], v0, s[76:77] offset:-4096 sc1
global_load_dwordx4 v[84:87], v0, s[76:77] offset:-3072 sc1
s_mov_b32 s30, 0
s_cmp_eq_u32 s17, s31
s_cbranch_scc0 gather_10080
s_branch exit_10083
rt_10085:
global_load_dwordx4 v[32:35], v0, s[66:67] offset:-4096 sc1
global_load_dwordx4 v[36:39], v0, s[66:67] offset:0 sc1
global_load_dwordx4 v[40:43], v0, s[68:69] offset:0 sc1
s_add_u32 s30, s30, 1
s_cmp_gt_u32 s30, 262144
s_cbranch_scc1 L_fail
s_nop 0
v_mov_b64 v[8:9], 0
v_mov_b64 v[10:11], 0
v_mov_b64 v[12:13], 0
v_mov_b64 v[14:15], 0
v_mov_b64 v[16:17], 0
v_mov_b64 v[18:19], 0
v_mov_b64 v[20:21], 0
v_mov_b64 v[22:23], 0
v_mov_b64 v[24:25], 0
v_mov_b64 v[26:27], 0
v_mov_b64 v[28:29], 0
v_mov_b64 v[30:31], 0
s_waitcnt vmcnt(2)
v_bitop3_b32 v44, v32, v34, s18 bitop3:0x7e
s_waitcnt vmcnt(1)
v_bitop3_b32 v45, v36, v38, s18 bitop3:0x7e
v_or_b32 v44, v44, v45
s_waitcnt vmcnt(0)
v_bitop3_b32 v45, v40, v42, s18 bitop3:0x7e
v_bitop3_b32 v44, v44, v45, s19 bitop3:0xa8
v_cmp_ne_u32 vcc, 0, v44
s_cbranch_vccnz rt_10085
s_branch rt_10085_b
red_10091:
global_load_dwordx4 v[8:11], v0, s[62:63] offset:0 sc1
global_load_dwordx4 v[12:15], v0, s[62:63] offset:1024 sc1
global_load_dwordx4 v[16:19], v0, s[62:63] offset:2048 sc1
global_load_dwordx4 v[20:23], v0, s[62:63] offset:3072 sc1
s_add_u32 s30, s30, 1
s_cmp_gt_u32 s30, 262144
s_cbranch_scc1 L_fail
v_mov_b64 v[40:41], 0
v_mov_b64 v[42:43], 0
s_waitcnt vmcnt(2)
s_nop 0
v_smfmac_f32_16x16x64_bf16 v[40:43], v[44:47], v[8:15], v1
v_bitop3_b32 v24, v8, v10, s18 bitop3:0x7e
v_bitop3_b32 v25, v12, v14, s18 bitop3:0x7e
s_waitcnt vmcnt(0)
v_smfmac_f32_16x16x64_bf16 v[40:43], v[44:47], v[16:23], v1
v_bitop3_b32 v26, v16, v18, s18 bitop3:0x7e
v_bitop3_b32 v27, v20, v22, s18 bitop3:0x7e
v_or3_b32 v24, v24, v25, v26
v_bitop3_b32 v24, v24, v27, 1 bitop3:0xa8
v_cmp_ne_u32 vcc, 0, v24
s_cbranch_vccnz red_10091
s_branch red_10091_ok
rare_10081:
ds_read_b128 v[48:51], v6 offset:6144
ds_read_b128 v[52:55], v6 offset:7168
s_waitcnt lgkmcnt(0)
v_add_f32 v48, v48, v52
v_add_f32 v49, v49, v53
v_add_f32 v50, v50, v54
v_add_f32 v51, v51, v55
v_mov_b32_dpp v46, v46 quad_perm:[0,1,0,1] row_mask:0xf bank_mask:0xf
v_mov_b32_dpp v47, v47 quad_perm:[0,1,0,1] row_mask:0xf bank_mask:0xf
v_max3_f32 v19, v48, v49, v50
v_max3_f32 v19, v19, v51, v46
v_max_f32 v19, v19, v47
s_nop 1
v_max_f32_dpp v19, v19, v19 quad_perm:[2,3,0,1] row_mask:0xf bank_mask:0xf
v_mov_b32 v44, v19
s_nop 1
v_permlane32_swap_b32 v19, v44
v_max_f32 v19, v19, v44
v_mov_b32 v44, v19
s_nop 1
v_permlane16_swap_b32 v19, v44
v_max_f32 v19, v19, v44
v_sub_f32 v48, v48, v19
v_sub_f32 v49, v49, v19
v_sub_f32 v50, v50, v19
v_sub_f32 v51, v51, v19
v_sub_f32 v46, v46, v19
v_sub_f32 v47, v47, v19
v_exp_f32 v48, v48
v_exp_f32 v49, v49
v_exp_f32 v50, v50
v_exp_f32 v51, v51
v_cvt_pk_bf16_f32 v54, v48, v49
v_cvt_pk_bf16_f32 v55, v50, v51
s_nop 0
v_mov_b32_dpp v48, v54 quad_perm:[0,1,0,1] row_mask:0xf bank_mask:0xf
v_mov_b32_dpp v49, v55 quad_perm:[0,1,0,1] row_mask:0xf bank_mask:0xf
v_mov_b32_dpp v50, v54 quad_perm:[2,3,2,3] row_mask:0xf bank_mask:0xf
v_mov_b32_dpp v51, v55 quad_perm:[2,3,2,3] row_mask:0xf bank_mask:0xf
v_mov_b64 v[20:21], s[44:45]
v_mov_b64 v[22:23], s[44:45]
v_mfma_f32_16x16x32_bf16 v[8:11], v[56:59], v[48:51], 0
v_mfma_f32_16x16x32_bf16 v[12:15], v[60:63], v[48:51], 0
v_mfma_f32_16x16x32_bf16 v[16:19], v[20:23], v[48:51], 0
v_mov_b64 v[54:55], s[46:47]
v_exp_f32_dpp v44, v46 quad_perm:[0,1,0,1] row_mask:0xf bank_mask:0xf
v_exp_f32_dpp v45, v47 quad_perm:[0,1,0,1] row_mask:0xf bank_mask:0xf
s_nop 0
v_cvt_pk_bf16_f32 v52, v44, v45
v_cvt_pk_bf16_f32 v53, v44, v45
s_nop 1
v_mfma_f32_16x16x16_bf16 v[16:19], v[54:55], v[52:53], v[16:19]
v_mfma_f32_16x16x16_bf16 v[8:11], v[24:25], v[52:53], v[8:11]
v_mfma_f32_16x16x16_bf16 v[12:15], v[26:27], v[52:53], v[12:15]
s_nop 5
v_rcp_f32 v18, v16
s_nop 0
v_cndmask_b32 v8, v12, v8, s[40:41]
v_mul_f32 v8, v8, v18
v_cndmask_b32 v9, v13, v9, s[40:41]
v_mul_f32 v9, v9, v18
v_cndmask_b32 v10, v14, v10, s[40:41]
v_mul_f32 v10, v10, v18
v_cndmask_b32 v11, v15, v11, s[40:41]
v_mul_f32 v11, v11, v18
v_cvt_pk_bf16_f32 v12, v8, v9
v_cvt_pk_bf16_f32 v13, v10, v11
s_branch back_10082
exit_10083:
global_load_dwordx4 v[32:35], v0, s[66:67] offset:-4096 sc1
global_load_dwordx4 v[36:39], v0, s[66:67] offset:0 sc1
global_load_dwordx4 v[40:43], v0, s[68:69] offset:0 sc1
s_add_u32 s30, s30, 1
s_cmp_gt_u32 s30, 262144
s_cbranch_scc1 L_fail
s_waitcnt vmcnt(2)
v_bitop3_b32 v44, v32, v34, s18 bitop3:0x7e
s_waitcnt vmcnt(1)
v_bitop3_b32 v45, v36, v38, s18 bitop3:0x7e
v_or_b32 v44, v44, v45
s_waitcnt vmcnt(0)
v_bitop3_b32 v46, v40, v42, s18 bitop3:0x7e
v_bitop3_b32 v44, v44, v46, s19 bitop3:0xa8
v_cmp_ne_u32 vcc, 0, v44
s_cbranch_vccnz exit_10083
ds_write_b128 v0, v[32:35] offset:0
ds_write_b128 v0, v[36:39] offset:4096
ds_write_b128 v0, v[40:43] offset:8192
s_waitcnt lgkmcnt(0)
s_barrier
s_barrier
s_add_u32 s35, s35, 1
s_cmp_lt_u32 s35, 2
s_cbranch_scc1 layer_10079
s_endpgm
wave_10076:
layer_10096:
s_lshl_b32 s17, s35, 6
s_mul_i32 s27, s35, 34603008
s_lshl_b32 s28, s14, 14
s_add_u32 s27, s27, s28
s_add_u32 s20, s27, 16781312
s_mul_i32 s27, s17, 10240
s_add_u32 s27, s27, s24
s_add_u32 s21, s27, s25
s_mov_b32 s19, 0
s_add_u32 s33, s17, 1
s_add_u32 s31, s17, 63
s_add_u32 s32, s17, 64
s_mov_b32 s27, s20
v_mov_b32 v7, 0
s_add_u32 s66, s4, 414720
s_addc_u32 s67, s5, 0
s_add_u32 s70, s4, 398336
s_addc_u32 s71, s5, 0
s_add_u32 s68, s4, 418816
s_addc_u32 s69, s5, 0
s_add_u32 s72, s4, 402432
s_addc_u32 s73, s5, 0
s_add_u32 s42, s4, s20
s_addc_u32 s43, s5, 0
global_load_dwordx4 v[64:67], v0, s[74:75] offset:-4096 sc1
global_load_dwordx4 v[68:71], v0, s[74:75] offset:-3072 sc1
global_load_dwordx4 v[72:75], v0, s[74:75] offset:-2048 sc1
global_load_dwordx4 v[76:79], v0, s[74:75] offset:-1024 sc1
global_load_dwordx4 v[80:83], v0, s[76:77] offset:-4096 sc1
global_load_dwordx4 v[84:87], v0, s[76:77] offset:-3072 sc1
global_load_dwordx4 v[48:51], v0, s[74:75] offset:2048 sc1
global_load_dwordx4 v[52:55], v0, s[74:75] offset:3072 sc1
global_load_dwordx4 v[56:59], v0, s[74:75] offset:0 sc1
global_load_dwordx4 v[60:63], v0, s[74:75] offset:1024 sc1
v_mov_b64 v[8:9], 0
v_mov_b64 v[10:11], 0
v_mov_b64 v[12:13], 0
v_mov_b64 v[14:15], 0
v_mov_b64 v[16:17], 0
v_mov_b64 v[18:19], 0
v_mov_b64 v[20:21], 0
v_mov_b64 v[22:23], 0
v_mov_b64 v[24:25], 0
v_mov_b64 v[26:27], 0
v_mov_b64 v[28:29], 0
v_mov_b64 v[30:31], 0
s_barrier
v_bfe_u32 v7, v0, 2, 3
v_add_u32 v7, s22, v7
s_mov_b32 exec_hi, 0
v_and_b32 v7, 511, v0
v_lshl_add_u32 v7, v7, 3, s27
s_mov_b32 exec_hi, -1
global_load_dwordx4 v[32:35], v0, s[66:67] offset:-4096 sc1
global_load_dwordx4 v[36:39], v0, s[66:67] offset:0 sc1
global_load_dwordx4 v[40:43], v0, s[68:69] offset:0 sc1
s_mov_b32 s30, 0
s_waitcnt vmcnt(0)
.p2align 6
gather_10097:
s_waitcnt vmcnt(4)
rt_10102_b:
v_smfmac_f32_16x16x64_bf16 v[20:23], v[32:35], v[48:55], v1
ds_write_b128 v0, v[32:35] offset:1024
v_smfmac_f32_16x16x64_bf16 v[28:31], v[32:35], a[8:15], v1
v_bitop3_b32 v44, v32, v34, s18 bitop3:0x7e
v_smfmac_f32_16x16x64_bf16 v[16:19], v[32:35], v[56:63], v1
s_waitcnt vmcnt(3)
ds_write_b128 v0, v[36:39] offset:5120
v_bitop3_b32 v45, v36, v38, s18 bitop3:0x7e
v_or_b32 v44, v44, v45
s_waitcnt vmcnt(2)
v_bitop3_b32 v45, v40, v42, s18 bitop3:0x7e
v_smfmac_f32_16x16x64_bf16 v[20:23], v[36:39], a[40:47], v1
ds_write_b128 v0, v[40:43] offset:9216
v_bitop3_b32 v44, v44, v45, s19 bitop3:0xa8
v_cmp_ne_u32 vcc, 0, v44
v_smfmac_f32_16x16x64_bf16 v[8:11], v[32:35], v[64:71], v1
s_cbranch_vccnz rt_10102
ds_read_b128 v[56:59], v2 offset:0
v_smfmac_f32_16x16x64_bf16 v[24:27], v[32:35], a[0:7], v1
s_waitcnt lgkmcnt(2)
ds_read_b128 v[60:63], v2 offset:1024
global_load_dwordx4 v[64:67], v0, s[76:77] offset:-2048 sc1
v_smfmac_f32_16x16x64_bf16 v[8:11], v[36:39], a[16:23], v1
s_waitcnt lgkmcnt(2)
ds_read_b128 v[52:55], v2 offset:3072
ds_read_b128 v[48:51], v2 offset:2048
v_smfmac_f32_16x16x64_bf16 v[16:19], v[36:39], a[32:39], v1
s_barrier
ds_read_b128 v[40:43], v0 offset:0
v_smfmac_f32_16x16x64_bf16 v[12:15], v[32:35], v[72:79], v1
ds_read_b128 v[44:47], v0 offset:4096
global_load_dwordx4 v[68:71], v0, s[76:77] offset:-1024 sc1
v_smfmac_f32_16x16x64_bf16 v[12:15], v[36:39], a[24:31], v1
s_waitcnt lgkmcnt(4)
ds_read_b128 v[32:35], v0 offset:3072
global_load_dwordx4 v[72:75], v0, s[76:77] offset:0 sc1
v_smfmac_f32_16x16x64_bf16 v[24:27], v[36:39], v[56:63], v1
s_waitcnt lgkmcnt(3)
ds_read_b128 v[56:59], v2 offset:4096
s_xor_b32 s18, s18, 1
v_smfmac_f32_16x16x64_bf16 v[28:31], v[36:39], v[48:55], v1
s_waitcnt lgkmcnt(3)
ds_read_b128 v[60:63], v2 offset:5120
s_waitcnt vmcnt(3)
v_smfmac_f32_16x16x64_bf16 v[12:15], v[40:43], v[80:87], v1
s_waitcnt lgkmcnt(3)
ds_read_b128 v[84:87], v2 offset:7168
v_smfmac_f32_16x16x64_bf16 v[8:11], v[40:43], a[48:55], v1
ds_read_b128 v[36:39], v0 offset:7168
ds_read_b128 v[80:83], v2 offset:6144
v_smfmac_f32_16x16x64_bf16 v[12:15], v[44:47], a[64:71], v1
s_mov_b64 s[68:69], s[72:73]
global_load_dwordx4 v[76:79], v0, s[76:77] offset:1024 sc1
v_smfmac_f32_16x16x64_bf16 v[8:11], v[44:47], a[56:63], v1
s_waitcnt lgkmcnt(5)
ds_read_b128 v[40:43], v0 offset:2048
v_smfmac_f32_16x16x64_bf16 v[12:15], v[32:35], a[72:79], v1
ds_read_b128 v[44:47], v0 offset:6144
s_waitcnt lgkmcnt(5)
v_smfmac_f32_16x16x64_bf16 v[8:11], v[32:35], v[56:63], v1
s_waitcnt lgkmcnt(4)
ds_read_b128 v[56:59], v2 offset:8192
s_waitcnt lgkmcnt(4)
v_smfmac_f32_16x16x64_bf16 v[8:11], v[36:39], a[80:87], v1
ds_read_b128 v[60:63], v2 offset:9216
s_waitcnt lgkmcnt(4)
ds_read_b128 v[32:35], v0 offset:9216
v_smfmac_f32_16x16x64_bf16 v[12:15], v[36:39], v[80:87], v1
s_waitcnt lgkmcnt(4)
ds_read_b128 v[80:83], v2 offset:10240
v_smfmac_f32_16x16x64_bf16 v[12:15], v[40:43], a[96:103], v1
s_waitcnt lgkmcnt(4)
ds_read_b128 v[84:87], v2 offset:11264
global_load_dwordx4 v[48:51], v0, s[42:43] offset:0 nt sc1
v_smfmac_f32_16x16x64_bf16 v[12:15], v[44:47], a[104:111], v1
ds_read_b128 v[36:39], v0 offset:8192
global_load_dwordx4 v[52:55], v0, s[42:43] offset:1024 nt sc1
v_smfmac_f32_16x16x64_bf16 v[8:11], v[40:43], a[88:95], v1
s_mov_b64 vcc, s[40:41]
ds_read_b128 v[40:43], v0 offset:0
s_waitcnt lgkmcnt(4)
v_smfmac_f32_16x16x64_bf16 v[8:11], v[44:47], v[56:63], v1
ds_read_b128 v[56:59], v2 offset:12288
s_waitcnt lgkmcnt(4)
v_smfmac_f32_16x16x64_bf16 v[8:11], v[32:35], a[112:119], v1
ds_read_b128 v[60:63], v2 offset:13312
s_waitcnt lgkmcnt(4)
v_smfmac_f32_16x16x64_bf16 v[12:15], v[32:35], v[80:87], v1
s_waitcnt vmcnt(4)
ds_read_b128 v[32:35], v0 offset:4096
s_waitcnt lgkmcnt(4)
v_smfmac_f32_16x16x64_bf16 v[8:11], v[36:39], v[64:71], v1
s_add_u32 s20, s20, 524288
ds_read_b128 v[80:83], v2 offset:14336
v_smfmac_f32_16x16x64_bf16 v[12:15], v[36:39], a[120:127], v1
s_waitcnt lgkmcnt(4)
ds_read_b128 v[84:87], v2 offset:15360
global_load_dwordx4 v[64:67], v0, s[76:77] offset:2048 sc1
ds_read_b128 v[36:39], v0 offset:3072
v_smfmac_f32_16x16x64_bf16 v[20:23], v[40:43], a[128:135], v1
s_waitcnt lgkmcnt(4)
v_add_f32 v8, v8, v10
v_smfmac_f32_16x16x64_bf16 v[16:19], v[40:43], v[56:63], v1
s_waitcnt lgkmcnt(3)
ds_read_b128 v[56:59], v2 offset:16384
global_load_dwordx4 v[68:71], v0, s[76:77] offset:3072 sc1
ds_read_b128 v[40:43], v0 offset:7168
v_add_f32 v9, v9, v11
v_add_f32 v12, v12, v14
v_smfmac_f32_16x16x64_bf16 v[16:19], v[32:35], a[136:143], v1
s_waitcnt lgkmcnt(3)
ds_read_b128 v[60:63], v2 offset:17408
v_mul_f32 v12, s34, v12
v_smfmac_f32_16x16x64_bf16 v[20:23], v[32:35], v[80:87], v1
s_waitcnt lgkmcnt(3)
ds_read_b128 v[32:35], v0 offset:2048
ds_read_b128 v[84:87], v2 offset:19456
v_smfmac_f32_16x16x64_bf16 v[16:19], v[36:39], a[144:151], v1
s_waitcnt vmcnt(4)
ds_read_b128 v[80:83], v2 offset:18432
v_mul_f32 v8, s34, v8
v_add_f32 v13, v13, v15
v_mul_f32 v9, s34, v9
v_mul_f32 v13, s34, v13
v_cvt_pk_bf16_f32 v8, v8, v9
v_smfmac_f32_16x16x64_bf16 v[20:23], v[36:39], a[152:159], v1
s_waitcnt lgkmcnt(4)
ds_read_b128 v[36:39], v0 offset:6144
v_cvt_pk_bf16_f32 v12, v12, v13
v_smfmac_f32_16x16x64_bf16 v[16:19], v[40:43], v[72:79], v1
s_waitcnt lgkmcnt(4)
ds_write2_b32 v3, v8, v12 offset0:0 offset1:128
global_load_dwordx4 v[72:75], v0, s[78:79] offset:-4096 sc1
v_smfmac_f32_16x16x64_bf16 v[20:23], v[40:43], v[56:63], v1
s_waitcnt lgkmcnt(4)
global_load_dwordx4 v[76:79], v0, s[78:79] offset:-3072 sc1
v_smfmac_f32_16x16x64_bf16 v[16:19], v[32:35], a[160:167], v1
ds_read_b128 v[40:43], v0 offset:9216
global_load_dwordx4 v[56:59], v0, s[42:43] offset:2048 nt sc1
v_smfmac_f32_16x16x64_bf16 v[20:23], v[32:35], a[168:175], v1
s_waitcnt lgkmcnt(2)
global_load_dwordx4 v[60:63], v0, s[42:43] offset:3072 nt sc1
ds_read_b128 v[32:35], v0 offset:8192
v_smfmac_f32_16x16x64_bf16 v[16:19], v[36:39], a[176:183], v1
s_waitcnt lgkmcnt(2)
s_barrier
ds_read_b64_tr_b16 v[8:9], v4 offset:0
v_smfmac_f32_16x16x64_bf16 v[20:23], v[36:39], v[80:87], v1
s_waitcnt lgkmcnt(2)
ds_read_b64_tr_b16 v[10:11], v4 offset:512
ds_read_b128 v[36:39], v0 offset:9216
v_smfmac_f32_16x16x64_bf16 v[16:19], v[40:43], a[184:191], v1
s_waitcnt vmcnt(7)
ds_read_b64_tr_b16 v[14:15], v4 offset:1536
v_smfmac_f32_16x16x64_bf16 v[20:23], v[40:43], a[192:199], v1
s_waitcnt lgkmcnt(4)
ds_read_b128 v[40:43], v0 offset:8192
ds_read_b128 v[84:87], v2 offset:21504
v_smfmac_f32_16x16x64_bf16 v[16:19], v[32:35], a[200:207], v1
ds_read_b128 v[80:83], v2 offset:20480
s_waitcnt lgkmcnt(5)
s_waitcnt vmcnt(6)
ds_read_b64_tr_b16 v[12:13], v4 offset:1024
v_smfmac_f32_16x16x64_bf16 v[20:23], v[32:35], a[208:215], v1
s_waitcnt lgkmcnt(5)
ds_read_b128 v[32:35], v0 offset:0
v_smfmac_f32_16x16x64_bf16 v[28:31], v[36:39], a[224:231], v1
v_add_f32 v17, v17, v19
v_smfmac_f32_16x16x64_bf16 v[24:27], v[36:39], a[216:223], v1
s_mov_b32 s30, 0
ds_read_b128 v[36:39], v0 offset:4096
s_nop 0
v_add_f32 v20, v20, v22
v_mfma_f32_16x16x32_bf16 v[44:47], v[48:51], v[8:11], 0
s_waitcnt lgkmcnt(2)
global_load_dword v7, v7, s[4:5] sc1
v_mfma_f32_16x16x32_bf16 v[44:47], v[52:55], v[12:15], v[44:47]
s_waitcnt lgkmcnt(1)
v_add_f32 v16, v16, v18
v_cvt_pk_bf16_f32 v16, v16, v17
v_bfe_u32 v48, v0, 5, 1
v_add_f32 v21, v21, v23
v_cvt_pk_bf16_f32 v20, v20, v21
v_smfmac_f32_16x16x64_bf16 v[28:31], v[40:43], v[80:87], v1
ds_write2_b32 v3, v16, v20 offset0:1 offset1:129
v_cndmask_b32_dpp v45, v47, v45, vcc quad_perm:[0,1,0,1] row_mask:0xf bank_mask:0xf
v_lshl_add_u32 v48, v48, 3, v5
v_xor_b32 v48, 128, v48
v_cndmask_b32_dpp v44, v46, v44, vcc quad_perm:[0,1,0,1] row_mask:0xf bank_mask:0xf
v_smfmac_f32_16x16x64_bf16 v[24:27], v[40:43], a[232:239], v1
s_waitcnt vmcnt(5)
ds_write_b64 v48, v[44:45] offset:6656
v_smfmac_f32_16x16x64_bf16 v[28:31], v[32:35], a[248:255], v1
s_waitcnt lgkmcnt(2)
s_add_u32 s17, s17, 1
ds_read_b128 v[40:43], v0 offset:3072
v_smfmac_f32_16x16x64_bf16 v[24:27], v[32:35], a[240:247], v1
s_waitcnt lgkmcnt(1)
ds_read_b128 v[84:87], v2 offset:23552
v_smfmac_f32_16x16x64_bf16 v[24:27], v[36:39], v[64:71], v1
global_load_dwordx4 v[64:67], v0, s[74:75] offset:-4096 sc1
ds_read_b128 v[32:35], v0 offset:7168
v_smfmac_f32_16x16x64_bf16 v[28:31], v[36:39], v[88:95], v1
s_waitcnt vmcnt(4)
ds_read_b128 v[36:39], v0 offset:2048
s_barrier
ds_read_b128 v[52:55], v6 offset:7168
s_waitcnt lgkmcnt(4)
v_smfmac_f32_16x16x64_bf16 v[28:31], v[40:43], v[104:111], v1
ds_read_b128 v[48:51], v6 offset:6144
ds_read_b64_tr_b16 v[12:13], v4 offset:1024
v_smfmac_f32_16x16x64_bf16 v[24:27], v[40:43], v[96:103], v1
s_waitcnt vmcnt(3)
ds_read_b128 v[40:43], v0 offset:6144
s_waitcnt lgkmcnt(5)
ds_read_b64_tr_b16 v[10:11], v4 offset:512
v_smfmac_f32_16x16x64_bf16 v[24:27], v[32:35], v[112:119], v1
s_waitcnt vmcnt(2)
ds_read_b64_tr_b16 v[8:9], v4 offset:0
ds_read_b64_tr_b16 v[16:17], v4 offset:2048
v_smfmac_f32_16x16x64_bf16 v[28:31], v[32:35], v[120:127], v1
s_waitcnt lgkmcnt(7)
ds_read_b64_tr_b16 v[18:19], v4 offset:2560
v_mov_b64 v[34:35], 0
v_smfmac_f32_16x16x64_bf16 v[24:27], v[36:39], v[128:135], v1
s_waitcnt lgkmcnt(6)
ds_read_b64_tr_b16 v[22:23], v4 offset:3584
v_add_f32 v48, v48, v52
v_add_f32 v49, v49, v53
v_add_f32 v51, v51, v55
v_smfmac_f32_16x16x64_bf16 v[28:31], v[36:39], v[136:143], v1
s_waitcnt lgkmcnt(5)
ds_read_b64_tr_b16 v[14:15], v4 offset:1536
v_add_f32 v50, v50, v54
v_smfmac_f32_16x16x64_bf16 v[24:27], v[40:43], v[72:79], v1
s_waitcnt lgkmcnt(4)
ds_read_b64_tr_b16 v[20:21], v4 offset:3072
v_exp_f32 v51, v51
v_mfma_f32_16x16x32_bf16 v[44:47], v[8:11], v[8:11], 0
v_exp_f32 v50, v50
v_exp_f32 v48, v48
v_smfmac_f32_16x16x64_bf16 v[28:31], v[40:43], v[144:151], v1
s_waitcnt lgkmcnt(1)
ds_read_b128 v[80:83], v2 offset:22528
v_cvt_pk_bf16_f32 v55, v50, v51
v_mfma_f32_16x16x32_bf16 v[44:47], v[12:15], v[12:15], v[44:47]
s_waitcnt lgkmcnt(1)
v_exp_f32 v49, v49
v_mfma_f32_16x16x32_bf16 v[44:47], v[16:19], v[16:19], v[44:47]
v_cvt_pk_bf16_f32 v54, v48, v49
v_mov_b32_dpp v49, v55 quad_perm:[0,1,0,1] row_mask:0xf bank_mask:0xf
v_mfma_f32_16x16x32_bf16 v[44:47], v[20:23], v[20:23], v[44:47]
v_mov_b32_dpp v50, v54 quad_perm:[2,3,2,3] row_mask:0xf bank_mask:0xf
v_mov_b32_dpp v51, v55 quad_perm:[2,3,2,3] row_mask:0xf bank_mask:0xf
v_mov_b32_dpp v48, v54 quad_perm:[0,1,0,1] row_mask:0xf bank_mask:0xf
v_mov_b64 v[22:23], s[44:45]
v_cvt_pk_bf16_f32 v24, v24, v25
v_cvt_pk_bf16_f32 v25, v26, v27
v_mov_b64 v[20:21], s[44:45]
v_mfma_f32_16x16x32_bf16 v[8:11], v[56:59], v[48:51], 0
s_mov_b32 s19, 1
v_exp_f32_dpp v45, v47 quad_perm:[0,1,0,1] row_mask:0xf bank_mask:0xf
v_mfma_f32_16x16x32_bf16 v[12:15], v[60:63], v[48:51], 0
v_exp_f32_dpp v44, v46 quad_perm:[0,1,0,1] row_mask:0xf bank_mask:0xf
v_mfma_f32_16x16x32_bf16 v[16:19], v[20:23], v[48:51], 0
s_waitcnt lgkmcnt(0)
v_cvt_pk_bf16_f32 v52, v44, v45
v_cvt_pk_bf16_f32 v53, v44, v45
v_cvt_pk_bf16_f32 v26, v28, v29
v_cvt_pk_bf16_f32 v27, v30, v31
v_mfma_f32_16x16x16_bf16 v[8:11], v[24:25], v[52:53], v[8:11]
v_bfe_u32 v32, v0, 5, 1
v_mov_b64 v[54:55], s[46:47]
v_mfma_f32_16x16x16_bf16 v[12:15], v[26:27], v[52:53], v[12:15]
s_nop 0
ds_read_b128 v[28:31], v0 offset:31744
v_mov_b64 v[42:43], 0
v_mfma_f32_16x16x16_bf16 v[16:19], v[54:55], v[52:53], v[16:19]
s_add_u32 s21, s21, 10240
v_lshl_add_u32 v32, v32, 3, v5
v_mov_b64 v[40:41], 0
v_mov_b64 v[36:37], 0
v_cndmask_b32 v9, v13, v9, s[40:41]
v_cndmask_b32 v11, v15, v11, s[40:41]
v_cndmask_b32 v10, v14, v10, s[40:41]
v_cndmask_b32 v8, v12, v8, s[40:41]
v_rcp_f32 v18, v16
v_subrev_u32 v17, s36, v16
v_mul_f32 v9, v9, v18
v_mul_f32 v8, v8, v18
v_cvt_pk_bf16_f32 v12, v8, v9
v_mul_f32 v10, v10, v18
v_mul_f32 v11, v11, v18
v_cmp_lt_u32 vcc, s37, v17
v_cvt_pk_bf16_f32 v13, v10, v11
s_cbranch_vccnz rare_10098
back_10099:
ds_write_b64 v32, v[12:13] offset:512
v_mov_b64 v[50:51], 0
v_mov_b32_dpp v8, v12 quad_perm:[0,1,0,1] row_mask:0xf bank_mask:0xf
v_mov_b32_dpp v9, v13 quad_perm:[0,1,0,1] row_mask:0xf bank_mask:0xf
v_mov_b32_dpp v10, v12 quad_perm:[2,3,2,3] row_mask:0xf bank_mask:0xf
v_mov_b32_dpp v11, v13 quad_perm:[2,3,2,3] row_mask:0xf bank_mask:0xf
v_mov_b64 v[48:49], 0
v_mov_b64 v[38:39], 0
v_smfmac_f32_16x16x64_bf16 v[40:43], v[8:11], v[152:159], v1
ds_read_b128 v[16:19], v0 offset:28672
global_load_dwordx4 v[68:71], v0, s[74:75] offset:-3072 sc1
ds_read_b128 v[20:23], v0 offset:29696
v_smfmac_f32_16x16x64_bf16 v[48:51], v[8:11], v[160:167], v1
s_waitcnt lgkmcnt(3)
ds_read_b128 v[24:27], v0 offset:30720
s_waitcnt lgkmcnt(3)
s_barrier
ds_read_b128 v[56:59], v5 offset:0
global_load_dwordx4 v[72:75], v0, s[74:75] offset:-2048 sc1
ds_read_b128 v[60:63], v5 offset:1536
v_smfmac_f32_16x16x64_bf16 v[36:39], v[8:11], v[80:87], v1
ds_read_b128 v[12:15], v5 offset:1024
v_mov_b64 v[32:33], 0
v_mov_b64 v[54:55], 0
v_bfe_u32 v45, v0, 1, 7
v_smfmac_f32_16x16x64_bf16 v[32:35], v[8:11], v[176:183], v1
s_waitcnt lgkmcnt(4)
ds_read_b128 v[84:87], v0 offset:33792
global_load_dwordx4 v[76:79], v0, s[74:75] offset:-1024 sc1
ds_read_b128 v[80:83], v0 offset:32768
s_waitcnt lgkmcnt(4)
v_smfmac_f32_16x16x64_bf16 v[36:39], v[56:59], v[16:23], v1
ds_read_b128 v[20:23], v0 offset:35840
s_waitcnt lgkmcnt(4)
v_smfmac_f32_16x16x64_bf16 v[36:39], v[60:63], v[24:31], v1
ds_read_b128 v[28:31], v0 offset:37888
s_waitcnt lgkmcnt(4)
v_smfmac_f32_16x16x64_bf16 v[36:39], v[12:15], v[184:191], v1
ds_read_b128 v[24:27], v0 offset:36864
v_lshrrev_b32 v44, 8, v0
v_smfmac_f32_16x16x64_bf16 v[32:35], v[56:59], v[232:239], v1
s_waitcnt lgkmcnt(4)
ds_read_b128 v[16:19], v0 offset:34816
s_waitcnt lgkmcnt(4)
v_smfmac_f32_16x16x64_bf16 v[40:43], v[56:59], v[80:87], v1
s_add_u32 s33, s17, 2
ds_read_b128 v[80:83], v0 offset:38912
v_cvt_pk_bf16_f32 v36, v36, v37
v_smfmac_f32_16x16x64_bf16 v[40:43], v[60:63], v[192:199], v1
ds_read_b128 v[84:87], v0 offset:39936
v_lshl_or_b32 v44, v44, 12, v45
v_and_or_b32 v36, v36, -2, s18
v_cvt_pk_bf16_f32 v37, v38, v39
v_smfmac_f32_16x16x64_bf16 v[40:43], v[12:15], v[200:207], v1
s_nop 0
global_store_dwordx2 v44, v[36:37], s[48:49]
s_waitcnt lgkmcnt(5)
s_waitcnt lgkmcnt(2)
v_smfmac_f32_16x16x64_bf16 v[48:51], v[56:59], v[16:23], v1
s_min_u32 s33, s33, s32
s_nop 0
v_mov_b64 v[52:53], 0
v_cvt_pk_bf16_f32 v40, v40, v41
v_smfmac_f32_16x16x64_bf16 v[48:51], v[60:63], v[24:31], v1
s_waitcnt lgkmcnt(1)
v_and_or_b32 v40, v40, -2, s18
v_cvt_pk_bf16_f32 v41, v42, v43
v_smfmac_f32_16x16x64_bf16 v[48:51], v[12:15], v[208:215], v1
s_add_u32 s27, s20, 524288
global_store_dwordx2 v44, v[40:41], s[50:51]
s_add_u32 s42, s4, s20
v_smfmac_f32_16x16x64_bf16 v[52:55], v[8:11], v[168:175], v1
s_addc_u32 s43, s5, 0
s_waitcnt lgkmcnt(0)
v_smfmac_f32_16x16x64_bf16 v[52:55], v[56:59], v[80:87], v1
s_nop 0
v_cvt_pk_bf16_f32 v48, v48, v49
v_and_or_b32 v48, v48, -2, s18
v_cvt_pk_bf16_f32 v49, v50, v51
v_smfmac_f32_16x16x64_bf16 v[52:55], v[60:63], v[216:223], v1
s_mov_b64 s[66:67], s[70:71]
global_store_dwordx2 v44, v[48:49], s[52:53]
v_smfmac_f32_16x16x64_bf16 v[52:55], v[12:15], v[224:231], v1
s_nop 2
v_smfmac_f32_16x16x64_bf16 v[32:35], v[60:63], v[240:247], v1
s_nop 3
v_cvt_pk_bf16_f32 v52, v52, v53
v_and_or_b32 v52, v52, -2, s18
v_cvt_pk_bf16_f32 v53, v54, v55
v_smfmac_f32_16x16x64_bf16 v[32:35], v[12:15], v[248:255], v1
s_nop 0
global_store_dwordx2 v44, v[52:53], s[54:55]
s_nop 5
v_cvt_pk_bf16_f32 v32, v32, v33
v_cvt_pk_bf16_f32 v33, v34, v35
v_and_or_b32 v32, v32, -2, s18
global_store_dwordx2 v44, v[32:33], s[56:57]
v_bfe_u32 v24, v0, 6, 1
v_lshlrev_b32 v24, 4, v24
v_mov_b32 v25, 0x3f80
v_lshlrev_b32 v24, v24, v25
v_bfe_i32 v25, v0, 4, 1
v_and_b32 v45, v24, v25
v_and_b32 v47, v24, v25
v_xor_b32 v44, v24, v45
v_xor_b32 v46, v24, v45
v_and_b32 v28, 32, v0
v_bfe_u32 v29, v0, 6, 1
v_lshl_add_u32 v28, v29, 8, v28
v_bfe_u32 v29, v0, 8, 1
v_lshl_add_u32 v28, v29, 4, v28
v_bfe_u32 v29, v0, 4, 1
v_lshl_add_u32 v28, v29, 3, v28
s_waitcnt vmcnt(9)
v_bfe_u32 v7, v0, 2, 3
v_add_u32 v7, s22, v7
s_mov_b32 exec_hi, 0
v_and_b32 v7, 511, v0
v_lshl_add_u32 v7, v7, 3, s27
s_mov_b32 exec_hi, -1
s_nop 15
s_nop 15
s_nop 15
s_nop 15
s_nop 0
global_load_dwordx4 v[8:11], v0, s[62:63] offset:0 sc1
global_load_dwordx4 v[12:15], v0, s[62:63] offset:1024 sc1
global_load_dwordx4 v[16:19], v0, s[62:63] offset:2048 sc1
global_load_dwordx4 v[20:23], v0, s[62:63] offset:3072 sc1
s_nop 15
s_nop 1
global_load_dwordx4 v[56:59], v0, s[74:75] offset:0 sc1
global_load_dwordx4 v[60:63], v0, s[74:75] offset:1024 sc1
global_load_dwordx4 v[48:51], v0, s[74:75] offset:2048 sc1
global_load_dwordx4 v[52:55], v0, s[74:75] offset:3072 sc1
v_mov_b64 v[40:41], 0
v_mov_b64 v[42:43], 0
s_waitcnt vmcnt(6)
s_nop 0
v_smfmac_f32_16x16x64_bf16 v[40:43], v[44:47], v[8:15], v1
v_bitop3_b32 v24, v8, v10, s18 bitop3:0x7e
v_bitop3_b32 v25, v12, v14, s18 bitop3:0x7e
s_waitcnt vmcnt(4)
v_smfmac_f32_16x16x64_bf16 v[40:43], v[44:47], v[16:23], v1
v_bitop3_b32 v26, v16, v18, s18 bitop3:0x7e
v_bitop3_b32 v27, v20, v22, s18 bitop3:0x7e
v_or3_b32 v24, v24, v25, v26
v_bitop3_b32 v24, v24, v27, 1 bitop3:0xa8
v_cmp_ne_u32 vcc, 0, v24
s_cbranch_vccnz red_10105
red_10105_ok:
s_nop 1
v_add_f32_dpp v40, v40, v40 row_ror:8 row_mask:0xf bank_mask:0xf
v_add_f32_dpp v41, v41, v41 row_ror:8 row_mask:0xf bank_mask:0xf
v_add_f32_dpp v42, v42, v42 row_ror:8 row_mask:0xf bank_mask:0xf
v_add_f32_dpp v43, v43, v43 row_ror:8 row_mask:0xf bank_mask:0xf
v_cvt_pk_bf16_f32 v40, v40, v41
v_cvt_pk_bf16_f32 v41, v42, v43
v_and_or_b32 v40, v40, -2, s18
s_mov_b64 exec, 0x00ff00ff
global_store_dwordx2 v28, v[40:41], s[64:65]
s_mov_b64 exec, -1
v_mov_b64 v[8:9], 0
v_mov_b64 v[10:11], 0
v_mov_b64 v[12:13], 0
v_mov_b64 v[14:15], 0
v_mov_b64 v[16:17], 0
v_mov_b64 v[18:19], 0
v_mov_b64 v[20:21], 0
v_mov_b64 v[22:23], 0
v_mov_b64 v[24:25], 0
v_mov_b64 v[26:27], 0
v_mov_b64 v[28:29], 0
v_mov_b64 v[30:31], 0
s_nop 15
s_nop 6
s_barrier
global_load_dwordx4 v[32:35], v0, s[66:67] offset:-4096 sc1
s_nop 10
global_load_dwordx4 v[36:39], v0, s[66:67] offset:0 sc1
s_nop 10
global_load_dwordx4 v[40:43], v0, s[68:69] offset:0 sc1
s_barrier
global_load_dwordx4 v[80:83], v0, s[76:77] offset:-4096 sc1
global_load_dwordx4 v[84:87], v0, s[76:77] offset:-3072 sc1
s_mov_b32 s30, 0
s_cmp_eq_u32 s17, s31
s_cbranch_scc0 gather_10097
s_branch exit_10100
rt_10102:
global_load_dwordx4 v[32:35], v0, s[66:67] offset:-4096 sc1
global_load_dwordx4 v[36:39], v0, s[66:67] offset:0 sc1
global_load_dwordx4 v[40:43], v0, s[68:69] offset:0 sc1
s_add_u32 s30, s30, 1
s_cmp_gt_u32 s30, 262144
s_cbranch_scc1 L_fail
s_nop 0
v_mov_b64 v[8:9], 0
v_mov_b64 v[10:11], 0
v_mov_b64 v[12:13], 0
v_mov_b64 v[14:15], 0
v_mov_b64 v[16:17], 0
v_mov_b64 v[18:19], 0
v_mov_b64 v[20:21], 0
v_mov_b64 v[22:23], 0
v_mov_b64 v[24:25], 0
v_mov_b64 v[26:27], 0
v_mov_b64 v[28:29], 0
v_mov_b64 v[30:31], 0
s_waitcnt vmcnt(2)
v_bitop3_b32 v44, v32, v34, s18 bitop3:0x7e
s_waitcnt vmcnt(1)
v_bitop3_b32 v45, v36, v38, s18 bitop3:0x7e
v_or_b32 v44, v44, v45
s_waitcnt vmcnt(0)
v_bitop3_b32 v45, v40, v42, s18 bitop3:0x7e
v_bitop3_b32 v44, v44, v45, s19 bitop3:0xa8
v_cmp_ne_u32 vcc, 0, v44
s_cbranch_vccnz rt_10102
s_branch rt_10102_b
red_10105:
global_load_dwordx4 v[8:11], v0, s[62:63] offset:0 sc1
global_load_dwordx4 v[12:15], v0, s[62:63] offset:1024 sc1
global_load_dwordx4 v[16:19], v0, s[62:63] offset:2048 sc1
global_load_dwordx4 v[20:23], v0, s[62:63] offset:3072 sc1
s_add_u32 s30, s30, 1
s_cmp_gt_u32 s30, 262144
s_cbranch_scc1 L_fail
v_mov_b64 v[40:41], 0
v_mov_b64 v[42:43], 0
s_waitcnt vmcnt(2)
s_nop 0
v_smfmac_f32_16x16x64_bf16 v[40:43], v[44:47], v[8:15], v1
v_bitop3_b32 v24, v8, v10, s18 bitop3:0x7e
v_bitop3_b32 v25, v12, v14, s18 bitop3:0x7e
s_waitcnt vmcnt(0)
v_smfmac_f32_16x16x64_bf16 v[40:43], v[44:47], v[16:23], v1
v_bitop3_b32 v26, v16, v18, s18 bitop3:0x7e
v_bitop3_b32 v27, v20, v22, s18 bitop3:0x7e
v_or3_b32 v24, v24, v25, v26
v_bitop3_b32 v24, v24, v27, 1 bitop3:0xa8
v_cmp_ne_u32 vcc, 0, v24
s_cbranch_vccnz red_10105
s_branch red_10105_ok
rare_10098:
ds_read_b128 v[48:51], v6 offset:6144
ds_read_b128 v[52:55], v6 offset:7168
s_waitcnt lgkmcnt(0)
v_add_f32 v48, v48, v52
v_add_f32 v49, v49, v53
v_add_f32 v50, v50, v54
v_add_f32 v51, v51, v55
v_mov_b32_dpp v46, v46 quad_perm:[0,1,0,1] row_mask:0xf bank_mask:0xf
v_mov_b32_dpp v47, v47 quad_perm:[0,1,0,1] row_mask:0xf bank_mask:0xf
v_max3_f32 v19, v48, v49, v50
v_max3_f32 v19, v19, v51, v46
v_max_f32 v19, v19, v47
s_nop 1
v_max_f32_dpp v19, v19, v19 quad_perm:[2,3,0,1] row_mask:0xf bank_mask:0xf
v_mov_b32 v44, v19
s_nop 1
v_permlane32_swap_b32 v19, v44
v_max_f32 v19, v19, v44
v_mov_b32 v44, v19
s_nop 1
v_permlane16_swap_b32 v19, v44
v_max_f32 v19, v19, v44
v_sub_f32 v48, v48, v19
v_sub_f32 v49, v49, v19
v_sub_f32 v50, v50, v19
v_sub_f32 v51, v51, v19
v_sub_f32 v46, v46, v19
v_sub_f32 v47, v47, v19
v_exp_f32 v48, v48
v_exp_f32 v49, v49
v_exp_f32 v50, v50
v_exp_f32 v51, v51
v_cvt_pk_bf16_f32 v54, v48, v49
v_cvt_pk_bf16_f32 v55, v50, v51
s_nop 0
v_mov_b32_dpp v48, v54 quad_perm:[0,1,0,1] row_mask:0xf bank_mask:0xf
v_mov_b32_dpp v49, v55 quad_perm:[0,1,0,1] row_mask:0xf bank_mask:0xf
v_mov_b32_dpp v50, v54 quad_perm:[2,3,2,3] row_mask:0xf bank_mask:0xf
v_mov_b32_dpp v51, v55 quad_perm:[2,3,2,3] row_mask:0xf bank_mask:0xf
v_mov_b64 v[20:21], s[44:45]
v_mov_b64 v[22:23], s[44:45]
v_mfma_f32_16x16x32_bf16 v[8:11], v[56:59], v[48:51], 0
v_mfma_f32_16x16x32_bf16 v[12:15], v[60:63], v[48:51], 0
v_mfma_f32_16x16x32_bf16 v[16:19], v[20:23], v[48:51], 0
v_mov_b64 v[54:55], s[46:47]
v_exp_f32_dpp v44, v46 quad_perm:[0,1,0,1] row_mask:0xf bank_mask:0xf
v_exp_f32_dpp v45, v47 quad_perm:[0,1,0,1] row_mask:0xf bank_mask:0xf
s_nop 0
v_cvt_pk_bf16_f32 v52, v44, v45
v_cvt_pk_bf16_f32 v53, v44, v45
s_nop 1
v_mfma_f32_16x16x16_bf16 v[16:19], v[54:55], v[52:53], v[16:19]
v_mfma_f32_16x16x16_bf16 v[8:11], v[24:25], v[52:53], v[8:11]
v_mfma_f32_16x16x16_bf16 v[12:15], v[26:27], v[52:53], v[12:15]
s_nop 5
v_rcp_f32 v18, v16
s_nop 0
v_cndmask_b32 v8, v12, v8, s[40:41]
v_mul_f32 v8, v8, v18
v_cndmask_b32 v9, v13, v9, s[40:41]
v_mul_f32 v9, v9, v18
v_cndmask_b32 v10, v14, v10, s[40:41]
v_mul_f32 v10, v10, v18
v_cndmask_b32 v11, v15, v11, s[40:41]
v_mul_f32 v11, v11, v18
v_cvt_pk_bf16_f32 v12, v8, v9
v_cvt_pk_bf16_f32 v13, v10, v11
s_branch back_10099
exit_10100:
global_load_dwordx4 v[32:35], v0, s[66:67] offset:-4096 sc1
global_load_dwordx4 v[36:39], v0, s[66:67] offset:0 sc1
global_load_dwordx4 v[40:43], v0, s[68:69] offset:0 sc1
s_add_u32 s30, s30, 1
s_cmp_gt_u32 s30, 262144
s_cbranch_scc1 L_fail
s_waitcnt vmcnt(2)
v_bitop3_b32 v44, v32, v34, s18 bitop3:0x7e
s_waitcnt vmcnt(1)
v_bitop3_b32 v45, v36, v38, s18 bitop3:0x7e
v_or_b32 v44, v44, v45
s_waitcnt vmcnt(0)
v_bitop3_b32 v46, v40, v42, s18 bitop3:0x7e
v_bitop3_b32 v44, v44, v46, s19 bitop3:0xa8
v_cmp_ne_u32 vcc, 0, v44
s_cbranch_vccnz exit_10100
ds_write_b128 v0, v[32:35] offset:1024
ds_write_b128 v0, v[36:39] offset:5120
ds_write_b128 v0, v[40:43] offset:9216
s_waitcnt lgkmcnt(0)
s_barrier
s_barrier
s_add_u32 s35, s35, 1
s_cmp_lt_u32 s35, 2
s_cbranch_scc1 layer_10096
s_endpgm
wave_10077:
layer_10110:
s_lshl_b32 s17, s35, 6
s_mul_i32 s27, s35, 34603008
s_lshl_b32 s28, s14, 14
s_add_u32 s27, s27, s28
s_add_u32 s20, s27, 16785408
s_mul_i32 s27, s17, 10240
s_add_u32 s27, s27, s24
s_add_u32 s21, s27, s25
s_mov_b32 s19, 0
s_add_u32 s33, s17, 1
s_add_u32 s31, s17, 63
s_add_u32 s32, s17, 64
s_mov_b32 s27, s20
v_mov_b32 v7, 0
s_add_u32 s66, s4, 415744
s_addc_u32 s67, s5, 0
s_add_u32 s70, s4, 399360
s_addc_u32 s71, s5, 0
s_add_u32 s68, s4, 419840
s_addc_u32 s69, s5, 0
s_add_u32 s72, s4, 403456
s_addc_u32 s73, s5, 0
s_add_u32 s42, s4, s20
s_addc_u32 s43, s5, 0
global_load_dwordx4 v[64:67], v0, s[74:75] offset:-4096 sc1
global_load_dwordx4 v[68:71], v0, s[74:75] offset:-3072 sc1
global_load_dwordx4 v[72:75], v0, s[74:75] offset:-2048 sc1
global_load_dwordx4 v[76:79], v0, s[74:75] offset:-1024 sc1
global_load_dwordx4 v[80:83], v0, s[76:77] offset:-4096 sc1
global_load_dwordx4 v[84:87], v0, s[76:77] offset:-3072 sc1
global_load_dwordx4 v[48:51], v0, s[74:75] offset:2048 sc1
global_load_dwordx4 v[52:55], v0, s[74:75] offset:3072 sc1
global_load_dwordx4 v[56:59], v0, s[74:75] offset:0 sc1
global_load_dwordx4 v[60:63], v0, s[74:75] offset:1024 sc1
v_mov_b64 v[8:9], 0
v_mov_b64 v[10:11], 0
v_mov_b64 v[12:13], 0
v_mov_b64 v[14:15], 0
v_mov_b64 v[16:17], 0
v_mov_b64 v[18:19], 0
v_mov_b64 v[20:21], 0
v_mov_b64 v[22:23], 0
v_mov_b64 v[24:25], 0
v_mov_b64 v[26:27], 0
v_mov_b64 v[28:29], 0
v_mov_b64 v[30:31], 0
s_barrier
v_bfe_u32 v7, v0, 2, 3
v_add_u32 v7, s22, v7
s_mov_b32 exec_hi, 0
v_and_b32 v7, 511, v0
v_lshl_add_u32 v7, v7, 3, s27
s_mov_b32 exec_hi, -1
global_load_dwordx4 v[32:35], v0, s[66:67] offset:-4096 sc1
global_load_dwordx4 v[36:39], v0, s[66:67] offset:0 sc1
v_mov_b32 v45, -1
s_mov_b32 s30, 0
s_waitcnt vmcnt(0)
.p2align 6
gather_10111:
s_waitcnt vmcnt(3)
rt_10116_b:
v_smfmac_f32_16x16x64_bf16 v[20:23], v[32:35], v[48:55], v1
ds_write_b128 v0, v[32:35] offset:2048
v_smfmac_f32_16x16x64_bf16 v[28:31], v[32:35], a[8:15], v1
v_bitop3_b32 v44, v32, v34, s18 bitop3:0x7e
v_smfmac_f32_16x16x64_bf16 v[16:19], v[32:35], v[56:63], v1
s_waitcnt vmcnt(2)
ds_write_b128 v0, v[36:39] offset:6144
v_bitop3_b32 v45, v36, v38, s18 bitop3:0x7e
v_smfmac_f32_16x16x64_bf16 v[20:23], v[36:39], a[40:47], v1
v_bitop3_b32 v44, v44, v45, s19 bitop3:0xa8
v_cmp_ne_u32 vcc, 0, v44
v_smfmac_f32_16x16x64_bf16 v[8:11], v[32:35], v[64:71], v1
s_cbranch_vccnz rt_10116
ds_read_b128 v[56:59], v2 offset:0
v_smfmac_f32_16x16x64_bf16 v[24:27], v[32:35], a[0:7], v1
s_waitcnt lgkmcnt(1)
ds_read_b128 v[60:63], v2 offset:1024
global_load_dwordx4 v[64:67], v0, s[76:77] offset:-2048 sc1
v_smfmac_f32_16x16x64_bf16 v[8:11], v[36:39], a[16:23], v1
ds_read_b128 v[52:55], v2 offset:3072
ds_read_b128 v[48:51], v2 offset:2048
v_smfmac_f32_16x16x64_bf16 v[16:19], v[36:39], a[32:39], v1
s_barrier
ds_read_b128 v[40:43], v0 offset:3072
v_smfmac_f32_16x16x64_bf16 v[12:15], v[32:35], v[72:79], v1
ds_read_b128 v[44:47], v0 offset:7168
global_load_dwordx4 v[68:71], v0, s[76:77] offset:-1024 sc1
v_smfmac_f32_16x16x64_bf16 v[12:15], v[36:39], a[24:31], v1
s_waitcnt lgkmcnt(4)
ds_read_b128 v[32:35], v0 offset:0
global_load_dwordx4 v[72:75], v0, s[76:77] offset:0 sc1
v_smfmac_f32_16x16x64_bf16 v[24:27], v[36:39], v[56:63], v1
s_waitcnt lgkmcnt(3)
ds_read_b128 v[56:59], v2 offset:4096
s_xor_b32 s18, s18, 1
v_smfmac_f32_16x16x64_bf16 v[28:31], v[36:39], v[48:55], v1
s_waitcnt lgkmcnt(3)
ds_read_b128 v[60:63], v2 offset:5120
s_waitcnt vmcnt(3)
v_smfmac_f32_16x16x64_bf16 v[12:15], v[40:43], v[80:87], v1
s_waitcnt lgkmcnt(3)
ds_read_b128 v[84:87], v2 offset:7168
v_smfmac_f32_16x16x64_bf16 v[8:11], v[40:43], a[48:55], v1
ds_read_b128 v[36:39], v0 offset:4096
ds_read_b128 v[80:83], v2 offset:6144
v_smfmac_f32_16x16x64_bf16 v[12:15], v[44:47], a[64:71], v1
global_load_dwordx4 v[76:79], v0, s[76:77] offset:1024 sc1
v_smfmac_f32_16x16x64_bf16 v[8:11], v[44:47], a[56:63], v1
s_waitcnt lgkmcnt(5)
ds_read_b128 v[40:43], v0 offset:1024
v_smfmac_f32_16x16x64_bf16 v[12:15], v[32:35], a[72:79], v1
ds_read_b128 v[44:47], v0 offset:5120
s_waitcnt lgkmcnt(5)
v_smfmac_f32_16x16x64_bf16 v[8:11], v[32:35], v[56:63], v1
s_waitcnt lgkmcnt(4)
ds_read_b128 v[56:59], v2 offset:8192
s_waitcnt lgkmcnt(4)
v_smfmac_f32_16x16x64_bf16 v[8:11], v[36:39], a[80:87], v1
ds_read_b128 v[60:63], v2 offset:9216
s_waitcnt lgkmcnt(4)
ds_read_b128 v[32:35], v0 offset:8192
v_smfmac_f32_16x16x64_bf16 v[12:15], v[36:39], v[80:87], v1
s_waitcnt lgkmcnt(4)
ds_read_b128 v[80:83], v2 offset:10240
v_smfmac_f32_16x16x64_bf16 v[12:15], v[40:43], a[96:103], v1
s_waitcnt lgkmcnt(4)
ds_read_b128 v[84:87], v2 offset:11264
global_load_dwordx4 v[48:51], v0, s[42:43] offset:0 nt sc1
v_smfmac_f32_16x16x64_bf16 v[12:15], v[44:47], a[104:111], v1
ds_read_b128 v[36:39], v0 offset:9216
global_load_dwordx4 v[52:55], v0, s[42:43] offset:1024 nt sc1
v_smfmac_f32_16x16x64_bf16 v[8:11], v[40:43], a[88:95], v1
s_mov_b64 vcc, s[40:41]
ds_read_b128 v[40:43], v0 offset:3072
s_waitcnt lgkmcnt(4)
v_smfmac_f32_16x16x64_bf16 v[8:11], v[44:47], v[56:63], v1
ds_read_b128 v[56:59], v2 offset:12288
s_waitcnt lgkmcnt(4)
v_smfmac_f32_16x16x64_bf16 v[8:11], v[32:35], a[112:119], v1
ds_read_b128 v[60:63], v2 offset:13312
s_waitcnt lgkmcnt(4)
v_smfmac_f32_16x16x64_bf16 v[12:15], v[32:35], v[80:87], v1
s_waitcnt vmcnt(4)
ds_read_b128 v[32:35], v0 offset:7168
s_waitcnt lgkmcnt(4)
v_smfmac_f32_16x16x64_bf16 v[8:11], v[36:39], v[64:71], v1
s_add_u32 s20, s20, 524288
ds_read_b128 v[80:83], v2 offset:14336
v_smfmac_f32_16x16x64_bf16 v[12:15], v[36:39], a[120:127], v1
s_waitcnt lgkmcnt(4)
ds_read_b128 v[84:87], v2 offset:15360
global_load_dwordx4 v[64:67], v0, s[76:77] offset:2048 sc1
ds_read_b128 v[36:39], v0 offset:0
v_smfmac_f32_16x16x64_bf16 v[20:23], v[40:43], a[128:135], v1
s_waitcnt lgkmcnt(4)
v_add_f32 v8, v8, v10
v_smfmac_f32_16x16x64_bf16 v[16:19], v[40:43], v[56:63], v1
s_waitcnt lgkmcnt(3)
ds_read_b128 v[56:59], v2 offset:16384
global_load_dwordx4 v[68:71], v0, s[76:77] offset:3072 sc1
ds_read_b128 v[40:43], v0 offset:4096
v_add_f32 v9, v9, v11
v_add_f32 v12, v12, v14
v_smfmac_f32_16x16x64_bf16 v[16:19], v[32:35], a[136:143], v1
s_waitcnt lgkmcnt(3)
ds_read_b128 v[60:63], v2 offset:17408
v_mul_f32 v12, s34, v12
v_smfmac_f32_16x16x64_bf16 v[20:23], v[32:35], v[80:87], v1
s_waitcnt lgkmcnt(3)
ds_read_b128 v[32:35], v0 offset:1024
ds_read_b128 v[84:87], v2 offset:19456
v_smfmac_f32_16x16x64_bf16 v[16:19], v[36:39], a[144:151], v1
s_waitcnt vmcnt(4)
ds_read_b128 v[80:83], v2 offset:18432
v_mul_f32 v8, s34, v8
v_add_f32 v13, v13, v15
v_mul_f32 v9, s34, v9
v_mul_f32 v13, s34, v13
v_cvt_pk_bf16_f32 v8, v8, v9
v_smfmac_f32_16x16x64_bf16 v[20:23], v[36:39], a[152:159], v1
s_waitcnt lgkmcnt(4)
ds_read_b128 v[36:39], v0 offset:5120
v_cvt_pk_bf16_f32 v12, v12, v13
v_smfmac_f32_16x16x64_bf16 v[16:19], v[40:43], v[72:79], v1
s_waitcnt lgkmcnt(4)
ds_write2_b32 v3, v8, v12 offset0:0 offset1:128
global_load_dwordx4 v[72:75], v0, s[78:79] offset:-4096 sc1
v_smfmac_f32_16x16x64_bf16 v[20:23], v[40:43], v[56:63], v1
s_waitcnt lgkmcnt(4)
global_load_dwordx4 v[76:79], v0, s[78:79] offset:-3072 sc1
v_smfmac_f32_16x16x64_bf16 v[16:19], v[32:35], a[160:167], v1
ds_read_b128 v[40:43], v0 offset:8192
global_load_dwordx4 v[56:59], v0, s[42:43] offset:2048 nt sc1
v_smfmac_f32_16x16x64_bf16 v[20:23], v[32:35], a[168:175], v1
s_waitcnt lgkmcnt(2)
global_load_dwordx4 v[60:63], v0, s[42:43] offset:3072 nt sc1
ds_read_b128 v[32:35], v0 offset:9216
v_smfmac_f32_16x16x64_bf16 v[16:19], v[36:39], a[176:183], v1
s_waitcnt lgkmcnt(2)
s_barrier
ds_read_b64_tr_b16 v[8:9], v4 offset:2048
v_smfmac_f32_16x16x64_bf16 v[20:23], v[36:39], v[80:87], v1
s_waitcnt lgkmcnt(2)
ds_read_b64_tr_b16 v[10:11], v4 offset:2560
ds_read_b128 v[36:39], v0 offset:8192
v_smfmac_f32_16x16x64_bf16 v[16:19], v[40:43], a[184:191], v1
s_waitcnt vmcnt(7)
ds_read_b64_tr_b16 v[14:15], v4 offset:3584
v_smfmac_f32_16x16x64_bf16 v[20:23], v[40:43], a[192:199], v1
s_waitcnt lgkmcnt(4)
ds_read_b128 v[40:43], v0 offset:9216
ds_read_b128 v[84:87], v2 offset:21504
v_smfmac_f32_16x16x64_bf16 v[16:19], v[32:35], a[200:207], v1
ds_read_b128 v[80:83], v2 offset:20480
s_waitcnt lgkmcnt(5)
s_waitcnt vmcnt(6)
ds_read_b64_tr_b16 v[12:13], v4 offset:3072
v_smfmac_f32_16x16x64_bf16 v[20:23], v[32:35], a[208:215], v1
s_waitcnt lgkmcnt(5)
ds_read_b128 v[32:35], v0 offset:3072
v_smfmac_f32_16x16x64_bf16 v[28:31], v[36:39], a[224:231], v1
v_add_f32 v17, v17, v19
v_smfmac_f32_16x16x64_bf16 v[24:27], v[36:39], a[216:223], v1
s_mov_b32 s30, 0
ds_read_b128 v[36:39], v0 offset:7168
s_nop 0
v_add_f32 v20, v20, v22
v_mfma_f32_16x16x32_bf16 v[44:47], v[48:51], v[8:11], 0
s_waitcnt lgkmcnt(2)
global_load_dword v7, v7, s[4:5] sc1
v_mfma_f32_16x16x32_bf16 v[44:47], v[52:55], v[12:15], v[44:47]
s_waitcnt lgkmcnt(1)
v_add_f32 v16, v16, v18
v_cvt_pk_bf16_f32 v16, v16, v17
v_bfe_u32 v48, v0, 5, 1
v_add_f32 v21, v21, v23
v_cvt_pk_bf16_f32 v20, v20, v21
v_smfmac_f32_16x16x64_bf16 v[28:31], v[40:43], v[80:87], v1
ds_write2_b32 v3, v16, v20 offset0:1 offset1:129
v_cndmask_b32_dpp v45, v47, v45, vcc quad_perm:[0,1,0,1] row_mask:0xf bank_mask:0xf
v_lshl_add_u32 v48, v48, 3, v5
v_cndmask_b32_dpp v44, v46, v44, vcc quad_perm:[0,1,0,1] row_mask:0xf bank_mask:0xf
v_smfmac_f32_16x16x64_bf16 v[24:27], v[40:43], a[232:239], v1
s_waitcnt vmcnt(5)
ds_write_b64 v48, v[44:45] offset:7168
v_smfmac_f32_16x16x64_bf16 v[28:31], v[32:35], a[248:255], v1
s_waitcnt lgkmcnt(2)
s_add_u32 s17, s17, 1
ds_read_b128 v[40:43], v0 offset:0
v_smfmac_f32_16x16x64_bf16 v[24:27], v[32:35], a[240:247], v1
s_waitcnt lgkmcnt(1)
ds_read_b128 v[84:87], v2 offset:23552
v_smfmac_f32_16x16x64_bf16 v[24:27], v[36:39], v[64:71], v1
global_load_dwordx4 v[64:67], v0, s[74:75] offset:-4096 sc1
ds_read_b128 v[32:35], v0 offset:4096
v_smfmac_f32_16x16x64_bf16 v[28:31], v[36:39], v[88:95], v1
s_waitcnt vmcnt(4)
ds_read_b128 v[36:39], v0 offset:1024
s_barrier
ds_read_b128 v[52:55], v6 offset:7168
s_waitcnt lgkmcnt(4)
v_smfmac_f32_16x16x64_bf16 v[28:31], v[40:43], v[104:111], v1
ds_read_b128 v[48:51], v6 offset:6144
ds_read_b64_tr_b16 v[12:13], v4 offset:1024
v_smfmac_f32_16x16x64_bf16 v[24:27], v[40:43], v[96:103], v1
s_waitcnt vmcnt(3)
ds_read_b128 v[40:43], v0 offset:5120
s_waitcnt lgkmcnt(5)
ds_read_b64_tr_b16 v[10:11], v4 offset:512
v_smfmac_f32_16x16x64_bf16 v[24:27], v[32:35], v[112:119], v1
s_waitcnt vmcnt(2)
ds_read_b64_tr_b16 v[8:9], v4 offset:0
ds_read_b64_tr_b16 v[16:17], v4 offset:2048
v_smfmac_f32_16x16x64_bf16 v[28:31], v[32:35], v[120:127], v1
s_waitcnt lgkmcnt(7)
ds_read_b64_tr_b16 v[18:19], v4 offset:2560
v_mov_b64 v[34:35], 0
v_smfmac_f32_16x16x64_bf16 v[24:27], v[36:39], v[128:135], v1
s_waitcnt lgkmcnt(6)
ds_read_b64_tr_b16 v[22:23], v4 offset:3584
v_add_f32 v48, v48, v52
v_add_f32 v49, v49, v53
v_add_f32 v51, v51, v55
v_smfmac_f32_16x16x64_bf16 v[28:31], v[36:39], v[136:143], v1
s_waitcnt lgkmcnt(5)
ds_read_b64_tr_b16 v[14:15], v4 offset:1536
v_add_f32 v50, v50, v54
v_smfmac_f32_16x16x64_bf16 v[24:27], v[40:43], v[72:79], v1
s_waitcnt lgkmcnt(4)
ds_read_b64_tr_b16 v[20:21], v4 offset:3072
v_exp_f32 v51, v51
v_mfma_f32_16x16x32_bf16 v[44:47], v[8:11], v[8:11], 0
v_exp_f32 v50, v50
v_exp_f32 v48, v48
v_smfmac_f32_16x16x64_bf16 v[28:31], v[40:43], v[144:151], v1
s_waitcnt lgkmcnt(1)
ds_read_b128 v[80:83], v2 offset:22528
v_cvt_pk_bf16_f32 v55, v50, v51
v_mfma_f32_16x16x32_bf16 v[44:47], v[12:15], v[12:15], v[44:47]
s_waitcnt lgkmcnt(1)
v_exp_f32 v49, v49
v_mfma_f32_16x16x32_bf16 v[44:47], v[16:19], v[16:19], v[44:47]
v_cvt_pk_bf16_f32 v54, v48, v49
v_mov_b32_dpp v49, v55 quad_perm:[0,1,0,1] row_mask:0xf bank_mask:0xf
v_mfma_f32_16x16x32_bf16 v[44:47], v[20:23], v[20:23], v[44:47]
v_mov_b32_dpp v50, v54 quad_perm:[2,3,2,3] row_mask:0xf bank_mask:0xf
v_mov_b32_dpp v51, v55 quad_perm:[2,3,2,3] row_mask:0xf bank_mask:0xf
v_mov_b32_dpp v48, v54 quad_perm:[0,1,0,1] row_mask:0xf bank_mask:0xf
v_mov_b64 v[22:23], s[44:45]
v_cvt_pk_bf16_f32 v24, v24, v25
v_cvt_pk_bf16_f32 v25, v26, v27
v_mov_b64 v[20:21], s[44:45]
v_mfma_f32_16x16x32_bf16 v[8:11], v[56:59], v[48:51], 0
s_mov_b32 s19, 1
v_exp_f32_dpp v45, v47 quad_perm:[0,1,0,1] row_mask:0xf bank_mask:0xf
v_mfma_f32_16x16x32_bf16 v[12:15], v[60:63], v[48:51], 0
v_exp_f32_dpp v44, v46 quad_perm:[0,1,0,1] row_mask:0xf bank_mask:0xf
v_mfma_f32_16x16x32_bf16 v[16:19], v[20:23], v[48:51], 0
s_waitcnt lgkmcnt(0)
v_cvt_pk_bf16_f32 v52, v44, v45
v_cvt_pk_bf16_f32 v53, v44, v45
v_cvt_pk_bf16_f32 v26, v28, v29
v_cvt_pk_bf16_f32 v27, v30, v31
v_mfma_f32_16x16x16_bf16 v[8:11], v[24:25], v[52:53], v[8:11]
v_bfe_u32 v32, v0, 5, 1
v_mov_b64 v[54:55], s[46:47]
v_mfma_f32_16x16x16_bf16 v[12:15], v[26:27], v[52:53], v[12:15]
s_nop 0
ds_read_b128 v[28:31], v0 offset:44032
v_mov_b64 v[42:43], 0
v_mfma_f32_16x16x16_bf16 v[16:19], v[54:55], v[52:53], v[16:19]
s_add_u32 s21, s21, 10240
v_lshl_add_u32 v32, v32, 3, v5
v_mov_b64 v[40:41], 0
v_mov_b64 v[36:37], 0
v_cndmask_b32 v9, v13, v9, s[40:41]
v_cndmask_b32 v11, v15, v11, s[40:41]
v_cndmask_b32 v10, v14, v10, s[40:41]
v_cndmask_b32 v8, v12, v8, s[40:41]
v_rcp_f32 v18, v16
v_subrev_u32 v17, s36, v16
v_mul_f32 v9, v9, v18
v_mul_f32 v8, v8, v18
v_cvt_pk_bf16_f32 v12, v8, v9
v_mul_f32 v10, v10, v18
v_mul_f32 v11, v11, v18
v_cmp_lt_u32 vcc, s37, v17
v_cvt_pk_bf16_f32 v13, v10, v11
s_cbranch_vccnz rare_10112
back_10113:
ds_write_b64 v32, v[12:13] offset:1024
v_mov_b64 v[50:51], 0
v_mov_b32_dpp v8, v12 quad_perm:[0,1,0,1] row_mask:0xf bank_mask:0xf
v_mov_b32_dpp v9, v13 quad_perm:[0,1,0,1] row_mask:0xf bank_mask:0xf
v_mov_b32_dpp v10, v12 quad_perm:[2,3,2,3] row_mask:0xf bank_mask:0xf
v_mov_b32_dpp v11, v13 quad_perm:[2,3,2,3] row_mask:0xf bank_mask:0xf
v_mov_b64 v[48:49], 0
v_mov_b64 v[38:39], 0
v_smfmac_f32_16x16x64_bf16 v[40:43], v[8:11], v[152:159], v1
ds_read_b128 v[16:19], v0 offset:40960
global_load_dwordx4 v[68:71], v0, s[74:75] offset:-3072 sc1
ds_read_b128 v[20:23], v0 offset:41984
v_smfmac_f32_16x16x64_bf16 v[48:51], v[8:11], v[160:167], v1
s_waitcnt lgkmcnt(3)
ds_read_b128 v[24:27], v0 offset:43008
s_waitcnt lgkmcnt(3)
s_barrier
ds_read_b128 v[56:59], v5 offset:1536
global_load_dwordx4 v[72:75], v0, s[74:75] offset:-2048 sc1
ds_read_b128 v[60:63], v5 offset:0
v_smfmac_f32_16x16x64_bf16 v[36:39], v[8:11], v[80:87], v1
ds_read_b128 v[12:15], v5 offset:512
v_mov_b64 v[32:33], 0
v_mov_b64 v[54:55], 0
v_bfe_u32 v45, v0, 1, 7
v_smfmac_f32_16x16x64_bf16 v[32:35], v[8:11], v[176:183], v1
s_waitcnt lgkmcnt(4)
ds_read_b128 v[84:87], v0 offset:46080
global_load_dwordx4 v[76:79], v0, s[74:75] offset:-1024 sc1
ds_read_b128 v[80:83], v0 offset:45056
s_waitcnt lgkmcnt(4)
v_smfmac_f32_16x16x64_bf16 v[36:39], v[56:59], v[16:23], v1
ds_read_b128 v[20:23], v0 offset:48128
s_waitcnt lgkmcnt(4)
v_smfmac_f32_16x16x64_bf16 v[36:39], v[60:63], v[24:31], v1
ds_read_b128 v[28:31], v0 offset:50176
s_waitcnt lgkmcnt(4)
v_smfmac_f32_16x16x64_bf16 v[36:39], v[12:15], v[184:191], v1
ds_read_b128 v[24:27], v0 offset:49152
v_lshrrev_b32 v44, 8, v0
v_smfmac_f32_16x16x64_bf16 v[32:35], v[56:59], v[232:239], v1
s_waitcnt lgkmcnt(4)
ds_read_b128 v[16:19], v0 offset:47104
s_waitcnt lgkmcnt(4)
v_smfmac_f32_16x16x64_bf16 v[40:43], v[56:59], v[80:87], v1
s_add_u32 s33, s17, 2
ds_read_b128 v[80:83], v0 offset:51200
v_cvt_pk_bf16_f32 v36, v36, v37
v_smfmac_f32_16x16x64_bf16 v[40:43], v[60:63], v[192:199], v1
ds_read_b128 v[84:87], v0 offset:52224
v_lshl_or_b32 v44, v44, 12, v45
v_and_or_b32 v36, v36, -2, s18
v_cvt_pk_bf16_f32 v37, v38, v39
v_smfmac_f32_16x16x64_bf16 v[40:43], v[12:15], v[200:207], v1
s_nop 0
global_store_dwordx2 v44, v[36:37], s[48:49]
s_waitcnt lgkmcnt(5)
s_waitcnt lgkmcnt(2)
v_smfmac_f32_16x16x64_bf16 v[48:51], v[56:59], v[16:23], v1
s_min_u32 s33, s33, s32
s_nop 0
v_mov_b64 v[52:53], 0
v_cvt_pk_bf16_f32 v40, v40, v41
v_smfmac_f32_16x16x64_bf16 v[48:51], v[60:63], v[24:31], v1
s_waitcnt lgkmcnt(1)
v_and_or_b32 v40, v40, -2, s18
v_cvt_pk_bf16_f32 v41, v42, v43
v_smfmac_f32_16x16x64_bf16 v[48:51], v[12:15], v[208:215], v1
s_add_u32 s27, s20, 524288
global_store_dwordx2 v44, v[40:41], s[50:51]
s_add_u32 s42, s4, s20
v_smfmac_f32_16x16x64_bf16 v[52:55], v[8:11], v[168:175], v1
s_addc_u32 s43, s5, 0
s_waitcnt lgkmcnt(0)
v_smfmac_f32_16x16x64_bf16 v[52:55], v[56:59], v[80:87], v1
s_nop 0
v_cvt_pk_bf16_f32 v48, v48, v49
v_and_or_b32 v48, v48, -2, s18
v_cvt_pk_bf16_f32 v49, v50, v51
v_smfmac_f32_16x16x64_bf16 v[52:55], v[60:63], v[216:223], v1
s_mov_b64 s[66:67], s[70:71]
global_store_dwordx2 v44, v[48:49], s[52:53]
v_smfmac_f32_16x16x64_bf16 v[52:55], v[12:15], v[224:231], v1
s_nop 2
v_smfmac_f32_16x16x64_bf16 v[32:35], v[60:63], v[240:247], v1
s_nop 3
v_cvt_pk_bf16_f32 v52, v52, v53
v_and_or_b32 v52, v52, -2, s18
v_cvt_pk_bf16_f32 v53, v54, v55
v_smfmac_f32_16x16x64_bf16 v[32:35], v[12:15], v[248:255], v1
s_nop 0
global_store_dwordx2 v44, v[52:53], s[54:55]
s_nop 5
v_cvt_pk_bf16_f32 v32, v32, v33
v_cvt_pk_bf16_f32 v33, v34, v35
v_and_or_b32 v32, v32, -2, s18
global_store_dwordx2 v44, v[32:33], s[56:57]
s_cmp_ge_u32 s14, 16
s_cbranch_scc1 nored_10120
v_bfe_u32 v24, v0, 6, 1
v_lshlrev_b32 v24, 4, v24
v_mov_b32 v25, 0x3f80
v_lshlrev_b32 v24, v24, v25
v_bfe_i32 v25, v0, 4, 1
v_and_b32 v45, v24, v25
v_and_b32 v47, v24, v25
v_xor_b32 v44, v24, v45
v_xor_b32 v46, v24, v45
v_and_b32 v28, 32, v0
v_bfe_u32 v29, v0, 6, 1
v_lshl_add_u32 v28, v29, 8, v28
v_bfe_u32 v29, v0, 8, 1
v_lshl_add_u32 v28, v29, 4, v28
v_bfe_u32 v29, v0, 4, 1
v_lshl_add_u32 v28, v29, 3, v28
s_waitcnt vmcnt(9)
v_bfe_u32 v7, v0, 2, 3
v_add_u32 v7, s22, v7
s_mov_b32 exec_hi, 0
v_and_b32 v7, 511, v0
v_lshl_add_u32 v7, v7, 3, s27
s_mov_b32 exec_hi, -1
s_nop 15
s_nop 15
s_nop 15
s_nop 15
s_nop 13
global_load_dwordx4 v[8:11], v0, s[62:63] offset:0 sc1
global_load_dwordx4 v[12:15], v0, s[62:63] offset:1024 sc1
global_load_dwordx4 v[16:19], v0, s[62:63] offset:2048 sc1
global_load_dwordx4 v[20:23], v0, s[62:63] offset:3072 sc1
s_nop 5
global_load_dwordx4 v[56:59], v0, s[74:75] offset:0 sc1
global_load_dwordx4 v[60:63], v0, s[74:75] offset:1024 sc1
global_load_dwordx4 v[48:51], v0, s[74:75] offset:2048 sc1
global_load_dwordx4 v[52:55], v0, s[74:75] offset:3072 sc1
v_mov_b64 v[40:41], 0
v_mov_b64 v[42:43], 0
s_waitcnt vmcnt(6)
s_nop 0
v_smfmac_f32_16x16x64_bf16 v[40:43], v[44:47], v[8:15], v1
v_bitop3_b32 v24, v8, v10, s18 bitop3:0x7e
v_bitop3_b32 v25, v12, v14, s18 bitop3:0x7e
s_waitcnt vmcnt(4)
v_smfmac_f32_16x16x64_bf16 v[40:43], v[44:47], v[16:23], v1
v_bitop3_b32 v26, v16, v18, s18 bitop3:0x7e
v_bitop3_b32 v27, v20, v22, s18 bitop3:0x7e
v_or3_b32 v24, v24, v25, v26
v_bitop3_b32 v24, v24, v27, 1 bitop3:0xa8
v_cmp_ne_u32 vcc, 0, v24
s_cbranch_vccnz red_10119
red_10119_ok:
s_nop 1
v_add_f32_dpp v40, v40, v40 row_ror:8 row_mask:0xf bank_mask:0xf
v_add_f32_dpp v41, v41, v41 row_ror:8 row_mask:0xf bank_mask:0xf
v_add_f32_dpp v42, v42, v42 row_ror:8 row_mask:0xf bank_mask:0xf
v_add_f32_dpp v43, v43, v43 row_ror:8 row_mask:0xf bank_mask:0xf
v_cvt_pk_bf16_f32 v40, v40, v41
v_cvt_pk_bf16_f32 v41, v42, v43
v_and_or_b32 v40, v40, -2, s18
s_mov_b64 exec, 0x00ff00ff
global_store_dwordx2 v28, v[40:41], s[64:65]
s_mov_b64 exec, -1
v_mov_b64 v[8:9], 0
v_mov_b64 v[10:11], 0
v_mov_b64 v[12:13], 0
v_mov_b64 v[14:15], 0
v_mov_b64 v[16:17], 0
v_mov_b64 v[18:19], 0
v_mov_b64 v[20:21], 0
v_mov_b64 v[22:23], 0
v_mov_b64 v[24:25], 0
v_mov_b64 v[26:27], 0
v_mov_b64 v[28:29], 0
v_mov_b64 v[30:31], 0
s_nop 15
s_nop 6
s_barrier
global_load_dwordx4 v[32:35], v0, s[66:67] offset:-4096 sc1
s_nop 10
global_load_dwordx4 v[36:39], v0, s[66:67] offset:0 sc1
s_barrier
global_load_dwordx4 v[80:83], v0, s[76:77] offset:-4096 sc1
global_load_dwordx4 v[84:87], v0, s[76:77] offset:-3072 sc1
s_mov_b32 s30, 0
s_cmp_eq_u32 s17, s31
s_cbranch_scc0 gather_10111
s_branch exit_10114
nored_10120:
s_waitcnt vmcnt(9)
v_bfe_u32 v7, v0, 2, 3
v_add_u32 v7, s22, v7
s_mov_b32 exec_hi, 0
v_and_b32 v7, 511, v0
v_lshl_add_u32 v7, v7, 3, s27
s_mov_b32 exec_hi, -1
v_mov_b64 v[8:9], 0
v_mov_b64 v[10:11], 0
v_mov_b64 v[12:13], 0
v_mov_b64 v[14:15], 0
v_mov_b64 v[16:17], 0
v_mov_b64 v[18:19], 0
v_mov_b64 v[20:21], 0
v_mov_b64 v[22:23], 0
v_mov_b64 v[24:25], 0
v_mov_b64 v[26:27], 0
v_mov_b64 v[28:29], 0
v_mov_b64 v[30:31], 0
s_nop 15
s_nop 15
s_nop 15
s_nop 15
s_nop 15
s_nop 11
global_load_dwordx4 v[56:59], v0, s[74:75] offset:0 sc1
global_load_dwordx4 v[60:63], v0, s[74:75] offset:1024 sc1
global_load_dwordx4 v[48:51], v0, s[74:75] offset:2048 sc1
global_load_dwordx4 v[52:55], v0, s[74:75] offset:3072 sc1
s_barrier
global_load_dwordx4 v[32:35], v0, s[66:67] offset:-4096 sc1
s_nop 10
global_load_dwordx4 v[36:39], v0, s[66:67] offset:0 sc1
s_barrier
global_load_dwordx4 v[80:83], v0, s[76:77] offset:-4096 sc1
global_load_dwordx4 v[84:87], v0, s[76:77] offset:-3072 sc1
s_mov_b32 s30, 0
s_cmp_eq_u32 s17, s31
s_cbranch_scc0 gather_10111
s_branch exit_10114
rt_10116:
global_load_dwordx4 v[32:35], v0, s[66:67] offset:-4096 sc1
global_load_dwordx4 v[36:39], v0, s[66:67] offset:0 sc1
s_add_u32 s30, s30, 1
s_cmp_gt_u32 s30, 262144
s_cbranch_scc1 L_fail
s_nop 1
v_mov_b64 v[8:9], 0
v_mov_b64 v[10:11], 0
v_mov_b64 v[12:13], 0
v_mov_b64 v[14:15], 0
v_mov_b64 v[16:17], 0
v_mov_b64 v[18:19], 0
v_mov_b64 v[20:21], 0
v_mov_b64 v[22:23], 0
v_mov_b64 v[24:25], 0
v_mov_b64 v[26:27], 0
v_mov_b64 v[28:29], 0
v_mov_b64 v[30:31], 0
s_waitcnt vmcnt(1)
v_bitop3_b32 v40, v32, v34, s18 bitop3:0x7e
s_waitcnt vmcnt(0)
v_bitop3_b32 v41, v36, v38, s18 bitop3:0x7e
v_bitop3_b32 v40, v40, v41, s19 bitop3:0xa8
v_cmp_ne_u32 vcc, 0, v40
s_cbranch_vccnz rt_10116
s_branch rt_10116_b
red_10119:
global_load_dwordx4 v[8:11], v0, s[62:63] offset:0 sc1
global_load_dwordx4 v[12:15], v0, s[62:63] offset:1024 sc1
global_load_dwordx4 v[16:19], v0, s[62:63] offset:2048 sc1
global_load_dwordx4 v[20:23], v0, s[62:63] offset:3072 sc1
s_add_u32 s30, s30, 1
s_cmp_gt_u32 s30, 262144
s_cbranch_scc1 L_fail
v_mov_b64 v[40:41], 0
v_mov_b64 v[42:43], 0
s_waitcnt vmcnt(2)
s_nop 0
v_smfmac_f32_16x16x64_bf16 v[40:43], v[44:47], v[8:15], v1
v_bitop3_b32 v24, v8, v10, s18 bitop3:0x7e
v_bitop3_b32 v25, v12, v14, s18 bitop3:0x7e
s_waitcnt vmcnt(0)
v_smfmac_f32_16x16x64_bf16 v[40:43], v[44:47], v[16:23], v1
v_bitop3_b32 v26, v16, v18, s18 bitop3:0x7e
v_bitop3_b32 v27, v20, v22, s18 bitop3:0x7e
v_or3_b32 v24, v24, v25, v26
v_bitop3_b32 v24, v24, v27, 1 bitop3:0xa8
v_cmp_ne_u32 vcc, 0, v24
s_cbranch_vccnz red_10119
s_branch red_10119_ok
rare_10112:
ds_read_b128 v[48:51], v6 offset:6144
ds_read_b128 v[52:55], v6 offset:7168
s_waitcnt lgkmcnt(0)
v_add_f32 v48, v48, v52
v_add_f32 v49, v49, v53
v_add_f32 v50, v50, v54
v_add_f32 v51, v51, v55
v_mov_b32_dpp v46, v46 quad_perm:[0,1,0,1] row_mask:0xf bank_mask:0xf
v_mov_b32_dpp v47, v47 quad_perm:[0,1,0,1] row_mask:0xf bank_mask:0xf
v_max3_f32 v19, v48, v49, v50
v_max3_f32 v19, v19, v51, v46
v_max_f32 v19, v19, v47
s_nop 1
v_max_f32_dpp v19, v19, v19 quad_perm:[2,3,0,1] row_mask:0xf bank_mask:0xf
v_mov_b32 v44, v19
s_nop 1
v_permlane32_swap_b32 v19, v44
v_max_f32 v19, v19, v44
v_mov_b32 v44, v19
s_nop 1
v_permlane16_swap_b32 v19, v44
v_max_f32 v19, v19, v44
v_sub_f32 v48, v48, v19
v_sub_f32 v49, v49, v19
v_sub_f32 v50, v50, v19
v_sub_f32 v51, v51, v19
v_sub_f32 v46, v46, v19
v_sub_f32 v47, v47, v19
v_exp_f32 v48, v48
v_exp_f32 v49, v49
v_exp_f32 v50, v50
v_exp_f32 v51, v51
v_cvt_pk_bf16_f32 v54, v48, v49
v_cvt_pk_bf16_f32 v55, v50, v51
s_nop 0
v_mov_b32_dpp v48, v54 quad_perm:[0,1,0,1] row_mask:0xf bank_mask:0xf
v_mov_b32_dpp v49, v55 quad_perm:[0,1,0,1] row_mask:0xf bank_mask:0xf
v_mov_b32_dpp v50, v54 quad_perm:[2,3,2,3] row_mask:0xf bank_mask:0xf
v_mov_b32_dpp v51, v55 quad_perm:[2,3,2,3] row_mask:0xf bank_mask:0xf
v_mov_b64 v[20:21], s[44:45]
v_mov_b64 v[22:23], s[44:45]
v_mfma_f32_16x16x32_bf16 v[8:11], v[56:59], v[48:51], 0
v_mfma_f32_16x16x32_bf16 v[12:15], v[60:63], v[48:51], 0
v_mfma_f32_16x16x32_bf16 v[16:19], v[20:23], v[48:51], 0
v_mov_b64 v[54:55], s[46:47]
v_exp_f32_dpp v44, v46 quad_perm:[0,1,0,1] row_mask:0xf bank_mask:0xf
v_exp_f32_dpp v45, v47 quad_perm:[0,1,0,1] row_mask:0xf bank_mask:0xf
s_nop 0
v_cvt_pk_bf16_f32 v52, v44, v45
v_cvt_pk_bf16_f32 v53, v44, v45
s_nop 1
v_mfma_f32_16x16x16_bf16 v[16:19], v[54:55], v[52:53], v[16:19]
v_mfma_f32_16x16x16_bf16 v[8:11], v[24:25], v[52:53], v[8:11]
v_mfma_f32_16x16x16_bf16 v[12:15], v[26:27], v[52:53], v[12:15]
s_nop 5
v_rcp_f32 v18, v16
s_nop 0
v_cndmask_b32 v8, v12, v8, s[40:41]
v_mul_f32 v8, v8, v18
v_cndmask_b32 v9, v13, v9, s[40:41]
v_mul_f32 v9, v9, v18
v_cndmask_b32 v10, v14, v10, s[40:41]
v_mul_f32 v10, v10, v18
v_cndmask_b32 v11, v15, v11, s[40:41]
v_mul_f32 v11, v11, v18
v_cvt_pk_bf16_f32 v12, v8, v9
v_cvt_pk_bf16_f32 v13, v10, v11
s_branch back_10113
exit_10114:
global_load_dwordx4 v[32:35], v0, s[66:67] offset:-4096 sc1
global_load_dwordx4 v[36:39], v0, s[66:67] offset:0 sc1
s_add_u32 s30, s30, 1
s_cmp_gt_u32 s30, 262144
s_cbranch_scc1 L_fail
s_waitcnt vmcnt(1)
v_bitop3_b32 v44, v32, v34, s18 bitop3:0x7e
s_waitcnt vmcnt(0)
v_bitop3_b32 v45, v36, v38, s18 bitop3:0x7e
v_bitop3_b32 v44, v44, v45, s19 bitop3:0xa8
v_cmp_ne_u32 vcc, 0, v44
s_cbranch_vccnz exit_10114
ds_write_b128 v0, v[32:35] offset:2048
ds_write_b128 v0, v[36:39] offset:6144
s_waitcnt lgkmcnt(0)
s_barrier
s_barrier
s_add_u32 s35, s35, 1
s_cmp_lt_u32 s35, 2
s_cbranch_scc1 layer_10110
s_endpgm
wave_10078:
layer_10124:
s_lshl_b32 s17, s35, 6
s_mul_i32 s27, s35, 34603008
s_lshl_b32 s28, s14, 14
s_add_u32 s27, s27, s28
s_add_u32 s20, s27, 16789504
s_mul_i32 s27, s17, 10240
s_add_u32 s27, s27, s24
s_add_u32 s21, s27, s25
s_mov_b32 s19, 0
s_add_u32 s33, s17, 1
s_add_u32 s31, s17, 63
s_add_u32 s32, s17, 64
s_mov_b32 s27, s20
v_mov_b32 v7, 0
s_add_u32 s66, s4, 416768
s_addc_u32 s67, s5, 0
s_add_u32 s70, s4, 400384
s_addc_u32 s71, s5, 0
s_add_u32 s68, s4, 420864
s_addc_u32 s69, s5, 0
s_add_u32 s72, s4, 404480
s_addc_u32 s73, s5, 0
s_add_u32 s42, s4, s20
s_addc_u32 s43, s5, 0
global_load_dwordx4 v[64:67], v0, s[74:75] offset:-4096 sc1
global_load_dwordx4 v[68:71], v0, s[74:75] offset:-3072 sc1
global_load_dwordx4 v[72:75], v0, s[74:75] offset:-2048 sc1
global_load_dwordx4 v[76:79], v0, s[74:75] offset:-1024 sc1
global_load_dwordx4 v[80:83], v0, s[76:77] offset:-4096 sc1
global_load_dwordx4 v[84:87], v0, s[76:77] offset:-3072 sc1
global_load_dwordx4 v[48:51], v0, s[74:75] offset:2048 sc1
global_load_dwordx4 v[52:55], v0, s[74:75] offset:3072 sc1
global_load_dwordx4 v[56:59], v0, s[74:75] offset:0 sc1
global_load_dwordx4 v[60:63], v0, s[74:75] offset:1024 sc1
v_mov_b64 v[8:9], 0
v_mov_b64 v[10:11], 0
v_mov_b64 v[12:13], 0
v_mov_b64 v[14:15], 0
v_mov_b64 v[16:17], 0
v_mov_b64 v[18:19], 0
v_mov_b64 v[20:21], 0
v_mov_b64 v[22:23], 0
v_mov_b64 v[24:25], 0
v_mov_b64 v[26:27], 0
v_mov_b64 v[28:29], 0
v_mov_b64 v[30:31], 0
s_barrier
v_bfe_u32 v7, v0, 2, 3
v_add_u32 v7, s22, v7
s_mov_b32 exec_hi, 0
v_and_b32 v7, 511, v0
v_lshl_add_u32 v7, v7, 3, s27
s_mov_b32 exec_hi, -1
global_load_dwordx4 v[32:35], v0, s[66:67] offset:-4096 sc1
global_load_dwordx4 v[36:39], v0, s[66:67] offset:0 sc1
s_mov_b32 s30, 0
s_waitcnt vmcnt(0)
.p2align 6
gather_10125:
s_waitcnt vmcnt(3)
rt_10130_b:
v_smfmac_f32_16x16x64_bf16 v[20:23], v[32:35], v[48:55], v1
ds_write_b128 v0, v[32:35] offset:3072
v_smfmac_f32_16x16x64_bf16 v[28:31], v[32:35], a[8:15], v1
v_bitop3_b32 v44, v32, v34, s18 bitop3:0x7e
v_smfmac_f32_16x16x64_bf16 v[16:19], v[32:35], v[56:63], v1
s_waitcnt vmcnt(2)
ds_write_b128 v0, v[36:39] offset:7168
v_bitop3_b32 v45, v36, v38, s18 bitop3:0x7e
v_smfmac_f32_16x16x64_bf16 v[20:23], v[36:39], a[40:47], v1
v_bitop3_b32 v44, v44, v45, s19 bitop3:0xa8
v_cmp_ne_u32 vcc, 0, v44
v_smfmac_f32_16x16x64_bf16 v[8:11], v[32:35], v[64:71], v1
s_cbranch_vccnz rt_10130
ds_read_b128 v[56:59], v2 offset:0
v_smfmac_f32_16x16x64_bf16 v[24:27], v[32:35], a[0:7], v1
s_waitcnt lgkmcnt(1)
ds_read_b128 v[60:63], v2 offset:1024
global_load_dwordx4 v[64:67], v0, s[76:77] offset:-2048 sc1
v_smfmac_f32_16x16x64_bf16 v[8:11], v[36:39], a[16:23], v1
ds_read_b128 v[52:55], v2 offset:3072
ds_read_b128 v[48:51], v2 offset:2048
v_smfmac_f32_16x16x64_bf16 v[16:19], v[36:39], a[32:39], v1
s_barrier
ds_read_b128 v[40:43], v0 offset:2048
v_smfmac_f32_16x16x64_bf16 v[12:15], v[32:35], v[72:79], v1
ds_read_b128 v[44:47], v0 offset:6144
global_load_dwordx4 v[68:71], v0, s[76:77] offset:-1024 sc1
v_smfmac_f32_16x16x64_bf16 v[12:15], v[36:39], a[24:31], v1
s_waitcnt lgkmcnt(4)
ds_read_b128 v[32:35], v0 offset:1024
global_load_dwordx4 v[72:75], v0, s[76:77] offset:0 sc1
v_smfmac_f32_16x16x64_bf16 v[24:27], v[36:39], v[56:63], v1
s_waitcnt lgkmcnt(3)
ds_read_b128 v[56:59], v2 offset:4096
s_xor_b32 s18, s18, 1
v_smfmac_f32_16x16x64_bf16 v[28:31], v[36:39], v[48:55], v1
s_waitcnt lgkmcnt(3)
ds_read_b128 v[60:63], v2 offset:5120
s_waitcnt vmcnt(3)
v_smfmac_f32_16x16x64_bf16 v[12:15], v[40:43], v[80:87], v1
s_waitcnt lgkmcnt(3)
ds_read_b128 v[84:87], v2 offset:7168
v_smfmac_f32_16x16x64_bf16 v[8:11], v[40:43], a[48:55], v1
ds_read_b128 v[36:39], v0 offset:5120
ds_read_b128 v[80:83], v2 offset:6144
v_smfmac_f32_16x16x64_bf16 v[12:15], v[44:47], a[64:71], v1
global_load_dwordx4 v[76:79], v0, s[76:77] offset:1024 sc1
v_smfmac_f32_16x16x64_bf16 v[8:11], v[44:47], a[56:63], v1
s_waitcnt lgkmcnt(5)
ds_read_b128 v[40:43], v0 offset:0
v_smfmac_f32_16x16x64_bf16 v[12:15], v[32:35], a[72:79], v1
ds_read_b128 v[44:47], v0 offset:4096
s_waitcnt lgkmcnt(5)
v_smfmac_f32_16x16x64_bf16 v[8:11], v[32:35], v[56:63], v1
s_waitcnt lgkmcnt(4)
ds_read_b128 v[56:59], v2 offset:8192
s_waitcnt lgkmcnt(4)
v_smfmac_f32_16x16x64_bf16 v[8:11], v[36:39], a[80:87], v1
ds_read_b128 v[60:63], v2 offset:9216
s_waitcnt lgkmcnt(4)
ds_read_b128 v[32:35], v0 offset:9216
v_smfmac_f32_16x16x64_bf16 v[12:15], v[36:39], v[80:87], v1
s_waitcnt lgkmcnt(4)
ds_read_b128 v[80:83], v2 offset:10240
v_smfmac_f32_16x16x64_bf16 v[12:15], v[40:43], a[96:103], v1
s_waitcnt lgkmcnt(4)
ds_read_b128 v[84:87], v2 offset:11264
global_load_dwordx4 v[48:51], v0, s[42:43] offset:0 nt sc1
v_smfmac_f32_16x16x64_bf16 v[12:15], v[44:47], a[104:111], v1
ds_read_b128 v[36:39], v0 offset:8192
global_load_dwordx4 v[52:55], v0, s[42:43] offset:1024 nt sc1
v_smfmac_f32_16x16x64_bf16 v[8:11], v[40:43], a[88:95], v1
s_mov_b64 vcc, s[40:41]
ds_read_b128 v[40:43], v0 offset:2048
s_waitcnt lgkmcnt(4)
v_smfmac_f32_16x16x64_bf16 v[8:11], v[44:47], v[56:63], v1
ds_read_b128 v[56:59], v2 offset:12288
s_waitcnt lgkmcnt(4)
v_smfmac_f32_16x16x64_bf16 v[8:11], v[32:35], a[112:119], v1
ds_read_b128 v[60:63], v2 offset:13312
s_waitcnt lgkmcnt(4)
v_smfmac_f32_16x16x64_bf16 v[12:15], v[32:35], v[80:87], v1
s_waitcnt vmcnt(4)
ds_read_b128 v[32:35], v0 offset:6144
s_waitcnt lgkmcnt(4)
v_smfmac_f32_16x16x64_bf16 v[8:11], v[36:39], v[64:71], v1
s_add_u32 s20, s20, 524288
ds_read_b128 v[80:83], v2 offset:14336
v_add_u32 v44, s24, v0
v_smfmac_f32_16x16x64_bf16 v[12:15], v[36:39], a[120:127], v1
s_waitcnt lgkmcnt(4)
ds_read_b128 v[84:87], v2 offset:15360
global_load_dwordx4 v[64:67], v0, s[76:77] offset:2048 sc1
ds_read_b128 v[36:39], v0 offset:1024
v_smfmac_f32_16x16x64_bf16 v[20:23], v[40:43], a[128:135], v1
s_waitcnt lgkmcnt(4)
ds_read_b128 v[44:47], v44
v_add_f32 v8, v8, v10
v_smfmac_f32_16x16x64_bf16 v[16:19], v[40:43], v[56:63], v1
s_waitcnt lgkmcnt(4)
ds_read_b128 v[56:59], v2 offset:16384
global_load_dwordx4 v[68:71], v0, s[76:77] offset:3072 sc1
ds_read_b128 v[40:43], v0 offset:5120
v_add_f32 v9, v9, v11
v_add_f32 v12, v12, v14
v_smfmac_f32_16x16x64_bf16 v[16:19], v[32:35], a[136:143], v1
s_waitcnt lgkmcnt(4)
ds_read_b128 v[60:63], v2 offset:17408
v_mul_f32 v12, s34, v12
v_smfmac_f32_16x16x64_bf16 v[20:23], v[32:35], v[80:87], v1
s_waitcnt lgkmcnt(4)
ds_read_b128 v[32:35], v0 offset:0
ds_read_b128 v[84:87], v2 offset:19456
v_smfmac_f32_16x16x64_bf16 v[16:19], v[36:39], a[144:151], v1
s_waitcnt vmcnt(4)
ds_read_b128 v[80:83], v2 offset:18432
v_mul_f32 v8, s34, v8
v_add_f32 v13, v13, v15
v_mul_f32 v9, s34, v9
v_mul_f32 v13, s34, v13
v_cvt_pk_bf16_f32 v8, v8, v9
v_smfmac_f32_16x16x64_bf16 v[20:23], v[36:39], a[152:159], v1
s_waitcnt lgkmcnt(4)
ds_read_b128 v[36:39], v0 offset:4096
v_cvt_pk_bf16_f32 v12, v12, v13
v_smfmac_f32_16x16x64_bf16 v[16:19], v[40:43], v[72:79], v1
s_waitcnt lgkmcnt(4)
ds_write2_b32 v3, v8, v12 offset0:0 offset1:128
global_load_dwordx4 v[72:75], v0, s[78:79] offset:-4096 sc1
v_smfmac_f32_16x16x64_bf16 v[20:23], v[40:43], v[56:63], v1
s_waitcnt lgkmcnt(4)
global_load_dwordx4 v[76:79], v0, s[78:79] offset:-3072 sc1
v_smfmac_f32_16x16x64_bf16 v[16:19], v[32:35], a[160:167], v1
ds_read_b128 v[40:43], v0 offset:9216
global_load_dwordx4 v[56:59], v0, s[42:43] offset:2048 nt sc1
v_smfmac_f32_16x16x64_bf16 v[20:23], v[32:35], a[168:175], v1
s_waitcnt lgkmcnt(2)
global_load_dwordx4 v[60:63], v0, s[42:43] offset:3072 nt sc1
ds_read_b128 v[32:35], v0 offset:8192
v_smfmac_f32_16x16x64_bf16 v[16:19], v[36:39], a[176:183], v1
s_waitcnt lgkmcnt(2)
s_barrier
ds_read_b64_tr_b16 v[8:9], v4 offset:2048
v_smfmac_f32_16x16x64_bf16 v[20:23], v[36:39], v[80:87], v1
s_waitcnt lgkmcnt(2)
ds_read_b64_tr_b16 v[10:11], v4 offset:2560
ds_read_b128 v[36:39], v0 offset:9216
v_smfmac_f32_16x16x64_bf16 v[16:19], v[40:43], a[184:191], v1
s_waitcnt vmcnt(7)
ds_read_b64_tr_b16 v[14:15], v4 offset:3584
v_swap_b32 v45, v46
v_smfmac_f32_16x16x64_bf16 v[20:23], v[40:43], a[192:199], v1
s_waitcnt lgkmcnt(4)
ds_read_b128 v[40:43], v0 offset:8192
ds_read_b128 v[84:87], v2 offset:21504
v_smfmac_f32_16x16x64_bf16 v[16:19], v[32:35], a[200:207], v1
ds_read_b128 v[80:83], v2 offset:20480
buffer_store_dwordx4 v[44:47], v0, s[4:7], s21 offen sc1
s_waitcnt lgkmcnt(5)
s_waitcnt vmcnt(7)
ds_read_b64_tr_b16 v[12:13], v4 offset:3072
v_smfmac_f32_16x16x64_bf16 v[20:23], v[32:35], a[208:215], v1
s_waitcnt lgkmcnt(5)
ds_read_b128 v[32:35], v0 offset:2048
v_mov_b32 v47, s17
v_smfmac_f32_16x16x64_bf16 v[28:31], v[36:39], a[224:231], v1
s_mov_b64 exec, 1
buffer_store_dword v47, off, s[4:7], s23 sc1
s_mov_b64 exec, -1
v_add_f32 v17, v17, v19
v_smfmac_f32_16x16x64_bf16 v[24:27], v[36:39], a[216:223], v1
s_mov_b32 s30, 0
ds_read_b128 v[36:39], v0 offset:6144
v_add_f32 v20, v20, v22
v_mfma_f32_16x16x32_bf16 v[44:47], v[48:51], v[8:11], 0
s_waitcnt lgkmcnt(2)
global_load_dword v7, v7, s[4:5] sc1
v_mfma_f32_16x16x32_bf16 v[44:47], v[52:55], v[12:15], v[44:47]
s_waitcnt lgkmcnt(1)
v_add_f32 v16, v16, v18
v_cvt_pk_bf16_f32 v16, v16, v17
v_bfe_u32 v48, v0, 5, 1
v_add_f32 v21, v21, v23
v_cvt_pk_bf16_f32 v20, v20, v21
v_smfmac_f32_16x16x64_bf16 v[28:31], v[40:43], v[80:87], v1
ds_write2_b32 v3, v16, v20 offset0:1 offset1:129
v_cndmask_b32_dpp v45, v47, v45, vcc quad_perm:[0,1,0,1] row_mask:0xf bank_mask:0xf
v_lshl_add_u32 v48, v48, 3, v5
v_xor_b32 v48, 128, v48
v_cndmask_b32_dpp v44, v46, v44, vcc quad_perm:[0,1,0,1] row_mask:0xf bank_mask:0xf
v_smfmac_f32_16x16x64_bf16 v[24:27], v[40:43], a[232:239], v1
s_waitcnt vmcnt(7)
ds_write_b64 v48, v[44:45] offset:7680
v_smfmac_f32_16x16x64_bf16 v[28:31], v[32:35], a[248:255], v1
s_waitcnt lgkmcnt(2)
s_add_u32 s17, s17, 1
ds_read_b128 v[40:43], v0 offset:1024
v_smfmac_f32_16x16x64_bf16 v[24:27], v[32:35], a[240:247], v1
s_waitcnt lgkmcnt(1)
ds_read_b128 v[84:87], v2 offset:23552
v_smfmac_f32_16x16x64_bf16 v[24:27], v[36:39], v[64:71], v1
global_load_dwordx4 v[64:67], v0, s[74:75] offset:-4096 sc1
ds_read_b128 v[32:35], v0 offset:5120
v_smfmac_f32_16x16x64_bf16 v[28:31], v[36:39], v[88:95], v1
s_waitcnt vmcnt(6)
ds_read_b128 v[36:39], v0 offset:0
s_barrier
ds_read_b128 v[52:55], v6 offset:7168
s_waitcnt lgkmcnt(4)
v_smfmac_f32_16x16x64_bf16 v[28:31], v[40:43], v[104:111], v1
ds_read_b128 v[48:51], v6 offset:6144
ds_read_b64_tr_b16 v[12:13], v4 offset:1024
v_smfmac_f32_16x16x64_bf16 v[24:27], v[40:43], v[96:103], v1
s_waitcnt vmcnt(5)
ds_read_b128 v[40:43], v0 offset:4096
s_waitcnt lgkmcnt(5)
ds_read_b64_tr_b16 v[10:11], v4 offset:512
v_smfmac_f32_16x16x64_bf16 v[24:27], v[32:35], v[112:119], v1
s_waitcnt vmcnt(4)
ds_read_b64_tr_b16 v[8:9], v4 offset:0
ds_read_b64_tr_b16 v[16:17], v4 offset:2048
v_smfmac_f32_16x16x64_bf16 v[28:31], v[32:35], v[120:127], v1
s_waitcnt lgkmcnt(7)
ds_read_b64_tr_b16 v[18:19], v4 offset:2560
v_mov_b64 v[34:35], 0
v_smfmac_f32_16x16x64_bf16 v[24:27], v[36:39], v[128:135], v1
s_waitcnt lgkmcnt(6)
ds_read_b64_tr_b16 v[22:23], v4 offset:3584
v_add_f32 v48, v48, v52
v_add_f32 v49, v49, v53
v_add_f32 v51, v51, v55
v_smfmac_f32_16x16x64_bf16 v[28:31], v[36:39], v[136:143], v1
s_waitcnt lgkmcnt(5)
ds_read_b64_tr_b16 v[14:15], v4 offset:1536
v_add_f32 v50, v50, v54
v_smfmac_f32_16x16x64_bf16 v[24:27], v[40:43], v[72:79], v1
s_waitcnt lgkmcnt(4)
ds_read_b64_tr_b16 v[20:21], v4 offset:3072
v_exp_f32 v51, v51
v_mfma_f32_16x16x32_bf16 v[44:47], v[8:11], v[8:11], 0
v_exp_f32 v50, v50
v_exp_f32 v48, v48
v_smfmac_f32_16x16x64_bf16 v[28:31], v[40:43], v[144:151], v1
s_waitcnt lgkmcnt(1)
ds_read_b128 v[80:83], v2 offset:22528
v_cvt_pk_bf16_f32 v55, v50, v51
v_mfma_f32_16x16x32_bf16 v[44:47], v[12:15], v[12:15], v[44:47]
s_waitcnt lgkmcnt(1)
v_exp_f32 v49, v49
v_mfma_f32_16x16x32_bf16 v[44:47], v[16:19], v[16:19], v[44:47]
v_cvt_pk_bf16_f32 v54, v48, v49
v_mov_b32_dpp v49, v55 quad_perm:[0,1,0,1] row_mask:0xf bank_mask:0xf
v_mfma_f32_16x16x32_bf16 v[44:47], v[20:23], v[20:23], v[44:47]
v_mov_b32_dpp v50, v54 quad_perm:[2,3,2,3] row_mask:0xf bank_mask:0xf
v_mov_b32_dpp v51, v55 quad_perm:[2,3,2,3] row_mask:0xf bank_mask:0xf
v_mov_b32_dpp v48, v54 quad_perm:[0,1,0,1] row_mask:0xf bank_mask:0xf
v_mov_b64 v[22:23], s[44:45]
v_cvt_pk_bf16_f32 v24, v24, v25
v_cvt_pk_bf16_f32 v25, v26, v27
v_mov_b64 v[20:21], s[44:45]
v_mfma_f32_16x16x32_bf16 v[8:11], v[56:59], v[48:51], 0
s_mov_b32 s19, 1
v_exp_f32_dpp v45, v47 quad_perm:[0,1,0,1] row_mask:0xf bank_mask:0xf
v_mfma_f32_16x16x32_bf16 v[12:15], v[60:63], v[48:51], 0
v_exp_f32_dpp v44, v46 quad_perm:[0,1,0,1] row_mask:0xf bank_mask:0xf
v_mfma_f32_16x16x32_bf16 v[16:19], v[20:23], v[48:51], 0
s_waitcnt lgkmcnt(0)
v_cvt_pk_bf16_f32 v52, v44, v45
v_cvt_pk_bf16_f32 v53, v44, v45
v_cvt_pk_bf16_f32 v26, v28, v29
v_cvt_pk_bf16_f32 v27, v30, v31
v_mfma_f32_16x16x16_bf16 v[8:11], v[24:25], v[52:53], v[8:11]
v_bfe_u32 v32, v0, 5, 1
v_mov_b64 v[54:55], s[46:47]
v_mfma_f32_16x16x16_bf16 v[12:15], v[26:27], v[52:53], v[12:15]
s_nop 0
ds_read_b128 v[28:31], v0 offset:56320
v_mov_b64 v[42:43], 0
v_mfma_f32_16x16x16_bf16 v[16:19], v[54:55], v[52:53], v[16:19]
s_add_u32 s21, s21, 10240
v_lshl_add_u32 v32, v32, 3, v5
v_mov_b64 v[40:41], 0
v_mov_b64 v[36:37], 0
v_cndmask_b32 v9, v13, v9, s[40:41]
v_cndmask_b32 v11, v15, v11, s[40:41]
v_cndmask_b32 v10, v14, v10, s[40:41]
v_cndmask_b32 v8, v12, v8, s[40:41]
v_rcp_f32 v18, v16
v_subrev_u32 v17, s36, v16
v_mul_f32 v9, v9, v18
v_mul_f32 v8, v8, v18
v_cvt_pk_bf16_f32 v12, v8, v9
v_mul_f32 v10, v10, v18
v_mul_f32 v11, v11, v18
v_cmp_lt_u32 vcc, s37, v17
v_cvt_pk_bf16_f32 v13, v10, v11
s_cbranch_vccnz rare_10126
back_10127:
ds_write_b64 v32, v[12:13] offset:1536
v_mov_b64 v[50:51], 0
v_mov_b32_dpp v8, v12 quad_perm:[0,1,0,1] row_mask:0xf bank_mask:0xf
v_mov_b32_dpp v9, v13 quad_perm:[0,1,0,1] row_mask:0xf bank_mask:0xf
v_mov_b32_dpp v10, v12 quad_perm:[2,3,2,3] row_mask:0xf bank_mask:0xf
v_mov_b32_dpp v11, v13 quad_perm:[2,3,2,3] row_mask:0xf bank_mask:0xf
v_mov_b64 v[48:49], 0
v_mov_b64 v[38:39], 0
v_smfmac_f32_16x16x64_bf16 v[40:43], v[8:11], v[152:159], v1
ds_read_b128 v[16:19], v0 offset:53248
global_load_dwordx4 v[68:71], v0, s[74:75] offset:-3072 sc1
ds_read_b128 v[20:23], v0 offset:54272
v_smfmac_f32_16x16x64_bf16 v[48:51], v[8:11], v[160:167], v1
s_waitcnt lgkmcnt(3)
ds_read_b128 v[24:27], v0 offset:55296
s_waitcnt lgkmcnt(3)
s_barrier
ds_read_b128 v[56:59], v5 offset:1024
global_load_dwordx4 v[72:75], v0, s[74:75] offset:-2048 sc1
ds_read_b128 v[60:63], v5 offset:512
v_smfmac_f32_16x16x64_bf16 v[36:39], v[8:11], v[80:87], v1
ds_read_b128 v[12:15], v5 offset:0
v_mov_b64 v[32:33], 0
v_mov_b64 v[54:55], 0
v_bfe_u32 v45, v0, 1, 7
v_smfmac_f32_16x16x64_bf16 v[32:35], v[8:11], v[176:183], v1
s_waitcnt lgkmcnt(4)
ds_read_b128 v[84:87], v0 offset:58368
global_load_dwordx4 v[76:79], v0, s[74:75] offset:-1024 sc1
ds_read_b128 v[80:83], v0 offset:57344
s_waitcnt lgkmcnt(4)
v_smfmac_f32_16x16x64_bf16 v[36:39], v[56:59], v[16:23], v1
ds_read_b128 v[20:23], v0 offset:60416
s_waitcnt lgkmcnt(4)
v_smfmac_f32_16x16x64_bf16 v[36:39], v[60:63], v[24:31], v1
ds_read_b128 v[28:31], v0 offset:62464
s_waitcnt lgkmcnt(4)
v_smfmac_f32_16x16x64_bf16 v[36:39], v[12:15], v[184:191], v1
ds_read_b128 v[24:27], v0 offset:61440
v_lshrrev_b32 v44, 8, v0
v_smfmac_f32_16x16x64_bf16 v[32:35], v[56:59], v[232:239], v1
s_waitcnt lgkmcnt(4)
ds_read_b128 v[16:19], v0 offset:59392
s_waitcnt lgkmcnt(4)
v_smfmac_f32_16x16x64_bf16 v[40:43], v[56:59], v[80:87], v1
s_add_u32 s33, s17, 2
ds_read_b128 v[80:83], v0 offset:63488
v_cvt_pk_bf16_f32 v36, v36, v37
v_smfmac_f32_16x16x64_bf16 v[40:43], v[60:63], v[192:199], v1
ds_read_b128 v[84:87], v0 offset:64512
v_lshl_or_b32 v44, v44, 12, v45
v_and_or_b32 v36, v36, -2, s18
v_cvt_pk_bf16_f32 v37, v38, v39
v_smfmac_f32_16x16x64_bf16 v[40:43], v[12:15], v[200:207], v1
s_nop 0
global_store_dwordx2 v44, v[36:37], s[48:49]
s_waitcnt lgkmcnt(5)
s_waitcnt lgkmcnt(2)
v_smfmac_f32_16x16x64_bf16 v[48:51], v[56:59], v[16:23], v1
s_min_u32 s33, s33, s32
s_nop 0
v_mov_b64 v[52:53], 0
v_cvt_pk_bf16_f32 v40, v40, v41
v_smfmac_f32_16x16x64_bf16 v[48:51], v[60:63], v[24:31], v1
s_waitcnt lgkmcnt(1)
v_and_or_b32 v40, v40, -2, s18
v_cvt_pk_bf16_f32 v41, v42, v43
v_smfmac_f32_16x16x64_bf16 v[48:51], v[12:15], v[208:215], v1
s_add_u32 s27, s20, 524288
global_store_dwordx2 v44, v[40:41], s[50:51]
s_add_u32 s42, s4, s20
v_smfmac_f32_16x16x64_bf16 v[52:55], v[8:11], v[168:175], v1
s_addc_u32 s43, s5, 0
s_waitcnt lgkmcnt(0)
v_smfmac_f32_16x16x64_bf16 v[52:55], v[56:59], v[80:87], v1
s_nop 0
v_cvt_pk_bf16_f32 v48, v48, v49
v_and_or_b32 v48, v48, -2, s18
v_cvt_pk_bf16_f32 v49, v50, v51
v_smfmac_f32_16x16x64_bf16 v[52:55], v[60:63], v[216:223], v1
s_mov_b64 s[66:67], s[70:71]
global_store_dwordx2 v44, v[48:49], s[52:53]
v_smfmac_f32_16x16x64_bf16 v[52:55], v[12:15], v[224:231], v1
s_nop 2
v_smfmac_f32_16x16x64_bf16 v[32:35], v[60:63], v[240:247], v1
s_nop 3
v_cvt_pk_bf16_f32 v52, v52, v53
v_and_or_b32 v52, v52, -2, s18
v_cvt_pk_bf16_f32 v53, v54, v55
v_smfmac_f32_16x16x64_bf16 v[32:35], v[12:15], v[248:255], v1
s_nop 0
global_store_dwordx2 v44, v[52:53], s[54:55]
s_nop 5
v_cvt_pk_bf16_f32 v32, v32, v33
v_cvt_pk_bf16_f32 v33, v34, v35
v_and_or_b32 v32, v32, -2, s18
global_store_dwordx2 v44, v[32:33], s[56:57]
s_waitcnt vmcnt(9)
v_cmp_gt_u32 vcc, s33, v7
s_cmp_eq_u32 vcc_hi, 0
s_cbranch_scc1 kv_10140
s_mov_b32 s30, 0
kv_10139:
v_bfe_u32 v7, v0, 2, 3
buffer_load_dword v7, v7, s[4:7], s22 offen sc1
s_add_u32 s30, s30, 1
s_cmp_gt_u32 s30, 262144
s_cbranch_scc1 L_fail
s_waitcnt vmcnt(0)
v_cmp_gt_u32 vcc, s33, v7
s_cbranch_vccnz kv_10139
kv_10140:
s_mov_b32 s30, 0
v_bfe_u32 v7, v0, 2, 3
v_add_u32 v7, s22, v7
s_mov_b32 exec_hi, 0
v_and_b32 v7, 511, v0
v_lshl_add_u32 v7, v7, 3, s27
s_mov_b32 exec_hi, -1
v_mov_b64 v[8:9], 0
v_mov_b64 v[10:11], 0
v_mov_b64 v[12:13], 0
v_mov_b64 v[14:15], 0
v_mov_b64 v[16:17], 0
v_mov_b64 v[18:19], 0
v_mov_b64 v[20:21], 0
v_mov_b64 v[22:23], 0
v_mov_b64 v[24:25], 0
v_mov_b64 v[26:27], 0
v_mov_b64 v[28:29], 0
v_mov_b64 v[30:31], 0
s_nop 15
s_nop 15
s_nop 15
s_nop 15
s_nop 14
global_load_dwordx4 v[56:59], v0, s[74:75] offset:0 sc1
global_load_dwordx4 v[60:63], v0, s[74:75] offset:1024 sc1
global_load_dwordx4 v[48:51], v0, s[74:75] offset:2048 sc1
global_load_dwordx4 v[52:55], v0, s[74:75] offset:3072 sc1
s_nop 15
s_nop 15
s_nop 15
s_nop 15
s_nop 15
s_nop 6
s_barrier
global_load_dwordx4 v[32:35], v0, s[66:67] offset:-4096 sc1
s_nop 10
global_load_dwordx4 v[36:39], v0, s[66:67] offset:0 sc1
s_barrier
global_load_dwordx4 v[80:83], v0, s[76:77] offset:-4096 sc1
global_load_dwordx4 v[84:87], v0, s[76:77] offset:-3072 sc1
s_mov_b32 s30, 0
s_cmp_eq_u32 s17, s31
s_cbranch_scc0 gather_10125
s_branch exit_10128
rt_10130:
global_load_dwordx4 v[32:35], v0, s[66:67] offset:-4096 sc1
global_load_dwordx4 v[36:39], v0, s[66:67] offset:0 sc1
s_add_u32 s30, s30, 1
s_cmp_gt_u32 s30, 262144
s_cbranch_scc1 L_fail
s_nop 1
v_mov_b64 v[8:9], 0
v_mov_b64 v[10:11], 0
v_mov_b64 v[12:13], 0
v_mov_b64 v[14:15], 0
v_mov_b64 v[16:17], 0
v_mov_b64 v[18:19], 0
v_mov_b64 v[20:21], 0
v_mov_b64 v[22:23], 0
v_mov_b64 v[24:25], 0
v_mov_b64 v[26:27], 0
v_mov_b64 v[28:29], 0
v_mov_b64 v[30:31], 0
s_waitcnt vmcnt(1)
v_bitop3_b32 v40, v32, v34, s18 bitop3:0x7e
s_waitcnt vmcnt(0)
v_bitop3_b32 v41, v36, v38, s18 bitop3:0x7e
v_bitop3_b32 v40, v40, v41, s19 bitop3:0xa8
v_cmp_ne_u32 vcc, 0, v40
s_cbranch_vccnz rt_10130
s_branch rt_10130_b
rare_10126:
ds_read_b128 v[48:51], v6 offset:6144
ds_read_b128 v[52:55], v6 offset:7168
s_waitcnt lgkmcnt(0)
v_add_f32 v48, v48, v52
v_add_f32 v49, v49, v53
v_add_f32 v50, v50, v54
v_add_f32 v51, v51, v55
v_mov_b32_dpp v46, v46 quad_perm:[0,1,0,1] row_mask:0xf bank_mask:0xf
v_mov_b32_dpp v47, v47 quad_perm:[0,1,0,1] row_mask:0xf bank_mask:0xf
v_max3_f32 v19, v48, v49, v50
v_max3_f32 v19, v19, v51, v46
v_max_f32 v19, v19, v47
s_nop 1
v_max_f32_dpp v19, v19, v19 quad_perm:[2,3,0,1] row_mask:0xf bank_mask:0xf
v_mov_b32 v44, v19
s_nop 1
v_permlane32_swap_b32 v19, v44
v_max_f32 v19, v19, v44
v_mov_b32 v44, v19
s_nop 1
v_permlane16_swap_b32 v19, v44
v_max_f32 v19, v19, v44
v_sub_f32 v48, v48, v19
v_sub_f32 v49, v49, v19
v_sub_f32 v50, v50, v19
v_sub_f32 v51, v51, v19
v_sub_f32 v46, v46, v19
v_sub_f32 v47, v47, v19
v_exp_f32 v48, v48
v_exp_f32 v49, v49
v_exp_f32 v50, v50
v_exp_f32 v51, v51
v_cvt_pk_bf16_f32 v54, v48, v49
v_cvt_pk_bf16_f32 v55, v50, v51
s_nop 0
v_mov_b32_dpp v48, v54 quad_perm:[0,1,0,1] row_mask:0xf bank_mask:0xf
v_mov_b32_dpp v49, v55 quad_perm:[0,1,0,1] row_mask:0xf bank_mask:0xf
v_mov_b32_dpp v50, v54 quad_perm:[2,3,2,3] row_mask:0xf bank_mask:0xf
v_mov_b32_dpp v51, v55 quad_perm:[2,3,2,3] row_mask:0xf bank_mask:0xf
v_mov_b64 v[20:21], s[44:45]
v_mov_b64 v[22:23], s[44:45]
v_mfma_f32_16x16x32_bf16 v[8:11], v[56:59], v[48:51], 0
v_mfma_f32_16x16x32_bf16 v[12:15], v[60:63], v[48:51], 0
v_mfma_f32_16x16x32_bf16 v[16:19], v[20:23], v[48:51], 0
v_mov_b64 v[54:55], s[46:47]
v_exp_f32_dpp v44, v46 quad_perm:[0,1,0,1] row_mask:0xf bank_mask:0xf
v_exp_f32_dpp v45, v47 quad_perm:[0,1,0,1] row_mask:0xf bank_mask:0xf
s_nop 0
v_cvt_pk_bf16_f32 v52, v44, v45
v_cvt_pk_bf16_f32 v53, v44, v45
s_nop 1
v_mfma_f32_16x16x16_bf16 v[16:19], v[54:55], v[52:53], v[16:19]
v_mfma_f32_16x16x16_bf16 v[8:11], v[24:25], v[52:53], v[8:11]
v_mfma_f32_16x16x16_bf16 v[12:15], v[26:27], v[52:53], v[12:15]
s_nop 5
v_rcp_f32 v18, v16
s_nop 0
v_cndmask_b32 v8, v12, v8, s[40:41]
v_mul_f32 v8, v8, v18
v_cndmask_b32 v9, v13, v9, s[40:41]
v_mul_f32 v9, v9, v18
v_cndmask_b32 v10, v14, v10, s[40:41]
v_mul_f32 v10, v10, v18
v_cndmask_b32 v11, v15, v11, s[40:41]
v_mul_f32 v11, v11, v18
v_cvt_pk_bf16_f32 v12, v8, v9
v_cvt_pk_bf16_f32 v13, v10, v11
s_branch back_10127
exit_10128:
global_load_dwordx4 v[32:35], v0, s[66:67] offset:-4096 sc1
global_load_dwordx4 v[36:39], v0, s[66:67] offset:0 sc1
s_add_u32 s30, s30, 1
s_cmp_gt_u32 s30, 262144
s_cbranch_scc1 L_fail
s_waitcnt vmcnt(1)
v_bitop3_b32 v44, v32, v34, s18 bitop3:0x7e
s_waitcnt vmcnt(0)
v_bitop3_b32 v45, v36, v38, s18 bitop3:0x7e
v_bitop3_b32 v44, v44, v45, s19 bitop3:0xa8
v_cmp_ne_u32 vcc, 0, v44
s_cbranch_vccnz exit_10128
ds_write_b128 v0, v[32:35] offset:3072
ds_write_b128 v0, v[36:39] offset:7168
s_waitcnt lgkmcnt(0)
s_barrier
v_add_u32 v44, s24, v0
ds_read_b128 v[44:47], v44
s_waitcnt lgkmcnt(0)
v_swap_b32 v45, v46
buffer_store_dwordx4 v[44:47], v0, s[4:7], s21 offen sc1
s_add_u32 s26, s17, 1
s_waitcnt vmcnt(0)
v_mov_b32 v44, s26
s_mov_b64 exec, 1
buffer_store_dword v44, off, s[4:7], s23 sc1
s_mov_b64 exec, -1
s_barrier
s_add_u32 s35, s35, 1
s_cmp_lt_u32 s35, 2
s_cbranch_scc1 layer_10124
s_endpgm
grp_10071:
s_endpgm

.section .rodata,"a"
.p2align 6
.amdhsa_kernel interleave_layers__spectral_gfnet__memory_aug_recurrent_mem_tr__prompt_kernel
  .amdhsa_next_free_vgpr 512
  .amdhsa_next_free_sgpr 102
  .amdhsa_accum_offset 256
  .amdhsa_group_segment_fixed_size 0
  .amdhsa_kernarg_size 104
  .amdhsa_user_sgpr_count 2
  .amdhsa_user_sgpr_kernarg_segment_ptr 1
  .amdhsa_system_sgpr_workgroup_id_x 1
  .amdhsa_float_denorm_mode_32 3
  .amdhsa_ieee_mode 0
.end_amdhsa_kernel
```

```asm
; @launch grid=(256,1,1) block=(256,1,1) lds=163840
.amdgcn_target "amdgcn-amd-amdhsa--gfx950"
.text
.globl interleave_layers__spectral_gfnet__memory_aug_recurrent_mem_tr__prompt_kernel
.p2align 8
.type interleave_layers__spectral_gfnet__memory_aug_recurrent_mem_tr__prompt_kernel,@function
interleave_layers__spectral_gfnet__memory_aug_recurrent_mem_tr__prompt_kernel:
s_cmp_ge_u32 s2, 256
s_cbranch_scc1 L_end
s_load_dwordx2 s[4:5], s[0:1], 96
s_load_dwordx2 s[8:9], s[0:1], 88
s_mov_b32 s6, 268435456
s_mov_b32 s7, 0x20000
s_mov_b32 s10, 256
s_mov_b32 s11, 0x20000
s_getreg_b32 s12, hwreg(HW_REG_XCC_ID, 0, 3)
v_lshrrev_b32 v1, 6, v0
s_nop 0
v_readfirstlane_b32 s13, v1
s_waitcnt lgkmcnt(0)
s_cmp_lg_u32 s13, 0
s_cbranch_scc1 reg_3
s_cmp_ge_u32 s2, 16
s_cbranch_scc1 reg_4
v_lshlrev_b32 v1, 4, v0
s_lshl_b32 s15, s2, 12
v_mov_b64 v[4:5], 0
v_mov_b64 v[6:7], 0
buffer_store_dwordx4 v[4:7], v1, s[4:7], s15 offen offset:0 sc1
buffer_store_dwordx4 v[4:7], v1, s[4:7], s15 offen offset:1024 sc1
buffer_store_dwordx4 v[4:7], v1, s[4:7], s15 offen offset:2048 sc1
buffer_store_dwordx4 v[4:7], v1, s[4:7], s15 offen offset:3072 sc1
s_waitcnt vmcnt(0)
reg_4:
v_mov_b32 v1, 0
v_mov_b32 v2, -1
ds_write_b32 v1, v2
s_lshl_b32 s15, s12, 5
v_mov_b32 v2, 1
s_mov_b64 exec, 1
buffer_atomic_add v2, off, s[8:11], s15 sc0
s_mov_b64 exec, -1
v_and_b32 v1, 7, v0
v_lshlrev_b32 v1, 5, v1
s_mov_b32 s16, 0
reg_1:
buffer_load_dword v3, v1, s[8:11], 0 offen sc1
s_add_u32 s16, s16, 1
s_cmp_gt_u32 s16, 262144
s_cbranch_scc1 L_fail
s_waitcnt vmcnt(0)
v_add_u32_dpp v4, v3, v3 quad_perm:[1,0,3,2] row_mask:0xf bank_mask:0xf
s_nop 1
v_add_u32_dpp v4, v4, v4 quad_perm:[2,3,0,1] row_mask:0xf bank_mask:0xf
s_nop 1
v_add_u32_dpp v4, v4, v4 row_ror:4 row_mask:0xf bank_mask:0xf
v_cmp_ne_u32 vcc, 0x100, v4
s_cbranch_vccnz reg_1
v_readfirstlane_b32 s17, v2
v_readlane_b32 s20, v3, 0
v_readlane_b32 s21, v3, 1
v_readlane_b32 s22, v3, 2
v_readlane_b32 s23, v3, 3
v_readlane_b32 s24, v3, 4
v_readlane_b32 s25, v3, 5
v_readlane_b32 s26, v3, 6
v_readlane_b32 s27, v3, 7
s_mov_b32 s15, 6
s_cmp_ge_u32 s25, 32
s_cselect_b32 s15, 5, s15
s_cmp_ge_u32 s24, 32
s_cselect_b32 s15, 4, s15
s_cmp_ge_u32 s23, 32
s_cselect_b32 s15, 3, s15
s_cmp_ge_u32 s22, 32
s_cselect_b32 s15, 2, s15
s_cmp_ge_u32 s21, 32
s_cselect_b32 s15, 1, s15
s_cmp_ge_u32 s20, 32
s_cselect_b32 s15, 0, s15
s_cmp_ge_u32 s27, 32
s_cselect_b32 s15, 7, s15
s_mov_b32 s16, s17
s_cmp_gt_u32 s12, 0
s_cselect_b32 s18, s20, 0
s_add_u32 s16, s16, s18
s_cmp_gt_u32 s12, 1
s_cselect_b32 s18, s21, 0
s_add_u32 s16, s16, s18
s_cmp_gt_u32 s12, 2
s_cselect_b32 s18, s22, 0
s_add_u32 s16, s16, s18
s_cmp_gt_u32 s12, 3
s_cselect_b32 s18, s23, 0
s_add_u32 s16, s16, s18
s_cmp_gt_u32 s12, 4
s_cselect_b32 s18, s24, 0
s_add_u32 s16, s16, s18
s_cmp_gt_u32 s12, 5
s_cselect_b32 s18, s25, 0
s_add_u32 s16, s16, s18
s_cmp_gt_u32 s12, 6
s_cselect_b32 s18, s26, 0
s_add_u32 s16, s16, s18
s_add_u32 s18, s16, 32
s_cmp_lt_u32 s12, s15
s_cselect_b32 s16, s18, s16
s_cmp_eq_u32 s12, s15
s_cselect_b32 s18, s17, 32
s_cmp_lt_u32 s18, 32
s_cselect_b32 s16, s18, s16
v_mov_b32 v1, 0
v_mov_b32 v2, s16
ds_write_b32 v1, v2
s_waitcnt lgkmcnt(0)
s_branch reg_2
reg_3:
s_lshl_b32 s15, s13, 3
s_sub_u32 s15, s15, 8
s_load_dwordx2 s[20:21], s[0:1], s15
s_mov_b32 s16, 1314816
s_cmp_eq_u32 s13, 1
s_cselect_b32 s22, 2621440, s16
s_cselect_b32 s16, 80, 41
s_mov_b32 s23, 0x20000
s_mul_i32 s17, s16, s2
s_lshl_b32 s17, s17, 7
s_sub_u32 s16, s16, 1
v_and_b32 v1, 63, v0
v_add_u32 v2, 64, v1
v_min_u32 v1, s16, v1
v_min_u32 v2, s16, v2
v_lshlrev_b32 v1, 7, v1
v_lshlrev_b32 v2, 7, v2
s_waitcnt lgkmcnt(0)
buffer_load_dword v3, v1, s[20:23], s17 offen
buffer_load_dword v4, v2, s[20:23], s17 offen
reg_2:
s_barrier
v_mov_b32 v1, 0
ds_read_b32 v2, v1
s_waitcnt lgkmcnt(0)
v_readfirstlane_b32 s14, v2
s_barrier
s_cmp_ge_u32 s14, 256
s_cbranch_scc1 L_end
s_cmp_lt_u32 s14, 32
s_cbranch_scc1 L_chain
s_sub_u32 s15, s14, 32
v_and_b32 v0, 63, v0
v_lshlrev_b32 v0, 4, v0
s_mov_b32 s24, 0x3f803f80
s_mul_i32 s31, s13, 10240
s_lshl_b32 s37, s13, 10
s_mov_b32 s22, s6
s_mov_b32 s23, 0
s_mov_b32 s16, 0
s_cmp_ge_u32 s15, 64
s_cbranch_scc1 roleA_6
s_and_b32 s32, s15, 31
s_cmp_ge_u32 s15, 32
s_cbranch_scc1 roleV_5
s_lshl_b32 s26, s32, 8
s_lshl_b32 s18, s13, 6
s_add_u32 s26, s26, s18
s_load_dwordx2 s[40:41], s[0:1], 48
s_mov_b32 s42, 5242880
s_mov_b32 s43, 0x20000
s_waitcnt lgkmcnt(0)
v_lshrrev_b32 v32, 6, v0
v_mul_u32_u24 v32, 8192, v32
v_and_b32 v33, 48, v0
v_add_u32 v30, v32, v33
v_bfe_u32 v32, v0, 6, 2
v_lshrrev_b32 v33, 9, v0
v_lshl_add_u32 v32, v33, 3, v32
v_lshlrev_b32 v31, 6, v32
v_and_b32 v32, 16, v0
v_add_u32 v31, v31, v32
v_bfe_u32 v32, v0, 5, 1
v_lshl_add_u32 v31, v32, 3, v31
v_bfe_u32 v32, v0, 8, 1
v_lshl_add_u32 v31, v32, 5, v31
s_mul_i32 s18, s13, 36864
v_add_u32 v31, s18, v31
s_barrier
s_add_u32 m0, s18, 0
s_add_u32 s19, s26, 0
buffer_load_dwordx4 v30, s[40:43], s19 offen lds
s_add_u32 m0, s18, 1024
s_add_u32 s19, s26, 131072
buffer_load_dwordx4 v30, s[40:43], s19 offen lds
s_add_u32 m0, s18, 2048
s_add_u32 s19, s26, 262144
buffer_load_dwordx4 v30, s[40:43], s19 offen lds
s_add_u32 m0, s18, 3072
s_add_u32 s19, s26, 393216
buffer_load_dwordx4 v30, s[40:43], s19 offen lds
s_add_u32 m0, s18, 4096
s_add_u32 s19, s26, 524288
buffer_load_dwordx4 v30, s[40:43], s19 offen lds
s_add_u32 m0, s18, 5120
s_add_u32 s19, s26, 655360
buffer_load_dwordx4 v30, s[40:43], s19 offen lds
s_add_u32 m0, s18, 6144
s_add_u32 s19, s26, 786432
buffer_load_dwordx4 v30, s[40:43], s19 offen lds
s_add_u32 m0, s18, 7168
s_add_u32 s19, s26, 917504
buffer_load_dwordx4 v30, s[40:43], s19 offen lds
s_add_u32 m0, s18, 8192
s_add_u32 s19, s26, 1048576
buffer_load_dwordx4 v30, s[40:43], s19 offen lds
s_add_u32 m0, s18, 9216
s_add_u32 s19, s26, 1179648
buffer_load_dwordx4 v30, s[40:43], s19 offen lds
s_add_u32 m0, s18, 10240
s_add_u32 s19, s26, 1310720
buffer_load_dwordx4 v30, s[40:43], s19 offen lds
s_add_u32 m0, s18, 11264
s_add_u32 s19, s26, 1441792
buffer_load_dwordx4 v30, s[40:43], s19 offen lds
s_add_u32 m0, s18, 12288
s_add_u32 s19, s26, 1572864
buffer_load_dwordx4 v30, s[40:43], s19 offen lds
s_add_u32 m0, s18, 13312
s_add_u32 s19, s26, 1703936
buffer_load_dwordx4 v30, s[40:43], s19 offen lds
s_add_u32 m0, s18, 14336
s_add_u32 s19, s26, 1835008
buffer_load_dwordx4 v30, s[40:43], s19 offen lds
s_add_u32 m0, s18, 15360
s_add_u32 s19, s26, 1966080
buffer_load_dwordx4 v30, s[40:43], s19 offen lds
s_add_u32 m0, s18, 16384
s_add_u32 s19, s26, 2097152
buffer_load_dwordx4 v30, s[40:43], s19 offen lds
s_add_u32 m0, s18, 17408
s_add_u32 s19, s26, 2228224
buffer_load_dwordx4 v30, s[40:43], s19 offen lds
s_add_u32 m0, s18, 18432
s_add_u32 s19, s26, 2359296
buffer_load_dwordx4 v30, s[40:43], s19 offen lds
s_add_u32 m0, s18, 19456
s_add_u32 s19, s26, 2490368
buffer_load_dwordx4 v30, s[40:43], s19 offen lds
s_add_u32 m0, s18, 20480
s_add_u32 s19, s26, 2621440
buffer_load_dwordx4 v30, s[40:43], s19 offen lds
s_add_u32 m0, s18, 21504
s_add_u32 s19, s26, 2752512
buffer_load_dwordx4 v30, s[40:43], s19 offen lds
s_add_u32 m0, s18, 22528
s_add_u32 s19, s26, 2883584
buffer_load_dwordx4 v30, s[40:43], s19 offen lds
s_add_u32 m0, s18, 23552
s_add_u32 s19, s26, 3014656
buffer_load_dwordx4 v30, s[40:43], s19 offen lds
s_add_u32 m0, s18, 24576
s_add_u32 s19, s26, 3145728
buffer_load_dwordx4 v30, s[40:43], s19 offen lds
s_add_u32 m0, s18, 25600
s_add_u32 s19, s26, 3276800
buffer_load_dwordx4 v30, s[40:43], s19 offen lds
s_add_u32 m0, s18, 26624
s_add_u32 s19, s26, 3407872
buffer_load_dwordx4 v30, s[40:43], s19 offen lds
s_add_u32 m0, s18, 27648
s_add_u32 s19, s26, 3538944
buffer_load_dwordx4 v30, s[40:43], s19 offen lds
s_add_u32 m0, s18, 28672
s_add_u32 s19, s26, 3670016
buffer_load_dwordx4 v30, s[40:43], s19 offen lds
s_add_u32 m0, s18, 29696
s_add_u32 s19, s26, 3801088
buffer_load_dwordx4 v30, s[40:43], s19 offen lds
s_add_u32 m0, s18, 30720
s_add_u32 s19, s26, 3932160
buffer_load_dwordx4 v30, s[40:43], s19 offen lds
s_add_u32 m0, s18, 31744
s_add_u32 s19, s26, 4063232
buffer_load_dwordx4 v30, s[40:43], s19 offen lds
s_add_u32 m0, s18, 32768
s_add_u32 s19, s26, 4194304
buffer_load_dwordx4 v30, s[40:43], s19 offen lds
s_add_u32 m0, s18, 33792
s_add_u32 s19, s26, 4325376
buffer_load_dwordx4 v30, s[40:43], s19 offen lds
s_add_u32 m0, s18, 34816
s_add_u32 s19, s26, 4456448
buffer_load_dwordx4 v30, s[40:43], s19 offen lds
s_add_u32 m0, s18, 35840
s_add_u32 s19, s26, 4587520
buffer_load_dwordx4 v30, s[40:43], s19 offen lds
s_waitcnt vmcnt(32)
ds_read_b64_tr_b16 a[0:1], v31 offset:0
ds_read_b64_tr_b16 a[2:3], v31 offset:256
ds_read_b64_tr_b16 a[4:5], v31 offset:1024
ds_read_b64_tr_b16 a[6:7], v31 offset:1280
ds_read_b64_tr_b16 a[8:9], v31 offset:2048
ds_read_b64_tr_b16 a[10:11], v31 offset:2304
ds_read_b64_tr_b16 a[12:13], v31 offset:3072
ds_read_b64_tr_b16 a[14:15], v31 offset:3328
s_waitcnt lgkmcnt(0)
s_add_u32 m0, s18, 0
s_add_u32 s19, s26, 4718592
buffer_load_dwordx4 v30, s[40:43], s19 offen lds
s_add_u32 m0, s18, 1024
s_add_u32 s19, s26, 4849664
buffer_load_dwordx4 v30, s[40:43], s19 offen lds
s_add_u32 m0, s18, 2048
s_add_u32 s19, s26, 4980736
buffer_load_dwordx4 v30, s[40:43], s19 offen lds
s_add_u32 m0, s18, 3072
s_add_u32 s19, s26, 5111808
buffer_load_dwordx4 v30, s[40:43], s19 offen lds
s_waitcnt vmcnt(32)
ds_read_b64_tr_b16 a[16:17], v31 offset:4096
ds_read_b64_tr_b16 a[18:19], v31 offset:4352
ds_read_b64_tr_b16 a[20:21], v31 offset:5120
ds_read_b64_tr_b16 a[22:23], v31 offset:5376
ds_read_b64_tr_b16 a[24:25], v31 offset:6144
ds_read_b64_tr_b16 a[26:27], v31 offset:6400
ds_read_b64_tr_b16 a[28:29], v31 offset:7168
ds_read_b64_tr_b16 a[30:31], v31 offset:7424
s_waitcnt vmcnt(28)
ds_read_b64_tr_b16 a[32:33], v31 offset:8192
ds_read_b64_tr_b16 a[34:35], v31 offset:8448
ds_read_b64_tr_b16 a[36:37], v31 offset:9216
ds_read_b64_tr_b16 a[38:39], v31 offset:9472
ds_read_b64_tr_b16 a[40:41], v31 offset:10240
ds_read_b64_tr_b16 a[42:43], v31 offset:10496
ds_read_b64_tr_b16 a[44:45], v31 offset:11264
ds_read_b64_tr_b16 a[46:47], v31 offset:11520
s_waitcnt vmcnt(24)
ds_read_b64_tr_b16 a[48:49], v31 offset:12288
ds_read_b64_tr_b16 a[50:51], v31 offset:12544
ds_read_b64_tr_b16 a[52:53], v31 offset:13312
ds_read_b64_tr_b16 a[54:55], v31 offset:13568
ds_read_b64_tr_b16 a[56:57], v31 offset:14336
ds_read_b64_tr_b16 a[58:59], v31 offset:14592
ds_read_b64_tr_b16 a[60:61], v31 offset:15360
ds_read_b64_tr_b16 a[62:63], v31 offset:15616
s_waitcnt vmcnt(20)
ds_read_b64_tr_b16 a[64:65], v31 offset:16384
ds_read_b64_tr_b16 a[66:67], v31 offset:16640
ds_read_b64_tr_b16 a[68:69], v31 offset:17408
ds_read_b64_tr_b16 a[70:71], v31 offset:17664
ds_read_b64_tr_b16 a[72:73], v31 offset:18432
ds_read_b64_tr_b16 a[74:75], v31 offset:18688
ds_read_b64_tr_b16 a[76:77], v31 offset:19456
ds_read_b64_tr_b16 a[78:79], v31 offset:19712
s_waitcnt vmcnt(16)
ds_read_b64_tr_b16 a[80:81], v31 offset:20480
ds_read_b64_tr_b16 a[82:83], v31 offset:20736
ds_read_b64_tr_b16 a[84:85], v31 offset:21504
ds_read_b64_tr_b16 a[86:87], v31 offset:21760
ds_read_b64_tr_b16 a[88:89], v31 offset:22528
ds_read_b64_tr_b16 a[90:91], v31 offset:22784
ds_read_b64_tr_b16 a[92:93], v31 offset:23552
ds_read_b64_tr_b16 a[94:95], v31 offset:23808
s_waitcnt vmcnt(12)
ds_read_b64_tr_b16 a[96:97], v31 offset:24576
ds_read_b64_tr_b16 a[98:99], v31 offset:24832
ds_read_b64_tr_b16 a[100:101], v31 offset:25600
ds_read_b64_tr_b16 a[102:103], v31 offset:25856
ds_read_b64_tr_b16 a[104:105], v31 offset:26624
ds_read_b64_tr_b16 a[106:107], v31 offset:26880
ds_read_b64_tr_b16 a[108:109], v31 offset:27648
ds_read_b64_tr_b16 a[110:111], v31 offset:27904
s_waitcnt vmcnt(8)
ds_read_b64_tr_b16 a[112:113], v31 offset:28672
ds_read_b64_tr_b16 a[114:115], v31 offset:28928
ds_read_b64_tr_b16 a[116:117], v31 offset:29696
ds_read_b64_tr_b16 a[118:119], v31 offset:29952
ds_read_b64_tr_b16 a[120:121], v31 offset:30720
ds_read_b64_tr_b16 a[122:123], v31 offset:30976
ds_read_b64_tr_b16 a[124:125], v31 offset:31744
ds_read_b64_tr_b16 a[126:127], v31 offset:32000
s_waitcnt vmcnt(4)
ds_read_b64_tr_b16 a[128:129], v31 offset:32768
ds_read_b64_tr_b16 a[130:131], v31 offset:33024
ds_read_b64_tr_b16 a[132:133], v31 offset:33792
ds_read_b64_tr_b16 a[134:135], v31 offset:34048
ds_read_b64_tr_b16 a[136:137], v31 offset:34816
ds_read_b64_tr_b16 a[138:139], v31 offset:35072
ds_read_b64_tr_b16 a[140:141], v31 offset:35840
ds_read_b64_tr_b16 a[142:143], v31 offset:36096
s_waitcnt vmcnt(0)
ds_read_b64_tr_b16 a[144:145], v31 offset:0
ds_read_b64_tr_b16 a[146:147], v31 offset:256
ds_read_b64_tr_b16 a[148:149], v31 offset:1024
ds_read_b64_tr_b16 a[150:151], v31 offset:1280
ds_read_b64_tr_b16 a[152:153], v31 offset:2048
ds_read_b64_tr_b16 a[154:155], v31 offset:2304
ds_read_b64_tr_b16 a[156:157], v31 offset:3072
ds_read_b64_tr_b16 a[158:159], v31 offset:3328
s_waitcnt lgkmcnt(0)
s_barrier
s_load_dwordx2 s[40:41], s[0:1], 40
s_mov_b32 s42, 5242880
s_mov_b32 s43, 0x20000
s_waitcnt lgkmcnt(0)
v_lshrrev_b32 v5, 5, v0
v_lshlrev_b32 v5, 13, v5
v_bfe_u32 v6, v0, 4, 1
v_lshl_add_u32 v5, v6, 7, v5
s_lshl_b32 s18, s32, 8
s_mul_i32 s19, s13, 1310720
s_add_u32 s18, s18, s19
buffer_load_dword v24, v5, s[40:43], s18 offen
s_add_u32 s18, s18, 262144
buffer_load_dword v25, v5, s[40:43], s18 offen
s_add_u32 s18, s18, 262144
buffer_load_dword v26, v5, s[40:43], s18 offen
s_add_u32 s18, s18, 262144
buffer_load_dword v27, v5, s[40:43], s18 offen
s_add_u32 s18, s18, 262144
buffer_load_dword v28, v5, s[40:43], s18 offen
s_add_u32 s18, s18, 262144
v_mov_b32 v32, s24
v_mov_b32 v33, s24
v_mov_b32 v34, s24
v_mov_b32 v35, s24
s_nop 1
v_mfma_f32_32x32x16_bf16 v[36:51], a[0:3], v[32:35], 0
v_mfma_f32_32x32x16_bf16 v[36:51], a[4:7], v[32:35], v[36:51]
v_mfma_f32_32x32x16_bf16 v[36:51], a[8:11], v[32:35], v[36:51]
v_mfma_f32_32x32x16_bf16 v[36:51], a[12:15], v[32:35], v[36:51]
v_mfma_f32_32x32x16_bf16 v[36:51], a[16:19], v[32:35], v[36:51]
v_mfma_f32_32x32x16_bf16 v[36:51], a[20:23], v[32:35], v[36:51]
v_mfma_f32_32x32x16_bf16 v[36:51], a[24:27], v[32:35], v[36:51]
v_mfma_f32_32x32x16_bf16 v[36:51], a[28:31], v[32:35], v[36:51]
v_mfma_f32_32x32x16_bf16 v[36:51], a[32:35], v[32:35], v[36:51]
v_mfma_f32_32x32x16_bf16 v[36:51], a[36:39], v[32:35], v[36:51]
v_mfma_f32_32x32x16_bf16 v[36:51], a[40:43], v[32:35], v[36:51]
v_mfma_f32_32x32x16_bf16 v[36:51], a[44:47], v[32:35], v[36:51]
v_mfma_f32_32x32x16_bf16 v[36:51], a[48:51], v[32:35], v[36:51]
v_mfma_f32_32x32x16_bf16 v[36:51], a[52:55], v[32:35], v[36:51]
v_mfma_f32_32x32x16_bf16 v[36:51], a[56:59], v[32:35], v[36:51]
v_mfma_f32_32x32x16_bf16 v[36:51], a[60:63], v[32:35], v[36:51]
v_mfma_f32_32x32x16_bf16 v[36:51], a[64:67], v[32:35], v[36:51]
v_mfma_f32_32x32x16_bf16 v[36:51], a[68:71], v[32:35], v[36:51]
v_mfma_f32_32x32x16_bf16 v[36:51], a[72:75], v[32:35], v[36:51]
v_mfma_f32_32x32x16_bf16 v[36:51], a[76:79], v[32:35], v[36:51]
v_mfma_f32_32x32x16_bf16 v[36:51], a[80:83], v[32:35], v[36:51]
v_mfma_f32_32x32x16_bf16 v[36:51], a[84:87], v[32:35], v[36:51]
v_mfma_f32_32x32x16_bf16 v[36:51], a[88:91], v[32:35], v[36:51]
v_mfma_f32_32x32x16_bf16 v[36:51], a[92:95], v[32:35], v[36:51]
v_mfma_f32_32x32x16_bf16 v[36:51], a[96:99], v[32:35], v[36:51]
v_mfma_f32_32x32x16_bf16 v[36:51], a[100:103], v[32:35], v[36:51]
v_mfma_f32_32x32x16_bf16 v[36:51], a[104:107], v[32:35], v[36:51]
v_mfma_f32_32x32x16_bf16 v[36:51], a[108:111], v[32:35], v[36:51]
v_mfma_f32_32x32x16_bf16 v[36:51], a[112:115], v[32:35], v[36:51]
v_mfma_f32_32x32x16_bf16 v[36:51], a[116:119], v[32:35], v[36:51]
v_mfma_f32_32x32x16_bf16 v[36:51], a[120:123], v[32:35], v[36:51]
v_mfma_f32_32x32x16_bf16 v[36:51], a[124:127], v[32:35], v[36:51]
v_mfma_f32_32x32x16_bf16 v[36:51], a[128:131], v[32:35], v[36:51]
v_mfma_f32_32x32x16_bf16 v[36:51], a[132:135], v[32:35], v[36:51]
v_mfma_f32_32x32x16_bf16 v[36:51], a[136:139], v[32:35], v[36:51]
v_mfma_f32_32x32x16_bf16 v[36:51], a[140:143], v[32:35], v[36:51]
v_mfma_f32_32x32x16_bf16 v[36:51], a[144:147], v[32:35], v[36:51]
v_mfma_f32_32x32x16_bf16 v[36:51], a[148:151], v[32:35], v[36:51]
v_mfma_f32_32x32x16_bf16 v[36:51], a[152:155], v[32:35], v[36:51]
v_mfma_f32_32x32x16_bf16 v[36:51], a[156:159], v[32:35], v[36:51]
s_nop 11
v_mov_b32 v8, v36
v_mov_b32 v9, v37
v_mov_b32 v10, v38
v_mov_b32 v11, v39
v_mov_b32 v12, v40
v_mov_b32 v13, v41
v_mov_b32 v14, v42
v_mov_b32 v15, v43
v_mov_b32 v16, v44
v_mov_b32 v17, v45
v_mov_b32 v18, v46
v_mov_b32 v19, v47
v_mov_b32 v20, v48
v_mov_b32 v21, v49
v_mov_b32 v22, v50
v_mov_b32 v23, v51
v_and_b32 v5, 0x70, v0
s_waitcnt vmcnt(4)
v_lshrrev_b32 v24, 8, v0
v_lshl_add_u32 v5, v24, 7, v5
v_bfe_u32 v24, v0, 7, 1
v_lshl_add_u32 v5, v24, 12, v5
s_lshr_b32 s34, s13, 1
s_lshl_b32 s34, s34, 13
s_and_b32 s18, s13, 1
s_lshl_b32 s18, s18, 10
s_add_u32 s34, s34, s18
s_lshl_b32 s18, s32, 14
s_add_u32 s34, s34, s18
v_bfe_u32 v6, v0, 7, 2
v_mul_u32_u24 v6, 10240, v6
v_bfe_u32 v24, v0, 5, 2
v_lshl_add_u32 v6, v24, 6, v6
v_lshrrev_b32 v24, 9, v0
v_lshl_add_u32 v6, v24, 5, v6
v_and_b32 v24, 16, v0
v_add_u32 v6, v24, v6
s_lshl_b32 s51, s32, 7
s_add_u32 s51, s51, 0
s_mul_i32 s52, s13, 2560
s_add_u32 s52, s52, 12582912
s_add_u32 s50, s34, 110100480
s_mov_b32 s39, 0
kvlay_7:
s_mul_i32 s26, s16, 6291456
s_add_u32 s26, s26, 88080384
s_add_u32 s26, s26, s31
s_mul_i32 s54, s16, 327680
s_add_u32 s54, s54, 163577856
s_mul_i32 s27, s16, 35651584
s_add_u32 s27, s27, 16777216
s_mul_i32 s18, s32, 0
s_add_u32 s27, s27, s18
s_add_u32 s27, s27, s34
s_lshl_b32 s29, s16, 1
s_add_u32 s29, s29, 1
s_mov_b32 s28, 0
s_mov_b32 s30, 0
s_cmp_lt_u32 s30, 64
s_cselect_b32 s53, s26, s6
s_cselect_b32 s36, s54, s6
s_mov_b32 s38, 1024
v_mov_b32 v7, v0
s_add_u32 s26, s26, 40960
s_add_u32 s54, s54, 5120
s_add_u32 s30, s30, 1
v_xor_b32 v1, 40960, v0
s_mov_b32 s25, s31
s_mov_b32 s35, 131072
s_cmp_lg_u32 s13, 0
s_cbranch_scc1 polld_16
s_waitcnt vmcnt(0)
v_lshrrev_b32 v28, 2, v0
v_min_u32 v28, 36, v28
s_mov_b32 s21, 8192
s_mov_b32 s17, 0
poll_15:
buffer_load_dword v24, v28, s[4:7], s21 offen offset:0 sc1
s_add_u32 s17, s17, 1
s_cmp_gt_u32 s17, 262144
s_cbranch_scc1 L_fail
s_waitcnt vmcnt(0)
v_cmp_gt_u32 vcc, s29, v24
s_cbranch_vccz polld_16
s_sleep 2
s_branch poll_15
polld_16:
s_barrier
s_add_u32 m0, s25, 2048
s_mov_b32 s20, s53
buffer_load_dwordx4 v7, s[4:7], s20 offen sc1 lds
s_add_u32 m0, s25, 3072
s_add_u32 s20, s20, s38
buffer_load_dwordx4 v7, s[4:7], s20 offen sc1 lds
s_add_u32 m0, s25, 4096
s_add_u32 s20, s20, s38
buffer_load_dwordx4 v7, s[4:7], s20 offen sc1 lds
s_add_u32 m0, s25, 5120
s_add_u32 s20, s20, s38
buffer_load_dwordx4 v7, s[4:7], s20 offen sc1 lds
s_add_u32 m0, s25, 6144
s_add_u32 s20, s20, s38
buffer_load_dwordx4 v7, s[4:7], s20 offen sc1 lds
s_add_u32 m0, s25, 7168
s_add_u32 s20, s20, s38
buffer_load_dwordx4 v7, s[4:7], s20 offen sc1 lds
s_add_u32 m0, s25, 8192
s_add_u32 s20, s20, s38
buffer_load_dwordx4 v7, s[4:7], s20 offen sc1 lds
s_add_u32 m0, s25, 9216
s_add_u32 s20, s20, s38
buffer_load_dwordx4 v7, s[4:7], s20 offen sc1 lds
s_add_u32 m0, s25, 10240
s_add_u32 s20, s20, s38
buffer_load_dwordx4 v7, s[4:7], s20 offen sc1 lds
s_add_u32 m0, s25, 11264
s_add_u32 s20, s20, s38
buffer_load_dwordx4 v7, s[4:7], s20 offen sc1 lds
s_add_u32 m0, s35, s37
s_add_u32 s20, s36, s37
buffer_load_dwordx4 v0, s[4:7], s20 offen sc1 lds
s_add_u32 m0, s35, 4096
s_add_u32 s20, s36, 4096
buffer_load_dwordx4 v0, s[4:7], s20 offen sc1 lds
s_waitcnt vmcnt(0)
kvx_8:
v_xor_b32 v1, 40960, v1
s_sub_u32 s25, s25, s31
s_xor_b32 s25, s25, 40960
s_add_u32 s25, s25, s31
s_xor_b32 s35, s35, 8192
s_cmp_eq_u32 s28, 1
s_cbranch_scc1 kv_10
s_cmp_eq_u32 s28, 30
s_cbranch_scc0 kv_11
s_add_u32 s29, s29, 1
kv_10:
s_waitcnt vmcnt(0)
s_barrier
v_mov_b32 v3, s23
s_mov_b64 exec, 1
buffer_store_dword v3, off, s[4:7], s22 sc1
s_mov_b64 exec, -1
s_mov_b32 s22, s6
s_cmp_lg_u32 s13, 0
s_cbranch_scc1 polld_18
v_min_u32 v28, 624, v0
s_mov_b32 s21, 8192
s_mov_b32 s17, 0
poll_17:
buffer_load_dwordx4 v[24:27], v28, s[4:7], s21 offen offset:0 sc1
s_add_u32 s17, s17, 1
s_cmp_gt_u32 s17, 262144
s_cbranch_scc1 L_fail
s_waitcnt vmcnt(0)
v_min3_u32 v24, v24, v25, v26
v_min_u32 v24, v24, v27
v_cmp_gt_u32 vcc, s29, v24
s_cbranch_vccz polld_18
s_sleep 2
s_branch poll_17
polld_18:
s_barrier
kv_11:
s_add_u32 s28, s28, 1
s_and_b32 s33, s28, 3
s_cmp_lt_u32 s28, 12
s_cselect_b32 s33, 1, s33
s_cmp_eq_u32 s33, 0
s_cbranch_scc1 kv_12
s_cmp_lt_u32 s30, 64
s_cselect_b32 s53, s26, s6
s_cselect_b32 s36, s54, s6
s_mov_b32 s38, 1024
v_mov_b32 v7, v0
s_add_u32 s26, s26, 40960
s_add_u32 s54, s54, 5120
s_add_u32 s30, s30, 1
kvn_9:
s_waitcnt vmcnt(3)
s_barrier
ds_read_b128 v[48:51], v1 offset:2048
s_add_u32 m0, s25, 2048
s_mov_b32 s20, s53
buffer_load_dwordx4 v7, s[4:7], s20 offen sc1 lds
ds_read_b128 v[52:55], v1 offset:3072
ds_read_b128 v[60:63], v1 offset:5120
ds_read_b128 v[56:59], v1 offset:4096
s_xor_b32 s18, s35, 8192
v_lshrrev_b32 v2, 2, v0
s_add_u32 m0, s25, 3072
s_add_u32 s20, s20, s38
buffer_load_dwordx4 v7, s[4:7], s20 offen sc1 lds
v_add_u32 v2, s18, v2
s_waitcnt lgkmcnt(3)
v_mfma_f32_32x32x16_bf16 v[32:47], a[0:3], v[48:51], 0
ds_read2st64_b32 v[78:79], v2 offset0:10 offset1:11
ds_read2st64_b32 v[76:77], v2 offset0:8 offset1:9
ds_read2st64_b32 v[72:73], v2 offset0:4 offset1:5
s_waitcnt lgkmcnt(5)
v_mfma_f32_32x32x16_bf16 v[32:47], a[4:7], v[52:55], v[32:47]
ds_read_b128 v[52:55], v1 offset:7168
ds_read_b128 v[48:51], v1 offset:6144
s_waitcnt lgkmcnt(5)
v_mfma_f32_32x32x16_bf16 v[32:47], a[8:11], v[56:59], v[32:47]
s_add_u32 m0, s25, 4096
s_add_u32 s20, s20, s38
buffer_load_dwordx4 v7, s[4:7], s20 offen sc1 lds
ds_read2st64_b32 v[84:85], v2 offset0:16 offset1:17
ds_read2st64_b32 v[64:65], v2 offset0:0 offset1:1
s_waitcnt lgkmcnt(5)
ds_read_b128 v[56:59], v1 offset:8192
v_mfma_f32_32x32x16_bf16 v[32:47], a[12:15], v[60:63], v[32:47]
ds_read2st64_b32 v[66:67], v2 offset0:2 offset1:3
ds_read2st64_b32 v[74:75], v2 offset0:6 offset1:7
ds_read_b128 v[60:63], v1 offset:9216
s_waitcnt lgkmcnt(7)
s_waitcnt lgkmcnt(6)
v_mfma_f32_32x32x16_bf16 v[32:47], a[16:19], v[48:51], v[32:47]
s_add_u32 m0, s25, 5120
s_add_u32 s20, s20, s38
buffer_load_dwordx4 v7, s[4:7], s20 offen sc1 lds
s_add_u32 m0, s25, 6144
s_add_u32 s20, s20, s38
buffer_load_dwordx4 v7, s[4:7], s20 offen sc1 lds
ds_read2st64_b32 v[86:87], v2 offset0:18 offset1:19
v_mfma_f32_32x32x16_bf16 v[32:47], a[20:23], v[52:55], v[32:47]
s_waitcnt lgkmcnt(3)
ds_read2st64_b32 v[82:83], v2 offset0:14 offset1:15
ds_read_b128 v[48:51], v1 offset:10240
s_waitcnt lgkmcnt(4)
v_mfma_f32_32x32x16_bf16 v[32:47], a[24:27], v[56:59], v[32:47]
ds_read_b128 v[56:59], v1 offset:12288
ds_read_b128 v[52:55], v1 offset:11264
ds_read2st64_b32 v[80:81], v2 offset0:12 offset1:13
s_waitcnt lgkmcnt(6)
v_mfma_f32_32x32x16_bf16 v[32:47], a[28:31], v[60:63], v[32:47]
s_waitcnt lgkmcnt(5)
ds_read_b128 v[60:63], v1 offset:13312
s_waitcnt lgkmcnt(4)
v_add_f32 v65, v65, v67
v_mfma_f32_32x32x16_bf16 v[32:47], a[32:35], v[48:51], v[32:47]
v_add_f32 v64, v64, v66
v_mov_b32 v3, s23
v_add_f32 v64, v64, v72
s_waitcnt lgkmcnt(2)
v_add_f32 v64, v64, v74
v_mfma_f32_32x32x16_bf16 v[32:47], a[36:39], v[52:55], v[32:47]
s_add_u32 m0, s25, 7168
s_add_u32 s20, s20, s38
buffer_load_dwordx4 v7, s[4:7], s20 offen sc1 lds
v_add_f32 v64, v64, v76
ds_read_b128 v[48:51], v1 offset:14336
v_mfma_f32_32x32x16_bf16 v[32:47], a[40:43], v[56:59], v[32:47]
s_waitcnt lgkmcnt(1)
ds_read_b128 v[56:59], v1 offset:16384
ds_read_b128 v[52:55], v1 offset:15360
v_mfma_f32_32x32x16_bf16 v[32:47], a[44:47], v[60:63], v[32:47]
v_add_f32 v65, v65, v73
s_waitcnt lgkmcnt(2)
v_mfma_f32_32x32x16_bf16 v[32:47], a[48:51], v[48:51], v[32:47]
s_add_u32 m0, s25, 8192
s_add_u32 s20, s20, s38
buffer_load_dwordx4 v7, s[4:7], s20 offen sc1 lds
ds_read_b128 v[60:63], v1 offset:17408
v_add_f32 v64, v64, v78
s_waitcnt lgkmcnt(1)
v_mfma_f32_32x32x16_bf16 v[32:47], a[52:55], v[52:55], v[32:47]
ds_read_b128 v[48:51], v1 offset:18432
ds_read_b128 v[52:55], v1 offset:19456
s_add_u32 m0, s25, 9216
s_add_u32 s20, s20, s38
buffer_load_dwordx4 v7, s[4:7], s20 offen sc1 lds
v_mfma_f32_32x32x16_bf16 v[32:47], a[56:59], v[56:59], v[32:47]
ds_read_b128 v[56:59], v1 offset:20480
s_add_u32 m0, s25, 10240
s_add_u32 s20, s20, s38
buffer_load_dwordx4 v7, s[4:7], s20 offen sc1 lds
s_waitcnt lgkmcnt(3)
v_mfma_f32_32x32x16_bf16 v[32:47], a[60:63], v[60:63], v[32:47]
ds_read_b128 v[60:63], v1 offset:21504
v_add_f32 v65, v65, v75
v_add_f32 v65, v65, v77
s_waitcnt lgkmcnt(3)
v_mfma_f32_32x32x16_bf16 v[32:47], a[64:67], v[48:51], v[32:47]
v_add_f32 v64, v64, v80
s_waitcnt lgkmcnt(2)
ds_read_b128 v[48:51], v1 offset:22528
v_mfma_f32_32x32x16_bf16 v[32:47], a[68:71], v[52:55], v[32:47]
ds_read_b128 v[52:55], v1 offset:23552
s_waitcnt lgkmcnt(3)
v_add_f32 v65, v65, v79
v_add_f32 v64, v64, v82
v_mfma_f32_32x32x16_bf16 v[32:47], a[72:75], v[56:59], v[32:47]
s_waitcnt lgkmcnt(2)
ds_read_b128 v[56:59], v1 offset:24576
v_add_f32 v65, v65, v81
v_add_f32 v64, v64, v84
v_mfma_f32_32x32x16_bf16 v[32:47], a[76:79], v[60:63], v[32:47]
v_add_f32 v65, v65, v83
ds_read_b128 v[60:63], v1 offset:25600
s_waitcnt lgkmcnt(3)
v_mfma_f32_32x32x16_bf16 v[32:47], a[80:83], v[48:51], v[32:47]
ds_read_b128 v[48:51], v1 offset:26624
v_add_f32 v65, v65, v85
s_waitcnt lgkmcnt(2)
v_add_f32 v64, v64, v86
v_mfma_f32_32x32x16_bf16 v[32:47], a[84:87], v[52:55], v[32:47]
s_add_u32 m0, s25, 11264
s_add_u32 s20, s20, s38
buffer_load_dwordx4 v7, s[4:7], s20 offen sc1 lds
s_waitcnt lgkmcnt(1)
ds_read_b128 v[52:55], v1 offset:27648
v_mfma_f32_32x32x16_bf16 v[32:47], a[88:91], v[56:59], v[32:47]
v_add_f32 v65, v65, v87
ds_read_b128 v[56:59], v1 offset:28672
v_add_f32 v64, v64, v65
v_mov_b32 v68, v64
v_mfma_f32_32x32x16_bf16 v[32:47], a[92:95], v[60:63], v[32:47]
s_waitcnt lgkmcnt(2)
s_add_u32 m0, s35, s37
s_add_u32 s20, s36, s37
buffer_load_dwordx4 v0, s[4:7], s20 offen sc1 lds
v_permlane32_swap_b32 v64, v68
v_mfma_f32_32x32x16_bf16 v[32:47], a[96:99], v[48:51], v[32:47]
ds_read_b128 v[48:51], v1 offset:30720
ds_read_b128 v[60:63], v1 offset:29696
s_waitcnt lgkmcnt(3)
v_mul_f32 v68, 0x3acccccd, v68
s_waitcnt lgkmcnt(2)
v_mul_f32 v64, 0x3acccccd, v64
v_mfma_f32_32x32x16_bf16 v[32:47], a[100:103], v[52:55], v[32:47]
s_add_u32 m0, s35, 4096
s_add_u32 s20, s36, 4096
buffer_load_dwordx4 v0, s[4:7], s20 offen sc1 lds
ds_read_b128 v[52:55], v1 offset:31744
v_mfma_f32_32x32x16_bf16 v[32:47], a[104:107], v[56:59], v[32:47]
ds_read_b128 v[56:59], v1 offset:32768
v_fma_f32 v68, -v64, v64, v68
s_waitcnt lgkmcnt(3)
v_max_f32 v68, 0, v68
s_waitcnt lgkmcnt(2)
v_add_f32 v68, 0x3727c5ac, v68
v_mfma_f32_32x32x16_bf16 v[32:47], a[108:111], v[60:63], v[32:47]
ds_read_b128 v[60:63], v1 offset:33792
v_mfma_f32_32x32x16_bf16 v[32:47], a[112:115], v[48:51], v[32:47]
s_waitcnt lgkmcnt(1)
ds_read_b128 v[48:51], v1 offset:34816
v_rsq_f32 v68, v68
v_mfma_f32_32x32x16_bf16 v[32:47], a[116:119], v[52:55], v[32:47]
ds_read_b128 v[52:55], v1 offset:35840
s_waitcnt lgkmcnt(2)
s_waitcnt vmcnt(12)
s_barrier
v_mfma_f32_32x32x16_bf16 v[32:47], a[120:123], v[56:59], v[32:47]
ds_read_b128 v[56:59], v1 offset:36864
s_waitcnt lgkmcnt(2)
s_mov_b64 exec, 1
buffer_store_dword v3, off, s[4:7], s22 sc1
s_mov_b64 exec, -1
v_mfma_f32_32x32x16_bf16 v[32:47], a[124:127], v[60:63], v[32:47]
ds_read_b128 v[60:63], v1 offset:37888
v_mfma_f32_32x32x16_bf16 v[32:47], a[128:131], v[48:51], v[32:47]
ds_read_b128 v[48:51], v1 offset:38912
s_waitcnt lgkmcnt(2)
v_mul_f32 v64, v68, v64
v_mul_f32 v83, v64, v19
v_mfma_f32_32x32x16_bf16 v[32:47], a[132:135], v[52:55], v[32:47]
s_waitcnt lgkmcnt(1)
v_mfma_f32_32x32x16_bf16 v[32:47], a[136:139], v[56:59], v[32:47]
v_mul_f32 v77, v64, v13
v_mul_f32 v86, v64, v22
ds_read_b128 v[52:55], v1 offset:39936
v_mfma_f32_32x32x16_bf16 v[32:47], a[140:143], v[60:63], v[32:47]
s_waitcnt lgkmcnt(1)
ds_read_b128 v[56:59], v1 offset:40960
v_mul_f32 v73, v64, v9
ds_read_b128 v[60:63], v1 offset:41984
v_mfma_f32_32x32x16_bf16 v[32:47], a[144:147], v[48:51], v[32:47]
v_mul_f32 v75, v64, v11
s_waitcnt lgkmcnt(2)
v_mul_f32 v84, v64, v20
v_mfma_f32_32x32x16_bf16 v[32:47], a[148:151], v[52:55], v[32:47]
v_mul_f32 v81, v64, v17
s_waitcnt lgkmcnt(1)
v_mfma_f32_32x32x16_bf16 v[32:47], a[152:155], v[56:59], v[32:47]
s_waitcnt lgkmcnt(0)
v_mul_f32 v87, v64, v23
v_mul_f32 v85, v64, v21
v_mul_f32 v80, v64, v16
v_mul_f32 v82, v64, v18
v_mul_f32 v74, v64, v10
v_mfma_f32_32x32x16_bf16 v[32:47], a[156:159], v[60:63], v[32:47]
s_nop 0
v_mul_f32 v79, v64, v15
s_nop 9
v_pk_fma_f32 v[34:35], v[34:35], v[68:69], v[74:75] op_sel_hi:[1,0,1] neg_lo:[0,0,1] neg_hi:[0,0,1]
v_pk_fma_f32 v[44:45], v[44:45], v[68:69], v[84:85] op_sel_hi:[1,0,1] neg_lo:[0,0,1] neg_hi:[0,0,1]
v_pk_fma_f32 v[40:41], v[40:41], v[68:69], v[80:81] op_sel_hi:[1,0,1] neg_lo:[0,0,1] neg_hi:[0,0,1]
v_mul_f32 v78, v64, v14
v_mul_f32 v72, v64, v8
v_cvt_pk_bf16_f32 v54, v44, v45
v_pk_fma_f32 v[42:43], v[42:43], v[68:69], v[82:83] op_sel_hi:[1,0,1] neg_lo:[0,0,1] neg_hi:[0,0,1]
v_mul_f32 v76, v64, v12
v_pk_fma_f32 v[32:33], v[32:33], v[68:69], v[72:73] op_sel_hi:[1,0,1] neg_lo:[0,0,1] neg_hi:[0,0,1]
v_pk_fma_f32 v[46:47], v[46:47], v[68:69], v[86:87] op_sel_hi:[1,0,1] neg_lo:[0,0,1] neg_hi:[0,0,1]
v_pk_fma_f32 v[38:39], v[38:39], v[68:69], v[78:79] op_sel_hi:[1,0,1] neg_lo:[0,0,1] neg_hi:[0,0,1]
v_cvt_pk_bf16_f32 v48, v32, v33
v_cvt_pk_bf16_f32 v55, v46, v47
v_cvt_pk_bf16_f32 v52, v40, v41
v_pk_fma_f32 v[36:37], v[36:37], v[68:69], v[76:77] op_sel_hi:[1,0,1] neg_lo:[0,0,1] neg_hi:[0,0,1]
v_cvt_pk_bf16_f32 v49, v34, v35
v_cvt_pk_bf16_f32 v53, v42, v43
v_cvt_pk_bf16_f32 v50, v36, v37
v_cvt_pk_bf16_f32 v51, v38, v39
buffer_store_dwordx4 v[48:51], v5, s[4:7], s27 offen offset:0 sc1
buffer_store_dwordx4 v[52:55], v5, s[4:7], s27 offen offset:512 sc1
s_lshl_b32 s18, s16, 6
s_add_u32 s18, s18, s28
s_add_u32 s27, s27, 524288
s_cmp_eq_u32 s13, 0
s_cselect_b32 s22, s51, s6
s_mov_b32 s23, s18
s_cmp_lg_u32 s33, 0
s_cbranch_scc1 kvx_8
kvm_13:
v_xor_b32 v1, 40960, v1
s_sub_u32 s25, s25, s31
s_xor_b32 s25, s25, 40960
s_add_u32 s25, s25, s31
s_xor_b32 s35, s35, 8192
s_cmp_lt_u32 s30, 64
s_cselect_b32 s53, s26, s6
s_cselect_b32 s36, s54, s6
s_mov_b32 s38, 1024
v_mov_b32 v7, v0
s_add_u32 s26, s26, 40960
s_add_u32 s54, s54, 5120
s_add_u32 s30, s30, 1
s_waitcnt vmcnt(3)
s_barrier
ds_read_b128 v[48:51], v1 offset:2048
s_add_u32 m0, s25, 2048
s_mov_b32 s20, s53
buffer_load_dwordx4 v7, s[4:7], s20 offen sc1 lds
ds_read_b128 v[52:55], v1 offset:3072
ds_read_b128 v[56:59], v1 offset:4096
s_add_u32 m0, s25, 3072
s_add_u32 s20, s20, s38
buffer_load_dwordx4 v7, s[4:7], s20 offen sc1 lds
s_waitcnt lgkmcnt(2)
v_mfma_f32_32x32x16_bf16 v[32:47], a[0:3], v[48:51], 0
ds_read_b128 v[60:63], v1 offset:5120
s_waitcnt lgkmcnt(2)
s_add_u32 m0, s25, 4096
s_add_u32 s20, s20, s38
buffer_load_dwordx4 v7, s[4:7], s20 offen sc1 lds
s_waitcnt lgkmcnt(1)
v_mfma_f32_32x32x16_bf16 v[32:47], a[4:7], v[52:55], v[32:47]
s_add_u32 m0, s25, 5120
s_add_u32 s20, s20, s38
buffer_load_dwordx4 v7, s[4:7], s20 offen sc1 lds
ds_read_b128 v[48:51], v1 offset:6144
ds_read_b128 v[52:55], v1 offset:7168
v_mfma_f32_32x32x16_bf16 v[32:47], a[8:11], v[56:59], v[32:47]
ds_read_b128 v[56:59], v1 offset:8192
s_waitcnt lgkmcnt(3)
v_mfma_f32_32x32x16_bf16 v[32:47], a[12:15], v[60:63], v[32:47]
s_waitcnt lgkmcnt(2)
v_mfma_f32_32x32x16_bf16 v[32:47], a[16:19], v[48:51], v[32:47]
ds_read_b128 v[60:63], v1 offset:9216
ds_read_b128 v[48:51], v1 offset:10240
s_waitcnt lgkmcnt(2)
v_mfma_f32_32x32x16_bf16 v[32:47], a[20:23], v[52:55], v[32:47]
v_mfma_f32_32x32x16_bf16 v[32:47], a[24:27], v[56:59], v[32:47]
ds_read_b128 v[56:59], v1 offset:12288
s_waitcnt lgkmcnt(2)
ds_read_b128 v[52:55], v1 offset:11264
v_mfma_f32_32x32x16_bf16 v[32:47], a[28:31], v[60:63], v[32:47]
s_waitcnt lgkmcnt(2)
s_add_u32 m0, s25, 6144
s_add_u32 s20, s20, s38
buffer_load_dwordx4 v7, s[4:7], s20 offen sc1 lds
ds_read_b128 v[60:63], v1 offset:13312
v_mfma_f32_32x32x16_bf16 v[32:47], a[32:35], v[48:51], v[32:47]
s_waitcnt lgkmcnt(2)
s_add_u32 m0, s25, 7168
s_add_u32 s20, s20, s38
buffer_load_dwordx4 v7, s[4:7], s20 offen sc1 lds
s_waitcnt lgkmcnt(1)
v_mfma_f32_32x32x16_bf16 v[32:47], a[36:39], v[52:55], v[32:47]
ds_read_b128 v[48:51], v1 offset:14336
s_add_u32 m0, s25, 8192
s_add_u32 s20, s20, s38
buffer_load_dwordx4 v7, s[4:7], s20 offen sc1 lds
s_waitcnt lgkmcnt(1)
ds_read_b128 v[52:55], v1 offset:15360
v_mfma_f32_32x32x16_bf16 v[32:47], a[40:43], v[56:59], v[32:47]
ds_read_b128 v[56:59], v1 offset:16384
v_mfma_f32_32x32x16_bf16 v[32:47], a[44:47], v[60:63], v[32:47]
s_waitcnt lgkmcnt(2)
ds_read_b128 v[60:63], v1 offset:17408
v_mfma_f32_32x32x16_bf16 v[32:47], a[48:51], v[48:51], v[32:47]
ds_read_b128 v[48:51], v1 offset:18432
s_waitcnt lgkmcnt(2)
v_mfma_f32_32x32x16_bf16 v[32:47], a[52:55], v[52:55], v[32:47]
ds_read_b128 v[52:55], v1 offset:19456
s_add_u32 m0, s25, 9216
s_add_u32 s20, s20, s38
buffer_load_dwordx4 v7, s[4:7], s20 offen sc1 lds
s_waitcnt lgkmcnt(2)
v_mfma_f32_32x32x16_bf16 v[32:47], a[56:59], v[56:59], v[32:47]
v_mfma_f32_32x32x16_bf16 v[32:47], a[60:63], v[60:63], v[32:47]
ds_read_b128 v[60:63], v1 offset:21504
ds_read_b128 v[56:59], v1 offset:20480
s_waitcnt lgkmcnt(3)
v_mov_b32 v3, s23
v_mfma_f32_32x32x16_bf16 v[32:47], a[64:67], v[48:51], v[32:47]
s_waitcnt lgkmcnt(2)
s_add_u32 m0, s25, 10240
s_add_u32 s20, s20, s38
buffer_load_dwordx4 v7, s[4:7], s20 offen sc1 lds
ds_read_b128 v[48:51], v1 offset:22528
v_mfma_f32_32x32x16_bf16 v[32:47], a[68:71], v[52:55], v[32:47]
ds_read_b128 v[52:55], v1 offset:23552
s_waitcnt lgkmcnt(2)
v_mfma_f32_32x32x16_bf16 v[32:47], a[72:75], v[56:59], v[32:47]
v_mfma_f32_32x32x16_bf16 v[32:47], a[76:79], v[60:63], v[32:47]
s_waitcnt lgkmcnt(0)
ds_read_b128 v[56:59], v1 offset:24576
v_mfma_f32_32x32x16_bf16 v[32:47], a[80:83], v[48:51], v[32:47]
ds_read_b128 v[60:63], v1 offset:25600
s_add_u32 m0, s25, 11264
s_add_u32 s20, s20, s38
buffer_load_dwordx4 v7, s[4:7], s20 offen sc1 lds
v_mfma_f32_32x32x16_bf16 v[32:47], a[84:87], v[52:55], v[32:47]
ds_read_b128 v[48:51], v1 offset:26624
s_waitcnt lgkmcnt(2)
ds_read_b128 v[52:55], v1 offset:27648
v_mfma_f32_32x32x16_bf16 v[32:47], a[88:91], v[56:59], v[32:47]
s_waitcnt lgkmcnt(2)
ds_read_b128 v[56:59], v1 offset:28672
s_add_u32 m0, s35, s37
s_add_u32 s20, s36, s37
buffer_load_dwordx4 v0, s[4:7], s20 offen sc1 lds
v_mfma_f32_32x32x16_bf16 v[32:47], a[92:95], v[60:63], v[32:47]
ds_read_b128 v[60:63], v1 offset:29696
s_waitcnt lgkmcnt(3)
v_mfma_f32_32x32x16_bf16 v[32:47], a[96:99], v[48:51], v[32:47]
s_waitcnt lgkmcnt(1)
ds_read_b128 v[48:51], v1 offset:30720
s_add_u32 m0, s35, 4096
s_add_u32 s20, s36, 4096
buffer_load_dwordx4 v0, s[4:7], s20 offen sc1 lds
v_mfma_f32_32x32x16_bf16 v[32:47], a[100:103], v[52:55], v[32:47]
ds_read_b128 v[52:55], v1 offset:31744
v_mfma_f32_32x32x16_bf16 v[32:47], a[104:107], v[56:59], v[32:47]
s_waitcnt lgkmcnt(2)
s_waitcnt lgkmcnt(1)
v_mfma_f32_32x32x16_bf16 v[32:47], a[108:111], v[60:63], v[32:47]
ds_read_b128 v[56:59], v1 offset:32768
ds_read_b128 v[60:63], v1 offset:33792
v_mfma_f32_32x32x16_bf16 v[32:47], a[112:115], v[48:51], v[32:47]
ds_read_b128 v[48:51], v1 offset:34816
s_waitcnt lgkmcnt(3)
v_mfma_f32_32x32x16_bf16 v[32:47], a[116:119], v[52:55], v[32:47]
s_waitcnt vmcnt(12)
s_barrier
ds_read_b128 v[52:55], v1 offset:35840
s_waitcnt lgkmcnt(3)
v_mfma_f32_32x32x16_bf16 v[32:47], a[120:123], v[56:59], v[32:47]
s_mov_b64 exec, 1
buffer_store_dword v3, off, s[4:7], s22 sc1
s_mov_b64 exec, -1
s_waitcnt lgkmcnt(1)
v_mfma_f32_32x32x16_bf16 v[32:47], a[124:127], v[60:63], v[32:47]
ds_read_b128 v[56:59], v1 offset:36864
s_waitcnt lgkmcnt(1)
ds_read_b128 v[60:63], v1 offset:37888
v_mfma_f32_32x32x16_bf16 v[32:47], a[128:131], v[48:51], v[32:47]
v_mfma_f32_32x32x16_bf16 v[32:47], a[132:135], v[52:55], v[32:47]
s_waitcnt lgkmcnt(1)
ds_read_b128 v[52:55], v1 offset:39936
ds_read_b128 v[48:51], v1 offset:38912
v_mfma_f32_32x32x16_bf16 v[32:47], a[136:139], v[56:59], v[32:47]
s_waitcnt lgkmcnt(2)
v_mfma_f32_32x32x16_bf16 v[32:47], a[140:143], v[60:63], v[32:47]
ds_read_b128 v[56:59], v1 offset:40960
ds_read_b128 v[60:63], v1 offset:41984
s_waitcnt lgkmcnt(2)
v_mfma_f32_32x32x16_bf16 v[32:47], a[144:147], v[48:51], v[32:47]
v_mfma_f32_32x32x16_bf16 v[32:47], a[148:151], v[52:55], v[32:47]
s_waitcnt lgkmcnt(1)
v_mfma_f32_32x32x16_bf16 v[32:47], a[152:155], v[56:59], v[32:47]
s_waitcnt lgkmcnt(0)
v_mfma_f32_32x32x16_bf16 v[32:47], a[156:159], v[60:63], v[32:47]
s_nop 11
v_cvt_pk_bf16_f32 v49, v34, v35
v_cvt_pk_bf16_f32 v48, v32, v33
v_cvt_pk_bf16_f32 v53, v42, v43
v_cvt_pk_bf16_f32 v51, v38, v39
v_cvt_pk_bf16_f32 v54, v44, v45
v_cvt_pk_bf16_f32 v50, v36, v37
v_cvt_pk_bf16_f32 v52, v40, v41
v_cvt_pk_bf16_f32 v55, v46, v47
buffer_store_dwordx4 v[48:51], v5, s[4:7], s50 offen offset:0 sc1
buffer_store_dwordx4 v[52:55], v5, s[4:7], s50 offen offset:512 sc1
s_add_u32 s39, s39, 1
s_add_u32 s50, s50, 524288
s_add_u32 s18, s51, 12288
s_cmp_eq_u32 s13, 0
s_cselect_b32 s22, s18, s6
s_mov_b32 s23, s39
s_cmp_lt_u32 s28, 64
s_cbranch_scc1 kvx_8
s_and_b32 s18, s39, 15
s_cbranch_scc0 kvt_14
s_waitcnt vmcnt(0)
s_barrier
v_mov_b32 v3, s23
s_mov_b64 exec, 1
buffer_store_dword v3, off, s[4:7], s22 sc1
s_mov_b64 exec, -1
s_mov_b32 s22, s6
s_lshl_b32 s18, s39, 2
s_add_u32 s18, s18, 4
s_cmp_lg_u32 s13, 0
s_cbranch_scc1 polld_20
v_lshrrev_b32 v28, 2, v0
v_min_u32 v28, 36, v28
s_mov_b32 s21, 4096
s_mov_b32 s17, 0
poll_19:
buffer_load_dword v24, v28, s[4:7], s21 offen offset:0 sc1
s_add_u32 s17, s17, 1
s_cmp_gt_u32 s17, 262144
s_cbranch_scc1 L_fail
s_waitcnt vmcnt(0)
v_cmp_gt_u32 vcc, s18, v24
s_cbranch_vccz polld_20
s_sleep 6
s_branch poll_19
polld_20:
s_barrier
s_mov_b32 s53, s52
s_mov_b32 s36, s6
s_mov_b32 s38, 256
v_mov_b32 v7, v6
s_add_u32 s52, s52, 40960
s_add_u32 m0, s25, 2048
s_mov_b32 s20, s53
buffer_load_dwordx4 v7, s[4:7], s20 offen sc1 lds
s_add_u32 m0, s25, 3072
s_add_u32 s20, s20, s38
buffer_load_dwordx4 v7, s[4:7], s20 offen sc1 lds
s_add_u32 m0, s25, 4096
s_add_u32 s20, s20, s38
buffer_load_dwordx4 v7, s[4:7], s20 offen sc1 lds
s_add_u32 m0, s25, 5120
s_add_u32 s20, s20, s38
buffer_load_dwordx4 v7, s[4:7], s20 offen sc1 lds
s_add_u32 m0, s25, 6144
s_add_u32 s20, s20, s38
buffer_load_dwordx4 v7, s[4:7], s20 offen sc1 lds
s_add_u32 m0, s25, 7168
s_add_u32 s20, s20, s38
buffer_load_dwordx4 v7, s[4:7], s20 offen sc1 lds
s_add_u32 m0, s25, 8192
s_add_u32 s20, s20, s38
buffer_load_dwordx4 v7, s[4:7], s20 offen sc1 lds
s_add_u32 m0, s25, 9216
s_add_u32 s20, s20, s38
buffer_load_dwordx4 v7, s[4:7], s20 offen sc1 lds
s_add_u32 m0, s25, 10240
s_add_u32 s20, s20, s38
buffer_load_dwordx4 v7, s[4:7], s20 offen sc1 lds
s_add_u32 m0, s25, 11264
s_add_u32 s20, s20, s38
buffer_load_dwordx4 v7, s[4:7], s20 offen sc1 lds
s_waitcnt vmcnt(0)
s_branch kvm_13
kv_12:
s_lshl_b32 s18, s39, 2
s_add_u32 s18, s18, 4
s_cmp_lg_u32 s13, 0
s_cbranch_scc1 polld_22
v_lshrrev_b32 v28, 2, v0
v_min_u32 v28, 36, v28
s_mov_b32 s21, 4096
s_mov_b32 s17, 0
poll_21:
buffer_load_dword v24, v28, s[4:7], s21 offen offset:0 sc1
s_add_u32 s17, s17, 1
s_cmp_gt_u32 s17, 262144
s_cbranch_scc1 L_fail
s_waitcnt vmcnt(0)
v_cmp_gt_u32 vcc, s18, v24
s_cbranch_vccz polld_22
s_sleep 6
s_branch poll_21
polld_22:
s_barrier
s_mov_b32 s53, s52
s_mov_b32 s36, s6
s_mov_b32 s38, 256
v_mov_b32 v7, v6
s_add_u32 s52, s52, 40960
s_branch kvn_9
kvt_14:
s_waitcnt vmcnt(0)
s_barrier
v_mov_b32 v3, s23
s_mov_b64 exec, 1
buffer_store_dword v3, off, s[4:7], s22 sc1
s_mov_b64 exec, -1
s_mov_b32 s22, s6
s_add_u32 s16, s16, 1
s_cmp_lt_u32 s16, 2
s_cbranch_scc1 kvlay_7
s_endpgm
roleV_5:
s_lshl_b32 s26, s32, 8
s_lshl_b32 s18, s13, 6
s_add_u32 s26, s26, s18
s_load_dwordx2 s[40:41], s[0:1], 56
s_mov_b32 s42, 5242880
s_mov_b32 s43, 0x20000
s_waitcnt lgkmcnt(0)
v_lshrrev_b32 v20, 6, v0
v_mul_u32_u24 v20, 8192, v20
v_and_b32 v21, 48, v0
v_add_u32 v18, v20, v21
v_bfe_u32 v20, v0, 6, 2
v_lshrrev_b32 v21, 9, v0
v_lshl_add_u32 v20, v21, 3, v20
v_lshlrev_b32 v19, 6, v20
v_and_b32 v20, 48, v0
v_add_u32 v19, v19, v20
v_bfe_u32 v20, v0, 8, 1
v_lshl_add_u32 v19, v20, 3, v19
s_mul_i32 s18, s13, 36864
v_add_u32 v19, s18, v19
s_barrier
s_add_u32 m0, s18, 0
s_add_u32 s19, s26, 0
buffer_load_dwordx4 v18, s[40:43], s19 offen lds
s_add_u32 m0, s18, 1024
s_add_u32 s19, s26, 131072
buffer_load_dwordx4 v18, s[40:43], s19 offen lds
s_add_u32 m0, s18, 2048
s_add_u32 s19, s26, 262144
buffer_load_dwordx4 v18, s[40:43], s19 offen lds
s_add_u32 m0, s18, 3072
s_add_u32 s19, s26, 393216
buffer_load_dwordx4 v18, s[40:43], s19 offen lds
s_add_u32 m0, s18, 4096
s_add_u32 s19, s26, 524288
buffer_load_dwordx4 v18, s[40:43], s19 offen lds
s_add_u32 m0, s18, 5120
s_add_u32 s19, s26, 655360
buffer_load_dwordx4 v18, s[40:43], s19 offen lds
s_add_u32 m0, s18, 6144
s_add_u32 s19, s26, 786432
buffer_load_dwordx4 v18, s[40:43], s19 offen lds
s_add_u32 m0, s18, 7168
s_add_u32 s19, s26, 917504
buffer_load_dwordx4 v18, s[40:43], s19 offen lds
s_add_u32 m0, s18, 8192
s_add_u32 s19, s26, 1048576
buffer_load_dwordx4 v18, s[40:43], s19 offen lds
s_add_u32 m0, s18, 9216
s_add_u32 s19, s26, 1179648
buffer_load_dwordx4 v18, s[40:43], s19 offen lds
s_add_u32 m0, s18, 10240
s_add_u32 s19, s26, 1310720
buffer_load_dwordx4 v18, s[40:43], s19 offen lds
s_add_u32 m0, s18, 11264
s_add_u32 s19, s26, 1441792
buffer_load_dwordx4 v18, s[40:43], s19 offen lds
s_add_u32 m0, s18, 12288
s_add_u32 s19, s26, 1572864
buffer_load_dwordx4 v18, s[40:43], s19 offen lds
s_add_u32 m0, s18, 13312
s_add_u32 s19, s26, 1703936
buffer_load_dwordx4 v18, s[40:43], s19 offen lds
s_add_u32 m0, s18, 14336
s_add_u32 s19, s26, 1835008
buffer_load_dwordx4 v18, s[40:43], s19 offen lds
s_add_u32 m0, s18, 15360
s_add_u32 s19, s26, 1966080
buffer_load_dwordx4 v18, s[40:43], s19 offen lds
s_add_u32 m0, s18, 16384
s_add_u32 s19, s26, 2097152
buffer_load_dwordx4 v18, s[40:43], s19 offen lds
s_add_u32 m0, s18, 17408
s_add_u32 s19, s26, 2228224
buffer_load_dwordx4 v18, s[40:43], s19 offen lds
s_add_u32 m0, s18, 18432
s_add_u32 s19, s26, 2359296
buffer_load_dwordx4 v18, s[40:43], s19 offen lds
s_add_u32 m0, s18, 19456
s_add_u32 s19, s26, 2490368
buffer_load_dwordx4 v18, s[40:43], s19 offen lds
s_add_u32 m0, s18, 20480
s_add_u32 s19, s26, 2621440
buffer_load_dwordx4 v18, s[40:43], s19 offen lds
s_add_u32 m0, s18, 21504
s_add_u32 s19, s26, 2752512
buffer_load_dwordx4 v18, s[40:43], s19 offen lds
s_add_u32 m0, s18, 22528
s_add_u32 s19, s26, 2883584
buffer_load_dwordx4 v18, s[40:43], s19 offen lds
s_add_u32 m0, s18, 23552
s_add_u32 s19, s26, 3014656
buffer_load_dwordx4 v18, s[40:43], s19 offen lds
s_add_u32 m0, s18, 24576
s_add_u32 s19, s26, 3145728
buffer_load_dwordx4 v18, s[40:43], s19 offen lds
s_add_u32 m0, s18, 25600
s_add_u32 s19, s26, 3276800
buffer_load_dwordx4 v18, s[40:43], s19 offen lds
s_add_u32 m0, s18, 26624
s_add_u32 s19, s26, 3407872
buffer_load_dwordx4 v18, s[40:43], s19 offen lds
s_add_u32 m0, s18, 27648
s_add_u32 s19, s26, 3538944
buffer_load_dwordx4 v18, s[40:43], s19 offen lds
s_add_u32 m0, s18, 28672
s_add_u32 s19, s26, 3670016
buffer_load_dwordx4 v18, s[40:43], s19 offen lds
s_add_u32 m0, s18, 29696
s_add_u32 s19, s26, 3801088
buffer_load_dwordx4 v18, s[40:43], s19 offen lds
s_add_u32 m0, s18, 30720
s_add_u32 s19, s26, 3932160
buffer_load_dwordx4 v18, s[40:43], s19 offen lds
s_add_u32 m0, s18, 31744
s_add_u32 s19, s26, 4063232
buffer_load_dwordx4 v18, s[40:43], s19 offen lds
s_add_u32 m0, s18, 32768
s_add_u32 s19, s26, 4194304
buffer_load_dwordx4 v18, s[40:43], s19 offen lds
s_add_u32 m0, s18, 33792
s_add_u32 s19, s26, 4325376
buffer_load_dwordx4 v18, s[40:43], s19 offen lds
s_add_u32 m0, s18, 34816
s_add_u32 s19, s26, 4456448
buffer_load_dwordx4 v18, s[40:43], s19 offen lds
s_add_u32 m0, s18, 35840
s_add_u32 s19, s26, 4587520
buffer_load_dwordx4 v18, s[40:43], s19 offen lds
s_waitcnt vmcnt(32)
ds_read_b64_tr_b16 a[0:1], v19 offset:0
ds_read_b64_tr_b16 a[2:3], v19 offset:256
ds_read_b64_tr_b16 a[4:5], v19 offset:1024
ds_read_b64_tr_b16 a[6:7], v19 offset:1280
ds_read_b64_tr_b16 a[8:9], v19 offset:2048
ds_read_b64_tr_b16 a[10:11], v19 offset:2304
ds_read_b64_tr_b16 a[12:13], v19 offset:3072
ds_read_b64_tr_b16 a[14:15], v19 offset:3328
s_waitcnt lgkmcnt(0)
s_add_u32 m0, s18, 0
s_add_u32 s19, s26, 4718592
buffer_load_dwordx4 v18, s[40:43], s19 offen lds
s_add_u32 m0, s18, 1024
s_add_u32 s19, s26, 4849664
buffer_load_dwordx4 v18, s[40:43], s19 offen lds
s_add_u32 m0, s18, 2048
s_add_u32 s19, s26, 4980736
buffer_load_dwordx4 v18, s[40:43], s19 offen lds
s_add_u32 m0, s18, 3072
s_add_u32 s19, s26, 5111808
buffer_load_dwordx4 v18, s[40:43], s19 offen lds
s_waitcnt vmcnt(32)
ds_read_b64_tr_b16 a[16:17], v19 offset:4096
ds_read_b64_tr_b16 a[18:19], v19 offset:4352
ds_read_b64_tr_b16 a[20:21], v19 offset:5120
ds_read_b64_tr_b16 a[22:23], v19 offset:5376
ds_read_b64_tr_b16 a[24:25], v19 offset:6144
ds_read_b64_tr_b16 a[26:27], v19 offset:6400
ds_read_b64_tr_b16 a[28:29], v19 offset:7168
ds_read_b64_tr_b16 a[30:31], v19 offset:7424
s_waitcnt vmcnt(28)
ds_read_b64_tr_b16 a[32:33], v19 offset:8192
ds_read_b64_tr_b16 a[34:35], v19 offset:8448
ds_read_b64_tr_b16 a[36:37], v19 offset:9216
ds_read_b64_tr_b16 a[38:39], v19 offset:9472
ds_read_b64_tr_b16 a[40:41], v19 offset:10240
ds_read_b64_tr_b16 a[42:43], v19 offset:10496
ds_read_b64_tr_b16 a[44:45], v19 offset:11264
ds_read_b64_tr_b16 a[46:47], v19 offset:11520
s_waitcnt vmcnt(24)
ds_read_b64_tr_b16 a[48:49], v19 offset:12288
ds_read_b64_tr_b16 a[50:51], v19 offset:12544
ds_read_b64_tr_b16 a[52:53], v19 offset:13312
ds_read_b64_tr_b16 a[54:55], v19 offset:13568
ds_read_b64_tr_b16 a[56:57], v19 offset:14336
ds_read_b64_tr_b16 a[58:59], v19 offset:14592
ds_read_b64_tr_b16 a[60:61], v19 offset:15360
ds_read_b64_tr_b16 a[62:63], v19 offset:15616
s_waitcnt vmcnt(20)
ds_read_b64_tr_b16 a[64:65], v19 offset:16384
ds_read_b64_tr_b16 a[66:67], v19 offset:16640
ds_read_b64_tr_b16 a[68:69], v19 offset:17408
ds_read_b64_tr_b16 a[70:71], v19 offset:17664
ds_read_b64_tr_b16 a[72:73], v19 offset:18432
ds_read_b64_tr_b16 a[74:75], v19 offset:18688
ds_read_b64_tr_b16 a[76:77], v19 offset:19456
ds_read_b64_tr_b16 a[78:79], v19 offset:19712
s_waitcnt vmcnt(16)
ds_read_b64_tr_b16 a[80:81], v19 offset:20480
ds_read_b64_tr_b16 a[82:83], v19 offset:20736
ds_read_b64_tr_b16 a[84:85], v19 offset:21504
ds_read_b64_tr_b16 a[86:87], v19 offset:21760
ds_read_b64_tr_b16 a[88:89], v19 offset:22528
ds_read_b64_tr_b16 a[90:91], v19 offset:22784
ds_read_b64_tr_b16 a[92:93], v19 offset:23552
ds_read_b64_tr_b16 a[94:95], v19 offset:23808
s_waitcnt vmcnt(12)
ds_read_b64_tr_b16 a[96:97], v19 offset:24576
ds_read_b64_tr_b16 a[98:99], v19 offset:24832
ds_read_b64_tr_b16 a[100:101], v19 offset:25600
ds_read_b64_tr_b16 a[102:103], v19 offset:25856
ds_read_b64_tr_b16 a[104:105], v19 offset:26624
ds_read_b64_tr_b16 a[106:107], v19 offset:26880
ds_read_b64_tr_b16 a[108:109], v19 offset:27648
ds_read_b64_tr_b16 a[110:111], v19 offset:27904
s_waitcnt vmcnt(8)
ds_read_b64_tr_b16 a[112:113], v19 offset:28672
ds_read_b64_tr_b16 a[114:115], v19 offset:28928
ds_read_b64_tr_b16 a[116:117], v19 offset:29696
ds_read_b64_tr_b16 a[118:119], v19 offset:29952
ds_read_b64_tr_b16 a[120:121], v19 offset:30720
ds_read_b64_tr_b16 a[122:123], v19 offset:30976
ds_read_b64_tr_b16 a[124:125], v19 offset:31744
ds_read_b64_tr_b16 a[126:127], v19 offset:32000
s_waitcnt vmcnt(4)
ds_read_b64_tr_b16 a[128:129], v19 offset:32768
ds_read_b64_tr_b16 a[130:131], v19 offset:33024
ds_read_b64_tr_b16 a[132:133], v19 offset:33792
ds_read_b64_tr_b16 a[134:135], v19 offset:34048
ds_read_b64_tr_b16 a[136:137], v19 offset:34816
ds_read_b64_tr_b16 a[138:139], v19 offset:35072
ds_read_b64_tr_b16 a[140:141], v19 offset:35840
ds_read_b64_tr_b16 a[142:143], v19 offset:36096
s_waitcnt vmcnt(0)
ds_read_b64_tr_b16 a[144:145], v19 offset:0
ds_read_b64_tr_b16 a[146:147], v19 offset:256
ds_read_b64_tr_b16 a[148:149], v19 offset:1024
ds_read_b64_tr_b16 a[150:151], v19 offset:1280
ds_read_b64_tr_b16 a[152:153], v19 offset:2048
ds_read_b64_tr_b16 a[154:155], v19 offset:2304
ds_read_b64_tr_b16 a[156:157], v19 offset:3072
ds_read_b64_tr_b16 a[158:159], v19 offset:3328
s_waitcnt lgkmcnt(0)
s_barrier
s_load_dwordx2 s[40:41], s[0:1], 64
s_mov_b32 s42, 5242880
s_mov_b32 s43, 0x20000
s_waitcnt lgkmcnt(0)
v_lshlrev_b32 v6, 3, v0
s_mul_i32 s18, s32, 163840
s_mul_i32 s19, s13, 40960
s_add_u32 s18, s18, s19
buffer_load_dword v12, v6, s[40:43], s18 offen
s_add_u32 s18, s18, 8192
buffer_load_dword v13, v6, s[40:43], s18 offen
s_add_u32 s18, s18, 8192
buffer_load_dword v14, v6, s[40:43], s18 offen
s_add_u32 s18, s18, 8192
buffer_load_dword v15, v6, s[40:43], s18 offen
s_add_u32 s18, s18, 8192
buffer_load_dword v16, v6, s[40:43], s18 offen
s_add_u32 s18, s18, 8192
v_mov_b32 v20, s24
v_mov_b32 v21, s24
v_mov_b32 v22, s24
v_mov_b32 v23, s24
s_nop 1
v_mfma_f32_32x32x16_bf16 v[24:39], v[20:23], a[0:3], 0
v_mfma_f32_32x32x16_bf16 v[24:39], v[20:23], a[4:7], v[24:39]
v_mfma_f32_32x32x16_bf16 v[24:39], v[20:23], a[8:11], v[24:39]
v_mfma_f32_32x32x16_bf16 v[24:39], v[20:23], a[12:15], v[24:39]
v_mfma_f32_32x32x16_bf16 v[24:39], v[20:23], a[16:19], v[24:39]
v_mfma_f32_32x32x16_bf16 v[24:39], v[20:23], a[20:23], v[24:39]
v_mfma_f32_32x32x16_bf16 v[24:39], v[20:23], a[24:27], v[24:39]
v_mfma_f32_32x32x16_bf16 v[24:39], v[20:23], a[28:31], v[24:39]
v_mfma_f32_32x32x16_bf16 v[24:39], v[20:23], a[32:35], v[24:39]
v_mfma_f32_32x32x16_bf16 v[24:39], v[20:23], a[36:39], v[24:39]
v_mfma_f32_32x32x16_bf16 v[24:39], v[20:23], a[40:43], v[24:39]
v_mfma_f32_32x32x16_bf16 v[24:39], v[20:23], a[44:47], v[24:39]
v_mfma_f32_32x32x16_bf16 v[24:39], v[20:23], a[48:51], v[24:39]
v_mfma_f32_32x32x16_bf16 v[24:39], v[20:23], a[52:55], v[24:39]
v_mfma_f32_32x32x16_bf16 v[24:39], v[20:23], a[56:59], v[24:39]
v_mfma_f32_32x32x16_bf16 v[24:39], v[20:23], a[60:63], v[24:39]
v_mfma_f32_32x32x16_bf16 v[24:39], v[20:23], a[64:67], v[24:39]
v_mfma_f32_32x32x16_bf16 v[24:39], v[20:23], a[68:71], v[24:39]
v_mfma_f32_32x32x16_bf16 v[24:39], v[20:23], a[72:75], v[24:39]
v_mfma_f32_32x32x16_bf16 v[24:39], v[20:23], a[76:79], v[24:39]
v_mfma_f32_32x32x16_bf16 v[24:39], v[20:23], a[80:83], v[24:39]
v_mfma_f32_32x32x16_bf16 v[24:39], v[20:23], a[84:87], v[24:39]
v_mfma_f32_32x32x16_bf16 v[24:39], v[20:23], a[88:91], v[24:39]
v_mfma_f32_32x32x16_bf16 v[24:39], v[20:23], a[92:95], v[24:39]
v_mfma_f32_32x32x16_bf16 v[24:39], v[20:23], a[96:99], v[24:39]
v_mfma_f32_32x32x16_bf16 v[24:39], v[20:23], a[100:103], v[24:39]
v_mfma_f32_32x32x16_bf16 v[24:39], v[20:23], a[104:107], v[24:39]
v_mfma_f32_32x32x16_bf16 v[24:39], v[20:23], a[108:111], v[24:39]
v_mfma_f32_32x32x16_bf16 v[24:39], v[20:23], a[112:115], v[24:39]
v_mfma_f32_32x32x16_bf16 v[24:39], v[20:23], a[116:119], v[24:39]
v_mfma_f32_32x32x16_bf16 v[24:39], v[20:23], a[120:123], v[24:39]
v_mfma_f32_32x32x16_bf16 v[24:39], v[20:23], a[124:127], v[24:39]
v_mfma_f32_32x32x16_bf16 v[24:39], v[20:23], a[128:131], v[24:39]
v_mfma_f32_32x32x16_bf16 v[24:39], v[20:23], a[132:135], v[24:39]
v_mfma_f32_32x32x16_bf16 v[24:39], v[20:23], a[136:139], v[24:39]
v_mfma_f32_32x32x16_bf16 v[24:39], v[20:23], a[140:143], v[24:39]
v_mfma_f32_32x32x16_bf16 v[24:39], v[20:23], a[144:147], v[24:39]
v_mfma_f32_32x32x16_bf16 v[24:39], v[20:23], a[148:151], v[24:39]
v_mfma_f32_32x32x16_bf16 v[24:39], v[20:23], a[152:155], v[24:39]
v_mfma_f32_32x32x16_bf16 v[24:39], v[20:23], a[156:159], v[24:39]
s_nop 11
v_mov_b32 v5, v24
v_and_b32 v6, 0xf0, v0
s_waitcnt vmcnt(4)
v_bfe_u32 v12, v0, 8, 1
v_lshl_add_u32 v6, v12, 10, v6
v_lshrrev_b32 v12, 9, v0
v_lshl_add_u32 v6, v12, 8, v6
s_lshl_b32 s34, s13, 12
s_add_u32 s34, s34, 2048
s_lshl_b32 s18, s32, 14
s_add_u32 s34, s34, s18
v_bfe_u32 v7, v0, 7, 2
v_mul_u32_u24 v7, 10240, v7
v_bfe_u32 v12, v0, 5, 2
v_lshl_add_u32 v7, v12, 6, v7
v_lshrrev_b32 v12, 9, v0
v_lshl_add_u32 v7, v12, 5, v7
v_and_b32 v12, 16, v0
v_add_u32 v7, v12, v7
s_lshl_b32 s51, s32, 7
s_add_u32 s51, s51, 4
s_mul_i32 s52, s13, 2560
s_add_u32 s52, s52, 12582912
s_add_u32 s50, s34, 110100480
s_mov_b32 s39, 0
kvlay_23:
s_mul_i32 s26, s16, 6291456
s_add_u32 s26, s26, 88080384
s_add_u32 s26, s26, s31
s_mul_i32 s54, s16, 327680
s_add_u32 s54, s54, 163577856
s_mul_i32 s27, s16, 35651584
s_add_u32 s27, s27, 16777216
s_mul_i32 s18, s32, 0
s_add_u32 s27, s27, s18
s_add_u32 s27, s27, s34
s_lshl_b32 s29, s16, 1
s_add_u32 s29, s29, 1
s_mov_b32 s28, 0
s_mov_b32 s30, 0
s_cmp_lt_u32 s30, 64
s_cselect_b32 s53, s26, s6
s_cselect_b32 s36, s54, s6
s_mov_b32 s38, 1024
v_mov_b32 v8, v0
s_add_u32 s26, s26, 40960
s_add_u32 s54, s54, 5120
s_add_u32 s30, s30, 1
v_xor_b32 v1, 40960, v0
s_mov_b32 s25, s31
s_mov_b32 s35, 131072
s_cmp_lg_u32 s13, 0
s_cbranch_scc1 polld_32
s_waitcnt vmcnt(0)
v_lshrrev_b32 v16, 2, v0
v_min_u32 v16, 36, v16
s_mov_b32 s21, 8192
s_mov_b32 s17, 0
poll_31:
buffer_load_dword v12, v16, s[4:7], s21 offen offset:0 sc1
s_add_u32 s17, s17, 1
s_cmp_gt_u32 s17, 262144
s_cbranch_scc1 L_fail
s_waitcnt vmcnt(0)
v_cmp_gt_u32 vcc, s29, v12
s_cbranch_vccz polld_32
s_sleep 2
s_branch poll_31
polld_32:
s_barrier
s_add_u32 m0, s25, 2048
s_mov_b32 s20, s53
buffer_load_dwordx4 v8, s[4:7], s20 offen sc1 lds
s_add_u32 m0, s25, 3072
s_add_u32 s20, s20, s38
buffer_load_dwordx4 v8, s[4:7], s20 offen sc1 lds
s_add_u32 m0, s25, 4096
s_add_u32 s20, s20, s38
buffer_load_dwordx4 v8, s[4:7], s20 offen sc1 lds
s_add_u32 m0, s25, 5120
s_add_u32 s20, s20, s38
buffer_load_dwordx4 v8, s[4:7], s20 offen sc1 lds
s_add_u32 m0, s25, 6144
s_add_u32 s20, s20, s38
buffer_load_dwordx4 v8, s[4:7], s20 offen sc1 lds
s_add_u32 m0, s25, 7168
s_add_u32 s20, s20, s38
buffer_load_dwordx4 v8, s[4:7], s20 offen sc1 lds
s_add_u32 m0, s25, 8192
s_add_u32 s20, s20, s38
buffer_load_dwordx4 v8, s[4:7], s20 offen sc1 lds
s_add_u32 m0, s25, 9216
s_add_u32 s20, s20, s38
buffer_load_dwordx4 v8, s[4:7], s20 offen sc1 lds
s_add_u32 m0, s25, 10240
s_add_u32 s20, s20, s38
buffer_load_dwordx4 v8, s[4:7], s20 offen sc1 lds
s_add_u32 m0, s25, 11264
s_add_u32 s20, s20, s38
buffer_load_dwordx4 v8, s[4:7], s20 offen sc1 lds
s_add_u32 m0, s35, s37
s_add_u32 s20, s36, s37
buffer_load_dwordx4 v0, s[4:7], s20 offen sc1 lds
s_add_u32 m0, s35, 4096
s_add_u32 s20, s36, 4096
buffer_load_dwordx4 v0, s[4:7], s20 offen sc1 lds
s_waitcnt vmcnt(0)
kvx_24:
v_xor_b32 v1, 40960, v1
s_sub_u32 s25, s25, s31
s_xor_b32 s25, s25, 40960
s_add_u32 s25, s25, s31
s_xor_b32 s35, s35, 8192
s_cmp_eq_u32 s28, 1
s_cbranch_scc1 kv_26
s_cmp_eq_u32 s28, 30
s_cbranch_scc0 kv_27
s_add_u32 s29, s29, 1
kv_26:
s_waitcnt vmcnt(0)
s_barrier
v_mov_b32 v3, s23
s_mov_b64 exec, 1
buffer_store_dword v3, off, s[4:7], s22 sc1
s_mov_b64 exec, -1
s_mov_b32 s22, s6
s_cmp_lg_u32 s13, 0
s_cbranch_scc1 polld_34
v_min_u32 v16, 624, v0
s_mov_b32 s21, 8192
s_mov_b32 s17, 0
poll_33:
buffer_load_dwordx4 v[12:15], v16, s[4:7], s21 offen offset:0 sc1
s_add_u32 s17, s17, 1
s_cmp_gt_u32 s17, 262144
s_cbranch_scc1 L_fail
s_waitcnt vmcnt(0)
v_min3_u32 v12, v12, v13, v14
v_min_u32 v12, v12, v15
v_cmp_gt_u32 vcc, s29, v12
s_cbranch_vccz polld_34
s_sleep 2
s_branch poll_33
polld_34:
s_barrier
kv_27:
s_add_u32 s28, s28, 1
s_and_b32 s33, s28, 3
s_cmp_lt_u32 s28, 12
s_cselect_b32 s33, 1, s33
s_cmp_eq_u32 s33, 0
s_cbranch_scc1 kv_28
s_cmp_lt_u32 s30, 64
s_cselect_b32 s53, s26, s6
s_cselect_b32 s36, s54, s6
s_mov_b32 s38, 1024
v_mov_b32 v8, v0
s_add_u32 s26, s26, 40960
s_add_u32 s54, s54, 5120
s_add_u32 s30, s30, 1
kvn_25:
s_waitcnt vmcnt(3)
s_barrier
ds_read_b128 v[36:39], v1 offset:2048
s_add_u32 m0, s25, 2048
s_mov_b32 s20, s53
buffer_load_dwordx4 v8, s[4:7], s20 offen sc1 lds
ds_read_b128 v[40:43], v1 offset:3072
s_xor_b32 s18, s35, 8192
v_lshrrev_b32 v2, 2, v0
v_add_u32 v2, s18, v2
ds_read_b128 v[48:51], v1 offset:5120
s_add_u32 m0, s25, 3072
s_add_u32 s20, s20, s38
buffer_load_dwordx4 v8, s[4:7], s20 offen sc1 lds
ds_read_b128 v[44:47], v1 offset:4096
s_waitcnt lgkmcnt(3)
v_mfma_f32_32x32x16_bf16 v[20:35], v[36:39], a[0:3], 0
ds_read2st64_b32 v[62:63], v2 offset0:6 offset1:7
s_waitcnt lgkmcnt(3)
ds_read2st64_b32 v[72:73], v2 offset0:16 offset1:17
ds_read2st64_b32 v[74:75], v2 offset0:18 offset1:19
ds_read_b128 v[36:39], v1 offset:6144
v_mfma_f32_32x32x16_bf16 v[20:35], v[40:43], a[4:7], v[20:35]
s_add_u32 m0, s25, 4096
s_add_u32 s20, s20, s38
buffer_load_dwordx4 v8, s[4:7], s20 offen sc1 lds
ds_read2st64_b32 v[54:55], v2 offset0:2 offset1:3
s_waitcnt lgkmcnt(5)
ds_read2st64_b32 v[52:53], v2 offset0:0 offset1:1
v_mfma_f32_32x32x16_bf16 v[20:35], v[44:47], a[8:11], v[20:35]
ds_read_b128 v[40:43], v1 offset:7168
ds_read2st64_b32 v[60:61], v2 offset0:4 offset1:5
ds_read2st64_b32 v[66:67], v2 offset0:10 offset1:11
s_add_u32 m0, s25, 5120
s_add_u32 s20, s20, s38
buffer_load_dwordx4 v8, s[4:7], s20 offen sc1 lds
v_mfma_f32_32x32x16_bf16 v[20:35], v[48:51], a[12:15], v[20:35]
ds_read_b128 v[48:51], v1 offset:9216
s_waitcnt lgkmcnt(6)
ds_read_b128 v[44:47], v1 offset:8192
s_waitcnt lgkmcnt(5)
ds_read2st64_b32 v[70:71], v2 offset0:14 offset1:15
v_mfma_f32_32x32x16_bf16 v[20:35], v[36:39], a[16:19], v[20:35]
s_add_u32 m0, s25, 6144
s_add_u32 s20, s20, s38
buffer_load_dwordx4 v8, s[4:7], s20 offen sc1 lds
s_waitcnt lgkmcnt(3)
ds_read2st64_b32 v[68:69], v2 offset0:12 offset1:13
v_mfma_f32_32x32x16_bf16 v[20:35], v[40:43], a[20:23], v[20:35]
s_waitcnt lgkmcnt(3)
ds_read_b128 v[36:39], v1 offset:10240
s_waitcnt lgkmcnt(3)
ds_read_b128 v[40:43], v1 offset:11264
v_mfma_f32_32x32x16_bf16 v[20:35], v[44:47], a[24:27], v[20:35]
ds_read_b128 v[44:47], v1 offset:12288
v_add_f32 v52, v52, v54
ds_read2st64_b32 v[64:65], v2 offset0:8 offset1:9
v_mfma_f32_32x32x16_bf16 v[20:35], v[48:51], a[28:31], v[20:35]
s_add_u32 m0, s25, 7168
s_add_u32 s20, s20, s38
buffer_load_dwordx4 v8, s[4:7], s20 offen sc1 lds
v_add_f32 v53, v53, v55
v_add_f32 v52, v52, v60
s_waitcnt lgkmcnt(3)
v_mfma_f32_32x32x16_bf16 v[20:35], v[36:39], a[32:35], v[20:35]
ds_read_b128 v[48:51], v1 offset:13312
s_waitcnt lgkmcnt(3)
s_waitcnt lgkmcnt(2)
ds_read_b128 v[36:39], v1 offset:14336
v_mfma_f32_32x32x16_bf16 v[20:35], v[40:43], a[36:39], v[20:35]
ds_read_b128 v[40:43], v1 offset:15360
s_add_u32 m0, s25, 8192
s_add_u32 s20, s20, s38
buffer_load_dwordx4 v8, s[4:7], s20 offen sc1 lds
v_mfma_f32_32x32x16_bf16 v[20:35], v[44:47], a[40:43], v[20:35]
s_add_u32 m0, s25, 9216
s_add_u32 s20, s20, s38
buffer_load_dwordx4 v8, s[4:7], s20 offen sc1 lds
v_mov_b32 v3, s23
v_add_f32 v53, v53, v61
s_waitcnt lgkmcnt(1)
v_add_f32 v53, v53, v63
v_mfma_f32_32x32x16_bf16 v[20:35], v[48:51], a[44:47], v[20:35]
v_add_f32 v52, v52, v62
v_add_f32 v52, v52, v64
ds_read_b128 v[44:47], v1 offset:16384
v_add_f32 v53, v53, v65
v_mfma_f32_32x32x16_bf16 v[20:35], v[36:39], a[48:51], v[20:35]
s_waitcnt lgkmcnt(1)
ds_read_b128 v[48:51], v1 offset:17408
ds_read_b128 v[36:39], v1 offset:18432
v_bfe_u32 v54, v0, 5, 5
v_add_f32 v53, v53, v67
v_and_b32 v54, 16, v54
v_add_f32 v53, v53, v69
v_mfma_f32_32x32x16_bf16 v[20:35], v[40:43], a[52:55], v[20:35]
v_add_f32 v52, v52, v66
ds_read_b128 v[40:43], v1 offset:19456
s_waitcnt lgkmcnt(3)
v_mfma_f32_32x32x16_bf16 v[20:35], v[44:47], a[56:59], v[20:35]
s_waitcnt lgkmcnt(2)
v_add_f32 v52, v52, v68
s_add_u32 m0, s25, 10240
s_add_u32 s20, s20, s38
buffer_load_dwordx4 v8, s[4:7], s20 offen sc1 lds
v_mfma_f32_32x32x16_bf16 v[20:35], v[48:51], a[60:63], v[20:35]
ds_read_b128 v[44:47], v1 offset:20480
v_add_f32 v53, v53, v71
s_waitcnt lgkmcnt(2)
v_add_f32 v52, v52, v70
v_add_f32 v52, v52, v72
v_add_f32 v53, v53, v73
v_mfma_f32_32x32x16_bf16 v[20:35], v[36:39], a[64:67], v[20:35]
ds_read_b128 v[48:51], v1 offset:21504
v_add_f32 v52, v52, v74
s_waitcnt lgkmcnt(2)
v_mfma_f32_32x32x16_bf16 v[20:35], v[40:43], a[68:71], v[20:35]
ds_read_b128 v[40:43], v1 offset:23552
ds_read_b128 v[36:39], v1 offset:22528
v_add_f32 v53, v53, v75
s_waitcnt lgkmcnt(3)
v_add_f32 v52, v52, v53
v_mfma_f32_32x32x16_bf16 v[20:35], v[44:47], a[72:75], v[20:35]
v_mov_b32 v56, v52
s_nop 1
v_permlane32_swap_b32 v52, v56
s_waitcnt lgkmcnt(2)
v_mfma_f32_32x32x16_bf16 v[20:35], v[48:51], a[76:79], v[20:35]
ds_read_b128 v[44:47], v1 offset:24576
s_waitcnt lgkmcnt(1)
ds_read_b128 v[48:51], v1 offset:25600
v_mfma_f32_32x32x16_bf16 v[20:35], v[36:39], a[80:83], v[20:35]
ds_read_b128 v[36:39], v1 offset:26624
v_mul_f32 v52, 0x3acccccd, v52
v_lshrrev_b32 v53, 2, v0
v_mul_f32 v56, 0x3acccccd, v56
s_add_u32 m0, s25, 11264
s_add_u32 s20, s20, s38
buffer_load_dwordx4 v8, s[4:7], s20 offen sc1 lds
v_mfma_f32_32x32x16_bf16 v[20:35], v[40:43], a[84:87], v[20:35]
s_waitcnt lgkmcnt(2)
ds_read_b128 v[40:43], v1 offset:27648
v_fma_f32 v56, -v52, v52, v56
v_max_f32 v56, 0, v56
s_waitcnt lgkmcnt(2)
v_lshl_add_u32 v53, s13, 8, v53
v_add_f32 v56, 0x3727c5ac, v56
v_mfma_f32_32x32x16_bf16 v[20:35], v[44:47], a[88:91], v[20:35]
ds_read_b128 v[44:47], v1 offset:28672
s_add_u32 m0, s35, s37
s_add_u32 s20, s36, s37
buffer_load_dwordx4 v0, s[4:7], s20 offen sc1 lds
v_mfma_f32_32x32x16_bf16 v[20:35], v[48:51], a[92:95], v[20:35]
s_waitcnt lgkmcnt(2)
v_rsq_f32 v56, v56
ds_read_b128 v[48:51], v1 offset:29696
v_mul_f32 v52, v56, v52
v_mfma_f32_32x32x16_bf16 v[20:35], v[36:39], a[96:99], v[20:35]
ds_read_b128 v[36:39], v1 offset:30720
s_waitcnt lgkmcnt(3)
s_add_u32 m0, s35, 4096
s_add_u32 s20, s36, 4096
buffer_load_dwordx4 v0, s[4:7], s20 offen sc1 lds
v_mfma_f32_32x32x16_bf16 v[20:35], v[40:43], a[100:103], v[20:35]
ds_read_b128 v[40:43], v1 offset:31744
s_waitcnt lgkmcnt(3)
v_permlane32_swap_b32 v56, v52
v_lshl_add_u32 v54, s13, 8, v54
v_mfma_f32_32x32x16_bf16 v[20:35], v[44:47], a[104:107], v[20:35]
s_waitcnt lgkmcnt(1)
ds_read_b128 v[44:47], v1 offset:32768
ds_write_b32 v53, v56 offset:1024
ds_read_b128 v[80:83], v54 offset:1184
ds_read_b128 v[76:79], v54 offset:1152
v_mfma_f32_32x32x16_bf16 v[20:35], v[48:51], a[108:111], v[20:35]
v_mfma_f32_32x32x16_bf16 v[20:35], v[36:39], a[112:115], v[20:35]
s_waitcnt lgkmcnt(4)
ds_read_b128 v[48:51], v1 offset:33792
ds_read_b128 v[88:91], v54 offset:1248
ds_read_b128 v[36:39], v1 offset:34816
s_waitcnt lgkmcnt(6)
ds_read_b128 v[84:87], v54 offset:1216
v_mfma_f32_32x32x16_bf16 v[20:35], v[40:43], a[116:119], v[20:35]
s_waitcnt vmcnt(12)
s_barrier
s_mov_b64 exec, 1
buffer_store_dword v3, off, s[4:7], s22 sc1
s_mov_b64 exec, -1
v_mfma_f32_32x32x16_bf16 v[20:35], v[44:47], a[120:123], v[20:35]
ds_read_b128 v[40:43], v1 offset:35840
s_waitcnt lgkmcnt(4)
ds_read_b128 v[44:47], v1 offset:36864
v_mfma_f32_32x32x16_bf16 v[20:35], v[48:51], a[124:127], v[20:35]
ds_read_b128 v[48:51], v1 offset:37888
ds_read_b128 v[72:75], v54 offset:1120
s_waitcnt lgkmcnt(4)
v_mul_f32 v79, v79, v5
v_mul_f32 v86, v86, v5
v_mfma_f32_32x32x16_bf16 v[20:35], v[36:39], a[128:131], v[20:35]
s_waitcnt lgkmcnt(3)
v_mfma_f32_32x32x16_bf16 v[20:35], v[40:43], a[132:135], v[20:35]
v_mul_f32 v89, v89, v5
v_mul_f32 v90, v90, v5
s_waitcnt lgkmcnt(2)
s_waitcnt lgkmcnt(1)
ds_read_b128 v[36:39], v1 offset:38912
ds_read_b128 v[60:63], v54 offset:1024
v_mfma_f32_32x32x16_bf16 v[20:35], v[44:47], a[136:139], v[20:35]
ds_read_b128 v[40:43], v1 offset:39936
ds_read_b128 v[44:47], v1 offset:40960
ds_read_b128 v[64:67], v54 offset:1056
v_mul_f32 v87, v87, v5
v_mfma_f32_32x32x16_bf16 v[20:35], v[48:51], a[140:143], v[20:35]
ds_read_b128 v[48:51], v1 offset:41984
ds_read_b128 v[68:71], v54 offset:1088
s_waitcnt lgkmcnt(6)
v_mfma_f32_32x32x16_bf16 v[20:35], v[36:39], a[144:147], v[20:35]
s_waitcnt lgkmcnt(4)
v_mul_f32 v78, v78, v5
v_mfma_f32_32x32x16_bf16 v[20:35], v[40:43], a[148:151], v[20:35]
v_mul_f32 v76, v76, v5
v_mul_f32 v85, v85, v5
v_mul_f32 v91, v91, v5
v_mul_f32 v77, v77, v5
s_waitcnt lgkmcnt(3)
v_mul_f32 v84, v84, v5
v_mfma_f32_32x32x16_bf16 v[20:35], v[44:47], a[152:155], v[20:35]
s_waitcnt lgkmcnt(1)
v_mul_f32 v88, v88, v5
v_mul_f32 v80, v80, v5
v_mfma_f32_32x32x16_bf16 v[20:35], v[48:51], a[156:159], v[20:35]
s_waitcnt lgkmcnt(0)
v_mul_f32 v83, v83, v5
v_mul_f32 v82, v82, v5
v_mul_f32 v81, v81, v5
s_nop 7
v_pk_fma_f32 v[26:27], v[26:27], v[66:67], v[82:83] neg_lo:[0,0,1] neg_hi:[0,0,1]
v_pk_fma_f32 v[24:25], v[24:25], v[64:65], v[80:81] neg_lo:[0,0,1] neg_hi:[0,0,1]
v_pk_fma_f32 v[34:35], v[34:35], v[74:75], v[90:91] neg_lo:[0,0,1] neg_hi:[0,0,1]
v_pk_fma_f32 v[22:23], v[22:23], v[62:63], v[78:79] neg_lo:[0,0,1] neg_hi:[0,0,1]
v_cvt_pk_bf16_f32 v37, v22, v23
v_pk_fma_f32 v[30:31], v[30:31], v[70:71], v[86:87] neg_lo:[0,0,1] neg_hi:[0,0,1]
v_cvt_pk_bf16_f32 v39, v26, v27
v_pk_fma_f32 v[32:33], v[32:33], v[72:73], v[88:89] neg_lo:[0,0,1] neg_hi:[0,0,1]
v_pk_fma_f32 v[20:21], v[20:21], v[60:61], v[76:77] neg_lo:[0,0,1] neg_hi:[0,0,1]
v_pk_fma_f32 v[28:29], v[28:29], v[68:69], v[84:85] neg_lo:[0,0,1] neg_hi:[0,0,1]
v_cvt_pk_bf16_f32 v38, v24, v25
v_cvt_pk_bf16_f32 v42, v32, v33
v_cvt_pk_bf16_f32 v40, v28, v29
v_cvt_pk_bf16_f32 v41, v30, v31
v_cvt_pk_bf16_f32 v43, v34, v35
v_cvt_pk_bf16_f32 v36, v20, v21
buffer_store_dwordx4 v[36:39], v6, s[4:7], s27 offen offset:0 sc1
buffer_store_dwordx4 v[40:43], v6, s[4:7], s27 offen offset:512 sc1
s_lshl_b32 s18, s16, 6
s_add_u32 s18, s18, s28
s_add_u32 s27, s27, 524288
s_cmp_eq_u32 s13, 0
s_cselect_b32 s22, s51, s6
s_mov_b32 s23, s18
s_cmp_lg_u32 s33, 0
s_cbranch_scc1 kvx_24
kvm_29:
v_xor_b32 v1, 40960, v1
s_sub_u32 s25, s25, s31
s_xor_b32 s25, s25, 40960
s_add_u32 s25, s25, s31
s_xor_b32 s35, s35, 8192
s_cmp_lt_u32 s30, 64
s_cselect_b32 s53, s26, s6
s_cselect_b32 s36, s54, s6
s_mov_b32 s38, 1024
v_mov_b32 v8, v0
s_add_u32 s26, s26, 40960
s_add_u32 s54, s54, 5120
s_add_u32 s30, s30, 1
s_waitcnt vmcnt(3)
s_barrier
ds_read_b128 v[36:39], v1 offset:2048
s_add_u32 m0, s25, 2048
s_mov_b32 s20, s53
buffer_load_dwordx4 v8, s[4:7], s20 offen sc1 lds
ds_read_b128 v[40:43], v1 offset:3072
ds_read_b128 v[44:47], v1 offset:4096
s_add_u32 m0, s25, 3072
s_add_u32 s20, s20, s38
buffer_load_dwordx4 v8, s[4:7], s20 offen sc1 lds
s_waitcnt lgkmcnt(2)
v_mfma_f32_32x32x16_bf16 v[20:35], v[36:39], a[0:3], 0
ds_read_b128 v[48:51], v1 offset:5120
s_waitcnt lgkmcnt(2)
s_add_u32 m0, s25, 4096
s_add_u32 s20, s20, s38
buffer_load_dwordx4 v8, s[4:7], s20 offen sc1 lds
s_waitcnt lgkmcnt(1)
v_mfma_f32_32x32x16_bf16 v[20:35], v[40:43], a[4:7], v[20:35]
s_add_u32 m0, s25, 5120
s_add_u32 s20, s20, s38
buffer_load_dwordx4 v8, s[4:7], s20 offen sc1 lds
ds_read_b128 v[36:39], v1 offset:6144
ds_read_b128 v[40:43], v1 offset:7168
v_mfma_f32_32x32x16_bf16 v[20:35], v[44:47], a[8:11], v[20:35]
ds_read_b128 v[44:47], v1 offset:8192
s_waitcnt lgkmcnt(3)
v_mfma_f32_32x32x16_bf16 v[20:35], v[48:51], a[12:15], v[20:35]
s_waitcnt lgkmcnt(2)
v_mfma_f32_32x32x16_bf16 v[20:35], v[36:39], a[16:19], v[20:35]
ds_read_b128 v[48:51], v1 offset:9216
ds_read_b128 v[36:39], v1 offset:10240
s_waitcnt lgkmcnt(2)
v_mfma_f32_32x32x16_bf16 v[20:35], v[40:43], a[20:23], v[20:35]
v_mfma_f32_32x32x16_bf16 v[20:35], v[44:47], a[24:27], v[20:35]
ds_read_b128 v[44:47], v1 offset:12288
s_waitcnt lgkmcnt(2)
ds_read_b128 v[40:43], v1 offset:11264
v_mfma_f32_32x32x16_bf16 v[20:35], v[48:51], a[28:31], v[20:35]
s_waitcnt lgkmcnt(2)
s_add_u32 m0, s25, 6144
s_add_u32 s20, s20, s38
buffer_load_dwordx4 v8, s[4:7], s20 offen sc1 lds
ds_read_b128 v[48:51], v1 offset:13312
v_mfma_f32_32x32x16_bf16 v[20:35], v[36:39], a[32:35], v[20:35]
s_waitcnt lgkmcnt(2)
s_add_u32 m0, s25, 7168
s_add_u32 s20, s20, s38
buffer_load_dwordx4 v8, s[4:7], s20 offen sc1 lds
s_waitcnt lgkmcnt(1)
v_mfma_f32_32x32x16_bf16 v[20:35], v[40:43], a[36:39], v[20:35]
ds_read_b128 v[36:39], v1 offset:14336
s_add_u32 m0, s25, 8192
s_add_u32 s20, s20, s38
buffer_load_dwordx4 v8, s[4:7], s20 offen sc1 lds
s_waitcnt lgkmcnt(1)
ds_read_b128 v[40:43], v1 offset:15360
v_mfma_f32_32x32x16_bf16 v[20:35], v[44:47], a[40:43], v[20:35]
ds_read_b128 v[44:47], v1 offset:16384
v_mfma_f32_32x32x16_bf16 v[20:35], v[48:51], a[44:47], v[20:35]
s_waitcnt lgkmcnt(2)
ds_read_b128 v[48:51], v1 offset:17408
v_mfma_f32_32x32x16_bf16 v[20:35], v[36:39], a[48:51], v[20:35]
ds_read_b128 v[36:39], v1 offset:18432
s_waitcnt lgkmcnt(2)
v_mfma_f32_32x32x16_bf16 v[20:35], v[40:43], a[52:55], v[20:35]
ds_read_b128 v[40:43], v1 offset:19456
s_add_u32 m0, s25, 9216
s_add_u32 s20, s20, s38
buffer_load_dwordx4 v8, s[4:7], s20 offen sc1 lds
s_waitcnt lgkmcnt(2)
v_mfma_f32_32x32x16_bf16 v[20:35], v[44:47], a[56:59], v[20:35]
v_mfma_f32_32x32x16_bf16 v[20:35], v[48:51], a[60:63], v[20:35]
ds_read_b128 v[48:51], v1 offset:21504
ds_read_b128 v[44:47], v1 offset:20480
s_waitcnt lgkmcnt(3)
v_mov_b32 v3, s23
v_mfma_f32_32x32x16_bf16 v[20:35], v[36:39], a[64:67], v[20:35]
s_waitcnt lgkmcnt(2)
s_add_u32 m0, s25, 10240
s_add_u32 s20, s20, s38
buffer_load_dwordx4 v8, s[4:7], s20 offen sc1 lds
ds_read_b128 v[36:39], v1 offset:22528
v_mfma_f32_32x32x16_bf16 v[20:35], v[40:43], a[68:71], v[20:35]
ds_read_b128 v[40:43], v1 offset:23552
s_waitcnt lgkmcnt(2)
v_mfma_f32_32x32x16_bf16 v[20:35], v[44:47], a[72:75], v[20:35]
v_mfma_f32_32x32x16_bf16 v[20:35], v[48:51], a[76:79], v[20:35]
s_waitcnt lgkmcnt(0)
ds_read_b128 v[44:47], v1 offset:24576
v_mfma_f32_32x32x16_bf16 v[20:35], v[36:39], a[80:83], v[20:35]
ds_read_b128 v[48:51], v1 offset:25600
s_add_u32 m0, s25, 11264
s_add_u32 s20, s20, s38
buffer_load_dwordx4 v8, s[4:7], s20 offen sc1 lds
v_mfma_f32_32x32x16_bf16 v[20:35], v[40:43], a[84:87], v[20:35]
ds_read_b128 v[36:39], v1 offset:26624
s_waitcnt lgkmcnt(2)
ds_read_b128 v[40:43], v1 offset:27648
v_mfma_f32_32x32x16_bf16 v[20:35], v[44:47], a[88:91], v[20:35]
s_waitcnt lgkmcnt(2)
ds_read_b128 v[44:47], v1 offset:28672
s_add_u32 m0, s35, s37
s_add_u32 s20, s36, s37
buffer_load_dwordx4 v0, s[4:7], s20 offen sc1 lds
v_mfma_f32_32x32x16_bf16 v[20:35], v[48:51], a[92:95], v[20:35]
ds_read_b128 v[48:51], v1 offset:29696
s_waitcnt lgkmcnt(3)
v_mfma_f32_32x32x16_bf16 v[20:35], v[36:39], a[96:99], v[20:35]
s_waitcnt lgkmcnt(1)
ds_read_b128 v[36:39], v1 offset:30720
s_add_u32 m0, s35, 4096
s_add_u32 s20, s36, 4096
buffer_load_dwordx4 v0, s[4:7], s20 offen sc1 lds
v_mfma_f32_32x32x16_bf16 v[20:35], v[40:43], a[100:103], v[20:35]
ds_read_b128 v[40:43], v1 offset:31744
v_mfma_f32_32x32x16_bf16 v[20:35], v[44:47], a[104:107], v[20:35]
s_waitcnt lgkmcnt(2)
s_waitcnt lgkmcnt(1)
v_mfma_f32_32x32x16_bf16 v[20:35], v[48:51], a[108:111], v[20:35]
ds_read_b128 v[44:47], v1 offset:32768
ds_read_b128 v[48:51], v1 offset:33792
v_mfma_f32_32x32x16_bf16 v[20:35], v[36:39], a[112:115], v[20:35]
ds_read_b128 v[36:39], v1 offset:34816
s_waitcnt lgkmcnt(3)
v_mfma_f32_32x32x16_bf16 v[20:35], v[40:43], a[116:119], v[20:35]
s_waitcnt vmcnt(12)
s_barrier
ds_read_b128 v[40:43], v1 offset:35840
s_waitcnt lgkmcnt(3)
v_mfma_f32_32x32x16_bf16 v[20:35], v[44:47], a[120:123], v[20:35]
s_mov_b64 exec, 1
buffer_store_dword v3, off, s[4:7], s22 sc1
s_mov_b64 exec, -1
s_waitcnt lgkmcnt(1)
v_mfma_f32_32x32x16_bf16 v[20:35], v[48:51], a[124:127], v[20:35]
ds_read_b128 v[44:47], v1 offset:36864
s_waitcnt lgkmcnt(1)
ds_read_b128 v[48:51], v1 offset:37888
v_mfma_f32_32x32x16_bf16 v[20:35], v[36:39], a[128:131], v[20:35]
v_mfma_f32_32x32x16_bf16 v[20:35], v[40:43], a[132:135], v[20:35]
s_waitcnt lgkmcnt(1)
ds_read_b128 v[40:43], v1 offset:39936
ds_read_b128 v[36:39], v1 offset:38912
v_mfma_f32_32x32x16_bf16 v[20:35], v[44:47], a[136:139], v[20:35]
s_waitcnt lgkmcnt(2)
v_mfma_f32_32x32x16_bf16 v[20:35], v[48:51], a[140:143], v[20:35]
ds_read_b128 v[44:47], v1 offset:40960
ds_read_b128 v[48:51], v1 offset:41984
s_waitcnt lgkmcnt(2)
v_mfma_f32_32x32x16_bf16 v[20:35], v[36:39], a[144:147], v[20:35]
v_mfma_f32_32x32x16_bf16 v[20:35], v[40:43], a[148:151], v[20:35]
s_waitcnt lgkmcnt(1)
v_mfma_f32_32x32x16_bf16 v[20:35], v[44:47], a[152:155], v[20:35]
s_waitcnt lgkmcnt(0)
v_mfma_f32_32x32x16_bf16 v[20:35], v[48:51], a[156:159], v[20:35]
s_nop 11
v_cvt_pk_bf16_f32 v37, v22, v23
v_cvt_pk_bf16_f32 v36, v20, v21
v_cvt_pk_bf16_f32 v41, v30, v31
v_cvt_pk_bf16_f32 v39, v26, v27
v_cvt_pk_bf16_f32 v42, v32, v33
v_cvt_pk_bf16_f32 v38, v24, v25
v_cvt_pk_bf16_f32 v40, v28, v29
v_cvt_pk_bf16_f32 v43, v34, v35
buffer_store_dwordx4 v[36:39], v6, s[4:7], s50 offen offset:0 sc1
buffer_store_dwordx4 v[40:43], v6, s[4:7], s50 offen offset:512 sc1
s_add_u32 s39, s39, 1
s_add_u32 s50, s50, 524288
s_add_u32 s18, s51, 12288
s_cmp_eq_u32 s13, 0
s_cselect_b32 s22, s18, s6
s_mov_b32 s23, s39
s_cmp_lt_u32 s28, 64
s_cbranch_scc1 kvx_24
s_and_b32 s18, s39, 15
s_cbranch_scc0 kvt_30
s_waitcnt vmcnt(0)
s_barrier
v_mov_b32 v3, s23
s_mov_b64 exec, 1
buffer_store_dword v3, off, s[4:7], s22 sc1
s_mov_b64 exec, -1
s_mov_b32 s22, s6
s_lshl_b32 s18, s39, 2
s_add_u32 s18, s18, 4
s_cmp_lg_u32 s13, 0
s_cbranch_scc1 polld_36
v_lshrrev_b32 v16, 2, v0
v_min_u32 v16, 36, v16
s_mov_b32 s21, 4096
s_mov_b32 s17, 0
poll_35:
buffer_load_dword v12, v16, s[4:7], s21 offen offset:0 sc1
s_add_u32 s17, s17, 1
s_cmp_gt_u32 s17, 262144
s_cbranch_scc1 L_fail
s_waitcnt vmcnt(0)
v_cmp_gt_u32 vcc, s18, v12
s_cbranch_vccz polld_36
s_sleep 6
s_branch poll_35
polld_36:
s_barrier
s_mov_b32 s53, s52
s_mov_b32 s36, s6
s_mov_b32 s38, 256
v_mov_b32 v8, v7
s_add_u32 s52, s52, 40960
s_add_u32 m0, s25, 2048
s_mov_b32 s20, s53
buffer_load_dwordx4 v8, s[4:7], s20 offen sc1 lds
s_add_u32 m0, s25, 3072
s_add_u32 s20, s20, s38
buffer_load_dwordx4 v8, s[4:7], s20 offen sc1 lds
s_add_u32 m0, s25, 4096
s_add_u32 s20, s20, s38
buffer_load_dwordx4 v8, s[4:7], s20 offen sc1 lds
s_add_u32 m0, s25, 5120
s_add_u32 s20, s20, s38
buffer_load_dwordx4 v8, s[4:7], s20 offen sc1 lds
s_add_u32 m0, s25, 6144
s_add_u32 s20, s20, s38
buffer_load_dwordx4 v8, s[4:7], s20 offen sc1 lds
s_add_u32 m0, s25, 7168
s_add_u32 s20, s20, s38
buffer_load_dwordx4 v8, s[4:7], s20 offen sc1 lds
s_add_u32 m0, s25, 8192
s_add_u32 s20, s20, s38
buffer_load_dwordx4 v8, s[4:7], s20 offen sc1 lds
s_add_u32 m0, s25, 9216
s_add_u32 s20, s20, s38
buffer_load_dwordx4 v8, s[4:7], s20 offen sc1 lds
s_add_u32 m0, s25, 10240
s_add_u32 s20, s20, s38
buffer_load_dwordx4 v8, s[4:7], s20 offen sc1 lds
s_add_u32 m0, s25, 11264
s_add_u32 s20, s20, s38
buffer_load_dwordx4 v8, s[4:7], s20 offen sc1 lds
s_waitcnt vmcnt(0)
s_branch kvm_29
kv_28:
s_lshl_b32 s18, s39, 2
s_add_u32 s18, s18, 4
s_cmp_lg_u32 s13, 0
s_cbranch_scc1 polld_38
v_lshrrev_b32 v16, 2, v0
v_min_u32 v16, 36, v16
s_mov_b32 s21, 4096
s_mov_b32 s17, 0
poll_37:
buffer_load_dword v12, v16, s[4:7], s21 offen offset:0 sc1
s_add_u32 s17, s17, 1
s_cmp_gt_u32 s17, 262144
s_cbranch_scc1 L_fail
s_waitcnt vmcnt(0)
v_cmp_gt_u32 vcc, s18, v12
s_cbranch_vccz polld_38
s_sleep 6
s_branch poll_37
polld_38:
s_barrier
s_mov_b32 s53, s52
s_mov_b32 s36, s6
s_mov_b32 s38, 256
v_mov_b32 v8, v7
s_add_u32 s52, s52, 40960
s_branch kvn_25
kvt_30:
s_waitcnt vmcnt(0)
s_barrier
v_mov_b32 v3, s23
s_mov_b64 exec, 1
buffer_store_dword v3, off, s[4:7], s22 sc1
s_mov_b64 exec, -1
s_mov_b32 s22, s6
s_add_u32 s16, s16, 1
s_cmp_lt_u32 s16, 2
s_cbranch_scc1 kvlay_23
s_endpgm
roleA_6:
s_sub_u32 s39, s15, 64
s_mul_i32 s50, s39, 13108
s_lshr_b32 s50, s50, 16
s_mul_i32 s18, s50, 5
s_sub_u32 s34, s39, s18
v_bfe_u32 v5, v0, 4, 5
v_mul_u32_u24 v5, 1280, v5
v_lshrrev_b32 v8, 9, v0
v_lshl_add_u32 v5, v8, 4, v5
v_and_b32 v6, 0x1ff, v0
v_lshlrev_b32 v6, 1, v6
v_lshl_add_u32 v6, v8, 4, v6
s_load_dwordx2 s[44:45], s[0:1], 0
s_mov_b32 s46, 2621440
s_mov_b32 s47, 0x20000
s_waitcnt lgkmcnt(0)
s_load_dwordx2 s[40:41], s[0:1], 8
s_mov_b32 s42, 1314816
s_mov_b32 s43, 0x20000
s_waitcnt lgkmcnt(0)
s_load_dwordx2 s[52:53], s[0:1], 16
s_mov_b32 s54, 1314816
s_mov_b32 s55, 0x20000
s_waitcnt lgkmcnt(0)
v_lshrrev_b32 v8, 7, v0
v_lshl_add_u32 v8, s13, 3, v8
v_bfe_u32 v9, v8, 1, 3
v_lshlrev_b32 v9, 4, v9
v_xor_b32 v9, v9, v0
v_and_b32 v9, 0x70, v9
v_mul_u32_u24 v8, 1280, v8
v_add_u32 v8, v8, v9
s_mul_i32 s26, s50, 40960
s_lshl_b32 s25, s13, 10
s_add_u32 m0, s25, 2048
s_add_u32 s20, s26, 0
buffer_load_dwordx4 v8, s[44:47], s20 offen sc1 lds
s_add_u32 m0, s25, 6144
s_add_u32 s20, s26, 128
buffer_load_dwordx4 v8, s[44:47], s20 offen sc1 lds
s_add_u32 m0, s25, 10240
s_add_u32 s20, s26, 256
buffer_load_dwordx4 v8, s[44:47], s20 offen sc1 lds
s_add_u32 m0, s25, 14336
s_add_u32 s20, s26, 384
buffer_load_dwordx4 v8, s[44:47], s20 offen sc1 lds
s_add_u32 m0, s25, 18432
s_add_u32 s20, s26, 512
buffer_load_dwordx4 v8, s[44:47], s20 offen sc1 lds
s_add_u32 m0, s25, 22528
s_add_u32 s20, s26, 640
buffer_load_dwordx4 v8, s[44:47], s20 offen sc1 lds
s_add_u32 m0, s25, 26624
s_add_u32 s20, s26, 768
buffer_load_dwordx4 v8, s[44:47], s20 offen sc1 lds
s_add_u32 m0, s25, 30720
s_add_u32 s20, s26, 896
buffer_load_dwordx4 v8, s[44:47], s20 offen sc1 lds
s_add_u32 m0, s25, 34816
s_add_u32 s20, s26, 1024
buffer_load_dwordx4 v8, s[44:47], s20 offen sc1 lds
s_add_u32 m0, s25, 38912
s_add_u32 s20, s26, 1152
buffer_load_dwordx4 v8, s[44:47], s20 offen sc1 lds
s_add_u32 s26, s26, 1310720
s_add_u32 s25, s25, 40960
v_bfe_u32 v1, v0, 4, 4
v_and_b32 v9, 0x300, v0
v_add_u32 v1, v1, v9
v_lshl_add_u32 v1, s13, 4, v1
v_mul_u32_u24 v1, 642, v1
s_lshl_b32 s30, s39, 2
s_add_u32 s30, s30, 2
s_lshl_b32 s18, s13, 12
s_add_u32 s18, s18, 147456
s_waitcnt vmcnt(10)
v_add_u32 v4, s18, v0
v_bfe_u32 v176, v0, 5, 3
v_lshrrev_b32 v9, 9, v0
v_xor_b32 v176, v176, v9
v_lshlrev_b32 v176, 4, v176
v_and_b32 v9, 0x1f0, v0
v_lshl_add_u32 v176, v9, 3, v176
v_xor_b32 v177, 32, v176
v_xor_b32 v178, 64, v176
v_xor_b32 v179, 96, v176
s_lshl_b32 s18, s34, 7
s_lshl_b32 s19, s13, 5
s_add_u32 s18, s18, s19
s_mov_b32 s19, 0x3acccccd
v_bfe_u32 v202, v0, 4, 5
v_lshrrev_b32 v197, 9, v0
v_add_u32 v202, s18, v202
v_and_b32 v201, 1, v202
v_mul_u32_u24 v201, 160, v201
v_lshrrev_b32 v200, 1, v202
v_add_u32 v200, 1, v200
v_lshlrev_b32 v197, 3, v197
v_mad_u32_u24 v201, v197, v200, v201
v_mad_u32_u24 v196, v200, 16, 0
v_cvt_f32_u32 v196, v196
v_mul_f32 v202, s19, v196
v_rndne_f32 v202, v202
v_fmac_f32 v196, 0xc4200000, v202
v_mul_f32 v196, s19, v196
v_cos_f32 v196, v196
s_nop 0
v_add_f32 v196, v196, v196
v_mad_u32_u24 v198, v200, 1, 0
v_cvt_f32_u32 v198, v198
v_mul_f32 v202, s19, v198
v_rndne_f32 v202, v202
v_fmac_f32 v198, 0xc4200000, v202
v_mul_f32 v198, s19, v198
v_cos_f32 v198, v198
s_nop 0
v_add_f32 v198, v198, v198
v_mad_u32_u24 v183, v200, 3, v201
v_cvt_f32_u32 v183, v183
v_mul_f32 v202, s19, v183
v_rndne_f32 v202, v202
v_fmac_f32 v183, 0xc4200000, v202
v_mul_f32 v183, s19, v183
v_cos_f32 v183, v183
v_mad_u32_u24 v184, v200, 4, v201
v_cvt_f32_u32 v184, v184
v_mul_f32 v202, s19, v184
v_rndne_f32 v202, v202
v_fmac_f32 v184, 0xc4200000, v202
v_mul_f32 v184, s19, v184
v_cos_f32 v184, v184
s_nop 0
v_fma_f32 v185, v198, v184, -v183
v_fma_f32 v182, v198, v183, -v184
v_fma_f32 v186, v198, v185, -v184
v_fma_f32 v181, v198, v182, -v183
v_fma_f32 v187, v198, v186, -v185
v_fma_f32 v180, v198, v181, -v182
v_cvt_pk_bf16_f32 v16, v180, v181
v_cvt_pk_bf16_f32 v17, v182, v183
v_cvt_pk_bf16_f32 v18, v184, v185
v_cvt_pk_bf16_f32 v19, v186, v187
v_mad_u32_u24 v191, v200, 19, v201
v_cvt_f32_u32 v191, v191
v_mul_f32 v202, s19, v191
v_rndne_f32 v202, v202
v_fmac_f32 v191, 0xc4200000, v202
v_mul_f32 v191, s19, v191
v_cos_f32 v191, v191
v_mad_u32_u24 v192, v200, 20, v201
v_cvt_f32_u32 v192, v192
v_mul_f32 v202, s19, v192
v_rndne_f32 v202, v202
v_fmac_f32 v192, 0xc4200000, v202
v_mul_f32 v192, s19, v192
v_cos_f32 v192, v192
s_nop 0
v_fma_f32 v193, v198, v192, -v191
v_fma_f32 v190, v198, v191, -v192
v_fma_f32 v194, v198, v193, -v192
v_fma_f32 v189, v198, v190, -v191
v_fma_f32 v195, v198, v194, -v193
v_fma_f32 v188, v198, v189, -v190
v_cvt_pk_bf16_f32 v20, v188, v189
v_cvt_pk_bf16_f32 v21, v190, v191
v_cvt_pk_bf16_f32 v22, v192, v193
v_cvt_pk_bf16_f32 v23, v194, v195
v_pk_fma_f32 v[180:181], v[196:197], v[188:189], v[180:181] op_sel_hi:[0,1,1] neg_lo:[0,0,1] neg_hi:[0,0,1]
v_pk_fma_f32 v[182:183], v[196:197], v[190:191], v[182:183] op_sel_hi:[0,1,1] neg_lo:[0,0,1] neg_hi:[0,0,1]
v_pk_fma_f32 v[184:185], v[196:197], v[192:193], v[184:185] op_sel_hi:[0,1,1] neg_lo:[0,0,1] neg_hi:[0,0,1]
v_pk_fma_f32 v[186:187], v[196:197], v[194:195], v[186:187] op_sel_hi:[0,1,1] neg_lo:[0,0,1] neg_hi:[0,0,1]
v_cvt_pk_bf16_f32 v24, v180, v181
v_cvt_pk_bf16_f32 v25, v182, v183
v_cvt_pk_bf16_f32 v26, v184, v185
v_cvt_pk_bf16_f32 v27, v186, v187
v_pk_fma_f32 v[188:189], v[196:197], v[180:181], v[188:189] op_sel_hi:[0,1,1] neg_lo:[0,0,1] neg_hi:[0,0,1]
v_pk_fma_f32 v[190:191], v[196:197], v[182:183], v[190:191] op_sel_hi:[0,1,1] neg_lo:[0,0,1] neg_hi:[0,0,1]
v_pk_fma_f32 v[192:193], v[196:197], v[184:185], v[192:193] op_sel_hi:[0,1,1] neg_lo:[0,0,1] neg_hi:[0,0,1]
v_pk_fma_f32 v[194:195], v[196:197], v[186:187], v[194:195] op_sel_hi:[0,1,1] neg_lo:[0,0,1] neg_hi:[0,0,1]
v_cvt_pk_bf16_f32 v28, v188, v189
v_cvt_pk_bf16_f32 v29, v190, v191
v_cvt_pk_bf16_f32 v30, v192, v193
v_cvt_pk_bf16_f32 v31, v194, v195
v_pk_fma_f32 v[180:181], v[196:197], v[188:189], v[180:181] op_sel_hi:[0,1,1] neg_lo:[0,0,1] neg_hi:[0,0,1]
v_pk_fma_f32 v[182:183], v[196:197], v[190:191], v[182:183] op_sel_hi:[0,1,1] neg_lo:[0,0,1] neg_hi:[0,0,1]
v_pk_fma_f32 v[184:185], v[196:197], v[192:193], v[184:185] op_sel_hi:[0,1,1] neg_lo:[0,0,1] neg_hi:[0,0,1]
v_pk_fma_f32 v[186:187], v[196:197], v[194:195], v[186:187] op_sel_hi:[0,1,1] neg_lo:[0,0,1] neg_hi:[0,0,1]
v_cvt_pk_bf16_f32 v32, v180, v181
v_cvt_pk_bf16_f32 v33, v182, v183
v_cvt_pk_bf16_f32 v34, v184, v185
v_cvt_pk_bf16_f32 v35, v186, v187
v_pk_fma_f32 v[188:189], v[196:197], v[180:181], v[188:189] op_sel_hi:[0,1,1] neg_lo:[0,0,1] neg_hi:[0,0,1]
v_pk_fma_f32 v[190:191], v[196:197], v[182:183], v[190:191] op_sel_hi:[0,1,1] neg_lo:[0,0,1] neg_hi:[0,0,1]
v_pk_fma_f32 v[192:193], v[196:197], v[184:185], v[192:193] op_sel_hi:[0,1,1] neg_lo:[0,0,1] neg_hi:[0,0,1]
v_pk_fma_f32 v[194:195], v[196:197], v[186:187], v[194:195] op_sel_hi:[0,1,1] neg_lo:[0,0,1] neg_hi:[0,0,1]
v_cvt_pk_bf16_f32 v36, v188, v189
v_cvt_pk_bf16_f32 v37, v190, v191
v_cvt_pk_bf16_f32 v38, v192, v193
v_cvt_pk_bf16_f32 v39, v194, v195
v_pk_fma_f32 v[180:181], v[196:197], v[188:189], v[180:181] op_sel_hi:[0,1,1] neg_lo:[0,0,1] neg_hi:[0,0,1]
v_pk_fma_f32 v[182:183], v[196:197], v[190:191], v[182:183] op_sel_hi:[0,1,1] neg_lo:[0,0,1] neg_hi:[0,0,1]
v_pk_fma_f32 v[184:185], v[196:197], v[192:193], v[184:185] op_sel_hi:[0,1,1] neg_lo:[0,0,1] neg_hi:[0,0,1]
v_pk_fma_f32 v[186:187], v[196:197], v[194:195], v[186:187] op_sel_hi:[0,1,1] neg_lo:[0,0,1] neg_hi:[0,0,1]
v_cvt_pk_bf16_f32 v40, v180, v181
v_cvt_pk_bf16_f32 v41, v182, v183
v_cvt_pk_bf16_f32 v42, v184, v185
v_cvt_pk_bf16_f32 v43, v186, v187
v_pk_fma_f32 v[188:189], v[196:197], v[180:181], v[188:189] op_sel_hi:[0,1,1] neg_lo:[0,0,1] neg_hi:[0,0,1]
v_pk_fma_f32 v[190:191], v[196:197], v[182:183], v[190:191] op_sel_hi:[0,1,1] neg_lo:[0,0,1] neg_hi:[0,0,1]
v_pk_fma_f32 v[192:193], v[196:197], v[184:185], v[192:193] op_sel_hi:[0,1,1] neg_lo:[0,0,1] neg_hi:[0,0,1]
v_pk_fma_f32 v[194:195], v[196:197], v[186:187], v[194:195] op_sel_hi:[0,1,1] neg_lo:[0,0,1] neg_hi:[0,0,1]
v_cvt_pk_bf16_f32 v44, v188, v189
v_cvt_pk_bf16_f32 v45, v190, v191
v_cvt_pk_bf16_f32 v46, v192, v193
v_cvt_pk_bf16_f32 v47, v194, v195
v_pk_fma_f32 v[180:181], v[196:197], v[188:189], v[180:181] op_sel_hi:[0,1,1] neg_lo:[0,0,1] neg_hi:[0,0,1]
v_pk_fma_f32 v[182:183], v[196:197], v[190:191], v[182:183] op_sel_hi:[0,1,1] neg_lo:[0,0,1] neg_hi:[0,0,1]
v_pk_fma_f32 v[184:185], v[196:197], v[192:193], v[184:185] op_sel_hi:[0,1,1] neg_lo:[0,0,1] neg_hi:[0,0,1]
v_pk_fma_f32 v[186:187], v[196:197], v[194:195], v[186:187] op_sel_hi:[0,1,1] neg_lo:[0,0,1] neg_hi:[0,0,1]
v_cvt_pk_bf16_f32 v48, v180, v181
v_cvt_pk_bf16_f32 v49, v182, v183
v_cvt_pk_bf16_f32 v50, v184, v185
v_cvt_pk_bf16_f32 v51, v186, v187
v_pk_fma_f32 v[188:189], v[196:197], v[180:181], v[188:189] op_sel_hi:[0,1,1] neg_lo:[0,0,1] neg_hi:[0,0,1]
v_pk_fma_f32 v[190:191], v[196:197], v[182:183], v[190:191] op_sel_hi:[0,1,1] neg_lo:[0,0,1] neg_hi:[0,0,1]
v_pk_fma_f32 v[192:193], v[196:197], v[184:185], v[192:193] op_sel_hi:[0,1,1] neg_lo:[0,0,1] neg_hi:[0,0,1]
v_pk_fma_f32 v[194:195], v[196:197], v[186:187], v[194:195] op_sel_hi:[0,1,1] neg_lo:[0,0,1] neg_hi:[0,0,1]
v_cvt_pk_bf16_f32 v52, v188, v189
v_cvt_pk_bf16_f32 v53, v190, v191
v_cvt_pk_bf16_f32 v54, v192, v193
v_cvt_pk_bf16_f32 v55, v194, v195
v_pk_fma_f32 v[180:181], v[196:197], v[188:189], v[180:181] op_sel_hi:[0,1,1] neg_lo:[0,0,1] neg_hi:[0,0,1]
v_pk_fma_f32 v[182:183], v[196:197], v[190:191], v[182:183] op_sel_hi:[0,1,1] neg_lo:[0,0,1] neg_hi:[0,0,1]
v_pk_fma_f32 v[184:185], v[196:197], v[192:193], v[184:185] op_sel_hi:[0,1,1] neg_lo:[0,0,1] neg_hi:[0,0,1]
v_pk_fma_f32 v[186:187], v[196:197], v[194:195], v[186:187] op_sel_hi:[0,1,1] neg_lo:[0,0,1] neg_hi:[0,0,1]
v_cvt_pk_bf16_f32 v56, v180, v181
v_cvt_pk_bf16_f32 v57, v182, v183
v_cvt_pk_bf16_f32 v58, v184, v185
v_cvt_pk_bf16_f32 v59, v186, v187
s_add_u32 m0, s25, 2048
s_add_u32 s21, s26, 0
buffer_load_dwordx4 v8, s[44:47], s21 offen lds
v_pk_fma_f32 v[188:189], v[196:197], v[180:181], v[188:189] op_sel_hi:[0,1,1] neg_lo:[0,0,1] neg_hi:[0,0,1]
v_pk_fma_f32 v[190:191], v[196:197], v[182:183], v[190:191] op_sel_hi:[0,1,1] neg_lo:[0,0,1] neg_hi:[0,0,1]
v_pk_fma_f32 v[192:193], v[196:197], v[184:185], v[192:193] op_sel_hi:[0,1,1] neg_lo:[0,0,1] neg_hi:[0,0,1]
v_pk_fma_f32 v[194:195], v[196:197], v[186:187], v[194:195] op_sel_hi:[0,1,1] neg_lo:[0,0,1] neg_hi:[0,0,1]
v_cvt_pk_bf16_f32 v60, v188, v189
v_cvt_pk_bf16_f32 v61, v190, v191
v_cvt_pk_bf16_f32 v62, v192, v193
v_cvt_pk_bf16_f32 v63, v194, v195
s_add_u32 m0, s25, 6144
s_add_u32 s21, s26, 128
buffer_load_dwordx4 v8, s[44:47], s21 offen lds
v_pk_fma_f32 v[180:181], v[196:197], v[188:189], v[180:181] op_sel_hi:[0,1,1] neg_lo:[0,0,1] neg_hi:[0,0,1]
v_pk_fma_f32 v[182:183], v[196:197], v[190:191], v[182:183] op_sel_hi:[0,1,1] neg_lo:[0,0,1] neg_hi:[0,0,1]
v_pk_fma_f32 v[184:185], v[196:197], v[192:193], v[184:185] op_sel_hi:[0,1,1] neg_lo:[0,0,1] neg_hi:[0,0,1]
v_pk_fma_f32 v[186:187], v[196:197], v[194:195], v[186:187] op_sel_hi:[0,1,1] neg_lo:[0,0,1] neg_hi:[0,0,1]
v_cvt_pk_bf16_f32 v64, v180, v181
v_cvt_pk_bf16_f32 v65, v182, v183
v_cvt_pk_bf16_f32 v66, v184, v185
v_cvt_pk_bf16_f32 v67, v186, v187
s_add_u32 m0, s25, 10240
s_add_u32 s21, s26, 256
buffer_load_dwordx4 v8, s[44:47], s21 offen lds
v_pk_fma_f32 v[188:189], v[196:197], v[180:181], v[188:189] op_sel_hi:[0,1,1] neg_lo:[0,0,1] neg_hi:[0,0,1]
v_pk_fma_f32 v[190:191], v[196:197], v[182:183], v[190:191] op_sel_hi:[0,1,1] neg_lo:[0,0,1] neg_hi:[0,0,1]
v_pk_fma_f32 v[192:193], v[196:197], v[184:185], v[192:193] op_sel_hi:[0,1,1] neg_lo:[0,0,1] neg_hi:[0,0,1]
v_pk_fma_f32 v[194:195], v[196:197], v[186:187], v[194:195] op_sel_hi:[0,1,1] neg_lo:[0,0,1] neg_hi:[0,0,1]
v_cvt_pk_bf16_f32 v68, v188, v189
v_cvt_pk_bf16_f32 v69, v190, v191
v_cvt_pk_bf16_f32 v70, v192, v193
v_cvt_pk_bf16_f32 v71, v194, v195
s_add_u32 m0, s25, 14336
s_add_u32 s21, s26, 384
buffer_load_dwordx4 v8, s[44:47], s21 offen lds
v_pk_fma_f32 v[180:181], v[196:197], v[188:189], v[180:181] op_sel_hi:[0,1,1] neg_lo:[0,0,1] neg_hi:[0,0,1]
v_pk_fma_f32 v[182:183], v[196:197], v[190:191], v[182:183] op_sel_hi:[0,1,1] neg_lo:[0,0,1] neg_hi:[0,0,1]
v_pk_fma_f32 v[184:185], v[196:197], v[192:193], v[184:185] op_sel_hi:[0,1,1] neg_lo:[0,0,1] neg_hi:[0,0,1]
v_pk_fma_f32 v[186:187], v[196:197], v[194:195], v[186:187] op_sel_hi:[0,1,1] neg_lo:[0,0,1] neg_hi:[0,0,1]
v_cvt_pk_bf16_f32 v72, v180, v181
v_cvt_pk_bf16_f32 v73, v182, v183
v_cvt_pk_bf16_f32 v74, v184, v185
v_cvt_pk_bf16_f32 v75, v186, v187
s_add_u32 m0, s25, 18432
s_add_u32 s21, s26, 512
buffer_load_dwordx4 v8, s[44:47], s21 offen lds
v_pk_fma_f32 v[188:189], v[196:197], v[180:181], v[188:189] op_sel_hi:[0,1,1] neg_lo:[0,0,1] neg_hi:[0,0,1]
v_pk_fma_f32 v[190:191], v[196:197], v[182:183], v[190:191] op_sel_hi:[0,1,1] neg_lo:[0,0,1] neg_hi:[0,0,1]
v_pk_fma_f32 v[192:193], v[196:197], v[184:185], v[192:193] op_sel_hi:[0,1,1] neg_lo:[0,0,1] neg_hi:[0,0,1]
v_pk_fma_f32 v[194:195], v[196:197], v[186:187], v[194:195] op_sel_hi:[0,1,1] neg_lo:[0,0,1] neg_hi:[0,0,1]
v_cvt_pk_bf16_f32 v76, v188, v189
v_cvt_pk_bf16_f32 v77, v190, v191
v_cvt_pk_bf16_f32 v78, v192, v193
v_cvt_pk_bf16_f32 v79, v194, v195
s_add_u32 m0, s25, 22528
s_add_u32 s21, s26, 640
buffer_load_dwordx4 v8, s[44:47], s21 offen lds
v_pk_fma_f32 v[180:181], v[196:197], v[188:189], v[180:181] op_sel_hi:[0,1,1] neg_lo:[0,0,1] neg_hi:[0,0,1]
v_pk_fma_f32 v[182:183], v[196:197], v[190:191], v[182:183] op_sel_hi:[0,1,1] neg_lo:[0,0,1] neg_hi:[0,0,1]
v_pk_fma_f32 v[184:185], v[196:197], v[192:193], v[184:185] op_sel_hi:[0,1,1] neg_lo:[0,0,1] neg_hi:[0,0,1]
v_pk_fma_f32 v[186:187], v[196:197], v[194:195], v[186:187] op_sel_hi:[0,1,1] neg_lo:[0,0,1] neg_hi:[0,0,1]
v_cvt_pk_bf16_f32 v80, v180, v181
v_cvt_pk_bf16_f32 v81, v182, v183
v_cvt_pk_bf16_f32 v82, v184, v185
v_cvt_pk_bf16_f32 v83, v186, v187
s_add_u32 m0, s25, 26624
s_add_u32 s21, s26, 768
buffer_load_dwordx4 v8, s[44:47], s21 offen lds
v_pk_fma_f32 v[188:189], v[196:197], v[180:181], v[188:189] op_sel_hi:[0,1,1] neg_lo:[0,0,1] neg_hi:[0,0,1]
v_pk_fma_f32 v[190:191], v[196:197], v[182:183], v[190:191] op_sel_hi:[0,1,1] neg_lo:[0,0,1] neg_hi:[0,0,1]
v_pk_fma_f32 v[192:193], v[196:197], v[184:185], v[192:193] op_sel_hi:[0,1,1] neg_lo:[0,0,1] neg_hi:[0,0,1]
v_pk_fma_f32 v[194:195], v[196:197], v[186:187], v[194:195] op_sel_hi:[0,1,1] neg_lo:[0,0,1] neg_hi:[0,0,1]
v_cvt_pk_bf16_f32 v84, v188, v189
v_cvt_pk_bf16_f32 v85, v190, v191
v_cvt_pk_bf16_f32 v86, v192, v193
v_cvt_pk_bf16_f32 v87, v194, v195
s_add_u32 m0, s25, 30720
s_add_u32 s21, s26, 896
buffer_load_dwordx4 v8, s[44:47], s21 offen lds
v_pk_fma_f32 v[180:181], v[196:197], v[188:189], v[180:181] op_sel_hi:[0,1,1] neg_lo:[0,0,1] neg_hi:[0,0,1]
v_pk_fma_f32 v[182:183], v[196:197], v[190:191], v[182:183] op_sel_hi:[0,1,1] neg_lo:[0,0,1] neg_hi:[0,0,1]
v_pk_fma_f32 v[184:185], v[196:197], v[192:193], v[184:185] op_sel_hi:[0,1,1] neg_lo:[0,0,1] neg_hi:[0,0,1]
v_pk_fma_f32 v[186:187], v[196:197], v[194:195], v[186:187] op_sel_hi:[0,1,1] neg_lo:[0,0,1] neg_hi:[0,0,1]
v_cvt_pk_bf16_f32 v88, v180, v181
v_cvt_pk_bf16_f32 v89, v182, v183
v_cvt_pk_bf16_f32 v90, v184, v185
v_cvt_pk_bf16_f32 v91, v186, v187
s_add_u32 m0, s25, 34816
s_add_u32 s21, s26, 1024
buffer_load_dwordx4 v8, s[44:47], s21 offen lds
v_pk_fma_f32 v[188:189], v[196:197], v[180:181], v[188:189] op_sel_hi:[0,1,1] neg_lo:[0,0,1] neg_hi:[0,0,1]
v_pk_fma_f32 v[190:191], v[196:197], v[182:183], v[190:191] op_sel_hi:[0,1,1] neg_lo:[0,0,1] neg_hi:[0,0,1]
v_pk_fma_f32 v[192:193], v[196:197], v[184:185], v[192:193] op_sel_hi:[0,1,1] neg_lo:[0,0,1] neg_hi:[0,0,1]
v_pk_fma_f32 v[194:195], v[196:197], v[186:187], v[194:195] op_sel_hi:[0,1,1] neg_lo:[0,0,1] neg_hi:[0,0,1]
v_cvt_pk_bf16_f32 v92, v188, v189
v_cvt_pk_bf16_f32 v93, v190, v191
v_cvt_pk_bf16_f32 v94, v192, v193
v_cvt_pk_bf16_f32 v95, v194, v195
s_add_u32 m0, s25, 38912
s_add_u32 s21, s26, 1152
buffer_load_dwordx4 v8, s[44:47], s21 offen lds
s_mov_b32 s20, 323
v_mad_u32_u24 v183, v200, s20, v201
v_cvt_f32_u32 v183, v183
v_mul_f32 v202, s19, v183
v_rndne_f32 v202, v202
v_fmac_f32 v183, 0xc4200000, v202
v_mul_f32 v183, s19, v183
v_cos_f32 v183, v183
s_mov_b32 s20, 324
v_mad_u32_u24 v184, v200, s20, v201
v_cvt_f32_u32 v184, v184
v_mul_f32 v202, s19, v184
v_rndne_f32 v202, v202
v_fmac_f32 v184, 0xc4200000, v202
v_mul_f32 v184, s19, v184
v_cos_f32 v184, v184
s_nop 0
v_fma_f32 v185, v198, v184, -v183
v_fma_f32 v182, v198, v183, -v184
v_fma_f32 v186, v198, v185, -v184
v_fma_f32 v181, v198, v182, -v183
v_fma_f32 v187, v198, v186, -v185
v_fma_f32 v180, v198, v181, -v182
v_cvt_pk_bf16_f32 v96, v180, v181
v_cvt_pk_bf16_f32 v97, v182, v183
v_cvt_pk_bf16_f32 v98, v184, v185
v_cvt_pk_bf16_f32 v99, v186, v187
s_mov_b32 s20, 339
v_mad_u32_u24 v191, v200, s20, v201
v_cvt_f32_u32 v191, v191
v_mul_f32 v202, s19, v191
v_rndne_f32 v202, v202
v_fmac_f32 v191, 0xc4200000, v202
v_mul_f32 v191, s19, v191
v_cos_f32 v191, v191
s_mov_b32 s20, 340
v_mad_u32_u24 v192, v200, s20, v201
v_cvt_f32_u32 v192, v192
v_mul_f32 v202, s19, v192
v_rndne_f32 v202, v202
v_fmac_f32 v192, 0xc4200000, v202
v_mul_f32 v192, s19, v192
v_cos_f32 v192, v192
s_nop 0
v_fma_f32 v193, v198, v192, -v191
v_fma_f32 v190, v198, v191, -v192
v_fma_f32 v194, v198, v193, -v192
v_fma_f32 v189, v198, v190, -v191
v_fma_f32 v195, v198, v194, -v193
v_fma_f32 v188, v198, v189, -v190
v_cvt_pk_bf16_f32 v100, v188, v189
v_cvt_pk_bf16_f32 v101, v190, v191
v_cvt_pk_bf16_f32 v102, v192, v193
v_cvt_pk_bf16_f32 v103, v194, v195
v_pk_fma_f32 v[180:181], v[196:197], v[188:189], v[180:181] op_sel_hi:[0,1,1] neg_lo:[0,0,1] neg_hi:[0,0,1]
v_pk_fma_f32 v[182:183], v[196:197], v[190:191], v[182:183] op_sel_hi:[0,1,1] neg_lo:[0,0,1] neg_hi:[0,0,1]
v_pk_fma_f32 v[184:185], v[196:197], v[192:193], v[184:185] op_sel_hi:[0,1,1] neg_lo:[0,0,1] neg_hi:[0,0,1]
v_pk_fma_f32 v[186:187], v[196:197], v[194:195], v[186:187] op_sel_hi:[0,1,1] neg_lo:[0,0,1] neg_hi:[0,0,1]
v_cvt_pk_bf16_f32 v104, v180, v181
v_cvt_pk_bf16_f32 v105, v182, v183
v_cvt_pk_bf16_f32 v106, v184, v185
v_cvt_pk_bf16_f32 v107, v186, v187
v_pk_fma_f32 v[188:189], v[196:197], v[180:181], v[188:189] op_sel_hi:[0,1,1] neg_lo:[0,0,1] neg_hi:[0,0,1]
v_pk_fma_f32 v[190:191], v[196:197], v[182:183], v[190:191] op_sel_hi:[0,1,1] neg_lo:[0,0,1] neg_hi:[0,0,1]
v_pk_fma_f32 v[192:193], v[196:197], v[184:185], v[192:193] op_sel_hi:[0,1,1] neg_lo:[0,0,1] neg_hi:[0,0,1]
v_pk_fma_f32 v[194:195], v[196:197], v[186:187], v[194:195] op_sel_hi:[0,1,1] neg_lo:[0,0,1] neg_hi:[0,0,1]
v_cvt_pk_bf16_f32 v108, v188, v189
v_cvt_pk_bf16_f32 v109, v190, v191
v_cvt_pk_bf16_f32 v110, v192, v193
v_cvt_pk_bf16_f32 v111, v194, v195
v_pk_fma_f32 v[180:181], v[196:197], v[188:189], v[180:181] op_sel_hi:[0,1,1] neg_lo:[0,0,1] neg_hi:[0,0,1]
v_pk_fma_f32 v[182:183], v[196:197], v[190:191], v[182:183] op_sel_hi:[0,1,1] neg_lo:[0,0,1] neg_hi:[0,0,1]
v_pk_fma_f32 v[184:185], v[196:197], v[192:193], v[184:185] op_sel_hi:[0,1,1] neg_lo:[0,0,1] neg_hi:[0,0,1]
v_pk_fma_f32 v[186:187], v[196:197], v[194:195], v[186:187] op_sel_hi:[0,1,1] neg_lo:[0,0,1] neg_hi:[0,0,1]
v_cvt_pk_bf16_f32 v112, v180, v181
v_cvt_pk_bf16_f32 v113, v182, v183
v_cvt_pk_bf16_f32 v114, v184, v185
v_cvt_pk_bf16_f32 v115, v186, v187
v_pk_fma_f32 v[188:189], v[196:197], v[180:181], v[188:189] op_sel_hi:[0,1,1] neg_lo:[0,0,1] neg_hi:[0,0,1]
v_pk_fma_f32 v[190:191], v[196:197], v[182:183], v[190:191] op_sel_hi:[0,1,1] neg_lo:[0,0,1] neg_hi:[0,0,1]
v_pk_fma_f32 v[192:193], v[196:197], v[184:185], v[192:193] op_sel_hi:[0,1,1] neg_lo:[0,0,1] neg_hi:[0,0,1]
v_pk_fma_f32 v[194:195], v[196:197], v[186:187], v[194:195] op_sel_hi:[0,1,1] neg_lo:[0,0,1] neg_hi:[0,0,1]
v_cvt_pk_bf16_f32 v116, v188, v189
v_cvt_pk_bf16_f32 v117, v190, v191
v_cvt_pk_bf16_f32 v118, v192, v193
v_cvt_pk_bf16_f32 v119, v194, v195
v_pk_fma_f32 v[180:181], v[196:197], v[188:189], v[180:181] op_sel_hi:[0,1,1] neg_lo:[0,0,1] neg_hi:[0,0,1]
v_pk_fma_f32 v[182:183], v[196:197], v[190:191], v[182:183] op_sel_hi:[0,1,1] neg_lo:[0,0,1] neg_hi:[0,0,1]
v_pk_fma_f32 v[184:185], v[196:197], v[192:193], v[184:185] op_sel_hi:[0,1,1] neg_lo:[0,0,1] neg_hi:[0,0,1]
v_pk_fma_f32 v[186:187], v[196:197], v[194:195], v[186:187] op_sel_hi:[0,1,1] neg_lo:[0,0,1] neg_hi:[0,0,1]
v_cvt_pk_bf16_f32 v120, v180, v181
v_cvt_pk_bf16_f32 v121, v182, v183
v_cvt_pk_bf16_f32 v122, v184, v185
v_cvt_pk_bf16_f32 v123, v186, v187
v_pk_fma_f32 v[188:189], v[196:197], v[180:181], v[188:189] op_sel_hi:[0,1,1] neg_lo:[0,0,1] neg_hi:[0,0,1]
v_pk_fma_f32 v[190:191], v[196:197], v[182:183], v[190:191] op_sel_hi:[0,1,1] neg_lo:[0,0,1] neg_hi:[0,0,1]
v_pk_fma_f32 v[192:193], v[196:197], v[184:185], v[192:193] op_sel_hi:[0,1,1] neg_lo:[0,0,1] neg_hi:[0,0,1]
v_pk_fma_f32 v[194:195], v[196:197], v[186:187], v[194:195] op_sel_hi:[0,1,1] neg_lo:[0,0,1] neg_hi:[0,0,1]
v_cvt_pk_bf16_f32 v124, v188, v189
v_cvt_pk_bf16_f32 v125, v190, v191
v_cvt_pk_bf16_f32 v126, v192, v193
v_cvt_pk_bf16_f32 v127, v194, v195
v_pk_fma_f32 v[180:181], v[196:197], v[188:189], v[180:181] op_sel_hi:[0,1,1] neg_lo:[0,0,1] neg_hi:[0,0,1]
v_pk_fma_f32 v[182:183], v[196:197], v[190:191], v[182:183] op_sel_hi:[0,1,1] neg_lo:[0,0,1] neg_hi:[0,0,1]
v_pk_fma_f32 v[184:185], v[196:197], v[192:193], v[184:185] op_sel_hi:[0,1,1] neg_lo:[0,0,1] neg_hi:[0,0,1]
v_pk_fma_f32 v[186:187], v[196:197], v[194:195], v[186:187] op_sel_hi:[0,1,1] neg_lo:[0,0,1] neg_hi:[0,0,1]
v_cvt_pk_bf16_f32 v128, v180, v181
v_cvt_pk_bf16_f32 v129, v182, v183
v_cvt_pk_bf16_f32 v130, v184, v185
v_cvt_pk_bf16_f32 v131, v186, v187
v_pk_fma_f32 v[188:189], v[196:197], v[180:181], v[188:189] op_sel_hi:[0,1,1] neg_lo:[0,0,1] neg_hi:[0,0,1]
v_pk_fma_f32 v[190:191], v[196:197], v[182:183], v[190:191] op_sel_hi:[0,1,1] neg_lo:[0,0,1] neg_hi:[0,0,1]
v_pk_fma_f32 v[192:193], v[196:197], v[184:185], v[192:193] op_sel_hi:[0,1,1] neg_lo:[0,0,1] neg_hi:[0,0,1]
v_pk_fma_f32 v[194:195], v[196:197], v[186:187], v[194:195] op_sel_hi:[0,1,1] neg_lo:[0,0,1] neg_hi:[0,0,1]
v_cvt_pk_bf16_f32 v132, v188, v189
v_cvt_pk_bf16_f32 v133, v190, v191
v_cvt_pk_bf16_f32 v134, v192, v193
v_cvt_pk_bf16_f32 v135, v194, v195
v_pk_fma_f32 v[180:181], v[196:197], v[188:189], v[180:181] op_sel_hi:[0,1,1] neg_lo:[0,0,1] neg_hi:[0,0,1]
v_pk_fma_f32 v[182:183], v[196:197], v[190:191], v[182:183] op_sel_hi:[0,1,1] neg_lo:[0,0,1] neg_hi:[0,0,1]
v_pk_fma_f32 v[184:185], v[196:197], v[192:193], v[184:185] op_sel_hi:[0,1,1] neg_lo:[0,0,1] neg_hi:[0,0,1]
v_pk_fma_f32 v[186:187], v[196:197], v[194:195], v[186:187] op_sel_hi:[0,1,1] neg_lo:[0,0,1] neg_hi:[0,0,1]
v_cvt_pk_bf16_f32 v136, v180, v181
v_cvt_pk_bf16_f32 v137, v182, v183
v_cvt_pk_bf16_f32 v138, v184, v185
v_cvt_pk_bf16_f32 v139, v186, v187
v_pk_fma_f32 v[188:189], v[196:197], v[180:181], v[188:189] op_sel_hi:[0,1,1] neg_lo:[0,0,1] neg_hi:[0,0,1]
v_pk_fma_f32 v[190:191], v[196:197], v[182:183], v[190:191] op_sel_hi:[0,1,1] neg_lo:[0,0,1] neg_hi:[0,0,1]
v_pk_fma_f32 v[192:193], v[196:197], v[184:185], v[192:193] op_sel_hi:[0,1,1] neg_lo:[0,0,1] neg_hi:[0,0,1]
v_pk_fma_f32 v[194:195], v[196:197], v[186:187], v[194:195] op_sel_hi:[0,1,1] neg_lo:[0,0,1] neg_hi:[0,0,1]
v_cvt_pk_bf16_f32 v140, v188, v189
v_cvt_pk_bf16_f32 v141, v190, v191
v_cvt_pk_bf16_f32 v142, v192, v193
v_cvt_pk_bf16_f32 v143, v194, v195
v_pk_fma_f32 v[180:181], v[196:197], v[188:189], v[180:181] op_sel_hi:[0,1,1] neg_lo:[0,0,1] neg_hi:[0,0,1]
v_pk_fma_f32 v[182:183], v[196:197], v[190:191], v[182:183] op_sel_hi:[0,1,1] neg_lo:[0,0,1] neg_hi:[0,0,1]
v_pk_fma_f32 v[184:185], v[196:197], v[192:193], v[184:185] op_sel_hi:[0,1,1] neg_lo:[0,0,1] neg_hi:[0,0,1]
v_pk_fma_f32 v[186:187], v[196:197], v[194:195], v[186:187] op_sel_hi:[0,1,1] neg_lo:[0,0,1] neg_hi:[0,0,1]
v_cvt_pk_bf16_f32 v144, v180, v181
v_cvt_pk_bf16_f32 v145, v182, v183
v_cvt_pk_bf16_f32 v146, v184, v185
v_cvt_pk_bf16_f32 v147, v186, v187
v_pk_fma_f32 v[188:189], v[196:197], v[180:181], v[188:189] op_sel_hi:[0,1,1] neg_lo:[0,0,1] neg_hi:[0,0,1]
v_pk_fma_f32 v[190:191], v[196:197], v[182:183], v[190:191] op_sel_hi:[0,1,1] neg_lo:[0,0,1] neg_hi:[0,0,1]
v_pk_fma_f32 v[192:193], v[196:197], v[184:185], v[192:193] op_sel_hi:[0,1,1] neg_lo:[0,0,1] neg_hi:[0,0,1]
v_pk_fma_f32 v[194:195], v[196:197], v[186:187], v[194:195] op_sel_hi:[0,1,1] neg_lo:[0,0,1] neg_hi:[0,0,1]
v_cvt_pk_bf16_f32 v148, v188, v189
v_cvt_pk_bf16_f32 v149, v190, v191
v_cvt_pk_bf16_f32 v150, v192, v193
v_cvt_pk_bf16_f32 v151, v194, v195
v_pk_fma_f32 v[180:181], v[196:197], v[188:189], v[180:181] op_sel_hi:[0,1,1] neg_lo:[0,0,1] neg_hi:[0,0,1]
v_pk_fma_f32 v[182:183], v[196:197], v[190:191], v[182:183] op_sel_hi:[0,1,1] neg_lo:[0,0,1] neg_hi:[0,0,1]
v_pk_fma_f32 v[184:185], v[196:197], v[192:193], v[184:185] op_sel_hi:[0,1,1] neg_lo:[0,0,1] neg_hi:[0,0,1]
v_pk_fma_f32 v[186:187], v[196:197], v[194:195], v[186:187] op_sel_hi:[0,1,1] neg_lo:[0,0,1] neg_hi:[0,0,1]
v_cvt_pk_bf16_f32 v152, v180, v181
v_cvt_pk_bf16_f32 v153, v182, v183
v_cvt_pk_bf16_f32 v154, v184, v185
v_cvt_pk_bf16_f32 v155, v186, v187
v_pk_fma_f32 v[188:189], v[196:197], v[180:181], v[188:189] op_sel_hi:[0,1,1] neg_lo:[0,0,1] neg_hi:[0,0,1]
v_pk_fma_f32 v[190:191], v[196:197], v[182:183], v[190:191] op_sel_hi:[0,1,1] neg_lo:[0,0,1] neg_hi:[0,0,1]
v_pk_fma_f32 v[192:193], v[196:197], v[184:185], v[192:193] op_sel_hi:[0,1,1] neg_lo:[0,0,1] neg_hi:[0,0,1]
v_pk_fma_f32 v[194:195], v[196:197], v[186:187], v[194:195] op_sel_hi:[0,1,1] neg_lo:[0,0,1] neg_hi:[0,0,1]
v_cvt_pk_bf16_f32 v156, v188, v189
v_cvt_pk_bf16_f32 v157, v190, v191
v_cvt_pk_bf16_f32 v158, v192, v193
v_cvt_pk_bf16_f32 v159, v194, v195
v_pk_fma_f32 v[180:181], v[196:197], v[188:189], v[180:181] op_sel_hi:[0,1,1] neg_lo:[0,0,1] neg_hi:[0,0,1]
v_pk_fma_f32 v[182:183], v[196:197], v[190:191], v[182:183] op_sel_hi:[0,1,1] neg_lo:[0,0,1] neg_hi:[0,0,1]
v_pk_fma_f32 v[184:185], v[196:197], v[192:193], v[184:185] op_sel_hi:[0,1,1] neg_lo:[0,0,1] neg_hi:[0,0,1]
v_pk_fma_f32 v[186:187], v[196:197], v[194:195], v[186:187] op_sel_hi:[0,1,1] neg_lo:[0,0,1] neg_hi:[0,0,1]
v_cvt_pk_bf16_f32 v160, v180, v181
v_cvt_pk_bf16_f32 v161, v182, v183
v_cvt_pk_bf16_f32 v162, v184, v185
v_cvt_pk_bf16_f32 v163, v186, v187
v_pk_fma_f32 v[188:189], v[196:197], v[180:181], v[188:189] op_sel_hi:[0,1,1] neg_lo:[0,0,1] neg_hi:[0,0,1]
v_pk_fma_f32 v[190:191], v[196:197], v[182:183], v[190:191] op_sel_hi:[0,1,1] neg_lo:[0,0,1] neg_hi:[0,0,1]
v_pk_fma_f32 v[192:193], v[196:197], v[184:185], v[192:193] op_sel_hi:[0,1,1] neg_lo:[0,0,1] neg_hi:[0,0,1]
v_pk_fma_f32 v[194:195], v[196:197], v[186:187], v[194:195] op_sel_hi:[0,1,1] neg_lo:[0,0,1] neg_hi:[0,0,1]
v_cvt_pk_bf16_f32 v164, v188, v189
v_cvt_pk_bf16_f32 v165, v190, v191
v_cvt_pk_bf16_f32 v166, v192, v193
v_cvt_pk_bf16_f32 v167, v194, v195
v_pk_fma_f32 v[180:181], v[196:197], v[188:189], v[180:181] op_sel_hi:[0,1,1] neg_lo:[0,0,1] neg_hi:[0,0,1]
v_pk_fma_f32 v[182:183], v[196:197], v[190:191], v[182:183] op_sel_hi:[0,1,1] neg_lo:[0,0,1] neg_hi:[0,0,1]
v_pk_fma_f32 v[184:185], v[196:197], v[192:193], v[184:185] op_sel_hi:[0,1,1] neg_lo:[0,0,1] neg_hi:[0,0,1]
v_pk_fma_f32 v[186:187], v[196:197], v[194:195], v[186:187] op_sel_hi:[0,1,1] neg_lo:[0,0,1] neg_hi:[0,0,1]
v_cvt_pk_bf16_f32 v168, v180, v181
v_cvt_pk_bf16_f32 v169, v182, v183
v_cvt_pk_bf16_f32 v170, v184, v185
v_cvt_pk_bf16_f32 v171, v186, v187
v_pk_fma_f32 v[188:189], v[196:197], v[180:181], v[188:189] op_sel_hi:[0,1,1] neg_lo:[0,0,1] neg_hi:[0,0,1]
v_pk_fma_f32 v[190:191], v[196:197], v[182:183], v[190:191] op_sel_hi:[0,1,1] neg_lo:[0,0,1] neg_hi:[0,0,1]
v_pk_fma_f32 v[192:193], v[196:197], v[184:185], v[192:193] op_sel_hi:[0,1,1] neg_lo:[0,0,1] neg_hi:[0,0,1]
v_pk_fma_f32 v[194:195], v[196:197], v[186:187], v[194:195] op_sel_hi:[0,1,1] neg_lo:[0,0,1] neg_hi:[0,0,1]
v_cvt_pk_bf16_f32 v172, v188, v189
v_cvt_pk_bf16_f32 v173, v190, v191
v_cvt_pk_bf16_f32 v174, v192, v193
v_cvt_pk_bf16_f32 v175, v194, v195
v_mov_b32 v180, s24
v_mov_b32 v181, s24
v_mov_b32 v182, s24
v_mov_b32 v183, s24
s_nop 1
v_mfma_f32_32x32x16_bf16 v[184:199], v[180:183], v[16:19], 0
v_mfma_f32_32x32x16_bf16 v[184:199], v[180:183], v[20:23], v[184:199]
v_mfma_f32_32x32x16_bf16 v[184:199], v[180:183], v[24:27], v[184:199]
v_mfma_f32_32x32x16_bf16 v[184:199], v[180:183], v[28:31], v[184:199]
v_mfma_f32_32x32x16_bf16 v[184:199], v[180:183], v[32:35], v[184:199]
v_mfma_f32_32x32x16_bf16 v[184:199], v[180:183], v[36:39], v[184:199]
v_mfma_f32_32x32x16_bf16 v[184:199], v[180:183], v[40:43], v[184:199]
v_mfma_f32_32x32x16_bf16 v[184:199], v[180:183], v[44:47], v[184:199]
v_mfma_f32_32x32x16_bf16 v[184:199], v[180:183], v[48:51], v[184:199]
v_mfma_f32_32x32x16_bf16 v[184:199], v[180:183], v[52:55], v[184:199]
v_mfma_f32_32x32x16_bf16 v[184:199], v[180:183], v[56:59], v[184:199]
v_mfma_f32_32x32x16_bf16 v[184:199], v[180:183], v[60:63], v[184:199]
v_mfma_f32_32x32x16_bf16 v[184:199], v[180:183], v[64:67], v[184:199]
v_mfma_f32_32x32x16_bf16 v[184:199], v[180:183], v[68:71], v[184:199]
v_mfma_f32_32x32x16_bf16 v[184:199], v[180:183], v[72:75], v[184:199]
v_mfma_f32_32x32x16_bf16 v[184:199], v[180:183], v[76:79], v[184:199]
v_mfma_f32_32x32x16_bf16 v[184:199], v[180:183], v[80:83], v[184:199]
v_mfma_f32_32x32x16_bf16 v[184:199], v[180:183], v[84:87], v[184:199]
v_mfma_f32_32x32x16_bf16 v[184:199], v[180:183], v[88:91], v[184:199]
v_mfma_f32_32x32x16_bf16 v[184:199], v[180:183], v[92:95], v[184:199]
v_mfma_f32_32x32x16_bf16 v[184:199], v[180:183], v[96:99], v[184:199]
v_mfma_f32_32x32x16_bf16 v[184:199], v[180:183], v[100:103], v[184:199]
v_mfma_f32_32x32x16_bf16 v[184:199], v[180:183], v[104:107], v[184:199]
v_mfma_f32_32x32x16_bf16 v[184:199], v[180:183], v[108:111], v[184:199]
v_mfma_f32_32x32x16_bf16 v[184:199], v[180:183], v[112:115], v[184:199]
v_mfma_f32_32x32x16_bf16 v[184:199], v[180:183], v[116:119], v[184:199]
v_mfma_f32_32x32x16_bf16 v[184:199], v[180:183], v[120:123], v[184:199]
v_mfma_f32_32x32x16_bf16 v[184:199], v[180:183], v[124:127], v[184:199]
v_mfma_f32_32x32x16_bf16 v[184:199], v[180:183], v[128:131], v[184:199]
v_mfma_f32_32x32x16_bf16 v[184:199], v[180:183], v[132:135], v[184:199]
v_mfma_f32_32x32x16_bf16 v[184:199], v[180:183], v[136:139], v[184:199]
v_mfma_f32_32x32x16_bf16 v[184:199], v[180:183], v[140:143], v[184:199]
v_mfma_f32_32x32x16_bf16 v[184:199], v[180:183], v[144:147], v[184:199]
v_mfma_f32_32x32x16_bf16 v[184:199], v[180:183], v[148:151], v[184:199]
v_mfma_f32_32x32x16_bf16 v[184:199], v[180:183], v[152:155], v[184:199]
v_mfma_f32_32x32x16_bf16 v[184:199], v[180:183], v[156:159], v[184:199]
v_mfma_f32_32x32x16_bf16 v[184:199], v[180:183], v[160:163], v[184:199]
v_mfma_f32_32x32x16_bf16 v[184:199], v[180:183], v[164:167], v[184:199]
v_mfma_f32_32x32x16_bf16 v[184:199], v[180:183], v[168:171], v[184:199]
v_mfma_f32_32x32x16_bf16 v[184:199], v[180:183], v[172:175], v[184:199]
s_nop 11
v_mov_b32 v7, v184
s_lshl_b32 s18, s34, 2
s_add_u32 s18, s18, s13
s_lshl_b32 s33, s18, 11
s_mul_i32 s27, s50, 40960
s_add_u32 s27, s27, s33
s_add_u32 s27, s27, 97517568
s_mov_b32 s28, 0
s_waitcnt vmcnt(0)
p1_39:
s_barrier
s_lshl_b32 s18, s13, 5
v_xor_b32 v2, s18, v176
ds_read_b128 v[220:223], v2 offset:2048
ds_read_b128 v[228:231], v2 offset:10240
ds_read_b128 v[224:227], v2 offset:6144
ds_read_b128 v[204:207], v178 offset:2048
v_mov_b64 v[212:213], 0
s_add_u32 s19, s30, 0
buffer_load_dword a0, v1, s[40:43], s19 offen
ds_read_b128 v[232:235], v2 offset:14336
ds_read_b128 v[196:199], v176 offset:2048
ds_read_b128 v[208:211], v179 offset:2048
ds_read_b128 v[200:203], v177 offset:2048
s_waitcnt lgkmcnt(7)
v_dot2c_f32_bf16 v212, s24, v220
v_dot2c_f32_bf16 v213, v220, v220
v_dot2c_f32_bf16 v212, s24, v221
v_dot2c_f32_bf16 v213, v221, v221
v_dot2c_f32_bf16 v212, s24, v222
v_dot2c_f32_bf16 v213, v222, v222
v_dot2c_f32_bf16 v212, s24, v223
s_waitcnt lgkmcnt(5)
v_dot2c_f32_bf16 v213, v223, v223
v_dot2c_f32_bf16 v212, s24, v224
v_dot2c_f32_bf16 v213, v224, v224
v_dot2c_f32_bf16 v212, s24, v225
v_dot2c_f32_bf16 v213, v225, v225
v_dot2c_f32_bf16 v212, s24, v226
v_dot2c_f32_bf16 v213, v226, v226
v_dot2c_f32_bf16 v212, s24, v227
v_dot2c_f32_bf16 v213, v227, v227
v_dot2c_f32_bf16 v212, s24, v228
s_waitcnt lgkmcnt(3)
ds_read_b128 v[220:223], v2 offset:18432
ds_read_b128 v[224:227], v2 offset:22528
v_dot2c_f32_bf16 v213, v228, v228
v_dot2c_f32_bf16 v212, s24, v229
v_dot2c_f32_bf16 v213, v229, v229
v_dot2c_f32_bf16 v212, s24, v230
v_dot2c_f32_bf16 v213, v230, v230
v_dot2c_f32_bf16 v212, s24, v231
v_dot2c_f32_bf16 v213, v231, v231
v_dot2c_f32_bf16 v212, s24, v232
v_dot2c_f32_bf16 v213, v232, v232
v_dot2c_f32_bf16 v212, s24, v233
v_dot2c_f32_bf16 v213, v233, v233
v_dot2c_f32_bf16 v212, s24, v234
v_dot2c_f32_bf16 v213, v234, v234
v_dot2c_f32_bf16 v212, s24, v235
v_dot2c_f32_bf16 v213, v235, v235
s_waitcnt lgkmcnt(3)
s_add_u32 s19, s30, 41088
buffer_load_dword a1, v1, s[40:43], s19 offen
ds_read_b128 v[228:231], v2 offset:26624
s_waitcnt lgkmcnt(1)
ds_read_b128 v[232:235], v2 offset:30720
v_dot2c_f32_bf16 v212, s24, v220
v_dot2c_f32_bf16 v213, v220, v220
v_dot2c_f32_bf16 v212, s24, v221
v_dot2c_f32_bf16 v213, v221, v221
v_dot2c_f32_bf16 v212, s24, v222
v_dot2c_f32_bf16 v213, v222, v222
v_dot2c_f32_bf16 v212, s24, v223
v_dot2c_f32_bf16 v213, v223, v223
v_dot2c_f32_bf16 v212, s24, v224
v_dot2c_f32_bf16 v213, v224, v224
v_dot2c_f32_bf16 v212, s24, v225
v_dot2c_f32_bf16 v213, v225, v225
v_dot2c_f32_bf16 v212, s24, v226
v_dot2c_f32_bf16 v213, v226, v226
v_dot2c_f32_bf16 v212, s24, v227
v_dot2c_f32_bf16 v213, v227, v227
s_waitcnt lgkmcnt(0)
ds_read_b128 v[220:223], v2 offset:34816
ds_read_b128 v[224:227], v2 offset:38912
v_dot2c_f32_bf16 v212, s24, v228
v_dot2c_f32_bf16 v213, v228, v228
v_dot2c_f32_bf16 v212, s24, v229
v_dot2c_f32_bf16 v213, v229, v229
v_dot2c_f32_bf16 v212, s24, v230
v_dot2c_f32_bf16 v213, v230, v230
v_dot2c_f32_bf16 v212, s24, v231
v_dot2c_f32_bf16 v213, v231, v231
v_dot2c_f32_bf16 v212, s24, v232
v_dot2c_f32_bf16 v213, v232, v232
v_dot2c_f32_bf16 v212, s24, v233
v_dot2c_f32_bf16 v213, v233, v233
v_dot2c_f32_bf16 v212, s24, v234
v_dot2c_f32_bf16 v213, v234, v234
v_dot2c_f32_bf16 v212, s24, v235
v_dot2c_f32_bf16 v213, v235, v235
s_waitcnt lgkmcnt(1)
v_dot2c_f32_bf16 v212, s24, v220
v_dot2c_f32_bf16 v213, v220, v220
v_dot2c_f32_bf16 v212, s24, v221
v_dot2c_f32_bf16 v213, v221, v221
v_dot2c_f32_bf16 v212, s24, v222
v_dot2c_f32_bf16 v213, v222, v222
v_dot2c_f32_bf16 v212, s24, v223
v_dot2c_f32_bf16 v213, v223, v223
s_waitcnt lgkmcnt(0)
v_dot2c_f32_bf16 v212, s24, v224
v_dot2c_f32_bf16 v213, v224, v224
v_dot2c_f32_bf16 v212, s24, v225
v_dot2c_f32_bf16 v213, v225, v225
v_dot2c_f32_bf16 v212, s24, v226
v_dot2c_f32_bf16 v213, v226, v226
v_dot2c_f32_bf16 v212, s24, v227
v_dot2c_f32_bf16 v213, v227, v227
v_mfma_f32_32x32x16_bf16 v[180:195], v[196:199], v[16:19], 0
ds_read_b128 v[196:199], v176 offset:6144
s_add_u32 s19, s30, 82176
buffer_load_dword a2, v1, s[40:43], s19 offen
v_permlane32_swap_b32 v212, v213
v_mfma_f32_32x32x16_bf16 v[180:195], v[200:203], v[20:23], v[180:195]
v_add_f32 v212, v212, v213
v_lshl_add_u32 v213, s13, 2, v0
ds_read_b128 v[200:203], v177 offset:6144
v_and_b32 v2, 0x1ff, v0
v_mfma_f32_32x32x16_bf16 v[180:195], v[204:207], v[24:27], v[180:195]
ds_write_b32 v213, v212 offset:0
ds_read_b128 v[204:207], v178 offset:6144
s_waitcnt lgkmcnt(3)
v_mfma_f32_32x32x16_bf16 v[180:195], v[208:211], v[28:31], v[180:195]
ds_read_b128 v[208:211], v179 offset:6144
v_mfma_f32_32x32x16_bf16 v[180:195], v[196:199], v[32:35], v[180:195]
ds_read_b128 v[196:199], v176 offset:10240
s_add_u32 s19, s30, 123264
buffer_load_dword a3, v1, s[40:43], s19 offen
s_waitcnt lgkmcnt(4)
v_mfma_f32_32x32x16_bf16 v[180:195], v[200:203], v[36:39], v[180:195]
s_waitcnt lgkmcnt(1)
ds_read_b128 v[200:203], v177 offset:10240
v_mfma_f32_32x32x16_bf16 v[180:195], v[204:207], v[40:43], v[180:195]
s_barrier
ds_read_b128 v[204:207], v178 offset:10240
ds_read_b128 v[216:219], v2 offset:512
v_mfma_f32_32x32x16_bf16 v[180:195], v[208:211], v[44:47], v[180:195]
ds_read_b128 v[208:211], v179 offset:10240
s_waitcnt lgkmcnt(4)
v_mfma_f32_32x32x16_bf16 v[180:195], v[196:199], v[48:51], v[180:195]
ds_read_b128 v[212:215], v2 offset:0
s_waitcnt lgkmcnt(4)
ds_read_b128 v[196:199], v176 offset:14336
v_mfma_f32_32x32x16_bf16 v[180:195], v[200:203], v[52:55], v[180:195]
ds_read_b128 v[200:203], v177 offset:14336
s_waitcnt lgkmcnt(3)
v_mfma_f32_32x32x16_bf16 v[180:195], v[204:207], v[56:59], v[180:195]
s_waitcnt lgkmcnt(1)
ds_read_b128 v[204:207], v178 offset:14336
v_mfma_f32_32x32x16_bf16 v[180:195], v[208:211], v[60:63], v[180:195]
ds_read_b128 v[208:211], v179 offset:14336
v_add_f32 v212, v212, v213
v_mfma_f32_32x32x16_bf16 v[180:195], v[196:199], v[64:67], v[180:195]
v_add_f32 v216, v216, v217
v_add_f32 v218, v218, v219
s_waitcnt lgkmcnt(2)
ds_read_b128 v[196:199], v176 offset:18432
s_waitcnt lgkmcnt(2)
v_mfma_f32_32x32x16_bf16 v[180:195], v[200:203], v[68:71], v[180:195]
s_add_u32 s19, s30, 657408
buffer_load_dword a4, v1, s[40:43], s19 offen
ds_read_b128 v[200:203], v177 offset:18432
v_add_f32 v214, v214, v215
v_mfma_f32_32x32x16_bf16 v[180:195], v[204:207], v[72:75], v[180:195]
v_add_f32 v216, v216, v218
ds_read_b128 v[204:207], v178 offset:18432
v_add_f32 v212, v212, v214
s_waitcnt lgkmcnt(3)
v_mfma_f32_32x32x16_bf16 v[180:195], v[208:211], v[76:79], v[180:195]
ds_read_b128 v[208:211], v179 offset:18432
v_mul_f32 v212, 0x3acccccd, v212
s_waitcnt lgkmcnt(2)
v_bfe_u32 v214, v0, 5, 5
v_mul_f32 v216, 0x3acccccd, v216
v_mfma_f32_32x32x16_bf16 v[180:195], v[196:199], v[80:83], v[180:195]
v_fma_f32 v216, -v212, v212, v216
v_max_f32 v216, 0, v216
v_and_b32 v214, 16, v214
s_waitcnt lgkmcnt(1)
v_add_f32 v216, 0x3727c5ac, v216
v_lshrrev_b32 v213, 2, v0
v_mfma_f32_32x32x16_bf16 v[180:195], v[200:203], v[84:87], v[180:195]
ds_read_b128 v[196:199], v176 offset:22528
s_waitcnt lgkmcnt(1)
s_add_u32 s19, s30, 698496
buffer_load_dword a5, v1, s[40:43], s19 offen
v_lshl_add_u32 v213, s13, 8, v213
v_mfma_f32_32x32x16_bf16 v[180:195], v[204:207], v[88:91], v[180:195]
v_rsq_f32 v216, v216
ds_read_b128 v[200:203], v177 offset:22528
v_mul_f32 v212, v216, v212
v_mfma_f32_32x32x16_bf16 v[180:195], v[208:211], v[92:95], v[180:195]
s_waitcnt lgkmcnt(1)
ds_read_b128 v[208:211], v179 offset:22528
ds_read_b128 v[204:207], v178 offset:22528
v_permlane32_swap_b32 v216, v212
v_lshl_add_u32 v214, s13, 8, v214
v_mfma_f32_32x32x16_bf16 v[180:195], v[196:199], v[96:99], v[180:195]
ds_read_b128 v[196:199], v176 offset:26624
ds_write_b32 v213, v216 offset:1024
s_waitcnt lgkmcnt(4)
v_mfma_f32_32x32x16_bf16 v[180:195], v[200:203], v[100:103], v[180:195]
ds_read_b128 v[200:203], v177 offset:26624
ds_read_b128 v[236:239], v214 offset:1152
s_waitcnt lgkmcnt(5)
s_waitcnt lgkmcnt(4)
v_mfma_f32_32x32x16_bf16 v[180:195], v[204:207], v[104:107], v[180:195]
ds_read_b128 v[204:207], v178 offset:26624
v_mfma_f32_32x32x16_bf16 v[180:195], v[208:211], v[108:111], v[180:195]
s_waitcnt lgkmcnt(4)
ds_read_b128 v[208:211], v179 offset:26624
s_add_u32 s19, s30, 739584
buffer_load_dword a6, v1, s[40:43], s19 offen
s_waitcnt lgkmcnt(2)
v_mfma_f32_32x32x16_bf16 v[180:195], v[196:199], v[112:115], v[180:195]
ds_read_b128 v[248:251], v214 offset:1248
ds_read_b128 v[240:243], v214 offset:1184
ds_read_b128 v[196:199], v176 offset:30720
v_mfma_f32_32x32x16_bf16 v[180:195], v[200:203], v[116:119], v[180:195]
s_waitcnt lgkmcnt(4)
v_mul_f32 v239, v239, v7
ds_read_b128 v[244:247], v214 offset:1216
v_mul_f32 v236, v236, v7
v_mfma_f32_32x32x16_bf16 v[180:195], v[204:207], v[120:123], v[180:195]
ds_read_b128 v[200:203], v177 offset:30720
s_waitcnt lgkmcnt(5)
s_waitcnt lgkmcnt(4)
ds_read_b128 v[204:207], v178 offset:30720
ds_read_b128 v[232:235], v214 offset:1120
v_mfma_f32_32x32x16_bf16 v[180:195], v[208:211], v[124:127], v[180:195]
ds_read_b128 v[228:231], v214 offset:1088
ds_read_b128 v[208:211], v179 offset:30720
s_waitcnt lgkmcnt(6)
v_mfma_f32_32x32x16_bf16 v[180:195], v[196:199], v[128:131], v[180:195]
ds_read_b128 v[196:199], v176 offset:34816
s_waitcnt lgkmcnt(5)
ds_read_b128 v[220:223], v214 offset:1024
v_mul_f32 v238, v238, v7
v_mfma_f32_32x32x16_bf16 v[180:195], v[200:203], v[132:135], v[180:195]
ds_read_b128 v[200:203], v177 offset:34816
s_waitcnt lgkmcnt(6)
v_mfma_f32_32x32x16_bf16 v[180:195], v[204:207], v[136:139], v[180:195]
v_mul_f32 v243, v243, v7
s_waitcnt lgkmcnt(3)
s_add_u32 s19, s30, 780672
buffer_load_dword a7, v1, s[40:43], s19 offen
v_mul_f32 v246, v246, v7
v_mfma_f32_32x32x16_bf16 v[180:195], v[208:211], v[140:143], v[180:195]
ds_read_b128 v[208:211], v179 offset:34816
ds_read_b128 v[204:207], v178 offset:34816
v_mul_f32 v237, v237, v7
v_mul_f32 v251, v251, v7
s_waitcnt lgkmcnt(4)
v_mul_f32 v248, v248, v7
v_mfma_f32_32x32x16_bf16 v[180:195], v[196:199], v[144:147], v[180:195]
ds_read_b128 v[196:199], v176 offset:38912
s_waitcnt lgkmcnt(3)
v_mfma_f32_32x32x16_bf16 v[180:195], v[200:203], v[148:151], v[180:195]
s_waitcnt lgkmcnt(1)
ds_read_b128 v[200:203], v177 offset:38912
ds_read_b128 v[224:227], v214 offset:1056
v_mfma_f32_32x32x16_bf16 v[180:195], v[204:207], v[152:155], v[180:195]
v_mul_f32 v250, v250, v7
ds_read_b128 v[204:207], v178 offset:38912
v_mul_f32 v244, v244, v7
s_waitcnt lgkmcnt(3)
v_mfma_f32_32x32x16_bf16 v[180:195], v[208:211], v[156:159], v[180:195]
ds_read_b128 v[208:211], v179 offset:38912
s_waitcnt lgkmcnt(3)
v_mfma_f32_32x32x16_bf16 v[180:195], v[196:199], v[160:163], v[180:195]
v_mul_f32 v240, v240, v7
v_mfma_f32_32x32x16_bf16 v[180:195], v[200:203], v[164:167], v[180:195]
s_waitcnt lgkmcnt(1)
v_mul_f32 v241, v241, v7
v_mul_f32 v245, v245, v7
v_mfma_f32_32x32x16_bf16 v[180:195], v[204:207], v[168:171], v[180:195]
v_mul_f32 v249, v249, v7
s_waitcnt lgkmcnt(0)
v_mfma_f32_32x32x16_bf16 v[180:195], v[208:211], v[172:175], v[180:195]
s_nop 0
v_mul_f32 v247, v247, v7
v_mul_f32 v242, v242, v7
s_nop 8
v_pk_fma_f32 v[192:193], v[192:193], v[232:233], v[248:249] neg_lo:[0,0,1] neg_hi:[0,0,1]
v_pk_fma_f32 v[180:181], v[180:181], v[220:221], v[236:237] neg_lo:[0,0,1] neg_hi:[0,0,1]
v_pk_fma_f32 v[184:185], v[184:185], v[224:225], v[240:241] neg_lo:[0,0,1] neg_hi:[0,0,1]
v_pk_fma_f32 v[188:189], v[188:189], v[228:229], v[244:245] neg_lo:[0,0,1] neg_hi:[0,0,1]
v_pk_fma_f32 v[186:187], v[186:187], v[226:227], v[242:243] neg_lo:[0,0,1] neg_hi:[0,0,1]
v_pk_fma_f32 v[190:191], v[190:191], v[230:231], v[246:247] neg_lo:[0,0,1] neg_hi:[0,0,1]
v_cvt_pk_bf16_f32 v202, v192, v193
v_pk_fma_f32 v[182:183], v[182:183], v[222:223], v[238:239] neg_lo:[0,0,1] neg_hi:[0,0,1]
v_pk_fma_f32 v[194:195], v[194:195], v[234:235], v[250:251] neg_lo:[0,0,1] neg_hi:[0,0,1]
v_cvt_pk_bf16_f32 v196, v180, v181
v_cvt_pk_bf16_f32 v198, v184, v185
v_cvt_pk_bf16_f32 v200, v188, v189
v_cvt_pk_bf16_f32 v203, v194, v195
v_cvt_pk_bf16_f32 v197, v182, v183
v_cvt_pk_bf16_f32 v201, v190, v191
v_cvt_pk_bf16_f32 v199, v186, v187
buffer_store_dwordx4 v[196:199], v6, s[4:7], s27 offen offset:0 sc1
buffer_store_dwordx4 v[200:203], v6, s[4:7], s27 offen offset:1024 sc1
s_waitcnt vmcnt(6)
ds_write_b128 v4, a[0:3] offset:0
s_waitcnt vmcnt(2)
ds_write_b128 v4, a[4:7] offset:1024
v_add_u32 v4, 2048, v4
s_mov_b64 s[40:41], s[52:53]
v_add_u32 v176, 40960, v176
v_add_u32 v177, 40960, v177
v_add_u32 v178, 40960, v178
v_add_u32 v179, 40960, v179
s_add_u32 s27, s27, 1310720
s_add_u32 s28, s28, 1
s_cmp_lt_u32 s28, 2
s_cbranch_scc1 p1_39
s_lshl_b32 s18, s39, 2
s_add_u32 s18, s18, 5120
s_cmp_eq_u32 s13, 0
s_cselect_b32 s22, s18, s6
s_mov_b32 s23, 1
s_waitcnt vmcnt(0)
s_barrier
v_mov_b32 v3, s23
s_mov_b64 exec, 1
buffer_store_dword v3, off, s[4:7], s22 sc1
s_mov_b64 exec, -1
s_mov_b32 s22, s6
alay_40:
v_bfe_u32 v96, v0, 4, 4
v_lshrrev_b32 v97, 8, v0
v_lshlrev_b32 v97, 2, v97
v_lshl_add_u32 v98, s13, 4, v96
v_add_u32 v99, 0, v97
v_mul_u32_u24 v99, v99, v98
v_and_b32 v99, 63, v99
v_cvt_f32_u32 v99, v99
v_mul_f32 v99, 0x3c800000, v99
v_cos_f32 v104, v99
v_sin_f32 v112, v99
v_add_u32 v99, 1, v97
v_mul_u32_u24 v99, v99, v98
v_and_b32 v99, 63, v99
v_cvt_f32_u32 v99, v99
v_mul_f32 v99, 0x3c800000, v99
v_cos_f32 v105, v99
v_sin_f32 v113, v99
v_add_u32 v99, 2, v97
v_mul_u32_u24 v99, v99, v98
v_and_b32 v99, 63, v99
v_cvt_f32_u32 v99, v99
v_mul_f32 v99, 0x3c800000, v99
v_cos_f32 v106, v99
v_sin_f32 v114, v99
v_add_u32 v99, 3, v97
v_mul_u32_u24 v99, v99, v98
v_and_b32 v99, 63, v99
v_cvt_f32_u32 v99, v99
v_mul_f32 v99, 0x3c800000, v99
v_cos_f32 v107, v99
v_sin_f32 v115, v99
v_add_u32 v99, 16, v97
v_mul_u32_u24 v99, v99, v98
v_and_b32 v99, 63, v99
v_cvt_f32_u32 v99, v99
v_mul_f32 v99, 0x3c800000, v99
v_cos_f32 v108, v99
v_sin_f32 v116, v99
v_add_u32 v99, 17, v97
v_mul_u32_u24 v99, v99, v98
v_and_b32 v99, 63, v99
v_cvt_f32_u32 v99, v99
v_mul_f32 v99, 0x3c800000, v99
v_cos_f32 v109, v99
v_sin_f32 v117, v99
v_add_u32 v99, 18, v97
v_mul_u32_u24 v99, v99, v98
v_and_b32 v99, 63, v99
v_cvt_f32_u32 v99, v99
v_mul_f32 v99, 0x3c800000, v99
v_cos_f32 v110, v99
v_sin_f32 v118, v99
v_add_u32 v99, 19, v97
v_mul_u32_u24 v99, v99, v98
v_and_b32 v99, 63, v99
v_cvt_f32_u32 v99, v99
v_mul_f32 v99, 0x3c800000, v99
v_cos_f32 v111, v99
v_sin_f32 v119, v99
v_cvt_pk_bf16_f32 v16, v104, v105
v_cvt_pk_bf16_f32 v24, v112, v113
v_xor_b32 v32, 0x80008000, v24
v_cvt_pk_bf16_f32 v17, v106, v107
v_cvt_pk_bf16_f32 v25, v114, v115
v_xor_b32 v33, 0x80008000, v25
v_cvt_pk_bf16_f32 v18, v108, v109
v_cvt_pk_bf16_f32 v26, v116, v117
v_xor_b32 v34, 0x80008000, v26
v_cvt_pk_bf16_f32 v19, v110, v111
v_cvt_pk_bf16_f32 v27, v118, v119
v_xor_b32 v35, 0x80008000, v27
v_add_u32 v99, 32, v97
v_mul_u32_u24 v99, v99, v98
v_and_b32 v99, 63, v99
v_cvt_f32_u32 v99, v99
v_mul_f32 v99, 0x3c800000, v99
v_cos_f32 v104, v99
v_sin_f32 v112, v99
v_add_u32 v99, 33, v97
v_mul_u32_u24 v99, v99, v98
v_and_b32 v99, 63, v99
v_cvt_f32_u32 v99, v99
v_mul_f32 v99, 0x3c800000, v99
v_cos_f32 v105, v99
v_sin_f32 v113, v99
v_add_u32 v99, 34, v97
v_mul_u32_u24 v99, v99, v98
v_and_b32 v99, 63, v99
v_cvt_f32_u32 v99, v99
v_mul_f32 v99, 0x3c800000, v99
v_cos_f32 v106, v99
v_sin_f32 v114, v99
v_add_u32 v99, 35, v97
v_mul_u32_u24 v99, v99, v98
v_and_b32 v99, 63, v99
v_cvt_f32_u32 v99, v99
v_mul_f32 v99, 0x3c800000, v99
v_cos_f32 v107, v99
v_sin_f32 v115, v99
v_add_u32 v99, 48, v97
v_mul_u32_u24 v99, v99, v98
v_and_b32 v99, 63, v99
v_cvt_f32_u32 v99, v99
v_mul_f32 v99, 0x3c800000, v99
v_cos_f32 v108, v99
v_sin_f32 v116, v99
v_add_u32 v99, 49, v97
v_mul_u32_u24 v99, v99, v98
v_and_b32 v99, 63, v99
v_cvt_f32_u32 v99, v99
v_mul_f32 v99, 0x3c800000, v99
v_cos_f32 v109, v99
v_sin_f32 v117, v99
v_add_u32 v99, 50, v97
v_mul_u32_u24 v99, v99, v98
v_and_b32 v99, 63, v99
v_cvt_f32_u32 v99, v99
v_mul_f32 v99, 0x3c800000, v99
v_cos_f32 v110, v99
v_sin_f32 v118, v99
v_add_u32 v99, 51, v97
v_mul_u32_u24 v99, v99, v98
v_and_b32 v99, 63, v99
v_cvt_f32_u32 v99, v99
v_mul_f32 v99, 0x3c800000, v99
v_cos_f32 v111, v99
v_sin_f32 v119, v99
v_cvt_pk_bf16_f32 v20, v104, v105
v_cvt_pk_bf16_f32 v28, v112, v113
v_xor_b32 v36, 0x80008000, v28
v_cvt_pk_bf16_f32 v21, v106, v107
v_cvt_pk_bf16_f32 v29, v114, v115
v_xor_b32 v37, 0x80008000, v29
v_cvt_pk_bf16_f32 v22, v108, v109
v_cvt_pk_bf16_f32 v30, v116, v117
v_xor_b32 v38, 0x80008000, v30
v_cvt_pk_bf16_f32 v23, v110, v111
v_cvt_pk_bf16_f32 v31, v118, v119
v_xor_b32 v39, 0x80008000, v31
v_add_u32 v99, 0, v97
v_mul_u32_u24 v99, v99, v98
v_and_b32 v99, 2047, v99
v_cvt_f32_u32 v99, v99
v_mul_f32 v99, 0x3a000000, v99
v_cos_f32 v64, v99
v_sin_f32 v72, v99
v_add_u32 v99, 1, v97
v_mul_u32_u24 v99, v99, v98
v_and_b32 v99, 2047, v99
v_cvt_f32_u32 v99, v99
v_mul_f32 v99, 0x3a000000, v99
v_cos_f32 v65, v99
v_sin_f32 v73, v99
v_add_u32 v99, 2, v97
v_mul_u32_u24 v99, v99, v98
v_and_b32 v99, 2047, v99
v_cvt_f32_u32 v99, v99
v_mul_f32 v99, 0x3a000000, v99
v_cos_f32 v66, v99
v_sin_f32 v74, v99
v_add_u32 v99, 3, v97
v_mul_u32_u24 v99, v99, v98
v_and_b32 v99, 2047, v99
v_cvt_f32_u32 v99, v99
v_mul_f32 v99, 0x3a000000, v99
v_cos_f32 v67, v99
v_sin_f32 v75, v99
v_add_u32 v99, 16, v97
v_mul_u32_u24 v99, v99, v98
v_and_b32 v99, 2047, v99
v_cvt_f32_u32 v99, v99
v_mul_f32 v99, 0x3a000000, v99
v_cos_f32 v68, v99
v_sin_f32 v76, v99
v_add_u32 v99, 17, v97
v_mul_u32_u24 v99, v99, v98
v_and_b32 v99, 2047, v99
v_cvt_f32_u32 v99, v99
v_mul_f32 v99, 0x3a000000, v99
v_cos_f32 v69, v99
v_sin_f32 v77, v99
v_add_u32 v99, 18, v97
v_mul_u32_u24 v99, v99, v98
v_and_b32 v99, 2047, v99
v_cvt_f32_u32 v99, v99
v_mul_f32 v99, 0x3a000000, v99
v_cos_f32 v70, v99
v_sin_f32 v78, v99
v_add_u32 v99, 19, v97
v_mul_u32_u24 v99, v99, v98
v_and_b32 v99, 2047, v99
v_cvt_f32_u32 v99, v99
v_mul_f32 v99, 0x3a000000, v99
v_cos_f32 v71, v99
v_sin_f32 v79, v99
v_lshl_add_u32 v100, s13, 4, v97
v_add_u32 v98, 0, v96
v_add_u32 v99, 0, v97
v_mul_u32_u24 v99, v99, v98
v_and_b32 v99, 31, v99
v_cvt_f32_u32 v99, v99
v_mul_f32 v99, 0x3d000000, v99
v_cos_f32 v104, v99
v_sin_f32 v112, v99
v_add_u32 v99, 1, v97
v_mul_u32_u24 v99, v99, v98
v_and_b32 v99, 31, v99
v_cvt_f32_u32 v99, v99
v_mul_f32 v99, 0x3d000000, v99
v_cos_f32 v105, v99
v_sin_f32 v113, v99
v_add_u32 v99, 2, v97
v_mul_u32_u24 v99, v99, v98
v_and_b32 v99, 31, v99
v_cvt_f32_u32 v99, v99
v_mul_f32 v99, 0x3d000000, v99
v_cos_f32 v106, v99
v_sin_f32 v114, v99
v_add_u32 v99, 3, v97
v_mul_u32_u24 v99, v99, v98
v_and_b32 v99, 31, v99
v_cvt_f32_u32 v99, v99
v_mul_f32 v99, 0x3d000000, v99
v_cos_f32 v107, v99
v_sin_f32 v115, v99
v_add_u32 v99, 16, v97
v_mul_u32_u24 v99, v99, v98
v_and_b32 v99, 31, v99
v_cvt_f32_u32 v99, v99
v_mul_f32 v99, 0x3d000000, v99
v_cos_f32 v108, v99
v_sin_f32 v116, v99
v_add_u32 v99, 17, v97
v_mul_u32_u24 v99, v99, v98
v_and_b32 v99, 31, v99
v_cvt_f32_u32 v99, v99
v_mul_f32 v99, 0x3d000000, v99
v_cos_f32 v109, v99
v_sin_f32 v117, v99
v_add_u32 v99, 18, v97
v_mul_u32_u24 v99, v99, v98
v_and_b32 v99, 31, v99
v_cvt_f32_u32 v99, v99
v_mul_f32 v99, 0x3d000000, v99
v_cos_f32 v110, v99
v_sin_f32 v118, v99
v_add_u32 v99, 19, v97
v_mul_u32_u24 v99, v99, v98
v_and_b32 v99, 31, v99
v_cvt_f32_u32 v99, v99
v_mul_f32 v99, 0x3d000000, v99
v_cos_f32 v111, v99
v_sin_f32 v119, v99
v_cvt_pk_bf16_f32 v40, v104, v105
v_cvt_pk_bf16_f32 v48, v112, v113
v_xor_b32 v56, 0x80008000, v48
v_cvt_pk_bf16_f32 v41, v106, v107
v_cvt_pk_bf16_f32 v49, v114, v115
v_xor_b32 v57, 0x80008000, v49
v_cvt_pk_bf16_f32 v42, v108, v109
v_cvt_pk_bf16_f32 v50, v116, v117
v_xor_b32 v58, 0x80008000, v50
v_cvt_pk_bf16_f32 v43, v110, v111
v_cvt_pk_bf16_f32 v51, v118, v119
v_xor_b32 v59, 0x80008000, v51
v_add_u32 v99, 0, v100
v_mul_u32_u24 v99, v99, v98
v_and_b32 v99, 2047, v99
v_cvt_f32_u32 v99, v99
v_mul_f32 v99, 0x3a000000, v99
v_cos_f32 v80, v99
v_sin_f32 v88, v99
v_mul_f32 v80, 0x3a000000, v80
v_mul_f32 v88, 0x3a000000, v88
v_add_u32 v99, 1, v100
v_mul_u32_u24 v99, v99, v98
v_and_b32 v99, 2047, v99
v_cvt_f32_u32 v99, v99
v_mul_f32 v99, 0x3a000000, v99
v_cos_f32 v81, v99
v_sin_f32 v89, v99
v_mul_f32 v81, 0x3a000000, v81
v_mul_f32 v89, 0x3a000000, v89
v_add_u32 v99, 2, v100
v_mul_u32_u24 v99, v99, v98
v_and_b32 v99, 2047, v99
v_cvt_f32_u32 v99, v99
v_mul_f32 v99, 0x3a000000, v99
v_cos_f32 v82, v99
v_sin_f32 v90, v99
v_mul_f32 v82, 0x3a000000, v82
v_mul_f32 v90, 0x3a000000, v90
v_add_u32 v99, 3, v100
v_mul_u32_u24 v99, v99, v98
v_and_b32 v99, 2047, v99
v_cvt_f32_u32 v99, v99
v_mul_f32 v99, 0x3a000000, v99
v_cos_f32 v83, v99
v_sin_f32 v91, v99
v_mul_f32 v83, 0x3a000000, v83
v_mul_f32 v91, 0x3a000000, v91
v_add_u32 v98, 16, v96
v_add_u32 v99, 0, v97
v_mul_u32_u24 v99, v99, v98
v_and_b32 v99, 31, v99
v_cvt_f32_u32 v99, v99
v_mul_f32 v99, 0x3d000000, v99
v_cos_f32 v104, v99
v_sin_f32 v112, v99
v_add_u32 v99, 1, v97
v_mul_u32_u24 v99, v99, v98
v_and_b32 v99, 31, v99
v_cvt_f32_u32 v99, v99
v_mul_f32 v99, 0x3d000000, v99
v_cos_f32 v105, v99
v_sin_f32 v113, v99
v_add_u32 v99, 2, v97
v_mul_u32_u24 v99, v99, v98
v_and_b32 v99, 31, v99
v_cvt_f32_u32 v99, v99
v_mul_f32 v99, 0x3d000000, v99
v_cos_f32 v106, v99
v_sin_f32 v114, v99
v_add_u32 v99, 3, v97
v_mul_u32_u24 v99, v99, v98
v_and_b32 v99, 31, v99
v_cvt_f32_u32 v99, v99
v_mul_f32 v99, 0x3d000000, v99
v_cos_f32 v107, v99
v_sin_f32 v115, v99
v_add_u32 v99, 16, v97
v_mul_u32_u24 v99, v99, v98
v_and_b32 v99, 31, v99
v_cvt_f32_u32 v99, v99
v_mul_f32 v99, 0x3d000000, v99
v_cos_f32 v108, v99
v_sin_f32 v116, v99
v_add_u32 v99, 17, v97
v_mul_u32_u24 v99, v99, v98
v_and_b32 v99, 31, v99
v_cvt_f32_u32 v99, v99
v_mul_f32 v99, 0x3d000000, v99
v_cos_f32 v109, v99
v_sin_f32 v117, v99
v_add_u32 v99, 18, v97
v_mul_u32_u24 v99, v99, v98
v_and_b32 v99, 31, v99
v_cvt_f32_u32 v99, v99
v_mul_f32 v99, 0x3d000000, v99
v_cos_f32 v110, v99
v_sin_f32 v118, v99
v_add_u32 v99, 19, v97
v_mul_u32_u24 v99, v99, v98
v_and_b32 v99, 31, v99
v_cvt_f32_u32 v99, v99
v_mul_f32 v99, 0x3d000000, v99
v_cos_f32 v111, v99
v_sin_f32 v119, v99
v_cvt_pk_bf16_f32 v44, v104, v105
v_cvt_pk_bf16_f32 v52, v112, v113
v_xor_b32 v60, 0x80008000, v52
v_cvt_pk_bf16_f32 v45, v106, v107
v_cvt_pk_bf16_f32 v53, v114, v115
v_xor_b32 v61, 0x80008000, v53
v_cvt_pk_bf16_f32 v46, v108, v109
v_cvt_pk_bf16_f32 v54, v116, v117
v_xor_b32 v62, 0x80008000, v54
v_cvt_pk_bf16_f32 v47, v110, v111
v_cvt_pk_bf16_f32 v55, v118, v119
v_xor_b32 v63, 0x80008000, v55
v_add_u32 v99, 0, v100
v_mul_u32_u24 v99, v99, v98
v_and_b32 v99, 2047, v99
v_cvt_f32_u32 v99, v99
v_mul_f32 v99, 0x3a000000, v99
v_cos_f32 v84, v99
v_sin_f32 v92, v99
v_mul_f32 v84, 0x3a000000, v84
v_mul_f32 v92, 0x3a000000, v92
v_add_u32 v99, 1, v100
v_mul_u32_u24 v99, v99, v98
v_and_b32 v99, 2047, v99
v_cvt_f32_u32 v99, v99
v_mul_f32 v99, 0x3a000000, v99
v_cos_f32 v85, v99
v_sin_f32 v93, v99
v_mul_f32 v85, 0x3a000000, v85
v_mul_f32 v93, 0x3a000000, v93
v_add_u32 v99, 2, v100
v_mul_u32_u24 v99, v99, v98
v_and_b32 v99, 2047, v99
v_cvt_f32_u32 v99, v99
v_mul_f32 v99, 0x3a000000, v99
v_cos_f32 v86, v99
v_sin_f32 v94, v99
v_mul_f32 v86, 0x3a000000, v86
v_mul_f32 v94, 0x3a000000, v94
v_add_u32 v99, 3, v100
v_mul_u32_u24 v99, v99, v98
v_and_b32 v99, 2047, v99
v_cvt_f32_u32 v99, v99
v_mul_f32 v99, 0x3a000000, v99
v_cos_f32 v87, v99
v_sin_f32 v95, v99
v_mul_f32 v87, 0x3a000000, v87
v_mul_f32 v95, 0x3a000000, v95
v_lshrrev_b32 v98, 6, v0
v_and_b32 v99, 7, v98
v_lshlrev_b32 v99, 5, v99
v_lshl_add_u32 v98, v98, 8, v99
v_and_b32 v99, 16, v0
v_add_u32 v98, v98, v99
v_bfe_u32 v99, v0, 5, 1
v_lshl_add_u32 v224, v99, 3, v98
v_xor_b32 v225, 32, v224
v_xor_b32 v226, 64, v224
v_xor_b32 v227, 96, v224
v_xor_b32 v228, 128, v224
v_xor_b32 v229, 160, v224
v_xor_b32 v230, 192, v224
v_xor_b32 v231, 224, v224
v_lshrrev_b32 v98, 8, v0
v_bfe_u32 v99, v0, 5, 3
v_xor_b32 v99, v99, v98
v_mul_u32_u24 v98, 40960, v98
v_and_b32 v96, 16, v0
v_add_u32 v98, v98, v96
v_and_b32 v96, 3, v99
v_lshl_add_u32 v98, v96, 5, v98
v_lshrrev_b32 v99, 2, v99
v_lshl_add_u32 v232, v99, 10, v98
v_xor_b32 v99, 1, v99
v_lshl_add_u32 v233, v99, 10, v98
s_lshl_b32 s18, s13, 12
s_add_u32 s19, s18, 147456
v_add_u32 v99, s19, v0
ds_read_b128 v[208:211], v99 offset:0
ds_read_b128 v[212:215], v99 offset:1024
ds_read_b128 v[216:219], v99 offset:2048
ds_read_b128 v[220:223], v99 offset:3072
s_mov_b32 s25, s18
s_mul_i32 s26, s16, 3145728
s_mul_i32 s19, s13, 655360
s_add_u32 s26, s26, s19
s_lshl_b32 s19, s39, 8
s_add_u32 s27, s26, s19
s_add_u32 s27, s27, 103809024
s_lshr_b32 s19, s39, 3
s_lshl_b32 s19, s19, 11
s_add_u32 s26, s26, s19
s_and_b32 s19, s39, 7
s_lshl_b32 s19, s19, 7
s_add_u32 s26, s26, s19
s_add_u32 s26, s26, 97517568
s_cmp_lg_u32 s16, 0
s_cbranch_scc1 cw_41
s_cmp_lg_u32 s13, 0
s_cbranch_scc1 polld_44
v_min_u32 v12, 624, v0
s_mov_b32 s21, 5120
s_mov_b32 s17, 0
poll_43:
buffer_load_dwordx4 v[8:11], v12, s[4:7], s21 offen offset:0 sc1
s_add_u32 s17, s17, 1
s_cmp_gt_u32 s17, 262144
s_cbranch_scc1 L_fail
s_waitcnt vmcnt(0)
v_min3_u32 v8, v8, v9, v10
v_min_u32 v8, v8, v11
v_cmp_gt_u32 vcc, 1, v8
s_cbranch_vccz polld_44
s_sleep 2
s_branch poll_43
polld_44:
s_barrier
s_branch cw_42
cw_41:
s_cmp_lg_u32 s13, 0
s_cbranch_scc1 polld_46
v_lshrrev_b32 v12, 2, v0
v_min_u32 v12, 136, v12
s_mov_b32 s21, 6144
s_mov_b32 s17, 0
poll_45:
buffer_load_dword v8, v12, s[4:7], s21 offen offset:0 sc1
s_add_u32 s17, s17, 1
s_cmp_gt_u32 s17, 262144
s_cbranch_scc1 L_fail
s_waitcnt vmcnt(0)
v_cmp_gt_u32 vcc, 1, v8
s_cbranch_vccz polld_46
s_sleep 2
s_branch poll_45
polld_46:
s_barrier
cw_42:
s_add_u32 m0, s25, 0
s_add_u32 s20, s26, 0
buffer_load_dwordx4 v232, s[4:7], s20 offen sc1 lds
s_add_u32 m0, s25, 1024
s_add_u32 s20, s26, 163840
buffer_load_dwordx4 v233, s[4:7], s20 offen sc1 lds
s_add_u32 m0, s25, 2048
s_add_u32 s20, s26, 327680
buffer_load_dwordx4 v232, s[4:7], s20 offen sc1 lds
s_add_u32 m0, s25, 3072
s_add_u32 s20, s26, 491520
buffer_load_dwordx4 v233, s[4:7], s20 offen sc1 lds
s_lshr_b32 s18, s13, 1
s_lshl_b32 s18, s18, 10
s_and_b32 s19, s13, 1
s_lshl_b32 s19, s19, 3
s_add_u32 s18, s18, s19
v_add_u32 v234, s18, v0
v_bfe_u32 v235, v0, 4, 4
v_mul_u32_u24 v235, 40960, v235
v_lshrrev_b32 v99, 8, v0
v_lshl_add_u32 v235, v99, 4, v235
s_waitcnt vmcnt(0)
s_barrier
ds_read_b64_tr_b16 v[96:97], v224 offset:0
ds_read_b64_tr_b16 v[98:99], v224 offset:4096
ds_read_b64_tr_b16 v[114:115], v225 offset:4096
ds_read_b64_tr_b16 v[112:113], v225 offset:0
ds_read_b64_tr_b16 v[118:119], v225 offset:12288
ds_read_b64_tr_b16 v[102:103], v224 offset:12288
ds_read_b64_tr_b16 v[124:125], v229 offset:8192
ds_read_b64_tr_b16 v[100:101], v224 offset:8192
ds_read_b64_tr_b16 v[116:117], v225 offset:8192
ds_read_b64_tr_b16 v[120:121], v229 offset:0
ds_read_b64_tr_b16 v[122:123], v229 offset:4096
ds_read_b64_tr_b16 v[106:107], v228 offset:4096
ds_read_b64_tr_b16 v[142:143], v230 offset:12288
ds_read_b64_tr_b16 v[110:111], v228 offset:12288
ds_read_b64_tr_b16 v[104:105], v228 offset:0
ds_read_b64_tr_b16 v[156:157], v231 offset:8192
s_waitcnt lgkmcnt(14)
v_mfma_f32_16x16x32_bf16 v[160:163], v[96:99], v[16:19], 0
s_waitcnt lgkmcnt(13)
ds_read_b64_tr_b16 v[126:127], v229 offset:12288
s_waitcnt lgkmcnt(13)
v_mfma_f32_16x16x32_bf16 v[168:171], v[112:115], v[16:19], 0
s_waitcnt lgkmcnt(12)
ds_read_b64_tr_b16 v[108:109], v228 offset:8192
ds_read_b64_tr_b16 v[132:133], v226 offset:8192
v_mfma_f32_16x16x32_bf16 v[160:163], v[112:115], v[24:27], v[160:163]
ds_read_b64_tr_b16 v[146:147], v227 offset:4096
ds_read_b64_tr_b16 v[138:139], v230 offset:4096
v_mfma_f32_16x16x32_bf16 v[168:171], v[96:99], v[32:35], v[168:171]
s_waitcnt lgkmcnt(13)
ds_read_b64_tr_b16 v[154:155], v231 offset:4096
ds_read_b64_tr_b16 v[136:137], v230 offset:0
v_mfma_f32_16x16x32_bf16 v[160:163], v[100:103], v[20:23], v[160:163]
s_waitcnt lgkmcnt(12)
ds_read_b64_tr_b16 v[128:129], v226 offset:0
v_and_b32 v112, 0xffff0000, v208
v_mfma_f32_16x16x32_bf16 v[160:163], v[116:119], v[28:31], v[160:163]
ds_read_b64_tr_b16 v[158:159], v231 offset:12288
ds_read_b64_tr_b16 v[130:131], v226 offset:4096
v_mfma_f32_16x16x32_bf16 v[168:171], v[116:119], v[20:23], v[168:171]
ds_read_b64_tr_b16 v[150:151], v227 offset:12288
v_lshlrev_b32 v98, 16, v209
v_mfma_f32_16x16x32_bf16 v[168:171], v[100:103], v[36:39], v[168:171]
s_waitcnt lgkmcnt(12)
ds_read_b64_tr_b16 v[144:145], v227 offset:0
v_mul_f32 v232, v160, v72
v_mfma_f32_16x16x32_bf16 v[172:175], v[120:123], v[16:19], 0
s_waitcnt lgkmcnt(9)
ds_read_b64_tr_b16 v[148:149], v227 offset:8192
ds_read_b64_tr_b16 v[134:135], v226 offset:12288
v_mfma_f32_16x16x32_bf16 v[172:175], v[104:107], v[32:35], v[172:175]
v_and_b32 v113, 0xffff0000, v216
v_mul_f32 v160, v160, v64
v_mfma_f32_16x16x32_bf16 v[164:167], v[104:107], v[16:19], 0
s_waitcnt lgkmcnt(7)
v_mul_f32 v233, v161, v73
v_fma_f32 v160, v168, v72, v160
v_mfma_f32_16x16x32_bf16 v[172:175], v[124:127], v[20:23], v[172:175]
s_waitcnt lgkmcnt(6)
ds_read_b64_tr_b16 v[140:141], v230 offset:8192
v_fma_f32 v168, v168, v64, -v232
v_mfma_f32_16x16x32_bf16 v[172:175], v[108:111], v[36:39], v[172:175]
v_mul_f32 v232, v162, v74
v_mul_f32 v161, v161, v65
v_mfma_f32_16x16x32_bf16 v[164:167], v[120:123], v[24:27], v[164:167]
ds_read_b64_tr_b16 v[152:153], v231 offset:0
v_fma_f32 v161, v169, v73, v161
v_mfma_f32_16x16x32_bf16 v[164:167], v[108:111], v[20:23], v[164:167]
v_fma_f32 v169, v169, v65, -v233
v_mul_f32 v233, v163, v75
v_mfma_f32_16x16x32_bf16 v[164:167], v[124:127], v[28:31], v[164:167]
s_waitcnt lgkmcnt(4)
v_mul_f32 v162, v162, v66
v_mul_f32 v163, v163, v67
v_mfma_f32_16x16x32_bf16 v[180:183], v[136:139], v[16:19], 0
s_waitcnt lgkmcnt(2)
v_fma_f32 v163, v171, v75, v163
v_fma_f32 v162, v170, v74, v162
v_mfma_f32_16x16x32_bf16 v[184:187], v[144:147], v[16:19], 0
s_waitcnt lgkmcnt(0)
v_fma_f32 v171, v171, v67, -v233
v_mul_f32 v233, v165, v77
v_mfma_f32_16x16x32_bf16 v[188:191], v[152:155], v[16:19], 0
v_fma_f32 v170, v170, v66, -v232
v_cvt_pk_bf16_f32 v193, v162, v163
v_mfma_f32_16x16x32_bf16 v[176:179], v[128:131], v[16:19], 0
v_mul_f32 v232, v164, v76
v_mul_f32 v164, v164, v68
v_mfma_f32_16x16x32_bf16 v[184:187], v[128:131], v[32:35], v[184:187]
v_fma_f32 v164, v172, v76, v164
v_fma_f32 v172, v172, v68, -v232
v_mfma_f32_16x16x32_bf16 v[184:187], v[148:151], v[20:23], v[184:187]
v_mul_f32 v165, v165, v69
v_fma_f32 v165, v173, v77, v165
v_mfma_f32_16x16x32_bf16 v[176:179], v[144:147], v[24:27], v[176:179]
v_mul_f32 v232, v166, v78
v_lshlrev_b32 v100, 16, v210
v_mfma_f32_16x16x32_bf16 v[176:179], v[132:135], v[20:23], v[176:179]
v_fma_f32 v173, v173, v69, -v233
v_mul_f32 v233, v167, v79
v_mfma_f32_16x16x32_bf16 v[176:179], v[148:151], v[28:31], v[176:179]
v_cvt_pk_bf16_f32 v194, v164, v165
v_mul_f32 v166, v166, v70
v_mfma_f32_16x16x32_bf16 v[180:183], v[152:155], v[24:27], v[180:183]
v_mul_f32 v167, v167, v71
v_fma_f32 v166, v174, v78, v166
v_mfma_f32_16x16x32_bf16 v[180:183], v[140:143], v[20:23], v[180:183]
v_fma_f32 v167, v175, v79, v167
v_cvt_pk_bf16_f32 v196, v168, v169
v_mfma_f32_16x16x32_bf16 v[184:187], v[132:135], v[36:39], v[184:187]
v_cvt_pk_bf16_f32 v192, v160, v161
v_fma_f32 v174, v174, v70, -v232
v_mfma_f32_16x16x32_bf16 v[188:191], v[136:139], v[32:35], v[188:191]
v_cvt_pk_bf16_f32 v198, v172, v173
v_fma_f32 v175, v175, v71, -v233
v_mfma_f32_16x16x32_bf16 v[180:183], v[156:159], v[28:31], v[180:183]
v_cvt_pk_bf16_f32 v197, v170, v171
v_cvt_pk_bf16_f32 v199, v174, v175
v_mfma_f32_16x16x32_bf16 v[188:191], v[156:159], v[20:23], v[188:191]
v_mul_f32 v233, v177, v73
v_mul_f32 v177, v177, v65
v_mfma_f32_16x16x32_bf16 v[168:171], v[40:43], v[196:199], 0
v_cvt_pk_bf16_f32 v195, v166, v167
v_mul_f32 v232, v176, v72
v_mfma_f32_16x16x32_bf16 v[172:175], v[44:47], v[196:199], 0
v_mul_f32 v176, v176, v64
v_fma_f32 v177, v185, v73, v177
v_mfma_f32_16x16x32_bf16 v[188:191], v[140:143], v[36:39], v[188:191]
v_lshlrev_b32 v97, 16, v216
v_fma_f32 v176, v184, v72, v176
v_mfma_f32_16x16x32_bf16 v[168:171], v[56:59], v[192:195], v[168:171]
v_fma_f32 v184, v184, v64, -v232
v_mul_f32 v232, v178, v74
v_mfma_f32_16x16x32_bf16 v[160:163], v[40:43], v[192:195], 0
v_fma_f32 v185, v185, v65, -v233
v_mul_f32 v178, v178, v66
v_mfma_f32_16x16x32_bf16 v[160:163], v[48:51], v[196:199], v[160:163]
v_fma_f32 v178, v186, v74, v178
v_fma_f32 v186, v186, v66, -v232
v_mfma_f32_16x16x32_bf16 v[164:167], v[44:47], v[192:195], 0
v_mul_f32 v232, v180, v76
v_mul_f32 v180, v180, v68
v_mul_f32 v233, v179, v75
v_mfma_f32_16x16x32_bf16 v[172:175], v[60:63], v[192:195], v[172:175]
v_mul_f32 v179, v179, v67
v_cvt_pk_bf16_f32 v200, v176, v177
v_mfma_f32_16x16x32_bf16 v[164:167], v[52:55], v[196:199], v[164:167]
v_fma_f32 v179, v187, v75, v179
v_fma_f32 v187, v187, v67, -v233
v_fma_f32 v180, v188, v76, v180
v_mul_f32 v233, v181, v77
v_cvt_pk_bf16_f32 v204, v184, v185
v_mul_f32 v181, v181, v69
v_lshlrev_b32 v102, 16, v211
v_fma_f32 v188, v188, v68, -v232
v_cvt_pk_bf16_f32 v205, v186, v187
v_mul_f32 v232, v182, v78
v_cvt_pk_bf16_f32 v201, v178, v179
v_mul_f32 v182, v182, v70
v_fma_f32 v181, v189, v77, v181
v_fma_f32 v189, v189, v69, -v233
v_mul_f32 v233, v183, v79
v_fma_f32 v182, v190, v78, v182
v_cvt_pk_bf16_f32 v202, v180, v181
v_lshlrev_b32 v99, 16, v217
v_mul_f32 v183, v183, v71
v_fma_f32 v183, v191, v79, v183
v_cvt_pk_bf16_f32 v203, v182, v183
v_lshlrev_b32 v106, 16, v213
v_fma_f32 v191, v191, v71, -v233
v_fma_f32 v190, v190, v70, -v232
v_lshlrev_b32 v96, 16, v208
v_mfma_f32_16x16x32_bf16 v[176:179], v[40:43], v[200:203], 0
v_cvt_pk_bf16_f32 v207, v190, v191
v_lshlrev_b32 v103, 16, v219
v_mfma_f32_16x16x32_bf16 v[180:183], v[44:47], v[200:203], 0
v_mul_f32 v232, v160, v97
v_cvt_pk_bf16_f32 v206, v188, v189
v_mul_f32 v233, v161, v99
v_mul_f32 v161, v161, v98
v_mfma_f32_16x16x32_bf16 v[188:191], v[44:47], v[204:207], 0
v_and_b32 v117, 0xffff0000, v218
v_lshlrev_b32 v105, 16, v220
v_mfma_f32_16x16x32_bf16 v[184:187], v[40:43], v[204:207], 0
v_lshlrev_b32 v104, 16, v212
v_lshlrev_b32 v109, 16, v222
v_mfma_f32_16x16x32_bf16 v[180:183], v[52:55], v[204:207], v[180:183]
v_lshlrev_b32 v101, 16, v218
v_lshlrev_b32 v107, 16, v221
v_fma_f32 v161, v169, -v99, v161
v_mfma_f32_16x16x32_bf16 v[184:187], v[56:59], v[200:203], v[184:187]
v_lshlrev_b32 v108, 16, v214
v_lshlrev_b32 v111, 16, v223
v_fma_f32 v169, v169, v98, v233
v_mul_f32 v160, v160, v96
v_fma_f32 v160, v168, -v97, v160
v_fma_f32 v168, v168, v96, v232
v_mul_f32 v233, v163, v103
v_mul_f32 v232, v162, v101
v_mfma_f32_16x16x32_bf16 v[176:179], v[48:51], v[204:207], v[176:179]
v_mul_f32 v162, v162, v100
v_fma_f32 v162, v170, -v101, v162
v_mul_f32 v163, v163, v102
v_fma_f32 v163, v171, -v103, v163
v_cvt_pk_bf16_f32 v193, v162, v163
v_mfma_f32_16x16x32_bf16 v[188:191], v[60:63], v[200:203], v[188:191]
v_fma_f32 v170, v170, v100, v232
v_fma_f32 v171, v171, v102, v233
v_mul_f32 v233, v165, v107
v_mul_f32 v232, v164, v105
v_lshlrev_b32 v110, 16, v215
v_cvt_pk_bf16_f32 v192, v160, v161
v_cvt_pk_bf16_f32 v197, v170, v171
v_mul_f32 v165, v165, v106
v_mul_f32 v164, v164, v104
v_fma_f32 v164, v172, -v105, v164
v_fma_f32 v165, v173, -v107, v165
v_fma_f32 v172, v172, v104, v232
v_fma_f32 v173, v173, v106, v233
v_mul_f32 v232, v166, v109
v_cvt_pk_bf16_f32 v194, v164, v165
v_mul_f32 v233, v167, v111
v_mul_f32 v167, v167, v110
v_fma_f32 v167, v175, -v111, v167
v_mul_f32 v166, v166, v108
v_fma_f32 v166, v174, -v109, v166
v_cvt_pk_bf16_f32 v195, v166, v167
v_fma_f32 v175, v175, v110, v233
v_cvt_pk_bf16_f32 v198, v172, v173
v_mfma_f32_16x16x32_bf16 v[160:163], v[192:195], v[40:43], 0
v_fma_f32 v174, v174, v108, v232
v_cvt_pk_bf16_f32 v196, v168, v169
v_cvt_pk_bf16_f32 v199, v174, v175
v_and_b32 v115, 0xffff0000, v217
v_and_b32 v114, 0xffff0000, v209
v_mfma_f32_16x16x32_bf16 v[164:167], v[192:195], v[44:47], 0
v_and_b32 v119, 0xffff0000, v219
v_mul_f32 v232, v176, v113
v_and_b32 v127, 0xffff0000, v223
v_mul_f32 v233, v177, v115
v_mfma_f32_16x16x32_bf16 v[172:175], v[196:199], v[44:47], 0
v_mul_f32 v176, v176, v112
v_and_b32 v118, 0xffff0000, v211
v_mfma_f32_16x16x32_bf16 v[160:163], v[196:199], v[56:59], v[160:163]
v_and_b32 v121, 0xffff0000, v220
v_and_b32 v116, 0xffff0000, v210
v_and_b32 v124, 0xffff0000, v214
v_mul_f32 v177, v177, v114
v_fma_f32 v176, v184, -v113, v176
v_mfma_f32_16x16x32_bf16 v[168:171], v[196:199], v[40:43], 0
v_fma_f32 v177, v185, -v115, v177
v_fma_f32 v184, v184, v112, v232
v_mfma_f32_16x16x32_bf16 v[172:175], v[192:195], v[52:55], v[172:175]
v_fma_f32 v185, v185, v114, v233
v_mul_f32 v232, v178, v117
v_mfma_f32_16x16x32_bf16 v[164:167], v[196:199], v[60:63], v[164:167]
v_mul_f32 v178, v178, v116
v_cvt_pk_bf16_f32 v200, v176, v177
v_mfma_f32_16x16x32_bf16 v[168:171], v[192:195], v[48:51], v[168:171]
v_and_b32 v123, 0xffff0000, v221
v_mul_f32 v233, v179, v119
v_mul_f32 v179, v179, v118
v_and_b32 v122, 0xffff0000, v213
v_fma_f32 v179, v187, -v119, v179
v_fma_f32 v187, v187, v118, v233
v_fma_f32 v178, v186, -v117, v178
v_mul_f32 v233, v181, v123
v_and_b32 v126, 0xffff0000, v215
v_and_b32 v120, 0xffff0000, v212
v_fma_f32 v186, v186, v116, v232
v_and_b32 v125, 0xffff0000, v222
v_cvt_pk_bf16_f32 v205, v186, v187
v_mul_f32 v181, v181, v122
v_fma_f32 v181, v189, -v123, v181
v_fma_f32 v189, v189, v122, v233
v_mul_f32 v232, v180, v121
v_mul_f32 v180, v180, v120
v_mul_f32 v233, v183, v127
v_mul_f32 v183, v183, v126
v_fma_f32 v183, v191, -v127, v183
v_fma_f32 v180, v188, -v121, v180
v_fma_f32 v191, v191, v126, v233
v_fma_f32 v188, v188, v120, v232
v_mul_f32 v232, v182, v125
v_mul_f32 v233, v161, v89
v_mul_f32 v182, v182, v124
v_fma_f32 v182, v190, -v125, v182
v_cvt_pk_bf16_f32 v206, v188, v189
v_cvt_pk_bf16_f32 v204, v184, v185
v_cvt_pk_bf16_f32 v201, v178, v179
v_fma_f32 v190, v190, v124, v232
v_cvt_pk_bf16_f32 v207, v190, v191
v_mul_f32 v232, v160, v88
v_mul_f32 v160, v160, v80
v_mfma_f32_16x16x32_bf16 v[188:191], v[204:207], v[44:47], 0
v_fma_f32 v160, v168, -v88, v160
v_fma_f32 v168, v168, v80, v232
v_mul_f32 v232, v162, v90
v_mul_f32 v161, v161, v81
v_cvt_pk_bf16_f32 v203, v182, v183
v_mfma_f32_16x16x32_bf16 v[184:187], v[204:207], v[40:43], 0
v_fma_f32 v161, v169, -v89, v161
v_cvt_pk_bf16_f32 v202, v180, v181
v_fma_f32 v169, v169, v81, v233
v_mul_f32 v162, v162, v82
v_mfma_f32_16x16x32_bf16 v[180:183], v[200:203], v[44:47], 0
v_fma_f32 v162, v170, -v90, v162
v_mul_f32 v233, v163, v91
v_mfma_f32_16x16x32_bf16 v[176:179], v[200:203], v[40:43], 0
v_fma_f32 v170, v170, v82, v232
v_mul_f32 v163, v163, v83
v_mfma_f32_16x16x32_bf16 v[184:187], v[200:203], v[48:51], v[184:187]
v_fma_f32 v163, v171, -v91, v163
v_mul_f32 v232, v164, v92
v_mul_f32 v164, v164, v84
v_mfma_f32_16x16x32_bf16 v[176:179], v[204:207], v[56:59], v[176:179]
v_fma_f32 v171, v171, v83, v233
v_fma_f32 v164, v172, -v92, v164
v_mul_f32 v233, v165, v93
v_mul_f32 v165, v165, v85
v_fma_f32 v165, v173, -v93, v165
v_cvt_pk_bf16_f32 v192, v160, v161
v_mfma_f32_16x16x32_bf16 v[188:191], v[200:203], v[52:55], v[188:191]
v_fma_f32 v173, v173, v85, v233
v_mul_f32 v233, v167, v95
v_mul_f32 v167, v167, v87
v_fma_f32 v172, v172, v84, v232
v_cvt_pk_bf16_f32 v196, v168, v169
v_mul_f32 v232, v166, v94
v_cvt_pk_bf16_f32 v193, v162, v163
v_fma_f32 v167, v175, -v95, v167
v_mul_f32 v166, v166, v86
v_fma_f32 v166, v174, -v94, v166
v_fma_f32 v174, v174, v86, v232
v_mul_f32 v232, v176, v88
v_mul_f32 v176, v176, v80
v_cvt_pk_bf16_f32 v197, v170, v171
v_cvt_pk_bf16_f32 v195, v166, v167
v_fma_f32 v175, v175, v87, v233
v_mul_f32 v233, v177, v89
v_cvt_pk_bf16_f32 v199, v174, v175
v_cvt_pk_bf16_f32 v198, v172, v173
v_fma_f32 v176, v184, -v88, v176
v_mul_f32 v177, v177, v81
v_fma_f32 v177, v185, -v89, v177
v_mfma_f32_16x16x32_bf16 v[180:183], v[204:207], v[60:63], v[180:183]
ds_write_b64 v234, v[198:199] offset:22528
ds_write_b64 v234, v[192:193] offset:16384
ds_write_b64 v234, v[196:197] offset:20480
v_fma_f32 v185, v185, v81, v233
v_fma_f32 v184, v184, v80, v232
v_cvt_pk_bf16_f32 v200, v176, v177
v_mul_f32 v232, v178, v90
v_mul_f32 v233, v179, v91
v_mul_f32 v179, v179, v83
v_mul_f32 v178, v178, v82
v_fma_f32 v179, v187, -v91, v179
v_fma_f32 v178, v186, -v90, v178
v_fma_f32 v186, v186, v82, v232
v_cvt_pk_bf16_f32 v194, v164, v165
v_fma_f32 v187, v187, v83, v233
v_mul_f32 v233, v181, v93
v_mul_f32 v181, v181, v85
v_mul_f32 v232, v180, v92
v_fma_f32 v181, v189, -v93, v181
v_cvt_pk_bf16_f32 v204, v184, v185
v_cvt_pk_bf16_f32 v201, v178, v179
v_fma_f32 v189, v189, v85, v233
v_mul_f32 v180, v180, v84
v_fma_f32 v180, v188, -v92, v180
v_cvt_pk_bf16_f32 v205, v186, v187
s_waitcnt lgkmcnt(0)
ds_write_b64 v234, v[204:205] offset:28672
ds_write_b64 v234, v[200:201] offset:24576
ds_write_b64 v234, v[194:195] offset:18432
v_fma_f32 v188, v188, v84, v232
v_mul_f32 v233, v183, v95
v_mul_f32 v183, v183, v87
v_mul_f32 v232, v182, v94
v_fma_f32 v183, v191, -v95, v183
v_fma_f32 v191, v191, v87, v233
v_mul_f32 v182, v182, v86
v_cvt_pk_bf16_f32 v206, v188, v189
v_fma_f32 v182, v190, -v94, v182
v_fma_f32 v190, v190, v86, v232
v_cvt_pk_bf16_f32 v202, v180, v181
v_cvt_pk_bf16_f32 v207, v190, v191
ds_write_b64 v234, v[206:207] offset:30720
v_cvt_pk_bf16_f32 v203, v182, v183
s_waitcnt lgkmcnt(0)
ds_write_b64 v234, v[202:203] offset:26624
s_waitcnt lgkmcnt(0)
s_barrier
ds_read_b128 v[96:99], v0 offset:16384
ds_read_b128 v[112:115], v0 offset:20480
ds_read_b128 v[128:131], v0 offset:24576
ds_read_b128 v[124:127], v0 offset:23552
ds_read_b128 v[144:147], v0 offset:28672
ds_read_b128 v[120:123], v0 offset:22528
s_waitcnt lgkmcnt(5)
v_mfma_f32_16x16x32_bf16 v[160:163], v[96:99], v[16:19], 0
ds_read_b128 v[100:103], v0 offset:17408
s_waitcnt lgkmcnt(5)
v_mfma_f32_16x16x32_bf16 v[168:171], v[112:115], v[16:19], 0
ds_read_b128 v[136:139], v0 offset:26624
v_mfma_f32_16x16x32_bf16 v[160:163], v[112:115], v[32:35], v[160:163]
ds_read_b128 v[148:151], v0 offset:29696
s_waitcnt lgkmcnt(6)
v_mfma_f32_16x16x32_bf16 v[176:179], v[128:131], v[16:19], 0
v_mfma_f32_16x16x32_bf16 v[168:171], v[96:99], v[24:27], v[168:171]
s_waitcnt lgkmcnt(4)
ds_read_b128 v[116:119], v0 offset:21504
ds_read_b128 v[132:135], v0 offset:25600
v_mfma_f32_16x16x32_bf16 v[176:179], v[144:147], v[32:35], v[176:179]
ds_read_b128 v[156:159], v0 offset:31744
v_mfma_f32_16x16x32_bf16 v[184:187], v[144:147], v[16:19], 0
s_waitcnt lgkmcnt(5)
ds_read_b128 v[104:107], v0 offset:18432
v_mfma_f32_16x16x32_bf16 v[184:187], v[128:131], v[24:27], v[184:187]
ds_read_b128 v[152:155], v0 offset:30720
s_waitcnt lgkmcnt(5)
v_mfma_f32_16x16x32_bf16 v[184:187], v[148:151], v[20:23], v[184:187]
s_waitcnt lgkmcnt(4)
v_mfma_f32_16x16x32_bf16 v[160:163], v[100:103], v[20:23], v[160:163]
v_mfma_f32_16x16x32_bf16 v[168:171], v[116:119], v[20:23], v[168:171]
ds_read_b128 v[108:111], v0 offset:19456
v_mfma_f32_16x16x32_bf16 v[172:175], v[120:123], v[16:19], 0
ds_read_b128 v[140:143], v0 offset:27648
s_waitcnt lgkmcnt(3)
v_mfma_f32_16x16x32_bf16 v[164:167], v[104:107], v[16:19], 0
v_mfma_f32_16x16x32_bf16 v[164:167], v[120:123], v[32:35], v[164:167]
v_mfma_f32_16x16x32_bf16 v[180:183], v[136:139], v[16:19], 0
v_mfma_f32_16x16x32_bf16 v[160:163], v[116:119], v[36:39], v[160:163]
s_waitcnt lgkmcnt(1)
s_nop 0
v_mfma_f32_16x16x32_bf16 v[180:183], v[152:155], v[32:35], v[180:183]
s_nop 2
v_mfma_f32_16x16x32_bf16 v[176:179], v[132:135], v[20:23], v[176:179]
s_nop 0
v_cvt_pk_bf16_f32 v193, v162, v163
v_mfma_f32_16x16x32_bf16 v[168:171], v[100:103], v[28:31], v[168:171]
v_mfma_f32_16x16x32_bf16 v[164:167], v[108:111], v[20:23], v[164:167]
v_mfma_f32_16x16x32_bf16 v[176:179], v[148:151], v[36:39], v[176:179]
v_cvt_pk_bf16_f32 v192, v160, v161
s_nop 0
v_mfma_f32_16x16x32_bf16 v[164:167], v[124:127], v[36:39], v[164:167]
s_nop 2
v_mfma_f32_16x16x32_bf16 v[172:175], v[104:107], v[24:27], v[172:175]
s_nop 0
v_cvt_pk_bf16_f32 v200, v176, v177
v_mfma_f32_16x16x32_bf16 v[172:175], v[124:127], v[20:23], v[172:175]
s_nop 0
v_cvt_pk_bf16_f32 v194, v164, v165
s_waitcnt lgkmcnt(0)
v_mfma_f32_16x16x32_bf16 v[180:183], v[140:143], v[20:23], v[180:183]
v_cvt_pk_bf16_f32 v195, v166, v167
v_mfma_f32_16x16x32_bf16 v[180:183], v[156:159], v[36:39], v[180:183]
v_cvt_pk_bf16_f32 v196, v168, v169
v_cvt_pk_bf16_f32 v201, v178, v179
v_mfma_f32_16x16x32_bf16 v[172:175], v[108:111], v[28:31], v[172:175]
buffer_store_dwordx4 v[192:195], v235, s[4:7], s27 offen offset:0 sc1
s_nop 1
v_mfma_f32_16x16x32_bf16 v[184:187], v[132:135], v[28:31], v[184:187]
s_nop 0
v_cvt_pk_bf16_f32 v202, v180, v181
v_mfma_f32_16x16x32_bf16 v[188:191], v[152:155], v[16:19], 0
s_nop 0
v_cvt_pk_bf16_f32 v198, v172, v173
v_cvt_pk_bf16_f32 v203, v182, v183
v_mfma_f32_16x16x32_bf16 v[188:191], v[136:139], v[24:27], v[188:191]
s_nop 0
v_cvt_pk_bf16_f32 v205, v186, v187
v_cvt_pk_bf16_f32 v204, v184, v185
v_mfma_f32_16x16x32_bf16 v[188:191], v[156:159], v[20:23], v[188:191]
v_cvt_pk_bf16_f32 v199, v174, v175
v_cvt_pk_bf16_f32 v197, v170, v171
v_mfma_f32_16x16x32_bf16 v[188:191], v[140:143], v[28:31], v[188:191]
buffer_store_dwordx4 v[196:199], v235, s[4:7], s27 offen offset:64 sc1
s_nop 2
buffer_store_dwordx4 v[200:203], v235, s[4:7], s27 offen offset:128 sc1
s_nop 2
v_cvt_pk_bf16_f32 v207, v190, v191
v_cvt_pk_bf16_f32 v206, v188, v189
buffer_store_dwordx4 v[204:207], v235, s[4:7], s27 offen offset:192 sc1
s_lshl_b32 s18, s39, 2
s_add_u32 s18, s18, 7168
s_add_u32 s29, s16, 1
s_cmp_eq_u32 s13, 0
s_cselect_b32 s22, s18, s6
s_mov_b32 s23, s29
s_lshl_b32 s18, s34, 7
s_lshl_b32 s19, s13, 5
s_add_u32 s18, s18, s19
s_mov_b32 s19, 0x3acccccd
v_bfe_u32 v222, v0, 4, 5
v_lshrrev_b32 v217, 9, v0
v_and_b32 v220, 19, v222
v_bfe_u32 v223, v222, 2, 1
v_lshl_add_u32 v220, v223, 3, v220
v_bfe_u32 v223, v222, 3, 1
v_lshl_add_u32 v220, v223, 2, v220
v_add_u32 v220, s18, v220
v_lshlrev_b32 v217, 2, v217
v_mov_b32 v221, 0
v_mad_u32_u24 v221, v217, v220, v221
v_mad_u32_u24 v216, v220, 8, 0
v_cvt_f32_u32 v216, v216
v_mul_f32 v222, s19, v216
v_rndne_f32 v222, v222
v_fmac_f32 v216, 0xc4200000, v222
v_mul_f32 v216, s19, v216
v_cos_f32 v216, v216
s_nop 0
v_add_f32 v216, v216, v216
v_mad_u32_u24 v218, v220, 1, 0
v_cvt_f32_u32 v218, v218
v_mul_f32 v222, s19, v218
v_rndne_f32 v222, v222
v_fmac_f32 v218, 0xc4200000, v222
v_mul_f32 v218, s19, v218
v_cos_f32 v218, v218
s_nop 0
v_add_f32 v218, v218, v218
v_mad_u32_u24 v200, v220, 1, v221
v_cvt_f32_u32 v200, v200
v_mul_f32 v222, s19, v200
v_rndne_f32 v222, v222
v_fmac_f32 v200, 0xc4200000, v222
v_mul_f32 v200, s19, v200
v_sin_f32 v201, -v200
v_cos_f32 v200, v200
v_mad_u32_u24 v202, v220, 2, v221
v_cvt_f32_u32 v202, v202
v_mul_f32 v222, s19, v202
v_rndne_f32 v222, v222
v_fmac_f32 v202, 0xc4200000, v222
v_mul_f32 v202, s19, v202
v_sin_f32 v203, -v202
v_cos_f32 v202, v202
s_nop 0
v_pk_fma_f32 v[204:205], v[218:219], v[202:203], v[200:201] op_sel_hi:[0,1,1] neg_lo:[0,0,1] neg_hi:[0,0,1]
v_pk_fma_f32 v[206:207], v[218:219], v[204:205], v[202:203] op_sel_hi:[0,1,1] neg_lo:[0,0,1] neg_hi:[0,0,1]
v_cvt_pk_bf16_f32 v16, v200, v201
v_cvt_pk_bf16_f32 v17, v202, v203
v_cvt_pk_bf16_f32 v18, v204, v205
v_cvt_pk_bf16_f32 v19, v206, v207
v_mad_u32_u24 v208, v220, 9, v221
v_cvt_f32_u32 v208, v208
v_mul_f32 v222, s19, v208
v_rndne_f32 v222, v222
v_fmac_f32 v208, 0xc4200000, v222
v_mul_f32 v208, s19, v208
v_sin_f32 v209, -v208
v_cos_f32 v208, v208
v_mad_u32_u24 v210, v220, 10, v221
v_cvt_f32_u32 v210, v210
v_mul_f32 v222, s19, v210
v_rndne_f32 v222, v222
v_fmac_f32 v210, 0xc4200000, v222
v_mul_f32 v210, s19, v210
v_sin_f32 v211, -v210
v_cos_f32 v210, v210
s_nop 0
v_pk_fma_f32 v[212:213], v[218:219], v[210:211], v[208:209] op_sel_hi:[0,1,1] neg_lo:[0,0,1] neg_hi:[0,0,1]
v_pk_fma_f32 v[214:215], v[218:219], v[212:213], v[210:211] op_sel_hi:[0,1,1] neg_lo:[0,0,1] neg_hi:[0,0,1]
v_cvt_pk_bf16_f32 v20, v208, v209
v_cvt_pk_bf16_f32 v21, v210, v211
v_cvt_pk_bf16_f32 v22, v212, v213
v_cvt_pk_bf16_f32 v23, v214, v215
v_pk_fma_f32 v[200:201], v[216:217], v[208:209], v[200:201] op_sel_hi:[0,1,1] neg_lo:[0,0,1] neg_hi:[0,0,1]
v_pk_fma_f32 v[202:203], v[216:217], v[210:211], v[202:203] op_sel_hi:[0,1,1] neg_lo:[0,0,1] neg_hi:[0,0,1]
v_pk_fma_f32 v[204:205], v[216:217], v[212:213], v[204:205] op_sel_hi:[0,1,1] neg_lo:[0,0,1] neg_hi:[0,0,1]
v_pk_fma_f32 v[206:207], v[216:217], v[214:215], v[206:207] op_sel_hi:[0,1,1] neg_lo:[0,0,1] neg_hi:[0,0,1]
v_cvt_pk_bf16_f32 v24, v200, v201
v_cvt_pk_bf16_f32 v25, v202, v203
v_cvt_pk_bf16_f32 v26, v204, v205
v_cvt_pk_bf16_f32 v27, v206, v207
v_pk_fma_f32 v[208:209], v[216:217], v[200:201], v[208:209] op_sel_hi:[0,1,1] neg_lo:[0,0,1] neg_hi:[0,0,1]
v_pk_fma_f32 v[210:211], v[216:217], v[202:203], v[210:211] op_sel_hi:[0,1,1] neg_lo:[0,0,1] neg_hi:[0,0,1]
v_pk_fma_f32 v[212:213], v[216:217], v[204:205], v[212:213] op_sel_hi:[0,1,1] neg_lo:[0,0,1] neg_hi:[0,0,1]
v_pk_fma_f32 v[214:215], v[216:217], v[206:207], v[214:215] op_sel_hi:[0,1,1] neg_lo:[0,0,1] neg_hi:[0,0,1]
v_cvt_pk_bf16_f32 v28, v208, v209
v_cvt_pk_bf16_f32 v29, v210, v211
v_cvt_pk_bf16_f32 v30, v212, v213
v_cvt_pk_bf16_f32 v31, v214, v215
v_pk_fma_f32 v[200:201], v[216:217], v[208:209], v[200:201] op_sel_hi:[0,1,1] neg_lo:[0,0,1] neg_hi:[0,0,1]
v_pk_fma_f32 v[202:203], v[216:217], v[210:211], v[202:203] op_sel_hi:[0,1,1] neg_lo:[0,0,1] neg_hi:[0,0,1]
v_pk_fma_f32 v[204:205], v[216:217], v[212:213], v[204:205] op_sel_hi:[0,1,1] neg_lo:[0,0,1] neg_hi:[0,0,1]
v_pk_fma_f32 v[206:207], v[216:217], v[214:215], v[206:207] op_sel_hi:[0,1,1] neg_lo:[0,0,1] neg_hi:[0,0,1]
v_cvt_pk_bf16_f32 v32, v200, v201
v_cvt_pk_bf16_f32 v33, v202, v203
v_cvt_pk_bf16_f32 v34, v204, v205
v_cvt_pk_bf16_f32 v35, v206, v207
v_pk_fma_f32 v[208:209], v[216:217], v[200:201], v[208:209] op_sel_hi:[0,1,1] neg_lo:[0,0,1] neg_hi:[0,0,1]
v_pk_fma_f32 v[210:211], v[216:217], v[202:203], v[210:211] op_sel_hi:[0,1,1] neg_lo:[0,0,1] neg_hi:[0,0,1]
v_pk_fma_f32 v[212:213], v[216:217], v[204:205], v[212:213] op_sel_hi:[0,1,1] neg_lo:[0,0,1] neg_hi:[0,0,1]
v_pk_fma_f32 v[214:215], v[216:217], v[206:207], v[214:215] op_sel_hi:[0,1,1] neg_lo:[0,0,1] neg_hi:[0,0,1]
v_cvt_pk_bf16_f32 v36, v208, v209
v_cvt_pk_bf16_f32 v37, v210, v211
v_cvt_pk_bf16_f32 v38, v212, v213
v_cvt_pk_bf16_f32 v39, v214, v215
v_pk_fma_f32 v[200:201], v[216:217], v[208:209], v[200:201] op_sel_hi:[0,1,1] neg_lo:[0,0,1] neg_hi:[0,0,1]
v_pk_fma_f32 v[202:203], v[216:217], v[210:211], v[202:203] op_sel_hi:[0,1,1] neg_lo:[0,0,1] neg_hi:[0,0,1]
v_pk_fma_f32 v[204:205], v[216:217], v[212:213], v[204:205] op_sel_hi:[0,1,1] neg_lo:[0,0,1] neg_hi:[0,0,1]
v_pk_fma_f32 v[206:207], v[216:217], v[214:215], v[206:207] op_sel_hi:[0,1,1] neg_lo:[0,0,1] neg_hi:[0,0,1]
v_cvt_pk_bf16_f32 v40, v200, v201
v_cvt_pk_bf16_f32 v41, v202, v203
v_cvt_pk_bf16_f32 v42, v204, v205
v_cvt_pk_bf16_f32 v43, v206, v207
v_pk_fma_f32 v[208:209], v[216:217], v[200:201], v[208:209] op_sel_hi:[0,1,1] neg_lo:[0,0,1] neg_hi:[0,0,1]
v_pk_fma_f32 v[210:211], v[216:217], v[202:203], v[210:211] op_sel_hi:[0,1,1] neg_lo:[0,0,1] neg_hi:[0,0,1]
v_pk_fma_f32 v[212:213], v[216:217], v[204:205], v[212:213] op_sel_hi:[0,1,1] neg_lo:[0,0,1] neg_hi:[0,0,1]
v_pk_fma_f32 v[214:215], v[216:217], v[206:207], v[214:215] op_sel_hi:[0,1,1] neg_lo:[0,0,1] neg_hi:[0,0,1]
v_cvt_pk_bf16_f32 v44, v208, v209
v_cvt_pk_bf16_f32 v45, v210, v211
v_cvt_pk_bf16_f32 v46, v212, v213
v_cvt_pk_bf16_f32 v47, v214, v215
v_pk_fma_f32 v[200:201], v[216:217], v[208:209], v[200:201] op_sel_hi:[0,1,1] neg_lo:[0,0,1] neg_hi:[0,0,1]
v_pk_fma_f32 v[202:203], v[216:217], v[210:211], v[202:203] op_sel_hi:[0,1,1] neg_lo:[0,0,1] neg_hi:[0,0,1]
v_pk_fma_f32 v[204:205], v[216:217], v[212:213], v[204:205] op_sel_hi:[0,1,1] neg_lo:[0,0,1] neg_hi:[0,0,1]
v_pk_fma_f32 v[206:207], v[216:217], v[214:215], v[206:207] op_sel_hi:[0,1,1] neg_lo:[0,0,1] neg_hi:[0,0,1]
v_cvt_pk_bf16_f32 v48, v200, v201
v_cvt_pk_bf16_f32 v49, v202, v203
v_cvt_pk_bf16_f32 v50, v204, v205
v_cvt_pk_bf16_f32 v51, v206, v207
v_pk_fma_f32 v[208:209], v[216:217], v[200:201], v[208:209] op_sel_hi:[0,1,1] neg_lo:[0,0,1] neg_hi:[0,0,1]
v_pk_fma_f32 v[210:211], v[216:217], v[202:203], v[210:211] op_sel_hi:[0,1,1] neg_lo:[0,0,1] neg_hi:[0,0,1]
v_pk_fma_f32 v[212:213], v[216:217], v[204:205], v[212:213] op_sel_hi:[0,1,1] neg_lo:[0,0,1] neg_hi:[0,0,1]
v_pk_fma_f32 v[214:215], v[216:217], v[206:207], v[214:215] op_sel_hi:[0,1,1] neg_lo:[0,0,1] neg_hi:[0,0,1]
v_cvt_pk_bf16_f32 v52, v208, v209
v_cvt_pk_bf16_f32 v53, v210, v211
v_cvt_pk_bf16_f32 v54, v212, v213
v_cvt_pk_bf16_f32 v55, v214, v215
v_pk_fma_f32 v[200:201], v[216:217], v[208:209], v[200:201] op_sel_hi:[0,1,1] neg_lo:[0,0,1] neg_hi:[0,0,1]
v_pk_fma_f32 v[202:203], v[216:217], v[210:211], v[202:203] op_sel_hi:[0,1,1] neg_lo:[0,0,1] neg_hi:[0,0,1]
v_pk_fma_f32 v[204:205], v[216:217], v[212:213], v[204:205] op_sel_hi:[0,1,1] neg_lo:[0,0,1] neg_hi:[0,0,1]
v_pk_fma_f32 v[206:207], v[216:217], v[214:215], v[206:207] op_sel_hi:[0,1,1] neg_lo:[0,0,1] neg_hi:[0,0,1]
v_cvt_pk_bf16_f32 v56, v200, v201
v_cvt_pk_bf16_f32 v57, v202, v203
v_cvt_pk_bf16_f32 v58, v204, v205
v_cvt_pk_bf16_f32 v59, v206, v207
v_pk_fma_f32 v[208:209], v[216:217], v[200:201], v[208:209] op_sel_hi:[0,1,1] neg_lo:[0,0,1] neg_hi:[0,0,1]
v_pk_fma_f32 v[210:211], v[216:217], v[202:203], v[210:211] op_sel_hi:[0,1,1] neg_lo:[0,0,1] neg_hi:[0,0,1]
v_pk_fma_f32 v[212:213], v[216:217], v[204:205], v[212:213] op_sel_hi:[0,1,1] neg_lo:[0,0,1] neg_hi:[0,0,1]
v_pk_fma_f32 v[214:215], v[216:217], v[206:207], v[214:215] op_sel_hi:[0,1,1] neg_lo:[0,0,1] neg_hi:[0,0,1]
v_cvt_pk_bf16_f32 v60, v208, v209
v_cvt_pk_bf16_f32 v61, v210, v211
v_cvt_pk_bf16_f32 v62, v212, v213
v_cvt_pk_bf16_f32 v63, v214, v215
v_pk_fma_f32 v[200:201], v[216:217], v[208:209], v[200:201] op_sel_hi:[0,1,1] neg_lo:[0,0,1] neg_hi:[0,0,1]
v_pk_fma_f32 v[202:203], v[216:217], v[210:211], v[202:203] op_sel_hi:[0,1,1] neg_lo:[0,0,1] neg_hi:[0,0,1]
v_pk_fma_f32 v[204:205], v[216:217], v[212:213], v[204:205] op_sel_hi:[0,1,1] neg_lo:[0,0,1] neg_hi:[0,0,1]
v_pk_fma_f32 v[206:207], v[216:217], v[214:215], v[206:207] op_sel_hi:[0,1,1] neg_lo:[0,0,1] neg_hi:[0,0,1]
v_cvt_pk_bf16_f32 v64, v200, v201
v_cvt_pk_bf16_f32 v65, v202, v203
v_cvt_pk_bf16_f32 v66, v204, v205
v_cvt_pk_bf16_f32 v67, v206, v207
s_waitcnt vmcnt(0)
s_barrier
v_mov_b32 v3, s23
s_mov_b64 exec, 1
buffer_store_dword v3, off, s[4:7], s22 sc1
s_mov_b64 exec, -1
s_mov_b32 s22, s6
v_pk_fma_f32 v[208:209], v[216:217], v[200:201], v[208:209] op_sel_hi:[0,1,1] neg_lo:[0,0,1] neg_hi:[0,0,1]
v_pk_fma_f32 v[210:211], v[216:217], v[202:203], v[210:211] op_sel_hi:[0,1,1] neg_lo:[0,0,1] neg_hi:[0,0,1]
v_pk_fma_f32 v[212:213], v[216:217], v[204:205], v[212:213] op_sel_hi:[0,1,1] neg_lo:[0,0,1] neg_hi:[0,0,1]
v_pk_fma_f32 v[214:215], v[216:217], v[206:207], v[214:215] op_sel_hi:[0,1,1] neg_lo:[0,0,1] neg_hi:[0,0,1]
v_cvt_pk_bf16_f32 v68, v208, v209
v_cvt_pk_bf16_f32 v69, v210, v211
v_cvt_pk_bf16_f32 v70, v212, v213
v_cvt_pk_bf16_f32 v71, v214, v215
v_pk_fma_f32 v[200:201], v[216:217], v[208:209], v[200:201] op_sel_hi:[0,1,1] neg_lo:[0,0,1] neg_hi:[0,0,1]
v_pk_fma_f32 v[202:203], v[216:217], v[210:211], v[202:203] op_sel_hi:[0,1,1] neg_lo:[0,0,1] neg_hi:[0,0,1]
v_pk_fma_f32 v[204:205], v[216:217], v[212:213], v[204:205] op_sel_hi:[0,1,1] neg_lo:[0,0,1] neg_hi:[0,0,1]
v_pk_fma_f32 v[206:207], v[216:217], v[214:215], v[206:207] op_sel_hi:[0,1,1] neg_lo:[0,0,1] neg_hi:[0,0,1]
v_cvt_pk_bf16_f32 v72, v200, v201
v_cvt_pk_bf16_f32 v73, v202, v203
v_cvt_pk_bf16_f32 v74, v204, v205
v_cvt_pk_bf16_f32 v75, v206, v207
v_pk_fma_f32 v[208:209], v[216:217], v[200:201], v[208:209] op_sel_hi:[0,1,1] neg_lo:[0,0,1] neg_hi:[0,0,1]
v_pk_fma_f32 v[210:211], v[216:217], v[202:203], v[210:211] op_sel_hi:[0,1,1] neg_lo:[0,0,1] neg_hi:[0,0,1]
v_pk_fma_f32 v[212:213], v[216:217], v[204:205], v[212:213] op_sel_hi:[0,1,1] neg_lo:[0,0,1] neg_hi:[0,0,1]
v_pk_fma_f32 v[214:215], v[216:217], v[206:207], v[214:215] op_sel_hi:[0,1,1] neg_lo:[0,0,1] neg_hi:[0,0,1]
v_cvt_pk_bf16_f32 v76, v208, v209
v_cvt_pk_bf16_f32 v77, v210, v211
v_cvt_pk_bf16_f32 v78, v212, v213
v_cvt_pk_bf16_f32 v79, v214, v215
v_pk_fma_f32 v[200:201], v[216:217], v[208:209], v[200:201] op_sel_hi:[0,1,1] neg_lo:[0,0,1] neg_hi:[0,0,1]
v_pk_fma_f32 v[202:203], v[216:217], v[210:211], v[202:203] op_sel_hi:[0,1,1] neg_lo:[0,0,1] neg_hi:[0,0,1]
v_pk_fma_f32 v[204:205], v[216:217], v[212:213], v[204:205] op_sel_hi:[0,1,1] neg_lo:[0,0,1] neg_hi:[0,0,1]
v_pk_fma_f32 v[206:207], v[216:217], v[214:215], v[206:207] op_sel_hi:[0,1,1] neg_lo:[0,0,1] neg_hi:[0,0,1]
v_cvt_pk_bf16_f32 v80, v200, v201
v_cvt_pk_bf16_f32 v81, v202, v203
v_cvt_pk_bf16_f32 v82, v204, v205
v_cvt_pk_bf16_f32 v83, v206, v207
v_pk_fma_f32 v[208:209], v[216:217], v[200:201], v[208:209] op_sel_hi:[0,1,1] neg_lo:[0,0,1] neg_hi:[0,0,1]
v_pk_fma_f32 v[210:211], v[216:217], v[202:203], v[210:211] op_sel_hi:[0,1,1] neg_lo:[0,0,1] neg_hi:[0,0,1]
v_pk_fma_f32 v[212:213], v[216:217], v[204:205], v[212:213] op_sel_hi:[0,1,1] neg_lo:[0,0,1] neg_hi:[0,0,1]
v_pk_fma_f32 v[214:215], v[216:217], v[206:207], v[214:215] op_sel_hi:[0,1,1] neg_lo:[0,0,1] neg_hi:[0,0,1]
v_cvt_pk_bf16_f32 v84, v208, v209
v_cvt_pk_bf16_f32 v85, v210, v211
v_cvt_pk_bf16_f32 v86, v212, v213
v_cvt_pk_bf16_f32 v87, v214, v215
v_pk_fma_f32 v[200:201], v[216:217], v[208:209], v[200:201] op_sel_hi:[0,1,1] neg_lo:[0,0,1] neg_hi:[0,0,1]
v_pk_fma_f32 v[202:203], v[216:217], v[210:211], v[202:203] op_sel_hi:[0,1,1] neg_lo:[0,0,1] neg_hi:[0,0,1]
v_pk_fma_f32 v[204:205], v[216:217], v[212:213], v[204:205] op_sel_hi:[0,1,1] neg_lo:[0,0,1] neg_hi:[0,0,1]
v_pk_fma_f32 v[206:207], v[216:217], v[214:215], v[206:207] op_sel_hi:[0,1,1] neg_lo:[0,0,1] neg_hi:[0,0,1]
v_cvt_pk_bf16_f32 v88, v200, v201
v_cvt_pk_bf16_f32 v89, v202, v203
v_cvt_pk_bf16_f32 v90, v204, v205
v_cvt_pk_bf16_f32 v91, v206, v207
v_pk_fma_f32 v[208:209], v[216:217], v[200:201], v[208:209] op_sel_hi:[0,1,1] neg_lo:[0,0,1] neg_hi:[0,0,1]
v_pk_fma_f32 v[210:211], v[216:217], v[202:203], v[210:211] op_sel_hi:[0,1,1] neg_lo:[0,0,1] neg_hi:[0,0,1]
v_pk_fma_f32 v[212:213], v[216:217], v[204:205], v[212:213] op_sel_hi:[0,1,1] neg_lo:[0,0,1] neg_hi:[0,0,1]
v_pk_fma_f32 v[214:215], v[216:217], v[206:207], v[214:215] op_sel_hi:[0,1,1] neg_lo:[0,0,1] neg_hi:[0,0,1]
v_cvt_pk_bf16_f32 v92, v208, v209
v_cvt_pk_bf16_f32 v93, v210, v211
v_cvt_pk_bf16_f32 v94, v212, v213
v_cvt_pk_bf16_f32 v95, v214, v215
s_mov_b32 s20, 161
v_mad_u32_u24 v200, v220, s20, v221
v_cvt_f32_u32 v200, v200
v_mul_f32 v222, s19, v200
v_rndne_f32 v222, v222
v_fmac_f32 v200, 0xc4200000, v222
v_mul_f32 v200, s19, v200
v_sin_f32 v201, -v200
v_cos_f32 v200, v200
s_mov_b32 s20, 162
v_mad_u32_u24 v202, v220, s20, v221
v_cvt_f32_u32 v202, v202
v_mul_f32 v222, s19, v202
v_rndne_f32 v222, v222
v_fmac_f32 v202, 0xc4200000, v222
v_mul_f32 v202, s19, v202
v_sin_f32 v203, -v202
v_cos_f32 v202, v202
s_nop 0
v_pk_fma_f32 v[204:205], v[218:219], v[202:203], v[200:201] op_sel_hi:[0,1,1] neg_lo:[0,0,1] neg_hi:[0,0,1]
v_pk_fma_f32 v[206:207], v[218:219], v[204:205], v[202:203] op_sel_hi:[0,1,1] neg_lo:[0,0,1] neg_hi:[0,0,1]
v_cvt_pk_bf16_f32 v96, v200, v201
v_cvt_pk_bf16_f32 v97, v202, v203
v_cvt_pk_bf16_f32 v98, v204, v205
v_cvt_pk_bf16_f32 v99, v206, v207
s_mov_b32 s20, 169
v_mad_u32_u24 v208, v220, s20, v221
v_cvt_f32_u32 v208, v208
v_mul_f32 v222, s19, v208
v_rndne_f32 v222, v222
v_fmac_f32 v208, 0xc4200000, v222
v_mul_f32 v208, s19, v208
v_sin_f32 v209, -v208
v_cos_f32 v208, v208
s_mov_b32 s20, 170
v_mad_u32_u24 v210, v220, s20, v221
v_cvt_f32_u32 v210, v210
v_mul_f32 v222, s19, v210
v_rndne_f32 v222, v222
v_fmac_f32 v210, 0xc4200000, v222
v_mul_f32 v210, s19, v210
v_sin_f32 v211, -v210
v_cos_f32 v210, v210
s_nop 0
v_pk_fma_f32 v[212:213], v[218:219], v[210:211], v[208:209] op_sel_hi:[0,1,1] neg_lo:[0,0,1] neg_hi:[0,0,1]
v_pk_fma_f32 v[214:215], v[218:219], v[212:213], v[210:211] op_sel_hi:[0,1,1] neg_lo:[0,0,1] neg_hi:[0,0,1]
v_cvt_pk_bf16_f32 v100, v208, v209
v_cvt_pk_bf16_f32 v101, v210, v211
v_cvt_pk_bf16_f32 v102, v212, v213
v_cvt_pk_bf16_f32 v103, v214, v215
v_pk_fma_f32 v[200:201], v[216:217], v[208:209], v[200:201] op_sel_hi:[0,1,1] neg_lo:[0,0,1] neg_hi:[0,0,1]
v_pk_fma_f32 v[202:203], v[216:217], v[210:211], v[202:203] op_sel_hi:[0,1,1] neg_lo:[0,0,1] neg_hi:[0,0,1]
v_pk_fma_f32 v[204:205], v[216:217], v[212:213], v[204:205] op_sel_hi:[0,1,1] neg_lo:[0,0,1] neg_hi:[0,0,1]
v_pk_fma_f32 v[206:207], v[216:217], v[214:215], v[206:207] op_sel_hi:[0,1,1] neg_lo:[0,0,1] neg_hi:[0,0,1]
v_cvt_pk_bf16_f32 v104, v200, v201
v_cvt_pk_bf16_f32 v105, v202, v203
v_cvt_pk_bf16_f32 v106, v204, v205
v_cvt_pk_bf16_f32 v107, v206, v207
v_pk_fma_f32 v[208:209], v[216:217], v[200:201], v[208:209] op_sel_hi:[0,1,1] neg_lo:[0,0,1] neg_hi:[0,0,1]
v_pk_fma_f32 v[210:211], v[216:217], v[202:203], v[210:211] op_sel_hi:[0,1,1] neg_lo:[0,0,1] neg_hi:[0,0,1]
v_pk_fma_f32 v[212:213], v[216:217], v[204:205], v[212:213] op_sel_hi:[0,1,1] neg_lo:[0,0,1] neg_hi:[0,0,1]
v_pk_fma_f32 v[214:215], v[216:217], v[206:207], v[214:215] op_sel_hi:[0,1,1] neg_lo:[0,0,1] neg_hi:[0,0,1]
v_cvt_pk_bf16_f32 v108, v208, v209
v_cvt_pk_bf16_f32 v109, v210, v211
v_cvt_pk_bf16_f32 v110, v212, v213
v_cvt_pk_bf16_f32 v111, v214, v215
v_pk_fma_f32 v[200:201], v[216:217], v[208:209], v[200:201] op_sel_hi:[0,1,1] neg_lo:[0,0,1] neg_hi:[0,0,1]
v_pk_fma_f32 v[202:203], v[216:217], v[210:211], v[202:203] op_sel_hi:[0,1,1] neg_lo:[0,0,1] neg_hi:[0,0,1]
v_pk_fma_f32 v[204:205], v[216:217], v[212:213], v[204:205] op_sel_hi:[0,1,1] neg_lo:[0,0,1] neg_hi:[0,0,1]
v_pk_fma_f32 v[206:207], v[216:217], v[214:215], v[206:207] op_sel_hi:[0,1,1] neg_lo:[0,0,1] neg_hi:[0,0,1]
v_cvt_pk_bf16_f32 v112, v200, v201
v_cvt_pk_bf16_f32 v113, v202, v203
v_cvt_pk_bf16_f32 v114, v204, v205
v_cvt_pk_bf16_f32 v115, v206, v207
v_pk_fma_f32 v[208:209], v[216:217], v[200:201], v[208:209] op_sel_hi:[0,1,1] neg_lo:[0,0,1] neg_hi:[0,0,1]
v_pk_fma_f32 v[210:211], v[216:217], v[202:203], v[210:211] op_sel_hi:[0,1,1] neg_lo:[0,0,1] neg_hi:[0,0,1]
v_pk_fma_f32 v[212:213], v[216:217], v[204:205], v[212:213] op_sel_hi:[0,1,1] neg_lo:[0,0,1] neg_hi:[0,0,1]
v_pk_fma_f32 v[214:215], v[216:217], v[206:207], v[214:215] op_sel_hi:[0,1,1] neg_lo:[0,0,1] neg_hi:[0,0,1]
v_cvt_pk_bf16_f32 v116, v208, v209
v_cvt_pk_bf16_f32 v117, v210, v211
v_cvt_pk_bf16_f32 v118, v212, v213
v_cvt_pk_bf16_f32 v119, v214, v215
v_pk_fma_f32 v[200:201], v[216:217], v[208:209], v[200:201] op_sel_hi:[0,1,1] neg_lo:[0,0,1] neg_hi:[0,0,1]
v_pk_fma_f32 v[202:203], v[216:217], v[210:211], v[202:203] op_sel_hi:[0,1,1] neg_lo:[0,0,1] neg_hi:[0,0,1]
v_pk_fma_f32 v[204:205], v[216:217], v[212:213], v[204:205] op_sel_hi:[0,1,1] neg_lo:[0,0,1] neg_hi:[0,0,1]
v_pk_fma_f32 v[206:207], v[216:217], v[214:215], v[206:207] op_sel_hi:[0,1,1] neg_lo:[0,0,1] neg_hi:[0,0,1]
v_cvt_pk_bf16_f32 v120, v200, v201
v_cvt_pk_bf16_f32 v121, v202, v203
v_cvt_pk_bf16_f32 v122, v204, v205
v_cvt_pk_bf16_f32 v123, v206, v207
v_pk_fma_f32 v[208:209], v[216:217], v[200:201], v[208:209] op_sel_hi:[0,1,1] neg_lo:[0,0,1] neg_hi:[0,0,1]
v_pk_fma_f32 v[210:211], v[216:217], v[202:203], v[210:211] op_sel_hi:[0,1,1] neg_lo:[0,0,1] neg_hi:[0,0,1]
v_pk_fma_f32 v[212:213], v[216:217], v[204:205], v[212:213] op_sel_hi:[0,1,1] neg_lo:[0,0,1] neg_hi:[0,0,1]
v_pk_fma_f32 v[214:215], v[216:217], v[206:207], v[214:215] op_sel_hi:[0,1,1] neg_lo:[0,0,1] neg_hi:[0,0,1]
v_cvt_pk_bf16_f32 v124, v208, v209
v_cvt_pk_bf16_f32 v125, v210, v211
v_cvt_pk_bf16_f32 v126, v212, v213
v_cvt_pk_bf16_f32 v127, v214, v215
v_pk_fma_f32 v[200:201], v[216:217], v[208:209], v[200:201] op_sel_hi:[0,1,1] neg_lo:[0,0,1] neg_hi:[0,0,1]
v_pk_fma_f32 v[202:203], v[216:217], v[210:211], v[202:203] op_sel_hi:[0,1,1] neg_lo:[0,0,1] neg_hi:[0,0,1]
v_pk_fma_f32 v[204:205], v[216:217], v[212:213], v[204:205] op_sel_hi:[0,1,1] neg_lo:[0,0,1] neg_hi:[0,0,1]
v_pk_fma_f32 v[206:207], v[216:217], v[214:215], v[206:207] op_sel_hi:[0,1,1] neg_lo:[0,0,1] neg_hi:[0,0,1]
v_cvt_pk_bf16_f32 v128, v200, v201
v_cvt_pk_bf16_f32 v129, v202, v203
v_cvt_pk_bf16_f32 v130, v204, v205
v_cvt_pk_bf16_f32 v131, v206, v207
v_pk_fma_f32 v[208:209], v[216:217], v[200:201], v[208:209] op_sel_hi:[0,1,1] neg_lo:[0,0,1] neg_hi:[0,0,1]
v_pk_fma_f32 v[210:211], v[216:217], v[202:203], v[210:211] op_sel_hi:[0,1,1] neg_lo:[0,0,1] neg_hi:[0,0,1]
v_pk_fma_f32 v[212:213], v[216:217], v[204:205], v[212:213] op_sel_hi:[0,1,1] neg_lo:[0,0,1] neg_hi:[0,0,1]
v_pk_fma_f32 v[214:215], v[216:217], v[206:207], v[214:215] op_sel_hi:[0,1,1] neg_lo:[0,0,1] neg_hi:[0,0,1]
v_cvt_pk_bf16_f32 v132, v208, v209
v_cvt_pk_bf16_f32 v133, v210, v211
v_cvt_pk_bf16_f32 v134, v212, v213
v_cvt_pk_bf16_f32 v135, v214, v215
v_pk_fma_f32 v[200:201], v[216:217], v[208:209], v[200:201] op_sel_hi:[0,1,1] neg_lo:[0,0,1] neg_hi:[0,0,1]
v_pk_fma_f32 v[202:203], v[216:217], v[210:211], v[202:203] op_sel_hi:[0,1,1] neg_lo:[0,0,1] neg_hi:[0,0,1]
v_pk_fma_f32 v[204:205], v[216:217], v[212:213], v[204:205] op_sel_hi:[0,1,1] neg_lo:[0,0,1] neg_hi:[0,0,1]
v_pk_fma_f32 v[206:207], v[216:217], v[214:215], v[206:207] op_sel_hi:[0,1,1] neg_lo:[0,0,1] neg_hi:[0,0,1]
v_cvt_pk_bf16_f32 v136, v200, v201
v_cvt_pk_bf16_f32 v137, v202, v203
v_cvt_pk_bf16_f32 v138, v204, v205
v_cvt_pk_bf16_f32 v139, v206, v207
v_pk_fma_f32 v[208:209], v[216:217], v[200:201], v[208:209] op_sel_hi:[0,1,1] neg_lo:[0,0,1] neg_hi:[0,0,1]
v_pk_fma_f32 v[210:211], v[216:217], v[202:203], v[210:211] op_sel_hi:[0,1,1] neg_lo:[0,0,1] neg_hi:[0,0,1]
v_pk_fma_f32 v[212:213], v[216:217], v[204:205], v[212:213] op_sel_hi:[0,1,1] neg_lo:[0,0,1] neg_hi:[0,0,1]
v_pk_fma_f32 v[214:215], v[216:217], v[206:207], v[214:215] op_sel_hi:[0,1,1] neg_lo:[0,0,1] neg_hi:[0,0,1]
v_cvt_pk_bf16_f32 v140, v208, v209
v_cvt_pk_bf16_f32 v141, v210, v211
v_cvt_pk_bf16_f32 v142, v212, v213
v_cvt_pk_bf16_f32 v143, v214, v215
v_pk_fma_f32 v[200:201], v[216:217], v[208:209], v[200:201] op_sel_hi:[0,1,1] neg_lo:[0,0,1] neg_hi:[0,0,1]
v_pk_fma_f32 v[202:203], v[216:217], v[210:211], v[202:203] op_sel_hi:[0,1,1] neg_lo:[0,0,1] neg_hi:[0,0,1]
v_pk_fma_f32 v[204:205], v[216:217], v[212:213], v[204:205] op_sel_hi:[0,1,1] neg_lo:[0,0,1] neg_hi:[0,0,1]
v_pk_fma_f32 v[206:207], v[216:217], v[214:215], v[206:207] op_sel_hi:[0,1,1] neg_lo:[0,0,1] neg_hi:[0,0,1]
v_cvt_pk_bf16_f32 v144, v200, v201
v_cvt_pk_bf16_f32 v145, v202, v203
v_cvt_pk_bf16_f32 v146, v204, v205
v_cvt_pk_bf16_f32 v147, v206, v207
v_pk_fma_f32 v[208:209], v[216:217], v[200:201], v[208:209] op_sel_hi:[0,1,1] neg_lo:[0,0,1] neg_hi:[0,0,1]
v_pk_fma_f32 v[210:211], v[216:217], v[202:203], v[210:211] op_sel_hi:[0,1,1] neg_lo:[0,0,1] neg_hi:[0,0,1]
v_pk_fma_f32 v[212:213], v[216:217], v[204:205], v[212:213] op_sel_hi:[0,1,1] neg_lo:[0,0,1] neg_hi:[0,0,1]
v_pk_fma_f32 v[214:215], v[216:217], v[206:207], v[214:215] op_sel_hi:[0,1,1] neg_lo:[0,0,1] neg_hi:[0,0,1]
v_cvt_pk_bf16_f32 v148, v208, v209
v_cvt_pk_bf16_f32 v149, v210, v211
v_cvt_pk_bf16_f32 v150, v212, v213
v_cvt_pk_bf16_f32 v151, v214, v215
v_pk_fma_f32 v[200:201], v[216:217], v[208:209], v[200:201] op_sel_hi:[0,1,1] neg_lo:[0,0,1] neg_hi:[0,0,1]
v_pk_fma_f32 v[202:203], v[216:217], v[210:211], v[202:203] op_sel_hi:[0,1,1] neg_lo:[0,0,1] neg_hi:[0,0,1]
v_pk_fma_f32 v[204:205], v[216:217], v[212:213], v[204:205] op_sel_hi:[0,1,1] neg_lo:[0,0,1] neg_hi:[0,0,1]
v_pk_fma_f32 v[206:207], v[216:217], v[214:215], v[206:207] op_sel_hi:[0,1,1] neg_lo:[0,0,1] neg_hi:[0,0,1]
v_cvt_pk_bf16_f32 v152, v200, v201
v_cvt_pk_bf16_f32 v153, v202, v203
v_cvt_pk_bf16_f32 v154, v204, v205
v_cvt_pk_bf16_f32 v155, v206, v207
v_pk_fma_f32 v[208:209], v[216:217], v[200:201], v[208:209] op_sel_hi:[0,1,1] neg_lo:[0,0,1] neg_hi:[0,0,1]
v_pk_fma_f32 v[210:211], v[216:217], v[202:203], v[210:211] op_sel_hi:[0,1,1] neg_lo:[0,0,1] neg_hi:[0,0,1]
v_pk_fma_f32 v[212:213], v[216:217], v[204:205], v[212:213] op_sel_hi:[0,1,1] neg_lo:[0,0,1] neg_hi:[0,0,1]
v_pk_fma_f32 v[214:215], v[216:217], v[206:207], v[214:215] op_sel_hi:[0,1,1] neg_lo:[0,0,1] neg_hi:[0,0,1]
v_cvt_pk_bf16_f32 v156, v208, v209
v_cvt_pk_bf16_f32 v157, v210, v211
v_cvt_pk_bf16_f32 v158, v212, v213
v_cvt_pk_bf16_f32 v159, v214, v215
v_pk_fma_f32 v[200:201], v[216:217], v[208:209], v[200:201] op_sel_hi:[0,1,1] neg_lo:[0,0,1] neg_hi:[0,0,1]
v_pk_fma_f32 v[202:203], v[216:217], v[210:211], v[202:203] op_sel_hi:[0,1,1] neg_lo:[0,0,1] neg_hi:[0,0,1]
v_pk_fma_f32 v[204:205], v[216:217], v[212:213], v[204:205] op_sel_hi:[0,1,1] neg_lo:[0,0,1] neg_hi:[0,0,1]
v_pk_fma_f32 v[206:207], v[216:217], v[214:215], v[206:207] op_sel_hi:[0,1,1] neg_lo:[0,0,1] neg_hi:[0,0,1]
v_cvt_pk_bf16_f32 v160, v200, v201
v_cvt_pk_bf16_f32 v161, v202, v203
v_cvt_pk_bf16_f32 v162, v204, v205
v_cvt_pk_bf16_f32 v163, v206, v207
v_pk_fma_f32 v[208:209], v[216:217], v[200:201], v[208:209] op_sel_hi:[0,1,1] neg_lo:[0,0,1] neg_hi:[0,0,1]
v_pk_fma_f32 v[210:211], v[216:217], v[202:203], v[210:211] op_sel_hi:[0,1,1] neg_lo:[0,0,1] neg_hi:[0,0,1]
v_pk_fma_f32 v[212:213], v[216:217], v[204:205], v[212:213] op_sel_hi:[0,1,1] neg_lo:[0,0,1] neg_hi:[0,0,1]
v_pk_fma_f32 v[214:215], v[216:217], v[206:207], v[214:215] op_sel_hi:[0,1,1] neg_lo:[0,0,1] neg_hi:[0,0,1]
v_cvt_pk_bf16_f32 v164, v208, v209
v_cvt_pk_bf16_f32 v165, v210, v211
v_cvt_pk_bf16_f32 v166, v212, v213
v_cvt_pk_bf16_f32 v167, v214, v215
v_pk_fma_f32 v[200:201], v[216:217], v[208:209], v[200:201] op_sel_hi:[0,1,1] neg_lo:[0,0,1] neg_hi:[0,0,1]
v_pk_fma_f32 v[202:203], v[216:217], v[210:211], v[202:203] op_sel_hi:[0,1,1] neg_lo:[0,0,1] neg_hi:[0,0,1]
v_pk_fma_f32 v[204:205], v[216:217], v[212:213], v[204:205] op_sel_hi:[0,1,1] neg_lo:[0,0,1] neg_hi:[0,0,1]
v_pk_fma_f32 v[206:207], v[216:217], v[214:215], v[206:207] op_sel_hi:[0,1,1] neg_lo:[0,0,1] neg_hi:[0,0,1]
v_cvt_pk_bf16_f32 v168, v200, v201
v_cvt_pk_bf16_f32 v169, v202, v203
v_cvt_pk_bf16_f32 v170, v204, v205
v_cvt_pk_bf16_f32 v171, v206, v207
v_pk_fma_f32 v[208:209], v[216:217], v[200:201], v[208:209] op_sel_hi:[0,1,1] neg_lo:[0,0,1] neg_hi:[0,0,1]
v_pk_fma_f32 v[210:211], v[216:217], v[202:203], v[210:211] op_sel_hi:[0,1,1] neg_lo:[0,0,1] neg_hi:[0,0,1]
v_pk_fma_f32 v[212:213], v[216:217], v[204:205], v[212:213] op_sel_hi:[0,1,1] neg_lo:[0,0,1] neg_hi:[0,0,1]
v_pk_fma_f32 v[214:215], v[216:217], v[206:207], v[214:215] op_sel_hi:[0,1,1] neg_lo:[0,0,1] neg_hi:[0,0,1]
s_mov_b32 exec_lo, 0
v_mul_f32 v214, 0.5, v214
s_mov_b32 exec_lo, -1
v_cvt_pk_bf16_f32 v172, v208, v209
v_cvt_pk_bf16_f32 v173, v210, v211
v_cvt_pk_bf16_f32 v174, v212, v213
v_cvt_pk_bf16_f32 v175, v214, v215
v_and_b32 v1, 0x2f0, v0
v_bfe_u32 v3, v0, 8, 1
v_lshl_add_u32 v1, v3, 3, v1
s_mul_i32 s18, s50, 40960
s_mul_i32 s19, s16, 3145728
s_add_u32 s26, s18, s19
s_add_u32 s27, s26, s19
s_add_u32 s27, s27, s33
s_add_u32 s27, s27, 88080384
s_add_u32 s26, s26, s31
s_add_u32 s26, s26, 103809024
s_lshl_b32 s19, s16, 6
s_add_u32 s19, s19, s50
s_mul_i32 s19, s19, 5120
s_lshr_b32 s36, s33, 3
s_add_u32 s36, s36, s19
s_add_u32 s36, s36, 163577856
s_mov_b32 s43, 0x20000
s_cmp_lg_u32 s16, 0
s_cbranch_scc1 rs_47
s_mov_b64 s[40:41], s[44:45]
s_mov_b32 s42, s46
s_lshr_b32 s51, s33, 5
s_add_u32 s51, s51, s18
s_add_u32 s52, s51, 32
v_mov_b32 v13, v5
s_branch rs_48
rs_47:
s_mov_b64 s[40:41], s[4:5]
s_mov_b32 s42, s6
s_sub_u32 s51, s27, 3145728
s_add_u32 s52, s51, 1024
v_mov_b32 v13, v0
rs_48:
s_cmp_lg_u32 s13, 0
s_cbranch_scc1 polld_50
v_min_u32 v12, 624, v0
s_mov_b32 s21, 7168
s_mov_b32 s17, 0
poll_49:
buffer_load_dwordx4 v[8:11], v12, s[4:7], s21 offen offset:0 sc1
s_add_u32 s17, s17, 1
s_cmp_gt_u32 s17, 262144
s_cbranch_scc1 L_fail
s_waitcnt vmcnt(0)
v_min3_u32 v8, v8, v9, v10
v_min_u32 v8, v8, v11
v_cmp_gt_u32 vcc, s29, v8
s_cbranch_vccz polld_50
s_sleep 2
s_branch poll_49
polld_50:
s_barrier
s_add_u32 m0, s31, 2048
s_add_u32 s20, s26, 0
buffer_load_dwordx4 v0, s[4:7], s20 offen sc1 lds
s_add_u32 m0, s31, 3072
s_add_u32 s20, s26, 1024
buffer_load_dwordx4 v0, s[4:7], s20 offen sc1 lds
s_add_u32 m0, s31, 4096
s_add_u32 s20, s26, 2048
buffer_load_dwordx4 v0, s[4:7], s20 offen sc1 lds
s_add_u32 m0, s31, 5120
s_add_u32 s20, s26, 3072
buffer_load_dwordx4 v0, s[4:7], s20 offen sc1 lds
s_add_u32 m0, s31, 6144
s_add_u32 s20, s26, 4096
buffer_load_dwordx4 v0, s[4:7], s20 offen sc1 lds
s_add_u32 m0, s31, 7168
s_add_u32 s20, s26, 5120
buffer_load_dwordx4 v0, s[4:7], s20 offen sc1 lds
s_add_u32 m0, s31, 8192
s_add_u32 s20, s26, 6144
buffer_load_dwordx4 v0, s[4:7], s20 offen sc1 lds
s_add_u32 m0, s31, 9216
s_add_u32 s20, s26, 7168
buffer_load_dwordx4 v0, s[4:7], s20 offen sc1 lds
s_add_u32 m0, s31, 10240
s_add_u32 s20, s26, 8192
buffer_load_dwordx4 v0, s[4:7], s20 offen sc1 lds
s_add_u32 m0, s31, 11264
s_add_u32 s20, s26, 9216
buffer_load_dwordx4 v0, s[4:7], s20 offen sc1 lds
s_add_u32 s26, s26, 1310720
s_add_u32 s25, s31, 40960
s_mov_b32 s28, 0
s_waitcnt vmcnt(0)
p3_51:
s_barrier
ds_read_b64_tr_b16 v[216:217], v1 offset:2048
ds_read_b64_tr_b16 v[218:219], v1 offset:2304
ds_read_b64_tr_b16 v[222:223], v1 offset:3328
ds_read_b64_tr_b16 v[220:221], v1 offset:3072
buffer_load_dwordx4 v[176:179], v13, s[40:43], s51 offen sc1
ds_read_b64_tr_b16 v[224:225], v1 offset:4096
buffer_load_dwordx4 v[180:183], v13, s[40:43], s52 offen sc1
ds_read_b64_tr_b16 v[230:231], v1 offset:5376
ds_read_b64_tr_b16 v[226:227], v1 offset:4352
s_add_u32 m0, s25, 2048
s_add_u32 s20, s26, 0
buffer_load_dwordx4 v0, s[4:7], s20 offen sc1 lds
s_waitcnt lgkmcnt(5)
v_mfma_f32_32x32x16_bf16 v[200:215], v[16:19], v[216:219], 0
s_waitcnt lgkmcnt(4)
ds_read_b64_tr_b16 v[228:229], v1 offset:5120
ds_read_b64_tr_b16 v[218:219], v1 offset:6400
s_add_u32 m0, s25, 3072
s_add_u32 s20, s26, 1024
buffer_load_dwordx4 v0, s[4:7], s20 offen sc1 lds
s_waitcnt lgkmcnt(4)
v_mfma_f32_32x32x16_bf16 v[200:215], v[20:23], v[220:223], v[200:215]
s_add_u32 m0, s25, 4096
s_add_u32 s20, s26, 2048
buffer_load_dwordx4 v0, s[4:7], s20 offen sc1 lds
ds_read_b64_tr_b16 v[216:217], v1 offset:6144
s_waitcnt lgkmcnt(3)
ds_read_b64_tr_b16 v[222:223], v1 offset:7424
v_mfma_f32_32x32x16_bf16 v[200:215], v[24:27], v[224:227], v[200:215]
s_waitcnt lgkmcnt(3)
ds_read_b64_tr_b16 v[220:221], v1 offset:7168
ds_read_b64_tr_b16 v[224:225], v1 offset:8192
s_waitcnt lgkmcnt(4)
v_mfma_f32_32x32x16_bf16 v[200:215], v[28:31], v[228:231], v[200:215]
s_add_u32 m0, s25, 5120
s_add_u32 s20, s26, 3072
buffer_load_dwordx4 v0, s[4:7], s20 offen sc1 lds
s_waitcnt lgkmcnt(3)
ds_read_b64_tr_b16 v[226:227], v1 offset:8448
ds_read_b64_tr_b16 v[230:231], v1 offset:9472
ds_read_b64_tr_b16 v[228:229], v1 offset:9216
v_mfma_f32_32x32x16_bf16 v[200:215], v[32:35], v[216:219], v[200:215]
ds_read_b64_tr_b16 v[216:217], v1 offset:10240
s_waitcnt lgkmcnt(5)
v_mfma_f32_32x32x16_bf16 v[200:215], v[36:39], v[220:223], v[200:215]
ds_read_b64_tr_b16 v[220:221], v1 offset:11264
s_waitcnt lgkmcnt(4)
ds_read_b64_tr_b16 v[218:219], v1 offset:10496
v_mfma_f32_32x32x16_bf16 v[200:215], v[40:43], v[224:227], v[200:215]
ds_read_b64_tr_b16 v[222:223], v1 offset:11520
ds_read_b64_tr_b16 v[224:225], v1 offset:12288
s_waitcnt lgkmcnt(5)
v_mfma_f32_32x32x16_bf16 v[200:215], v[44:47], v[228:231], v[200:215]
ds_read_b64_tr_b16 v[228:229], v1 offset:13312
ds_read_b64_tr_b16 v[226:227], v1 offset:12544
s_waitcnt lgkmcnt(6)
s_waitcnt lgkmcnt(4)
ds_read_b64_tr_b16 v[230:231], v1 offset:13568
v_mfma_f32_32x32x16_bf16 v[200:215], v[48:51], v[216:219], v[200:215]
ds_read_b64_tr_b16 v[218:219], v1 offset:14592
s_add_u32 m0, s25, 6144
s_add_u32 s20, s26, 4096
buffer_load_dwordx4 v0, s[4:7], s20 offen sc1 lds
s_waitcnt lgkmcnt(5)
ds_read_b64_tr_b16 v[216:217], v1 offset:14336
v_mfma_f32_32x32x16_bf16 v[200:215], v[52:55], v[220:223], v[200:215]
ds_read_b64_tr_b16 v[222:223], v1 offset:15616
s_waitcnt lgkmcnt(4)
s_add_u32 m0, s25, 7168
s_add_u32 s20, s26, 5120
buffer_load_dwordx4 v0, s[4:7], s20 offen sc1 lds
ds_read_b64_tr_b16 v[220:221], v1 offset:15360
v_mfma_f32_32x32x16_bf16 v[200:215], v[56:59], v[224:227], v[200:215]
s_waitcnt lgkmcnt(4)
ds_read_b64_tr_b16 v[226:227], v1 offset:16640
ds_read_b64_tr_b16 v[224:225], v1 offset:16384
s_waitcnt lgkmcnt(5)
s_waitcnt lgkmcnt(4)
v_mfma_f32_32x32x16_bf16 v[200:215], v[60:63], v[228:231], v[200:215]
v_mfma_f32_32x32x16_bf16 v[200:215], v[64:67], v[216:219], v[200:215]
s_waitcnt lgkmcnt(2)
ds_read_b64_tr_b16 v[218:219], v1 offset:18688
s_waitcnt lgkmcnt(1)
ds_read_b64_tr_b16 v[230:231], v1 offset:17664
ds_read_b64_tr_b16 v[228:229], v1 offset:17408
ds_read_b64_tr_b16 v[216:217], v1 offset:18432
v_mfma_f32_32x32x16_bf16 v[200:215], v[68:71], v[220:223], v[200:215]
v_mfma_f32_32x32x16_bf16 v[200:215], v[72:75], v[224:227], v[200:215]
s_waitcnt lgkmcnt(3)
ds_read_b64_tr_b16 v[224:225], v1 offset:20480
ds_read_b64_tr_b16 v[226:227], v1 offset:20736
ds_read_b64_tr_b16 v[222:223], v1 offset:19712
s_waitcnt lgkmcnt(4)
ds_read_b64_tr_b16 v[220:221], v1 offset:19456
v_mfma_f32_32x32x16_bf16 v[200:215], v[76:79], v[228:231], v[200:215]
ds_read_b64_tr_b16 v[230:231], v1 offset:21760
s_waitcnt lgkmcnt(5)
ds_read_b64_tr_b16 v[228:229], v1 offset:21504
v_mfma_f32_32x32x16_bf16 v[200:215], v[80:83], v[216:219], v[200:215]
ds_read_b64_tr_b16 v[218:219], v1 offset:22784
s_waitcnt lgkmcnt(3)
ds_read_b64_tr_b16 v[216:217], v1 offset:22528
v_mfma_f32_32x32x16_bf16 v[200:215], v[84:87], v[220:223], v[200:215]
ds_read_b64_tr_b16 v[220:221], v1 offset:23552
s_waitcnt lgkmcnt(4)
ds_read_b64_tr_b16 v[222:223], v1 offset:23808
v_mfma_f32_32x32x16_bf16 v[200:215], v[88:91], v[224:227], v[200:215]
s_add_u32 m0, s25, 8192
s_add_u32 s20, s26, 6144
buffer_load_dwordx4 v0, s[4:7], s20 offen sc1 lds
s_waitcnt lgkmcnt(2)
ds_read_b64_tr_b16 v[224:225], v1 offset:24576
ds_read_b64_tr_b16 v[226:227], v1 offset:24832
v_mfma_f32_32x32x16_bf16 v[200:215], v[92:95], v[228:231], v[200:215]
s_waitcnt lgkmcnt(3)
ds_read_b64_tr_b16 v[230:231], v1 offset:25856
s_waitcnt lgkmcnt(3)
v_mfma_f32_32x32x16_bf16 v[200:215], v[96:99], v[216:219], v[200:215]
s_waitcnt lgkmcnt(2)
ds_read_b64_tr_b16 v[228:229], v1 offset:25600
ds_read_b64_tr_b16 v[218:219], v1 offset:26880
v_mfma_f32_32x32x16_bf16 v[200:215], v[100:103], v[220:223], v[200:215]
ds_read_b64_tr_b16 v[216:217], v1 offset:26624
ds_read_b64_tr_b16 v[222:223], v1 offset:27904
ds_read_b64_tr_b16 v[220:221], v1 offset:27648
s_waitcnt lgkmcnt(6)
v_mfma_f32_32x32x16_bf16 v[200:215], v[104:107], v[224:227], v[200:215]
s_waitcnt lgkmcnt(4)
ds_read_b64_tr_b16 v[224:225], v1 offset:28672
ds_read_b64_tr_b16 v[226:227], v1 offset:28928
s_waitcnt lgkmcnt(5)
v_mfma_f32_32x32x16_bf16 v[200:215], v[108:111], v[228:231], v[200:215]
ds_read_b64_tr_b16 v[228:229], v1 offset:29696
s_waitcnt lgkmcnt(5)
v_mfma_f32_32x32x16_bf16 v[200:215], v[112:115], v[216:219], v[200:215]
s_waitcnt lgkmcnt(4)
s_waitcnt lgkmcnt(1)
ds_read_b64_tr_b16 v[218:219], v1 offset:30976
ds_read_b64_tr_b16 v[230:231], v1 offset:29952
v_mfma_f32_32x32x16_bf16 v[200:215], v[116:119], v[220:223], v[200:215]
s_add_u32 m0, s25, 9216
s_add_u32 s20, s26, 7168
buffer_load_dwordx4 v0, s[4:7], s20 offen sc1 lds
ds_read_b64_tr_b16 v[216:217], v1 offset:30720
ds_read_b64_tr_b16 v[220:221], v1 offset:31744
s_waitcnt lgkmcnt(4)
v_mfma_f32_32x32x16_bf16 v[200:215], v[120:123], v[224:227], v[200:215]
ds_read_b64_tr_b16 v[226:227], v1 offset:33024
ds_read_b64_tr_b16 v[222:223], v1 offset:32000
ds_read_b64_tr_b16 v[224:225], v1 offset:32768
s_waitcnt lgkmcnt(5)
v_lshrrev_b32 v2, 2, v0
v_mfma_f32_32x32x16_bf16 v[200:215], v[124:127], v[228:231], v[200:215]
s_add_u32 m0, s25, 10240
s_add_u32 s20, s26, 8192
buffer_load_dwordx4 v0, s[4:7], s20 offen sc1 lds
s_waitcnt lgkmcnt(4)
ds_read_b64_tr_b16 v[228:229], v1 offset:33792
s_waitcnt lgkmcnt(4)
v_mfma_f32_32x32x16_bf16 v[200:215], v[128:131], v[216:219], v[200:215]
s_waitcnt lgkmcnt(3)
s_waitcnt lgkmcnt(2)
ds_read_b64_tr_b16 v[230:231], v1 offset:34048
ds_read_b64_tr_b16 v[216:217], v1 offset:34816
ds_read_b64_tr_b16 v[218:219], v1 offset:35072
v_mfma_f32_32x32x16_bf16 v[200:215], v[132:135], v[220:223], v[200:215]
s_waitcnt vmcnt(10)
s_waitcnt lgkmcnt(4)
ds_read_b64_tr_b16 v[220:221], v1 offset:35840
s_add_u32 m0, s25, 11264
s_add_u32 s20, s26, 9216
buffer_load_dwordx4 v0, s[4:7], s20 offen sc1 lds
v_mfma_f32_32x32x16_bf16 v[200:215], v[136:139], v[224:227], v[200:215]
ds_read_b64_tr_b16 v[222:223], v1 offset:36096
ds_read_b64_tr_b16 v[226:227], v1 offset:37120
v_and_b32 v187, 0xffff0000, v177
s_waitcnt lgkmcnt(5)
v_lshlrev_b32 v184, 16, v176
s_waitcnt vmcnt(10)
v_mfma_f32_32x32x16_bf16 v[200:215], v[140:143], v[228:231], v[200:215]
s_waitcnt lgkmcnt(3)
ds_read_b64_tr_b16 v[230:231], v1 offset:38144
ds_read_b64_tr_b16 v[224:225], v1 offset:36864
s_waitcnt lgkmcnt(4)
ds_read_b64_tr_b16 v[228:229], v1 offset:37888
v_mfma_f32_32x32x16_bf16 v[200:215], v[144:147], v[216:219], v[200:215]
s_waitcnt lgkmcnt(3)
ds_read_b64_tr_b16 v[218:219], v1 offset:39168
ds_read_b64_tr_b16 v[216:217], v1 offset:38912
v_and_b32 v199, 0xffff0000, v183
v_mfma_f32_32x32x16_bf16 v[200:215], v[148:151], v[220:223], v[200:215]
s_waitcnt lgkmcnt(4)
s_waitcnt lgkmcnt(3)
s_waitcnt lgkmcnt(2)
v_lshlrev_b32 v198, 16, v183
v_and_b32 v189, 0xffff0000, v178
v_and_b32 v197, 0xffff0000, v182
v_mfma_f32_32x32x16_bf16 v[200:215], v[152:155], v[224:227], v[200:215]
ds_read_b64_tr_b16 v[220:221], v1 offset:39936
s_waitcnt lgkmcnt(2)
ds_read_b64_tr_b16 v[224:225], v1 offset:40960
ds_read_b64_tr_b16 v[222:223], v1 offset:40192
v_mfma_f32_32x32x16_bf16 v[200:215], v[156:159], v[228:231], v[200:215]
s_waitcnt lgkmcnt(3)
ds_read_b64_tr_b16 v[230:231], v1 offset:42240
ds_read_b64_tr_b16 v[226:227], v1 offset:41216
v_mfma_f32_32x32x16_bf16 v[200:215], v[160:163], v[216:219], v[200:215]
ds_read_b64_tr_b16 v[228:229], v1 offset:41984
s_waitcnt lgkmcnt(3)
v_and_b32 v193, 0xffff0000, v180
v_lshlrev_b32 v186, 16, v177
v_and_b32 v191, 0xffff0000, v179
v_mfma_f32_32x32x16_bf16 v[200:215], v[164:167], v[220:223], v[200:215]
s_waitcnt lgkmcnt(1)
v_lshlrev_b32 v196, 16, v182
v_mfma_f32_32x32x16_bf16 v[200:215], v[168:171], v[224:227], v[200:215]
v_lshlrev_b32 v188, 16, v178
s_waitcnt lgkmcnt(0)
v_lshlrev_b32 v194, 16, v181
v_mfma_f32_32x32x16_bf16 v[200:215], v[172:175], v[228:231], v[200:215]
s_nop 0
v_lshlrev_b32 v190, 16, v179
v_lshlrev_b32 v192, 16, v180
v_and_b32 v185, 0xffff0000, v176
v_and_b32 v195, 0xffff0000, v181
v_mov_b32 v176, 0x3b4ccccd
s_nop 5
v_pk_fma_f32 v[200:201], v[200:201], v[176:177], v[184:185] op_sel_hi:[1,0,1]
v_pk_fma_f32 v[202:203], v[202:203], v[176:177], v[186:187] op_sel_hi:[1,0,1]
v_pk_fma_f32 v[204:205], v[204:205], v[176:177], v[188:189] op_sel_hi:[1,0,1]
v_pk_mul_f32 v[180:181], v[200:201], v[200:201]
v_pk_fma_f32 v[206:207], v[206:207], v[176:177], v[190:191] op_sel_hi:[1,0,1]
v_pk_add_f32 v[178:179], v[200:201], v[202:203]
v_pk_fma_f32 v[208:209], v[208:209], v[176:177], v[192:193] op_sel_hi:[1,0,1]
v_pk_add_f32 v[178:179], v[178:179], v[204:205]
v_pk_add_f32 v[178:179], v[178:179], v[206:207]
v_pk_fma_f32 v[180:181], v[202:203], v[202:203], v[180:181]
v_pk_fma_f32 v[180:181], v[204:205], v[204:205], v[180:181]
v_pk_fma_f32 v[210:211], v[210:211], v[176:177], v[194:195] op_sel_hi:[1,0,1]
v_pk_fma_f32 v[180:181], v[206:207], v[206:207], v[180:181]
v_pk_add_f32 v[178:179], v[178:179], v[208:209]
v_pk_fma_f32 v[180:181], v[208:209], v[208:209], v[180:181]
v_pk_add_f32 v[178:179], v[178:179], v[210:211]
v_pk_fma_f32 v[180:181], v[210:211], v[210:211], v[180:181]
v_pk_fma_f32 v[214:215], v[214:215], v[176:177], v[198:199] op_sel_hi:[1,0,1]
v_pk_fma_f32 v[212:213], v[212:213], v[176:177], v[196:197] op_sel_hi:[1,0,1]
v_pk_add_f32 v[178:179], v[178:179], v[212:213]
v_pk_add_f32 v[178:179], v[178:179], v[214:215]
v_pk_fma_f32 v[180:181], v[212:213], v[212:213], v[180:181]
v_add_f32 v178, v178, v179
v_pk_fma_f32 v[180:181], v[214:215], v[214:215], v[180:181]
v_add_f32 v180, v180, v181
v_cvt_pk_bf16_f32 v220, v208, v209
v_cvt_pk_bf16_f32 v221, v210, v211
v_permlane32_swap_b32 v178, v180
v_cvt_pk_bf16_f32 v223, v214, v215
v_cvt_pk_bf16_f32 v222, v212, v213
v_cvt_pk_bf16_f32 v219, v206, v207
v_cvt_pk_bf16_f32 v216, v200, v201
v_cvt_pk_bf16_f32 v218, v204, v205
v_add_f32 v178, v178, v180
v_cvt_pk_bf16_f32 v217, v202, v203
buffer_store_dwordx4 v[216:219], v0, s[4:7], s27 offen offset:0 sc1
buffer_store_dwordx4 v[220:223], v0, s[4:7], s27 offen offset:1024 sc1
buffer_store_dword v178, v2, s[4:7], s36 offen sc1
v_xor_b32 v1, 40960, v1
s_mov_b32 s26, s6
s_mov_b32 s25, s31
s_add_u32 s27, s27, 1310720
s_add_u32 s36, s36, 163840
s_add_u32 s51, s51, 1310720
s_add_u32 s52, s52, 1310720
s_add_u32 s28, s28, 1
s_lshl_b32 s18, s39, 2
s_add_u32 s18, s18, 8192
s_lshl_b32 s19, s16, 1
s_add_u32 s19, s19, s28
s_cmp_eq_u32 s13, 0
s_cselect_b32 s22, s18, s6
s_mov_b32 s23, s19
s_waitcnt vmcnt(0)
s_barrier
v_mov_b32 v3, s23
s_mov_b64 exec, 1
buffer_store_dword v3, off, s[4:7], s22 sc1
s_mov_b64 exec, -1
s_mov_b32 s22, s6
s_cmp_lt_u32 s28, 2
s_cbranch_scc1 p3_51
s_cmp_ge_u32 s39, 144
s_cbranch_scc1 p1b_53
s_cmp_ge_u32 s39, 64
s_cbranch_scc1 wo_52
s_and_b32 s32, s39, 31
s_cmp_lg_u32 s16, 0
s_cbranch_scc1 qw_56
s_lshl_b32 s26, s32, 8
s_lshl_b32 s18, s13, 6
s_add_u32 s26, s26, s18
s_load_dwordx2 s[40:41], s[0:1], 40
s_mov_b32 s42, 5242880
s_mov_b32 s43, 0x20000
s_waitcnt lgkmcnt(0)
v_lshrrev_b32 v34, 6, v0
v_mul_u32_u24 v34, 8192, v34
v_and_b32 v35, 48, v0
v_add_u32 v32, v34, v35
v_bfe_u32 v34, v0, 6, 2
v_lshrrev_b32 v35, 9, v0
v_lshl_add_u32 v34, v35, 3, v34
v_lshlrev_b32 v33, 6, v34
v_and_b32 v34, 16, v0
v_add_u32 v33, v33, v34
v_bfe_u32 v34, v0, 5, 1
v_lshl_add_u32 v33, v34, 3, v33
v_bfe_u32 v34, v0, 8, 1
v_lshl_add_u32 v33, v34, 5, v33
s_mul_i32 s18, s13, 36864
v_add_u32 v33, s18, v33
s_barrier
s_add_u32 m0, s18, 0
s_add_u32 s19, s26, 0
buffer_load_dwordx4 v32, s[40:43], s19 offen lds
s_add_u32 m0, s18, 1024
s_add_u32 s19, s26, 131072
buffer_load_dwordx4 v32, s[40:43], s19 offen lds
s_add_u32 m0, s18, 2048
s_add_u32 s19, s26, 262144
buffer_load_dwordx4 v32, s[40:43], s19 offen lds
s_add_u32 m0, s18, 3072
s_add_u32 s19, s26, 393216
buffer_load_dwordx4 v32, s[40:43], s19 offen lds
s_add_u32 m0, s18, 4096
s_add_u32 s19, s26, 524288
buffer_load_dwordx4 v32, s[40:43], s19 offen lds
s_add_u32 m0, s18, 5120
s_add_u32 s19, s26, 655360
buffer_load_dwordx4 v32, s[40:43], s19 offen lds
s_add_u32 m0, s18, 6144
s_add_u32 s19, s26, 786432
buffer_load_dwordx4 v32, s[40:43], s19 offen lds
s_add_u32 m0, s18, 7168
s_add_u32 s19, s26, 917504
buffer_load_dwordx4 v32, s[40:43], s19 offen lds
s_add_u32 m0, s18, 8192
s_add_u32 s19, s26, 1048576
buffer_load_dwordx4 v32, s[40:43], s19 offen lds
s_add_u32 m0, s18, 9216
s_add_u32 s19, s26, 1179648
buffer_load_dwordx4 v32, s[40:43], s19 offen lds
s_add_u32 m0, s18, 10240
s_add_u32 s19, s26, 1310720
buffer_load_dwordx4 v32, s[40:43], s19 offen lds
s_add_u32 m0, s18, 11264
s_add_u32 s19, s26, 1441792
buffer_load_dwordx4 v32, s[40:43], s19 offen lds
s_add_u32 m0, s18, 12288
s_add_u32 s19, s26, 1572864
buffer_load_dwordx4 v32, s[40:43], s19 offen lds
s_add_u32 m0, s18, 13312
s_add_u32 s19, s26, 1703936
buffer_load_dwordx4 v32, s[40:43], s19 offen lds
s_add_u32 m0, s18, 14336
s_add_u32 s19, s26, 1835008
buffer_load_dwordx4 v32, s[40:43], s19 offen lds
s_add_u32 m0, s18, 15360
s_add_u32 s19, s26, 1966080
buffer_load_dwordx4 v32, s[40:43], s19 offen lds
s_add_u32 m0, s18, 16384
s_add_u32 s19, s26, 2097152
buffer_load_dwordx4 v32, s[40:43], s19 offen lds
s_add_u32 m0, s18, 17408
s_add_u32 s19, s26, 2228224
buffer_load_dwordx4 v32, s[40:43], s19 offen lds
s_add_u32 m0, s18, 18432
s_add_u32 s19, s26, 2359296
buffer_load_dwordx4 v32, s[40:43], s19 offen lds
s_add_u32 m0, s18, 19456
s_add_u32 s19, s26, 2490368
buffer_load_dwordx4 v32, s[40:43], s19 offen lds
s_add_u32 m0, s18, 20480
s_add_u32 s19, s26, 2621440
buffer_load_dwordx4 v32, s[40:43], s19 offen lds
s_add_u32 m0, s18, 21504
s_add_u32 s19, s26, 2752512
buffer_load_dwordx4 v32, s[40:43], s19 offen lds
s_add_u32 m0, s18, 22528
s_add_u32 s19, s26, 2883584
buffer_load_dwordx4 v32, s[40:43], s19 offen lds
s_add_u32 m0, s18, 23552
s_add_u32 s19, s26, 3014656
buffer_load_dwordx4 v32, s[40:43], s19 offen lds
s_add_u32 m0, s18, 24576
s_add_u32 s19, s26, 3145728
buffer_load_dwordx4 v32, s[40:43], s19 offen lds
s_add_u32 m0, s18, 25600
s_add_u32 s19, s26, 3276800
buffer_load_dwordx4 v32, s[40:43], s19 offen lds
s_add_u32 m0, s18, 26624
s_add_u32 s19, s26, 3407872
buffer_load_dwordx4 v32, s[40:43], s19 offen lds
s_add_u32 m0, s18, 27648
s_add_u32 s19, s26, 3538944
buffer_load_dwordx4 v32, s[40:43], s19 offen lds
s_add_u32 m0, s18, 28672
s_add_u32 s19, s26, 3670016
buffer_load_dwordx4 v32, s[40:43], s19 offen lds
s_add_u32 m0, s18, 29696
s_add_u32 s19, s26, 3801088
buffer_load_dwordx4 v32, s[40:43], s19 offen lds
s_add_u32 m0, s18, 30720
s_add_u32 s19, s26, 3932160
buffer_load_dwordx4 v32, s[40:43], s19 offen lds
s_add_u32 m0, s18, 31744
s_add_u32 s19, s26, 4063232
buffer_load_dwordx4 v32, s[40:43], s19 offen lds
s_add_u32 m0, s18, 32768
s_add_u32 s19, s26, 4194304
buffer_load_dwordx4 v32, s[40:43], s19 offen lds
s_add_u32 m0, s18, 33792
s_add_u32 s19, s26, 4325376
buffer_load_dwordx4 v32, s[40:43], s19 offen lds
s_add_u32 m0, s18, 34816
s_add_u32 s19, s26, 4456448
buffer_load_dwordx4 v32, s[40:43], s19 offen lds
s_add_u32 m0, s18, 35840
s_add_u32 s19, s26, 4587520
buffer_load_dwordx4 v32, s[40:43], s19 offen lds
s_waitcnt vmcnt(32)
ds_read_b64_tr_b16 a[0:1], v33 offset:0
ds_read_b64_tr_b16 a[2:3], v33 offset:256
ds_read_b64_tr_b16 a[4:5], v33 offset:1024
ds_read_b64_tr_b16 a[6:7], v33 offset:1280
ds_read_b64_tr_b16 a[8:9], v33 offset:2048
ds_read_b64_tr_b16 a[10:11], v33 offset:2304
ds_read_b64_tr_b16 a[12:13], v33 offset:3072
ds_read_b64_tr_b16 a[14:15], v33 offset:3328
s_waitcnt lgkmcnt(0)
s_add_u32 m0, s18, 0
s_add_u32 s19, s26, 4718592
buffer_load_dwordx4 v32, s[40:43], s19 offen lds
s_add_u32 m0, s18, 1024
s_add_u32 s19, s26, 4849664
buffer_load_dwordx4 v32, s[40:43], s19 offen lds
s_add_u32 m0, s18, 2048
s_add_u32 s19, s26, 4980736
buffer_load_dwordx4 v32, s[40:43], s19 offen lds
s_add_u32 m0, s18, 3072
s_add_u32 s19, s26, 5111808
buffer_load_dwordx4 v32, s[40:43], s19 offen lds
s_waitcnt vmcnt(32)
ds_read_b64_tr_b16 a[16:17], v33 offset:4096
ds_read_b64_tr_b16 a[18:19], v33 offset:4352
ds_read_b64_tr_b16 a[20:21], v33 offset:5120
ds_read_b64_tr_b16 a[22:23], v33 offset:5376
ds_read_b64_tr_b16 a[24:25], v33 offset:6144
ds_read_b64_tr_b16 a[26:27], v33 offset:6400
ds_read_b64_tr_b16 a[28:29], v33 offset:7168
ds_read_b64_tr_b16 a[30:31], v33 offset:7424
s_waitcnt vmcnt(28)
ds_read_b64_tr_b16 a[32:33], v33 offset:8192
ds_read_b64_tr_b16 a[34:35], v33 offset:8448
ds_read_b64_tr_b16 a[36:37], v33 offset:9216
ds_read_b64_tr_b16 a[38:39], v33 offset:9472
ds_read_b64_tr_b16 a[40:41], v33 offset:10240
ds_read_b64_tr_b16 a[42:43], v33 offset:10496
ds_read_b64_tr_b16 a[44:45], v33 offset:11264
ds_read_b64_tr_b16 a[46:47], v33 offset:11520
s_waitcnt vmcnt(24)
ds_read_b64_tr_b16 a[48:49], v33 offset:12288
ds_read_b64_tr_b16 a[50:51], v33 offset:12544
ds_read_b64_tr_b16 a[52:53], v33 offset:13312
ds_read_b64_tr_b16 a[54:55], v33 offset:13568
ds_read_b64_tr_b16 a[56:57], v33 offset:14336
ds_read_b64_tr_b16 a[58:59], v33 offset:14592
ds_read_b64_tr_b16 a[60:61], v33 offset:15360
ds_read_b64_tr_b16 a[62:63], v33 offset:15616
s_waitcnt vmcnt(20)
ds_read_b64_tr_b16 a[64:65], v33 offset:16384
ds_read_b64_tr_b16 a[66:67], v33 offset:16640
ds_read_b64_tr_b16 a[68:69], v33 offset:17408
ds_read_b64_tr_b16 a[70:71], v33 offset:17664
ds_read_b64_tr_b16 a[72:73], v33 offset:18432
ds_read_b64_tr_b16 a[74:75], v33 offset:18688
ds_read_b64_tr_b16 a[76:77], v33 offset:19456
ds_read_b64_tr_b16 a[78:79], v33 offset:19712
s_waitcnt vmcnt(16)
ds_read_b64_tr_b16 a[80:81], v33 offset:20480
ds_read_b64_tr_b16 a[82:83], v33 offset:20736
ds_read_b64_tr_b16 a[84:85], v33 offset:21504
ds_read_b64_tr_b16 a[86:87], v33 offset:21760
ds_read_b64_tr_b16 a[88:89], v33 offset:22528
ds_read_b64_tr_b16 a[90:91], v33 offset:22784
ds_read_b64_tr_b16 a[92:93], v33 offset:23552
ds_read_b64_tr_b16 a[94:95], v33 offset:23808
s_waitcnt vmcnt(12)
ds_read_b64_tr_b16 a[96:97], v33 offset:24576
ds_read_b64_tr_b16 a[98:99], v33 offset:24832
ds_read_b64_tr_b16 a[100:101], v33 offset:25600
ds_read_b64_tr_b16 a[102:103], v33 offset:25856
ds_read_b64_tr_b16 a[104:105], v33 offset:26624
ds_read_b64_tr_b16 a[106:107], v33 offset:26880
ds_read_b64_tr_b16 a[108:109], v33 offset:27648
ds_read_b64_tr_b16 a[110:111], v33 offset:27904
s_waitcnt vmcnt(8)
ds_read_b64_tr_b16 a[112:113], v33 offset:28672
ds_read_b64_tr_b16 a[114:115], v33 offset:28928
ds_read_b64_tr_b16 a[116:117], v33 offset:29696
ds_read_b64_tr_b16 a[118:119], v33 offset:29952
ds_read_b64_tr_b16 a[120:121], v33 offset:30720
ds_read_b64_tr_b16 a[122:123], v33 offset:30976
ds_read_b64_tr_b16 a[124:125], v33 offset:31744
ds_read_b64_tr_b16 a[126:127], v33 offset:32000
s_waitcnt vmcnt(4)
ds_read_b64_tr_b16 a[128:129], v33 offset:32768
ds_read_b64_tr_b16 a[130:131], v33 offset:33024
ds_read_b64_tr_b16 a[132:133], v33 offset:33792
ds_read_b64_tr_b16 a[134:135], v33 offset:34048
ds_read_b64_tr_b16 a[136:137], v33 offset:34816
ds_read_b64_tr_b16 a[138:139], v33 offset:35072
ds_read_b64_tr_b16 a[140:141], v33 offset:35840
ds_read_b64_tr_b16 a[142:143], v33 offset:36096
s_waitcnt vmcnt(0)
ds_read_b64_tr_b16 a[144:145], v33 offset:0
ds_read_b64_tr_b16 a[146:147], v33 offset:256
ds_read_b64_tr_b16 a[148:149], v33 offset:1024
ds_read_b64_tr_b16 a[150:151], v33 offset:1280
ds_read_b64_tr_b16 a[152:153], v33 offset:2048
ds_read_b64_tr_b16 a[154:155], v33 offset:2304
ds_read_b64_tr_b16 a[156:157], v33 offset:3072
ds_read_b64_tr_b16 a[158:159], v33 offset:3328
s_waitcnt lgkmcnt(0)
s_barrier
v_mov_b32 v32, s24
v_mov_b32 v33, s24
v_mov_b32 v34, s24
v_mov_b32 v35, s24
s_nop 1
v_mfma_f32_32x32x16_bf16 v[36:51], a[0:3], v[32:35], 0
v_mfma_f32_32x32x16_bf16 v[36:51], a[4:7], v[32:35], v[36:51]
v_mfma_f32_32x32x16_bf16 v[36:51], a[8:11], v[32:35], v[36:51]
v_mfma_f32_32x32x16_bf16 v[36:51], a[12:15], v[32:35], v[36:51]
v_mfma_f32_32x32x16_bf16 v[36:51], a[16:19], v[32:35], v[36:51]
v_mfma_f32_32x32x16_bf16 v[36:51], a[20:23], v[32:35], v[36:51]
v_mfma_f32_32x32x16_bf16 v[36:51], a[24:27], v[32:35], v[36:51]
v_mfma_f32_32x32x16_bf16 v[36:51], a[28:31], v[32:35], v[36:51]
v_mfma_f32_32x32x16_bf16 v[36:51], a[32:35], v[32:35], v[36:51]
v_mfma_f32_32x32x16_bf16 v[36:51], a[36:39], v[32:35], v[36:51]
v_mfma_f32_32x32x16_bf16 v[36:51], a[40:43], v[32:35], v[36:51]
v_mfma_f32_32x32x16_bf16 v[36:51], a[44:47], v[32:35], v[36:51]
v_mfma_f32_32x32x16_bf16 v[36:51], a[48:51], v[32:35], v[36:51]
v_mfma_f32_32x32x16_bf16 v[36:51], a[52:55], v[32:35], v[36:51]
v_mfma_f32_32x32x16_bf16 v[36:51], a[56:59], v[32:35], v[36:51]
v_mfma_f32_32x32x16_bf16 v[36:51], a[60:63], v[32:35], v[36:51]
v_mfma_f32_32x32x16_bf16 v[36:51], a[64:67], v[32:35], v[36:51]
v_mfma_f32_32x32x16_bf16 v[36:51], a[68:71], v[32:35], v[36:51]
v_mfma_f32_32x32x16_bf16 v[36:51], a[72:75], v[32:35], v[36:51]
v_mfma_f32_32x32x16_bf16 v[36:51], a[76:79], v[32:35], v[36:51]
v_mfma_f32_32x32x16_bf16 v[36:51], a[80:83], v[32:35], v[36:51]
v_mfma_f32_32x32x16_bf16 v[36:51], a[84:87], v[32:35], v[36:51]
v_mfma_f32_32x32x16_bf16 v[36:51], a[88:91], v[32:35], v[36:51]
v_mfma_f32_32x32x16_bf16 v[36:51], a[92:95], v[32:35], v[36:51]
v_mfma_f32_32x32x16_bf16 v[36:51], a[96:99], v[32:35], v[36:51]
v_mfma_f32_32x32x16_bf16 v[36:51], a[100:103], v[32:35], v[36:51]
v_mfma_f32_32x32x16_bf16 v[36:51], a[104:107], v[32:35], v[36:51]
v_mfma_f32_32x32x16_bf16 v[36:51], a[108:111], v[32:35], v[36:51]
v_mfma_f32_32x32x16_bf16 v[36:51], a[112:115], v[32:35], v[36:51]
v_mfma_f32_32x32x16_bf16 v[36:51], a[116:119], v[32:35], v[36:51]
v_mfma_f32_32x32x16_bf16 v[36:51], a[120:123], v[32:35], v[36:51]
v_mfma_f32_32x32x16_bf16 v[36:51], a[124:127], v[32:35], v[36:51]
v_mfma_f32_32x32x16_bf16 v[36:51], a[128:131], v[32:35], v[36:51]
v_mfma_f32_32x32x16_bf16 v[36:51], a[132:135], v[32:35], v[36:51]
v_mfma_f32_32x32x16_bf16 v[36:51], a[136:139], v[32:35], v[36:51]
v_mfma_f32_32x32x16_bf16 v[36:51], a[140:143], v[32:35], v[36:51]
v_mfma_f32_32x32x16_bf16 v[36:51], a[144:147], v[32:35], v[36:51]
v_mfma_f32_32x32x16_bf16 v[36:51], a[148:151], v[32:35], v[36:51]
v_mfma_f32_32x32x16_bf16 v[36:51], a[152:155], v[32:35], v[36:51]
v_mfma_f32_32x32x16_bf16 v[36:51], a[156:159], v[32:35], v[36:51]
s_nop 11
v_mov_b32 v16, v36
v_mov_b32 v17, v37
v_mov_b32 v18, v38
v_mov_b32 v19, v39
v_mov_b32 v20, v40
v_mov_b32 v21, v41
v_mov_b32 v22, v42
v_mov_b32 v23, v43
v_mov_b32 v24, v44
v_mov_b32 v25, v45
v_mov_b32 v26, v46
v_mov_b32 v27, v47
v_mov_b32 v28, v48
v_mov_b32 v29, v49
v_mov_b32 v30, v50
v_mov_b32 v31, v51
v_accvgpr_write_b32 a160, v16
v_accvgpr_write_b32 a161, v17
v_accvgpr_write_b32 a162, v18
v_accvgpr_write_b32 a163, v19
v_accvgpr_write_b32 a164, v20
v_accvgpr_write_b32 a165, v21
v_accvgpr_write_b32 a166, v22
v_accvgpr_write_b32 a167, v23
v_accvgpr_write_b32 a168, v24
v_accvgpr_write_b32 a169, v25
v_accvgpr_write_b32 a170, v26
v_accvgpr_write_b32 a171, v27
v_accvgpr_write_b32 a172, v28
v_accvgpr_write_b32 a173, v29
v_accvgpr_write_b32 a174, v30
v_accvgpr_write_b32 a175, v31
qw_56:
v_accvgpr_read_b32 v16, a160
v_accvgpr_read_b32 v17, a161
v_accvgpr_read_b32 v18, a162
v_accvgpr_read_b32 v19, a163
v_accvgpr_read_b32 v20, a164
v_accvgpr_read_b32 v21, a165
v_accvgpr_read_b32 v22, a166
v_accvgpr_read_b32 v23, a167
v_accvgpr_read_b32 v24, a168
v_accvgpr_read_b32 v25, a169
v_accvgpr_read_b32 v26, a170
v_accvgpr_read_b32 v27, a171
v_accvgpr_read_b32 v28, a172
v_accvgpr_read_b32 v29, a173
v_accvgpr_read_b32 v30, a174
v_accvgpr_read_b32 v31, a175
s_lshl_b32 s29, s16, 1
s_add_u32 s29, s29, 2
s_lshr_b32 s52, s39, 5
s_lshl_b32 s53, s32, 7
s_add_u32 s53, s53, 0
s_cmp_lg_u32 s13, 0
s_cbranch_scc1 polld_58
v_min_u32 v12, 624, v0
s_mov_b32 s21, 8192
s_mov_b32 s17, 0
poll_57:
buffer_load_dwordx4 v[8:11], v12, s[4:7], s21 offen offset:0 sc1
s_add_u32 s17, s17, 1
s_cmp_gt_u32 s17, 262144
s_cbranch_scc1 L_fail
s_waitcnt vmcnt(0)
v_min3_u32 v8, v8, v9, v10
v_min_u32 v8, v8, v11
v_cmp_gt_u32 vcc, s29, v8
s_cbranch_vccz polld_58
s_sleep 2
s_branch poll_57
polld_58:
s_barrier
qr_59:
s_mul_i32 s26, s16, 6291456
s_mul_i32 s18, s52, 163840
s_add_u32 s26, s26, s18
s_add_u32 s26, s26, s31
s_add_u32 s26, s26, 88080384
s_lshl_b32 s18, s16, 4
s_add_u32 s18, s18, s52
s_mul_i32 s18, s18, 20480
s_add_u32 s36, s18, 163577856
s_lshl_b32 s18, s13, 11
s_add_u32 s18, s18, 83968
v_add_u32 v13, s18, v0
s_mov_b32 s28, 0
v_xor_b32 v1, 40960, v0
s_mov_b32 s25, s31
s_mov_b32 s35, 131072
s_add_u32 m0, s25, 2048
s_add_u32 s20, s26, 0
buffer_load_dwordx4 v0, s[4:7], s20 offen sc1 lds
s_add_u32 m0, s25, 3072
s_add_u32 s20, s26, 1024
buffer_load_dwordx4 v0, s[4:7], s20 offen sc1 lds
s_add_u32 m0, s25, 4096
s_add_u32 s20, s26, 2048
buffer_load_dwordx4 v0, s[4:7], s20 offen sc1 lds
s_add_u32 m0, s25, 5120
s_add_u32 s20, s26, 3072
buffer_load_dwordx4 v0, s[4:7], s20 offen sc1 lds
s_add_u32 m0, s25, 6144
s_add_u32 s20, s26, 4096
buffer_load_dwordx4 v0, s[4:7], s20 offen sc1 lds
s_add_u32 m0, s25, 7168
s_add_u32 s20, s26, 5120
buffer_load_dwordx4 v0, s[4:7], s20 offen sc1 lds
s_add_u32 m0, s25, 8192
s_add_u32 s20, s26, 6144
buffer_load_dwordx4 v0, s[4:7], s20 offen sc1 lds
s_add_u32 m0, s25, 9216
s_add_u32 s20, s26, 7168
buffer_load_dwordx4 v0, s[4:7], s20 offen sc1 lds
s_add_u32 m0, s25, 10240
s_add_u32 s20, s26, 8192
buffer_load_dwordx4 v0, s[4:7], s20 offen sc1 lds
s_add_u32 m0, s25, 11264
s_add_u32 s20, s26, 9216
buffer_load_dwordx4 v0, s[4:7], s20 offen sc1 lds
s_add_u32 m0, s35, s37
s_add_u32 s20, s36, s37
buffer_load_dwordx4 v0, s[4:7], s20 offen sc1 lds
s_add_u32 m0, s35, 4096
s_add_u32 s20, s36, 4096
buffer_load_dwordx4 v0, s[4:7], s20 offen sc1 lds
s_waitcnt vmcnt(0)
qu_60:
v_xor_b32 v1, 40960, v1
s_sub_u32 s25, s25, s31
s_xor_b32 s25, s25, 40960
s_add_u32 s25, s25, s31
s_xor_b32 s35, s35, 8192
s_add_u32 s26, s26, 40960
s_add_u32 s36, s36, 5120
s_cmp_eq_u32 s28, 3
s_cselect_b32 s26, s6, s26
s_cselect_b32 s36, s6, s36
s_waitcnt vmcnt(0)
s_barrier
ds_read_b128 v[48:51], v1 offset:2048
ds_read_b128 v[52:55], v1 offset:3072
s_add_u32 m0, s25, 2048
s_add_u32 s20, s26, 0
buffer_load_dwordx4 v0, s[4:7], s20 offen sc1 lds
v_lshrrev_b32 v2, 2, v0
ds_read_b128 v[56:59], v1 offset:4096
ds_read_b128 v[60:63], v1 offset:5120
s_xor_b32 s18, s35, 8192
v_add_u32 v2, s18, v2
ds_read2st64_b32 v[72:73], v2 offset0:4 offset1:5
s_waitcnt lgkmcnt(4)
v_mfma_f32_32x32x16_bf16 v[32:47], a[0:3], v[48:51], 0
s_add_u32 m0, s25, 3072
s_add_u32 s20, s26, 1024
buffer_load_dwordx4 v0, s[4:7], s20 offen sc1 lds
ds_read_b128 v[48:51], v1 offset:6144
ds_read2st64_b32 v[66:67], v2 offset0:2 offset1:3
s_waitcnt lgkmcnt(4)
v_mfma_f32_32x32x16_bf16 v[32:47], a[4:7], v[52:55], v[32:47]
ds_read_b128 v[52:55], v1 offset:7168
ds_read2st64_b32 v[78:79], v2 offset0:10 offset1:11
s_add_u32 m0, s25, 4096
s_add_u32 s20, s26, 2048
buffer_load_dwordx4 v0, s[4:7], s20 offen sc1 lds
v_mfma_f32_32x32x16_bf16 v[32:47], a[8:11], v[56:59], v[32:47]
s_waitcnt lgkmcnt(3)
ds_read_b128 v[56:59], v1 offset:8192
ds_read2st64_b32 v[86:87], v2 offset0:18 offset1:19
v_mfma_f32_32x32x16_bf16 v[32:47], a[12:15], v[60:63], v[32:47]
ds_read_b128 v[60:63], v1 offset:9216
ds_read2st64_b32 v[64:65], v2 offset0:0 offset1:1
s_waitcnt lgkmcnt(5)
ds_read2st64_b32 v[74:75], v2 offset0:6 offset1:7
v_mfma_f32_32x32x16_bf16 v[32:47], a[16:19], v[48:51], v[32:47]
ds_read2st64_b32 v[80:81], v2 offset0:12 offset1:13
ds_read_b128 v[48:51], v1 offset:10240
ds_read2st64_b32 v[82:83], v2 offset0:14 offset1:15
ds_read2st64_b32 v[76:77], v2 offset0:8 offset1:9
v_mfma_f32_32x32x16_bf16 v[32:47], a[20:23], v[52:55], v[32:47]
ds_read_b128 v[52:55], v1 offset:11264
s_waitcnt lgkmcnt(9)
s_add_u32 m0, s25, 5120
s_add_u32 s20, s26, 3072
buffer_load_dwordx4 v0, s[4:7], s20 offen sc1 lds
v_mfma_f32_32x32x16_bf16 v[32:47], a[24:27], v[56:59], v[32:47]
s_waitcnt lgkmcnt(7)
s_add_u32 m0, s25, 6144
s_add_u32 s20, s26, 4096
buffer_load_dwordx4 v0, s[4:7], s20 offen sc1 lds
s_waitcnt lgkmcnt(6)
v_add_f32 v64, v64, v66
v_mfma_f32_32x32x16_bf16 v[32:47], a[28:31], v[60:63], v[32:47]
ds_read_b128 v[56:59], v1 offset:12288
ds_read_b128 v[60:63], v1 offset:13312
v_add_f32 v65, v65, v67
s_waitcnt lgkmcnt(5)
v_mfma_f32_32x32x16_bf16 v[32:47], a[32:35], v[48:51], v[32:47]
ds_read_b128 v[48:51], v1 offset:14336
v_add_f32 v65, v65, v73
s_waitcnt lgkmcnt(3)
v_add_f32 v65, v65, v75
v_mfma_f32_32x32x16_bf16 v[32:47], a[36:39], v[52:55], v[32:47]
s_add_u32 m0, s25, 7168
s_add_u32 s20, s26, 5120
buffer_load_dwordx4 v0, s[4:7], s20 offen sc1 lds
ds_read2st64_b32 v[84:85], v2 offset0:16 offset1:17
v_add_f32 v64, v64, v72
s_waitcnt lgkmcnt(3)
v_add_f32 v65, v65, v77
v_mfma_f32_32x32x16_bf16 v[32:47], a[40:43], v[56:59], v[32:47]
s_waitcnt lgkmcnt(2)
ds_read_b128 v[56:59], v1 offset:16384
ds_read_b128 v[52:55], v1 offset:15360
v_add_f32 v64, v64, v74
v_add_f32 v64, v64, v76
v_mfma_f32_32x32x16_bf16 v[32:47], a[44:47], v[60:63], v[32:47]
s_waitcnt lgkmcnt(3)
ds_read_b128 v[60:63], v1 offset:17408
v_add_f32 v65, v65, v79
v_mfma_f32_32x32x16_bf16 v[32:47], a[48:51], v[48:51], v[32:47]
v_add_f32 v64, v64, v78
s_add_u32 m0, s25, 8192
s_add_u32 s20, s26, 6144
buffer_load_dwordx4 v0, s[4:7], s20 offen sc1 lds
s_waitcnt lgkmcnt(1)
v_mfma_f32_32x32x16_bf16 v[32:47], a[52:55], v[52:55], v[32:47]
ds_read_b128 v[48:51], v1 offset:18432
v_add_f32 v65, v65, v81
s_waitcnt lgkmcnt(1)
ds_read_b128 v[52:55], v1 offset:19456
v_mfma_f32_32x32x16_bf16 v[32:47], a[56:59], v[56:59], v[32:47]
s_add_u32 m0, s25, 9216
s_add_u32 s20, s26, 7168
buffer_load_dwordx4 v0, s[4:7], s20 offen sc1 lds
v_mfma_f32_32x32x16_bf16 v[32:47], a[60:63], v[60:63], v[32:47]
ds_read_b128 v[60:63], v1 offset:21504
s_waitcnt lgkmcnt(2)
ds_read_b128 v[56:59], v1 offset:20480
v_mfma_f32_32x32x16_bf16 v[32:47], a[64:67], v[48:51], v[32:47]
v_add_f32 v65, v65, v83
s_waitcnt lgkmcnt(2)
ds_read_b128 v[48:51], v1 offset:22528
v_mfma_f32_32x32x16_bf16 v[32:47], a[68:71], v[52:55], v[32:47]
v_add_f32 v65, v65, v85
v_add_f32 v64, v64, v80
v_add_f32 v64, v64, v82
s_waitcnt lgkmcnt(2)
s_waitcnt lgkmcnt(1)
v_mfma_f32_32x32x16_bf16 v[32:47], a[72:75], v[56:59], v[32:47]
s_add_u32 m0, s25, 10240
s_add_u32 s20, s26, 8192
buffer_load_dwordx4 v0, s[4:7], s20 offen sc1 lds
ds_read_b128 v[52:55], v1 offset:23552
v_add_f32 v64, v64, v84
v_add_f32 v65, v65, v87
s_waitcnt lgkmcnt(1)
v_mfma_f32_32x32x16_bf16 v[32:47], a[76:79], v[60:63], v[32:47]
v_add_f32 v64, v64, v86
ds_read_b128 v[56:59], v1 offset:24576
v_mfma_f32_32x32x16_bf16 v[32:47], a[80:83], v[48:51], v[32:47]
ds_read_b128 v[60:63], v1 offset:25600
ds_read_b128 v[48:51], v1 offset:26624
v_add_f32 v64, v64, v65
v_mov_b32 v68, v64
s_waitcnt lgkmcnt(3)
v_mfma_f32_32x32x16_bf16 v[32:47], a[84:87], v[52:55], v[32:47]
s_add_u32 m0, s25, 11264
s_add_u32 s20, s26, 9216
buffer_load_dwordx4 v0, s[4:7], s20 offen sc1 lds
s_waitcnt lgkmcnt(2)
v_permlane32_swap_b32 v64, v68
v_mfma_f32_32x32x16_bf16 v[32:47], a[88:91], v[56:59], v[32:47]
ds_read_b128 v[56:59], v1 offset:28672
ds_read_b128 v[52:55], v1 offset:27648
v_mul_f32 v68, 0x3acccccd, v68
s_waitcnt lgkmcnt(3)
v_mul_f32 v64, 0x3acccccd, v64
v_fma_f32 v68, -v64, v64, v68
v_mfma_f32_32x32x16_bf16 v[32:47], a[92:95], v[60:63], v[32:47]
s_add_u32 m0, s35, s37
s_add_u32 s20, s36, s37
buffer_load_dwordx4 v0, s[4:7], s20 offen sc1 lds
ds_read_b128 v[60:63], v1 offset:29696
s_waitcnt lgkmcnt(3)
v_max_f32 v68, 0, v68
v_add_f32 v68, 0x3727c5ac, v68
v_mfma_f32_32x32x16_bf16 v[32:47], a[96:99], v[48:51], v[32:47]
ds_read_b128 v[48:51], v1 offset:30720
v_rsq_f32 v68, v68
s_waitcnt lgkmcnt(2)
v_mul_f32 v68, 0x3e0293ee, v68
v_mfma_f32_32x32x16_bf16 v[32:47], a[100:103], v[52:55], v[32:47]
s_add_u32 m0, s35, 4096
s_add_u32 s20, s36, 4096
buffer_load_dwordx4 v0, s[4:7], s20 offen sc1 lds
v_mul_f32 v64, v68, v64
s_waitcnt lgkmcnt(1)
v_mfma_f32_32x32x16_bf16 v[32:47], a[104:107], v[56:59], v[32:47]
v_mul_f32 v82, v64, v26
s_waitcnt lgkmcnt(0)
ds_read_b128 v[52:55], v1 offset:31744
ds_read_b128 v[56:59], v1 offset:32768
v_mfma_f32_32x32x16_bf16 v[32:47], a[108:111], v[60:63], v[32:47]
ds_read_b128 v[60:63], v1 offset:33792
v_mfma_f32_32x32x16_bf16 v[32:47], a[112:115], v[48:51], v[32:47]
s_waitcnt lgkmcnt(2)
v_mul_f32 v84, v64, v28
v_mul_f32 v73, v64, v17
v_mfma_f32_32x32x16_bf16 v[32:47], a[116:119], v[52:55], v[32:47]
ds_read_b128 v[52:55], v1 offset:35840
s_waitcnt lgkmcnt(2)
ds_read_b128 v[48:51], v1 offset:34816
v_mfma_f32_32x32x16_bf16 v[32:47], a[120:123], v[56:59], v[32:47]
v_mul_f32 v87, v64, v31
v_mul_f32 v77, v64, v21
v_mul_f32 v81, v64, v25
s_waitcnt lgkmcnt(2)
v_mfma_f32_32x32x16_bf16 v[32:47], a[124:127], v[60:63], v[32:47]
ds_read_b128 v[60:63], v1 offset:37888
s_waitcnt lgkmcnt(2)
s_waitcnt lgkmcnt(1)
ds_read_b128 v[56:59], v1 offset:36864
v_mfma_f32_32x32x16_bf16 v[32:47], a[128:131], v[48:51], v[32:47]
ds_read_b128 v[48:51], v1 offset:38912
v_mul_f32 v75, v64, v19
v_mfma_f32_32x32x16_bf16 v[32:47], a[132:135], v[52:55], v[32:47]
s_waitcnt lgkmcnt(1)
v_mfma_f32_32x32x16_bf16 v[32:47], a[136:139], v[56:59], v[32:47]
ds_read_b128 v[56:59], v1 offset:40960
ds_read_b128 v[52:55], v1 offset:39936
v_mul_f32 v79, v64, v23
v_mul_f32 v85, v64, v29
v_mul_f32 v76, v64, v20
v_mfma_f32_32x32x16_bf16 v[32:47], a[140:143], v[60:63], v[32:47]
s_waitcnt lgkmcnt(2)
ds_read_b128 v[60:63], v1 offset:41984
v_mul_f32 v74, v64, v18
v_mul_f32 v86, v64, v30
v_mfma_f32_32x32x16_bf16 v[32:47], a[144:147], v[48:51], v[32:47]
s_waitcnt lgkmcnt(1)
v_mfma_f32_32x32x16_bf16 v[32:47], a[148:151], v[52:55], v[32:47]
s_waitcnt lgkmcnt(0)
v_mfma_f32_32x32x16_bf16 v[32:47], a[152:155], v[56:59], v[32:47]
v_mfma_f32_32x32x16_bf16 v[32:47], a[156:159], v[60:63], v[32:47]
s_nop 0
v_mul_f32 v72, v64, v16
v_mul_f32 v78, v64, v22
v_mul_f32 v83, v64, v27
v_mul_f32 v80, v64, v24
s_nop 6
v_pk_fma_f32 v[44:45], v[44:45], v[68:69], v[84:85] op_sel_hi:[1,0,1] neg_lo:[0,0,1] neg_hi:[0,0,1]
v_pk_fma_f32 v[38:39], v[38:39], v[68:69], v[78:79] op_sel_hi:[1,0,1] neg_lo:[0,0,1] neg_hi:[0,0,1]
v_pk_fma_f32 v[42:43], v[42:43], v[68:69], v[82:83] op_sel_hi:[1,0,1] neg_lo:[0,0,1] neg_hi:[0,0,1]
v_pk_fma_f32 v[46:47], v[46:47], v[68:69], v[86:87] op_sel_hi:[1,0,1] neg_lo:[0,0,1] neg_hi:[0,0,1]
v_pk_fma_f32 v[34:35], v[34:35], v[68:69], v[74:75] op_sel_hi:[1,0,1] neg_lo:[0,0,1] neg_hi:[0,0,1]
v_pk_fma_f32 v[32:33], v[32:33], v[68:69], v[72:73] op_sel_hi:[1,0,1] neg_lo:[0,0,1] neg_hi:[0,0,1]
v_cvt_pk_bf16_f32 v51, v38, v39
v_cvt_pk_bf16_f32 v49, v34, v35
v_pk_fma_f32 v[36:37], v[36:37], v[68:69], v[76:77] op_sel_hi:[1,0,1] neg_lo:[0,0,1] neg_hi:[0,0,1]
v_cvt_pk_bf16_f32 v54, v44, v45
v_cvt_pk_bf16_f32 v50, v36, v37
v_cvt_pk_bf16_f32 v48, v32, v33
v_pk_fma_f32 v[40:41], v[40:41], v[68:69], v[80:81] op_sel_hi:[1,0,1] neg_lo:[0,0,1] neg_hi:[0,0,1]
v_cvt_pk_bf16_f32 v55, v46, v47
v_cvt_pk_bf16_f32 v53, v42, v43
v_cvt_pk_bf16_f32 v52, v40, v41
ds_write_b128 v13, v[48:51] offset:0
ds_write_b128 v13, v[52:55] offset:1024
v_add_u32 v13, 8192, v13
s_add_u32 s28, s28, 1
s_cmp_lt_u32 s28, 4
s_cbranch_scc1 qu_60
s_waitcnt lgkmcnt(0)
s_barrier
s_lshl_b32 s30, s52, 2
s_add_u32 s30, s30, s13
s_lshl_b32 s18, s16, 6
s_add_u32 s29, s18, s30
s_lshl_b32 s27, s29, 18
s_lshl_b32 s19, s32, 13
s_add_u32 s27, s27, s19
s_add_u32 s27, s27, 127926272
s_mul_i32 s18, s16, 35651584
s_mul_i32 s19, s30, 524288
s_add_u32 s18, s18, s19
s_mul_i32 s19, s32, 16384
s_add_u32 s18, s18, s19
s_lshl_b32 s30, s29, 7
s_add_u32 s29, s29, 1
s_lshl_b32 s19, s13, 13
s_add_u32 s19, s19, 83968
v_add_u32 v200, s19, v0
s_add_u32 s54, s18, 16777216
s_add_u32 s55, s18, 16781312
s_add_u32 s56, s18, 16785408
s_add_u32 s57, s18, 16789504
ds_read_b128 v[32:35], v200 offset:0
ds_read_b128 v[36:39], v200 offset:1024
ds_read_b128 v[40:43], v200 offset:2048
ds_read_b128 v[44:47], v200 offset:3072
ds_read_b128 v[48:51], v200 offset:4096
ds_read_b128 v[52:55], v200 offset:5120
ds_read_b128 v[56:59], v200 offset:6144
ds_read_b128 v[60:63], v200 offset:7168
v_and_b32 v14, 0x70, v0
v_lshrrev_b32 v200, 8, v0
v_lshl_add_u32 v14, v200, 7, v14
v_bfe_u32 v200, v0, 7, 1
v_lshl_add_u32 v14, v200, 12, v14
v_and_b32 v15, 0x70, v0
v_lshrrev_b32 v200, 8, v0
v_lshl_add_u32 v15, v200, 7, v15
v_bfe_u32 v200, v0, 7, 1
v_lshl_add_u32 v15, v200, 10, v15
v_bfe_u32 v200, v0, 4, 5
v_lshrrev_b32 v144, 9, v0
v_lshlrev_b32 v144, 2, v144
v_sub_u32 v200, v200, v144
v_mov_b32 v145, 0xf149f2ca
v_cmp_gt_i32 vcc, 0, v200
s_nop 1
v_cndmask_b32 v128, 0, v145, vcc
v_cmp_gt_i32 vcc, 1, v200
s_nop 1
v_cndmask_b32 v129, 0, v145, vcc
v_cmp_gt_i32 vcc, 2, v200
s_nop 1
v_cndmask_b32 v130, 0, v145, vcc
v_cmp_gt_i32 vcc, 3, v200
s_nop 1
v_cndmask_b32 v131, 0, v145, vcc
v_cmp_gt_i32 vcc, 8, v200
s_nop 1
v_cndmask_b32 v132, 0, v145, vcc
v_cmp_gt_i32 vcc, 9, v200
s_nop 1
v_cndmask_b32 v133, 0, v145, vcc
v_cmp_gt_i32 vcc, 10, v200
s_nop 1
v_cndmask_b32 v134, 0, v145, vcc
v_cmp_gt_i32 vcc, 11, v200
s_nop 1
v_cndmask_b32 v135, 0, v145, vcc
v_cmp_gt_i32 vcc, 16, v200
s_nop 1
v_cndmask_b32 v136, 0, v145, vcc
v_cmp_gt_i32 vcc, 17, v200
s_nop 1
v_cndmask_b32 v137, 0, v145, vcc
v_cmp_gt_i32 vcc, 18, v200
s_nop 1
v_cndmask_b32 v138, 0, v145, vcc
v_cmp_gt_i32 vcc, 19, v200
s_nop 1
v_cndmask_b32 v139, 0, v145, vcc
v_cmp_gt_i32 vcc, 24, v200
s_nop 1
v_cndmask_b32 v140, 0, v145, vcc
v_cmp_gt_i32 vcc, 25, v200
s_nop 1
v_cndmask_b32 v141, 0, v145, vcc
v_cmp_gt_i32 vcc, 26, v200
s_nop 1
v_cndmask_b32 v142, 0, v145, vcc
v_cmp_gt_i32 vcc, 27, v200
s_nop 1
v_cndmask_b32 v143, 0, v145, vcc
v_lshrrev_b32 v12, 2, v0
v_min_u32 v12, 4, v12
s_mov_b32 s17, 0
poll_61:
buffer_load_dword v8, v12, s[4:7], s53 offen offset:0 sc1
s_add_u32 s17, s17, 1
s_cmp_gt_u32 s17, 262144
s_cbranch_scc1 L_fail
s_waitcnt vmcnt(0)
v_cmp_gt_u32 vcc, s29, v8
s_cbranch_vccz polld_62
s_sleep 2
s_branch poll_61
polld_62:
buffer_load_dwordx4 v[64:67], v14, s[4:7], s54 offen offset:0 sc1
buffer_load_dwordx4 v[68:71], v14, s[4:7], s54 offen offset:512 sc1
buffer_load_dwordx4 v[72:75], v14, s[4:7], s54 offen offset:1024 sc1
buffer_load_dwordx4 v[76:79], v14, s[4:7], s54 offen offset:1536 sc1
buffer_load_dwordx4 v[80:83], v14, s[4:7], s56 offen offset:0 sc1
buffer_load_dwordx4 v[84:87], v14, s[4:7], s56 offen offset:512 sc1
buffer_load_dwordx4 v[88:91], v14, s[4:7], s56 offen offset:1024 sc1
buffer_load_dwordx4 v[92:95], v14, s[4:7], s56 offen offset:1536 sc1
buffer_load_dwordx4 v[96:99], v15, s[4:7], s54 offen offset:2048 sc1
buffer_load_dwordx4 v[100:103], v15, s[4:7], s54 offen offset:2560 sc1
buffer_load_dwordx4 v[104:107], v15, s[4:7], s55 offen offset:2048 sc1
buffer_load_dwordx4 v[108:111], v15, s[4:7], s55 offen offset:2560 sc1
buffer_load_dwordx4 v[112:115], v15, s[4:7], s56 offen offset:2048 sc1
buffer_load_dwordx4 v[116:119], v15, s[4:7], s56 offen offset:2560 sc1
buffer_load_dwordx4 v[120:123], v15, s[4:7], s57 offen offset:2048 sc1
buffer_load_dwordx4 v[124:127], v15, s[4:7], s57 offen offset:2560 sc1
s_waitcnt vmcnt(15) lgkmcnt(7)
v_mfma_f32_32x32x16_bf16 v[128:143], v[64:67], v[32:35], v[128:143]
s_waitcnt vmcnt(14) lgkmcnt(6)
v_mfma_f32_32x32x16_bf16 v[128:143], v[68:71], v[36:39], v[128:143]
s_waitcnt vmcnt(13) lgkmcnt(5)
v_mfma_f32_32x32x16_bf16 v[128:143], v[72:75], v[40:43], v[128:143]
s_waitcnt vmcnt(12) lgkmcnt(4)
v_mfma_f32_32x32x16_bf16 v[128:143], v[76:79], v[44:47], v[128:143]
s_waitcnt vmcnt(11) lgkmcnt(3)
v_mfma_f32_32x32x16_bf16 v[128:143], v[80:83], v[48:51], v[128:143]
s_waitcnt vmcnt(10) lgkmcnt(2)
v_mfma_f32_32x32x16_bf16 v[128:143], v[84:87], v[52:55], v[128:143]
s_waitcnt vmcnt(9) lgkmcnt(1)
v_mfma_f32_32x32x16_bf16 v[128:143], v[88:91], v[56:59], v[128:143]
s_waitcnt vmcnt(8) lgkmcnt(0)
v_mfma_f32_32x32x16_bf16 v[128:143], v[92:95], v[60:63], v[128:143]
s_lshl_b32 s18, s16, 4
s_add_u32 s29, s18, s52
s_lshl_b32 s18, s29, 19
s_lshl_b32 s19, s32, 14
s_add_u32 s18, s18, s19
s_add_u32 s29, s29, 1
s_and_b32 s19, s13, 1
s_lshr_b32 s20, s13, 1
v_and_b32 v14, 0x170, v14
v_lshl_add_u32 v14, s19, 12, v14
v_lshl_add_u32 v14, s20, 7, v14
v_lshl_add_u32 v15, s19, 3, v15
v_lshl_add_u32 v15, s20, 9, v15
s_add_u32 s54, s18, 110100480
s_add_u32 s55, s18, 110104576
s_add_u32 s56, s18, 110108672
s_add_u32 s57, s18, 110112768
v_max3_f32 v200, v128, v129, v130
v_max3_f32 v200, v200, v131, v132
v_max3_f32 v200, v200, v133, v134
v_max3_f32 v200, v200, v135, v136
v_max3_f32 v200, v200, v137, v138
v_max3_f32 v200, v200, v139, v140
v_max3_f32 v200, v200, v141, v142
v_max_f32 v200, v200, v143
s_add_u32 s18, s53, 12288
v_lshrrev_b32 v12, 2, v0
v_min_u32 v12, 4, v12
s_mov_b32 s17, 0
poll_63:
buffer_load_dword v8, v12, s[4:7], s18 offen offset:0 sc1
s_add_u32 s17, s17, 1
s_cmp_gt_u32 s17, 262144
s_cbranch_scc1 L_fail
s_waitcnt vmcnt(0)
v_cmp_gt_u32 vcc, s29, v8
s_cbranch_vccz polld_64
s_sleep 2
s_branch poll_63
polld_64:
buffer_load_dwordx4 v[64:67], v14, s[4:7], s54 offen offset:0 sc1
buffer_load_dwordx4 v[68:71], v14, s[4:7], s54 offen offset:512 sc1
buffer_load_dwordx4 v[72:75], v14, s[4:7], s54 offen offset:1024 sc1
buffer_load_dwordx4 v[76:79], v14, s[4:7], s54 offen offset:1536 sc1
buffer_load_dwordx4 v[80:83], v14, s[4:7], s56 offen offset:0 sc1
buffer_load_dwordx4 v[84:87], v14, s[4:7], s56 offen offset:512 sc1
buffer_load_dwordx4 v[88:91], v14, s[4:7], s56 offen offset:1024 sc1
buffer_load_dwordx4 v[92:95], v14, s[4:7], s56 offen offset:1536 sc1
buffer_load_dwordx2 v[192:193], v15, s[4:7], s54 offen offset:2048 sc1
buffer_load_dwordx2 v[194:195], v15, s[4:7], s55 offen offset:2048 sc1
buffer_load_dwordx2 v[196:197], v15, s[4:7], s56 offen offset:2048 sc1
buffer_load_dwordx2 v[198:199], v15, s[4:7], s57 offen offset:2048 sc1
s_waitcnt vmcnt(11)
v_mfma_f32_32x32x16_bf16 v[144:159], v[64:67], v[32:35], 0
s_waitcnt vmcnt(10)
v_mfma_f32_32x32x16_bf16 v[144:159], v[68:71], v[36:39], v[144:159]
s_waitcnt vmcnt(9)
v_mfma_f32_32x32x16_bf16 v[144:159], v[72:75], v[40:43], v[144:159]
s_waitcnt vmcnt(8)
v_mfma_f32_32x32x16_bf16 v[144:159], v[76:79], v[44:47], v[144:159]
s_waitcnt vmcnt(7)
v_mfma_f32_32x32x16_bf16 v[144:159], v[80:83], v[48:51], v[144:159]
s_waitcnt vmcnt(6)
v_mfma_f32_32x32x16_bf16 v[144:159], v[84:87], v[52:55], v[144:159]
s_waitcnt vmcnt(5)
v_mfma_f32_32x32x16_bf16 v[144:159], v[88:91], v[56:59], v[144:159]
s_waitcnt vmcnt(4)
v_mfma_f32_32x32x16_bf16 v[144:159], v[92:95], v[60:63], v[144:159]
s_nop 11
v_max3_f32 v148, v200, v144, v145
v_max3_f32 v148, v148, v146, v147
v_mov_b32 v150, v148
s_nop 1
v_permlane32_swap_b32 v148, v150
v_max_f32 v148, v148, v150
v_sub_f32 v147, v147, v148
v_sub_f32 v144, v144, v148
v_exp_f32 v144, v144
v_sub_f32 v145, v145, v148
v_sub_f32 v146, v146, v148
v_exp_f32 v147, v147
v_exp_f32 v146, v146
v_exp_f32 v145, v145
v_cvt_pk_bf16_f32 v41, v146, v147
v_cvt_pk_bf16_f32 v40, v144, v145
v_sub_f32 v134, v134, v148
v_sub_f32 v133, v133, v148
s_waitcnt vmcnt(1)
v_mfma_f32_32x32x8_bf16 v[64:79], v[196:197], v[40:41], 0
v_sub_f32 v129, v129, v148
v_exp_f32 v133, v133
v_exp_f32 v129, v129
v_sub_f32 v131, v131, v148
v_mfma_f32_32x32x8_bf16 v[176:191], v[194:195], v[40:41], 0
v_sub_f32 v132, v132, v148
v_exp_f32 v132, v132
v_exp_f32 v134, v134
v_sub_f32 v128, v128, v148
s_waitcnt vmcnt(0)
v_mfma_f32_32x32x8_bf16 v[80:95], v[198:199], v[40:41], 0
v_sub_f32 v135, v135, v148
v_sub_f32 v130, v130, v148
v_exp_f32 v131, v131
v_exp_f32 v130, v130
v_mfma_f32_32x32x8_bf16 v[160:175], v[192:193], v[40:41], 0
v_exp_f32 v135, v135
v_cvt_pk_bf16_f32 v34, v132, v133
v_exp_f32 v128, v128
v_cvt_pk_bf16_f32 v33, v130, v131
v_cvt_pk_bf16_f32 v35, v134, v135
v_cvt_pk_bf16_f32 v32, v128, v129
v_sub_f32 v136, v136, v148
v_add_f32 v149, v128, v129
v_mfma_f32_32x32x16_bf16 v[80:95], v[120:123], v[32:35], v[80:95]
s_add_u32 s19, s27, 4096
v_sub_f32 v142, v142, v148
v_sub_f32 v138, v138, v148
v_sub_f32 v139, v139, v148
v_sub_f32 v143, v143, v148
v_exp_f32 v143, v143
v_mfma_f32_32x32x16_bf16 v[64:79], v[112:115], v[32:35], v[64:79]
v_exp_f32 v136, v136
v_sub_f32 v140, v140, v148
v_sub_f32 v141, v141, v148
v_exp_f32 v140, v140
v_mfma_f32_32x32x16_bf16 v[160:175], v[96:99], v[32:35], v[160:175]
v_exp_f32 v141, v141
v_sub_f32 v137, v137, v148
v_cvt_pk_bf16_f32 v38, v140, v141
v_exp_f32 v142, v142
v_mfma_f32_32x32x16_bf16 v[176:191], v[104:107], v[32:35], v[176:191]
v_cvt_pk_bf16_f32 v39, v142, v143
v_exp_f32 v137, v137
v_exp_f32 v139, v139
v_exp_f32 v138, v138
v_cvt_pk_bf16_f32 v36, v136, v137
v_cvt_pk_bf16_f32 v37, v138, v139
v_add_f32 v149, v149, v130
v_add_f32 v149, v149, v131
v_mfma_f32_32x32x16_bf16 v[160:175], v[100:103], v[36:39], v[160:175]
v_add_f32 v149, v149, v132
v_add_f32 v149, v149, v133
v_add_f32 v149, v149, v134
v_add_f32 v149, v149, v135
v_add_f32 v149, v149, v136
v_add_f32 v149, v149, v137
v_mfma_f32_32x32x16_bf16 v[64:79], v[116:119], v[36:39], v[64:79]
v_add_f32 v149, v149, v138
v_add_f32 v149, v149, v139
v_add_f32 v149, v149, v140
v_add_f32 v149, v149, v141
v_add_f32 v149, v149, v142
v_add_f32 v149, v149, v143
v_add_f32 v149, v149, v144
v_add_f32 v149, v149, v145
v_add_f32 v149, v149, v146
v_add_f32 v149, v149, v147
v_mov_b32 v150, v149
v_mfma_f32_32x32x16_bf16 v[80:95], v[124:127], v[36:39], v[80:95]
s_nop 0
v_permlane32_swap_b32 v149, v150
v_add_f32 v149, v149, v150
v_rcp_f32 v149, v149
v_mfma_f32_32x32x16_bf16 v[176:191], v[108:111], v[36:39], v[176:191]
s_nop 0
v_mul_f32 v161, v161, v149
v_mul_f32 v64, v64, v149
v_mul_f32 v167, v167, v149
v_mul_f32 v74, v74, v149
v_mul_f32 v66, v66, v149
v_mul_f32 v69, v69, v149
v_mul_f32 v67, v67, v149
v_mul_f32 v166, v166, v149
v_mul_f32 v65, v65, v149
v_mul_f32 v160, v160, v149
v_mul_f32 v71, v71, v149
v_mul_f32 v177, v177, v149
v_mul_f32 v165, v165, v149
v_mul_f32 v188, v188, v149
v_mul_f32 v170, v170, v149
v_mul_f32 v80, v80, v149
v_mul_f32 v85, v85, v149
v_cvt_pk_bf16_f32 v64, v64, v65
v_mul_f32 v178, v178, v149
v_mul_f32 v168, v168, v149
v_mul_f32 v162, v162, v149
v_mul_f32 v92, v92, v149
v_mul_f32 v84, v84, v149
v_mul_f32 v163, v163, v149
v_mul_f32 v185, v185, v149
v_cvt_pk_bf16_f32 v160, v160, v161
v_mul_f32 v73, v73, v149
v_mul_f32 v189, v189, v149
v_mul_f32 v169, v169, v149
v_mul_f32 v83, v83, v149
v_mul_f32 v172, v172, v149
v_mul_f32 v75, v75, v149
v_cvt_pk_bf16_f32 v161, v162, v163
v_mul_f32 v176, v176, v149
v_mul_f32 v91, v91, v149
v_mul_f32 v180, v180, v149
v_mul_f32 v181, v181, v149
v_cvt_pk_bf16_f32 v65, v66, v67
v_mul_f32 v164, v164, v149
v_cvt_pk_bf16_f32 v162, v164, v165
v_mul_f32 v173, v173, v149
v_mul_f32 v179, v179, v149
v_mul_f32 v190, v190, v149
v_mul_f32 v182, v182, v149
v_mul_f32 v90, v90, v149
v_mul_f32 v81, v81, v149
v_mul_f32 v89, v89, v149
v_mul_f32 v171, v171, v149
v_mul_f32 v88, v88, v149
v_mul_f32 v82, v82, v149
v_mul_f32 v68, v68, v149
v_cvt_pk_bf16_f32 v66, v68, v69
v_mul_f32 v174, v174, v149
v_mul_f32 v183, v183, v149
v_cvt_pk_bf16_f32 v164, v168, v169
v_cvt_pk_bf16_f32 v165, v170, v171
v_cvt_pk_bf16_f32 v176, v176, v177
v_mul_f32 v72, v72, v149
v_cvt_pk_bf16_f32 v177, v178, v179
v_cvt_pk_bf16_f32 v163, v166, v167
v_mul_f32 v95, v95, v149
v_mul_f32 v175, v175, v149
v_mul_f32 v79, v79, v149
v_cvt_pk_bf16_f32 v166, v172, v173
v_cvt_pk_bf16_f32 v167, v174, v175
v_cvt_pk_bf16_f32 v178, v180, v181
v_cvt_pk_bf16_f32 v179, v182, v183
v_mul_f32 v87, v87, v149
buffer_store_dwordx4 v[160:163], v0, s[4:7], s27 offen offset:0 sc1
buffer_store_dwordx4 v[164:167], v0, s[4:7], s27 offen offset:1024 sc1
buffer_store_dwordx4 v[176:179], v0, s[4:7], s27 offen offset:2048 sc1
v_mul_f32 v78, v78, v149
v_mul_f32 v76, v76, v149
v_mul_f32 v86, v86, v149
v_cvt_pk_bf16_f32 v80, v80, v81
v_mul_f32 v77, v77, v149
v_mul_f32 v70, v70, v149
v_mul_f32 v186, v186, v149
v_mul_f32 v184, v184, v149
v_mul_f32 v187, v187, v149
v_cvt_pk_bf16_f32 v81, v82, v83
v_cvt_pk_bf16_f32 v67, v70, v71
v_mul_f32 v191, v191, v149
v_cvt_pk_bf16_f32 v182, v188, v189
v_cvt_pk_bf16_f32 v83, v86, v87
v_cvt_pk_bf16_f32 v82, v84, v85
v_mul_f32 v94, v94, v149
v_cvt_pk_bf16_f32 v181, v186, v187
v_cvt_pk_bf16_f32 v180, v184, v185
v_cvt_pk_bf16_f32 v69, v74, v75
v_mul_f32 v93, v93, v149
v_cvt_pk_bf16_f32 v183, v190, v191
v_cvt_pk_bf16_f32 v68, v72, v73
v_cvt_pk_bf16_f32 v85, v90, v91
v_cvt_pk_bf16_f32 v86, v92, v93
v_cvt_pk_bf16_f32 v71, v78, v79
v_cvt_pk_bf16_f32 v87, v94, v95
v_cvt_pk_bf16_f32 v84, v88, v89
v_cvt_pk_bf16_f32 v70, v76, v77
buffer_store_dwordx4 v[180:183], v0, s[4:7], s27 offen offset:3072 sc1
buffer_store_dwordx4 v[64:67], v0, s[4:7], s19 offen offset:0 sc1
buffer_store_dwordx4 v[68:71], v0, s[4:7], s19 offen offset:1024 sc1
buffer_store_dwordx4 v[80:83], v0, s[4:7], s19 offen offset:2048 sc1
buffer_store_dwordx4 v[84:87], v0, s[4:7], s19 offen offset:3072 sc1
s_lshl_b32 s18, s32, 2
s_add_u32 s18, s18, s30
s_add_u32 s18, s18, 16384
s_waitcnt vmcnt(0)
v_mov_b32 v3, 1
s_mov_b64 exec, 1
buffer_store_dword v3, off, s[4:7], s18 sc1
s_mov_b64 exec, -1
s_add_u32 s52, s52, 2
s_cmp_lt_u32 s52, 16
s_cbranch_scc1 qr_59
s_barrier
s_cmp_ge_u32 s39, 20
s_cbranch_scc1 aend_54
s_add_u32 s30, s50, 60
s_add_u32 s51, s39, 15
s_branch p1c_55
wo_52:
s_sub_u32 s18, s39, 64
s_mul_i32 s30, s18, 3277
s_lshr_b32 s30, s30, 16
s_mul_i32 s19, s30, 20
s_sub_u32 s52, s18, s19
s_cmp_lg_u32 s16, 0
s_cbranch_scc1 ww_65
s_mul_i32 s26, s13, 1310720
s_lshl_b32 s18, s52, 6
s_add_u32 s26, s26, s18
s_load_dwordx2 s[40:41], s[0:1], 64
s_mov_b32 s42, 5242880
s_mov_b32 s43, 0x20000
s_waitcnt lgkmcnt(0)
v_lshrrev_b32 v214, 6, v0
v_mul_u32_u24 v214, 1280, v214
v_and_b32 v215, 48, v0
v_add_u32 v212, v214, v215
v_bfe_u32 v214, v0, 6, 2
v_lshrrev_b32 v215, 9, v0
v_lshl_add_u32 v214, v215, 3, v214
v_lshlrev_b32 v213, 6, v214
v_and_b32 v214, 16, v0
v_add_u32 v213, v213, v214
v_bfe_u32 v214, v0, 5, 1
v_lshl_add_u32 v213, v214, 3, v213
v_bfe_u32 v214, v0, 8, 1
v_lshl_add_u32 v213, v214, 5, v213
s_mul_i32 s18, s13, 36864
v_add_u32 v213, s18, v213
s_barrier
s_add_u32 m0, s18, 0
s_add_u32 s19, s26, 0
buffer_load_dwordx4 v212, s[40:43], s19 offen lds
s_add_u32 m0, s18, 1024
s_add_u32 s19, s26, 20480
buffer_load_dwordx4 v212, s[40:43], s19 offen lds
s_add_u32 m0, s18, 2048
s_add_u32 s19, s26, 40960
buffer_load_dwordx4 v212, s[40:43], s19 offen lds
s_add_u32 m0, s18, 3072
s_add_u32 s19, s26, 61440
buffer_load_dwordx4 v212, s[40:43], s19 offen lds
s_add_u32 m0, s18, 4096
s_add_u32 s19, s26, 81920
buffer_load_dwordx4 v212, s[40:43], s19 offen lds
s_add_u32 m0, s18, 5120
s_add_u32 s19, s26, 102400
buffer_load_dwordx4 v212, s[40:43], s19 offen lds
s_add_u32 m0, s18, 6144
s_add_u32 s19, s26, 122880
buffer_load_dwordx4 v212, s[40:43], s19 offen lds
s_add_u32 m0, s18, 7168
s_add_u32 s19, s26, 143360
buffer_load_dwordx4 v212, s[40:43], s19 offen lds
s_add_u32 m0, s18, 8192
s_add_u32 s19, s26, 163840
buffer_load_dwordx4 v212, s[40:43], s19 offen lds
s_add_u32 m0, s18, 9216
s_add_u32 s19, s26, 184320
buffer_load_dwordx4 v212, s[40:43], s19 offen lds
s_add_u32 m0, s18, 10240
s_add_u32 s19, s26, 204800
buffer_load_dwordx4 v212, s[40:43], s19 offen lds
s_add_u32 m0, s18, 11264
s_add_u32 s19, s26, 225280
buffer_load_dwordx4 v212, s[40:43], s19 offen lds
s_add_u32 m0, s18, 12288
s_add_u32 s19, s26, 245760
buffer_load_dwordx4 v212, s[40:43], s19 offen lds
s_add_u32 m0, s18, 13312
s_add_u32 s19, s26, 266240
buffer_load_dwordx4 v212, s[40:43], s19 offen lds
s_add_u32 m0, s18, 14336
s_add_u32 s19, s26, 286720
buffer_load_dwordx4 v212, s[40:43], s19 offen lds
s_add_u32 m0, s18, 15360
s_add_u32 s19, s26, 307200
buffer_load_dwordx4 v212, s[40:43], s19 offen lds
s_add_u32 m0, s18, 16384
s_add_u32 s19, s26, 327680
buffer_load_dwordx4 v212, s[40:43], s19 offen lds
s_add_u32 m0, s18, 17408
s_add_u32 s19, s26, 348160
buffer_load_dwordx4 v212, s[40:43], s19 offen lds
s_add_u32 m0, s18, 18432
s_add_u32 s19, s26, 368640
buffer_load_dwordx4 v212, s[40:43], s19 offen lds
s_add_u32 m0, s18, 19456
s_add_u32 s19, s26, 389120
buffer_load_dwordx4 v212, s[40:43], s19 offen lds
s_add_u32 m0, s18, 20480
s_add_u32 s19, s26, 409600
buffer_load_dwordx4 v212, s[40:43], s19 offen lds
s_add_u32 m0, s18, 21504
s_add_u32 s19, s26, 430080
buffer_load_dwordx4 v212, s[40:43], s19 offen lds
s_add_u32 m0, s18, 22528
s_add_u32 s19, s26, 450560
buffer_load_dwordx4 v212, s[40:43], s19 offen lds
s_add_u32 m0, s18, 23552
s_add_u32 s19, s26, 471040
buffer_load_dwordx4 v212, s[40:43], s19 offen lds
s_add_u32 m0, s18, 24576
s_add_u32 s19, s26, 491520
buffer_load_dwordx4 v212, s[40:43], s19 offen lds
s_add_u32 m0, s18, 25600
s_add_u32 s19, s26, 512000
buffer_load_dwordx4 v212, s[40:43], s19 offen lds
s_add_u32 m0, s18, 26624
s_add_u32 s19, s26, 532480
buffer_load_dwordx4 v212, s[40:43], s19 offen lds
s_add_u32 m0, s18, 27648
s_add_u32 s19, s26, 552960
buffer_load_dwordx4 v212, s[40:43], s19 offen lds
s_add_u32 m0, s18, 28672
s_add_u32 s19, s26, 573440
buffer_load_dwordx4 v212, s[40:43], s19 offen lds
s_add_u32 m0, s18, 29696
s_add_u32 s19, s26, 593920
buffer_load_dwordx4 v212, s[40:43], s19 offen lds
s_add_u32 m0, s18, 30720
s_add_u32 s19, s26, 614400
buffer_load_dwordx4 v212, s[40:43], s19 offen lds
s_add_u32 m0, s18, 31744
s_add_u32 s19, s26, 634880
buffer_load_dwordx4 v212, s[40:43], s19 offen lds
s_add_u32 m0, s18, 32768
s_add_u32 s19, s26, 655360
buffer_load_dwordx4 v212, s[40:43], s19 offen lds
s_add_u32 m0, s18, 33792
s_add_u32 s19, s26, 675840
buffer_load_dwordx4 v212, s[40:43], s19 offen lds
s_add_u32 m0, s18, 34816
s_add_u32 s19, s26, 696320
buffer_load_dwordx4 v212, s[40:43], s19 offen lds
s_add_u32 m0, s18, 35840
s_add_u32 s19, s26, 716800
buffer_load_dwordx4 v212, s[40:43], s19 offen lds
s_waitcnt vmcnt(32)
ds_read_b64_tr_b16 a[0:1], v213 offset:0
ds_read_b64_tr_b16 a[2:3], v213 offset:256
ds_read_b64_tr_b16 a[4:5], v213 offset:1024
ds_read_b64_tr_b16 a[6:7], v213 offset:1280
ds_read_b64_tr_b16 a[8:9], v213 offset:2048
ds_read_b64_tr_b16 a[10:11], v213 offset:2304
ds_read_b64_tr_b16 a[12:13], v213 offset:3072
ds_read_b64_tr_b16 a[14:15], v213 offset:3328
s_waitcnt lgkmcnt(0)
s_add_u32 m0, s18, 0
s_add_u32 s19, s26, 737280
buffer_load_dwordx4 v212, s[40:43], s19 offen lds
s_add_u32 m0, s18, 1024
s_add_u32 s19, s26, 757760
buffer_load_dwordx4 v212, s[40:43], s19 offen lds
s_add_u32 m0, s18, 2048
s_add_u32 s19, s26, 778240
buffer_load_dwordx4 v212, s[40:43], s19 offen lds
s_add_u32 m0, s18, 3072
s_add_u32 s19, s26, 798720
buffer_load_dwordx4 v212, s[40:43], s19 offen lds
s_waitcnt vmcnt(32)
ds_read_b64_tr_b16 a[16:17], v213 offset:4096
ds_read_b64_tr_b16 a[18:19], v213 offset:4352
ds_read_b64_tr_b16 a[20:21], v213 offset:5120
ds_read_b64_tr_b16 a[22:23], v213 offset:5376
ds_read_b64_tr_b16 a[24:25], v213 offset:6144
ds_read_b64_tr_b16 a[26:27], v213 offset:6400
ds_read_b64_tr_b16 a[28:29], v213 offset:7168
ds_read_b64_tr_b16 a[30:31], v213 offset:7424
s_waitcnt lgkmcnt(0)
s_add_u32 m0, s18, 4096
s_add_u32 s19, s26, 819200
buffer_load_dwordx4 v212, s[40:43], s19 offen lds
s_add_u32 m0, s18, 5120
s_add_u32 s19, s26, 839680
buffer_load_dwordx4 v212, s[40:43], s19 offen lds
s_add_u32 m0, s18, 6144
s_add_u32 s19, s26, 860160
buffer_load_dwordx4 v212, s[40:43], s19 offen lds
s_add_u32 m0, s18, 7168
s_add_u32 s19, s26, 880640
buffer_load_dwordx4 v212, s[40:43], s19 offen lds
s_waitcnt vmcnt(32)
ds_read_b64_tr_b16 a[32:33], v213 offset:8192
ds_read_b64_tr_b16 a[34:35], v213 offset:8448
ds_read_b64_tr_b16 a[36:37], v213 offset:9216
ds_read_b64_tr_b16 a[38:39], v213 offset:9472
ds_read_b64_tr_b16 a[40:41], v213 offset:10240
ds_read_b64_tr_b16 a[42:43], v213 offset:10496
ds_read_b64_tr_b16 a[44:45], v213 offset:11264
ds_read_b64_tr_b16 a[46:47], v213 offset:11520
s_waitcnt lgkmcnt(0)
s_add_u32 m0, s18, 8192
s_add_u32 s19, s26, 901120
buffer_load_dwordx4 v212, s[40:43], s19 offen lds
s_add_u32 m0, s18, 9216
s_add_u32 s19, s26, 921600
buffer_load_dwordx4 v212, s[40:43], s19 offen lds
s_add_u32 m0, s18, 10240
s_add_u32 s19, s26, 942080
buffer_load_dwordx4 v212, s[40:43], s19 offen lds
s_add_u32 m0, s18, 11264
s_add_u32 s19, s26, 962560
buffer_load_dwordx4 v212, s[40:43], s19 offen lds
s_waitcnt vmcnt(32)
ds_read_b64_tr_b16 a[48:49], v213 offset:12288
ds_read_b64_tr_b16 a[50:51], v213 offset:12544
ds_read_b64_tr_b16 a[52:53], v213 offset:13312
ds_read_b64_tr_b16 a[54:55], v213 offset:13568
ds_read_b64_tr_b16 a[56:57], v213 offset:14336
ds_read_b64_tr_b16 a[58:59], v213 offset:14592
ds_read_b64_tr_b16 a[60:61], v213 offset:15360
ds_read_b64_tr_b16 a[62:63], v213 offset:15616
s_waitcnt lgkmcnt(0)
s_add_u32 m0, s18, 12288
s_add_u32 s19, s26, 983040
buffer_load_dwordx4 v212, s[40:43], s19 offen lds
s_add_u32 m0, s18, 13312
s_add_u32 s19, s26, 1003520
buffer_load_dwordx4 v212, s[40:43], s19 offen lds
s_add_u32 m0, s18, 14336
s_add_u32 s19, s26, 1024000
buffer_load_dwordx4 v212, s[40:43], s19 offen lds
s_add_u32 m0, s18, 15360
s_add_u32 s19, s26, 1044480
buffer_load_dwordx4 v212, s[40:43], s19 offen lds
s_waitcnt vmcnt(32)
ds_read_b64_tr_b16 a[64:65], v213 offset:16384
ds_read_b64_tr_b16 a[66:67], v213 offset:16640
ds_read_b64_tr_b16 a[68:69], v213 offset:17408
ds_read_b64_tr_b16 a[70:71], v213 offset:17664
ds_read_b64_tr_b16 a[72:73], v213 offset:18432
ds_read_b64_tr_b16 a[74:75], v213 offset:18688
ds_read_b64_tr_b16 a[76:77], v213 offset:19456
ds_read_b64_tr_b16 a[78:79], v213 offset:19712
s_waitcnt lgkmcnt(0)
s_add_u32 m0, s18, 16384
s_add_u32 s19, s26, 1064960
buffer_load_dwordx4 v212, s[40:43], s19 offen lds
s_add_u32 m0, s18, 17408
s_add_u32 s19, s26, 1085440
buffer_load_dwordx4 v212, s[40:43], s19 offen lds
s_add_u32 m0, s18, 18432
s_add_u32 s19, s26, 1105920
buffer_load_dwordx4 v212, s[40:43], s19 offen lds
s_add_u32 m0, s18, 19456
s_add_u32 s19, s26, 1126400
buffer_load_dwordx4 v212, s[40:43], s19 offen lds
s_waitcnt vmcnt(32)
ds_read_b64_tr_b16 a[80:81], v213 offset:20480
ds_read_b64_tr_b16 a[82:83], v213 offset:20736
ds_read_b64_tr_b16 a[84:85], v213 offset:21504
ds_read_b64_tr_b16 a[86:87], v213 offset:21760
ds_read_b64_tr_b16 a[88:89], v213 offset:22528
ds_read_b64_tr_b16 a[90:91], v213 offset:22784
ds_read_b64_tr_b16 a[92:93], v213 offset:23552
ds_read_b64_tr_b16 a[94:95], v213 offset:23808
s_waitcnt lgkmcnt(0)
s_add_u32 m0, s18, 20480
s_add_u32 s19, s26, 1146880
buffer_load_dwordx4 v212, s[40:43], s19 offen lds
s_add_u32 m0, s18, 21504
s_add_u32 s19, s26, 1167360
buffer_load_dwordx4 v212, s[40:43], s19 offen lds
s_add_u32 m0, s18, 22528
s_add_u32 s19, s26, 1187840
buffer_load_dwordx4 v212, s[40:43], s19 offen lds
s_add_u32 m0, s18, 23552
s_add_u32 s19, s26, 1208320
buffer_load_dwordx4 v212, s[40:43], s19 offen lds
s_waitcnt vmcnt(32)
ds_read_b64_tr_b16 a[96:97], v213 offset:24576
ds_read_b64_tr_b16 a[98:99], v213 offset:24832
ds_read_b64_tr_b16 a[100:101], v213 offset:25600
ds_read_b64_tr_b16 a[102:103], v213 offset:25856
ds_read_b64_tr_b16 a[104:105], v213 offset:26624
ds_read_b64_tr_b16 a[106:107], v213 offset:26880
ds_read_b64_tr_b16 a[108:109], v213 offset:27648
ds_read_b64_tr_b16 a[110:111], v213 offset:27904
s_waitcnt lgkmcnt(0)
s_add_u32 m0, s18, 24576
s_add_u32 s19, s26, 1228800
buffer_load_dwordx4 v212, s[40:43], s19 offen lds
s_add_u32 m0, s18, 25600
s_add_u32 s19, s26, 1249280
buffer_load_dwordx4 v212, s[40:43], s19 offen lds
s_add_u32 m0, s18, 26624
s_add_u32 s19, s26, 1269760
buffer_load_dwordx4 v212, s[40:43], s19 offen lds
s_add_u32 m0, s18, 27648
s_add_u32 s19, s26, 1290240
buffer_load_dwordx4 v212, s[40:43], s19 offen lds
s_waitcnt vmcnt(32)
ds_read_b64_tr_b16 a[112:113], v213 offset:28672
ds_read_b64_tr_b16 a[114:115], v213 offset:28928
ds_read_b64_tr_b16 a[116:117], v213 offset:29696
ds_read_b64_tr_b16 a[118:119], v213 offset:29952
ds_read_b64_tr_b16 a[120:121], v213 offset:30720
ds_read_b64_tr_b16 a[122:123], v213 offset:30976
ds_read_b64_tr_b16 a[124:125], v213 offset:31744
ds_read_b64_tr_b16 a[126:127], v213 offset:32000
s_waitcnt vmcnt(28)
ds_read_b64_tr_b16 a[128:129], v213 offset:32768
ds_read_b64_tr_b16 a[130:131], v213 offset:33024
ds_read_b64_tr_b16 a[132:133], v213 offset:33792
ds_read_b64_tr_b16 a[134:135], v213 offset:34048
ds_read_b64_tr_b16 a[136:137], v213 offset:34816
ds_read_b64_tr_b16 a[138:139], v213 offset:35072
ds_read_b64_tr_b16 a[140:141], v213 offset:35840
ds_read_b64_tr_b16 a[142:143], v213 offset:36096
s_waitcnt vmcnt(24)
ds_read_b64_tr_b16 a[144:145], v213 offset:0
ds_read_b64_tr_b16 a[146:147], v213 offset:256
ds_read_b64_tr_b16 a[148:149], v213 offset:1024
ds_read_b64_tr_b16 a[150:151], v213 offset:1280
ds_read_b64_tr_b16 a[152:153], v213 offset:2048
ds_read_b64_tr_b16 a[154:155], v213 offset:2304
ds_read_b64_tr_b16 a[156:157], v213 offset:3072
ds_read_b64_tr_b16 a[158:159], v213 offset:3328
s_waitcnt vmcnt(20)
ds_read_b64_tr_b16 a[160:161], v213 offset:4096
ds_read_b64_tr_b16 a[162:163], v213 offset:4352
ds_read_b64_tr_b16 a[164:165], v213 offset:5120
ds_read_b64_tr_b16 a[166:167], v213 offset:5376
ds_read_b64_tr_b16 a[168:169], v213 offset:6144
ds_read_b64_tr_b16 a[170:171], v213 offset:6400
ds_read_b64_tr_b16 a[172:173], v213 offset:7168
ds_read_b64_tr_b16 a[174:175], v213 offset:7424
s_waitcnt vmcnt(16)
ds_read_b64_tr_b16 a[176:177], v213 offset:8192
ds_read_b64_tr_b16 a[178:179], v213 offset:8448
ds_read_b64_tr_b16 a[180:181], v213 offset:9216
ds_read_b64_tr_b16 a[182:183], v213 offset:9472
ds_read_b64_tr_b16 a[184:185], v213 offset:10240
ds_read_b64_tr_b16 a[186:187], v213 offset:10496
ds_read_b64_tr_b16 a[188:189], v213 offset:11264
ds_read_b64_tr_b16 a[190:191], v213 offset:11520
s_waitcnt vmcnt(12)
ds_read_b64_tr_b16 a[192:193], v213 offset:12288
ds_read_b64_tr_b16 a[194:195], v213 offset:12544
ds_read_b64_tr_b16 a[196:197], v213 offset:13312
ds_read_b64_tr_b16 a[198:199], v213 offset:13568
ds_read_b64_tr_b16 a[200:201], v213 offset:14336
ds_read_b64_tr_b16 a[202:203], v213 offset:14592
ds_read_b64_tr_b16 a[204:205], v213 offset:15360
ds_read_b64_tr_b16 a[206:207], v213 offset:15616
s_waitcnt vmcnt(8)
ds_read_b64_tr_b16 a[208:209], v213 offset:16384
ds_read_b64_tr_b16 a[210:211], v213 offset:16640
ds_read_b64_tr_b16 a[212:213], v213 offset:17408
ds_read_b64_tr_b16 a[214:215], v213 offset:17664
ds_read_b64_tr_b16 a[216:217], v213 offset:18432
ds_read_b64_tr_b16 a[218:219], v213 offset:18688
ds_read_b64_tr_b16 a[220:221], v213 offset:19456
ds_read_b64_tr_b16 a[222:223], v213 offset:19712
s_waitcnt vmcnt(4)
ds_read_b64_tr_b16 a[224:225], v213 offset:20480
ds_read_b64_tr_b16 a[226:227], v213 offset:20736
ds_read_b64_tr_b16 a[228:229], v213 offset:21504
ds_read_b64_tr_b16 a[230:231], v213 offset:21760
ds_read_b64_tr_b16 a[232:233], v213 offset:22528
ds_read_b64_tr_b16 a[234:235], v213 offset:22784
ds_read_b64_tr_b16 a[236:237], v213 offset:23552
ds_read_b64_tr_b16 a[238:239], v213 offset:23808
s_waitcnt vmcnt(0)
ds_read_b64_tr_b16 a[240:241], v213 offset:24576
ds_read_b64_tr_b16 a[242:243], v213 offset:24832
ds_read_b64_tr_b16 a[244:245], v213 offset:25600
ds_read_b64_tr_b16 a[246:247], v213 offset:25856
ds_read_b64_tr_b16 a[248:249], v213 offset:26624
ds_read_b64_tr_b16 a[250:251], v213 offset:26880
ds_read_b64_tr_b16 a[252:253], v213 offset:27648
ds_read_b64_tr_b16 a[254:255], v213 offset:27904
s_waitcnt lgkmcnt(0)
s_barrier
ww_65:
s_load_dwordx2 s[56:57], s[0:1], 80
s_mov_b32 s58, 2621440
s_mov_b32 s59, 0x20000
s_waitcnt lgkmcnt(0)
s_lshl_b32 s18, s13, 12
v_add_u32 v13, s18, v0
s_lshl_b32 s18, s13, 11
v_add_u32 v14, s18, v0
ws_66:
s_lshl_b32 s18, s16, 6
s_add_u32 s18, s18, s30
s_lshl_b32 s26, s18, 18
s_lshl_b32 s19, s13, 16
s_add_u32 s26, s26, s19
s_add_u32 s26, s26, 127926272
s_lshl_b32 s18, s18, 7
s_lshl_b32 s19, s13, 5
s_add_u32 s18, s18, s19
s_add_u32 s28, s18, 16384
s_mul_i32 s27, s30, 40960
s_and_b32 s18, s13, 1
s_lshl_b32 s19, s52, 1
s_add_u32 s29, s18, s19
v_lshrrev_b32 v12, 2, v0
v_min_u32 v12, 28, v12
s_mov_b32 s17, 0
poll_70:
buffer_load_dword v8, v12, s[4:7], s28 offen offset:0 sc1
s_add_u32 s17, s17, 1
s_cmp_gt_u32 s17, 262144
s_cbranch_scc1 L_fail
s_waitcnt vmcnt(0)
v_cmp_gt_u32 vcc, 1, v8
s_cbranch_vccz polld_71
s_sleep 2
s_branch poll_70
polld_71:
s_lshl_b32 s18, s29, 10
s_add_u32 s18, s18, s27
s_mul_i32 s19, s16, 6291456
s_add_u32 s18, s18, s19
s_add_u32 s18, s18, 88080384
s_add_u32 s19, s26, 0
buffer_load_dwordx4 v[16:19], v0, s[4:7], s19 offen offset:0 sc1
buffer_load_dwordx4 v[20:23], v0, s[4:7], s19 offen offset:1024 sc1
buffer_load_dwordx4 v[24:27], v0, s[4:7], s19 offen offset:2048 sc1
buffer_load_dwordx4 v[28:31], v0, s[4:7], s19 offen offset:3072 sc1
s_add_u32 s19, s26, 4096
buffer_load_dwordx4 v[32:35], v0, s[4:7], s19 offen offset:0 sc1
buffer_load_dwordx4 v[36:39], v0, s[4:7], s19 offen offset:1024 sc1
buffer_load_dwordx4 v[40:43], v0, s[4:7], s19 offen offset:2048 sc1
buffer_load_dwordx4 v[44:47], v0, s[4:7], s19 offen offset:3072 sc1
s_add_u32 s19, s26, 8192
buffer_load_dwordx4 v[48:51], v0, s[4:7], s19 offen offset:0 sc1
buffer_load_dwordx4 v[52:55], v0, s[4:7], s19 offen offset:1024 sc1
buffer_load_dwordx4 v[56:59], v0, s[4:7], s19 offen offset:2048 sc1
buffer_load_dwordx4 v[60:63], v0, s[4:7], s19 offen offset:3072 sc1
s_add_u32 s19, s26, 12288
buffer_load_dwordx4 v[64:67], v0, s[4:7], s19 offen offset:0 sc1
buffer_load_dwordx4 v[68:71], v0, s[4:7], s19 offen offset:1024 sc1
buffer_load_dwordx4 v[72:75], v0, s[4:7], s19 offen offset:2048 sc1
buffer_load_dwordx4 v[76:79], v0, s[4:7], s19 offen offset:3072 sc1
s_add_u32 s19, s26, 16384
buffer_load_dwordx4 v[80:83], v0, s[4:7], s19 offen offset:0 sc1
buffer_load_dwordx4 v[84:87], v0, s[4:7], s19 offen offset:1024 sc1
buffer_load_dwordx4 v[88:91], v0, s[4:7], s19 offen offset:2048 sc1
buffer_load_dwordx4 v[92:95], v0, s[4:7], s19 offen offset:3072 sc1
s_add_u32 s19, s26, 20480
buffer_load_dwordx4 v[96:99], v0, s[4:7], s19 offen offset:0 sc1
buffer_load_dwordx4 v[100:103], v0, s[4:7], s19 offen offset:1024 sc1
buffer_load_dwordx4 v[104:107], v0, s[4:7], s19 offen offset:2048 sc1
buffer_load_dwordx4 v[108:111], v0, s[4:7], s19 offen offset:3072 sc1
s_add_u32 s19, s26, 24576
buffer_load_dwordx4 v[112:115], v0, s[4:7], s19 offen offset:0 sc1
buffer_load_dwordx4 v[116:119], v0, s[4:7], s19 offen offset:1024 sc1
buffer_load_dwordx4 v[120:123], v0, s[4:7], s19 offen offset:2048 sc1
buffer_load_dwordx4 v[124:127], v0, s[4:7], s19 offen offset:3072 sc1
s_add_u32 s19, s26, 28672
buffer_load_dwordx4 v[128:131], v0, s[4:7], s19 offen offset:0 sc1
buffer_load_dwordx4 v[132:135], v0, s[4:7], s19 offen offset:1024 sc1
buffer_load_dwordx4 v[136:139], v0, s[4:7], s19 offen offset:2048 sc1
buffer_load_dwordx4 v[140:143], v0, s[4:7], s19 offen offset:3072 sc1
s_add_u32 s19, s26, 32768
buffer_load_dwordx4 v[144:147], v0, s[4:7], s19 offen offset:0 sc1
buffer_load_dwordx4 v[148:151], v0, s[4:7], s19 offen offset:1024 sc1
buffer_load_dwordx4 v[152:155], v0, s[4:7], s19 offen offset:2048 sc1
buffer_load_dwordx4 v[156:159], v0, s[4:7], s19 offen offset:3072 sc1
s_add_u32 s19, s26, 36864
buffer_load_dwordx4 v[160:163], v0, s[4:7], s19 offen offset:0 sc1
buffer_load_dwordx4 v[164:167], v0, s[4:7], s19 offen offset:1024 sc1
buffer_load_dwordx4 v[168:171], v0, s[4:7], s19 offen offset:2048 sc1
buffer_load_dwordx4 v[172:175], v0, s[4:7], s19 offen offset:3072 sc1
s_add_u32 s19, s26, 40960
buffer_load_dwordx4 v[176:179], v0, s[4:7], s19 offen offset:0 sc1
buffer_load_dwordx4 v[180:183], v0, s[4:7], s19 offen offset:1024 sc1
buffer_load_dwordx4 v[184:187], v0, s[4:7], s19 offen offset:2048 sc1
buffer_load_dwordx4 v[188:191], v0, s[4:7], s19 offen offset:3072 sc1
s_waitcnt vmcnt(43)
v_mfma_f32_32x32x16_bf16 v[192:207], a[0:3], v[16:19], 0
s_add_u32 s19, s26, 45056
buffer_load_dwordx4 v[16:19], v0, s[4:7], s19 offen offset:0 sc1
s_waitcnt vmcnt(43)
v_mfma_f32_32x32x16_bf16 v[192:207], a[4:7], v[20:23], v[192:207]
buffer_load_dwordx4 v[20:23], v0, s[4:7], s19 offen offset:1024 sc1
s_waitcnt vmcnt(43)
v_mfma_f32_32x32x16_bf16 v[192:207], a[8:11], v[24:27], v[192:207]
buffer_load_dwordx4 v[24:27], v0, s[4:7], s19 offen offset:2048 sc1
s_waitcnt vmcnt(43)
v_mfma_f32_32x32x16_bf16 v[192:207], a[12:15], v[28:31], v[192:207]
buffer_load_dwordx4 v[28:31], v0, s[4:7], s19 offen offset:3072 sc1
s_waitcnt vmcnt(43)
v_mfma_f32_32x32x16_bf16 v[192:207], a[16:19], v[32:35], v[192:207]
s_add_u32 s19, s26, 49152
buffer_load_dwordx4 v[32:35], v0, s[4:7], s19 offen offset:0 sc1
s_waitcnt vmcnt(43)
v_mfma_f32_32x32x16_bf16 v[192:207], a[20:23], v[36:39], v[192:207]
buffer_load_dwordx4 v[36:39], v0, s[4:7], s19 offen offset:1024 sc1
s_waitcnt vmcnt(43)
v_mfma_f32_32x32x16_bf16 v[192:207], a[24:27], v[40:43], v[192:207]
buffer_load_dwordx4 v[40:43], v0, s[4:7], s19 offen offset:2048 sc1
s_waitcnt vmcnt(43)
v_mfma_f32_32x32x16_bf16 v[192:207], a[28:31], v[44:47], v[192:207]
buffer_load_dwordx4 v[44:47], v0, s[4:7], s19 offen offset:3072 sc1
s_waitcnt vmcnt(43)
v_mfma_f32_32x32x16_bf16 v[192:207], a[32:35], v[48:51], v[192:207]
s_add_u32 s19, s26, 53248
buffer_load_dwordx4 v[48:51], v0, s[4:7], s19 offen offset:0 sc1
s_waitcnt vmcnt(43)
v_mfma_f32_32x32x16_bf16 v[192:207], a[36:39], v[52:55], v[192:207]
buffer_load_dwordx4 v[52:55], v0, s[4:7], s19 offen offset:1024 sc1
s_waitcnt vmcnt(43)
v_mfma_f32_32x32x16_bf16 v[192:207], a[40:43], v[56:59], v[192:207]
buffer_load_dwordx4 v[56:59], v0, s[4:7], s19 offen offset:2048 sc1
s_waitcnt vmcnt(43)
v_mfma_f32_32x32x16_bf16 v[192:207], a[44:47], v[60:63], v[192:207]
buffer_load_dwordx4 v[60:63], v0, s[4:7], s19 offen offset:3072 sc1
s_waitcnt vmcnt(43)
v_mfma_f32_32x32x16_bf16 v[192:207], a[48:51], v[64:67], v[192:207]
s_add_u32 s19, s26, 57344
buffer_load_dwordx4 v[64:67], v0, s[4:7], s19 offen offset:0 sc1
s_waitcnt vmcnt(43)
v_mfma_f32_32x32x16_bf16 v[192:207], a[52:55], v[68:71], v[192:207]
buffer_load_dwordx4 v[68:71], v0, s[4:7], s19 offen offset:1024 sc1
s_waitcnt vmcnt(43)
v_mfma_f32_32x32x16_bf16 v[192:207], a[56:59], v[72:75], v[192:207]
buffer_load_dwordx4 v[72:75], v0, s[4:7], s19 offen offset:2048 sc1
s_waitcnt vmcnt(43)
v_mfma_f32_32x32x16_bf16 v[192:207], a[60:63], v[76:79], v[192:207]
buffer_load_dwordx4 v[76:79], v0, s[4:7], s19 offen offset:3072 sc1
s_waitcnt vmcnt(43)
v_mfma_f32_32x32x16_bf16 v[192:207], a[64:67], v[80:83], v[192:207]
s_add_u32 s19, s26, 61440
buffer_load_dwordx4 v[80:83], v0, s[4:7], s19 offen offset:0 sc1
s_waitcnt vmcnt(43)
v_mfma_f32_32x32x16_bf16 v[192:207], a[68:71], v[84:87], v[192:207]
buffer_load_dwordx4 v[84:87], v0, s[4:7], s19 offen offset:1024 sc1
s_waitcnt vmcnt(43)
v_mfma_f32_32x32x16_bf16 v[192:207], a[72:75], v[88:91], v[192:207]
buffer_load_dwordx4 v[88:91], v0, s[4:7], s19 offen offset:2048 sc1
s_waitcnt vmcnt(43)
v_mfma_f32_32x32x16_bf16 v[192:207], a[76:79], v[92:95], v[192:207]
buffer_load_dwordx4 v[92:95], v0, s[4:7], s19 offen offset:3072 sc1
s_waitcnt vmcnt(43)
v_mfma_f32_32x32x16_bf16 v[192:207], a[80:83], v[96:99], v[192:207]
buffer_load_dwordx4 v[208:211], v0, s[4:7], s18 offen sc1
s_waitcnt vmcnt(43)
v_mfma_f32_32x32x16_bf16 v[192:207], a[84:87], v[100:103], v[192:207]
s_waitcnt vmcnt(42)
v_mfma_f32_32x32x16_bf16 v[192:207], a[88:91], v[104:107], v[192:207]
s_waitcnt vmcnt(41)
v_mfma_f32_32x32x16_bf16 v[192:207], a[92:95], v[108:111], v[192:207]
s_waitcnt vmcnt(40)
v_mfma_f32_32x32x16_bf16 v[192:207], a[96:99], v[112:115], v[192:207]
s_waitcnt vmcnt(39)
v_mfma_f32_32x32x16_bf16 v[192:207], a[100:103], v[116:119], v[192:207]
s_waitcnt vmcnt(38)
v_mfma_f32_32x32x16_bf16 v[192:207], a[104:107], v[120:123], v[192:207]
s_waitcnt vmcnt(37)
v_mfma_f32_32x32x16_bf16 v[192:207], a[108:111], v[124:127], v[192:207]
s_waitcnt vmcnt(36)
v_mfma_f32_32x32x16_bf16 v[192:207], a[112:115], v[128:131], v[192:207]
s_waitcnt vmcnt(35)
v_mfma_f32_32x32x16_bf16 v[192:207], a[116:119], v[132:135], v[192:207]
s_waitcnt vmcnt(34)
v_mfma_f32_32x32x16_bf16 v[192:207], a[120:123], v[136:139], v[192:207]
s_waitcnt vmcnt(33)
v_mfma_f32_32x32x16_bf16 v[192:207], a[124:127], v[140:143], v[192:207]
s_waitcnt vmcnt(32)
v_mfma_f32_32x32x16_bf16 v[192:207], a[128:131], v[144:147], v[192:207]
s_waitcnt vmcnt(31)
v_mfma_f32_32x32x16_bf16 v[192:207], a[132:135], v[148:151], v[192:207]
s_waitcnt vmcnt(30)
v_mfma_f32_32x32x16_bf16 v[192:207], a[136:139], v[152:155], v[192:207]
s_waitcnt vmcnt(29)
v_mfma_f32_32x32x16_bf16 v[192:207], a[140:143], v[156:159], v[192:207]
s_waitcnt vmcnt(28)
v_mfma_f32_32x32x16_bf16 v[192:207], a[144:147], v[160:163], v[192:207]
s_waitcnt vmcnt(27)
v_mfma_f32_32x32x16_bf16 v[192:207], a[148:151], v[164:167], v[192:207]
s_waitcnt vmcnt(26)
v_mfma_f32_32x32x16_bf16 v[192:207], a[152:155], v[168:171], v[192:207]
s_waitcnt vmcnt(25)
v_mfma_f32_32x32x16_bf16 v[192:207], a[156:159], v[172:175], v[192:207]
s_waitcnt vmcnt(24)
v_mfma_f32_32x32x16_bf16 v[192:207], a[160:163], v[176:179], v[192:207]
s_waitcnt vmcnt(23)
v_mfma_f32_32x32x16_bf16 v[192:207], a[164:167], v[180:183], v[192:207]
s_waitcnt vmcnt(22)
v_mfma_f32_32x32x16_bf16 v[192:207], a[168:171], v[184:187], v[192:207]
s_waitcnt vmcnt(21)
v_mfma_f32_32x32x16_bf16 v[192:207], a[172:175], v[188:191], v[192:207]
s_waitcnt vmcnt(20)
v_mfma_f32_32x32x16_bf16 v[192:207], a[176:179], v[16:19], v[192:207]
s_waitcnt vmcnt(19)
v_mfma_f32_32x32x16_bf16 v[192:207], a[180:183], v[20:23], v[192:207]
s_waitcnt vmcnt(18)
v_mfma_f32_32x32x16_bf16 v[192:207], a[184:187], v[24:27], v[192:207]
s_waitcnt vmcnt(17)
v_mfma_f32_32x32x16_bf16 v[192:207], a[188:191], v[28:31], v[192:207]
s_waitcnt vmcnt(16)
v_mfma_f32_32x32x16_bf16 v[192:207], a[192:195], v[32:35], v[192:207]
s_waitcnt vmcnt(15)
v_mfma_f32_32x32x16_bf16 v[192:207], a[196:199], v[36:39], v[192:207]
s_waitcnt vmcnt(14)
v_mfma_f32_32x32x16_bf16 v[192:207], a[200:203], v[40:43], v[192:207]
s_waitcnt vmcnt(13)
v_mfma_f32_32x32x16_bf16 v[192:207], a[204:207], v[44:47], v[192:207]
s_waitcnt vmcnt(12)
v_mfma_f32_32x32x16_bf16 v[192:207], a[208:211], v[48:51], v[192:207]
s_waitcnt vmcnt(11)
v_mfma_f32_32x32x16_bf16 v[192:207], a[212:215], v[52:55], v[192:207]
s_waitcnt vmcnt(10)
v_mfma_f32_32x32x16_bf16 v[192:207], a[216:219], v[56:59], v[192:207]
s_waitcnt vmcnt(9)
v_mfma_f32_32x32x16_bf16 v[192:207], a[220:223], v[60:63], v[192:207]
s_waitcnt vmcnt(8)
v_mfma_f32_32x32x16_bf16 v[192:207], a[224:227], v[64:67], v[192:207]
s_waitcnt vmcnt(7)
v_mfma_f32_32x32x16_bf16 v[192:207], a[228:231], v[68:71], v[192:207]
s_waitcnt vmcnt(6)
v_mfma_f32_32x32x16_bf16 v[192:207], a[232:235], v[72:75], v[192:207]
s_waitcnt vmcnt(5)
v_mfma_f32_32x32x16_bf16 v[192:207], a[236:239], v[76:79], v[192:207]
s_waitcnt vmcnt(4)
v_mfma_f32_32x32x16_bf16 v[192:207], a[240:243], v[80:83], v[192:207]
s_waitcnt vmcnt(3)
v_mfma_f32_32x32x16_bf16 v[192:207], a[244:247], v[84:87], v[192:207]
s_waitcnt vmcnt(2)
v_mfma_f32_32x32x16_bf16 v[192:207], a[248:251], v[88:91], v[192:207]
s_waitcnt vmcnt(1)
v_mfma_f32_32x32x16_bf16 v[192:207], a[252:255], v[92:95], v[192:207]
s_nop 11
ds_write_b128 v13, v[192:195] offset:0
ds_write_b128 v13, v[196:199] offset:1024
ds_write_b128 v13, v[200:203] offset:2048
ds_write_b128 v13, v[204:207] offset:3072
s_waitcnt lgkmcnt(0)
s_barrier
s_cmp_ge_u32 s13, 2
s_cbranch_scc1 wn_67
ds_read_b128 v[16:19], v14 offset:0
ds_read_b128 v[20:23], v14 offset:1024
ds_read_b128 v[24:27], v14 offset:4096
ds_read_b128 v[28:31], v14 offset:5120
ds_read_b128 v[32:35], v14 offset:8192
ds_read_b128 v[36:39], v14 offset:9216
ds_read_b128 v[40:43], v14 offset:12288
ds_read_b128 v[44:47], v14 offset:13312
s_waitcnt vmcnt(0)
v_lshlrev_b32 v192, 16, v208
v_and_b32 v193, 0xffff0000, v208
v_lshlrev_b32 v194, 16, v209
v_and_b32 v195, 0xffff0000, v209
v_lshlrev_b32 v196, 16, v210
v_and_b32 v197, 0xffff0000, v210
v_lshlrev_b32 v198, 16, v211
v_and_b32 v199, 0xffff0000, v211
s_waitcnt lgkmcnt(5)
v_add_f32 v16, v16, v24
s_waitcnt lgkmcnt(1)
v_add_f32 v32, v32, v40
v_add_f32 v17, v17, v25
v_add_f32 v33, v33, v41
v_add_f32 v18, v18, v26
v_add_f32 v34, v34, v42
v_add_f32 v19, v19, v27
v_add_f32 v35, v35, v43
v_add_f32 v20, v20, v28
s_waitcnt lgkmcnt(0)
v_add_f32 v36, v36, v44
v_add_f32 v21, v21, v29
v_add_f32 v37, v37, v45
v_add_f32 v22, v22, v30
v_add_f32 v38, v38, v46
v_add_f32 v23, v23, v31
v_add_f32 v39, v39, v47
v_add_f32 v16, v16, v32
v_add_f32 v17, v17, v33
v_add_f32 v18, v18, v34
v_add_f32 v19, v19, v35
v_add_f32 v20, v20, v36
v_add_f32 v21, v21, v37
v_add_f32 v22, v22, v38
v_add_f32 v23, v23, v39
v_add_f32 v16, v16, v192
v_add_f32 v17, v17, v193
v_add_f32 v18, v18, v194
v_add_f32 v19, v19, v195
v_add_f32 v20, v20, v196
v_add_f32 v21, v21, v197
v_add_f32 v22, v22, v198
v_add_f32 v23, v23, v199
v_cvt_pk_bf16_f32 v208, v16, v17
v_cvt_pk_bf16_f32 v209, v18, v19
v_cvt_pk_bf16_f32 v210, v20, v21
v_cvt_pk_bf16_f32 v211, v22, v23
s_cmp_lg_u32 s16, 0
s_cbranch_scc1 wo_68
s_add_u32 s18, s18, 3145728
buffer_store_dwordx4 v[208:211], v0, s[4:7], s18 offen sc1
s_branch wn_67
wo_68:
s_lshl_b32 s18, s29, 5
s_add_u32 s18, s18, s27
buffer_store_dwordx4 v[208:211], v5, s[56:59], s18 offen
wn_67:
s_lshl_b32 s18, s30, 7
s_lshl_b32 s19, s52, 2
s_add_u32 s18, s18, s19
s_add_u32 s18, s18, 32768
s_cmp_eq_u32 s13, 0
s_cselect_b32 s22, s18, s6
s_mov_b32 s23, 1
s_waitcnt vmcnt(0)
s_barrier
v_mov_b32 v3, s23
s_mov_b64 exec, 1
buffer_store_dword v3, off, s[4:7], s22 sc1
s_mov_b64 exec, -1
s_mov_b32 s22, s6
s_add_u32 s30, s30, 4
s_cmp_lt_u32 s30, 64
s_cbranch_scc1 ws_66
s_branch aend_54
p1b_53:
s_cmp_eq_u32 s39, 144
s_cbranch_scc1 aend_54
s_sub_u32 s30, s50, 29
s_sub_u32 s51, s39, 145
p1c_55:
s_cmp_lg_u32 s16, 0
s_cbranch_scc1 aend_54
s_lshl_b32 s18, s34, 7
s_lshl_b32 s19, s13, 5
s_add_u32 s18, s18, s19
s_mov_b32 s19, 0x3acccccd
v_bfe_u32 v198, v0, 4, 5
v_lshrrev_b32 v193, 9, v0
v_add_u32 v198, s18, v198
v_and_b32 v197, 1, v198
v_mul_u32_u24 v197, 160, v197
v_lshrrev_b32 v196, 1, v198
v_add_u32 v196, 1, v196
v_lshlrev_b32 v193, 3, v193
v_mad_u32_u24 v197, v193, v196, v197
v_mad_u32_u24 v192, v196, 16, 0
v_cvt_f32_u32 v192, v192
v_mul_f32 v198, s19, v192
v_rndne_f32 v198, v198
v_fmac_f32 v192, 0xc4200000, v198
v_mul_f32 v192, s19, v192
v_cos_f32 v192, v192
s_nop 0
v_add_f32 v192, v192, v192
v_mad_u32_u24 v194, v196, 1, 0
v_cvt_f32_u32 v194, v194
v_mul_f32 v198, s19, v194
v_rndne_f32 v198, v198
v_fmac_f32 v194, 0xc4200000, v198
v_mul_f32 v194, s19, v194
v_cos_f32 v194, v194
s_nop 0
v_add_f32 v194, v194, v194
v_mad_u32_u24 v179, v196, 3, v197
v_cvt_f32_u32 v179, v179
v_mul_f32 v198, s19, v179
v_rndne_f32 v198, v198
v_fmac_f32 v179, 0xc4200000, v198
v_mul_f32 v179, s19, v179
v_cos_f32 v179, v179
v_mad_u32_u24 v180, v196, 4, v197
v_cvt_f32_u32 v180, v180
v_mul_f32 v198, s19, v180
v_rndne_f32 v198, v198
v_fmac_f32 v180, 0xc4200000, v198
v_mul_f32 v180, s19, v180
v_cos_f32 v180, v180
s_nop 0
v_fma_f32 v181, v194, v180, -v179
v_fma_f32 v178, v194, v179, -v180
v_fma_f32 v182, v194, v181, -v180
v_fma_f32 v177, v194, v178, -v179
v_fma_f32 v183, v194, v182, -v181
v_fma_f32 v176, v194, v177, -v178
v_cvt_pk_bf16_f32 v16, v176, v177
v_cvt_pk_bf16_f32 v17, v178, v179
v_cvt_pk_bf16_f32 v18, v180, v181
v_cvt_pk_bf16_f32 v19, v182, v183
v_mad_u32_u24 v187, v196, 19, v197
v_cvt_f32_u32 v187, v187
v_mul_f32 v198, s19, v187
v_rndne_f32 v198, v198
v_fmac_f32 v187, 0xc4200000, v198
v_mul_f32 v187, s19, v187
v_cos_f32 v187, v187
v_mad_u32_u24 v188, v196, 20, v197
v_cvt_f32_u32 v188, v188
v_mul_f32 v198, s19, v188
v_rndne_f32 v198, v198
v_fmac_f32 v188, 0xc4200000, v198
v_mul_f32 v188, s19, v188
v_cos_f32 v188, v188
s_nop 0
v_fma_f32 v189, v194, v188, -v187
v_fma_f32 v186, v194, v187, -v188
v_fma_f32 v190, v194, v189, -v188
v_fma_f32 v185, v194, v186, -v187
v_fma_f32 v191, v194, v190, -v189
v_fma_f32 v184, v194, v185, -v186
v_cvt_pk_bf16_f32 v20, v184, v185
v_cvt_pk_bf16_f32 v21, v186, v187
v_cvt_pk_bf16_f32 v22, v188, v189
v_cvt_pk_bf16_f32 v23, v190, v191
v_pk_fma_f32 v[176:177], v[192:193], v[184:185], v[176:177] op_sel_hi:[0,1,1] neg_lo:[0,0,1] neg_hi:[0,0,1]
v_pk_fma_f32 v[178:179], v[192:193], v[186:187], v[178:179] op_sel_hi:[0,1,1] neg_lo:[0,0,1] neg_hi:[0,0,1]
v_pk_fma_f32 v[180:181], v[192:193], v[188:189], v[180:181] op_sel_hi:[0,1,1] neg_lo:[0,0,1] neg_hi:[0,0,1]
v_pk_fma_f32 v[182:183], v[192:193], v[190:191], v[182:183] op_sel_hi:[0,1,1] neg_lo:[0,0,1] neg_hi:[0,0,1]
v_cvt_pk_bf16_f32 v24, v176, v177
v_cvt_pk_bf16_f32 v25, v178, v179
v_cvt_pk_bf16_f32 v26, v180, v181
v_cvt_pk_bf16_f32 v27, v182, v183
v_pk_fma_f32 v[184:185], v[192:193], v[176:177], v[184:185] op_sel_hi:[0,1,1] neg_lo:[0,0,1] neg_hi:[0,0,1]
v_pk_fma_f32 v[186:187], v[192:193], v[178:179], v[186:187] op_sel_hi:[0,1,1] neg_lo:[0,0,1] neg_hi:[0,0,1]
v_pk_fma_f32 v[188:189], v[192:193], v[180:181], v[188:189] op_sel_hi:[0,1,1] neg_lo:[0,0,1] neg_hi:[0,0,1]
v_pk_fma_f32 v[190:191], v[192:193], v[182:183], v[190:191] op_sel_hi:[0,1,1] neg_lo:[0,0,1] neg_hi:[0,0,1]
v_cvt_pk_bf16_f32 v28, v184, v185
v_cvt_pk_bf16_f32 v29, v186, v187
v_cvt_pk_bf16_f32 v30, v188, v189
v_cvt_pk_bf16_f32 v31, v190, v191
v_pk_fma_f32 v[176:177], v[192:193], v[184:185], v[176:177] op_sel_hi:[0,1,1] neg_lo:[0,0,1] neg_hi:[0,0,1]
v_pk_fma_f32 v[178:179], v[192:193], v[186:187], v[178:179] op_sel_hi:[0,1,1] neg_lo:[0,0,1] neg_hi:[0,0,1]
v_pk_fma_f32 v[180:181], v[192:193], v[188:189], v[180:181] op_sel_hi:[0,1,1] neg_lo:[0,0,1] neg_hi:[0,0,1]
v_pk_fma_f32 v[182:183], v[192:193], v[190:191], v[182:183] op_sel_hi:[0,1,1] neg_lo:[0,0,1] neg_hi:[0,0,1]
v_cvt_pk_bf16_f32 v32, v176, v177
v_cvt_pk_bf16_f32 v33, v178, v179
v_cvt_pk_bf16_f32 v34, v180, v181
v_cvt_pk_bf16_f32 v35, v182, v183
v_pk_fma_f32 v[184:185], v[192:193], v[176:177], v[184:185] op_sel_hi:[0,1,1] neg_lo:[0,0,1] neg_hi:[0,0,1]
v_pk_fma_f32 v[186:187], v[192:193], v[178:179], v[186:187] op_sel_hi:[0,1,1] neg_lo:[0,0,1] neg_hi:[0,0,1]
v_pk_fma_f32 v[188:189], v[192:193], v[180:181], v[188:189] op_sel_hi:[0,1,1] neg_lo:[0,0,1] neg_hi:[0,0,1]
v_pk_fma_f32 v[190:191], v[192:193], v[182:183], v[190:191] op_sel_hi:[0,1,1] neg_lo:[0,0,1] neg_hi:[0,0,1]
v_cvt_pk_bf16_f32 v36, v184, v185
v_cvt_pk_bf16_f32 v37, v186, v187
v_cvt_pk_bf16_f32 v38, v188, v189
v_cvt_pk_bf16_f32 v39, v190, v191
v_pk_fma_f32 v[176:177], v[192:193], v[184:185], v[176:177] op_sel_hi:[0,1,1] neg_lo:[0,0,1] neg_hi:[0,0,1]
v_pk_fma_f32 v[178:179], v[192:193], v[186:187], v[178:179] op_sel_hi:[0,1,1] neg_lo:[0,0,1] neg_hi:[0,0,1]
v_pk_fma_f32 v[180:181], v[192:193], v[188:189], v[180:181] op_sel_hi:[0,1,1] neg_lo:[0,0,1] neg_hi:[0,0,1]
v_pk_fma_f32 v[182:183], v[192:193], v[190:191], v[182:183] op_sel_hi:[0,1,1] neg_lo:[0,0,1] neg_hi:[0,0,1]
v_cvt_pk_bf16_f32 v40, v176, v177
v_cvt_pk_bf16_f32 v41, v178, v179
v_cvt_pk_bf16_f32 v42, v180, v181
v_cvt_pk_bf16_f32 v43, v182, v183
v_pk_fma_f32 v[184:185], v[192:193], v[176:177], v[184:185] op_sel_hi:[0,1,1] neg_lo:[0,0,1] neg_hi:[0,0,1]
v_pk_fma_f32 v[186:187], v[192:193], v[178:179], v[186:187] op_sel_hi:[0,1,1] neg_lo:[0,0,1] neg_hi:[0,0,1]
v_pk_fma_f32 v[188:189], v[192:193], v[180:181], v[188:189] op_sel_hi:[0,1,1] neg_lo:[0,0,1] neg_hi:[0,0,1]
v_pk_fma_f32 v[190:191], v[192:193], v[182:183], v[190:191] op_sel_hi:[0,1,1] neg_lo:[0,0,1] neg_hi:[0,0,1]
v_cvt_pk_bf16_f32 v44, v184, v185
v_cvt_pk_bf16_f32 v45, v186, v187
v_cvt_pk_bf16_f32 v46, v188, v189
v_cvt_pk_bf16_f32 v47, v190, v191
v_pk_fma_f32 v[176:177], v[192:193], v[184:185], v[176:177] op_sel_hi:[0,1,1] neg_lo:[0,0,1] neg_hi:[0,0,1]
v_pk_fma_f32 v[178:179], v[192:193], v[186:187], v[178:179] op_sel_hi:[0,1,1] neg_lo:[0,0,1] neg_hi:[0,0,1]
v_pk_fma_f32 v[180:181], v[192:193], v[188:189], v[180:181] op_sel_hi:[0,1,1] neg_lo:[0,0,1] neg_hi:[0,0,1]
v_pk_fma_f32 v[182:183], v[192:193], v[190:191], v[182:183] op_sel_hi:[0,1,1] neg_lo:[0,0,1] neg_hi:[0,0,1]
v_cvt_pk_bf16_f32 v48, v176, v177
v_cvt_pk_bf16_f32 v49, v178, v179
v_cvt_pk_bf16_f32 v50, v180, v181
v_cvt_pk_bf16_f32 v51, v182, v183
v_pk_fma_f32 v[184:185], v[192:193], v[176:177], v[184:185] op_sel_hi:[0,1,1] neg_lo:[0,0,1] neg_hi:[0,0,1]
v_pk_fma_f32 v[186:187], v[192:193], v[178:179], v[186:187] op_sel_hi:[0,1,1] neg_lo:[0,0,1] neg_hi:[0,0,1]
v_pk_fma_f32 v[188:189], v[192:193], v[180:181], v[188:189] op_sel_hi:[0,1,1] neg_lo:[0,0,1] neg_hi:[0,0,1]
v_pk_fma_f32 v[190:191], v[192:193], v[182:183], v[190:191] op_sel_hi:[0,1,1] neg_lo:[0,0,1] neg_hi:[0,0,1]
v_cvt_pk_bf16_f32 v52, v184, v185
v_cvt_pk_bf16_f32 v53, v186, v187
v_cvt_pk_bf16_f32 v54, v188, v189
v_cvt_pk_bf16_f32 v55, v190, v191
v_pk_fma_f32 v[176:177], v[192:193], v[184:185], v[176:177] op_sel_hi:[0,1,1] neg_lo:[0,0,1] neg_hi:[0,0,1]
v_pk_fma_f32 v[178:179], v[192:193], v[186:187], v[178:179] op_sel_hi:[0,1,1] neg_lo:[0,0,1] neg_hi:[0,0,1]
v_pk_fma_f32 v[180:181], v[192:193], v[188:189], v[180:181] op_sel_hi:[0,1,1] neg_lo:[0,0,1] neg_hi:[0,0,1]
v_pk_fma_f32 v[182:183], v[192:193], v[190:191], v[182:183] op_sel_hi:[0,1,1] neg_lo:[0,0,1] neg_hi:[0,0,1]
v_cvt_pk_bf16_f32 v56, v176, v177
v_cvt_pk_bf16_f32 v57, v178, v179
v_cvt_pk_bf16_f32 v58, v180, v181
v_cvt_pk_bf16_f32 v59, v182, v183
v_pk_fma_f32 v[184:185], v[192:193], v[176:177], v[184:185] op_sel_hi:[0,1,1] neg_lo:[0,0,1] neg_hi:[0,0,1]
v_pk_fma_f32 v[186:187], v[192:193], v[178:179], v[186:187] op_sel_hi:[0,1,1] neg_lo:[0,0,1] neg_hi:[0,0,1]
v_pk_fma_f32 v[188:189], v[192:193], v[180:181], v[188:189] op_sel_hi:[0,1,1] neg_lo:[0,0,1] neg_hi:[0,0,1]
v_pk_fma_f32 v[190:191], v[192:193], v[182:183], v[190:191] op_sel_hi:[0,1,1] neg_lo:[0,0,1] neg_hi:[0,0,1]
v_cvt_pk_bf16_f32 v60, v184, v185
v_cvt_pk_bf16_f32 v61, v186, v187
v_cvt_pk_bf16_f32 v62, v188, v189
v_cvt_pk_bf16_f32 v63, v190, v191
v_pk_fma_f32 v[176:177], v[192:193], v[184:185], v[176:177] op_sel_hi:[0,1,1] neg_lo:[0,0,1] neg_hi:[0,0,1]
v_pk_fma_f32 v[178:179], v[192:193], v[186:187], v[178:179] op_sel_hi:[0,1,1] neg_lo:[0,0,1] neg_hi:[0,0,1]
v_pk_fma_f32 v[180:181], v[192:193], v[188:189], v[180:181] op_sel_hi:[0,1,1] neg_lo:[0,0,1] neg_hi:[0,0,1]
v_pk_fma_f32 v[182:183], v[192:193], v[190:191], v[182:183] op_sel_hi:[0,1,1] neg_lo:[0,0,1] neg_hi:[0,0,1]
v_cvt_pk_bf16_f32 v64, v176, v177
v_cvt_pk_bf16_f32 v65, v178, v179
v_cvt_pk_bf16_f32 v66, v180, v181
v_cvt_pk_bf16_f32 v67, v182, v183
v_pk_fma_f32 v[184:185], v[192:193], v[176:177], v[184:185] op_sel_hi:[0,1,1] neg_lo:[0,0,1] neg_hi:[0,0,1]
v_pk_fma_f32 v[186:187], v[192:193], v[178:179], v[186:187] op_sel_hi:[0,1,1] neg_lo:[0,0,1] neg_hi:[0,0,1]
v_pk_fma_f32 v[188:189], v[192:193], v[180:181], v[188:189] op_sel_hi:[0,1,1] neg_lo:[0,0,1] neg_hi:[0,0,1]
v_pk_fma_f32 v[190:191], v[192:193], v[182:183], v[190:191] op_sel_hi:[0,1,1] neg_lo:[0,0,1] neg_hi:[0,0,1]
v_cvt_pk_bf16_f32 v68, v184, v185
v_cvt_pk_bf16_f32 v69, v186, v187
v_cvt_pk_bf16_f32 v70, v188, v189
v_cvt_pk_bf16_f32 v71, v190, v191
v_pk_fma_f32 v[176:177], v[192:193], v[184:185], v[176:177] op_sel_hi:[0,1,1] neg_lo:[0,0,1] neg_hi:[0,0,1]
v_pk_fma_f32 v[178:179], v[192:193], v[186:187], v[178:179] op_sel_hi:[0,1,1] neg_lo:[0,0,1] neg_hi:[0,0,1]
v_pk_fma_f32 v[180:181], v[192:193], v[188:189], v[180:181] op_sel_hi:[0,1,1] neg_lo:[0,0,1] neg_hi:[0,0,1]
v_pk_fma_f32 v[182:183], v[192:193], v[190:191], v[182:183] op_sel_hi:[0,1,1] neg_lo:[0,0,1] neg_hi:[0,0,1]
v_cvt_pk_bf16_f32 v72, v176, v177
v_cvt_pk_bf16_f32 v73, v178, v179
v_cvt_pk_bf16_f32 v74, v180, v181
v_cvt_pk_bf16_f32 v75, v182, v183
v_pk_fma_f32 v[184:185], v[192:193], v[176:177], v[184:185] op_sel_hi:[0,1,1] neg_lo:[0,0,1] neg_hi:[0,0,1]
v_pk_fma_f32 v[186:187], v[192:193], v[178:179], v[186:187] op_sel_hi:[0,1,1] neg_lo:[0,0,1] neg_hi:[0,0,1]
v_pk_fma_f32 v[188:189], v[192:193], v[180:181], v[188:189] op_sel_hi:[0,1,1] neg_lo:[0,0,1] neg_hi:[0,0,1]
v_pk_fma_f32 v[190:191], v[192:193], v[182:183], v[190:191] op_sel_hi:[0,1,1] neg_lo:[0,0,1] neg_hi:[0,0,1]
v_cvt_pk_bf16_f32 v76, v184, v185
v_cvt_pk_bf16_f32 v77, v186, v187
v_cvt_pk_bf16_f32 v78, v188, v189
v_cvt_pk_bf16_f32 v79, v190, v191
v_pk_fma_f32 v[176:177], v[192:193], v[184:185], v[176:177] op_sel_hi:[0,1,1] neg_lo:[0,0,1] neg_hi:[0,0,1]
v_pk_fma_f32 v[178:179], v[192:193], v[186:187], v[178:179] op_sel_hi:[0,1,1] neg_lo:[0,0,1] neg_hi:[0,0,1]
v_pk_fma_f32 v[180:181], v[192:193], v[188:189], v[180:181] op_sel_hi:[0,1,1] neg_lo:[0,0,1] neg_hi:[0,0,1]
v_pk_fma_f32 v[182:183], v[192:193], v[190:191], v[182:183] op_sel_hi:[0,1,1] neg_lo:[0,0,1] neg_hi:[0,0,1]
v_cvt_pk_bf16_f32 v80, v176, v177
v_cvt_pk_bf16_f32 v81, v178, v179
v_cvt_pk_bf16_f32 v82, v180, v181
v_cvt_pk_bf16_f32 v83, v182, v183
v_pk_fma_f32 v[184:185], v[192:193], v[176:177], v[184:185] op_sel_hi:[0,1,1] neg_lo:[0,0,1] neg_hi:[0,0,1]
v_pk_fma_f32 v[186:187], v[192:193], v[178:179], v[186:187] op_sel_hi:[0,1,1] neg_lo:[0,0,1] neg_hi:[0,0,1]
v_pk_fma_f32 v[188:189], v[192:193], v[180:181], v[188:189] op_sel_hi:[0,1,1] neg_lo:[0,0,1] neg_hi:[0,0,1]
v_pk_fma_f32 v[190:191], v[192:193], v[182:183], v[190:191] op_sel_hi:[0,1,1] neg_lo:[0,0,1] neg_hi:[0,0,1]
v_cvt_pk_bf16_f32 v84, v184, v185
v_cvt_pk_bf16_f32 v85, v186, v187
v_cvt_pk_bf16_f32 v86, v188, v189
v_cvt_pk_bf16_f32 v87, v190, v191
v_pk_fma_f32 v[176:177], v[192:193], v[184:185], v[176:177] op_sel_hi:[0,1,1] neg_lo:[0,0,1] neg_hi:[0,0,1]
v_pk_fma_f32 v[178:179], v[192:193], v[186:187], v[178:179] op_sel_hi:[0,1,1] neg_lo:[0,0,1] neg_hi:[0,0,1]
v_pk_fma_f32 v[180:181], v[192:193], v[188:189], v[180:181] op_sel_hi:[0,1,1] neg_lo:[0,0,1] neg_hi:[0,0,1]
v_pk_fma_f32 v[182:183], v[192:193], v[190:191], v[182:183] op_sel_hi:[0,1,1] neg_lo:[0,0,1] neg_hi:[0,0,1]
v_cvt_pk_bf16_f32 v88, v176, v177
v_cvt_pk_bf16_f32 v89, v178, v179
v_cvt_pk_bf16_f32 v90, v180, v181
v_cvt_pk_bf16_f32 v91, v182, v183
v_pk_fma_f32 v[184:185], v[192:193], v[176:177], v[184:185] op_sel_hi:[0,1,1] neg_lo:[0,0,1] neg_hi:[0,0,1]
v_pk_fma_f32 v[186:187], v[192:193], v[178:179], v[186:187] op_sel_hi:[0,1,1] neg_lo:[0,0,1] neg_hi:[0,0,1]
v_pk_fma_f32 v[188:189], v[192:193], v[180:181], v[188:189] op_sel_hi:[0,1,1] neg_lo:[0,0,1] neg_hi:[0,0,1]
v_pk_fma_f32 v[190:191], v[192:193], v[182:183], v[190:191] op_sel_hi:[0,1,1] neg_lo:[0,0,1] neg_hi:[0,0,1]
v_cvt_pk_bf16_f32 v92, v184, v185
v_cvt_pk_bf16_f32 v93, v186, v187
v_cvt_pk_bf16_f32 v94, v188, v189
v_cvt_pk_bf16_f32 v95, v190, v191
s_mov_b32 s20, 323
v_mad_u32_u24 v179, v196, s20, v197
v_cvt_f32_u32 v179, v179
v_mul_f32 v198, s19, v179
v_rndne_f32 v198, v198
v_fmac_f32 v179, 0xc4200000, v198
v_mul_f32 v179, s19, v179
v_cos_f32 v179, v179
s_mov_b32 s20, 324
v_mad_u32_u24 v180, v196, s20, v197
v_cvt_f32_u32 v180, v180
v_mul_f32 v198, s19, v180
v_rndne_f32 v198, v198
v_fmac_f32 v180, 0xc4200000, v198
v_mul_f32 v180, s19, v180
v_cos_f32 v180, v180
s_nop 0
v_fma_f32 v181, v194, v180, -v179
v_fma_f32 v178, v194, v179, -v180
v_fma_f32 v182, v194, v181, -v180
v_fma_f32 v177, v194, v178, -v179
v_fma_f32 v183, v194, v182, -v181
v_fma_f32 v176, v194, v177, -v178
v_cvt_pk_bf16_f32 v96, v176, v177
v_cvt_pk_bf16_f32 v97, v178, v179
v_cvt_pk_bf16_f32 v98, v180, v181
v_cvt_pk_bf16_f32 v99, v182, v183
s_mov_b32 s20, 339
v_mad_u32_u24 v187, v196, s20, v197
v_cvt_f32_u32 v187, v187
v_mul_f32 v198, s19, v187
v_rndne_f32 v198, v198
v_fmac_f32 v187, 0xc4200000, v198
v_mul_f32 v187, s19, v187
v_cos_f32 v187, v187
s_mov_b32 s20, 340
v_mad_u32_u24 v188, v196, s20, v197
v_cvt_f32_u32 v188, v188
v_mul_f32 v198, s19, v188
v_rndne_f32 v198, v198
v_fmac_f32 v188, 0xc4200000, v198
v_mul_f32 v188, s19, v188
v_cos_f32 v188, v188
s_nop 0
v_fma_f32 v189, v194, v188, -v187
v_fma_f32 v186, v194, v187, -v188
v_fma_f32 v190, v194, v189, -v188
v_fma_f32 v185, v194, v186, -v187
v_fma_f32 v191, v194, v190, -v189
v_fma_f32 v184, v194, v185, -v186
v_cvt_pk_bf16_f32 v100, v184, v185
v_cvt_pk_bf16_f32 v101, v186, v187
v_cvt_pk_bf16_f32 v102, v188, v189
v_cvt_pk_bf16_f32 v103, v190, v191
v_pk_fma_f32 v[176:177], v[192:193], v[184:185], v[176:177] op_sel_hi:[0,1,1] neg_lo:[0,0,1] neg_hi:[0,0,1]
v_pk_fma_f32 v[178:179], v[192:193], v[186:187], v[178:179] op_sel_hi:[0,1,1] neg_lo:[0,0,1] neg_hi:[0,0,1]
v_pk_fma_f32 v[180:181], v[192:193], v[188:189], v[180:181] op_sel_hi:[0,1,1] neg_lo:[0,0,1] neg_hi:[0,0,1]
v_pk_fma_f32 v[182:183], v[192:193], v[190:191], v[182:183] op_sel_hi:[0,1,1] neg_lo:[0,0,1] neg_hi:[0,0,1]
v_cvt_pk_bf16_f32 v104, v176, v177
v_cvt_pk_bf16_f32 v105, v178, v179
v_cvt_pk_bf16_f32 v106, v180, v181
v_cvt_pk_bf16_f32 v107, v182, v183
v_pk_fma_f32 v[184:185], v[192:193], v[176:177], v[184:185] op_sel_hi:[0,1,1] neg_lo:[0,0,1] neg_hi:[0,0,1]
v_pk_fma_f32 v[186:187], v[192:193], v[178:179], v[186:187] op_sel_hi:[0,1,1] neg_lo:[0,0,1] neg_hi:[0,0,1]
v_pk_fma_f32 v[188:189], v[192:193], v[180:181], v[188:189] op_sel_hi:[0,1,1] neg_lo:[0,0,1] neg_hi:[0,0,1]
v_pk_fma_f32 v[190:191], v[192:193], v[182:183], v[190:191] op_sel_hi:[0,1,1] neg_lo:[0,0,1] neg_hi:[0,0,1]
v_cvt_pk_bf16_f32 v108, v184, v185
v_cvt_pk_bf16_f32 v109, v186, v187
v_cvt_pk_bf16_f32 v110, v188, v189
v_cvt_pk_bf16_f32 v111, v190, v191
v_pk_fma_f32 v[176:177], v[192:193], v[184:185], v[176:177] op_sel_hi:[0,1,1] neg_lo:[0,0,1] neg_hi:[0,0,1]
v_pk_fma_f32 v[178:179], v[192:193], v[186:187], v[178:179] op_sel_hi:[0,1,1] neg_lo:[0,0,1] neg_hi:[0,0,1]
v_pk_fma_f32 v[180:181], v[192:193], v[188:189], v[180:181] op_sel_hi:[0,1,1] neg_lo:[0,0,1] neg_hi:[0,0,1]
v_pk_fma_f32 v[182:183], v[192:193], v[190:191], v[182:183] op_sel_hi:[0,1,1] neg_lo:[0,0,1] neg_hi:[0,0,1]
v_cvt_pk_bf16_f32 v112, v176, v177
v_cvt_pk_bf16_f32 v113, v178, v179
v_cvt_pk_bf16_f32 v114, v180, v181
v_cvt_pk_bf16_f32 v115, v182, v183
v_pk_fma_f32 v[184:185], v[192:193], v[176:177], v[184:185] op_sel_hi:[0,1,1] neg_lo:[0,0,1] neg_hi:[0,0,1]
v_pk_fma_f32 v[186:187], v[192:193], v[178:179], v[186:187] op_sel_hi:[0,1,1] neg_lo:[0,0,1] neg_hi:[0,0,1]
v_pk_fma_f32 v[188:189], v[192:193], v[180:181], v[188:189] op_sel_hi:[0,1,1] neg_lo:[0,0,1] neg_hi:[0,0,1]
v_pk_fma_f32 v[190:191], v[192:193], v[182:183], v[190:191] op_sel_hi:[0,1,1] neg_lo:[0,0,1] neg_hi:[0,0,1]
v_cvt_pk_bf16_f32 v116, v184, v185
v_cvt_pk_bf16_f32 v117, v186, v187
v_cvt_pk_bf16_f32 v118, v188, v189
v_cvt_pk_bf16_f32 v119, v190, v191
v_pk_fma_f32 v[176:177], v[192:193], v[184:185], v[176:177] op_sel_hi:[0,1,1] neg_lo:[0,0,1] neg_hi:[0,0,1]
v_pk_fma_f32 v[178:179], v[192:193], v[186:187], v[178:179] op_sel_hi:[0,1,1] neg_lo:[0,0,1] neg_hi:[0,0,1]
v_pk_fma_f32 v[180:181], v[192:193], v[188:189], v[180:181] op_sel_hi:[0,1,1] neg_lo:[0,0,1] neg_hi:[0,0,1]
v_pk_fma_f32 v[182:183], v[192:193], v[190:191], v[182:183] op_sel_hi:[0,1,1] neg_lo:[0,0,1] neg_hi:[0,0,1]
v_cvt_pk_bf16_f32 v120, v176, v177
v_cvt_pk_bf16_f32 v121, v178, v179
v_cvt_pk_bf16_f32 v122, v180, v181
v_cvt_pk_bf16_f32 v123, v182, v183
v_pk_fma_f32 v[184:185], v[192:193], v[176:177], v[184:185] op_sel_hi:[0,1,1] neg_lo:[0,0,1] neg_hi:[0,0,1]
v_pk_fma_f32 v[186:187], v[192:193], v[178:179], v[186:187] op_sel_hi:[0,1,1] neg_lo:[0,0,1] neg_hi:[0,0,1]
v_pk_fma_f32 v[188:189], v[192:193], v[180:181], v[188:189] op_sel_hi:[0,1,1] neg_lo:[0,0,1] neg_hi:[0,0,1]
v_pk_fma_f32 v[190:191], v[192:193], v[182:183], v[190:191] op_sel_hi:[0,1,1] neg_lo:[0,0,1] neg_hi:[0,0,1]
v_cvt_pk_bf16_f32 v124, v184, v185
v_cvt_pk_bf16_f32 v125, v186, v187
v_cvt_pk_bf16_f32 v126, v188, v189
v_cvt_pk_bf16_f32 v127, v190, v191
v_pk_fma_f32 v[176:177], v[192:193], v[184:185], v[176:177] op_sel_hi:[0,1,1] neg_lo:[0,0,1] neg_hi:[0,0,1]
v_pk_fma_f32 v[178:179], v[192:193], v[186:187], v[178:179] op_sel_hi:[0,1,1] neg_lo:[0,0,1] neg_hi:[0,0,1]
v_pk_fma_f32 v[180:181], v[192:193], v[188:189], v[180:181] op_sel_hi:[0,1,1] neg_lo:[0,0,1] neg_hi:[0,0,1]
v_pk_fma_f32 v[182:183], v[192:193], v[190:191], v[182:183] op_sel_hi:[0,1,1] neg_lo:[0,0,1] neg_hi:[0,0,1]
v_cvt_pk_bf16_f32 v128, v176, v177
v_cvt_pk_bf16_f32 v129, v178, v179
v_cvt_pk_bf16_f32 v130, v180, v181
v_cvt_pk_bf16_f32 v131, v182, v183
v_pk_fma_f32 v[184:185], v[192:193], v[176:177], v[184:185] op_sel_hi:[0,1,1] neg_lo:[0,0,1] neg_hi:[0,0,1]
v_pk_fma_f32 v[186:187], v[192:193], v[178:179], v[186:187] op_sel_hi:[0,1,1] neg_lo:[0,0,1] neg_hi:[0,0,1]
v_pk_fma_f32 v[188:189], v[192:193], v[180:181], v[188:189] op_sel_hi:[0,1,1] neg_lo:[0,0,1] neg_hi:[0,0,1]
v_pk_fma_f32 v[190:191], v[192:193], v[182:183], v[190:191] op_sel_hi:[0,1,1] neg_lo:[0,0,1] neg_hi:[0,0,1]
v_cvt_pk_bf16_f32 v132, v184, v185
v_cvt_pk_bf16_f32 v133, v186, v187
v_cvt_pk_bf16_f32 v134, v188, v189
v_cvt_pk_bf16_f32 v135, v190, v191
v_pk_fma_f32 v[176:177], v[192:193], v[184:185], v[176:177] op_sel_hi:[0,1,1] neg_lo:[0,0,1] neg_hi:[0,0,1]
v_pk_fma_f32 v[178:179], v[192:193], v[186:187], v[178:179] op_sel_hi:[0,1,1] neg_lo:[0,0,1] neg_hi:[0,0,1]
v_pk_fma_f32 v[180:181], v[192:193], v[188:189], v[180:181] op_sel_hi:[0,1,1] neg_lo:[0,0,1] neg_hi:[0,0,1]
v_pk_fma_f32 v[182:183], v[192:193], v[190:191], v[182:183] op_sel_hi:[0,1,1] neg_lo:[0,0,1] neg_hi:[0,0,1]
v_cvt_pk_bf16_f32 v136, v176, v177
v_cvt_pk_bf16_f32 v137, v178, v179
v_cvt_pk_bf16_f32 v138, v180, v181
v_cvt_pk_bf16_f32 v139, v182, v183
v_pk_fma_f32 v[184:185], v[192:193], v[176:177], v[184:185] op_sel_hi:[0,1,1] neg_lo:[0,0,1] neg_hi:[0,0,1]
v_pk_fma_f32 v[186:187], v[192:193], v[178:179], v[186:187] op_sel_hi:[0,1,1] neg_lo:[0,0,1] neg_hi:[0,0,1]
v_pk_fma_f32 v[188:189], v[192:193], v[180:181], v[188:189] op_sel_hi:[0,1,1] neg_lo:[0,0,1] neg_hi:[0,0,1]
v_pk_fma_f32 v[190:191], v[192:193], v[182:183], v[190:191] op_sel_hi:[0,1,1] neg_lo:[0,0,1] neg_hi:[0,0,1]
v_cvt_pk_bf16_f32 v140, v184, v185
v_cvt_pk_bf16_f32 v141, v186, v187
v_cvt_pk_bf16_f32 v142, v188, v189
v_cvt_pk_bf16_f32 v143, v190, v191
v_pk_fma_f32 v[176:177], v[192:193], v[184:185], v[176:177] op_sel_hi:[0,1,1] neg_lo:[0,0,1] neg_hi:[0,0,1]
v_pk_fma_f32 v[178:179], v[192:193], v[186:187], v[178:179] op_sel_hi:[0,1,1] neg_lo:[0,0,1] neg_hi:[0,0,1]
v_pk_fma_f32 v[180:181], v[192:193], v[188:189], v[180:181] op_sel_hi:[0,1,1] neg_lo:[0,0,1] neg_hi:[0,0,1]
v_pk_fma_f32 v[182:183], v[192:193], v[190:191], v[182:183] op_sel_hi:[0,1,1] neg_lo:[0,0,1] neg_hi:[0,0,1]
v_cvt_pk_bf16_f32 v144, v176, v177
v_cvt_pk_bf16_f32 v145, v178, v179
v_cvt_pk_bf16_f32 v146, v180, v181
v_cvt_pk_bf16_f32 v147, v182, v183
v_pk_fma_f32 v[184:185], v[192:193], v[176:177], v[184:185] op_sel_hi:[0,1,1] neg_lo:[0,0,1] neg_hi:[0,0,1]
v_pk_fma_f32 v[186:187], v[192:193], v[178:179], v[186:187] op_sel_hi:[0,1,1] neg_lo:[0,0,1] neg_hi:[0,0,1]
v_pk_fma_f32 v[188:189], v[192:193], v[180:181], v[188:189] op_sel_hi:[0,1,1] neg_lo:[0,0,1] neg_hi:[0,0,1]
v_pk_fma_f32 v[190:191], v[192:193], v[182:183], v[190:191] op_sel_hi:[0,1,1] neg_lo:[0,0,1] neg_hi:[0,0,1]
v_cvt_pk_bf16_f32 v148, v184, v185
v_cvt_pk_bf16_f32 v149, v186, v187
v_cvt_pk_bf16_f32 v150, v188, v189
v_cvt_pk_bf16_f32 v151, v190, v191
v_pk_fma_f32 v[176:177], v[192:193], v[184:185], v[176:177] op_sel_hi:[0,1,1] neg_lo:[0,0,1] neg_hi:[0,0,1]
v_pk_fma_f32 v[178:179], v[192:193], v[186:187], v[178:179] op_sel_hi:[0,1,1] neg_lo:[0,0,1] neg_hi:[0,0,1]
v_pk_fma_f32 v[180:181], v[192:193], v[188:189], v[180:181] op_sel_hi:[0,1,1] neg_lo:[0,0,1] neg_hi:[0,0,1]
v_pk_fma_f32 v[182:183], v[192:193], v[190:191], v[182:183] op_sel_hi:[0,1,1] neg_lo:[0,0,1] neg_hi:[0,0,1]
v_cvt_pk_bf16_f32 v152, v176, v177
v_cvt_pk_bf16_f32 v153, v178, v179
v_cvt_pk_bf16_f32 v154, v180, v181
v_cvt_pk_bf16_f32 v155, v182, v183
v_pk_fma_f32 v[184:185], v[192:193], v[176:177], v[184:185] op_sel_hi:[0,1,1] neg_lo:[0,0,1] neg_hi:[0,0,1]
v_pk_fma_f32 v[186:187], v[192:193], v[178:179], v[186:187] op_sel_hi:[0,1,1] neg_lo:[0,0,1] neg_hi:[0,0,1]
v_pk_fma_f32 v[188:189], v[192:193], v[180:181], v[188:189] op_sel_hi:[0,1,1] neg_lo:[0,0,1] neg_hi:[0,0,1]
v_pk_fma_f32 v[190:191], v[192:193], v[182:183], v[190:191] op_sel_hi:[0,1,1] neg_lo:[0,0,1] neg_hi:[0,0,1]
v_cvt_pk_bf16_f32 v156, v184, v185
v_cvt_pk_bf16_f32 v157, v186, v187
v_cvt_pk_bf16_f32 v158, v188, v189
v_cvt_pk_bf16_f32 v159, v190, v191
v_pk_fma_f32 v[176:177], v[192:193], v[184:185], v[176:177] op_sel_hi:[0,1,1] neg_lo:[0,0,1] neg_hi:[0,0,1]
v_pk_fma_f32 v[178:179], v[192:193], v[186:187], v[178:179] op_sel_hi:[0,1,1] neg_lo:[0,0,1] neg_hi:[0,0,1]
v_pk_fma_f32 v[180:181], v[192:193], v[188:189], v[180:181] op_sel_hi:[0,1,1] neg_lo:[0,0,1] neg_hi:[0,0,1]
v_pk_fma_f32 v[182:183], v[192:193], v[190:191], v[182:183] op_sel_hi:[0,1,1] neg_lo:[0,0,1] neg_hi:[0,0,1]
v_cvt_pk_bf16_f32 v160, v176, v177
v_cvt_pk_bf16_f32 v161, v178, v179
v_cvt_pk_bf16_f32 v162, v180, v181
v_cvt_pk_bf16_f32 v163, v182, v183
v_pk_fma_f32 v[184:185], v[192:193], v[176:177], v[184:185] op_sel_hi:[0,1,1] neg_lo:[0,0,1] neg_hi:[0,0,1]
v_pk_fma_f32 v[186:187], v[192:193], v[178:179], v[186:187] op_sel_hi:[0,1,1] neg_lo:[0,0,1] neg_hi:[0,0,1]
v_pk_fma_f32 v[188:189], v[192:193], v[180:181], v[188:189] op_sel_hi:[0,1,1] neg_lo:[0,0,1] neg_hi:[0,0,1]
v_pk_fma_f32 v[190:191], v[192:193], v[182:183], v[190:191] op_sel_hi:[0,1,1] neg_lo:[0,0,1] neg_hi:[0,0,1]
v_cvt_pk_bf16_f32 v164, v184, v185
v_cvt_pk_bf16_f32 v165, v186, v187
v_cvt_pk_bf16_f32 v166, v188, v189
v_cvt_pk_bf16_f32 v167, v190, v191
v_pk_fma_f32 v[176:177], v[192:193], v[184:185], v[176:177] op_sel_hi:[0,1,1] neg_lo:[0,0,1] neg_hi:[0,0,1]
v_pk_fma_f32 v[178:179], v[192:193], v[186:187], v[178:179] op_sel_hi:[0,1,1] neg_lo:[0,0,1] neg_hi:[0,0,1]
v_pk_fma_f32 v[180:181], v[192:193], v[188:189], v[180:181] op_sel_hi:[0,1,1] neg_lo:[0,0,1] neg_hi:[0,0,1]
v_pk_fma_f32 v[182:183], v[192:193], v[190:191], v[182:183] op_sel_hi:[0,1,1] neg_lo:[0,0,1] neg_hi:[0,0,1]
v_cvt_pk_bf16_f32 v168, v176, v177
v_cvt_pk_bf16_f32 v169, v178, v179
v_cvt_pk_bf16_f32 v170, v180, v181
v_cvt_pk_bf16_f32 v171, v182, v183
v_pk_fma_f32 v[184:185], v[192:193], v[176:177], v[184:185] op_sel_hi:[0,1,1] neg_lo:[0,0,1] neg_hi:[0,0,1]
v_pk_fma_f32 v[186:187], v[192:193], v[178:179], v[186:187] op_sel_hi:[0,1,1] neg_lo:[0,0,1] neg_hi:[0,0,1]
v_pk_fma_f32 v[188:189], v[192:193], v[180:181], v[188:189] op_sel_hi:[0,1,1] neg_lo:[0,0,1] neg_hi:[0,0,1]
v_pk_fma_f32 v[190:191], v[192:193], v[182:183], v[190:191] op_sel_hi:[0,1,1] neg_lo:[0,0,1] neg_hi:[0,0,1]
v_cvt_pk_bf16_f32 v172, v184, v185
v_cvt_pk_bf16_f32 v173, v186, v187
v_cvt_pk_bf16_f32 v174, v188, v189
v_cvt_pk_bf16_f32 v175, v190, v191
p1q_72:
s_lshl_b32 s18, s30, 7
s_add_u32 s18, s18, 32768
s_cmp_lg_u32 s13, 0
s_cbranch_scc1 polld_74
v_lshrrev_b32 v12, 2, v0
v_min_u32 v12, 76, v12
s_mov_b32 s17, 0
poll_73:
buffer_load_dword v8, v12, s[4:7], s18 offen offset:0 sc1
s_add_u32 s17, s17, 1
s_cmp_gt_u32 s17, 262144
s_cbranch_scc1 L_fail
s_waitcnt vmcnt(0)
v_cmp_gt_u32 vcc, 1, v8
s_cbranch_vccz polld_74
s_sleep 2
s_branch poll_73
polld_74:
s_barrier
s_mul_i32 s18, s30, 40960
s_add_u32 s26, s18, 91226112
s_add_u32 s26, s26, s31
s_add_u32 s27, s18, 100663296
s_add_u32 s27, s27, s33
s_add_u32 m0, s31, 2048
s_add_u32 s20, s26, 0
buffer_load_dwordx4 v0, s[4:7], s20 offen sc1 lds
s_add_u32 m0, s31, 3072
s_add_u32 s20, s26, 1024
buffer_load_dwordx4 v0, s[4:7], s20 offen sc1 lds
s_add_u32 m0, s31, 4096
s_add_u32 s20, s26, 2048
buffer_load_dwordx4 v0, s[4:7], s20 offen sc1 lds
s_add_u32 m0, s31, 5120
s_add_u32 s20, s26, 3072
buffer_load_dwordx4 v0, s[4:7], s20 offen sc1 lds
s_add_u32 m0, s31, 6144
s_add_u32 s20, s26, 4096
buffer_load_dwordx4 v0, s[4:7], s20 offen sc1 lds
s_add_u32 m0, s31, 7168
s_add_u32 s20, s26, 5120
buffer_load_dwordx4 v0, s[4:7], s20 offen sc1 lds
s_add_u32 m0, s31, 8192
s_add_u32 s20, s26, 6144
buffer_load_dwordx4 v0, s[4:7], s20 offen sc1 lds
s_add_u32 m0, s31, 9216
s_add_u32 s20, s26, 7168
buffer_load_dwordx4 v0, s[4:7], s20 offen sc1 lds
s_add_u32 m0, s31, 10240
s_add_u32 s20, s26, 8192
buffer_load_dwordx4 v0, s[4:7], s20 offen sc1 lds
s_add_u32 m0, s31, 11264
s_add_u32 s20, s26, 9216
buffer_load_dwordx4 v0, s[4:7], s20 offen sc1 lds
s_waitcnt vmcnt(0)
s_barrier
v_add_u32 v2, s31, v0
ds_read_b128 v[216:219], v2 offset:2048
ds_read_b128 v[220:223], v2 offset:3072
ds_read_b128 v[224:227], v2 offset:4096
ds_read_b128 v[196:199], v0 offset:3072
ds_read_b128 v[228:231], v2 offset:5120
ds_read_b128 v[192:195], v0 offset:2048
v_mov_b64 v[208:209], 0
ds_read_b128 v[200:203], v0 offset:4096
ds_read_b128 v[204:207], v0 offset:5120
s_waitcnt lgkmcnt(7)
v_dot2c_f32_bf16 v208, s24, v216
v_dot2c_f32_bf16 v209, v216, v216
v_dot2c_f32_bf16 v208, s24, v217
v_dot2c_f32_bf16 v209, v217, v217
v_dot2c_f32_bf16 v208, s24, v218
v_dot2c_f32_bf16 v209, v218, v218
v_dot2c_f32_bf16 v208, s24, v219
s_waitcnt lgkmcnt(5)
v_dot2c_f32_bf16 v209, v219, v219
v_dot2c_f32_bf16 v208, s24, v220
v_dot2c_f32_bf16 v209, v220, v220
v_dot2c_f32_bf16 v208, s24, v221
v_dot2c_f32_bf16 v209, v221, v221
v_dot2c_f32_bf16 v208, s24, v222
v_dot2c_f32_bf16 v209, v222, v222
v_dot2c_f32_bf16 v208, s24, v223
v_dot2c_f32_bf16 v209, v223, v223
v_dot2c_f32_bf16 v208, s24, v224
v_dot2c_f32_bf16 v209, v224, v224
s_waitcnt lgkmcnt(3)
ds_read_b128 v[216:219], v2 offset:6144
ds_read_b128 v[220:223], v2 offset:7168
v_dot2c_f32_bf16 v208, s24, v225
v_dot2c_f32_bf16 v209, v225, v225
v_dot2c_f32_bf16 v208, s24, v226
v_dot2c_f32_bf16 v209, v226, v226
v_dot2c_f32_bf16 v208, s24, v227
v_dot2c_f32_bf16 v209, v227, v227
v_dot2c_f32_bf16 v208, s24, v228
v_dot2c_f32_bf16 v209, v228, v228
v_dot2c_f32_bf16 v208, s24, v229
v_dot2c_f32_bf16 v209, v229, v229
v_dot2c_f32_bf16 v208, s24, v230
v_dot2c_f32_bf16 v209, v230, v230
v_dot2c_f32_bf16 v208, s24, v231
v_dot2c_f32_bf16 v209, v231, v231
s_waitcnt lgkmcnt(1)
ds_read_b128 v[228:231], v2 offset:9216
ds_read_b128 v[224:227], v2 offset:8192
v_dot2c_f32_bf16 v208, s24, v216
v_dot2c_f32_bf16 v209, v216, v216
v_dot2c_f32_bf16 v208, s24, v217
s_waitcnt lgkmcnt(2)
v_dot2c_f32_bf16 v209, v217, v217
v_dot2c_f32_bf16 v208, s24, v218
v_dot2c_f32_bf16 v209, v218, v218
v_dot2c_f32_bf16 v208, s24, v219
v_dot2c_f32_bf16 v209, v219, v219
v_dot2c_f32_bf16 v208, s24, v220
v_dot2c_f32_bf16 v209, v220, v220
v_dot2c_f32_bf16 v208, s24, v221
v_dot2c_f32_bf16 v209, v221, v221
v_dot2c_f32_bf16 v208, s24, v222
v_dot2c_f32_bf16 v209, v222, v222
v_dot2c_f32_bf16 v208, s24, v223
v_dot2c_f32_bf16 v209, v223, v223
s_waitcnt lgkmcnt(0)
ds_read_b128 v[216:219], v2 offset:10240
ds_read_b128 v[220:223], v2 offset:11264
v_dot2c_f32_bf16 v208, s24, v224
v_dot2c_f32_bf16 v209, v224, v224
v_dot2c_f32_bf16 v208, s24, v225
v_dot2c_f32_bf16 v209, v225, v225
v_dot2c_f32_bf16 v208, s24, v226
v_dot2c_f32_bf16 v209, v226, v226
v_dot2c_f32_bf16 v208, s24, v227
v_dot2c_f32_bf16 v209, v227, v227
v_dot2c_f32_bf16 v208, s24, v228
v_dot2c_f32_bf16 v209, v228, v228
v_dot2c_f32_bf16 v208, s24, v229
v_dot2c_f32_bf16 v209, v229, v229
v_dot2c_f32_bf16 v208, s24, v230
v_dot2c_f32_bf16 v209, v230, v230
s_waitcnt lgkmcnt(1)
v_dot2c_f32_bf16 v208, s24, v231
v_dot2c_f32_bf16 v209, v231, v231
v_dot2c_f32_bf16 v208, s24, v216
s_waitcnt lgkmcnt(0)
v_dot2c_f32_bf16 v209, v216, v216
v_dot2c_f32_bf16 v208, s24, v217
v_dot2c_f32_bf16 v209, v217, v217
v_dot2c_f32_bf16 v208, s24, v218
v_dot2c_f32_bf16 v209, v218, v218
v_dot2c_f32_bf16 v208, s24, v219
v_dot2c_f32_bf16 v209, v219, v219
v_dot2c_f32_bf16 v208, s24, v220
v_dot2c_f32_bf16 v209, v220, v220
v_dot2c_f32_bf16 v208, s24, v221
v_dot2c_f32_bf16 v209, v221, v221
v_dot2c_f32_bf16 v208, s24, v222
v_dot2c_f32_bf16 v209, v222, v222
v_dot2c_f32_bf16 v208, s24, v223
v_dot2c_f32_bf16 v209, v223, v223
v_mfma_f32_32x32x16_bf16 v[176:191], v[192:195], v[16:19], 0
s_nop 1
v_permlane32_swap_b32 v208, v209
ds_read_b128 v[192:195], v0 offset:6144
v_mfma_f32_32x32x16_bf16 v[176:191], v[196:199], v[20:23], v[176:191]
v_and_b32 v2, 0x1ff, v0
v_add_f32 v208, v208, v209
v_mfma_f32_32x32x16_bf16 v[176:191], v[200:203], v[24:27], v[176:191]
v_lshl_add_u32 v209, s13, 2, v0
ds_read_b128 v[196:199], v0 offset:7168
ds_write_b32 v209, v208 offset:0
v_mfma_f32_32x32x16_bf16 v[176:191], v[204:207], v[28:31], v[176:191]
s_waitcnt lgkmcnt(2)
ds_read_b128 v[200:203], v0 offset:8192
ds_read_b128 v[204:207], v0 offset:9216
v_mfma_f32_32x32x16_bf16 v[176:191], v[192:195], v[32:35], v[176:191]
s_waitcnt lgkmcnt(3)
v_mfma_f32_32x32x16_bf16 v[176:191], v[196:199], v[36:39], v[176:191]
s_waitcnt lgkmcnt(2)
ds_read_b128 v[192:195], v0 offset:10240
s_waitcnt lgkmcnt(2)
s_waitcnt lgkmcnt(1)
v_mfma_f32_32x32x16_bf16 v[176:191], v[200:203], v[40:43], v[176:191]
ds_read_b128 v[196:199], v0 offset:11264
s_barrier
ds_read_b128 v[208:211], v2 offset:0
v_mfma_f32_32x32x16_bf16 v[176:191], v[204:207], v[44:47], v[176:191]
ds_read_b128 v[204:207], v0 offset:13312
ds_read_b128 v[200:203], v0 offset:12288
s_waitcnt lgkmcnt(4)
v_mfma_f32_32x32x16_bf16 v[176:191], v[192:195], v[48:51], v[176:191]
s_waitcnt lgkmcnt(3)
ds_read_b128 v[212:215], v2 offset:512
ds_read_b128 v[192:195], v0 offset:14336
v_mfma_f32_32x32x16_bf16 v[176:191], v[196:199], v[52:55], v[176:191]
s_waitcnt lgkmcnt(2)
v_mfma_f32_32x32x16_bf16 v[176:191], v[200:203], v[56:59], v[176:191]
ds_read_b128 v[196:199], v0 offset:15360
ds_read_b128 v[200:203], v0 offset:16384
v_add_f32 v208, v208, v209
v_add_f32 v210, v210, v211
s_waitcnt lgkmcnt(3)
v_mfma_f32_32x32x16_bf16 v[176:191], v[204:207], v[60:63], v[176:191]
s_waitcnt lgkmcnt(2)
ds_read_b128 v[204:207], v0 offset:17408
v_add_f32 v212, v212, v213
v_add_f32 v208, v208, v210
v_mfma_f32_32x32x16_bf16 v[176:191], v[192:195], v[64:67], v[176:191]
s_waitcnt lgkmcnt(2)
v_mfma_f32_32x32x16_bf16 v[176:191], v[196:199], v[68:71], v[176:191]
v_mul_f32 v208, 0x3acccccd, v208
s_waitcnt lgkmcnt(1)
ds_read_b128 v[192:195], v0 offset:18432
v_add_f32 v214, v214, v215
s_waitcnt lgkmcnt(1)
v_mfma_f32_32x32x16_bf16 v[176:191], v[200:203], v[72:75], v[176:191]
v_lshrrev_b32 v209, 2, v0
ds_read_b128 v[196:199], v0 offset:19456
v_mfma_f32_32x32x16_bf16 v[176:191], v[204:207], v[76:79], v[176:191]
ds_read_b128 v[200:203], v0 offset:20480
ds_read_b128 v[204:207], v0 offset:21504
v_add_f32 v212, v212, v214
v_mul_f32 v212, 0x3acccccd, v212
s_waitcnt lgkmcnt(3)
v_mfma_f32_32x32x16_bf16 v[176:191], v[192:195], v[80:83], v[176:191]
v_fma_f32 v212, -v208, v208, v212
s_waitcnt lgkmcnt(2)
v_max_f32 v212, 0, v212
v_add_f32 v212, 0x3727c5ac, v212
v_mfma_f32_32x32x16_bf16 v[176:191], v[196:199], v[84:87], v[176:191]
ds_read_b128 v[192:195], v0 offset:22528
s_waitcnt lgkmcnt(2)
v_bfe_u32 v210, v0, 5, 5
v_lshl_add_u32 v209, s13, 8, v209
v_mfma_f32_32x32x16_bf16 v[176:191], v[200:203], v[88:91], v[176:191]
ds_read_b128 v[196:199], v0 offset:23552
ds_read_b128 v[200:203], v0 offset:24576
v_rsq_f32 v212, v212
s_waitcnt lgkmcnt(3)
v_and_b32 v210, 16, v210
v_mfma_f32_32x32x16_bf16 v[176:191], v[204:207], v[92:95], v[176:191]
ds_read_b128 v[204:207], v0 offset:25600
s_waitcnt lgkmcnt(3)
v_mul_f32 v208, v212, v208
v_mfma_f32_32x32x16_bf16 v[176:191], v[192:195], v[96:99], v[176:191]
v_lshl_add_u32 v210, s13, 8, v210
v_permlane32_swap_b32 v212, v208
s_waitcnt lgkmcnt(2)
ds_read_b128 v[192:195], v0 offset:26624
v_mfma_f32_32x32x16_bf16 v[176:191], v[196:199], v[100:103], v[176:191]
ds_write_b32 v209, v212 offset:1024
s_waitcnt lgkmcnt(3)
s_waitcnt lgkmcnt(2)
v_mfma_f32_32x32x16_bf16 v[176:191], v[200:203], v[104:107], v[176:191]
ds_read_b128 v[240:243], v210 offset:1216
ds_read_b128 v[196:199], v0 offset:27648
v_mfma_f32_32x32x16_bf16 v[176:191], v[204:207], v[108:111], v[176:191]
ds_read_b128 v[200:203], v0 offset:28672
s_waitcnt lgkmcnt(4)
ds_read_b128 v[232:235], v210 offset:1152
v_mfma_f32_32x32x16_bf16 v[176:191], v[192:195], v[112:115], v[176:191]
ds_read_b128 v[204:207], v0 offset:29696
ds_read_b128 v[192:195], v0 offset:30720
s_waitcnt lgkmcnt(4)
v_mfma_f32_32x32x16_bf16 v[176:191], v[196:199], v[116:119], v[176:191]
ds_read_b128 v[228:231], v210 offset:1120
s_waitcnt lgkmcnt(4)
ds_read_b128 v[216:219], v210 offset:1024
ds_read_b128 v[196:199], v0 offset:31744
v_mfma_f32_32x32x16_bf16 v[176:191], v[200:203], v[120:123], v[176:191]
v_mul_f32 v241, v241, v7
s_waitcnt lgkmcnt(3)
ds_read_b128 v[200:203], v0 offset:32768
v_mfma_f32_32x32x16_bf16 v[176:191], v[204:207], v[124:127], v[176:191]
ds_read_b128 v[220:223], v210 offset:1056
v_mfma_f32_32x32x16_bf16 v[176:191], v[192:195], v[128:131], v[176:191]
ds_read_b128 v[204:207], v0 offset:33792
s_waitcnt lgkmcnt(3)
v_mfma_f32_32x32x16_bf16 v[176:191], v[196:199], v[132:135], v[176:191]
s_waitcnt lgkmcnt(2)
ds_read_b128 v[192:195], v0 offset:34816
ds_read_b128 v[224:227], v210 offset:1088
ds_read_b128 v[196:199], v0 offset:35840
ds_read_b128 v[244:247], v210 offset:1248
v_mfma_f32_32x32x16_bf16 v[176:191], v[200:203], v[136:139], v[176:191]
s_waitcnt lgkmcnt(4)
ds_read_b128 v[200:203], v0 offset:36864
v_mfma_f32_32x32x16_bf16 v[176:191], v[204:207], v[140:143], v[176:191]
v_mul_f32 v242, v242, v7
ds_read_b128 v[236:239], v210 offset:1184
s_waitcnt lgkmcnt(5)
v_mfma_f32_32x32x16_bf16 v[176:191], v[192:195], v[144:147], v[176:191]
ds_read_b128 v[204:207], v0 offset:37888
s_waitcnt lgkmcnt(3)
ds_read_b128 v[192:195], v0 offset:38912
v_mfma_f32_32x32x16_bf16 v[176:191], v[196:199], v[148:151], v[176:191]
ds_read_b128 v[196:199], v0 offset:39936
s_waitcnt lgkmcnt(4)
s_waitcnt lgkmcnt(3)
v_mul_f32 v240, v240, v7
v_mfma_f32_32x32x16_bf16 v[176:191], v[200:203], v[152:155], v[176:191]
v_mul_f32 v247, v247, v7
v_mul_f32 v245, v245, v7
v_mul_f32 v233, v233, v7
s_waitcnt lgkmcnt(2)
v_mfma_f32_32x32x16_bf16 v[176:191], v[204:207], v[156:159], v[176:191]
ds_read_b128 v[200:203], v0 offset:40960
s_waitcnt lgkmcnt(1)
ds_read_b128 v[204:207], v0 offset:41984
v_mul_f32 v232, v232, v7
v_mfma_f32_32x32x16_bf16 v[176:191], v[192:195], v[160:163], v[176:191]
v_mul_f32 v246, v246, v7
v_mul_f32 v244, v244, v7
v_mul_f32 v236, v236, v7
v_mfma_f32_32x32x16_bf16 v[176:191], v[196:199], v[164:167], v[176:191]
s_waitcnt lgkmcnt(0)
v_mul_f32 v239, v239, v7
v_mfma_f32_32x32x16_bf16 v[176:191], v[200:203], v[168:171], v[176:191]
v_mul_f32 v238, v238, v7
v_mfma_f32_32x32x16_bf16 v[176:191], v[204:207], v[172:175], v[176:191]
s_nop 0
v_mul_f32 v237, v237, v7
v_mul_f32 v235, v235, v7
v_mul_f32 v234, v234, v7
v_mul_f32 v243, v243, v7
s_nop 6
v_pk_fma_f32 v[184:185], v[184:185], v[224:225], v[240:241] neg_lo:[0,0,1] neg_hi:[0,0,1]
v_pk_fma_f32 v[182:183], v[182:183], v[222:223], v[238:239] neg_lo:[0,0,1] neg_hi:[0,0,1]
v_pk_fma_f32 v[180:181], v[180:181], v[220:221], v[236:237] neg_lo:[0,0,1] neg_hi:[0,0,1]
v_pk_fma_f32 v[188:189], v[188:189], v[228:229], v[244:245] neg_lo:[0,0,1] neg_hi:[0,0,1]
v_pk_fma_f32 v[176:177], v[176:177], v[216:217], v[232:233] neg_lo:[0,0,1] neg_hi:[0,0,1]
v_cvt_pk_bf16_f32 v194, v180, v181
v_pk_fma_f32 v[178:179], v[178:179], v[218:219], v[234:235] neg_lo:[0,0,1] neg_hi:[0,0,1]
v_cvt_pk_bf16_f32 v198, v188, v189
v_pk_fma_f32 v[190:191], v[190:191], v[230:231], v[246:247] neg_lo:[0,0,1] neg_hi:[0,0,1]
v_cvt_pk_bf16_f32 v199, v190, v191
v_cvt_pk_bf16_f32 v195, v182, v183
v_pk_fma_f32 v[186:187], v[186:187], v[226:227], v[242:243] neg_lo:[0,0,1] neg_hi:[0,0,1]
v_cvt_pk_bf16_f32 v193, v178, v179
v_cvt_pk_bf16_f32 v196, v184, v185
v_cvt_pk_bf16_f32 v197, v186, v187
v_cvt_pk_bf16_f32 v192, v176, v177
buffer_store_dwordx4 v[192:195], v6, s[4:7], s27 offen offset:0 sc1
buffer_store_dwordx4 v[196:199], v6, s[4:7], s27 offen offset:1024 sc1
s_add_u32 s30, s30, 3
s_cmp_lt_u32 s30, 60
s_cbranch_scc1 p1q_72
s_lshl_b32 s18, s51, 2
s_add_u32 s18, s18, 6144
s_cmp_eq_u32 s13, 0
s_cselect_b32 s22, s18, s6
s_mov_b32 s23, 1
s_waitcnt vmcnt(0)
s_barrier
v_mov_b32 v3, s23
s_mov_b64 exec, 1
buffer_store_dword v3, off, s[4:7], s22 sc1
s_mov_b64 exec, -1
s_mov_b32 s22, s6
aend_54:
s_add_u32 s16, s16, 1
s_cmp_lt_u32 s16, 2
s_cbranch_scc1 alay_40
s_endpgm
L_fail:
s_mov_b64 exec, 1
v_mov_b32 v1, 0xdead
buffer_store_dword v1, off, s[8:11], 0 offset:8 sc1
L_end:
s_endpgm
L_chain:
s_waitcnt vmcnt(0)
s_nop 4
s_bitcmp1_b32 0x55555555, s14
s_cbranch_scc0 grp_10001
s_bfm_b32 s24, s14, 0
s_and_b32 s24, s24, 0x55555555
s_bcnt1_i32_b32 s24, s24
v_and_b32 v64, 63, v0
v_and_b32 v65, 15, v64
v_lshrrev_b32 v66, 4, v64
v_lshlrev_b32 v0, 4, v64
v_and_b32 v67, 2, v64
v_mov_b32 v68, 0x4444
v_mov_b32 v69, 0xeeee
v_cmp_eq_u32 vcc, 0, v67
s_nop 1
v_cndmask_b32 v1, v69, v68, vcc
s_mul_i32 s26, s13, 24576
s_add_u32 s26, s26, 65536
v_add_u32 v2, s26, v0
v_lshrrev_b32 v67, 2, v65
v_xor_b32 v68, v66, v67
v_lshlrev_b32 v68, 3, v68
v_lshl_add_u32 v68, v65, 5, v68
s_lshl_b32 s26, s13, 10
s_add_u32 s26, s26, 10240
v_add_u32 v3, s26, v68
v_lshl_add_u32 v68, v66, 2, v67
v_and_b32 v69, 3, v65
v_xor_b32 v69, v69, v66
v_lshlrev_b32 v69, 3, v69
v_lshl_add_u32 v68, v68, 5, v69
v_add_u32 v4, 10240, v68
v_and_b32 v69, 1, v65
v_lshl_add_u32 v68, v67, 1, v69
v_lshlrev_b32 v68, 4, v68
v_lshl_add_u32 v68, v66, 7, v68
v_add_u32 v5, 8192, v68
v_bfe_u32 v69, v65, 1, 1
v_mul_u32_u24 v69, 640, v69
v_xor_b32 v6, v69, v5
s_mov_b32 s42, 0x33333333
s_mov_b32 s43, 0x33333333
s_mov_b32 s44, 0x3f803f80
s_mov_b32 s45, 0x3f803f80
s_mov_b32 s46, 0x3f803f80
s_mov_b32 s47, 0
s_mov_b32 s37, 729808896
s_mov_b32 s38, 671088640
v_lshlrev_b32 v68, 3, v65
v_lshl_add_u32 v7, v66, 12, v68
s_lshl_b32 s26, s13, 14
s_lshl_b32 s27, s14, 7
s_add_u32 s26, s26, s27
s_add_u32 s90, s26, 65536
s_lshl_b32 s26, s13, 5
s_add_u32 s93, s26, s14
s_lshl_b32 s26, s93, 12
s_add_u32 s91, s26, 65536
s_lshr_b32 s26, s93, 2
s_lshl_b32 s26, s26, 9
s_and_b32 s27, s93, 3
s_lshl_b32 s27, s27, 6
s_add_u32 s26, s26, s27
s_add_u32 s92, s26, 393216
s_lshl_b32 s26, s14, 7
s_add_u32 s22, s26, 0
s_lshl_b32 s26, s24, 2
s_add_u32 s26, s26, 4096
s_cmp_lt_u32 s24, 10
s_cselect_b32 s23, s26, 268435456
s_cselect_b32 s24, s24, 0
s_cselect_b32 s25, 12582912, s23
s_lshl_b32 s24, s24, 10
s_and_b32 s26, s14, 0
s_lshl_b32 s26, s26, 12
s_add_u32 s94, s26, 425984
s_lshl_b32 s26, s14, 7
s_add_u32 s95, s26, 425984
s_mov_b32 s35, 0x3e0293ee
s_lshl_b32 s26, s14, 2
s_add_u32 s26, s26, s13
s_mul_i32 s27, s26, 18432
s_add_u32 s89, s27, 1048576
s_add_u32 s48, s4, s90
s_addc_u32 s49, s5, 0
s_add_u32 s50, s90, 65536
s_add_u32 s50, s4, s50
s_addc_u32 s51, s5, 0
s_add_u32 s52, s90, 131072
s_add_u32 s52, s4, s52
s_addc_u32 s53, s5, 0
s_add_u32 s54, s90, 196608
s_add_u32 s54, s4, s54
s_addc_u32 s55, s5, 0
s_add_u32 s56, s90, 262144
s_add_u32 s56, s4, s56
s_addc_u32 s57, s5, 0
s_add_u32 s76, s89, 4096
s_add_u32 s76, s4, s76
s_addc_u32 s77, s5, 0
s_add_u32 s78, s89, 12288
s_add_u32 s78, s4, s78
s_addc_u32 s79, s5, 0
s_add_u32 s80, s89, 20480
s_add_u32 s80, s4, s80
s_addc_u32 s81, s5, 0
s_add_u32 s60, s4, s94
s_addc_u32 s61, s5, 0
s_add_u32 s62, s4, s95
s_addc_u32 s63, s5, 0
s_add_u32 s64, s4, s91
s_addc_u32 s65, s5, 0
s_add_u32 s66, s4, s92
s_addc_u32 s67, s5, 0
v_mov_b32 v72, 0
v_mov_b32 v73, 0
s_mov_b32 s26, s90
buffer_store_dwordx2 v[72:73], v7, s[4:7], s26 offen
s_add_u32 s26, s26, 65536
buffer_store_dwordx2 v[72:73], v7, s[4:7], s26 offen
s_add_u32 s26, s26, 65536
buffer_store_dwordx2 v[72:73], v7, s[4:7], s26 offen
s_add_u32 s26, s26, 65536
buffer_store_dwordx2 v[72:73], v7, s[4:7], s26 offen
s_add_u32 s26, s26, 65536
buffer_store_dwordx2 v[72:73], v7, s[4:7], s26 offen
s_add_u32 s26, s26, 65536
buffer_store_dword v72, off, s[4:7], s95 offset:0
s_load_dwordx2 s[96:97], s[0:1], 32
s_mov_b32 s98, 10240
s_mov_b32 s99, 0x20000
s_cmp_ge_u32 s93, 80
s_cbranch_scc1 nm0_10002
s_and_b32 s26, s93, 3
s_mul_i32 s26, s26, 2560
s_lshr_b32 s27, s93, 2
s_lshl_b32 s27, s27, 6
s_add_u32 s26, s26, s27
v_bfe_u32 v68, v65, 1, 2
v_lshlrev_b32 v68, 4, v68
v_and_b32 v69, 1, v65
v_lshl_add_u32 v68, v69, 2, v68
v_and_b32 v69, 1, v66
v_mul_u32_u24 v69, 1280, v69
v_add_u32 v68, v68, v69
s_waitcnt lgkmcnt(0)
buffer_load_dword v74, v68, s[96:99], s26 offen
buffer_load_dword v75, v68, s[96:99], s26 offen offset:8
v_and_b32 v68, 32, v0
v_bfe_u32 v69, v0, 6, 1
v_lshl_add_u32 v68, v69, 8, v68
v_bfe_u32 v69, v0, 8, 1
v_lshl_add_u32 v68, v69, 4, v68
v_bfe_u32 v69, v0, 4, 1
v_lshl_add_u32 v68, v69, 3, v68
s_add_u32 s27, s92, 16384
buffer_store_dwordx2 v[72:73], v68, s[4:7], s92 offen
s_waitcnt vmcnt(1)
buffer_store_dwordx2 v[74:75], v68, s[4:7], s27 offen
nm0_10002:
s_waitcnt vmcnt(0) lgkmcnt(0)
v_lshrrev_b32 v67, 3, v64
v_and_b32 v68, 7, v64
v_lshlrev_b32 v68, 4, v68
v_lshl_add_u32 v32, v67, 13, v68
v_mul_u32_u24 v67, 1280, v67
v_add_u32 v36, v67, v68
v_lshrrev_b32 v67, 1, v66
v_lshlrev_b32 v67, 4, v67
v_and_b32 v68, 1, v66
v_lshl_add_u32 v67, v68, 1, v67
v_lshrrev_b32 v68, 3, v65
v_lshl_add_u32 v67, v68, 3, v67
v_bfe_u32 v68, v65, 2, 1
v_add_u32 v67, v67, v68
v_and_b32 v69, 3, v65
v_lshlrev_b32 v40, 4, v69
v_lshl_add_u32 v40, v67, 7, v40
v_lshl_add_u32 v67, v66, 2, v68
v_lshlrev_b32 v42, 4, v69
v_lshl_add_u32 v42, v67, 7, v42
v_lshrrev_b32 v68, 3, v65
v_lshl_add_u32 v42, v68, 3, v42
s_lshl_b32 s29, s13, 12
s_and_b32 s26, s13, 1
s_lshl_b32 s26, s26, 6
s_add_u32 s26, s26, s29
v_add_u32 v40, s26, v40
v_add_u32 v42, s26, v42
v_xor_b32 v41, 4096, v40
v_xor_b32 v43, 4096, v42
v_add_u32 v33, 64512, v32
v_add_u32 v37, 9216, v36
v_add_u32 v34, 129024, v32
v_add_u32 v38, 18432, v36
v_add_u32 v35, 193536, v32
v_add_u32 v39, 27648, v36
s_lshr_b32 s28, s13, 1
s_lshl_b32 s28, s28, 7
s_lshl_b32 s27, s14, 8
s_add_u32 s27, s27, s28
s_xor_b32 s26, s13, 0
s_lshl_b32 s82, s26, 19
s_add_u32 s82, s82, s27
s_lshl_b32 s85, s14, 2
s_add_u32 s85, s85, s26
s_mul_i32 s85, s85, 40960
s_add_u32 s85, s85, s28
s_xor_b32 s26, s13, 2
s_lshl_b32 s83, s26, 19
s_add_u32 s83, s83, s27
s_lshl_b32 s86, s14, 2
s_add_u32 s86, s86, s26
s_mul_i32 s86, s86, 40960
s_add_u32 s86, s86, s28
s_and_b32 s26, s13, 1
s_add_u32 s26, s26, 8
s_lshl_b32 s84, s26, 19
s_add_u32 s84, s84, s27
s_load_dwordx2 s[68:69], s[0:1], 40
s_load_dwordx2 s[70:71], s[0:1], 48
s_load_dwordx2 s[72:73], s[0:1], 56
s_load_dwordx2 s[74:75], s[0:1], 64
s_mov_b32 s98, 5242880
s_waitcnt lgkmcnt(0)
s_mov_b64 s[96:97], s[70:71]
s_add_u32 m0, s29, 0
s_add_u32 s26, s82, 0
buffer_load_dwordx4 v32, s[96:99], s26 offen offset:0 lds
buffer_load_dwordx4 v33, s[96:99], s26 offen offset:1024 lds
buffer_load_dwordx4 v34, s[96:99], s26 offen offset:2048 lds
buffer_load_dwordx4 v35, s[96:99], s26 offen offset:3072 lds
s_add_u32 m0, s29, 16384
s_add_u32 s26, s82, 262144
buffer_load_dwordx4 v32, s[96:99], s26 offen offset:0 lds
buffer_load_dwordx4 v33, s[96:99], s26 offen offset:1024 lds
buffer_load_dwordx4 v34, s[96:99], s26 offen offset:2048 lds
buffer_load_dwordx4 v35, s[96:99], s26 offen offset:3072 lds
s_add_u32 m0, s29, 32768
s_add_u32 s26, s82, 2097152
buffer_load_dwordx4 v32, s[96:99], s26 offen offset:0 lds
buffer_load_dwordx4 v33, s[96:99], s26 offen offset:1024 lds
buffer_load_dwordx4 v34, s[96:99], s26 offen offset:2048 lds
buffer_load_dwordx4 v35, s[96:99], s26 offen offset:3072 lds
s_waitcnt vmcnt(8)
s_barrier
s_add_u32 m0, s29, 49152
s_add_u32 s26, s82, 2359296
buffer_load_dwordx4 v32, s[96:99], s26 offen offset:0 lds
buffer_load_dwordx4 v33, s[96:99], s26 offen offset:1024 lds
buffer_load_dwordx4 v34, s[96:99], s26 offen offset:2048 lds
buffer_load_dwordx4 v35, s[96:99], s26 offen offset:3072 lds
ds_read_b64_tr_b16 v[72:73], v40 offset:0
ds_read_b64_tr_b16 v[74:75], v40 offset:512
ds_read_b64_tr_b16 v[76:77], v40 offset:8
ds_read_b64_tr_b16 v[78:79], v40 offset:520
ds_read_b64_tr_b16 a[160:161], v41 offset:0
ds_read_b64_tr_b16 a[162:163], v41 offset:512
ds_read_b64_tr_b16 v[84:85], v41 offset:8
ds_read_b64_tr_b16 v[86:87], v41 offset:520
s_waitcnt lgkmcnt(6)
global_store_dwordx4 v0, v[72:75], s[76:77] offset:0
s_waitcnt lgkmcnt(4)
global_store_dwordx4 v0, v[76:79], s[76:77] offset:2048
s_waitcnt lgkmcnt(0)
ds_write_b128 v2, v[84:87] offset:6144
s_waitcnt vmcnt(10)
s_barrier
s_add_u32 m0, s29, 0
s_add_u32 s26, s83, 0
buffer_load_dwordx4 v32, s[96:99], s26 offen offset:0 lds
buffer_load_dwordx4 v33, s[96:99], s26 offen offset:1024 lds
buffer_load_dwordx4 v34, s[96:99], s26 offen offset:2048 lds
buffer_load_dwordx4 v35, s[96:99], s26 offen offset:3072 lds
ds_read_b64_tr_b16 v[72:73], v40 offset:16384
ds_read_b64_tr_b16 v[74:75], v40 offset:16896
ds_read_b64_tr_b16 v[76:77], v40 offset:16392
ds_read_b64_tr_b16 v[78:79], v40 offset:16904
ds_read_b64_tr_b16 a[164:165], v41 offset:16384
ds_read_b64_tr_b16 a[166:167], v41 offset:16896
ds_read_b64_tr_b16 v[84:85], v41 offset:16392
ds_read_b64_tr_b16 v[86:87], v41 offset:16904
s_waitcnt lgkmcnt(6)
global_store_dwordx4 v0, v[72:75], s[76:77] offset:1024
s_waitcnt lgkmcnt(4)
global_store_dwordx4 v0, v[76:79], s[76:77] offset:3072
s_waitcnt lgkmcnt(0)
ds_write_b128 v2, v[84:87] offset:7168
s_waitcnt vmcnt(12)
s_barrier
s_add_u32 m0, s29, 16384
s_add_u32 s26, s83, 262144
buffer_load_dwordx4 v32, s[96:99], s26 offen offset:0 lds
buffer_load_dwordx4 v33, s[96:99], s26 offen offset:1024 lds
buffer_load_dwordx4 v34, s[96:99], s26 offen offset:2048 lds
buffer_load_dwordx4 v35, s[96:99], s26 offen offset:3072 lds
ds_read_b64_tr_b16 a[32:33], v40 offset:32768
ds_read_b64_tr_b16 a[34:35], v40 offset:33280
ds_read_b64_tr_b16 a[40:41], v40 offset:32776
ds_read_b64_tr_b16 a[42:43], v40 offset:33288
ds_read_b64_tr_b16 a[168:169], v41 offset:32768
ds_read_b64_tr_b16 a[170:171], v41 offset:33280
ds_read_b64_tr_b16 a[176:177], v41 offset:32776
ds_read_b64_tr_b16 a[178:179], v41 offset:33288
s_waitcnt vmcnt(12) lgkmcnt(0)
s_barrier
s_add_u32 m0, s29, 32768
s_add_u32 s26, s83, 2097152
buffer_load_dwordx4 v32, s[96:99], s26 offen offset:0 lds
buffer_load_dwordx4 v33, s[96:99], s26 offen offset:1024 lds
buffer_load_dwordx4 v34, s[96:99], s26 offen offset:2048 lds
buffer_load_dwordx4 v35, s[96:99], s26 offen offset:3072 lds
ds_read_b64_tr_b16 a[36:37], v40 offset:49152
ds_read_b64_tr_b16 a[38:39], v40 offset:49664
ds_read_b64_tr_b16 a[44:45], v40 offset:49160
ds_read_b64_tr_b16 a[46:47], v40 offset:49672
ds_read_b64_tr_b16 a[172:173], v41 offset:49152
ds_read_b64_tr_b16 a[174:175], v41 offset:49664
ds_read_b64_tr_b16 a[180:181], v41 offset:49160
ds_read_b64_tr_b16 a[182:183], v41 offset:49672
s_waitcnt vmcnt(10) lgkmcnt(0)
s_barrier
s_add_u32 m0, s29, 49152
s_add_u32 s26, s83, 2359296
buffer_load_dwordx4 v32, s[96:99], s26 offen offset:0 lds
buffer_load_dwordx4 v33, s[96:99], s26 offen offset:1024 lds
buffer_load_dwordx4 v34, s[96:99], s26 offen offset:2048 lds
buffer_load_dwordx4 v35, s[96:99], s26 offen offset:3072 lds
ds_read_b64_tr_b16 v[72:73], v40 offset:0
ds_read_b64_tr_b16 v[74:75], v40 offset:512
ds_read_b64_tr_b16 a[184:185], v40 offset:8
ds_read_b64_tr_b16 a[186:187], v40 offset:520
ds_read_b64_tr_b16 a[192:193], v41 offset:0
ds_read_b64_tr_b16 a[194:195], v41 offset:512
ds_read_b64_tr_b16 a[200:201], v41 offset:8
ds_read_b64_tr_b16 a[202:203], v41 offset:520
s_waitcnt lgkmcnt(6)
ds_write_b128 v2, v[72:75] offset:8192
s_waitcnt vmcnt(8) lgkmcnt(1)
s_barrier
s_add_u32 m0, s29, 0
s_add_u32 s26, s84, 0
buffer_load_dwordx4 v32, s[96:99], s26 offen offset:0 lds
buffer_load_dwordx4 v33, s[96:99], s26 offen offset:1024 lds
buffer_load_dwordx4 v34, s[96:99], s26 offen offset:2048 lds
buffer_load_dwordx4 v35, s[96:99], s26 offen offset:3072 lds
ds_read_b64_tr_b16 v[72:73], v40 offset:16384
ds_read_b64_tr_b16 v[74:75], v40 offset:16896
ds_read_b64_tr_b16 a[188:189], v40 offset:16392
ds_read_b64_tr_b16 a[190:191], v40 offset:16904
ds_read_b64_tr_b16 a[196:197], v41 offset:16384
ds_read_b64_tr_b16 a[198:199], v41 offset:16896
ds_read_b64_tr_b16 a[204:205], v41 offset:16392
ds_read_b64_tr_b16 a[206:207], v41 offset:16904
s_waitcnt lgkmcnt(6)
ds_write_b128 v2, v[72:75] offset:9216
s_waitcnt vmcnt(8) lgkmcnt(1)
s_barrier
s_add_u32 m0, s29, 16384
s_add_u32 s26, s84, 262144
buffer_load_dwordx4 v32, s[96:99], s26 offen offset:0 lds
buffer_load_dwordx4 v33, s[96:99], s26 offen offset:1024 lds
buffer_load_dwordx4 v34, s[96:99], s26 offen offset:2048 lds
buffer_load_dwordx4 v35, s[96:99], s26 offen offset:3072 lds
ds_read_b64_tr_b16 v[72:73], v40 offset:32768
ds_read_b64_tr_b16 v[74:75], v40 offset:33280
ds_read_b64_tr_b16 v[76:77], v40 offset:32776
ds_read_b64_tr_b16 v[78:79], v40 offset:33288
ds_read_b64_tr_b16 v[80:81], v41 offset:32768
ds_read_b64_tr_b16 v[82:83], v41 offset:33280
ds_read_b64_tr_b16 a[208:209], v41 offset:32776
ds_read_b64_tr_b16 a[210:211], v41 offset:33288
s_waitcnt lgkmcnt(6)
global_store_dwordx4 v0, v[72:75], s[78:79] offset:-2048
s_waitcnt lgkmcnt(4)
ds_write_b128 v2, v[76:79] offset:10240
s_waitcnt lgkmcnt(3)
ds_write_b128 v2, v[80:83] offset:12288
s_waitcnt vmcnt(9) lgkmcnt(2)
s_barrier
s_mov_b64 s[96:97], s[72:73]
s_add_u32 m0, s29, 32768
s_add_u32 s26, s82, 0
buffer_load_dwordx4 v32, s[96:99], s26 offen offset:0 lds
buffer_load_dwordx4 v33, s[96:99], s26 offen offset:1024 lds
buffer_load_dwordx4 v34, s[96:99], s26 offen offset:2048 lds
buffer_load_dwordx4 v35, s[96:99], s26 offen offset:3072 lds
ds_read_b64_tr_b16 v[72:73], v40 offset:49152
ds_read_b64_tr_b16 v[74:75], v40 offset:49664
ds_read_b64_tr_b16 v[76:77], v40 offset:49160
ds_read_b64_tr_b16 v[78:79], v40 offset:49672
ds_read_b64_tr_b16 v[80:81], v41 offset:49152
ds_read_b64_tr_b16 v[82:83], v41 offset:49664
ds_read_b64_tr_b16 a[212:213], v41 offset:49160
ds_read_b64_tr_b16 a[214:215], v41 offset:49672
s_waitcnt lgkmcnt(6)
global_store_dwordx4 v0, v[72:75], s[78:79] offset:-1024
s_waitcnt lgkmcnt(4)
ds_write_b128 v2, v[76:79] offset:11264
s_waitcnt lgkmcnt(3)
ds_write_b128 v2, v[80:83] offset:13312
s_waitcnt vmcnt(10) lgkmcnt(2)
s_barrier
s_add_u32 m0, s29, 49152
s_add_u32 s26, s82, 262144
buffer_load_dwordx4 v32, s[96:99], s26 offen offset:0 lds
buffer_load_dwordx4 v33, s[96:99], s26 offen offset:1024 lds
buffer_load_dwordx4 v34, s[96:99], s26 offen offset:2048 lds
buffer_load_dwordx4 v35, s[96:99], s26 offen offset:3072 lds
ds_read_b64_tr_b16 v[72:73], v40 offset:0
ds_read_b64_tr_b16 v[74:75], v40 offset:512
ds_read_b64_tr_b16 a[216:217], v40 offset:8
ds_read_b64_tr_b16 a[218:219], v40 offset:520
ds_read_b64_tr_b16 a[224:225], v41 offset:0
ds_read_b64_tr_b16 a[226:227], v41 offset:512
ds_read_b64_tr_b16 v[84:85], v41 offset:8
ds_read_b64_tr_b16 v[86:87], v41 offset:520
s_waitcnt lgkmcnt(6)
ds_write_b128 v2, v[72:75] offset:14336
s_waitcnt lgkmcnt(1)
ds_write_b128 v2, v[84:87] offset:16384
s_waitcnt vmcnt(10)
s_barrier
s_add_u32 m0, s29, 0
s_add_u32 s26, s82, 2097152
buffer_load_dwordx4 v32, s[96:99], s26 offen offset:0 lds
buffer_load_dwordx4 v33, s[96:99], s26 offen offset:1024 lds
buffer_load_dwordx4 v34, s[96:99], s26 offen offset:2048 lds
buffer_load_dwordx4 v35, s[96:99], s26 offen offset:3072 lds
ds_read_b64_tr_b16 v[72:73], v40 offset:16384
ds_read_b64_tr_b16 v[74:75], v40 offset:16896
ds_read_b64_tr_b16 a[220:221], v40 offset:16392
ds_read_b64_tr_b16 a[222:223], v40 offset:16904
ds_read_b64_tr_b16 a[228:229], v41 offset:16384
ds_read_b64_tr_b16 a[230:231], v41 offset:16896
ds_read_b64_tr_b16 v[84:85], v41 offset:16392
ds_read_b64_tr_b16 v[86:87], v41 offset:16904
s_waitcnt lgkmcnt(6)
ds_write_b128 v2, v[72:75] offset:15360
s_waitcnt lgkmcnt(1)
ds_write_b128 v2, v[84:87] offset:17408
s_waitcnt vmcnt(9)
s_barrier
s_add_u32 m0, s29, 16384
s_add_u32 s26, s82, 2359296
buffer_load_dwordx4 v32, s[96:99], s26 offen offset:0 lds
buffer_load_dwordx4 v33, s[96:99], s26 offen offset:1024 lds
buffer_load_dwordx4 v34, s[96:99], s26 offen offset:2048 lds
buffer_load_dwordx4 v35, s[96:99], s26 offen offset:3072 lds
ds_read_b64_tr_b16 a[0:1], v40 offset:32768
ds_read_b64_tr_b16 a[2:3], v40 offset:33280
ds_read_b64_tr_b16 a[8:9], v40 offset:32776
ds_read_b64_tr_b16 a[10:11], v40 offset:33288
ds_read_b64_tr_b16 a[248:249], v41 offset:32768
ds_read_b64_tr_b16 a[250:251], v41 offset:33280
ds_read_b64_tr_b16 v[88:89], v41 offset:32776
ds_read_b64_tr_b16 v[90:91], v41 offset:33288
s_waitcnt vmcnt(8) lgkmcnt(0)
s_barrier
s_add_u32 m0, s29, 32768
s_add_u32 s26, s83, 0
buffer_load_dwordx4 v32, s[96:99], s26 offen offset:0 lds
buffer_load_dwordx4 v33, s[96:99], s26 offen offset:1024 lds
buffer_load_dwordx4 v34, s[96:99], s26 offen offset:2048 lds
buffer_load_dwordx4 v35, s[96:99], s26 offen offset:3072 lds
ds_read_b64_tr_b16 a[4:5], v40 offset:49152
ds_read_b64_tr_b16 a[6:7], v40 offset:49664
ds_read_b64_tr_b16 a[12:13], v40 offset:49160
ds_read_b64_tr_b16 a[14:15], v40 offset:49672
ds_read_b64_tr_b16 a[252:253], v41 offset:49152
ds_read_b64_tr_b16 a[254:255], v41 offset:49664
ds_read_b64_tr_b16 v[92:93], v41 offset:49160
ds_read_b64_tr_b16 v[94:95], v41 offset:49672
s_waitcnt vmcnt(8) lgkmcnt(0)
s_barrier
s_add_u32 m0, s29, 49152
s_add_u32 s26, s83, 262144
buffer_load_dwordx4 v32, s[96:99], s26 offen offset:0 lds
buffer_load_dwordx4 v33, s[96:99], s26 offen offset:1024 lds
buffer_load_dwordx4 v34, s[96:99], s26 offen offset:2048 lds
buffer_load_dwordx4 v35, s[96:99], s26 offen offset:3072 lds
ds_read_b64_tr_b16 a[48:49], v40 offset:0
ds_read_b64_tr_b16 a[50:51], v40 offset:512
ds_read_b64_tr_b16 v[76:77], v40 offset:8
ds_read_b64_tr_b16 v[78:79], v40 offset:520
ds_read_b64_tr_b16 v[80:81], v41 offset:0
ds_read_b64_tr_b16 v[82:83], v41 offset:512
ds_read_b64_tr_b16 v[96:97], v41 offset:8
ds_read_b64_tr_b16 v[98:99], v41 offset:520
s_waitcnt lgkmcnt(4)
ds_write_b128 v2, v[76:79] offset:0
s_waitcnt lgkmcnt(3)
ds_write_b128 v2, v[80:83] offset:22528
s_waitcnt vmcnt(8) lgkmcnt(2)
s_barrier
s_add_u32 m0, s29, 0
s_add_u32 s26, s83, 2097152
buffer_load_dwordx4 v32, s[96:99], s26 offen offset:0 lds
buffer_load_dwordx4 v33, s[96:99], s26 offen offset:1024 lds
buffer_load_dwordx4 v34, s[96:99], s26 offen offset:2048 lds
buffer_load_dwordx4 v35, s[96:99], s26 offen offset:3072 lds
ds_read_b64_tr_b16 a[52:53], v40 offset:16384
ds_read_b64_tr_b16 a[54:55], v40 offset:16896
ds_read_b64_tr_b16 v[76:77], v40 offset:16392
ds_read_b64_tr_b16 v[78:79], v40 offset:16904
ds_read_b64_tr_b16 v[80:81], v41 offset:16384
ds_read_b64_tr_b16 v[82:83], v41 offset:16896
ds_read_b64_tr_b16 v[100:101], v41 offset:16392
ds_read_b64_tr_b16 v[102:103], v41 offset:16904
s_waitcnt lgkmcnt(4)
ds_write_b128 v2, v[76:79] offset:1024
s_waitcnt lgkmcnt(3)
ds_write_b128 v2, v[80:83] offset:23552
s_waitcnt vmcnt(8) lgkmcnt(2)
s_barrier
s_add_u32 m0, s29, 16384
s_add_u32 s26, s83, 2359296
buffer_load_dwordx4 v32, s[96:99], s26 offen offset:0 lds
buffer_load_dwordx4 v33, s[96:99], s26 offen offset:1024 lds
buffer_load_dwordx4 v34, s[96:99], s26 offen offset:2048 lds
buffer_load_dwordx4 v35, s[96:99], s26 offen offset:3072 lds
ds_read_b64_tr_b16 v[104:105], v40 offset:32768
ds_read_b64_tr_b16 v[106:107], v40 offset:33280
ds_read_b64_tr_b16 v[112:113], v40 offset:32776
ds_read_b64_tr_b16 v[114:115], v40 offset:33288
ds_read_b64_tr_b16 v[136:137], v41 offset:32768
ds_read_b64_tr_b16 v[138:139], v41 offset:33280
ds_read_b64_tr_b16 v[144:145], v41 offset:32776
ds_read_b64_tr_b16 v[146:147], v41 offset:33288
s_waitcnt vmcnt(8) lgkmcnt(0)
s_barrier
s_add_u32 m0, s29, 32768
s_add_u32 s26, s84, 0
buffer_load_dwordx4 v32, s[96:99], s26 offen offset:0 lds
buffer_load_dwordx4 v33, s[96:99], s26 offen offset:1024 lds
buffer_load_dwordx4 v34, s[96:99], s26 offen offset:2048 lds
buffer_load_dwordx4 v35, s[96:99], s26 offen offset:3072 lds
ds_read_b64_tr_b16 v[108:109], v40 offset:49152
ds_read_b64_tr_b16 v[110:111], v40 offset:49664
ds_read_b64_tr_b16 v[116:117], v40 offset:49160
ds_read_b64_tr_b16 v[118:119], v40 offset:49672
ds_read_b64_tr_b16 v[140:141], v41 offset:49152
ds_read_b64_tr_b16 v[142:143], v41 offset:49664
ds_read_b64_tr_b16 v[148:149], v41 offset:49160
ds_read_b64_tr_b16 v[150:151], v41 offset:49672
s_waitcnt vmcnt(8) lgkmcnt(0)
s_barrier
s_add_u32 m0, s29, 49152
s_add_u32 s26, s84, 262144
buffer_load_dwordx4 v32, s[96:99], s26 offen offset:0 lds
buffer_load_dwordx4 v33, s[96:99], s26 offen offset:1024 lds
buffer_load_dwordx4 v34, s[96:99], s26 offen offset:2048 lds
buffer_load_dwordx4 v35, s[96:99], s26 offen offset:3072 lds
ds_read_b64_tr_b16 v[120:121], v40 offset:0
ds_read_b64_tr_b16 v[122:123], v40 offset:512
ds_read_b64_tr_b16 v[128:129], v40 offset:8
ds_read_b64_tr_b16 v[130:131], v40 offset:520
ds_read_b64_tr_b16 v[152:153], v41 offset:0
ds_read_b64_tr_b16 v[154:155], v41 offset:512
ds_read_b64_tr_b16 v[160:161], v41 offset:8
ds_read_b64_tr_b16 v[162:163], v41 offset:520
s_waitcnt vmcnt(8) lgkmcnt(0)
s_barrier
s_mov_b64 s[96:97], s[68:69]
s_add_u32 m0, s29, 0
s_add_u32 s26, s82, 0
buffer_load_dwordx4 v32, s[96:99], s26 offen offset:0 lds
buffer_load_dwordx4 v33, s[96:99], s26 offen offset:1024 lds
buffer_load_dwordx4 v34, s[96:99], s26 offen offset:2048 lds
buffer_load_dwordx4 v35, s[96:99], s26 offen offset:3072 lds
ds_read_b64_tr_b16 v[124:125], v40 offset:16384
ds_read_b64_tr_b16 v[126:127], v40 offset:16896
ds_read_b64_tr_b16 v[132:133], v40 offset:16392
ds_read_b64_tr_b16 v[134:135], v40 offset:16904
ds_read_b64_tr_b16 v[156:157], v41 offset:16384
ds_read_b64_tr_b16 v[158:159], v41 offset:16896
ds_read_b64_tr_b16 v[164:165], v41 offset:16392
ds_read_b64_tr_b16 v[166:167], v41 offset:16904
s_waitcnt vmcnt(8) lgkmcnt(0)
s_barrier
s_add_u32 m0, s29, 16384
s_add_u32 s26, s82, 262144
buffer_load_dwordx4 v32, s[96:99], s26 offen offset:0 lds
buffer_load_dwordx4 v33, s[96:99], s26 offen offset:1024 lds
buffer_load_dwordx4 v34, s[96:99], s26 offen offset:2048 lds
buffer_load_dwordx4 v35, s[96:99], s26 offen offset:3072 lds
ds_read_b64_tr_b16 v[72:73], v40 offset:32768
ds_read_b64_tr_b16 v[74:75], v40 offset:33280
ds_read_b64_tr_b16 a[232:233], v40 offset:32776
ds_read_b64_tr_b16 a[234:235], v40 offset:33288
ds_read_b64_tr_b16 a[240:241], v41 offset:32768
ds_read_b64_tr_b16 a[242:243], v41 offset:33280
ds_read_b64_tr_b16 v[84:85], v41 offset:32776
ds_read_b64_tr_b16 v[86:87], v41 offset:33288
s_waitcnt lgkmcnt(6)
ds_write_b128 v2, v[72:75] offset:18432
s_waitcnt lgkmcnt(1)
ds_write_b128 v2, v[84:87] offset:20480
s_waitcnt vmcnt(8)
s_barrier
s_add_u32 m0, s29, 32768
s_add_u32 s26, s82, 2097152
buffer_load_dwordx4 v32, s[96:99], s26 offen offset:0 lds
buffer_load_dwordx4 v33, s[96:99], s26 offen offset:1024 lds
buffer_load_dwordx4 v34, s[96:99], s26 offen offset:2048 lds
buffer_load_dwordx4 v35, s[96:99], s26 offen offset:3072 lds
ds_read_b64_tr_b16 v[72:73], v40 offset:49152
ds_read_b64_tr_b16 v[74:75], v40 offset:49664
ds_read_b64_tr_b16 a[236:237], v40 offset:49160
ds_read_b64_tr_b16 a[238:239], v40 offset:49672
ds_read_b64_tr_b16 a[244:245], v41 offset:49152
ds_read_b64_tr_b16 a[246:247], v41 offset:49664
ds_read_b64_tr_b16 v[84:85], v41 offset:49160
ds_read_b64_tr_b16 v[86:87], v41 offset:49672
s_waitcnt lgkmcnt(6)
ds_write_b128 v2, v[72:75] offset:19456
s_waitcnt lgkmcnt(1)
ds_write_b128 v2, v[84:87] offset:21504
s_waitcnt vmcnt(8)
s_barrier
s_add_u32 m0, s29, 49152
s_add_u32 s26, s82, 2359296
buffer_load_dwordx4 v32, s[96:99], s26 offen offset:0 lds
buffer_load_dwordx4 v33, s[96:99], s26 offen offset:1024 lds
buffer_load_dwordx4 v34, s[96:99], s26 offen offset:2048 lds
buffer_load_dwordx4 v35, s[96:99], s26 offen offset:3072 lds
ds_read_b64_tr_b16 v[72:73], v40 offset:0
ds_read_b64_tr_b16 v[74:75], v40 offset:512
ds_read_b64_tr_b16 v[76:77], v40 offset:8
ds_read_b64_tr_b16 v[78:79], v40 offset:520
ds_read_b64_tr_b16 a[56:57], v41 offset:0
ds_read_b64_tr_b16 a[58:59], v41 offset:512
ds_read_b64_tr_b16 a[64:65], v41 offset:8
ds_read_b64_tr_b16 a[66:67], v41 offset:520
s_waitcnt lgkmcnt(6)
global_store_dwordx4 v0, v[72:75], s[76:77] offset:-4096
s_waitcnt lgkmcnt(4)
global_store_dwordx4 v0, v[76:79], s[76:77] offset:-2048
s_waitcnt vmcnt(10) lgkmcnt(0)
s_barrier
s_add_u32 m0, s29, 0
s_add_u32 s26, s83, 0
buffer_load_dwordx4 v32, s[96:99], s26 offen offset:0 lds
buffer_load_dwordx4 v33, s[96:99], s26 offen offset:1024 lds
buffer_load_dwordx4 v34, s[96:99], s26 offen offset:2048 lds
buffer_load_dwordx4 v35, s[96:99], s26 offen offset:3072 lds
ds_read_b64_tr_b16 v[72:73], v40 offset:16384
ds_read_b64_tr_b16 v[74:75], v40 offset:16896
ds_read_b64_tr_b16 v[76:77], v40 offset:16392
ds_read_b64_tr_b16 v[78:79], v40 offset:16904
ds_read_b64_tr_b16 a[60:61], v41 offset:16384
ds_read_b64_tr_b16 a[62:63], v41 offset:16896
ds_read_b64_tr_b16 a[68:69], v41 offset:16392
ds_read_b64_tr_b16 a[70:71], v41 offset:16904
s_waitcnt lgkmcnt(6)
global_store_dwordx4 v0, v[72:75], s[76:77] offset:-3072
s_waitcnt lgkmcnt(4)
global_store_dwordx4 v0, v[76:79], s[76:77] offset:-1024
s_waitcnt vmcnt(12) lgkmcnt(0)
s_barrier
s_add_u32 m0, s29, 16384
s_add_u32 s26, s83, 262144
buffer_load_dwordx4 v32, s[96:99], s26 offen offset:0 lds
buffer_load_dwordx4 v33, s[96:99], s26 offen offset:1024 lds
buffer_load_dwordx4 v34, s[96:99], s26 offen offset:2048 lds
buffer_load_dwordx4 v35, s[96:99], s26 offen offset:3072 lds
ds_read_b64_tr_b16 a[16:17], v40 offset:32768
ds_read_b64_tr_b16 a[18:19], v40 offset:33280
ds_read_b64_tr_b16 a[24:25], v40 offset:32776
ds_read_b64_tr_b16 a[26:27], v40 offset:33288
ds_read_b64_tr_b16 a[72:73], v41 offset:32768
ds_read_b64_tr_b16 a[74:75], v41 offset:33280
ds_read_b64_tr_b16 a[80:81], v41 offset:32776
ds_read_b64_tr_b16 a[82:83], v41 offset:33288
s_waitcnt vmcnt(12) lgkmcnt(0)
s_barrier
s_add_u32 m0, s29, 32768
s_add_u32 s26, s83, 2097152
buffer_load_dwordx4 v32, s[96:99], s26 offen offset:0 lds
buffer_load_dwordx4 v33, s[96:99], s26 offen offset:1024 lds
buffer_load_dwordx4 v34, s[96:99], s26 offen offset:2048 lds
buffer_load_dwordx4 v35, s[96:99], s26 offen offset:3072 lds
ds_read_b64_tr_b16 a[20:21], v40 offset:49152
ds_read_b64_tr_b16 a[22:23], v40 offset:49664
ds_read_b64_tr_b16 a[28:29], v40 offset:49160
ds_read_b64_tr_b16 a[30:31], v40 offset:49672
ds_read_b64_tr_b16 a[76:77], v41 offset:49152
ds_read_b64_tr_b16 a[78:79], v41 offset:49664
ds_read_b64_tr_b16 a[84:85], v41 offset:49160
ds_read_b64_tr_b16 a[86:87], v41 offset:49672
s_waitcnt vmcnt(10) lgkmcnt(0)
s_barrier
s_add_u32 m0, s29, 49152
s_add_u32 s26, s83, 2359296
buffer_load_dwordx4 v32, s[96:99], s26 offen offset:0 lds
buffer_load_dwordx4 v33, s[96:99], s26 offen offset:1024 lds
buffer_load_dwordx4 v34, s[96:99], s26 offen offset:2048 lds
buffer_load_dwordx4 v35, s[96:99], s26 offen offset:3072 lds
ds_read_b64_tr_b16 a[88:89], v40 offset:0
ds_read_b64_tr_b16 a[90:91], v40 offset:512
ds_read_b64_tr_b16 v[76:77], v40 offset:8
ds_read_b64_tr_b16 v[78:79], v40 offset:520
ds_read_b64_tr_b16 a[112:113], v41 offset:0
ds_read_b64_tr_b16 a[114:115], v41 offset:512
ds_read_b64_tr_b16 a[120:121], v41 offset:8
ds_read_b64_tr_b16 a[122:123], v41 offset:520
s_waitcnt lgkmcnt(4)
ds_write_b128 v2, v[76:79] offset:2048
s_waitcnt vmcnt(8) lgkmcnt(1)
s_barrier
s_add_u32 m0, s29, 0
s_add_u32 s26, s84, 0
buffer_load_dwordx4 v32, s[96:99], s26 offen offset:0 lds
buffer_load_dwordx4 v33, s[96:99], s26 offen offset:1024 lds
buffer_load_dwordx4 v34, s[96:99], s26 offen offset:2048 lds
buffer_load_dwordx4 v35, s[96:99], s26 offen offset:3072 lds
ds_read_b64_tr_b16 a[92:93], v40 offset:16384
ds_read_b64_tr_b16 a[94:95], v40 offset:16896
ds_read_b64_tr_b16 v[76:77], v40 offset:16392
ds_read_b64_tr_b16 v[78:79], v40 offset:16904
ds_read_b64_tr_b16 a[116:117], v41 offset:16384
ds_read_b64_tr_b16 a[118:119], v41 offset:16896
ds_read_b64_tr_b16 a[124:125], v41 offset:16392
ds_read_b64_tr_b16 a[126:127], v41 offset:16904
s_waitcnt lgkmcnt(4)
ds_write_b128 v2, v[76:79] offset:3072
s_waitcnt vmcnt(8) lgkmcnt(1)
s_barrier
s_add_u32 m0, s29, 16384
s_add_u32 s26, s84, 262144
buffer_load_dwordx4 v32, s[96:99], s26 offen offset:0 lds
buffer_load_dwordx4 v33, s[96:99], s26 offen offset:1024 lds
buffer_load_dwordx4 v34, s[96:99], s26 offen offset:2048 lds
buffer_load_dwordx4 v35, s[96:99], s26 offen offset:3072 lds
ds_read_b64_tr_b16 a[96:97], v40 offset:32768
ds_read_b64_tr_b16 a[98:99], v40 offset:33280
ds_read_b64_tr_b16 a[104:105], v40 offset:32776
ds_read_b64_tr_b16 a[106:107], v40 offset:33288
ds_read_b64_tr_b16 a[128:129], v41 offset:32768
ds_read_b64_tr_b16 a[130:131], v41 offset:33280
ds_read_b64_tr_b16 v[84:85], v41 offset:32776
ds_read_b64_tr_b16 v[86:87], v41 offset:33288
s_waitcnt lgkmcnt(0)
ds_write_b128 v2, v[84:87] offset:4096
s_waitcnt vmcnt(8)
s_barrier
s_mov_b64 s[96:97], s[74:75]
s_add_u32 m0, s29, 32768
s_add_u32 s26, s85, 0
buffer_load_dwordx4 v36, s[96:99], s26 offen offset:0 lds
buffer_load_dwordx4 v37, s[96:99], s26 offen offset:1024 lds
buffer_load_dwordx4 v38, s[96:99], s26 offen offset:2048 lds
buffer_load_dwordx4 v39, s[96:99], s26 offen offset:3072 lds
ds_read_b64_tr_b16 a[100:101], v40 offset:49152
ds_read_b64_tr_b16 a[102:103], v40 offset:49664
ds_read_b64_tr_b16 a[108:109], v40 offset:49160
ds_read_b64_tr_b16 a[110:111], v40 offset:49672
ds_read_b64_tr_b16 a[132:133], v41 offset:49152
ds_read_b64_tr_b16 a[134:135], v41 offset:49664
ds_read_b64_tr_b16 v[84:85], v41 offset:49160
ds_read_b64_tr_b16 v[86:87], v41 offset:49672
s_waitcnt lgkmcnt(0)
ds_write_b128 v2, v[84:87] offset:5120
s_waitcnt vmcnt(8)
s_barrier
s_add_u32 m0, s29, 49152
s_add_u32 s26, s86, 0
buffer_load_dwordx4 v36, s[96:99], s26 offen offset:0 lds
buffer_load_dwordx4 v37, s[96:99], s26 offen offset:1024 lds
buffer_load_dwordx4 v38, s[96:99], s26 offen offset:2048 lds
buffer_load_dwordx4 v39, s[96:99], s26 offen offset:3072 lds
ds_read_b64_tr_b16 a[136:137], v40 offset:0
ds_read_b64_tr_b16 a[138:139], v40 offset:512
ds_read_b64_tr_b16 a[144:145], v40 offset:8
ds_read_b64_tr_b16 a[146:147], v40 offset:520
ds_read_b64_tr_b16 v[80:81], v41 offset:0
ds_read_b64_tr_b16 v[82:83], v41 offset:512
ds_read_b64_tr_b16 a[152:153], v41 offset:8
ds_read_b64_tr_b16 a[154:155], v41 offset:520
s_waitcnt lgkmcnt(2)
global_store_dwordx4 v0, v[80:83], s[78:79] offset:-4096
s_waitcnt vmcnt(9) lgkmcnt(0)
s_barrier
s_add_u32 m0, s29, 0
s_add_u32 s26, s85, 256
buffer_load_dwordx4 v36, s[96:99], s26 offen offset:0 lds
buffer_load_dwordx4 v37, s[96:99], s26 offen offset:1024 lds
buffer_load_dwordx4 v38, s[96:99], s26 offen offset:2048 lds
buffer_load_dwordx4 v39, s[96:99], s26 offen offset:3072 lds
ds_read_b64_tr_b16 a[140:141], v40 offset:16384
ds_read_b64_tr_b16 a[142:143], v40 offset:16896
ds_read_b64_tr_b16 a[148:149], v40 offset:16392
ds_read_b64_tr_b16 a[150:151], v40 offset:16904
ds_read_b64_tr_b16 v[80:81], v41 offset:16384
ds_read_b64_tr_b16 v[82:83], v41 offset:16896
ds_read_b64_tr_b16 a[156:157], v41 offset:16392
ds_read_b64_tr_b16 a[158:159], v41 offset:16904
s_waitcnt lgkmcnt(2)
global_store_dwordx4 v0, v[80:83], s[78:79] offset:-3072
s_waitcnt vmcnt(10) lgkmcnt(0)
s_barrier
s_add_u32 m0, s29, 16384
s_add_u32 s26, s86, 256
buffer_load_dwordx4 v36, s[96:99], s26 offen offset:0 lds
buffer_load_dwordx4 v37, s[96:99], s26 offen offset:1024 lds
buffer_load_dwordx4 v38, s[96:99], s26 offen offset:2048 lds
buffer_load_dwordx4 v39, s[96:99], s26 offen offset:3072 lds
ds_read_b64_tr_b16 v[72:73], v42 offset:32768
ds_read_b64_tr_b16 v[74:75], v42 offset:33024
ds_read_b64_tr_b16 v[76:77], v42 offset:34816
ds_read_b64_tr_b16 v[78:79], v42 offset:35072
ds_read_b64_tr_b16 v[8:9], v43 offset:32768
ds_read_b64_tr_b16 v[10:11], v43 offset:33024
ds_read_b64_tr_b16 v[12:13], v43 offset:34816
ds_read_b64_tr_b16 v[14:15], v43 offset:35072
s_waitcnt lgkmcnt(6)
global_store_dwordx4 v0, v[72:75], s[78:79] offset:0
s_waitcnt lgkmcnt(4)
global_store_dwordx4 v0, v[76:79], s[78:79] offset:1024
s_waitcnt vmcnt(12) lgkmcnt(0)
s_barrier
s_add_u32 m0, s29, 32768
s_add_u32 s26, s85, 512
buffer_load_dwordx4 v36, s[96:99], s26 offen offset:0 lds
buffer_load_dwordx4 v37, s[96:99], s26 offen offset:1024 lds
buffer_load_dwordx4 v38, s[96:99], s26 offen offset:2048 lds
buffer_load_dwordx4 v39, s[96:99], s26 offen offset:3072 lds
ds_read_b64_tr_b16 v[16:17], v42 offset:49152
ds_read_b64_tr_b16 v[18:19], v42 offset:49408
ds_read_b64_tr_b16 v[20:21], v42 offset:51200
ds_read_b64_tr_b16 v[22:23], v42 offset:51456
ds_read_b64_tr_b16 v[184:185], v43 offset:49152
ds_read_b64_tr_b16 v[186:187], v43 offset:49408
ds_read_b64_tr_b16 v[188:189], v43 offset:51200
ds_read_b64_tr_b16 v[190:191], v43 offset:51456
s_waitcnt vmcnt(11) lgkmcnt(0)
s_barrier
s_add_u32 m0, s29, 49152
s_add_u32 s26, s86, 512
buffer_load_dwordx4 v36, s[96:99], s26 offen offset:0 lds
buffer_load_dwordx4 v37, s[96:99], s26 offen offset:1024 lds
buffer_load_dwordx4 v38, s[96:99], s26 offen offset:2048 lds
buffer_load_dwordx4 v39, s[96:99], s26 offen offset:3072 lds
ds_read_b64_tr_b16 v[72:73], v42 offset:0
ds_read_b64_tr_b16 v[74:75], v42 offset:256
ds_read_b64_tr_b16 v[76:77], v42 offset:2048
ds_read_b64_tr_b16 v[78:79], v42 offset:2304
ds_read_b64_tr_b16 v[192:193], v43 offset:0
ds_read_b64_tr_b16 v[194:195], v43 offset:256
ds_read_b64_tr_b16 v[196:197], v43 offset:2048
ds_read_b64_tr_b16 v[198:199], v43 offset:2304
s_waitcnt lgkmcnt(6)
global_store_dwordx4 v0, v[72:75], s[78:79] offset:2048
s_waitcnt lgkmcnt(4)
global_store_dwordx4 v0, v[76:79], s[78:79] offset:3072
s_waitcnt vmcnt(12) lgkmcnt(0)
s_barrier
s_add_u32 m0, s29, 0
s_add_u32 s26, s85, 768
buffer_load_dwordx4 v36, s[96:99], s26 offen offset:0 lds
buffer_load_dwordx4 v37, s[96:99], s26 offen offset:1024 lds
buffer_load_dwordx4 v38, s[96:99], s26 offen offset:2048 lds
buffer_load_dwordx4 v39, s[96:99], s26 offen offset:3072 lds
ds_read_b64_tr_b16 v[24:25], v42 offset:16384
ds_read_b64_tr_b16 v[26:27], v42 offset:16640
ds_read_b64_tr_b16 v[28:29], v42 offset:18432
ds_read_b64_tr_b16 v[30:31], v42 offset:18688
ds_read_b64_tr_b16 v[200:201], v43 offset:16384
ds_read_b64_tr_b16 v[202:203], v43 offset:16640
ds_read_b64_tr_b16 v[204:205], v43 offset:18432
ds_read_b64_tr_b16 v[206:207], v43 offset:18688
s_waitcnt vmcnt(10) lgkmcnt(0)
s_barrier
s_add_u32 m0, s29, 16384
s_add_u32 s26, s86, 768
buffer_load_dwordx4 v36, s[96:99], s26 offen offset:0 lds
buffer_load_dwordx4 v37, s[96:99], s26 offen offset:1024 lds
buffer_load_dwordx4 v38, s[96:99], s26 offen offset:2048 lds
buffer_load_dwordx4 v39, s[96:99], s26 offen offset:3072 lds
ds_read_b64_tr_b16 v[168:169], v42 offset:32768
ds_read_b64_tr_b16 v[170:171], v42 offset:33024
ds_read_b64_tr_b16 v[172:173], v42 offset:34816
ds_read_b64_tr_b16 v[174:175], v42 offset:35072
ds_read_b64_tr_b16 v[48:49], v43 offset:32768
ds_read_b64_tr_b16 v[50:51], v43 offset:33024
ds_read_b64_tr_b16 v[52:53], v43 offset:34816
ds_read_b64_tr_b16 v[54:55], v43 offset:35072
s_waitcnt vmcnt(10) lgkmcnt(0)
s_barrier
s_add_u32 m0, s29, 32768
s_add_u32 s26, s85, 1024
buffer_load_dwordx4 v36, s[96:99], s26 offen offset:0 lds
buffer_load_dwordx4 v37, s[96:99], s26 offen offset:1024 lds
buffer_load_dwordx4 v38, s[96:99], s26 offen offset:2048 lds
buffer_load_dwordx4 v39, s[96:99], s26 offen offset:3072 lds
ds_read_b64_tr_b16 v[56:57], v42 offset:49152
ds_read_b64_tr_b16 v[58:59], v42 offset:49408
ds_read_b64_tr_b16 v[60:61], v42 offset:51200
ds_read_b64_tr_b16 v[62:63], v42 offset:51456
ds_read_b64_tr_b16 v[208:209], v43 offset:49152
ds_read_b64_tr_b16 v[210:211], v43 offset:49408
ds_read_b64_tr_b16 v[212:213], v43 offset:51200
ds_read_b64_tr_b16 v[214:215], v43 offset:51456
s_waitcnt vmcnt(8) lgkmcnt(0)
s_barrier
s_add_u32 m0, s29, 49152
s_add_u32 s26, s86, 1024
buffer_load_dwordx4 v36, s[96:99], s26 offen offset:0 lds
buffer_load_dwordx4 v37, s[96:99], s26 offen offset:1024 lds
buffer_load_dwordx4 v38, s[96:99], s26 offen offset:2048 lds
buffer_load_dwordx4 v39, s[96:99], s26 offen offset:3072 lds
ds_read_b64_tr_b16 v[176:177], v42 offset:0
ds_read_b64_tr_b16 v[178:179], v42 offset:256
ds_read_b64_tr_b16 v[180:181], v42 offset:2048
ds_read_b64_tr_b16 v[182:183], v42 offset:2304
ds_read_b64_tr_b16 v[216:217], v43 offset:0
ds_read_b64_tr_b16 v[218:219], v43 offset:256
ds_read_b64_tr_b16 v[220:221], v43 offset:2048
ds_read_b64_tr_b16 v[222:223], v43 offset:2304
s_waitcnt vmcnt(8) lgkmcnt(0)
s_barrier
ds_read_b64_tr_b16 v[64:65], v42 offset:16384
ds_read_b64_tr_b16 v[66:67], v42 offset:16640
ds_read_b64_tr_b16 v[68:69], v42 offset:18432
ds_read_b64_tr_b16 v[70:71], v42 offset:18688
ds_read_b64_tr_b16 v[224:225], v43 offset:16384
ds_read_b64_tr_b16 v[226:227], v43 offset:16640
ds_read_b64_tr_b16 v[228:229], v43 offset:18432
ds_read_b64_tr_b16 v[230:231], v43 offset:18688
s_waitcnt vmcnt(4) lgkmcnt(0)
s_barrier
ds_read_b64_tr_b16 v[72:73], v42 offset:32768
ds_read_b64_tr_b16 v[74:75], v42 offset:33024
ds_read_b64_tr_b16 v[76:77], v42 offset:34816
ds_read_b64_tr_b16 v[78:79], v42 offset:35072
ds_read_b64_tr_b16 v[232:233], v43 offset:32768
ds_read_b64_tr_b16 v[234:235], v43 offset:33024
ds_read_b64_tr_b16 v[236:237], v43 offset:34816
ds_read_b64_tr_b16 v[238:239], v43 offset:35072
s_waitcnt lgkmcnt(6)
global_store_dwordx4 v0, v[72:75], s[80:81] offset:-4096
s_waitcnt lgkmcnt(4)
global_store_dwordx4 v0, v[76:79], s[80:81] offset:-3072
s_waitcnt vmcnt(2) lgkmcnt(0)
s_barrier
ds_read_b64_tr_b16 v[240:241], v42 offset:49152
ds_read_b64_tr_b16 v[242:243], v42 offset:49408
ds_read_b64_tr_b16 v[244:245], v42 offset:51200
ds_read_b64_tr_b16 v[246:247], v42 offset:51456
ds_read_b64_tr_b16 v[248:249], v43 offset:49152
ds_read_b64_tr_b16 v[250:251], v43 offset:49408
ds_read_b64_tr_b16 v[252:253], v43 offset:51200
ds_read_b64_tr_b16 v[254:255], v43 offset:51456
s_waitcnt lgkmcnt(0)
s_barrier
s_mul_i32 s26, s13, 12288
v_add_u32 v44, s26, v0
ds_write_b128 v44, v[8:11] offset:16384
ds_write_b128 v44, v[12:15] offset:17408
ds_write_b128 v44, v[16:19] offset:18432
ds_write_b128 v44, v[20:23] offset:19456
ds_write_b128 v44, v[24:27] offset:20480
ds_write_b128 v44, v[28:31] offset:21504
ds_write_b128 v44, v[48:51] offset:22528
ds_write_b128 v44, v[52:55] offset:23552
ds_write_b128 v44, v[56:59] offset:24576
ds_write_b128 v44, v[60:63] offset:25600
ds_write_b128 v44, v[64:67] offset:26624
ds_write_b128 v44, v[68:71] offset:27648
s_waitcnt vmcnt(0) lgkmcnt(0)
s_barrier
s_cmp_lg_u32 s13, 0
s_cbranch_scc1 cb_10004
v_mov_b32 v44, 4
v_mov_b32 v45, 1
s_mov_b64 exec, 1
buffer_atomic_add v45, v44, s[8:11], 0 offen
s_mov_b32 s30, 0
cb_10003:
buffer_load_dword v45, v44, s[8:11], 0 offen sc1
s_add_u32 s30, s30, 1
s_cmp_gt_u32 s30, 262144
s_cbranch_scc1 L_fail
s_waitcnt vmcnt(0)
v_cmp_gt_u32 vcc, 32, v45
s_cbranch_vccnz cb_10003
s_mov_b64 exec, -1
cb_10004:
s_barrier
s_mov_b32 s18, 0
s_mov_b32 s36, 0
s_cmp_eq_u32 s13, 1
s_cbranch_scc1 wave_10006
s_cmp_eq_u32 s13, 2
s_cbranch_scc1 wave_10007
s_cmp_eq_u32 s13, 3
s_cbranch_scc1 wave_10008
wave_10005:
layer_10009:
s_lshl_b32 s17, s36, 6
s_mul_i32 s27, s36, 35651584
s_mul_i32 s28, s14, 16384
s_add_u32 s27, s27, s28
s_add_u32 s20, s27, 16777216
s_mul_i32 s27, s17, 10240
s_add_u32 s27, s27, s24
s_add_u32 s21, s27, s25
s_mov_b32 s19, 0
s_mov_b32 s33, s6
s_add_u32 s34, s17, 1
s_add_u32 s31, s17, 63
s_add_u32 s32, s17, 64
s_mov_b32 s27, s20
v_mov_b32 v7, 0
s_add_u32 s68, s4, 413696
s_addc_u32 s69, s5, 0
s_add_u32 s72, s4, 397312
s_addc_u32 s73, s5, 0
s_add_u32 s70, s4, 417792
s_addc_u32 s71, s5, 0
s_add_u32 s74, s4, 401408
s_addc_u32 s75, s5, 0
s_add_u32 s58, s4, s20
s_addc_u32 s59, s5, 0
global_load_dwordx4 v[64:67], v0, s[76:77] offset:-4096 sc1
global_load_dwordx4 v[68:71], v0, s[76:77] offset:-3072 sc1
global_load_dwordx4 v[72:75], v0, s[76:77] offset:-2048 sc1
global_load_dwordx4 v[76:79], v0, s[76:77] offset:-1024 sc1
global_load_dwordx4 v[80:83], v0, s[76:77] offset:2048 sc1
global_load_dwordx4 v[84:87], v0, s[76:77] offset:3072 sc1
global_load_dwordx4 v[56:59], v0, s[76:77] offset:0 sc1
global_load_dwordx4 v[60:63], v0, s[76:77] offset:1024 sc1
v_mov_b64 v[8:9], 0
v_mov_b64 v[10:11], 0
v_mov_b64 v[12:13], 0
v_mov_b64 v[14:15], 0
v_mov_b64 v[16:17], 0
v_mov_b64 v[18:19], 0
v_mov_b64 v[20:21], 0
v_mov_b64 v[22:23], 0
v_mov_b64 v[24:25], 0
v_mov_b64 v[26:27], 0
v_mov_b64 v[28:29], 0
v_mov_b64 v[30:31], 0
v_cmp_gt_u32 vcc, s34, v7
s_cmp_eq_u32 vcc_hi, 0
s_cbranch_scc1 kv_10020
s_mov_b32 s30, 0
kv_10019:
v_bfe_u32 v7, v0, 2, 3
buffer_load_dword v7, v7, s[4:7], s22 offen sc1
s_add_u32 s30, s30, 1
s_cmp_gt_u32 s30, 262144
s_cbranch_scc1 L_fail
s_waitcnt vmcnt(0)
v_cmp_gt_u32 vcc, s34, v7
s_cbranch_vccnz kv_10019
kv_10020:
s_barrier
global_load_dwordx4 v[48:51], v0, s[58:59] offset:0 nt sc1
global_load_dwordx4 v[52:55], v0, s[58:59] offset:1024 nt sc1
v_and_b32 v7, 255, v0
v_lshl_add_u32 v7, v7, 3, s27
global_load_dwordx4 v[32:35], v0, s[68:69] offset:-4096 sc1
global_load_dwordx4 v[36:39], v0, s[68:69] offset:0 sc1
global_load_dwordx4 v[40:43], v0, s[70:71] offset:0 sc1
s_mov_b32 s30, 0
s_waitcnt vmcnt(0)
.p2align 6
gather_10010:
s_waitcnt vmcnt(4)
rt_10015_b:
v_smfmac_f32_16x16x64_bf16 v[24:27], v[32:35], a[0:7], v1
ds_write_b128 v0, v[32:35] offset:0
v_smfmac_f32_16x16x64_bf16 v[8:11], v[32:35], v[64:71], v1
v_bitop3_b32 v44, v32, v34, s18 bitop3:0x7e
v_smfmac_f32_16x16x64_bf16 v[12:15], v[32:35], v[72:79], v1
s_waitcnt vmcnt(3)
ds_write_b128 v0, v[36:39] offset:4096
v_bitop3_b32 v45, v36, v38, s18 bitop3:0x7e
v_or_b32 v44, v44, v45
s_waitcnt vmcnt(2)
v_bitop3_b32 v45, v40, v42, s18 bitop3:0x7e
v_bitop3_b32 v44, v44, v45, s19 bitop3:0xa8
v_cmp_ne_u32 vcc, 0, v44
v_smfmac_f32_16x16x64_bf16 v[8:11], v[36:39], a[16:23], v1
ds_write_b128 v0, v[40:43] offset:8192
v_smfmac_f32_16x16x64_bf16 v[20:23], v[32:35], v[80:87], v1
s_cbranch_vccnz rt_10015
global_load_dwordx4 v[64:67], v0, s[78:79] offset:-4096 sc1
ds_read_b128 v[80:83], v2 offset:0
v_smfmac_f32_16x16x64_bf16 v[28:31], v[32:35], a[8:15], v1
global_load_dwordx4 v[68:71], v0, s[78:79] offset:-3072 sc1
ds_read_b128 v[84:87], v2 offset:1024
v_smfmac_f32_16x16x64_bf16 v[20:23], v[36:39], a[40:47], v1
s_waitcnt lgkmcnt(2)
global_load_dwordx4 v[72:75], v0, s[78:79] offset:-2048 sc1
global_load_dwordx4 v[76:79], v0, s[78:79] offset:-1024 sc1
v_smfmac_f32_16x16x64_bf16 v[16:19], v[32:35], v[56:63], v1
s_barrier
ds_read_b128 v[40:43], v0 offset:1024
v_smfmac_f32_16x16x64_bf16 v[16:19], v[36:39], a[32:39], v1
s_waitcnt lgkmcnt(1)
ds_read_b128 v[44:47], v0 offset:5120
v_smfmac_f32_16x16x64_bf16 v[28:31], v[36:39], v[80:87], v1
s_xor_b32 s18, s18, 1
ds_read_b128 v[32:35], v0 offset:2048
v_smfmac_f32_16x16x64_bf16 v[24:27], v[36:39], a[48:55], v1
s_add_u32 s20, s20, 524288
ds_read_b128 v[84:87], v2 offset:3072
v_smfmac_f32_16x16x64_bf16 v[12:15], v[36:39], a[24:31], v1
ds_read_b128 v[80:83], v2 offset:2048
s_waitcnt lgkmcnt(4)
v_smfmac_f32_16x16x64_bf16 v[12:15], v[40:43], a[64:71], v1
ds_read_b128 v[36:39], v0 offset:6144
v_smfmac_f32_16x16x64_bf16 v[8:11], v[40:43], a[56:63], v1
s_waitcnt lgkmcnt(4)
ds_read_b128 v[40:43], v0 offset:3072
s_waitcnt lgkmcnt(4)
v_smfmac_f32_16x16x64_bf16 v[12:15], v[44:47], a[80:87], v1
s_add_u32 s17, s17, 1
global_load_dwordx4 v[56:59], v0, s[58:59] offset:2048 nt sc1
v_smfmac_f32_16x16x64_bf16 v[8:11], v[44:47], a[72:79], v1
s_waitcnt lgkmcnt(3)
ds_read_b128 v[44:47], v0 offset:7168
s_waitcnt lgkmcnt(3)
v_smfmac_f32_16x16x64_bf16 v[12:15], v[32:35], v[80:87], v1
ds_read_b128 v[80:83], v2 offset:4096
v_smfmac_f32_16x16x64_bf16 v[8:11], v[32:35], a[88:95], v1
s_waitcnt lgkmcnt(3)
ds_read_b128 v[84:87], v2 offset:5120
s_add_u32 s21, s21, 10240
v_smfmac_f32_16x16x64_bf16 v[12:15], v[36:39], a[104:111], v1
ds_read_b128 v[32:35], v0 offset:8192
v_smfmac_f32_16x16x64_bf16 v[8:11], v[36:39], a[96:103], v1
s_waitcnt lgkmcnt(4)
s_waitcnt lgkmcnt(3)
ds_read_b128 v[36:39], v0 offset:9216
v_smfmac_f32_16x16x64_bf16 v[12:15], v[40:43], a[120:127], v1
global_load_dwordx4 v[60:63], v0, s[58:59] offset:3072 nt sc1
v_smfmac_f32_16x16x64_bf16 v[8:11], v[40:43], a[112:119], v1
s_waitcnt lgkmcnt(2)
ds_read_b128 v[40:43], v0 offset:1024
v_smfmac_f32_16x16x64_bf16 v[12:15], v[44:47], v[80:87], v1
s_waitcnt lgkmcnt(2)
ds_read_b128 v[84:87], v2 offset:7168
v_smfmac_f32_16x16x64_bf16 v[8:11], v[44:47], a[128:135], v1
ds_read_b128 v[80:83], v2 offset:6144
s_waitcnt lgkmcnt(3)
v_smfmac_f32_16x16x64_bf16 v[12:15], v[32:35], a[144:151], v1
s_waitcnt vmcnt(5)
global_load_dword v7, v7, s[4:5] sc1
v_smfmac_f32_16x16x64_bf16 v[8:11], v[32:35], a[136:143], v1
s_mov_b64 s[68:69], s[72:73]
ds_read_b128 v[32:35], v0 offset:5120
s_waitcnt vmcnt(5)
v_smfmac_f32_16x16x64_bf16 v[8:11], v[36:39], v[64:71], v1
ds_read_b128 v[68:71], v2 offset:9216
s_waitcnt lgkmcnt(3)
ds_read_b128 v[64:67], v2 offset:8192
v_smfmac_f32_16x16x64_bf16 v[12:15], v[36:39], a[152:159], v1
s_waitcnt lgkmcnt(3)
ds_read_b128 v[36:39], v0 offset:2048
v_smfmac_f32_16x16x64_bf16 v[20:23], v[40:43], v[80:87], v1
ds_read_b128 v[84:87], v2 offset:11264
v_add_f32 v9, v9, v11
v_smfmac_f32_16x16x64_bf16 v[16:19], v[40:43], a[160:167], v1
s_waitcnt lgkmcnt(4)
ds_read_b128 v[40:43], v0 offset:6144
v_add_f32 v12, v12, v14
v_smfmac_f32_16x16x64_bf16 v[16:19], v[32:35], a[168:175], v1
s_waitcnt vmcnt(4)
ds_read_b128 v[80:83], v2 offset:10240
v_mul_f32 v12, s35, v12
v_add_f32 v13, v13, v15
v_mul_f32 v9, s35, v9
v_add_f32 v8, v8, v10
v_mul_f32 v8, s35, v8
v_smfmac_f32_16x16x64_bf16 v[20:23], v[32:35], a[176:183], v1
s_waitcnt lgkmcnt(3)
ds_read_b128 v[32:35], v0 offset:3072
v_cvt_pk_bf16_f32 v8, v8, v9
v_smfmac_f32_16x16x64_bf16 v[16:19], v[36:39], v[64:71], v1
s_add_u32 s34, s17, 2
ds_read_b128 v[64:67], v2 offset:12288
ds_read_b128 v[68:71], v2 offset:13312
v_mul_f32 v13, s35, v13
v_cvt_pk_bf16_f32 v12, v12, v13
v_smfmac_f32_16x16x64_bf16 v[20:23], v[36:39], a[184:191], v1
s_waitcnt lgkmcnt(4)
ds_read_b128 v[36:39], v0 offset:7168
s_waitcnt vmcnt(3)
ds_write2_b32 v3, v8, v12 offset0:0 offset1:128
v_smfmac_f32_16x16x64_bf16 v[16:19], v[40:43], v[72:79], v1
s_waitcnt lgkmcnt(4)
ds_read_b128 v[72:75], v2 offset:14336
v_smfmac_f32_16x16x64_bf16 v[20:23], v[40:43], v[80:87], v1
ds_read_b128 v[80:83], v2 offset:16384
v_smfmac_f32_16x16x64_bf16 v[20:23], v[32:35], a[200:207], v1
s_mov_b64 s[70:71], s[74:75]
ds_read_b128 v[40:43], v0 offset:8192
s_waitcnt lgkmcnt(5)
v_smfmac_f32_16x16x64_bf16 v[16:19], v[32:35], a[192:199], v1
ds_read_b128 v[76:79], v2 offset:15360
s_waitcnt lgkmcnt(5)
ds_read_b128 v[84:87], v2 offset:17408
v_smfmac_f32_16x16x64_bf16 v[16:19], v[36:39], v[64:71], v1
s_waitcnt lgkmcnt(5)
ds_read_b128 v[32:35], v0 offset:9216
s_barrier
ds_read_b64_tr_b16 v[10:11], v4 offset:512
v_smfmac_f32_16x16x64_bf16 v[20:23], v[36:39], a[208:215], v1
ds_read_b64_tr_b16 v[8:9], v4 offset:0
s_waitcnt lgkmcnt(5)
ds_read_b64_tr_b16 v[12:13], v4 offset:1024
v_smfmac_f32_16x16x64_bf16 v[20:23], v[40:43], a[216:223], v1
s_waitcnt lgkmcnt(5)
ds_read_b64_tr_b16 v[14:15], v4 offset:1536
s_mov_b64 vcc, s[42:43]
ds_read_b128 v[68:71], v2 offset:19456
v_smfmac_f32_16x16x64_bf16 v[16:19], v[40:43], v[72:79], v1
ds_read_b128 v[36:39], v0 offset:8192
s_waitcnt lgkmcnt(6)
v_smfmac_f32_16x16x64_bf16 v[20:23], v[32:35], v[80:87], v1
s_waitcnt lgkmcnt(5)
ds_read_b128 v[64:67], v2 offset:18432
ds_read_b128 v[40:43], v0 offset:9216
v_smfmac_f32_16x16x64_bf16 v[16:19], v[32:35], a[224:231], v1
s_waitcnt lgkmcnt(5)
ds_read_b128 v[72:75], v2 offset:20480
ds_read_b128 v[32:35], v0 offset:1024
v_mfma_f32_16x16x32_bf16 v[44:47], v[48:51], v[8:11], 0
s_waitcnt lgkmcnt(6)
ds_read_b128 v[76:79], v2 offset:21504
v_bfe_u32 v48, v0, 5, 1
v_add_f32 v21, v21, v23
v_add_f32 v17, v17, v19
v_mfma_f32_16x16x32_bf16 v[44:47], v[52:55], v[12:15], v[44:47]
s_waitcnt lgkmcnt(5)
ds_read_b128 v[80:83], v2 offset:22528
v_lshl_add_u32 v48, v48, 3, v5
v_add_f32 v16, v16, v18
v_cvt_pk_bf16_f32 v16, v16, v17
v_add_f32 v20, v20, v22
v_cvt_pk_bf16_f32 v20, v20, v21
v_smfmac_f32_16x16x64_bf16 v[28:31], v[36:39], a[232:239], v1
s_waitcnt lgkmcnt(4)
ds_write2_b32 v3, v16, v20 offset0:1 offset1:129
v_cndmask_b32_dpp v44, v46, v44, vcc quad_perm:[0,1,0,1] row_mask:0xf bank_mask:0xf
v_cndmask_b32_dpp v45, v47, v45, vcc quad_perm:[0,1,0,1] row_mask:0xf bank_mask:0xf
v_smfmac_f32_16x16x64_bf16 v[24:27], v[36:39], v[64:71], v1
ds_write_b64 v48, v[44:45] offset:6144
v_smfmac_f32_16x16x64_bf16 v[24:27], v[40:43], a[240:247], v1
s_waitcnt lgkmcnt(3)
global_load_dwordx4 v[64:67], v0, s[78:79] offset:0 sc1
ds_read_b128 v[84:87], v2 offset:23552
v_smfmac_f32_16x16x64_bf16 v[28:31], v[40:43], v[72:79], v1
s_waitcnt lgkmcnt(3)
ds_read_b128 v[36:39], v0 offset:5120
global_load_dwordx4 v[68:71], v0, s[78:79] offset:1024 sc1
v_smfmac_f32_16x16x64_bf16 v[24:27], v[32:35], a[248:255], v1
global_load_dwordx4 v[72:75], v0, s[78:79] offset:2048 sc1
ds_read_b128 v[40:43], v0 offset:2048
v_smfmac_f32_16x16x64_bf16 v[28:31], v[32:35], v[88:95], v1
s_waitcnt lgkmcnt(3)
ds_read_b128 v[32:35], v0 offset:6144
s_barrier
ds_read_b128 v[52:55], v6 offset:7168
s_waitcnt lgkmcnt(3)
v_smfmac_f32_16x16x64_bf16 v[28:31], v[36:39], v[96:103], v1
ds_read_b128 v[48:51], v6 offset:6144
ds_read_b64_tr_b16 v[8:9], v4 offset:0
v_smfmac_f32_16x16x64_bf16 v[24:27], v[36:39], v[80:87], v1
s_waitcnt lgkmcnt(4)
ds_read_b128 v[36:39], v0 offset:3072
global_load_dwordx4 v[76:79], v0, s[78:79] offset:3072 sc1
ds_read_b64_tr_b16 v[10:11], v4 offset:512
v_smfmac_f32_16x16x64_bf16 v[28:31], v[40:43], v[112:119], v1
s_waitcnt lgkmcnt(5)
ds_read_b64_tr_b16 v[14:15], v4 offset:1536
ds_read_b64_tr_b16 v[18:19], v4 offset:2560
v_smfmac_f32_16x16x64_bf16 v[24:27], v[40:43], v[104:111], v1
s_waitcnt lgkmcnt(6)
ds_read_b64_tr_b16 v[12:13], v4 offset:1024
ds_read_b64_tr_b16 v[16:17], v4 offset:2048
v_smfmac_f32_16x16x64_bf16 v[28:31], v[32:35], v[128:135], v1
s_waitcnt lgkmcnt(7)
ds_read_b64_tr_b16 v[22:23], v4 offset:3584
v_add_f32 v50, v50, v54
v_add_f32 v49, v49, v53
v_smfmac_f32_16x16x64_bf16 v[24:27], v[32:35], v[120:127], v1
s_waitcnt lgkmcnt(6)
ds_read_b128 v[40:43], v0 offset:7168
v_add_f32 v48, v48, v52
v_smfmac_f32_16x16x64_bf16 v[24:27], v[36:39], v[136:143], v1
s_waitcnt lgkmcnt(5)
ds_read_b64_tr_b16 v[20:21], v4 offset:3072
v_add_f32 v51, v51, v55
v_smfmac_f32_16x16x64_bf16 v[28:31], v[36:39], v[144:151], v1
s_waitcnt lgkmcnt(4)
global_load_dwordx4 v[80:83], v0, s[80:81] offset:-4096 sc1
v_exp_f32 v51, v51
v_mfma_f32_16x16x32_bf16 v[44:47], v[8:11], v[8:11], 0
s_waitcnt lgkmcnt(3)
v_exp_f32 v49, v49
v_mfma_f32_16x16x32_bf16 v[44:47], v[12:15], v[12:15], v[44:47]
s_waitcnt lgkmcnt(1)
v_exp_f32 v50, v50
v_exp_f32 v48, v48
v_mfma_f32_16x16x32_bf16 v[44:47], v[16:19], v[16:19], v[44:47]
s_waitcnt lgkmcnt(0)
v_cvt_pk_bf16_f32 v54, v48, v49
v_cvt_pk_bf16_f32 v55, v50, v51
v_mfma_f32_16x16x32_bf16 v[44:47], v[20:23], v[20:23], v[44:47]
s_nop 0
v_mov_b32_dpp v51, v55 quad_perm:[2,3,2,3] row_mask:0xf bank_mask:0xf
v_mov_b32_dpp v50, v54 quad_perm:[2,3,2,3] row_mask:0xf bank_mask:0xf
v_smfmac_f32_16x16x64_bf16 v[24:27], v[40:43], v[152:159], v1
v_mov_b32_dpp v49, v55 quad_perm:[0,1,0,1] row_mask:0xf bank_mask:0xf
v_mov_b64 v[22:23], s[44:45]
v_mov_b32_dpp v48, v54 quad_perm:[0,1,0,1] row_mask:0xf bank_mask:0xf
v_mov_b64 v[20:21], s[44:45]
v_smfmac_f32_16x16x64_bf16 v[28:31], v[40:43], v[160:167], v1
s_waitcnt vmcnt(7)
global_load_dwordx4 v[84:87], v0, s[80:81] offset:-3072 sc1
v_exp_f32_dpp v44, v46 quad_perm:[0,1,0,1] row_mask:0xf bank_mask:0xf
v_mfma_f32_16x16x32_bf16 v[8:11], v[56:59], v[48:51], 0
v_exp_f32_dpp v45, v47 quad_perm:[0,1,0,1] row_mask:0xf bank_mask:0xf
v_mfma_f32_16x16x32_bf16 v[16:19], v[20:23], v[48:51], 0
s_waitcnt vmcnt(7)
v_cvt_pk_bf16_f32 v52, v44, v45
v_mov_b64 v[54:55], s[46:47]
v_mfma_f32_16x16x32_bf16 v[12:15], v[60:63], v[48:51], 0
v_cvt_pk_bf16_f32 v53, v44, v45
v_cvt_pk_bf16_f32 v24, v24, v25
v_cvt_pk_bf16_f32 v25, v26, v27
v_mfma_f32_16x16x16_bf16 v[16:19], v[54:55], v[52:53], v[16:19]
s_min_u32 s34, s34, s32
v_cvt_pk_bf16_f32 v27, v30, v31
v_cvt_pk_bf16_f32 v26, v28, v29
v_mfma_f32_16x16x16_bf16 v[8:11], v[24:25], v[52:53], v[8:11]
ds_read_b128 v[28:31], v0 offset:19456
v_mov_b64 v[38:39], 0
v_mfma_f32_16x16x16_bf16 v[12:15], v[26:27], v[52:53], v[12:15]
s_waitcnt vmcnt(4)
v_mov_b64 v[36:37], 0
v_bfe_u32 v32, v0, 5, 1
v_rcp_f32 v18, v16
v_subrev_u32 v17, s37, v16
v_cmp_lt_u32 vcc, s38, v17
v_lshl_add_u32 v32, v32, 3, v5
v_mov_b64 v[42:43], 0
v_cndmask_b32 v11, v15, v11, s[42:43]
v_cndmask_b32 v8, v12, v8, s[42:43]
v_cndmask_b32 v10, v14, v10, s[42:43]
v_mul_f32 v11, v11, v18
v_mul_f32 v8, v8, v18
v_cndmask_b32 v9, v13, v9, s[42:43]
v_mul_f32 v9, v9, v18
v_mul_f32 v10, v10, v18
v_cvt_pk_bf16_f32 v12, v8, v9
v_cvt_pk_bf16_f32 v13, v10, v11
s_cbranch_vccnz rare_10011
back_10012:
ds_write_b64 v32, v[12:13] offset:0
v_mov_b32_dpp v11, v13 quad_perm:[2,3,2,3] row_mask:0xf bank_mask:0xf
v_mov_b32_dpp v9, v13 quad_perm:[0,1,0,1] row_mask:0xf bank_mask:0xf
v_mov_b32_dpp v8, v12 quad_perm:[0,1,0,1] row_mask:0xf bank_mask:0xf
v_mov_b32_dpp v10, v12 quad_perm:[2,3,2,3] row_mask:0xf bank_mask:0xf
v_mov_b64 v[52:53], 0
v_mov_b64 v[34:35], 0
v_smfmac_f32_16x16x64_bf16 v[36:39], v[8:11], v[64:71], v1
s_waitcnt vmcnt(2)
global_load_dwordx4 v[64:67], v0, s[76:77] offset:-4096 sc1
ds_read_b128 v[20:23], v0 offset:17408
ds_read_b128 v[24:27], v0 offset:18432
v_mov_b64 v[54:55], 0
v_mov_b64 v[32:33], 0
v_mov_b64 v[40:41], 0
v_smfmac_f32_16x16x64_bf16 v[52:55], v[8:11], v[176:183], v1
s_waitcnt lgkmcnt(2)
ds_read_b128 v[16:19], v0 offset:16384
s_barrier
ds_read_b128 v[56:59], v5 offset:512
global_load_dwordx4 v[68:71], v0, s[76:77] offset:-3072 sc1
ds_read_b128 v[60:63], v5 offset:1024
v_smfmac_f32_16x16x64_bf16 v[40:43], v[8:11], v[72:79], v1
s_waitcnt vmcnt(2)
ds_read_b128 v[12:15], v5 offset:1536
v_mov_b64 v[50:51], 0
v_mov_b64 v[48:49], 0
v_smfmac_f32_16x16x64_bf16 v[32:35], v[8:11], v[80:87], v1
global_load_dwordx4 v[72:75], v0, s[76:77] offset:-2048 sc1
ds_read_b128 v[80:83], v0 offset:20480
v_smfmac_f32_16x16x64_bf16 v[48:51], v[8:11], v[168:175], v1
s_waitcnt lgkmcnt(3)
ds_read_b128 v[84:87], v0 offset:21504
v_smfmac_f32_16x16x64_bf16 v[40:43], v[56:59], v[192:199], v1
global_load_dwordx4 v[76:79], v0, s[76:77] offset:-1024 sc1
v_smfmac_f32_16x16x64_bf16 v[36:39], v[56:59], v[16:23], v1
s_waitcnt lgkmcnt(3)
ds_read_b128 v[16:19], v0 offset:22528
v_lshrrev_b32 v44, 8, v0
v_smfmac_f32_16x16x64_bf16 v[36:39], v[60:63], v[24:31], v1
s_waitcnt lgkmcnt(3)
ds_read_b128 v[20:23], v0 offset:23552
v_bfe_u32 v45, v0, 1, 7
v_smfmac_f32_16x16x64_bf16 v[36:39], v[12:15], v[184:191], v1
ds_read_b128 v[28:31], v0 offset:25600
s_waitcnt lgkmcnt(3)
v_smfmac_f32_16x16x64_bf16 v[40:43], v[60:63], v[80:87], v1
ds_read_b128 v[24:27], v0 offset:24576
v_lshl_or_b32 v44, v44, 12, v45
v_smfmac_f32_16x16x64_bf16 v[40:43], v[12:15], v[200:207], v1
s_nop 0
ds_read_b128 v[80:83], v0 offset:26624
v_cvt_pk_bf16_f32 v36, v36, v37
v_smfmac_f32_16x16x64_bf16 v[32:35], v[56:59], v[232:239], v1
ds_read_b128 v[84:87], v0 offset:27648
v_and_or_b32 v36, v36, -2, s18
v_cvt_pk_bf16_f32 v37, v38, v39
v_smfmac_f32_16x16x64_bf16 v[52:55], v[56:59], v[216:223], v1
s_waitcnt lgkmcnt(4)
global_store_dwordx2 v44, v[36:37], s[48:49]
s_waitcnt lgkmcnt(3)
v_cvt_pk_bf16_f32 v40, v40, v41
v_cvt_pk_bf16_f32 v41, v42, v43
v_smfmac_f32_16x16x64_bf16 v[48:51], v[56:59], v[16:23], v1
s_waitcnt lgkmcnt(2)
s_add_u32 s27, s20, 524288
v_and_or_b32 v40, v40, -2, s18
v_smfmac_f32_16x16x64_bf16 v[48:51], v[60:63], v[24:31], v1
global_store_dwordx2 v44, v[40:41], s[50:51]
s_waitcnt lgkmcnt(0)
v_smfmac_f32_16x16x64_bf16 v[48:51], v[12:15], v[208:215], v1
s_add_u32 s58, s4, s20
v_smfmac_f32_16x16x64_bf16 v[32:35], v[60:63], v[240:247], v1
s_nop 2
v_smfmac_f32_16x16x64_bf16 v[52:55], v[60:63], v[80:87], v1
s_nop 1
v_cvt_pk_bf16_f32 v48, v48, v49
v_and_or_b32 v48, v48, -2, s18
v_cvt_pk_bf16_f32 v49, v50, v51
v_smfmac_f32_16x16x64_bf16 v[52:55], v[12:15], v[224:231], v1
s_nop 0
global_store_dwordx2 v44, v[48:49], s[52:53]
s_addc_u32 s59, s5, 0
s_mov_b32 s30, 0
v_smfmac_f32_16x16x64_bf16 v[32:35], v[12:15], v[248:255], v1
s_nop 2
v_cvt_pk_bf16_f32 v52, v52, v53
v_cvt_pk_bf16_f32 v53, v54, v55
s_mov_b32 s19, 1
v_and_or_b32 v52, v52, -2, s18
global_store_dwordx2 v44, v[52:53], s[54:55]
v_cvt_pk_bf16_f32 v32, v32, v33
v_cvt_pk_bf16_f32 v33, v34, v35
v_and_or_b32 v32, v32, -2, s18
global_store_dwordx2 v44, v[32:33], s[56:57]
v_bfe_u32 v32, v0, 6, 1
v_lshlrev_b32 v32, 4, v32
v_mov_b32 v33, 0x3f80
v_lshlrev_b32 v32, v32, v33
v_bfe_i32 v33, v0, 4, 1
v_and_b32 v45, v32, v33
v_and_b32 v47, v32, v33
v_xor_b32 v44, v32, v45
v_xor_b32 v46, v32, v45
v_and_b32 v36, 32, v0
v_bfe_u32 v37, v0, 6, 1
v_lshl_add_u32 v36, v37, 8, v36
v_bfe_u32 v37, v0, 8, 1
v_lshl_add_u32 v36, v37, 4, v36
v_bfe_u32 v37, v0, 4, 1
v_lshl_add_u32 v36, v37, 3, v36
v_and_b32 v7, 255, v0
v_lshl_add_u32 v7, v7, 3, s27
s_nop 15
s_nop 15
s_nop 15
s_nop 8
global_load_dwordx4 v[8:11], v0, s[64:65] offset:0 sc1
global_load_dwordx4 v[12:15], v0, s[64:65] offset:1024 sc1
global_load_dwordx4 v[16:19], v0, s[64:65] offset:2048 sc1
global_load_dwordx4 v[20:23], v0, s[64:65] offset:3072 sc1
chk_10023:
v_mov_b64 v[40:41], 0
v_mov_b64 v[42:43], 0
s_waitcnt vmcnt(2)
s_nop 0
v_smfmac_f32_16x16x64_bf16 v[40:43], v[44:47], v[8:15], v1
v_bitop3_b32 v32, v8, v10, s18 bitop3:0x7e
v_bitop3_b32 v33, v12, v14, s18 bitop3:0x7e
s_waitcnt vmcnt(0)
v_smfmac_f32_16x16x64_bf16 v[40:43], v[44:47], v[16:23], v1
v_bitop3_b32 v34, v16, v18, s18 bitop3:0x7e
v_bitop3_b32 v35, v20, v22, s18 bitop3:0x7e
v_or3_b32 v32, v32, v33, v34
v_bitop3_b32 v32, v32, v35, 1 bitop3:0xa8
v_cmp_ne_u32 vcc, 0, v32
s_cbranch_vccnz chk_10023_f
s_nop 1
v_add_f32_dpp v40, v40, v40 row_ror:8 row_mask:0xf bank_mask:0xf
v_add_f32_dpp v41, v41, v41 row_ror:8 row_mask:0xf bank_mask:0xf
v_add_f32_dpp v42, v42, v42 row_ror:8 row_mask:0xf bank_mask:0xf
v_add_f32_dpp v43, v43, v43 row_ror:8 row_mask:0xf bank_mask:0xf
v_cvt_pk_bf16_f32 v40, v40, v41
v_cvt_pk_bf16_f32 v41, v42, v43
v_and_or_b32 v40, v40, -2, s18
s_mov_b64 exec, 0x00ff00ff
global_store_dwordx2 v36, v[40:41], s[66:67]
s_mov_b64 exec, -1
s_branch join_10022
chk_10023_f:
global_load_dwordx4 v[8:11], v0, s[64:65] offset:0 sc1
global_load_dwordx4 v[12:15], v0, s[64:65] offset:1024 sc1
global_load_dwordx4 v[16:19], v0, s[64:65] offset:2048 sc1
global_load_dwordx4 v[20:23], v0, s[64:65] offset:3072 sc1
s_add_u32 s30, s30, 1
s_cmp_le_u32 s30, 262144
s_cbranch_scc1 chk_10023
s_branch L_fail
nored_10021:
join_10022:
s_nop 11
s_barrier
global_load_dwordx4 v[56:59], v0, s[76:77] offset:0 sc1
global_load_dwordx4 v[60:63], v0, s[76:77] offset:1024 sc1
global_load_dwordx4 v[80:83], v0, s[76:77] offset:2048 sc1
global_load_dwordx4 v[84:87], v0, s[76:77] offset:3072 sc1
s_nop 15
s_nop 15
s_nop 3
s_barrier
global_load_dwordx4 v[32:35], v0, s[68:69] offset:-4096 sc1
s_nop 10
global_load_dwordx4 v[36:39], v0, s[68:69] offset:0 sc1
s_nop 10
global_load_dwordx4 v[40:43], v0, s[70:71] offset:0 sc1
s_barrier
global_load_dwordx4 v[48:51], v0, s[58:59] offset:0 nt sc1
global_load_dwordx4 v[52:55], v0, s[58:59] offset:1024 nt sc1
v_mov_b64 v[8:9], 0
v_mov_b64 v[10:11], 0
v_mov_b64 v[12:13], 0
v_mov_b64 v[14:15], 0
v_mov_b64 v[16:17], 0
v_mov_b64 v[18:19], 0
v_mov_b64 v[20:21], 0
v_mov_b64 v[22:23], 0
v_mov_b64 v[24:25], 0
v_mov_b64 v[26:27], 0
v_mov_b64 v[28:29], 0
v_mov_b64 v[30:31], 0
s_mov_b32 s30, 0
s_cmp_eq_u32 s17, s31
s_cbranch_scc0 gather_10010
s_branch exit_10013
rt_10015:
global_load_dwordx4 v[32:35], v0, s[68:69] offset:-4096 sc1
global_load_dwordx4 v[36:39], v0, s[68:69] offset:0 sc1
global_load_dwordx4 v[40:43], v0, s[70:71] offset:0 sc1
s_add_u32 s30, s30, 1
s_cmp_gt_u32 s30, 262144
s_cbranch_scc1 L_fail
s_mov_b64 exec, 1
global_store_dword v0, v0, s[62:63]
global_store_dword v0, v0, s[62:63]
s_mov_b64 exec, -1
v_mov_b64 v[8:9], 0
v_mov_b64 v[10:11], 0
v_mov_b64 v[12:13], 0
v_mov_b64 v[14:15], 0
v_mov_b64 v[16:17], 0
v_mov_b64 v[18:19], 0
v_mov_b64 v[20:21], 0
v_mov_b64 v[22:23], 0
v_mov_b64 v[24:25], 0
v_mov_b64 v[26:27], 0
v_mov_b64 v[28:29], 0
v_mov_b64 v[30:31], 0
s_branch gather_10010
rare_10011:
ds_read_b128 v[48:51], v6 offset:6144
ds_read_b128 v[52:55], v6 offset:7168
s_waitcnt lgkmcnt(0)
v_add_f32 v48, v48, v52
v_add_f32 v49, v49, v53
v_add_f32 v50, v50, v54
v_add_f32 v51, v51, v55
v_mov_b32_dpp v46, v46 quad_perm:[0,1,0,1] row_mask:0xf bank_mask:0xf
v_mov_b32_dpp v47, v47 quad_perm:[0,1,0,1] row_mask:0xf bank_mask:0xf
v_max3_f32 v19, v48, v49, v50
v_max3_f32 v19, v19, v51, v46
v_max_f32 v19, v19, v47
s_nop 1
v_max_f32_dpp v19, v19, v19 quad_perm:[2,3,0,1] row_mask:0xf bank_mask:0xf
v_mov_b32 v44, v19
s_nop 1
v_permlane32_swap_b32 v19, v44
v_max_f32 v19, v19, v44
v_mov_b32 v44, v19
s_nop 1
v_permlane16_swap_b32 v19, v44
v_max_f32 v19, v19, v44
v_sub_f32 v48, v48, v19
v_sub_f32 v49, v49, v19
v_sub_f32 v50, v50, v19
v_sub_f32 v51, v51, v19
v_sub_f32 v46, v46, v19
v_sub_f32 v47, v47, v19
v_exp_f32 v48, v48
v_exp_f32 v49, v49
v_exp_f32 v50, v50
v_exp_f32 v51, v51
v_cvt_pk_bf16_f32 v54, v48, v49
v_cvt_pk_bf16_f32 v55, v50, v51
s_nop 0
v_mov_b32_dpp v48, v54 quad_perm:[0,1,0,1] row_mask:0xf bank_mask:0xf
v_mov_b32_dpp v49, v55 quad_perm:[0,1,0,1] row_mask:0xf bank_mask:0xf
v_mov_b32_dpp v50, v54 quad_perm:[2,3,2,3] row_mask:0xf bank_mask:0xf
v_mov_b32_dpp v51, v55 quad_perm:[2,3,2,3] row_mask:0xf bank_mask:0xf
v_mov_b64 v[20:21], s[44:45]
v_mov_b64 v[22:23], s[44:45]
v_mfma_f32_16x16x32_bf16 v[8:11], v[56:59], v[48:51], 0
v_mfma_f32_16x16x32_bf16 v[12:15], v[60:63], v[48:51], 0
v_mfma_f32_16x16x32_bf16 v[16:19], v[20:23], v[48:51], 0
v_mov_b64 v[54:55], s[46:47]
v_exp_f32_dpp v44, v46 quad_perm:[0,1,0,1] row_mask:0xf bank_mask:0xf
v_exp_f32_dpp v45, v47 quad_perm:[0,1,0,1] row_mask:0xf bank_mask:0xf
s_nop 0
v_cvt_pk_bf16_f32 v52, v44, v45
v_cvt_pk_bf16_f32 v53, v44, v45
s_nop 1
v_mfma_f32_16x16x16_bf16 v[16:19], v[54:55], v[52:53], v[16:19]
v_mfma_f32_16x16x16_bf16 v[8:11], v[24:25], v[52:53], v[8:11]
v_mfma_f32_16x16x16_bf16 v[12:15], v[26:27], v[52:53], v[12:15]
s_nop 5
v_rcp_f32 v18, v16
s_nop 0
v_cndmask_b32 v8, v12, v8, s[42:43]
v_mul_f32 v8, v8, v18
v_cndmask_b32 v9, v13, v9, s[42:43]
v_mul_f32 v9, v9, v18
v_cndmask_b32 v10, v14, v10, s[42:43]
v_mul_f32 v10, v10, v18
v_cndmask_b32 v11, v15, v11, s[42:43]
v_mul_f32 v11, v11, v18
v_cvt_pk_bf16_f32 v12, v8, v9
v_cvt_pk_bf16_f32 v13, v10, v11
s_branch back_10012
exit_10013:
global_load_dwordx4 v[32:35], v0, s[68:69] offset:-4096 sc1
global_load_dwordx4 v[36:39], v0, s[68:69] offset:0 sc1
global_load_dwordx4 v[40:43], v0, s[70:71] offset:0 sc1
s_add_u32 s30, s30, 1
s_cmp_gt_u32 s30, 262144
s_cbranch_scc1 L_fail
s_waitcnt vmcnt(2)
v_bitop3_b32 v44, v32, v34, s18 bitop3:0x7e
s_waitcnt vmcnt(1)
v_bitop3_b32 v45, v36, v38, s18 bitop3:0x7e
v_or_b32 v44, v44, v45
s_waitcnt vmcnt(0)
v_bitop3_b32 v46, v40, v42, s18 bitop3:0x7e
v_bitop3_b32 v44, v44, v46, s19 bitop3:0xa8
v_cmp_ne_u32 vcc, 0, v44
s_cbranch_vccnz exit_10013
s_add_u32 s36, s36, 1
s_cmp_lt_u32 s36, 2
s_cbranch_scc1 layer_10009
s_endpgm
wave_10006:
layer_10024:
s_lshl_b32 s17, s36, 6
s_mul_i32 s27, s36, 35651584
s_mul_i32 s28, s14, 16384
s_add_u32 s27, s27, s28
s_add_u32 s20, s27, 16781312
s_mul_i32 s27, s17, 10240
s_add_u32 s27, s27, s24
s_add_u32 s21, s27, s25
s_mov_b32 s19, 0
s_mov_b32 s33, s6
s_add_u32 s34, s17, 1
s_add_u32 s31, s17, 63
s_add_u32 s32, s17, 64
s_mov_b32 s27, s20
v_mov_b32 v7, 0
s_add_u32 s68, s4, 414720
s_addc_u32 s69, s5, 0
s_add_u32 s72, s4, 398336
s_addc_u32 s73, s5, 0
s_add_u32 s70, s4, 418816
s_addc_u32 s71, s5, 0
s_add_u32 s74, s4, 402432
s_addc_u32 s75, s5, 0
s_add_u32 s58, s4, s20
s_addc_u32 s59, s5, 0
global_load_dwordx4 v[64:67], v0, s[76:77] offset:-4096 sc1
global_load_dwordx4 v[68:71], v0, s[76:77] offset:-3072 sc1
global_load_dwordx4 v[72:75], v0, s[76:77] offset:-2048 sc1
global_load_dwordx4 v[76:79], v0, s[76:77] offset:-1024 sc1
global_load_dwordx4 v[80:83], v0, s[76:77] offset:2048 sc1
global_load_dwordx4 v[84:87], v0, s[76:77] offset:3072 sc1
global_load_dwordx4 v[56:59], v0, s[76:77] offset:0 sc1
global_load_dwordx4 v[60:63], v0, s[76:77] offset:1024 sc1
v_mov_b64 v[8:9], 0
v_mov_b64 v[10:11], 0
v_mov_b64 v[12:13], 0
v_mov_b64 v[14:15], 0
v_mov_b64 v[16:17], 0
v_mov_b64 v[18:19], 0
v_mov_b64 v[20:21], 0
v_mov_b64 v[22:23], 0
v_mov_b64 v[24:25], 0
v_mov_b64 v[26:27], 0
v_mov_b64 v[28:29], 0
v_mov_b64 v[30:31], 0
s_barrier
global_load_dwordx4 v[48:51], v0, s[58:59] offset:0 nt sc1
global_load_dwordx4 v[52:55], v0, s[58:59] offset:1024 nt sc1
v_and_b32 v7, 255, v0
v_lshl_add_u32 v7, v7, 3, s27
global_load_dwordx4 v[32:35], v0, s[68:69] offset:-4096 sc1
global_load_dwordx4 v[36:39], v0, s[68:69] offset:0 sc1
global_load_dwordx4 v[40:43], v0, s[70:71] offset:0 sc1
s_mov_b32 s30, 0
s_waitcnt vmcnt(0)
.p2align 6
gather_10025:
s_waitcnt vmcnt(4)
rt_10030_b:
v_smfmac_f32_16x16x64_bf16 v[24:27], v[32:35], a[0:7], v1
ds_write_b128 v0, v[32:35] offset:1024
v_smfmac_f32_16x16x64_bf16 v[8:11], v[32:35], v[64:71], v1
v_bitop3_b32 v44, v32, v34, s18 bitop3:0x7e
v_smfmac_f32_16x16x64_bf16 v[12:15], v[32:35], v[72:79], v1
s_waitcnt vmcnt(3)
ds_write_b128 v0, v[36:39] offset:5120
v_bitop3_b32 v45, v36, v38, s18 bitop3:0x7e
v_or_b32 v44, v44, v45
s_waitcnt vmcnt(2)
v_bitop3_b32 v45, v40, v42, s18 bitop3:0x7e
v_bitop3_b32 v44, v44, v45, s19 bitop3:0xa8
v_cmp_ne_u32 vcc, 0, v44
v_smfmac_f32_16x16x64_bf16 v[8:11], v[36:39], a[16:23], v1
ds_write_b128 v0, v[40:43] offset:9216
v_smfmac_f32_16x16x64_bf16 v[20:23], v[32:35], v[80:87], v1
s_cbranch_vccnz rt_10030
global_load_dwordx4 v[64:67], v0, s[78:79] offset:-4096 sc1
ds_read_b128 v[80:83], v2 offset:0
v_smfmac_f32_16x16x64_bf16 v[28:31], v[32:35], a[8:15], v1
global_load_dwordx4 v[68:71], v0, s[78:79] offset:-3072 sc1
ds_read_b128 v[84:87], v2 offset:1024
v_smfmac_f32_16x16x64_bf16 v[20:23], v[36:39], a[40:47], v1
s_waitcnt lgkmcnt(2)
global_load_dwordx4 v[72:75], v0, s[78:79] offset:-2048 sc1
global_load_dwordx4 v[76:79], v0, s[78:79] offset:-1024 sc1
v_smfmac_f32_16x16x64_bf16 v[16:19], v[32:35], v[56:63], v1
s_barrier
ds_read_b128 v[40:43], v0 offset:0
v_smfmac_f32_16x16x64_bf16 v[16:19], v[36:39], a[32:39], v1
s_waitcnt lgkmcnt(1)
ds_read_b128 v[44:47], v0 offset:4096
v_smfmac_f32_16x16x64_bf16 v[28:31], v[36:39], v[80:87], v1
s_xor_b32 s18, s18, 1
ds_read_b128 v[32:35], v0 offset:3072
v_smfmac_f32_16x16x64_bf16 v[24:27], v[36:39], a[48:55], v1
s_add_u32 s20, s20, 524288
ds_read_b128 v[84:87], v2 offset:3072
v_smfmac_f32_16x16x64_bf16 v[12:15], v[36:39], a[24:31], v1
ds_read_b128 v[80:83], v2 offset:2048
s_waitcnt lgkmcnt(4)
v_smfmac_f32_16x16x64_bf16 v[12:15], v[40:43], a[64:71], v1
ds_read_b128 v[36:39], v0 offset:7168
v_smfmac_f32_16x16x64_bf16 v[8:11], v[40:43], a[56:63], v1
s_waitcnt lgkmcnt(4)
ds_read_b128 v[40:43], v0 offset:2048
s_waitcnt lgkmcnt(4)
v_smfmac_f32_16x16x64_bf16 v[12:15], v[44:47], a[80:87], v1
s_add_u32 s17, s17, 1
global_load_dwordx4 v[56:59], v0, s[58:59] offset:2048 nt sc1
v_smfmac_f32_16x16x64_bf16 v[8:11], v[44:47], a[72:79], v1
s_waitcnt lgkmcnt(3)
ds_read_b128 v[44:47], v0 offset:6144
s_waitcnt lgkmcnt(3)
v_smfmac_f32_16x16x64_bf16 v[12:15], v[32:35], v[80:87], v1
ds_read_b128 v[80:83], v2 offset:4096
v_smfmac_f32_16x16x64_bf16 v[8:11], v[32:35], a[88:95], v1
s_waitcnt lgkmcnt(3)
ds_read_b128 v[84:87], v2 offset:5120
s_add_u32 s21, s21, 10240
v_smfmac_f32_16x16x64_bf16 v[12:15], v[36:39], a[104:111], v1
ds_read_b128 v[32:35], v0 offset:9216
v_smfmac_f32_16x16x64_bf16 v[8:11], v[36:39], a[96:103], v1
s_waitcnt lgkmcnt(4)
s_waitcnt lgkmcnt(3)
ds_read_b128 v[36:39], v0 offset:8192
v_smfmac_f32_16x16x64_bf16 v[12:15], v[40:43], a[120:127], v1
global_load_dwordx4 v[60:63], v0, s[58:59] offset:3072 nt sc1
v_smfmac_f32_16x16x64_bf16 v[8:11], v[40:43], a[112:119], v1
s_waitcnt lgkmcnt(2)
ds_read_b128 v[40:43], v0 offset:0
v_smfmac_f32_16x16x64_bf16 v[12:15], v[44:47], v[80:87], v1
s_waitcnt lgkmcnt(2)
ds_read_b128 v[84:87], v2 offset:7168
v_smfmac_f32_16x16x64_bf16 v[8:11], v[44:47], a[128:135], v1
ds_read_b128 v[80:83], v2 offset:6144
s_waitcnt lgkmcnt(3)
v_smfmac_f32_16x16x64_bf16 v[12:15], v[32:35], a[144:151], v1
s_waitcnt vmcnt(5)
global_load_dword v7, v7, s[4:5] sc1
v_smfmac_f32_16x16x64_bf16 v[8:11], v[32:35], a[136:143], v1
s_mov_b64 s[68:69], s[72:73]
ds_read_b128 v[32:35], v0 offset:4096
s_waitcnt vmcnt(5)
v_smfmac_f32_16x16x64_bf16 v[8:11], v[36:39], v[64:71], v1
ds_read_b128 v[68:71], v2 offset:9216
s_waitcnt lgkmcnt(3)
ds_read_b128 v[64:67], v2 offset:8192
v_smfmac_f32_16x16x64_bf16 v[12:15], v[36:39], a[152:159], v1
s_waitcnt lgkmcnt(3)
ds_read_b128 v[36:39], v0 offset:3072
v_smfmac_f32_16x16x64_bf16 v[20:23], v[40:43], v[80:87], v1
ds_read_b128 v[84:87], v2 offset:11264
v_add_f32 v9, v9, v11
v_smfmac_f32_16x16x64_bf16 v[16:19], v[40:43], a[160:167], v1
s_waitcnt lgkmcnt(4)
ds_read_b128 v[40:43], v0 offset:7168
v_add_f32 v12, v12, v14
v_smfmac_f32_16x16x64_bf16 v[16:19], v[32:35], a[168:175], v1
s_waitcnt vmcnt(4)
ds_read_b128 v[80:83], v2 offset:10240
v_mul_f32 v12, s35, v12
v_add_f32 v13, v13, v15
v_mul_f32 v9, s35, v9
v_add_f32 v8, v8, v10
v_mul_f32 v8, s35, v8
v_smfmac_f32_16x16x64_bf16 v[20:23], v[32:35], a[176:183], v1
s_waitcnt lgkmcnt(3)
ds_read_b128 v[32:35], v0 offset:2048
v_cvt_pk_bf16_f32 v8, v8, v9
v_smfmac_f32_16x16x64_bf16 v[16:19], v[36:39], v[64:71], v1
s_add_u32 s34, s17, 2
ds_read_b128 v[64:67], v2 offset:12288
ds_read_b128 v[68:71], v2 offset:13312
v_mul_f32 v13, s35, v13
v_cvt_pk_bf16_f32 v12, v12, v13
v_smfmac_f32_16x16x64_bf16 v[20:23], v[36:39], a[184:191], v1
s_waitcnt lgkmcnt(4)
ds_read_b128 v[36:39], v0 offset:6144
s_waitcnt vmcnt(3)
ds_write2_b32 v3, v8, v12 offset0:0 offset1:128
v_smfmac_f32_16x16x64_bf16 v[16:19], v[40:43], v[72:79], v1
s_waitcnt lgkmcnt(4)
ds_read_b128 v[72:75], v2 offset:14336
v_smfmac_f32_16x16x64_bf16 v[20:23], v[40:43], v[80:87], v1
ds_read_b128 v[80:83], v2 offset:16384
v_smfmac_f32_16x16x64_bf16 v[20:23], v[32:35], a[200:207], v1
s_mov_b64 s[70:71], s[74:75]
ds_read_b128 v[40:43], v0 offset:9216
s_waitcnt lgkmcnt(5)
v_smfmac_f32_16x16x64_bf16 v[16:19], v[32:35], a[192:199], v1
ds_read_b128 v[76:79], v2 offset:15360
s_waitcnt lgkmcnt(5)
ds_read_b128 v[84:87], v2 offset:17408
v_smfmac_f32_16x16x64_bf16 v[16:19], v[36:39], v[64:71], v1
s_waitcnt lgkmcnt(5)
ds_read_b128 v[32:35], v0 offset:8192
s_barrier
ds_read_b64_tr_b16 v[10:11], v4 offset:512
v_smfmac_f32_16x16x64_bf16 v[20:23], v[36:39], a[208:215], v1
ds_read_b64_tr_b16 v[8:9], v4 offset:0
s_waitcnt lgkmcnt(5)
ds_read_b64_tr_b16 v[12:13], v4 offset:1024
v_smfmac_f32_16x16x64_bf16 v[20:23], v[40:43], a[216:223], v1
s_waitcnt lgkmcnt(5)
ds_read_b64_tr_b16 v[14:15], v4 offset:1536
s_mov_b64 vcc, s[42:43]
ds_read_b128 v[68:71], v2 offset:19456
v_smfmac_f32_16x16x64_bf16 v[16:19], v[40:43], v[72:79], v1
ds_read_b128 v[36:39], v0 offset:9216
s_waitcnt lgkmcnt(6)
v_smfmac_f32_16x16x64_bf16 v[20:23], v[32:35], v[80:87], v1
s_waitcnt lgkmcnt(5)
ds_read_b128 v[64:67], v2 offset:18432
ds_read_b128 v[40:43], v0 offset:8192
v_smfmac_f32_16x16x64_bf16 v[16:19], v[32:35], a[224:231], v1
s_waitcnt lgkmcnt(5)
ds_read_b128 v[72:75], v2 offset:20480
ds_read_b128 v[32:35], v0 offset:0
v_mfma_f32_16x16x32_bf16 v[44:47], v[48:51], v[8:11], 0
s_waitcnt lgkmcnt(6)
ds_read_b128 v[76:79], v2 offset:21504
v_bfe_u32 v48, v0, 5, 1
v_add_f32 v21, v21, v23
v_add_f32 v17, v17, v19
v_mfma_f32_16x16x32_bf16 v[44:47], v[52:55], v[12:15], v[44:47]
s_waitcnt lgkmcnt(5)
ds_read_b128 v[80:83], v2 offset:22528
v_lshl_add_u32 v48, v48, 3, v5
v_add_f32 v16, v16, v18
v_cvt_pk_bf16_f32 v16, v16, v17
v_add_f32 v20, v20, v22
v_cvt_pk_bf16_f32 v20, v20, v21
v_smfmac_f32_16x16x64_bf16 v[28:31], v[36:39], a[232:239], v1
s_waitcnt lgkmcnt(4)
ds_write2_b32 v3, v16, v20 offset0:1 offset1:129
v_cndmask_b32_dpp v44, v46, v44, vcc quad_perm:[0,1,0,1] row_mask:0xf bank_mask:0xf
v_xor_b32 v48, 128, v48
v_cndmask_b32_dpp v45, v47, v45, vcc quad_perm:[0,1,0,1] row_mask:0xf bank_mask:0xf
v_smfmac_f32_16x16x64_bf16 v[24:27], v[36:39], v[64:71], v1
ds_write_b64 v48, v[44:45] offset:6656
v_smfmac_f32_16x16x64_bf16 v[24:27], v[40:43], a[240:247], v1
s_waitcnt lgkmcnt(3)
global_load_dwordx4 v[64:67], v0, s[78:79] offset:0 sc1
ds_read_b128 v[84:87], v2 offset:23552
v_smfmac_f32_16x16x64_bf16 v[28:31], v[40:43], v[72:79], v1
s_waitcnt lgkmcnt(3)
ds_read_b128 v[36:39], v0 offset:4096
global_load_dwordx4 v[68:71], v0, s[78:79] offset:1024 sc1
v_smfmac_f32_16x16x64_bf16 v[24:27], v[32:35], a[248:255], v1
global_load_dwordx4 v[72:75], v0, s[78:79] offset:2048 sc1
ds_read_b128 v[40:43], v0 offset:3072
v_smfmac_f32_16x16x64_bf16 v[28:31], v[32:35], v[88:95], v1
s_waitcnt lgkmcnt(3)
ds_read_b128 v[32:35], v0 offset:7168
s_barrier
ds_read_b128 v[52:55], v6 offset:7168
s_waitcnt lgkmcnt(3)
v_smfmac_f32_16x16x64_bf16 v[28:31], v[36:39], v[96:103], v1
ds_read_b128 v[48:51], v6 offset:6144
ds_read_b64_tr_b16 v[8:9], v4 offset:0
v_smfmac_f32_16x16x64_bf16 v[24:27], v[36:39], v[80:87], v1
s_waitcnt lgkmcnt(4)
ds_read_b128 v[36:39], v0 offset:2048
global_load_dwordx4 v[76:79], v0, s[78:79] offset:3072 sc1
ds_read_b64_tr_b16 v[10:11], v4 offset:512
v_smfmac_f32_16x16x64_bf16 v[28:31], v[40:43], v[112:119], v1
s_waitcnt lgkmcnt(5)
ds_read_b64_tr_b16 v[14:15], v4 offset:1536
ds_read_b64_tr_b16 v[18:19], v4 offset:2560
v_smfmac_f32_16x16x64_bf16 v[24:27], v[40:43], v[104:111], v1
s_waitcnt lgkmcnt(6)
ds_read_b64_tr_b16 v[12:13], v4 offset:1024
ds_read_b64_tr_b16 v[16:17], v4 offset:2048
v_smfmac_f32_16x16x64_bf16 v[28:31], v[32:35], v[128:135], v1
s_waitcnt lgkmcnt(7)
ds_read_b64_tr_b16 v[22:23], v4 offset:3584
v_add_f32 v50, v50, v54
v_add_f32 v49, v49, v53
v_smfmac_f32_16x16x64_bf16 v[24:27], v[32:35], v[120:127], v1
s_waitcnt lgkmcnt(6)
ds_read_b128 v[40:43], v0 offset:6144
v_add_f32 v48, v48, v52
v_smfmac_f32_16x16x64_bf16 v[24:27], v[36:39], v[136:143], v1
s_waitcnt lgkmcnt(5)
ds_read_b64_tr_b16 v[20:21], v4 offset:3072
v_add_f32 v51, v51, v55
v_smfmac_f32_16x16x64_bf16 v[28:31], v[36:39], v[144:151], v1
s_waitcnt lgkmcnt(4)
global_load_dwordx4 v[80:83], v0, s[80:81] offset:-4096 sc1
v_exp_f32 v51, v51
v_mfma_f32_16x16x32_bf16 v[44:47], v[8:11], v[8:11], 0
s_waitcnt lgkmcnt(3)
v_exp_f32 v49, v49
v_mfma_f32_16x16x32_bf16 v[44:47], v[12:15], v[12:15], v[44:47]
s_waitcnt lgkmcnt(1)
v_exp_f32 v50, v50
v_exp_f32 v48, v48
v_mfma_f32_16x16x32_bf16 v[44:47], v[16:19], v[16:19], v[44:47]
s_waitcnt lgkmcnt(0)
v_cvt_pk_bf16_f32 v54, v48, v49
v_cvt_pk_bf16_f32 v55, v50, v51
v_mfma_f32_16x16x32_bf16 v[44:47], v[20:23], v[20:23], v[44:47]
s_nop 0
v_mov_b32_dpp v51, v55 quad_perm:[2,3,2,3] row_mask:0xf bank_mask:0xf
v_mov_b32_dpp v50, v54 quad_perm:[2,3,2,3] row_mask:0xf bank_mask:0xf
v_smfmac_f32_16x16x64_bf16 v[24:27], v[40:43], v[152:159], v1
v_mov_b32_dpp v49, v55 quad_perm:[0,1,0,1] row_mask:0xf bank_mask:0xf
v_mov_b64 v[22:23], s[44:45]
v_mov_b32_dpp v48, v54 quad_perm:[0,1,0,1] row_mask:0xf bank_mask:0xf
v_mov_b64 v[20:21], s[44:45]
v_smfmac_f32_16x16x64_bf16 v[28:31], v[40:43], v[160:167], v1
s_waitcnt vmcnt(7)
global_load_dwordx4 v[84:87], v0, s[80:81] offset:-3072 sc1
v_exp_f32_dpp v44, v46 quad_perm:[0,1,0,1] row_mask:0xf bank_mask:0xf
v_mfma_f32_16x16x32_bf16 v[8:11], v[56:59], v[48:51], 0
v_exp_f32_dpp v45, v47 quad_perm:[0,1,0,1] row_mask:0xf bank_mask:0xf
v_mfma_f32_16x16x32_bf16 v[16:19], v[20:23], v[48:51], 0
s_waitcnt vmcnt(7)
v_cvt_pk_bf16_f32 v52, v44, v45
v_mov_b64 v[54:55], s[46:47]
v_mfma_f32_16x16x32_bf16 v[12:15], v[60:63], v[48:51], 0
v_cvt_pk_bf16_f32 v53, v44, v45
v_cvt_pk_bf16_f32 v24, v24, v25
v_cvt_pk_bf16_f32 v25, v26, v27
v_mfma_f32_16x16x16_bf16 v[16:19], v[54:55], v[52:53], v[16:19]
s_min_u32 s34, s34, s32
v_cvt_pk_bf16_f32 v27, v30, v31
v_cvt_pk_bf16_f32 v26, v28, v29
v_mfma_f32_16x16x16_bf16 v[8:11], v[24:25], v[52:53], v[8:11]
ds_read_b128 v[28:31], v0 offset:31744
v_mov_b64 v[38:39], 0
v_mfma_f32_16x16x16_bf16 v[12:15], v[26:27], v[52:53], v[12:15]
s_waitcnt vmcnt(4)
v_mov_b64 v[36:37], 0
v_bfe_u32 v32, v0, 5, 1
v_rcp_f32 v18, v16
v_subrev_u32 v17, s37, v16
v_cmp_lt_u32 vcc, s38, v17
v_lshl_add_u32 v32, v32, 3, v5
v_mov_b64 v[42:43], 0
v_cndmask_b32 v11, v15, v11, s[42:43]
v_cndmask_b32 v8, v12, v8, s[42:43]
v_cndmask_b32 v10, v14, v10, s[42:43]
v_mul_f32 v11, v11, v18
v_mul_f32 v8, v8, v18
v_cndmask_b32 v9, v13, v9, s[42:43]
v_mul_f32 v9, v9, v18
v_mul_f32 v10, v10, v18
v_cvt_pk_bf16_f32 v12, v8, v9
v_cvt_pk_bf16_f32 v13, v10, v11
s_cbranch_vccnz rare_10026
back_10027:
ds_write_b64 v32, v[12:13] offset:512
v_mov_b32_dpp v11, v13 quad_perm:[2,3,2,3] row_mask:0xf bank_mask:0xf
v_mov_b32_dpp v9, v13 quad_perm:[0,1,0,1] row_mask:0xf bank_mask:0xf
v_mov_b32_dpp v8, v12 quad_perm:[0,1,0,1] row_mask:0xf bank_mask:0xf
v_mov_b32_dpp v10, v12 quad_perm:[2,3,2,3] row_mask:0xf bank_mask:0xf
v_mov_b64 v[52:53], 0
v_mov_b64 v[34:35], 0
v_smfmac_f32_16x16x64_bf16 v[36:39], v[8:11], v[64:71], v1
s_waitcnt vmcnt(2)
global_load_dwordx4 v[64:67], v0, s[76:77] offset:-4096 sc1
ds_read_b128 v[20:23], v0 offset:29696
ds_read_b128 v[24:27], v0 offset:30720
v_mov_b64 v[54:55], 0
v_mov_b64 v[32:33], 0
v_mov_b64 v[40:41], 0
v_smfmac_f32_16x16x64_bf16 v[52:55], v[8:11], v[176:183], v1
s_waitcnt lgkmcnt(2)
ds_read_b128 v[16:19], v0 offset:28672
s_barrier
ds_read_b128 v[56:59], v5 offset:0
global_load_dwordx4 v[68:71], v0, s[76:77] offset:-3072 sc1
ds_read_b128 v[60:63], v5 offset:1536
v_smfmac_f32_16x16x64_bf16 v[40:43], v[8:11], v[72:79], v1
s_waitcnt vmcnt(2)
ds_read_b128 v[12:15], v5 offset:1024
v_mov_b64 v[50:51], 0
v_mov_b64 v[48:49], 0
v_smfmac_f32_16x16x64_bf16 v[32:35], v[8:11], v[80:87], v1
global_load_dwordx4 v[72:75], v0, s[76:77] offset:-2048 sc1
ds_read_b128 v[80:83], v0 offset:32768
v_smfmac_f32_16x16x64_bf16 v[48:51], v[8:11], v[168:175], v1
s_waitcnt lgkmcnt(3)
ds_read_b128 v[84:87], v0 offset:33792
v_smfmac_f32_16x16x64_bf16 v[40:43], v[56:59], v[192:199], v1
global_load_dwordx4 v[76:79], v0, s[76:77] offset:-1024 sc1
v_smfmac_f32_16x16x64_bf16 v[36:39], v[56:59], v[16:23], v1
s_waitcnt lgkmcnt(3)
ds_read_b128 v[16:19], v0 offset:34816
v_lshrrev_b32 v44, 8, v0
v_smfmac_f32_16x16x64_bf16 v[36:39], v[60:63], v[24:31], v1
s_waitcnt lgkmcnt(3)
ds_read_b128 v[20:23], v0 offset:35840
v_bfe_u32 v45, v0, 1, 7
v_smfmac_f32_16x16x64_bf16 v[36:39], v[12:15], v[184:191], v1
ds_read_b128 v[28:31], v0 offset:37888
s_waitcnt lgkmcnt(3)
v_smfmac_f32_16x16x64_bf16 v[40:43], v[60:63], v[80:87], v1
ds_read_b128 v[24:27], v0 offset:36864
v_lshl_or_b32 v44, v44, 12, v45
v_smfmac_f32_16x16x64_bf16 v[40:43], v[12:15], v[200:207], v1
s_nop 0
ds_read_b128 v[80:83], v0 offset:38912
v_cvt_pk_bf16_f32 v36, v36, v37
v_smfmac_f32_16x16x64_bf16 v[32:35], v[56:59], v[232:239], v1
ds_read_b128 v[84:87], v0 offset:39936
v_and_or_b32 v36, v36, -2, s18
v_cvt_pk_bf16_f32 v37, v38, v39
v_smfmac_f32_16x16x64_bf16 v[52:55], v[56:59], v[216:223], v1
s_waitcnt lgkmcnt(4)
global_store_dwordx2 v44, v[36:37], s[48:49]
s_waitcnt lgkmcnt(3)
v_cvt_pk_bf16_f32 v40, v40, v41
v_cvt_pk_bf16_f32 v41, v42, v43
v_smfmac_f32_16x16x64_bf16 v[48:51], v[56:59], v[16:23], v1
s_waitcnt lgkmcnt(2)
s_add_u32 s27, s20, 524288
v_and_or_b32 v40, v40, -2, s18
v_smfmac_f32_16x16x64_bf16 v[48:51], v[60:63], v[24:31], v1
global_store_dwordx2 v44, v[40:41], s[50:51]
s_waitcnt lgkmcnt(0)
v_smfmac_f32_16x16x64_bf16 v[48:51], v[12:15], v[208:215], v1
s_add_u32 s58, s4, s20
v_smfmac_f32_16x16x64_bf16 v[32:35], v[60:63], v[240:247], v1
s_nop 2
v_smfmac_f32_16x16x64_bf16 v[52:55], v[60:63], v[80:87], v1
s_nop 1
v_cvt_pk_bf16_f32 v48, v48, v49
v_and_or_b32 v48, v48, -2, s18
v_cvt_pk_bf16_f32 v49, v50, v51
v_smfmac_f32_16x16x64_bf16 v[52:55], v[12:15], v[224:231], v1
s_nop 0
global_store_dwordx2 v44, v[48:49], s[52:53]
s_addc_u32 s59, s5, 0
s_mov_b32 s30, 0
v_smfmac_f32_16x16x64_bf16 v[32:35], v[12:15], v[248:255], v1
s_nop 2
v_cvt_pk_bf16_f32 v52, v52, v53
v_cvt_pk_bf16_f32 v53, v54, v55
s_mov_b32 s19, 1
v_and_or_b32 v52, v52, -2, s18
global_store_dwordx2 v44, v[52:53], s[54:55]
v_cvt_pk_bf16_f32 v32, v32, v33
v_cvt_pk_bf16_f32 v33, v34, v35
v_and_or_b32 v32, v32, -2, s18
global_store_dwordx2 v44, v[32:33], s[56:57]
v_bfe_u32 v32, v0, 6, 1
v_lshlrev_b32 v32, 4, v32
v_mov_b32 v33, 0x3f80
v_lshlrev_b32 v32, v32, v33
v_bfe_i32 v33, v0, 4, 1
v_and_b32 v45, v32, v33
v_and_b32 v47, v32, v33
v_xor_b32 v44, v32, v45
v_xor_b32 v46, v32, v45
v_and_b32 v36, 32, v0
v_bfe_u32 v37, v0, 6, 1
v_lshl_add_u32 v36, v37, 8, v36
v_bfe_u32 v37, v0, 8, 1
v_lshl_add_u32 v36, v37, 4, v36
v_bfe_u32 v37, v0, 4, 1
v_lshl_add_u32 v36, v37, 3, v36
v_and_b32 v7, 255, v0
v_lshl_add_u32 v7, v7, 3, s27
s_nop 15
s_nop 15
s_nop 15
s_nop 15
global_load_dwordx4 v[8:11], v0, s[64:65] offset:0 sc1
global_load_dwordx4 v[12:15], v0, s[64:65] offset:1024 sc1
global_load_dwordx4 v[16:19], v0, s[64:65] offset:2048 sc1
global_load_dwordx4 v[20:23], v0, s[64:65] offset:3072 sc1
s_nop 15
s_nop 15
s_nop 5
global_load_dwordx4 v[24:27], v0, s[64:65] offset:0 sc1
global_load_dwordx4 v[28:31], v0, s[64:65] offset:1024 sc1
global_load_dwordx4 v[48:51], v0, s[64:65] offset:2048 sc1
global_load_dwordx4 v[52:55], v0, s[64:65] offset:3072 sc1
chk_10035:
v_mov_b64 v[40:41], 0
v_mov_b64 v[42:43], 0
s_waitcnt vmcnt(6)
s_nop 0
v_smfmac_f32_16x16x64_bf16 v[40:43], v[44:47], v[8:15], v1
v_bitop3_b32 v32, v8, v10, s18 bitop3:0x7e
v_bitop3_b32 v33, v12, v14, s18 bitop3:0x7e
s_waitcnt vmcnt(4)
v_smfmac_f32_16x16x64_bf16 v[40:43], v[44:47], v[16:23], v1
v_bitop3_b32 v34, v16, v18, s18 bitop3:0x7e
v_bitop3_b32 v35, v20, v22, s18 bitop3:0x7e
v_or3_b32 v32, v32, v33, v34
v_bitop3_b32 v32, v32, v35, 1 bitop3:0xa8
v_cmp_ne_u32 vcc, 0, v32
s_cbranch_vccnz chk_10035_f
s_nop 1
v_add_f32_dpp v40, v40, v40 row_ror:8 row_mask:0xf bank_mask:0xf
v_add_f32_dpp v41, v41, v41 row_ror:8 row_mask:0xf bank_mask:0xf
v_add_f32_dpp v42, v42, v42 row_ror:8 row_mask:0xf bank_mask:0xf
v_add_f32_dpp v43, v43, v43 row_ror:8 row_mask:0xf bank_mask:0xf
v_cvt_pk_bf16_f32 v40, v40, v41
v_cvt_pk_bf16_f32 v41, v42, v43
v_and_or_b32 v40, v40, -2, s18
s_mov_b64 exec, 0x00ff00ff
global_store_dwordx2 v36, v[40:41], s[66:67]
s_mov_b64 exec, -1
s_branch join_10034
chk_10035_f:
global_load_dwordx4 v[8:11], v0, s[64:65] offset:0 sc1
global_load_dwordx4 v[12:15], v0, s[64:65] offset:1024 sc1
global_load_dwordx4 v[16:19], v0, s[64:65] offset:2048 sc1
global_load_dwordx4 v[20:23], v0, s[64:65] offset:3072 sc1
chk_10036:
v_mov_b64 v[40:41], 0
v_mov_b64 v[42:43], 0
s_waitcnt vmcnt(6)
s_nop 0
v_smfmac_f32_16x16x64_bf16 v[40:43], v[44:47], v[24:31], v1
v_bitop3_b32 v32, v24, v26, s18 bitop3:0x7e
v_bitop3_b32 v33, v28, v30, s18 bitop3:0x7e
s_waitcnt vmcnt(4)
v_smfmac_f32_16x16x64_bf16 v[40:43], v[44:47], v[48:55], v1
v_bitop3_b32 v34, v48, v50, s18 bitop3:0x7e
v_bitop3_b32 v35, v52, v54, s18 bitop3:0x7e
v_or3_b32 v32, v32, v33, v34
v_bitop3_b32 v32, v32, v35, 1 bitop3:0xa8
v_cmp_ne_u32 vcc, 0, v32
s_cbranch_vccnz chk_10036_f
s_nop 1
v_add_f32_dpp v40, v40, v40 row_ror:8 row_mask:0xf bank_mask:0xf
v_add_f32_dpp v41, v41, v41 row_ror:8 row_mask:0xf bank_mask:0xf
v_add_f32_dpp v42, v42, v42 row_ror:8 row_mask:0xf bank_mask:0xf
v_add_f32_dpp v43, v43, v43 row_ror:8 row_mask:0xf bank_mask:0xf
v_cvt_pk_bf16_f32 v40, v40, v41
v_cvt_pk_bf16_f32 v41, v42, v43
v_and_or_b32 v40, v40, -2, s18
s_mov_b64 exec, 0x00ff00ff
global_store_dwordx2 v36, v[40:41], s[66:67]
s_mov_b64 exec, -1
s_branch join_10034
chk_10036_f:
global_load_dwordx4 v[24:27], v0, s[64:65] offset:0 sc1
global_load_dwordx4 v[28:31], v0, s[64:65] offset:1024 sc1
global_load_dwordx4 v[48:51], v0, s[64:65] offset:2048 sc1
global_load_dwordx4 v[52:55], v0, s[64:65] offset:3072 sc1
s_add_u32 s30, s30, 1
s_cmp_le_u32 s30, 262144
s_cbranch_scc1 chk_10035
s_branch L_fail
nored_10033:
join_10034:
s_barrier
global_load_dwordx4 v[56:59], v0, s[76:77] offset:0 sc1
global_load_dwordx4 v[60:63], v0, s[76:77] offset:1024 sc1
global_load_dwordx4 v[80:83], v0, s[76:77] offset:2048 sc1
global_load_dwordx4 v[84:87], v0, s[76:77] offset:3072 sc1
s_nop 15
s_nop 15
s_nop 3
s_barrier
global_load_dwordx4 v[32:35], v0, s[68:69] offset:-4096 sc1
s_nop 10
global_load_dwordx4 v[36:39], v0, s[68:69] offset:0 sc1
s_nop 10
global_load_dwordx4 v[40:43], v0, s[70:71] offset:0 sc1
s_barrier
global_load_dwordx4 v[48:51], v0, s[58:59] offset:0 nt sc1
global_load_dwordx4 v[52:55], v0, s[58:59] offset:1024 nt sc1
s_waitcnt vmcnt(13)
v_mov_b64 v[8:9], 0
v_mov_b64 v[10:11], 0
s_waitcnt vmcnt(12)
v_mov_b64 v[12:13], 0
v_mov_b64 v[14:15], 0
s_waitcnt vmcnt(11)
v_mov_b64 v[16:17], 0
v_mov_b64 v[18:19], 0
s_waitcnt vmcnt(10)
v_mov_b64 v[20:21], 0
v_mov_b64 v[22:23], 0
v_mov_b64 v[24:25], 0
v_mov_b64 v[26:27], 0
v_mov_b64 v[28:29], 0
v_mov_b64 v[30:31], 0
s_mov_b32 s30, 0
s_cmp_eq_u32 s17, s31
s_cbranch_scc0 gather_10025
s_branch exit_10028
rt_10030:
global_load_dwordx4 v[32:35], v0, s[68:69] offset:-4096 sc1
global_load_dwordx4 v[36:39], v0, s[68:69] offset:0 sc1
global_load_dwordx4 v[40:43], v0, s[70:71] offset:0 sc1
s_add_u32 s30, s30, 1
s_cmp_gt_u32 s30, 262144
s_cbranch_scc1 L_fail
s_mov_b64 exec, 1
global_store_dword v0, v0, s[62:63]
global_store_dword v0, v0, s[62:63]
s_mov_b64 exec, -1
v_mov_b64 v[8:9], 0
v_mov_b64 v[10:11], 0
v_mov_b64 v[12:13], 0
v_mov_b64 v[14:15], 0
v_mov_b64 v[16:17], 0
v_mov_b64 v[18:19], 0
v_mov_b64 v[20:21], 0
v_mov_b64 v[22:23], 0
v_mov_b64 v[24:25], 0
v_mov_b64 v[26:27], 0
v_mov_b64 v[28:29], 0
v_mov_b64 v[30:31], 0
s_branch gather_10025
rare_10026:
ds_read_b128 v[48:51], v6 offset:6144
ds_read_b128 v[52:55], v6 offset:7168
s_waitcnt lgkmcnt(0)
v_add_f32 v48, v48, v52
v_add_f32 v49, v49, v53
v_add_f32 v50, v50, v54
v_add_f32 v51, v51, v55
v_mov_b32_dpp v46, v46 quad_perm:[0,1,0,1] row_mask:0xf bank_mask:0xf
v_mov_b32_dpp v47, v47 quad_perm:[0,1,0,1] row_mask:0xf bank_mask:0xf
v_max3_f32 v19, v48, v49, v50
v_max3_f32 v19, v19, v51, v46
v_max_f32 v19, v19, v47
s_nop 1
v_max_f32_dpp v19, v19, v19 quad_perm:[2,3,0,1] row_mask:0xf bank_mask:0xf
v_mov_b32 v44, v19
s_nop 1
v_permlane32_swap_b32 v19, v44
v_max_f32 v19, v19, v44
v_mov_b32 v44, v19
s_nop 1
v_permlane16_swap_b32 v19, v44
v_max_f32 v19, v19, v44
v_sub_f32 v48, v48, v19
v_sub_f32 v49, v49, v19
v_sub_f32 v50, v50, v19
v_sub_f32 v51, v51, v19
v_sub_f32 v46, v46, v19
v_sub_f32 v47, v47, v19
v_exp_f32 v48, v48
v_exp_f32 v49, v49
v_exp_f32 v50, v50
v_exp_f32 v51, v51
v_cvt_pk_bf16_f32 v54, v48, v49
v_cvt_pk_bf16_f32 v55, v50, v51
s_nop 0
v_mov_b32_dpp v48, v54 quad_perm:[0,1,0,1] row_mask:0xf bank_mask:0xf
v_mov_b32_dpp v49, v55 quad_perm:[0,1,0,1] row_mask:0xf bank_mask:0xf
v_mov_b32_dpp v50, v54 quad_perm:[2,3,2,3] row_mask:0xf bank_mask:0xf
v_mov_b32_dpp v51, v55 quad_perm:[2,3,2,3] row_mask:0xf bank_mask:0xf
v_mov_b64 v[20:21], s[44:45]
v_mov_b64 v[22:23], s[44:45]
v_mfma_f32_16x16x32_bf16 v[8:11], v[56:59], v[48:51], 0
v_mfma_f32_16x16x32_bf16 v[12:15], v[60:63], v[48:51], 0
v_mfma_f32_16x16x32_bf16 v[16:19], v[20:23], v[48:51], 0
v_mov_b64 v[54:55], s[46:47]
v_exp_f32_dpp v44, v46 quad_perm:[0,1,0,1] row_mask:0xf bank_mask:0xf
v_exp_f32_dpp v45, v47 quad_perm:[0,1,0,1] row_mask:0xf bank_mask:0xf
s_nop 0
v_cvt_pk_bf16_f32 v52, v44, v45
v_cvt_pk_bf16_f32 v53, v44, v45
s_nop 1
v_mfma_f32_16x16x16_bf16 v[16:19], v[54:55], v[52:53], v[16:19]
v_mfma_f32_16x16x16_bf16 v[8:11], v[24:25], v[52:53], v[8:11]
v_mfma_f32_16x16x16_bf16 v[12:15], v[26:27], v[52:53], v[12:15]
s_nop 5
v_rcp_f32 v18, v16
s_nop 0
v_cndmask_b32 v8, v12, v8, s[42:43]
v_mul_f32 v8, v8, v18
v_cndmask_b32 v9, v13, v9, s[42:43]
v_mul_f32 v9, v9, v18
v_cndmask_b32 v10, v14, v10, s[42:43]
v_mul_f32 v10, v10, v18
v_cndmask_b32 v11, v15, v11, s[42:43]
v_mul_f32 v11, v11, v18
v_cvt_pk_bf16_f32 v12, v8, v9
v_cvt_pk_bf16_f32 v13, v10, v11
s_branch back_10027
exit_10028:
global_load_dwordx4 v[32:35], v0, s[68:69] offset:-4096 sc1
global_load_dwordx4 v[36:39], v0, s[68:69] offset:0 sc1
global_load_dwordx4 v[40:43], v0, s[70:71] offset:0 sc1
s_add_u32 s30, s30, 1
s_cmp_gt_u32 s30, 262144
s_cbranch_scc1 L_fail
s_waitcnt vmcnt(2)
v_bitop3_b32 v44, v32, v34, s18 bitop3:0x7e
s_waitcnt vmcnt(1)
v_bitop3_b32 v45, v36, v38, s18 bitop3:0x7e
v_or_b32 v44, v44, v45
s_waitcnt vmcnt(0)
v_bitop3_b32 v46, v40, v42, s18 bitop3:0x7e
v_bitop3_b32 v44, v44, v46, s19 bitop3:0xa8
v_cmp_ne_u32 vcc, 0, v44
s_cbranch_vccnz exit_10028
s_add_u32 s36, s36, 1
s_cmp_lt_u32 s36, 2
s_cbranch_scc1 layer_10024
s_endpgm
wave_10007:
layer_10037:
s_lshl_b32 s17, s36, 6
s_mul_i32 s27, s36, 35651584
s_mul_i32 s28, s14, 16384
s_add_u32 s27, s27, s28
s_add_u32 s20, s27, 16785408
s_mul_i32 s27, s17, 10240
s_add_u32 s27, s27, s24
s_add_u32 s21, s27, s25
s_mov_b32 s19, 0
s_mov_b32 s33, s6
s_add_u32 s34, s17, 1
s_add_u32 s31, s17, 63
s_add_u32 s32, s17, 64
s_mov_b32 s27, s20
v_mov_b32 v7, 0
s_add_u32 s68, s4, 415744
s_addc_u32 s69, s5, 0
s_add_u32 s72, s4, 399360
s_addc_u32 s73, s5, 0
s_add_u32 s70, s4, 419840
s_addc_u32 s71, s5, 0
s_add_u32 s74, s4, 403456
s_addc_u32 s75, s5, 0
s_add_u32 s58, s4, s20
s_addc_u32 s59, s5, 0
global_load_dwordx4 v[64:67], v0, s[76:77] offset:-4096 sc1
global_load_dwordx4 v[68:71], v0, s[76:77] offset:-3072 sc1
global_load_dwordx4 v[72:75], v0, s[76:77] offset:-2048 sc1
global_load_dwordx4 v[76:79], v0, s[76:77] offset:-1024 sc1
global_load_dwordx4 v[80:83], v0, s[76:77] offset:2048 sc1
global_load_dwordx4 v[84:87], v0, s[76:77] offset:3072 sc1
global_load_dwordx4 v[56:59], v0, s[76:77] offset:0 sc1
global_load_dwordx4 v[60:63], v0, s[76:77] offset:1024 sc1
v_mov_b64 v[8:9], 0
v_mov_b64 v[10:11], 0
v_mov_b64 v[12:13], 0
v_mov_b64 v[14:15], 0
v_mov_b64 v[16:17], 0
v_mov_b64 v[18:19], 0
v_mov_b64 v[20:21], 0
v_mov_b64 v[22:23], 0
v_mov_b64 v[24:25], 0
v_mov_b64 v[26:27], 0
v_mov_b64 v[28:29], 0
v_mov_b64 v[30:31], 0
s_barrier
global_load_dwordx4 v[48:51], v0, s[58:59] offset:0 nt sc1
global_load_dwordx4 v[52:55], v0, s[58:59] offset:1024 nt sc1
v_and_b32 v7, 255, v0
v_lshl_add_u32 v7, v7, 3, s27
global_load_dwordx4 v[32:35], v0, s[68:69] offset:-4096 sc1
global_load_dwordx4 v[36:39], v0, s[68:69] offset:0 sc1
v_mov_b32 v45, -1
s_mov_b32 s30, 0
s_waitcnt vmcnt(0)
.p2align 6
gather_10038:
s_waitcnt vmcnt(3)
rt_10043_b:
v_smfmac_f32_16x16x64_bf16 v[24:27], v[32:35], a[0:7], v1
ds_write_b128 v0, v[32:35] offset:2048
v_smfmac_f32_16x16x64_bf16 v[8:11], v[32:35], v[64:71], v1
v_bitop3_b32 v44, v32, v34, s18 bitop3:0x7e
v_smfmac_f32_16x16x64_bf16 v[12:15], v[32:35], v[72:79], v1
s_waitcnt vmcnt(2)
ds_write_b128 v0, v[36:39] offset:6144
v_bitop3_b32 v45, v36, v38, s18 bitop3:0x7e
v_bitop3_b32 v44, v44, v45, s19 bitop3:0xa8
v_cmp_ne_u32 vcc, 0, v44
v_smfmac_f32_16x16x64_bf16 v[8:11], v[36:39], a[16:23], v1
v_smfmac_f32_16x16x64_bf16 v[20:23], v[32:35], v[80:87], v1
s_cbranch_vccnz rt_10043
global_load_dwordx4 v[64:67], v0, s[78:79] offset:-4096 sc1
ds_read_b128 v[80:83], v2 offset:0
v_smfmac_f32_16x16x64_bf16 v[28:31], v[32:35], a[8:15], v1
global_load_dwordx4 v[68:71], v0, s[78:79] offset:-3072 sc1
ds_read_b128 v[84:87], v2 offset:1024
v_smfmac_f32_16x16x64_bf16 v[20:23], v[36:39], a[40:47], v1
global_load_dwordx4 v[72:75], v0, s[78:79] offset:-2048 sc1
global_load_dwordx4 v[76:79], v0, s[78:79] offset:-1024 sc1
v_smfmac_f32_16x16x64_bf16 v[16:19], v[32:35], v[56:63], v1
s_waitcnt lgkmcnt(2)
s_barrier
ds_read_b128 v[40:43], v0 offset:3072
v_smfmac_f32_16x16x64_bf16 v[16:19], v[36:39], a[32:39], v1
s_waitcnt lgkmcnt(1)
ds_read_b128 v[44:47], v0 offset:7168
v_smfmac_f32_16x16x64_bf16 v[28:31], v[36:39], v[80:87], v1
s_xor_b32 s18, s18, 1
ds_read_b128 v[32:35], v0 offset:0
v_smfmac_f32_16x16x64_bf16 v[24:27], v[36:39], a[48:55], v1
s_add_u32 s20, s20, 524288
ds_read_b128 v[84:87], v2 offset:3072
v_smfmac_f32_16x16x64_bf16 v[12:15], v[36:39], a[24:31], v1
ds_read_b128 v[80:83], v2 offset:2048
s_waitcnt lgkmcnt(4)
v_smfmac_f32_16x16x64_bf16 v[12:15], v[40:43], a[64:71], v1
ds_read_b128 v[36:39], v0 offset:4096
v_smfmac_f32_16x16x64_bf16 v[8:11], v[40:43], a[56:63], v1
s_waitcnt lgkmcnt(4)
ds_read_b128 v[40:43], v0 offset:1024
s_waitcnt lgkmcnt(4)
v_smfmac_f32_16x16x64_bf16 v[12:15], v[44:47], a[80:87], v1
s_add_u32 s17, s17, 1
global_load_dwordx4 v[56:59], v0, s[58:59] offset:2048 nt sc1
v_smfmac_f32_16x16x64_bf16 v[8:11], v[44:47], a[72:79], v1
s_waitcnt lgkmcnt(3)
ds_read_b128 v[44:47], v0 offset:5120
s_waitcnt lgkmcnt(3)
v_smfmac_f32_16x16x64_bf16 v[12:15], v[32:35], v[80:87], v1
ds_read_b128 v[80:83], v2 offset:4096
v_smfmac_f32_16x16x64_bf16 v[8:11], v[32:35], a[88:95], v1
s_waitcnt lgkmcnt(3)
ds_read_b128 v[84:87], v2 offset:5120
s_add_u32 s21, s21, 10240
v_smfmac_f32_16x16x64_bf16 v[12:15], v[36:39], a[104:111], v1
ds_read_b128 v[32:35], v0 offset:8192
v_smfmac_f32_16x16x64_bf16 v[8:11], v[36:39], a[96:103], v1
s_waitcnt lgkmcnt(4)
s_waitcnt lgkmcnt(3)
ds_read_b128 v[36:39], v0 offset:9216
v_smfmac_f32_16x16x64_bf16 v[12:15], v[40:43], a[120:127], v1
global_load_dwordx4 v[60:63], v0, s[58:59] offset:3072 nt sc1
v_smfmac_f32_16x16x64_bf16 v[8:11], v[40:43], a[112:119], v1
s_waitcnt lgkmcnt(2)
ds_read_b128 v[40:43], v0 offset:3072
v_smfmac_f32_16x16x64_bf16 v[12:15], v[44:47], v[80:87], v1
s_waitcnt lgkmcnt(2)
ds_read_b128 v[84:87], v2 offset:7168
v_smfmac_f32_16x16x64_bf16 v[8:11], v[44:47], a[128:135], v1
ds_read_b128 v[80:83], v2 offset:6144
s_waitcnt lgkmcnt(3)
v_smfmac_f32_16x16x64_bf16 v[12:15], v[32:35], a[144:151], v1
s_waitcnt vmcnt(5)
global_load_dword v7, v7, s[4:5] sc1
v_smfmac_f32_16x16x64_bf16 v[8:11], v[32:35], a[136:143], v1
s_mov_b64 s[68:69], s[72:73]
ds_read_b128 v[32:35], v0 offset:7168
s_waitcnt vmcnt(5)
v_smfmac_f32_16x16x64_bf16 v[8:11], v[36:39], v[64:71], v1
ds_read_b128 v[68:71], v2 offset:9216
s_waitcnt lgkmcnt(3)
ds_read_b128 v[64:67], v2 offset:8192
v_smfmac_f32_16x16x64_bf16 v[12:15], v[36:39], a[152:159], v1
s_waitcnt lgkmcnt(3)
ds_read_b128 v[36:39], v0 offset:0
v_smfmac_f32_16x16x64_bf16 v[20:23], v[40:43], v[80:87], v1
ds_read_b128 v[84:87], v2 offset:11264
v_add_f32 v9, v9, v11
v_smfmac_f32_16x16x64_bf16 v[16:19], v[40:43], a[160:167], v1
s_waitcnt lgkmcnt(4)
ds_read_b128 v[40:43], v0 offset:4096
v_add_f32 v12, v12, v14
v_smfmac_f32_16x16x64_bf16 v[16:19], v[32:35], a[168:175], v1
s_waitcnt vmcnt(4)
ds_read_b128 v[80:83], v2 offset:10240
v_mul_f32 v12, s35, v12
v_add_f32 v13, v13, v15
v_mul_f32 v9, s35, v9
v_add_f32 v8, v8, v10
v_mul_f32 v8, s35, v8
v_smfmac_f32_16x16x64_bf16 v[20:23], v[32:35], a[176:183], v1
s_waitcnt lgkmcnt(3)
ds_read_b128 v[32:35], v0 offset:1024
v_cvt_pk_bf16_f32 v8, v8, v9
v_smfmac_f32_16x16x64_bf16 v[16:19], v[36:39], v[64:71], v1
s_add_u32 s34, s17, 2
ds_read_b128 v[64:67], v2 offset:12288
ds_read_b128 v[68:71], v2 offset:13312
v_mul_f32 v13, s35, v13
v_cvt_pk_bf16_f32 v12, v12, v13
v_smfmac_f32_16x16x64_bf16 v[20:23], v[36:39], a[184:191], v1
s_waitcnt lgkmcnt(4)
ds_read_b128 v[36:39], v0 offset:5120
s_waitcnt vmcnt(3)
ds_write2_b32 v3, v8, v12 offset0:0 offset1:128
v_smfmac_f32_16x16x64_bf16 v[16:19], v[40:43], v[72:79], v1
s_waitcnt lgkmcnt(4)
ds_read_b128 v[72:75], v2 offset:14336
v_smfmac_f32_16x16x64_bf16 v[20:23], v[40:43], v[80:87], v1
ds_read_b128 v[80:83], v2 offset:16384
v_smfmac_f32_16x16x64_bf16 v[20:23], v[32:35], a[200:207], v1
ds_read_b128 v[40:43], v0 offset:8192
s_waitcnt lgkmcnt(5)
v_smfmac_f32_16x16x64_bf16 v[16:19], v[32:35], a[192:199], v1
ds_read_b128 v[76:79], v2 offset:15360
s_waitcnt lgkmcnt(5)
ds_read_b128 v[84:87], v2 offset:17408
v_smfmac_f32_16x16x64_bf16 v[16:19], v[36:39], v[64:71], v1
s_waitcnt lgkmcnt(5)
ds_read_b128 v[32:35], v0 offset:9216
s_barrier
ds_read_b64_tr_b16 v[10:11], v4 offset:2560
v_smfmac_f32_16x16x64_bf16 v[20:23], v[36:39], a[208:215], v1
ds_read_b64_tr_b16 v[8:9], v4 offset:2048
s_waitcnt lgkmcnt(5)
ds_read_b64_tr_b16 v[12:13], v4 offset:3072
v_smfmac_f32_16x16x64_bf16 v[20:23], v[40:43], a[216:223], v1
s_waitcnt lgkmcnt(5)
ds_read_b64_tr_b16 v[14:15], v4 offset:3584
s_mov_b64 vcc, s[42:43]
ds_read_b128 v[68:71], v2 offset:19456
v_smfmac_f32_16x16x64_bf16 v[16:19], v[40:43], v[72:79], v1
ds_read_b128 v[36:39], v0 offset:8192
s_waitcnt lgkmcnt(6)
v_smfmac_f32_16x16x64_bf16 v[20:23], v[32:35], v[80:87], v1
s_waitcnt lgkmcnt(5)
ds_read_b128 v[64:67], v2 offset:18432
ds_read_b128 v[40:43], v0 offset:9216
v_smfmac_f32_16x16x64_bf16 v[16:19], v[32:35], a[224:231], v1
s_waitcnt lgkmcnt(5)
ds_read_b128 v[72:75], v2 offset:20480
ds_read_b128 v[32:35], v0 offset:3072
v_mfma_f32_16x16x32_bf16 v[44:47], v[48:51], v[8:11], 0
s_waitcnt lgkmcnt(6)
ds_read_b128 v[76:79], v2 offset:21504
v_bfe_u32 v48, v0, 5, 1
v_add_f32 v21, v21, v23
v_add_f32 v17, v17, v19
v_mfma_f32_16x16x32_bf16 v[44:47], v[52:55], v[12:15], v[44:47]
s_waitcnt lgkmcnt(5)
ds_read_b128 v[80:83], v2 offset:22528
v_lshl_add_u32 v48, v48, 3, v5
v_add_f32 v16, v16, v18
v_cvt_pk_bf16_f32 v16, v16, v17
v_add_f32 v20, v20, v22
v_cvt_pk_bf16_f32 v20, v20, v21
v_smfmac_f32_16x16x64_bf16 v[28:31], v[36:39], a[232:239], v1
s_waitcnt lgkmcnt(4)
ds_write2_b32 v3, v16, v20 offset0:1 offset1:129
v_cndmask_b32_dpp v44, v46, v44, vcc quad_perm:[0,1,0,1] row_mask:0xf bank_mask:0xf
v_cndmask_b32_dpp v45, v47, v45, vcc quad_perm:[0,1,0,1] row_mask:0xf bank_mask:0xf
v_smfmac_f32_16x16x64_bf16 v[24:27], v[36:39], v[64:71], v1
ds_write_b64 v48, v[44:45] offset:7168
v_smfmac_f32_16x16x64_bf16 v[24:27], v[40:43], a[240:247], v1
s_waitcnt lgkmcnt(3)
global_load_dwordx4 v[64:67], v0, s[78:79] offset:0 sc1
ds_read_b128 v[84:87], v2 offset:23552
v_smfmac_f32_16x16x64_bf16 v[28:31], v[40:43], v[72:79], v1
s_waitcnt lgkmcnt(3)
ds_read_b128 v[36:39], v0 offset:7168
global_load_dwordx4 v[68:71], v0, s[78:79] offset:1024 sc1
v_smfmac_f32_16x16x64_bf16 v[24:27], v[32:35], a[248:255], v1
global_load_dwordx4 v[72:75], v0, s[78:79] offset:2048 sc1
ds_read_b128 v[40:43], v0 offset:0
v_smfmac_f32_16x16x64_bf16 v[28:31], v[32:35], v[88:95], v1
s_waitcnt lgkmcnt(3)
ds_read_b128 v[32:35], v0 offset:4096
s_barrier
ds_read_b128 v[52:55], v6 offset:7168
s_waitcnt lgkmcnt(3)
v_smfmac_f32_16x16x64_bf16 v[28:31], v[36:39], v[96:103], v1
ds_read_b128 v[48:51], v6 offset:6144
ds_read_b64_tr_b16 v[8:9], v4 offset:0
v_smfmac_f32_16x16x64_bf16 v[24:27], v[36:39], v[80:87], v1
s_waitcnt lgkmcnt(4)
ds_read_b128 v[36:39], v0 offset:1024
global_load_dwordx4 v[76:79], v0, s[78:79] offset:3072 sc1
ds_read_b64_tr_b16 v[10:11], v4 offset:512
v_smfmac_f32_16x16x64_bf16 v[28:31], v[40:43], v[112:119], v1
s_waitcnt lgkmcnt(5)
ds_read_b64_tr_b16 v[14:15], v4 offset:1536
ds_read_b64_tr_b16 v[18:19], v4 offset:2560
v_smfmac_f32_16x16x64_bf16 v[24:27], v[40:43], v[104:111], v1
s_waitcnt lgkmcnt(6)
ds_read_b64_tr_b16 v[12:13], v4 offset:1024
ds_read_b64_tr_b16 v[16:17], v4 offset:2048
v_smfmac_f32_16x16x64_bf16 v[28:31], v[32:35], v[128:135], v1
s_waitcnt lgkmcnt(7)
ds_read_b64_tr_b16 v[22:23], v4 offset:3584
v_add_f32 v50, v50, v54
v_add_f32 v49, v49, v53
v_smfmac_f32_16x16x64_bf16 v[24:27], v[32:35], v[120:127], v1
s_waitcnt lgkmcnt(6)
ds_read_b128 v[40:43], v0 offset:5120
v_add_f32 v48, v48, v52
v_smfmac_f32_16x16x64_bf16 v[24:27], v[36:39], v[136:143], v1
s_waitcnt lgkmcnt(5)
ds_read_b64_tr_b16 v[20:21], v4 offset:3072
v_add_f32 v51, v51, v55
v_smfmac_f32_16x16x64_bf16 v[28:31], v[36:39], v[144:151], v1
s_waitcnt lgkmcnt(4)
global_load_dwordx4 v[80:83], v0, s[80:81] offset:-4096 sc1
v_exp_f32 v51, v51
v_mfma_f32_16x16x32_bf16 v[44:47], v[8:11], v[8:11], 0
s_waitcnt lgkmcnt(3)
v_exp_f32 v49, v49
v_mfma_f32_16x16x32_bf16 v[44:47], v[12:15], v[12:15], v[44:47]
s_waitcnt lgkmcnt(1)
v_exp_f32 v50, v50
v_exp_f32 v48, v48
v_mfma_f32_16x16x32_bf16 v[44:47], v[16:19], v[16:19], v[44:47]
s_waitcnt lgkmcnt(0)
v_cvt_pk_bf16_f32 v54, v48, v49
v_cvt_pk_bf16_f32 v55, v50, v51
v_mfma_f32_16x16x32_bf16 v[44:47], v[20:23], v[20:23], v[44:47]
s_nop 0
v_mov_b32_dpp v51, v55 quad_perm:[2,3,2,3] row_mask:0xf bank_mask:0xf
v_mov_b32_dpp v50, v54 quad_perm:[2,3,2,3] row_mask:0xf bank_mask:0xf
v_smfmac_f32_16x16x64_bf16 v[24:27], v[40:43], v[152:159], v1
v_mov_b32_dpp v49, v55 quad_perm:[0,1,0,1] row_mask:0xf bank_mask:0xf
v_mov_b64 v[22:23], s[44:45]
v_mov_b32_dpp v48, v54 quad_perm:[0,1,0,1] row_mask:0xf bank_mask:0xf
v_mov_b64 v[20:21], s[44:45]
v_smfmac_f32_16x16x64_bf16 v[28:31], v[40:43], v[160:167], v1
s_waitcnt vmcnt(7)
global_load_dwordx4 v[84:87], v0, s[80:81] offset:-3072 sc1
v_exp_f32_dpp v44, v46 quad_perm:[0,1,0,1] row_mask:0xf bank_mask:0xf
v_mfma_f32_16x16x32_bf16 v[8:11], v[56:59], v[48:51], 0
v_exp_f32_dpp v45, v47 quad_perm:[0,1,0,1] row_mask:0xf bank_mask:0xf
v_mfma_f32_16x16x32_bf16 v[16:19], v[20:23], v[48:51], 0
s_waitcnt vmcnt(7)
v_cvt_pk_bf16_f32 v52, v44, v45
v_mov_b64 v[54:55], s[46:47]
v_mfma_f32_16x16x32_bf16 v[12:15], v[60:63], v[48:51], 0
v_cvt_pk_bf16_f32 v53, v44, v45
v_cvt_pk_bf16_f32 v24, v24, v25
v_cvt_pk_bf16_f32 v25, v26, v27
v_mfma_f32_16x16x16_bf16 v[16:19], v[54:55], v[52:53], v[16:19]
s_min_u32 s34, s34, s32
v_cvt_pk_bf16_f32 v27, v30, v31
v_cvt_pk_bf16_f32 v26, v28, v29
v_mfma_f32_16x16x16_bf16 v[8:11], v[24:25], v[52:53], v[8:11]
ds_read_b128 v[28:31], v0 offset:44032
v_mov_b64 v[38:39], 0
v_mfma_f32_16x16x16_bf16 v[12:15], v[26:27], v[52:53], v[12:15]
s_waitcnt vmcnt(4)
v_mov_b64 v[36:37], 0
v_bfe_u32 v32, v0, 5, 1
v_rcp_f32 v18, v16
v_subrev_u32 v17, s37, v16
v_cmp_lt_u32 vcc, s38, v17
v_lshl_add_u32 v32, v32, 3, v5
v_mov_b64 v[42:43], 0
v_cndmask_b32 v11, v15, v11, s[42:43]
v_cndmask_b32 v8, v12, v8, s[42:43]
v_cndmask_b32 v10, v14, v10, s[42:43]
v_mul_f32 v11, v11, v18
v_mul_f32 v8, v8, v18
v_cndmask_b32 v9, v13, v9, s[42:43]
v_mul_f32 v9, v9, v18
v_mul_f32 v10, v10, v18
v_cvt_pk_bf16_f32 v12, v8, v9
v_cvt_pk_bf16_f32 v13, v10, v11
s_cbranch_vccnz rare_10039
back_10040:
ds_write_b64 v32, v[12:13] offset:1024
v_mov_b32_dpp v11, v13 quad_perm:[2,3,2,3] row_mask:0xf bank_mask:0xf
v_mov_b32_dpp v9, v13 quad_perm:[0,1,0,1] row_mask:0xf bank_mask:0xf
v_mov_b32_dpp v8, v12 quad_perm:[0,1,0,1] row_mask:0xf bank_mask:0xf
v_mov_b32_dpp v10, v12 quad_perm:[2,3,2,3] row_mask:0xf bank_mask:0xf
v_mov_b64 v[52:53], 0
v_mov_b64 v[34:35], 0
v_smfmac_f32_16x16x64_bf16 v[36:39], v[8:11], v[64:71], v1
s_waitcnt vmcnt(2)
global_load_dwordx4 v[64:67], v0, s[76:77] offset:-4096 sc1
ds_read_b128 v[20:23], v0 offset:41984
ds_read_b128 v[24:27], v0 offset:43008
v_mov_b64 v[54:55], 0
v_mov_b64 v[32:33], 0
v_mov_b64 v[40:41], 0
v_smfmac_f32_16x16x64_bf16 v[52:55], v[8:11], v[176:183], v1
s_waitcnt lgkmcnt(2)
ds_read_b128 v[16:19], v0 offset:40960
s_barrier
ds_read_b128 v[56:59], v5 offset:1536
global_load_dwordx4 v[68:71], v0, s[76:77] offset:-3072 sc1
ds_read_b128 v[60:63], v5 offset:0
v_smfmac_f32_16x16x64_bf16 v[40:43], v[8:11], v[72:79], v1
s_waitcnt vmcnt(2)
ds_read_b128 v[12:15], v5 offset:512
v_mov_b64 v[50:51], 0
v_mov_b64 v[48:49], 0
v_smfmac_f32_16x16x64_bf16 v[32:35], v[8:11], v[80:87], v1
global_load_dwordx4 v[72:75], v0, s[76:77] offset:-2048 sc1
ds_read_b128 v[80:83], v0 offset:45056
v_smfmac_f32_16x16x64_bf16 v[48:51], v[8:11], v[168:175], v1
s_waitcnt lgkmcnt(3)
ds_read_b128 v[84:87], v0 offset:46080
v_smfmac_f32_16x16x64_bf16 v[40:43], v[56:59], v[192:199], v1
global_load_dwordx4 v[76:79], v0, s[76:77] offset:-1024 sc1
v_smfmac_f32_16x16x64_bf16 v[36:39], v[56:59], v[16:23], v1
s_waitcnt lgkmcnt(3)
ds_read_b128 v[16:19], v0 offset:47104
v_lshrrev_b32 v44, 8, v0
v_smfmac_f32_16x16x64_bf16 v[36:39], v[60:63], v[24:31], v1
s_waitcnt lgkmcnt(3)
ds_read_b128 v[20:23], v0 offset:48128
v_bfe_u32 v45, v0, 1, 7
v_smfmac_f32_16x16x64_bf16 v[36:39], v[12:15], v[184:191], v1
ds_read_b128 v[28:31], v0 offset:50176
s_waitcnt lgkmcnt(3)
v_smfmac_f32_16x16x64_bf16 v[40:43], v[60:63], v[80:87], v1
ds_read_b128 v[24:27], v0 offset:49152
v_lshl_or_b32 v44, v44, 12, v45
v_smfmac_f32_16x16x64_bf16 v[40:43], v[12:15], v[200:207], v1
s_nop 0
ds_read_b128 v[80:83], v0 offset:51200
v_cvt_pk_bf16_f32 v36, v36, v37
v_smfmac_f32_16x16x64_bf16 v[32:35], v[56:59], v[232:239], v1
ds_read_b128 v[84:87], v0 offset:52224
v_and_or_b32 v36, v36, -2, s18
v_cvt_pk_bf16_f32 v37, v38, v39
v_smfmac_f32_16x16x64_bf16 v[52:55], v[56:59], v[216:223], v1
s_waitcnt lgkmcnt(4)
global_store_dwordx2 v44, v[36:37], s[48:49]
s_waitcnt lgkmcnt(3)
v_cvt_pk_bf16_f32 v40, v40, v41
v_cvt_pk_bf16_f32 v41, v42, v43
v_smfmac_f32_16x16x64_bf16 v[48:51], v[56:59], v[16:23], v1
s_waitcnt lgkmcnt(2)
s_add_u32 s27, s20, 524288
v_and_or_b32 v40, v40, -2, s18
v_smfmac_f32_16x16x64_bf16 v[48:51], v[60:63], v[24:31], v1
global_store_dwordx2 v44, v[40:41], s[50:51]
s_waitcnt lgkmcnt(0)
v_smfmac_f32_16x16x64_bf16 v[48:51], v[12:15], v[208:215], v1
s_add_u32 s58, s4, s20
v_smfmac_f32_16x16x64_bf16 v[32:35], v[60:63], v[240:247], v1
s_nop 2
v_smfmac_f32_16x16x64_bf16 v[52:55], v[60:63], v[80:87], v1
s_nop 1
v_cvt_pk_bf16_f32 v48, v48, v49
v_and_or_b32 v48, v48, -2, s18
v_cvt_pk_bf16_f32 v49, v50, v51
v_smfmac_f32_16x16x64_bf16 v[52:55], v[12:15], v[224:231], v1
s_nop 0
global_store_dwordx2 v44, v[48:49], s[52:53]
s_addc_u32 s59, s5, 0
s_mov_b32 s30, 0
v_smfmac_f32_16x16x64_bf16 v[32:35], v[12:15], v[248:255], v1
s_nop 2
v_cvt_pk_bf16_f32 v52, v52, v53
v_cvt_pk_bf16_f32 v53, v54, v55
s_mov_b32 s19, 1
v_and_or_b32 v52, v52, -2, s18
global_store_dwordx2 v44, v[52:53], s[54:55]
v_cvt_pk_bf16_f32 v32, v32, v33
v_cvt_pk_bf16_f32 v33, v34, v35
v_and_or_b32 v32, v32, -2, s18
global_store_dwordx2 v44, v[32:33], s[56:57]
s_cmp_ge_u32 s14, 16
s_cbranch_scc1 nored_10046
v_bfe_u32 v32, v0, 6, 1
v_lshlrev_b32 v32, 4, v32
v_mov_b32 v33, 0x3f80
v_lshlrev_b32 v32, v32, v33
v_bfe_i32 v33, v0, 4, 1
v_and_b32 v45, v32, v33
v_and_b32 v47, v32, v33
v_xor_b32 v44, v32, v45
v_xor_b32 v46, v32, v45
v_and_b32 v36, 32, v0
v_bfe_u32 v37, v0, 6, 1
v_lshl_add_u32 v36, v37, 8, v36
v_bfe_u32 v37, v0, 8, 1
v_lshl_add_u32 v36, v37, 4, v36
v_bfe_u32 v37, v0, 4, 1
v_lshl_add_u32 v36, v37, 3, v36
v_and_b32 v7, 255, v0
v_lshl_add_u32 v7, v7, 3, s27
s_nop 15
s_nop 15
s_nop 15
s_nop 15
s_nop 12
global_load_dwordx4 v[8:11], v0, s[64:65] offset:0 sc1
global_load_dwordx4 v[12:15], v0, s[64:65] offset:1024 sc1
global_load_dwordx4 v[16:19], v0, s[64:65] offset:2048 sc1
global_load_dwordx4 v[20:23], v0, s[64:65] offset:3072 sc1
s_nop 15
s_nop 15
s_nop 5
global_load_dwordx4 v[24:27], v0, s[64:65] offset:0 sc1
global_load_dwordx4 v[28:31], v0, s[64:65] offset:1024 sc1
global_load_dwordx4 v[48:51], v0, s[64:65] offset:2048 sc1
global_load_dwordx4 v[52:55], v0, s[64:65] offset:3072 sc1
chk_10048:
v_mov_b64 v[40:41], 0
v_mov_b64 v[42:43], 0
s_waitcnt vmcnt(6)
s_nop 0
v_smfmac_f32_16x16x64_bf16 v[40:43], v[44:47], v[8:15], v1
v_bitop3_b32 v32, v8, v10, s18 bitop3:0x7e
v_bitop3_b32 v33, v12, v14, s18 bitop3:0x7e
s_waitcnt vmcnt(4)
v_smfmac_f32_16x16x64_bf16 v[40:43], v[44:47], v[16:23], v1
v_bitop3_b32 v34, v16, v18, s18 bitop3:0x7e
v_bitop3_b32 v35, v20, v22, s18 bitop3:0x7e
v_or3_b32 v32, v32, v33, v34
v_bitop3_b32 v32, v32, v35, 1 bitop3:0xa8
v_cmp_ne_u32 vcc, 0, v32
s_cbranch_vccnz chk_10048_f
s_nop 1
v_add_f32_dpp v40, v40, v40 row_ror:8 row_mask:0xf bank_mask:0xf
v_add_f32_dpp v41, v41, v41 row_ror:8 row_mask:0xf bank_mask:0xf
v_add_f32_dpp v42, v42, v42 row_ror:8 row_mask:0xf bank_mask:0xf
v_add_f32_dpp v43, v43, v43 row_ror:8 row_mask:0xf bank_mask:0xf
v_cvt_pk_bf16_f32 v40, v40, v41
v_cvt_pk_bf16_f32 v41, v42, v43
v_and_or_b32 v40, v40, -2, s18
s_mov_b64 exec, 0x00ff00ff
global_store_dwordx2 v36, v[40:41], s[66:67]
s_mov_b64 exec, -1
s_branch join_10047
chk_10048_f:
global_load_dwordx4 v[8:11], v0, s[64:65] offset:0 sc1
global_load_dwordx4 v[12:15], v0, s[64:65] offset:1024 sc1
global_load_dwordx4 v[16:19], v0, s[64:65] offset:2048 sc1
global_load_dwordx4 v[20:23], v0, s[64:65] offset:3072 sc1
chk_10049:
v_mov_b64 v[40:41], 0
v_mov_b64 v[42:43], 0
s_waitcnt vmcnt(6)
s_nop 0
v_smfmac_f32_16x16x64_bf16 v[40:43], v[44:47], v[24:31], v1
v_bitop3_b32 v32, v24, v26, s18 bitop3:0x7e
v_bitop3_b32 v33, v28, v30, s18 bitop3:0x7e
s_waitcnt vmcnt(4)
v_smfmac_f32_16x16x64_bf16 v[40:43], v[44:47], v[48:55], v1
v_bitop3_b32 v34, v48, v50, s18 bitop3:0x7e
v_bitop3_b32 v35, v52, v54, s18 bitop3:0x7e
v_or3_b32 v32, v32, v33, v34
v_bitop3_b32 v32, v32, v35, 1 bitop3:0xa8
v_cmp_ne_u32 vcc, 0, v32
s_cbranch_vccnz chk_10049_f
s_nop 1
v_add_f32_dpp v40, v40, v40 row_ror:8 row_mask:0xf bank_mask:0xf
v_add_f32_dpp v41, v41, v41 row_ror:8 row_mask:0xf bank_mask:0xf
v_add_f32_dpp v42, v42, v42 row_ror:8 row_mask:0xf bank_mask:0xf
v_add_f32_dpp v43, v43, v43 row_ror:8 row_mask:0xf bank_mask:0xf
v_cvt_pk_bf16_f32 v40, v40, v41
v_cvt_pk_bf16_f32 v41, v42, v43
v_and_or_b32 v40, v40, -2, s18
s_mov_b64 exec, 0x00ff00ff
global_store_dwordx2 v36, v[40:41], s[66:67]
s_mov_b64 exec, -1
s_branch join_10047
chk_10049_f:
global_load_dwordx4 v[24:27], v0, s[64:65] offset:0 sc1
global_load_dwordx4 v[28:31], v0, s[64:65] offset:1024 sc1
global_load_dwordx4 v[48:51], v0, s[64:65] offset:2048 sc1
global_load_dwordx4 v[52:55], v0, s[64:65] offset:3072 sc1
s_add_u32 s30, s30, 1
s_cmp_le_u32 s30, 262144
s_cbranch_scc1 chk_10048
s_branch L_fail
nored_10046:
v_and_b32 v7, 255, v0
v_lshl_add_u32 v7, v7, 3, s27
join_10047:
s_barrier
global_load_dwordx4 v[56:59], v0, s[76:77] offset:0 sc1
global_load_dwordx4 v[60:63], v0, s[76:77] offset:1024 sc1
global_load_dwordx4 v[80:83], v0, s[76:77] offset:2048 sc1
global_load_dwordx4 v[84:87], v0, s[76:77] offset:3072 sc1
s_nop 15
s_nop 15
s_nop 3
s_barrier
global_load_dwordx4 v[32:35], v0, s[68:69] offset:-4096 sc1
s_nop 10
global_load_dwordx4 v[36:39], v0, s[68:69] offset:0 sc1
s_barrier
global_load_dwordx4 v[48:51], v0, s[58:59] offset:0 nt sc1
global_load_dwordx4 v[52:55], v0, s[58:59] offset:1024 nt sc1
s_waitcnt vmcnt(12)
v_mov_b64 v[8:9], 0
v_mov_b64 v[10:11], 0
s_waitcnt vmcnt(11)
v_mov_b64 v[12:13], 0
v_mov_b64 v[14:15], 0
s_waitcnt vmcnt(10)
v_mov_b64 v[16:17], 0
v_mov_b64 v[18:19], 0
s_waitcnt vmcnt(9)
v_mov_b64 v[20:21], 0
v_mov_b64 v[22:23], 0
v_mov_b64 v[24:25], 0
v_mov_b64 v[26:27], 0
v_mov_b64 v[28:29], 0
v_mov_b64 v[30:31], 0
s_mov_b32 s30, 0
s_cmp_eq_u32 s17, s31
s_cbranch_scc0 gather_10038
s_branch exit_10041
rt_10043:
global_load_dwordx4 v[32:35], v0, s[68:69] offset:-4096 sc1
global_load_dwordx4 v[36:39], v0, s[68:69] offset:0 sc1
s_add_u32 s30, s30, 1
s_cmp_gt_u32 s30, 262144
s_cbranch_scc1 L_fail
s_mov_b64 exec, 1
global_store_dword v0, v0, s[62:63]
global_store_dword v0, v0, s[62:63]
s_mov_b64 exec, -1
v_mov_b64 v[8:9], 0
v_mov_b64 v[10:11], 0
v_mov_b64 v[12:13], 0
v_mov_b64 v[14:15], 0
v_mov_b64 v[16:17], 0
v_mov_b64 v[18:19], 0
v_mov_b64 v[20:21], 0
v_mov_b64 v[22:23], 0
v_mov_b64 v[24:25], 0
v_mov_b64 v[26:27], 0
v_mov_b64 v[28:29], 0
v_mov_b64 v[30:31], 0
s_branch gather_10038
rare_10039:
ds_read_b128 v[48:51], v6 offset:6144
ds_read_b128 v[52:55], v6 offset:7168
s_waitcnt lgkmcnt(0)
v_add_f32 v48, v48, v52
v_add_f32 v49, v49, v53
v_add_f32 v50, v50, v54
v_add_f32 v51, v51, v55
v_mov_b32_dpp v46, v46 quad_perm:[0,1,0,1] row_mask:0xf bank_mask:0xf
v_mov_b32_dpp v47, v47 quad_perm:[0,1,0,1] row_mask:0xf bank_mask:0xf
v_max3_f32 v19, v48, v49, v50
v_max3_f32 v19, v19, v51, v46
v_max_f32 v19, v19, v47
s_nop 1
v_max_f32_dpp v19, v19, v19 quad_perm:[2,3,0,1] row_mask:0xf bank_mask:0xf
v_mov_b32 v44, v19
s_nop 1
v_permlane32_swap_b32 v19, v44
v_max_f32 v19, v19, v44
v_mov_b32 v44, v19
s_nop 1
v_permlane16_swap_b32 v19, v44
v_max_f32 v19, v19, v44
v_sub_f32 v48, v48, v19
v_sub_f32 v49, v49, v19
v_sub_f32 v50, v50, v19
v_sub_f32 v51, v51, v19
v_sub_f32 v46, v46, v19
v_sub_f32 v47, v47, v19
v_exp_f32 v48, v48
v_exp_f32 v49, v49
v_exp_f32 v50, v50
v_exp_f32 v51, v51
v_cvt_pk_bf16_f32 v54, v48, v49
v_cvt_pk_bf16_f32 v55, v50, v51
s_nop 0
v_mov_b32_dpp v48, v54 quad_perm:[0,1,0,1] row_mask:0xf bank_mask:0xf
v_mov_b32_dpp v49, v55 quad_perm:[0,1,0,1] row_mask:0xf bank_mask:0xf
v_mov_b32_dpp v50, v54 quad_perm:[2,3,2,3] row_mask:0xf bank_mask:0xf
v_mov_b32_dpp v51, v55 quad_perm:[2,3,2,3] row_mask:0xf bank_mask:0xf
v_mov_b64 v[20:21], s[44:45]
v_mov_b64 v[22:23], s[44:45]
v_mfma_f32_16x16x32_bf16 v[8:11], v[56:59], v[48:51], 0
v_mfma_f32_16x16x32_bf16 v[12:15], v[60:63], v[48:51], 0
v_mfma_f32_16x16x32_bf16 v[16:19], v[20:23], v[48:51], 0
v_mov_b64 v[54:55], s[46:47]
v_exp_f32_dpp v44, v46 quad_perm:[0,1,0,1] row_mask:0xf bank_mask:0xf
v_exp_f32_dpp v45, v47 quad_perm:[0,1,0,1] row_mask:0xf bank_mask:0xf
s_nop 0
v_cvt_pk_bf16_f32 v52, v44, v45
v_cvt_pk_bf16_f32 v53, v44, v45
s_nop 1
v_mfma_f32_16x16x16_bf16 v[16:19], v[54:55], v[52:53], v[16:19]
v_mfma_f32_16x16x16_bf16 v[8:11], v[24:25], v[52:53], v[8:11]
v_mfma_f32_16x16x16_bf16 v[12:15], v[26:27], v[52:53], v[12:15]
s_nop 5
v_rcp_f32 v18, v16
s_nop 0
v_cndmask_b32 v8, v12, v8, s[42:43]
v_mul_f32 v8, v8, v18
v_cndmask_b32 v9, v13, v9, s[42:43]
v_mul_f32 v9, v9, v18
v_cndmask_b32 v10, v14, v10, s[42:43]
v_mul_f32 v10, v10, v18
v_cndmask_b32 v11, v15, v11, s[42:43]
v_mul_f32 v11, v11, v18
v_cvt_pk_bf16_f32 v12, v8, v9
v_cvt_pk_bf16_f32 v13, v10, v11
s_branch back_10040
exit_10041:
global_load_dwordx4 v[32:35], v0, s[68:69] offset:-4096 sc1
global_load_dwordx4 v[36:39], v0, s[68:69] offset:0 sc1
s_add_u32 s30, s30, 1
s_cmp_gt_u32 s30, 262144
s_cbranch_scc1 L_fail
s_waitcnt vmcnt(1)
v_bitop3_b32 v44, v32, v34, s18 bitop3:0x7e
s_waitcnt vmcnt(0)
v_bitop3_b32 v45, v36, v38, s18 bitop3:0x7e
v_bitop3_b32 v44, v44, v45, s19 bitop3:0xa8
v_cmp_ne_u32 vcc, 0, v44
s_cbranch_vccnz exit_10041
s_add_u32 s36, s36, 1
s_cmp_lt_u32 s36, 2
s_cbranch_scc1 layer_10037
s_endpgm
wave_10008:
layer_10050:
s_lshl_b32 s17, s36, 6
s_mul_i32 s27, s36, 35651584
s_mul_i32 s28, s14, 16384
s_add_u32 s27, s27, s28
s_add_u32 s20, s27, 16789504
s_mul_i32 s27, s17, 10240
s_add_u32 s27, s27, s24
s_add_u32 s21, s27, s25
s_mov_b32 s19, 0
s_mov_b32 s33, s6
s_add_u32 s34, s17, 1
s_add_u32 s31, s17, 63
s_add_u32 s32, s17, 64
s_mov_b32 s27, s20
v_mov_b32 v7, 0
s_add_u32 s68, s4, 416768
s_addc_u32 s69, s5, 0
s_add_u32 s72, s4, 400384
s_addc_u32 s73, s5, 0
s_add_u32 s70, s4, 420864
s_addc_u32 s71, s5, 0
s_add_u32 s74, s4, 404480
s_addc_u32 s75, s5, 0
s_add_u32 s58, s4, s20
s_addc_u32 s59, s5, 0
global_load_dwordx4 v[64:67], v0, s[76:77] offset:-4096 sc1
global_load_dwordx4 v[68:71], v0, s[76:77] offset:-3072 sc1
global_load_dwordx4 v[72:75], v0, s[76:77] offset:-2048 sc1
global_load_dwordx4 v[76:79], v0, s[76:77] offset:-1024 sc1
global_load_dwordx4 v[80:83], v0, s[76:77] offset:2048 sc1
global_load_dwordx4 v[84:87], v0, s[76:77] offset:3072 sc1
global_load_dwordx4 v[56:59], v0, s[76:77] offset:0 sc1
global_load_dwordx4 v[60:63], v0, s[76:77] offset:1024 sc1
v_mov_b64 v[8:9], 0
v_mov_b64 v[10:11], 0
v_mov_b64 v[12:13], 0
v_mov_b64 v[14:15], 0
v_mov_b64 v[16:17], 0
v_mov_b64 v[18:19], 0
v_mov_b64 v[20:21], 0
v_mov_b64 v[22:23], 0
v_mov_b64 v[24:25], 0
v_mov_b64 v[26:27], 0
v_mov_b64 v[28:29], 0
v_mov_b64 v[30:31], 0
s_barrier
global_load_dwordx4 v[48:51], v0, s[58:59] offset:0 nt sc1
global_load_dwordx4 v[52:55], v0, s[58:59] offset:1024 nt sc1
v_bfe_u32 v7, v0, 2, 3
v_add_u32 v7, s22, v7
s_mov_b32 exec_hi, 0
v_and_b32 v7, 255, v0
v_lshl_add_u32 v7, v7, 3, s27
s_mov_b32 exec_hi, -1
global_load_dwordx4 v[32:35], v0, s[68:69] offset:-4096 sc1
global_load_dwordx4 v[36:39], v0, s[68:69] offset:0 sc1
s_mov_b32 s30, 0
s_waitcnt vmcnt(0)
.p2align 6
gather_10051:
s_waitcnt vmcnt(3)
rt_10056_b:
v_smfmac_f32_16x16x64_bf16 v[24:27], v[32:35], a[0:7], v1
ds_write_b128 v0, v[32:35] offset:3072
v_smfmac_f32_16x16x64_bf16 v[8:11], v[32:35], v[64:71], v1
v_bitop3_b32 v44, v32, v34, s18 bitop3:0x7e
v_smfmac_f32_16x16x64_bf16 v[12:15], v[32:35], v[72:79], v1
s_waitcnt vmcnt(2)
ds_write_b128 v0, v[36:39] offset:7168
v_bitop3_b32 v45, v36, v38, s18 bitop3:0x7e
v_bitop3_b32 v44, v44, v45, s19 bitop3:0xa8
v_cmp_ne_u32 vcc, 0, v44
v_smfmac_f32_16x16x64_bf16 v[8:11], v[36:39], a[16:23], v1
v_smfmac_f32_16x16x64_bf16 v[20:23], v[32:35], v[80:87], v1
s_cbranch_vccnz rt_10056
global_load_dwordx4 v[64:67], v0, s[78:79] offset:-4096 sc1
ds_read_b128 v[80:83], v2 offset:0
v_smfmac_f32_16x16x64_bf16 v[28:31], v[32:35], a[8:15], v1
global_load_dwordx4 v[68:71], v0, s[78:79] offset:-3072 sc1
ds_read_b128 v[84:87], v2 offset:1024
v_smfmac_f32_16x16x64_bf16 v[20:23], v[36:39], a[40:47], v1
global_load_dwordx4 v[72:75], v0, s[78:79] offset:-2048 sc1
global_load_dwordx4 v[76:79], v0, s[78:79] offset:-1024 sc1
v_smfmac_f32_16x16x64_bf16 v[16:19], v[32:35], v[56:63], v1
s_waitcnt lgkmcnt(2)
s_barrier
ds_read_b128 v[40:43], v0 offset:2048
v_smfmac_f32_16x16x64_bf16 v[16:19], v[36:39], a[32:39], v1
s_waitcnt lgkmcnt(1)
ds_read_b128 v[44:47], v0 offset:6144
v_smfmac_f32_16x16x64_bf16 v[28:31], v[36:39], v[80:87], v1
s_xor_b32 s18, s18, 1
ds_read_b128 v[32:35], v0 offset:1024
v_smfmac_f32_16x16x64_bf16 v[24:27], v[36:39], a[48:55], v1
s_add_u32 s20, s20, 524288
ds_read_b128 v[84:87], v2 offset:3072
v_smfmac_f32_16x16x64_bf16 v[12:15], v[36:39], a[24:31], v1
ds_read_b128 v[80:83], v2 offset:2048
s_waitcnt lgkmcnt(4)
v_smfmac_f32_16x16x64_bf16 v[12:15], v[40:43], a[64:71], v1
ds_read_b128 v[36:39], v0 offset:5120
v_smfmac_f32_16x16x64_bf16 v[8:11], v[40:43], a[56:63], v1
s_waitcnt lgkmcnt(4)
ds_read_b128 v[40:43], v0 offset:0
s_waitcnt lgkmcnt(4)
v_smfmac_f32_16x16x64_bf16 v[12:15], v[44:47], a[80:87], v1
s_add_u32 s17, s17, 1
global_load_dwordx4 v[56:59], v0, s[58:59] offset:2048 nt sc1
v_smfmac_f32_16x16x64_bf16 v[8:11], v[44:47], a[72:79], v1
s_waitcnt lgkmcnt(3)
ds_read_b128 v[44:47], v0 offset:4096
s_waitcnt lgkmcnt(3)
v_smfmac_f32_16x16x64_bf16 v[12:15], v[32:35], v[80:87], v1
ds_read_b128 v[80:83], v2 offset:4096
v_smfmac_f32_16x16x64_bf16 v[8:11], v[32:35], a[88:95], v1
s_waitcnt lgkmcnt(3)
ds_read_b128 v[84:87], v2 offset:5120
s_add_u32 s21, s21, 10240
v_smfmac_f32_16x16x64_bf16 v[12:15], v[36:39], a[104:111], v1
ds_read_b128 v[32:35], v0 offset:9216
v_smfmac_f32_16x16x64_bf16 v[8:11], v[36:39], a[96:103], v1
s_waitcnt lgkmcnt(4)
s_waitcnt lgkmcnt(3)
ds_read_b128 v[36:39], v0 offset:8192
v_smfmac_f32_16x16x64_bf16 v[12:15], v[40:43], a[120:127], v1
global_load_dwordx4 v[60:63], v0, s[58:59] offset:3072 nt sc1
v_smfmac_f32_16x16x64_bf16 v[8:11], v[40:43], a[112:119], v1
s_waitcnt lgkmcnt(2)
ds_read_b128 v[40:43], v0 offset:2048
v_smfmac_f32_16x16x64_bf16 v[12:15], v[44:47], v[80:87], v1
s_waitcnt lgkmcnt(2)
ds_read_b128 v[84:87], v2 offset:7168
v_smfmac_f32_16x16x64_bf16 v[8:11], v[44:47], a[128:135], v1
ds_read_b128 v[80:83], v2 offset:6144
s_waitcnt lgkmcnt(3)
v_smfmac_f32_16x16x64_bf16 v[12:15], v[32:35], a[144:151], v1
s_waitcnt vmcnt(5)
global_load_dword v7, v7, s[4:5] sc1
v_smfmac_f32_16x16x64_bf16 v[8:11], v[32:35], a[136:143], v1
s_mov_b64 s[68:69], s[72:73]
ds_read_b128 v[32:35], v0 offset:6144
s_waitcnt vmcnt(5)
v_smfmac_f32_16x16x64_bf16 v[8:11], v[36:39], v[64:71], v1
ds_read_b128 v[68:71], v2 offset:9216
s_waitcnt lgkmcnt(3)
ds_read_b128 v[64:67], v2 offset:8192
v_smfmac_f32_16x16x64_bf16 v[12:15], v[36:39], a[152:159], v1
s_waitcnt lgkmcnt(3)
ds_read_b128 v[36:39], v0 offset:1024
v_smfmac_f32_16x16x64_bf16 v[20:23], v[40:43], v[80:87], v1
ds_read_b128 v[84:87], v2 offset:11264
v_add_f32 v9, v9, v11
v_smfmac_f32_16x16x64_bf16 v[16:19], v[40:43], a[160:167], v1
s_waitcnt lgkmcnt(4)
ds_read_b128 v[40:43], v0 offset:5120
v_add_f32 v12, v12, v14
v_smfmac_f32_16x16x64_bf16 v[16:19], v[32:35], a[168:175], v1
s_waitcnt vmcnt(4)
ds_read_b128 v[80:83], v2 offset:10240
v_mul_f32 v12, s35, v12
v_add_f32 v13, v13, v15
v_mul_f32 v9, s35, v9
v_add_f32 v8, v8, v10
v_mul_f32 v8, s35, v8
v_smfmac_f32_16x16x64_bf16 v[20:23], v[32:35], a[176:183], v1
s_waitcnt lgkmcnt(3)
ds_read_b128 v[32:35], v0 offset:0
v_cvt_pk_bf16_f32 v8, v8, v9
v_smfmac_f32_16x16x64_bf16 v[16:19], v[36:39], v[64:71], v1
s_add_u32 s34, s17, 2
ds_read_b128 v[64:67], v2 offset:12288
ds_read_b128 v[68:71], v2 offset:13312
v_mul_f32 v13, s35, v13
v_cvt_pk_bf16_f32 v12, v12, v13
v_smfmac_f32_16x16x64_bf16 v[20:23], v[36:39], a[184:191], v1
s_waitcnt lgkmcnt(4)
ds_read_b128 v[36:39], v0 offset:4096
s_waitcnt vmcnt(3)
ds_write2_b32 v3, v8, v12 offset0:0 offset1:128
v_smfmac_f32_16x16x64_bf16 v[16:19], v[40:43], v[72:79], v1
s_waitcnt lgkmcnt(4)
ds_read_b128 v[72:75], v2 offset:14336
v_smfmac_f32_16x16x64_bf16 v[20:23], v[40:43], v[80:87], v1
ds_read_b128 v[80:83], v2 offset:16384
v_smfmac_f32_16x16x64_bf16 v[20:23], v[32:35], a[200:207], v1
ds_read_b128 v[40:43], v0 offset:9216
s_waitcnt lgkmcnt(5)
v_smfmac_f32_16x16x64_bf16 v[16:19], v[32:35], a[192:199], v1
ds_read_b128 v[76:79], v2 offset:15360
s_waitcnt lgkmcnt(5)
ds_read_b128 v[84:87], v2 offset:17408
v_smfmac_f32_16x16x64_bf16 v[16:19], v[36:39], v[64:71], v1
s_waitcnt lgkmcnt(5)
ds_read_b128 v[32:35], v0 offset:8192
s_barrier
ds_read_b64_tr_b16 v[10:11], v4 offset:2560
v_smfmac_f32_16x16x64_bf16 v[20:23], v[36:39], a[208:215], v1
ds_read_b64_tr_b16 v[8:9], v4 offset:2048
s_waitcnt lgkmcnt(5)
ds_read_b64_tr_b16 v[12:13], v4 offset:3072
v_smfmac_f32_16x16x64_bf16 v[20:23], v[40:43], a[216:223], v1
s_waitcnt lgkmcnt(5)
ds_read_b64_tr_b16 v[14:15], v4 offset:3584
s_mov_b64 vcc, s[42:43]
ds_read_b128 v[68:71], v2 offset:19456
v_smfmac_f32_16x16x64_bf16 v[16:19], v[40:43], v[72:79], v1
ds_read_b128 v[36:39], v0 offset:9216
s_waitcnt lgkmcnt(6)
v_smfmac_f32_16x16x64_bf16 v[20:23], v[32:35], v[80:87], v1
s_waitcnt lgkmcnt(5)
ds_read_b128 v[64:67], v2 offset:18432
ds_read_b128 v[40:43], v0 offset:8192
v_smfmac_f32_16x16x64_bf16 v[16:19], v[32:35], a[224:231], v1
s_waitcnt lgkmcnt(5)
ds_read_b128 v[72:75], v2 offset:20480
ds_read_b128 v[32:35], v0 offset:2048
v_mfma_f32_16x16x32_bf16 v[44:47], v[48:51], v[8:11], 0
s_waitcnt lgkmcnt(6)
ds_read_b128 v[76:79], v2 offset:21504
v_bfe_u32 v48, v0, 5, 1
v_add_f32 v21, v21, v23
v_add_f32 v17, v17, v19
v_mfma_f32_16x16x32_bf16 v[44:47], v[52:55], v[12:15], v[44:47]
s_waitcnt lgkmcnt(5)
ds_read_b128 v[80:83], v2 offset:22528
v_lshl_add_u32 v48, v48, 3, v5
v_add_f32 v16, v16, v18
v_cvt_pk_bf16_f32 v16, v16, v17
v_add_f32 v20, v20, v22
v_cvt_pk_bf16_f32 v20, v20, v21
v_smfmac_f32_16x16x64_bf16 v[28:31], v[36:39], a[232:239], v1
s_waitcnt lgkmcnt(4)
ds_write2_b32 v3, v16, v20 offset0:1 offset1:129
v_cndmask_b32_dpp v44, v46, v44, vcc quad_perm:[0,1,0,1] row_mask:0xf bank_mask:0xf
v_xor_b32 v48, 128, v48
v_cndmask_b32_dpp v45, v47, v45, vcc quad_perm:[0,1,0,1] row_mask:0xf bank_mask:0xf
v_smfmac_f32_16x16x64_bf16 v[24:27], v[36:39], v[64:71], v1
ds_write_b64 v48, v[44:45] offset:7680
v_smfmac_f32_16x16x64_bf16 v[24:27], v[40:43], a[240:247], v1
s_waitcnt lgkmcnt(3)
global_load_dwordx4 v[64:67], v0, s[78:79] offset:0 sc1
ds_read_b128 v[84:87], v2 offset:23552
v_smfmac_f32_16x16x64_bf16 v[28:31], v[40:43], v[72:79], v1
s_waitcnt lgkmcnt(3)
ds_read_b128 v[36:39], v0 offset:6144
global_load_dwordx4 v[68:71], v0, s[78:79] offset:1024 sc1
v_smfmac_f32_16x16x64_bf16 v[24:27], v[32:35], a[248:255], v1
global_load_dwordx4 v[72:75], v0, s[78:79] offset:2048 sc1
ds_read_b128 v[40:43], v0 offset:1024
v_smfmac_f32_16x16x64_bf16 v[28:31], v[32:35], v[88:95], v1
s_waitcnt lgkmcnt(3)
ds_read_b128 v[32:35], v0 offset:5120
s_barrier
ds_read_b128 v[52:55], v6 offset:7168
s_waitcnt lgkmcnt(3)
v_smfmac_f32_16x16x64_bf16 v[28:31], v[36:39], v[96:103], v1
ds_read_b128 v[48:51], v6 offset:6144
ds_read_b64_tr_b16 v[8:9], v4 offset:0
v_smfmac_f32_16x16x64_bf16 v[24:27], v[36:39], v[80:87], v1
s_waitcnt lgkmcnt(4)
ds_read_b128 v[36:39], v0 offset:0
global_load_dwordx4 v[76:79], v0, s[78:79] offset:3072 sc1
ds_read_b64_tr_b16 v[10:11], v4 offset:512
v_smfmac_f32_16x16x64_bf16 v[28:31], v[40:43], v[112:119], v1
s_waitcnt lgkmcnt(5)
ds_read_b64_tr_b16 v[14:15], v4 offset:1536
ds_read_b64_tr_b16 v[18:19], v4 offset:2560
v_smfmac_f32_16x16x64_bf16 v[24:27], v[40:43], v[104:111], v1
s_waitcnt lgkmcnt(6)
ds_read_b64_tr_b16 v[12:13], v4 offset:1024
ds_read_b64_tr_b16 v[16:17], v4 offset:2048
v_smfmac_f32_16x16x64_bf16 v[28:31], v[32:35], v[128:135], v1
s_waitcnt lgkmcnt(7)
ds_read_b64_tr_b16 v[22:23], v4 offset:3584
v_add_f32 v50, v50, v54
v_add_f32 v49, v49, v53
v_smfmac_f32_16x16x64_bf16 v[24:27], v[32:35], v[120:127], v1
s_waitcnt lgkmcnt(6)
ds_read_b128 v[40:43], v0 offset:4096
v_add_f32 v48, v48, v52
v_smfmac_f32_16x16x64_bf16 v[24:27], v[36:39], v[136:143], v1
s_waitcnt lgkmcnt(5)
ds_read_b64_tr_b16 v[20:21], v4 offset:3072
v_add_f32 v51, v51, v55
v_smfmac_f32_16x16x64_bf16 v[28:31], v[36:39], v[144:151], v1
s_waitcnt lgkmcnt(4)
global_load_dwordx4 v[80:83], v0, s[80:81] offset:-4096 sc1
v_exp_f32 v51, v51
v_mfma_f32_16x16x32_bf16 v[44:47], v[8:11], v[8:11], 0
s_waitcnt lgkmcnt(3)
v_exp_f32 v49, v49
v_mfma_f32_16x16x32_bf16 v[44:47], v[12:15], v[12:15], v[44:47]
s_waitcnt lgkmcnt(1)
v_exp_f32 v50, v50
v_exp_f32 v48, v48
v_mfma_f32_16x16x32_bf16 v[44:47], v[16:19], v[16:19], v[44:47]
s_waitcnt lgkmcnt(0)
v_cvt_pk_bf16_f32 v54, v48, v49
v_cvt_pk_bf16_f32 v55, v50, v51
v_mfma_f32_16x16x32_bf16 v[44:47], v[20:23], v[20:23], v[44:47]
s_nop 0
v_mov_b32_dpp v51, v55 quad_perm:[2,3,2,3] row_mask:0xf bank_mask:0xf
v_mov_b32_dpp v50, v54 quad_perm:[2,3,2,3] row_mask:0xf bank_mask:0xf
v_smfmac_f32_16x16x64_bf16 v[24:27], v[40:43], v[152:159], v1
v_mov_b32_dpp v49, v55 quad_perm:[0,1,0,1] row_mask:0xf bank_mask:0xf
v_mov_b64 v[22:23], s[44:45]
v_mov_b32_dpp v48, v54 quad_perm:[0,1,0,1] row_mask:0xf bank_mask:0xf
v_mov_b64 v[20:21], s[44:45]
v_smfmac_f32_16x16x64_bf16 v[28:31], v[40:43], v[160:167], v1
s_waitcnt vmcnt(7)
global_load_dwordx4 v[84:87], v0, s[80:81] offset:-3072 sc1
v_exp_f32_dpp v44, v46 quad_perm:[0,1,0,1] row_mask:0xf bank_mask:0xf
v_mfma_f32_16x16x32_bf16 v[8:11], v[56:59], v[48:51], 0
v_exp_f32_dpp v45, v47 quad_perm:[0,1,0,1] row_mask:0xf bank_mask:0xf
v_mfma_f32_16x16x32_bf16 v[16:19], v[20:23], v[48:51], 0
s_waitcnt vmcnt(7)
v_cvt_pk_bf16_f32 v52, v44, v45
v_mov_b64 v[54:55], s[46:47]
v_mfma_f32_16x16x32_bf16 v[12:15], v[60:63], v[48:51], 0
v_cvt_pk_bf16_f32 v53, v44, v45
v_cvt_pk_bf16_f32 v24, v24, v25
v_cvt_pk_bf16_f32 v25, v26, v27
v_mfma_f32_16x16x16_bf16 v[16:19], v[54:55], v[52:53], v[16:19]
s_min_u32 s34, s34, s32
v_cvt_pk_bf16_f32 v27, v30, v31
v_cvt_pk_bf16_f32 v26, v28, v29
v_mfma_f32_16x16x16_bf16 v[8:11], v[24:25], v[52:53], v[8:11]
ds_read_b128 v[28:31], v0 offset:56320
v_mov_b64 v[38:39], 0
v_mfma_f32_16x16x16_bf16 v[12:15], v[26:27], v[52:53], v[12:15]
s_waitcnt vmcnt(4)
v_mov_b64 v[36:37], 0
v_bfe_u32 v32, v0, 5, 1
v_rcp_f32 v18, v16
v_subrev_u32 v17, s37, v16
v_cmp_lt_u32 vcc, s38, v17
v_lshl_add_u32 v32, v32, 3, v5
v_mov_b64 v[42:43], 0
v_cndmask_b32 v11, v15, v11, s[42:43]
v_cndmask_b32 v8, v12, v8, s[42:43]
v_cndmask_b32 v10, v14, v10, s[42:43]
v_mul_f32 v11, v11, v18
v_mul_f32 v8, v8, v18
v_cndmask_b32 v9, v13, v9, s[42:43]
v_mul_f32 v9, v9, v18
v_mul_f32 v10, v10, v18
v_cvt_pk_bf16_f32 v12, v8, v9
v_cvt_pk_bf16_f32 v13, v10, v11
s_cbranch_vccnz rare_10052
back_10053:
ds_write_b64 v32, v[12:13] offset:1536
v_mov_b32_dpp v11, v13 quad_perm:[2,3,2,3] row_mask:0xf bank_mask:0xf
v_mov_b32_dpp v9, v13 quad_perm:[0,1,0,1] row_mask:0xf bank_mask:0xf
v_mov_b32_dpp v8, v12 quad_perm:[0,1,0,1] row_mask:0xf bank_mask:0xf
v_mov_b32_dpp v10, v12 quad_perm:[2,3,2,3] row_mask:0xf bank_mask:0xf
v_mov_b64 v[52:53], 0
v_mov_b64 v[34:35], 0
v_smfmac_f32_16x16x64_bf16 v[36:39], v[8:11], v[64:71], v1
s_waitcnt vmcnt(2)
global_load_dwordx4 v[64:67], v0, s[76:77] offset:-4096 sc1
ds_read_b128 v[20:23], v0 offset:54272
ds_read_b128 v[24:27], v0 offset:55296
v_mov_b64 v[54:55], 0
v_mov_b64 v[32:33], 0
v_mov_b64 v[40:41], 0
v_smfmac_f32_16x16x64_bf16 v[52:55], v[8:11], v[176:183], v1
s_waitcnt lgkmcnt(2)
ds_read_b128 v[16:19], v0 offset:53248
s_barrier
ds_read_b128 v[56:59], v5 offset:1024
global_load_dwordx4 v[68:71], v0, s[76:77] offset:-3072 sc1
ds_read_b128 v[60:63], v5 offset:512
v_smfmac_f32_16x16x64_bf16 v[40:43], v[8:11], v[72:79], v1
s_waitcnt vmcnt(2)
ds_read_b128 v[12:15], v5 offset:0
v_mov_b64 v[50:51], 0
v_mov_b64 v[48:49], 0
v_smfmac_f32_16x16x64_bf16 v[32:35], v[8:11], v[80:87], v1
global_load_dwordx4 v[72:75], v0, s[76:77] offset:-2048 sc1
ds_read_b128 v[80:83], v0 offset:57344
v_smfmac_f32_16x16x64_bf16 v[48:51], v[8:11], v[168:175], v1
s_waitcnt lgkmcnt(3)
ds_read_b128 v[84:87], v0 offset:58368
v_smfmac_f32_16x16x64_bf16 v[40:43], v[56:59], v[192:199], v1
global_load_dwordx4 v[76:79], v0, s[76:77] offset:-1024 sc1
v_smfmac_f32_16x16x64_bf16 v[36:39], v[56:59], v[16:23], v1
s_waitcnt lgkmcnt(3)
ds_read_b128 v[16:19], v0 offset:59392
v_lshrrev_b32 v44, 8, v0
v_smfmac_f32_16x16x64_bf16 v[36:39], v[60:63], v[24:31], v1
s_waitcnt lgkmcnt(3)
ds_read_b128 v[20:23], v0 offset:60416
v_bfe_u32 v45, v0, 1, 7
v_smfmac_f32_16x16x64_bf16 v[36:39], v[12:15], v[184:191], v1
ds_read_b128 v[28:31], v0 offset:62464
s_waitcnt lgkmcnt(3)
v_smfmac_f32_16x16x64_bf16 v[40:43], v[60:63], v[80:87], v1
ds_read_b128 v[24:27], v0 offset:61440
v_lshl_or_b32 v44, v44, 12, v45
v_smfmac_f32_16x16x64_bf16 v[40:43], v[12:15], v[200:207], v1
s_nop 0
ds_read_b128 v[80:83], v0 offset:63488
v_cvt_pk_bf16_f32 v36, v36, v37
v_smfmac_f32_16x16x64_bf16 v[32:35], v[56:59], v[232:239], v1
ds_read_b128 v[84:87], v0 offset:64512
v_and_or_b32 v36, v36, -2, s18
v_cvt_pk_bf16_f32 v37, v38, v39
v_smfmac_f32_16x16x64_bf16 v[52:55], v[56:59], v[216:223], v1
s_waitcnt lgkmcnt(4)
global_store_dwordx2 v44, v[36:37], s[48:49]
s_waitcnt lgkmcnt(3)
v_cvt_pk_bf16_f32 v40, v40, v41
v_cvt_pk_bf16_f32 v41, v42, v43
v_smfmac_f32_16x16x64_bf16 v[48:51], v[56:59], v[16:23], v1
s_waitcnt lgkmcnt(2)
s_add_u32 s27, s20, 524288
v_and_or_b32 v40, v40, -2, s18
v_smfmac_f32_16x16x64_bf16 v[48:51], v[60:63], v[24:31], v1
global_store_dwordx2 v44, v[40:41], s[50:51]
s_waitcnt lgkmcnt(0)
v_smfmac_f32_16x16x64_bf16 v[48:51], v[12:15], v[208:215], v1
s_add_u32 s58, s4, s20
v_smfmac_f32_16x16x64_bf16 v[32:35], v[60:63], v[240:247], v1
s_nop 2
v_smfmac_f32_16x16x64_bf16 v[52:55], v[60:63], v[80:87], v1
s_nop 1
v_cvt_pk_bf16_f32 v48, v48, v49
v_and_or_b32 v48, v48, -2, s18
v_cvt_pk_bf16_f32 v49, v50, v51
v_smfmac_f32_16x16x64_bf16 v[52:55], v[12:15], v[224:231], v1
s_nop 0
global_store_dwordx2 v44, v[48:49], s[52:53]
s_addc_u32 s59, s5, 0
s_mov_b32 s30, 0
v_smfmac_f32_16x16x64_bf16 v[32:35], v[12:15], v[248:255], v1
s_nop 2
v_cvt_pk_bf16_f32 v52, v52, v53
v_cvt_pk_bf16_f32 v53, v54, v55
s_mov_b32 s19, 1
v_and_or_b32 v52, v52, -2, s18
global_store_dwordx2 v44, v[52:53], s[54:55]
v_cvt_pk_bf16_f32 v32, v32, v33
v_cvt_pk_bf16_f32 v33, v34, v35
v_and_or_b32 v32, v32, -2, s18
global_store_dwordx2 v44, v[32:33], s[56:57]
nored_10059:
v_cmp_gt_u32 vcc, s34, v7
s_cmp_eq_u32 vcc_hi, 0
s_cbranch_scc1 kv_10063
s_mov_b32 s30, 0
kv_10062:
v_bfe_u32 v7, v0, 2, 3
buffer_load_dword v7, v7, s[4:7], s22 offen sc1
s_add_u32 s30, s30, 1
s_cmp_gt_u32 s30, 262144
s_cbranch_scc1 L_fail
s_waitcnt vmcnt(0)
v_cmp_gt_u32 vcc, s34, v7
s_cbranch_vccnz kv_10062
kv_10063:
v_bfe_u32 v7, v0, 2, 3
v_add_u32 v7, s22, v7
s_mov_b32 exec_hi, 0
v_and_b32 v7, 255, v0
v_lshl_add_u32 v7, v7, 3, s27
s_mov_b32 exec_hi, -1
s_nop 15
s_nop 15
s_nop 15
s_nop 15
s_nop 15
s_nop 1
global_load_dwordx4 v[56:59], v0, s[76:77] offset:0 sc1
global_load_dwordx4 v[60:63], v0, s[76:77] offset:1024 sc1
global_load_dwordx4 v[80:83], v0, s[76:77] offset:2048 sc1
global_load_dwordx4 v[84:87], v0, s[76:77] offset:3072 sc1
join_10060:
s_barrier
s_nop 15
s_nop 15
s_nop 7
s_barrier
global_load_dwordx4 v[32:35], v0, s[68:69] offset:-4096 sc1
s_nop 10
global_load_dwordx4 v[36:39], v0, s[68:69] offset:0 sc1
s_barrier
global_load_dwordx4 v[48:51], v0, s[58:59] offset:0 nt sc1
global_load_dwordx4 v[52:55], v0, s[58:59] offset:1024 nt sc1
v_mov_b64 v[8:9], 0
v_mov_b64 v[10:11], 0
v_mov_b64 v[12:13], 0
v_mov_b64 v[14:15], 0
v_mov_b64 v[16:17], 0
v_mov_b64 v[18:19], 0
v_mov_b64 v[20:21], 0
v_mov_b64 v[22:23], 0
v_mov_b64 v[24:25], 0
v_mov_b64 v[26:27], 0
v_mov_b64 v[28:29], 0
v_mov_b64 v[30:31], 0
s_mov_b32 s30, 0
s_cmp_eq_u32 s17, s31
s_cbranch_scc0 gather_10051
s_branch exit_10054
rt_10056:
global_load_dwordx4 v[32:35], v0, s[68:69] offset:-4096 sc1
global_load_dwordx4 v[36:39], v0, s[68:69] offset:0 sc1
s_add_u32 s30, s30, 1
s_cmp_gt_u32 s30, 262144
s_cbranch_scc1 L_fail
s_mov_b64 exec, 1
global_store_dword v0, v0, s[62:63]
global_store_dword v0, v0, s[62:63]
s_mov_b64 exec, -1
v_mov_b64 v[8:9], 0
v_mov_b64 v[10:11], 0
v_mov_b64 v[12:13], 0
v_mov_b64 v[14:15], 0
v_mov_b64 v[16:17], 0
v_mov_b64 v[18:19], 0
v_mov_b64 v[20:21], 0
v_mov_b64 v[22:23], 0
v_mov_b64 v[24:25], 0
v_mov_b64 v[26:27], 0
v_mov_b64 v[28:29], 0
v_mov_b64 v[30:31], 0
s_branch gather_10051
rare_10052:
ds_read_b128 v[48:51], v6 offset:6144
ds_read_b128 v[52:55], v6 offset:7168
s_waitcnt lgkmcnt(0)
v_add_f32 v48, v48, v52
v_add_f32 v49, v49, v53
v_add_f32 v50, v50, v54
v_add_f32 v51, v51, v55
v_mov_b32_dpp v46, v46 quad_perm:[0,1,0,1] row_mask:0xf bank_mask:0xf
v_mov_b32_dpp v47, v47 quad_perm:[0,1,0,1] row_mask:0xf bank_mask:0xf
v_max3_f32 v19, v48, v49, v50
v_max3_f32 v19, v19, v51, v46
v_max_f32 v19, v19, v47
s_nop 1
v_max_f32_dpp v19, v19, v19 quad_perm:[2,3,0,1] row_mask:0xf bank_mask:0xf
v_mov_b32 v44, v19
s_nop 1
v_permlane32_swap_b32 v19, v44
v_max_f32 v19, v19, v44
v_mov_b32 v44, v19
s_nop 1
v_permlane16_swap_b32 v19, v44
v_max_f32 v19, v19, v44
v_sub_f32 v48, v48, v19
v_sub_f32 v49, v49, v19
v_sub_f32 v50, v50, v19
v_sub_f32 v51, v51, v19
v_sub_f32 v46, v46, v19
v_sub_f32 v47, v47, v19
v_exp_f32 v48, v48
v_exp_f32 v49, v49
v_exp_f32 v50, v50
v_exp_f32 v51, v51
v_cvt_pk_bf16_f32 v54, v48, v49
v_cvt_pk_bf16_f32 v55, v50, v51
s_nop 0
v_mov_b32_dpp v48, v54 quad_perm:[0,1,0,1] row_mask:0xf bank_mask:0xf
v_mov_b32_dpp v49, v55 quad_perm:[0,1,0,1] row_mask:0xf bank_mask:0xf
v_mov_b32_dpp v50, v54 quad_perm:[2,3,2,3] row_mask:0xf bank_mask:0xf
v_mov_b32_dpp v51, v55 quad_perm:[2,3,2,3] row_mask:0xf bank_mask:0xf
v_mov_b64 v[20:21], s[44:45]
v_mov_b64 v[22:23], s[44:45]
v_mfma_f32_16x16x32_bf16 v[8:11], v[56:59], v[48:51], 0
v_mfma_f32_16x16x32_bf16 v[12:15], v[60:63], v[48:51], 0
v_mfma_f32_16x16x32_bf16 v[16:19], v[20:23], v[48:51], 0
v_mov_b64 v[54:55], s[46:47]
v_exp_f32_dpp v44, v46 quad_perm:[0,1,0,1] row_mask:0xf bank_mask:0xf
v_exp_f32_dpp v45, v47 quad_perm:[0,1,0,1] row_mask:0xf bank_mask:0xf
s_nop 0
v_cvt_pk_bf16_f32 v52, v44, v45
v_cvt_pk_bf16_f32 v53, v44, v45
s_nop 1
v_mfma_f32_16x16x16_bf16 v[16:19], v[54:55], v[52:53], v[16:19]
v_mfma_f32_16x16x16_bf16 v[8:11], v[24:25], v[52:53], v[8:11]
v_mfma_f32_16x16x16_bf16 v[12:15], v[26:27], v[52:53], v[12:15]
s_nop 5
v_rcp_f32 v18, v16
s_nop 0
v_cndmask_b32 v8, v12, v8, s[42:43]
v_mul_f32 v8, v8, v18
v_cndmask_b32 v9, v13, v9, s[42:43]
v_mul_f32 v9, v9, v18
v_cndmask_b32 v10, v14, v10, s[42:43]
v_mul_f32 v10, v10, v18
v_cndmask_b32 v11, v15, v11, s[42:43]
v_mul_f32 v11, v11, v18
v_cvt_pk_bf16_f32 v12, v8, v9
v_cvt_pk_bf16_f32 v13, v10, v11
s_branch back_10053
exit_10054:
global_load_dwordx4 v[32:35], v0, s[68:69] offset:-4096 sc1
global_load_dwordx4 v[36:39], v0, s[68:69] offset:0 sc1
s_add_u32 s30, s30, 1
s_cmp_gt_u32 s30, 262144
s_cbranch_scc1 L_fail
s_waitcnt vmcnt(1)
v_bitop3_b32 v44, v32, v34, s18 bitop3:0x7e
s_waitcnt vmcnt(0)
v_bitop3_b32 v45, v36, v38, s18 bitop3:0x7e
v_bitop3_b32 v44, v44, v45, s19 bitop3:0xa8
v_cmp_ne_u32 vcc, 0, v44
s_cbranch_vccnz exit_10054
s_add_u32 s36, s36, 1
s_cmp_lt_u32 s36, 2
s_cbranch_scc1 layer_10050
s_endpgm
grp_10001:
s_bfm_b32 s24, s14, 0
s_and_b32 s24, s24, 0xaaaaaaaa
s_bcnt1_i32_b32 s24, s24
v_and_b32 v64, 63, v0
v_and_b32 v65, 15, v64
v_lshrrev_b32 v66, 4, v64
v_lshlrev_b32 v0, 4, v64
v_and_b32 v67, 2, v64
v_mov_b32 v68, 0x4444
v_mov_b32 v69, 0xeeee
v_cmp_eq_u32 vcc, 0, v67
s_nop 1
v_cndmask_b32 v1, v69, v68, vcc
s_mul_i32 s26, s13, 24576
s_add_u32 s26, s26, 65536
v_add_u32 v2, s26, v0
v_lshrrev_b32 v67, 2, v65
v_xor_b32 v68, v66, v67
v_lshlrev_b32 v68, 3, v68
v_lshl_add_u32 v68, v65, 5, v68
s_lshl_b32 s26, s13, 10
s_add_u32 s26, s26, 10240
v_add_u32 v3, s26, v68
v_lshl_add_u32 v68, v66, 2, v67
v_and_b32 v69, 3, v65
v_xor_b32 v69, v69, v66
v_lshlrev_b32 v69, 3, v69
v_lshl_add_u32 v68, v68, 5, v69
v_add_u32 v4, 10240, v68
v_and_b32 v69, 1, v65
v_lshl_add_u32 v68, v67, 1, v69
v_lshlrev_b32 v68, 4, v68
v_lshl_add_u32 v68, v66, 7, v68
v_add_u32 v5, 8192, v68
v_bfe_u32 v69, v65, 1, 1
v_mul_u32_u24 v69, 640, v69
v_xor_b32 v6, v69, v5
s_mov_b32 s42, 0x33333333
s_mov_b32 s43, 0x33333333
s_mov_b32 s44, 0x3f803f80
s_mov_b32 s45, 0x3f803f80
s_mov_b32 s46, 0x3f803f80
s_mov_b32 s47, 0
s_mov_b32 s37, 729808896
s_mov_b32 s38, 671088640
v_lshlrev_b32 v68, 3, v65
v_lshl_add_u32 v7, v66, 12, v68
s_lshl_b32 s26, s13, 14
s_lshl_b32 s27, s14, 7
s_add_u32 s26, s26, s27
s_add_u32 s90, s26, 65536
s_lshl_b32 s26, s13, 5
s_add_u32 s93, s26, s14
s_lshl_b32 s26, s93, 12
s_add_u32 s91, s26, 65536
s_lshr_b32 s26, s93, 2
s_lshl_b32 s26, s26, 9
s_and_b32 s27, s93, 3
s_lshl_b32 s27, s27, 6
s_add_u32 s26, s26, s27
s_add_u32 s92, s26, 393216
s_lshl_b32 s26, s14, 7
s_add_u32 s22, s26, 0
s_lshl_b32 s26, s24, 2
s_add_u32 s26, s26, 4096
s_cmp_lt_u32 s24, 10
s_cselect_b32 s23, s26, 268435456
s_cselect_b32 s24, s24, 0
s_cselect_b32 s25, 12582912, s23
s_lshl_b32 s24, s24, 10
s_and_b32 s26, s14, 0
s_lshl_b32 s26, s26, 12
s_add_u32 s94, s26, 425984
s_lshl_b32 s26, s14, 7
s_add_u32 s95, s26, 425984
s_mov_b32 s35, 0x3e0293ee
s_lshl_b32 s26, s14, 2
s_add_u32 s26, s26, s13
s_mul_i32 s27, s26, 18432
s_add_u32 s89, s27, 1048576
s_add_u32 s48, s4, s90
s_addc_u32 s49, s5, 0
s_add_u32 s50, s90, 65536
s_add_u32 s50, s4, s50
s_addc_u32 s51, s5, 0
s_add_u32 s52, s90, 131072
s_add_u32 s52, s4, s52
s_addc_u32 s53, s5, 0
s_add_u32 s54, s90, 196608
s_add_u32 s54, s4, s54
s_addc_u32 s55, s5, 0
s_add_u32 s56, s90, 262144
s_add_u32 s56, s4, s56
s_addc_u32 s57, s5, 0
s_add_u32 s76, s89, 4096
s_add_u32 s76, s4, s76
s_addc_u32 s77, s5, 0
s_add_u32 s78, s89, 12288
s_add_u32 s78, s4, s78
s_addc_u32 s79, s5, 0
s_add_u32 s80, s89, 20480
s_add_u32 s80, s4, s80
s_addc_u32 s81, s5, 0
s_add_u32 s60, s4, s94
s_addc_u32 s61, s5, 0
s_add_u32 s62, s4, s95
s_addc_u32 s63, s5, 0
s_add_u32 s64, s4, s91
s_addc_u32 s65, s5, 0
s_add_u32 s66, s4, s92
s_addc_u32 s67, s5, 0
v_mov_b32 v72, 0
v_mov_b32 v73, 0
s_mov_b32 s26, s90
buffer_store_dwordx2 v[72:73], v7, s[4:7], s26 offen
s_add_u32 s26, s26, 65536
buffer_store_dwordx2 v[72:73], v7, s[4:7], s26 offen
s_add_u32 s26, s26, 65536
buffer_store_dwordx2 v[72:73], v7, s[4:7], s26 offen
s_add_u32 s26, s26, 65536
buffer_store_dwordx2 v[72:73], v7, s[4:7], s26 offen
s_add_u32 s26, s26, 65536
buffer_store_dwordx2 v[72:73], v7, s[4:7], s26 offen
s_add_u32 s26, s26, 65536
buffer_store_dword v72, off, s[4:7], s95 offset:0
s_load_dwordx2 s[96:97], s[0:1], 32
s_mov_b32 s98, 10240
s_mov_b32 s99, 0x20000
s_cmp_ge_u32 s93, 80
s_cbranch_scc1 nm0_10065
s_and_b32 s26, s93, 3
s_mul_i32 s26, s26, 2560
s_lshr_b32 s27, s93, 2
s_lshl_b32 s27, s27, 6
s_add_u32 s26, s26, s27
v_bfe_u32 v68, v65, 1, 2
v_lshlrev_b32 v68, 4, v68
v_and_b32 v69, 1, v65
v_lshl_add_u32 v68, v69, 2, v68
v_and_b32 v69, 1, v66
v_mul_u32_u24 v69, 1280, v69
v_add_u32 v68, v68, v69
s_waitcnt lgkmcnt(0)
buffer_load_dword v74, v68, s[96:99], s26 offen
buffer_load_dword v75, v68, s[96:99], s26 offen offset:8
v_and_b32 v68, 32, v0
v_bfe_u32 v69, v0, 6, 1
v_lshl_add_u32 v68, v69, 8, v68
v_bfe_u32 v69, v0, 8, 1
v_lshl_add_u32 v68, v69, 4, v68
v_bfe_u32 v69, v0, 4, 1
v_lshl_add_u32 v68, v69, 3, v68
s_add_u32 s27, s92, 16384
buffer_store_dwordx2 v[72:73], v68, s[4:7], s92 offen
s_waitcnt vmcnt(1)
buffer_store_dwordx2 v[74:75], v68, s[4:7], s27 offen
nm0_10065:
s_waitcnt vmcnt(0) lgkmcnt(0)
v_lshrrev_b32 v67, 3, v64
v_and_b32 v68, 7, v64
v_lshlrev_b32 v68, 4, v68
v_lshl_add_u32 v32, v67, 13, v68
v_mul_u32_u24 v67, 1280, v67
v_add_u32 v36, v67, v68
v_lshrrev_b32 v67, 1, v66
v_lshlrev_b32 v67, 4, v67
v_and_b32 v68, 1, v66
v_lshl_add_u32 v67, v68, 1, v67
v_lshrrev_b32 v68, 3, v65
v_lshl_add_u32 v67, v68, 3, v67
v_bfe_u32 v68, v65, 2, 1
v_add_u32 v67, v67, v68
v_and_b32 v69, 3, v65
v_lshlrev_b32 v40, 4, v69
v_lshl_add_u32 v40, v67, 7, v40
v_lshl_add_u32 v67, v66, 2, v68
v_lshlrev_b32 v42, 4, v69
v_lshl_add_u32 v42, v67, 7, v42
v_lshrrev_b32 v68, 3, v65
v_lshl_add_u32 v42, v68, 3, v42
s_lshl_b32 s29, s13, 12
s_and_b32 s26, s13, 1
s_lshl_b32 s26, s26, 6
s_add_u32 s26, s26, s29
v_add_u32 v40, s26, v40
v_add_u32 v42, s26, v42
v_xor_b32 v41, 4096, v40
v_xor_b32 v43, 4096, v42
v_add_u32 v33, 64512, v32
v_add_u32 v37, 9216, v36
v_add_u32 v34, 129024, v32
v_add_u32 v38, 18432, v36
v_add_u32 v35, 193536, v32
v_add_u32 v39, 27648, v36
s_lshr_b32 s28, s13, 1
s_lshl_b32 s28, s28, 7
s_lshl_b32 s27, s14, 8
s_add_u32 s27, s27, s28
s_xor_b32 s26, s13, 0
s_lshl_b32 s82, s26, 19
s_add_u32 s82, s82, s27
s_lshl_b32 s85, s14, 2
s_add_u32 s85, s85, s26
s_mul_i32 s85, s85, 40960
s_add_u32 s85, s85, s28
s_xor_b32 s26, s13, 2
s_lshl_b32 s83, s26, 19
s_add_u32 s83, s83, s27
s_lshl_b32 s86, s14, 2
s_add_u32 s86, s86, s26
s_mul_i32 s86, s86, 40960
s_add_u32 s86, s86, s28
s_and_b32 s26, s13, 1
s_add_u32 s26, s26, 8
s_lshl_b32 s84, s26, 19
s_add_u32 s84, s84, s27
s_load_dwordx2 s[68:69], s[0:1], 40
s_load_dwordx2 s[70:71], s[0:1], 48
s_load_dwordx2 s[72:73], s[0:1], 56
s_load_dwordx2 s[74:75], s[0:1], 64
s_mov_b32 s98, 5242880
s_waitcnt lgkmcnt(0)
s_mov_b64 s[96:97], s[70:71]
s_add_u32 m0, s29, 0
s_add_u32 s26, s82, 0
buffer_load_dwordx4 v32, s[96:99], s26 offen offset:0 lds
buffer_load_dwordx4 v33, s[96:99], s26 offen offset:1024 lds
buffer_load_dwordx4 v34, s[96:99], s26 offen offset:2048 lds
buffer_load_dwordx4 v35, s[96:99], s26 offen offset:3072 lds
s_add_u32 m0, s29, 16384
s_add_u32 s26, s82, 262144
buffer_load_dwordx4 v32, s[96:99], s26 offen offset:0 lds
buffer_load_dwordx4 v33, s[96:99], s26 offen offset:1024 lds
buffer_load_dwordx4 v34, s[96:99], s26 offen offset:2048 lds
buffer_load_dwordx4 v35, s[96:99], s26 offen offset:3072 lds
s_add_u32 m0, s29, 32768
s_add_u32 s26, s82, 2097152
buffer_load_dwordx4 v32, s[96:99], s26 offen offset:0 lds
buffer_load_dwordx4 v33, s[96:99], s26 offen offset:1024 lds
buffer_load_dwordx4 v34, s[96:99], s26 offen offset:2048 lds
buffer_load_dwordx4 v35, s[96:99], s26 offen offset:3072 lds
s_waitcnt vmcnt(8)
s_barrier
s_add_u32 m0, s29, 49152
s_add_u32 s26, s82, 2359296
buffer_load_dwordx4 v32, s[96:99], s26 offen offset:0 lds
buffer_load_dwordx4 v33, s[96:99], s26 offen offset:1024 lds
buffer_load_dwordx4 v34, s[96:99], s26 offen offset:2048 lds
buffer_load_dwordx4 v35, s[96:99], s26 offen offset:3072 lds
ds_read_b64_tr_b16 v[72:73], v40 offset:0
ds_read_b64_tr_b16 v[74:75], v40 offset:512
ds_read_b64_tr_b16 v[76:77], v40 offset:8
ds_read_b64_tr_b16 v[78:79], v40 offset:520
ds_read_b64_tr_b16 v[80:81], v41 offset:0
ds_read_b64_tr_b16 v[82:83], v41 offset:512
ds_read_b64_tr_b16 a[128:129], v41 offset:8
ds_read_b64_tr_b16 a[130:131], v41 offset:520
s_waitcnt lgkmcnt(6)
global_store_dwordx4 v0, v[72:75], s[76:77] offset:0
s_waitcnt lgkmcnt(4)
global_store_dwordx4 v0, v[76:79], s[76:77] offset:2048
s_waitcnt lgkmcnt(2)
ds_write_b128 v2, v[80:83] offset:12288
s_waitcnt vmcnt(10) lgkmcnt(1)
s_barrier
s_add_u32 m0, s29, 0
s_add_u32 s26, s83, 0
buffer_load_dwordx4 v32, s[96:99], s26 offen offset:0 lds
buffer_load_dwordx4 v33, s[96:99], s26 offen offset:1024 lds
buffer_load_dwordx4 v34, s[96:99], s26 offen offset:2048 lds
buffer_load_dwordx4 v35, s[96:99], s26 offen offset:3072 lds
ds_read_b64_tr_b16 v[72:73], v40 offset:16384
ds_read_b64_tr_b16 v[74:75], v40 offset:16896
ds_read_b64_tr_b16 v[76:77], v40 offset:16392
ds_read_b64_tr_b16 v[78:79], v40 offset:16904
ds_read_b64_tr_b16 v[80:81], v41 offset:16384
ds_read_b64_tr_b16 v[82:83], v41 offset:16896
ds_read_b64_tr_b16 a[132:133], v41 offset:16392
ds_read_b64_tr_b16 a[134:135], v41 offset:16904
s_waitcnt lgkmcnt(6)
global_store_dwordx4 v0, v[72:75], s[76:77] offset:1024
s_waitcnt lgkmcnt(4)
global_store_dwordx4 v0, v[76:79], s[76:77] offset:3072
s_waitcnt lgkmcnt(2)
ds_write_b128 v2, v[80:83] offset:13312
s_waitcnt vmcnt(12) lgkmcnt(1)
s_barrier
s_add_u32 m0, s29, 16384
s_add_u32 s26, s83, 262144
buffer_load_dwordx4 v32, s[96:99], s26 offen offset:0 lds
buffer_load_dwordx4 v33, s[96:99], s26 offen offset:1024 lds
buffer_load_dwordx4 v34, s[96:99], s26 offen offset:2048 lds
buffer_load_dwordx4 v35, s[96:99], s26 offen offset:3072 lds
ds_read_b64_tr_b16 a[32:33], v40 offset:32768
ds_read_b64_tr_b16 a[34:35], v40 offset:33280
ds_read_b64_tr_b16 a[40:41], v40 offset:32776
ds_read_b64_tr_b16 a[42:43], v40 offset:33288
ds_read_b64_tr_b16 a[136:137], v41 offset:32768
ds_read_b64_tr_b16 a[138:139], v41 offset:33280
ds_read_b64_tr_b16 v[84:85], v41 offset:32776
ds_read_b64_tr_b16 v[86:87], v41 offset:33288
s_waitcnt lgkmcnt(0)
ds_write_b128 v2, v[84:87] offset:14336
s_waitcnt vmcnt(12)
s_barrier
s_add_u32 m0, s29, 32768
s_add_u32 s26, s83, 2097152
buffer_load_dwordx4 v32, s[96:99], s26 offen offset:0 lds
buffer_load_dwordx4 v33, s[96:99], s26 offen offset:1024 lds
buffer_load_dwordx4 v34, s[96:99], s26 offen offset:2048 lds
buffer_load_dwordx4 v35, s[96:99], s26 offen offset:3072 lds
ds_read_b64_tr_b16 a[36:37], v40 offset:49152
ds_read_b64_tr_b16 a[38:39], v40 offset:49664
ds_read_b64_tr_b16 a[44:45], v40 offset:49160
ds_read_b64_tr_b16 a[46:47], v40 offset:49672
ds_read_b64_tr_b16 a[140:141], v41 offset:49152
ds_read_b64_tr_b16 a[142:143], v41 offset:49664
ds_read_b64_tr_b16 v[84:85], v41 offset:49160
ds_read_b64_tr_b16 v[86:87], v41 offset:49672
s_waitcnt lgkmcnt(0)
ds_write_b128 v2, v[84:87] offset:15360
s_waitcnt vmcnt(10)
s_barrier
s_add_u32 m0, s29, 49152
s_add_u32 s26, s83, 2359296
buffer_load_dwordx4 v32, s[96:99], s26 offen offset:0 lds
buffer_load_dwordx4 v33, s[96:99], s26 offen offset:1024 lds
buffer_load_dwordx4 v34, s[96:99], s26 offen offset:2048 lds
buffer_load_dwordx4 v35, s[96:99], s26 offen offset:3072 lds
ds_read_b64_tr_b16 a[144:145], v40 offset:0
ds_read_b64_tr_b16 a[146:147], v40 offset:512
ds_read_b64_tr_b16 a[152:153], v40 offset:8
ds_read_b64_tr_b16 a[154:155], v40 offset:520
ds_read_b64_tr_b16 a[160:161], v41 offset:0
ds_read_b64_tr_b16 a[162:163], v41 offset:512
ds_read_b64_tr_b16 a[168:169], v41 offset:8
ds_read_b64_tr_b16 a[170:171], v41 offset:520
s_waitcnt vmcnt(8) lgkmcnt(0)
s_barrier
s_add_u32 m0, s29, 0
s_add_u32 s26, s84, 0
buffer_load_dwordx4 v32, s[96:99], s26 offen offset:0 lds
buffer_load_dwordx4 v33, s[96:99], s26 offen offset:1024 lds
buffer_load_dwordx4 v34, s[96:99], s26 offen offset:2048 lds
buffer_load_dwordx4 v35, s[96:99], s26 offen offset:3072 lds
ds_read_b64_tr_b16 a[148:149], v40 offset:16384
ds_read_b64_tr_b16 a[150:151], v40 offset:16896
ds_read_b64_tr_b16 a[156:157], v40 offset:16392
ds_read_b64_tr_b16 a[158:159], v40 offset:16904
ds_read_b64_tr_b16 a[164:165], v41 offset:16384
ds_read_b64_tr_b16 a[166:167], v41 offset:16896
ds_read_b64_tr_b16 a[172:173], v41 offset:16392
ds_read_b64_tr_b16 a[174:175], v41 offset:16904
s_waitcnt vmcnt(8) lgkmcnt(0)
s_barrier
s_add_u32 m0, s29, 16384
s_add_u32 s26, s84, 262144
buffer_load_dwordx4 v32, s[96:99], s26 offen offset:0 lds
buffer_load_dwordx4 v33, s[96:99], s26 offen offset:1024 lds
buffer_load_dwordx4 v34, s[96:99], s26 offen offset:2048 lds
buffer_load_dwordx4 v35, s[96:99], s26 offen offset:3072 lds
ds_read_b64_tr_b16 v[72:73], v40 offset:32768
ds_read_b64_tr_b16 v[74:75], v40 offset:33280
ds_read_b64_tr_b16 v[76:77], v40 offset:32776
ds_read_b64_tr_b16 v[78:79], v40 offset:33288
ds_read_b64_tr_b16 a[176:177], v41 offset:32768
ds_read_b64_tr_b16 a[178:179], v41 offset:33280
ds_read_b64_tr_b16 v[84:85], v41 offset:32776
ds_read_b64_tr_b16 v[86:87], v41 offset:33288
s_waitcnt lgkmcnt(6)
global_store_dwordx4 v0, v[72:75], s[78:79] offset:0
s_waitcnt lgkmcnt(4)
ds_write_b128 v2, v[76:79] offset:16384
s_waitcnt lgkmcnt(1)
ds_write_b128 v2, v[84:87] offset:18432
s_waitcnt vmcnt(9)
s_barrier
s_mov_b64 s[96:97], s[72:73]
s_add_u32 m0, s29, 32768
s_add_u32 s26, s82, 0
buffer_load_dwordx4 v32, s[96:99], s26 offen offset:0 lds
buffer_load_dwordx4 v33, s[96:99], s26 offen offset:1024 lds
buffer_load_dwordx4 v34, s[96:99], s26 offen offset:2048 lds
buffer_load_dwordx4 v35, s[96:99], s26 offen offset:3072 lds
ds_read_b64_tr_b16 v[72:73], v40 offset:49152
ds_read_b64_tr_b16 v[74:75], v40 offset:49664
ds_read_b64_tr_b16 v[76:77], v40 offset:49160
ds_read_b64_tr_b16 v[78:79], v40 offset:49672
ds_read_b64_tr_b16 a[180:181], v41 offset:49152
ds_read_b64_tr_b16 a[182:183], v41 offset:49664
ds_read_b64_tr_b16 v[84:85], v41 offset:49160
ds_read_b64_tr_b16 v[86:87], v41 offset:49672
s_waitcnt lgkmcnt(6)
global_store_dwordx4 v0, v[72:75], s[78:79] offset:1024
s_waitcnt lgkmcnt(4)
ds_write_b128 v2, v[76:79] offset:17408
s_waitcnt lgkmcnt(1)
ds_write_b128 v2, v[84:87] offset:19456
s_waitcnt vmcnt(10)
s_barrier
s_add_u32 m0, s29, 49152
s_add_u32 s26, s82, 262144
buffer_load_dwordx4 v32, s[96:99], s26 offen offset:0 lds
buffer_load_dwordx4 v33, s[96:99], s26 offen offset:1024 lds
buffer_load_dwordx4 v34, s[96:99], s26 offen offset:2048 lds
buffer_load_dwordx4 v35, s[96:99], s26 offen offset:3072 lds
ds_read_b64_tr_b16 a[184:185], v40 offset:0
ds_read_b64_tr_b16 a[186:187], v40 offset:512
ds_read_b64_tr_b16 a[192:193], v40 offset:8
ds_read_b64_tr_b16 a[194:195], v40 offset:520
ds_read_b64_tr_b16 a[200:201], v41 offset:0
ds_read_b64_tr_b16 a[202:203], v41 offset:512
ds_read_b64_tr_b16 a[208:209], v41 offset:8
ds_read_b64_tr_b16 a[210:211], v41 offset:520
s_waitcnt vmcnt(10) lgkmcnt(0)
s_barrier
s_add_u32 m0, s29, 0
s_add_u32 s26, s82, 2097152
buffer_load_dwordx4 v32, s[96:99], s26 offen offset:0 lds
buffer_load_dwordx4 v33, s[96:99], s26 offen offset:1024 lds
buffer_load_dwordx4 v34, s[96:99], s26 offen offset:2048 lds
buffer_load_dwordx4 v35, s[96:99], s26 offen offset:3072 lds
ds_read_b64_tr_b16 a[188:189], v40 offset:16384
ds_read_b64_tr_b16 a[190:191], v40 offset:16896
ds_read_b64_tr_b16 a[196:197], v40 offset:16392
ds_read_b64_tr_b16 a[198:199], v40 offset:16904
ds_read_b64_tr_b16 a[204:205], v41 offset:16384
ds_read_b64_tr_b16 a[206:207], v41 offset:16896
ds_read_b64_tr_b16 a[212:213], v41 offset:16392
ds_read_b64_tr_b16 a[214:215], v41 offset:16904
s_waitcnt vmcnt(9) lgkmcnt(0)
s_barrier
s_add_u32 m0, s29, 16384
s_add_u32 s26, s82, 2359296
buffer_load_dwordx4 v32, s[96:99], s26 offen offset:0 lds
buffer_load_dwordx4 v33, s[96:99], s26 offen offset:1024 lds
buffer_load_dwordx4 v34, s[96:99], s26 offen offset:2048 lds
buffer_load_dwordx4 v35, s[96:99], s26 offen offset:3072 lds
ds_read_b64_tr_b16 a[0:1], v40 offset:32768
ds_read_b64_tr_b16 a[2:3], v40 offset:33280
ds_read_b64_tr_b16 a[8:9], v40 offset:32776
ds_read_b64_tr_b16 a[10:11], v40 offset:33288
ds_read_b64_tr_b16 a[240:241], v41 offset:32768
ds_read_b64_tr_b16 a[242:243], v41 offset:33280
ds_read_b64_tr_b16 a[248:249], v41 offset:32776
ds_read_b64_tr_b16 a[250:251], v41 offset:33288
s_waitcnt vmcnt(8) lgkmcnt(0)
s_barrier
s_add_u32 m0, s29, 32768
s_add_u32 s26, s83, 0
buffer_load_dwordx4 v32, s[96:99], s26 offen offset:0 lds
buffer_load_dwordx4 v33, s[96:99], s26 offen offset:1024 lds
buffer_load_dwordx4 v34, s[96:99], s26 offen offset:2048 lds
buffer_load_dwordx4 v35, s[96:99], s26 offen offset:3072 lds
ds_read_b64_tr_b16 a[4:5], v40 offset:49152
ds_read_b64_tr_b16 a[6:7], v40 offset:49664
ds_read_b64_tr_b16 a[12:13], v40 offset:49160
ds_read_b64_tr_b16 a[14:15], v40 offset:49672
ds_read_b64_tr_b16 a[244:245], v41 offset:49152
ds_read_b64_tr_b16 a[246:247], v41 offset:49664
ds_read_b64_tr_b16 a[252:253], v41 offset:49160
ds_read_b64_tr_b16 a[254:255], v41 offset:49672
s_waitcnt vmcnt(8) lgkmcnt(0)
s_barrier
s_add_u32 m0, s29, 49152
s_add_u32 s26, s83, 262144
buffer_load_dwordx4 v32, s[96:99], s26 offen offset:0 lds
buffer_load_dwordx4 v33, s[96:99], s26 offen offset:1024 lds
buffer_load_dwordx4 v34, s[96:99], s26 offen offset:2048 lds
buffer_load_dwordx4 v35, s[96:99], s26 offen offset:3072 lds
ds_read_b64_tr_b16 v[72:73], v40 offset:0
ds_read_b64_tr_b16 v[74:75], v40 offset:512
ds_read_b64_tr_b16 v[76:77], v40 offset:8
ds_read_b64_tr_b16 v[78:79], v40 offset:520
ds_read_b64_tr_b16 v[80:81], v41 offset:0
ds_read_b64_tr_b16 v[82:83], v41 offset:512
ds_read_b64_tr_b16 v[88:89], v41 offset:8
ds_read_b64_tr_b16 v[90:91], v41 offset:520
s_waitcnt lgkmcnt(6)
ds_write_b128 v2, v[72:75] offset:0
s_waitcnt lgkmcnt(5)
ds_write_b128 v2, v[76:79] offset:2048
s_waitcnt lgkmcnt(4)
global_store_dwordx4 v0, v[80:83], s[78:79] offset:2048
s_waitcnt vmcnt(9) lgkmcnt(2)
s_barrier
s_add_u32 m0, s29, 0
s_add_u32 s26, s83, 2097152
buffer_load_dwordx4 v32, s[96:99], s26 offen offset:0 lds
buffer_load_dwordx4 v33, s[96:99], s26 offen offset:1024 lds
buffer_load_dwordx4 v34, s[96:99], s26 offen offset:2048 lds
buffer_load_dwordx4 v35, s[96:99], s26 offen offset:3072 lds
ds_read_b64_tr_b16 v[72:73], v40 offset:16384
ds_read_b64_tr_b16 v[74:75], v40 offset:16896
ds_read_b64_tr_b16 v[76:77], v40 offset:16392
ds_read_b64_tr_b16 v[78:79], v40 offset:16904
ds_read_b64_tr_b16 v[80:81], v41 offset:16384
ds_read_b64_tr_b16 v[82:83], v41 offset:16896
ds_read_b64_tr_b16 v[92:93], v41 offset:16392
ds_read_b64_tr_b16 v[94:95], v41 offset:16904
s_waitcnt lgkmcnt(6)
ds_write_b128 v2, v[72:75] offset:1024
s_waitcnt lgkmcnt(5)
ds_write_b128 v2, v[76:79] offset:3072
s_waitcnt lgkmcnt(4)
global_store_dwordx4 v0, v[80:83], s[78:79] offset:3072
s_waitcnt vmcnt(10) lgkmcnt(2)
s_barrier
s_add_u32 m0, s29, 16384
s_add_u32 s26, s83, 2359296
buffer_load_dwordx4 v32, s[96:99], s26 offen offset:0 lds
buffer_load_dwordx4 v33, s[96:99], s26 offen offset:1024 lds
buffer_load_dwordx4 v34, s[96:99], s26 offen offset:2048 lds
buffer_load_dwordx4 v35, s[96:99], s26 offen offset:3072 lds
ds_read_b64_tr_b16 v[96:97], v40 offset:32768
ds_read_b64_tr_b16 v[98:99], v40 offset:33280
ds_read_b64_tr_b16 v[104:105], v40 offset:32776
ds_read_b64_tr_b16 v[106:107], v40 offset:33288
ds_read_b64_tr_b16 v[128:129], v41 offset:32768
ds_read_b64_tr_b16 v[130:131], v41 offset:33280
ds_read_b64_tr_b16 v[136:137], v41 offset:32776
ds_read_b64_tr_b16 v[138:139], v41 offset:33288
s_waitcnt vmcnt(10) lgkmcnt(0)
s_barrier
s_add_u32 m0, s29, 32768
s_add_u32 s26, s84, 0
buffer_load_dwordx4 v32, s[96:99], s26 offen offset:0 lds
buffer_load_dwordx4 v33, s[96:99], s26 offen offset:1024 lds
buffer_load_dwordx4 v34, s[96:99], s26 offen offset:2048 lds
buffer_load_dwordx4 v35, s[96:99], s26 offen offset:3072 lds
ds_read_b64_tr_b16 v[100:101], v40 offset:49152
ds_read_b64_tr_b16 v[102:103], v40 offset:49664
ds_read_b64_tr_b16 v[108:109], v40 offset:49160
ds_read_b64_tr_b16 v[110:111], v40 offset:49672
ds_read_b64_tr_b16 v[132:133], v41 offset:49152
ds_read_b64_tr_b16 v[134:135], v41 offset:49664
ds_read_b64_tr_b16 v[140:141], v41 offset:49160
ds_read_b64_tr_b16 v[142:143], v41 offset:49672
s_waitcnt vmcnt(9) lgkmcnt(0)
s_barrier
s_add_u32 m0, s29, 49152
s_add_u32 s26, s84, 262144
buffer_load_dwordx4 v32, s[96:99], s26 offen offset:0 lds
buffer_load_dwordx4 v33, s[96:99], s26 offen offset:1024 lds
buffer_load_dwordx4 v34, s[96:99], s26 offen offset:2048 lds
buffer_load_dwordx4 v35, s[96:99], s26 offen offset:3072 lds
ds_read_b64_tr_b16 v[112:113], v40 offset:0
ds_read_b64_tr_b16 v[114:115], v40 offset:512
ds_read_b64_tr_b16 v[120:121], v40 offset:8
ds_read_b64_tr_b16 v[122:123], v40 offset:520
ds_read_b64_tr_b16 v[80:81], v41 offset:0
ds_read_b64_tr_b16 v[82:83], v41 offset:512
ds_read_b64_tr_b16 v[144:145], v41 offset:8
ds_read_b64_tr_b16 v[146:147], v41 offset:520
s_waitcnt lgkmcnt(2)
global_store_dwordx4 v0, v[80:83], s[80:81] offset:-4096
s_waitcnt vmcnt(9) lgkmcnt(0)
s_barrier
s_mov_b64 s[96:97], s[68:69]
s_add_u32 m0, s29, 0
s_add_u32 s26, s82, 0
buffer_load_dwordx4 v32, s[96:99], s26 offen offset:0 lds
buffer_load_dwordx4 v33, s[96:99], s26 offen offset:1024 lds
buffer_load_dwordx4 v34, s[96:99], s26 offen offset:2048 lds
buffer_load_dwordx4 v35, s[96:99], s26 offen offset:3072 lds
ds_read_b64_tr_b16 v[116:117], v40 offset:16384
ds_read_b64_tr_b16 v[118:119], v40 offset:16896
ds_read_b64_tr_b16 v[124:125], v40 offset:16392
ds_read_b64_tr_b16 v[126:127], v40 offset:16904
ds_read_b64_tr_b16 v[80:81], v41 offset:16384
ds_read_b64_tr_b16 v[82:83], v41 offset:16896
ds_read_b64_tr_b16 v[148:149], v41 offset:16392
ds_read_b64_tr_b16 v[150:151], v41 offset:16904
s_waitcnt lgkmcnt(2)
global_store_dwordx4 v0, v[80:83], s[80:81] offset:-3072
s_waitcnt vmcnt(10) lgkmcnt(0)
s_barrier
s_add_u32 m0, s29, 16384
s_add_u32 s26, s82, 262144
buffer_load_dwordx4 v32, s[96:99], s26 offen offset:0 lds
buffer_load_dwordx4 v33, s[96:99], s26 offen offset:1024 lds
buffer_load_dwordx4 v34, s[96:99], s26 offen offset:2048 lds
buffer_load_dwordx4 v35, s[96:99], s26 offen offset:3072 lds
ds_read_b64_tr_b16 a[216:217], v40 offset:32768
ds_read_b64_tr_b16 a[218:219], v40 offset:33280
ds_read_b64_tr_b16 a[224:225], v40 offset:32776
ds_read_b64_tr_b16 a[226:227], v40 offset:33288
ds_read_b64_tr_b16 a[232:233], v41 offset:32768
ds_read_b64_tr_b16 a[234:235], v41 offset:33280
ds_read_b64_tr_b16 v[84:85], v41 offset:32776
ds_read_b64_tr_b16 v[86:87], v41 offset:33288
s_waitcnt lgkmcnt(0)
ds_write_b128 v2, v[84:87] offset:20480
s_waitcnt vmcnt(10)
s_barrier
s_add_u32 m0, s29, 32768
s_add_u32 s26, s82, 2097152
buffer_load_dwordx4 v32, s[96:99], s26 offen offset:0 lds
buffer_load_dwordx4 v33, s[96:99], s26 offen offset:1024 lds
buffer_load_dwordx4 v34, s[96:99], s26 offen offset:2048 lds
buffer_load_dwordx4 v35, s[96:99], s26 offen offset:3072 lds
ds_read_b64_tr_b16 a[220:221], v40 offset:49152
ds_read_b64_tr_b16 a[222:223], v40 offset:49664
ds_read_b64_tr_b16 a[228:229], v40 offset:49160
ds_read_b64_tr_b16 a[230:231], v40 offset:49672
ds_read_b64_tr_b16 a[236:237], v41 offset:49152
ds_read_b64_tr_b16 a[238:239], v41 offset:49664
ds_read_b64_tr_b16 v[84:85], v41 offset:49160
ds_read_b64_tr_b16 v[86:87], v41 offset:49672
s_waitcnt lgkmcnt(0)
ds_write_b128 v2, v[84:87] offset:21504
s_waitcnt vmcnt(9)
s_barrier
s_add_u32 m0, s29, 49152
s_add_u32 s26, s82, 2359296
buffer_load_dwordx4 v32, s[96:99], s26 offen offset:0 lds
buffer_load_dwordx4 v33, s[96:99], s26 offen offset:1024 lds
buffer_load_dwordx4 v34, s[96:99], s26 offen offset:2048 lds
buffer_load_dwordx4 v35, s[96:99], s26 offen offset:3072 lds
ds_read_b64_tr_b16 v[72:73], v40 offset:0
ds_read_b64_tr_b16 v[74:75], v40 offset:512
ds_read_b64_tr_b16 v[76:77], v40 offset:8
ds_read_b64_tr_b16 v[78:79], v40 offset:520
ds_read_b64_tr_b16 a[48:49], v41 offset:0
ds_read_b64_tr_b16 a[50:51], v41 offset:512
ds_read_b64_tr_b16 v[84:85], v41 offset:8
ds_read_b64_tr_b16 v[86:87], v41 offset:520
s_waitcnt lgkmcnt(6)
global_store_dwordx4 v0, v[72:75], s[76:77] offset:-4096
s_waitcnt lgkmcnt(4)
global_store_dwordx4 v0, v[76:79], s[76:77] offset:-2048
s_waitcnt lgkmcnt(0)
global_store_dwordx4 v0, v[84:87], s[78:79] offset:-4096
s_waitcnt vmcnt(11)
s_barrier
s_add_u32 m0, s29, 0
s_add_u32 s26, s83, 0
buffer_load_dwordx4 v32, s[96:99], s26 offen offset:0 lds
buffer_load_dwordx4 v33, s[96:99], s26 offen offset:1024 lds
buffer_load_dwordx4 v34, s[96:99], s26 offen offset:2048 lds
buffer_load_dwordx4 v35, s[96:99], s26 offen offset:3072 lds
ds_read_b64_tr_b16 v[72:73], v40 offset:16384
ds_read_b64_tr_b16 v[74:75], v40 offset:16896
ds_read_b64_tr_b16 v[76:77], v40 offset:16392
ds_read_b64_tr_b16 v[78:79], v40 offset:16904
ds_read_b64_tr_b16 a[52:53], v41 offset:16384
ds_read_b64_tr_b16 a[54:55], v41 offset:16896
ds_read_b64_tr_b16 v[84:85], v41 offset:16392
ds_read_b64_tr_b16 v[86:87], v41 offset:16904
s_waitcnt lgkmcnt(6)
global_store_dwordx4 v0, v[72:75], s[76:77] offset:-3072
s_waitcnt lgkmcnt(4)
global_store_dwordx4 v0, v[76:79], s[76:77] offset:-1024
s_waitcnt lgkmcnt(0)
global_store_dwordx4 v0, v[84:87], s[78:79] offset:-3072
s_waitcnt vmcnt(14)
s_barrier
s_add_u32 m0, s29, 16384
s_add_u32 s26, s83, 262144
buffer_load_dwordx4 v32, s[96:99], s26 offen offset:0 lds
buffer_load_dwordx4 v33, s[96:99], s26 offen offset:1024 lds
buffer_load_dwordx4 v34, s[96:99], s26 offen offset:2048 lds
buffer_load_dwordx4 v35, s[96:99], s26 offen offset:3072 lds
ds_read_b64_tr_b16 a[16:17], v40 offset:32768
ds_read_b64_tr_b16 a[18:19], v40 offset:33280
ds_read_b64_tr_b16 a[24:25], v40 offset:32776
ds_read_b64_tr_b16 a[26:27], v40 offset:33288
ds_read_b64_tr_b16 a[56:57], v41 offset:32768
ds_read_b64_tr_b16 a[58:59], v41 offset:33280
ds_read_b64_tr_b16 a[64:65], v41 offset:32776
ds_read_b64_tr_b16 a[66:67], v41 offset:33288
s_waitcnt vmcnt(14) lgkmcnt(0)
s_barrier
s_add_u32 m0, s29, 32768
s_add_u32 s26, s83, 2097152
buffer_load_dwordx4 v32, s[96:99], s26 offen offset:0 lds
buffer_load_dwordx4 v33, s[96:99], s26 offen offset:1024 lds
buffer_load_dwordx4 v34, s[96:99], s26 offen offset:2048 lds
buffer_load_dwordx4 v35, s[96:99], s26 offen offset:3072 lds
ds_read_b64_tr_b16 a[20:21], v40 offset:49152
ds_read_b64_tr_b16 a[22:23], v40 offset:49664
ds_read_b64_tr_b16 a[28:29], v40 offset:49160
ds_read_b64_tr_b16 a[30:31], v40 offset:49672
ds_read_b64_tr_b16 a[60:61], v41 offset:49152
ds_read_b64_tr_b16 a[62:63], v41 offset:49664
ds_read_b64_tr_b16 a[68:69], v41 offset:49160
ds_read_b64_tr_b16 a[70:71], v41 offset:49672
s_waitcnt vmcnt(11) lgkmcnt(0)
s_barrier
s_add_u32 m0, s29, 49152
s_add_u32 s26, s83, 2359296
buffer_load_dwordx4 v32, s[96:99], s26 offen offset:0 lds
buffer_load_dwordx4 v33, s[96:99], s26 offen offset:1024 lds
buffer_load_dwordx4 v34, s[96:99], s26 offen offset:2048 lds
buffer_load_dwordx4 v35, s[96:99], s26 offen offset:3072 lds
ds_read_b64_tr_b16 v[72:73], v40 offset:0
ds_read_b64_tr_b16 v[74:75], v40 offset:512
ds_read_b64_tr_b16 a[72:73], v40 offset:8
ds_read_b64_tr_b16 a[74:75], v40 offset:520
ds_read_b64_tr_b16 a[88:89], v41 offset:0
ds_read_b64_tr_b16 a[90:91], v41 offset:512
ds_read_b64_tr_b16 a[96:97], v41 offset:8
ds_read_b64_tr_b16 a[98:99], v41 offset:520
s_waitcnt lgkmcnt(6)
ds_write_b128 v2, v[72:75] offset:4096
s_waitcnt vmcnt(8) lgkmcnt(1)
s_barrier
s_add_u32 m0, s29, 0
s_add_u32 s26, s84, 0
buffer_load_dwordx4 v32, s[96:99], s26 offen offset:0 lds
buffer_load_dwordx4 v33, s[96:99], s26 offen offset:1024 lds
buffer_load_dwordx4 v34, s[96:99], s26 offen offset:2048 lds
buffer_load_dwordx4 v35, s[96:99], s26 offen offset:3072 lds
ds_read_b64_tr_b16 v[72:73], v40 offset:16384
ds_read_b64_tr_b16 v[74:75], v40 offset:16896
ds_read_b64_tr_b16 a[76:77], v40 offset:16392
ds_read_b64_tr_b16 a[78:79], v40 offset:16904
ds_read_b64_tr_b16 a[92:93], v41 offset:16384
ds_read_b64_tr_b16 a[94:95], v41 offset:16896
ds_read_b64_tr_b16 a[100:101], v41 offset:16392
ds_read_b64_tr_b16 a[102:103], v41 offset:16904
s_waitcnt lgkmcnt(6)
ds_write_b128 v2, v[72:75] offset:5120
s_waitcnt vmcnt(8) lgkmcnt(1)
s_barrier
s_add_u32 m0, s29, 16384
s_add_u32 s26, s84, 262144
buffer_load_dwordx4 v32, s[96:99], s26 offen offset:0 lds
buffer_load_dwordx4 v33, s[96:99], s26 offen offset:1024 lds
buffer_load_dwordx4 v34, s[96:99], s26 offen offset:2048 lds
buffer_load_dwordx4 v35, s[96:99], s26 offen offset:3072 lds
ds_read_b64_tr_b16 a[80:81], v40 offset:32768
ds_read_b64_tr_b16 a[82:83], v40 offset:33280
ds_read_b64_tr_b16 v[76:77], v40 offset:32776
ds_read_b64_tr_b16 v[78:79], v40 offset:33288
ds_read_b64_tr_b16 v[80:81], v41 offset:32768
ds_read_b64_tr_b16 v[82:83], v41 offset:33280
ds_read_b64_tr_b16 a[104:105], v41 offset:32776
ds_read_b64_tr_b16 a[106:107], v41 offset:33288
s_waitcnt lgkmcnt(4)
ds_write_b128 v2, v[76:79] offset:6144
s_waitcnt lgkmcnt(3)
ds_write_b128 v2, v[80:83] offset:8192
s_waitcnt vmcnt(8) lgkmcnt(2)
s_barrier
s_mov_b64 s[96:97], s[74:75]
s_add_u32 m0, s29, 32768
s_add_u32 s26, s85, 0
buffer_load_dwordx4 v36, s[96:99], s26 offen offset:0 lds
buffer_load_dwordx4 v37, s[96:99], s26 offen offset:1024 lds
buffer_load_dwordx4 v38, s[96:99], s26 offen offset:2048 lds
buffer_load_dwordx4 v39, s[96:99], s26 offen offset:3072 lds
ds_read_b64_tr_b16 a[84:85], v40 offset:49152
ds_read_b64_tr_b16 a[86:87], v40 offset:49664
ds_read_b64_tr_b16 v[76:77], v40 offset:49160
ds_read_b64_tr_b16 v[78:79], v40 offset:49672
ds_read_b64_tr_b16 v[80:81], v41 offset:49152
ds_read_b64_tr_b16 v[82:83], v41 offset:49664
ds_read_b64_tr_b16 a[108:109], v41 offset:49160
ds_read_b64_tr_b16 a[110:111], v41 offset:49672
s_waitcnt lgkmcnt(4)
ds_write_b128 v2, v[76:79] offset:7168
s_waitcnt lgkmcnt(3)
ds_write_b128 v2, v[80:83] offset:9216
s_waitcnt vmcnt(8) lgkmcnt(2)
s_barrier
s_add_u32 m0, s29, 49152
s_add_u32 s26, s86, 0
buffer_load_dwordx4 v36, s[96:99], s26 offen offset:0 lds
buffer_load_dwordx4 v37, s[96:99], s26 offen offset:1024 lds
buffer_load_dwordx4 v38, s[96:99], s26 offen offset:2048 lds
buffer_load_dwordx4 v39, s[96:99], s26 offen offset:3072 lds
ds_read_b64_tr_b16 a[112:113], v40 offset:0
ds_read_b64_tr_b16 a[114:115], v40 offset:512
ds_read_b64_tr_b16 v[76:77], v40 offset:8
ds_read_b64_tr_b16 v[78:79], v40 offset:520
ds_read_b64_tr_b16 v[80:81], v41 offset:0
ds_read_b64_tr_b16 v[82:83], v41 offset:512
ds_read_b64_tr_b16 a[120:121], v41 offset:8
ds_read_b64_tr_b16 a[122:123], v41 offset:520
s_waitcnt lgkmcnt(4)
ds_write_b128 v2, v[76:79] offset:10240
s_waitcnt lgkmcnt(3)
global_store_dwordx4 v0, v[80:83], s[78:79] offset:-2048
s_waitcnt vmcnt(9) lgkmcnt(1)
s_barrier
s_add_u32 m0, s29, 0
s_add_u32 s26, s85, 256
buffer_load_dwordx4 v36, s[96:99], s26 offen offset:0 lds
buffer_load_dwordx4 v37, s[96:99], s26 offen offset:1024 lds
buffer_load_dwordx4 v38, s[96:99], s26 offen offset:2048 lds
buffer_load_dwordx4 v39, s[96:99], s26 offen offset:3072 lds
ds_read_b64_tr_b16 a[116:117], v40 offset:16384
ds_read_b64_tr_b16 a[118:119], v40 offset:16896
ds_read_b64_tr_b16 v[76:77], v40 offset:16392
ds_read_b64_tr_b16 v[78:79], v40 offset:16904
ds_read_b64_tr_b16 v[80:81], v41 offset:16384
ds_read_b64_tr_b16 v[82:83], v41 offset:16896
ds_read_b64_tr_b16 a[124:125], v41 offset:16392
ds_read_b64_tr_b16 a[126:127], v41 offset:16904
s_waitcnt lgkmcnt(4)
ds_write_b128 v2, v[76:79] offset:11264
s_waitcnt lgkmcnt(3)
global_store_dwordx4 v0, v[80:83], s[78:79] offset:-1024
s_waitcnt vmcnt(10) lgkmcnt(1)
s_barrier
s_add_u32 m0, s29, 16384
s_add_u32 s26, s86, 256
buffer_load_dwordx4 v36, s[96:99], s26 offen offset:0 lds
buffer_load_dwordx4 v37, s[96:99], s26 offen offset:1024 lds
buffer_load_dwordx4 v38, s[96:99], s26 offen offset:2048 lds
buffer_load_dwordx4 v39, s[96:99], s26 offen offset:3072 lds
ds_read_b64_tr_b16 v[72:73], v42 offset:32768
ds_read_b64_tr_b16 v[74:75], v42 offset:33024
ds_read_b64_tr_b16 v[76:77], v42 offset:34816
ds_read_b64_tr_b16 v[78:79], v42 offset:35072
ds_read_b64_tr_b16 v[8:9], v43 offset:32768
ds_read_b64_tr_b16 v[10:11], v43 offset:33024
ds_read_b64_tr_b16 v[12:13], v43 offset:34816
ds_read_b64_tr_b16 v[14:15], v43 offset:35072
s_waitcnt lgkmcnt(6)
ds_write_b128 v2, v[72:75] offset:22528
s_waitcnt lgkmcnt(5)
ds_write_b128 v2, v[76:79] offset:23552
s_waitcnt vmcnt(10) lgkmcnt(2)
s_barrier
s_add_u32 m0, s29, 32768
s_add_u32 s26, s85, 512
buffer_load_dwordx4 v36, s[96:99], s26 offen offset:0 lds
buffer_load_dwordx4 v37, s[96:99], s26 offen offset:1024 lds
buffer_load_dwordx4 v38, s[96:99], s26 offen offset:2048 lds
buffer_load_dwordx4 v39, s[96:99], s26 offen offset:3072 lds
ds_read_b64_tr_b16 v[16:17], v42 offset:49152
ds_read_b64_tr_b16 v[18:19], v42 offset:49408
ds_read_b64_tr_b16 v[20:21], v42 offset:51200
ds_read_b64_tr_b16 v[22:23], v42 offset:51456
ds_read_b64_tr_b16 v[184:185], v43 offset:49152
ds_read_b64_tr_b16 v[186:187], v43 offset:49408
ds_read_b64_tr_b16 v[188:189], v43 offset:51200
ds_read_b64_tr_b16 v[190:191], v43 offset:51456
s_waitcnt vmcnt(9) lgkmcnt(0)
s_barrier
s_add_u32 m0, s29, 49152
s_add_u32 s26, s86, 512
buffer_load_dwordx4 v36, s[96:99], s26 offen offset:0 lds
buffer_load_dwordx4 v37, s[96:99], s26 offen offset:1024 lds
buffer_load_dwordx4 v38, s[96:99], s26 offen offset:2048 lds
buffer_load_dwordx4 v39, s[96:99], s26 offen offset:3072 lds
ds_read_b64_tr_b16 v[152:153], v42 offset:0
ds_read_b64_tr_b16 v[154:155], v42 offset:256
ds_read_b64_tr_b16 v[156:157], v42 offset:2048
ds_read_b64_tr_b16 v[158:159], v42 offset:2304
ds_read_b64_tr_b16 v[24:25], v43 offset:0
ds_read_b64_tr_b16 v[26:27], v43 offset:256
ds_read_b64_tr_b16 v[28:29], v43 offset:2048
ds_read_b64_tr_b16 v[30:31], v43 offset:2304
s_waitcnt vmcnt(8) lgkmcnt(0)
s_barrier
s_add_u32 m0, s29, 0
s_add_u32 s26, s85, 768
buffer_load_dwordx4 v36, s[96:99], s26 offen offset:0 lds
buffer_load_dwordx4 v37, s[96:99], s26 offen offset:1024 lds
buffer_load_dwordx4 v38, s[96:99], s26 offen offset:2048 lds
buffer_load_dwordx4 v39, s[96:99], s26 offen offset:3072 lds
ds_read_b64_tr_b16 v[192:193], v42 offset:16384
ds_read_b64_tr_b16 v[194:195], v42 offset:16640
ds_read_b64_tr_b16 v[196:197], v42 offset:18432
ds_read_b64_tr_b16 v[198:199], v42 offset:18688
ds_read_b64_tr_b16 v[200:201], v43 offset:16384
ds_read_b64_tr_b16 v[202:203], v43 offset:16640
ds_read_b64_tr_b16 v[204:205], v43 offset:18432
ds_read_b64_tr_b16 v[206:207], v43 offset:18688
s_waitcnt vmcnt(8) lgkmcnt(0)
s_barrier
s_add_u32 m0, s29, 16384
s_add_u32 s26, s86, 768
buffer_load_dwordx4 v36, s[96:99], s26 offen offset:0 lds
buffer_load_dwordx4 v37, s[96:99], s26 offen offset:1024 lds
buffer_load_dwordx4 v38, s[96:99], s26 offen offset:2048 lds
buffer_load_dwordx4 v39, s[96:99], s26 offen offset:3072 lds
ds_read_b64_tr_b16 v[160:161], v42 offset:32768
ds_read_b64_tr_b16 v[162:163], v42 offset:33024
ds_read_b64_tr_b16 v[164:165], v42 offset:34816
ds_read_b64_tr_b16 v[166:167], v42 offset:35072
ds_read_b64_tr_b16 v[48:49], v43 offset:32768
ds_read_b64_tr_b16 v[50:51], v43 offset:33024
ds_read_b64_tr_b16 v[52:53], v43 offset:34816
ds_read_b64_tr_b16 v[54:55], v43 offset:35072
s_waitcnt vmcnt(8) lgkmcnt(0)
s_barrier
s_add_u32 m0, s29, 32768
s_add_u32 s26, s85, 1024
buffer_load_dwordx4 v36, s[96:99], s26 offen offset:0 lds
buffer_load_dwordx4 v37, s[96:99], s26 offen offset:1024 lds
buffer_load_dwordx4 v38, s[96:99], s26 offen offset:2048 lds
buffer_load_dwordx4 v39, s[96:99], s26 offen offset:3072 lds
ds_read_b64_tr_b16 v[56:57], v42 offset:49152
ds_read_b64_tr_b16 v[58:59], v42 offset:49408
ds_read_b64_tr_b16 v[60:61], v42 offset:51200
ds_read_b64_tr_b16 v[62:63], v42 offset:51456
ds_read_b64_tr_b16 v[208:209], v43 offset:49152
ds_read_b64_tr_b16 v[210:211], v43 offset:49408
ds_read_b64_tr_b16 v[212:213], v43 offset:51200
ds_read_b64_tr_b16 v[214:215], v43 offset:51456
s_waitcnt vmcnt(8) lgkmcnt(0)
s_barrier
s_add_u32 m0, s29, 49152
s_add_u32 s26, s86, 1024
buffer_load_dwordx4 v36, s[96:99], s26 offen offset:0 lds
buffer_load_dwordx4 v37, s[96:99], s26 offen offset:1024 lds
buffer_load_dwordx4 v38, s[96:99], s26 offen offset:2048 lds
buffer_load_dwordx4 v39, s[96:99], s26 offen offset:3072 lds
ds_read_b64_tr_b16 v[168:169], v42 offset:0
ds_read_b64_tr_b16 v[170:171], v42 offset:256
ds_read_b64_tr_b16 v[172:173], v42 offset:2048
ds_read_b64_tr_b16 v[174:175], v42 offset:2304
ds_read_b64_tr_b16 v[64:65], v43 offset:0
ds_read_b64_tr_b16 v[66:67], v43 offset:256
ds_read_b64_tr_b16 v[68:69], v43 offset:2048
ds_read_b64_tr_b16 v[70:71], v43 offset:2304
s_waitcnt vmcnt(8) lgkmcnt(0)
s_barrier
ds_read_b64_tr_b16 v[216:217], v42 offset:16384
ds_read_b64_tr_b16 v[218:219], v42 offset:16640
ds_read_b64_tr_b16 v[220:221], v42 offset:18432
ds_read_b64_tr_b16 v[222:223], v42 offset:18688
ds_read_b64_tr_b16 v[224:225], v43 offset:16384
ds_read_b64_tr_b16 v[226:227], v43 offset:16640
ds_read_b64_tr_b16 v[228:229], v43 offset:18432
ds_read_b64_tr_b16 v[230:231], v43 offset:18688
s_waitcnt vmcnt(4) lgkmcnt(0)
s_barrier
ds_read_b64_tr_b16 v[176:177], v42 offset:32768
ds_read_b64_tr_b16 v[178:179], v42 offset:33024
ds_read_b64_tr_b16 v[180:181], v42 offset:34816
ds_read_b64_tr_b16 v[182:183], v42 offset:35072
ds_read_b64_tr_b16 v[232:233], v43 offset:32768
ds_read_b64_tr_b16 v[234:235], v43 offset:33024
ds_read_b64_tr_b16 v[236:237], v43 offset:34816
ds_read_b64_tr_b16 v[238:239], v43 offset:35072
s_waitcnt vmcnt(0) lgkmcnt(0)
s_barrier
ds_read_b64_tr_b16 v[240:241], v42 offset:49152
ds_read_b64_tr_b16 v[242:243], v42 offset:49408
ds_read_b64_tr_b16 v[244:245], v42 offset:51200
ds_read_b64_tr_b16 v[246:247], v42 offset:51456
ds_read_b64_tr_b16 v[248:249], v43 offset:49152
ds_read_b64_tr_b16 v[250:251], v43 offset:49408
ds_read_b64_tr_b16 v[252:253], v43 offset:51200
ds_read_b64_tr_b16 v[254:255], v43 offset:51456
s_waitcnt lgkmcnt(0)
s_barrier
s_mul_i32 s26, s13, 12288
v_add_u32 v44, s26, v0
ds_write_b128 v44, v[8:11] offset:16384
ds_write_b128 v44, v[12:15] offset:17408
ds_write_b128 v44, v[16:19] offset:18432
ds_write_b128 v44, v[20:23] offset:19456
ds_write_b128 v44, v[24:27] offset:20480
ds_write_b128 v44, v[28:31] offset:21504
ds_write_b128 v44, v[48:51] offset:22528
ds_write_b128 v44, v[52:55] offset:23552
ds_write_b128 v44, v[56:59] offset:24576
ds_write_b128 v44, v[60:63] offset:25600
ds_write_b128 v44, v[64:67] offset:26624
ds_write_b128 v44, v[68:71] offset:27648
s_waitcnt vmcnt(0) lgkmcnt(0)
s_barrier
s_cmp_lg_u32 s13, 0
s_cbranch_scc1 cb_10067
v_mov_b32 v44, 4
v_mov_b32 v45, 1
s_mov_b64 exec, 1
buffer_atomic_add v45, v44, s[8:11], 0 offen
s_mov_b32 s30, 0
cb_10066:
buffer_load_dword v45, v44, s[8:11], 0 offen sc1
s_add_u32 s30, s30, 1
s_cmp_gt_u32 s30, 262144
s_cbranch_scc1 L_fail
s_waitcnt vmcnt(0)
v_cmp_gt_u32 vcc, 32, v45
s_cbranch_vccnz cb_10066
s_mov_b64 exec, -1
cb_10067:
s_barrier
s_mov_b32 s18, 0
s_mov_b32 s36, 0
s_cmp_eq_u32 s13, 1
s_cbranch_scc1 wave_10069
s_cmp_eq_u32 s13, 2
s_cbranch_scc1 wave_10070
s_cmp_eq_u32 s13, 3
s_cbranch_scc1 wave_10071
wave_10068:
layer_10072:
s_lshl_b32 s17, s36, 6
s_mul_i32 s27, s36, 35651584
s_mul_i32 s28, s14, 16384
s_add_u32 s27, s27, s28
s_add_u32 s20, s27, 16777216
s_mul_i32 s27, s17, 10240
s_add_u32 s27, s27, s24
s_add_u32 s21, s27, s25
s_mov_b32 s19, 0
s_mov_b32 s33, s6
s_add_u32 s34, s17, 1
s_add_u32 s31, s17, 63
s_add_u32 s32, s17, 64
s_mov_b32 s27, s20
v_mov_b32 v7, 0
s_add_u32 s68, s4, 413696
s_addc_u32 s69, s5, 0
s_add_u32 s72, s4, 397312
s_addc_u32 s73, s5, 0
s_add_u32 s70, s4, 417792
s_addc_u32 s71, s5, 0
s_add_u32 s74, s4, 401408
s_addc_u32 s75, s5, 0
s_add_u32 s58, s4, s20
s_addc_u32 s59, s5, 0
global_load_dwordx4 v[64:67], v0, s[76:77] offset:-4096 sc1
global_load_dwordx4 v[68:71], v0, s[76:77] offset:-3072 sc1
global_load_dwordx4 v[72:75], v0, s[76:77] offset:-2048 sc1
global_load_dwordx4 v[76:79], v0, s[76:77] offset:-1024 sc1
global_load_dwordx4 v[80:83], v0, s[78:79] offset:-4096 sc1
global_load_dwordx4 v[84:87], v0, s[78:79] offset:-3072 sc1
global_load_dwordx4 v[48:51], v0, s[76:77] offset:2048 sc1
global_load_dwordx4 v[52:55], v0, s[76:77] offset:3072 sc1
global_load_dwordx4 v[56:59], v0, s[76:77] offset:0 sc1
global_load_dwordx4 v[60:63], v0, s[76:77] offset:1024 sc1
v_mov_b64 v[8:9], 0
v_mov_b64 v[10:11], 0
v_mov_b64 v[12:13], 0
v_mov_b64 v[14:15], 0
v_mov_b64 v[16:17], 0
v_mov_b64 v[18:19], 0
v_mov_b64 v[20:21], 0
v_mov_b64 v[22:23], 0
v_mov_b64 v[24:25], 0
v_mov_b64 v[26:27], 0
v_mov_b64 v[28:29], 0
v_mov_b64 v[30:31], 0
v_cmp_gt_u32 vcc, s34, v7
s_cmp_eq_u32 vcc_hi, 0
s_cbranch_scc1 kv_10083
s_mov_b32 s30, 0
kv_10082:
v_bfe_u32 v7, v0, 2, 3
buffer_load_dword v7, v7, s[4:7], s22 offen sc1
s_add_u32 s30, s30, 1
s_cmp_gt_u32 s30, 262144
s_cbranch_scc1 L_fail
s_waitcnt vmcnt(0)
v_cmp_gt_u32 vcc, s34, v7
s_cbranch_vccnz kv_10082
kv_10083:
s_barrier
v_and_b32 v7, 511, v0
v_lshl_add_u32 v7, v7, 3, s27
global_load_dwordx4 v[32:35], v0, s[68:69] offset:-4096 sc1
global_load_dwordx4 v[36:39], v0, s[68:69] offset:0 sc1
global_load_dwordx4 v[40:43], v0, s[70:71] offset:0 sc1
s_mov_b32 s30, 0
s_waitcnt vmcnt(0)
.p2align 6
gather_10073:
s_waitcnt vmcnt(4)
rt_10078_b:
v_smfmac_f32_16x16x64_bf16 v[12:15], v[32:35], v[72:79], v1
ds_write_b128 v0, v[32:35] offset:0
v_smfmac_f32_16x16x64_bf16 v[24:27], v[32:35], a[0:7], v1
v_bitop3_b32 v44, v32, v34, s18 bitop3:0x7e
v_smfmac_f32_16x16x64_bf16 v[16:19], v[32:35], v[56:63], v1
s_waitcnt vmcnt(3)
ds_write_b128 v0, v[36:39] offset:4096
v_bitop3_b32 v45, v36, v38, s18 bitop3:0x7e
v_or_b32 v44, v44, v45
s_waitcnt vmcnt(2)
v_bitop3_b32 v45, v40, v42, s18 bitop3:0x7e
v_smfmac_f32_16x16x64_bf16 v[8:11], v[32:35], v[64:71], v1
ds_write_b128 v0, v[40:43] offset:8192
v_bitop3_b32 v44, v44, v45, s19 bitop3:0xa8
v_cmp_ne_u32 vcc, 0, v44
v_smfmac_f32_16x16x64_bf16 v[8:11], v[36:39], a[16:23], v1
s_cbranch_vccnz rt_10078
ds_read_b128 v[56:59], v2 offset:0
v_smfmac_f32_16x16x64_bf16 v[20:23], v[32:35], v[48:55], v1
s_mov_b64 s[68:69], s[72:73]
ds_read_b128 v[60:63], v2 offset:1024
global_load_dwordx4 v[64:67], v0, s[78:79] offset:-2048 sc1
v_smfmac_f32_16x16x64_bf16 v[16:19], v[36:39], a[32:39], v1
s_waitcnt lgkmcnt(2)
ds_read_b128 v[48:51], v2 offset:2048
ds_read_b128 v[52:55], v2 offset:3072
v_smfmac_f32_16x16x64_bf16 v[28:31], v[32:35], a[8:15], v1
s_barrier
ds_read_b128 v[40:43], v0 offset:1024
global_load_dwordx4 v[68:71], v0, s[78:79] offset:-1024 sc1
ds_read_b128 v[32:35], v0 offset:2048
v_smfmac_f32_16x16x64_bf16 v[12:15], v[36:39], a[24:31], v1
s_waitcnt lgkmcnt(4)
ds_read_b128 v[44:47], v0 offset:5120
global_load_dwordx4 v[72:75], v0, s[78:79] offset:0 sc1
v_smfmac_f32_16x16x64_bf16 v[24:27], v[36:39], v[56:63], v1
s_waitcnt lgkmcnt(4)
ds_read_b128 v[56:59], v2 offset:4096
s_waitcnt lgkmcnt(4)
v_smfmac_f32_16x16x64_bf16 v[28:31], v[36:39], v[48:55], v1
ds_read_b128 v[60:63], v2 offset:5120
s_waitcnt lgkmcnt(4)
s_waitcnt vmcnt(3)
v_smfmac_f32_16x16x64_bf16 v[12:15], v[40:43], v[80:87], v1
ds_read_b128 v[80:83], v2 offset:6144
s_xor_b32 s18, s18, 1
v_smfmac_f32_16x16x64_bf16 v[20:23], v[36:39], a[40:47], v1
s_mov_b32 s30, 0
ds_read_b128 v[36:39], v0 offset:6144
ds_read_b128 v[84:87], v2 offset:7168
v_smfmac_f32_16x16x64_bf16 v[8:11], v[40:43], a[48:55], v1
s_waitcnt lgkmcnt(5)
global_load_dwordx4 v[76:79], v0, s[78:79] offset:1024 sc1
v_smfmac_f32_16x16x64_bf16 v[12:15], v[44:47], a[64:71], v1
s_add_u32 s20, s20, 524288
ds_read_b128 v[40:43], v0 offset:3072
s_waitcnt lgkmcnt(5)
v_smfmac_f32_16x16x64_bf16 v[8:11], v[44:47], a[56:63], v1
s_waitcnt lgkmcnt(4)
ds_read_b128 v[44:47], v0 offset:7168
v_smfmac_f32_16x16x64_bf16 v[8:11], v[32:35], v[56:63], v1
ds_read_b128 v[56:59], v2 offset:8192
ds_read_b128 v[60:63], v2 offset:9216
v_smfmac_f32_16x16x64_bf16 v[12:15], v[32:35], a[72:79], v1
s_waitcnt lgkmcnt(5)
global_load_dwordx4 v[48:51], v0, s[58:59] offset:0 nt sc1
v_smfmac_f32_16x16x64_bf16 v[8:11], v[36:39], a[80:87], v1
s_mov_b32 s19, 1
ds_read_b128 v[32:35], v0 offset:8192
s_waitcnt lgkmcnt(5)
v_smfmac_f32_16x16x64_bf16 v[12:15], v[36:39], v[80:87], v1
ds_read_b128 v[80:83], v2 offset:10240
s_waitcnt lgkmcnt(5)
v_smfmac_f32_16x16x64_bf16 v[12:15], v[40:43], a[96:103], v1
ds_read_b128 v[84:87], v2 offset:11264
s_mov_b64 s[70:71], s[74:75]
v_smfmac_f32_16x16x64_bf16 v[8:11], v[40:43], a[88:95], v1
s_waitcnt lgkmcnt(5)
ds_read_b128 v[36:39], v0 offset:9216
s_waitcnt lgkmcnt(4)
v_smfmac_f32_16x16x64_bf16 v[12:15], v[44:47], a[104:111], v1
s_waitcnt vmcnt(4)
ds_read_b128 v[40:43], v0 offset:1024
global_load_dwordx4 v[52:55], v0, s[58:59] offset:1024 nt sc1
v_smfmac_f32_16x16x64_bf16 v[8:11], v[44:47], v[56:63], v1
s_waitcnt lgkmcnt(4)
ds_read_b128 v[60:63], v2 offset:13312
v_smfmac_f32_16x16x64_bf16 v[8:11], v[32:35], a[112:119], v1
s_waitcnt lgkmcnt(4)
ds_read_b128 v[56:59], v2 offset:12288
s_waitcnt lgkmcnt(4)
v_smfmac_f32_16x16x64_bf16 v[12:15], v[32:35], v[80:87], v1
s_waitcnt vmcnt(4)
ds_read_b128 v[84:87], v2 offset:15360
s_waitcnt lgkmcnt(4)
v_smfmac_f32_16x16x64_bf16 v[8:11], v[36:39], v[64:71], v1
s_nop 0
ds_read_b128 v[32:35], v0 offset:5120
ds_read_b128 v[80:83], v2 offset:14336
v_smfmac_f32_16x16x64_bf16 v[12:15], v[36:39], a[120:127], v1
s_waitcnt lgkmcnt(5)
ds_read_b128 v[36:39], v0 offset:2048
global_load_dwordx4 v[64:67], v0, s[78:79] offset:2048 sc1
s_nop 0
v_add_f32 v9, v9, v11
s_waitcnt lgkmcnt(4)
v_add_f32 v8, v8, v10
v_smfmac_f32_16x16x64_bf16 v[16:19], v[40:43], v[56:63], v1
s_waitcnt vmcnt(4)
ds_read_b128 v[60:63], v2 offset:17408
v_add_f32 v13, v13, v15
v_smfmac_f32_16x16x64_bf16 v[20:23], v[40:43], a[128:135], v1
s_waitcnt lgkmcnt(3)
ds_read_b128 v[56:59], v2 offset:16384
v_mul_f32 v8, s35, v8
v_smfmac_f32_16x16x64_bf16 v[16:19], v[32:35], a[136:143], v1
s_waitcnt lgkmcnt(3)
ds_read_b128 v[40:43], v0 offset:6144
v_add_f32 v12, v12, v14
v_smfmac_f32_16x16x64_bf16 v[20:23], v[32:35], v[80:87], v1
s_waitcnt lgkmcnt(3)
ds_read_b128 v[32:35], v0 offset:3072
v_mul_f32 v9, s35, v9
v_mul_f32 v13, s35, v13
v_smfmac_f32_16x16x64_bf16 v[20:23], v[36:39], a[152:159], v1
s_mov_b64 vcc, s[42:43]
ds_read_b128 v[84:87], v2 offset:19456
global_load_dwordx4 v[68:71], v0, s[78:79] offset:3072 sc1
ds_read_b128 v[80:83], v2 offset:18432
v_cvt_pk_bf16_f32 v8, v8, v9
v_smfmac_f32_16x16x64_bf16 v[16:19], v[36:39], a[144:151], v1
s_waitcnt lgkmcnt(5)
ds_read_b128 v[36:39], v0 offset:7168
v_mul_f32 v12, s35, v12
v_cvt_pk_bf16_f32 v12, v12, v13
s_waitcnt lgkmcnt(4)
v_smfmac_f32_16x16x64_bf16 v[20:23], v[40:43], v[56:63], v1
s_waitcnt vmcnt(4)
ds_write2_b32 v3, v8, v12 offset0:0 offset1:128
v_smfmac_f32_16x16x64_bf16 v[16:19], v[40:43], v[72:79], v1
s_waitcnt lgkmcnt(4)
global_load_dwordx4 v[72:75], v0, s[80:81] offset:-4096 sc1
ds_read_b128 v[40:43], v0 offset:8192
v_smfmac_f32_16x16x64_bf16 v[20:23], v[32:35], a[168:175], v1
s_waitcnt lgkmcnt(3)
global_load_dwordx4 v[76:79], v0, s[80:81] offset:-3072 sc1
v_smfmac_f32_16x16x64_bf16 v[16:19], v[32:35], a[160:167], v1
s_waitcnt lgkmcnt(2)
global_load_dwordx4 v[56:59], v0, s[58:59] offset:2048 nt sc1
ds_read_b128 v[32:35], v0 offset:9216
v_smfmac_f32_16x16x64_bf16 v[20:23], v[36:39], v[80:87], v1
s_waitcnt vmcnt(5)
ds_read_b128 v[84:87], v2 offset:21504
global_load_dwordx4 v[60:63], v0, s[58:59] offset:3072 nt sc1
v_smfmac_f32_16x16x64_bf16 v[16:19], v[36:39], a[176:183], v1
s_waitcnt lgkmcnt(2)
ds_read_b128 v[36:39], v0 offset:8192
v_smfmac_f32_16x16x64_bf16 v[20:23], v[40:43], a[192:199], v1
s_barrier
ds_read_b64_tr_b16 v[12:13], v4 offset:1024
v_smfmac_f32_16x16x64_bf16 v[16:19], v[40:43], a[184:191], v1
s_waitcnt lgkmcnt(3)
ds_read_b64_tr_b16 v[8:9], v4 offset:0
ds_read_b64_tr_b16 v[10:11], v4 offset:512
v_smfmac_f32_16x16x64_bf16 v[20:23], v[32:35], a[208:215], v1
s_add_u32 s17, s17, 1
ds_read_b64_tr_b16 v[14:15], v4 offset:1536
s_waitcnt lgkmcnt(4)
ds_read_b128 v[40:43], v0 offset:9216
v_smfmac_f32_16x16x64_bf16 v[28:31], v[36:39], a[224:231], v1
ds_read_b128 v[80:83], v2 offset:20480
v_smfmac_f32_16x16x64_bf16 v[16:19], v[32:35], a[200:207], v1
s_waitcnt lgkmcnt(3)
ds_read_b128 v[32:35], v0 offset:1024
v_smfmac_f32_16x16x64_bf16 v[24:27], v[36:39], a[216:223], v1
v_add_f32 v20, v20, v22
v_mfma_f32_16x16x32_bf16 v[44:47], v[48:51], v[8:11], 0
s_waitcnt lgkmcnt(2)
ds_read_b128 v[36:39], v0 offset:5120
v_add_f32 v21, v21, v23
v_mfma_f32_16x16x32_bf16 v[44:47], v[52:55], v[12:15], v[44:47]
v_add_f32 v16, v16, v18
v_cvt_pk_bf16_f32 v20, v20, v21
v_add_f32 v17, v17, v19
v_bfe_u32 v48, v0, 5, 1
v_cvt_pk_bf16_f32 v16, v16, v17
v_smfmac_f32_16x16x64_bf16 v[24:27], v[40:43], a[232:239], v1
s_waitcnt lgkmcnt(1)
global_load_dword v7, v7, s[4:5] sc1
ds_write2_b32 v3, v16, v20 offset0:1 offset1:129
v_cndmask_b32_dpp v44, v46, v44, vcc quad_perm:[0,1,0,1] row_mask:0xf bank_mask:0xf
v_cndmask_b32_dpp v45, v47, v45, vcc quad_perm:[0,1,0,1] row_mask:0xf bank_mask:0xf
v_lshl_add_u32 v48, v48, 3, v5
v_smfmac_f32_16x16x64_bf16 v[28:31], v[40:43], v[80:87], v1
s_waitcnt vmcnt(5)
ds_write_b64 v48, v[44:45] offset:6144
v_smfmac_f32_16x16x64_bf16 v[24:27], v[32:35], a[240:247], v1
s_waitcnt lgkmcnt(2)
ds_read_b128 v[40:43], v0 offset:2048
v_smfmac_f32_16x16x64_bf16 v[28:31], v[32:35], a[248:255], v1
ds_read_b128 v[32:35], v0 offset:6144
s_waitcnt vmcnt(3)
v_smfmac_f32_16x16x64_bf16 v[24:27], v[36:39], v[64:71], v1
s_waitcnt lgkmcnt(2)
global_load_dwordx4 v[64:67], v0, s[76:77] offset:-4096 sc1
ds_read_b128 v[80:83], v2 offset:22528
v_smfmac_f32_16x16x64_bf16 v[28:31], v[36:39], v[88:95], v1
ds_read_b128 v[36:39], v0 offset:3072
s_barrier
ds_read_b128 v[52:55], v6 offset:7168
s_waitcnt lgkmcnt(3)
ds_read_b128 v[48:51], v6 offset:6144
v_smfmac_f32_16x16x64_bf16 v[28:31], v[40:43], v[104:111], v1
global_load_dwordx4 v[68:71], v0, s[76:77] offset:-3072 sc1
v_smfmac_f32_16x16x64_bf16 v[24:27], v[40:43], v[96:103], v1
ds_read_b128 v[40:43], v0 offset:7168
ds_read_b64_tr_b16 v[8:9], v4 offset:0
v_smfmac_f32_16x16x64_bf16 v[28:31], v[32:35], v[120:127], v1
ds_read_b64_tr_b16 v[10:11], v4 offset:512
ds_read_b64_tr_b16 v[18:19], v4 offset:2560
v_smfmac_f32_16x16x64_bf16 v[24:27], v[32:35], v[112:119], v1
s_waitcnt lgkmcnt(6)
ds_read_b128 v[84:87], v2 offset:23552
ds_read_b64_tr_b16 v[22:23], v4 offset:3584
v_smfmac_f32_16x16x64_bf16 v[28:31], v[36:39], v[136:143], v1
s_waitcnt lgkmcnt(6)
ds_read_b64_tr_b16 v[12:13], v4 offset:1024
v_add_f32 v49, v49, v53
v_add_f32 v50, v50, v54
v_smfmac_f32_16x16x64_bf16 v[24:27], v[36:39], v[128:135], v1
s_waitcnt lgkmcnt(6)
ds_read_b64_tr_b16 v[14:15], v4 offset:1536
v_exp_f32 v50, v50
v_smfmac_f32_16x16x64_bf16 v[28:31], v[40:43], v[144:151], v1
ds_read_b64_tr_b16 v[16:17], v4 offset:2048
v_add_f32 v48, v48, v52
v_add_f32 v51, v51, v55
v_smfmac_f32_16x16x64_bf16 v[24:27], v[40:43], v[72:79], v1
s_waitcnt lgkmcnt(5)
ds_read_b64_tr_b16 v[20:21], v4 offset:3072
v_exp_f32 v51, v51
v_exp_f32 v49, v49
v_mfma_f32_16x16x32_bf16 v[44:47], v[8:11], v[8:11], 0
s_waitcnt lgkmcnt(2)
v_exp_f32 v48, v48
v_mfma_f32_16x16x32_bf16 v[44:47], v[12:15], v[12:15], v[44:47]
s_waitcnt lgkmcnt(1)
v_cvt_pk_bf16_f32 v55, v50, v51
v_cvt_pk_bf16_f32 v54, v48, v49
v_mfma_f32_16x16x32_bf16 v[44:47], v[16:19], v[16:19], v[44:47]
s_waitcnt lgkmcnt(0)
v_mov_b32_dpp v51, v55 quad_perm:[2,3,2,3] row_mask:0xf bank_mask:0xf
v_mov_b32_dpp v49, v55 quad_perm:[0,1,0,1] row_mask:0xf bank_mask:0xf
v_mfma_f32_16x16x32_bf16 v[44:47], v[20:23], v[20:23], v[44:47]
s_waitcnt vmcnt(3)
v_mov_b32_dpp v50, v54 quad_perm:[2,3,2,3] row_mask:0xf bank_mask:0xf
v_mov_b32_dpp v48, v54 quad_perm:[0,1,0,1] row_mask:0xf bank_mask:0xf
v_mov_b64 v[20:21], s[44:45]
v_mov_b64 v[54:55], s[46:47]
v_mov_b64 v[22:23], s[44:45]
v_mfma_f32_16x16x32_bf16 v[12:15], v[60:63], v[48:51], 0
s_nop 0
v_exp_f32_dpp v44, v46 quad_perm:[0,1,0,1] row_mask:0xf bank_mask:0xf
v_mfma_f32_16x16x32_bf16 v[16:19], v[20:23], v[48:51], 0
s_add_u32 s21, s21, 10240
v_exp_f32_dpp v45, v47 quad_perm:[0,1,0,1] row_mask:0xf bank_mask:0xf
v_mfma_f32_16x16x32_bf16 v[8:11], v[56:59], v[48:51], 0
v_cvt_pk_bf16_f32 v52, v44, v45
v_cvt_pk_bf16_f32 v53, v44, v45
v_cvt_pk_bf16_f32 v24, v24, v25
v_cvt_pk_bf16_f32 v25, v26, v27
v_mfma_f32_16x16x16_bf16 v[16:19], v[54:55], v[52:53], v[16:19]
s_add_u32 s34, s17, 2
v_cvt_pk_bf16_f32 v26, v28, v29
v_cvt_pk_bf16_f32 v27, v30, v31
v_mfma_f32_16x16x16_bf16 v[8:11], v[24:25], v[52:53], v[8:11]
v_mov_b64 v[40:41], 0
v_bfe_u32 v32, v0, 5, 1
v_mfma_f32_16x16x16_bf16 v[12:15], v[26:27], v[52:53], v[12:15]
s_min_u32 s34, s34, s32
ds_read_b128 v[28:31], v0 offset:19456
v_mov_b64 v[36:37], 0
v_subrev_u32 v17, s37, v16
v_mov_b64 v[38:39], 0
v_rcp_f32 v18, v16
v_lshl_add_u32 v32, v32, 3, v5
v_cmp_lt_u32 vcc, s38, v17
v_cndmask_b32 v10, v14, v10, s[42:43]
v_cndmask_b32 v9, v13, v9, s[42:43]
v_cndmask_b32 v11, v15, v11, s[42:43]
v_mul_f32 v9, v9, v18
v_mul_f32 v11, v11, v18
v_mul_f32 v10, v10, v18
v_cvt_pk_bf16_f32 v13, v10, v11
v_cndmask_b32 v8, v12, v8, s[42:43]
v_mul_f32 v8, v8, v18
v_cvt_pk_bf16_f32 v12, v8, v9
s_cbranch_vccnz rare_10074
back_10075:
ds_read_b128 v[16:19], v0 offset:16384
ds_write_b64 v32, v[12:13] offset:0
v_mov_b32_dpp v9, v13 quad_perm:[0,1,0,1] row_mask:0xf bank_mask:0xf
v_mov_b32_dpp v10, v12 quad_perm:[2,3,2,3] row_mask:0xf bank_mask:0xf
v_mov_b32_dpp v11, v13 quad_perm:[2,3,2,3] row_mask:0xf bank_mask:0xf
v_mov_b32_dpp v8, v12 quad_perm:[0,1,0,1] row_mask:0xf bank_mask:0xf
v_mov_b64 v[52:53], 0
v_mov_b64 v[42:43], 0
v_smfmac_f32_16x16x64_bf16 v[36:39], v[8:11], v[80:87], v1
ds_read_b128 v[84:87], v0 offset:21504
v_mov_b64 v[54:55], 0
v_mov_b64 v[34:35], 0
v_mov_b64 v[48:49], 0
v_mov_b64 v[50:51], 0
v_smfmac_f32_16x16x64_bf16 v[40:43], v[8:11], v[152:159], v1
s_add_u32 s27, s20, 524288
ds_read_b128 v[80:83], v0 offset:20480
s_waitcnt lgkmcnt(2)
ds_read_b128 v[20:23], v0 offset:17408
s_barrier
ds_read_b128 v[56:59], v5 offset:512
v_smfmac_f32_16x16x64_bf16 v[52:55], v[8:11], v[168:175], v1
ds_read_b128 v[24:27], v0 offset:18432
v_mov_b64 v[32:33], 0
v_smfmac_f32_16x16x64_bf16 v[48:51], v[8:11], v[160:167], v1
s_waitcnt lgkmcnt(4)
ds_read_b128 v[60:63], v5 offset:1024
global_load_dwordx4 v[72:75], v0, s[76:77] offset:-2048 sc1
v_smfmac_f32_16x16x64_bf16 v[32:35], v[8:11], v[176:183], v1
s_waitcnt lgkmcnt(4)
ds_read_b128 v[12:15], v5 offset:1536
global_load_dwordx4 v[76:79], v0, s[76:77] offset:-1024 sc1
v_lshrrev_b32 v44, 8, v0
s_waitcnt lgkmcnt(3)
v_smfmac_f32_16x16x64_bf16 v[40:43], v[56:59], v[80:87], v1
s_add_u32 s58, s4, s20
ds_read_b128 v[84:87], v0 offset:27648
v_smfmac_f32_16x16x64_bf16 v[36:39], v[56:59], v[16:23], v1
s_waitcnt lgkmcnt(3)
ds_read_b128 v[16:19], v0 offset:22528
s_waitcnt lgkmcnt(3)
v_smfmac_f32_16x16x64_bf16 v[36:39], v[60:63], v[24:31], v1
ds_read_b128 v[20:23], v0 offset:23552
s_waitcnt lgkmcnt(3)
v_smfmac_f32_16x16x64_bf16 v[36:39], v[12:15], v[184:191], v1
ds_read_b128 v[24:27], v0 offset:24576
v_bfe_u32 v45, v0, 1, 7
v_smfmac_f32_16x16x64_bf16 v[40:43], v[60:63], v[192:199], v1
s_addc_u32 s59, s5, 0
ds_read_b128 v[28:31], v0 offset:25600
v_lshl_or_b32 v44, v44, 12, v45
v_smfmac_f32_16x16x64_bf16 v[40:43], v[12:15], v[200:207], v1
s_nop 0
ds_read_b128 v[80:83], v0 offset:26624
v_cvt_pk_bf16_f32 v36, v36, v37
v_cvt_pk_bf16_f32 v37, v38, v39
v_and_or_b32 v36, v36, -2, s18
v_smfmac_f32_16x16x64_bf16 v[32:35], v[56:59], v[232:239], v1
global_store_dwordx2 v44, v[36:37], s[48:49]
s_waitcnt lgkmcnt(2)
v_cvt_pk_bf16_f32 v40, v40, v41
v_smfmac_f32_16x16x64_bf16 v[48:51], v[56:59], v[16:23], v1
s_waitcnt lgkmcnt(1)
v_cvt_pk_bf16_f32 v41, v42, v43
v_smfmac_f32_16x16x64_bf16 v[48:51], v[60:63], v[24:31], v1
v_and_or_b32 v40, v40, -2, s18
v_smfmac_f32_16x16x64_bf16 v[48:51], v[12:15], v[208:215], v1
global_store_dwordx2 v44, v[40:41], s[50:51]
s_waitcnt lgkmcnt(0)
v_smfmac_f32_16x16x64_bf16 v[52:55], v[56:59], v[80:87], v1
s_nop 2
v_smfmac_f32_16x16x64_bf16 v[52:55], v[60:63], v[216:223], v1
s_nop 0
v_cvt_pk_bf16_f32 v48, v48, v49
v_smfmac_f32_16x16x64_bf16 v[52:55], v[12:15], v[224:231], v1
v_cvt_pk_bf16_f32 v49, v50, v51
v_and_or_b32 v48, v48, -2, s18
v_smfmac_f32_16x16x64_bf16 v[32:35], v[60:63], v[240:247], v1
global_store_dwordx2 v44, v[48:49], s[52:53]
s_nop 0
v_smfmac_f32_16x16x64_bf16 v[32:35], v[12:15], v[248:255], v1
s_nop 1
v_cvt_pk_bf16_f32 v52, v52, v53
v_cvt_pk_bf16_f32 v53, v54, v55
v_and_or_b32 v52, v52, -2, s18
s_nop 0
global_store_dwordx2 v44, v[52:53], s[54:55]
s_nop 0
v_cvt_pk_bf16_f32 v32, v32, v33
v_and_or_b32 v32, v32, -2, s18
v_cvt_pk_bf16_f32 v33, v34, v35
global_store_dwordx2 v44, v[32:33], s[56:57]
v_bfe_u32 v32, v0, 6, 1
v_lshlrev_b32 v32, 4, v32
v_mov_b32 v33, 0x3f80
v_lshlrev_b32 v32, v32, v33
v_bfe_i32 v33, v0, 4, 1
v_and_b32 v45, v32, v33
v_and_b32 v47, v32, v33
v_xor_b32 v44, v32, v45
v_xor_b32 v46, v32, v45
v_and_b32 v36, 32, v0
v_bfe_u32 v37, v0, 6, 1
v_lshl_add_u32 v36, v37, 8, v36
v_bfe_u32 v37, v0, 8, 1
v_lshl_add_u32 v36, v37, 4, v36
v_bfe_u32 v37, v0, 4, 1
v_lshl_add_u32 v36, v37, 3, v36
s_waitcnt vmcnt(9)
v_and_b32 v7, 511, v0
v_lshl_add_u32 v7, v7, 3, s27
s_nop 15
s_nop 15
s_nop 15
s_nop 8
global_load_dwordx4 v[8:11], v0, s[64:65] offset:0 sc1
global_load_dwordx4 v[12:15], v0, s[64:65] offset:1024 sc1
global_load_dwordx4 v[16:19], v0, s[64:65] offset:2048 sc1
global_load_dwordx4 v[20:23], v0, s[64:65] offset:3072 sc1
chk_10086:
v_mov_b64 v[40:41], 0
v_mov_b64 v[42:43], 0
s_waitcnt vmcnt(2)
s_nop 0
v_smfmac_f32_16x16x64_bf16 v[40:43], v[44:47], v[8:15], v1
v_bitop3_b32 v32, v8, v10, s18 bitop3:0x7e
v_bitop3_b32 v33, v12, v14, s18 bitop3:0x7e
s_waitcnt vmcnt(0)
v_smfmac_f32_16x16x64_bf16 v[40:43], v[44:47], v[16:23], v1
v_bitop3_b32 v34, v16, v18, s18 bitop3:0x7e
v_bitop3_b32 v35, v20, v22, s18 bitop3:0x7e
v_or3_b32 v32, v32, v33, v34
v_bitop3_b32 v32, v32, v35, 1 bitop3:0xa8
v_cmp_ne_u32 vcc, 0, v32
s_cbranch_vccnz chk_10086_f
s_nop 1
v_add_f32_dpp v40, v40, v40 row_ror:8 row_mask:0xf bank_mask:0xf
v_add_f32_dpp v41, v41, v41 row_ror:8 row_mask:0xf bank_mask:0xf
v_add_f32_dpp v42, v42, v42 row_ror:8 row_mask:0xf bank_mask:0xf
v_add_f32_dpp v43, v43, v43 row_ror:8 row_mask:0xf bank_mask:0xf
v_cvt_pk_bf16_f32 v40, v40, v41
v_cvt_pk_bf16_f32 v41, v42, v43
v_and_or_b32 v40, v40, -2, s18
s_mov_b64 exec, 0x00ff00ff
global_store_dwordx2 v36, v[40:41], s[66:67]
s_mov_b64 exec, -1
s_branch join_10085
chk_10086_f:
global_load_dwordx4 v[8:11], v0, s[64:65] offset:0 sc1
global_load_dwordx4 v[12:15], v0, s[64:65] offset:1024 sc1
global_load_dwordx4 v[16:19], v0, s[64:65] offset:2048 sc1
global_load_dwordx4 v[20:23], v0, s[64:65] offset:3072 sc1
s_add_u32 s30, s30, 1
s_cmp_le_u32 s30, 262144
s_cbranch_scc1 chk_10086
s_branch L_fail
nored_10084:
join_10085:
s_nop 11
s_barrier
global_load_dwordx4 v[56:59], v0, s[76:77] offset:0 sc1
global_load_dwordx4 v[60:63], v0, s[76:77] offset:1024 sc1
global_load_dwordx4 v[48:51], v0, s[76:77] offset:2048 sc1
global_load_dwordx4 v[52:55], v0, s[76:77] offset:3072 sc1
s_nop 15
s_nop 15
s_nop 3
s_barrier
global_load_dwordx4 v[32:35], v0, s[68:69] offset:-4096 sc1
s_nop 10
global_load_dwordx4 v[36:39], v0, s[68:69] offset:0 sc1
s_nop 10
global_load_dwordx4 v[40:43], v0, s[70:71] offset:0 sc1
s_barrier
global_load_dwordx4 v[80:83], v0, s[78:79] offset:-4096 sc1
global_load_dwordx4 v[84:87], v0, s[78:79] offset:-3072 sc1
v_mov_b64 v[8:9], 0
v_mov_b64 v[10:11], 0
v_mov_b64 v[12:13], 0
v_mov_b64 v[14:15], 0
v_mov_b64 v[16:17], 0
v_mov_b64 v[18:19], 0
v_mov_b64 v[20:21], 0
v_mov_b64 v[22:23], 0
v_mov_b64 v[24:25], 0
v_mov_b64 v[26:27], 0
v_mov_b64 v[28:29], 0
v_mov_b64 v[30:31], 0
s_mov_b32 s30, 0
s_cmp_eq_u32 s17, s31
s_cbranch_scc0 gather_10073
s_branch exit_10076
rt_10078:
global_load_dwordx4 v[32:35], v0, s[68:69] offset:-4096 sc1
global_load_dwordx4 v[36:39], v0, s[68:69] offset:0 sc1
global_load_dwordx4 v[40:43], v0, s[70:71] offset:0 sc1
s_add_u32 s30, s30, 1
s_cmp_gt_u32 s30, 262144
s_cbranch_scc1 L_fail
s_mov_b64 exec, 1
global_store_dword v0, v0, s[62:63]
global_store_dword v0, v0, s[62:63]
s_mov_b64 exec, -1
v_mov_b64 v[8:9], 0
v_mov_b64 v[10:11], 0
v_mov_b64 v[12:13], 0
v_mov_b64 v[14:15], 0
v_mov_b64 v[16:17], 0
v_mov_b64 v[18:19], 0
v_mov_b64 v[20:21], 0
v_mov_b64 v[22:23], 0
v_mov_b64 v[24:25], 0
v_mov_b64 v[26:27], 0
v_mov_b64 v[28:29], 0
v_mov_b64 v[30:31], 0
s_branch gather_10073
rare_10074:
ds_read_b128 v[48:51], v6 offset:6144
ds_read_b128 v[52:55], v6 offset:7168
s_waitcnt lgkmcnt(0)
v_add_f32 v48, v48, v52
v_add_f32 v49, v49, v53
v_add_f32 v50, v50, v54
v_add_f32 v51, v51, v55
v_mov_b32_dpp v46, v46 quad_perm:[0,1,0,1] row_mask:0xf bank_mask:0xf
v_mov_b32_dpp v47, v47 quad_perm:[0,1,0,1] row_mask:0xf bank_mask:0xf
v_max3_f32 v19, v48, v49, v50
v_max3_f32 v19, v19, v51, v46
v_max_f32 v19, v19, v47
s_nop 1
v_max_f32_dpp v19, v19, v19 quad_perm:[2,3,0,1] row_mask:0xf bank_mask:0xf
v_mov_b32 v44, v19
s_nop 1
v_permlane32_swap_b32 v19, v44
v_max_f32 v19, v19, v44
v_mov_b32 v44, v19
s_nop 1
v_permlane16_swap_b32 v19, v44
v_max_f32 v19, v19, v44
v_sub_f32 v48, v48, v19
v_sub_f32 v49, v49, v19
v_sub_f32 v50, v50, v19
v_sub_f32 v51, v51, v19
v_sub_f32 v46, v46, v19
v_sub_f32 v47, v47, v19
v_exp_f32 v48, v48
v_exp_f32 v49, v49
v_exp_f32 v50, v50
v_exp_f32 v51, v51
v_cvt_pk_bf16_f32 v54, v48, v49
v_cvt_pk_bf16_f32 v55, v50, v51
s_nop 0
v_mov_b32_dpp v48, v54 quad_perm:[0,1,0,1] row_mask:0xf bank_mask:0xf
v_mov_b32_dpp v49, v55 quad_perm:[0,1,0,1] row_mask:0xf bank_mask:0xf
v_mov_b32_dpp v50, v54 quad_perm:[2,3,2,3] row_mask:0xf bank_mask:0xf
v_mov_b32_dpp v51, v55 quad_perm:[2,3,2,3] row_mask:0xf bank_mask:0xf
v_mov_b64 v[20:21], s[44:45]
v_mov_b64 v[22:23], s[44:45]
v_mfma_f32_16x16x32_bf16 v[8:11], v[56:59], v[48:51], 0
v_mfma_f32_16x16x32_bf16 v[12:15], v[60:63], v[48:51], 0
v_mfma_f32_16x16x32_bf16 v[16:19], v[20:23], v[48:51], 0
v_mov_b64 v[54:55], s[46:47]
v_exp_f32_dpp v44, v46 quad_perm:[0,1,0,1] row_mask:0xf bank_mask:0xf
v_exp_f32_dpp v45, v47 quad_perm:[0,1,0,1] row_mask:0xf bank_mask:0xf
s_nop 0
v_cvt_pk_bf16_f32 v52, v44, v45
v_cvt_pk_bf16_f32 v53, v44, v45
s_nop 1
v_mfma_f32_16x16x16_bf16 v[16:19], v[54:55], v[52:53], v[16:19]
v_mfma_f32_16x16x16_bf16 v[8:11], v[24:25], v[52:53], v[8:11]
v_mfma_f32_16x16x16_bf16 v[12:15], v[26:27], v[52:53], v[12:15]
s_nop 5
v_rcp_f32 v18, v16
s_nop 0
v_cndmask_b32 v8, v12, v8, s[42:43]
v_mul_f32 v8, v8, v18
v_cndmask_b32 v9, v13, v9, s[42:43]
v_mul_f32 v9, v9, v18
v_cndmask_b32 v10, v14, v10, s[42:43]
v_mul_f32 v10, v10, v18
v_cndmask_b32 v11, v15, v11, s[42:43]
v_mul_f32 v11, v11, v18
v_cvt_pk_bf16_f32 v12, v8, v9
v_cvt_pk_bf16_f32 v13, v10, v11
s_branch back_10075
exit_10076:
global_load_dwordx4 v[32:35], v0, s[68:69] offset:-4096 sc1
global_load_dwordx4 v[36:39], v0, s[68:69] offset:0 sc1
global_load_dwordx4 v[40:43], v0, s[70:71] offset:0 sc1
s_add_u32 s30, s30, 1
s_cmp_gt_u32 s30, 262144
s_cbranch_scc1 L_fail
s_waitcnt vmcnt(2)
v_bitop3_b32 v44, v32, v34, s18 bitop3:0x7e
s_waitcnt vmcnt(1)
v_bitop3_b32 v45, v36, v38, s18 bitop3:0x7e
v_or_b32 v44, v44, v45
s_waitcnt vmcnt(0)
v_bitop3_b32 v46, v40, v42, s18 bitop3:0x7e
v_bitop3_b32 v44, v44, v46, s19 bitop3:0xa8
v_cmp_ne_u32 vcc, 0, v44
s_cbranch_vccnz exit_10076
ds_write_b128 v0, v[32:35] offset:0
ds_write_b128 v0, v[36:39] offset:4096
ds_write_b128 v0, v[40:43] offset:8192
s_waitcnt lgkmcnt(0)
s_barrier
s_barrier
s_add_u32 s36, s36, 1
s_cmp_lt_u32 s36, 2
s_cbranch_scc1 layer_10072
s_endpgm
wave_10069:
layer_10087:
s_lshl_b32 s17, s36, 6
s_mul_i32 s27, s36, 35651584
s_mul_i32 s28, s14, 16384
s_add_u32 s27, s27, s28
s_add_u32 s20, s27, 16781312
s_mul_i32 s27, s17, 10240
s_add_u32 s27, s27, s24
s_add_u32 s21, s27, s25
s_mov_b32 s19, 0
s_mov_b32 s33, s6
s_add_u32 s34, s17, 1
s_add_u32 s31, s17, 63
s_add_u32 s32, s17, 64
s_mov_b32 s27, s20
v_mov_b32 v7, 0
s_add_u32 s68, s4, 414720
s_addc_u32 s69, s5, 0
s_add_u32 s72, s4, 398336
s_addc_u32 s73, s5, 0
s_add_u32 s70, s4, 418816
s_addc_u32 s71, s5, 0
s_add_u32 s74, s4, 402432
s_addc_u32 s75, s5, 0
s_add_u32 s58, s4, s20
s_addc_u32 s59, s5, 0
global_load_dwordx4 v[64:67], v0, s[76:77] offset:-4096 sc1
global_load_dwordx4 v[68:71], v0, s[76:77] offset:-3072 sc1
global_load_dwordx4 v[72:75], v0, s[76:77] offset:-2048 sc1
global_load_dwordx4 v[76:79], v0, s[76:77] offset:-1024 sc1
global_load_dwordx4 v[80:83], v0, s[78:79] offset:-4096 sc1
global_load_dwordx4 v[84:87], v0, s[78:79] offset:-3072 sc1
global_load_dwordx4 v[48:51], v0, s[76:77] offset:2048 sc1
global_load_dwordx4 v[52:55], v0, s[76:77] offset:3072 sc1
global_load_dwordx4 v[56:59], v0, s[76:77] offset:0 sc1
global_load_dwordx4 v[60:63], v0, s[76:77] offset:1024 sc1
v_mov_b64 v[8:9], 0
v_mov_b64 v[10:11], 0
v_mov_b64 v[12:13], 0
v_mov_b64 v[14:15], 0
v_mov_b64 v[16:17], 0
v_mov_b64 v[18:19], 0
v_mov_b64 v[20:21], 0
v_mov_b64 v[22:23], 0
v_mov_b64 v[24:25], 0
v_mov_b64 v[26:27], 0
v_mov_b64 v[28:29], 0
v_mov_b64 v[30:31], 0
s_barrier
v_and_b32 v7, 511, v0
v_lshl_add_u32 v7, v7, 3, s27
global_load_dwordx4 v[32:35], v0, s[68:69] offset:-4096 sc1
global_load_dwordx4 v[36:39], v0, s[68:69] offset:0 sc1
global_load_dwordx4 v[40:43], v0, s[70:71] offset:0 sc1
s_mov_b32 s30, 0
s_waitcnt vmcnt(0)
.p2align 6
gather_10088:
s_waitcnt vmcnt(4)
rt_10093_b:
v_smfmac_f32_16x16x64_bf16 v[12:15], v[32:35], v[72:79], v1
ds_write_b128 v0, v[32:35] offset:1024
v_smfmac_f32_16x16x64_bf16 v[24:27], v[32:35], a[0:7], v1
v_bitop3_b32 v44, v32, v34, s18 bitop3:0x7e
v_smfmac_f32_16x16x64_bf16 v[16:19], v[32:35], v[56:63], v1
s_waitcnt vmcnt(3)
ds_write_b128 v0, v[36:39] offset:5120
v_bitop3_b32 v45, v36, v38, s18 bitop3:0x7e
v_or_b32 v44, v44, v45
s_waitcnt vmcnt(2)
v_bitop3_b32 v45, v40, v42, s18 bitop3:0x7e
v_smfmac_f32_16x16x64_bf16 v[8:11], v[32:35], v[64:71], v1
ds_write_b128 v0, v[40:43] offset:9216
v_bitop3_b32 v44, v44, v45, s19 bitop3:0xa8
v_cmp_ne_u32 vcc, 0, v44
v_smfmac_f32_16x16x64_bf16 v[8:11], v[36:39], a[16:23], v1
s_cbranch_vccnz rt_10093
ds_read_b128 v[56:59], v2 offset:0
v_smfmac_f32_16x16x64_bf16 v[20:23], v[32:35], v[48:55], v1
s_mov_b64 s[68:69], s[72:73]
ds_read_b128 v[60:63], v2 offset:1024
global_load_dwordx4 v[64:67], v0, s[78:79] offset:-2048 sc1
v_smfmac_f32_16x16x64_bf16 v[16:19], v[36:39], a[32:39], v1
s_waitcnt lgkmcnt(2)
ds_read_b128 v[48:51], v2 offset:2048
ds_read_b128 v[52:55], v2 offset:3072
v_smfmac_f32_16x16x64_bf16 v[28:31], v[32:35], a[8:15], v1
s_barrier
ds_read_b128 v[40:43], v0 offset:0
global_load_dwordx4 v[68:71], v0, s[78:79] offset:-1024 sc1
ds_read_b128 v[32:35], v0 offset:3072
v_smfmac_f32_16x16x64_bf16 v[12:15], v[36:39], a[24:31], v1
s_waitcnt lgkmcnt(4)
ds_read_b128 v[44:47], v0 offset:4096
global_load_dwordx4 v[72:75], v0, s[78:79] offset:0 sc1
v_smfmac_f32_16x16x64_bf16 v[24:27], v[36:39], v[56:63], v1
s_waitcnt lgkmcnt(4)
ds_read_b128 v[56:59], v2 offset:4096
s_waitcnt lgkmcnt(4)
v_smfmac_f32_16x16x64_bf16 v[28:31], v[36:39], v[48:55], v1
ds_read_b128 v[60:63], v2 offset:5120
s_waitcnt lgkmcnt(4)
s_waitcnt vmcnt(3)
v_smfmac_f32_16x16x64_bf16 v[12:15], v[40:43], v[80:87], v1
ds_read_b128 v[80:83], v2 offset:6144
s_xor_b32 s18, s18, 1
v_smfmac_f32_16x16x64_bf16 v[20:23], v[36:39], a[40:47], v1
s_mov_b32 s30, 0
ds_read_b128 v[36:39], v0 offset:7168
ds_read_b128 v[84:87], v2 offset:7168
v_smfmac_f32_16x16x64_bf16 v[8:11], v[40:43], a[48:55], v1
s_waitcnt lgkmcnt(5)
global_load_dwordx4 v[76:79], v0, s[78:79] offset:1024 sc1
v_smfmac_f32_16x16x64_bf16 v[12:15], v[44:47], a[64:71], v1
s_add_u32 s20, s20, 524288
ds_read_b128 v[40:43], v0 offset:2048
s_waitcnt lgkmcnt(5)
v_smfmac_f32_16x16x64_bf16 v[8:11], v[44:47], a[56:63], v1
s_waitcnt lgkmcnt(4)
ds_read_b128 v[44:47], v0 offset:6144
v_smfmac_f32_16x16x64_bf16 v[8:11], v[32:35], v[56:63], v1
ds_read_b128 v[56:59], v2 offset:8192
ds_read_b128 v[60:63], v2 offset:9216
v_smfmac_f32_16x16x64_bf16 v[12:15], v[32:35], a[72:79], v1
s_waitcnt lgkmcnt(5)
global_load_dwordx4 v[48:51], v0, s[58:59] offset:0 nt sc1
v_smfmac_f32_16x16x64_bf16 v[8:11], v[36:39], a[80:87], v1
s_mov_b32 s19, 1
ds_read_b128 v[32:35], v0 offset:9216
s_waitcnt lgkmcnt(5)
v_smfmac_f32_16x16x64_bf16 v[12:15], v[36:39], v[80:87], v1
ds_read_b128 v[80:83], v2 offset:10240
s_waitcnt lgkmcnt(5)
v_smfmac_f32_16x16x64_bf16 v[12:15], v[40:43], a[96:103], v1
ds_read_b128 v[84:87], v2 offset:11264
s_mov_b64 s[70:71], s[74:75]
v_smfmac_f32_16x16x64_bf16 v[8:11], v[40:43], a[88:95], v1
s_waitcnt lgkmcnt(5)
ds_read_b128 v[36:39], v0 offset:8192
s_waitcnt lgkmcnt(4)
v_smfmac_f32_16x16x64_bf16 v[12:15], v[44:47], a[104:111], v1
s_waitcnt vmcnt(4)
ds_read_b128 v[40:43], v0 offset:0
global_load_dwordx4 v[52:55], v0, s[58:59] offset:1024 nt sc1
v_smfmac_f32_16x16x64_bf16 v[8:11], v[44:47], v[56:63], v1
s_waitcnt lgkmcnt(4)
ds_read_b128 v[60:63], v2 offset:13312
v_smfmac_f32_16x16x64_bf16 v[8:11], v[32:35], a[112:119], v1
s_waitcnt lgkmcnt(4)
ds_read_b128 v[56:59], v2 offset:12288
s_waitcnt lgkmcnt(4)
v_smfmac_f32_16x16x64_bf16 v[12:15], v[32:35], v[80:87], v1
s_waitcnt vmcnt(4)
ds_read_b128 v[84:87], v2 offset:15360
s_waitcnt lgkmcnt(4)
v_smfmac_f32_16x16x64_bf16 v[8:11], v[36:39], v[64:71], v1
s_nop 0
ds_read_b128 v[32:35], v0 offset:4096
ds_read_b128 v[80:83], v2 offset:14336
v_smfmac_f32_16x16x64_bf16 v[12:15], v[36:39], a[120:127], v1
s_waitcnt lgkmcnt(5)
ds_read_b128 v[36:39], v0 offset:3072
global_load_dwordx4 v[64:67], v0, s[78:79] offset:2048 sc1
s_nop 0
v_add_f32 v9, v9, v11
s_waitcnt lgkmcnt(4)
v_add_f32 v8, v8, v10
v_smfmac_f32_16x16x64_bf16 v[16:19], v[40:43], v[56:63], v1
s_waitcnt vmcnt(4)
ds_read_b128 v[60:63], v2 offset:17408
v_add_f32 v13, v13, v15
v_smfmac_f32_16x16x64_bf16 v[20:23], v[40:43], a[128:135], v1
s_waitcnt lgkmcnt(3)
ds_read_b128 v[56:59], v2 offset:16384
v_mul_f32 v8, s35, v8
v_smfmac_f32_16x16x64_bf16 v[16:19], v[32:35], a[136:143], v1
s_waitcnt lgkmcnt(3)
ds_read_b128 v[40:43], v0 offset:7168
v_add_f32 v12, v12, v14
v_smfmac_f32_16x16x64_bf16 v[20:23], v[32:35], v[80:87], v1
s_waitcnt lgkmcnt(3)
ds_read_b128 v[32:35], v0 offset:2048
v_mul_f32 v9, s35, v9
v_mul_f32 v13, s35, v13
v_smfmac_f32_16x16x64_bf16 v[20:23], v[36:39], a[152:159], v1
s_mov_b64 vcc, s[42:43]
ds_read_b128 v[84:87], v2 offset:19456
global_load_dwordx4 v[68:71], v0, s[78:79] offset:3072 sc1
ds_read_b128 v[80:83], v2 offset:18432
v_cvt_pk_bf16_f32 v8, v8, v9
v_smfmac_f32_16x16x64_bf16 v[16:19], v[36:39], a[144:151], v1
s_waitcnt lgkmcnt(5)
ds_read_b128 v[36:39], v0 offset:6144
v_mul_f32 v12, s35, v12
v_cvt_pk_bf16_f32 v12, v12, v13
s_waitcnt lgkmcnt(4)
v_smfmac_f32_16x16x64_bf16 v[20:23], v[40:43], v[56:63], v1
s_waitcnt vmcnt(4)
ds_write2_b32 v3, v8, v12 offset0:0 offset1:128
v_smfmac_f32_16x16x64_bf16 v[16:19], v[40:43], v[72:79], v1
s_waitcnt lgkmcnt(4)
global_load_dwordx4 v[72:75], v0, s[80:81] offset:-4096 sc1
ds_read_b128 v[40:43], v0 offset:9216
v_smfmac_f32_16x16x64_bf16 v[20:23], v[32:35], a[168:175], v1
s_waitcnt lgkmcnt(3)
global_load_dwordx4 v[76:79], v0, s[80:81] offset:-3072 sc1
v_smfmac_f32_16x16x64_bf16 v[16:19], v[32:35], a[160:167], v1
s_waitcnt lgkmcnt(2)
global_load_dwordx4 v[56:59], v0, s[58:59] offset:2048 nt sc1
ds_read_b128 v[32:35], v0 offset:8192
v_smfmac_f32_16x16x64_bf16 v[20:23], v[36:39], v[80:87], v1
s_waitcnt vmcnt(5)
ds_read_b128 v[84:87], v2 offset:21504
global_load_dwordx4 v[60:63], v0, s[58:59] offset:3072 nt sc1
v_smfmac_f32_16x16x64_bf16 v[16:19], v[36:39], a[176:183], v1
s_waitcnt lgkmcnt(2)
ds_read_b128 v[36:39], v0 offset:9216
v_smfmac_f32_16x16x64_bf16 v[20:23], v[40:43], a[192:199], v1
s_barrier
ds_read_b64_tr_b16 v[12:13], v4 offset:1024
v_smfmac_f32_16x16x64_bf16 v[16:19], v[40:43], a[184:191], v1
s_waitcnt lgkmcnt(3)
ds_read_b64_tr_b16 v[8:9], v4 offset:0
ds_read_b64_tr_b16 v[10:11], v4 offset:512
v_smfmac_f32_16x16x64_bf16 v[20:23], v[32:35], a[208:215], v1
s_add_u32 s17, s17, 1
ds_read_b64_tr_b16 v[14:15], v4 offset:1536
s_waitcnt lgkmcnt(4)
ds_read_b128 v[40:43], v0 offset:8192
v_smfmac_f32_16x16x64_bf16 v[28:31], v[36:39], a[224:231], v1
ds_read_b128 v[80:83], v2 offset:20480
v_smfmac_f32_16x16x64_bf16 v[16:19], v[32:35], a[200:207], v1
s_waitcnt lgkmcnt(3)
ds_read_b128 v[32:35], v0 offset:0
v_smfmac_f32_16x16x64_bf16 v[24:27], v[36:39], a[216:223], v1
v_add_f32 v20, v20, v22
v_mfma_f32_16x16x32_bf16 v[44:47], v[48:51], v[8:11], 0
s_waitcnt lgkmcnt(2)
ds_read_b128 v[36:39], v0 offset:4096
v_add_f32 v21, v21, v23
v_mfma_f32_16x16x32_bf16 v[44:47], v[52:55], v[12:15], v[44:47]
v_add_f32 v16, v16, v18
v_cvt_pk_bf16_f32 v20, v20, v21
v_add_f32 v17, v17, v19
v_bfe_u32 v48, v0, 5, 1
v_cvt_pk_bf16_f32 v16, v16, v17
v_smfmac_f32_16x16x64_bf16 v[24:27], v[40:43], a[232:239], v1
s_waitcnt lgkmcnt(1)
global_load_dword v7, v7, s[4:5] sc1
ds_write2_b32 v3, v16, v20 offset0:1 offset1:129
v_cndmask_b32_dpp v44, v46, v44, vcc quad_perm:[0,1,0,1] row_mask:0xf bank_mask:0xf
v_cndmask_b32_dpp v45, v47, v45, vcc quad_perm:[0,1,0,1] row_mask:0xf bank_mask:0xf
v_lshl_add_u32 v48, v48, 3, v5
v_xor_b32 v48, 128, v48
v_smfmac_f32_16x16x64_bf16 v[28:31], v[40:43], v[80:87], v1
s_waitcnt vmcnt(5)
ds_write_b64 v48, v[44:45] offset:6656
v_smfmac_f32_16x16x64_bf16 v[24:27], v[32:35], a[240:247], v1
s_waitcnt lgkmcnt(2)
ds_read_b128 v[40:43], v0 offset:3072
v_smfmac_f32_16x16x64_bf16 v[28:31], v[32:35], a[248:255], v1
ds_read_b128 v[32:35], v0 offset:7168
s_waitcnt vmcnt(3)
v_smfmac_f32_16x16x64_bf16 v[24:27], v[36:39], v[64:71], v1
s_waitcnt lgkmcnt(2)
global_load_dwordx4 v[64:67], v0, s[76:77] offset:-4096 sc1
ds_read_b128 v[80:83], v2 offset:22528
v_smfmac_f32_16x16x64_bf16 v[28:31], v[36:39], v[88:95], v1
ds_read_b128 v[36:39], v0 offset:2048
s_barrier
ds_read_b128 v[52:55], v6 offset:7168
s_waitcnt lgkmcnt(3)
ds_read_b128 v[48:51], v6 offset:6144
v_smfmac_f32_16x16x64_bf16 v[28:31], v[40:43], v[104:111], v1
global_load_dwordx4 v[68:71], v0, s[76:77] offset:-3072 sc1
v_smfmac_f32_16x16x64_bf16 v[24:27], v[40:43], v[96:103], v1
ds_read_b128 v[40:43], v0 offset:6144
ds_read_b64_tr_b16 v[8:9], v4 offset:0
v_smfmac_f32_16x16x64_bf16 v[28:31], v[32:35], v[120:127], v1
ds_read_b64_tr_b16 v[10:11], v4 offset:512
ds_read_b64_tr_b16 v[18:19], v4 offset:2560
v_smfmac_f32_16x16x64_bf16 v[24:27], v[32:35], v[112:119], v1
s_waitcnt lgkmcnt(6)
ds_read_b128 v[84:87], v2 offset:23552
ds_read_b64_tr_b16 v[22:23], v4 offset:3584
v_smfmac_f32_16x16x64_bf16 v[28:31], v[36:39], v[136:143], v1
s_waitcnt lgkmcnt(6)
ds_read_b64_tr_b16 v[12:13], v4 offset:1024
v_add_f32 v49, v49, v53
v_add_f32 v50, v50, v54
v_smfmac_f32_16x16x64_bf16 v[24:27], v[36:39], v[128:135], v1
s_waitcnt lgkmcnt(6)
ds_read_b64_tr_b16 v[14:15], v4 offset:1536
v_exp_f32 v50, v50
v_smfmac_f32_16x16x64_bf16 v[28:31], v[40:43], v[144:151], v1
ds_read_b64_tr_b16 v[16:17], v4 offset:2048
v_add_f32 v48, v48, v52
v_add_f32 v51, v51, v55
v_smfmac_f32_16x16x64_bf16 v[24:27], v[40:43], v[72:79], v1
s_waitcnt lgkmcnt(5)
ds_read_b64_tr_b16 v[20:21], v4 offset:3072
v_exp_f32 v51, v51
v_exp_f32 v49, v49
v_mfma_f32_16x16x32_bf16 v[44:47], v[8:11], v[8:11], 0
s_waitcnt lgkmcnt(2)
v_exp_f32 v48, v48
v_mfma_f32_16x16x32_bf16 v[44:47], v[12:15], v[12:15], v[44:47]
s_waitcnt lgkmcnt(1)
v_cvt_pk_bf16_f32 v55, v50, v51
v_cvt_pk_bf16_f32 v54, v48, v49
v_mfma_f32_16x16x32_bf16 v[44:47], v[16:19], v[16:19], v[44:47]
s_waitcnt lgkmcnt(0)
v_mov_b32_dpp v51, v55 quad_perm:[2,3,2,3] row_mask:0xf bank_mask:0xf
v_mov_b32_dpp v49, v55 quad_perm:[0,1,0,1] row_mask:0xf bank_mask:0xf
v_mfma_f32_16x16x32_bf16 v[44:47], v[20:23], v[20:23], v[44:47]
s_waitcnt vmcnt(3)
v_mov_b32_dpp v50, v54 quad_perm:[2,3,2,3] row_mask:0xf bank_mask:0xf
v_mov_b32_dpp v48, v54 quad_perm:[0,1,0,1] row_mask:0xf bank_mask:0xf
v_mov_b64 v[20:21], s[44:45]
v_mov_b64 v[54:55], s[46:47]
v_mov_b64 v[22:23], s[44:45]
v_mfma_f32_16x16x32_bf16 v[12:15], v[60:63], v[48:51], 0
s_nop 0
v_exp_f32_dpp v44, v46 quad_perm:[0,1,0,1] row_mask:0xf bank_mask:0xf
v_mfma_f32_16x16x32_bf16 v[16:19], v[20:23], v[48:51], 0
s_add_u32 s21, s21, 10240
v_exp_f32_dpp v45, v47 quad_perm:[0,1,0,1] row_mask:0xf bank_mask:0xf
v_mfma_f32_16x16x32_bf16 v[8:11], v[56:59], v[48:51], 0
v_cvt_pk_bf16_f32 v52, v44, v45
v_cvt_pk_bf16_f32 v53, v44, v45
v_cvt_pk_bf16_f32 v24, v24, v25
v_cvt_pk_bf16_f32 v25, v26, v27
v_mfma_f32_16x16x16_bf16 v[16:19], v[54:55], v[52:53], v[16:19]
s_add_u32 s34, s17, 2
v_cvt_pk_bf16_f32 v26, v28, v29
v_cvt_pk_bf16_f32 v27, v30, v31
v_mfma_f32_16x16x16_bf16 v[8:11], v[24:25], v[52:53], v[8:11]
v_mov_b64 v[40:41], 0
v_bfe_u32 v32, v0, 5, 1
v_mfma_f32_16x16x16_bf16 v[12:15], v[26:27], v[52:53], v[12:15]
s_min_u32 s34, s34, s32
ds_read_b128 v[28:31], v0 offset:31744
v_mov_b64 v[36:37], 0
v_subrev_u32 v17, s37, v16
v_mov_b64 v[38:39], 0
v_rcp_f32 v18, v16
v_lshl_add_u32 v32, v32, 3, v5
v_cmp_lt_u32 vcc, s38, v17
v_cndmask_b32 v10, v14, v10, s[42:43]
v_cndmask_b32 v9, v13, v9, s[42:43]
v_cndmask_b32 v11, v15, v11, s[42:43]
v_mul_f32 v9, v9, v18
v_mul_f32 v11, v11, v18
v_mul_f32 v10, v10, v18
v_cvt_pk_bf16_f32 v13, v10, v11
v_cndmask_b32 v8, v12, v8, s[42:43]
v_mul_f32 v8, v8, v18
v_cvt_pk_bf16_f32 v12, v8, v9
s_cbranch_vccnz rare_10089
back_10090:
ds_read_b128 v[16:19], v0 offset:28672
ds_write_b64 v32, v[12:13] offset:512
v_mov_b32_dpp v9, v13 quad_perm:[0,1,0,1] row_mask:0xf bank_mask:0xf
v_mov_b32_dpp v10, v12 quad_perm:[2,3,2,3] row_mask:0xf bank_mask:0xf
v_mov_b32_dpp v11, v13 quad_perm:[2,3,2,3] row_mask:0xf bank_mask:0xf
v_mov_b32_dpp v8, v12 quad_perm:[0,1,0,1] row_mask:0xf bank_mask:0xf
v_mov_b64 v[52:53], 0
v_mov_b64 v[42:43], 0
v_smfmac_f32_16x16x64_bf16 v[36:39], v[8:11], v[80:87], v1
ds_read_b128 v[84:87], v0 offset:33792
v_mov_b64 v[54:55], 0
v_mov_b64 v[34:35], 0
v_mov_b64 v[48:49], 0
v_mov_b64 v[50:51], 0
v_smfmac_f32_16x16x64_bf16 v[40:43], v[8:11], v[152:159], v1
s_add_u32 s27, s20, 524288
ds_read_b128 v[80:83], v0 offset:32768
s_waitcnt lgkmcnt(2)
ds_read_b128 v[20:23], v0 offset:29696
s_barrier
ds_read_b128 v[56:59], v5 offset:0
v_smfmac_f32_16x16x64_bf16 v[52:55], v[8:11], v[168:175], v1
ds_read_b128 v[24:27], v0 offset:30720
v_mov_b64 v[32:33], 0
v_smfmac_f32_16x16x64_bf16 v[48:51], v[8:11], v[160:167], v1
s_waitcnt lgkmcnt(4)
ds_read_b128 v[60:63], v5 offset:1536
global_load_dwordx4 v[72:75], v0, s[76:77] offset:-2048 sc1
v_smfmac_f32_16x16x64_bf16 v[32:35], v[8:11], v[176:183], v1
s_waitcnt lgkmcnt(4)
ds_read_b128 v[12:15], v5 offset:1024
global_load_dwordx4 v[76:79], v0, s[76:77] offset:-1024 sc1
v_lshrrev_b32 v44, 8, v0
s_waitcnt lgkmcnt(3)
v_smfmac_f32_16x16x64_bf16 v[40:43], v[56:59], v[80:87], v1
s_add_u32 s58, s4, s20
ds_read_b128 v[84:87], v0 offset:39936
v_smfmac_f32_16x16x64_bf16 v[36:39], v[56:59], v[16:23], v1
s_waitcnt lgkmcnt(3)
ds_read_b128 v[16:19], v0 offset:34816
s_waitcnt lgkmcnt(3)
v_smfmac_f32_16x16x64_bf16 v[36:39], v[60:63], v[24:31], v1
ds_read_b128 v[20:23], v0 offset:35840
s_waitcnt lgkmcnt(3)
v_smfmac_f32_16x16x64_bf16 v[36:39], v[12:15], v[184:191], v1
ds_read_b128 v[24:27], v0 offset:36864
v_bfe_u32 v45, v0, 1, 7
v_smfmac_f32_16x16x64_bf16 v[40:43], v[60:63], v[192:199], v1
s_addc_u32 s59, s5, 0
ds_read_b128 v[28:31], v0 offset:37888
v_lshl_or_b32 v44, v44, 12, v45
v_smfmac_f32_16x16x64_bf16 v[40:43], v[12:15], v[200:207], v1
s_nop 0
ds_read_b128 v[80:83], v0 offset:38912
v_cvt_pk_bf16_f32 v36, v36, v37
v_cvt_pk_bf16_f32 v37, v38, v39
v_and_or_b32 v36, v36, -2, s18
v_smfmac_f32_16x16x64_bf16 v[32:35], v[56:59], v[232:239], v1
global_store_dwordx2 v44, v[36:37], s[48:49]
s_waitcnt lgkmcnt(2)
v_cvt_pk_bf16_f32 v40, v40, v41
v_smfmac_f32_16x16x64_bf16 v[48:51], v[56:59], v[16:23], v1
s_waitcnt lgkmcnt(1)
v_cvt_pk_bf16_f32 v41, v42, v43
v_smfmac_f32_16x16x64_bf16 v[48:51], v[60:63], v[24:31], v1
v_and_or_b32 v40, v40, -2, s18
v_smfmac_f32_16x16x64_bf16 v[48:51], v[12:15], v[208:215], v1
global_store_dwordx2 v44, v[40:41], s[50:51]
s_waitcnt lgkmcnt(0)
v_smfmac_f32_16x16x64_bf16 v[52:55], v[56:59], v[80:87], v1
s_nop 2
v_smfmac_f32_16x16x64_bf16 v[52:55], v[60:63], v[216:223], v1
s_nop 0
v_cvt_pk_bf16_f32 v48, v48, v49
v_smfmac_f32_16x16x64_bf16 v[52:55], v[12:15], v[224:231], v1
v_cvt_pk_bf16_f32 v49, v50, v51
v_and_or_b32 v48, v48, -2, s18
v_smfmac_f32_16x16x64_bf16 v[32:35], v[60:63], v[240:247], v1
global_store_dwordx2 v44, v[48:49], s[52:53]
s_nop 0
v_smfmac_f32_16x16x64_bf16 v[32:35], v[12:15], v[248:255], v1
s_nop 1
v_cvt_pk_bf16_f32 v52, v52, v53
v_cvt_pk_bf16_f32 v53, v54, v55
v_and_or_b32 v52, v52, -2, s18
s_nop 0
global_store_dwordx2 v44, v[52:53], s[54:55]
s_nop 0
v_cvt_pk_bf16_f32 v32, v32, v33
v_and_or_b32 v32, v32, -2, s18
v_cvt_pk_bf16_f32 v33, v34, v35
global_store_dwordx2 v44, v[32:33], s[56:57]
v_bfe_u32 v32, v0, 6, 1
v_lshlrev_b32 v32, 4, v32
v_mov_b32 v33, 0x3f80
v_lshlrev_b32 v32, v32, v33
v_bfe_i32 v33, v0, 4, 1
v_and_b32 v45, v32, v33
v_and_b32 v47, v32, v33
v_xor_b32 v44, v32, v45
v_xor_b32 v46, v32, v45
v_and_b32 v36, 32, v0
v_bfe_u32 v37, v0, 6, 1
v_lshl_add_u32 v36, v37, 8, v36
v_bfe_u32 v37, v0, 8, 1
v_lshl_add_u32 v36, v37, 4, v36
v_bfe_u32 v37, v0, 4, 1
v_lshl_add_u32 v36, v37, 3, v36
s_waitcnt vmcnt(9)
v_and_b32 v7, 511, v0
v_lshl_add_u32 v7, v7, 3, s27
s_nop 15
s_nop 15
s_nop 15
s_nop 15
global_load_dwordx4 v[8:11], v0, s[64:65] offset:0 sc1
global_load_dwordx4 v[12:15], v0, s[64:65] offset:1024 sc1
global_load_dwordx4 v[16:19], v0, s[64:65] offset:2048 sc1
global_load_dwordx4 v[20:23], v0, s[64:65] offset:3072 sc1
s_nop 15
s_nop 15
s_nop 5
global_load_dwordx4 v[24:27], v0, s[64:65] offset:0 sc1
global_load_dwordx4 v[28:31], v0, s[64:65] offset:1024 sc1
global_load_dwordx4 v[80:83], v0, s[64:65] offset:2048 sc1
global_load_dwordx4 v[84:87], v0, s[64:65] offset:3072 sc1
chk_10098:
v_mov_b64 v[40:41], 0
v_mov_b64 v[42:43], 0
s_waitcnt vmcnt(6)
s_nop 0
v_smfmac_f32_16x16x64_bf16 v[40:43], v[44:47], v[8:15], v1
v_bitop3_b32 v32, v8, v10, s18 bitop3:0x7e
v_bitop3_b32 v33, v12, v14, s18 bitop3:0x7e
s_waitcnt vmcnt(4)
v_smfmac_f32_16x16x64_bf16 v[40:43], v[44:47], v[16:23], v1
v_bitop3_b32 v34, v16, v18, s18 bitop3:0x7e
v_bitop3_b32 v35, v20, v22, s18 bitop3:0x7e
v_or3_b32 v32, v32, v33, v34
v_bitop3_b32 v32, v32, v35, 1 bitop3:0xa8
v_cmp_ne_u32 vcc, 0, v32
s_cbranch_vccnz chk_10098_f
s_nop 1
v_add_f32_dpp v40, v40, v40 row_ror:8 row_mask:0xf bank_mask:0xf
v_add_f32_dpp v41, v41, v41 row_ror:8 row_mask:0xf bank_mask:0xf
v_add_f32_dpp v42, v42, v42 row_ror:8 row_mask:0xf bank_mask:0xf
v_add_f32_dpp v43, v43, v43 row_ror:8 row_mask:0xf bank_mask:0xf
v_cvt_pk_bf16_f32 v40, v40, v41
v_cvt_pk_bf16_f32 v41, v42, v43
v_and_or_b32 v40, v40, -2, s18
s_mov_b64 exec, 0x00ff00ff
global_store_dwordx2 v36, v[40:41], s[66:67]
s_mov_b64 exec, -1
s_branch join_10097
chk_10098_f:
global_load_dwordx4 v[8:11], v0, s[64:65] offset:0 sc1
global_load_dwordx4 v[12:15], v0, s[64:65] offset:1024 sc1
global_load_dwordx4 v[16:19], v0, s[64:65] offset:2048 sc1
global_load_dwordx4 v[20:23], v0, s[64:65] offset:3072 sc1
chk_10099:
v_mov_b64 v[40:41], 0
v_mov_b64 v[42:43], 0
s_waitcnt vmcnt(6)
s_nop 0
v_smfmac_f32_16x16x64_bf16 v[40:43], v[44:47], v[24:31], v1
v_bitop3_b32 v32, v24, v26, s18 bitop3:0x7e
v_bitop3_b32 v33, v28, v30, s18 bitop3:0x7e
s_waitcnt vmcnt(4)
v_smfmac_f32_16x16x64_bf16 v[40:43], v[44:47], v[80:87], v1
v_bitop3_b32 v34, v80, v82, s18 bitop3:0x7e
v_bitop3_b32 v35, v84, v86, s18 bitop3:0x7e
v_or3_b32 v32, v32, v33, v34
v_bitop3_b32 v32, v32, v35, 1 bitop3:0xa8
v_cmp_ne_u32 vcc, 0, v32
s_cbranch_vccnz chk_10099_f
s_nop 1
v_add_f32_dpp v40, v40, v40 row_ror:8 row_mask:0xf bank_mask:0xf
v_add_f32_dpp v41, v41, v41 row_ror:8 row_mask:0xf bank_mask:0xf
v_add_f32_dpp v42, v42, v42 row_ror:8 row_mask:0xf bank_mask:0xf
v_add_f32_dpp v43, v43, v43 row_ror:8 row_mask:0xf bank_mask:0xf
v_cvt_pk_bf16_f32 v40, v40, v41
v_cvt_pk_bf16_f32 v41, v42, v43
v_and_or_b32 v40, v40, -2, s18
s_mov_b64 exec, 0x00ff00ff
global_store_dwordx2 v36, v[40:41], s[66:67]
s_mov_b64 exec, -1
s_branch join_10097
chk_10099_f:
global_load_dwordx4 v[24:27], v0, s[64:65] offset:0 sc1
global_load_dwordx4 v[28:31], v0, s[64:65] offset:1024 sc1
global_load_dwordx4 v[80:83], v0, s[64:65] offset:2048 sc1
global_load_dwordx4 v[84:87], v0, s[64:65] offset:3072 sc1
s_add_u32 s30, s30, 1
s_cmp_le_u32 s30, 262144
s_cbranch_scc1 chk_10098
s_branch L_fail
nored_10096:
join_10097:
s_barrier
global_load_dwordx4 v[56:59], v0, s[76:77] offset:0 sc1
global_load_dwordx4 v[60:63], v0, s[76:77] offset:1024 sc1
global_load_dwordx4 v[48:51], v0, s[76:77] offset:2048 sc1
global_load_dwordx4 v[52:55], v0, s[76:77] offset:3072 sc1
s_nop 15
s_nop 15
s_nop 3
s_barrier
global_load_dwordx4 v[32:35], v0, s[68:69] offset:-4096 sc1
s_nop 10
global_load_dwordx4 v[36:39], v0, s[68:69] offset:0 sc1
s_nop 10
global_load_dwordx4 v[40:43], v0, s[70:71] offset:0 sc1
s_barrier
global_load_dwordx4 v[80:83], v0, s[78:79] offset:-4096 sc1
global_load_dwordx4 v[84:87], v0, s[78:79] offset:-3072 sc1
s_waitcnt vmcnt(13)
v_mov_b64 v[8:9], 0
v_mov_b64 v[10:11], 0
s_waitcnt vmcnt(12)
v_mov_b64 v[12:13], 0
v_mov_b64 v[14:15], 0
s_waitcnt vmcnt(11)
v_mov_b64 v[16:17], 0
v_mov_b64 v[18:19], 0
s_waitcnt vmcnt(10)
v_mov_b64 v[20:21], 0
v_mov_b64 v[22:23], 0
v_mov_b64 v[24:25], 0
v_mov_b64 v[26:27], 0
v_mov_b64 v[28:29], 0
v_mov_b64 v[30:31], 0
s_mov_b32 s30, 0
s_cmp_eq_u32 s17, s31
s_cbranch_scc0 gather_10088
s_branch exit_10091
rt_10093:
global_load_dwordx4 v[32:35], v0, s[68:69] offset:-4096 sc1
global_load_dwordx4 v[36:39], v0, s[68:69] offset:0 sc1
global_load_dwordx4 v[40:43], v0, s[70:71] offset:0 sc1
s_add_u32 s30, s30, 1
s_cmp_gt_u32 s30, 262144
s_cbranch_scc1 L_fail
s_mov_b64 exec, 1
global_store_dword v0, v0, s[62:63]
global_store_dword v0, v0, s[62:63]
s_mov_b64 exec, -1
v_mov_b64 v[8:9], 0
v_mov_b64 v[10:11], 0
v_mov_b64 v[12:13], 0
v_mov_b64 v[14:15], 0
v_mov_b64 v[16:17], 0
v_mov_b64 v[18:19], 0
v_mov_b64 v[20:21], 0
v_mov_b64 v[22:23], 0
v_mov_b64 v[24:25], 0
v_mov_b64 v[26:27], 0
v_mov_b64 v[28:29], 0
v_mov_b64 v[30:31], 0
s_branch gather_10088
rare_10089:
ds_read_b128 v[48:51], v6 offset:6144
ds_read_b128 v[52:55], v6 offset:7168
s_waitcnt lgkmcnt(0)
v_add_f32 v48, v48, v52
v_add_f32 v49, v49, v53
v_add_f32 v50, v50, v54
v_add_f32 v51, v51, v55
v_mov_b32_dpp v46, v46 quad_perm:[0,1,0,1] row_mask:0xf bank_mask:0xf
v_mov_b32_dpp v47, v47 quad_perm:[0,1,0,1] row_mask:0xf bank_mask:0xf
v_max3_f32 v19, v48, v49, v50
v_max3_f32 v19, v19, v51, v46
v_max_f32 v19, v19, v47
s_nop 1
v_max_f32_dpp v19, v19, v19 quad_perm:[2,3,0,1] row_mask:0xf bank_mask:0xf
v_mov_b32 v44, v19
s_nop 1
v_permlane32_swap_b32 v19, v44
v_max_f32 v19, v19, v44
v_mov_b32 v44, v19
s_nop 1
v_permlane16_swap_b32 v19, v44
v_max_f32 v19, v19, v44
v_sub_f32 v48, v48, v19
v_sub_f32 v49, v49, v19
v_sub_f32 v50, v50, v19
v_sub_f32 v51, v51, v19
v_sub_f32 v46, v46, v19
v_sub_f32 v47, v47, v19
v_exp_f32 v48, v48
v_exp_f32 v49, v49
v_exp_f32 v50, v50
v_exp_f32 v51, v51
v_cvt_pk_bf16_f32 v54, v48, v49
v_cvt_pk_bf16_f32 v55, v50, v51
s_nop 0
v_mov_b32_dpp v48, v54 quad_perm:[0,1,0,1] row_mask:0xf bank_mask:0xf
v_mov_b32_dpp v49, v55 quad_perm:[0,1,0,1] row_mask:0xf bank_mask:0xf
v_mov_b32_dpp v50, v54 quad_perm:[2,3,2,3] row_mask:0xf bank_mask:0xf
v_mov_b32_dpp v51, v55 quad_perm:[2,3,2,3] row_mask:0xf bank_mask:0xf
v_mov_b64 v[20:21], s[44:45]
v_mov_b64 v[22:23], s[44:45]
v_mfma_f32_16x16x32_bf16 v[8:11], v[56:59], v[48:51], 0
v_mfma_f32_16x16x32_bf16 v[12:15], v[60:63], v[48:51], 0
v_mfma_f32_16x16x32_bf16 v[16:19], v[20:23], v[48:51], 0
v_mov_b64 v[54:55], s[46:47]
v_exp_f32_dpp v44, v46 quad_perm:[0,1,0,1] row_mask:0xf bank_mask:0xf
v_exp_f32_dpp v45, v47 quad_perm:[0,1,0,1] row_mask:0xf bank_mask:0xf
s_nop 0
v_cvt_pk_bf16_f32 v52, v44, v45
v_cvt_pk_bf16_f32 v53, v44, v45
s_nop 1
v_mfma_f32_16x16x16_bf16 v[16:19], v[54:55], v[52:53], v[16:19]
v_mfma_f32_16x16x16_bf16 v[8:11], v[24:25], v[52:53], v[8:11]
v_mfma_f32_16x16x16_bf16 v[12:15], v[26:27], v[52:53], v[12:15]
s_nop 5
v_rcp_f32 v18, v16
s_nop 0
v_cndmask_b32 v8, v12, v8, s[42:43]
v_mul_f32 v8, v8, v18
v_cndmask_b32 v9, v13, v9, s[42:43]
v_mul_f32 v9, v9, v18
v_cndmask_b32 v10, v14, v10, s[42:43]
v_mul_f32 v10, v10, v18
v_cndmask_b32 v11, v15, v11, s[42:43]
v_mul_f32 v11, v11, v18
v_cvt_pk_bf16_f32 v12, v8, v9
v_cvt_pk_bf16_f32 v13, v10, v11
s_branch back_10090
exit_10091:
global_load_dwordx4 v[32:35], v0, s[68:69] offset:-4096 sc1
global_load_dwordx4 v[36:39], v0, s[68:69] offset:0 sc1
global_load_dwordx4 v[40:43], v0, s[70:71] offset:0 sc1
s_add_u32 s30, s30, 1
s_cmp_gt_u32 s30, 262144
s_cbranch_scc1 L_fail
s_waitcnt vmcnt(2)
v_bitop3_b32 v44, v32, v34, s18 bitop3:0x7e
s_waitcnt vmcnt(1)
v_bitop3_b32 v45, v36, v38, s18 bitop3:0x7e
v_or_b32 v44, v44, v45
s_waitcnt vmcnt(0)
v_bitop3_b32 v46, v40, v42, s18 bitop3:0x7e
v_bitop3_b32 v44, v44, v46, s19 bitop3:0xa8
v_cmp_ne_u32 vcc, 0, v44
s_cbranch_vccnz exit_10091
ds_write_b128 v0, v[32:35] offset:1024
ds_write_b128 v0, v[36:39] offset:5120
ds_write_b128 v0, v[40:43] offset:9216
s_waitcnt lgkmcnt(0)
s_barrier
s_barrier
s_add_u32 s36, s36, 1
s_cmp_lt_u32 s36, 2
s_cbranch_scc1 layer_10087
s_endpgm
wave_10070:
layer_10100:
s_lshl_b32 s17, s36, 6
s_mul_i32 s27, s36, 35651584
s_mul_i32 s28, s14, 16384
s_add_u32 s27, s27, s28
s_add_u32 s20, s27, 16785408
s_mul_i32 s27, s17, 10240
s_add_u32 s27, s27, s24
s_add_u32 s21, s27, s25
s_mov_b32 s19, 0
s_mov_b32 s33, s6
s_add_u32 s34, s17, 1
s_add_u32 s31, s17, 63
s_add_u32 s32, s17, 64
s_mov_b32 s27, s20
v_mov_b32 v7, 0
s_add_u32 s68, s4, 415744
s_addc_u32 s69, s5, 0
s_add_u32 s72, s4, 399360
s_addc_u32 s73, s5, 0
s_add_u32 s70, s4, 419840
s_addc_u32 s71, s5, 0
s_add_u32 s74, s4, 403456
s_addc_u32 s75, s5, 0
s_add_u32 s58, s4, s20
s_addc_u32 s59, s5, 0
global_load_dwordx4 v[64:67], v0, s[76:77] offset:-4096 sc1
global_load_dwordx4 v[68:71], v0, s[76:77] offset:-3072 sc1
global_load_dwordx4 v[72:75], v0, s[76:77] offset:-2048 sc1
global_load_dwordx4 v[76:79], v0, s[76:77] offset:-1024 sc1
global_load_dwordx4 v[80:83], v0, s[78:79] offset:-4096 sc1
global_load_dwordx4 v[84:87], v0, s[78:79] offset:-3072 sc1
global_load_dwordx4 v[48:51], v0, s[76:77] offset:2048 sc1
global_load_dwordx4 v[52:55], v0, s[76:77] offset:3072 sc1
global_load_dwordx4 v[56:59], v0, s[76:77] offset:0 sc1
global_load_dwordx4 v[60:63], v0, s[76:77] offset:1024 sc1
v_mov_b64 v[8:9], 0
v_mov_b64 v[10:11], 0
v_mov_b64 v[12:13], 0
v_mov_b64 v[14:15], 0
v_mov_b64 v[16:17], 0
v_mov_b64 v[18:19], 0
v_mov_b64 v[20:21], 0
v_mov_b64 v[22:23], 0
v_mov_b64 v[24:25], 0
v_mov_b64 v[26:27], 0
v_mov_b64 v[28:29], 0
v_mov_b64 v[30:31], 0
s_barrier
v_and_b32 v7, 511, v0
v_lshl_add_u32 v7, v7, 3, s27
global_load_dwordx4 v[32:35], v0, s[68:69] offset:-4096 sc1
global_load_dwordx4 v[36:39], v0, s[68:69] offset:0 sc1
v_mov_b32 v45, -1
s_mov_b32 s30, 0
s_waitcnt vmcnt(0)
.p2align 6
gather_10101:
s_waitcnt vmcnt(3)
rt_10106_b:
v_smfmac_f32_16x16x64_bf16 v[12:15], v[32:35], v[72:79], v1
ds_write_b128 v0, v[32:35] offset:2048
v_smfmac_f32_16x16x64_bf16 v[24:27], v[32:35], a[0:7], v1
v_bitop3_b32 v44, v32, v34, s18 bitop3:0x7e
v_smfmac_f32_16x16x64_bf16 v[16:19], v[32:35], v[56:63], v1
s_waitcnt vmcnt(2)
ds_write_b128 v0, v[36:39] offset:6144
v_bitop3_b32 v45, v36, v38, s18 bitop3:0x7e
v_smfmac_f32_16x16x64_bf16 v[8:11], v[32:35], v[64:71], v1
v_bitop3_b32 v44, v44, v45, s19 bitop3:0xa8
v_cmp_ne_u32 vcc, 0, v44
v_smfmac_f32_16x16x64_bf16 v[8:11], v[36:39], a[16:23], v1
s_cbranch_vccnz rt_10106
ds_read_b128 v[56:59], v2 offset:0
v_smfmac_f32_16x16x64_bf16 v[20:23], v[32:35], v[48:55], v1
s_mov_b64 s[68:69], s[72:73]
ds_read_b128 v[60:63], v2 offset:1024
global_load_dwordx4 v[64:67], v0, s[78:79] offset:-2048 sc1
v_smfmac_f32_16x16x64_bf16 v[16:19], v[36:39], a[32:39], v1
ds_read_b128 v[48:51], v2 offset:2048
ds_read_b128 v[52:55], v2 offset:3072
v_smfmac_f32_16x16x64_bf16 v[28:31], v[32:35], a[8:15], v1
s_waitcnt lgkmcnt(4)
s_barrier
ds_read_b128 v[40:43], v0 offset:3072
global_load_dwordx4 v[68:71], v0, s[78:79] offset:-1024 sc1
ds_read_b128 v[32:35], v0 offset:0
v_smfmac_f32_16x16x64_bf16 v[12:15], v[36:39], a[24:31], v1
s_waitcnt lgkmcnt(4)
ds_read_b128 v[44:47], v0 offset:7168
global_load_dwordx4 v[72:75], v0, s[78:79] offset:0 sc1
v_smfmac_f32_16x16x64_bf16 v[24:27], v[36:39], v[56:63], v1
s_waitcnt lgkmcnt(4)
ds_read_b128 v[56:59], v2 offset:4096
s_waitcnt lgkmcnt(4)
v_smfmac_f32_16x16x64_bf16 v[28:31], v[36:39], v[48:55], v1
ds_read_b128 v[60:63], v2 offset:5120
s_waitcnt lgkmcnt(4)
s_waitcnt vmcnt(3)
v_smfmac_f32_16x16x64_bf16 v[12:15], v[40:43], v[80:87], v1
ds_read_b128 v[80:83], v2 offset:6144
s_xor_b32 s18, s18, 1
v_smfmac_f32_16x16x64_bf16 v[20:23], v[36:39], a[40:47], v1
s_mov_b32 s30, 0
ds_read_b128 v[36:39], v0 offset:4096
ds_read_b128 v[84:87], v2 offset:7168
v_smfmac_f32_16x16x64_bf16 v[8:11], v[40:43], a[48:55], v1
s_waitcnt lgkmcnt(5)
global_load_dwordx4 v[76:79], v0, s[78:79] offset:1024 sc1
v_smfmac_f32_16x16x64_bf16 v[12:15], v[44:47], a[64:71], v1
s_add_u32 s20, s20, 524288
ds_read_b128 v[40:43], v0 offset:1024
s_waitcnt lgkmcnt(5)
v_smfmac_f32_16x16x64_bf16 v[8:11], v[44:47], a[56:63], v1
s_waitcnt lgkmcnt(4)
ds_read_b128 v[44:47], v0 offset:5120
v_smfmac_f32_16x16x64_bf16 v[8:11], v[32:35], v[56:63], v1
ds_read_b128 v[56:59], v2 offset:8192
ds_read_b128 v[60:63], v2 offset:9216
v_smfmac_f32_16x16x64_bf16 v[12:15], v[32:35], a[72:79], v1
s_waitcnt lgkmcnt(5)
global_load_dwordx4 v[48:51], v0, s[58:59] offset:0 nt sc1
v_smfmac_f32_16x16x64_bf16 v[8:11], v[36:39], a[80:87], v1
s_mov_b32 s19, 1
ds_read_b128 v[32:35], v0 offset:8192
s_waitcnt lgkmcnt(5)
v_smfmac_f32_16x16x64_bf16 v[12:15], v[36:39], v[80:87], v1
ds_read_b128 v[80:83], v2 offset:10240
s_waitcnt lgkmcnt(5)
v_smfmac_f32_16x16x64_bf16 v[12:15], v[40:43], a[96:103], v1
ds_read_b128 v[84:87], v2 offset:11264
v_smfmac_f32_16x16x64_bf16 v[8:11], v[40:43], a[88:95], v1
s_waitcnt lgkmcnt(5)
ds_read_b128 v[36:39], v0 offset:9216
s_waitcnt lgkmcnt(4)
v_smfmac_f32_16x16x64_bf16 v[12:15], v[44:47], a[104:111], v1
s_waitcnt vmcnt(4)
ds_read_b128 v[40:43], v0 offset:3072
global_load_dwordx4 v[52:55], v0, s[58:59] offset:1024 nt sc1
v_smfmac_f32_16x16x64_bf16 v[8:11], v[44:47], v[56:63], v1
s_waitcnt lgkmcnt(4)
ds_read_b128 v[60:63], v2 offset:13312
v_smfmac_f32_16x16x64_bf16 v[8:11], v[32:35], a[112:119], v1
s_waitcnt lgkmcnt(4)
ds_read_b128 v[56:59], v2 offset:12288
s_waitcnt lgkmcnt(4)
v_smfmac_f32_16x16x64_bf16 v[12:15], v[32:35], v[80:87], v1
s_waitcnt vmcnt(4)
ds_read_b128 v[84:87], v2 offset:15360
s_waitcnt lgkmcnt(4)
v_smfmac_f32_16x16x64_bf16 v[8:11], v[36:39], v[64:71], v1
s_nop 0
ds_read_b128 v[32:35], v0 offset:7168
ds_read_b128 v[80:83], v2 offset:14336
v_smfmac_f32_16x16x64_bf16 v[12:15], v[36:39], a[120:127], v1
s_waitcnt lgkmcnt(5)
ds_read_b128 v[36:39], v0 offset:0
global_load_dwordx4 v[64:67], v0, s[78:79] offset:2048 sc1
s_nop 0
v_add_f32 v9, v9, v11
s_waitcnt lgkmcnt(4)
v_add_f32 v8, v8, v10
v_smfmac_f32_16x16x64_bf16 v[16:19], v[40:43], v[56:63], v1
s_waitcnt vmcnt(4)
ds_read_b128 v[60:63], v2 offset:17408
v_add_f32 v13, v13, v15
v_smfmac_f32_16x16x64_bf16 v[20:23], v[40:43], a[128:135], v1
s_waitcnt lgkmcnt(3)
ds_read_b128 v[56:59], v2 offset:16384
v_mul_f32 v8, s35, v8
v_smfmac_f32_16x16x64_bf16 v[16:19], v[32:35], a[136:143], v1
s_waitcnt lgkmcnt(3)
ds_read_b128 v[40:43], v0 offset:4096
v_add_f32 v12, v12, v14
v_smfmac_f32_16x16x64_bf16 v[20:23], v[32:35], v[80:87], v1
s_waitcnt lgkmcnt(3)
ds_read_b128 v[32:35], v0 offset:1024
v_mul_f32 v9, s35, v9
v_mul_f32 v13, s35, v13
v_smfmac_f32_16x16x64_bf16 v[20:23], v[36:39], a[152:159], v1
s_mov_b64 vcc, s[42:43]
ds_read_b128 v[84:87], v2 offset:19456
global_load_dwordx4 v[68:71], v0, s[78:79] offset:3072 sc1
ds_read_b128 v[80:83], v2 offset:18432
v_cvt_pk_bf16_f32 v8, v8, v9
v_smfmac_f32_16x16x64_bf16 v[16:19], v[36:39], a[144:151], v1
s_waitcnt lgkmcnt(5)
ds_read_b128 v[36:39], v0 offset:5120
v_mul_f32 v12, s35, v12
v_cvt_pk_bf16_f32 v12, v12, v13
s_waitcnt lgkmcnt(4)
v_smfmac_f32_16x16x64_bf16 v[20:23], v[40:43], v[56:63], v1
s_waitcnt vmcnt(4)
ds_write2_b32 v3, v8, v12 offset0:0 offset1:128
v_smfmac_f32_16x16x64_bf16 v[16:19], v[40:43], v[72:79], v1
s_waitcnt lgkmcnt(4)
global_load_dwordx4 v[72:75], v0, s[80:81] offset:-4096 sc1
ds_read_b128 v[40:43], v0 offset:8192
v_smfmac_f32_16x16x64_bf16 v[20:23], v[32:35], a[168:175], v1
s_waitcnt lgkmcnt(3)
global_load_dwordx4 v[76:79], v0, s[80:81] offset:-3072 sc1
v_smfmac_f32_16x16x64_bf16 v[16:19], v[32:35], a[160:167], v1
s_waitcnt lgkmcnt(2)
global_load_dwordx4 v[56:59], v0, s[58:59] offset:2048 nt sc1
ds_read_b128 v[32:35], v0 offset:9216
v_smfmac_f32_16x16x64_bf16 v[20:23], v[36:39], v[80:87], v1
s_waitcnt vmcnt(5)
ds_read_b128 v[84:87], v2 offset:21504
global_load_dwordx4 v[60:63], v0, s[58:59] offset:3072 nt sc1
v_smfmac_f32_16x16x64_bf16 v[16:19], v[36:39], a[176:183], v1
s_waitcnt lgkmcnt(2)
ds_read_b128 v[36:39], v0 offset:8192
v_smfmac_f32_16x16x64_bf16 v[20:23], v[40:43], a[192:199], v1
s_barrier
ds_read_b64_tr_b16 v[12:13], v4 offset:3072
v_smfmac_f32_16x16x64_bf16 v[16:19], v[40:43], a[184:191], v1
s_waitcnt lgkmcnt(3)
ds_read_b64_tr_b16 v[8:9], v4 offset:2048
ds_read_b64_tr_b16 v[10:11], v4 offset:2560
v_smfmac_f32_16x16x64_bf16 v[20:23], v[32:35], a[208:215], v1
s_add_u32 s17, s17, 1
ds_read_b64_tr_b16 v[14:15], v4 offset:3584
s_waitcnt lgkmcnt(4)
ds_read_b128 v[40:43], v0 offset:9216
v_smfmac_f32_16x16x64_bf16 v[28:31], v[36:39], a[224:231], v1
ds_read_b128 v[80:83], v2 offset:20480
v_smfmac_f32_16x16x64_bf16 v[16:19], v[32:35], a[200:207], v1
s_waitcnt lgkmcnt(3)
ds_read_b128 v[32:35], v0 offset:3072
v_smfmac_f32_16x16x64_bf16 v[24:27], v[36:39], a[216:223], v1
v_add_f32 v20, v20, v22
v_mfma_f32_16x16x32_bf16 v[44:47], v[48:51], v[8:11], 0
s_waitcnt lgkmcnt(2)
ds_read_b128 v[36:39], v0 offset:7168
v_add_f32 v21, v21, v23
v_mfma_f32_16x16x32_bf16 v[44:47], v[52:55], v[12:15], v[44:47]
v_add_f32 v16, v16, v18
v_cvt_pk_bf16_f32 v20, v20, v21
v_add_f32 v17, v17, v19
v_bfe_u32 v48, v0, 5, 1
v_cvt_pk_bf16_f32 v16, v16, v17
v_smfmac_f32_16x16x64_bf16 v[24:27], v[40:43], a[232:239], v1
s_waitcnt lgkmcnt(1)
global_load_dword v7, v7, s[4:5] sc1
ds_write2_b32 v3, v16, v20 offset0:1 offset1:129
v_cndmask_b32_dpp v44, v46, v44, vcc quad_perm:[0,1,0,1] row_mask:0xf bank_mask:0xf
v_cndmask_b32_dpp v45, v47, v45, vcc quad_perm:[0,1,0,1] row_mask:0xf bank_mask:0xf
v_lshl_add_u32 v48, v48, 3, v5
v_smfmac_f32_16x16x64_bf16 v[28:31], v[40:43], v[80:87], v1
s_waitcnt vmcnt(5)
ds_write_b64 v48, v[44:45] offset:7168
v_smfmac_f32_16x16x64_bf16 v[24:27], v[32:35], a[240:247], v1
s_waitcnt lgkmcnt(2)
ds_read_b128 v[40:43], v0 offset:0
v_smfmac_f32_16x16x64_bf16 v[28:31], v[32:35], a[248:255], v1
ds_read_b128 v[32:35], v0 offset:4096
s_waitcnt vmcnt(3)
v_smfmac_f32_16x16x64_bf16 v[24:27], v[36:39], v[64:71], v1
s_waitcnt lgkmcnt(2)
global_load_dwordx4 v[64:67], v0, s[76:77] offset:-4096 sc1
ds_read_b128 v[80:83], v2 offset:22528
v_smfmac_f32_16x16x64_bf16 v[28:31], v[36:39], v[88:95], v1
ds_read_b128 v[36:39], v0 offset:1024
s_barrier
ds_read_b128 v[52:55], v6 offset:7168
s_waitcnt lgkmcnt(3)
ds_read_b128 v[48:51], v6 offset:6144
v_smfmac_f32_16x16x64_bf16 v[28:31], v[40:43], v[104:111], v1
global_load_dwordx4 v[68:71], v0, s[76:77] offset:-3072 sc1
v_smfmac_f32_16x16x64_bf16 v[24:27], v[40:43], v[96:103], v1
ds_read_b128 v[40:43], v0 offset:5120
ds_read_b64_tr_b16 v[8:9], v4 offset:0
v_smfmac_f32_16x16x64_bf16 v[28:31], v[32:35], v[120:127], v1
ds_read_b64_tr_b16 v[10:11], v4 offset:512
ds_read_b64_tr_b16 v[18:19], v4 offset:2560
v_smfmac_f32_16x16x64_bf16 v[24:27], v[32:35], v[112:119], v1
s_waitcnt lgkmcnt(6)
ds_read_b128 v[84:87], v2 offset:23552
ds_read_b64_tr_b16 v[22:23], v4 offset:3584
v_smfmac_f32_16x16x64_bf16 v[28:31], v[36:39], v[136:143], v1
s_waitcnt lgkmcnt(6)
ds_read_b64_tr_b16 v[12:13], v4 offset:1024
v_add_f32 v49, v49, v53
v_add_f32 v50, v50, v54
v_smfmac_f32_16x16x64_bf16 v[24:27], v[36:39], v[128:135], v1
s_waitcnt lgkmcnt(6)
ds_read_b64_tr_b16 v[14:15], v4 offset:1536
v_exp_f32 v50, v50
v_smfmac_f32_16x16x64_bf16 v[28:31], v[40:43], v[144:151], v1
ds_read_b64_tr_b16 v[16:17], v4 offset:2048
v_add_f32 v48, v48, v52
v_add_f32 v51, v51, v55
v_smfmac_f32_16x16x64_bf16 v[24:27], v[40:43], v[72:79], v1
s_waitcnt lgkmcnt(5)
ds_read_b64_tr_b16 v[20:21], v4 offset:3072
v_exp_f32 v51, v51
v_exp_f32 v49, v49
v_mfma_f32_16x16x32_bf16 v[44:47], v[8:11], v[8:11], 0
s_waitcnt lgkmcnt(2)
v_exp_f32 v48, v48
v_mfma_f32_16x16x32_bf16 v[44:47], v[12:15], v[12:15], v[44:47]
s_waitcnt lgkmcnt(1)
v_cvt_pk_bf16_f32 v55, v50, v51
v_cvt_pk_bf16_f32 v54, v48, v49
v_mfma_f32_16x16x32_bf16 v[44:47], v[16:19], v[16:19], v[44:47]
s_waitcnt lgkmcnt(0)
v_mov_b32_dpp v51, v55 quad_perm:[2,3,2,3] row_mask:0xf bank_mask:0xf
v_mov_b32_dpp v49, v55 quad_perm:[0,1,0,1] row_mask:0xf bank_mask:0xf
v_mfma_f32_16x16x32_bf16 v[44:47], v[20:23], v[20:23], v[44:47]
s_waitcnt vmcnt(3)
v_mov_b32_dpp v50, v54 quad_perm:[2,3,2,3] row_mask:0xf bank_mask:0xf
v_mov_b32_dpp v48, v54 quad_perm:[0,1,0,1] row_mask:0xf bank_mask:0xf
v_mov_b64 v[20:21], s[44:45]
v_mov_b64 v[54:55], s[46:47]
v_mov_b64 v[22:23], s[44:45]
v_mfma_f32_16x16x32_bf16 v[12:15], v[60:63], v[48:51], 0
s_nop 0
v_exp_f32_dpp v44, v46 quad_perm:[0,1,0,1] row_mask:0xf bank_mask:0xf
v_mfma_f32_16x16x32_bf16 v[16:19], v[20:23], v[48:51], 0
s_add_u32 s21, s21, 10240
v_exp_f32_dpp v45, v47 quad_perm:[0,1,0,1] row_mask:0xf bank_mask:0xf
v_mfma_f32_16x16x32_bf16 v[8:11], v[56:59], v[48:51], 0
v_cvt_pk_bf16_f32 v52, v44, v45
v_cvt_pk_bf16_f32 v53, v44, v45
v_cvt_pk_bf16_f32 v24, v24, v25
v_cvt_pk_bf16_f32 v25, v26, v27
v_mfma_f32_16x16x16_bf16 v[16:19], v[54:55], v[52:53], v[16:19]
s_add_u32 s34, s17, 2
v_cvt_pk_bf16_f32 v26, v28, v29
v_cvt_pk_bf16_f32 v27, v30, v31
v_mfma_f32_16x16x16_bf16 v[8:11], v[24:25], v[52:53], v[8:11]
v_mov_b64 v[40:41], 0
v_bfe_u32 v32, v0, 5, 1
v_mfma_f32_16x16x16_bf16 v[12:15], v[26:27], v[52:53], v[12:15]
s_min_u32 s34, s34, s32
ds_read_b128 v[28:31], v0 offset:44032
v_mov_b64 v[36:37], 0
v_subrev_u32 v17, s37, v16
v_mov_b64 v[38:39], 0
v_rcp_f32 v18, v16
v_lshl_add_u32 v32, v32, 3, v5
v_cmp_lt_u32 vcc, s38, v17
v_cndmask_b32 v10, v14, v10, s[42:43]
v_cndmask_b32 v9, v13, v9, s[42:43]
v_cndmask_b32 v11, v15, v11, s[42:43]
v_mul_f32 v9, v9, v18
v_mul_f32 v11, v11, v18
v_mul_f32 v10, v10, v18
v_cvt_pk_bf16_f32 v13, v10, v11
v_cndmask_b32 v8, v12, v8, s[42:43]
v_mul_f32 v8, v8, v18
v_cvt_pk_bf16_f32 v12, v8, v9
s_cbranch_vccnz rare_10102
back_10103:
ds_read_b128 v[16:19], v0 offset:40960
ds_write_b64 v32, v[12:13] offset:1024
v_mov_b32_dpp v9, v13 quad_perm:[0,1,0,1] row_mask:0xf bank_mask:0xf
v_mov_b32_dpp v10, v12 quad_perm:[2,3,2,3] row_mask:0xf bank_mask:0xf
v_mov_b32_dpp v11, v13 quad_perm:[2,3,2,3] row_mask:0xf bank_mask:0xf
v_mov_b32_dpp v8, v12 quad_perm:[0,1,0,1] row_mask:0xf bank_mask:0xf
v_mov_b64 v[52:53], 0
v_mov_b64 v[42:43], 0
v_smfmac_f32_16x16x64_bf16 v[36:39], v[8:11], v[80:87], v1
ds_read_b128 v[84:87], v0 offset:46080
v_mov_b64 v[54:55], 0
v_mov_b64 v[34:35], 0
v_mov_b64 v[48:49], 0
v_mov_b64 v[50:51], 0
v_smfmac_f32_16x16x64_bf16 v[40:43], v[8:11], v[152:159], v1
s_add_u32 s27, s20, 524288
ds_read_b128 v[80:83], v0 offset:45056
s_waitcnt lgkmcnt(2)
ds_read_b128 v[20:23], v0 offset:41984
s_barrier
ds_read_b128 v[56:59], v5 offset:1536
v_smfmac_f32_16x16x64_bf16 v[52:55], v[8:11], v[168:175], v1
ds_read_b128 v[24:27], v0 offset:43008
v_mov_b64 v[32:33], 0
v_smfmac_f32_16x16x64_bf16 v[48:51], v[8:11], v[160:167], v1
s_waitcnt lgkmcnt(4)
ds_read_b128 v[60:63], v5 offset:0
global_load_dwordx4 v[72:75], v0, s[76:77] offset:-2048 sc1
v_smfmac_f32_16x16x64_bf16 v[32:35], v[8:11], v[176:183], v1
s_waitcnt lgkmcnt(4)
ds_read_b128 v[12:15], v5 offset:512
global_load_dwordx4 v[76:79], v0, s[76:77] offset:-1024 sc1
v_lshrrev_b32 v44, 8, v0
s_waitcnt lgkmcnt(3)
v_smfmac_f32_16x16x64_bf16 v[40:43], v[56:59], v[80:87], v1
s_add_u32 s58, s4, s20
ds_read_b128 v[84:87], v0 offset:52224
v_smfmac_f32_16x16x64_bf16 v[36:39], v[56:59], v[16:23], v1
s_waitcnt lgkmcnt(3)
ds_read_b128 v[16:19], v0 offset:47104
s_waitcnt lgkmcnt(3)
v_smfmac_f32_16x16x64_bf16 v[36:39], v[60:63], v[24:31], v1
ds_read_b128 v[20:23], v0 offset:48128
s_waitcnt lgkmcnt(3)
v_smfmac_f32_16x16x64_bf16 v[36:39], v[12:15], v[184:191], v1
ds_read_b128 v[24:27], v0 offset:49152
v_bfe_u32 v45, v0, 1, 7
v_smfmac_f32_16x16x64_bf16 v[40:43], v[60:63], v[192:199], v1
s_addc_u32 s59, s5, 0
ds_read_b128 v[28:31], v0 offset:50176
v_lshl_or_b32 v44, v44, 12, v45
v_smfmac_f32_16x16x64_bf16 v[40:43], v[12:15], v[200:207], v1
s_nop 0
ds_read_b128 v[80:83], v0 offset:51200
v_cvt_pk_bf16_f32 v36, v36, v37
v_cvt_pk_bf16_f32 v37, v38, v39
v_and_or_b32 v36, v36, -2, s18
v_smfmac_f32_16x16x64_bf16 v[32:35], v[56:59], v[232:239], v1
global_store_dwordx2 v44, v[36:37], s[48:49]
s_waitcnt lgkmcnt(2)
v_cvt_pk_bf16_f32 v40, v40, v41
v_smfmac_f32_16x16x64_bf16 v[48:51], v[56:59], v[16:23], v1
s_waitcnt lgkmcnt(1)
v_cvt_pk_bf16_f32 v41, v42, v43
v_smfmac_f32_16x16x64_bf16 v[48:51], v[60:63], v[24:31], v1
v_and_or_b32 v40, v40, -2, s18
v_smfmac_f32_16x16x64_bf16 v[48:51], v[12:15], v[208:215], v1
global_store_dwordx2 v44, v[40:41], s[50:51]
s_waitcnt lgkmcnt(0)
v_smfmac_f32_16x16x64_bf16 v[52:55], v[56:59], v[80:87], v1
s_nop 2
v_smfmac_f32_16x16x64_bf16 v[52:55], v[60:63], v[216:223], v1
s_nop 0
v_cvt_pk_bf16_f32 v48, v48, v49
v_smfmac_f32_16x16x64_bf16 v[52:55], v[12:15], v[224:231], v1
v_cvt_pk_bf16_f32 v49, v50, v51
v_and_or_b32 v48, v48, -2, s18
v_smfmac_f32_16x16x64_bf16 v[32:35], v[60:63], v[240:247], v1
global_store_dwordx2 v44, v[48:49], s[52:53]
s_nop 0
v_smfmac_f32_16x16x64_bf16 v[32:35], v[12:15], v[248:255], v1
s_nop 1
v_cvt_pk_bf16_f32 v52, v52, v53
v_cvt_pk_bf16_f32 v53, v54, v55
v_and_or_b32 v52, v52, -2, s18
s_nop 0
global_store_dwordx2 v44, v[52:53], s[54:55]
s_nop 0
v_cvt_pk_bf16_f32 v32, v32, v33
v_and_or_b32 v32, v32, -2, s18
v_cvt_pk_bf16_f32 v33, v34, v35
global_store_dwordx2 v44, v[32:33], s[56:57]
s_cmp_ge_u32 s14, 16
s_cbranch_scc1 nored_10109
v_bfe_u32 v32, v0, 6, 1
v_lshlrev_b32 v32, 4, v32
v_mov_b32 v33, 0x3f80
v_lshlrev_b32 v32, v32, v33
v_bfe_i32 v33, v0, 4, 1
v_and_b32 v45, v32, v33
v_and_b32 v47, v32, v33
v_xor_b32 v44, v32, v45
v_xor_b32 v46, v32, v45
v_and_b32 v36, 32, v0
v_bfe_u32 v37, v0, 6, 1
v_lshl_add_u32 v36, v37, 8, v36
v_bfe_u32 v37, v0, 8, 1
v_lshl_add_u32 v36, v37, 4, v36
v_bfe_u32 v37, v0, 4, 1
v_lshl_add_u32 v36, v37, 3, v36
s_waitcnt vmcnt(9)
v_and_b32 v7, 511, v0
v_lshl_add_u32 v7, v7, 3, s27
s_nop 15
s_nop 15
s_nop 15
s_nop 15
s_nop 12
global_load_dwordx4 v[8:11], v0, s[64:65] offset:0 sc1
global_load_dwordx4 v[12:15], v0, s[64:65] offset:1024 sc1
global_load_dwordx4 v[16:19], v0, s[64:65] offset:2048 sc1
global_load_dwordx4 v[20:23], v0, s[64:65] offset:3072 sc1
s_nop 15
s_nop 15
s_nop 5
global_load_dwordx4 v[24:27], v0, s[64:65] offset:0 sc1
global_load_dwordx4 v[28:31], v0, s[64:65] offset:1024 sc1
global_load_dwordx4 v[80:83], v0, s[64:65] offset:2048 sc1
global_load_dwordx4 v[84:87], v0, s[64:65] offset:3072 sc1
chk_10111:
v_mov_b64 v[40:41], 0
v_mov_b64 v[42:43], 0
s_waitcnt vmcnt(6)
s_nop 0
v_smfmac_f32_16x16x64_bf16 v[40:43], v[44:47], v[8:15], v1
v_bitop3_b32 v32, v8, v10, s18 bitop3:0x7e
v_bitop3_b32 v33, v12, v14, s18 bitop3:0x7e
s_waitcnt vmcnt(4)
v_smfmac_f32_16x16x64_bf16 v[40:43], v[44:47], v[16:23], v1
v_bitop3_b32 v34, v16, v18, s18 bitop3:0x7e
v_bitop3_b32 v35, v20, v22, s18 bitop3:0x7e
v_or3_b32 v32, v32, v33, v34
v_bitop3_b32 v32, v32, v35, 1 bitop3:0xa8
v_cmp_ne_u32 vcc, 0, v32
s_cbranch_vccnz chk_10111_f
s_nop 1
v_add_f32_dpp v40, v40, v40 row_ror:8 row_mask:0xf bank_mask:0xf
v_add_f32_dpp v41, v41, v41 row_ror:8 row_mask:0xf bank_mask:0xf
v_add_f32_dpp v42, v42, v42 row_ror:8 row_mask:0xf bank_mask:0xf
v_add_f32_dpp v43, v43, v43 row_ror:8 row_mask:0xf bank_mask:0xf
v_cvt_pk_bf16_f32 v40, v40, v41
v_cvt_pk_bf16_f32 v41, v42, v43
v_and_or_b32 v40, v40, -2, s18
s_mov_b64 exec, 0x00ff00ff
global_store_dwordx2 v36, v[40:41], s[66:67]
s_mov_b64 exec, -1
s_branch join_10110
chk_10111_f:
global_load_dwordx4 v[8:11], v0, s[64:65] offset:0 sc1
global_load_dwordx4 v[12:15], v0, s[64:65] offset:1024 sc1
global_load_dwordx4 v[16:19], v0, s[64:65] offset:2048 sc1
global_load_dwordx4 v[20:23], v0, s[64:65] offset:3072 sc1
chk_10112:
v_mov_b64 v[40:41], 0
v_mov_b64 v[42:43], 0
s_waitcnt vmcnt(6)
s_nop 0
v_smfmac_f32_16x16x64_bf16 v[40:43], v[44:47], v[24:31], v1
v_bitop3_b32 v32, v24, v26, s18 bitop3:0x7e
v_bitop3_b32 v33, v28, v30, s18 bitop3:0x7e
s_waitcnt vmcnt(4)
v_smfmac_f32_16x16x64_bf16 v[40:43], v[44:47], v[80:87], v1
v_bitop3_b32 v34, v80, v82, s18 bitop3:0x7e
v_bitop3_b32 v35, v84, v86, s18 bitop3:0x7e
v_or3_b32 v32, v32, v33, v34
v_bitop3_b32 v32, v32, v35, 1 bitop3:0xa8
v_cmp_ne_u32 vcc, 0, v32
s_cbranch_vccnz chk_10112_f
s_nop 1
v_add_f32_dpp v40, v40, v40 row_ror:8 row_mask:0xf bank_mask:0xf
v_add_f32_dpp v41, v41, v41 row_ror:8 row_mask:0xf bank_mask:0xf
v_add_f32_dpp v42, v42, v42 row_ror:8 row_mask:0xf bank_mask:0xf
v_add_f32_dpp v43, v43, v43 row_ror:8 row_mask:0xf bank_mask:0xf
v_cvt_pk_bf16_f32 v40, v40, v41
v_cvt_pk_bf16_f32 v41, v42, v43
v_and_or_b32 v40, v40, -2, s18
s_mov_b64 exec, 0x00ff00ff
global_store_dwordx2 v36, v[40:41], s[66:67]
s_mov_b64 exec, -1
s_branch join_10110
chk_10112_f:
global_load_dwordx4 v[24:27], v0, s[64:65] offset:0 sc1
global_load_dwordx4 v[28:31], v0, s[64:65] offset:1024 sc1
global_load_dwordx4 v[80:83], v0, s[64:65] offset:2048 sc1
global_load_dwordx4 v[84:87], v0, s[64:65] offset:3072 sc1
s_add_u32 s30, s30, 1
s_cmp_le_u32 s30, 262144
s_cbranch_scc1 chk_10111
s_branch L_fail
nored_10109:
s_waitcnt vmcnt(9)
v_and_b32 v7, 511, v0
v_lshl_add_u32 v7, v7, 3, s27
join_10110:
s_barrier
global_load_dwordx4 v[56:59], v0, s[76:77] offset:0 sc1
global_load_dwordx4 v[60:63], v0, s[76:77] offset:1024 sc1
global_load_dwordx4 v[48:51], v0, s[76:77] offset:2048 sc1
global_load_dwordx4 v[52:55], v0, s[76:77] offset:3072 sc1
s_nop 15
s_nop 15
s_nop 3
s_barrier
global_load_dwordx4 v[32:35], v0, s[68:69] offset:-4096 sc1
s_nop 10
global_load_dwordx4 v[36:39], v0, s[68:69] offset:0 sc1
s_barrier
global_load_dwordx4 v[80:83], v0, s[78:79] offset:-4096 sc1
global_load_dwordx4 v[84:87], v0, s[78:79] offset:-3072 sc1
s_waitcnt vmcnt(12)
v_mov_b64 v[8:9], 0
v_mov_b64 v[10:11], 0
s_waitcnt vmcnt(11)
v_mov_b64 v[12:13], 0
v_mov_b64 v[14:15], 0
s_waitcnt vmcnt(10)
v_mov_b64 v[16:17], 0
v_mov_b64 v[18:19], 0
s_waitcnt vmcnt(9)
v_mov_b64 v[20:21], 0
v_mov_b64 v[22:23], 0
v_mov_b64 v[24:25], 0
v_mov_b64 v[26:27], 0
v_mov_b64 v[28:29], 0
v_mov_b64 v[30:31], 0
s_mov_b32 s30, 0
s_cmp_eq_u32 s17, s31
s_cbranch_scc0 gather_10101
s_branch exit_10104
rt_10106:
global_load_dwordx4 v[32:35], v0, s[68:69] offset:-4096 sc1
global_load_dwordx4 v[36:39], v0, s[68:69] offset:0 sc1
s_add_u32 s30, s30, 1
s_cmp_gt_u32 s30, 262144
s_cbranch_scc1 L_fail
s_mov_b64 exec, 1
global_store_dword v0, v0, s[62:63]
global_store_dword v0, v0, s[62:63]
s_mov_b64 exec, -1
v_mov_b64 v[8:9], 0
v_mov_b64 v[10:11], 0
v_mov_b64 v[12:13], 0
v_mov_b64 v[14:15], 0
v_mov_b64 v[16:17], 0
v_mov_b64 v[18:19], 0
v_mov_b64 v[20:21], 0
v_mov_b64 v[22:23], 0
v_mov_b64 v[24:25], 0
v_mov_b64 v[26:27], 0
v_mov_b64 v[28:29], 0
v_mov_b64 v[30:31], 0
s_branch gather_10101
rare_10102:
ds_read_b128 v[48:51], v6 offset:6144
ds_read_b128 v[52:55], v6 offset:7168
s_waitcnt lgkmcnt(0)
v_add_f32 v48, v48, v52
v_add_f32 v49, v49, v53
v_add_f32 v50, v50, v54
v_add_f32 v51, v51, v55
v_mov_b32_dpp v46, v46 quad_perm:[0,1,0,1] row_mask:0xf bank_mask:0xf
v_mov_b32_dpp v47, v47 quad_perm:[0,1,0,1] row_mask:0xf bank_mask:0xf
v_max3_f32 v19, v48, v49, v50
v_max3_f32 v19, v19, v51, v46
v_max_f32 v19, v19, v47
s_nop 1
v_max_f32_dpp v19, v19, v19 quad_perm:[2,3,0,1] row_mask:0xf bank_mask:0xf
v_mov_b32 v44, v19
s_nop 1
v_permlane32_swap_b32 v19, v44
v_max_f32 v19, v19, v44
v_mov_b32 v44, v19
s_nop 1
v_permlane16_swap_b32 v19, v44
v_max_f32 v19, v19, v44
v_sub_f32 v48, v48, v19
v_sub_f32 v49, v49, v19
v_sub_f32 v50, v50, v19
v_sub_f32 v51, v51, v19
v_sub_f32 v46, v46, v19
v_sub_f32 v47, v47, v19
v_exp_f32 v48, v48
v_exp_f32 v49, v49
v_exp_f32 v50, v50
v_exp_f32 v51, v51
v_cvt_pk_bf16_f32 v54, v48, v49
v_cvt_pk_bf16_f32 v55, v50, v51
s_nop 0
v_mov_b32_dpp v48, v54 quad_perm:[0,1,0,1] row_mask:0xf bank_mask:0xf
v_mov_b32_dpp v49, v55 quad_perm:[0,1,0,1] row_mask:0xf bank_mask:0xf
v_mov_b32_dpp v50, v54 quad_perm:[2,3,2,3] row_mask:0xf bank_mask:0xf
v_mov_b32_dpp v51, v55 quad_perm:[2,3,2,3] row_mask:0xf bank_mask:0xf
v_mov_b64 v[20:21], s[44:45]
v_mov_b64 v[22:23], s[44:45]
v_mfma_f32_16x16x32_bf16 v[8:11], v[56:59], v[48:51], 0
v_mfma_f32_16x16x32_bf16 v[12:15], v[60:63], v[48:51], 0
v_mfma_f32_16x16x32_bf16 v[16:19], v[20:23], v[48:51], 0
v_mov_b64 v[54:55], s[46:47]
v_exp_f32_dpp v44, v46 quad_perm:[0,1,0,1] row_mask:0xf bank_mask:0xf
v_exp_f32_dpp v45, v47 quad_perm:[0,1,0,1] row_mask:0xf bank_mask:0xf
s_nop 0
v_cvt_pk_bf16_f32 v52, v44, v45
v_cvt_pk_bf16_f32 v53, v44, v45
s_nop 1
v_mfma_f32_16x16x16_bf16 v[16:19], v[54:55], v[52:53], v[16:19]
v_mfma_f32_16x16x16_bf16 v[8:11], v[24:25], v[52:53], v[8:11]
v_mfma_f32_16x16x16_bf16 v[12:15], v[26:27], v[52:53], v[12:15]
s_nop 5
v_rcp_f32 v18, v16
s_nop 0
v_cndmask_b32 v8, v12, v8, s[42:43]
v_mul_f32 v8, v8, v18
v_cndmask_b32 v9, v13, v9, s[42:43]
v_mul_f32 v9, v9, v18
v_cndmask_b32 v10, v14, v10, s[42:43]
v_mul_f32 v10, v10, v18
v_cndmask_b32 v11, v15, v11, s[42:43]
v_mul_f32 v11, v11, v18
v_cvt_pk_bf16_f32 v12, v8, v9
v_cvt_pk_bf16_f32 v13, v10, v11
s_branch back_10103
exit_10104:
global_load_dwordx4 v[32:35], v0, s[68:69] offset:-4096 sc1
global_load_dwordx4 v[36:39], v0, s[68:69] offset:0 sc1
s_add_u32 s30, s30, 1
s_cmp_gt_u32 s30, 262144
s_cbranch_scc1 L_fail
s_waitcnt vmcnt(1)
v_bitop3_b32 v44, v32, v34, s18 bitop3:0x7e
s_waitcnt vmcnt(0)
v_bitop3_b32 v45, v36, v38, s18 bitop3:0x7e
v_bitop3_b32 v44, v44, v45, s19 bitop3:0xa8
v_cmp_ne_u32 vcc, 0, v44
s_cbranch_vccnz exit_10104
ds_write_b128 v0, v[32:35] offset:2048
ds_write_b128 v0, v[36:39] offset:6144
s_waitcnt lgkmcnt(0)
s_barrier
s_barrier
s_add_u32 s36, s36, 1
s_cmp_lt_u32 s36, 2
s_cbranch_scc1 layer_10100
s_endpgm
wave_10071:
layer_10113:
s_lshl_b32 s17, s36, 6
s_mul_i32 s27, s36, 35651584
s_mul_i32 s28, s14, 16384
s_add_u32 s27, s27, s28
s_add_u32 s20, s27, 16789504
s_mul_i32 s27, s17, 10240
s_add_u32 s27, s27, s24
s_add_u32 s21, s27, s25
s_mov_b32 s19, 0
s_mov_b32 s33, s6
s_add_u32 s34, s17, 1
s_add_u32 s31, s17, 63
s_add_u32 s32, s17, 64
s_mov_b32 s27, s20
v_mov_b32 v7, 0
s_add_u32 s68, s4, 416768
s_addc_u32 s69, s5, 0
s_add_u32 s72, s4, 400384
s_addc_u32 s73, s5, 0
s_add_u32 s70, s4, 420864
s_addc_u32 s71, s5, 0
s_add_u32 s74, s4, 404480
s_addc_u32 s75, s5, 0
s_add_u32 s58, s4, s20
s_addc_u32 s59, s5, 0
global_load_dwordx4 v[64:67], v0, s[76:77] offset:-4096 sc1
global_load_dwordx4 v[68:71], v0, s[76:77] offset:-3072 sc1
global_load_dwordx4 v[72:75], v0, s[76:77] offset:-2048 sc1
global_load_dwordx4 v[76:79], v0, s[76:77] offset:-1024 sc1
global_load_dwordx4 v[80:83], v0, s[78:79] offset:-4096 sc1
global_load_dwordx4 v[84:87], v0, s[78:79] offset:-3072 sc1
global_load_dwordx4 v[48:51], v0, s[76:77] offset:2048 sc1
global_load_dwordx4 v[52:55], v0, s[76:77] offset:3072 sc1
global_load_dwordx4 v[56:59], v0, s[76:77] offset:0 sc1
global_load_dwordx4 v[60:63], v0, s[76:77] offset:1024 sc1
v_mov_b64 v[8:9], 0
v_mov_b64 v[10:11], 0
v_mov_b64 v[12:13], 0
v_mov_b64 v[14:15], 0
v_mov_b64 v[16:17], 0
v_mov_b64 v[18:19], 0
v_mov_b64 v[20:21], 0
v_mov_b64 v[22:23], 0
v_mov_b64 v[24:25], 0
v_mov_b64 v[26:27], 0
v_mov_b64 v[28:29], 0
v_mov_b64 v[30:31], 0
s_barrier
v_bfe_u32 v7, v0, 2, 3
v_add_u32 v7, s22, v7
s_mov_b32 exec_hi, 0
v_and_b32 v7, 511, v0
v_lshl_add_u32 v7, v7, 3, s27
s_mov_b32 exec_hi, -1
global_load_dwordx4 v[32:35], v0, s[68:69] offset:-4096 sc1
global_load_dwordx4 v[36:39], v0, s[68:69] offset:0 sc1
s_mov_b32 s30, 0
s_waitcnt vmcnt(0)
.p2align 6
gather_10114:
s_waitcnt vmcnt(3)
rt_10119_b:
v_smfmac_f32_16x16x64_bf16 v[12:15], v[32:35], v[72:79], v1
ds_write_b128 v0, v[32:35] offset:3072
v_smfmac_f32_16x16x64_bf16 v[24:27], v[32:35], a[0:7], v1
v_bitop3_b32 v44, v32, v34, s18 bitop3:0x7e
v_smfmac_f32_16x16x64_bf16 v[16:19], v[32:35], v[56:63], v1
s_waitcnt vmcnt(2)
ds_write_b128 v0, v[36:39] offset:7168
v_bitop3_b32 v45, v36, v38, s18 bitop3:0x7e
v_smfmac_f32_16x16x64_bf16 v[8:11], v[32:35], v[64:71], v1
v_bitop3_b32 v44, v44, v45, s19 bitop3:0xa8
v_cmp_ne_u32 vcc, 0, v44
v_smfmac_f32_16x16x64_bf16 v[8:11], v[36:39], a[16:23], v1
s_cbranch_vccnz rt_10119
ds_read_b128 v[56:59], v2 offset:0
v_smfmac_f32_16x16x64_bf16 v[20:23], v[32:35], v[48:55], v1
s_mov_b64 s[68:69], s[72:73]
ds_read_b128 v[60:63], v2 offset:1024
global_load_dwordx4 v[64:67], v0, s[78:79] offset:-2048 sc1
v_smfmac_f32_16x16x64_bf16 v[16:19], v[36:39], a[32:39], v1
ds_read_b128 v[48:51], v2 offset:2048
ds_read_b128 v[52:55], v2 offset:3072
v_smfmac_f32_16x16x64_bf16 v[28:31], v[32:35], a[8:15], v1
s_waitcnt lgkmcnt(4)
s_barrier
ds_read_b128 v[40:43], v0 offset:2048
global_load_dwordx4 v[68:71], v0, s[78:79] offset:-1024 sc1
ds_read_b128 v[32:35], v0 offset:1024
v_smfmac_f32_16x16x64_bf16 v[12:15], v[36:39], a[24:31], v1
s_waitcnt lgkmcnt(4)
ds_read_b128 v[44:47], v0 offset:6144
global_load_dwordx4 v[72:75], v0, s[78:79] offset:0 sc1
v_smfmac_f32_16x16x64_bf16 v[24:27], v[36:39], v[56:63], v1
s_waitcnt lgkmcnt(4)
ds_read_b128 v[56:59], v2 offset:4096
s_waitcnt lgkmcnt(4)
v_smfmac_f32_16x16x64_bf16 v[28:31], v[36:39], v[48:55], v1
ds_read_b128 v[60:63], v2 offset:5120
s_waitcnt lgkmcnt(4)
s_waitcnt vmcnt(3)
v_smfmac_f32_16x16x64_bf16 v[12:15], v[40:43], v[80:87], v1
ds_read_b128 v[80:83], v2 offset:6144
s_xor_b32 s18, s18, 1
v_smfmac_f32_16x16x64_bf16 v[20:23], v[36:39], a[40:47], v1
s_mov_b32 s30, 0
ds_read_b128 v[36:39], v0 offset:5120
ds_read_b128 v[84:87], v2 offset:7168
v_smfmac_f32_16x16x64_bf16 v[8:11], v[40:43], a[48:55], v1
s_waitcnt lgkmcnt(5)
global_load_dwordx4 v[76:79], v0, s[78:79] offset:1024 sc1
v_smfmac_f32_16x16x64_bf16 v[12:15], v[44:47], a[64:71], v1
s_add_u32 s20, s20, 524288
ds_read_b128 v[40:43], v0 offset:0
s_waitcnt lgkmcnt(5)
v_smfmac_f32_16x16x64_bf16 v[8:11], v[44:47], a[56:63], v1
s_waitcnt lgkmcnt(4)
ds_read_b128 v[44:47], v0 offset:4096
v_smfmac_f32_16x16x64_bf16 v[8:11], v[32:35], v[56:63], v1
ds_read_b128 v[56:59], v2 offset:8192
ds_read_b128 v[60:63], v2 offset:9216
v_smfmac_f32_16x16x64_bf16 v[12:15], v[32:35], a[72:79], v1
s_waitcnt lgkmcnt(5)
global_load_dwordx4 v[48:51], v0, s[58:59] offset:0 nt sc1
v_smfmac_f32_16x16x64_bf16 v[8:11], v[36:39], a[80:87], v1
s_mov_b32 s19, 1
ds_read_b128 v[32:35], v0 offset:9216
s_waitcnt lgkmcnt(5)
v_smfmac_f32_16x16x64_bf16 v[12:15], v[36:39], v[80:87], v1
ds_read_b128 v[80:83], v2 offset:10240
s_waitcnt lgkmcnt(5)
v_smfmac_f32_16x16x64_bf16 v[12:15], v[40:43], a[96:103], v1
ds_read_b128 v[84:87], v2 offset:11264
v_smfmac_f32_16x16x64_bf16 v[8:11], v[40:43], a[88:95], v1
s_waitcnt lgkmcnt(5)
ds_read_b128 v[36:39], v0 offset:8192
s_waitcnt lgkmcnt(4)
v_smfmac_f32_16x16x64_bf16 v[12:15], v[44:47], a[104:111], v1
s_waitcnt vmcnt(4)
ds_read_b128 v[40:43], v0 offset:2048
global_load_dwordx4 v[52:55], v0, s[58:59] offset:1024 nt sc1
v_smfmac_f32_16x16x64_bf16 v[8:11], v[44:47], v[56:63], v1
s_waitcnt lgkmcnt(4)
ds_read_b128 v[60:63], v2 offset:13312
v_add_u32 v44, s24, v0
v_smfmac_f32_16x16x64_bf16 v[8:11], v[32:35], a[112:119], v1
s_waitcnt lgkmcnt(4)
ds_read_b128 v[56:59], v2 offset:12288
s_waitcnt lgkmcnt(4)
v_smfmac_f32_16x16x64_bf16 v[12:15], v[32:35], v[80:87], v1
s_waitcnt vmcnt(4)
ds_read_b128 v[84:87], v2 offset:15360
s_waitcnt lgkmcnt(4)
v_smfmac_f32_16x16x64_bf16 v[8:11], v[36:39], v[64:71], v1
s_nop 0
ds_read_b128 v[32:35], v0 offset:6144
ds_read_b128 v[80:83], v2 offset:14336
v_smfmac_f32_16x16x64_bf16 v[12:15], v[36:39], a[120:127], v1
s_waitcnt lgkmcnt(5)
ds_read_b128 v[36:39], v0 offset:1024
global_load_dwordx4 v[64:67], v0, s[78:79] offset:2048 sc1
ds_read_b128 v[44:47], v44
v_add_f32 v9, v9, v11
s_waitcnt lgkmcnt(5)
v_add_f32 v8, v8, v10
v_smfmac_f32_16x16x64_bf16 v[16:19], v[40:43], v[56:63], v1
s_waitcnt vmcnt(4)
ds_read_b128 v[60:63], v2 offset:17408
v_add_f32 v13, v13, v15
v_smfmac_f32_16x16x64_bf16 v[20:23], v[40:43], a[128:135], v1
s_waitcnt lgkmcnt(4)
ds_read_b128 v[56:59], v2 offset:16384
v_mul_f32 v8, s35, v8
v_smfmac_f32_16x16x64_bf16 v[16:19], v[32:35], a[136:143], v1
s_waitcnt lgkmcnt(4)
ds_read_b128 v[40:43], v0 offset:5120
v_add_f32 v12, v12, v14
v_smfmac_f32_16x16x64_bf16 v[20:23], v[32:35], v[80:87], v1
s_waitcnt lgkmcnt(4)
ds_read_b128 v[32:35], v0 offset:0
v_mul_f32 v9, s35, v9
v_mul_f32 v13, s35, v13
v_smfmac_f32_16x16x64_bf16 v[20:23], v[36:39], a[152:159], v1
s_mov_b64 vcc, s[42:43]
ds_read_b128 v[84:87], v2 offset:19456
global_load_dwordx4 v[68:71], v0, s[78:79] offset:3072 sc1
ds_read_b128 v[80:83], v2 offset:18432
v_cvt_pk_bf16_f32 v8, v8, v9
v_smfmac_f32_16x16x64_bf16 v[16:19], v[36:39], a[144:151], v1
s_waitcnt lgkmcnt(5)
ds_read_b128 v[36:39], v0 offset:4096
v_mul_f32 v12, s35, v12
v_cvt_pk_bf16_f32 v12, v12, v13
s_waitcnt lgkmcnt(4)
v_smfmac_f32_16x16x64_bf16 v[20:23], v[40:43], v[56:63], v1
s_waitcnt vmcnt(4)
ds_write2_b32 v3, v8, v12 offset0:0 offset1:128
v_smfmac_f32_16x16x64_bf16 v[16:19], v[40:43], v[72:79], v1
s_waitcnt lgkmcnt(4)
global_load_dwordx4 v[72:75], v0, s[80:81] offset:-4096 sc1
ds_read_b128 v[40:43], v0 offset:9216
v_smfmac_f32_16x16x64_bf16 v[20:23], v[32:35], a[168:175], v1
s_waitcnt lgkmcnt(3)
global_load_dwordx4 v[76:79], v0, s[80:81] offset:-3072 sc1
v_smfmac_f32_16x16x64_bf16 v[16:19], v[32:35], a[160:167], v1
s_waitcnt lgkmcnt(2)
global_load_dwordx4 v[56:59], v0, s[58:59] offset:2048 nt sc1
ds_read_b128 v[32:35], v0 offset:8192
v_smfmac_f32_16x16x64_bf16 v[20:23], v[36:39], v[80:87], v1
s_waitcnt vmcnt(5)
ds_read_b128 v[84:87], v2 offset:21504
global_load_dwordx4 v[60:63], v0, s[58:59] offset:3072 nt sc1
v_smfmac_f32_16x16x64_bf16 v[16:19], v[36:39], a[176:183], v1
s_waitcnt lgkmcnt(2)
ds_read_b128 v[36:39], v0 offset:9216
v_swap_b32 v45, v46
v_smfmac_f32_16x16x64_bf16 v[20:23], v[40:43], a[192:199], v1
s_barrier
ds_read_b64_tr_b16 v[12:13], v4 offset:3072
v_smfmac_f32_16x16x64_bf16 v[16:19], v[40:43], a[184:191], v1
s_waitcnt lgkmcnt(3)
ds_read_b64_tr_b16 v[8:9], v4 offset:2048
ds_read_b64_tr_b16 v[10:11], v4 offset:2560
v_smfmac_f32_16x16x64_bf16 v[20:23], v[32:35], a[208:215], v1
s_add_u32 s17, s17, 1
ds_read_b64_tr_b16 v[14:15], v4 offset:3584
buffer_store_dwordx4 v[44:47], v0, s[4:7], s21 offen sc1
s_waitcnt lgkmcnt(4)
ds_read_b128 v[40:43], v0 offset:8192
v_smfmac_f32_16x16x64_bf16 v[28:31], v[36:39], a[224:231], v1
ds_read_b128 v[80:83], v2 offset:20480
v_mov_b32 v47, s29
v_smfmac_f32_16x16x64_bf16 v[16:19], v[32:35], a[200:207], v1
s_waitcnt lgkmcnt(3)
ds_read_b128 v[32:35], v0 offset:2048
v_lshrrev_b32 v46, 2, v0
v_smfmac_f32_16x16x64_bf16 v[24:27], v[36:39], a[216:223], v1
s_mov_b64 exec, 1023
buffer_store_dword v47, v46, s[4:7], s33 offen sc1
s_mov_b64 exec, -1
v_add_f32 v20, v20, v22
v_mfma_f32_16x16x32_bf16 v[44:47], v[48:51], v[8:11], 0
s_waitcnt lgkmcnt(2)
ds_read_b128 v[36:39], v0 offset:6144
v_add_f32 v21, v21, v23
v_mfma_f32_16x16x32_bf16 v[44:47], v[52:55], v[12:15], v[44:47]
v_add_f32 v16, v16, v18
v_cvt_pk_bf16_f32 v20, v20, v21
v_add_f32 v17, v17, v19
v_bfe_u32 v48, v0, 5, 1
v_cvt_pk_bf16_f32 v16, v16, v17
v_smfmac_f32_16x16x64_bf16 v[24:27], v[40:43], a[232:239], v1
s_waitcnt lgkmcnt(1)
global_load_dword v7, v7, s[4:5] sc1
ds_write2_b32 v3, v16, v20 offset0:1 offset1:129
v_cndmask_b32_dpp v44, v46, v44, vcc quad_perm:[0,1,0,1] row_mask:0xf bank_mask:0xf
v_cndmask_b32_dpp v45, v47, v45, vcc quad_perm:[0,1,0,1] row_mask:0xf bank_mask:0xf
v_lshl_add_u32 v48, v48, 3, v5
v_xor_b32 v48, 128, v48
v_smfmac_f32_16x16x64_bf16 v[28:31], v[40:43], v[80:87], v1
s_waitcnt vmcnt(7)
ds_write_b64 v48, v[44:45] offset:7680
v_smfmac_f32_16x16x64_bf16 v[24:27], v[32:35], a[240:247], v1
s_waitcnt lgkmcnt(2)
ds_read_b128 v[40:43], v0 offset:1024
v_smfmac_f32_16x16x64_bf16 v[28:31], v[32:35], a[248:255], v1
ds_read_b128 v[32:35], v0 offset:5120
s_waitcnt vmcnt(5)
v_smfmac_f32_16x16x64_bf16 v[24:27], v[36:39], v[64:71], v1
s_waitcnt lgkmcnt(2)
global_load_dwordx4 v[64:67], v0, s[76:77] offset:-4096 sc1
ds_read_b128 v[80:83], v2 offset:22528
v_smfmac_f32_16x16x64_bf16 v[28:31], v[36:39], v[88:95], v1
ds_read_b128 v[36:39], v0 offset:0
s_barrier
ds_read_b128 v[52:55], v6 offset:7168
s_waitcnt lgkmcnt(3)
ds_read_b128 v[48:51], v6 offset:6144
v_smfmac_f32_16x16x64_bf16 v[28:31], v[40:43], v[104:111], v1
global_load_dwordx4 v[68:71], v0, s[76:77] offset:-3072 sc1
v_smfmac_f32_16x16x64_bf16 v[24:27], v[40:43], v[96:103], v1
ds_read_b128 v[40:43], v0 offset:4096
ds_read_b64_tr_b16 v[8:9], v4 offset:0
v_smfmac_f32_16x16x64_bf16 v[28:31], v[32:35], v[120:127], v1
ds_read_b64_tr_b16 v[10:11], v4 offset:512
ds_read_b64_tr_b16 v[18:19], v4 offset:2560
v_smfmac_f32_16x16x64_bf16 v[24:27], v[32:35], v[112:119], v1
s_waitcnt lgkmcnt(6)
ds_read_b128 v[84:87], v2 offset:23552
ds_read_b64_tr_b16 v[22:23], v4 offset:3584
v_smfmac_f32_16x16x64_bf16 v[28:31], v[36:39], v[136:143], v1
s_waitcnt lgkmcnt(6)
ds_read_b64_tr_b16 v[12:13], v4 offset:1024
v_add_f32 v49, v49, v53
v_add_f32 v50, v50, v54
v_smfmac_f32_16x16x64_bf16 v[24:27], v[36:39], v[128:135], v1
s_waitcnt lgkmcnt(6)
ds_read_b64_tr_b16 v[14:15], v4 offset:1536
v_exp_f32 v50, v50
v_smfmac_f32_16x16x64_bf16 v[28:31], v[40:43], v[144:151], v1
ds_read_b64_tr_b16 v[16:17], v4 offset:2048
v_add_f32 v48, v48, v52
v_add_f32 v51, v51, v55
v_smfmac_f32_16x16x64_bf16 v[24:27], v[40:43], v[72:79], v1
s_waitcnt lgkmcnt(5)
ds_read_b64_tr_b16 v[20:21], v4 offset:3072
v_exp_f32 v51, v51
v_exp_f32 v49, v49
v_mfma_f32_16x16x32_bf16 v[44:47], v[8:11], v[8:11], 0
s_waitcnt lgkmcnt(2)
v_exp_f32 v48, v48
v_mfma_f32_16x16x32_bf16 v[44:47], v[12:15], v[12:15], v[44:47]
s_waitcnt lgkmcnt(1)
v_cvt_pk_bf16_f32 v55, v50, v51
v_cvt_pk_bf16_f32 v54, v48, v49
v_mfma_f32_16x16x32_bf16 v[44:47], v[16:19], v[16:19], v[44:47]
s_waitcnt lgkmcnt(0)
v_mov_b32_dpp v51, v55 quad_perm:[2,3,2,3] row_mask:0xf bank_mask:0xf
v_mov_b32_dpp v49, v55 quad_perm:[0,1,0,1] row_mask:0xf bank_mask:0xf
v_mfma_f32_16x16x32_bf16 v[44:47], v[20:23], v[20:23], v[44:47]
s_waitcnt vmcnt(5)
v_mov_b32_dpp v50, v54 quad_perm:[2,3,2,3] row_mask:0xf bank_mask:0xf
v_mov_b32_dpp v48, v54 quad_perm:[0,1,0,1] row_mask:0xf bank_mask:0xf
v_mov_b64 v[20:21], s[44:45]
v_mov_b64 v[54:55], s[46:47]
v_mov_b64 v[22:23], s[44:45]
v_mfma_f32_16x16x32_bf16 v[12:15], v[60:63], v[48:51], 0
s_nop 0
v_exp_f32_dpp v44, v46 quad_perm:[0,1,0,1] row_mask:0xf bank_mask:0xf
v_mfma_f32_16x16x32_bf16 v[16:19], v[20:23], v[48:51], 0
s_add_u32 s21, s21, 10240
v_exp_f32_dpp v45, v47 quad_perm:[0,1,0,1] row_mask:0xf bank_mask:0xf
v_mfma_f32_16x16x32_bf16 v[8:11], v[56:59], v[48:51], 0
v_cvt_pk_bf16_f32 v52, v44, v45
v_cvt_pk_bf16_f32 v53, v44, v45
v_cvt_pk_bf16_f32 v24, v24, v25
v_cvt_pk_bf16_f32 v25, v26, v27
v_mfma_f32_16x16x16_bf16 v[16:19], v[54:55], v[52:53], v[16:19]
s_add_u32 s34, s17, 2
v_cvt_pk_bf16_f32 v26, v28, v29
v_cvt_pk_bf16_f32 v27, v30, v31
v_mfma_f32_16x16x16_bf16 v[8:11], v[24:25], v[52:53], v[8:11]
v_mov_b64 v[40:41], 0
v_bfe_u32 v32, v0, 5, 1
v_mfma_f32_16x16x16_bf16 v[12:15], v[26:27], v[52:53], v[12:15]
s_min_u32 s34, s34, s32
ds_read_b128 v[28:31], v0 offset:56320
v_mov_b64 v[36:37], 0
v_subrev_u32 v17, s37, v16
v_mov_b64 v[38:39], 0
v_rcp_f32 v18, v16
v_lshl_add_u32 v32, v32, 3, v5
v_cmp_lt_u32 vcc, s38, v17
v_cndmask_b32 v10, v14, v10, s[42:43]
v_cndmask_b32 v9, v13, v9, s[42:43]
v_cndmask_b32 v11, v15, v11, s[42:43]
v_mul_f32 v9, v9, v18
v_mul_f32 v11, v11, v18
v_mul_f32 v10, v10, v18
v_cvt_pk_bf16_f32 v13, v10, v11
v_cndmask_b32 v8, v12, v8, s[42:43]
v_mul_f32 v8, v8, v18
v_cvt_pk_bf16_f32 v12, v8, v9
s_cbranch_vccnz rare_10115
back_10116:
ds_read_b128 v[16:19], v0 offset:53248
ds_write_b64 v32, v[12:13] offset:1536
v_mov_b32_dpp v9, v13 quad_perm:[0,1,0,1] row_mask:0xf bank_mask:0xf
v_mov_b32_dpp v10, v12 quad_perm:[2,3,2,3] row_mask:0xf bank_mask:0xf
v_mov_b32_dpp v11, v13 quad_perm:[2,3,2,3] row_mask:0xf bank_mask:0xf
v_mov_b32_dpp v8, v12 quad_perm:[0,1,0,1] row_mask:0xf bank_mask:0xf
v_mov_b64 v[52:53], 0
v_mov_b64 v[42:43], 0
v_smfmac_f32_16x16x64_bf16 v[36:39], v[8:11], v[80:87], v1
ds_read_b128 v[84:87], v0 offset:58368
v_mov_b64 v[54:55], 0
v_mov_b64 v[34:35], 0
v_mov_b64 v[48:49], 0
v_mov_b64 v[50:51], 0
v_smfmac_f32_16x16x64_bf16 v[40:43], v[8:11], v[152:159], v1
s_add_u32 s27, s20, 524288
ds_read_b128 v[80:83], v0 offset:57344
s_waitcnt lgkmcnt(2)
ds_read_b128 v[20:23], v0 offset:54272
s_barrier
ds_read_b128 v[56:59], v5 offset:1024
v_smfmac_f32_16x16x64_bf16 v[52:55], v[8:11], v[168:175], v1
ds_read_b128 v[24:27], v0 offset:55296
v_mov_b64 v[32:33], 0
v_smfmac_f32_16x16x64_bf16 v[48:51], v[8:11], v[160:167], v1
s_waitcnt lgkmcnt(4)
ds_read_b128 v[60:63], v5 offset:512
global_load_dwordx4 v[72:75], v0, s[76:77] offset:-2048 sc1
v_smfmac_f32_16x16x64_bf16 v[32:35], v[8:11], v[176:183], v1
s_waitcnt lgkmcnt(4)
ds_read_b128 v[12:15], v5 offset:0
global_load_dwordx4 v[76:79], v0, s[76:77] offset:-1024 sc1
v_lshrrev_b32 v44, 8, v0
s_waitcnt lgkmcnt(3)
v_smfmac_f32_16x16x64_bf16 v[40:43], v[56:59], v[80:87], v1
s_add_u32 s58, s4, s20
ds_read_b128 v[84:87], v0 offset:64512
v_smfmac_f32_16x16x64_bf16 v[36:39], v[56:59], v[16:23], v1
s_waitcnt lgkmcnt(3)
ds_read_b128 v[16:19], v0 offset:59392
s_waitcnt lgkmcnt(3)
v_smfmac_f32_16x16x64_bf16 v[36:39], v[60:63], v[24:31], v1
ds_read_b128 v[20:23], v0 offset:60416
s_waitcnt lgkmcnt(3)
v_smfmac_f32_16x16x64_bf16 v[36:39], v[12:15], v[184:191], v1
ds_read_b128 v[24:27], v0 offset:61440
v_bfe_u32 v45, v0, 1, 7
v_smfmac_f32_16x16x64_bf16 v[40:43], v[60:63], v[192:199], v1
s_addc_u32 s59, s5, 0
ds_read_b128 v[28:31], v0 offset:62464
v_lshl_or_b32 v44, v44, 12, v45
v_smfmac_f32_16x16x64_bf16 v[40:43], v[12:15], v[200:207], v1
ds_read_b128 v[80:83], v0 offset:63488
v_cvt_pk_bf16_f32 v36, v36, v37
v_cvt_pk_bf16_f32 v37, v38, v39
v_and_or_b32 v36, v36, -2, s18
v_smfmac_f32_16x16x64_bf16 v[32:35], v[56:59], v[232:239], v1
s_sub_u32 s29, s17, 1
global_store_dwordx2 v44, v[36:37], s[48:49]
s_waitcnt lgkmcnt(2)
v_cvt_pk_bf16_f32 v40, v40, v41
v_smfmac_f32_16x16x64_bf16 v[48:51], v[56:59], v[16:23], v1
s_waitcnt lgkmcnt(1)
v_cvt_pk_bf16_f32 v41, v42, v43
v_smfmac_f32_16x16x64_bf16 v[48:51], v[60:63], v[24:31], v1
s_and_b32 s33, s29, 3
v_and_or_b32 v40, v40, -2, s18
v_smfmac_f32_16x16x64_bf16 v[48:51], v[12:15], v[208:215], v1
global_store_dwordx2 v44, v[40:41], s[50:51]
s_waitcnt lgkmcnt(0)
v_smfmac_f32_16x16x64_bf16 v[52:55], v[56:59], v[80:87], v1
s_nop 1
v_smfmac_f32_16x16x64_bf16 v[52:55], v[60:63], v[216:223], v1
s_or_b32 s33, s33, s24
s_nop 0
v_cvt_pk_bf16_f32 v48, v48, v49
v_smfmac_f32_16x16x64_bf16 v[52:55], v[12:15], v[224:231], v1
v_cvt_pk_bf16_f32 v49, v50, v51
v_and_or_b32 v48, v48, -2, s18
v_smfmac_f32_16x16x64_bf16 v[32:35], v[60:63], v[240:247], v1
global_store_dwordx2 v44, v[48:49], s[52:53]
s_nop 0
v_smfmac_f32_16x16x64_bf16 v[32:35], v[12:15], v[248:255], v1
s_nop 1
v_cvt_pk_bf16_f32 v52, v52, v53
v_cvt_pk_bf16_f32 v53, v54, v55
v_and_or_b32 v52, v52, -2, s18
s_nop 0
global_store_dwordx2 v44, v[52:53], s[54:55]
s_nop 0
v_cvt_pk_bf16_f32 v32, v32, v33
v_and_or_b32 v32, v32, -2, s18
v_cvt_pk_bf16_f32 v33, v34, v35
s_cselect_b32 s33, s6, s23
global_store_dwordx2 v44, v[32:33], s[56:57]
nored_10122:
s_waitcnt vmcnt(9)
v_cmp_gt_u32 vcc, s34, v7
s_cmp_eq_u32 vcc_hi, 0
s_cbranch_scc1 kv_10126
s_mov_b32 s30, 0
kv_10125:
v_bfe_u32 v7, v0, 2, 3
buffer_load_dword v7, v7, s[4:7], s22 offen sc1
s_add_u32 s30, s30, 1
s_cmp_gt_u32 s30, 262144
s_cbranch_scc1 L_fail
s_waitcnt vmcnt(0)
v_cmp_gt_u32 vcc, s34, v7
s_cbranch_vccnz kv_10125
kv_10126:
v_bfe_u32 v7, v0, 2, 3
v_add_u32 v7, s22, v7
s_mov_b32 exec_hi, 0
v_and_b32 v7, 511, v0
v_lshl_add_u32 v7, v7, 3, s27
s_mov_b32 exec_hi, -1
s_nop 15
s_nop 15
s_nop 15
s_nop 15
s_nop 15
s_nop 1
global_load_dwordx4 v[56:59], v0, s[76:77] offset:0 sc1
global_load_dwordx4 v[60:63], v0, s[76:77] offset:1024 sc1
global_load_dwordx4 v[48:51], v0, s[76:77] offset:2048 sc1
global_load_dwordx4 v[52:55], v0, s[76:77] offset:3072 sc1
join_10123:
s_barrier
s_nop 15
s_nop 15
s_nop 7
s_barrier
global_load_dwordx4 v[32:35], v0, s[68:69] offset:-4096 sc1
s_nop 10
global_load_dwordx4 v[36:39], v0, s[68:69] offset:0 sc1
s_barrier
global_load_dwordx4 v[80:83], v0, s[78:79] offset:-4096 sc1
global_load_dwordx4 v[84:87], v0, s[78:79] offset:-3072 sc1
v_mov_b64 v[8:9], 0
v_mov_b64 v[10:11], 0
v_mov_b64 v[12:13], 0
v_mov_b64 v[14:15], 0
v_mov_b64 v[16:17], 0
v_mov_b64 v[18:19], 0
v_mov_b64 v[20:21], 0
v_mov_b64 v[22:23], 0
v_mov_b64 v[24:25], 0
v_mov_b64 v[26:27], 0
v_mov_b64 v[28:29], 0
v_mov_b64 v[30:31], 0
s_mov_b32 s30, 0
s_cmp_eq_u32 s17, s31
s_cbranch_scc0 gather_10114
s_branch exit_10117
rt_10119:
global_load_dwordx4 v[32:35], v0, s[68:69] offset:-4096 sc1
global_load_dwordx4 v[36:39], v0, s[68:69] offset:0 sc1
s_add_u32 s30, s30, 1
s_cmp_gt_u32 s30, 262144
s_cbranch_scc1 L_fail
s_mov_b64 exec, 1
global_store_dword v0, v0, s[62:63]
global_store_dword v0, v0, s[62:63]
s_mov_b64 exec, -1
v_mov_b64 v[8:9], 0
v_mov_b64 v[10:11], 0
v_mov_b64 v[12:13], 0
v_mov_b64 v[14:15], 0
v_mov_b64 v[16:17], 0
v_mov_b64 v[18:19], 0
v_mov_b64 v[20:21], 0
v_mov_b64 v[22:23], 0
v_mov_b64 v[24:25], 0
v_mov_b64 v[26:27], 0
v_mov_b64 v[28:29], 0
v_mov_b64 v[30:31], 0
s_branch gather_10114
rare_10115:
ds_read_b128 v[48:51], v6 offset:6144
ds_read_b128 v[52:55], v6 offset:7168
s_waitcnt lgkmcnt(0)
v_add_f32 v48, v48, v52
v_add_f32 v49, v49, v53
v_add_f32 v50, v50, v54
v_add_f32 v51, v51, v55
v_mov_b32_dpp v46, v46 quad_perm:[0,1,0,1] row_mask:0xf bank_mask:0xf
v_mov_b32_dpp v47, v47 quad_perm:[0,1,0,1] row_mask:0xf bank_mask:0xf
v_max3_f32 v19, v48, v49, v50
v_max3_f32 v19, v19, v51, v46
v_max_f32 v19, v19, v47
s_nop 1
v_max_f32_dpp v19, v19, v19 quad_perm:[2,3,0,1] row_mask:0xf bank_mask:0xf
v_mov_b32 v44, v19
s_nop 1
v_permlane32_swap_b32 v19, v44
v_max_f32 v19, v19, v44
v_mov_b32 v44, v19
s_nop 1
v_permlane16_swap_b32 v19, v44
v_max_f32 v19, v19, v44
v_sub_f32 v48, v48, v19
v_sub_f32 v49, v49, v19
v_sub_f32 v50, v50, v19
v_sub_f32 v51, v51, v19
v_sub_f32 v46, v46, v19
v_sub_f32 v47, v47, v19
v_exp_f32 v48, v48
v_exp_f32 v49, v49
v_exp_f32 v50, v50
v_exp_f32 v51, v51
v_cvt_pk_bf16_f32 v54, v48, v49
v_cvt_pk_bf16_f32 v55, v50, v51
s_nop 0
v_mov_b32_dpp v48, v54 quad_perm:[0,1,0,1] row_mask:0xf bank_mask:0xf
v_mov_b32_dpp v49, v55 quad_perm:[0,1,0,1] row_mask:0xf bank_mask:0xf
v_mov_b32_dpp v50, v54 quad_perm:[2,3,2,3] row_mask:0xf bank_mask:0xf
v_mov_b32_dpp v51, v55 quad_perm:[2,3,2,3] row_mask:0xf bank_mask:0xf
v_mov_b64 v[20:21], s[44:45]
v_mov_b64 v[22:23], s[44:45]
v_mfma_f32_16x16x32_bf16 v[8:11], v[56:59], v[48:51], 0
v_mfma_f32_16x16x32_bf16 v[12:15], v[60:63], v[48:51], 0
v_mfma_f32_16x16x32_bf16 v[16:19], v[20:23], v[48:51], 0
v_mov_b64 v[54:55], s[46:47]
v_exp_f32_dpp v44, v46 quad_perm:[0,1,0,1] row_mask:0xf bank_mask:0xf
v_exp_f32_dpp v45, v47 quad_perm:[0,1,0,1] row_mask:0xf bank_mask:0xf
s_nop 0
v_cvt_pk_bf16_f32 v52, v44, v45
v_cvt_pk_bf16_f32 v53, v44, v45
s_nop 1
v_mfma_f32_16x16x16_bf16 v[16:19], v[54:55], v[52:53], v[16:19]
v_mfma_f32_16x16x16_bf16 v[8:11], v[24:25], v[52:53], v[8:11]
v_mfma_f32_16x16x16_bf16 v[12:15], v[26:27], v[52:53], v[12:15]
s_nop 5
v_rcp_f32 v18, v16
s_nop 0
v_cndmask_b32 v8, v12, v8, s[42:43]
v_mul_f32 v8, v8, v18
v_cndmask_b32 v9, v13, v9, s[42:43]
v_mul_f32 v9, v9, v18
v_cndmask_b32 v10, v14, v10, s[42:43]
v_mul_f32 v10, v10, v18
v_cndmask_b32 v11, v15, v11, s[42:43]
v_mul_f32 v11, v11, v18
v_cvt_pk_bf16_f32 v12, v8, v9
v_cvt_pk_bf16_f32 v13, v10, v11
s_branch back_10116
exit_10117:
global_load_dwordx4 v[32:35], v0, s[68:69] offset:-4096 sc1
global_load_dwordx4 v[36:39], v0, s[68:69] offset:0 sc1
s_add_u32 s30, s30, 1
s_cmp_gt_u32 s30, 262144
s_cbranch_scc1 L_fail
s_waitcnt vmcnt(1)
v_bitop3_b32 v44, v32, v34, s18 bitop3:0x7e
s_waitcnt vmcnt(0)
v_bitop3_b32 v45, v36, v38, s18 bitop3:0x7e
v_bitop3_b32 v44, v44, v45, s19 bitop3:0xa8
v_cmp_ne_u32 vcc, 0, v44
s_cbranch_vccnz exit_10117
ds_write_b128 v0, v[32:35] offset:3072
ds_write_b128 v0, v[36:39] offset:7168
s_waitcnt lgkmcnt(0)
s_barrier
v_add_u32 v44, s24, v0
ds_read_b128 v[44:47], v44
s_waitcnt lgkmcnt(0)
v_swap_b32 v45, v46
buffer_store_dwordx4 v[44:47], v0, s[4:7], s21 offen sc1
s_add_u32 s26, s17, 1
s_waitcnt vmcnt(0)
v_mov_b32 v44, s26
s_mov_b64 exec, 1
buffer_store_dword v44, off, s[4:7], s23 sc1
s_mov_b64 exec, -1
s_barrier
s_add_u32 s36, s36, 1
s_cmp_lt_u32 s36, 2
s_cbranch_scc1 layer_10113
s_endpgm
grp_10064:
s_endpgm

.section .rodata,"a"
.p2align 6
.amdhsa_kernel interleave_layers__spectral_gfnet__memory_aug_recurrent_mem_tr__prompt_kernel
  .amdhsa_next_free_vgpr 512
  .amdhsa_next_free_sgpr 102
  .amdhsa_accum_offset 256
  .amdhsa_group_segment_fixed_size 0
  .amdhsa_kernarg_size 104
  .amdhsa_user_sgpr_count 2
  .amdhsa_user_sgpr_kernarg_segment_ptr 1
  .amdhsa_system_sgpr_workgroup_id_x 1
  .amdhsa_float_denorm_mode_32 3
  .amdhsa_ieee_mode 0
.end_amdhsa_kernel
```

```asm
; @launch grid=(256,1,1) block=(256,1,1) lds=163840
.amdgcn_target "amdgcn-amd-amdhsa--gfx950"
.text
.globl interleave_layers__spectral_gfnet__memory_aug_recurrent_mem_tr__prompt_kernel
.p2align 8
.type interleave_layers__spectral_gfnet__memory_aug_recurrent_mem_tr__prompt_kernel,@function
interleave_layers__spectral_gfnet__memory_aug_recurrent_mem_tr__prompt_kernel:
s_cmp_ge_u32 s2, 256
s_cbranch_scc1 L_end
s_load_dwordx2 s[4:5], s[0:1], 96
s_load_dwordx2 s[8:9], s[0:1], 88
s_mov_b32 s6, 268435456
s_mov_b32 s7, 0x20000
s_mov_b32 s10, 256
s_mov_b32 s11, 0x20000
s_getreg_b32 s12, hwreg(HW_REG_XCC_ID, 0, 3)
v_lshrrev_b32 v1, 6, v0
s_nop 0
v_readfirstlane_b32 s13, v1
s_waitcnt lgkmcnt(0)
s_cmp_lg_u32 s13, 0
s_cbranch_scc1 reg_3
s_cmp_ge_u32 s2, 16
s_cbranch_scc1 reg_4
v_lshlrev_b32 v1, 7, v0
s_lshl_b32 s15, s2, 13
s_add_u32 s15, s15, 11534336
v_mov_b32 v4, 0
buffer_store_dword v4, v1, s[4:7], s15 offen sc1
s_waitcnt vmcnt(0)
reg_4:
v_mov_b32 v1, 0
v_mov_b32 v2, -1
ds_write_b32 v1, v2
s_lshl_b32 s15, s12, 5
v_mov_b32 v2, 1
s_mov_b64 exec, 1
buffer_atomic_add v2, off, s[8:11], s15 sc0
s_mov_b64 exec, -1
v_and_b32 v1, 7, v0
v_lshlrev_b32 v1, 5, v1
s_mov_b32 s16, 0
reg_1:
buffer_load_dword v3, v1, s[8:11], 0 offen sc1
s_add_u32 s16, s16, 1
s_cmp_gt_u32 s16, 262144
s_cbranch_scc1 L_fail
s_waitcnt vmcnt(0)
v_add_u32_dpp v4, v3, v3 quad_perm:[1,0,3,2] row_mask:0xf bank_mask:0xf
s_nop 1
v_add_u32_dpp v4, v4, v4 quad_perm:[2,3,0,1] row_mask:0xf bank_mask:0xf
s_nop 1
v_add_u32_dpp v4, v4, v4 row_ror:4 row_mask:0xf bank_mask:0xf
v_cmp_ne_u32 vcc, 0x100, v4
s_cbranch_vccnz reg_1
v_readfirstlane_b32 s17, v2
v_readlane_b32 s20, v3, 0
v_readlane_b32 s21, v3, 1
v_readlane_b32 s22, v3, 2
v_readlane_b32 s23, v3, 3
v_readlane_b32 s24, v3, 4
v_readlane_b32 s25, v3, 5
v_readlane_b32 s26, v3, 6
v_readlane_b32 s27, v3, 7
s_mov_b32 s15, 6
s_cmp_ge_u32 s25, 32
s_cselect_b32 s15, 5, s15
s_cmp_ge_u32 s24, 32
s_cselect_b32 s15, 4, s15
s_cmp_ge_u32 s23, 32
s_cselect_b32 s15, 3, s15
s_cmp_ge_u32 s22, 32
s_cselect_b32 s15, 2, s15
s_cmp_ge_u32 s21, 32
s_cselect_b32 s15, 1, s15
s_cmp_ge_u32 s20, 32
s_cselect_b32 s15, 0, s15
s_cmp_ge_u32 s27, 32
s_cselect_b32 s15, 7, s15
s_mov_b32 s16, s17
s_cmp_gt_u32 s12, 0
s_cselect_b32 s18, s20, 0
s_add_u32 s16, s16, s18
s_cmp_gt_u32 s12, 1
s_cselect_b32 s18, s21, 0
s_add_u32 s16, s16, s18
s_cmp_gt_u32 s12, 2
s_cselect_b32 s18, s22, 0
s_add_u32 s16, s16, s18
s_cmp_gt_u32 s12, 3
s_cselect_b32 s18, s23, 0
s_add_u32 s16, s16, s18
s_cmp_gt_u32 s12, 4
s_cselect_b32 s18, s24, 0
s_add_u32 s16, s16, s18
s_cmp_gt_u32 s12, 5
s_cselect_b32 s18, s25, 0
s_add_u32 s16, s16, s18
s_cmp_gt_u32 s12, 6
s_cselect_b32 s18, s26, 0
s_add_u32 s16, s16, s18
s_add_u32 s18, s16, 32
s_cmp_lt_u32 s12, s15
s_cselect_b32 s16, s18, s16
s_cmp_eq_u32 s12, s15
s_cselect_b32 s18, s17, 32
s_cmp_lt_u32 s18, 32
s_cselect_b32 s16, s18, s16
v_mov_b32 v1, 0
v_mov_b32 v2, s16
ds_write_b32 v1, v2
s_waitcnt lgkmcnt(0)
s_branch reg_2
reg_3:
s_lshl_b32 s15, s13, 3
s_sub_u32 s15, s15, 8
s_load_dwordx2 s[20:21], s[0:1], s15
s_mov_b32 s16, 1314816
s_cmp_eq_u32 s13, 1
s_cselect_b32 s22, 2621440, s16
s_cselect_b32 s16, 80, 41
s_mov_b32 s23, 0x20000
s_mul_i32 s17, s16, s2
s_lshl_b32 s17, s17, 7
s_sub_u32 s16, s16, 1
v_and_b32 v1, 63, v0
v_add_u32 v2, 64, v1
v_min_u32 v1, s16, v1
v_min_u32 v2, s16, v2
v_lshlrev_b32 v1, 7, v1
v_lshlrev_b32 v2, 7, v2
s_waitcnt lgkmcnt(0)
buffer_load_dword v3, v1, s[20:23], s17 offen
buffer_load_dword v4, v2, s[20:23], s17 offen
reg_2:
s_barrier
v_mov_b32 v1, 0
ds_read_b32 v2, v1
s_waitcnt lgkmcnt(0)
v_readfirstlane_b32 s14, v2
s_barrier
s_cmp_ge_u32 s14, 256
s_cbranch_scc1 L_end
s_cmp_lt_u32 s14, 32
s_cbranch_scc1 L_chain
s_sub_u32 s15, s14, 32
v_and_b32 v0, 63, v0
v_lshlrev_b32 v0, 4, v0
s_mov_b32 s24, 0x3f803f80
s_mul_i32 s31, s13, 10240
s_lshl_b32 s37, s13, 10
s_mov_b32 s22, s6
s_mov_b32 s23, 0
s_mov_b32 s16, 0
s_lshr_b32 s18, s15, 5
s_lshl_b32 s18, s18, 2
s_lshr_b32 s18, 106180896, s18
s_and_b32 s18, s18, 7
s_lshl_b32 s18, s18, 5
s_and_b32 s15, s15, 31
s_or_b32 s15, s15, s18
s_cmp_ge_u32 s15, 64
s_cbranch_scc1 roleA_6
s_and_b32 s32, s15, 31
s_cmp_ge_u32 s15, 32
s_cbranch_scc1 roleV_5
s_lshl_b32 s26, s32, 8
s_lshl_b32 s18, s13, 6
s_add_u32 s26, s26, s18
s_load_dwordx2 s[40:41], s[0:1], 48
s_mov_b32 s42, 5242880
s_mov_b32 s43, 0x20000
s_waitcnt lgkmcnt(0)
v_lshrrev_b32 v32, 6, v0
v_mul_u32_u24 v32, 8192, v32
v_and_b32 v33, 48, v0
v_add_u32 v30, v32, v33
v_bfe_u32 v32, v0, 6, 2
v_lshrrev_b32 v33, 9, v0
v_lshl_add_u32 v32, v33, 3, v32
v_lshlrev_b32 v31, 6, v32
v_and_b32 v32, 16, v0
v_add_u32 v31, v31, v32
v_bfe_u32 v32, v0, 5, 1
v_lshl_add_u32 v31, v32, 3, v31
v_bfe_u32 v32, v0, 8, 1
v_lshl_add_u32 v31, v32, 5, v31
s_mul_i32 s18, s13, 36864
v_add_u32 v31, s18, v31
s_barrier
s_add_u32 m0, s18, 0
s_add_u32 s19, s26, 0
buffer_load_dwordx4 v30, s[40:43], s19 offen lds
s_add_u32 m0, s18, 1024
s_add_u32 s19, s26, 131072
buffer_load_dwordx4 v30, s[40:43], s19 offen lds
s_add_u32 m0, s18, 2048
s_add_u32 s19, s26, 262144
buffer_load_dwordx4 v30, s[40:43], s19 offen lds
s_add_u32 m0, s18, 3072
s_add_u32 s19, s26, 393216
buffer_load_dwordx4 v30, s[40:43], s19 offen lds
s_add_u32 m0, s18, 4096
s_add_u32 s19, s26, 524288
buffer_load_dwordx4 v30, s[40:43], s19 offen lds
s_add_u32 m0, s18, 5120
s_add_u32 s19, s26, 655360
buffer_load_dwordx4 v30, s[40:43], s19 offen lds
s_add_u32 m0, s18, 6144
s_add_u32 s19, s26, 786432
buffer_load_dwordx4 v30, s[40:43], s19 offen lds
s_add_u32 m0, s18, 7168
s_add_u32 s19, s26, 917504
buffer_load_dwordx4 v30, s[40:43], s19 offen lds
s_add_u32 m0, s18, 8192
s_add_u32 s19, s26, 1048576
buffer_load_dwordx4 v30, s[40:43], s19 offen lds
s_add_u32 m0, s18, 9216
s_add_u32 s19, s26, 1179648
buffer_load_dwordx4 v30, s[40:43], s19 offen lds
s_add_u32 m0, s18, 10240
s_add_u32 s19, s26, 1310720
buffer_load_dwordx4 v30, s[40:43], s19 offen lds
s_add_u32 m0, s18, 11264
s_add_u32 s19, s26, 1441792
buffer_load_dwordx4 v30, s[40:43], s19 offen lds
s_add_u32 m0, s18, 12288
s_add_u32 s19, s26, 1572864
buffer_load_dwordx4 v30, s[40:43], s19 offen lds
s_add_u32 m0, s18, 13312
s_add_u32 s19, s26, 1703936
buffer_load_dwordx4 v30, s[40:43], s19 offen lds
s_add_u32 m0, s18, 14336
s_add_u32 s19, s26, 1835008
buffer_load_dwordx4 v30, s[40:43], s19 offen lds
s_add_u32 m0, s18, 15360
s_add_u32 s19, s26, 1966080
buffer_load_dwordx4 v30, s[40:43], s19 offen lds
s_add_u32 m0, s18, 16384
s_add_u32 s19, s26, 2097152
buffer_load_dwordx4 v30, s[40:43], s19 offen lds
s_add_u32 m0, s18, 17408
s_add_u32 s19, s26, 2228224
buffer_load_dwordx4 v30, s[40:43], s19 offen lds
s_add_u32 m0, s18, 18432
s_add_u32 s19, s26, 2359296
buffer_load_dwordx4 v30, s[40:43], s19 offen lds
s_add_u32 m0, s18, 19456
s_add_u32 s19, s26, 2490368
buffer_load_dwordx4 v30, s[40:43], s19 offen lds
s_add_u32 m0, s18, 20480
s_add_u32 s19, s26, 2621440
buffer_load_dwordx4 v30, s[40:43], s19 offen lds
s_add_u32 m0, s18, 21504
s_add_u32 s19, s26, 2752512
buffer_load_dwordx4 v30, s[40:43], s19 offen lds
s_add_u32 m0, s18, 22528
s_add_u32 s19, s26, 2883584
buffer_load_dwordx4 v30, s[40:43], s19 offen lds
s_add_u32 m0, s18, 23552
s_add_u32 s19, s26, 3014656
buffer_load_dwordx4 v30, s[40:43], s19 offen lds
s_add_u32 m0, s18, 24576
s_add_u32 s19, s26, 3145728
buffer_load_dwordx4 v30, s[40:43], s19 offen lds
s_add_u32 m0, s18, 25600
s_add_u32 s19, s26, 3276800
buffer_load_dwordx4 v30, s[40:43], s19 offen lds
s_add_u32 m0, s18, 26624
s_add_u32 s19, s26, 3407872
buffer_load_dwordx4 v30, s[40:43], s19 offen lds
s_add_u32 m0, s18, 27648
s_add_u32 s19, s26, 3538944
buffer_load_dwordx4 v30, s[40:43], s19 offen lds
s_add_u32 m0, s18, 28672
s_add_u32 s19, s26, 3670016
buffer_load_dwordx4 v30, s[40:43], s19 offen lds
s_add_u32 m0, s18, 29696
s_add_u32 s19, s26, 3801088
buffer_load_dwordx4 v30, s[40:43], s19 offen lds
s_add_u32 m0, s18, 30720
s_add_u32 s19, s26, 3932160
buffer_load_dwordx4 v30, s[40:43], s19 offen lds
s_add_u32 m0, s18, 31744
s_add_u32 s19, s26, 4063232
buffer_load_dwordx4 v30, s[40:43], s19 offen lds
s_add_u32 m0, s18, 32768
s_add_u32 s19, s26, 4194304
buffer_load_dwordx4 v30, s[40:43], s19 offen lds
s_add_u32 m0, s18, 33792
s_add_u32 s19, s26, 4325376
buffer_load_dwordx4 v30, s[40:43], s19 offen lds
s_add_u32 m0, s18, 34816
s_add_u32 s19, s26, 4456448
buffer_load_dwordx4 v30, s[40:43], s19 offen lds
s_add_u32 m0, s18, 35840
s_add_u32 s19, s26, 4587520
buffer_load_dwordx4 v30, s[40:43], s19 offen lds
s_waitcnt vmcnt(32)
ds_read_b64_tr_b16 a[0:1], v31 offset:0
ds_read_b64_tr_b16 a[2:3], v31 offset:256
ds_read_b64_tr_b16 a[4:5], v31 offset:1024
ds_read_b64_tr_b16 a[6:7], v31 offset:1280
ds_read_b64_tr_b16 a[8:9], v31 offset:2048
ds_read_b64_tr_b16 a[10:11], v31 offset:2304
ds_read_b64_tr_b16 a[12:13], v31 offset:3072
ds_read_b64_tr_b16 a[14:15], v31 offset:3328
s_waitcnt lgkmcnt(0)
s_add_u32 m0, s18, 0
s_add_u32 s19, s26, 4718592
buffer_load_dwordx4 v30, s[40:43], s19 offen lds
s_add_u32 m0, s18, 1024
s_add_u32 s19, s26, 4849664
buffer_load_dwordx4 v30, s[40:43], s19 offen lds
s_add_u32 m0, s18, 2048
s_add_u32 s19, s26, 4980736
buffer_load_dwordx4 v30, s[40:43], s19 offen lds
s_add_u32 m0, s18, 3072
s_add_u32 s19, s26, 5111808
buffer_load_dwordx4 v30, s[40:43], s19 offen lds
s_waitcnt vmcnt(32)
ds_read_b64_tr_b16 a[16:17], v31 offset:4096
ds_read_b64_tr_b16 a[18:19], v31 offset:4352
ds_read_b64_tr_b16 a[20:21], v31 offset:5120
ds_read_b64_tr_b16 a[22:23], v31 offset:5376
ds_read_b64_tr_b16 a[24:25], v31 offset:6144
ds_read_b64_tr_b16 a[26:27], v31 offset:6400
ds_read_b64_tr_b16 a[28:29], v31 offset:7168
ds_read_b64_tr_b16 a[30:31], v31 offset:7424
s_waitcnt vmcnt(28)
ds_read_b64_tr_b16 a[32:33], v31 offset:8192
ds_read_b64_tr_b16 a[34:35], v31 offset:8448
ds_read_b64_tr_b16 a[36:37], v31 offset:9216
ds_read_b64_tr_b16 a[38:39], v31 offset:9472
ds_read_b64_tr_b16 a[40:41], v31 offset:10240
ds_read_b64_tr_b16 a[42:43], v31 offset:10496
ds_read_b64_tr_b16 a[44:45], v31 offset:11264
ds_read_b64_tr_b16 a[46:47], v31 offset:11520
s_waitcnt vmcnt(24)
ds_read_b64_tr_b16 a[48:49], v31 offset:12288
ds_read_b64_tr_b16 a[50:51], v31 offset:12544
ds_read_b64_tr_b16 a[52:53], v31 offset:13312
ds_read_b64_tr_b16 a[54:55], v31 offset:13568
ds_read_b64_tr_b16 a[56:57], v31 offset:14336
ds_read_b64_tr_b16 a[58:59], v31 offset:14592
ds_read_b64_tr_b16 a[60:61], v31 offset:15360
ds_read_b64_tr_b16 a[62:63], v31 offset:15616
s_waitcnt vmcnt(20)
ds_read_b64_tr_b16 a[64:65], v31 offset:16384
ds_read_b64_tr_b16 a[66:67], v31 offset:16640
ds_read_b64_tr_b16 a[68:69], v31 offset:17408
ds_read_b64_tr_b16 a[70:71], v31 offset:17664
ds_read_b64_tr_b16 a[72:73], v31 offset:18432
ds_read_b64_tr_b16 a[74:75], v31 offset:18688
ds_read_b64_tr_b16 a[76:77], v31 offset:19456
ds_read_b64_tr_b16 a[78:79], v31 offset:19712
s_waitcnt vmcnt(16)
ds_read_b64_tr_b16 a[80:81], v31 offset:20480
ds_read_b64_tr_b16 a[82:83], v31 offset:20736
ds_read_b64_tr_b16 a[84:85], v31 offset:21504
ds_read_b64_tr_b16 a[86:87], v31 offset:21760
ds_read_b64_tr_b16 a[88:89], v31 offset:22528
ds_read_b64_tr_b16 a[90:91], v31 offset:22784
ds_read_b64_tr_b16 a[92:93], v31 offset:23552
ds_read_b64_tr_b16 a[94:95], v31 offset:23808
s_waitcnt vmcnt(12)
ds_read_b64_tr_b16 a[96:97], v31 offset:24576
ds_read_b64_tr_b16 a[98:99], v31 offset:24832
ds_read_b64_tr_b16 a[100:101], v31 offset:25600
ds_read_b64_tr_b16 a[102:103], v31 offset:25856
ds_read_b64_tr_b16 a[104:105], v31 offset:26624
ds_read_b64_tr_b16 a[106:107], v31 offset:26880
ds_read_b64_tr_b16 a[108:109], v31 offset:27648
ds_read_b64_tr_b16 a[110:111], v31 offset:27904
s_waitcnt vmcnt(8)
ds_read_b64_tr_b16 a[112:113], v31 offset:28672
ds_read_b64_tr_b16 a[114:115], v31 offset:28928
ds_read_b64_tr_b16 a[116:117], v31 offset:29696
ds_read_b64_tr_b16 a[118:119], v31 offset:29952
ds_read_b64_tr_b16 a[120:121], v31 offset:30720
ds_read_b64_tr_b16 a[122:123], v31 offset:30976
ds_read_b64_tr_b16 a[124:125], v31 offset:31744
ds_read_b64_tr_b16 a[126:127], v31 offset:32000
s_waitcnt vmcnt(4)
ds_read_b64_tr_b16 a[128:129], v31 offset:32768
ds_read_b64_tr_b16 a[130:131], v31 offset:33024
ds_read_b64_tr_b16 a[132:133], v31 offset:33792
ds_read_b64_tr_b16 a[134:135], v31 offset:34048
ds_read_b64_tr_b16 a[136:137], v31 offset:34816
ds_read_b64_tr_b16 a[138:139], v31 offset:35072
ds_read_b64_tr_b16 a[140:141], v31 offset:35840
ds_read_b64_tr_b16 a[142:143], v31 offset:36096
s_waitcnt vmcnt(0)
ds_read_b64_tr_b16 a[144:145], v31 offset:0
ds_read_b64_tr_b16 a[146:147], v31 offset:256
ds_read_b64_tr_b16 a[148:149], v31 offset:1024
ds_read_b64_tr_b16 a[150:151], v31 offset:1280
ds_read_b64_tr_b16 a[152:153], v31 offset:2048
ds_read_b64_tr_b16 a[154:155], v31 offset:2304
ds_read_b64_tr_b16 a[156:157], v31 offset:3072
ds_read_b64_tr_b16 a[158:159], v31 offset:3328
s_waitcnt lgkmcnt(0)
s_barrier
s_load_dwordx2 s[40:41], s[0:1], 40
s_mov_b32 s42, 5242880
s_mov_b32 s43, 0x20000
s_waitcnt lgkmcnt(0)
v_lshrrev_b32 v5, 5, v0
v_lshlrev_b32 v5, 13, v5
v_bfe_u32 v6, v0, 4, 1
v_lshl_add_u32 v5, v6, 7, v5
s_lshl_b32 s18, s32, 8
s_mul_i32 s19, s13, 1310720
s_add_u32 s18, s18, s19
buffer_load_dword v24, v5, s[40:43], s18 offen
s_add_u32 s18, s18, 262144
buffer_load_dword v25, v5, s[40:43], s18 offen
s_add_u32 s18, s18, 262144
buffer_load_dword v26, v5, s[40:43], s18 offen
s_add_u32 s18, s18, 262144
buffer_load_dword v27, v5, s[40:43], s18 offen
s_add_u32 s18, s18, 262144
buffer_load_dword v28, v5, s[40:43], s18 offen
s_add_u32 s18, s18, 262144
v_mov_b32 v32, s24
v_mov_b32 v33, s24
v_mov_b32 v34, s24
v_mov_b32 v35, s24
s_nop 1
v_mfma_f32_32x32x16_bf16 v[36:51], a[0:3], v[32:35], 0
v_mfma_f32_32x32x16_bf16 v[36:51], a[4:7], v[32:35], v[36:51]
v_mfma_f32_32x32x16_bf16 v[36:51], a[8:11], v[32:35], v[36:51]
v_mfma_f32_32x32x16_bf16 v[36:51], a[12:15], v[32:35], v[36:51]
v_mfma_f32_32x32x16_bf16 v[36:51], a[16:19], v[32:35], v[36:51]
v_mfma_f32_32x32x16_bf16 v[36:51], a[20:23], v[32:35], v[36:51]
v_mfma_f32_32x32x16_bf16 v[36:51], a[24:27], v[32:35], v[36:51]
v_mfma_f32_32x32x16_bf16 v[36:51], a[28:31], v[32:35], v[36:51]
v_mfma_f32_32x32x16_bf16 v[36:51], a[32:35], v[32:35], v[36:51]
v_mfma_f32_32x32x16_bf16 v[36:51], a[36:39], v[32:35], v[36:51]
v_mfma_f32_32x32x16_bf16 v[36:51], a[40:43], v[32:35], v[36:51]
v_mfma_f32_32x32x16_bf16 v[36:51], a[44:47], v[32:35], v[36:51]
v_mfma_f32_32x32x16_bf16 v[36:51], a[48:51], v[32:35], v[36:51]
v_mfma_f32_32x32x16_bf16 v[36:51], a[52:55], v[32:35], v[36:51]
v_mfma_f32_32x32x16_bf16 v[36:51], a[56:59], v[32:35], v[36:51]
v_mfma_f32_32x32x16_bf16 v[36:51], a[60:63], v[32:35], v[36:51]
v_mfma_f32_32x32x16_bf16 v[36:51], a[64:67], v[32:35], v[36:51]
v_mfma_f32_32x32x16_bf16 v[36:51], a[68:71], v[32:35], v[36:51]
v_mfma_f32_32x32x16_bf16 v[36:51], a[72:75], v[32:35], v[36:51]
v_mfma_f32_32x32x16_bf16 v[36:51], a[76:79], v[32:35], v[36:51]
v_mfma_f32_32x32x16_bf16 v[36:51], a[80:83], v[32:35], v[36:51]
v_mfma_f32_32x32x16_bf16 v[36:51], a[84:87], v[32:35], v[36:51]
v_mfma_f32_32x32x16_bf16 v[36:51], a[88:91], v[32:35], v[36:51]
v_mfma_f32_32x32x16_bf16 v[36:51], a[92:95], v[32:35], v[36:51]
v_mfma_f32_32x32x16_bf16 v[36:51], a[96:99], v[32:35], v[36:51]
v_mfma_f32_32x32x16_bf16 v[36:51], a[100:103], v[32:35], v[36:51]
v_mfma_f32_32x32x16_bf16 v[36:51], a[104:107], v[32:35], v[36:51]
v_mfma_f32_32x32x16_bf16 v[36:51], a[108:111], v[32:35], v[36:51]
v_mfma_f32_32x32x16_bf16 v[36:51], a[112:115], v[32:35], v[36:51]
v_mfma_f32_32x32x16_bf16 v[36:51], a[116:119], v[32:35], v[36:51]
v_mfma_f32_32x32x16_bf16 v[36:51], a[120:123], v[32:35], v[36:51]
v_mfma_f32_32x32x16_bf16 v[36:51], a[124:127], v[32:35], v[36:51]
v_mfma_f32_32x32x16_bf16 v[36:51], a[128:131], v[32:35], v[36:51]
v_mfma_f32_32x32x16_bf16 v[36:51], a[132:135], v[32:35], v[36:51]
v_mfma_f32_32x32x16_bf16 v[36:51], a[136:139], v[32:35], v[36:51]
v_mfma_f32_32x32x16_bf16 v[36:51], a[140:143], v[32:35], v[36:51]
v_mfma_f32_32x32x16_bf16 v[36:51], a[144:147], v[32:35], v[36:51]
v_mfma_f32_32x32x16_bf16 v[36:51], a[148:151], v[32:35], v[36:51]
v_mfma_f32_32x32x16_bf16 v[36:51], a[152:155], v[32:35], v[36:51]
v_mfma_f32_32x32x16_bf16 v[36:51], a[156:159], v[32:35], v[36:51]
s_nop 11
v_mov_b32 v8, v36
v_mov_b32 v9, v37
v_mov_b32 v10, v38
v_mov_b32 v11, v39
v_mov_b32 v12, v40
v_mov_b32 v13, v41
v_mov_b32 v14, v42
v_mov_b32 v15, v43
v_mov_b32 v16, v44
v_mov_b32 v17, v45
v_mov_b32 v18, v46
v_mov_b32 v19, v47
v_mov_b32 v20, v48
v_mov_b32 v21, v49
v_mov_b32 v22, v50
v_mov_b32 v23, v51
v_and_b32 v5, 0x70, v0
s_waitcnt vmcnt(4)
v_lshrrev_b32 v24, 8, v0
v_lshl_add_u32 v5, v24, 7, v5
v_bfe_u32 v24, v0, 7, 1
v_lshl_add_u32 v5, v24, 12, v5
s_lshr_b32 s34, s13, 1
s_lshl_b32 s34, s34, 13
s_and_b32 s18, s13, 1
s_lshl_b32 s18, s18, 10
s_add_u32 s34, s34, s18
s_lshl_b32 s18, s32, 14
s_add_u32 s34, s34, s18
v_bfe_u32 v6, v0, 7, 2
v_mul_u32_u24 v6, 10240, v6
v_bfe_u32 v24, v0, 5, 2
v_lshl_add_u32 v6, v24, 6, v6
v_lshrrev_b32 v24, 9, v0
v_lshl_add_u32 v6, v24, 5, v6
v_and_b32 v24, 16, v0
v_add_u32 v6, v24, v6
s_lshl_b32 s51, s32, 8
s_add_u32 s51, s51, 11534336
s_mul_i32 s52, s13, 2560
s_add_u32 s52, s52, 12582912
s_add_u32 s50, s34, 110100480
s_mov_b32 s39, 0
kvlay_7:
s_mul_i32 s26, s16, 6291456
s_add_u32 s26, s26, 88080384
s_add_u32 s26, s26, s31
s_mul_i32 s54, s16, 327680
s_add_u32 s54, s54, 163577856
s_mul_i32 s27, s16, 35651584
s_add_u32 s27, s27, 16777216
s_mul_i32 s18, s32, 0
s_add_u32 s27, s27, s18
s_add_u32 s27, s27, s34
s_lshl_b32 s29, s16, 1
s_add_u32 s29, s29, 1
s_mov_b32 s28, 0
s_mov_b32 s30, 0
s_cmp_lt_u32 s30, 64
s_cselect_b32 s53, s26, s6
s_cselect_b32 s36, s54, s6
s_mov_b32 s38, 1024
v_mov_b32 v7, v0
s_add_u32 s26, s26, 40960
s_add_u32 s54, s54, 5120
s_add_u32 s30, s30, 1
v_xor_b32 v1, 40960, v0
s_mov_b32 s25, s31
s_mov_b32 s35, 131072
s_cmp_lg_u32 s13, 0
s_cbranch_scc1 polld_16
s_waitcnt vmcnt(1)
v_lshlrev_b32 v27, 3, v0
v_min_u32 v27, 1152, v27
s_mov_b32 s21, 11612160
s_mov_b32 s17, 0
poll_15:
buffer_load_dword v24, v27, s[4:7], s21 offen sc1
s_add_u32 s17, s17, 1
s_cmp_gt_u32 s17, 262144
s_cbranch_scc1 L_fail
s_waitcnt vmcnt(0)
v_cmp_gt_u32 vcc, s29, v24
s_cbranch_vccz polld_16
s_sleep 2
s_branch poll_15
polld_16:
s_barrier
s_add_u32 m0, s25, 2048
s_mov_b32 s20, s53
buffer_load_dwordx4 v7, s[4:7], s20 offen sc1 lds
s_add_u32 m0, s25, 3072
s_add_u32 s20, s20, s38
buffer_load_dwordx4 v7, s[4:7], s20 offen sc1 lds
s_add_u32 m0, s25, 4096
s_add_u32 s20, s20, s38
buffer_load_dwordx4 v7, s[4:7], s20 offen sc1 lds
s_add_u32 m0, s25, 5120
s_add_u32 s20, s20, s38
buffer_load_dwordx4 v7, s[4:7], s20 offen sc1 lds
s_add_u32 m0, s25, 6144
s_add_u32 s20, s20, s38
buffer_load_dwordx4 v7, s[4:7], s20 offen sc1 lds
s_add_u32 m0, s25, 7168
s_add_u32 s20, s20, s38
buffer_load_dwordx4 v7, s[4:7], s20 offen sc1 lds
s_add_u32 m0, s25, 8192
s_add_u32 s20, s20, s38
buffer_load_dwordx4 v7, s[4:7], s20 offen sc1 lds
s_add_u32 m0, s25, 9216
s_add_u32 s20, s20, s38
buffer_load_dwordx4 v7, s[4:7], s20 offen sc1 lds
s_add_u32 m0, s25, 10240
s_add_u32 s20, s20, s38
buffer_load_dwordx4 v7, s[4:7], s20 offen sc1 lds
s_add_u32 m0, s25, 11264
s_add_u32 s20, s20, s38
buffer_load_dwordx4 v7, s[4:7], s20 offen sc1 lds
s_add_u32 m0, s35, s37
s_add_u32 s20, s36, s37
buffer_load_dwordx4 v0, s[4:7], s20 offen sc1 lds
s_add_u32 m0, s35, 4096
s_add_u32 s20, s36, 4096
buffer_load_dwordx4 v0, s[4:7], s20 offen sc1 lds
s_waitcnt vmcnt(0)
kvx_8:
v_xor_b32 v1, 40960, v1
s_sub_u32 s25, s25, s31
s_xor_b32 s25, s25, 40960
s_add_u32 s25, s25, s31
s_xor_b32 s35, s35, 8192
s_cmp_eq_u32 s28, 1
s_cbranch_scc1 kv_10
s_cmp_eq_u32 s28, 30
s_cbranch_scc0 kv_11
s_add_u32 s29, s29, 1
kv_10:
s_waitcnt vmcnt(0)
s_barrier
v_mov_b32 v3, s23
s_mov_b64 exec, 1
buffer_store_dword v3, off, s[4:7], s22 sc1
s_mov_b64 exec, -1
s_mov_b32 s22, s6
s_cmp_lg_u32 s13, 0
s_cbranch_scc1 polld_18
v_lshlrev_b32 v27, 3, v0
v_add_u32 v28, 8192, v27
v_add_u32 v3, 16384, v27
v_min_u32 v3, 20352, v3
s_mov_b32 s21, 11612160
s_mov_b32 s17, 0
poll_17:
buffer_load_dword v24, v27, s[4:7], s21 offen sc1
buffer_load_dword v25, v28, s[4:7], s21 offen sc1
buffer_load_dword v26, v3, s[4:7], s21 offen sc1
s_add_u32 s17, s17, 1
s_cmp_gt_u32 s17, 262144
s_cbranch_scc1 L_fail
s_waitcnt vmcnt(0)
v_min3_u32 v24, v24, v25, v26
v_cmp_gt_u32 vcc, s29, v24
s_cbranch_vccz polld_18
s_sleep 2
s_branch poll_17
polld_18:
s_barrier
kv_11:
s_add_u32 s28, s28, 1
s_and_b32 s33, s28, 3
s_cmp_lt_u32 s28, 12
s_cselect_b32 s33, 1, s33
s_cmp_eq_u32 s33, 0
s_cbranch_scc1 kv_12
s_cmp_lt_u32 s30, 64
s_cselect_b32 s53, s26, s6
s_cselect_b32 s36, s54, s6
s_mov_b32 s38, 1024
v_mov_b32 v7, v0
s_add_u32 s26, s26, 40960
s_add_u32 s54, s54, 5120
s_add_u32 s30, s30, 1
kvn_9:
s_waitcnt vmcnt(3)
s_barrier
s_add_u32 m0, s25, 2048
s_mov_b32 s20, s53
buffer_load_dwordx4 v7, s[4:7], s20 offen sc1 lds
ds_read_b128 v[48:51], v1 offset:2048
ds_read_b128 v[52:55], v1 offset:3072
s_add_u32 m0, s25, 3072
s_add_u32 s20, s20, s38
buffer_load_dwordx4 v7, s[4:7], s20 offen sc1 lds
s_add_u32 m0, s25, 4096
s_add_u32 s20, s20, s38
buffer_load_dwordx4 v7, s[4:7], s20 offen sc1 lds
ds_read_b128 v[56:59], v1 offset:4096
ds_read_b128 v[60:63], v1 offset:5120
s_waitcnt lgkmcnt(3)
v_mfma_f32_32x32x16_bf16 v[32:47], a[0:3], v[48:51], 0
s_xor_b32 s18, s35, 8192
ds_read_b128 v[48:51], v1 offset:6144
v_lshrrev_b32 v2, 2, v0
s_waitcnt lgkmcnt(3)
v_mfma_f32_32x32x16_bf16 v[32:47], a[4:7], v[52:55], v[32:47]
ds_read_b128 v[52:55], v1 offset:7168
v_add_u32 v2, s18, v2
s_waitcnt lgkmcnt(3)
v_mfma_f32_32x32x16_bf16 v[32:47], a[8:11], v[56:59], v[32:47]
ds_read2st64_b32 v[64:65], v2 offset0:0 offset1:1
s_waitcnt lgkmcnt(2)
ds_read2st64_b32 v[66:67], v2 offset0:2 offset1:3
ds_read_b128 v[56:59], v1 offset:8192
v_mfma_f32_32x32x16_bf16 v[32:47], a[12:15], v[60:63], v[32:47]
ds_read_b128 v[60:63], v1 offset:9216
ds_read2st64_b32 v[74:75], v2 offset0:6 offset1:7
s_waitcnt lgkmcnt(5)
v_mfma_f32_32x32x16_bf16 v[32:47], a[16:19], v[48:51], v[32:47]
s_add_u32 m0, s25, 5120
s_add_u32 s20, s20, s38
buffer_load_dwordx4 v7, s[4:7], s20 offen sc1 lds
ds_read2st64_b32 v[72:73], v2 offset0:4 offset1:5
ds_read_b128 v[48:51], v1 offset:10240
ds_read2st64_b32 v[84:85], v2 offset0:16 offset1:17
s_waitcnt lgkmcnt(5)
v_mfma_f32_32x32x16_bf16 v[32:47], a[20:23], v[52:55], v[32:47]
s_waitcnt lgkmcnt(4)
s_add_u32 m0, s25, 6144
s_add_u32 s20, s20, s38
buffer_load_dwordx4 v7, s[4:7], s20 offen sc1 lds
v_mfma_f32_32x32x16_bf16 v[32:47], a[24:27], v[56:59], v[32:47]
ds_read_b128 v[52:55], v1 offset:11264
s_add_u32 m0, s25, 7168
s_add_u32 s20, s20, s38
buffer_load_dwordx4 v7, s[4:7], s20 offen sc1 lds
v_mfma_f32_32x32x16_bf16 v[32:47], a[28:31], v[60:63], v[32:47]
ds_read_b128 v[60:63], v1 offset:13312
s_waitcnt lgkmcnt(2)
ds_read_b128 v[56:59], v1 offset:12288
ds_read2st64_b32 v[80:81], v2 offset0:12 offset1:13
v_add_f32 v65, v65, v67
v_mfma_f32_32x32x16_bf16 v[32:47], a[32:35], v[48:51], v[32:47]
s_waitcnt lgkmcnt(3)
ds_read_b128 v[48:51], v1 offset:14336
ds_read2st64_b32 v[76:77], v2 offset0:8 offset1:9
s_add_u32 m0, s25, 8192
s_add_u32 s20, s20, s38
buffer_load_dwordx4 v7, s[4:7], s20 offen sc1 lds
v_mfma_f32_32x32x16_bf16 v[32:47], a[36:39], v[52:55], v[32:47]
s_add_u32 m0, s25, 9216
s_add_u32 s20, s20, s38
buffer_load_dwordx4 v7, s[4:7], s20 offen sc1 lds
ds_read_b128 v[52:55], v1 offset:15360
s_waitcnt lgkmcnt(4)
v_mfma_f32_32x32x16_bf16 v[32:47], a[40:43], v[56:59], v[32:47]
s_waitcnt lgkmcnt(2)
v_add_f32 v64, v64, v66
v_mov_b32 v3, s23
s_waitcnt lgkmcnt(1)
v_mfma_f32_32x32x16_bf16 v[32:47], a[44:47], v[60:63], v[32:47]
ds_read_b128 v[60:63], v1 offset:17408
ds_read_b128 v[56:59], v1 offset:16384
v_mfma_f32_32x32x16_bf16 v[32:47], a[48:51], v[48:51], v[32:47]
s_waitcnt lgkmcnt(2)
ds_read_b128 v[48:51], v1 offset:18432
ds_read2st64_b32 v[86:87], v2 offset0:18 offset1:19
v_mfma_f32_32x32x16_bf16 v[32:47], a[52:55], v[52:55], v[32:47]
ds_read2st64_b32 v[78:79], v2 offset0:10 offset1:11
s_waitcnt lgkmcnt(3)
v_mfma_f32_32x32x16_bf16 v[32:47], a[56:59], v[56:59], v[32:47]
s_waitcnt lgkmcnt(2)
ds_read_b128 v[52:55], v1 offset:19456
ds_read2st64_b32 v[82:83], v2 offset0:14 offset1:15
s_add_u32 m0, s25, 10240
s_add_u32 s20, s20, s38
buffer_load_dwordx4 v7, s[4:7], s20 offen sc1 lds
v_mfma_f32_32x32x16_bf16 v[32:47], a[60:63], v[60:63], v[32:47]
ds_read_b128 v[56:59], v1 offset:20480
s_waitcnt lgkmcnt(3)
ds_read_b128 v[60:63], v1 offset:21504
v_add_f32 v65, v65, v73
v_mfma_f32_32x32x16_bf16 v[32:47], a[64:67], v[48:51], v[32:47]
v_add_f32 v64, v64, v72
s_waitcnt lgkmcnt(3)
v_add_f32 v64, v64, v74
v_add_f32 v65, v65, v75
s_waitcnt lgkmcnt(2)
v_mfma_f32_32x32x16_bf16 v[32:47], a[68:71], v[52:55], v[32:47]
ds_read_b128 v[52:55], v1 offset:23552
ds_read_b128 v[48:51], v1 offset:22528
s_waitcnt lgkmcnt(3)
v_add_f32 v65, v65, v77
v_add_f32 v64, v64, v76
v_mfma_f32_32x32x16_bf16 v[32:47], a[72:75], v[56:59], v[32:47]
v_add_f32 v64, v64, v78
ds_read_b128 v[56:59], v1 offset:24576
s_waitcnt lgkmcnt(3)
v_mfma_f32_32x32x16_bf16 v[32:47], a[76:79], v[60:63], v[32:47]
ds_read_b128 v[60:63], v1 offset:25600
s_waitcnt lgkmcnt(3)
v_add_f32 v64, v64, v80
s_waitcnt lgkmcnt(2)
v_mfma_f32_32x32x16_bf16 v[32:47], a[80:83], v[48:51], v[32:47]
ds_read_b128 v[48:51], v1 offset:26624
s_add_u32 m0, s25, 11264
s_add_u32 s20, s20, s38
buffer_load_dwordx4 v7, s[4:7], s20 offen sc1 lds
v_mfma_f32_32x32x16_bf16 v[32:47], a[84:87], v[52:55], v[32:47]
s_waitcnt lgkmcnt(2)
ds_read_b128 v[52:55], v1 offset:27648
v_add_f32 v65, v65, v79
s_waitcnt lgkmcnt(2)
v_mfma_f32_32x32x16_bf16 v[32:47], a[88:91], v[56:59], v[32:47]
s_waitcnt lgkmcnt(1)
s_add_u32 m0, s35, s37
s_add_u32 s20, s36, s37
buffer_load_dwordx4 v0, s[4:7], s20 offen sc1 lds
v_mfma_f32_32x32x16_bf16 v[32:47], a[92:95], v[60:63], v[32:47]
ds_read_b128 v[56:59], v1 offset:28672
ds_read_b128 v[60:63], v1 offset:29696
s_waitcnt lgkmcnt(2)
v_add_f32 v64, v64, v82
v_add_f32 v65, v65, v81
v_mfma_f32_32x32x16_bf16 v[32:47], a[96:99], v[48:51], v[32:47]
s_add_u32 m0, s35, 4096
s_add_u32 s20, s36, 4096
buffer_load_dwordx4 v0, s[4:7], s20 offen sc1 lds
v_mfma_f32_32x32x16_bf16 v[32:47], a[100:103], v[52:55], v[32:47]
ds_read_b128 v[48:51], v1 offset:30720
s_waitcnt lgkmcnt(2)
ds_read_b128 v[52:55], v1 offset:31744
v_mfma_f32_32x32x16_bf16 v[32:47], a[104:107], v[56:59], v[32:47]
ds_read_b128 v[56:59], v1 offset:32768
v_add_f32 v65, v65, v83
s_waitcnt lgkmcnt(3)
v_add_f32 v64, v64, v84
v_add_f32 v65, v65, v85
v_mfma_f32_32x32x16_bf16 v[32:47], a[108:111], v[60:63], v[32:47]
s_waitcnt lgkmcnt(2)
v_add_f32 v65, v65, v87
s_waitcnt lgkmcnt(1)
v_add_f32 v64, v64, v86
v_mfma_f32_32x32x16_bf16 v[32:47], a[112:115], v[48:51], v[32:47]
s_waitcnt lgkmcnt(0)
ds_read_b128 v[48:51], v1 offset:34816
ds_read_b128 v[60:63], v1 offset:33792
v_add_f32 v64, v64, v65
v_mov_b32 v68, v64
v_mfma_f32_32x32x16_bf16 v[32:47], a[116:119], v[52:55], v[32:47]
s_waitcnt vmcnt(12)
s_barrier
s_mov_b64 exec, 1
buffer_store_dword v3, off, s[4:7], s22 sc1
s_mov_b64 exec, -1
v_mfma_f32_32x32x16_bf16 v[32:47], a[120:123], v[56:59], v[32:47]
ds_read_b128 v[52:55], v1 offset:35840
ds_read_b128 v[56:59], v1 offset:36864
s_waitcnt lgkmcnt(2)
v_mfma_f32_32x32x16_bf16 v[32:47], a[124:127], v[60:63], v[32:47]
ds_read_b128 v[60:63], v1 offset:37888
v_permlane32_swap_b32 v64, v68
v_mul_f32 v68, 0x3acccccd, v68
v_mul_f32 v64, 0x3acccccd, v64
v_mfma_f32_32x32x16_bf16 v[32:47], a[128:131], v[48:51], v[32:47]
s_waitcnt lgkmcnt(2)
v_mfma_f32_32x32x16_bf16 v[32:47], a[132:135], v[52:55], v[32:47]
s_waitcnt lgkmcnt(0)
ds_read_b128 v[48:51], v1 offset:38912
v_fma_f32 v68, -v64, v64, v68
v_max_f32 v68, 0, v68
v_add_f32 v68, 0x3727c5ac, v68
v_mfma_f32_32x32x16_bf16 v[32:47], a[136:139], v[56:59], v[32:47]
ds_read_b128 v[52:55], v1 offset:39936
v_rsq_f32 v68, v68
s_nop 0
v_mul_f32 v64, v68, v64
v_mfma_f32_32x32x16_bf16 v[32:47], a[140:143], v[60:63], v[32:47]
ds_read_b128 v[56:59], v1 offset:40960
s_waitcnt lgkmcnt(2)
v_mfma_f32_32x32x16_bf16 v[32:47], a[144:147], v[48:51], v[32:47]
ds_read_b128 v[60:63], v1 offset:41984
v_mul_f32 v78, v64, v14
v_mul_f32 v85, v64, v21
s_waitcnt lgkmcnt(2)
v_mul_f32 v75, v64, v11
v_mul_f32 v79, v64, v15
v_mfma_f32_32x32x16_bf16 v[32:47], a[148:151], v[52:55], v[32:47]
v_mul_f32 v84, v64, v20
s_waitcnt lgkmcnt(1)
v_mul_f32 v73, v64, v9
v_mul_f32 v72, v64, v8
v_mul_f32 v82, v64, v18
v_mul_f32 v87, v64, v23
v_mfma_f32_32x32x16_bf16 v[32:47], a[152:155], v[56:59], v[32:47]
s_waitcnt lgkmcnt(0)
v_mul_f32 v83, v64, v19
v_mul_f32 v74, v64, v10
v_mul_f32 v81, v64, v17
v_mul_f32 v86, v64, v22
v_mfma_f32_32x32x16_bf16 v[32:47], a[156:159], v[60:63], v[32:47]
s_nop 0
v_mul_f32 v80, v64, v16
v_mul_f32 v76, v64, v12
v_mul_f32 v77, v64, v13
s_nop 7
v_pk_fma_f32 v[40:41], v[40:41], v[68:69], v[80:81] op_sel_hi:[1,0,1] neg_lo:[0,0,1] neg_hi:[0,0,1]
v_pk_fma_f32 v[32:33], v[32:33], v[68:69], v[72:73] op_sel_hi:[1,0,1] neg_lo:[0,0,1] neg_hi:[0,0,1]
v_pk_fma_f32 v[34:35], v[34:35], v[68:69], v[74:75] op_sel_hi:[1,0,1] neg_lo:[0,0,1] neg_hi:[0,0,1]
v_pk_fma_f32 v[42:43], v[42:43], v[68:69], v[82:83] op_sel_hi:[1,0,1] neg_lo:[0,0,1] neg_hi:[0,0,1]
v_cvt_pk_bf16_f32 v48, v32, v33
v_cvt_pk_bf16_f32 v49, v34, v35
v_pk_fma_f32 v[44:45], v[44:45], v[68:69], v[84:85] op_sel_hi:[1,0,1] neg_lo:[0,0,1] neg_hi:[0,0,1]
v_pk_fma_f32 v[46:47], v[46:47], v[68:69], v[86:87] op_sel_hi:[1,0,1] neg_lo:[0,0,1] neg_hi:[0,0,1]
v_pk_fma_f32 v[36:37], v[36:37], v[68:69], v[76:77] op_sel_hi:[1,0,1] neg_lo:[0,0,1] neg_hi:[0,0,1]
v_cvt_pk_bf16_f32 v50, v36, v37
v_cvt_pk_bf16_f32 v52, v40, v41
v_cvt_pk_bf16_f32 v54, v44, v45
v_pk_fma_f32 v[38:39], v[38:39], v[68:69], v[78:79] op_sel_hi:[1,0,1] neg_lo:[0,0,1] neg_hi:[0,0,1]
v_cvt_pk_bf16_f32 v51, v38, v39
v_cvt_pk_bf16_f32 v53, v42, v43
v_cvt_pk_bf16_f32 v55, v46, v47
buffer_store_dwordx4 v[48:51], v5, s[4:7], s27 offen offset:0 sc1
buffer_store_dwordx4 v[52:55], v5, s[4:7], s27 offen offset:512 sc1
s_lshl_b32 s18, s16, 6
s_add_u32 s18, s18, s28
s_add_u32 s27, s27, 524288
s_cmp_eq_u32 s13, 0
s_cselect_b32 s22, s51, s6
s_mov_b32 s23, s18
s_cmp_lg_u32 s33, 0
s_cbranch_scc1 kvx_8
kvm_13:
v_xor_b32 v1, 40960, v1
s_sub_u32 s25, s25, s31
s_xor_b32 s25, s25, 40960
s_add_u32 s25, s25, s31
s_xor_b32 s35, s35, 8192
s_cmp_lt_u32 s30, 64
s_cselect_b32 s53, s26, s6
s_cselect_b32 s36, s54, s6
s_mov_b32 s38, 1024
v_mov_b32 v7, v0
s_add_u32 s26, s26, 40960
s_add_u32 s54, s54, 5120
s_add_u32 s30, s30, 1
s_waitcnt vmcnt(3)
s_barrier
ds_read_b128 v[48:51], v1 offset:2048
s_add_u32 m0, s25, 2048
s_mov_b32 s20, s53
buffer_load_dwordx4 v7, s[4:7], s20 offen sc1 lds
ds_read_b128 v[52:55], v1 offset:3072
ds_read_b128 v[56:59], v1 offset:4096
s_add_u32 m0, s25, 3072
s_add_u32 s20, s20, s38
buffer_load_dwordx4 v7, s[4:7], s20 offen sc1 lds
s_waitcnt lgkmcnt(2)
v_mfma_f32_32x32x16_bf16 v[32:47], a[0:3], v[48:51], 0
ds_read_b128 v[60:63], v1 offset:5120
s_waitcnt lgkmcnt(2)
s_add_u32 m0, s25, 4096
s_add_u32 s20, s20, s38
buffer_load_dwordx4 v7, s[4:7], s20 offen sc1 lds
s_waitcnt lgkmcnt(1)
v_mfma_f32_32x32x16_bf16 v[32:47], a[4:7], v[52:55], v[32:47]
s_add_u32 m0, s25, 5120
s_add_u32 s20, s20, s38
buffer_load_dwordx4 v7, s[4:7], s20 offen sc1 lds
ds_read_b128 v[48:51], v1 offset:6144
ds_read_b128 v[52:55], v1 offset:7168
v_mfma_f32_32x32x16_bf16 v[32:47], a[8:11], v[56:59], v[32:47]
ds_read_b128 v[56:59], v1 offset:8192
s_waitcnt lgkmcnt(3)
v_mfma_f32_32x32x16_bf16 v[32:47], a[12:15], v[60:63], v[32:47]
s_waitcnt lgkmcnt(2)
v_mfma_f32_32x32x16_bf16 v[32:47], a[16:19], v[48:51], v[32:47]
ds_read_b128 v[60:63], v1 offset:9216
ds_read_b128 v[48:51], v1 offset:10240
s_waitcnt lgkmcnt(2)
v_mfma_f32_32x32x16_bf16 v[32:47], a[20:23], v[52:55], v[32:47]
v_mfma_f32_32x32x16_bf16 v[32:47], a[24:27], v[56:59], v[32:47]
ds_read_b128 v[56:59], v1 offset:12288
s_waitcnt lgkmcnt(2)
ds_read_b128 v[52:55], v1 offset:11264
v_mfma_f32_32x32x16_bf16 v[32:47], a[28:31], v[60:63], v[32:47]
s_waitcnt lgkmcnt(2)
s_add_u32 m0, s25, 6144
s_add_u32 s20, s20, s38
buffer_load_dwordx4 v7, s[4:7], s20 offen sc1 lds
ds_read_b128 v[60:63], v1 offset:13312
v_mfma_f32_32x32x16_bf16 v[32:47], a[32:35], v[48:51], v[32:47]
s_waitcnt lgkmcnt(2)
s_add_u32 m0, s25, 7168
s_add_u32 s20, s20, s38
buffer_load_dwordx4 v7, s[4:7], s20 offen sc1 lds
s_waitcnt lgkmcnt(1)
v_mfma_f32_32x32x16_bf16 v[32:47], a[36:39], v[52:55], v[32:47]
ds_read_b128 v[48:51], v1 offset:14336
s_add_u32 m0, s25, 8192
s_add_u32 s20, s20, s38
buffer_load_dwordx4 v7, s[4:7], s20 offen sc1 lds
s_waitcnt lgkmcnt(1)
ds_read_b128 v[52:55], v1 offset:15360
v_mfma_f32_32x32x16_bf16 v[32:47], a[40:43], v[56:59], v[32:47]
ds_read_b128 v[56:59], v1 offset:16384
v_mfma_f32_32x32x16_bf16 v[32:47], a[44:47], v[60:63], v[32:47]
s_waitcnt lgkmcnt(2)
ds_read_b128 v[60:63], v1 offset:17408
v_mfma_f32_32x32x16_bf16 v[32:47], a[48:51], v[48:51], v[32:47]
ds_read_b128 v[48:51], v1 offset:18432
s_waitcnt lgkmcnt(2)
v_mfma_f32_32x32x16_bf16 v[32:47], a[52:55], v[52:55], v[32:47]
ds_read_b128 v[52:55], v1 offset:19456
s_add_u32 m0, s25, 9216
s_add_u32 s20, s20, s38
buffer_load_dwordx4 v7, s[4:7], s20 offen sc1 lds
s_waitcnt lgkmcnt(2)
v_mfma_f32_32x32x16_bf16 v[32:47], a[56:59], v[56:59], v[32:47]
v_mfma_f32_32x32x16_bf16 v[32:47], a[60:63], v[60:63], v[32:47]
ds_read_b128 v[60:63], v1 offset:21504
ds_read_b128 v[56:59], v1 offset:20480
s_waitcnt lgkmcnt(3)
v_mov_b32 v3, s23
v_mfma_f32_32x32x16_bf16 v[32:47], a[64:67], v[48:51], v[32:47]
s_waitcnt lgkmcnt(2)
s_add_u32 m0, s25, 10240
s_add_u32 s20, s20, s38
buffer_load_dwordx4 v7, s[4:7], s20 offen sc1 lds
ds_read_b128 v[48:51], v1 offset:22528
v_mfma_f32_32x32x16_bf16 v[32:47], a[68:71], v[52:55], v[32:47]
ds_read_b128 v[52:55], v1 offset:23552
s_waitcnt lgkmcnt(2)
v_mfma_f32_32x32x16_bf16 v[32:47], a[72:75], v[56:59], v[32:47]
v_mfma_f32_32x32x16_bf16 v[32:47], a[76:79], v[60:63], v[32:47]
s_waitcnt lgkmcnt(0)
ds_read_b128 v[56:59], v1 offset:24576
v_mfma_f32_32x32x16_bf16 v[32:47], a[80:83], v[48:51], v[32:47]
ds_read_b128 v[60:63], v1 offset:25600
s_add_u32 m0, s25, 11264
s_add_u32 s20, s20, s38
buffer_load_dwordx4 v7, s[4:7], s20 offen sc1 lds
v_mfma_f32_32x32x16_bf16 v[32:47], a[84:87], v[52:55], v[32:47]
ds_read_b128 v[48:51], v1 offset:26624
s_waitcnt lgkmcnt(2)
ds_read_b128 v[52:55], v1 offset:27648
v_mfma_f32_32x32x16_bf16 v[32:47], a[88:91], v[56:59], v[32:47]
s_waitcnt lgkmcnt(2)
ds_read_b128 v[56:59], v1 offset:28672
s_add_u32 m0, s35, s37
s_add_u32 s20, s36, s37
buffer_load_dwordx4 v0, s[4:7], s20 offen sc1 lds
v_mfma_f32_32x32x16_bf16 v[32:47], a[92:95], v[60:63], v[32:47]
ds_read_b128 v[60:63], v1 offset:29696
s_waitcnt lgkmcnt(3)
v_mfma_f32_32x32x16_bf16 v[32:47], a[96:99], v[48:51], v[32:47]
s_waitcnt lgkmcnt(1)
ds_read_b128 v[48:51], v1 offset:30720
s_add_u32 m0, s35, 4096
s_add_u32 s20, s36, 4096
buffer_load_dwordx4 v0, s[4:7], s20 offen sc1 lds
v_mfma_f32_32x32x16_bf16 v[32:47], a[100:103], v[52:55], v[32:47]
ds_read_b128 v[52:55], v1 offset:31744
v_mfma_f32_32x32x16_bf16 v[32:47], a[104:107], v[56:59], v[32:47]
s_waitcnt lgkmcnt(2)
s_waitcnt lgkmcnt(1)
v_mfma_f32_32x32x16_bf16 v[32:47], a[108:111], v[60:63], v[32:47]
ds_read_b128 v[56:59], v1 offset:32768
ds_read_b128 v[60:63], v1 offset:33792
v_mfma_f32_32x32x16_bf16 v[32:47], a[112:115], v[48:51], v[32:47]
ds_read_b128 v[48:51], v1 offset:34816
s_waitcnt lgkmcnt(3)
v_mfma_f32_32x32x16_bf16 v[32:47], a[116:119], v[52:55], v[32:47]
s_waitcnt vmcnt(12)
s_barrier
ds_read_b128 v[52:55], v1 offset:35840
s_waitcnt lgkmcnt(3)
v_mfma_f32_32x32x16_bf16 v[32:47], a[120:123], v[56:59], v[32:47]
s_mov_b64 exec, 1
buffer_store_dword v3, off, s[4:7], s22 sc1
s_mov_b64 exec, -1
s_waitcnt lgkmcnt(1)
v_mfma_f32_32x32x16_bf16 v[32:47], a[124:127], v[60:63], v[32:47]
ds_read_b128 v[56:59], v1 offset:36864
s_waitcnt lgkmcnt(1)
ds_read_b128 v[60:63], v1 offset:37888
v_mfma_f32_32x32x16_bf16 v[32:47], a[128:131], v[48:51], v[32:47]
v_mfma_f32_32x32x16_bf16 v[32:47], a[132:135], v[52:55], v[32:47]
s_waitcnt lgkmcnt(1)
ds_read_b128 v[52:55], v1 offset:39936
ds_read_b128 v[48:51], v1 offset:38912
v_mfma_f32_32x32x16_bf16 v[32:47], a[136:139], v[56:59], v[32:47]
s_waitcnt lgkmcnt(2)
v_mfma_f32_32x32x16_bf16 v[32:47], a[140:143], v[60:63], v[32:47]
ds_read_b128 v[56:59], v1 offset:40960
ds_read_b128 v[60:63], v1 offset:41984
s_waitcnt lgkmcnt(2)
v_mfma_f32_32x32x16_bf16 v[32:47], a[144:147], v[48:51], v[32:47]
v_mfma_f32_32x32x16_bf16 v[32:47], a[148:151], v[52:55], v[32:47]
s_waitcnt lgkmcnt(1)
v_mfma_f32_32x32x16_bf16 v[32:47], a[152:155], v[56:59], v[32:47]
s_waitcnt lgkmcnt(0)
v_mfma_f32_32x32x16_bf16 v[32:47], a[156:159], v[60:63], v[32:47]
s_nop 11
v_cvt_pk_bf16_f32 v49, v34, v35
v_cvt_pk_bf16_f32 v48, v32, v33
v_cvt_pk_bf16_f32 v53, v42, v43
v_cvt_pk_bf16_f32 v51, v38, v39
v_cvt_pk_bf16_f32 v54, v44, v45
v_cvt_pk_bf16_f32 v50, v36, v37
v_cvt_pk_bf16_f32 v52, v40, v41
v_cvt_pk_bf16_f32 v55, v46, v47
buffer_store_dwordx4 v[48:51], v5, s[4:7], s50 offen offset:0 sc1
buffer_store_dwordx4 v[52:55], v5, s[4:7], s50 offen offset:512 sc1
s_add_u32 s39, s39, 1
s_add_u32 s50, s50, 524288
s_add_u32 s18, s51, 8192
s_cmp_eq_u32 s13, 0
s_cselect_b32 s22, s18, s6
s_mov_b32 s23, s39
s_cmp_lt_u32 s28, 64
s_cbranch_scc1 kvx_8
s_and_b32 s18, s39, 15
s_cbranch_scc0 kvt_14
s_waitcnt vmcnt(0)
s_barrier
v_mov_b32 v3, s23
s_mov_b64 exec, 1
buffer_store_dword v3, off, s[4:7], s22 sc1
s_mov_b64 exec, -1
s_mov_b32 s22, s6
s_lshl_b32 s18, s39, 2
s_add_u32 s18, s18, 4
s_cmp_lg_u32 s13, 0
s_cbranch_scc1 polld_20
v_lshlrev_b32 v27, 3, v0
v_min_u32 v27, 1152, v27
s_mov_b32 s21, 11550720
s_mov_b32 s17, 0
poll_19:
buffer_load_dword v24, v27, s[4:7], s21 offen sc1
s_add_u32 s17, s17, 1
s_cmp_gt_u32 s17, 262144
s_cbranch_scc1 L_fail
s_waitcnt vmcnt(0)
v_cmp_gt_u32 vcc, s18, v24
s_cbranch_vccz polld_20
s_sleep 2
s_branch poll_19
polld_20:
s_barrier
s_mov_b32 s53, s52
s_mov_b32 s36, s6
s_mov_b32 s38, 256
v_mov_b32 v7, v6
s_add_u32 s52, s52, 40960
s_add_u32 m0, s25, 2048
s_mov_b32 s20, s53
buffer_load_dwordx4 v7, s[4:7], s20 offen sc1 lds
s_add_u32 m0, s25, 3072
s_add_u32 s20, s20, s38
buffer_load_dwordx4 v7, s[4:7], s20 offen sc1 lds
s_add_u32 m0, s25, 4096
s_add_u32 s20, s20, s38
buffer_load_dwordx4 v7, s[4:7], s20 offen sc1 lds
s_add_u32 m0, s25, 5120
s_add_u32 s20, s20, s38
buffer_load_dwordx4 v7, s[4:7], s20 offen sc1 lds
s_add_u32 m0, s25, 6144
s_add_u32 s20, s20, s38
buffer_load_dwordx4 v7, s[4:7], s20 offen sc1 lds
s_add_u32 m0, s25, 7168
s_add_u32 s20, s20, s38
buffer_load_dwordx4 v7, s[4:7], s20 offen sc1 lds
s_add_u32 m0, s25, 8192
s_add_u32 s20, s20, s38
buffer_load_dwordx4 v7, s[4:7], s20 offen sc1 lds
s_add_u32 m0, s25, 9216
s_add_u32 s20, s20, s38
buffer_load_dwordx4 v7, s[4:7], s20 offen sc1 lds
s_add_u32 m0, s25, 10240
s_add_u32 s20, s20, s38
buffer_load_dwordx4 v7, s[4:7], s20 offen sc1 lds
s_add_u32 m0, s25, 11264
s_add_u32 s20, s20, s38
buffer_load_dwordx4 v7, s[4:7], s20 offen sc1 lds
s_waitcnt vmcnt(0)
s_branch kvm_13
kv_12:
s_lshl_b32 s18, s39, 2
s_add_u32 s18, s18, 4
s_cmp_lg_u32 s13, 0
s_cbranch_scc1 polld_22
v_lshlrev_b32 v27, 3, v0
v_min_u32 v27, 1152, v27
s_mov_b32 s21, 11550720
s_mov_b32 s17, 0
poll_21:
buffer_load_dword v24, v27, s[4:7], s21 offen sc1
s_add_u32 s17, s17, 1
s_cmp_gt_u32 s17, 262144
s_cbranch_scc1 L_fail
s_waitcnt vmcnt(0)
v_cmp_gt_u32 vcc, s18, v24
s_cbranch_vccz polld_22
s_sleep 2
s_branch poll_21
polld_22:
s_barrier
s_mov_b32 s53, s52
s_mov_b32 s36, s6
s_mov_b32 s38, 256
v_mov_b32 v7, v6
s_add_u32 s52, s52, 40960
s_branch kvn_9
kvt_14:
s_waitcnt vmcnt(0)
s_barrier
v_mov_b32 v3, s23
s_mov_b64 exec, 1
buffer_store_dword v3, off, s[4:7], s22 sc1
s_mov_b64 exec, -1
s_mov_b32 s22, s6
s_add_u32 s16, s16, 1
s_cmp_lt_u32 s16, 2
s_cbranch_scc1 kvlay_7
s_endpgm
roleV_5:
s_lshl_b32 s26, s32, 8
s_lshl_b32 s18, s13, 6
s_add_u32 s26, s26, s18
s_load_dwordx2 s[40:41], s[0:1], 56
s_mov_b32 s42, 5242880
s_mov_b32 s43, 0x20000
s_waitcnt lgkmcnt(0)
v_lshrrev_b32 v20, 6, v0
v_mul_u32_u24 v20, 8192, v20
v_and_b32 v21, 48, v0
v_add_u32 v18, v20, v21
v_bfe_u32 v20, v0, 6, 2
v_lshrrev_b32 v21, 9, v0
v_lshl_add_u32 v20, v21, 3, v20
v_lshlrev_b32 v19, 6, v20
v_and_b32 v20, 48, v0
v_add_u32 v19, v19, v20
v_bfe_u32 v20, v0, 8, 1
v_lshl_add_u32 v19, v20, 3, v19
s_mul_i32 s18, s13, 36864
v_add_u32 v19, s18, v19
s_barrier
s_add_u32 m0, s18, 0
s_add_u32 s19, s26, 0
buffer_load_dwordx4 v18, s[40:43], s19 offen lds
s_add_u32 m0, s18, 1024
s_add_u32 s19, s26, 131072
buffer_load_dwordx4 v18, s[40:43], s19 offen lds
s_add_u32 m0, s18, 2048
s_add_u32 s19, s26, 262144
buffer_load_dwordx4 v18, s[40:43], s19 offen lds
s_add_u32 m0, s18, 3072
s_add_u32 s19, s26, 393216
buffer_load_dwordx4 v18, s[40:43], s19 offen lds
s_add_u32 m0, s18, 4096
s_add_u32 s19, s26, 524288
buffer_load_dwordx4 v18, s[40:43], s19 offen lds
s_add_u32 m0, s18, 5120
s_add_u32 s19, s26, 655360
buffer_load_dwordx4 v18, s[40:43], s19 offen lds
s_add_u32 m0, s18, 6144
s_add_u32 s19, s26, 786432
buffer_load_dwordx4 v18, s[40:43], s19 offen lds
s_add_u32 m0, s18, 7168
s_add_u32 s19, s26, 917504
buffer_load_dwordx4 v18, s[40:43], s19 offen lds
s_add_u32 m0, s18, 8192
s_add_u32 s19, s26, 1048576
buffer_load_dwordx4 v18, s[40:43], s19 offen lds
s_add_u32 m0, s18, 9216
s_add_u32 s19, s26, 1179648
buffer_load_dwordx4 v18, s[40:43], s19 offen lds
s_add_u32 m0, s18, 10240
s_add_u32 s19, s26, 1310720
buffer_load_dwordx4 v18, s[40:43], s19 offen lds
s_add_u32 m0, s18, 11264
s_add_u32 s19, s26, 1441792
buffer_load_dwordx4 v18, s[40:43], s19 offen lds
s_add_u32 m0, s18, 12288
s_add_u32 s19, s26, 1572864
buffer_load_dwordx4 v18, s[40:43], s19 offen lds
s_add_u32 m0, s18, 13312
s_add_u32 s19, s26, 1703936
buffer_load_dwordx4 v18, s[40:43], s19 offen lds
s_add_u32 m0, s18, 14336
s_add_u32 s19, s26, 1835008
buffer_load_dwordx4 v18, s[40:43], s19 offen lds
s_add_u32 m0, s18, 15360
s_add_u32 s19, s26, 1966080
buffer_load_dwordx4 v18, s[40:43], s19 offen lds
s_add_u32 m0, s18, 16384
s_add_u32 s19, s26, 2097152
buffer_load_dwordx4 v18, s[40:43], s19 offen lds
s_add_u32 m0, s18, 17408
s_add_u32 s19, s26, 2228224
buffer_load_dwordx4 v18, s[40:43], s19 offen lds
s_add_u32 m0, s18, 18432
s_add_u32 s19, s26, 2359296
buffer_load_dwordx4 v18, s[40:43], s19 offen lds
s_add_u32 m0, s18, 19456
s_add_u32 s19, s26, 2490368
buffer_load_dwordx4 v18, s[40:43], s19 offen lds
s_add_u32 m0, s18, 20480
s_add_u32 s19, s26, 2621440
buffer_load_dwordx4 v18, s[40:43], s19 offen lds
s_add_u32 m0, s18, 21504
s_add_u32 s19, s26, 2752512
buffer_load_dwordx4 v18, s[40:43], s19 offen lds
s_add_u32 m0, s18, 22528
s_add_u32 s19, s26, 2883584
buffer_load_dwordx4 v18, s[40:43], s19 offen lds
s_add_u32 m0, s18, 23552
s_add_u32 s19, s26, 3014656
buffer_load_dwordx4 v18, s[40:43], s19 offen lds
s_add_u32 m0, s18, 24576
s_add_u32 s19, s26, 3145728
buffer_load_dwordx4 v18, s[40:43], s19 offen lds
s_add_u32 m0, s18, 25600
s_add_u32 s19, s26, 3276800
buffer_load_dwordx4 v18, s[40:43], s19 offen lds
s_add_u32 m0, s18, 26624
s_add_u32 s19, s26, 3407872
buffer_load_dwordx4 v18, s[40:43], s19 offen lds
s_add_u32 m0, s18, 27648
s_add_u32 s19, s26, 3538944
buffer_load_dwordx4 v18, s[40:43], s19 offen lds
s_add_u32 m0, s18, 28672
s_add_u32 s19, s26, 3670016
buffer_load_dwordx4 v18, s[40:43], s19 offen lds
s_add_u32 m0, s18, 29696
s_add_u32 s19, s26, 3801088
buffer_load_dwordx4 v18, s[40:43], s19 offen lds
s_add_u32 m0, s18, 30720
s_add_u32 s19, s26, 3932160
buffer_load_dwordx4 v18, s[40:43], s19 offen lds
s_add_u32 m0, s18, 31744
s_add_u32 s19, s26, 4063232
buffer_load_dwordx4 v18, s[40:43], s19 offen lds
s_add_u32 m0, s18, 32768
s_add_u32 s19, s26, 4194304
buffer_load_dwordx4 v18, s[40:43], s19 offen lds
s_add_u32 m0, s18, 33792
s_add_u32 s19, s26, 4325376
buffer_load_dwordx4 v18, s[40:43], s19 offen lds
s_add_u32 m0, s18, 34816
s_add_u32 s19, s26, 4456448
buffer_load_dwordx4 v18, s[40:43], s19 offen lds
s_add_u32 m0, s18, 35840
s_add_u32 s19, s26, 4587520
buffer_load_dwordx4 v18, s[40:43], s19 offen lds
s_waitcnt vmcnt(32)
ds_read_b64_tr_b16 a[0:1], v19 offset:0
ds_read_b64_tr_b16 a[2:3], v19 offset:256
ds_read_b64_tr_b16 a[4:5], v19 offset:1024
ds_read_b64_tr_b16 a[6:7], v19 offset:1280
ds_read_b64_tr_b16 a[8:9], v19 offset:2048
ds_read_b64_tr_b16 a[10:11], v19 offset:2304
ds_read_b64_tr_b16 a[12:13], v19 offset:3072
ds_read_b64_tr_b16 a[14:15], v19 offset:3328
s_waitcnt lgkmcnt(0)
s_add_u32 m0, s18, 0
s_add_u32 s19, s26, 4718592
buffer_load_dwordx4 v18, s[40:43], s19 offen lds
s_add_u32 m0, s18, 1024
s_add_u32 s19, s26, 4849664
buffer_load_dwordx4 v18, s[40:43], s19 offen lds
s_add_u32 m0, s18, 2048
s_add_u32 s19, s26, 4980736
buffer_load_dwordx4 v18, s[40:43], s19 offen lds
s_add_u32 m0, s18, 3072
s_add_u32 s19, s26, 5111808
buffer_load_dwordx4 v18, s[40:43], s19 offen lds
s_waitcnt vmcnt(32)
ds_read_b64_tr_b16 a[16:17], v19 offset:4096
ds_read_b64_tr_b16 a[18:19], v19 offset:4352
ds_read_b64_tr_b16 a[20:21], v19 offset:5120
ds_read_b64_tr_b16 a[22:23], v19 offset:5376
ds_read_b64_tr_b16 a[24:25], v19 offset:6144
ds_read_b64_tr_b16 a[26:27], v19 offset:6400
ds_read_b64_tr_b16 a[28:29], v19 offset:7168
ds_read_b64_tr_b16 a[30:31], v19 offset:7424
s_waitcnt vmcnt(28)
ds_read_b64_tr_b16 a[32:33], v19 offset:8192
ds_read_b64_tr_b16 a[34:35], v19 offset:8448
ds_read_b64_tr_b16 a[36:37], v19 offset:9216
ds_read_b64_tr_b16 a[38:39], v19 offset:9472
ds_read_b64_tr_b16 a[40:41], v19 offset:10240
ds_read_b64_tr_b16 a[42:43], v19 offset:10496
ds_read_b64_tr_b16 a[44:45], v19 offset:11264
ds_read_b64_tr_b16 a[46:47], v19 offset:11520
s_waitcnt vmcnt(24)
ds_read_b64_tr_b16 a[48:49], v19 offset:12288
ds_read_b64_tr_b16 a[50:51], v19 offset:12544
ds_read_b64_tr_b16 a[52:53], v19 offset:13312
ds_read_b64_tr_b16 a[54:55], v19 offset:13568
ds_read_b64_tr_b16 a[56:57], v19 offset:14336
ds_read_b64_tr_b16 a[58:59], v19 offset:14592
ds_read_b64_tr_b16 a[60:61], v19 offset:15360
ds_read_b64_tr_b16 a[62:63], v19 offset:15616
s_waitcnt vmcnt(20)
ds_read_b64_tr_b16 a[64:65], v19 offset:16384
ds_read_b64_tr_b16 a[66:67], v19 offset:16640
ds_read_b64_tr_b16 a[68:69], v19 offset:17408
ds_read_b64_tr_b16 a[70:71], v19 offset:17664
ds_read_b64_tr_b16 a[72:73], v19 offset:18432
ds_read_b64_tr_b16 a[74:75], v19 offset:18688
ds_read_b64_tr_b16 a[76:77], v19 offset:19456
ds_read_b64_tr_b16 a[78:79], v19 offset:19712
s_waitcnt vmcnt(16)
ds_read_b64_tr_b16 a[80:81], v19 offset:20480
ds_read_b64_tr_b16 a[82:83], v19 offset:20736
ds_read_b64_tr_b16 a[84:85], v19 offset:21504
ds_read_b64_tr_b16 a[86:87], v19 offset:21760
ds_read_b64_tr_b16 a[88:89], v19 offset:22528
ds_read_b64_tr_b16 a[90:91], v19 offset:22784
ds_read_b64_tr_b16 a[92:93], v19 offset:23552
ds_read_b64_tr_b16 a[94:95], v19 offset:23808
s_waitcnt vmcnt(12)
ds_read_b64_tr_b16 a[96:97], v19 offset:24576
ds_read_b64_tr_b16 a[98:99], v19 offset:24832
ds_read_b64_tr_b16 a[100:101], v19 offset:25600
ds_read_b64_tr_b16 a[102:103], v19 offset:25856
ds_read_b64_tr_b16 a[104:105], v19 offset:26624
ds_read_b64_tr_b16 a[106:107], v19 offset:26880
ds_read_b64_tr_b16 a[108:109], v19 offset:27648
ds_read_b64_tr_b16 a[110:111], v19 offset:27904
s_waitcnt vmcnt(8)
ds_read_b64_tr_b16 a[112:113], v19 offset:28672
ds_read_b64_tr_b16 a[114:115], v19 offset:28928
ds_read_b64_tr_b16 a[116:117], v19 offset:29696
ds_read_b64_tr_b16 a[118:119], v19 offset:29952
ds_read_b64_tr_b16 a[120:121], v19 offset:30720
ds_read_b64_tr_b16 a[122:123], v19 offset:30976
ds_read_b64_tr_b16 a[124:125], v19 offset:31744
ds_read_b64_tr_b16 a[126:127], v19 offset:32000
s_waitcnt vmcnt(4)
ds_read_b64_tr_b16 a[128:129], v19 offset:32768
ds_read_b64_tr_b16 a[130:131], v19 offset:33024
ds_read_b64_tr_b16 a[132:133], v19 offset:33792
ds_read_b64_tr_b16 a[134:135], v19 offset:34048
ds_read_b64_tr_b16 a[136:137], v19 offset:34816
ds_read_b64_tr_b16 a[138:139], v19 offset:35072
ds_read_b64_tr_b16 a[140:141], v19 offset:35840
ds_read_b64_tr_b16 a[142:143], v19 offset:36096
s_waitcnt vmcnt(0)
ds_read_b64_tr_b16 a[144:145], v19 offset:0
ds_read_b64_tr_b16 a[146:147], v19 offset:256
ds_read_b64_tr_b16 a[148:149], v19 offset:1024
ds_read_b64_tr_b16 a[150:151], v19 offset:1280
ds_read_b64_tr_b16 a[152:153], v19 offset:2048
ds_read_b64_tr_b16 a[154:155], v19 offset:2304
ds_read_b64_tr_b16 a[156:157], v19 offset:3072
ds_read_b64_tr_b16 a[158:159], v19 offset:3328
s_waitcnt lgkmcnt(0)
s_barrier
s_load_dwordx2 s[40:41], s[0:1], 64
s_mov_b32 s42, 5242880
s_mov_b32 s43, 0x20000
s_waitcnt lgkmcnt(0)
v_lshlrev_b32 v6, 3, v0
s_mul_i32 s18, s32, 163840
s_mul_i32 s19, s13, 40960
s_add_u32 s18, s18, s19
buffer_load_dword v12, v6, s[40:43], s18 offen
s_add_u32 s18, s18, 8192
buffer_load_dword v13, v6, s[40:43], s18 offen
s_add_u32 s18, s18, 8192
buffer_load_dword v14, v6, s[40:43], s18 offen
s_add_u32 s18, s18, 8192
buffer_load_dword v15, v6, s[40:43], s18 offen
s_add_u32 s18, s18, 8192
buffer_load_dword v16, v6, s[40:43], s18 offen
s_add_u32 s18, s18, 8192
v_mov_b32 v20, s24
v_mov_b32 v21, s24
v_mov_b32 v22, s24
v_mov_b32 v23, s24
s_nop 1
v_mfma_f32_32x32x16_bf16 v[24:39], v[20:23], a[0:3], 0
v_mfma_f32_32x32x16_bf16 v[24:39], v[20:23], a[4:7], v[24:39]
v_mfma_f32_32x32x16_bf16 v[24:39], v[20:23], a[8:11], v[24:39]
v_mfma_f32_32x32x16_bf16 v[24:39], v[20:23], a[12:15], v[24:39]
v_mfma_f32_32x32x16_bf16 v[24:39], v[20:23], a[16:19], v[24:39]
v_mfma_f32_32x32x16_bf16 v[24:39], v[20:23], a[20:23], v[24:39]
v_mfma_f32_32x32x16_bf16 v[24:39], v[20:23], a[24:27], v[24:39]
v_mfma_f32_32x32x16_bf16 v[24:39], v[20:23], a[28:31], v[24:39]
v_mfma_f32_32x32x16_bf16 v[24:39], v[20:23], a[32:35], v[24:39]
v_mfma_f32_32x32x16_bf16 v[24:39], v[20:23], a[36:39], v[24:39]
v_mfma_f32_32x32x16_bf16 v[24:39], v[20:23], a[40:43], v[24:39]
v_mfma_f32_32x32x16_bf16 v[24:39], v[20:23], a[44:47], v[24:39]
v_mfma_f32_32x32x16_bf16 v[24:39], v[20:23], a[48:51], v[24:39]
v_mfma_f32_32x32x16_bf16 v[24:39], v[20:23], a[52:55], v[24:39]
v_mfma_f32_32x32x16_bf16 v[24:39], v[20:23], a[56:59], v[24:39]
v_mfma_f32_32x32x16_bf16 v[24:39], v[20:23], a[60:63], v[24:39]
v_mfma_f32_32x32x16_bf16 v[24:39], v[20:23], a[64:67], v[24:39]
v_mfma_f32_32x32x16_bf16 v[24:39], v[20:23], a[68:71], v[24:39]
v_mfma_f32_32x32x16_bf16 v[24:39], v[20:23], a[72:75], v[24:39]
v_mfma_f32_32x32x16_bf16 v[24:39], v[20:23], a[76:79], v[24:39]
v_mfma_f32_32x32x16_bf16 v[24:39], v[20:23], a[80:83], v[24:39]
v_mfma_f32_32x32x16_bf16 v[24:39], v[20:23], a[84:87], v[24:39]
v_mfma_f32_32x32x16_bf16 v[24:39], v[20:23], a[88:91], v[24:39]
v_mfma_f32_32x32x16_bf16 v[24:39], v[20:23], a[92:95], v[24:39]
v_mfma_f32_32x32x16_bf16 v[24:39], v[20:23], a[96:99], v[24:39]
v_mfma_f32_32x32x16_bf16 v[24:39], v[20:23], a[100:103], v[24:39]
v_mfma_f32_32x32x16_bf16 v[24:39], v[20:23], a[104:107], v[24:39]
v_mfma_f32_32x32x16_bf16 v[24:39], v[20:23], a[108:111], v[24:39]
v_mfma_f32_32x32x16_bf16 v[24:39], v[20:23], a[112:115], v[24:39]
v_mfma_f32_32x32x16_bf16 v[24:39], v[20:23], a[116:119], v[24:39]
v_mfma_f32_32x32x16_bf16 v[24:39], v[20:23], a[120:123], v[24:39]
v_mfma_f32_32x32x16_bf16 v[24:39], v[20:23], a[124:127], v[24:39]
v_mfma_f32_32x32x16_bf16 v[24:39], v[20:23], a[128:131], v[24:39]
v_mfma_f32_32x32x16_bf16 v[24:39], v[20:23], a[132:135], v[24:39]
v_mfma_f32_32x32x16_bf16 v[24:39], v[20:23], a[136:139], v[24:39]
v_mfma_f32_32x32x16_bf16 v[24:39], v[20:23], a[140:143], v[24:39]
v_mfma_f32_32x32x16_bf16 v[24:39], v[20:23], a[144:147], v[24:39]
v_mfma_f32_32x32x16_bf16 v[24:39], v[20:23], a[148:151], v[24:39]
v_mfma_f32_32x32x16_bf16 v[24:39], v[20:23], a[152:155], v[24:39]
v_mfma_f32_32x32x16_bf16 v[24:39], v[20:23], a[156:159], v[24:39]
s_nop 11
v_mov_b32 v5, v24
v_and_b32 v6, 0xf0, v0
s_waitcnt vmcnt(4)
v_bfe_u32 v12, v0, 8, 1
v_lshl_add_u32 v6, v12, 10, v6
v_lshrrev_b32 v12, 9, v0
v_lshl_add_u32 v6, v12, 8, v6
s_lshl_b32 s34, s13, 12
s_add_u32 s34, s34, 2048
s_lshl_b32 s18, s32, 14
s_add_u32 s34, s34, s18
v_bfe_u32 v7, v0, 7, 2
v_mul_u32_u24 v7, 10240, v7
v_bfe_u32 v12, v0, 5, 2
v_lshl_add_u32 v7, v12, 6, v7
v_lshrrev_b32 v12, 9, v0
v_lshl_add_u32 v7, v12, 5, v7
v_and_b32 v12, 16, v0
v_add_u32 v7, v12, v7
s_lshl_b32 s51, s32, 8
s_add_u32 s51, s51, 11534464
s_mul_i32 s52, s13, 2560
s_add_u32 s52, s52, 12582912
s_add_u32 s50, s34, 110100480
s_mov_b32 s39, 0
kvlay_23:
s_mul_i32 s26, s16, 6291456
s_add_u32 s26, s26, 88080384
s_add_u32 s26, s26, s31
s_mul_i32 s54, s16, 327680
s_add_u32 s54, s54, 163577856
s_mul_i32 s27, s16, 35651584
s_add_u32 s27, s27, 16777216
s_mul_i32 s18, s32, 0
s_add_u32 s27, s27, s18
s_add_u32 s27, s27, s34
s_lshl_b32 s29, s16, 1
s_add_u32 s29, s29, 1
s_mov_b32 s28, 0
s_mov_b32 s30, 0
s_cmp_lt_u32 s30, 64
s_cselect_b32 s53, s26, s6
s_cselect_b32 s36, s54, s6
s_mov_b32 s38, 1024
v_mov_b32 v8, v0
s_add_u32 s26, s26, 40960
s_add_u32 s54, s54, 5120
s_add_u32 s30, s30, 1
v_xor_b32 v1, 40960, v0
s_mov_b32 s25, s31
s_mov_b32 s35, 131072
s_cmp_lg_u32 s13, 0
s_cbranch_scc1 polld_32
s_waitcnt vmcnt(1)
v_lshlrev_b32 v15, 3, v0
v_min_u32 v15, 1152, v15
s_mov_b32 s21, 11612160
s_mov_b32 s17, 0
poll_31:
buffer_load_dword v12, v15, s[4:7], s21 offen sc1
s_add_u32 s17, s17, 1
s_cmp_gt_u32 s17, 262144
s_cbranch_scc1 L_fail
s_waitcnt vmcnt(0)
v_cmp_gt_u32 vcc, s29, v12
s_cbranch_vccz polld_32
s_sleep 2
s_branch poll_31
polld_32:
s_barrier
s_add_u32 m0, s25, 2048
s_mov_b32 s20, s53
buffer_load_dwordx4 v8, s[4:7], s20 offen sc1 lds
s_add_u32 m0, s25, 3072
s_add_u32 s20, s20, s38
buffer_load_dwordx4 v8, s[4:7], s20 offen sc1 lds
s_add_u32 m0, s25, 4096
s_add_u32 s20, s20, s38
buffer_load_dwordx4 v8, s[4:7], s20 offen sc1 lds
s_add_u32 m0, s25, 5120
s_add_u32 s20, s20, s38
buffer_load_dwordx4 v8, s[4:7], s20 offen sc1 lds
s_add_u32 m0, s25, 6144
s_add_u32 s20, s20, s38
buffer_load_dwordx4 v8, s[4:7], s20 offen sc1 lds
s_add_u32 m0, s25, 7168
s_add_u32 s20, s20, s38
buffer_load_dwordx4 v8, s[4:7], s20 offen sc1 lds
s_add_u32 m0, s25, 8192
s_add_u32 s20, s20, s38
buffer_load_dwordx4 v8, s[4:7], s20 offen sc1 lds
s_add_u32 m0, s25, 9216
s_add_u32 s20, s20, s38
buffer_load_dwordx4 v8, s[4:7], s20 offen sc1 lds
s_add_u32 m0, s25, 10240
s_add_u32 s20, s20, s38
buffer_load_dwordx4 v8, s[4:7], s20 offen sc1 lds
s_add_u32 m0, s25, 11264
s_add_u32 s20, s20, s38
buffer_load_dwordx4 v8, s[4:7], s20 offen sc1 lds
s_add_u32 m0, s35, s37
s_add_u32 s20, s36, s37
buffer_load_dwordx4 v0, s[4:7], s20 offen sc1 lds
s_add_u32 m0, s35, 4096
s_add_u32 s20, s36, 4096
buffer_load_dwordx4 v0, s[4:7], s20 offen sc1 lds
s_waitcnt vmcnt(0)
kvx_24:
v_xor_b32 v1, 40960, v1
s_sub_u32 s25, s25, s31
s_xor_b32 s25, s25, 40960
s_add_u32 s25, s25, s31
s_xor_b32 s35, s35, 8192
s_cmp_eq_u32 s28, 1
s_cbranch_scc1 kv_26
s_cmp_eq_u32 s28, 30
s_cbranch_scc0 kv_27
s_add_u32 s29, s29, 1
kv_26:
s_waitcnt vmcnt(0)
s_barrier
v_mov_b32 v3, s23
s_mov_b64 exec, 1
buffer_store_dword v3, off, s[4:7], s22 sc1
s_mov_b64 exec, -1
s_mov_b32 s22, s6
s_cmp_lg_u32 s13, 0
s_cbranch_scc1 polld_34
v_lshlrev_b32 v15, 3, v0
v_add_u32 v16, 8192, v15
v_add_u32 v3, 16384, v15
v_min_u32 v3, 20352, v3
s_mov_b32 s21, 11612160
s_mov_b32 s17, 0
poll_33:
buffer_load_dword v12, v15, s[4:7], s21 offen sc1
buffer_load_dword v13, v16, s[4:7], s21 offen sc1
buffer_load_dword v14, v3, s[4:7], s21 offen sc1
s_add_u32 s17, s17, 1
s_cmp_gt_u32 s17, 262144
s_cbranch_scc1 L_fail
s_waitcnt vmcnt(0)
v_min3_u32 v12, v12, v13, v14
v_cmp_gt_u32 vcc, s29, v12
s_cbranch_vccz polld_34
s_sleep 2
s_branch poll_33
polld_34:
s_barrier
kv_27:
s_add_u32 s28, s28, 1
s_and_b32 s33, s28, 3
s_cmp_lt_u32 s28, 12
s_cselect_b32 s33, 1, s33
s_cmp_eq_u32 s33, 0
s_cbranch_scc1 kv_28
s_cmp_lt_u32 s30, 64
s_cselect_b32 s53, s26, s6
s_cselect_b32 s36, s54, s6
s_mov_b32 s38, 1024
v_mov_b32 v8, v0
s_add_u32 s26, s26, 40960
s_add_u32 s54, s54, 5120
s_add_u32 s30, s30, 1
kvn_25:
s_waitcnt vmcnt(3)
s_barrier
ds_read_b128 v[36:39], v1 offset:2048
s_add_u32 m0, s25, 2048
s_mov_b32 s20, s53
buffer_load_dwordx4 v8, s[4:7], s20 offen sc1 lds
ds_read_b128 v[40:43], v1 offset:3072
s_xor_b32 s18, s35, 8192
v_lshrrev_b32 v2, 2, v0
v_add_u32 v2, s18, v2
ds_read_b128 v[48:51], v1 offset:5120
s_add_u32 m0, s25, 3072
s_add_u32 s20, s20, s38
buffer_load_dwordx4 v8, s[4:7], s20 offen sc1 lds
ds_read_b128 v[44:47], v1 offset:4096
s_waitcnt lgkmcnt(3)
v_mfma_f32_32x32x16_bf16 v[20:35], v[36:39], a[0:3], 0
ds_read2st64_b32 v[62:63], v2 offset0:6 offset1:7
s_waitcnt lgkmcnt(3)
ds_read2st64_b32 v[72:73], v2 offset0:16 offset1:17
ds_read2st64_b32 v[74:75], v2 offset0:18 offset1:19
ds_read_b128 v[36:39], v1 offset:6144
v_mfma_f32_32x32x16_bf16 v[20:35], v[40:43], a[4:7], v[20:35]
s_add_u32 m0, s25, 4096
s_add_u32 s20, s20, s38
buffer_load_dwordx4 v8, s[4:7], s20 offen sc1 lds
ds_read2st64_b32 v[54:55], v2 offset0:2 offset1:3
s_waitcnt lgkmcnt(5)
ds_read2st64_b32 v[52:53], v2 offset0:0 offset1:1
v_mfma_f32_32x32x16_bf16 v[20:35], v[44:47], a[8:11], v[20:35]
ds_read_b128 v[40:43], v1 offset:7168
ds_read2st64_b32 v[60:61], v2 offset0:4 offset1:5
ds_read2st64_b32 v[66:67], v2 offset0:10 offset1:11
s_add_u32 m0, s25, 5120
s_add_u32 s20, s20, s38
buffer_load_dwordx4 v8, s[4:7], s20 offen sc1 lds
v_mfma_f32_32x32x16_bf16 v[20:35], v[48:51], a[12:15], v[20:35]
ds_read_b128 v[48:51], v1 offset:9216
s_waitcnt lgkmcnt(6)
ds_read_b128 v[44:47], v1 offset:8192
s_waitcnt lgkmcnt(5)
ds_read2st64_b32 v[70:71], v2 offset0:14 offset1:15
v_mfma_f32_32x32x16_bf16 v[20:35], v[36:39], a[16:19], v[20:35]
s_add_u32 m0, s25, 6144
s_add_u32 s20, s20, s38
buffer_load_dwordx4 v8, s[4:7], s20 offen sc1 lds
s_waitcnt lgkmcnt(3)
ds_read2st64_b32 v[68:69], v2 offset0:12 offset1:13
v_mfma_f32_32x32x16_bf16 v[20:35], v[40:43], a[20:23], v[20:35]
s_waitcnt lgkmcnt(3)
ds_read_b128 v[36:39], v1 offset:10240
s_waitcnt lgkmcnt(3)
ds_read_b128 v[40:43], v1 offset:11264
v_mfma_f32_32x32x16_bf16 v[20:35], v[44:47], a[24:27], v[20:35]
ds_read_b128 v[44:47], v1 offset:12288
v_add_f32 v52, v52, v54
ds_read2st64_b32 v[64:65], v2 offset0:8 offset1:9
v_mfma_f32_32x32x16_bf16 v[20:35], v[48:51], a[28:31], v[20:35]
s_add_u32 m0, s25, 7168
s_add_u32 s20, s20, s38
buffer_load_dwordx4 v8, s[4:7], s20 offen sc1 lds
v_add_f32 v53, v53, v55
v_add_f32 v52, v52, v60
s_waitcnt lgkmcnt(3)
v_mfma_f32_32x32x16_bf16 v[20:35], v[36:39], a[32:35], v[20:35]
ds_read_b128 v[48:51], v1 offset:13312
s_waitcnt lgkmcnt(3)
s_waitcnt lgkmcnt(2)
ds_read_b128 v[36:39], v1 offset:14336
v_mfma_f32_32x32x16_bf16 v[20:35], v[40:43], a[36:39], v[20:35]
ds_read_b128 v[40:43], v1 offset:15360
s_add_u32 m0, s25, 8192
s_add_u32 s20, s20, s38
buffer_load_dwordx4 v8, s[4:7], s20 offen sc1 lds
v_mfma_f32_32x32x16_bf16 v[20:35], v[44:47], a[40:43], v[20:35]
s_add_u32 m0, s25, 9216
s_add_u32 s20, s20, s38
buffer_load_dwordx4 v8, s[4:7], s20 offen sc1 lds
v_mov_b32 v3, s23
v_add_f32 v53, v53, v61
s_waitcnt lgkmcnt(1)
v_add_f32 v53, v53, v63
v_mfma_f32_32x32x16_bf16 v[20:35], v[48:51], a[44:47], v[20:35]
v_add_f32 v52, v52, v62
v_add_f32 v52, v52, v64
ds_read_b128 v[44:47], v1 offset:16384
v_add_f32 v53, v53, v65
v_mfma_f32_32x32x16_bf16 v[20:35], v[36:39], a[48:51], v[20:35]
s_waitcnt lgkmcnt(1)
ds_read_b128 v[48:51], v1 offset:17408
ds_read_b128 v[36:39], v1 offset:18432
v_bfe_u32 v54, v0, 5, 5
v_add_f32 v53, v53, v67
v_and_b32 v54, 16, v54
v_add_f32 v53, v53, v69
v_mfma_f32_32x32x16_bf16 v[20:35], v[40:43], a[52:55], v[20:35]
v_add_f32 v52, v52, v66
ds_read_b128 v[40:43], v1 offset:19456
s_waitcnt lgkmcnt(3)
v_mfma_f32_32x32x16_bf16 v[20:35], v[44:47], a[56:59], v[20:35]
s_waitcnt lgkmcnt(2)
v_add_f32 v52, v52, v68
s_add_u32 m0, s25, 10240
s_add_u32 s20, s20, s38
buffer_load_dwordx4 v8, s[4:7], s20 offen sc1 lds
v_mfma_f32_32x32x16_bf16 v[20:35], v[48:51], a[60:63], v[20:35]
ds_read_b128 v[44:47], v1 offset:20480
v_add_f32 v53, v53, v71
s_waitcnt lgkmcnt(2)
v_add_f32 v52, v52, v70
v_add_f32 v52, v52, v72
v_add_f32 v53, v53, v73
v_mfma_f32_32x32x16_bf16 v[20:35], v[36:39], a[64:67], v[20:35]
ds_read_b128 v[48:51], v1 offset:21504
v_add_f32 v52, v52, v74
s_waitcnt lgkmcnt(2)
v_mfma_f32_32x32x16_bf16 v[20:35], v[40:43], a[68:71], v[20:35]
ds_read_b128 v[40:43], v1 offset:23552
ds_read_b128 v[36:39], v1 offset:22528
v_add_f32 v53, v53, v75
s_waitcnt lgkmcnt(3)
v_add_f32 v52, v52, v53
v_mfma_f32_32x32x16_bf16 v[20:35], v[44:47], a[72:75], v[20:35]
v_mov_b32 v56, v52
s_nop 1
v_permlane32_swap_b32 v52, v56
s_waitcnt lgkmcnt(2)
v_mfma_f32_32x32x16_bf16 v[20:35], v[48:51], a[76:79], v[20:35]
ds_read_b128 v[44:47], v1 offset:24576
s_waitcnt lgkmcnt(1)
ds_read_b128 v[48:51], v1 offset:25600
v_mfma_f32_32x32x16_bf16 v[20:35], v[36:39], a[80:83], v[20:35]
ds_read_b128 v[36:39], v1 offset:26624
v_mul_f32 v52, 0x3acccccd, v52
v_lshrrev_b32 v53, 2, v0
v_mul_f32 v56, 0x3acccccd, v56
s_add_u32 m0, s25, 11264
s_add_u32 s20, s20, s38
buffer_load_dwordx4 v8, s[4:7], s20 offen sc1 lds
v_mfma_f32_32x32x16_bf16 v[20:35], v[40:43], a[84:87], v[20:35]
s_waitcnt lgkmcnt(2)
ds_read_b128 v[40:43], v1 offset:27648
v_fma_f32 v56, -v52, v52, v56
v_max_f32 v56, 0, v56
s_waitcnt lgkmcnt(2)
v_lshl_add_u32 v53, s13, 8, v53
v_add_f32 v56, 0x3727c5ac, v56
v_mfma_f32_32x32x16_bf16 v[20:35], v[44:47], a[88:91], v[20:35]
ds_read_b128 v[44:47], v1 offset:28672
s_add_u32 m0, s35, s37
s_add_u32 s20, s36, s37
buffer_load_dwordx4 v0, s[4:7], s20 offen sc1 lds
v_mfma_f32_32x32x16_bf16 v[20:35], v[48:51], a[92:95], v[20:35]
s_waitcnt lgkmcnt(2)
v_rsq_f32 v56, v56
ds_read_b128 v[48:51], v1 offset:29696
v_mul_f32 v52, v56, v52
v_mfma_f32_32x32x16_bf16 v[20:35], v[36:39], a[96:99], v[20:35]
ds_read_b128 v[36:39], v1 offset:30720
s_waitcnt lgkmcnt(3)
s_add_u32 m0, s35, 4096
s_add_u32 s20, s36, 4096
buffer_load_dwordx4 v0, s[4:7], s20 offen sc1 lds
v_mfma_f32_32x32x16_bf16 v[20:35], v[40:43], a[100:103], v[20:35]
ds_read_b128 v[40:43], v1 offset:31744
s_waitcnt lgkmcnt(3)
v_permlane32_swap_b32 v56, v52
v_lshl_add_u32 v54, s13, 8, v54
v_mfma_f32_32x32x16_bf16 v[20:35], v[44:47], a[104:107], v[20:35]
s_waitcnt lgkmcnt(1)
ds_read_b128 v[44:47], v1 offset:32768
ds_write_b32 v53, v56 offset:1024
ds_read_b128 v[80:83], v54 offset:1184
ds_read_b128 v[76:79], v54 offset:1152
v_mfma_f32_32x32x16_bf16 v[20:35], v[48:51], a[108:111], v[20:35]
v_mfma_f32_32x32x16_bf16 v[20:35], v[36:39], a[112:115], v[20:35]
s_waitcnt lgkmcnt(4)
ds_read_b128 v[48:51], v1 offset:33792
ds_read_b128 v[88:91], v54 offset:1248
ds_read_b128 v[36:39], v1 offset:34816
s_waitcnt lgkmcnt(6)
ds_read_b128 v[84:87], v54 offset:1216
v_mfma_f32_32x32x16_bf16 v[20:35], v[40:43], a[116:119], v[20:35]
s_waitcnt vmcnt(12)
s_barrier
s_mov_b64 exec, 1
buffer_store_dword v3, off, s[4:7], s22 sc1
s_mov_b64 exec, -1
v_mfma_f32_32x32x16_bf16 v[20:35], v[44:47], a[120:123], v[20:35]
ds_read_b128 v[40:43], v1 offset:35840
s_waitcnt lgkmcnt(4)
ds_read_b128 v[44:47], v1 offset:36864
v_mfma_f32_32x32x16_bf16 v[20:35], v[48:51], a[124:127], v[20:35]
ds_read_b128 v[48:51], v1 offset:37888
ds_read_b128 v[72:75], v54 offset:1120
s_waitcnt lgkmcnt(4)
v_mul_f32 v79, v79, v5
v_mul_f32 v86, v86, v5
v_mfma_f32_32x32x16_bf16 v[20:35], v[36:39], a[128:131], v[20:35]
s_waitcnt lgkmcnt(3)
v_mfma_f32_32x32x16_bf16 v[20:35], v[40:43], a[132:135], v[20:35]
v_mul_f32 v89, v89, v5
v_mul_f32 v90, v90, v5
s_waitcnt lgkmcnt(2)
s_waitcnt lgkmcnt(1)
ds_read_b128 v[36:39], v1 offset:38912
ds_read_b128 v[60:63], v54 offset:1024
v_mfma_f32_32x32x16_bf16 v[20:35], v[44:47], a[136:139], v[20:35]
ds_read_b128 v[40:43], v1 offset:39936
ds_read_b128 v[44:47], v1 offset:40960
ds_read_b128 v[64:67], v54 offset:1056
v_mul_f32 v87, v87, v5
v_mfma_f32_32x32x16_bf16 v[20:35], v[48:51], a[140:143], v[20:35]
ds_read_b128 v[48:51], v1 offset:41984
ds_read_b128 v[68:71], v54 offset:1088
s_waitcnt lgkmcnt(6)
v_mfma_f32_32x32x16_bf16 v[20:35], v[36:39], a[144:147], v[20:35]
s_waitcnt lgkmcnt(4)
v_mul_f32 v78, v78, v5
v_mfma_f32_32x32x16_bf16 v[20:35], v[40:43], a[148:151], v[20:35]
v_mul_f32 v76, v76, v5
v_mul_f32 v85, v85, v5
v_mul_f32 v91, v91, v5
v_mul_f32 v77, v77, v5
s_waitcnt lgkmcnt(3)
v_mul_f32 v84, v84, v5
v_mfma_f32_32x32x16_bf16 v[20:35], v[44:47], a[152:155], v[20:35]
s_waitcnt lgkmcnt(1)
v_mul_f32 v88, v88, v5
v_mul_f32 v80, v80, v5
v_mfma_f32_32x32x16_bf16 v[20:35], v[48:51], a[156:159], v[20:35]
s_waitcnt lgkmcnt(0)
v_mul_f32 v83, v83, v5
v_mul_f32 v82, v82, v5
v_mul_f32 v81, v81, v5
s_nop 7
v_pk_fma_f32 v[26:27], v[26:27], v[66:67], v[82:83] neg_lo:[0,0,1] neg_hi:[0,0,1]
v_pk_fma_f32 v[24:25], v[24:25], v[64:65], v[80:81] neg_lo:[0,0,1] neg_hi:[0,0,1]
v_pk_fma_f32 v[34:35], v[34:35], v[74:75], v[90:91] neg_lo:[0,0,1] neg_hi:[0,0,1]
v_pk_fma_f32 v[22:23], v[22:23], v[62:63], v[78:79] neg_lo:[0,0,1] neg_hi:[0,0,1]
v_cvt_pk_bf16_f32 v37, v22, v23
v_pk_fma_f32 v[30:31], v[30:31], v[70:71], v[86:87] neg_lo:[0,0,1] neg_hi:[0,0,1]
v_cvt_pk_bf16_f32 v39, v26, v27
v_pk_fma_f32 v[32:33], v[32:33], v[72:73], v[88:89] neg_lo:[0,0,1] neg_hi:[0,0,1]
v_pk_fma_f32 v[20:21], v[20:21], v[60:61], v[76:77] neg_lo:[0,0,1] neg_hi:[0,0,1]
v_pk_fma_f32 v[28:29], v[28:29], v[68:69], v[84:85] neg_lo:[0,0,1] neg_hi:[0,0,1]
v_cvt_pk_bf16_f32 v38, v24, v25
v_cvt_pk_bf16_f32 v42, v32, v33
v_cvt_pk_bf16_f32 v40, v28, v29
v_cvt_pk_bf16_f32 v41, v30, v31
v_cvt_pk_bf16_f32 v43, v34, v35
v_cvt_pk_bf16_f32 v36, v20, v21
buffer_store_dwordx4 v[36:39], v6, s[4:7], s27 offen offset:0 sc1
buffer_store_dwordx4 v[40:43], v6, s[4:7], s27 offen offset:512 sc1
s_lshl_b32 s18, s16, 6
s_add_u32 s18, s18, s28
s_add_u32 s27, s27, 524288
s_cmp_eq_u32 s13, 0
s_cselect_b32 s22, s51, s6
s_mov_b32 s23, s18
s_cmp_lg_u32 s33, 0
s_cbranch_scc1 kvx_24
kvm_29:
v_xor_b32 v1, 40960, v1
s_sub_u32 s25, s25, s31
s_xor_b32 s25, s25, 40960
s_add_u32 s25, s25, s31
s_xor_b32 s35, s35, 8192
s_cmp_lt_u32 s30, 64
s_cselect_b32 s53, s26, s6
s_cselect_b32 s36, s54, s6
s_mov_b32 s38, 1024
v_mov_b32 v8, v0
s_add_u32 s26, s26, 40960
s_add_u32 s54, s54, 5120
s_add_u32 s30, s30, 1
s_waitcnt vmcnt(3)
s_barrier
ds_read_b128 v[36:39], v1 offset:2048
s_add_u32 m0, s25, 2048
s_mov_b32 s20, s53
buffer_load_dwordx4 v8, s[4:7], s20 offen sc1 lds
ds_read_b128 v[40:43], v1 offset:3072
ds_read_b128 v[44:47], v1 offset:4096
s_add_u32 m0, s25, 3072
s_add_u32 s20, s20, s38
buffer_load_dwordx4 v8, s[4:7], s20 offen sc1 lds
s_waitcnt lgkmcnt(2)
v_mfma_f32_32x32x16_bf16 v[20:35], v[36:39], a[0:3], 0
ds_read_b128 v[48:51], v1 offset:5120
s_waitcnt lgkmcnt(2)
s_add_u32 m0, s25, 4096
s_add_u32 s20, s20, s38
buffer_load_dwordx4 v8, s[4:7], s20 offen sc1 lds
s_waitcnt lgkmcnt(1)
v_mfma_f32_32x32x16_bf16 v[20:35], v[40:43], a[4:7], v[20:35]
s_add_u32 m0, s25, 5120
s_add_u32 s20, s20, s38
buffer_load_dwordx4 v8, s[4:7], s20 offen sc1 lds
ds_read_b128 v[36:39], v1 offset:6144
ds_read_b128 v[40:43], v1 offset:7168
v_mfma_f32_32x32x16_bf16 v[20:35], v[44:47], a[8:11], v[20:35]
ds_read_b128 v[44:47], v1 offset:8192
s_waitcnt lgkmcnt(3)
v_mfma_f32_32x32x16_bf16 v[20:35], v[48:51], a[12:15], v[20:35]
s_waitcnt lgkmcnt(2)
v_mfma_f32_32x32x16_bf16 v[20:35], v[36:39], a[16:19], v[20:35]
ds_read_b128 v[48:51], v1 offset:9216
ds_read_b128 v[36:39], v1 offset:10240
s_waitcnt lgkmcnt(2)
v_mfma_f32_32x32x16_bf16 v[20:35], v[40:43], a[20:23], v[20:35]
v_mfma_f32_32x32x16_bf16 v[20:35], v[44:47], a[24:27], v[20:35]
ds_read_b128 v[44:47], v1 offset:12288
s_waitcnt lgkmcnt(2)
ds_read_b128 v[40:43], v1 offset:11264
v_mfma_f32_32x32x16_bf16 v[20:35], v[48:51], a[28:31], v[20:35]
s_waitcnt lgkmcnt(2)
s_add_u32 m0, s25, 6144
s_add_u32 s20, s20, s38
buffer_load_dwordx4 v8, s[4:7], s20 offen sc1 lds
ds_read_b128 v[48:51], v1 offset:13312
v_mfma_f32_32x32x16_bf16 v[20:35], v[36:39], a[32:35], v[20:35]
s_waitcnt lgkmcnt(2)
s_add_u32 m0, s25, 7168
s_add_u32 s20, s20, s38
buffer_load_dwordx4 v8, s[4:7], s20 offen sc1 lds
s_waitcnt lgkmcnt(1)
v_mfma_f32_32x32x16_bf16 v[20:35], v[40:43], a[36:39], v[20:35]
ds_read_b128 v[36:39], v1 offset:14336
s_add_u32 m0, s25, 8192
s_add_u32 s20, s20, s38
buffer_load_dwordx4 v8, s[4:7], s20 offen sc1 lds
s_waitcnt lgkmcnt(1)
ds_read_b128 v[40:43], v1 offset:15360
v_mfma_f32_32x32x16_bf16 v[20:35], v[44:47], a[40:43], v[20:35]
ds_read_b128 v[44:47], v1 offset:16384
v_mfma_f32_32x32x16_bf16 v[20:35], v[48:51], a[44:47], v[20:35]
s_waitcnt lgkmcnt(2)
ds_read_b128 v[48:51], v1 offset:17408
v_mfma_f32_32x32x16_bf16 v[20:35], v[36:39], a[48:51], v[20:35]
ds_read_b128 v[36:39], v1 offset:18432
s_waitcnt lgkmcnt(2)
v_mfma_f32_32x32x16_bf16 v[20:35], v[40:43], a[52:55], v[20:35]
ds_read_b128 v[40:43], v1 offset:19456
s_add_u32 m0, s25, 9216
s_add_u32 s20, s20, s38
buffer_load_dwordx4 v8, s[4:7], s20 offen sc1 lds
s_waitcnt lgkmcnt(2)
v_mfma_f32_32x32x16_bf16 v[20:35], v[44:47], a[56:59], v[20:35]
v_mfma_f32_32x32x16_bf16 v[20:35], v[48:51], a[60:63], v[20:35]
ds_read_b128 v[48:51], v1 offset:21504
ds_read_b128 v[44:47], v1 offset:20480
s_waitcnt lgkmcnt(3)
v_mov_b32 v3, s23
v_mfma_f32_32x32x16_bf16 v[20:35], v[36:39], a[64:67], v[20:35]
s_waitcnt lgkmcnt(2)
s_add_u32 m0, s25, 10240
s_add_u32 s20, s20, s38
buffer_load_dwordx4 v8, s[4:7], s20 offen sc1 lds
ds_read_b128 v[36:39], v1 offset:22528
v_mfma_f32_32x32x16_bf16 v[20:35], v[40:43], a[68:71], v[20:35]
ds_read_b128 v[40:43], v1 offset:23552
s_waitcnt lgkmcnt(2)
v_mfma_f32_32x32x16_bf16 v[20:35], v[44:47], a[72:75], v[20:35]
v_mfma_f32_32x32x16_bf16 v[20:35], v[48:51], a[76:79], v[20:35]
s_waitcnt lgkmcnt(0)
ds_read_b128 v[44:47], v1 offset:24576
v_mfma_f32_32x32x16_bf16 v[20:35], v[36:39], a[80:83], v[20:35]
ds_read_b128 v[48:51], v1 offset:25600
s_add_u32 m0, s25, 11264
s_add_u32 s20, s20, s38
buffer_load_dwordx4 v8, s[4:7], s20 offen sc1 lds
v_mfma_f32_32x32x16_bf16 v[20:35], v[40:43], a[84:87], v[20:35]
ds_read_b128 v[36:39], v1 offset:26624
s_waitcnt lgkmcnt(2)
ds_read_b128 v[40:43], v1 offset:27648
v_mfma_f32_32x32x16_bf16 v[20:35], v[44:47], a[88:91], v[20:35]
s_waitcnt lgkmcnt(2)
ds_read_b128 v[44:47], v1 offset:28672
s_add_u32 m0, s35, s37
s_add_u32 s20, s36, s37
buffer_load_dwordx4 v0, s[4:7], s20 offen sc1 lds
v_mfma_f32_32x32x16_bf16 v[20:35], v[48:51], a[92:95], v[20:35]
ds_read_b128 v[48:51], v1 offset:29696
s_waitcnt lgkmcnt(3)
v_mfma_f32_32x32x16_bf16 v[20:35], v[36:39], a[96:99], v[20:35]
s_waitcnt lgkmcnt(1)
ds_read_b128 v[36:39], v1 offset:30720
s_add_u32 m0, s35, 4096
s_add_u32 s20, s36, 4096
buffer_load_dwordx4 v0, s[4:7], s20 offen sc1 lds
v_mfma_f32_32x32x16_bf16 v[20:35], v[40:43], a[100:103], v[20:35]
ds_read_b128 v[40:43], v1 offset:31744
v_mfma_f32_32x32x16_bf16 v[20:35], v[44:47], a[104:107], v[20:35]
s_waitcnt lgkmcnt(2)
s_waitcnt lgkmcnt(1)
v_mfma_f32_32x32x16_bf16 v[20:35], v[48:51], a[108:111], v[20:35]
ds_read_b128 v[44:47], v1 offset:32768
ds_read_b128 v[48:51], v1 offset:33792
v_mfma_f32_32x32x16_bf16 v[20:35], v[36:39], a[112:115], v[20:35]
ds_read_b128 v[36:39], v1 offset:34816
s_waitcnt lgkmcnt(3)
v_mfma_f32_32x32x16_bf16 v[20:35], v[40:43], a[116:119], v[20:35]
s_waitcnt vmcnt(12)
s_barrier
ds_read_b128 v[40:43], v1 offset:35840
s_waitcnt lgkmcnt(3)
v_mfma_f32_32x32x16_bf16 v[20:35], v[44:47], a[120:123], v[20:35]
s_mov_b64 exec, 1
buffer_store_dword v3, off, s[4:7], s22 sc1
s_mov_b64 exec, -1
s_waitcnt lgkmcnt(1)
v_mfma_f32_32x32x16_bf16 v[20:35], v[48:51], a[124:127], v[20:35]
ds_read_b128 v[44:47], v1 offset:36864
s_waitcnt lgkmcnt(1)
ds_read_b128 v[48:51], v1 offset:37888
v_mfma_f32_32x32x16_bf16 v[20:35], v[36:39], a[128:131], v[20:35]
v_mfma_f32_32x32x16_bf16 v[20:35], v[40:43], a[132:135], v[20:35]
s_waitcnt lgkmcnt(1)
ds_read_b128 v[40:43], v1 offset:39936
ds_read_b128 v[36:39], v1 offset:38912
v_mfma_f32_32x32x16_bf16 v[20:35], v[44:47], a[136:139], v[20:35]
s_waitcnt lgkmcnt(2)
v_mfma_f32_32x32x16_bf16 v[20:35], v[48:51], a[140:143], v[20:35]
ds_read_b128 v[44:47], v1 offset:40960
ds_read_b128 v[48:51], v1 offset:41984
s_waitcnt lgkmcnt(2)
v_mfma_f32_32x32x16_bf16 v[20:35], v[36:39], a[144:147], v[20:35]
v_mfma_f32_32x32x16_bf16 v[20:35], v[40:43], a[148:151], v[20:35]
s_waitcnt lgkmcnt(1)
v_mfma_f32_32x32x16_bf16 v[20:35], v[44:47], a[152:155], v[20:35]
s_waitcnt lgkmcnt(0)
v_mfma_f32_32x32x16_bf16 v[20:35], v[48:51], a[156:159], v[20:35]
s_nop 11
v_cvt_pk_bf16_f32 v37, v22, v23
v_cvt_pk_bf16_f32 v36, v20, v21
v_cvt_pk_bf16_f32 v41, v30, v31
v_cvt_pk_bf16_f32 v39, v26, v27
v_cvt_pk_bf16_f32 v42, v32, v33
v_cvt_pk_bf16_f32 v38, v24, v25
v_cvt_pk_bf16_f32 v40, v28, v29
v_cvt_pk_bf16_f32 v43, v34, v35
buffer_store_dwordx4 v[36:39], v6, s[4:7], s50 offen offset:0 sc1
buffer_store_dwordx4 v[40:43], v6, s[4:7], s50 offen offset:512 sc1
s_add_u32 s39, s39, 1
s_add_u32 s50, s50, 524288
s_add_u32 s18, s51, 8192
s_cmp_eq_u32 s13, 0
s_cselect_b32 s22, s18, s6
s_mov_b32 s23, s39
s_cmp_lt_u32 s28, 64
s_cbranch_scc1 kvx_24
s_and_b32 s18, s39, 15
s_cbranch_scc0 kvt_30
s_waitcnt vmcnt(0)
s_barrier
v_mov_b32 v3, s23
s_mov_b64 exec, 1
buffer_store_dword v3, off, s[4:7], s22 sc1
s_mov_b64 exec, -1
s_mov_b32 s22, s6
s_lshl_b32 s18, s39, 2
s_add_u32 s18, s18, 4
s_cmp_lg_u32 s13, 0
s_cbranch_scc1 polld_36
v_lshlrev_b32 v15, 3, v0
v_min_u32 v15, 1152, v15
s_mov_b32 s21, 11550720
s_mov_b32 s17, 0
poll_35:
buffer_load_dword v12, v15, s[4:7], s21 offen sc1
s_add_u32 s17, s17, 1
s_cmp_gt_u32 s17, 262144
s_cbranch_scc1 L_fail
s_waitcnt vmcnt(0)
v_cmp_gt_u32 vcc, s18, v12
s_cbranch_vccz polld_36
s_sleep 2
s_branch poll_35
polld_36:
s_barrier
s_mov_b32 s53, s52
s_mov_b32 s36, s6
s_mov_b32 s38, 256
v_mov_b32 v8, v7
s_add_u32 s52, s52, 40960
s_add_u32 m0, s25, 2048
s_mov_b32 s20, s53
buffer_load_dwordx4 v8, s[4:7], s20 offen sc1 lds
s_add_u32 m0, s25, 3072
s_add_u32 s20, s20, s38
buffer_load_dwordx4 v8, s[4:7], s20 offen sc1 lds
s_add_u32 m0, s25, 4096
s_add_u32 s20, s20, s38
buffer_load_dwordx4 v8, s[4:7], s20 offen sc1 lds
s_add_u32 m0, s25, 5120
s_add_u32 s20, s20, s38
buffer_load_dwordx4 v8, s[4:7], s20 offen sc1 lds
s_add_u32 m0, s25, 6144
s_add_u32 s20, s20, s38
buffer_load_dwordx4 v8, s[4:7], s20 offen sc1 lds
s_add_u32 m0, s25, 7168
s_add_u32 s20, s20, s38
buffer_load_dwordx4 v8, s[4:7], s20 offen sc1 lds
s_add_u32 m0, s25, 8192
s_add_u32 s20, s20, s38
buffer_load_dwordx4 v8, s[4:7], s20 offen sc1 lds
s_add_u32 m0, s25, 9216
s_add_u32 s20, s20, s38
buffer_load_dwordx4 v8, s[4:7], s20 offen sc1 lds
s_add_u32 m0, s25, 10240
s_add_u32 s20, s20, s38
buffer_load_dwordx4 v8, s[4:7], s20 offen sc1 lds
s_add_u32 m0, s25, 11264
s_add_u32 s20, s20, s38
buffer_load_dwordx4 v8, s[4:7], s20 offen sc1 lds
s_waitcnt vmcnt(0)
s_branch kvm_29
kv_28:
s_lshl_b32 s18, s39, 2
s_add_u32 s18, s18, 4
s_cmp_lg_u32 s13, 0
s_cbranch_scc1 polld_38
v_lshlrev_b32 v15, 3, v0
v_min_u32 v15, 1152, v15
s_mov_b32 s21, 11550720
s_mov_b32 s17, 0
poll_37:
buffer_load_dword v12, v15, s[4:7], s21 offen sc1
s_add_u32 s17, s17, 1
s_cmp_gt_u32 s17, 262144
s_cbranch_scc1 L_fail
s_waitcnt vmcnt(0)
v_cmp_gt_u32 vcc, s18, v12
s_cbranch_vccz polld_38
s_sleep 2
s_branch poll_37
polld_38:
s_barrier
s_mov_b32 s53, s52
s_mov_b32 s36, s6
s_mov_b32 s38, 256
v_mov_b32 v8, v7
s_add_u32 s52, s52, 40960
s_branch kvn_25
kvt_30:
s_waitcnt vmcnt(0)
s_barrier
v_mov_b32 v3, s23
s_mov_b64 exec, 1
buffer_store_dword v3, off, s[4:7], s22 sc1
s_mov_b64 exec, -1
s_mov_b32 s22, s6
s_cmp_lg_u32 s16, 0
s_cbranch_scc1 kvz_39
s_cmp_ge_u32 s32, 20
s_cbranch_scc1 kvz_39
s_mov_b32 s55, s34
s_mul_i32 s30, s32, 13108
s_lshr_b32 s30, s30, 16
s_mul_i32 s18, s30, 5
s_sub_u32 s34, s32, s18
s_add_u32 s30, s30, 60
s_add_u32 s54, s32, 15
s_lshl_b32 s18, s34, 2
s_add_u32 s18, s18, s13
s_lshl_b32 s33, s18, 11
v_lshrrev_b32 v12, 9, v0
v_and_b32 v10, 0x1ff, v0
v_lshlrev_b32 v10, 1, v10
v_lshl_add_u32 v10, v12, 4, v10
s_lshl_b32 s18, s34, 7
s_lshl_b32 s19, s13, 5
s_add_u32 s18, s18, s19
s_mov_b32 s19, 0x3acccccd
v_bfe_u32 v202, v0, 4, 5
v_lshrrev_b32 v197, 9, v0
v_add_u32 v202, s18, v202
v_and_b32 v201, 1, v202
v_mul_u32_u24 v201, 160, v201
v_lshrrev_b32 v200, 1, v202
v_add_u32 v200, 1, v200
v_lshlrev_b32 v197, 3, v197
v_mad_u32_u24 v201, v197, v200, v201
v_mad_u32_u24 v196, v200, 16, 0
v_cvt_f32_u32 v196, v196
v_mul_f32 v202, s19, v196
v_rndne_f32 v202, v202
v_fmac_f32 v196, 0xc4200000, v202
v_mul_f32 v196, s19, v196
v_cos_f32 v196, v196
s_nop 0
v_add_f32 v196, v196, v196
v_mad_u32_u24 v198, v200, 1, 0
v_cvt_f32_u32 v198, v198
v_mul_f32 v202, s19, v198
v_rndne_f32 v202, v202
v_fmac_f32 v198, 0xc4200000, v202
v_mul_f32 v198, s19, v198
v_cos_f32 v198, v198
s_nop 0
v_add_f32 v198, v198, v198
v_mad_u32_u24 v183, v200, 3, v201
v_cvt_f32_u32 v183, v183
v_mul_f32 v202, s19, v183
v_rndne_f32 v202, v202
v_fmac_f32 v183, 0xc4200000, v202
v_mul_f32 v183, s19, v183
v_cos_f32 v183, v183
v_mad_u32_u24 v184, v200, 4, v201
v_cvt_f32_u32 v184, v184
v_mul_f32 v202, s19, v184
v_rndne_f32 v202, v202
v_fmac_f32 v184, 0xc4200000, v202
v_mul_f32 v184, s19, v184
v_cos_f32 v184, v184
s_nop 0
v_fma_f32 v185, v198, v184, -v183
v_fma_f32 v182, v198, v183, -v184
v_fma_f32 v186, v198, v185, -v184
v_fma_f32 v181, v198, v182, -v183
v_fma_f32 v187, v198, v186, -v185
v_fma_f32 v180, v198, v181, -v182
v_cvt_pk_bf16_f32 v20, v180, v181
v_cvt_pk_bf16_f32 v21, v182, v183
v_cvt_pk_bf16_f32 v22, v184, v185
v_cvt_pk_bf16_f32 v23, v186, v187
v_mad_u32_u24 v191, v200, 19, v201
v_cvt_f32_u32 v191, v191
v_mul_f32 v202, s19, v191
v_rndne_f32 v202, v202
v_fmac_f32 v191, 0xc4200000, v202
v_mul_f32 v191, s19, v191
v_cos_f32 v191, v191
v_mad_u32_u24 v192, v200, 20, v201
v_cvt_f32_u32 v192, v192
v_mul_f32 v202, s19, v192
v_rndne_f32 v202, v202
v_fmac_f32 v192, 0xc4200000, v202
v_mul_f32 v192, s19, v192
v_cos_f32 v192, v192
s_nop 0
v_fma_f32 v193, v198, v192, -v191
v_fma_f32 v190, v198, v191, -v192
v_fma_f32 v194, v198, v193, -v192
v_fma_f32 v189, v198, v190, -v191
v_fma_f32 v195, v198, v194, -v193
v_fma_f32 v188, v198, v189, -v190
v_cvt_pk_bf16_f32 v24, v188, v189
v_cvt_pk_bf16_f32 v25, v190, v191
v_cvt_pk_bf16_f32 v26, v192, v193
v_cvt_pk_bf16_f32 v27, v194, v195
v_pk_fma_f32 v[180:181], v[196:197], v[188:189], v[180:181] op_sel_hi:[0,1,1] neg_lo:[0,0,1] neg_hi:[0,0,1]
v_pk_fma_f32 v[182:183], v[196:197], v[190:191], v[182:183] op_sel_hi:[0,1,1] neg_lo:[0,0,1] neg_hi:[0,0,1]
v_pk_fma_f32 v[184:185], v[196:197], v[192:193], v[184:185] op_sel_hi:[0,1,1] neg_lo:[0,0,1] neg_hi:[0,0,1]
v_pk_fma_f32 v[186:187], v[196:197], v[194:195], v[186:187] op_sel_hi:[0,1,1] neg_lo:[0,0,1] neg_hi:[0,0,1]
v_cvt_pk_bf16_f32 v28, v180, v181
v_cvt_pk_bf16_f32 v29, v182, v183
v_cvt_pk_bf16_f32 v30, v184, v185
v_cvt_pk_bf16_f32 v31, v186, v187
v_pk_fma_f32 v[188:189], v[196:197], v[180:181], v[188:189] op_sel_hi:[0,1,1] neg_lo:[0,0,1] neg_hi:[0,0,1]
v_pk_fma_f32 v[190:191], v[196:197], v[182:183], v[190:191] op_sel_hi:[0,1,1] neg_lo:[0,0,1] neg_hi:[0,0,1]
v_pk_fma_f32 v[192:193], v[196:197], v[184:185], v[192:193] op_sel_hi:[0,1,1] neg_lo:[0,0,1] neg_hi:[0,0,1]
v_pk_fma_f32 v[194:195], v[196:197], v[186:187], v[194:195] op_sel_hi:[0,1,1] neg_lo:[0,0,1] neg_hi:[0,0,1]
v_cvt_pk_bf16_f32 v32, v188, v189
v_cvt_pk_bf16_f32 v33, v190, v191
v_cvt_pk_bf16_f32 v34, v192, v193
v_cvt_pk_bf16_f32 v35, v194, v195
v_pk_fma_f32 v[180:181], v[196:197], v[188:189], v[180:181] op_sel_hi:[0,1,1] neg_lo:[0,0,1] neg_hi:[0,0,1]
v_pk_fma_f32 v[182:183], v[196:197], v[190:191], v[182:183] op_sel_hi:[0,1,1] neg_lo:[0,0,1] neg_hi:[0,0,1]
v_pk_fma_f32 v[184:185], v[196:197], v[192:193], v[184:185] op_sel_hi:[0,1,1] neg_lo:[0,0,1] neg_hi:[0,0,1]
v_pk_fma_f32 v[186:187], v[196:197], v[194:195], v[186:187] op_sel_hi:[0,1,1] neg_lo:[0,0,1] neg_hi:[0,0,1]
v_cvt_pk_bf16_f32 v36, v180, v181
v_cvt_pk_bf16_f32 v37, v182, v183
v_cvt_pk_bf16_f32 v38, v184, v185
v_cvt_pk_bf16_f32 v39, v186, v187
v_pk_fma_f32 v[188:189], v[196:197], v[180:181], v[188:189] op_sel_hi:[0,1,1] neg_lo:[0,0,1] neg_hi:[0,0,1]
v_pk_fma_f32 v[190:191], v[196:197], v[182:183], v[190:191] op_sel_hi:[0,1,1] neg_lo:[0,0,1] neg_hi:[0,0,1]
v_pk_fma_f32 v[192:193], v[196:197], v[184:185], v[192:193] op_sel_hi:[0,1,1] neg_lo:[0,0,1] neg_hi:[0,0,1]
v_pk_fma_f32 v[194:195], v[196:197], v[186:187], v[194:195] op_sel_hi:[0,1,1] neg_lo:[0,0,1] neg_hi:[0,0,1]
v_cvt_pk_bf16_f32 v40, v188, v189
v_cvt_pk_bf16_f32 v41, v190, v191
v_cvt_pk_bf16_f32 v42, v192, v193
v_cvt_pk_bf16_f32 v43, v194, v195
v_pk_fma_f32 v[180:181], v[196:197], v[188:189], v[180:181] op_sel_hi:[0,1,1] neg_lo:[0,0,1] neg_hi:[0,0,1]
v_pk_fma_f32 v[182:183], v[196:197], v[190:191], v[182:183] op_sel_hi:[0,1,1] neg_lo:[0,0,1] neg_hi:[0,0,1]
v_pk_fma_f32 v[184:185], v[196:197], v[192:193], v[184:185] op_sel_hi:[0,1,1] neg_lo:[0,0,1] neg_hi:[0,0,1]
v_pk_fma_f32 v[186:187], v[196:197], v[194:195], v[186:187] op_sel_hi:[0,1,1] neg_lo:[0,0,1] neg_hi:[0,0,1]
v_cvt_pk_bf16_f32 v44, v180, v181
v_cvt_pk_bf16_f32 v45, v182, v183
v_cvt_pk_bf16_f32 v46, v184, v185
v_cvt_pk_bf16_f32 v47, v186, v187
v_pk_fma_f32 v[188:189], v[196:197], v[180:181], v[188:189] op_sel_hi:[0,1,1] neg_lo:[0,0,1] neg_hi:[0,0,1]
v_pk_fma_f32 v[190:191], v[196:197], v[182:183], v[190:191] op_sel_hi:[0,1,1] neg_lo:[0,0,1] neg_hi:[0,0,1]
v_pk_fma_f32 v[192:193], v[196:197], v[184:185], v[192:193] op_sel_hi:[0,1,1] neg_lo:[0,0,1] neg_hi:[0,0,1]
v_pk_fma_f32 v[194:195], v[196:197], v[186:187], v[194:195] op_sel_hi:[0,1,1] neg_lo:[0,0,1] neg_hi:[0,0,1]
v_cvt_pk_bf16_f32 v48, v188, v189
v_cvt_pk_bf16_f32 v49, v190, v191
v_cvt_pk_bf16_f32 v50, v192, v193
v_cvt_pk_bf16_f32 v51, v194, v195
v_pk_fma_f32 v[180:181], v[196:197], v[188:189], v[180:181] op_sel_hi:[0,1,1] neg_lo:[0,0,1] neg_hi:[0,0,1]
v_pk_fma_f32 v[182:183], v[196:197], v[190:191], v[182:183] op_sel_hi:[0,1,1] neg_lo:[0,0,1] neg_hi:[0,0,1]
v_pk_fma_f32 v[184:185], v[196:197], v[192:193], v[184:185] op_sel_hi:[0,1,1] neg_lo:[0,0,1] neg_hi:[0,0,1]
v_pk_fma_f32 v[186:187], v[196:197], v[194:195], v[186:187] op_sel_hi:[0,1,1] neg_lo:[0,0,1] neg_hi:[0,0,1]
v_cvt_pk_bf16_f32 v52, v180, v181
v_cvt_pk_bf16_f32 v53, v182, v183
v_cvt_pk_bf16_f32 v54, v184, v185
v_cvt_pk_bf16_f32 v55, v186, v187
v_pk_fma_f32 v[188:189], v[196:197], v[180:181], v[188:189] op_sel_hi:[0,1,1] neg_lo:[0,0,1] neg_hi:[0,0,1]
v_pk_fma_f32 v[190:191], v[196:197], v[182:183], v[190:191] op_sel_hi:[0,1,1] neg_lo:[0,0,1] neg_hi:[0,0,1]
v_pk_fma_f32 v[192:193], v[196:197], v[184:185], v[192:193] op_sel_hi:[0,1,1] neg_lo:[0,0,1] neg_hi:[0,0,1]
v_pk_fma_f32 v[194:195], v[196:197], v[186:187], v[194:195] op_sel_hi:[0,1,1] neg_lo:[0,0,1] neg_hi:[0,0,1]
v_cvt_pk_bf16_f32 v56, v188, v189
v_cvt_pk_bf16_f32 v57, v190, v191
v_cvt_pk_bf16_f32 v58, v192, v193
v_cvt_pk_bf16_f32 v59, v194, v195
v_pk_fma_f32 v[180:181], v[196:197], v[188:189], v[180:181] op_sel_hi:[0,1,1] neg_lo:[0,0,1] neg_hi:[0,0,1]
v_pk_fma_f32 v[182:183], v[196:197], v[190:191], v[182:183] op_sel_hi:[0,1,1] neg_lo:[0,0,1] neg_hi:[0,0,1]
v_pk_fma_f32 v[184:185], v[196:197], v[192:193], v[184:185] op_sel_hi:[0,1,1] neg_lo:[0,0,1] neg_hi:[0,0,1]
v_pk_fma_f32 v[186:187], v[196:197], v[194:195], v[186:187] op_sel_hi:[0,1,1] neg_lo:[0,0,1] neg_hi:[0,0,1]
v_cvt_pk_bf16_f32 v60, v180, v181
v_cvt_pk_bf16_f32 v61, v182, v183
v_cvt_pk_bf16_f32 v62, v184, v185
v_cvt_pk_bf16_f32 v63, v186, v187
v_pk_fma_f32 v[188:189], v[196:197], v[180:181], v[188:189] op_sel_hi:[0,1,1] neg_lo:[0,0,1] neg_hi:[0,0,1]
v_pk_fma_f32 v[190:191], v[196:197], v[182:183], v[190:191] op_sel_hi:[0,1,1] neg_lo:[0,0,1] neg_hi:[0,0,1]
v_pk_fma_f32 v[192:193], v[196:197], v[184:185], v[192:193] op_sel_hi:[0,1,1] neg_lo:[0,0,1] neg_hi:[0,0,1]
v_pk_fma_f32 v[194:195], v[196:197], v[186:187], v[194:195] op_sel_hi:[0,1,1] neg_lo:[0,0,1] neg_hi:[0,0,1]
v_cvt_pk_bf16_f32 v64, v188, v189
v_cvt_pk_bf16_f32 v65, v190, v191
v_cvt_pk_bf16_f32 v66, v192, v193
v_cvt_pk_bf16_f32 v67, v194, v195
v_pk_fma_f32 v[180:181], v[196:197], v[188:189], v[180:181] op_sel_hi:[0,1,1] neg_lo:[0,0,1] neg_hi:[0,0,1]
v_pk_fma_f32 v[182:183], v[196:197], v[190:191], v[182:183] op_sel_hi:[0,1,1] neg_lo:[0,0,1] neg_hi:[0,0,1]
v_pk_fma_f32 v[184:185], v[196:197], v[192:193], v[184:185] op_sel_hi:[0,1,1] neg_lo:[0,0,1] neg_hi:[0,0,1]
v_pk_fma_f32 v[186:187], v[196:197], v[194:195], v[186:187] op_sel_hi:[0,1,1] neg_lo:[0,0,1] neg_hi:[0,0,1]
v_cvt_pk_bf16_f32 v68, v180, v181
v_cvt_pk_bf16_f32 v69, v182, v183
v_cvt_pk_bf16_f32 v70, v184, v185
v_cvt_pk_bf16_f32 v71, v186, v187
v_pk_fma_f32 v[188:189], v[196:197], v[180:181], v[188:189] op_sel_hi:[0,1,1] neg_lo:[0,0,1] neg_hi:[0,0,1]
v_pk_fma_f32 v[190:191], v[196:197], v[182:183], v[190:191] op_sel_hi:[0,1,1] neg_lo:[0,0,1] neg_hi:[0,0,1]
v_pk_fma_f32 v[192:193], v[196:197], v[184:185], v[192:193] op_sel_hi:[0,1,1] neg_lo:[0,0,1] neg_hi:[0,0,1]
v_pk_fma_f32 v[194:195], v[196:197], v[186:187], v[194:195] op_sel_hi:[0,1,1] neg_lo:[0,0,1] neg_hi:[0,0,1]
v_cvt_pk_bf16_f32 v72, v188, v189
v_cvt_pk_bf16_f32 v73, v190, v191
v_cvt_pk_bf16_f32 v74, v192, v193
v_cvt_pk_bf16_f32 v75, v194, v195
v_pk_fma_f32 v[180:181], v[196:197], v[188:189], v[180:181] op_sel_hi:[0,1,1] neg_lo:[0,0,1] neg_hi:[0,0,1]
v_pk_fma_f32 v[182:183], v[196:197], v[190:191], v[182:183] op_sel_hi:[0,1,1] neg_lo:[0,0,1] neg_hi:[0,0,1]
v_pk_fma_f32 v[184:185], v[196:197], v[192:193], v[184:185] op_sel_hi:[0,1,1] neg_lo:[0,0,1] neg_hi:[0,0,1]
v_pk_fma_f32 v[186:187], v[196:197], v[194:195], v[186:187] op_sel_hi:[0,1,1] neg_lo:[0,0,1] neg_hi:[0,0,1]
v_cvt_pk_bf16_f32 v76, v180, v181
v_cvt_pk_bf16_f32 v77, v182, v183
v_cvt_pk_bf16_f32 v78, v184, v185
v_cvt_pk_bf16_f32 v79, v186, v187
v_pk_fma_f32 v[188:189], v[196:197], v[180:181], v[188:189] op_sel_hi:[0,1,1] neg_lo:[0,0,1] neg_hi:[0,0,1]
v_pk_fma_f32 v[190:191], v[196:197], v[182:183], v[190:191] op_sel_hi:[0,1,1] neg_lo:[0,0,1] neg_hi:[0,0,1]
v_pk_fma_f32 v[192:193], v[196:197], v[184:185], v[192:193] op_sel_hi:[0,1,1] neg_lo:[0,0,1] neg_hi:[0,0,1]
v_pk_fma_f32 v[194:195], v[196:197], v[186:187], v[194:195] op_sel_hi:[0,1,1] neg_lo:[0,0,1] neg_hi:[0,0,1]
v_cvt_pk_bf16_f32 v80, v188, v189
v_cvt_pk_bf16_f32 v81, v190, v191
v_cvt_pk_bf16_f32 v82, v192, v193
v_cvt_pk_bf16_f32 v83, v194, v195
v_pk_fma_f32 v[180:181], v[196:197], v[188:189], v[180:181] op_sel_hi:[0,1,1] neg_lo:[0,0,1] neg_hi:[0,0,1]
v_pk_fma_f32 v[182:183], v[196:197], v[190:191], v[182:183] op_sel_hi:[0,1,1] neg_lo:[0,0,1] neg_hi:[0,0,1]
v_pk_fma_f32 v[184:185], v[196:197], v[192:193], v[184:185] op_sel_hi:[0,1,1] neg_lo:[0,0,1] neg_hi:[0,0,1]
v_pk_fma_f32 v[186:187], v[196:197], v[194:195], v[186:187] op_sel_hi:[0,1,1] neg_lo:[0,0,1] neg_hi:[0,0,1]
v_cvt_pk_bf16_f32 v84, v180, v181
v_cvt_pk_bf16_f32 v85, v182, v183
v_cvt_pk_bf16_f32 v86, v184, v185
v_cvt_pk_bf16_f32 v87, v186, v187
v_pk_fma_f32 v[188:189], v[196:197], v[180:181], v[188:189] op_sel_hi:[0,1,1] neg_lo:[0,0,1] neg_hi:[0,0,1]
v_pk_fma_f32 v[190:191], v[196:197], v[182:183], v[190:191] op_sel_hi:[0,1,1] neg_lo:[0,0,1] neg_hi:[0,0,1]
v_pk_fma_f32 v[192:193], v[196:197], v[184:185], v[192:193] op_sel_hi:[0,1,1] neg_lo:[0,0,1] neg_hi:[0,0,1]
v_pk_fma_f32 v[194:195], v[196:197], v[186:187], v[194:195] op_sel_hi:[0,1,1] neg_lo:[0,0,1] neg_hi:[0,0,1]
v_cvt_pk_bf16_f32 v88, v188, v189
v_cvt_pk_bf16_f32 v89, v190, v191
v_cvt_pk_bf16_f32 v90, v192, v193
v_cvt_pk_bf16_f32 v91, v194, v195
v_pk_fma_f32 v[180:181], v[196:197], v[188:189], v[180:181] op_sel_hi:[0,1,1] neg_lo:[0,0,1] neg_hi:[0,0,1]
v_pk_fma_f32 v[182:183], v[196:197], v[190:191], v[182:183] op_sel_hi:[0,1,1] neg_lo:[0,0,1] neg_hi:[0,0,1]
v_pk_fma_f32 v[184:185], v[196:197], v[192:193], v[184:185] op_sel_hi:[0,1,1] neg_lo:[0,0,1] neg_hi:[0,0,1]
v_pk_fma_f32 v[186:187], v[196:197], v[194:195], v[186:187] op_sel_hi:[0,1,1] neg_lo:[0,0,1] neg_hi:[0,0,1]
v_cvt_pk_bf16_f32 v92, v180, v181
v_cvt_pk_bf16_f32 v93, v182, v183
v_cvt_pk_bf16_f32 v94, v184, v185
v_cvt_pk_bf16_f32 v95, v186, v187
v_pk_fma_f32 v[188:189], v[196:197], v[180:181], v[188:189] op_sel_hi:[0,1,1] neg_lo:[0,0,1] neg_hi:[0,0,1]
v_pk_fma_f32 v[190:191], v[196:197], v[182:183], v[190:191] op_sel_hi:[0,1,1] neg_lo:[0,0,1] neg_hi:[0,0,1]
v_pk_fma_f32 v[192:193], v[196:197], v[184:185], v[192:193] op_sel_hi:[0,1,1] neg_lo:[0,0,1] neg_hi:[0,0,1]
v_pk_fma_f32 v[194:195], v[196:197], v[186:187], v[194:195] op_sel_hi:[0,1,1] neg_lo:[0,0,1] neg_hi:[0,0,1]
v_cvt_pk_bf16_f32 v96, v188, v189
v_cvt_pk_bf16_f32 v97, v190, v191
v_cvt_pk_bf16_f32 v98, v192, v193
v_cvt_pk_bf16_f32 v99, v194, v195
s_mov_b32 s20, 323
v_mad_u32_u24 v183, v200, s20, v201
v_cvt_f32_u32 v183, v183
v_mul_f32 v202, s19, v183
v_rndne_f32 v202, v202
v_fmac_f32 v183, 0xc4200000, v202
v_mul_f32 v183, s19, v183
v_cos_f32 v183, v183
s_mov_b32 s20, 324
v_mad_u32_u24 v184, v200, s20, v201
v_cvt_f32_u32 v184, v184
v_mul_f32 v202, s19, v184
v_rndne_f32 v202, v202
v_fmac_f32 v184, 0xc4200000, v202
v_mul_f32 v184, s19, v184
v_cos_f32 v184, v184
s_nop 0
v_fma_f32 v185, v198, v184, -v183
v_fma_f32 v182, v198, v183, -v184
v_fma_f32 v186, v198, v185, -v184
v_fma_f32 v181, v198, v182, -v183
v_fma_f32 v187, v198, v186, -v185
v_fma_f32 v180, v198, v181, -v182
v_cvt_pk_bf16_f32 v100, v180, v181
v_cvt_pk_bf16_f32 v101, v182, v183
v_cvt_pk_bf16_f32 v102, v184, v185
v_cvt_pk_bf16_f32 v103, v186, v187
s_mov_b32 s20, 339
v_mad_u32_u24 v191, v200, s20, v201
v_cvt_f32_u32 v191, v191
v_mul_f32 v202, s19, v191
v_rndne_f32 v202, v202
v_fmac_f32 v191, 0xc4200000, v202
v_mul_f32 v191, s19, v191
v_cos_f32 v191, v191
s_mov_b32 s20, 340
v_mad_u32_u24 v192, v200, s20, v201
v_cvt_f32_u32 v192, v192
v_mul_f32 v202, s19, v192
v_rndne_f32 v202, v202
v_fmac_f32 v192, 0xc4200000, v202
v_mul_f32 v192, s19, v192
v_cos_f32 v192, v192
s_nop 0
v_fma_f32 v193, v198, v192, -v191
v_fma_f32 v190, v198, v191, -v192
v_fma_f32 v194, v198, v193, -v192
v_fma_f32 v189, v198, v190, -v191
v_fma_f32 v195, v198, v194, -v193
v_fma_f32 v188, v198, v189, -v190
v_cvt_pk_bf16_f32 v104, v188, v189
v_cvt_pk_bf16_f32 v105, v190, v191
v_cvt_pk_bf16_f32 v106, v192, v193
v_cvt_pk_bf16_f32 v107, v194, v195
v_pk_fma_f32 v[180:181], v[196:197], v[188:189], v[180:181] op_sel_hi:[0,1,1] neg_lo:[0,0,1] neg_hi:[0,0,1]
v_pk_fma_f32 v[182:183], v[196:197], v[190:191], v[182:183] op_sel_hi:[0,1,1] neg_lo:[0,0,1] neg_hi:[0,0,1]
v_pk_fma_f32 v[184:185], v[196:197], v[192:193], v[184:185] op_sel_hi:[0,1,1] neg_lo:[0,0,1] neg_hi:[0,0,1]
v_pk_fma_f32 v[186:187], v[196:197], v[194:195], v[186:187] op_sel_hi:[0,1,1] neg_lo:[0,0,1] neg_hi:[0,0,1]
v_cvt_pk_bf16_f32 v108, v180, v181
v_cvt_pk_bf16_f32 v109, v182, v183
v_cvt_pk_bf16_f32 v110, v184, v185
v_cvt_pk_bf16_f32 v111, v186, v187
v_pk_fma_f32 v[188:189], v[196:197], v[180:181], v[188:189] op_sel_hi:[0,1,1] neg_lo:[0,0,1] neg_hi:[0,0,1]
v_pk_fma_f32 v[190:191], v[196:197], v[182:183], v[190:191] op_sel_hi:[0,1,1] neg_lo:[0,0,1] neg_hi:[0,0,1]
v_pk_fma_f32 v[192:193], v[196:197], v[184:185], v[192:193] op_sel_hi:[0,1,1] neg_lo:[0,0,1] neg_hi:[0,0,1]
v_pk_fma_f32 v[194:195], v[196:197], v[186:187], v[194:195] op_sel_hi:[0,1,1] neg_lo:[0,0,1] neg_hi:[0,0,1]
v_cvt_pk_bf16_f32 v112, v188, v189
v_cvt_pk_bf16_f32 v113, v190, v191
v_cvt_pk_bf16_f32 v114, v192, v193
v_cvt_pk_bf16_f32 v115, v194, v195
v_pk_fma_f32 v[180:181], v[196:197], v[188:189], v[180:181] op_sel_hi:[0,1,1] neg_lo:[0,0,1] neg_hi:[0,0,1]
v_pk_fma_f32 v[182:183], v[196:197], v[190:191], v[182:183] op_sel_hi:[0,1,1] neg_lo:[0,0,1] neg_hi:[0,0,1]
v_pk_fma_f32 v[184:185], v[196:197], v[192:193], v[184:185] op_sel_hi:[0,1,1] neg_lo:[0,0,1] neg_hi:[0,0,1]
v_pk_fma_f32 v[186:187], v[196:197], v[194:195], v[186:187] op_sel_hi:[0,1,1] neg_lo:[0,0,1] neg_hi:[0,0,1]
v_cvt_pk_bf16_f32 v116, v180, v181
v_cvt_pk_bf16_f32 v117, v182, v183
v_cvt_pk_bf16_f32 v118, v184, v185
v_cvt_pk_bf16_f32 v119, v186, v187
v_pk_fma_f32 v[188:189], v[196:197], v[180:181], v[188:189] op_sel_hi:[0,1,1] neg_lo:[0,0,1] neg_hi:[0,0,1]
v_pk_fma_f32 v[190:191], v[196:197], v[182:183], v[190:191] op_sel_hi:[0,1,1] neg_lo:[0,0,1] neg_hi:[0,0,1]
v_pk_fma_f32 v[192:193], v[196:197], v[184:185], v[192:193] op_sel_hi:[0,1,1] neg_lo:[0,0,1] neg_hi:[0,0,1]
v_pk_fma_f32 v[194:195], v[196:197], v[186:187], v[194:195] op_sel_hi:[0,1,1] neg_lo:[0,0,1] neg_hi:[0,0,1]
v_cvt_pk_bf16_f32 v120, v188, v189
v_cvt_pk_bf16_f32 v121, v190, v191
v_cvt_pk_bf16_f32 v122, v192, v193
v_cvt_pk_bf16_f32 v123, v194, v195
v_pk_fma_f32 v[180:181], v[196:197], v[188:189], v[180:181] op_sel_hi:[0,1,1] neg_lo:[0,0,1] neg_hi:[0,0,1]
v_pk_fma_f32 v[182:183], v[196:197], v[190:191], v[182:183] op_sel_hi:[0,1,1] neg_lo:[0,0,1] neg_hi:[0,0,1]
v_pk_fma_f32 v[184:185], v[196:197], v[192:193], v[184:185] op_sel_hi:[0,1,1] neg_lo:[0,0,1] neg_hi:[0,0,1]
v_pk_fma_f32 v[186:187], v[196:197], v[194:195], v[186:187] op_sel_hi:[0,1,1] neg_lo:[0,0,1] neg_hi:[0,0,1]
v_cvt_pk_bf16_f32 v124, v180, v181
v_cvt_pk_bf16_f32 v125, v182, v183
v_cvt_pk_bf16_f32 v126, v184, v185
v_cvt_pk_bf16_f32 v127, v186, v187
v_pk_fma_f32 v[188:189], v[196:197], v[180:181], v[188:189] op_sel_hi:[0,1,1] neg_lo:[0,0,1] neg_hi:[0,0,1]
v_pk_fma_f32 v[190:191], v[196:197], v[182:183], v[190:191] op_sel_hi:[0,1,1] neg_lo:[0,0,1] neg_hi:[0,0,1]
v_pk_fma_f32 v[192:193], v[196:197], v[184:185], v[192:193] op_sel_hi:[0,1,1] neg_lo:[0,0,1] neg_hi:[0,0,1]
v_pk_fma_f32 v[194:195], v[196:197], v[186:187], v[194:195] op_sel_hi:[0,1,1] neg_lo:[0,0,1] neg_hi:[0,0,1]
v_cvt_pk_bf16_f32 v128, v188, v189
v_cvt_pk_bf16_f32 v129, v190, v191
v_cvt_pk_bf16_f32 v130, v192, v193
v_cvt_pk_bf16_f32 v131, v194, v195
v_pk_fma_f32 v[180:181], v[196:197], v[188:189], v[180:181] op_sel_hi:[0,1,1] neg_lo:[0,0,1] neg_hi:[0,0,1]
v_pk_fma_f32 v[182:183], v[196:197], v[190:191], v[182:183] op_sel_hi:[0,1,1] neg_lo:[0,0,1] neg_hi:[0,0,1]
v_pk_fma_f32 v[184:185], v[196:197], v[192:193], v[184:185] op_sel_hi:[0,1,1] neg_lo:[0,0,1] neg_hi:[0,0,1]
v_pk_fma_f32 v[186:187], v[196:197], v[194:195], v[186:187] op_sel_hi:[0,1,1] neg_lo:[0,0,1] neg_hi:[0,0,1]
v_cvt_pk_bf16_f32 v132, v180, v181
v_cvt_pk_bf16_f32 v133, v182, v183
v_cvt_pk_bf16_f32 v134, v184, v185
v_cvt_pk_bf16_f32 v135, v186, v187
v_pk_fma_f32 v[188:189], v[196:197], v[180:181], v[188:189] op_sel_hi:[0,1,1] neg_lo:[0,0,1] neg_hi:[0,0,1]
v_pk_fma_f32 v[190:191], v[196:197], v[182:183], v[190:191] op_sel_hi:[0,1,1] neg_lo:[0,0,1] neg_hi:[0,0,1]
v_pk_fma_f32 v[192:193], v[196:197], v[184:185], v[192:193] op_sel_hi:[0,1,1] neg_lo:[0,0,1] neg_hi:[0,0,1]
v_pk_fma_f32 v[194:195], v[196:197], v[186:187], v[194:195] op_sel_hi:[0,1,1] neg_lo:[0,0,1] neg_hi:[0,0,1]
v_cvt_pk_bf16_f32 v136, v188, v189
v_cvt_pk_bf16_f32 v137, v190, v191
v_cvt_pk_bf16_f32 v138, v192, v193
v_cvt_pk_bf16_f32 v139, v194, v195
v_pk_fma_f32 v[180:181], v[196:197], v[188:189], v[180:181] op_sel_hi:[0,1,1] neg_lo:[0,0,1] neg_hi:[0,0,1]
v_pk_fma_f32 v[182:183], v[196:197], v[190:191], v[182:183] op_sel_hi:[0,1,1] neg_lo:[0,0,1] neg_hi:[0,0,1]
v_pk_fma_f32 v[184:185], v[196:197], v[192:193], v[184:185] op_sel_hi:[0,1,1] neg_lo:[0,0,1] neg_hi:[0,0,1]
v_pk_fma_f32 v[186:187], v[196:197], v[194:195], v[186:187] op_sel_hi:[0,1,1] neg_lo:[0,0,1] neg_hi:[0,0,1]
v_cvt_pk_bf16_f32 v140, v180, v181
v_cvt_pk_bf16_f32 v141, v182, v183
v_cvt_pk_bf16_f32 v142, v184, v185
v_cvt_pk_bf16_f32 v143, v186, v187
v_pk_fma_f32 v[188:189], v[196:197], v[180:181], v[188:189] op_sel_hi:[0,1,1] neg_lo:[0,0,1] neg_hi:[0,0,1]
v_pk_fma_f32 v[190:191], v[196:197], v[182:183], v[190:191] op_sel_hi:[0,1,1] neg_lo:[0,0,1] neg_hi:[0,0,1]
v_pk_fma_f32 v[192:193], v[196:197], v[184:185], v[192:193] op_sel_hi:[0,1,1] neg_lo:[0,0,1] neg_hi:[0,0,1]
v_pk_fma_f32 v[194:195], v[196:197], v[186:187], v[194:195] op_sel_hi:[0,1,1] neg_lo:[0,0,1] neg_hi:[0,0,1]
v_cvt_pk_bf16_f32 v144, v188, v189
v_cvt_pk_bf16_f32 v145, v190, v191
v_cvt_pk_bf16_f32 v146, v192, v193
v_cvt_pk_bf16_f32 v147, v194, v195
v_pk_fma_f32 v[180:181], v[196:197], v[188:189], v[180:181] op_sel_hi:[0,1,1] neg_lo:[0,0,1] neg_hi:[0,0,1]
v_pk_fma_f32 v[182:183], v[196:197], v[190:191], v[182:183] op_sel_hi:[0,1,1] neg_lo:[0,0,1] neg_hi:[0,0,1]
v_pk_fma_f32 v[184:185], v[196:197], v[192:193], v[184:185] op_sel_hi:[0,1,1] neg_lo:[0,0,1] neg_hi:[0,0,1]
v_pk_fma_f32 v[186:187], v[196:197], v[194:195], v[186:187] op_sel_hi:[0,1,1] neg_lo:[0,0,1] neg_hi:[0,0,1]
v_cvt_pk_bf16_f32 v148, v180, v181
v_cvt_pk_bf16_f32 v149, v182, v183
v_cvt_pk_bf16_f32 v150, v184, v185
v_cvt_pk_bf16_f32 v151, v186, v187
v_pk_fma_f32 v[188:189], v[196:197], v[180:181], v[188:189] op_sel_hi:[0,1,1] neg_lo:[0,0,1] neg_hi:[0,0,1]
v_pk_fma_f32 v[190:191], v[196:197], v[182:183], v[190:191] op_sel_hi:[0,1,1] neg_lo:[0,0,1] neg_hi:[0,0,1]
v_pk_fma_f32 v[192:193], v[196:197], v[184:185], v[192:193] op_sel_hi:[0,1,1] neg_lo:[0,0,1] neg_hi:[0,0,1]
v_pk_fma_f32 v[194:195], v[196:197], v[186:187], v[194:195] op_sel_hi:[0,1,1] neg_lo:[0,0,1] neg_hi:[0,0,1]
v_cvt_pk_bf16_f32 v152, v188, v189
v_cvt_pk_bf16_f32 v153, v190, v191
v_cvt_pk_bf16_f32 v154, v192, v193
v_cvt_pk_bf16_f32 v155, v194, v195
v_pk_fma_f32 v[180:181], v[196:197], v[188:189], v[180:181] op_sel_hi:[0,1,1] neg_lo:[0,0,1] neg_hi:[0,0,1]
v_pk_fma_f32 v[182:183], v[196:197], v[190:191], v[182:183] op_sel_hi:[0,1,1] neg_lo:[0,0,1] neg_hi:[0,0,1]
v_pk_fma_f32 v[184:185], v[196:197], v[192:193], v[184:185] op_sel_hi:[0,1,1] neg_lo:[0,0,1] neg_hi:[0,0,1]
v_pk_fma_f32 v[186:187], v[196:197], v[194:195], v[186:187] op_sel_hi:[0,1,1] neg_lo:[0,0,1] neg_hi:[0,0,1]
v_cvt_pk_bf16_f32 v156, v180, v181
v_cvt_pk_bf16_f32 v157, v182, v183
v_cvt_pk_bf16_f32 v158, v184, v185
v_cvt_pk_bf16_f32 v159, v186, v187
v_pk_fma_f32 v[188:189], v[196:197], v[180:181], v[188:189] op_sel_hi:[0,1,1] neg_lo:[0,0,1] neg_hi:[0,0,1]
v_pk_fma_f32 v[190:191], v[196:197], v[182:183], v[190:191] op_sel_hi:[0,1,1] neg_lo:[0,0,1] neg_hi:[0,0,1]
v_pk_fma_f32 v[192:193], v[196:197], v[184:185], v[192:193] op_sel_hi:[0,1,1] neg_lo:[0,0,1] neg_hi:[0,0,1]
v_pk_fma_f32 v[194:195], v[196:197], v[186:187], v[194:195] op_sel_hi:[0,1,1] neg_lo:[0,0,1] neg_hi:[0,0,1]
v_cvt_pk_bf16_f32 v160, v188, v189
v_cvt_pk_bf16_f32 v161, v190, v191
v_cvt_pk_bf16_f32 v162, v192, v193
v_cvt_pk_bf16_f32 v163, v194, v195
v_pk_fma_f32 v[180:181], v[196:197], v[188:189], v[180:181] op_sel_hi:[0,1,1] neg_lo:[0,0,1] neg_hi:[0,0,1]
v_pk_fma_f32 v[182:183], v[196:197], v[190:191], v[182:183] op_sel_hi:[0,1,1] neg_lo:[0,0,1] neg_hi:[0,0,1]
v_pk_fma_f32 v[184:185], v[196:197], v[192:193], v[184:185] op_sel_hi:[0,1,1] neg_lo:[0,0,1] neg_hi:[0,0,1]
v_pk_fma_f32 v[186:187], v[196:197], v[194:195], v[186:187] op_sel_hi:[0,1,1] neg_lo:[0,0,1] neg_hi:[0,0,1]
v_cvt_pk_bf16_f32 v164, v180, v181
v_cvt_pk_bf16_f32 v165, v182, v183
v_cvt_pk_bf16_f32 v166, v184, v185
v_cvt_pk_bf16_f32 v167, v186, v187
v_pk_fma_f32 v[188:189], v[196:197], v[180:181], v[188:189] op_sel_hi:[0,1,1] neg_lo:[0,0,1] neg_hi:[0,0,1]
v_pk_fma_f32 v[190:191], v[196:197], v[182:183], v[190:191] op_sel_hi:[0,1,1] neg_lo:[0,0,1] neg_hi:[0,0,1]
v_pk_fma_f32 v[192:193], v[196:197], v[184:185], v[192:193] op_sel_hi:[0,1,1] neg_lo:[0,0,1] neg_hi:[0,0,1]
v_pk_fma_f32 v[194:195], v[196:197], v[186:187], v[194:195] op_sel_hi:[0,1,1] neg_lo:[0,0,1] neg_hi:[0,0,1]
v_cvt_pk_bf16_f32 v168, v188, v189
v_cvt_pk_bf16_f32 v169, v190, v191
v_cvt_pk_bf16_f32 v170, v192, v193
v_cvt_pk_bf16_f32 v171, v194, v195
v_pk_fma_f32 v[180:181], v[196:197], v[188:189], v[180:181] op_sel_hi:[0,1,1] neg_lo:[0,0,1] neg_hi:[0,0,1]
v_pk_fma_f32 v[182:183], v[196:197], v[190:191], v[182:183] op_sel_hi:[0,1,1] neg_lo:[0,0,1] neg_hi:[0,0,1]
v_pk_fma_f32 v[184:185], v[196:197], v[192:193], v[184:185] op_sel_hi:[0,1,1] neg_lo:[0,0,1] neg_hi:[0,0,1]
v_pk_fma_f32 v[186:187], v[196:197], v[194:195], v[186:187] op_sel_hi:[0,1,1] neg_lo:[0,0,1] neg_hi:[0,0,1]
v_cvt_pk_bf16_f32 v172, v180, v181
v_cvt_pk_bf16_f32 v173, v182, v183
v_cvt_pk_bf16_f32 v174, v184, v185
v_cvt_pk_bf16_f32 v175, v186, v187
v_pk_fma_f32 v[188:189], v[196:197], v[180:181], v[188:189] op_sel_hi:[0,1,1] neg_lo:[0,0,1] neg_hi:[0,0,1]
v_pk_fma_f32 v[190:191], v[196:197], v[182:183], v[190:191] op_sel_hi:[0,1,1] neg_lo:[0,0,1] neg_hi:[0,0,1]
v_pk_fma_f32 v[192:193], v[196:197], v[184:185], v[192:193] op_sel_hi:[0,1,1] neg_lo:[0,0,1] neg_hi:[0,0,1]
v_pk_fma_f32 v[194:195], v[196:197], v[186:187], v[194:195] op_sel_hi:[0,1,1] neg_lo:[0,0,1] neg_hi:[0,0,1]
v_cvt_pk_bf16_f32 v176, v188, v189
v_cvt_pk_bf16_f32 v177, v190, v191
v_cvt_pk_bf16_f32 v178, v192, v193
v_cvt_pk_bf16_f32 v179, v194, v195
v_mov_b32 v180, s24
v_mov_b32 v181, s24
v_mov_b32 v182, s24
v_mov_b32 v183, s24
s_nop 1
v_mfma_f32_32x32x16_bf16 v[184:199], v[180:183], v[20:23], 0
v_mfma_f32_32x32x16_bf16 v[184:199], v[180:183], v[24:27], v[184:199]
v_mfma_f32_32x32x16_bf16 v[184:199], v[180:183], v[28:31], v[184:199]
v_mfma_f32_32x32x16_bf16 v[184:199], v[180:183], v[32:35], v[184:199]
v_mfma_f32_32x32x16_bf16 v[184:199], v[180:183], v[36:39], v[184:199]
v_mfma_f32_32x32x16_bf16 v[184:199], v[180:183], v[40:43], v[184:199]
v_mfma_f32_32x32x16_bf16 v[184:199], v[180:183], v[44:47], v[184:199]
v_mfma_f32_32x32x16_bf16 v[184:199], v[180:183], v[48:51], v[184:199]
v_mfma_f32_32x32x16_bf16 v[184:199], v[180:183], v[52:55], v[184:199]
v_mfma_f32_32x32x16_bf16 v[184:199], v[180:183], v[56:59], v[184:199]
v_mfma_f32_32x32x16_bf16 v[184:199], v[180:183], v[60:63], v[184:199]
v_mfma_f32_32x32x16_bf16 v[184:199], v[180:183], v[64:67], v[184:199]
v_mfma_f32_32x32x16_bf16 v[184:199], v[180:183], v[68:71], v[184:199]
v_mfma_f32_32x32x16_bf16 v[184:199], v[180:183], v[72:75], v[184:199]
v_mfma_f32_32x32x16_bf16 v[184:199], v[180:183], v[76:79], v[184:199]
v_mfma_f32_32x32x16_bf16 v[184:199], v[180:183], v[80:83], v[184:199]
v_mfma_f32_32x32x16_bf16 v[184:199], v[180:183], v[84:87], v[184:199]
v_mfma_f32_32x32x16_bf16 v[184:199], v[180:183], v[88:91], v[184:199]
v_mfma_f32_32x32x16_bf16 v[184:199], v[180:183], v[92:95], v[184:199]
v_mfma_f32_32x32x16_bf16 v[184:199], v[180:183], v[96:99], v[184:199]
v_mfma_f32_32x32x16_bf16 v[184:199], v[180:183], v[100:103], v[184:199]
v_mfma_f32_32x32x16_bf16 v[184:199], v[180:183], v[104:107], v[184:199]
v_mfma_f32_32x32x16_bf16 v[184:199], v[180:183], v[108:111], v[184:199]
v_mfma_f32_32x32x16_bf16 v[184:199], v[180:183], v[112:115], v[184:199]
v_mfma_f32_32x32x16_bf16 v[184:199], v[180:183], v[116:119], v[184:199]
v_mfma_f32_32x32x16_bf16 v[184:199], v[180:183], v[120:123], v[184:199]
v_mfma_f32_32x32x16_bf16 v[184:199], v[180:183], v[124:127], v[184:199]
v_mfma_f32_32x32x16_bf16 v[184:199], v[180:183], v[128:131], v[184:199]
v_mfma_f32_32x32x16_bf16 v[184:199], v[180:183], v[132:135], v[184:199]
v_mfma_f32_32x32x16_bf16 v[184:199], v[180:183], v[136:139], v[184:199]
v_mfma_f32_32x32x16_bf16 v[184:199], v[180:183], v[140:143], v[184:199]
v_mfma_f32_32x32x16_bf16 v[184:199], v[180:183], v[144:147], v[184:199]
v_mfma_f32_32x32x16_bf16 v[184:199], v[180:183], v[148:151], v[184:199]
v_mfma_f32_32x32x16_bf16 v[184:199], v[180:183], v[152:155], v[184:199]
v_mfma_f32_32x32x16_bf16 v[184:199], v[180:183], v[156:159], v[184:199]
v_mfma_f32_32x32x16_bf16 v[184:199], v[180:183], v[160:163], v[184:199]
v_mfma_f32_32x32x16_bf16 v[184:199], v[180:183], v[164:167], v[184:199]
v_mfma_f32_32x32x16_bf16 v[184:199], v[180:183], v[168:171], v[184:199]
v_mfma_f32_32x32x16_bf16 v[184:199], v[180:183], v[172:175], v[184:199]
v_mfma_f32_32x32x16_bf16 v[184:199], v[180:183], v[176:179], v[184:199]
s_nop 11
v_mov_b32 v9, v184
p1q_40:
s_mul_i32 s18, s30, 21846
s_lshr_b32 s18, s18, 16
s_mul_i32 s18, s18, 3
s_sub_u32 s18, s30, s18
s_and_b32 s19, s30, 3
s_cmp_lt_u32 s30, 56
s_cselect_b32 s18, s18, s19
s_mul_i32 s18, s18, 2560
s_add_u32 s18, s18, 11558912
s_add_u32 s29, s30, 1
s_cmp_lg_u32 s13, 0
s_cbranch_scc1 polld_42
v_lshlrev_b32 v15, 3, v0
v_min_u32 v15, 2432, v15
s_mov_b32 s17, 0
poll_41:
buffer_load_dword v12, v15, s[4:7], s18 offen sc1
s_add_u32 s17, s17, 1
s_cmp_gt_u32 s17, 262144
s_cbranch_scc1 L_fail
s_waitcnt vmcnt(0)
v_cmp_gt_u32 vcc, s29, v12
s_cbranch_vccz polld_42
s_sleep 2
s_branch poll_41
polld_42:
s_barrier
s_mul_i32 s18, s30, 40960
s_add_u32 s26, s18, 91226112
s_add_u32 s26, s26, s31
s_add_u32 s27, s18, 100663296
s_add_u32 s27, s27, s33
s_add_u32 m0, s31, 2048
s_add_u32 s20, s26, 0
buffer_load_dwordx4 v0, s[4:7], s20 offen sc1 lds
s_add_u32 m0, s31, 3072
s_add_u32 s20, s26, 1024
buffer_load_dwordx4 v0, s[4:7], s20 offen sc1 lds
s_add_u32 m0, s31, 4096
s_add_u32 s20, s26, 2048
buffer_load_dwordx4 v0, s[4:7], s20 offen sc1 lds
s_add_u32 m0, s31, 5120
s_add_u32 s20, s26, 3072
buffer_load_dwordx4 v0, s[4:7], s20 offen sc1 lds
s_add_u32 m0, s31, 6144
s_add_u32 s20, s26, 4096
buffer_load_dwordx4 v0, s[4:7], s20 offen sc1 lds
s_add_u32 m0, s31, 7168
s_add_u32 s20, s26, 5120
buffer_load_dwordx4 v0, s[4:7], s20 offen sc1 lds
s_add_u32 m0, s31, 8192
s_add_u32 s20, s26, 6144
buffer_load_dwordx4 v0, s[4:7], s20 offen sc1 lds
s_add_u32 m0, s31, 9216
s_add_u32 s20, s26, 7168
buffer_load_dwordx4 v0, s[4:7], s20 offen sc1 lds
s_add_u32 m0, s31, 10240
s_add_u32 s20, s26, 8192
buffer_load_dwordx4 v0, s[4:7], s20 offen sc1 lds
s_add_u32 m0, s31, 11264
s_add_u32 s20, s26, 9216
buffer_load_dwordx4 v0, s[4:7], s20 offen sc1 lds
s_waitcnt vmcnt(0)
s_barrier
v_add_u32 v2, s31, v0
ds_read_b128 v[220:223], v2 offset:2048
ds_read_b128 v[224:227], v2 offset:3072
ds_read_b128 v[228:231], v2 offset:4096
ds_read_b128 v[200:203], v0 offset:3072
ds_read_b128 v[232:235], v2 offset:5120
ds_read_b128 v[196:199], v0 offset:2048
v_mov_b64 v[212:213], 0
ds_read_b128 v[204:207], v0 offset:4096
ds_read_b128 v[208:211], v0 offset:5120
s_waitcnt lgkmcnt(7)
v_dot2c_f32_bf16 v212, s24, v220
v_dot2c_f32_bf16 v213, v220, v220
v_dot2c_f32_bf16 v212, s24, v221
v_dot2c_f32_bf16 v213, v221, v221
v_dot2c_f32_bf16 v212, s24, v222
v_dot2c_f32_bf16 v213, v222, v222
v_dot2c_f32_bf16 v212, s24, v223
s_waitcnt lgkmcnt(5)
v_dot2c_f32_bf16 v213, v223, v223
v_dot2c_f32_bf16 v212, s24, v224
v_dot2c_f32_bf16 v213, v224, v224
v_dot2c_f32_bf16 v212, s24, v225
v_dot2c_f32_bf16 v213, v225, v225
v_dot2c_f32_bf16 v212, s24, v226
v_dot2c_f32_bf16 v213, v226, v226
v_dot2c_f32_bf16 v212, s24, v227
v_dot2c_f32_bf16 v213, v227, v227
v_dot2c_f32_bf16 v212, s24, v228
v_dot2c_f32_bf16 v213, v228, v228
s_waitcnt lgkmcnt(3)
ds_read_b128 v[220:223], v2 offset:6144
ds_read_b128 v[224:227], v2 offset:7168
v_dot2c_f32_bf16 v212, s24, v229
v_dot2c_f32_bf16 v213, v229, v229
v_dot2c_f32_bf16 v212, s24, v230
v_dot2c_f32_bf16 v213, v230, v230
v_dot2c_f32_bf16 v212, s24, v231
v_dot2c_f32_bf16 v213, v231, v231
v_dot2c_f32_bf16 v212, s24, v232
v_dot2c_f32_bf16 v213, v232, v232
v_dot2c_f32_bf16 v212, s24, v233
v_dot2c_f32_bf16 v213, v233, v233
v_dot2c_f32_bf16 v212, s24, v234
v_dot2c_f32_bf16 v213, v234, v234
v_dot2c_f32_bf16 v212, s24, v235
v_dot2c_f32_bf16 v213, v235, v235
s_waitcnt lgkmcnt(1)
ds_read_b128 v[232:235], v2 offset:9216
ds_read_b128 v[228:231], v2 offset:8192
v_dot2c_f32_bf16 v212, s24, v220
v_dot2c_f32_bf16 v213, v220, v220
v_dot2c_f32_bf16 v212, s24, v221
s_waitcnt lgkmcnt(2)
v_dot2c_f32_bf16 v213, v221, v221
v_dot2c_f32_bf16 v212, s24, v222
v_dot2c_f32_bf16 v213, v222, v222
v_dot2c_f32_bf16 v212, s24, v223
v_dot2c_f32_bf16 v213, v223, v223
v_dot2c_f32_bf16 v212, s24, v224
v_dot2c_f32_bf16 v213, v224, v224
v_dot2c_f32_bf16 v212, s24, v225
v_dot2c_f32_bf16 v213, v225, v225
v_dot2c_f32_bf16 v212, s24, v226
v_dot2c_f32_bf16 v213, v226, v226
v_dot2c_f32_bf16 v212, s24, v227
v_dot2c_f32_bf16 v213, v227, v227
s_waitcnt lgkmcnt(0)
ds_read_b128 v[220:223], v2 offset:10240
ds_read_b128 v[224:227], v2 offset:11264
v_dot2c_f32_bf16 v212, s24, v228
v_dot2c_f32_bf16 v213, v228, v228
v_dot2c_f32_bf16 v212, s24, v229
v_dot2c_f32_bf16 v213, v229, v229
v_dot2c_f32_bf16 v212, s24, v230
v_dot2c_f32_bf16 v213, v230, v230
v_dot2c_f32_bf16 v212, s24, v231
v_dot2c_f32_bf16 v213, v231, v231
v_dot2c_f32_bf16 v212, s24, v232
v_dot2c_f32_bf16 v213, v232, v232
v_dot2c_f32_bf16 v212, s24, v233
v_dot2c_f32_bf16 v213, v233, v233
v_dot2c_f32_bf16 v212, s24, v234
v_dot2c_f32_bf16 v213, v234, v234
s_waitcnt lgkmcnt(1)
v_dot2c_f32_bf16 v212, s24, v235
v_dot2c_f32_bf16 v213, v235, v235
v_dot2c_f32_bf16 v212, s24, v220
s_waitcnt lgkmcnt(0)
v_dot2c_f32_bf16 v213, v220, v220
v_dot2c_f32_bf16 v212, s24, v221
v_dot2c_f32_bf16 v213, v221, v221
v_dot2c_f32_bf16 v212, s24, v222
v_dot2c_f32_bf16 v213, v222, v222
v_dot2c_f32_bf16 v212, s24, v223
v_dot2c_f32_bf16 v213, v223, v223
v_dot2c_f32_bf16 v212, s24, v224
v_dot2c_f32_bf16 v213, v224, v224
v_dot2c_f32_bf16 v212, s24, v225
v_dot2c_f32_bf16 v213, v225, v225
v_dot2c_f32_bf16 v212, s24, v226
v_dot2c_f32_bf16 v213, v226, v226
v_dot2c_f32_bf16 v212, s24, v227
v_dot2c_f32_bf16 v213, v227, v227
v_mfma_f32_32x32x16_bf16 v[180:195], v[196:199], v[20:23], 0
s_nop 1
v_permlane32_swap_b32 v212, v213
ds_read_b128 v[196:199], v0 offset:6144
v_mfma_f32_32x32x16_bf16 v[180:195], v[200:203], v[24:27], v[180:195]
v_and_b32 v2, 0x1ff, v0
v_add_f32 v212, v212, v213
v_mfma_f32_32x32x16_bf16 v[180:195], v[204:207], v[28:31], v[180:195]
v_lshl_add_u32 v213, s13, 2, v0
ds_read_b128 v[200:203], v0 offset:7168
ds_write_b32 v213, v212 offset:0
v_mfma_f32_32x32x16_bf16 v[180:195], v[208:211], v[32:35], v[180:195]
s_waitcnt lgkmcnt(2)
ds_read_b128 v[204:207], v0 offset:8192
ds_read_b128 v[208:211], v0 offset:9216
v_mfma_f32_32x32x16_bf16 v[180:195], v[196:199], v[36:39], v[180:195]
s_waitcnt lgkmcnt(3)
v_mfma_f32_32x32x16_bf16 v[180:195], v[200:203], v[40:43], v[180:195]
s_waitcnt lgkmcnt(2)
ds_read_b128 v[196:199], v0 offset:10240
s_waitcnt lgkmcnt(2)
s_waitcnt lgkmcnt(1)
v_mfma_f32_32x32x16_bf16 v[180:195], v[204:207], v[44:47], v[180:195]
ds_read_b128 v[200:203], v0 offset:11264
s_barrier
ds_read_b128 v[212:215], v2 offset:0
v_mfma_f32_32x32x16_bf16 v[180:195], v[208:211], v[48:51], v[180:195]
ds_read_b128 v[208:211], v0 offset:13312
ds_read_b128 v[204:207], v0 offset:12288
s_waitcnt lgkmcnt(4)
v_mfma_f32_32x32x16_bf16 v[180:195], v[196:199], v[52:55], v[180:195]
s_waitcnt lgkmcnt(3)
ds_read_b128 v[216:219], v2 offset:512
ds_read_b128 v[196:199], v0 offset:14336
v_mfma_f32_32x32x16_bf16 v[180:195], v[200:203], v[56:59], v[180:195]
s_waitcnt lgkmcnt(2)
v_mfma_f32_32x32x16_bf16 v[180:195], v[204:207], v[60:63], v[180:195]
ds_read_b128 v[200:203], v0 offset:15360
ds_read_b128 v[204:207], v0 offset:16384
v_add_f32 v212, v212, v213
v_add_f32 v214, v214, v215
s_waitcnt lgkmcnt(3)
v_mfma_f32_32x32x16_bf16 v[180:195], v[208:211], v[64:67], v[180:195]
s_waitcnt lgkmcnt(2)
ds_read_b128 v[208:211], v0 offset:17408
v_add_f32 v216, v216, v217
v_add_f32 v212, v212, v214
v_mfma_f32_32x32x16_bf16 v[180:195], v[196:199], v[68:71], v[180:195]
s_waitcnt lgkmcnt(2)
v_mfma_f32_32x32x16_bf16 v[180:195], v[200:203], v[72:75], v[180:195]
v_mul_f32 v212, 0x3acccccd, v212
s_waitcnt lgkmcnt(1)
ds_read_b128 v[196:199], v0 offset:18432
v_add_f32 v218, v218, v219
s_waitcnt lgkmcnt(1)
v_mfma_f32_32x32x16_bf16 v[180:195], v[204:207], v[76:79], v[180:195]
v_lshrrev_b32 v213, 2, v0
ds_read_b128 v[200:203], v0 offset:19456
v_mfma_f32_32x32x16_bf16 v[180:195], v[208:211], v[80:83], v[180:195]
ds_read_b128 v[204:207], v0 offset:20480
ds_read_b128 v[208:211], v0 offset:21504
v_add_f32 v216, v216, v218
v_mul_f32 v216, 0x3acccccd, v216
s_waitcnt lgkmcnt(3)
v_mfma_f32_32x32x16_bf16 v[180:195], v[196:199], v[84:87], v[180:195]
v_fma_f32 v216, -v212, v212, v216
s_waitcnt lgkmcnt(2)
v_max_f32 v216, 0, v216
v_add_f32 v216, 0x3727c5ac, v216
v_mfma_f32_32x32x16_bf16 v[180:195], v[200:203], v[88:91], v[180:195]
ds_read_b128 v[196:199], v0 offset:22528
s_waitcnt lgkmcnt(2)
v_bfe_u32 v214, v0, 5, 5
v_lshl_add_u32 v213, s13, 8, v213
v_mfma_f32_32x32x16_bf16 v[180:195], v[204:207], v[92:95], v[180:195]
ds_read_b128 v[200:203], v0 offset:23552
ds_read_b128 v[204:207], v0 offset:24576
v_rsq_f32 v216, v216
s_waitcnt lgkmcnt(3)
v_and_b32 v214, 16, v214
v_mfma_f32_32x32x16_bf16 v[180:195], v[208:211], v[96:99], v[180:195]
ds_read_b128 v[208:211], v0 offset:25600
s_waitcnt lgkmcnt(3)
v_mul_f32 v212, v216, v212
v_mfma_f32_32x32x16_bf16 v[180:195], v[196:199], v[100:103], v[180:195]
v_lshl_add_u32 v214, s13, 8, v214
v_permlane32_swap_b32 v216, v212
s_waitcnt lgkmcnt(2)
ds_read_b128 v[196:199], v0 offset:26624
v_mfma_f32_32x32x16_bf16 v[180:195], v[200:203], v[104:107], v[180:195]
ds_write_b32 v213, v216 offset:1024
s_waitcnt lgkmcnt(3)
s_waitcnt lgkmcnt(2)
v_mfma_f32_32x32x16_bf16 v[180:195], v[204:207], v[108:111], v[180:195]
ds_read_b128 v[244:247], v214 offset:1216
ds_read_b128 v[200:203], v0 offset:27648
v_mfma_f32_32x32x16_bf16 v[180:195], v[208:211], v[112:115], v[180:195]
ds_read_b128 v[204:207], v0 offset:28672
s_waitcnt lgkmcnt(4)
ds_read_b128 v[236:239], v214 offset:1152
v_mfma_f32_32x32x16_bf16 v[180:195], v[196:199], v[116:119], v[180:195]
ds_read_b128 v[208:211], v0 offset:29696
ds_read_b128 v[196:199], v0 offset:30720
s_waitcnt lgkmcnt(4)
v_mfma_f32_32x32x16_bf16 v[180:195], v[200:203], v[120:123], v[180:195]
ds_read_b128 v[232:235], v214 offset:1120
s_waitcnt lgkmcnt(4)
ds_read_b128 v[220:223], v214 offset:1024
ds_read_b128 v[200:203], v0 offset:31744
v_mfma_f32_32x32x16_bf16 v[180:195], v[204:207], v[124:127], v[180:195]
v_mul_f32 v245, v245, v9
s_waitcnt lgkmcnt(3)
ds_read_b128 v[204:207], v0 offset:32768
v_mfma_f32_32x32x16_bf16 v[180:195], v[208:211], v[128:131], v[180:195]
ds_read_b128 v[224:227], v214 offset:1056
v_mfma_f32_32x32x16_bf16 v[180:195], v[196:199], v[132:135], v[180:195]
ds_read_b128 v[208:211], v0 offset:33792
s_waitcnt lgkmcnt(3)
v_mfma_f32_32x32x16_bf16 v[180:195], v[200:203], v[136:139], v[180:195]
s_waitcnt lgkmcnt(2)
ds_read_b128 v[196:199], v0 offset:34816
ds_read_b128 v[228:231], v214 offset:1088
ds_read_b128 v[200:203], v0 offset:35840
ds_read_b128 v[248:251], v214 offset:1248
v_mfma_f32_32x32x16_bf16 v[180:195], v[204:207], v[140:143], v[180:195]
s_waitcnt lgkmcnt(4)
ds_read_b128 v[204:207], v0 offset:36864
v_mfma_f32_32x32x16_bf16 v[180:195], v[208:211], v[144:147], v[180:195]
v_mul_f32 v246, v246, v9
ds_read_b128 v[240:243], v214 offset:1184
s_waitcnt lgkmcnt(5)
v_mfma_f32_32x32x16_bf16 v[180:195], v[196:199], v[148:151], v[180:195]
ds_read_b128 v[208:211], v0 offset:37888
s_waitcnt lgkmcnt(3)
ds_read_b128 v[196:199], v0 offset:38912
v_mfma_f32_32x32x16_bf16 v[180:195], v[200:203], v[152:155], v[180:195]
ds_read_b128 v[200:203], v0 offset:39936
s_waitcnt lgkmcnt(4)
s_waitcnt lgkmcnt(3)
v_mul_f32 v244, v244, v9
v_mfma_f32_32x32x16_bf16 v[180:195], v[204:207], v[156:159], v[180:195]
v_mul_f32 v251, v251, v9
v_mul_f32 v249, v249, v9
v_mul_f32 v237, v237, v9
s_waitcnt lgkmcnt(2)
v_mfma_f32_32x32x16_bf16 v[180:195], v[208:211], v[160:163], v[180:195]
ds_read_b128 v[204:207], v0 offset:40960
s_waitcnt lgkmcnt(1)
ds_read_b128 v[208:211], v0 offset:41984
v_mul_f32 v236, v236, v9
v_mfma_f32_32x32x16_bf16 v[180:195], v[196:199], v[164:167], v[180:195]
v_mul_f32 v250, v250, v9
v_mul_f32 v248, v248, v9
v_mul_f32 v240, v240, v9
v_mfma_f32_32x32x16_bf16 v[180:195], v[200:203], v[168:171], v[180:195]
s_waitcnt lgkmcnt(0)
v_mul_f32 v243, v243, v9
v_mfma_f32_32x32x16_bf16 v[180:195], v[204:207], v[172:175], v[180:195]
v_mul_f32 v242, v242, v9
v_mfma_f32_32x32x16_bf16 v[180:195], v[208:211], v[176:179], v[180:195]
s_nop 0
v_mul_f32 v241, v241, v9
v_mul_f32 v239, v239, v9
v_mul_f32 v238, v238, v9
v_mul_f32 v247, v247, v9
s_nop 6
v_pk_fma_f32 v[188:189], v[188:189], v[228:229], v[244:245] neg_lo:[0,0,1] neg_hi:[0,0,1]
v_pk_fma_f32 v[186:187], v[186:187], v[226:227], v[242:243] neg_lo:[0,0,1] neg_hi:[0,0,1]
v_pk_fma_f32 v[184:185], v[184:185], v[224:225], v[240:241] neg_lo:[0,0,1] neg_hi:[0,0,1]
v_pk_fma_f32 v[192:193], v[192:193], v[232:233], v[248:249] neg_lo:[0,0,1] neg_hi:[0,0,1]
v_pk_fma_f32 v[180:181], v[180:181], v[220:221], v[236:237] neg_lo:[0,0,1] neg_hi:[0,0,1]
v_cvt_pk_bf16_f32 v198, v184, v185
v_pk_fma_f32 v[182:183], v[182:183], v[222:223], v[238:239] neg_lo:[0,0,1] neg_hi:[0,0,1]
v_cvt_pk_bf16_f32 v202, v192, v193
v_pk_fma_f32 v[194:195], v[194:195], v[234:235], v[250:251] neg_lo:[0,0,1] neg_hi:[0,0,1]
v_cvt_pk_bf16_f32 v203, v194, v195
v_cvt_pk_bf16_f32 v199, v186, v187
v_pk_fma_f32 v[190:191], v[190:191], v[230:231], v[246:247] neg_lo:[0,0,1] neg_hi:[0,0,1]
v_cvt_pk_bf16_f32 v197, v182, v183
v_cvt_pk_bf16_f32 v200, v188, v189
v_cvt_pk_bf16_f32 v201, v190, v191
v_cvt_pk_bf16_f32 v196, v180, v181
buffer_store_dwordx4 v[196:199], v10, s[4:7], s27 offen offset:0 sc1
buffer_store_dwordx4 v[200:203], v10, s[4:7], s27 offen offset:1024 sc1
s_add_u32 s30, s30, 3
s_cmp_lt_u32 s30, 60
s_cbranch_scc1 p1q_40
s_lshl_b32 s18, s54, 7
s_add_u32 s18, s18, 11552768
s_cmp_eq_u32 s13, 0
s_cselect_b32 s22, s18, s6
s_mov_b32 s23, 1
s_waitcnt vmcnt(0)
s_barrier
v_mov_b32 v3, s23
s_mov_b64 exec, 1
buffer_store_dword v3, off, s[4:7], s22 sc1
s_mov_b64 exec, -1
s_mov_b32 s22, s6
s_mov_b32 s34, s55
kvz_39:
s_add_u32 s16, s16, 1
s_cmp_lt_u32 s16, 2
s_cbranch_scc1 kvlay_23
s_endpgm
roleA_6:
s_sub_u32 s39, s15, 64
s_mul_i32 s50, s39, 13108
s_lshr_b32 s50, s50, 16
s_mul_i32 s18, s50, 5
s_sub_u32 s34, s39, s18
v_bfe_u32 v5, v0, 4, 5
v_mul_u32_u24 v5, 1280, v5
v_lshrrev_b32 v8, 9, v0
v_lshl_add_u32 v5, v8, 4, v5
v_and_b32 v6, 0x1ff, v0
v_lshlrev_b32 v6, 1, v6
v_lshl_add_u32 v6, v8, 4, v6
s_load_dwordx2 s[44:45], s[0:1], 0
s_mov_b32 s46, 2621440
s_mov_b32 s47, 0x20000
s_waitcnt lgkmcnt(0)
s_load_dwordx2 s[40:41], s[0:1], 8
s_mov_b32 s42, 1314816
s_mov_b32 s43, 0x20000
s_waitcnt lgkmcnt(0)
s_load_dwordx2 s[52:53], s[0:1], 16
s_mov_b32 s54, 1314816
s_mov_b32 s55, 0x20000
s_waitcnt lgkmcnt(0)
v_lshrrev_b32 v8, 7, v0
v_lshl_add_u32 v8, s13, 3, v8
v_bfe_u32 v9, v8, 1, 3
v_lshlrev_b32 v9, 4, v9
v_xor_b32 v9, v9, v0
v_and_b32 v9, 0x70, v9
v_mul_u32_u24 v8, 1280, v8
v_add_u32 v8, v8, v9
s_mul_i32 s26, s50, 40960
s_lshl_b32 s25, s13, 10
s_add_u32 m0, s25, 2048
s_add_u32 s20, s26, 0
buffer_load_dwordx4 v8, s[44:47], s20 offen sc1 lds
s_add_u32 m0, s25, 6144
s_add_u32 s20, s26, 128
buffer_load_dwordx4 v8, s[44:47], s20 offen sc1 lds
s_add_u32 m0, s25, 10240
s_add_u32 s20, s26, 256
buffer_load_dwordx4 v8, s[44:47], s20 offen sc1 lds
s_add_u32 m0, s25, 14336
s_add_u32 s20, s26, 384
buffer_load_dwordx4 v8, s[44:47], s20 offen sc1 lds
s_add_u32 m0, s25, 18432
s_add_u32 s20, s26, 512
buffer_load_dwordx4 v8, s[44:47], s20 offen sc1 lds
s_add_u32 m0, s25, 22528
s_add_u32 s20, s26, 640
buffer_load_dwordx4 v8, s[44:47], s20 offen sc1 lds
s_add_u32 m0, s25, 26624
s_add_u32 s20, s26, 768
buffer_load_dwordx4 v8, s[44:47], s20 offen sc1 lds
s_add_u32 m0, s25, 30720
s_add_u32 s20, s26, 896
buffer_load_dwordx4 v8, s[44:47], s20 offen sc1 lds
s_add_u32 m0, s25, 34816
s_add_u32 s20, s26, 1024
buffer_load_dwordx4 v8, s[44:47], s20 offen sc1 lds
s_add_u32 m0, s25, 38912
s_add_u32 s20, s26, 1152
buffer_load_dwordx4 v8, s[44:47], s20 offen sc1 lds
s_add_u32 s26, s26, 1310720
s_add_u32 s25, s25, 40960
v_bfe_u32 v1, v0, 4, 4
v_and_b32 v9, 0x300, v0
v_add_u32 v1, v1, v9
v_lshl_add_u32 v1, s13, 4, v1
v_mul_u32_u24 v1, 642, v1
s_lshl_b32 s30, s39, 2
s_add_u32 s30, s30, 2
s_lshl_b32 s18, s13, 12
s_add_u32 s18, s18, 147456
s_waitcnt vmcnt(10)
v_add_u32 v4, s18, v0
v_bfe_u32 v176, v0, 5, 3
v_lshrrev_b32 v9, 9, v0
v_xor_b32 v176, v176, v9
v_lshlrev_b32 v176, 4, v176
v_and_b32 v9, 0x1f0, v0
v_lshl_add_u32 v176, v9, 3, v176
v_xor_b32 v177, 32, v176
v_xor_b32 v178, 64, v176
v_xor_b32 v179, 96, v176
s_lshl_b32 s18, s34, 7
s_lshl_b32 s19, s13, 5
s_add_u32 s18, s18, s19
s_mov_b32 s19, 0x3acccccd
v_bfe_u32 v202, v0, 4, 5
v_lshrrev_b32 v197, 9, v0
v_add_u32 v202, s18, v202
v_and_b32 v201, 1, v202
v_mul_u32_u24 v201, 160, v201
v_lshrrev_b32 v200, 1, v202
v_add_u32 v200, 1, v200
v_lshlrev_b32 v197, 3, v197
v_mad_u32_u24 v201, v197, v200, v201
v_mad_u32_u24 v196, v200, 16, 0
v_cvt_f32_u32 v196, v196
v_mul_f32 v202, s19, v196
v_rndne_f32 v202, v202
v_fmac_f32 v196, 0xc4200000, v202
v_mul_f32 v196, s19, v196
v_cos_f32 v196, v196
s_nop 0
v_add_f32 v196, v196, v196
v_mad_u32_u24 v198, v200, 1, 0
v_cvt_f32_u32 v198, v198
v_mul_f32 v202, s19, v198
v_rndne_f32 v202, v202
v_fmac_f32 v198, 0xc4200000, v202
v_mul_f32 v198, s19, v198
v_cos_f32 v198, v198
s_nop 0
v_add_f32 v198, v198, v198
v_mad_u32_u24 v183, v200, 3, v201
v_cvt_f32_u32 v183, v183
v_mul_f32 v202, s19, v183
v_rndne_f32 v202, v202
v_fmac_f32 v183, 0xc4200000, v202
v_mul_f32 v183, s19, v183
v_cos_f32 v183, v183
v_mad_u32_u24 v184, v200, 4, v201
v_cvt_f32_u32 v184, v184
v_mul_f32 v202, s19, v184
v_rndne_f32 v202, v202
v_fmac_f32 v184, 0xc4200000, v202
v_mul_f32 v184, s19, v184
v_cos_f32 v184, v184
s_nop 0
v_fma_f32 v185, v198, v184, -v183
v_fma_f32 v182, v198, v183, -v184
v_fma_f32 v186, v198, v185, -v184
v_fma_f32 v181, v198, v182, -v183
v_fma_f32 v187, v198, v186, -v185
v_fma_f32 v180, v198, v181, -v182
v_cvt_pk_bf16_f32 v16, v180, v181
v_cvt_pk_bf16_f32 v17, v182, v183
v_cvt_pk_bf16_f32 v18, v184, v185
v_cvt_pk_bf16_f32 v19, v186, v187
v_mad_u32_u24 v191, v200, 19, v201
v_cvt_f32_u32 v191, v191
v_mul_f32 v202, s19, v191
v_rndne_f32 v202, v202
v_fmac_f32 v191, 0xc4200000, v202
v_mul_f32 v191, s19, v191
v_cos_f32 v191, v191
v_mad_u32_u24 v192, v200, 20, v201
v_cvt_f32_u32 v192, v192
v_mul_f32 v202, s19, v192
v_rndne_f32 v202, v202
v_fmac_f32 v192, 0xc4200000, v202
v_mul_f32 v192, s19, v192
v_cos_f32 v192, v192
s_nop 0
v_fma_f32 v193, v198, v192, -v191
v_fma_f32 v190, v198, v191, -v192
v_fma_f32 v194, v198, v193, -v192
v_fma_f32 v189, v198, v190, -v191
v_fma_f32 v195, v198, v194, -v193
v_fma_f32 v188, v198, v189, -v190
v_cvt_pk_bf16_f32 v20, v188, v189
v_cvt_pk_bf16_f32 v21, v190, v191
v_cvt_pk_bf16_f32 v22, v192, v193
v_cvt_pk_bf16_f32 v23, v194, v195
v_pk_fma_f32 v[180:181], v[196:197], v[188:189], v[180:181] op_sel_hi:[0,1,1] neg_lo:[0,0,1] neg_hi:[0,0,1]
v_pk_fma_f32 v[182:183], v[196:197], v[190:191], v[182:183] op_sel_hi:[0,1,1] neg_lo:[0,0,1] neg_hi:[0,0,1]
v_pk_fma_f32 v[184:185], v[196:197], v[192:193], v[184:185] op_sel_hi:[0,1,1] neg_lo:[0,0,1] neg_hi:[0,0,1]
v_pk_fma_f32 v[186:187], v[196:197], v[194:195], v[186:187] op_sel_hi:[0,1,1] neg_lo:[0,0,1] neg_hi:[0,0,1]
v_cvt_pk_bf16_f32 v24, v180, v181
v_cvt_pk_bf16_f32 v25, v182, v183
v_cvt_pk_bf16_f32 v26, v184, v185
v_cvt_pk_bf16_f32 v27, v186, v187
s_add_u32 m0, s25, 2048
s_add_u32 s21, s26, 0
buffer_load_dwordx4 v8, s[44:47], s21 offen lds
v_pk_fma_f32 v[188:189], v[196:197], v[180:181], v[188:189] op_sel_hi:[0,1,1] neg_lo:[0,0,1] neg_hi:[0,0,1]
v_pk_fma_f32 v[190:191], v[196:197], v[182:183], v[190:191] op_sel_hi:[0,1,1] neg_lo:[0,0,1] neg_hi:[0,0,1]
v_pk_fma_f32 v[192:193], v[196:197], v[184:185], v[192:193] op_sel_hi:[0,1,1] neg_lo:[0,0,1] neg_hi:[0,0,1]
v_pk_fma_f32 v[194:195], v[196:197], v[186:187], v[194:195] op_sel_hi:[0,1,1] neg_lo:[0,0,1] neg_hi:[0,0,1]
v_cvt_pk_bf16_f32 v28, v188, v189
v_cvt_pk_bf16_f32 v29, v190, v191
v_cvt_pk_bf16_f32 v30, v192, v193
v_cvt_pk_bf16_f32 v31, v194, v195
s_add_u32 m0, s25, 6144
s_add_u32 s21, s26, 128
buffer_load_dwordx4 v8, s[44:47], s21 offen lds
v_pk_fma_f32 v[180:181], v[196:197], v[188:189], v[180:181] op_sel_hi:[0,1,1] neg_lo:[0,0,1] neg_hi:[0,0,1]
v_pk_fma_f32 v[182:183], v[196:197], v[190:191], v[182:183] op_sel_hi:[0,1,1] neg_lo:[0,0,1] neg_hi:[0,0,1]
v_pk_fma_f32 v[184:185], v[196:197], v[192:193], v[184:185] op_sel_hi:[0,1,1] neg_lo:[0,0,1] neg_hi:[0,0,1]
v_pk_fma_f32 v[186:187], v[196:197], v[194:195], v[186:187] op_sel_hi:[0,1,1] neg_lo:[0,0,1] neg_hi:[0,0,1]
v_cvt_pk_bf16_f32 v32, v180, v181
v_cvt_pk_bf16_f32 v33, v182, v183
v_cvt_pk_bf16_f32 v34, v184, v185
v_cvt_pk_bf16_f32 v35, v186, v187
s_add_u32 m0, s25, 10240
s_add_u32 s21, s26, 256
buffer_load_dwordx4 v8, s[44:47], s21 offen lds
v_pk_fma_f32 v[188:189], v[196:197], v[180:181], v[188:189] op_sel_hi:[0,1,1] neg_lo:[0,0,1] neg_hi:[0,0,1]
v_pk_fma_f32 v[190:191], v[196:197], v[182:183], v[190:191] op_sel_hi:[0,1,1] neg_lo:[0,0,1] neg_hi:[0,0,1]
v_pk_fma_f32 v[192:193], v[196:197], v[184:185], v[192:193] op_sel_hi:[0,1,1] neg_lo:[0,0,1] neg_hi:[0,0,1]
v_pk_fma_f32 v[194:195], v[196:197], v[186:187], v[194:195] op_sel_hi:[0,1,1] neg_lo:[0,0,1] neg_hi:[0,0,1]
v_cvt_pk_bf16_f32 v36, v188, v189
v_cvt_pk_bf16_f32 v37, v190, v191
v_cvt_pk_bf16_f32 v38, v192, v193
v_cvt_pk_bf16_f32 v39, v194, v195
s_add_u32 m0, s25, 14336
s_add_u32 s21, s26, 384
buffer_load_dwordx4 v8, s[44:47], s21 offen lds
v_pk_fma_f32 v[180:181], v[196:197], v[188:189], v[180:181] op_sel_hi:[0,1,1] neg_lo:[0,0,1] neg_hi:[0,0,1]
v_pk_fma_f32 v[182:183], v[196:197], v[190:191], v[182:183] op_sel_hi:[0,1,1] neg_lo:[0,0,1] neg_hi:[0,0,1]
v_pk_fma_f32 v[184:185], v[196:197], v[192:193], v[184:185] op_sel_hi:[0,1,1] neg_lo:[0,0,1] neg_hi:[0,0,1]
v_pk_fma_f32 v[186:187], v[196:197], v[194:195], v[186:187] op_sel_hi:[0,1,1] neg_lo:[0,0,1] neg_hi:[0,0,1]
v_cvt_pk_bf16_f32 v40, v180, v181
v_cvt_pk_bf16_f32 v41, v182, v183
v_cvt_pk_bf16_f32 v42, v184, v185
v_cvt_pk_bf16_f32 v43, v186, v187
s_add_u32 m0, s25, 18432
s_add_u32 s21, s26, 512
buffer_load_dwordx4 v8, s[44:47], s21 offen lds
v_pk_fma_f32 v[188:189], v[196:197], v[180:181], v[188:189] op_sel_hi:[0,1,1] neg_lo:[0,0,1] neg_hi:[0,0,1]
v_pk_fma_f32 v[190:191], v[196:197], v[182:183], v[190:191] op_sel_hi:[0,1,1] neg_lo:[0,0,1] neg_hi:[0,0,1]
v_pk_fma_f32 v[192:193], v[196:197], v[184:185], v[192:193] op_sel_hi:[0,1,1] neg_lo:[0,0,1] neg_hi:[0,0,1]
v_pk_fma_f32 v[194:195], v[196:197], v[186:187], v[194:195] op_sel_hi:[0,1,1] neg_lo:[0,0,1] neg_hi:[0,0,1]
v_cvt_pk_bf16_f32 v44, v188, v189
v_cvt_pk_bf16_f32 v45, v190, v191
v_cvt_pk_bf16_f32 v46, v192, v193
v_cvt_pk_bf16_f32 v47, v194, v195
s_add_u32 m0, s25, 22528
s_add_u32 s21, s26, 640
buffer_load_dwordx4 v8, s[44:47], s21 offen lds
v_pk_fma_f32 v[180:181], v[196:197], v[188:189], v[180:181] op_sel_hi:[0,1,1] neg_lo:[0,0,1] neg_hi:[0,0,1]
v_pk_fma_f32 v[182:183], v[196:197], v[190:191], v[182:183] op_sel_hi:[0,1,1] neg_lo:[0,0,1] neg_hi:[0,0,1]
v_pk_fma_f32 v[184:185], v[196:197], v[192:193], v[184:185] op_sel_hi:[0,1,1] neg_lo:[0,0,1] neg_hi:[0,0,1]
v_pk_fma_f32 v[186:187], v[196:197], v[194:195], v[186:187] op_sel_hi:[0,1,1] neg_lo:[0,0,1] neg_hi:[0,0,1]
v_cvt_pk_bf16_f32 v48, v180, v181
v_cvt_pk_bf16_f32 v49, v182, v183
v_cvt_pk_bf16_f32 v50, v184, v185
v_cvt_pk_bf16_f32 v51, v186, v187
s_add_u32 m0, s25, 26624
s_add_u32 s21, s26, 768
buffer_load_dwordx4 v8, s[44:47], s21 offen lds
v_pk_fma_f32 v[188:189], v[196:197], v[180:181], v[188:189] op_sel_hi:[0,1,1] neg_lo:[0,0,1] neg_hi:[0,0,1]
v_pk_fma_f32 v[190:191], v[196:197], v[182:183], v[190:191] op_sel_hi:[0,1,1] neg_lo:[0,0,1] neg_hi:[0,0,1]
v_pk_fma_f32 v[192:193], v[196:197], v[184:185], v[192:193] op_sel_hi:[0,1,1] neg_lo:[0,0,1] neg_hi:[0,0,1]
v_pk_fma_f32 v[194:195], v[196:197], v[186:187], v[194:195] op_sel_hi:[0,1,1] neg_lo:[0,0,1] neg_hi:[0,0,1]
v_cvt_pk_bf16_f32 v52, v188, v189
v_cvt_pk_bf16_f32 v53, v190, v191
v_cvt_pk_bf16_f32 v54, v192, v193
v_cvt_pk_bf16_f32 v55, v194, v195
s_add_u32 m0, s25, 30720
s_add_u32 s21, s26, 896
buffer_load_dwordx4 v8, s[44:47], s21 offen lds
v_pk_fma_f32 v[180:181], v[196:197], v[188:189], v[180:181] op_sel_hi:[0,1,1] neg_lo:[0,0,1] neg_hi:[0,0,1]
v_pk_fma_f32 v[182:183], v[196:197], v[190:191], v[182:183] op_sel_hi:[0,1,1] neg_lo:[0,0,1] neg_hi:[0,0,1]
v_pk_fma_f32 v[184:185], v[196:197], v[192:193], v[184:185] op_sel_hi:[0,1,1] neg_lo:[0,0,1] neg_hi:[0,0,1]
v_pk_fma_f32 v[186:187], v[196:197], v[194:195], v[186:187] op_sel_hi:[0,1,1] neg_lo:[0,0,1] neg_hi:[0,0,1]
v_cvt_pk_bf16_f32 v56, v180, v181
v_cvt_pk_bf16_f32 v57, v182, v183
v_cvt_pk_bf16_f32 v58, v184, v185
v_cvt_pk_bf16_f32 v59, v186, v187
s_add_u32 m0, s25, 34816
s_add_u32 s21, s26, 1024
buffer_load_dwordx4 v8, s[44:47], s21 offen lds
v_pk_fma_f32 v[188:189], v[196:197], v[180:181], v[188:189] op_sel_hi:[0,1,1] neg_lo:[0,0,1] neg_hi:[0,0,1]
v_pk_fma_f32 v[190:191], v[196:197], v[182:183], v[190:191] op_sel_hi:[0,1,1] neg_lo:[0,0,1] neg_hi:[0,0,1]
v_pk_fma_f32 v[192:193], v[196:197], v[184:185], v[192:193] op_sel_hi:[0,1,1] neg_lo:[0,0,1] neg_hi:[0,0,1]
v_pk_fma_f32 v[194:195], v[196:197], v[186:187], v[194:195] op_sel_hi:[0,1,1] neg_lo:[0,0,1] neg_hi:[0,0,1]
v_cvt_pk_bf16_f32 v60, v188, v189
v_cvt_pk_bf16_f32 v61, v190, v191
v_cvt_pk_bf16_f32 v62, v192, v193
v_cvt_pk_bf16_f32 v63, v194, v195
s_add_u32 m0, s25, 38912
s_add_u32 s21, s26, 1152
buffer_load_dwordx4 v8, s[44:47], s21 offen lds
v_pk_fma_f32 v[180:181], v[196:197], v[188:189], v[180:181] op_sel_hi:[0,1,1] neg_lo:[0,0,1] neg_hi:[0,0,1]
v_pk_fma_f32 v[182:183], v[196:197], v[190:191], v[182:183] op_sel_hi:[0,1,1] neg_lo:[0,0,1] neg_hi:[0,0,1]
v_pk_fma_f32 v[184:185], v[196:197], v[192:193], v[184:185] op_sel_hi:[0,1,1] neg_lo:[0,0,1] neg_hi:[0,0,1]
v_pk_fma_f32 v[186:187], v[196:197], v[194:195], v[186:187] op_sel_hi:[0,1,1] neg_lo:[0,0,1] neg_hi:[0,0,1]
v_cvt_pk_bf16_f32 v64, v180, v181
v_cvt_pk_bf16_f32 v65, v182, v183
v_cvt_pk_bf16_f32 v66, v184, v185
v_cvt_pk_bf16_f32 v67, v186, v187
v_pk_fma_f32 v[188:189], v[196:197], v[180:181], v[188:189] op_sel_hi:[0,1,1] neg_lo:[0,0,1] neg_hi:[0,0,1]
v_pk_fma_f32 v[190:191], v[196:197], v[182:183], v[190:191] op_sel_hi:[0,1,1] neg_lo:[0,0,1] neg_hi:[0,0,1]
v_pk_fma_f32 v[192:193], v[196:197], v[184:185], v[192:193] op_sel_hi:[0,1,1] neg_lo:[0,0,1] neg_hi:[0,0,1]
v_pk_fma_f32 v[194:195], v[196:197], v[186:187], v[194:195] op_sel_hi:[0,1,1] neg_lo:[0,0,1] neg_hi:[0,0,1]
v_cvt_pk_bf16_f32 v68, v188, v189
v_cvt_pk_bf16_f32 v69, v190, v191
v_cvt_pk_bf16_f32 v70, v192, v193
v_cvt_pk_bf16_f32 v71, v194, v195
v_pk_fma_f32 v[180:181], v[196:197], v[188:189], v[180:181] op_sel_hi:[0,1,1] neg_lo:[0,0,1] neg_hi:[0,0,1]
v_pk_fma_f32 v[182:183], v[196:197], v[190:191], v[182:183] op_sel_hi:[0,1,1] neg_lo:[0,0,1] neg_hi:[0,0,1]
v_pk_fma_f32 v[184:185], v[196:197], v[192:193], v[184:185] op_sel_hi:[0,1,1] neg_lo:[0,0,1] neg_hi:[0,0,1]
v_pk_fma_f32 v[186:187], v[196:197], v[194:195], v[186:187] op_sel_hi:[0,1,1] neg_lo:[0,0,1] neg_hi:[0,0,1]
v_cvt_pk_bf16_f32 v72, v180, v181
v_cvt_pk_bf16_f32 v73, v182, v183
v_cvt_pk_bf16_f32 v74, v184, v185
v_cvt_pk_bf16_f32 v75, v186, v187
s_add_u32 s21, s30, 0
buffer_load_dword a8, v1, s[40:43], s21 offen
v_pk_fma_f32 v[188:189], v[196:197], v[180:181], v[188:189] op_sel_hi:[0,1,1] neg_lo:[0,0,1] neg_hi:[0,0,1]
v_pk_fma_f32 v[190:191], v[196:197], v[182:183], v[190:191] op_sel_hi:[0,1,1] neg_lo:[0,0,1] neg_hi:[0,0,1]
v_pk_fma_f32 v[192:193], v[196:197], v[184:185], v[192:193] op_sel_hi:[0,1,1] neg_lo:[0,0,1] neg_hi:[0,0,1]
v_pk_fma_f32 v[194:195], v[196:197], v[186:187], v[194:195] op_sel_hi:[0,1,1] neg_lo:[0,0,1] neg_hi:[0,0,1]
v_cvt_pk_bf16_f32 v76, v188, v189
v_cvt_pk_bf16_f32 v77, v190, v191
v_cvt_pk_bf16_f32 v78, v192, v193
v_cvt_pk_bf16_f32 v79, v194, v195
v_pk_fma_f32 v[180:181], v[196:197], v[188:189], v[180:181] op_sel_hi:[0,1,1] neg_lo:[0,0,1] neg_hi:[0,0,1]
v_pk_fma_f32 v[182:183], v[196:197], v[190:191], v[182:183] op_sel_hi:[0,1,1] neg_lo:[0,0,1] neg_hi:[0,0,1]
v_pk_fma_f32 v[184:185], v[196:197], v[192:193], v[184:185] op_sel_hi:[0,1,1] neg_lo:[0,0,1] neg_hi:[0,0,1]
v_pk_fma_f32 v[186:187], v[196:197], v[194:195], v[186:187] op_sel_hi:[0,1,1] neg_lo:[0,0,1] neg_hi:[0,0,1]
v_cvt_pk_bf16_f32 v80, v180, v181
v_cvt_pk_bf16_f32 v81, v182, v183
v_cvt_pk_bf16_f32 v82, v184, v185
v_cvt_pk_bf16_f32 v83, v186, v187
v_pk_fma_f32 v[188:189], v[196:197], v[180:181], v[188:189] op_sel_hi:[0,1,1] neg_lo:[0,0,1] neg_hi:[0,0,1]
v_pk_fma_f32 v[190:191], v[196:197], v[182:183], v[190:191] op_sel_hi:[0,1,1] neg_lo:[0,0,1] neg_hi:[0,0,1]
v_pk_fma_f32 v[192:193], v[196:197], v[184:185], v[192:193] op_sel_hi:[0,1,1] neg_lo:[0,0,1] neg_hi:[0,0,1]
v_pk_fma_f32 v[194:195], v[196:197], v[186:187], v[194:195] op_sel_hi:[0,1,1] neg_lo:[0,0,1] neg_hi:[0,0,1]
v_cvt_pk_bf16_f32 v84, v188, v189
v_cvt_pk_bf16_f32 v85, v190, v191
v_cvt_pk_bf16_f32 v86, v192, v193
v_cvt_pk_bf16_f32 v87, v194, v195
v_pk_fma_f32 v[180:181], v[196:197], v[188:189], v[180:181] op_sel_hi:[0,1,1] neg_lo:[0,0,1] neg_hi:[0,0,1]
v_pk_fma_f32 v[182:183], v[196:197], v[190:191], v[182:183] op_sel_hi:[0,1,1] neg_lo:[0,0,1] neg_hi:[0,0,1]
v_pk_fma_f32 v[184:185], v[196:197], v[192:193], v[184:185] op_sel_hi:[0,1,1] neg_lo:[0,0,1] neg_hi:[0,0,1]
v_pk_fma_f32 v[186:187], v[196:197], v[194:195], v[186:187] op_sel_hi:[0,1,1] neg_lo:[0,0,1] neg_hi:[0,0,1]
v_cvt_pk_bf16_f32 v88, v180, v181
v_cvt_pk_bf16_f32 v89, v182, v183
v_cvt_pk_bf16_f32 v90, v184, v185
v_cvt_pk_bf16_f32 v91, v186, v187
v_pk_fma_f32 v[188:189], v[196:197], v[180:181], v[188:189] op_sel_hi:[0,1,1] neg_lo:[0,0,1] neg_hi:[0,0,1]
v_pk_fma_f32 v[190:191], v[196:197], v[182:183], v[190:191] op_sel_hi:[0,1,1] neg_lo:[0,0,1] neg_hi:[0,0,1]
v_pk_fma_f32 v[192:193], v[196:197], v[184:185], v[192:193] op_sel_hi:[0,1,1] neg_lo:[0,0,1] neg_hi:[0,0,1]
v_pk_fma_f32 v[194:195], v[196:197], v[186:187], v[194:195] op_sel_hi:[0,1,1] neg_lo:[0,0,1] neg_hi:[0,0,1]
v_cvt_pk_bf16_f32 v92, v188, v189
v_cvt_pk_bf16_f32 v93, v190, v191
v_cvt_pk_bf16_f32 v94, v192, v193
v_cvt_pk_bf16_f32 v95, v194, v195
s_mov_b32 s20, 323
v_mad_u32_u24 v183, v200, s20, v201
v_cvt_f32_u32 v183, v183
v_mul_f32 v202, s19, v183
v_rndne_f32 v202, v202
v_fmac_f32 v183, 0xc4200000, v202
v_mul_f32 v183, s19, v183
v_cos_f32 v183, v183
s_mov_b32 s20, 324
v_mad_u32_u24 v184, v200, s20, v201
v_cvt_f32_u32 v184, v184
v_mul_f32 v202, s19, v184
v_rndne_f32 v202, v202
v_fmac_f32 v184, 0xc4200000, v202
v_mul_f32 v184, s19, v184
v_cos_f32 v184, v184
s_nop 0
v_fma_f32 v185, v198, v184, -v183
v_fma_f32 v182, v198, v183, -v184
v_fma_f32 v186, v198, v185, -v184
v_fma_f32 v181, v198, v182, -v183
v_fma_f32 v187, v198, v186, -v185
v_fma_f32 v180, v198, v181, -v182
v_cvt_pk_bf16_f32 v96, v180, v181
v_cvt_pk_bf16_f32 v97, v182, v183
v_cvt_pk_bf16_f32 v98, v184, v185
v_cvt_pk_bf16_f32 v99, v186, v187
s_add_u32 s21, s30, 41088
buffer_load_dword a9, v1, s[40:43], s21 offen
s_mov_b32 s20, 339
v_mad_u32_u24 v191, v200, s20, v201
v_cvt_f32_u32 v191, v191
v_mul_f32 v202, s19, v191
v_rndne_f32 v202, v202
v_fmac_f32 v191, 0xc4200000, v202
v_mul_f32 v191, s19, v191
v_cos_f32 v191, v191
s_mov_b32 s20, 340
v_mad_u32_u24 v192, v200, s20, v201
v_cvt_f32_u32 v192, v192
v_mul_f32 v202, s19, v192
v_rndne_f32 v202, v202
v_fmac_f32 v192, 0xc4200000, v202
v_mul_f32 v192, s19, v192
v_cos_f32 v192, v192
s_nop 0
v_fma_f32 v193, v198, v192, -v191
v_fma_f32 v190, v198, v191, -v192
v_fma_f32 v194, v198, v193, -v192
v_fma_f32 v189, v198, v190, -v191
v_fma_f32 v195, v198, v194, -v193
v_fma_f32 v188, v198, v189, -v190
v_cvt_pk_bf16_f32 v100, v188, v189
v_cvt_pk_bf16_f32 v101, v190, v191
v_cvt_pk_bf16_f32 v102, v192, v193
v_cvt_pk_bf16_f32 v103, v194, v195
v_pk_fma_f32 v[180:181], v[196:197], v[188:189], v[180:181] op_sel_hi:[0,1,1] neg_lo:[0,0,1] neg_hi:[0,0,1]
v_pk_fma_f32 v[182:183], v[196:197], v[190:191], v[182:183] op_sel_hi:[0,1,1] neg_lo:[0,0,1] neg_hi:[0,0,1]
v_pk_fma_f32 v[184:185], v[196:197], v[192:193], v[184:185] op_sel_hi:[0,1,1] neg_lo:[0,0,1] neg_hi:[0,0,1]
v_pk_fma_f32 v[186:187], v[196:197], v[194:195], v[186:187] op_sel_hi:[0,1,1] neg_lo:[0,0,1] neg_hi:[0,0,1]
v_cvt_pk_bf16_f32 v104, v180, v181
v_cvt_pk_bf16_f32 v105, v182, v183
v_cvt_pk_bf16_f32 v106, v184, v185
v_cvt_pk_bf16_f32 v107, v186, v187
v_pk_fma_f32 v[188:189], v[196:197], v[180:181], v[188:189] op_sel_hi:[0,1,1] neg_lo:[0,0,1] neg_hi:[0,0,1]
v_pk_fma_f32 v[190:191], v[196:197], v[182:183], v[190:191] op_sel_hi:[0,1,1] neg_lo:[0,0,1] neg_hi:[0,0,1]
v_pk_fma_f32 v[192:193], v[196:197], v[184:185], v[192:193] op_sel_hi:[0,1,1] neg_lo:[0,0,1] neg_hi:[0,0,1]
v_pk_fma_f32 v[194:195], v[196:197], v[186:187], v[194:195] op_sel_hi:[0,1,1] neg_lo:[0,0,1] neg_hi:[0,0,1]
v_cvt_pk_bf16_f32 v108, v188, v189
v_cvt_pk_bf16_f32 v109, v190, v191
v_cvt_pk_bf16_f32 v110, v192, v193
v_cvt_pk_bf16_f32 v111, v194, v195
v_pk_fma_f32 v[180:181], v[196:197], v[188:189], v[180:181] op_sel_hi:[0,1,1] neg_lo:[0,0,1] neg_hi:[0,0,1]
v_pk_fma_f32 v[182:183], v[196:197], v[190:191], v[182:183] op_sel_hi:[0,1,1] neg_lo:[0,0,1] neg_hi:[0,0,1]
v_pk_fma_f32 v[184:185], v[196:197], v[192:193], v[184:185] op_sel_hi:[0,1,1] neg_lo:[0,0,1] neg_hi:[0,0,1]
v_pk_fma_f32 v[186:187], v[196:197], v[194:195], v[186:187] op_sel_hi:[0,1,1] neg_lo:[0,0,1] neg_hi:[0,0,1]
v_cvt_pk_bf16_f32 v112, v180, v181
v_cvt_pk_bf16_f32 v113, v182, v183
v_cvt_pk_bf16_f32 v114, v184, v185
v_cvt_pk_bf16_f32 v115, v186, v187
v_pk_fma_f32 v[188:189], v[196:197], v[180:181], v[188:189] op_sel_hi:[0,1,1] neg_lo:[0,0,1] neg_hi:[0,0,1]
v_pk_fma_f32 v[190:191], v[196:197], v[182:183], v[190:191] op_sel_hi:[0,1,1] neg_lo:[0,0,1] neg_hi:[0,0,1]
v_pk_fma_f32 v[192:193], v[196:197], v[184:185], v[192:193] op_sel_hi:[0,1,1] neg_lo:[0,0,1] neg_hi:[0,0,1]
v_pk_fma_f32 v[194:195], v[196:197], v[186:187], v[194:195] op_sel_hi:[0,1,1] neg_lo:[0,0,1] neg_hi:[0,0,1]
v_cvt_pk_bf16_f32 v116, v188, v189
v_cvt_pk_bf16_f32 v117, v190, v191
v_cvt_pk_bf16_f32 v118, v192, v193
v_cvt_pk_bf16_f32 v119, v194, v195
v_pk_fma_f32 v[180:181], v[196:197], v[188:189], v[180:181] op_sel_hi:[0,1,1] neg_lo:[0,0,1] neg_hi:[0,0,1]
v_pk_fma_f32 v[182:183], v[196:197], v[190:191], v[182:183] op_sel_hi:[0,1,1] neg_lo:[0,0,1] neg_hi:[0,0,1]
v_pk_fma_f32 v[184:185], v[196:197], v[192:193], v[184:185] op_sel_hi:[0,1,1] neg_lo:[0,0,1] neg_hi:[0,0,1]
v_pk_fma_f32 v[186:187], v[196:197], v[194:195], v[186:187] op_sel_hi:[0,1,1] neg_lo:[0,0,1] neg_hi:[0,0,1]
v_cvt_pk_bf16_f32 v120, v180, v181
v_cvt_pk_bf16_f32 v121, v182, v183
v_cvt_pk_bf16_f32 v122, v184, v185
v_cvt_pk_bf16_f32 v123, v186, v187
s_add_u32 s21, s30, 82176
buffer_load_dword a10, v1, s[40:43], s21 offen
v_pk_fma_f32 v[188:189], v[196:197], v[180:181], v[188:189] op_sel_hi:[0,1,1] neg_lo:[0,0,1] neg_hi:[0,0,1]
v_pk_fma_f32 v[190:191], v[196:197], v[182:183], v[190:191] op_sel_hi:[0,1,1] neg_lo:[0,0,1] neg_hi:[0,0,1]
v_pk_fma_f32 v[192:193], v[196:197], v[184:185], v[192:193] op_sel_hi:[0,1,1] neg_lo:[0,0,1] neg_hi:[0,0,1]
v_pk_fma_f32 v[194:195], v[196:197], v[186:187], v[194:195] op_sel_hi:[0,1,1] neg_lo:[0,0,1] neg_hi:[0,0,1]
v_cvt_pk_bf16_f32 v124, v188, v189
v_cvt_pk_bf16_f32 v125, v190, v191
v_cvt_pk_bf16_f32 v126, v192, v193
v_cvt_pk_bf16_f32 v127, v194, v195
v_pk_fma_f32 v[180:181], v[196:197], v[188:189], v[180:181] op_sel_hi:[0,1,1] neg_lo:[0,0,1] neg_hi:[0,0,1]
v_pk_fma_f32 v[182:183], v[196:197], v[190:191], v[182:183] op_sel_hi:[0,1,1] neg_lo:[0,0,1] neg_hi:[0,0,1]
v_pk_fma_f32 v[184:185], v[196:197], v[192:193], v[184:185] op_sel_hi:[0,1,1] neg_lo:[0,0,1] neg_hi:[0,0,1]
v_pk_fma_f32 v[186:187], v[196:197], v[194:195], v[186:187] op_sel_hi:[0,1,1] neg_lo:[0,0,1] neg_hi:[0,0,1]
v_cvt_pk_bf16_f32 v128, v180, v181
v_cvt_pk_bf16_f32 v129, v182, v183
v_cvt_pk_bf16_f32 v130, v184, v185
v_cvt_pk_bf16_f32 v131, v186, v187
v_pk_fma_f32 v[188:189], v[196:197], v[180:181], v[188:189] op_sel_hi:[0,1,1] neg_lo:[0,0,1] neg_hi:[0,0,1]
v_pk_fma_f32 v[190:191], v[196:197], v[182:183], v[190:191] op_sel_hi:[0,1,1] neg_lo:[0,0,1] neg_hi:[0,0,1]
v_pk_fma_f32 v[192:193], v[196:197], v[184:185], v[192:193] op_sel_hi:[0,1,1] neg_lo:[0,0,1] neg_hi:[0,0,1]
v_pk_fma_f32 v[194:195], v[196:197], v[186:187], v[194:195] op_sel_hi:[0,1,1] neg_lo:[0,0,1] neg_hi:[0,0,1]
v_cvt_pk_bf16_f32 v132, v188, v189
v_cvt_pk_bf16_f32 v133, v190, v191
v_cvt_pk_bf16_f32 v134, v192, v193
v_cvt_pk_bf16_f32 v135, v194, v195
v_pk_fma_f32 v[180:181], v[196:197], v[188:189], v[180:181] op_sel_hi:[0,1,1] neg_lo:[0,0,1] neg_hi:[0,0,1]
v_pk_fma_f32 v[182:183], v[196:197], v[190:191], v[182:183] op_sel_hi:[0,1,1] neg_lo:[0,0,1] neg_hi:[0,0,1]
v_pk_fma_f32 v[184:185], v[196:197], v[192:193], v[184:185] op_sel_hi:[0,1,1] neg_lo:[0,0,1] neg_hi:[0,0,1]
v_pk_fma_f32 v[186:187], v[196:197], v[194:195], v[186:187] op_sel_hi:[0,1,1] neg_lo:[0,0,1] neg_hi:[0,0,1]
v_cvt_pk_bf16_f32 v136, v180, v181
v_cvt_pk_bf16_f32 v137, v182, v183
v_cvt_pk_bf16_f32 v138, v184, v185
v_cvt_pk_bf16_f32 v139, v186, v187
v_pk_fma_f32 v[188:189], v[196:197], v[180:181], v[188:189] op_sel_hi:[0,1,1] neg_lo:[0,0,1] neg_hi:[0,0,1]
v_pk_fma_f32 v[190:191], v[196:197], v[182:183], v[190:191] op_sel_hi:[0,1,1] neg_lo:[0,0,1] neg_hi:[0,0,1]
v_pk_fma_f32 v[192:193], v[196:197], v[184:185], v[192:193] op_sel_hi:[0,1,1] neg_lo:[0,0,1] neg_hi:[0,0,1]
v_pk_fma_f32 v[194:195], v[196:197], v[186:187], v[194:195] op_sel_hi:[0,1,1] neg_lo:[0,0,1] neg_hi:[0,0,1]
v_cvt_pk_bf16_f32 v140, v188, v189
v_cvt_pk_bf16_f32 v141, v190, v191
v_cvt_pk_bf16_f32 v142, v192, v193
v_cvt_pk_bf16_f32 v143, v194, v195
v_pk_fma_f32 v[180:181], v[196:197], v[188:189], v[180:181] op_sel_hi:[0,1,1] neg_lo:[0,0,1] neg_hi:[0,0,1]
v_pk_fma_f32 v[182:183], v[196:197], v[190:191], v[182:183] op_sel_hi:[0,1,1] neg_lo:[0,0,1] neg_hi:[0,0,1]
v_pk_fma_f32 v[184:185], v[196:197], v[192:193], v[184:185] op_sel_hi:[0,1,1] neg_lo:[0,0,1] neg_hi:[0,0,1]
v_pk_fma_f32 v[186:187], v[196:197], v[194:195], v[186:187] op_sel_hi:[0,1,1] neg_lo:[0,0,1] neg_hi:[0,0,1]
v_cvt_pk_bf16_f32 v144, v180, v181
v_cvt_pk_bf16_f32 v145, v182, v183
v_cvt_pk_bf16_f32 v146, v184, v185
v_cvt_pk_bf16_f32 v147, v186, v187
s_add_u32 s21, s30, 123264
buffer_load_dword a11, v1, s[40:43], s21 offen
v_pk_fma_f32 v[188:189], v[196:197], v[180:181], v[188:189] op_sel_hi:[0,1,1] neg_lo:[0,0,1] neg_hi:[0,0,1]
v_pk_fma_f32 v[190:191], v[196:197], v[182:183], v[190:191] op_sel_hi:[0,1,1] neg_lo:[0,0,1] neg_hi:[0,0,1]
v_pk_fma_f32 v[192:193], v[196:197], v[184:185], v[192:193] op_sel_hi:[0,1,1] neg_lo:[0,0,1] neg_hi:[0,0,1]
v_pk_fma_f32 v[194:195], v[196:197], v[186:187], v[194:195] op_sel_hi:[0,1,1] neg_lo:[0,0,1] neg_hi:[0,0,1]
v_cvt_pk_bf16_f32 v148, v188, v189
v_cvt_pk_bf16_f32 v149, v190, v191
v_cvt_pk_bf16_f32 v150, v192, v193
v_cvt_pk_bf16_f32 v151, v194, v195
v_pk_fma_f32 v[180:181], v[196:197], v[188:189], v[180:181] op_sel_hi:[0,1,1] neg_lo:[0,0,1] neg_hi:[0,0,1]
v_pk_fma_f32 v[182:183], v[196:197], v[190:191], v[182:183] op_sel_hi:[0,1,1] neg_lo:[0,0,1] neg_hi:[0,0,1]
v_pk_fma_f32 v[184:185], v[196:197], v[192:193], v[184:185] op_sel_hi:[0,1,1] neg_lo:[0,0,1] neg_hi:[0,0,1]
v_pk_fma_f32 v[186:187], v[196:197], v[194:195], v[186:187] op_sel_hi:[0,1,1] neg_lo:[0,0,1] neg_hi:[0,0,1]
v_cvt_pk_bf16_f32 v152, v180, v181
v_cvt_pk_bf16_f32 v153, v182, v183
v_cvt_pk_bf16_f32 v154, v184, v185
v_cvt_pk_bf16_f32 v155, v186, v187
v_pk_fma_f32 v[188:189], v[196:197], v[180:181], v[188:189] op_sel_hi:[0,1,1] neg_lo:[0,0,1] neg_hi:[0,0,1]
v_pk_fma_f32 v[190:191], v[196:197], v[182:183], v[190:191] op_sel_hi:[0,1,1] neg_lo:[0,0,1] neg_hi:[0,0,1]
v_pk_fma_f32 v[192:193], v[196:197], v[184:185], v[192:193] op_sel_hi:[0,1,1] neg_lo:[0,0,1] neg_hi:[0,0,1]
v_pk_fma_f32 v[194:195], v[196:197], v[186:187], v[194:195] op_sel_hi:[0,1,1] neg_lo:[0,0,1] neg_hi:[0,0,1]
v_cvt_pk_bf16_f32 v156, v188, v189
v_cvt_pk_bf16_f32 v157, v190, v191
v_cvt_pk_bf16_f32 v158, v192, v193
v_cvt_pk_bf16_f32 v159, v194, v195
v_pk_fma_f32 v[180:181], v[196:197], v[188:189], v[180:181] op_sel_hi:[0,1,1] neg_lo:[0,0,1] neg_hi:[0,0,1]
v_pk_fma_f32 v[182:183], v[196:197], v[190:191], v[182:183] op_sel_hi:[0,1,1] neg_lo:[0,0,1] neg_hi:[0,0,1]
v_pk_fma_f32 v[184:185], v[196:197], v[192:193], v[184:185] op_sel_hi:[0,1,1] neg_lo:[0,0,1] neg_hi:[0,0,1]
v_pk_fma_f32 v[186:187], v[196:197], v[194:195], v[186:187] op_sel_hi:[0,1,1] neg_lo:[0,0,1] neg_hi:[0,0,1]
v_cvt_pk_bf16_f32 v160, v180, v181
v_cvt_pk_bf16_f32 v161, v182, v183
v_cvt_pk_bf16_f32 v162, v184, v185
v_cvt_pk_bf16_f32 v163, v186, v187
v_pk_fma_f32 v[188:189], v[196:197], v[180:181], v[188:189] op_sel_hi:[0,1,1] neg_lo:[0,0,1] neg_hi:[0,0,1]
v_pk_fma_f32 v[190:191], v[196:197], v[182:183], v[190:191] op_sel_hi:[0,1,1] neg_lo:[0,0,1] neg_hi:[0,0,1]
v_pk_fma_f32 v[192:193], v[196:197], v[184:185], v[192:193] op_sel_hi:[0,1,1] neg_lo:[0,0,1] neg_hi:[0,0,1]
v_pk_fma_f32 v[194:195], v[196:197], v[186:187], v[194:195] op_sel_hi:[0,1,1] neg_lo:[0,0,1] neg_hi:[0,0,1]
v_cvt_pk_bf16_f32 v164, v188, v189
v_cvt_pk_bf16_f32 v165, v190, v191
v_cvt_pk_bf16_f32 v166, v192, v193
v_cvt_pk_bf16_f32 v167, v194, v195
v_pk_fma_f32 v[180:181], v[196:197], v[188:189], v[180:181] op_sel_hi:[0,1,1] neg_lo:[0,0,1] neg_hi:[0,0,1]
v_pk_fma_f32 v[182:183], v[196:197], v[190:191], v[182:183] op_sel_hi:[0,1,1] neg_lo:[0,0,1] neg_hi:[0,0,1]
v_pk_fma_f32 v[184:185], v[196:197], v[192:193], v[184:185] op_sel_hi:[0,1,1] neg_lo:[0,0,1] neg_hi:[0,0,1]
v_pk_fma_f32 v[186:187], v[196:197], v[194:195], v[186:187] op_sel_hi:[0,1,1] neg_lo:[0,0,1] neg_hi:[0,0,1]
v_cvt_pk_bf16_f32 v168, v180, v181
v_cvt_pk_bf16_f32 v169, v182, v183
v_cvt_pk_bf16_f32 v170, v184, v185
v_cvt_pk_bf16_f32 v171, v186, v187
s_add_u32 s21, s30, 657408
buffer_load_dword a12, v1, s[40:43], s21 offen
v_pk_fma_f32 v[188:189], v[196:197], v[180:181], v[188:189] op_sel_hi:[0,1,1] neg_lo:[0,0,1] neg_hi:[0,0,1]
v_pk_fma_f32 v[190:191], v[196:197], v[182:183], v[190:191] op_sel_hi:[0,1,1] neg_lo:[0,0,1] neg_hi:[0,0,1]
v_pk_fma_f32 v[192:193], v[196:197], v[184:185], v[192:193] op_sel_hi:[0,1,1] neg_lo:[0,0,1] neg_hi:[0,0,1]
v_pk_fma_f32 v[194:195], v[196:197], v[186:187], v[194:195] op_sel_hi:[0,1,1] neg_lo:[0,0,1] neg_hi:[0,0,1]
v_cvt_pk_bf16_f32 v172, v188, v189
v_cvt_pk_bf16_f32 v173, v190, v191
v_cvt_pk_bf16_f32 v174, v192, v193
v_cvt_pk_bf16_f32 v175, v194, v195
v_mov_b32 v180, s24
v_mov_b32 v181, s24
v_mov_b32 v182, s24
v_mov_b32 v183, s24
s_nop 1
v_mfma_f32_32x32x16_bf16 v[184:199], v[180:183], v[16:19], 0
v_mfma_f32_32x32x16_bf16 v[184:199], v[180:183], v[20:23], v[184:199]
v_mfma_f32_32x32x16_bf16 v[184:199], v[180:183], v[24:27], v[184:199]
v_mfma_f32_32x32x16_bf16 v[184:199], v[180:183], v[28:31], v[184:199]
v_mfma_f32_32x32x16_bf16 v[184:199], v[180:183], v[32:35], v[184:199]
s_add_u32 s21, s30, 698496
buffer_load_dword a13, v1, s[40:43], s21 offen
v_mfma_f32_32x32x16_bf16 v[184:199], v[180:183], v[36:39], v[184:199]
v_mfma_f32_32x32x16_bf16 v[184:199], v[180:183], v[40:43], v[184:199]
v_mfma_f32_32x32x16_bf16 v[184:199], v[180:183], v[44:47], v[184:199]
v_mfma_f32_32x32x16_bf16 v[184:199], v[180:183], v[48:51], v[184:199]
v_mfma_f32_32x32x16_bf16 v[184:199], v[180:183], v[52:55], v[184:199]
v_mfma_f32_32x32x16_bf16 v[184:199], v[180:183], v[56:59], v[184:199]
v_mfma_f32_32x32x16_bf16 v[184:199], v[180:183], v[60:63], v[184:199]
v_mfma_f32_32x32x16_bf16 v[184:199], v[180:183], v[64:67], v[184:199]
v_mfma_f32_32x32x16_bf16 v[184:199], v[180:183], v[68:71], v[184:199]
v_mfma_f32_32x32x16_bf16 v[184:199], v[180:183], v[72:75], v[184:199]
v_mfma_f32_32x32x16_bf16 v[184:199], v[180:183], v[76:79], v[184:199]
v_mfma_f32_32x32x16_bf16 v[184:199], v[180:183], v[80:83], v[184:199]
s_add_u32 s21, s30, 739584
buffer_load_dword a14, v1, s[40:43], s21 offen
v_mfma_f32_32x32x16_bf16 v[184:199], v[180:183], v[84:87], v[184:199]
v_mfma_f32_32x32x16_bf16 v[184:199], v[180:183], v[88:91], v[184:199]
v_mfma_f32_32x32x16_bf16 v[184:199], v[180:183], v[92:95], v[184:199]
v_mfma_f32_32x32x16_bf16 v[184:199], v[180:183], v[96:99], v[184:199]
v_mfma_f32_32x32x16_bf16 v[184:199], v[180:183], v[100:103], v[184:199]
v_mfma_f32_32x32x16_bf16 v[184:199], v[180:183], v[104:107], v[184:199]
v_mfma_f32_32x32x16_bf16 v[184:199], v[180:183], v[108:111], v[184:199]
v_mfma_f32_32x32x16_bf16 v[184:199], v[180:183], v[112:115], v[184:199]
v_mfma_f32_32x32x16_bf16 v[184:199], v[180:183], v[116:119], v[184:199]
v_mfma_f32_32x32x16_bf16 v[184:199], v[180:183], v[120:123], v[184:199]
v_mfma_f32_32x32x16_bf16 v[184:199], v[180:183], v[124:127], v[184:199]
v_mfma_f32_32x32x16_bf16 v[184:199], v[180:183], v[128:131], v[184:199]
s_add_u32 s21, s30, 780672
buffer_load_dword a15, v1, s[40:43], s21 offen
v_mfma_f32_32x32x16_bf16 v[184:199], v[180:183], v[132:135], v[184:199]
v_mfma_f32_32x32x16_bf16 v[184:199], v[180:183], v[136:139], v[184:199]
v_mfma_f32_32x32x16_bf16 v[184:199], v[180:183], v[140:143], v[184:199]
v_mfma_f32_32x32x16_bf16 v[184:199], v[180:183], v[144:147], v[184:199]
v_mfma_f32_32x32x16_bf16 v[184:199], v[180:183], v[148:151], v[184:199]
v_mfma_f32_32x32x16_bf16 v[184:199], v[180:183], v[152:155], v[184:199]
v_mfma_f32_32x32x16_bf16 v[184:199], v[180:183], v[156:159], v[184:199]
v_mfma_f32_32x32x16_bf16 v[184:199], v[180:183], v[160:163], v[184:199]
v_mfma_f32_32x32x16_bf16 v[184:199], v[180:183], v[164:167], v[184:199]
v_mfma_f32_32x32x16_bf16 v[184:199], v[180:183], v[168:171], v[184:199]
v_mfma_f32_32x32x16_bf16 v[184:199], v[180:183], v[172:175], v[184:199]
s_nop 11
v_mov_b32 v7, v184
s_lshl_b32 s18, s34, 2
s_add_u32 s18, s18, s13
s_lshl_b32 s33, s18, 11
s_mul_i32 s27, s50, 40960
s_add_u32 s27, s27, s33
s_add_u32 s27, s27, 97517568
s_mov_b32 s28, 0
s_waitcnt vmcnt(8)
p1_43:
s_barrier
s_lshl_b32 s18, s13, 5
v_xor_b32 v2, s18, v176
ds_read_b128 v[220:223], v2 offset:2048
v_mov_b64 v[212:213], 0
ds_read_b128 v[228:231], v2 offset:10240
ds_read_b128 v[224:227], v2 offset:6144
ds_read_b128 v[196:199], v176 offset:2048
ds_read_b128 v[208:211], v179 offset:2048
ds_read_b128 v[232:235], v2 offset:14336
s_add_u32 s19, s30, 0
buffer_load_dword a0, v1, s[52:55], s19 offen
ds_read_b128 v[200:203], v177 offset:2048
ds_read_b128 v[204:207], v178 offset:2048
s_waitcnt lgkmcnt(7)
v_dot2c_f32_bf16 v212, s24, v220
v_dot2c_f32_bf16 v213, v220, v220
v_dot2c_f32_bf16 v212, s24, v221
v_dot2c_f32_bf16 v213, v221, v221
v_dot2c_f32_bf16 v212, s24, v222
v_dot2c_f32_bf16 v213, v222, v222
v_dot2c_f32_bf16 v212, s24, v223
v_dot2c_f32_bf16 v213, v223, v223
s_waitcnt lgkmcnt(5)
ds_read_b128 v[220:223], v2 offset:18432
v_dot2c_f32_bf16 v212, s24, v224
v_dot2c_f32_bf16 v213, v224, v224
v_dot2c_f32_bf16 v212, s24, v225
v_dot2c_f32_bf16 v213, v225, v225
v_dot2c_f32_bf16 v212, s24, v226
v_dot2c_f32_bf16 v213, v226, v226
v_dot2c_f32_bf16 v212, s24, v227
v_dot2c_f32_bf16 v213, v227, v227
v_dot2c_f32_bf16 v212, s24, v228
v_dot2c_f32_bf16 v213, v228, v228
v_dot2c_f32_bf16 v212, s24, v229
v_dot2c_f32_bf16 v213, v229, v229
v_dot2c_f32_bf16 v212, s24, v230
v_dot2c_f32_bf16 v213, v230, v230
v_dot2c_f32_bf16 v212, s24, v231
v_dot2c_f32_bf16 v213, v231, v231
s_waitcnt lgkmcnt(3)
s_waitcnt lgkmcnt(1)
ds_read_b128 v[228:231], v2 offset:26624
ds_read_b128 v[224:227], v2 offset:22528
v_dot2c_f32_bf16 v212, s24, v232
v_dot2c_f32_bf16 v213, v232, v232
v_dot2c_f32_bf16 v212, s24, v233
v_dot2c_f32_bf16 v213, v233, v233
v_dot2c_f32_bf16 v212, s24, v234
s_waitcnt lgkmcnt(2)
v_dot2c_f32_bf16 v213, v234, v234
v_dot2c_f32_bf16 v212, s24, v235
v_dot2c_f32_bf16 v213, v235, v235
v_dot2c_f32_bf16 v212, s24, v220
v_dot2c_f32_bf16 v213, v220, v220
v_dot2c_f32_bf16 v212, s24, v221
v_dot2c_f32_bf16 v213, v221, v221
v_dot2c_f32_bf16 v212, s24, v222
v_dot2c_f32_bf16 v213, v222, v222
v_dot2c_f32_bf16 v212, s24, v223
v_dot2c_f32_bf16 v213, v223, v223
s_waitcnt lgkmcnt(0)
ds_read_b128 v[232:235], v2 offset:30720
ds_read_b128 v[220:223], v2 offset:34816
v_dot2c_f32_bf16 v212, s24, v224
v_dot2c_f32_bf16 v213, v224, v224
v_dot2c_f32_bf16 v212, s24, v225
v_dot2c_f32_bf16 v213, v225, v225
v_dot2c_f32_bf16 v212, s24, v226
v_dot2c_f32_bf16 v213, v226, v226
v_dot2c_f32_bf16 v212, s24, v227
v_dot2c_f32_bf16 v213, v227, v227
v_dot2c_f32_bf16 v212, s24, v228
v_dot2c_f32_bf16 v213, v228, v228
v_dot2c_f32_bf16 v212, s24, v229
v_dot2c_f32_bf16 v213, v229, v229
v_dot2c_f32_bf16 v212, s24, v230
s_add_u32 s19, s30, 41088
buffer_load_dword a1, v1, s[52:55], s19 offen
ds_read_b128 v[224:227], v2 offset:38912
v_dot2c_f32_bf16 v213, v230, v230
v_dot2c_f32_bf16 v212, s24, v231
v_dot2c_f32_bf16 v213, v231, v231
s_waitcnt lgkmcnt(1)
v_dot2c_f32_bf16 v212, s24, v232
v_dot2c_f32_bf16 v213, v232, v232
v_dot2c_f32_bf16 v212, s24, v233
v_dot2c_f32_bf16 v213, v233, v233
v_dot2c_f32_bf16 v212, s24, v234
v_dot2c_f32_bf16 v213, v234, v234
v_dot2c_f32_bf16 v212, s24, v235
v_dot2c_f32_bf16 v213, v235, v235
v_dot2c_f32_bf16 v212, s24, v220
v_dot2c_f32_bf16 v213, v220, v220
v_dot2c_f32_bf16 v212, s24, v221
v_dot2c_f32_bf16 v213, v221, v221
v_dot2c_f32_bf16 v212, s24, v222
v_dot2c_f32_bf16 v213, v222, v222
v_dot2c_f32_bf16 v212, s24, v223
s_waitcnt lgkmcnt(0)
v_dot2c_f32_bf16 v213, v223, v223
v_dot2c_f32_bf16 v212, s24, v224
v_dot2c_f32_bf16 v213, v224, v224
v_dot2c_f32_bf16 v212, s24, v225
v_dot2c_f32_bf16 v213, v225, v225
v_dot2c_f32_bf16 v212, s24, v226
v_dot2c_f32_bf16 v213, v226, v226
v_dot2c_f32_bf16 v212, s24, v227
v_dot2c_f32_bf16 v213, v227, v227
v_mfma_f32_32x32x16_bf16 v[180:195], v[196:199], v[16:19], 0
s_nop 1
v_permlane32_swap_b32 v212, v213
v_mfma_f32_32x32x16_bf16 v[180:195], v[200:203], v[20:23], v[180:195]
ds_read_b128 v[196:199], v176 offset:6144
v_add_f32 v212, v212, v213
ds_read_b128 v[200:203], v177 offset:6144
v_lshl_add_u32 v213, s13, 2, v0
v_mfma_f32_32x32x16_bf16 v[180:195], v[204:207], v[24:27], v[180:195]
ds_write_b32 v213, v212 offset:0
ds_read_b128 v[204:207], v178 offset:6144
v_mfma_f32_32x32x16_bf16 v[180:195], v[208:211], v[28:31], v[180:195]
s_waitcnt lgkmcnt(3)
v_mfma_f32_32x32x16_bf16 v[180:195], v[196:199], v[32:35], v[180:195]
ds_read_b128 v[208:211], v179 offset:6144
v_and_b32 v2, 0x1ff, v0
s_waitcnt lgkmcnt(2)
s_waitcnt lgkmcnt(1)
ds_read_b128 v[196:199], v176 offset:10240
v_mfma_f32_32x32x16_bf16 v[180:195], v[200:203], v[36:39], v[180:195]
s_barrier
v_mfma_f32_32x32x16_bf16 v[180:195], v[204:207], v[40:43], v[180:195]
s_waitcnt lgkmcnt(1)
ds_read_b128 v[200:203], v177 offset:10240
ds_read_b128 v[204:207], v178 offset:10240
s_waitcnt lgkmcnt(2)
v_mfma_f32_32x32x16_bf16 v[180:195], v[208:211], v[44:47], v[180:195]
ds_read_b128 v[212:215], v2 offset:0
s_add_u32 s19, s30, 82176
buffer_load_dword a2, v1, s[52:55], s19 offen
v_mfma_f32_32x32x16_bf16 v[180:195], v[196:199], v[48:51], v[180:195]
ds_read_b128 v[196:199], v176 offset:14336
s_waitcnt lgkmcnt(3)
ds_read_b128 v[208:211], v179 offset:10240
s_waitcnt lgkmcnt(3)
v_mfma_f32_32x32x16_bf16 v[180:195], v[200:203], v[52:55], v[180:195]
ds_read_b128 v[216:219], v2 offset:512
ds_read_b128 v[200:203], v177 offset:14336
v_mfma_f32_32x32x16_bf16 v[180:195], v[204:207], v[56:59], v[180:195]
ds_read_b128 v[204:207], v178 offset:14336
s_waitcnt lgkmcnt(4)
s_waitcnt lgkmcnt(3)
v_mfma_f32_32x32x16_bf16 v[180:195], v[208:211], v[60:63], v[180:195]
v_add_f32 v214, v214, v215
ds_read_b128 v[208:211], v179 offset:14336
s_waitcnt lgkmcnt(2)
v_add_f32 v212, v212, v213
v_mfma_f32_32x32x16_bf16 v[180:195], v[196:199], v[64:67], v[180:195]
ds_read_b128 v[196:199], v176 offset:18432
v_add_f32 v212, v212, v214
s_waitcnt lgkmcnt(2)
v_add_f32 v216, v216, v217
v_mfma_f32_32x32x16_bf16 v[180:195], v[200:203], v[68:71], v[180:195]
v_lshrrev_b32 v213, 2, v0
ds_read_b128 v[200:203], v177 offset:18432
v_bfe_u32 v214, v0, 5, 5
v_mul_f32 v212, 0x3acccccd, v212
v_mfma_f32_32x32x16_bf16 v[180:195], v[204:207], v[72:75], v[180:195]
ds_read_b128 v[204:207], v178 offset:18432
v_add_f32 v218, v218, v219
s_waitcnt lgkmcnt(3)
v_add_f32 v216, v216, v218
v_and_b32 v214, 16, v214
v_mfma_f32_32x32x16_bf16 v[180:195], v[208:211], v[76:79], v[180:195]
s_waitcnt lgkmcnt(2)
ds_read_b128 v[208:211], v179 offset:18432
s_waitcnt lgkmcnt(2)
v_lshl_add_u32 v214, s13, 8, v214
v_mfma_f32_32x32x16_bf16 v[180:195], v[196:199], v[80:83], v[180:195]
s_waitcnt lgkmcnt(1)
ds_read_b128 v[196:199], v176 offset:22528
v_mul_f32 v216, 0x3acccccd, v216
v_fma_f32 v216, -v212, v212, v216
v_max_f32 v216, 0, v216
v_lshl_add_u32 v213, s13, 8, v213
v_mfma_f32_32x32x16_bf16 v[180:195], v[200:203], v[84:87], v[180:195]
ds_read_b128 v[200:203], v177 offset:22528
s_waitcnt lgkmcnt(2)
v_add_f32 v216, 0x3727c5ac, v216
v_mfma_f32_32x32x16_bf16 v[180:195], v[204:207], v[88:91], v[180:195]
s_add_u32 s19, s30, 123264
buffer_load_dword a3, v1, s[52:55], s19 offen
ds_read_b128 v[204:207], v178 offset:22528
v_rsq_f32 v216, v216
s_waitcnt lgkmcnt(2)
v_mfma_f32_32x32x16_bf16 v[180:195], v[208:211], v[92:95], v[180:195]
v_mul_f32 v212, v216, v212
ds_read_b128 v[208:211], v179 offset:22528
v_mfma_f32_32x32x16_bf16 v[180:195], v[196:199], v[96:99], v[180:195]
ds_read_b128 v[196:199], v176 offset:26624
v_permlane32_swap_b32 v216, v212
s_waitcnt lgkmcnt(3)
v_mfma_f32_32x32x16_bf16 v[180:195], v[200:203], v[100:103], v[180:195]
s_waitcnt lgkmcnt(2)
ds_read_b128 v[200:203], v177 offset:26624
ds_write_b32 v213, v216 offset:1024
v_mfma_f32_32x32x16_bf16 v[180:195], v[204:207], v[104:107], v[180:195]
s_waitcnt lgkmcnt(3)
ds_read_b128 v[204:207], v178 offset:26624
ds_read_b128 v[244:247], v214 offset:1216
v_mfma_f32_32x32x16_bf16 v[180:195], v[208:211], v[108:111], v[180:195]
s_waitcnt lgkmcnt(4)
s_waitcnt lgkmcnt(3)
ds_read_b128 v[232:235], v214 offset:1120
ds_read_b128 v[208:211], v179 offset:26624
v_mfma_f32_32x32x16_bf16 v[180:195], v[196:199], v[112:115], v[180:195]
ds_read_b128 v[236:239], v214 offset:1152
ds_read_b128 v[248:251], v214 offset:1248
v_mfma_f32_32x32x16_bf16 v[180:195], v[200:203], v[116:119], v[180:195]
ds_read_b128 v[196:199], v176 offset:30720
s_waitcnt lgkmcnt(6)
ds_read_b128 v[224:227], v214 offset:1056
ds_read_b128 v[200:203], v177 offset:30720
s_waitcnt lgkmcnt(5)
v_mfma_f32_32x32x16_bf16 v[180:195], v[204:207], v[120:123], v[180:195]
ds_read_b128 v[240:243], v214 offset:1184
v_mfma_f32_32x32x16_bf16 v[180:195], v[208:211], v[124:127], v[180:195]
s_waitcnt lgkmcnt(5)
s_waitcnt lgkmcnt(3)
ds_read_b128 v[204:207], v178 offset:30720
ds_read_b128 v[208:211], v179 offset:30720
v_mul_f32 v247, v247, v7
v_mfma_f32_32x32x16_bf16 v[180:195], v[196:199], v[128:131], v[180:195]
ds_read_b128 v[196:199], v176 offset:34816
ds_read_b128 v[228:231], v214 offset:1088
ds_read_b128 v[220:223], v214 offset:1024
s_waitcnt lgkmcnt(6)
v_mul_f32 v238, v238, v7
v_mfma_f32_32x32x16_bf16 v[180:195], v[200:203], v[132:135], v[180:195]
v_mul_f32 v250, v250, v7
v_mul_f32 v237, v237, v7
v_mul_f32 v245, v245, v7
v_mul_f32 v236, v236, v7
s_waitcnt lgkmcnt(4)
v_mul_f32 v239, v239, v7
v_mfma_f32_32x32x16_bf16 v[180:195], v[204:207], v[136:139], v[180:195]
ds_read_b128 v[200:203], v177 offset:34816
v_mul_f32 v240, v240, v7
s_waitcnt lgkmcnt(3)
ds_read_b128 v[204:207], v178 offset:34816
v_mfma_f32_32x32x16_bf16 v[180:195], v[208:211], v[140:143], v[180:195]
v_mfma_f32_32x32x16_bf16 v[180:195], v[196:199], v[144:147], v[180:195]
ds_read_b128 v[208:211], v179 offset:34816
s_waitcnt lgkmcnt(1)
ds_read_b128 v[196:199], v176 offset:38912
v_mfma_f32_32x32x16_bf16 v[180:195], v[200:203], v[148:151], v[180:195]
v_mfma_f32_32x32x16_bf16 v[180:195], v[204:207], v[152:155], v[180:195]
v_mul_f32 v246, v246, v7
v_mul_f32 v242, v242, v7
s_waitcnt lgkmcnt(1)
ds_read_b128 v[200:203], v177 offset:38912
v_mfma_f32_32x32x16_bf16 v[180:195], v[208:211], v[156:159], v[180:195]
v_mul_f32 v249, v249, v7
ds_read_b128 v[204:207], v178 offset:38912
s_waitcnt lgkmcnt(2)
ds_read_b128 v[208:211], v179 offset:38912
v_mfma_f32_32x32x16_bf16 v[180:195], v[196:199], v[160:163], v[180:195]
s_waitcnt lgkmcnt(2)
v_mfma_f32_32x32x16_bf16 v[180:195], v[200:203], v[164:167], v[180:195]
v_mul_f32 v241, v241, v7
v_mul_f32 v244, v244, v7
v_mul_f32 v248, v248, v7
s_waitcnt lgkmcnt(1)
v_mfma_f32_32x32x16_bf16 v[180:195], v[204:207], v[168:171], v[180:195]
s_waitcnt lgkmcnt(0)
v_mul_f32 v251, v251, v7
v_mfma_f32_32x32x16_bf16 v[180:195], v[208:211], v[172:175], v[180:195]
s_nop 0
v_mul_f32 v243, v243, v7
s_nop 9
v_pk_fma_f32 v[182:183], v[182:183], v[222:223], v[238:239] neg_lo:[0,0,1] neg_hi:[0,0,1]
v_pk_fma_f32 v[180:181], v[180:181], v[220:221], v[236:237] neg_lo:[0,0,1] neg_hi:[0,0,1]
v_pk_fma_f32 v[194:195], v[194:195], v[234:235], v[250:251] neg_lo:[0,0,1] neg_hi:[0,0,1]
v_pk_fma_f32 v[186:187], v[186:187], v[226:227], v[242:243] neg_lo:[0,0,1] neg_hi:[0,0,1]
v_pk_fma_f32 v[192:193], v[192:193], v[232:233], v[248:249] neg_lo:[0,0,1] neg_hi:[0,0,1]
v_cvt_pk_bf16_f32 v197, v182, v183
v_cvt_pk_bf16_f32 v202, v192, v193
v_pk_fma_f32 v[188:189], v[188:189], v[228:229], v[244:245] neg_lo:[0,0,1] neg_hi:[0,0,1]
v_pk_fma_f32 v[190:191], v[190:191], v[230:231], v[246:247] neg_lo:[0,0,1] neg_hi:[0,0,1]
v_pk_fma_f32 v[184:185], v[184:185], v[224:225], v[240:241] neg_lo:[0,0,1] neg_hi:[0,0,1]
v_cvt_pk_bf16_f32 v198, v184, v185
v_cvt_pk_bf16_f32 v201, v190, v191
v_cvt_pk_bf16_f32 v203, v194, v195
v_cvt_pk_bf16_f32 v199, v186, v187
v_cvt_pk_bf16_f32 v200, v188, v189
v_cvt_pk_bf16_f32 v196, v180, v181
buffer_store_dwordx4 v[196:199], v6, s[4:7], s27 offen offset:0 sc1
buffer_store_dwordx4 v[200:203], v6, s[4:7], s27 offen offset:1024 sc1
s_waitcnt vmcnt(2)
ds_write_b128 v4, a[0:3] offset:2048
v_add_u32 v4, 1024, v4
s_add_u32 s30, s30, 657408
v_add_u32 v176, 40960, v176
v_add_u32 v177, 40960, v177
v_add_u32 v178, 40960, v178
v_add_u32 v179, 40960, v179
s_add_u32 s27, s27, 1310720
s_add_u32 s28, s28, 1
s_cmp_lt_u32 s28, 2
s_cbranch_scc1 p1_43
s_lshl_b32 s18, s39, 7
s_add_u32 s18, s18, 11571200
s_cmp_eq_u32 s13, 0
s_cselect_b32 s22, s18, s6
s_mov_b32 s23, 1
s_waitcnt vmcnt(0)
s_barrier
v_mov_b32 v3, s23
s_mov_b64 exec, 1
buffer_store_dword v3, off, s[4:7], s22 sc1
s_mov_b64 exec, -1
s_mov_b32 s22, s6
v_subrev_u32 v4, 2048, v4
ds_write_b128 v4, a[8:11] offset:0
ds_write_b128 v4, a[12:15] offset:1024
alay_44:
v_bfe_u32 v96, v0, 4, 4
v_lshrrev_b32 v97, 8, v0
v_lshlrev_b32 v97, 2, v97
v_lshl_add_u32 v98, s13, 4, v96
v_add_u32 v99, 0, v97
v_mul_u32_u24 v99, v99, v98
v_and_b32 v99, 63, v99
v_cvt_f32_u32 v99, v99
v_mul_f32 v99, 0x3c800000, v99
v_cos_f32 v104, v99
v_sin_f32 v112, v99
v_add_u32 v99, 1, v97
v_mul_u32_u24 v99, v99, v98
v_and_b32 v99, 63, v99
v_cvt_f32_u32 v99, v99
v_mul_f32 v99, 0x3c800000, v99
v_cos_f32 v105, v99
v_sin_f32 v113, v99
v_add_u32 v99, 2, v97
v_mul_u32_u24 v99, v99, v98
v_and_b32 v99, 63, v99
v_cvt_f32_u32 v99, v99
v_mul_f32 v99, 0x3c800000, v99
v_cos_f32 v106, v99
v_sin_f32 v114, v99
v_add_u32 v99, 3, v97
v_mul_u32_u24 v99, v99, v98
v_and_b32 v99, 63, v99
v_cvt_f32_u32 v99, v99
v_mul_f32 v99, 0x3c800000, v99
v_cos_f32 v107, v99
v_sin_f32 v115, v99
v_add_u32 v99, 16, v97
v_mul_u32_u24 v99, v99, v98
v_and_b32 v99, 63, v99
v_cvt_f32_u32 v99, v99
v_mul_f32 v99, 0x3c800000, v99
v_cos_f32 v108, v99
v_sin_f32 v116, v99
v_add_u32 v99, 17, v97
v_mul_u32_u24 v99, v99, v98
v_and_b32 v99, 63, v99
v_cvt_f32_u32 v99, v99
v_mul_f32 v99, 0x3c800000, v99
v_cos_f32 v109, v99
v_sin_f32 v117, v99
v_add_u32 v99, 18, v97
v_mul_u32_u24 v99, v99, v98
v_and_b32 v99, 63, v99
v_cvt_f32_u32 v99, v99
v_mul_f32 v99, 0x3c800000, v99
v_cos_f32 v110, v99
v_sin_f32 v118, v99
v_add_u32 v99, 19, v97
v_mul_u32_u24 v99, v99, v98
v_and_b32 v99, 63, v99
v_cvt_f32_u32 v99, v99
v_mul_f32 v99, 0x3c800000, v99
v_cos_f32 v111, v99
v_sin_f32 v119, v99
v_cvt_pk_bf16_f32 v16, v104, v105
v_cvt_pk_bf16_f32 v24, v112, v113
v_xor_b32 v32, 0x80008000, v24
v_cvt_pk_bf16_f32 v17, v106, v107
v_cvt_pk_bf16_f32 v25, v114, v115
v_xor_b32 v33, 0x80008000, v25
v_cvt_pk_bf16_f32 v18, v108, v109
v_cvt_pk_bf16_f32 v26, v116, v117
v_xor_b32 v34, 0x80008000, v26
v_cvt_pk_bf16_f32 v19, v110, v111
v_cvt_pk_bf16_f32 v27, v118, v119
v_xor_b32 v35, 0x80008000, v27
v_add_u32 v99, 32, v97
v_mul_u32_u24 v99, v99, v98
v_and_b32 v99, 63, v99
v_cvt_f32_u32 v99, v99
v_mul_f32 v99, 0x3c800000, v99
v_cos_f32 v104, v99
v_sin_f32 v112, v99
v_add_u32 v99, 33, v97
v_mul_u32_u24 v99, v99, v98
v_and_b32 v99, 63, v99
v_cvt_f32_u32 v99, v99
v_mul_f32 v99, 0x3c800000, v99
v_cos_f32 v105, v99
v_sin_f32 v113, v99
v_add_u32 v99, 34, v97
v_mul_u32_u24 v99, v99, v98
v_and_b32 v99, 63, v99
v_cvt_f32_u32 v99, v99
v_mul_f32 v99, 0x3c800000, v99
v_cos_f32 v106, v99
v_sin_f32 v114, v99
v_add_u32 v99, 35, v97
v_mul_u32_u24 v99, v99, v98
v_and_b32 v99, 63, v99
v_cvt_f32_u32 v99, v99
v_mul_f32 v99, 0x3c800000, v99
v_cos_f32 v107, v99
v_sin_f32 v115, v99
v_add_u32 v99, 48, v97
v_mul_u32_u24 v99, v99, v98
v_and_b32 v99, 63, v99
v_cvt_f32_u32 v99, v99
v_mul_f32 v99, 0x3c800000, v99
v_cos_f32 v108, v99
v_sin_f32 v116, v99
v_add_u32 v99, 49, v97
v_mul_u32_u24 v99, v99, v98
v_and_b32 v99, 63, v99
v_cvt_f32_u32 v99, v99
v_mul_f32 v99, 0x3c800000, v99
v_cos_f32 v109, v99
v_sin_f32 v117, v99
v_add_u32 v99, 50, v97
v_mul_u32_u24 v99, v99, v98
v_and_b32 v99, 63, v99
v_cvt_f32_u32 v99, v99
v_mul_f32 v99, 0x3c800000, v99
v_cos_f32 v110, v99
v_sin_f32 v118, v99
v_add_u32 v99, 51, v97
v_mul_u32_u24 v99, v99, v98
v_and_b32 v99, 63, v99
v_cvt_f32_u32 v99, v99
v_mul_f32 v99, 0x3c800000, v99
v_cos_f32 v111, v99
v_sin_f32 v119, v99
v_cvt_pk_bf16_f32 v20, v104, v105
v_cvt_pk_bf16_f32 v28, v112, v113
v_xor_b32 v36, 0x80008000, v28
v_cvt_pk_bf16_f32 v21, v106, v107
v_cvt_pk_bf16_f32 v29, v114, v115
v_xor_b32 v37, 0x80008000, v29
v_cvt_pk_bf16_f32 v22, v108, v109
v_cvt_pk_bf16_f32 v30, v116, v117
v_xor_b32 v38, 0x80008000, v30
v_cvt_pk_bf16_f32 v23, v110, v111
v_cvt_pk_bf16_f32 v31, v118, v119
v_xor_b32 v39, 0x80008000, v31
v_add_u32 v99, 0, v97
v_mul_u32_u24 v99, v99, v98
v_and_b32 v99, 2047, v99
v_cvt_f32_u32 v99, v99
v_mul_f32 v99, 0x3a000000, v99
v_cos_f32 v64, v99
v_sin_f32 v72, v99
v_add_u32 v99, 1, v97
v_mul_u32_u24 v99, v99, v98
v_and_b32 v99, 2047, v99
v_cvt_f32_u32 v99, v99
v_mul_f32 v99, 0x3a000000, v99
v_cos_f32 v65, v99
v_sin_f32 v73, v99
v_add_u32 v99, 2, v97
v_mul_u32_u24 v99, v99, v98
v_and_b32 v99, 2047, v99
v_cvt_f32_u32 v99, v99
v_mul_f32 v99, 0x3a000000, v99
v_cos_f32 v66, v99
v_sin_f32 v74, v99
v_add_u32 v99, 3, v97
v_mul_u32_u24 v99, v99, v98
v_and_b32 v99, 2047, v99
v_cvt_f32_u32 v99, v99
v_mul_f32 v99, 0x3a000000, v99
v_cos_f32 v67, v99
v_sin_f32 v75, v99
v_add_u32 v99, 16, v97
v_mul_u32_u24 v99, v99, v98
v_and_b32 v99, 2047, v99
v_cvt_f32_u32 v99, v99
v_mul_f32 v99, 0x3a000000, v99
v_cos_f32 v68, v99
v_sin_f32 v76, v99
v_add_u32 v99, 17, v97
v_mul_u32_u24 v99, v99, v98
v_and_b32 v99, 2047, v99
v_cvt_f32_u32 v99, v99
v_mul_f32 v99, 0x3a000000, v99
v_cos_f32 v69, v99
v_sin_f32 v77, v99
v_add_u32 v99, 18, v97
v_mul_u32_u24 v99, v99, v98
v_and_b32 v99, 2047, v99
v_cvt_f32_u32 v99, v99
v_mul_f32 v99, 0x3a000000, v99
v_cos_f32 v70, v99
v_sin_f32 v78, v99
v_add_u32 v99, 19, v97
v_mul_u32_u24 v99, v99, v98
v_and_b32 v99, 2047, v99
v_cvt_f32_u32 v99, v99
v_mul_f32 v99, 0x3a000000, v99
v_cos_f32 v71, v99
v_sin_f32 v79, v99
v_lshl_add_u32 v100, s13, 4, v97
v_add_u32 v98, 0, v96
v_add_u32 v99, 0, v97
v_mul_u32_u24 v99, v99, v98
v_and_b32 v99, 31, v99
v_cvt_f32_u32 v99, v99
v_mul_f32 v99, 0x3d000000, v99
v_cos_f32 v104, v99
v_sin_f32 v112, v99
v_add_u32 v99, 1, v97
v_mul_u32_u24 v99, v99, v98
v_and_b32 v99, 31, v99
v_cvt_f32_u32 v99, v99
v_mul_f32 v99, 0x3d000000, v99
v_cos_f32 v105, v99
v_sin_f32 v113, v99
v_add_u32 v99, 2, v97
v_mul_u32_u24 v99, v99, v98
v_and_b32 v99, 31, v99
v_cvt_f32_u32 v99, v99
v_mul_f32 v99, 0x3d000000, v99
v_cos_f32 v106, v99
v_sin_f32 v114, v99
v_add_u32 v99, 3, v97
v_mul_u32_u24 v99, v99, v98
v_and_b32 v99, 31, v99
v_cvt_f32_u32 v99, v99
v_mul_f32 v99, 0x3d000000, v99
v_cos_f32 v107, v99
v_sin_f32 v115, v99
v_add_u32 v99, 16, v97
v_mul_u32_u24 v99, v99, v98
v_and_b32 v99, 31, v99
v_cvt_f32_u32 v99, v99
v_mul_f32 v99, 0x3d000000, v99
v_cos_f32 v108, v99
v_sin_f32 v116, v99
v_add_u32 v99, 17, v97
v_mul_u32_u24 v99, v99, v98
v_and_b32 v99, 31, v99
v_cvt_f32_u32 v99, v99
v_mul_f32 v99, 0x3d000000, v99
v_cos_f32 v109, v99
v_sin_f32 v117, v99
v_add_u32 v99, 18, v97
v_mul_u32_u24 v99, v99, v98
v_and_b32 v99, 31, v99
v_cvt_f32_u32 v99, v99
v_mul_f32 v99, 0x3d000000, v99
v_cos_f32 v110, v99
v_sin_f32 v118, v99
v_add_u32 v99, 19, v97
v_mul_u32_u24 v99, v99, v98
v_and_b32 v99, 31, v99
v_cvt_f32_u32 v99, v99
v_mul_f32 v99, 0x3d000000, v99
v_cos_f32 v111, v99
v_sin_f32 v119, v99
v_cvt_pk_bf16_f32 v40, v104, v105
v_cvt_pk_bf16_f32 v48, v112, v113
v_xor_b32 v56, 0x80008000, v48
v_cvt_pk_bf16_f32 v41, v106, v107
v_cvt_pk_bf16_f32 v49, v114, v115
v_xor_b32 v57, 0x80008000, v49
v_cvt_pk_bf16_f32 v42, v108, v109
v_cvt_pk_bf16_f32 v50, v116, v117
v_xor_b32 v58, 0x80008000, v50
v_cvt_pk_bf16_f32 v43, v110, v111
v_cvt_pk_bf16_f32 v51, v118, v119
v_xor_b32 v59, 0x80008000, v51
v_add_u32 v99, 0, v100
v_mul_u32_u24 v99, v99, v98
v_and_b32 v99, 2047, v99
v_cvt_f32_u32 v99, v99
v_mul_f32 v99, 0x3a000000, v99
v_cos_f32 v80, v99
v_sin_f32 v88, v99
v_mul_f32 v80, 0x3a000000, v80
v_mul_f32 v88, 0x3a000000, v88
v_add_u32 v99, 1, v100
v_mul_u32_u24 v99, v99, v98
v_and_b32 v99, 2047, v99
v_cvt_f32_u32 v99, v99
v_mul_f32 v99, 0x3a000000, v99
v_cos_f32 v81, v99
v_sin_f32 v89, v99
v_mul_f32 v81, 0x3a000000, v81
v_mul_f32 v89, 0x3a000000, v89
v_add_u32 v99, 2, v100
v_mul_u32_u24 v99, v99, v98
v_and_b32 v99, 2047, v99
v_cvt_f32_u32 v99, v99
v_mul_f32 v99, 0x3a000000, v99
v_cos_f32 v82, v99
v_sin_f32 v90, v99
v_mul_f32 v82, 0x3a000000, v82
v_mul_f32 v90, 0x3a000000, v90
v_add_u32 v99, 3, v100
v_mul_u32_u24 v99, v99, v98
v_and_b32 v99, 2047, v99
v_cvt_f32_u32 v99, v99
v_mul_f32 v99, 0x3a000000, v99
v_cos_f32 v83, v99
v_sin_f32 v91, v99
v_mul_f32 v83, 0x3a000000, v83
v_mul_f32 v91, 0x3a000000, v91
v_add_u32 v98, 16, v96
v_add_u32 v99, 0, v97
v_mul_u32_u24 v99, v99, v98
v_and_b32 v99, 31, v99
v_cvt_f32_u32 v99, v99
v_mul_f32 v99, 0x3d000000, v99
v_cos_f32 v104, v99
v_sin_f32 v112, v99
v_add_u32 v99, 1, v97
v_mul_u32_u24 v99, v99, v98
v_and_b32 v99, 31, v99
v_cvt_f32_u32 v99, v99
v_mul_f32 v99, 0x3d000000, v99
v_cos_f32 v105, v99
v_sin_f32 v113, v99
v_add_u32 v99, 2, v97
v_mul_u32_u24 v99, v99, v98
v_and_b32 v99, 31, v99
v_cvt_f32_u32 v99, v99
v_mul_f32 v99, 0x3d000000, v99
v_cos_f32 v106, v99
v_sin_f32 v114, v99
v_add_u32 v99, 3, v97
v_mul_u32_u24 v99, v99, v98
v_and_b32 v99, 31, v99
v_cvt_f32_u32 v99, v99
v_mul_f32 v99, 0x3d000000, v99
v_cos_f32 v107, v99
v_sin_f32 v115, v99
v_add_u32 v99, 16, v97
v_mul_u32_u24 v99, v99, v98
v_and_b32 v99, 31, v99
v_cvt_f32_u32 v99, v99
v_mul_f32 v99, 0x3d000000, v99
v_cos_f32 v108, v99
v_sin_f32 v116, v99
v_add_u32 v99, 17, v97
v_mul_u32_u24 v99, v99, v98
v_and_b32 v99, 31, v99
v_cvt_f32_u32 v99, v99
v_mul_f32 v99, 0x3d000000, v99
v_cos_f32 v109, v99
v_sin_f32 v117, v99
v_add_u32 v99, 18, v97
v_mul_u32_u24 v99, v99, v98
v_and_b32 v99, 31, v99
v_cvt_f32_u32 v99, v99
v_mul_f32 v99, 0x3d000000, v99
v_cos_f32 v110, v99
v_sin_f32 v118, v99
v_add_u32 v99, 19, v97
v_mul_u32_u24 v99, v99, v98
v_and_b32 v99, 31, v99
v_cvt_f32_u32 v99, v99
v_mul_f32 v99, 0x3d000000, v99
v_cos_f32 v111, v99
v_sin_f32 v119, v99
v_cvt_pk_bf16_f32 v44, v104, v105
v_cvt_pk_bf16_f32 v52, v112, v113
v_xor_b32 v60, 0x80008000, v52
v_cvt_pk_bf16_f32 v45, v106, v107
v_cvt_pk_bf16_f32 v53, v114, v115
v_xor_b32 v61, 0x80008000, v53
v_cvt_pk_bf16_f32 v46, v108, v109
v_cvt_pk_bf16_f32 v54, v116, v117
v_xor_b32 v62, 0x80008000, v54
v_cvt_pk_bf16_f32 v47, v110, v111
v_cvt_pk_bf16_f32 v55, v118, v119
v_xor_b32 v63, 0x80008000, v55
v_add_u32 v99, 0, v100
v_mul_u32_u24 v99, v99, v98
v_and_b32 v99, 2047, v99
v_cvt_f32_u32 v99, v99
v_mul_f32 v99, 0x3a000000, v99
v_cos_f32 v84, v99
v_sin_f32 v92, v99
v_mul_f32 v84, 0x3a000000, v84
v_mul_f32 v92, 0x3a000000, v92
v_add_u32 v99, 1, v100
v_mul_u32_u24 v99, v99, v98
v_and_b32 v99, 2047, v99
v_cvt_f32_u32 v99, v99
v_mul_f32 v99, 0x3a000000, v99
v_cos_f32 v85, v99
v_sin_f32 v93, v99
v_mul_f32 v85, 0x3a000000, v85
v_mul_f32 v93, 0x3a000000, v93
v_add_u32 v99, 2, v100
v_mul_u32_u24 v99, v99, v98
v_and_b32 v99, 2047, v99
v_cvt_f32_u32 v99, v99
v_mul_f32 v99, 0x3a000000, v99
v_cos_f32 v86, v99
v_sin_f32 v94, v99
v_mul_f32 v86, 0x3a000000, v86
v_mul_f32 v94, 0x3a000000, v94
v_add_u32 v99, 3, v100
v_mul_u32_u24 v99, v99, v98
v_and_b32 v99, 2047, v99
v_cvt_f32_u32 v99, v99
v_mul_f32 v99, 0x3a000000, v99
v_cos_f32 v87, v99
v_sin_f32 v95, v99
v_mul_f32 v87, 0x3a000000, v87
v_mul_f32 v95, 0x3a000000, v95
v_lshrrev_b32 v98, 6, v0
v_and_b32 v99, 7, v98
v_lshlrev_b32 v99, 5, v99
v_lshl_add_u32 v98, v98, 8, v99
v_and_b32 v99, 16, v0
v_add_u32 v98, v98, v99
v_bfe_u32 v99, v0, 5, 1
v_lshl_add_u32 v224, v99, 3, v98
v_xor_b32 v225, 32, v224
v_xor_b32 v226, 64, v224
v_xor_b32 v227, 96, v224
v_xor_b32 v228, 128, v224
v_xor_b32 v229, 160, v224
v_xor_b32 v230, 192, v224
v_xor_b32 v231, 224, v224
v_lshrrev_b32 v98, 8, v0
v_bfe_u32 v99, v0, 5, 3
v_xor_b32 v99, v99, v98
v_mul_u32_u24 v98, 40960, v98
v_and_b32 v96, 16, v0
v_add_u32 v98, v98, v96
v_and_b32 v96, 3, v99
v_lshl_add_u32 v98, v96, 5, v98
v_lshrrev_b32 v99, 2, v99
v_lshl_add_u32 v232, v99, 10, v98
v_xor_b32 v99, 1, v99
v_lshl_add_u32 v233, v99, 10, v98
s_lshl_b32 s18, s13, 12
s_add_u32 s19, s18, 147456
v_add_u32 v99, s19, v0
ds_read_b128 v[208:211], v99 offset:0
ds_read_b128 v[212:215], v99 offset:1024
ds_read_b128 v[216:219], v99 offset:2048
ds_read_b128 v[220:223], v99 offset:3072
s_mov_b32 s25, s18
s_mul_i32 s26, s16, 3145728
s_mul_i32 s19, s13, 655360
s_add_u32 s26, s26, s19
s_lshl_b32 s19, s39, 8
s_add_u32 s27, s26, s19
s_add_u32 s27, s27, 103809024
s_lshr_b32 s19, s39, 3
s_lshl_b32 s19, s19, 11
s_add_u32 s26, s26, s19
s_and_b32 s19, s39, 7
s_lshl_b32 s19, s19, 7
s_add_u32 s26, s26, s19
s_add_u32 s26, s26, 97517568
s_cmp_lg_u32 s16, 0
s_cbranch_scc1 cw_45
s_cmp_lg_u32 s13, 0
s_cbranch_scc1 polld_48
v_lshlrev_b32 v11, 3, v0
v_add_u32 v12, 8192, v11
v_add_u32 v3, 16384, v11
v_min_u32 v3, 20352, v3
s_mov_b32 s21, 11571200
s_mov_b32 s17, 0
poll_47:
buffer_load_dword v8, v11, s[4:7], s21 offen sc1
buffer_load_dword v9, v12, s[4:7], s21 offen sc1
buffer_load_dword v10, v3, s[4:7], s21 offen sc1
s_add_u32 s17, s17, 1
s_cmp_gt_u32 s17, 262144
s_cbranch_scc1 L_fail
s_waitcnt vmcnt(0)
v_min3_u32 v8, v8, v9, v10
v_cmp_gt_u32 vcc, 1, v8
s_cbranch_vccz polld_48
s_sleep 2
s_branch poll_47
polld_48:
s_barrier
s_branch cw_46
cw_45:
s_cmp_lg_u32 s13, 0
s_cbranch_scc1 polld_50
v_lshlrev_b32 v11, 3, v0
v_min_u32 v11, 4352, v11
s_mov_b32 s21, 11552768
s_mov_b32 s17, 0
poll_49:
buffer_load_dword v8, v11, s[4:7], s21 offen sc1
s_add_u32 s17, s17, 1
s_cmp_gt_u32 s17, 262144
s_cbranch_scc1 L_fail
s_waitcnt vmcnt(0)
v_cmp_gt_u32 vcc, 1, v8
s_cbranch_vccz polld_50
s_sleep 2
s_branch poll_49
polld_50:
s_barrier
cw_46:
s_add_u32 m0, s25, 0
s_add_u32 s20, s26, 0
buffer_load_dwordx4 v232, s[4:7], s20 offen sc1 lds
s_add_u32 m0, s25, 1024
s_add_u32 s20, s26, 163840
buffer_load_dwordx4 v233, s[4:7], s20 offen sc1 lds
s_add_u32 m0, s25, 2048
s_add_u32 s20, s26, 327680
buffer_load_dwordx4 v232, s[4:7], s20 offen sc1 lds
s_add_u32 m0, s25, 3072
s_add_u32 s20, s26, 491520
buffer_load_dwordx4 v233, s[4:7], s20 offen sc1 lds
s_lshr_b32 s18, s13, 1
s_lshl_b32 s18, s18, 10
s_and_b32 s19, s13, 1
s_lshl_b32 s19, s19, 3
s_add_u32 s18, s18, s19
v_add_u32 v234, s18, v0
v_bfe_u32 v235, v0, 4, 4
v_mul_u32_u24 v235, 40960, v235
v_lshrrev_b32 v99, 8, v0
v_lshl_add_u32 v235, v99, 4, v235
s_waitcnt vmcnt(0)
s_barrier
ds_read_b64_tr_b16 v[96:97], v224 offset:0
ds_read_b64_tr_b16 v[98:99], v224 offset:4096
ds_read_b64_tr_b16 v[114:115], v225 offset:4096
ds_read_b64_tr_b16 v[112:113], v225 offset:0
ds_read_b64_tr_b16 v[118:119], v225 offset:12288
ds_read_b64_tr_b16 v[102:103], v224 offset:12288
ds_read_b64_tr_b16 v[124:125], v229 offset:8192
ds_read_b64_tr_b16 v[100:101], v224 offset:8192
ds_read_b64_tr_b16 v[116:117], v225 offset:8192
ds_read_b64_tr_b16 v[120:121], v229 offset:0
ds_read_b64_tr_b16 v[122:123], v229 offset:4096
ds_read_b64_tr_b16 v[106:107], v228 offset:4096
ds_read_b64_tr_b16 v[142:143], v230 offset:12288
ds_read_b64_tr_b16 v[110:111], v228 offset:12288
ds_read_b64_tr_b16 v[104:105], v228 offset:0
ds_read_b64_tr_b16 v[156:157], v231 offset:8192
s_waitcnt lgkmcnt(14)
v_mfma_f32_16x16x32_bf16 v[160:163], v[96:99], v[16:19], 0
s_waitcnt lgkmcnt(13)
ds_read_b64_tr_b16 v[126:127], v229 offset:12288
s_waitcnt lgkmcnt(13)
v_mfma_f32_16x16x32_bf16 v[168:171], v[112:115], v[16:19], 0
s_waitcnt lgkmcnt(12)
ds_read_b64_tr_b16 v[108:109], v228 offset:8192
ds_read_b64_tr_b16 v[132:133], v226 offset:8192
v_mfma_f32_16x16x32_bf16 v[160:163], v[112:115], v[24:27], v[160:163]
ds_read_b64_tr_b16 v[146:147], v227 offset:4096
ds_read_b64_tr_b16 v[138:139], v230 offset:4096
v_mfma_f32_16x16x32_bf16 v[168:171], v[96:99], v[32:35], v[168:171]
s_waitcnt lgkmcnt(13)
ds_read_b64_tr_b16 v[154:155], v231 offset:4096
ds_read_b64_tr_b16 v[136:137], v230 offset:0
v_mfma_f32_16x16x32_bf16 v[160:163], v[100:103], v[20:23], v[160:163]
s_waitcnt lgkmcnt(12)
ds_read_b64_tr_b16 v[128:129], v226 offset:0
v_and_b32 v112, 0xffff0000, v208
v_mfma_f32_16x16x32_bf16 v[160:163], v[116:119], v[28:31], v[160:163]
ds_read_b64_tr_b16 v[158:159], v231 offset:12288
ds_read_b64_tr_b16 v[130:131], v226 offset:4096
v_mfma_f32_16x16x32_bf16 v[168:171], v[116:119], v[20:23], v[168:171]
ds_read_b64_tr_b16 v[150:151], v227 offset:12288
v_lshlrev_b32 v98, 16, v209
v_mfma_f32_16x16x32_bf16 v[168:171], v[100:103], v[36:39], v[168:171]
s_waitcnt lgkmcnt(12)
ds_read_b64_tr_b16 v[144:145], v227 offset:0
v_mul_f32 v232, v160, v72
v_mfma_f32_16x16x32_bf16 v[172:175], v[120:123], v[16:19], 0
s_waitcnt lgkmcnt(9)
ds_read_b64_tr_b16 v[148:149], v227 offset:8192
ds_read_b64_tr_b16 v[134:135], v226 offset:12288
v_mfma_f32_16x16x32_bf16 v[172:175], v[104:107], v[32:35], v[172:175]
v_and_b32 v113, 0xffff0000, v216
v_mul_f32 v160, v160, v64
v_mfma_f32_16x16x32_bf16 v[164:167], v[104:107], v[16:19], 0
s_waitcnt lgkmcnt(7)
v_mul_f32 v233, v161, v73
v_fma_f32 v160, v168, v72, v160
v_mfma_f32_16x16x32_bf16 v[172:175], v[124:127], v[20:23], v[172:175]
s_waitcnt lgkmcnt(6)
ds_read_b64_tr_b16 v[140:141], v230 offset:8192
v_fma_f32 v168, v168, v64, -v232
v_mfma_f32_16x16x32_bf16 v[172:175], v[108:111], v[36:39], v[172:175]
v_mul_f32 v232, v162, v74
v_mul_f32 v161, v161, v65
v_mfma_f32_16x16x32_bf16 v[164:167], v[120:123], v[24:27], v[164:167]
ds_read_b64_tr_b16 v[152:153], v231 offset:0
v_fma_f32 v161, v169, v73, v161
v_mfma_f32_16x16x32_bf16 v[164:167], v[108:111], v[20:23], v[164:167]
v_fma_f32 v169, v169, v65, -v233
v_mul_f32 v233, v163, v75
v_mfma_f32_16x16x32_bf16 v[164:167], v[124:127], v[28:31], v[164:167]
s_waitcnt lgkmcnt(4)
v_mul_f32 v162, v162, v66
v_mul_f32 v163, v163, v67
v_mfma_f32_16x16x32_bf16 v[180:183], v[136:139], v[16:19], 0
s_waitcnt lgkmcnt(2)
v_fma_f32 v163, v171, v75, v163
v_fma_f32 v162, v170, v74, v162
v_mfma_f32_16x16x32_bf16 v[184:187], v[144:147], v[16:19], 0
s_waitcnt lgkmcnt(0)
v_fma_f32 v171, v171, v67, -v233
v_mul_f32 v233, v165, v77
v_mfma_f32_16x16x32_bf16 v[188:191], v[152:155], v[16:19], 0
v_fma_f32 v170, v170, v66, -v232
v_cvt_pk_bf16_f32 v193, v162, v163
v_mfma_f32_16x16x32_bf16 v[176:179], v[128:131], v[16:19], 0
v_mul_f32 v232, v164, v76
v_mul_f32 v164, v164, v68
v_mfma_f32_16x16x32_bf16 v[184:187], v[128:131], v[32:35], v[184:187]
v_fma_f32 v164, v172, v76, v164
v_fma_f32 v172, v172, v68, -v232
v_mfma_f32_16x16x32_bf16 v[184:187], v[148:151], v[20:23], v[184:187]
v_mul_f32 v165, v165, v69
v_fma_f32 v165, v173, v77, v165
v_mfma_f32_16x16x32_bf16 v[176:179], v[144:147], v[24:27], v[176:179]
v_mul_f32 v232, v166, v78
v_lshlrev_b32 v100, 16, v210
v_mfma_f32_16x16x32_bf16 v[176:179], v[132:135], v[20:23], v[176:179]
v_fma_f32 v173, v173, v69, -v233
v_mul_f32 v233, v167, v79
v_mfma_f32_16x16x32_bf16 v[176:179], v[148:151], v[28:31], v[176:179]
v_cvt_pk_bf16_f32 v194, v164, v165
v_mul_f32 v166, v166, v70
v_mfma_f32_16x16x32_bf16 v[180:183], v[152:155], v[24:27], v[180:183]
v_mul_f32 v167, v167, v71
v_fma_f32 v166, v174, v78, v166
v_mfma_f32_16x16x32_bf16 v[180:183], v[140:143], v[20:23], v[180:183]
v_fma_f32 v167, v175, v79, v167
v_cvt_pk_bf16_f32 v196, v168, v169
v_mfma_f32_16x16x32_bf16 v[184:187], v[132:135], v[36:39], v[184:187]
v_cvt_pk_bf16_f32 v192, v160, v161
v_fma_f32 v174, v174, v70, -v232
v_mfma_f32_16x16x32_bf16 v[188:191], v[136:139], v[32:35], v[188:191]
v_cvt_pk_bf16_f32 v198, v172, v173
v_fma_f32 v175, v175, v71, -v233
v_mfma_f32_16x16x32_bf16 v[180:183], v[156:159], v[28:31], v[180:183]
v_cvt_pk_bf16_f32 v197, v170, v171
v_cvt_pk_bf16_f32 v199, v174, v175
v_mfma_f32_16x16x32_bf16 v[188:191], v[156:159], v[20:23], v[188:191]
v_mul_f32 v233, v177, v73
v_mul_f32 v177, v177, v65
v_mfma_f32_16x16x32_bf16 v[168:171], v[40:43], v[196:199], 0
v_cvt_pk_bf16_f32 v195, v166, v167
v_mul_f32 v232, v176, v72
v_mfma_f32_16x16x32_bf16 v[172:175], v[44:47], v[196:199], 0
v_mul_f32 v176, v176, v64
v_fma_f32 v177, v185, v73, v177
v_mfma_f32_16x16x32_bf16 v[188:191], v[140:143], v[36:39], v[188:191]
v_lshlrev_b32 v97, 16, v216
v_fma_f32 v176, v184, v72, v176
v_mfma_f32_16x16x32_bf16 v[168:171], v[56:59], v[192:195], v[168:171]
v_fma_f32 v184, v184, v64, -v232
v_mul_f32 v232, v178, v74
v_mfma_f32_16x16x32_bf16 v[160:163], v[40:43], v[192:195], 0
v_fma_f32 v185, v185, v65, -v233
v_mul_f32 v178, v178, v66
v_mfma_f32_16x16x32_bf16 v[160:163], v[48:51], v[196:199], v[160:163]
v_fma_f32 v178, v186, v74, v178
v_fma_f32 v186, v186, v66, -v232
v_mfma_f32_16x16x32_bf16 v[164:167], v[44:47], v[192:195], 0
v_mul_f32 v232, v180, v76
v_mul_f32 v180, v180, v68
v_mul_f32 v233, v179, v75
v_mfma_f32_16x16x32_bf16 v[172:175], v[60:63], v[192:195], v[172:175]
v_mul_f32 v179, v179, v67
v_cvt_pk_bf16_f32 v200, v176, v177
v_mfma_f32_16x16x32_bf16 v[164:167], v[52:55], v[196:199], v[164:167]
v_fma_f32 v179, v187, v75, v179
v_fma_f32 v187, v187, v67, -v233
v_fma_f32 v180, v188, v76, v180
v_mul_f32 v233, v181, v77
v_cvt_pk_bf16_f32 v204, v184, v185
v_mul_f32 v181, v181, v69
v_lshlrev_b32 v102, 16, v211
v_fma_f32 v188, v188, v68, -v232
v_cvt_pk_bf16_f32 v205, v186, v187
v_mul_f32 v232, v182, v78
v_cvt_pk_bf16_f32 v201, v178, v179
v_mul_f32 v182, v182, v70
v_fma_f32 v181, v189, v77, v181
v_fma_f32 v189, v189, v69, -v233
v_mul_f32 v233, v183, v79
v_fma_f32 v182, v190, v78, v182
v_cvt_pk_bf16_f32 v202, v180, v181
v_lshlrev_b32 v99, 16, v217
v_mul_f32 v183, v183, v71
v_fma_f32 v183, v191, v79, v183
v_cvt_pk_bf16_f32 v203, v182, v183
v_lshlrev_b32 v106, 16, v213
v_fma_f32 v191, v191, v71, -v233
v_fma_f32 v190, v190, v70, -v232
v_lshlrev_b32 v96, 16, v208
v_mfma_f32_16x16x32_bf16 v[176:179], v[40:43], v[200:203], 0
v_cvt_pk_bf16_f32 v207, v190, v191
v_lshlrev_b32 v103, 16, v219
v_mfma_f32_16x16x32_bf16 v[180:183], v[44:47], v[200:203], 0
v_mul_f32 v232, v160, v97
v_cvt_pk_bf16_f32 v206, v188, v189
v_mul_f32 v233, v161, v99
v_mul_f32 v161, v161, v98
v_mfma_f32_16x16x32_bf16 v[188:191], v[44:47], v[204:207], 0
v_and_b32 v117, 0xffff0000, v218
v_lshlrev_b32 v105, 16, v220
v_mfma_f32_16x16x32_bf16 v[184:187], v[40:43], v[204:207], 0
v_lshlrev_b32 v104, 16, v212
v_lshlrev_b32 v109, 16, v222
v_mfma_f32_16x16x32_bf16 v[180:183], v[52:55], v[204:207], v[180:183]
v_lshlrev_b32 v101, 16, v218
v_lshlrev_b32 v107, 16, v221
v_fma_f32 v161, v169, -v99, v161
v_mfma_f32_16x16x32_bf16 v[184:187], v[56:59], v[200:203], v[184:187]
v_lshlrev_b32 v108, 16, v214
v_lshlrev_b32 v111, 16, v223
v_fma_f32 v169, v169, v98, v233
v_mul_f32 v160, v160, v96
v_fma_f32 v160, v168, -v97, v160
v_fma_f32 v168, v168, v96, v232
v_mul_f32 v233, v163, v103
v_mul_f32 v232, v162, v101
v_mfma_f32_16x16x32_bf16 v[176:179], v[48:51], v[204:207], v[176:179]
v_mul_f32 v162, v162, v100
v_fma_f32 v162, v170, -v101, v162
v_mul_f32 v163, v163, v102
v_fma_f32 v163, v171, -v103, v163
v_cvt_pk_bf16_f32 v193, v162, v163
v_mfma_f32_16x16x32_bf16 v[188:191], v[60:63], v[200:203], v[188:191]
v_fma_f32 v170, v170, v100, v232
v_fma_f32 v171, v171, v102, v233
v_mul_f32 v233, v165, v107
v_mul_f32 v232, v164, v105
v_lshlrev_b32 v110, 16, v215
v_cvt_pk_bf16_f32 v192, v160, v161
v_cvt_pk_bf16_f32 v197, v170, v171
v_mul_f32 v165, v165, v106
v_mul_f32 v164, v164, v104
v_fma_f32 v164, v172, -v105, v164
v_fma_f32 v165, v173, -v107, v165
v_fma_f32 v172, v172, v104, v232
v_fma_f32 v173, v173, v106, v233
v_mul_f32 v232, v166, v109
v_cvt_pk_bf16_f32 v194, v164, v165
v_mul_f32 v233, v167, v111
v_mul_f32 v167, v167, v110
v_fma_f32 v167, v175, -v111, v167
v_mul_f32 v166, v166, v108
v_fma_f32 v166, v174, -v109, v166
v_cvt_pk_bf16_f32 v195, v166, v167
v_fma_f32 v175, v175, v110, v233
v_cvt_pk_bf16_f32 v198, v172, v173
v_mfma_f32_16x16x32_bf16 v[160:163], v[192:195], v[40:43], 0
v_fma_f32 v174, v174, v108, v232
v_cvt_pk_bf16_f32 v196, v168, v169
v_cvt_pk_bf16_f32 v199, v174, v175
v_and_b32 v115, 0xffff0000, v217
v_and_b32 v114, 0xffff0000, v209
v_mfma_f32_16x16x32_bf16 v[164:167], v[192:195], v[44:47], 0
v_and_b32 v119, 0xffff0000, v219
v_mul_f32 v232, v176, v113
v_and_b32 v127, 0xffff0000, v223
v_mul_f32 v233, v177, v115
v_mfma_f32_16x16x32_bf16 v[172:175], v[196:199], v[44:47], 0
v_mul_f32 v176, v176, v112
v_and_b32 v118, 0xffff0000, v211
v_mfma_f32_16x16x32_bf16 v[160:163], v[196:199], v[56:59], v[160:163]
v_and_b32 v121, 0xffff0000, v220
v_and_b32 v116, 0xffff0000, v210
v_and_b32 v124, 0xffff0000, v214
v_mul_f32 v177, v177, v114
v_fma_f32 v176, v184, -v113, v176
v_mfma_f32_16x16x32_bf16 v[168:171], v[196:199], v[40:43], 0
v_fma_f32 v177, v185, -v115, v177
v_fma_f32 v184, v184, v112, v232
v_mfma_f32_16x16x32_bf16 v[172:175], v[192:195], v[52:55], v[172:175]
v_fma_f32 v185, v185, v114, v233
v_mul_f32 v232, v178, v117
v_mfma_f32_16x16x32_bf16 v[164:167], v[196:199], v[60:63], v[164:167]
v_mul_f32 v178, v178, v116
v_cvt_pk_bf16_f32 v200, v176, v177
v_mfma_f32_16x16x32_bf16 v[168:171], v[192:195], v[48:51], v[168:171]
v_and_b32 v123, 0xffff0000, v221
v_mul_f32 v233, v179, v119
v_mul_f32 v179, v179, v118
v_and_b32 v122, 0xffff0000, v213
v_fma_f32 v179, v187, -v119, v179
v_fma_f32 v187, v187, v118, v233
v_fma_f32 v178, v186, -v117, v178
v_mul_f32 v233, v181, v123
v_and_b32 v126, 0xffff0000, v215
v_and_b32 v120, 0xffff0000, v212
v_fma_f32 v186, v186, v116, v232
v_and_b32 v125, 0xffff0000, v222
v_cvt_pk_bf16_f32 v205, v186, v187
v_mul_f32 v181, v181, v122
v_fma_f32 v181, v189, -v123, v181
v_fma_f32 v189, v189, v122, v233
v_mul_f32 v232, v180, v121
v_mul_f32 v180, v180, v120
v_mul_f32 v233, v183, v127
v_mul_f32 v183, v183, v126
v_fma_f32 v183, v191, -v127, v183
v_fma_f32 v180, v188, -v121, v180
v_fma_f32 v191, v191, v126, v233
v_fma_f32 v188, v188, v120, v232
v_mul_f32 v232, v182, v125
v_mul_f32 v233, v161, v89
v_mul_f32 v182, v182, v124
v_fma_f32 v182, v190, -v125, v182
v_cvt_pk_bf16_f32 v206, v188, v189
v_cvt_pk_bf16_f32 v204, v184, v185
v_cvt_pk_bf16_f32 v201, v178, v179
v_fma_f32 v190, v190, v124, v232
v_cvt_pk_bf16_f32 v207, v190, v191
v_mul_f32 v232, v160, v88
v_mul_f32 v160, v160, v80
v_mfma_f32_16x16x32_bf16 v[188:191], v[204:207], v[44:47], 0
v_fma_f32 v160, v168, -v88, v160
v_fma_f32 v168, v168, v80, v232
v_mul_f32 v232, v162, v90
v_mul_f32 v161, v161, v81
v_cvt_pk_bf16_f32 v203, v182, v183
v_mfma_f32_16x16x32_bf16 v[184:187], v[204:207], v[40:43], 0
v_fma_f32 v161, v169, -v89, v161
v_cvt_pk_bf16_f32 v202, v180, v181
v_fma_f32 v169, v169, v81, v233
v_mul_f32 v162, v162, v82
v_mfma_f32_16x16x32_bf16 v[180:183], v[200:203], v[44:47], 0
v_fma_f32 v162, v170, -v90, v162
v_mul_f32 v233, v163, v91
v_mfma_f32_16x16x32_bf16 v[176:179], v[200:203], v[40:43], 0
v_fma_f32 v170, v170, v82, v232
v_mul_f32 v163, v163, v83
v_mfma_f32_16x16x32_bf16 v[184:187], v[200:203], v[48:51], v[184:187]
v_fma_f32 v163, v171, -v91, v163
v_mul_f32 v232, v164, v92
v_mul_f32 v164, v164, v84
v_mfma_f32_16x16x32_bf16 v[176:179], v[204:207], v[56:59], v[176:179]
v_fma_f32 v171, v171, v83, v233
v_fma_f32 v164, v172, -v92, v164
v_mul_f32 v233, v165, v93
v_mul_f32 v165, v165, v85
v_fma_f32 v165, v173, -v93, v165
v_cvt_pk_bf16_f32 v192, v160, v161
v_mfma_f32_16x16x32_bf16 v[188:191], v[200:203], v[52:55], v[188:191]
v_fma_f32 v173, v173, v85, v233
v_mul_f32 v233, v167, v95
v_mul_f32 v167, v167, v87
v_fma_f32 v172, v172, v84, v232
v_cvt_pk_bf16_f32 v196, v168, v169
v_mul_f32 v232, v166, v94
v_cvt_pk_bf16_f32 v193, v162, v163
v_fma_f32 v167, v175, -v95, v167
v_mul_f32 v166, v166, v86
v_fma_f32 v166, v174, -v94, v166
v_fma_f32 v174, v174, v86, v232
v_mul_f32 v232, v176, v88
v_mul_f32 v176, v176, v80
v_cvt_pk_bf16_f32 v197, v170, v171
v_cvt_pk_bf16_f32 v195, v166, v167
v_fma_f32 v175, v175, v87, v233
v_mul_f32 v233, v177, v89
v_cvt_pk_bf16_f32 v199, v174, v175
v_cvt_pk_bf16_f32 v198, v172, v173
v_fma_f32 v176, v184, -v88, v176
v_mul_f32 v177, v177, v81
v_fma_f32 v177, v185, -v89, v177
v_mfma_f32_16x16x32_bf16 v[180:183], v[204:207], v[60:63], v[180:183]
ds_write_b64 v234, v[198:199] offset:22528
ds_write_b64 v234, v[192:193] offset:16384
ds_write_b64 v234, v[196:197] offset:20480
v_fma_f32 v185, v185, v81, v233
v_fma_f32 v184, v184, v80, v232
v_cvt_pk_bf16_f32 v200, v176, v177
v_mul_f32 v232, v178, v90
v_mul_f32 v233, v179, v91
v_mul_f32 v179, v179, v83
v_mul_f32 v178, v178, v82
v_fma_f32 v179, v187, -v91, v179
v_fma_f32 v178, v186, -v90, v178
v_fma_f32 v186, v186, v82, v232
v_cvt_pk_bf16_f32 v194, v164, v165
v_fma_f32 v187, v187, v83, v233
v_mul_f32 v233, v181, v93
v_mul_f32 v181, v181, v85
v_mul_f32 v232, v180, v92
v_fma_f32 v181, v189, -v93, v181
v_cvt_pk_bf16_f32 v204, v184, v185
v_cvt_pk_bf16_f32 v201, v178, v179
v_fma_f32 v189, v189, v85, v233
v_mul_f32 v180, v180, v84
v_fma_f32 v180, v188, -v92, v180
v_cvt_pk_bf16_f32 v205, v186, v187
s_waitcnt lgkmcnt(0)
ds_write_b64 v234, v[204:205] offset:28672
ds_write_b64 v234, v[200:201] offset:24576
ds_write_b64 v234, v[194:195] offset:18432
v_fma_f32 v188, v188, v84, v232
v_mul_f32 v233, v183, v95
v_mul_f32 v183, v183, v87
v_mul_f32 v232, v182, v94
v_fma_f32 v183, v191, -v95, v183
v_fma_f32 v191, v191, v87, v233
v_mul_f32 v182, v182, v86
v_cvt_pk_bf16_f32 v206, v188, v189
v_fma_f32 v182, v190, -v94, v182
v_fma_f32 v190, v190, v86, v232
v_cvt_pk_bf16_f32 v202, v180, v181
v_cvt_pk_bf16_f32 v207, v190, v191
ds_write_b64 v234, v[206:207] offset:30720
v_cvt_pk_bf16_f32 v203, v182, v183
s_waitcnt lgkmcnt(0)
ds_write_b64 v234, v[202:203] offset:26624
s_waitcnt lgkmcnt(0)
s_barrier
ds_read_b128 v[96:99], v0 offset:16384
ds_read_b128 v[112:115], v0 offset:20480
ds_read_b128 v[128:131], v0 offset:24576
ds_read_b128 v[124:127], v0 offset:23552
ds_read_b128 v[144:147], v0 offset:28672
ds_read_b128 v[120:123], v0 offset:22528
s_waitcnt lgkmcnt(5)
v_mfma_f32_16x16x32_bf16 v[160:163], v[96:99], v[16:19], 0
ds_read_b128 v[100:103], v0 offset:17408
s_waitcnt lgkmcnt(5)
v_mfma_f32_16x16x32_bf16 v[168:171], v[112:115], v[16:19], 0
ds_read_b128 v[136:139], v0 offset:26624
v_mfma_f32_16x16x32_bf16 v[160:163], v[112:115], v[32:35], v[160:163]
ds_read_b128 v[148:151], v0 offset:29696
s_waitcnt lgkmcnt(6)
v_mfma_f32_16x16x32_bf16 v[176:179], v[128:131], v[16:19], 0
v_mfma_f32_16x16x32_bf16 v[168:171], v[96:99], v[24:27], v[168:171]
s_waitcnt lgkmcnt(4)
ds_read_b128 v[116:119], v0 offset:21504
ds_read_b128 v[132:135], v0 offset:25600
v_mfma_f32_16x16x32_bf16 v[176:179], v[144:147], v[32:35], v[176:179]
ds_read_b128 v[156:159], v0 offset:31744
v_mfma_f32_16x16x32_bf16 v[184:187], v[144:147], v[16:19], 0
s_waitcnt lgkmcnt(5)
ds_read_b128 v[104:107], v0 offset:18432
v_mfma_f32_16x16x32_bf16 v[184:187], v[128:131], v[24:27], v[184:187]
ds_read_b128 v[152:155], v0 offset:30720
s_waitcnt lgkmcnt(5)
v_mfma_f32_16x16x32_bf16 v[184:187], v[148:151], v[20:23], v[184:187]
s_waitcnt lgkmcnt(4)
v_mfma_f32_16x16x32_bf16 v[160:163], v[100:103], v[20:23], v[160:163]
v_mfma_f32_16x16x32_bf16 v[168:171], v[116:119], v[20:23], v[168:171]
ds_read_b128 v[108:111], v0 offset:19456
v_mfma_f32_16x16x32_bf16 v[172:175], v[120:123], v[16:19], 0
ds_read_b128 v[140:143], v0 offset:27648
s_waitcnt lgkmcnt(3)
v_mfma_f32_16x16x32_bf16 v[164:167], v[104:107], v[16:19], 0
v_mfma_f32_16x16x32_bf16 v[164:167], v[120:123], v[32:35], v[164:167]
v_mfma_f32_16x16x32_bf16 v[180:183], v[136:139], v[16:19], 0
v_mfma_f32_16x16x32_bf16 v[160:163], v[116:119], v[36:39], v[160:163]
s_waitcnt lgkmcnt(1)
s_nop 0
v_mfma_f32_16x16x32_bf16 v[180:183], v[152:155], v[32:35], v[180:183]
s_nop 2
v_mfma_f32_16x16x32_bf16 v[176:179], v[132:135], v[20:23], v[176:179]
s_nop 0
v_cvt_pk_bf16_f32 v193, v162, v163
v_mfma_f32_16x16x32_bf16 v[168:171], v[100:103], v[28:31], v[168:171]
v_mfma_f32_16x16x32_bf16 v[164:167], v[108:111], v[20:23], v[164:167]
v_mfma_f32_16x16x32_bf16 v[176:179], v[148:151], v[36:39], v[176:179]
v_cvt_pk_bf16_f32 v192, v160, v161
s_nop 0
v_mfma_f32_16x16x32_bf16 v[164:167], v[124:127], v[36:39], v[164:167]
s_nop 2
v_mfma_f32_16x16x32_bf16 v[172:175], v[104:107], v[24:27], v[172:175]
s_nop 0
v_cvt_pk_bf16_f32 v200, v176, v177
v_mfma_f32_16x16x32_bf16 v[172:175], v[124:127], v[20:23], v[172:175]
s_nop 0
v_cvt_pk_bf16_f32 v194, v164, v165
s_waitcnt lgkmcnt(0)
v_mfma_f32_16x16x32_bf16 v[180:183], v[140:143], v[20:23], v[180:183]
v_cvt_pk_bf16_f32 v195, v166, v167
v_mfma_f32_16x16x32_bf16 v[180:183], v[156:159], v[36:39], v[180:183]
v_cvt_pk_bf16_f32 v196, v168, v169
v_cvt_pk_bf16_f32 v201, v178, v179
v_mfma_f32_16x16x32_bf16 v[172:175], v[108:111], v[28:31], v[172:175]
buffer_store_dwordx4 v[192:195], v235, s[4:7], s27 offen offset:0 sc1
s_nop 1
v_mfma_f32_16x16x32_bf16 v[184:187], v[132:135], v[28:31], v[184:187]
s_nop 0
v_cvt_pk_bf16_f32 v202, v180, v181
v_mfma_f32_16x16x32_bf16 v[188:191], v[152:155], v[16:19], 0
s_nop 0
v_cvt_pk_bf16_f32 v198, v172, v173
v_cvt_pk_bf16_f32 v203, v182, v183
v_mfma_f32_16x16x32_bf16 v[188:191], v[136:139], v[24:27], v[188:191]
s_nop 0
v_cvt_pk_bf16_f32 v205, v186, v187
v_cvt_pk_bf16_f32 v204, v184, v185
v_mfma_f32_16x16x32_bf16 v[188:191], v[156:159], v[20:23], v[188:191]
v_cvt_pk_bf16_f32 v199, v174, v175
v_cvt_pk_bf16_f32 v197, v170, v171
v_mfma_f32_16x16x32_bf16 v[188:191], v[140:143], v[28:31], v[188:191]
buffer_store_dwordx4 v[196:199], v235, s[4:7], s27 offen offset:64 sc1
s_nop 2
buffer_store_dwordx4 v[200:203], v235, s[4:7], s27 offen offset:128 sc1
s_nop 2
v_cvt_pk_bf16_f32 v207, v190, v191
v_cvt_pk_bf16_f32 v206, v188, v189
buffer_store_dwordx4 v[204:207], v235, s[4:7], s27 offen offset:192 sc1
s_lshl_b32 s18, s39, 7
s_add_u32 s18, s18, 11591680
s_add_u32 s29, s16, 1
s_cmp_eq_u32 s13, 0
s_cselect_b32 s22, s18, s6
s_mov_b32 s23, s29
s_lshl_b32 s18, s34, 7
s_lshl_b32 s19, s13, 5
s_add_u32 s18, s18, s19
s_mov_b32 s19, 0x3acccccd
v_bfe_u32 v222, v0, 4, 5
v_lshrrev_b32 v217, 9, v0
v_and_b32 v220, 19, v222
v_bfe_u32 v223, v222, 2, 1
v_lshl_add_u32 v220, v223, 3, v220
v_bfe_u32 v223, v222, 3, 1
v_lshl_add_u32 v220, v223, 2, v220
v_add_u32 v220, s18, v220
v_lshlrev_b32 v217, 2, v217
v_mov_b32 v221, 0
v_mad_u32_u24 v221, v217, v220, v221
v_mad_u32_u24 v216, v220, 8, 0
v_cvt_f32_u32 v216, v216
v_mul_f32 v222, s19, v216
v_rndne_f32 v222, v222
v_fmac_f32 v216, 0xc4200000, v222
v_mul_f32 v216, s19, v216
v_cos_f32 v216, v216
s_nop 0
v_add_f32 v216, v216, v216
v_mad_u32_u24 v218, v220, 1, 0
v_cvt_f32_u32 v218, v218
v_mul_f32 v222, s19, v218
v_rndne_f32 v222, v222
v_fmac_f32 v218, 0xc4200000, v222
v_mul_f32 v218, s19, v218
v_cos_f32 v218, v218
s_nop 0
v_add_f32 v218, v218, v218
v_mad_u32_u24 v200, v220, 1, v221
v_cvt_f32_u32 v200, v200
v_mul_f32 v222, s19, v200
v_rndne_f32 v222, v222
v_fmac_f32 v200, 0xc4200000, v222
v_mul_f32 v200, s19, v200
v_sin_f32 v201, -v200
v_cos_f32 v200, v200
v_mad_u32_u24 v202, v220, 2, v221
v_cvt_f32_u32 v202, v202
v_mul_f32 v222, s19, v202
v_rndne_f32 v222, v222
v_fmac_f32 v202, 0xc4200000, v222
v_mul_f32 v202, s19, v202
v_sin_f32 v203, -v202
v_cos_f32 v202, v202
s_nop 0
v_pk_fma_f32 v[204:205], v[218:219], v[202:203], v[200:201] op_sel_hi:[0,1,1] neg_lo:[0,0,1] neg_hi:[0,0,1]
v_pk_fma_f32 v[206:207], v[218:219], v[204:205], v[202:203] op_sel_hi:[0,1,1] neg_lo:[0,0,1] neg_hi:[0,0,1]
v_cvt_pk_bf16_f32 v16, v200, v201
v_cvt_pk_bf16_f32 v17, v202, v203
v_cvt_pk_bf16_f32 v18, v204, v205
v_cvt_pk_bf16_f32 v19, v206, v207
v_mad_u32_u24 v208, v220, 9, v221
v_cvt_f32_u32 v208, v208
v_mul_f32 v222, s19, v208
v_rndne_f32 v222, v222
v_fmac_f32 v208, 0xc4200000, v222
v_mul_f32 v208, s19, v208
v_sin_f32 v209, -v208
v_cos_f32 v208, v208
v_mad_u32_u24 v210, v220, 10, v221
v_cvt_f32_u32 v210, v210
v_mul_f32 v222, s19, v210
v_rndne_f32 v222, v222
v_fmac_f32 v210, 0xc4200000, v222
v_mul_f32 v210, s19, v210
v_sin_f32 v211, -v210
v_cos_f32 v210, v210
s_nop 0
v_pk_fma_f32 v[212:213], v[218:219], v[210:211], v[208:209] op_sel_hi:[0,1,1] neg_lo:[0,0,1] neg_hi:[0,0,1]
v_pk_fma_f32 v[214:215], v[218:219], v[212:213], v[210:211] op_sel_hi:[0,1,1] neg_lo:[0,0,1] neg_hi:[0,0,1]
v_cvt_pk_bf16_f32 v20, v208, v209
v_cvt_pk_bf16_f32 v21, v210, v211
v_cvt_pk_bf16_f32 v22, v212, v213
v_cvt_pk_bf16_f32 v23, v214, v215
v_pk_fma_f32 v[200:201], v[216:217], v[208:209], v[200:201] op_sel_hi:[0,1,1] neg_lo:[0,0,1] neg_hi:[0,0,1]
v_pk_fma_f32 v[202:203], v[216:217], v[210:211], v[202:203] op_sel_hi:[0,1,1] neg_lo:[0,0,1] neg_hi:[0,0,1]
v_pk_fma_f32 v[204:205], v[216:217], v[212:213], v[204:205] op_sel_hi:[0,1,1] neg_lo:[0,0,1] neg_hi:[0,0,1]
v_pk_fma_f32 v[206:207], v[216:217], v[214:215], v[206:207] op_sel_hi:[0,1,1] neg_lo:[0,0,1] neg_hi:[0,0,1]
v_cvt_pk_bf16_f32 v24, v200, v201
v_cvt_pk_bf16_f32 v25, v202, v203
v_cvt_pk_bf16_f32 v26, v204, v205
v_cvt_pk_bf16_f32 v27, v206, v207
v_pk_fma_f32 v[208:209], v[216:217], v[200:201], v[208:209] op_sel_hi:[0,1,1] neg_lo:[0,0,1] neg_hi:[0,0,1]
v_pk_fma_f32 v[210:211], v[216:217], v[202:203], v[210:211] op_sel_hi:[0,1,1] neg_lo:[0,0,1] neg_hi:[0,0,1]
v_pk_fma_f32 v[212:213], v[216:217], v[204:205], v[212:213] op_sel_hi:[0,1,1] neg_lo:[0,0,1] neg_hi:[0,0,1]
v_pk_fma_f32 v[214:215], v[216:217], v[206:207], v[214:215] op_sel_hi:[0,1,1] neg_lo:[0,0,1] neg_hi:[0,0,1]
v_cvt_pk_bf16_f32 v28, v208, v209
v_cvt_pk_bf16_f32 v29, v210, v211
v_cvt_pk_bf16_f32 v30, v212, v213
v_cvt_pk_bf16_f32 v31, v214, v215
v_pk_fma_f32 v[200:201], v[216:217], v[208:209], v[200:201] op_sel_hi:[0,1,1] neg_lo:[0,0,1] neg_hi:[0,0,1]
v_pk_fma_f32 v[202:203], v[216:217], v[210:211], v[202:203] op_sel_hi:[0,1,1] neg_lo:[0,0,1] neg_hi:[0,0,1]
v_pk_fma_f32 v[204:205], v[216:217], v[212:213], v[204:205] op_sel_hi:[0,1,1] neg_lo:[0,0,1] neg_hi:[0,0,1]
v_pk_fma_f32 v[206:207], v[216:217], v[214:215], v[206:207] op_sel_hi:[0,1,1] neg_lo:[0,0,1] neg_hi:[0,0,1]
v_cvt_pk_bf16_f32 v32, v200, v201
v_cvt_pk_bf16_f32 v33, v202, v203
v_cvt_pk_bf16_f32 v34, v204, v205
v_cvt_pk_bf16_f32 v35, v206, v207
v_pk_fma_f32 v[208:209], v[216:217], v[200:201], v[208:209] op_sel_hi:[0,1,1] neg_lo:[0,0,1] neg_hi:[0,0,1]
v_pk_fma_f32 v[210:211], v[216:217], v[202:203], v[210:211] op_sel_hi:[0,1,1] neg_lo:[0,0,1] neg_hi:[0,0,1]
v_pk_fma_f32 v[212:213], v[216:217], v[204:205], v[212:213] op_sel_hi:[0,1,1] neg_lo:[0,0,1] neg_hi:[0,0,1]
v_pk_fma_f32 v[214:215], v[216:217], v[206:207], v[214:215] op_sel_hi:[0,1,1] neg_lo:[0,0,1] neg_hi:[0,0,1]
v_cvt_pk_bf16_f32 v36, v208, v209
v_cvt_pk_bf16_f32 v37, v210, v211
v_cvt_pk_bf16_f32 v38, v212, v213
v_cvt_pk_bf16_f32 v39, v214, v215
v_pk_fma_f32 v[200:201], v[216:217], v[208:209], v[200:201] op_sel_hi:[0,1,1] neg_lo:[0,0,1] neg_hi:[0,0,1]
v_pk_fma_f32 v[202:203], v[216:217], v[210:211], v[202:203] op_sel_hi:[0,1,1] neg_lo:[0,0,1] neg_hi:[0,0,1]
v_pk_fma_f32 v[204:205], v[216:217], v[212:213], v[204:205] op_sel_hi:[0,1,1] neg_lo:[0,0,1] neg_hi:[0,0,1]
v_pk_fma_f32 v[206:207], v[216:217], v[214:215], v[206:207] op_sel_hi:[0,1,1] neg_lo:[0,0,1] neg_hi:[0,0,1]
v_cvt_pk_bf16_f32 v40, v200, v201
v_cvt_pk_bf16_f32 v41, v202, v203
v_cvt_pk_bf16_f32 v42, v204, v205
v_cvt_pk_bf16_f32 v43, v206, v207
v_pk_fma_f32 v[208:209], v[216:217], v[200:201], v[208:209] op_sel_hi:[0,1,1] neg_lo:[0,0,1] neg_hi:[0,0,1]
v_pk_fma_f32 v[210:211], v[216:217], v[202:203], v[210:211] op_sel_hi:[0,1,1] neg_lo:[0,0,1] neg_hi:[0,0,1]
v_pk_fma_f32 v[212:213], v[216:217], v[204:205], v[212:213] op_sel_hi:[0,1,1] neg_lo:[0,0,1] neg_hi:[0,0,1]
v_pk_fma_f32 v[214:215], v[216:217], v[206:207], v[214:215] op_sel_hi:[0,1,1] neg_lo:[0,0,1] neg_hi:[0,0,1]
v_cvt_pk_bf16_f32 v44, v208, v209
v_cvt_pk_bf16_f32 v45, v210, v211
v_cvt_pk_bf16_f32 v46, v212, v213
v_cvt_pk_bf16_f32 v47, v214, v215
v_pk_fma_f32 v[200:201], v[216:217], v[208:209], v[200:201] op_sel_hi:[0,1,1] neg_lo:[0,0,1] neg_hi:[0,0,1]
v_pk_fma_f32 v[202:203], v[216:217], v[210:211], v[202:203] op_sel_hi:[0,1,1] neg_lo:[0,0,1] neg_hi:[0,0,1]
v_pk_fma_f32 v[204:205], v[216:217], v[212:213], v[204:205] op_sel_hi:[0,1,1] neg_lo:[0,0,1] neg_hi:[0,0,1]
v_pk_fma_f32 v[206:207], v[216:217], v[214:215], v[206:207] op_sel_hi:[0,1,1] neg_lo:[0,0,1] neg_hi:[0,0,1]
v_cvt_pk_bf16_f32 v48, v200, v201
v_cvt_pk_bf16_f32 v49, v202, v203
v_cvt_pk_bf16_f32 v50, v204, v205
v_cvt_pk_bf16_f32 v51, v206, v207
v_pk_fma_f32 v[208:209], v[216:217], v[200:201], v[208:209] op_sel_hi:[0,1,1] neg_lo:[0,0,1] neg_hi:[0,0,1]
v_pk_fma_f32 v[210:211], v[216:217], v[202:203], v[210:211] op_sel_hi:[0,1,1] neg_lo:[0,0,1] neg_hi:[0,0,1]
v_pk_fma_f32 v[212:213], v[216:217], v[204:205], v[212:213] op_sel_hi:[0,1,1] neg_lo:[0,0,1] neg_hi:[0,0,1]
v_pk_fma_f32 v[214:215], v[216:217], v[206:207], v[214:215] op_sel_hi:[0,1,1] neg_lo:[0,0,1] neg_hi:[0,0,1]
v_cvt_pk_bf16_f32 v52, v208, v209
v_cvt_pk_bf16_f32 v53, v210, v211
v_cvt_pk_bf16_f32 v54, v212, v213
v_cvt_pk_bf16_f32 v55, v214, v215
v_pk_fma_f32 v[200:201], v[216:217], v[208:209], v[200:201] op_sel_hi:[0,1,1] neg_lo:[0,0,1] neg_hi:[0,0,1]
v_pk_fma_f32 v[202:203], v[216:217], v[210:211], v[202:203] op_sel_hi:[0,1,1] neg_lo:[0,0,1] neg_hi:[0,0,1]
v_pk_fma_f32 v[204:205], v[216:217], v[212:213], v[204:205] op_sel_hi:[0,1,1] neg_lo:[0,0,1] neg_hi:[0,0,1]
v_pk_fma_f32 v[206:207], v[216:217], v[214:215], v[206:207] op_sel_hi:[0,1,1] neg_lo:[0,0,1] neg_hi:[0,0,1]
v_cvt_pk_bf16_f32 v56, v200, v201
v_cvt_pk_bf16_f32 v57, v202, v203
v_cvt_pk_bf16_f32 v58, v204, v205
v_cvt_pk_bf16_f32 v59, v206, v207
v_pk_fma_f32 v[208:209], v[216:217], v[200:201], v[208:209] op_sel_hi:[0,1,1] neg_lo:[0,0,1] neg_hi:[0,0,1]
v_pk_fma_f32 v[210:211], v[216:217], v[202:203], v[210:211] op_sel_hi:[0,1,1] neg_lo:[0,0,1] neg_hi:[0,0,1]
v_pk_fma_f32 v[212:213], v[216:217], v[204:205], v[212:213] op_sel_hi:[0,1,1] neg_lo:[0,0,1] neg_hi:[0,0,1]
v_pk_fma_f32 v[214:215], v[216:217], v[206:207], v[214:215] op_sel_hi:[0,1,1] neg_lo:[0,0,1] neg_hi:[0,0,1]
v_cvt_pk_bf16_f32 v60, v208, v209
v_cvt_pk_bf16_f32 v61, v210, v211
v_cvt_pk_bf16_f32 v62, v212, v213
v_cvt_pk_bf16_f32 v63, v214, v215
v_pk_fma_f32 v[200:201], v[216:217], v[208:209], v[200:201] op_sel_hi:[0,1,1] neg_lo:[0,0,1] neg_hi:[0,0,1]
v_pk_fma_f32 v[202:203], v[216:217], v[210:211], v[202:203] op_sel_hi:[0,1,1] neg_lo:[0,0,1] neg_hi:[0,0,1]
v_pk_fma_f32 v[204:205], v[216:217], v[212:213], v[204:205] op_sel_hi:[0,1,1] neg_lo:[0,0,1] neg_hi:[0,0,1]
v_pk_fma_f32 v[206:207], v[216:217], v[214:215], v[206:207] op_sel_hi:[0,1,1] neg_lo:[0,0,1] neg_hi:[0,0,1]
v_cvt_pk_bf16_f32 v64, v200, v201
v_cvt_pk_bf16_f32 v65, v202, v203
v_cvt_pk_bf16_f32 v66, v204, v205
v_cvt_pk_bf16_f32 v67, v206, v207
s_waitcnt vmcnt(0)
s_barrier
v_mov_b32 v3, s23
s_mov_b64 exec, 1
buffer_store_dword v3, off, s[4:7], s22 sc1
s_mov_b64 exec, -1
s_mov_b32 s22, s6
v_pk_fma_f32 v[208:209], v[216:217], v[200:201], v[208:209] op_sel_hi:[0,1,1] neg_lo:[0,0,1] neg_hi:[0,0,1]
v_pk_fma_f32 v[210:211], v[216:217], v[202:203], v[210:211] op_sel_hi:[0,1,1] neg_lo:[0,0,1] neg_hi:[0,0,1]
v_pk_fma_f32 v[212:213], v[216:217], v[204:205], v[212:213] op_sel_hi:[0,1,1] neg_lo:[0,0,1] neg_hi:[0,0,1]
v_pk_fma_f32 v[214:215], v[216:217], v[206:207], v[214:215] op_sel_hi:[0,1,1] neg_lo:[0,0,1] neg_hi:[0,0,1]
v_cvt_pk_bf16_f32 v68, v208, v209
v_cvt_pk_bf16_f32 v69, v210, v211
v_cvt_pk_bf16_f32 v70, v212, v213
v_cvt_pk_bf16_f32 v71, v214, v215
v_pk_fma_f32 v[200:201], v[216:217], v[208:209], v[200:201] op_sel_hi:[0,1,1] neg_lo:[0,0,1] neg_hi:[0,0,1]
v_pk_fma_f32 v[202:203], v[216:217], v[210:211], v[202:203] op_sel_hi:[0,1,1] neg_lo:[0,0,1] neg_hi:[0,0,1]
v_pk_fma_f32 v[204:205], v[216:217], v[212:213], v[204:205] op_sel_hi:[0,1,1] neg_lo:[0,0,1] neg_hi:[0,0,1]
v_pk_fma_f32 v[206:207], v[216:217], v[214:215], v[206:207] op_sel_hi:[0,1,1] neg_lo:[0,0,1] neg_hi:[0,0,1]
v_cvt_pk_bf16_f32 v72, v200, v201
v_cvt_pk_bf16_f32 v73, v202, v203
v_cvt_pk_bf16_f32 v74, v204, v205
v_cvt_pk_bf16_f32 v75, v206, v207
v_pk_fma_f32 v[208:209], v[216:217], v[200:201], v[208:209] op_sel_hi:[0,1,1] neg_lo:[0,0,1] neg_hi:[0,0,1]
v_pk_fma_f32 v[210:211], v[216:217], v[202:203], v[210:211] op_sel_hi:[0,1,1] neg_lo:[0,0,1] neg_hi:[0,0,1]
v_pk_fma_f32 v[212:213], v[216:217], v[204:205], v[212:213] op_sel_hi:[0,1,1] neg_lo:[0,0,1] neg_hi:[0,0,1]
v_pk_fma_f32 v[214:215], v[216:217], v[206:207], v[214:215] op_sel_hi:[0,1,1] neg_lo:[0,0,1] neg_hi:[0,0,1]
v_cvt_pk_bf16_f32 v76, v208, v209
v_cvt_pk_bf16_f32 v77, v210, v211
v_cvt_pk_bf16_f32 v78, v212, v213
v_cvt_pk_bf16_f32 v79, v214, v215
v_pk_fma_f32 v[200:201], v[216:217], v[208:209], v[200:201] op_sel_hi:[0,1,1] neg_lo:[0,0,1] neg_hi:[0,0,1]
v_pk_fma_f32 v[202:203], v[216:217], v[210:211], v[202:203] op_sel_hi:[0,1,1] neg_lo:[0,0,1] neg_hi:[0,0,1]
v_pk_fma_f32 v[204:205], v[216:217], v[212:213], v[204:205] op_sel_hi:[0,1,1] neg_lo:[0,0,1] neg_hi:[0,0,1]
v_pk_fma_f32 v[206:207], v[216:217], v[214:215], v[206:207] op_sel_hi:[0,1,1] neg_lo:[0,0,1] neg_hi:[0,0,1]
v_cvt_pk_bf16_f32 v80, v200, v201
v_cvt_pk_bf16_f32 v81, v202, v203
v_cvt_pk_bf16_f32 v82, v204, v205
v_cvt_pk_bf16_f32 v83, v206, v207
v_pk_fma_f32 v[208:209], v[216:217], v[200:201], v[208:209] op_sel_hi:[0,1,1] neg_lo:[0,0,1] neg_hi:[0,0,1]
v_pk_fma_f32 v[210:211], v[216:217], v[202:203], v[210:211] op_sel_hi:[0,1,1] neg_lo:[0,0,1] neg_hi:[0,0,1]
v_pk_fma_f32 v[212:213], v[216:217], v[204:205], v[212:213] op_sel_hi:[0,1,1] neg_lo:[0,0,1] neg_hi:[0,0,1]
v_pk_fma_f32 v[214:215], v[216:217], v[206:207], v[214:215] op_sel_hi:[0,1,1] neg_lo:[0,0,1] neg_hi:[0,0,1]
v_cvt_pk_bf16_f32 v84, v208, v209
v_cvt_pk_bf16_f32 v85, v210, v211
v_cvt_pk_bf16_f32 v86, v212, v213
v_cvt_pk_bf16_f32 v87, v214, v215
v_pk_fma_f32 v[200:201], v[216:217], v[208:209], v[200:201] op_sel_hi:[0,1,1] neg_lo:[0,0,1] neg_hi:[0,0,1]
v_pk_fma_f32 v[202:203], v[216:217], v[210:211], v[202:203] op_sel_hi:[0,1,1] neg_lo:[0,0,1] neg_hi:[0,0,1]
v_pk_fma_f32 v[204:205], v[216:217], v[212:213], v[204:205] op_sel_hi:[0,1,1] neg_lo:[0,0,1] neg_hi:[0,0,1]
v_pk_fma_f32 v[206:207], v[216:217], v[214:215], v[206:207] op_sel_hi:[0,1,1] neg_lo:[0,0,1] neg_hi:[0,0,1]
v_cvt_pk_bf16_f32 v88, v200, v201
v_cvt_pk_bf16_f32 v89, v202, v203
v_cvt_pk_bf16_f32 v90, v204, v205
v_cvt_pk_bf16_f32 v91, v206, v207
v_pk_fma_f32 v[208:209], v[216:217], v[200:201], v[208:209] op_sel_hi:[0,1,1] neg_lo:[0,0,1] neg_hi:[0,0,1]
v_pk_fma_f32 v[210:211], v[216:217], v[202:203], v[210:211] op_sel_hi:[0,1,1] neg_lo:[0,0,1] neg_hi:[0,0,1]
v_pk_fma_f32 v[212:213], v[216:217], v[204:205], v[212:213] op_sel_hi:[0,1,1] neg_lo:[0,0,1] neg_hi:[0,0,1]
v_pk_fma_f32 v[214:215], v[216:217], v[206:207], v[214:215] op_sel_hi:[0,1,1] neg_lo:[0,0,1] neg_hi:[0,0,1]
v_cvt_pk_bf16_f32 v92, v208, v209
v_cvt_pk_bf16_f32 v93, v210, v211
v_cvt_pk_bf16_f32 v94, v212, v213
v_cvt_pk_bf16_f32 v95, v214, v215
s_mov_b32 s20, 161
v_mad_u32_u24 v200, v220, s20, v221
v_cvt_f32_u32 v200, v200
v_mul_f32 v222, s19, v200
v_rndne_f32 v222, v222
v_fmac_f32 v200, 0xc4200000, v222
v_mul_f32 v200, s19, v200
v_sin_f32 v201, -v200
v_cos_f32 v200, v200
s_mov_b32 s20, 162
v_mad_u32_u24 v202, v220, s20, v221
v_cvt_f32_u32 v202, v202
v_mul_f32 v222, s19, v202
v_rndne_f32 v222, v222
v_fmac_f32 v202, 0xc4200000, v222
v_mul_f32 v202, s19, v202
v_sin_f32 v203, -v202
v_cos_f32 v202, v202
s_nop 0
v_pk_fma_f32 v[204:205], v[218:219], v[202:203], v[200:201] op_sel_hi:[0,1,1] neg_lo:[0,0,1] neg_hi:[0,0,1]
v_pk_fma_f32 v[206:207], v[218:219], v[204:205], v[202:203] op_sel_hi:[0,1,1] neg_lo:[0,0,1] neg_hi:[0,0,1]
v_cvt_pk_bf16_f32 v96, v200, v201
v_cvt_pk_bf16_f32 v97, v202, v203
v_cvt_pk_bf16_f32 v98, v204, v205
v_cvt_pk_bf16_f32 v99, v206, v207
s_mov_b32 s20, 169
v_mad_u32_u24 v208, v220, s20, v221
v_cvt_f32_u32 v208, v208
v_mul_f32 v222, s19, v208
v_rndne_f32 v222, v222
v_fmac_f32 v208, 0xc4200000, v222
v_mul_f32 v208, s19, v208
v_sin_f32 v209, -v208
v_cos_f32 v208, v208
s_mov_b32 s20, 170
v_mad_u32_u24 v210, v220, s20, v221
v_cvt_f32_u32 v210, v210
v_mul_f32 v222, s19, v210
v_rndne_f32 v222, v222
v_fmac_f32 v210, 0xc4200000, v222
v_mul_f32 v210, s19, v210
v_sin_f32 v211, -v210
v_cos_f32 v210, v210
s_nop 0
v_pk_fma_f32 v[212:213], v[218:219], v[210:211], v[208:209] op_sel_hi:[0,1,1] neg_lo:[0,0,1] neg_hi:[0,0,1]
v_pk_fma_f32 v[214:215], v[218:219], v[212:213], v[210:211] op_sel_hi:[0,1,1] neg_lo:[0,0,1] neg_hi:[0,0,1]
v_cvt_pk_bf16_f32 v100, v208, v209
v_cvt_pk_bf16_f32 v101, v210, v211
v_cvt_pk_bf16_f32 v102, v212, v213
v_cvt_pk_bf16_f32 v103, v214, v215
v_pk_fma_f32 v[200:201], v[216:217], v[208:209], v[200:201] op_sel_hi:[0,1,1] neg_lo:[0,0,1] neg_hi:[0,0,1]
v_pk_fma_f32 v[202:203], v[216:217], v[210:211], v[202:203] op_sel_hi:[0,1,1] neg_lo:[0,0,1] neg_hi:[0,0,1]
v_pk_fma_f32 v[204:205], v[216:217], v[212:213], v[204:205] op_sel_hi:[0,1,1] neg_lo:[0,0,1] neg_hi:[0,0,1]
v_pk_fma_f32 v[206:207], v[216:217], v[214:215], v[206:207] op_sel_hi:[0,1,1] neg_lo:[0,0,1] neg_hi:[0,0,1]
v_cvt_pk_bf16_f32 v104, v200, v201
v_cvt_pk_bf16_f32 v105, v202, v203
v_cvt_pk_bf16_f32 v106, v204, v205
v_cvt_pk_bf16_f32 v107, v206, v207
v_pk_fma_f32 v[208:209], v[216:217], v[200:201], v[208:209] op_sel_hi:[0,1,1] neg_lo:[0,0,1] neg_hi:[0,0,1]
v_pk_fma_f32 v[210:211], v[216:217], v[202:203], v[210:211] op_sel_hi:[0,1,1] neg_lo:[0,0,1] neg_hi:[0,0,1]
v_pk_fma_f32 v[212:213], v[216:217], v[204:205], v[212:213] op_sel_hi:[0,1,1] neg_lo:[0,0,1] neg_hi:[0,0,1]
v_pk_fma_f32 v[214:215], v[216:217], v[206:207], v[214:215] op_sel_hi:[0,1,1] neg_lo:[0,0,1] neg_hi:[0,0,1]
v_cvt_pk_bf16_f32 v108, v208, v209
v_cvt_pk_bf16_f32 v109, v210, v211
v_cvt_pk_bf16_f32 v110, v212, v213
v_cvt_pk_bf16_f32 v111, v214, v215
v_pk_fma_f32 v[200:201], v[216:217], v[208:209], v[200:201] op_sel_hi:[0,1,1] neg_lo:[0,0,1] neg_hi:[0,0,1]
v_pk_fma_f32 v[202:203], v[216:217], v[210:211], v[202:203] op_sel_hi:[0,1,1] neg_lo:[0,0,1] neg_hi:[0,0,1]
v_pk_fma_f32 v[204:205], v[216:217], v[212:213], v[204:205] op_sel_hi:[0,1,1] neg_lo:[0,0,1] neg_hi:[0,0,1]
v_pk_fma_f32 v[206:207], v[216:217], v[214:215], v[206:207] op_sel_hi:[0,1,1] neg_lo:[0,0,1] neg_hi:[0,0,1]
v_cvt_pk_bf16_f32 v112, v200, v201
v_cvt_pk_bf16_f32 v113, v202, v203
v_cvt_pk_bf16_f32 v114, v204, v205
v_cvt_pk_bf16_f32 v115, v206, v207
v_pk_fma_f32 v[208:209], v[216:217], v[200:201], v[208:209] op_sel_hi:[0,1,1] neg_lo:[0,0,1] neg_hi:[0,0,1]
v_pk_fma_f32 v[210:211], v[216:217], v[202:203], v[210:211] op_sel_hi:[0,1,1] neg_lo:[0,0,1] neg_hi:[0,0,1]
v_pk_fma_f32 v[212:213], v[216:217], v[204:205], v[212:213] op_sel_hi:[0,1,1] neg_lo:[0,0,1] neg_hi:[0,0,1]
v_pk_fma_f32 v[214:215], v[216:217], v[206:207], v[214:215] op_sel_hi:[0,1,1] neg_lo:[0,0,1] neg_hi:[0,0,1]
v_cvt_pk_bf16_f32 v116, v208, v209
v_cvt_pk_bf16_f32 v117, v210, v211
v_cvt_pk_bf16_f32 v118, v212, v213
v_cvt_pk_bf16_f32 v119, v214, v215
v_pk_fma_f32 v[200:201], v[216:217], v[208:209], v[200:201] op_sel_hi:[0,1,1] neg_lo:[0,0,1] neg_hi:[0,0,1]
v_pk_fma_f32 v[202:203], v[216:217], v[210:211], v[202:203] op_sel_hi:[0,1,1] neg_lo:[0,0,1] neg_hi:[0,0,1]
v_pk_fma_f32 v[204:205], v[216:217], v[212:213], v[204:205] op_sel_hi:[0,1,1] neg_lo:[0,0,1] neg_hi:[0,0,1]
v_pk_fma_f32 v[206:207], v[216:217], v[214:215], v[206:207] op_sel_hi:[0,1,1] neg_lo:[0,0,1] neg_hi:[0,0,1]
v_cvt_pk_bf16_f32 v120, v200, v201
v_cvt_pk_bf16_f32 v121, v202, v203
v_cvt_pk_bf16_f32 v122, v204, v205
v_cvt_pk_bf16_f32 v123, v206, v207
v_pk_fma_f32 v[208:209], v[216:217], v[200:201], v[208:209] op_sel_hi:[0,1,1] neg_lo:[0,0,1] neg_hi:[0,0,1]
v_pk_fma_f32 v[210:211], v[216:217], v[202:203], v[210:211] op_sel_hi:[0,1,1] neg_lo:[0,0,1] neg_hi:[0,0,1]
v_pk_fma_f32 v[212:213], v[216:217], v[204:205], v[212:213] op_sel_hi:[0,1,1] neg_lo:[0,0,1] neg_hi:[0,0,1]
v_pk_fma_f32 v[214:215], v[216:217], v[206:207], v[214:215] op_sel_hi:[0,1,1] neg_lo:[0,0,1] neg_hi:[0,0,1]
v_cvt_pk_bf16_f32 v124, v208, v209
v_cvt_pk_bf16_f32 v125, v210, v211
v_cvt_pk_bf16_f32 v126, v212, v213
v_cvt_pk_bf16_f32 v127, v214, v215
v_pk_fma_f32 v[200:201], v[216:217], v[208:209], v[200:201] op_sel_hi:[0,1,1] neg_lo:[0,0,1] neg_hi:[0,0,1]
v_pk_fma_f32 v[202:203], v[216:217], v[210:211], v[202:203] op_sel_hi:[0,1,1] neg_lo:[0,0,1] neg_hi:[0,0,1]
v_pk_fma_f32 v[204:205], v[216:217], v[212:213], v[204:205] op_sel_hi:[0,1,1] neg_lo:[0,0,1] neg_hi:[0,0,1]
v_pk_fma_f32 v[206:207], v[216:217], v[214:215], v[206:207] op_sel_hi:[0,1,1] neg_lo:[0,0,1] neg_hi:[0,0,1]
v_cvt_pk_bf16_f32 v128, v200, v201
v_cvt_pk_bf16_f32 v129, v202, v203
v_cvt_pk_bf16_f32 v130, v204, v205
v_cvt_pk_bf16_f32 v131, v206, v207
v_pk_fma_f32 v[208:209], v[216:217], v[200:201], v[208:209] op_sel_hi:[0,1,1] neg_lo:[0,0,1] neg_hi:[0,0,1]
v_pk_fma_f32 v[210:211], v[216:217], v[202:203], v[210:211] op_sel_hi:[0,1,1] neg_lo:[0,0,1] neg_hi:[0,0,1]
v_pk_fma_f32 v[212:213], v[216:217], v[204:205], v[212:213] op_sel_hi:[0,1,1] neg_lo:[0,0,1] neg_hi:[0,0,1]
v_pk_fma_f32 v[214:215], v[216:217], v[206:207], v[214:215] op_sel_hi:[0,1,1] neg_lo:[0,0,1] neg_hi:[0,0,1]
v_cvt_pk_bf16_f32 v132, v208, v209
v_cvt_pk_bf16_f32 v133, v210, v211
v_cvt_pk_bf16_f32 v134, v212, v213
v_cvt_pk_bf16_f32 v135, v214, v215
v_pk_fma_f32 v[200:201], v[216:217], v[208:209], v[200:201] op_sel_hi:[0,1,1] neg_lo:[0,0,1] neg_hi:[0,0,1]
v_pk_fma_f32 v[202:203], v[216:217], v[210:211], v[202:203] op_sel_hi:[0,1,1] neg_lo:[0,0,1] neg_hi:[0,0,1]
v_pk_fma_f32 v[204:205], v[216:217], v[212:213], v[204:205] op_sel_hi:[0,1,1] neg_lo:[0,0,1] neg_hi:[0,0,1]
v_pk_fma_f32 v[206:207], v[216:217], v[214:215], v[206:207] op_sel_hi:[0,1,1] neg_lo:[0,0,1] neg_hi:[0,0,1]
v_cvt_pk_bf16_f32 v136, v200, v201
v_cvt_pk_bf16_f32 v137, v202, v203
v_cvt_pk_bf16_f32 v138, v204, v205
v_cvt_pk_bf16_f32 v139, v206, v207
v_pk_fma_f32 v[208:209], v[216:217], v[200:201], v[208:209] op_sel_hi:[0,1,1] neg_lo:[0,0,1] neg_hi:[0,0,1]
v_pk_fma_f32 v[210:211], v[216:217], v[202:203], v[210:211] op_sel_hi:[0,1,1] neg_lo:[0,0,1] neg_hi:[0,0,1]
v_pk_fma_f32 v[212:213], v[216:217], v[204:205], v[212:213] op_sel_hi:[0,1,1] neg_lo:[0,0,1] neg_hi:[0,0,1]
v_pk_fma_f32 v[214:215], v[216:217], v[206:207], v[214:215] op_sel_hi:[0,1,1] neg_lo:[0,0,1] neg_hi:[0,0,1]
v_cvt_pk_bf16_f32 v140, v208, v209
v_cvt_pk_bf16_f32 v141, v210, v211
v_cvt_pk_bf16_f32 v142, v212, v213
v_cvt_pk_bf16_f32 v143, v214, v215
v_pk_fma_f32 v[200:201], v[216:217], v[208:209], v[200:201] op_sel_hi:[0,1,1] neg_lo:[0,0,1] neg_hi:[0,0,1]
v_pk_fma_f32 v[202:203], v[216:217], v[210:211], v[202:203] op_sel_hi:[0,1,1] neg_lo:[0,0,1] neg_hi:[0,0,1]
v_pk_fma_f32 v[204:205], v[216:217], v[212:213], v[204:205] op_sel_hi:[0,1,1] neg_lo:[0,0,1] neg_hi:[0,0,1]
v_pk_fma_f32 v[206:207], v[216:217], v[214:215], v[206:207] op_sel_hi:[0,1,1] neg_lo:[0,0,1] neg_hi:[0,0,1]
v_cvt_pk_bf16_f32 v144, v200, v201
v_cvt_pk_bf16_f32 v145, v202, v203
v_cvt_pk_bf16_f32 v146, v204, v205
v_cvt_pk_bf16_f32 v147, v206, v207
v_pk_fma_f32 v[208:209], v[216:217], v[200:201], v[208:209] op_sel_hi:[0,1,1] neg_lo:[0,0,1] neg_hi:[0,0,1]
v_pk_fma_f32 v[210:211], v[216:217], v[202:203], v[210:211] op_sel_hi:[0,1,1] neg_lo:[0,0,1] neg_hi:[0,0,1]
v_pk_fma_f32 v[212:213], v[216:217], v[204:205], v[212:213] op_sel_hi:[0,1,1] neg_lo:[0,0,1] neg_hi:[0,0,1]
v_pk_fma_f32 v[214:215], v[216:217], v[206:207], v[214:215] op_sel_hi:[0,1,1] neg_lo:[0,0,1] neg_hi:[0,0,1]
v_cvt_pk_bf16_f32 v148, v208, v209
v_cvt_pk_bf16_f32 v149, v210, v211
v_cvt_pk_bf16_f32 v150, v212, v213
v_cvt_pk_bf16_f32 v151, v214, v215
v_pk_fma_f32 v[200:201], v[216:217], v[208:209], v[200:201] op_sel_hi:[0,1,1] neg_lo:[0,0,1] neg_hi:[0,0,1]
v_pk_fma_f32 v[202:203], v[216:217], v[210:211], v[202:203] op_sel_hi:[0,1,1] neg_lo:[0,0,1] neg_hi:[0,0,1]
v_pk_fma_f32 v[204:205], v[216:217], v[212:213], v[204:205] op_sel_hi:[0,1,1] neg_lo:[0,0,1] neg_hi:[0,0,1]
v_pk_fma_f32 v[206:207], v[216:217], v[214:215], v[206:207] op_sel_hi:[0,1,1] neg_lo:[0,0,1] neg_hi:[0,0,1]
v_cvt_pk_bf16_f32 v152, v200, v201
v_cvt_pk_bf16_f32 v153, v202, v203
v_cvt_pk_bf16_f32 v154, v204, v205
v_cvt_pk_bf16_f32 v155, v206, v207
v_pk_fma_f32 v[208:209], v[216:217], v[200:201], v[208:209] op_sel_hi:[0,1,1] neg_lo:[0,0,1] neg_hi:[0,0,1]
v_pk_fma_f32 v[210:211], v[216:217], v[202:203], v[210:211] op_sel_hi:[0,1,1] neg_lo:[0,0,1] neg_hi:[0,0,1]
v_pk_fma_f32 v[212:213], v[216:217], v[204:205], v[212:213] op_sel_hi:[0,1,1] neg_lo:[0,0,1] neg_hi:[0,0,1]
v_pk_fma_f32 v[214:215], v[216:217], v[206:207], v[214:215] op_sel_hi:[0,1,1] neg_lo:[0,0,1] neg_hi:[0,0,1]
v_cvt_pk_bf16_f32 v156, v208, v209
v_cvt_pk_bf16_f32 v157, v210, v211
v_cvt_pk_bf16_f32 v158, v212, v213
v_cvt_pk_bf16_f32 v159, v214, v215
v_pk_fma_f32 v[200:201], v[216:217], v[208:209], v[200:201] op_sel_hi:[0,1,1] neg_lo:[0,0,1] neg_hi:[0,0,1]
v_pk_fma_f32 v[202:203], v[216:217], v[210:211], v[202:203] op_sel_hi:[0,1,1] neg_lo:[0,0,1] neg_hi:[0,0,1]
v_pk_fma_f32 v[204:205], v[216:217], v[212:213], v[204:205] op_sel_hi:[0,1,1] neg_lo:[0,0,1] neg_hi:[0,0,1]
v_pk_fma_f32 v[206:207], v[216:217], v[214:215], v[206:207] op_sel_hi:[0,1,1] neg_lo:[0,0,1] neg_hi:[0,0,1]
v_cvt_pk_bf16_f32 v160, v200, v201
v_cvt_pk_bf16_f32 v161, v202, v203
v_cvt_pk_bf16_f32 v162, v204, v205
v_cvt_pk_bf16_f32 v163, v206, v207
v_pk_fma_f32 v[208:209], v[216:217], v[200:201], v[208:209] op_sel_hi:[0,1,1] neg_lo:[0,0,1] neg_hi:[0,0,1]
v_pk_fma_f32 v[210:211], v[216:217], v[202:203], v[210:211] op_sel_hi:[0,1,1] neg_lo:[0,0,1] neg_hi:[0,0,1]
v_pk_fma_f32 v[212:213], v[216:217], v[204:205], v[212:213] op_sel_hi:[0,1,1] neg_lo:[0,0,1] neg_hi:[0,0,1]
v_pk_fma_f32 v[214:215], v[216:217], v[206:207], v[214:215] op_sel_hi:[0,1,1] neg_lo:[0,0,1] neg_hi:[0,0,1]
v_cvt_pk_bf16_f32 v164, v208, v209
v_cvt_pk_bf16_f32 v165, v210, v211
v_cvt_pk_bf16_f32 v166, v212, v213
v_cvt_pk_bf16_f32 v167, v214, v215
v_pk_fma_f32 v[200:201], v[216:217], v[208:209], v[200:201] op_sel_hi:[0,1,1] neg_lo:[0,0,1] neg_hi:[0,0,1]
v_pk_fma_f32 v[202:203], v[216:217], v[210:211], v[202:203] op_sel_hi:[0,1,1] neg_lo:[0,0,1] neg_hi:[0,0,1]
v_pk_fma_f32 v[204:205], v[216:217], v[212:213], v[204:205] op_sel_hi:[0,1,1] neg_lo:[0,0,1] neg_hi:[0,0,1]
v_pk_fma_f32 v[206:207], v[216:217], v[214:215], v[206:207] op_sel_hi:[0,1,1] neg_lo:[0,0,1] neg_hi:[0,0,1]
v_cvt_pk_bf16_f32 v168, v200, v201
v_cvt_pk_bf16_f32 v169, v202, v203
v_cvt_pk_bf16_f32 v170, v204, v205
v_cvt_pk_bf16_f32 v171, v206, v207
v_pk_fma_f32 v[208:209], v[216:217], v[200:201], v[208:209] op_sel_hi:[0,1,1] neg_lo:[0,0,1] neg_hi:[0,0,1]
v_pk_fma_f32 v[210:211], v[216:217], v[202:203], v[210:211] op_sel_hi:[0,1,1] neg_lo:[0,0,1] neg_hi:[0,0,1]
v_pk_fma_f32 v[212:213], v[216:217], v[204:205], v[212:213] op_sel_hi:[0,1,1] neg_lo:[0,0,1] neg_hi:[0,0,1]
v_pk_fma_f32 v[214:215], v[216:217], v[206:207], v[214:215] op_sel_hi:[0,1,1] neg_lo:[0,0,1] neg_hi:[0,0,1]
s_mov_b32 exec_lo, 0
v_mul_f32 v214, 0.5, v214
s_mov_b32 exec_lo, -1
v_cvt_pk_bf16_f32 v172, v208, v209
v_cvt_pk_bf16_f32 v173, v210, v211
v_cvt_pk_bf16_f32 v174, v212, v213
v_cvt_pk_bf16_f32 v175, v214, v215
v_and_b32 v1, 0x2f0, v0
v_bfe_u32 v3, v0, 8, 1
v_lshl_add_u32 v1, v3, 3, v1
s_mul_i32 s18, s50, 40960
s_mul_i32 s19, s16, 3145728
s_add_u32 s26, s18, s19
s_add_u32 s27, s26, s19
s_add_u32 s27, s27, s33
s_add_u32 s27, s27, 88080384
s_add_u32 s26, s26, s31
s_add_u32 s26, s26, 103809024
s_lshl_b32 s19, s16, 6
s_add_u32 s19, s19, s50
s_mul_i32 s19, s19, 5120
s_lshr_b32 s36, s33, 3
s_add_u32 s36, s36, s19
s_add_u32 s36, s36, 163577856
s_mov_b32 s43, 0x20000
s_cmp_lg_u32 s16, 0
s_cbranch_scc1 rs_51
s_mov_b64 s[40:41], s[44:45]
s_mov_b32 s42, s46
s_lshr_b32 s51, s33, 5
s_add_u32 s51, s51, s18
s_add_u32 s52, s51, 32
v_mov_b32 v13, v5
s_branch rs_52
rs_51:
s_mov_b64 s[40:41], s[4:5]
s_mov_b32 s42, s6
s_sub_u32 s51, s27, 3145728
s_add_u32 s52, s51, 1024
v_mov_b32 v13, v0
rs_52:
s_cmp_lg_u32 s13, 0
s_cbranch_scc1 polld_54
v_lshlrev_b32 v11, 3, v0
v_add_u32 v12, 8192, v11
v_add_u32 v3, 16384, v11
v_min_u32 v3, 20352, v3
s_mov_b32 s21, 11591680
s_mov_b32 s17, 0
poll_53:
buffer_load_dword v8, v11, s[4:7], s21 offen sc1
buffer_load_dword v9, v12, s[4:7], s21 offen sc1
buffer_load_dword v10, v3, s[4:7], s21 offen sc1
s_add_u32 s17, s17, 1
s_cmp_gt_u32 s17, 262144
s_cbranch_scc1 L_fail
s_waitcnt vmcnt(0)
v_min3_u32 v8, v8, v9, v10
v_cmp_gt_u32 vcc, s29, v8
s_cbranch_vccz polld_54
s_sleep 2
s_branch poll_53
polld_54:
s_barrier
s_add_u32 m0, s31, 2048
s_add_u32 s20, s26, 0
buffer_load_dwordx4 v0, s[4:7], s20 offen sc1 lds
s_add_u32 m0, s31, 3072
s_add_u32 s20, s26, 1024
buffer_load_dwordx4 v0, s[4:7], s20 offen sc1 lds
s_add_u32 m0, s31, 4096
s_add_u32 s20, s26, 2048
buffer_load_dwordx4 v0, s[4:7], s20 offen sc1 lds
s_add_u32 m0, s31, 5120
s_add_u32 s20, s26, 3072
buffer_load_dwordx4 v0, s[4:7], s20 offen sc1 lds
s_add_u32 m0, s31, 6144
s_add_u32 s20, s26, 4096
buffer_load_dwordx4 v0, s[4:7], s20 offen sc1 lds
s_add_u32 m0, s31, 7168
s_add_u32 s20, s26, 5120
buffer_load_dwordx4 v0, s[4:7], s20 offen sc1 lds
s_add_u32 m0, s31, 8192
s_add_u32 s20, s26, 6144
buffer_load_dwordx4 v0, s[4:7], s20 offen sc1 lds
s_add_u32 m0, s31, 9216
s_add_u32 s20, s26, 7168
buffer_load_dwordx4 v0, s[4:7], s20 offen sc1 lds
s_add_u32 m0, s31, 10240
s_add_u32 s20, s26, 8192
buffer_load_dwordx4 v0, s[4:7], s20 offen sc1 lds
s_add_u32 m0, s31, 11264
s_add_u32 s20, s26, 9216
buffer_load_dwordx4 v0, s[4:7], s20 offen sc1 lds
s_add_u32 s26, s26, 1310720
s_add_u32 s25, s31, 40960
s_mov_b32 s28, 0
s_waitcnt vmcnt(0)
p3_55:
s_barrier
ds_read_b64_tr_b16 v[216:217], v1 offset:2048
ds_read_b64_tr_b16 v[218:219], v1 offset:2304
ds_read_b64_tr_b16 v[222:223], v1 offset:3328
ds_read_b64_tr_b16 v[220:221], v1 offset:3072
buffer_load_dwordx4 v[176:179], v13, s[40:43], s51 offen sc1
ds_read_b64_tr_b16 v[224:225], v1 offset:4096
buffer_load_dwordx4 v[180:183], v13, s[40:43], s52 offen sc1
ds_read_b64_tr_b16 v[230:231], v1 offset:5376
ds_read_b64_tr_b16 v[226:227], v1 offset:4352
s_add_u32 m0, s25, 2048
s_add_u32 s20, s26, 0
buffer_load_dwordx4 v0, s[4:7], s20 offen sc1 lds
s_waitcnt lgkmcnt(5)
v_mfma_f32_32x32x16_bf16 v[200:215], v[16:19], v[216:219], 0
s_waitcnt lgkmcnt(4)
ds_read_b64_tr_b16 v[228:229], v1 offset:5120
ds_read_b64_tr_b16 v[218:219], v1 offset:6400
s_add_u32 m0, s25, 3072
s_add_u32 s20, s26, 1024
buffer_load_dwordx4 v0, s[4:7], s20 offen sc1 lds
s_waitcnt lgkmcnt(4)
v_mfma_f32_32x32x16_bf16 v[200:215], v[20:23], v[220:223], v[200:215]
s_add_u32 m0, s25, 4096
s_add_u32 s20, s26, 2048
buffer_load_dwordx4 v0, s[4:7], s20 offen sc1 lds
ds_read_b64_tr_b16 v[216:217], v1 offset:6144
s_waitcnt lgkmcnt(3)
ds_read_b64_tr_b16 v[222:223], v1 offset:7424
v_mfma_f32_32x32x16_bf16 v[200:215], v[24:27], v[224:227], v[200:215]
s_waitcnt lgkmcnt(3)
ds_read_b64_tr_b16 v[220:221], v1 offset:7168
ds_read_b64_tr_b16 v[224:225], v1 offset:8192
s_waitcnt lgkmcnt(4)
v_mfma_f32_32x32x16_bf16 v[200:215], v[28:31], v[228:231], v[200:215]
s_add_u32 m0, s25, 5120
s_add_u32 s20, s26, 3072
buffer_load_dwordx4 v0, s[4:7], s20 offen sc1 lds
s_waitcnt lgkmcnt(3)
ds_read_b64_tr_b16 v[226:227], v1 offset:8448
ds_read_b64_tr_b16 v[230:231], v1 offset:9472
ds_read_b64_tr_b16 v[228:229], v1 offset:9216
v_mfma_f32_32x32x16_bf16 v[200:215], v[32:35], v[216:219], v[200:215]
ds_read_b64_tr_b16 v[216:217], v1 offset:10240
s_waitcnt lgkmcnt(5)
v_mfma_f32_32x32x16_bf16 v[200:215], v[36:39], v[220:223], v[200:215]
ds_read_b64_tr_b16 v[220:221], v1 offset:11264
s_waitcnt lgkmcnt(4)
ds_read_b64_tr_b16 v[218:219], v1 offset:10496
v_mfma_f32_32x32x16_bf16 v[200:215], v[40:43], v[224:227], v[200:215]
ds_read_b64_tr_b16 v[222:223], v1 offset:11520
ds_read_b64_tr_b16 v[224:225], v1 offset:12288
s_waitcnt lgkmcnt(5)
v_mfma_f32_32x32x16_bf16 v[200:215], v[44:47], v[228:231], v[200:215]
ds_read_b64_tr_b16 v[228:229], v1 offset:13312
ds_read_b64_tr_b16 v[226:227], v1 offset:12544
s_waitcnt lgkmcnt(6)
s_waitcnt lgkmcnt(4)
ds_read_b64_tr_b16 v[230:231], v1 offset:13568
v_mfma_f32_32x32x16_bf16 v[200:215], v[48:51], v[216:219], v[200:215]
ds_read_b64_tr_b16 v[218:219], v1 offset:14592
s_add_u32 m0, s25, 6144
s_add_u32 s20, s26, 4096
buffer_load_dwordx4 v0, s[4:7], s20 offen sc1 lds
s_waitcnt lgkmcnt(5)
ds_read_b64_tr_b16 v[216:217], v1 offset:14336
v_mfma_f32_32x32x16_bf16 v[200:215], v[52:55], v[220:223], v[200:215]
ds_read_b64_tr_b16 v[222:223], v1 offset:15616
s_waitcnt lgkmcnt(4)
s_add_u32 m0, s25, 7168
s_add_u32 s20, s26, 5120
buffer_load_dwordx4 v0, s[4:7], s20 offen sc1 lds
ds_read_b64_tr_b16 v[220:221], v1 offset:15360
v_mfma_f32_32x32x16_bf16 v[200:215], v[56:59], v[224:227], v[200:215]
s_waitcnt lgkmcnt(4)
ds_read_b64_tr_b16 v[226:227], v1 offset:16640
ds_read_b64_tr_b16 v[224:225], v1 offset:16384
s_waitcnt lgkmcnt(5)
s_waitcnt lgkmcnt(4)
v_mfma_f32_32x32x16_bf16 v[200:215], v[60:63], v[228:231], v[200:215]
v_mfma_f32_32x32x16_bf16 v[200:215], v[64:67], v[216:219], v[200:215]
s_waitcnt lgkmcnt(2)
ds_read_b64_tr_b16 v[218:219], v1 offset:18688
s_waitcnt lgkmcnt(1)
ds_read_b64_tr_b16 v[230:231], v1 offset:17664
ds_read_b64_tr_b16 v[228:229], v1 offset:17408
ds_read_b64_tr_b16 v[216:217], v1 offset:18432
v_mfma_f32_32x32x16_bf16 v[200:215], v[68:71], v[220:223], v[200:215]
v_mfma_f32_32x32x16_bf16 v[200:215], v[72:75], v[224:227], v[200:215]
s_waitcnt lgkmcnt(3)
ds_read_b64_tr_b16 v[224:225], v1 offset:20480
ds_read_b64_tr_b16 v[226:227], v1 offset:20736
ds_read_b64_tr_b16 v[222:223], v1 offset:19712
s_waitcnt lgkmcnt(4)
ds_read_b64_tr_b16 v[220:221], v1 offset:19456
v_mfma_f32_32x32x16_bf16 v[200:215], v[76:79], v[228:231], v[200:215]
ds_read_b64_tr_b16 v[230:231], v1 offset:21760
s_waitcnt lgkmcnt(5)
ds_read_b64_tr_b16 v[228:229], v1 offset:21504
v_mfma_f32_32x32x16_bf16 v[200:215], v[80:83], v[216:219], v[200:215]
ds_read_b64_tr_b16 v[218:219], v1 offset:22784
s_waitcnt lgkmcnt(3)
ds_read_b64_tr_b16 v[216:217], v1 offset:22528
v_mfma_f32_32x32x16_bf16 v[200:215], v[84:87], v[220:223], v[200:215]
ds_read_b64_tr_b16 v[220:221], v1 offset:23552
s_waitcnt lgkmcnt(4)
ds_read_b64_tr_b16 v[222:223], v1 offset:23808
v_mfma_f32_32x32x16_bf16 v[200:215], v[88:91], v[224:227], v[200:215]
s_add_u32 m0, s25, 8192
s_add_u32 s20, s26, 6144
buffer_load_dwordx4 v0, s[4:7], s20 offen sc1 lds
s_waitcnt lgkmcnt(2)
ds_read_b64_tr_b16 v[224:225], v1 offset:24576
ds_read_b64_tr_b16 v[226:227], v1 offset:24832
v_mfma_f32_32x32x16_bf16 v[200:215], v[92:95], v[228:231], v[200:215]
s_waitcnt lgkmcnt(3)
ds_read_b64_tr_b16 v[230:231], v1 offset:25856
s_waitcnt lgkmcnt(3)
v_mfma_f32_32x32x16_bf16 v[200:215], v[96:99], v[216:219], v[200:215]
s_waitcnt lgkmcnt(2)
ds_read_b64_tr_b16 v[228:229], v1 offset:25600
ds_read_b64_tr_b16 v[218:219], v1 offset:26880
v_mfma_f32_32x32x16_bf16 v[200:215], v[100:103], v[220:223], v[200:215]
ds_read_b64_tr_b16 v[216:217], v1 offset:26624
ds_read_b64_tr_b16 v[222:223], v1 offset:27904
ds_read_b64_tr_b16 v[220:221], v1 offset:27648
s_waitcnt lgkmcnt(6)
v_mfma_f32_32x32x16_bf16 v[200:215], v[104:107], v[224:227], v[200:215]
s_waitcnt lgkmcnt(4)
ds_read_b64_tr_b16 v[224:225], v1 offset:28672
ds_read_b64_tr_b16 v[226:227], v1 offset:28928
s_waitcnt lgkmcnt(5)
v_mfma_f32_32x32x16_bf16 v[200:215], v[108:111], v[228:231], v[200:215]
ds_read_b64_tr_b16 v[228:229], v1 offset:29696
s_waitcnt lgkmcnt(5)
v_mfma_f32_32x32x16_bf16 v[200:215], v[112:115], v[216:219], v[200:215]
s_waitcnt lgkmcnt(4)
s_waitcnt lgkmcnt(1)
ds_read_b64_tr_b16 v[218:219], v1 offset:30976
ds_read_b64_tr_b16 v[230:231], v1 offset:29952
v_mfma_f32_32x32x16_bf16 v[200:215], v[116:119], v[220:223], v[200:215]
s_add_u32 m0, s25, 9216
s_add_u32 s20, s26, 7168
buffer_load_dwordx4 v0, s[4:7], s20 offen sc1 lds
ds_read_b64_tr_b16 v[216:217], v1 offset:30720
ds_read_b64_tr_b16 v[220:221], v1 offset:31744
s_waitcnt lgkmcnt(4)
v_mfma_f32_32x32x16_bf16 v[200:215], v[120:123], v[224:227], v[200:215]
ds_read_b64_tr_b16 v[226:227], v1 offset:33024
ds_read_b64_tr_b16 v[222:223], v1 offset:32000
ds_read_b64_tr_b16 v[224:225], v1 offset:32768
s_waitcnt lgkmcnt(5)
v_lshrrev_b32 v2, 2, v0
v_mfma_f32_32x32x16_bf16 v[200:215], v[124:127], v[228:231], v[200:215]
s_add_u32 m0, s25, 10240
s_add_u32 s20, s26, 8192
buffer_load_dwordx4 v0, s[4:7], s20 offen sc1 lds
s_waitcnt lgkmcnt(4)
ds_read_b64_tr_b16 v[228:229], v1 offset:33792
s_waitcnt lgkmcnt(4)
v_mfma_f32_32x32x16_bf16 v[200:215], v[128:131], v[216:219], v[200:215]
s_waitcnt lgkmcnt(3)
s_waitcnt lgkmcnt(2)
ds_read_b64_tr_b16 v[230:231], v1 offset:34048
ds_read_b64_tr_b16 v[216:217], v1 offset:34816
ds_read_b64_tr_b16 v[218:219], v1 offset:35072
v_mfma_f32_32x32x16_bf16 v[200:215], v[132:135], v[220:223], v[200:215]
s_waitcnt vmcnt(10)
s_waitcnt lgkmcnt(4)
ds_read_b64_tr_b16 v[220:221], v1 offset:35840
s_add_u32 m0, s25, 11264
s_add_u32 s20, s26, 9216
buffer_load_dwordx4 v0, s[4:7], s20 offen sc1 lds
v_mfma_f32_32x32x16_bf16 v[200:215], v[136:139], v[224:227], v[200:215]
ds_read_b64_tr_b16 v[222:223], v1 offset:36096
ds_read_b64_tr_b16 v[226:227], v1 offset:37120
v_and_b32 v187, 0xffff0000, v177
s_waitcnt lgkmcnt(5)
v_lshlrev_b32 v184, 16, v176
s_waitcnt vmcnt(10)
v_mfma_f32_32x32x16_bf16 v[200:215], v[140:143], v[228:231], v[200:215]
s_waitcnt lgkmcnt(3)
ds_read_b64_tr_b16 v[230:231], v1 offset:38144
ds_read_b64_tr_b16 v[224:225], v1 offset:36864
s_waitcnt lgkmcnt(4)
ds_read_b64_tr_b16 v[228:229], v1 offset:37888
v_mfma_f32_32x32x16_bf16 v[200:215], v[144:147], v[216:219], v[200:215]
s_waitcnt lgkmcnt(3)
ds_read_b64_tr_b16 v[218:219], v1 offset:39168
ds_read_b64_tr_b16 v[216:217], v1 offset:38912
v_and_b32 v199, 0xffff0000, v183
v_mfma_f32_32x32x16_bf16 v[200:215], v[148:151], v[220:223], v[200:215]
s_waitcnt lgkmcnt(4)
s_waitcnt lgkmcnt(3)
s_waitcnt lgkmcnt(2)
v_lshlrev_b32 v198, 16, v183
v_and_b32 v189, 0xffff0000, v178
v_and_b32 v197, 0xffff0000, v182
v_mfma_f32_32x32x16_bf16 v[200:215], v[152:155], v[224:227], v[200:215]
ds_read_b64_tr_b16 v[220:221], v1 offset:39936
s_waitcnt lgkmcnt(2)
ds_read_b64_tr_b16 v[224:225], v1 offset:40960
ds_read_b64_tr_b16 v[222:223], v1 offset:40192
v_mfma_f32_32x32x16_bf16 v[200:215], v[156:159], v[228:231], v[200:215]
s_waitcnt lgkmcnt(3)
ds_read_b64_tr_b16 v[230:231], v1 offset:42240
ds_read_b64_tr_b16 v[226:227], v1 offset:41216
v_mfma_f32_32x32x16_bf16 v[200:215], v[160:163], v[216:219], v[200:215]
ds_read_b64_tr_b16 v[228:229], v1 offset:41984
s_waitcnt lgkmcnt(3)
v_and_b32 v193, 0xffff0000, v180
v_lshlrev_b32 v186, 16, v177
v_and_b32 v191, 0xffff0000, v179
v_mfma_f32_32x32x16_bf16 v[200:215], v[164:167], v[220:223], v[200:215]
s_waitcnt lgkmcnt(1)
v_lshlrev_b32 v196, 16, v182
v_mfma_f32_32x32x16_bf16 v[200:215], v[168:171], v[224:227], v[200:215]
v_lshlrev_b32 v188, 16, v178
s_waitcnt lgkmcnt(0)
v_lshlrev_b32 v194, 16, v181
v_mfma_f32_32x32x16_bf16 v[200:215], v[172:175], v[228:231], v[200:215]
s_nop 0
v_lshlrev_b32 v190, 16, v179
v_lshlrev_b32 v192, 16, v180
v_and_b32 v185, 0xffff0000, v176
v_and_b32 v195, 0xffff0000, v181
v_mov_b32 v176, 0x3b4ccccd
s_nop 5
v_pk_fma_f32 v[200:201], v[200:201], v[176:177], v[184:185] op_sel_hi:[1,0,1]
v_pk_fma_f32 v[202:203], v[202:203], v[176:177], v[186:187] op_sel_hi:[1,0,1]
v_pk_fma_f32 v[204:205], v[204:205], v[176:177], v[188:189] op_sel_hi:[1,0,1]
v_pk_mul_f32 v[180:181], v[200:201], v[200:201]
v_pk_fma_f32 v[206:207], v[206:207], v[176:177], v[190:191] op_sel_hi:[1,0,1]
v_pk_add_f32 v[178:179], v[200:201], v[202:203]
v_pk_fma_f32 v[208:209], v[208:209], v[176:177], v[192:193] op_sel_hi:[1,0,1]
v_pk_add_f32 v[178:179], v[178:179], v[204:205]
v_pk_add_f32 v[178:179], v[178:179], v[206:207]
v_pk_fma_f32 v[180:181], v[202:203], v[202:203], v[180:181]
v_pk_fma_f32 v[180:181], v[204:205], v[204:205], v[180:181]
v_pk_fma_f32 v[210:211], v[210:211], v[176:177], v[194:195] op_sel_hi:[1,0,1]
v_pk_fma_f32 v[180:181], v[206:207], v[206:207], v[180:181]
v_pk_add_f32 v[178:179], v[178:179], v[208:209]
v_pk_fma_f32 v[180:181], v[208:209], v[208:209], v[180:181]
v_pk_add_f32 v[178:179], v[178:179], v[210:211]
v_pk_fma_f32 v[180:181], v[210:211], v[210:211], v[180:181]
v_pk_fma_f32 v[214:215], v[214:215], v[176:177], v[198:199] op_sel_hi:[1,0,1]
v_pk_fma_f32 v[212:213], v[212:213], v[176:177], v[196:197] op_sel_hi:[1,0,1]
v_pk_add_f32 v[178:179], v[178:179], v[212:213]
v_pk_add_f32 v[178:179], v[178:179], v[214:215]
v_pk_fma_f32 v[180:181], v[212:213], v[212:213], v[180:181]
v_add_f32 v178, v178, v179
v_pk_fma_f32 v[180:181], v[214:215], v[214:215], v[180:181]
v_add_f32 v180, v180, v181
v_cvt_pk_bf16_f32 v220, v208, v209
v_cvt_pk_bf16_f32 v221, v210, v211
v_permlane32_swap_b32 v178, v180
v_cvt_pk_bf16_f32 v223, v214, v215
v_cvt_pk_bf16_f32 v222, v212, v213
v_cvt_pk_bf16_f32 v219, v206, v207
v_cvt_pk_bf16_f32 v216, v200, v201
v_cvt_pk_bf16_f32 v218, v204, v205
v_add_f32 v178, v178, v180
v_cvt_pk_bf16_f32 v217, v202, v203
buffer_store_dwordx4 v[216:219], v0, s[4:7], s27 offen offset:0 sc1
buffer_store_dwordx4 v[220:223], v0, s[4:7], s27 offen offset:1024 sc1
buffer_store_dword v178, v2, s[4:7], s36 offen sc1
v_xor_b32 v1, 40960, v1
s_mov_b32 s26, s6
s_mov_b32 s25, s31
s_add_u32 s27, s27, 1310720
s_add_u32 s36, s36, 163840
s_add_u32 s51, s51, 1310720
s_add_u32 s52, s52, 1310720
s_add_u32 s28, s28, 1
s_lshl_b32 s18, s39, 7
s_add_u32 s18, s18, 11612160
s_lshl_b32 s19, s16, 1
s_add_u32 s19, s19, s28
s_cmp_eq_u32 s13, 0
s_cselect_b32 s22, s18, s6
s_mov_b32 s23, s19
s_waitcnt vmcnt(0)
s_barrier
v_mov_b32 v3, s23
s_mov_b64 exec, 1
buffer_store_dword v3, off, s[4:7], s22 sc1
s_mov_b64 exec, -1
s_mov_b32 s22, s6
s_cmp_lt_u32 s28, 2
s_cbranch_scc1 p3_55
s_cmp_ge_u32 s39, 144
s_cbranch_scc1 p1b_57
s_cmp_ge_u32 s39, 64
s_cbranch_scc1 wo_56
s_and_b32 s32, s39, 31
s_cmp_lg_u32 s16, 0
s_cbranch_scc1 qw_59
s_lshl_b32 s26, s32, 8
s_lshl_b32 s18, s13, 6
s_add_u32 s26, s26, s18
s_load_dwordx2 s[40:41], s[0:1], 40
s_mov_b32 s42, 5242880
s_mov_b32 s43, 0x20000
s_waitcnt lgkmcnt(0)
v_lshrrev_b32 v34, 6, v0
v_mul_u32_u24 v34, 8192, v34
v_and_b32 v35, 48, v0
v_add_u32 v32, v34, v35
v_bfe_u32 v34, v0, 6, 2
v_lshrrev_b32 v35, 9, v0
v_lshl_add_u32 v34, v35, 3, v34
v_lshlrev_b32 v33, 6, v34
v_and_b32 v34, 16, v0
v_add_u32 v33, v33, v34
v_bfe_u32 v34, v0, 5, 1
v_lshl_add_u32 v33, v34, 3, v33
v_bfe_u32 v34, v0, 8, 1
v_lshl_add_u32 v33, v34, 5, v33
s_mul_i32 s18, s13, 36864
v_add_u32 v33, s18, v33
s_barrier
s_add_u32 m0, s18, 0
s_add_u32 s19, s26, 0
buffer_load_dwordx4 v32, s[40:43], s19 offen lds
s_add_u32 m0, s18, 1024
s_add_u32 s19, s26, 131072
buffer_load_dwordx4 v32, s[40:43], s19 offen lds
s_add_u32 m0, s18, 2048
s_add_u32 s19, s26, 262144
buffer_load_dwordx4 v32, s[40:43], s19 offen lds
s_add_u32 m0, s18, 3072
s_add_u32 s19, s26, 393216
buffer_load_dwordx4 v32, s[40:43], s19 offen lds
s_add_u32 m0, s18, 4096
s_add_u32 s19, s26, 524288
buffer_load_dwordx4 v32, s[40:43], s19 offen lds
s_add_u32 m0, s18, 5120
s_add_u32 s19, s26, 655360
buffer_load_dwordx4 v32, s[40:43], s19 offen lds
s_add_u32 m0, s18, 6144
s_add_u32 s19, s26, 786432
buffer_load_dwordx4 v32, s[40:43], s19 offen lds
s_add_u32 m0, s18, 7168
s_add_u32 s19, s26, 917504
buffer_load_dwordx4 v32, s[40:43], s19 offen lds
s_add_u32 m0, s18, 8192
s_add_u32 s19, s26, 1048576
buffer_load_dwordx4 v32, s[40:43], s19 offen lds
s_add_u32 m0, s18, 9216
s_add_u32 s19, s26, 1179648
buffer_load_dwordx4 v32, s[40:43], s19 offen lds
s_add_u32 m0, s18, 10240
s_add_u32 s19, s26, 1310720
buffer_load_dwordx4 v32, s[40:43], s19 offen lds
s_add_u32 m0, s18, 11264
s_add_u32 s19, s26, 1441792
buffer_load_dwordx4 v32, s[40:43], s19 offen lds
s_add_u32 m0, s18, 12288
s_add_u32 s19, s26, 1572864
buffer_load_dwordx4 v32, s[40:43], s19 offen lds
s_add_u32 m0, s18, 13312
s_add_u32 s19, s26, 1703936
buffer_load_dwordx4 v32, s[40:43], s19 offen lds
s_add_u32 m0, s18, 14336
s_add_u32 s19, s26, 1835008
buffer_load_dwordx4 v32, s[40:43], s19 offen lds
s_add_u32 m0, s18, 15360
s_add_u32 s19, s26, 1966080
buffer_load_dwordx4 v32, s[40:43], s19 offen lds
s_add_u32 m0, s18, 16384
s_add_u32 s19, s26, 2097152
buffer_load_dwordx4 v32, s[40:43], s19 offen lds
s_add_u32 m0, s18, 17408
s_add_u32 s19, s26, 2228224
buffer_load_dwordx4 v32, s[40:43], s19 offen lds
s_add_u32 m0, s18, 18432
s_add_u32 s19, s26, 2359296
buffer_load_dwordx4 v32, s[40:43], s19 offen lds
s_add_u32 m0, s18, 19456
s_add_u32 s19, s26, 2490368
buffer_load_dwordx4 v32, s[40:43], s19 offen lds
s_add_u32 m0, s18, 20480
s_add_u32 s19, s26, 2621440
buffer_load_dwordx4 v32, s[40:43], s19 offen lds
s_add_u32 m0, s18, 21504
s_add_u32 s19, s26, 2752512
buffer_load_dwordx4 v32, s[40:43], s19 offen lds
s_add_u32 m0, s18, 22528
s_add_u32 s19, s26, 2883584
buffer_load_dwordx4 v32, s[40:43], s19 offen lds
s_add_u32 m0, s18, 23552
s_add_u32 s19, s26, 3014656
buffer_load_dwordx4 v32, s[40:43], s19 offen lds
s_add_u32 m0, s18, 24576
s_add_u32 s19, s26, 3145728
buffer_load_dwordx4 v32, s[40:43], s19 offen lds
s_add_u32 m0, s18, 25600
s_add_u32 s19, s26, 3276800
buffer_load_dwordx4 v32, s[40:43], s19 offen lds
s_add_u32 m0, s18, 26624
s_add_u32 s19, s26, 3407872
buffer_load_dwordx4 v32, s[40:43], s19 offen lds
s_add_u32 m0, s18, 27648
s_add_u32 s19, s26, 3538944
buffer_load_dwordx4 v32, s[40:43], s19 offen lds
s_add_u32 m0, s18, 28672
s_add_u32 s19, s26, 3670016
buffer_load_dwordx4 v32, s[40:43], s19 offen lds
s_add_u32 m0, s18, 29696
s_add_u32 s19, s26, 3801088
buffer_load_dwordx4 v32, s[40:43], s19 offen lds
s_add_u32 m0, s18, 30720
s_add_u32 s19, s26, 3932160
buffer_load_dwordx4 v32, s[40:43], s19 offen lds
s_add_u32 m0, s18, 31744
s_add_u32 s19, s26, 4063232
buffer_load_dwordx4 v32, s[40:43], s19 offen lds
s_add_u32 m0, s18, 32768
s_add_u32 s19, s26, 4194304
buffer_load_dwordx4 v32, s[40:43], s19 offen lds
s_add_u32 m0, s18, 33792
s_add_u32 s19, s26, 4325376
buffer_load_dwordx4 v32, s[40:43], s19 offen lds
s_add_u32 m0, s18, 34816
s_add_u32 s19, s26, 4456448
buffer_load_dwordx4 v32, s[40:43], s19 offen lds
s_add_u32 m0, s18, 35840
s_add_u32 s19, s26, 4587520
buffer_load_dwordx4 v32, s[40:43], s19 offen lds
s_waitcnt vmcnt(32)
ds_read_b64_tr_b16 a[0:1], v33 offset:0
ds_read_b64_tr_b16 a[2:3], v33 offset:256
ds_read_b64_tr_b16 a[4:5], v33 offset:1024
ds_read_b64_tr_b16 a[6:7], v33 offset:1280
ds_read_b64_tr_b16 a[8:9], v33 offset:2048
ds_read_b64_tr_b16 a[10:11], v33 offset:2304
ds_read_b64_tr_b16 a[12:13], v33 offset:3072
ds_read_b64_tr_b16 a[14:15], v33 offset:3328
s_waitcnt lgkmcnt(0)
s_add_u32 m0, s18, 0
s_add_u32 s19, s26, 4718592
buffer_load_dwordx4 v32, s[40:43], s19 offen lds
s_add_u32 m0, s18, 1024
s_add_u32 s19, s26, 4849664
buffer_load_dwordx4 v32, s[40:43], s19 offen lds
s_add_u32 m0, s18, 2048
s_add_u32 s19, s26, 4980736
buffer_load_dwordx4 v32, s[40:43], s19 offen lds
s_add_u32 m0, s18, 3072
s_add_u32 s19, s26, 5111808
buffer_load_dwordx4 v32, s[40:43], s19 offen lds
s_waitcnt vmcnt(32)
ds_read_b64_tr_b16 a[16:17], v33 offset:4096
ds_read_b64_tr_b16 a[18:19], v33 offset:4352
ds_read_b64_tr_b16 a[20:21], v33 offset:5120
ds_read_b64_tr_b16 a[22:23], v33 offset:5376
ds_read_b64_tr_b16 a[24:25], v33 offset:6144
ds_read_b64_tr_b16 a[26:27], v33 offset:6400
ds_read_b64_tr_b16 a[28:29], v33 offset:7168
ds_read_b64_tr_b16 a[30:31], v33 offset:7424
s_waitcnt vmcnt(28)
ds_read_b64_tr_b16 a[32:33], v33 offset:8192
ds_read_b64_tr_b16 a[34:35], v33 offset:8448
ds_read_b64_tr_b16 a[36:37], v33 offset:9216
ds_read_b64_tr_b16 a[38:39], v33 offset:9472
ds_read_b64_tr_b16 a[40:41], v33 offset:10240
ds_read_b64_tr_b16 a[42:43], v33 offset:10496
ds_read_b64_tr_b16 a[44:45], v33 offset:11264
ds_read_b64_tr_b16 a[46:47], v33 offset:11520
s_waitcnt vmcnt(24)
ds_read_b64_tr_b16 a[48:49], v33 offset:12288
ds_read_b64_tr_b16 a[50:51], v33 offset:12544
ds_read_b64_tr_b16 a[52:53], v33 offset:13312
ds_read_b64_tr_b16 a[54:55], v33 offset:13568
ds_read_b64_tr_b16 a[56:57], v33 offset:14336
ds_read_b64_tr_b16 a[58:59], v33 offset:14592
ds_read_b64_tr_b16 a[60:61], v33 offset:15360
ds_read_b64_tr_b16 a[62:63], v33 offset:15616
s_waitcnt vmcnt(20)
ds_read_b64_tr_b16 a[64:65], v33 offset:16384
ds_read_b64_tr_b16 a[66:67], v33 offset:16640
ds_read_b64_tr_b16 a[68:69], v33 offset:17408
ds_read_b64_tr_b16 a[70:71], v33 offset:17664
ds_read_b64_tr_b16 a[72:73], v33 offset:18432
ds_read_b64_tr_b16 a[74:75], v33 offset:18688
ds_read_b64_tr_b16 a[76:77], v33 offset:19456
ds_read_b64_tr_b16 a[78:79], v33 offset:19712
s_waitcnt vmcnt(16)
ds_read_b64_tr_b16 a[80:81], v33 offset:20480
ds_read_b64_tr_b16 a[82:83], v33 offset:20736
ds_read_b64_tr_b16 a[84:85], v33 offset:21504
ds_read_b64_tr_b16 a[86:87], v33 offset:21760
ds_read_b64_tr_b16 a[88:89], v33 offset:22528
ds_read_b64_tr_b16 a[90:91], v33 offset:22784
ds_read_b64_tr_b16 a[92:93], v33 offset:23552
ds_read_b64_tr_b16 a[94:95], v33 offset:23808
s_waitcnt vmcnt(12)
ds_read_b64_tr_b16 a[96:97], v33 offset:24576
ds_read_b64_tr_b16 a[98:99], v33 offset:24832
ds_read_b64_tr_b16 a[100:101], v33 offset:25600
ds_read_b64_tr_b16 a[102:103], v33 offset:25856
ds_read_b64_tr_b16 a[104:105], v33 offset:26624
ds_read_b64_tr_b16 a[106:107], v33 offset:26880
ds_read_b64_tr_b16 a[108:109], v33 offset:27648
ds_read_b64_tr_b16 a[110:111], v33 offset:27904
s_waitcnt vmcnt(8)
ds_read_b64_tr_b16 a[112:113], v33 offset:28672
ds_read_b64_tr_b16 a[114:115], v33 offset:28928
ds_read_b64_tr_b16 a[116:117], v33 offset:29696
ds_read_b64_tr_b16 a[118:119], v33 offset:29952
ds_read_b64_tr_b16 a[120:121], v33 offset:30720
ds_read_b64_tr_b16 a[122:123], v33 offset:30976
ds_read_b64_tr_b16 a[124:125], v33 offset:31744
ds_read_b64_tr_b16 a[126:127], v33 offset:32000
s_waitcnt vmcnt(4)
ds_read_b64_tr_b16 a[128:129], v33 offset:32768
ds_read_b64_tr_b16 a[130:131], v33 offset:33024
ds_read_b64_tr_b16 a[132:133], v33 offset:33792
ds_read_b64_tr_b16 a[134:135], v33 offset:34048
ds_read_b64_tr_b16 a[136:137], v33 offset:34816
ds_read_b64_tr_b16 a[138:139], v33 offset:35072
ds_read_b64_tr_b16 a[140:141], v33 offset:35840
ds_read_b64_tr_b16 a[142:143], v33 offset:36096
s_waitcnt vmcnt(0)
ds_read_b64_tr_b16 a[144:145], v33 offset:0
ds_read_b64_tr_b16 a[146:147], v33 offset:256
ds_read_b64_tr_b16 a[148:149], v33 offset:1024
ds_read_b64_tr_b16 a[150:151], v33 offset:1280
ds_read_b64_tr_b16 a[152:153], v33 offset:2048
ds_read_b64_tr_b16 a[154:155], v33 offset:2304
ds_read_b64_tr_b16 a[156:157], v33 offset:3072
ds_read_b64_tr_b16 a[158:159], v33 offset:3328
s_waitcnt lgkmcnt(0)
s_barrier
v_mov_b32 v32, s24
v_mov_b32 v33, s24
v_mov_b32 v34, s24
v_mov_b32 v35, s24
s_nop 1
v_mfma_f32_32x32x16_bf16 v[36:51], a[0:3], v[32:35], 0
v_mfma_f32_32x32x16_bf16 v[36:51], a[4:7], v[32:35], v[36:51]
v_mfma_f32_32x32x16_bf16 v[36:51], a[8:11], v[32:35], v[36:51]
v_mfma_f32_32x32x16_bf16 v[36:51], a[12:15], v[32:35], v[36:51]
v_mfma_f32_32x32x16_bf16 v[36:51], a[16:19], v[32:35], v[36:51]
v_mfma_f32_32x32x16_bf16 v[36:51], a[20:23], v[32:35], v[36:51]
v_mfma_f32_32x32x16_bf16 v[36:51], a[24:27], v[32:35], v[36:51]
v_mfma_f32_32x32x16_bf16 v[36:51], a[28:31], v[32:35], v[36:51]
v_mfma_f32_32x32x16_bf16 v[36:51], a[32:35], v[32:35], v[36:51]
v_mfma_f32_32x32x16_bf16 v[36:51], a[36:39], v[32:35], v[36:51]
v_mfma_f32_32x32x16_bf16 v[36:51], a[40:43], v[32:35], v[36:51]
v_mfma_f32_32x32x16_bf16 v[36:51], a[44:47], v[32:35], v[36:51]
v_mfma_f32_32x32x16_bf16 v[36:51], a[48:51], v[32:35], v[36:51]
v_mfma_f32_32x32x16_bf16 v[36:51], a[52:55], v[32:35], v[36:51]
v_mfma_f32_32x32x16_bf16 v[36:51], a[56:59], v[32:35], v[36:51]
v_mfma_f32_32x32x16_bf16 v[36:51], a[60:63], v[32:35], v[36:51]
v_mfma_f32_32x32x16_bf16 v[36:51], a[64:67], v[32:35], v[36:51]
v_mfma_f32_32x32x16_bf16 v[36:51], a[68:71], v[32:35], v[36:51]
v_mfma_f32_32x32x16_bf16 v[36:51], a[72:75], v[32:35], v[36:51]
v_mfma_f32_32x32x16_bf16 v[36:51], a[76:79], v[32:35], v[36:51]
v_mfma_f32_32x32x16_bf16 v[36:51], a[80:83], v[32:35], v[36:51]
v_mfma_f32_32x32x16_bf16 v[36:51], a[84:87], v[32:35], v[36:51]
v_mfma_f32_32x32x16_bf16 v[36:51], a[88:91], v[32:35], v[36:51]
v_mfma_f32_32x32x16_bf16 v[36:51], a[92:95], v[32:35], v[36:51]
v_mfma_f32_32x32x16_bf16 v[36:51], a[96:99], v[32:35], v[36:51]
v_mfma_f32_32x32x16_bf16 v[36:51], a[100:103], v[32:35], v[36:51]
v_mfma_f32_32x32x16_bf16 v[36:51], a[104:107], v[32:35], v[36:51]
v_mfma_f32_32x32x16_bf16 v[36:51], a[108:111], v[32:35], v[36:51]
v_mfma_f32_32x32x16_bf16 v[36:51], a[112:115], v[32:35], v[36:51]
v_mfma_f32_32x32x16_bf16 v[36:51], a[116:119], v[32:35], v[36:51]
v_mfma_f32_32x32x16_bf16 v[36:51], a[120:123], v[32:35], v[36:51]
v_mfma_f32_32x32x16_bf16 v[36:51], a[124:127], v[32:35], v[36:51]
v_mfma_f32_32x32x16_bf16 v[36:51], a[128:131], v[32:35], v[36:51]
v_mfma_f32_32x32x16_bf16 v[36:51], a[132:135], v[32:35], v[36:51]
v_mfma_f32_32x32x16_bf16 v[36:51], a[136:139], v[32:35], v[36:51]
v_mfma_f32_32x32x16_bf16 v[36:51], a[140:143], v[32:35], v[36:51]
v_mfma_f32_32x32x16_bf16 v[36:51], a[144:147], v[32:35], v[36:51]
v_mfma_f32_32x32x16_bf16 v[36:51], a[148:151], v[32:35], v[36:51]
v_mfma_f32_32x32x16_bf16 v[36:51], a[152:155], v[32:35], v[36:51]
v_mfma_f32_32x32x16_bf16 v[36:51], a[156:159], v[32:35], v[36:51]
s_nop 11
v_mov_b32 v16, v36
v_mov_b32 v17, v37
v_mov_b32 v18, v38
v_mov_b32 v19, v39
v_mov_b32 v20, v40
v_mov_b32 v21, v41
v_mov_b32 v22, v42
v_mov_b32 v23, v43
v_mov_b32 v24, v44
v_mov_b32 v25, v45
v_mov_b32 v26, v46
v_mov_b32 v27, v47
v_mov_b32 v28, v48
v_mov_b32 v29, v49
v_mov_b32 v30, v50
v_mov_b32 v31, v51
v_accvgpr_write_b32 a160, v16
v_accvgpr_write_b32 a161, v17
v_accvgpr_write_b32 a162, v18
v_accvgpr_write_b32 a163, v19
v_accvgpr_write_b32 a164, v20
v_accvgpr_write_b32 a165, v21
v_accvgpr_write_b32 a166, v22
v_accvgpr_write_b32 a167, v23
v_accvgpr_write_b32 a168, v24
v_accvgpr_write_b32 a169, v25
v_accvgpr_write_b32 a170, v26
v_accvgpr_write_b32 a171, v27
v_accvgpr_write_b32 a172, v28
v_accvgpr_write_b32 a173, v29
v_accvgpr_write_b32 a174, v30
v_accvgpr_write_b32 a175, v31
qw_59:
v_accvgpr_read_b32 v16, a160
v_accvgpr_read_b32 v17, a161
v_accvgpr_read_b32 v18, a162
v_accvgpr_read_b32 v19, a163
v_accvgpr_read_b32 v20, a164
v_accvgpr_read_b32 v21, a165
v_accvgpr_read_b32 v22, a166
v_accvgpr_read_b32 v23, a167
v_accvgpr_read_b32 v24, a168
v_accvgpr_read_b32 v25, a169
v_accvgpr_read_b32 v26, a170
v_accvgpr_read_b32 v27, a171
v_accvgpr_read_b32 v28, a172
v_accvgpr_read_b32 v29, a173
v_accvgpr_read_b32 v30, a174
v_accvgpr_read_b32 v31, a175
s_lshl_b32 s29, s16, 1
s_add_u32 s29, s29, 2
s_lshr_b32 s52, s39, 5
s_lshl_b32 s53, s32, 8
s_add_u32 s53, s53, 11534336
s_cmp_lg_u32 s13, 0
s_cbranch_scc1 polld_61
v_lshlrev_b32 v11, 3, v0
v_add_u32 v12, 8192, v11
v_add_u32 v3, 16384, v11
v_min_u32 v3, 20352, v3
s_mov_b32 s21, 11612160
s_mov_b32 s17, 0
poll_60:
buffer_load_dword v8, v11, s[4:7], s21 offen sc1
buffer_load_dword v9, v12, s[4:7], s21 offen sc1
buffer_load_dword v10, v3, s[4:7], s21 offen sc1
s_add_u32 s17, s17, 1
s_cmp_gt_u32 s17, 262144
s_cbranch_scc1 L_fail
s_waitcnt vmcnt(0)
v_min3_u32 v8, v8, v9, v10
v_cmp_gt_u32 vcc, s29, v8
s_cbranch_vccz polld_61
s_sleep 2
s_branch poll_60
polld_61:
s_barrier
qr_62:
s_mul_i32 s26, s16, 6291456
s_mul_i32 s18, s52, 163840
s_add_u32 s26, s26, s18
s_add_u32 s26, s26, s31
s_add_u32 s26, s26, 88080384
s_lshl_b32 s18, s16, 4
s_add_u32 s18, s18, s52
s_mul_i32 s18, s18, 20480
s_add_u32 s36, s18, 163577856
s_lshl_b32 s18, s13, 11
s_add_u32 s18, s18, 83968
v_add_u32 v13, s18, v0
s_mov_b32 s28, 0
v_xor_b32 v1, 40960, v0
s_mov_b32 s25, s31
s_mov_b32 s35, 131072
s_add_u32 m0, s25, 2048
s_add_u32 s20, s26, 0
buffer_load_dwordx4 v0, s[4:7], s20 offen sc1 lds
s_add_u32 m0, s25, 3072
s_add_u32 s20, s26, 1024
buffer_load_dwordx4 v0, s[4:7], s20 offen sc1 lds
s_add_u32 m0, s25, 4096
s_add_u32 s20, s26, 2048
buffer_load_dwordx4 v0, s[4:7], s20 offen sc1 lds
s_add_u32 m0, s25, 5120
s_add_u32 s20, s26, 3072
buffer_load_dwordx4 v0, s[4:7], s20 offen sc1 lds
s_add_u32 m0, s25, 6144
s_add_u32 s20, s26, 4096
buffer_load_dwordx4 v0, s[4:7], s20 offen sc1 lds
s_add_u32 m0, s25, 7168
s_add_u32 s20, s26, 5120
buffer_load_dwordx4 v0, s[4:7], s20 offen sc1 lds
s_add_u32 m0, s25, 8192
s_add_u32 s20, s26, 6144
buffer_load_dwordx4 v0, s[4:7], s20 offen sc1 lds
s_add_u32 m0, s25, 9216
s_add_u32 s20, s26, 7168
buffer_load_dwordx4 v0, s[4:7], s20 offen sc1 lds
s_add_u32 m0, s25, 10240
s_add_u32 s20, s26, 8192
buffer_load_dwordx4 v0, s[4:7], s20 offen sc1 lds
s_add_u32 m0, s25, 11264
s_add_u32 s20, s26, 9216
buffer_load_dwordx4 v0, s[4:7], s20 offen sc1 lds
s_add_u32 m0, s35, s37
s_add_u32 s20, s36, s37
buffer_load_dwordx4 v0, s[4:7], s20 offen sc1 lds
s_add_u32 m0, s35, 4096
s_add_u32 s20, s36, 4096
buffer_load_dwordx4 v0, s[4:7], s20 offen sc1 lds
s_waitcnt vmcnt(0)
qu_63:
v_xor_b32 v1, 40960, v1
s_sub_u32 s25, s25, s31
s_xor_b32 s25, s25, 40960
s_add_u32 s25, s25, s31
s_xor_b32 s35, s35, 8192
s_add_u32 s26, s26, 40960
s_add_u32 s36, s36, 5120
s_cmp_eq_u32 s28, 3
s_cselect_b32 s26, s6, s26
s_cselect_b32 s36, s6, s36
s_waitcnt vmcnt(0)
s_barrier
ds_read_b128 v[48:51], v1 offset:2048
ds_read_b128 v[52:55], v1 offset:3072
s_add_u32 m0, s25, 2048
s_add_u32 s20, s26, 0
buffer_load_dwordx4 v0, s[4:7], s20 offen sc1 lds
v_lshrrev_b32 v2, 2, v0
ds_read_b128 v[56:59], v1 offset:4096
ds_read_b128 v[60:63], v1 offset:5120
s_xor_b32 s18, s35, 8192
v_add_u32 v2, s18, v2
ds_read2st64_b32 v[72:73], v2 offset0:4 offset1:5
s_waitcnt lgkmcnt(4)
v_mfma_f32_32x32x16_bf16 v[32:47], a[0:3], v[48:51], 0
s_add_u32 m0, s25, 3072
s_add_u32 s20, s26, 1024
buffer_load_dwordx4 v0, s[4:7], s20 offen sc1 lds
ds_read_b128 v[48:51], v1 offset:6144
ds_read2st64_b32 v[66:67], v2 offset0:2 offset1:3
s_waitcnt lgkmcnt(4)
v_mfma_f32_32x32x16_bf16 v[32:47], a[4:7], v[52:55], v[32:47]
ds_read_b128 v[52:55], v1 offset:7168
ds_read2st64_b32 v[78:79], v2 offset0:10 offset1:11
s_add_u32 m0, s25, 4096
s_add_u32 s20, s26, 2048
buffer_load_dwordx4 v0, s[4:7], s20 offen sc1 lds
v_mfma_f32_32x32x16_bf16 v[32:47], a[8:11], v[56:59], v[32:47]
s_waitcnt lgkmcnt(3)
ds_read_b128 v[56:59], v1 offset:8192
ds_read2st64_b32 v[86:87], v2 offset0:18 offset1:19
v_mfma_f32_32x32x16_bf16 v[32:47], a[12:15], v[60:63], v[32:47]
ds_read_b128 v[60:63], v1 offset:9216
ds_read2st64_b32 v[64:65], v2 offset0:0 offset1:1
s_waitcnt lgkmcnt(5)
ds_read2st64_b32 v[74:75], v2 offset0:6 offset1:7
v_mfma_f32_32x32x16_bf16 v[32:47], a[16:19], v[48:51], v[32:47]
ds_read2st64_b32 v[80:81], v2 offset0:12 offset1:13
ds_read_b128 v[48:51], v1 offset:10240
ds_read2st64_b32 v[82:83], v2 offset0:14 offset1:15
ds_read2st64_b32 v[76:77], v2 offset0:8 offset1:9
v_mfma_f32_32x32x16_bf16 v[32:47], a[20:23], v[52:55], v[32:47]
ds_read_b128 v[52:55], v1 offset:11264
s_waitcnt lgkmcnt(9)
s_add_u32 m0, s25, 5120
s_add_u32 s20, s26, 3072
buffer_load_dwordx4 v0, s[4:7], s20 offen sc1 lds
v_mfma_f32_32x32x16_bf16 v[32:47], a[24:27], v[56:59], v[32:47]
s_waitcnt lgkmcnt(7)
s_add_u32 m0, s25, 6144
s_add_u32 s20, s26, 4096
buffer_load_dwordx4 v0, s[4:7], s20 offen sc1 lds
s_waitcnt lgkmcnt(6)
v_add_f32 v64, v64, v66
v_mfma_f32_32x32x16_bf16 v[32:47], a[28:31], v[60:63], v[32:47]
ds_read_b128 v[56:59], v1 offset:12288
ds_read_b128 v[60:63], v1 offset:13312
v_add_f32 v65, v65, v67
s_waitcnt lgkmcnt(5)
v_mfma_f32_32x32x16_bf16 v[32:47], a[32:35], v[48:51], v[32:47]
ds_read_b128 v[48:51], v1 offset:14336
v_add_f32 v65, v65, v73
s_waitcnt lgkmcnt(3)
v_add_f32 v65, v65, v75
v_mfma_f32_32x32x16_bf16 v[32:47], a[36:39], v[52:55], v[32:47]
s_add_u32 m0, s25, 7168
s_add_u32 s20, s26, 5120
buffer_load_dwordx4 v0, s[4:7], s20 offen sc1 lds
ds_read2st64_b32 v[84:85], v2 offset0:16 offset1:17
v_add_f32 v64, v64, v72
s_waitcnt lgkmcnt(3)
v_add_f32 v65, v65, v77
v_mfma_f32_32x32x16_bf16 v[32:47], a[40:43], v[56:59], v[32:47]
s_waitcnt lgkmcnt(2)
ds_read_b128 v[56:59], v1 offset:16384
ds_read_b128 v[52:55], v1 offset:15360
v_add_f32 v64, v64, v74
v_add_f32 v64, v64, v76
v_mfma_f32_32x32x16_bf16 v[32:47], a[44:47], v[60:63], v[32:47]
s_waitcnt lgkmcnt(3)
ds_read_b128 v[60:63], v1 offset:17408
v_add_f32 v65, v65, v79
v_mfma_f32_32x32x16_bf16 v[32:47], a[48:51], v[48:51], v[32:47]
v_add_f32 v64, v64, v78
s_add_u32 m0, s25, 8192
s_add_u32 s20, s26, 6144
buffer_load_dwordx4 v0, s[4:7], s20 offen sc1 lds
s_waitcnt lgkmcnt(1)
v_mfma_f32_32x32x16_bf16 v[32:47], a[52:55], v[52:55], v[32:47]
ds_read_b128 v[48:51], v1 offset:18432
v_add_f32 v65, v65, v81
s_waitcnt lgkmcnt(1)
ds_read_b128 v[52:55], v1 offset:19456
v_mfma_f32_32x32x16_bf16 v[32:47], a[56:59], v[56:59], v[32:47]
s_add_u32 m0, s25, 9216
s_add_u32 s20, s26, 7168
buffer_load_dwordx4 v0, s[4:7], s20 offen sc1 lds
v_mfma_f32_32x32x16_bf16 v[32:47], a[60:63], v[60:63], v[32:47]
ds_read_b128 v[60:63], v1 offset:21504
s_waitcnt lgkmcnt(2)
ds_read_b128 v[56:59], v1 offset:20480
v_mfma_f32_32x32x16_bf16 v[32:47], a[64:67], v[48:51], v[32:47]
v_add_f32 v65, v65, v83
s_waitcnt lgkmcnt(2)
ds_read_b128 v[48:51], v1 offset:22528
v_mfma_f32_32x32x16_bf16 v[32:47], a[68:71], v[52:55], v[32:47]
v_add_f32 v65, v65, v85
v_add_f32 v64, v64, v80
v_add_f32 v64, v64, v82
s_waitcnt lgkmcnt(2)
s_waitcnt lgkmcnt(1)
v_mfma_f32_32x32x16_bf16 v[32:47], a[72:75], v[56:59], v[32:47]
s_add_u32 m0, s25, 10240
s_add_u32 s20, s26, 8192
buffer_load_dwordx4 v0, s[4:7], s20 offen sc1 lds
ds_read_b128 v[52:55], v1 offset:23552
v_add_f32 v64, v64, v84
v_add_f32 v65, v65, v87
s_waitcnt lgkmcnt(1)
v_mfma_f32_32x32x16_bf16 v[32:47], a[76:79], v[60:63], v[32:47]
v_add_f32 v64, v64, v86
ds_read_b128 v[56:59], v1 offset:24576
v_mfma_f32_32x32x16_bf16 v[32:47], a[80:83], v[48:51], v[32:47]
ds_read_b128 v[60:63], v1 offset:25600
ds_read_b128 v[48:51], v1 offset:26624
v_add_f32 v64, v64, v65
v_mov_b32 v68, v64
s_waitcnt lgkmcnt(3)
v_mfma_f32_32x32x16_bf16 v[32:47], a[84:87], v[52:55], v[32:47]
s_add_u32 m0, s25, 11264
s_add_u32 s20, s26, 9216
buffer_load_dwordx4 v0, s[4:7], s20 offen sc1 lds
s_waitcnt lgkmcnt(2)
v_permlane32_swap_b32 v64, v68
v_mfma_f32_32x32x16_bf16 v[32:47], a[88:91], v[56:59], v[32:47]
ds_read_b128 v[56:59], v1 offset:28672
ds_read_b128 v[52:55], v1 offset:27648
v_mul_f32 v68, 0x3acccccd, v68
s_waitcnt lgkmcnt(3)
v_mul_f32 v64, 0x3acccccd, v64
v_fma_f32 v68, -v64, v64, v68
v_mfma_f32_32x32x16_bf16 v[32:47], a[92:95], v[60:63], v[32:47]
s_add_u32 m0, s35, s37
s_add_u32 s20, s36, s37
buffer_load_dwordx4 v0, s[4:7], s20 offen sc1 lds
ds_read_b128 v[60:63], v1 offset:29696
s_waitcnt lgkmcnt(3)
v_max_f32 v68, 0, v68
v_add_f32 v68, 0x3727c5ac, v68
v_mfma_f32_32x32x16_bf16 v[32:47], a[96:99], v[48:51], v[32:47]
ds_read_b128 v[48:51], v1 offset:30720
v_rsq_f32 v68, v68
s_waitcnt lgkmcnt(2)
v_mul_f32 v68, 0x3e0293ee, v68
v_mfma_f32_32x32x16_bf16 v[32:47], a[100:103], v[52:55], v[32:47]
s_add_u32 m0, s35, 4096
s_add_u32 s20, s36, 4096
buffer_load_dwordx4 v0, s[4:7], s20 offen sc1 lds
v_mul_f32 v64, v68, v64
s_waitcnt lgkmcnt(1)
v_mfma_f32_32x32x16_bf16 v[32:47], a[104:107], v[56:59], v[32:47]
v_mul_f32 v82, v64, v26
s_waitcnt lgkmcnt(0)
ds_read_b128 v[52:55], v1 offset:31744
ds_read_b128 v[56:59], v1 offset:32768
v_mfma_f32_32x32x16_bf16 v[32:47], a[108:111], v[60:63], v[32:47]
ds_read_b128 v[60:63], v1 offset:33792
v_mfma_f32_32x32x16_bf16 v[32:47], a[112:115], v[48:51], v[32:47]
s_waitcnt lgkmcnt(2)
v_mul_f32 v84, v64, v28
v_mul_f32 v73, v64, v17
v_mfma_f32_32x32x16_bf16 v[32:47], a[116:119], v[52:55], v[32:47]
ds_read_b128 v[52:55], v1 offset:35840
s_waitcnt lgkmcnt(2)
ds_read_b128 v[48:51], v1 offset:34816
v_mfma_f32_32x32x16_bf16 v[32:47], a[120:123], v[56:59], v[32:47]
v_mul_f32 v87, v64, v31
v_mul_f32 v77, v64, v21
v_mul_f32 v81, v64, v25
s_waitcnt lgkmcnt(2)
v_mfma_f32_32x32x16_bf16 v[32:47], a[124:127], v[60:63], v[32:47]
ds_read_b128 v[60:63], v1 offset:37888
s_waitcnt lgkmcnt(2)
s_waitcnt lgkmcnt(1)
ds_read_b128 v[56:59], v1 offset:36864
v_mfma_f32_32x32x16_bf16 v[32:47], a[128:131], v[48:51], v[32:47]
ds_read_b128 v[48:51], v1 offset:38912
v_mul_f32 v75, v64, v19
v_mfma_f32_32x32x16_bf16 v[32:47], a[132:135], v[52:55], v[32:47]
s_waitcnt lgkmcnt(1)
v_mfma_f32_32x32x16_bf16 v[32:47], a[136:139], v[56:59], v[32:47]
ds_read_b128 v[56:59], v1 offset:40960
ds_read_b128 v[52:55], v1 offset:39936
v_mul_f32 v79, v64, v23
v_mul_f32 v85, v64, v29
v_mul_f32 v76, v64, v20
v_mfma_f32_32x32x16_bf16 v[32:47], a[140:143], v[60:63], v[32:47]
s_waitcnt lgkmcnt(2)
ds_read_b128 v[60:63], v1 offset:41984
v_mul_f32 v74, v64, v18
v_mul_f32 v86, v64, v30
v_mfma_f32_32x32x16_bf16 v[32:47], a[144:147], v[48:51], v[32:47]
s_waitcnt lgkmcnt(1)
v_mfma_f32_32x32x16_bf16 v[32:47], a[148:151], v[52:55], v[32:47]
s_waitcnt lgkmcnt(0)
v_mfma_f32_32x32x16_bf16 v[32:47], a[152:155], v[56:59], v[32:47]
v_mfma_f32_32x32x16_bf16 v[32:47], a[156:159], v[60:63], v[32:47]
s_nop 0
v_mul_f32 v72, v64, v16
v_mul_f32 v78, v64, v22
v_mul_f32 v83, v64, v27
v_mul_f32 v80, v64, v24
s_nop 6
v_pk_fma_f32 v[44:45], v[44:45], v[68:69], v[84:85] op_sel_hi:[1,0,1] neg_lo:[0,0,1] neg_hi:[0,0,1]
v_pk_fma_f32 v[38:39], v[38:39], v[68:69], v[78:79] op_sel_hi:[1,0,1] neg_lo:[0,0,1] neg_hi:[0,0,1]
v_pk_fma_f32 v[42:43], v[42:43], v[68:69], v[82:83] op_sel_hi:[1,0,1] neg_lo:[0,0,1] neg_hi:[0,0,1]
v_pk_fma_f32 v[46:47], v[46:47], v[68:69], v[86:87] op_sel_hi:[1,0,1] neg_lo:[0,0,1] neg_hi:[0,0,1]
v_pk_fma_f32 v[34:35], v[34:35], v[68:69], v[74:75] op_sel_hi:[1,0,1] neg_lo:[0,0,1] neg_hi:[0,0,1]
v_pk_fma_f32 v[32:33], v[32:33], v[68:69], v[72:73] op_sel_hi:[1,0,1] neg_lo:[0,0,1] neg_hi:[0,0,1]
v_cvt_pk_bf16_f32 v51, v38, v39
v_cvt_pk_bf16_f32 v49, v34, v35
v_pk_fma_f32 v[36:37], v[36:37], v[68:69], v[76:77] op_sel_hi:[1,0,1] neg_lo:[0,0,1] neg_hi:[0,0,1]
v_cvt_pk_bf16_f32 v54, v44, v45
v_cvt_pk_bf16_f32 v50, v36, v37
v_cvt_pk_bf16_f32 v48, v32, v33
v_pk_fma_f32 v[40:41], v[40:41], v[68:69], v[80:81] op_sel_hi:[1,0,1] neg_lo:[0,0,1] neg_hi:[0,0,1]
v_cvt_pk_bf16_f32 v55, v46, v47
v_cvt_pk_bf16_f32 v53, v42, v43
v_cvt_pk_bf16_f32 v52, v40, v41
ds_write_b128 v13, v[48:51] offset:0
ds_write_b128 v13, v[52:55] offset:1024
v_add_u32 v13, 8192, v13
s_add_u32 s28, s28, 1
s_cmp_lt_u32 s28, 4
s_cbranch_scc1 qu_63
s_waitcnt lgkmcnt(0)
s_barrier
s_lshl_b32 s30, s52, 2
s_add_u32 s30, s30, s13
s_lshl_b32 s18, s16, 6
s_add_u32 s29, s18, s30
s_lshl_b32 s27, s29, 18
s_lshl_b32 s19, s32, 13
s_add_u32 s27, s27, s19
s_add_u32 s27, s27, 127926272
s_mul_i32 s18, s16, 35651584
s_mul_i32 s19, s30, 524288
s_add_u32 s18, s18, s19
s_mul_i32 s19, s32, 16384
s_add_u32 s18, s18, s19
s_add_u32 s29, s29, 1
s_mov_b32 s28, s29
s_lshl_b32 s19, s13, 13
s_add_u32 s19, s19, 83968
v_add_u32 v200, s19, v0
s_add_u32 s54, s18, 16777216
s_add_u32 s55, s18, 16781312
s_add_u32 s56, s18, 16785408
s_add_u32 s57, s18, 16789504
ds_read_b128 v[32:35], v200 offset:0
ds_read_b128 v[36:39], v200 offset:1024
ds_read_b128 v[40:43], v200 offset:2048
ds_read_b128 v[44:47], v200 offset:3072
ds_read_b128 v[48:51], v200 offset:4096
ds_read_b128 v[52:55], v200 offset:5120
ds_read_b128 v[56:59], v200 offset:6144
ds_read_b128 v[60:63], v200 offset:7168
v_and_b32 v14, 0x70, v0
v_lshrrev_b32 v200, 8, v0
v_lshl_add_u32 v14, v200, 7, v14
v_bfe_u32 v200, v0, 7, 1
v_lshl_add_u32 v14, v200, 12, v14
v_and_b32 v15, 0x70, v0
v_lshrrev_b32 v200, 8, v0
v_lshl_add_u32 v15, v200, 7, v15
v_bfe_u32 v200, v0, 7, 1
v_lshl_add_u32 v15, v200, 10, v15
v_bfe_u32 v200, v0, 4, 5
v_lshrrev_b32 v144, 9, v0
v_lshlrev_b32 v144, 2, v144
v_sub_u32 v200, v200, v144
v_mov_b32 v145, 0xf149f2ca
v_cmp_gt_i32 vcc, 0, v200
s_nop 1
v_cndmask_b32 v128, 0, v145, vcc
v_cmp_gt_i32 vcc, 1, v200
s_nop 1
v_cndmask_b32 v129, 0, v145, vcc
v_cmp_gt_i32 vcc, 2, v200
s_nop 1
v_cndmask_b32 v130, 0, v145, vcc
v_cmp_gt_i32 vcc, 3, v200
s_nop 1
v_cndmask_b32 v131, 0, v145, vcc
v_cmp_gt_i32 vcc, 8, v200
s_nop 1
v_cndmask_b32 v132, 0, v145, vcc
v_cmp_gt_i32 vcc, 9, v200
s_nop 1
v_cndmask_b32 v133, 0, v145, vcc
v_cmp_gt_i32 vcc, 10, v200
s_nop 1
v_cndmask_b32 v134, 0, v145, vcc
v_cmp_gt_i32 vcc, 11, v200
s_nop 1
v_cndmask_b32 v135, 0, v145, vcc
v_cmp_gt_i32 vcc, 16, v200
s_nop 1
v_cndmask_b32 v136, 0, v145, vcc
v_cmp_gt_i32 vcc, 17, v200
s_nop 1
v_cndmask_b32 v137, 0, v145, vcc
v_cmp_gt_i32 vcc, 18, v200
s_nop 1
v_cndmask_b32 v138, 0, v145, vcc
v_cmp_gt_i32 vcc, 19, v200
s_nop 1
v_cndmask_b32 v139, 0, v145, vcc
v_cmp_gt_i32 vcc, 24, v200
s_nop 1
v_cndmask_b32 v140, 0, v145, vcc
v_cmp_gt_i32 vcc, 25, v200
s_nop 1
v_cndmask_b32 v141, 0, v145, vcc
v_cmp_gt_i32 vcc, 26, v200
s_nop 1
v_cndmask_b32 v142, 0, v145, vcc
v_cmp_gt_i32 vcc, 27, v200
s_nop 1
v_cndmask_b32 v143, 0, v145, vcc
v_lshlrev_b32 v11, 3, v0
v_min_u32 v11, 128, v11
s_mov_b32 s17, 0
poll_64:
buffer_load_dword v8, v11, s[4:7], s53 offen sc1
s_add_u32 s17, s17, 1
s_cmp_gt_u32 s17, 262144
s_cbranch_scc1 L_fail
s_waitcnt vmcnt(0)
v_cmp_gt_u32 vcc, s29, v8
s_cbranch_vccz polld_65
s_sleep 2
s_branch poll_64
polld_65:
buffer_load_dwordx4 v[64:67], v14, s[4:7], s54 offen offset:0 sc1
buffer_load_dwordx4 v[68:71], v14, s[4:7], s54 offen offset:512 sc1
buffer_load_dwordx4 v[72:75], v14, s[4:7], s54 offen offset:1024 sc1
buffer_load_dwordx4 v[76:79], v14, s[4:7], s54 offen offset:1536 sc1
buffer_load_dwordx4 v[80:83], v14, s[4:7], s56 offen offset:0 sc1
buffer_load_dwordx4 v[84:87], v14, s[4:7], s56 offen offset:512 sc1
buffer_load_dwordx4 v[88:91], v14, s[4:7], s56 offen offset:1024 sc1
buffer_load_dwordx4 v[92:95], v14, s[4:7], s56 offen offset:1536 sc1
buffer_load_dwordx4 v[96:99], v15, s[4:7], s54 offen offset:2048 sc1
buffer_load_dwordx4 v[100:103], v15, s[4:7], s54 offen offset:2560 sc1
buffer_load_dwordx4 v[104:107], v15, s[4:7], s55 offen offset:2048 sc1
buffer_load_dwordx4 v[108:111], v15, s[4:7], s55 offen offset:2560 sc1
buffer_load_dwordx4 v[112:115], v15, s[4:7], s56 offen offset:2048 sc1
buffer_load_dwordx4 v[116:119], v15, s[4:7], s56 offen offset:2560 sc1
buffer_load_dwordx4 v[120:123], v15, s[4:7], s57 offen offset:2048 sc1
buffer_load_dwordx4 v[124:127], v15, s[4:7], s57 offen offset:2560 sc1
s_waitcnt vmcnt(15) lgkmcnt(7)
v_mfma_f32_32x32x16_bf16 v[128:143], v[64:67], v[32:35], v[128:143]
s_waitcnt vmcnt(14) lgkmcnt(6)
v_mfma_f32_32x32x16_bf16 v[128:143], v[68:71], v[36:39], v[128:143]
s_waitcnt vmcnt(13) lgkmcnt(5)
v_mfma_f32_32x32x16_bf16 v[128:143], v[72:75], v[40:43], v[128:143]
s_waitcnt vmcnt(12) lgkmcnt(4)
v_mfma_f32_32x32x16_bf16 v[128:143], v[76:79], v[44:47], v[128:143]
s_waitcnt vmcnt(11) lgkmcnt(3)
v_mfma_f32_32x32x16_bf16 v[128:143], v[80:83], v[48:51], v[128:143]
s_waitcnt vmcnt(10) lgkmcnt(2)
v_mfma_f32_32x32x16_bf16 v[128:143], v[84:87], v[52:55], v[128:143]
s_waitcnt vmcnt(9) lgkmcnt(1)
v_mfma_f32_32x32x16_bf16 v[128:143], v[88:91], v[56:59], v[128:143]
s_waitcnt vmcnt(8) lgkmcnt(0)
v_mfma_f32_32x32x16_bf16 v[128:143], v[92:95], v[60:63], v[128:143]
s_lshl_b32 s18, s16, 4
s_add_u32 s29, s18, s52
s_lshl_b32 s18, s29, 19
s_lshl_b32 s19, s32, 14
s_add_u32 s18, s18, s19
s_add_u32 s29, s29, 1
s_and_b32 s19, s13, 1
s_lshr_b32 s20, s13, 1
v_and_b32 v14, 0x170, v14
v_lshl_add_u32 v14, s19, 12, v14
v_lshl_add_u32 v14, s20, 7, v14
v_lshl_add_u32 v15, s19, 3, v15
v_lshl_add_u32 v15, s20, 9, v15
s_add_u32 s54, s18, 110100480
s_add_u32 s55, s18, 110104576
s_add_u32 s56, s18, 110108672
s_add_u32 s57, s18, 110112768
v_max3_f32 v200, v128, v129, v130
v_max3_f32 v200, v200, v131, v132
v_max3_f32 v200, v200, v133, v134
v_max3_f32 v200, v200, v135, v136
v_max3_f32 v200, v200, v137, v138
v_max3_f32 v200, v200, v139, v140
v_max3_f32 v200, v200, v141, v142
v_max_f32 v200, v200, v143
s_add_u32 s18, s53, 8192
v_lshlrev_b32 v11, 3, v0
v_min_u32 v11, 128, v11
s_mov_b32 s17, 0
poll_66:
buffer_load_dword v8, v11, s[4:7], s18 offen sc1
s_add_u32 s17, s17, 1
s_cmp_gt_u32 s17, 262144
s_cbranch_scc1 L_fail
s_waitcnt vmcnt(0)
v_cmp_gt_u32 vcc, s29, v8
s_cbranch_vccz polld_67
s_sleep 2
s_branch poll_66
polld_67:
buffer_load_dwordx4 v[64:67], v14, s[4:7], s54 offen offset:0 sc1
buffer_load_dwordx4 v[68:71], v14, s[4:7], s54 offen offset:512 sc1
buffer_load_dwordx4 v[72:75], v14, s[4:7], s54 offen offset:1024 sc1
buffer_load_dwordx4 v[76:79], v14, s[4:7], s54 offen offset:1536 sc1
buffer_load_dwordx4 v[80:83], v14, s[4:7], s56 offen offset:0 sc1
buffer_load_dwordx4 v[84:87], v14, s[4:7], s56 offen offset:512 sc1
buffer_load_dwordx4 v[88:91], v14, s[4:7], s56 offen offset:1024 sc1
buffer_load_dwordx4 v[92:95], v14, s[4:7], s56 offen offset:1536 sc1
buffer_load_dwordx2 v[192:193], v15, s[4:7], s54 offen offset:2048 sc1
buffer_load_dwordx2 v[194:195], v15, s[4:7], s55 offen offset:2048 sc1
buffer_load_dwordx2 v[196:197], v15, s[4:7], s56 offen offset:2048 sc1
buffer_load_dwordx2 v[198:199], v15, s[4:7], s57 offen offset:2048 sc1
s_waitcnt vmcnt(11)
v_mfma_f32_32x32x16_bf16 v[144:159], v[64:67], v[32:35], 0
s_waitcnt vmcnt(10)
v_mfma_f32_32x32x16_bf16 v[144:159], v[68:71], v[36:39], v[144:159]
s_waitcnt vmcnt(9)
v_mfma_f32_32x32x16_bf16 v[144:159], v[72:75], v[40:43], v[144:159]
s_waitcnt vmcnt(8)
v_mfma_f32_32x32x16_bf16 v[144:159], v[76:79], v[44:47], v[144:159]
s_waitcnt vmcnt(7)
v_mfma_f32_32x32x16_bf16 v[144:159], v[80:83], v[48:51], v[144:159]
s_waitcnt vmcnt(6)
v_mfma_f32_32x32x16_bf16 v[144:159], v[84:87], v[52:55], v[144:159]
s_waitcnt vmcnt(5)
v_mfma_f32_32x32x16_bf16 v[144:159], v[88:91], v[56:59], v[144:159]
s_waitcnt vmcnt(4)
v_mfma_f32_32x32x16_bf16 v[144:159], v[92:95], v[60:63], v[144:159]
s_nop 11
v_max3_f32 v148, v200, v144, v145
v_max3_f32 v148, v148, v146, v147
v_mov_b32 v150, v148
s_nop 1
v_permlane32_swap_b32 v148, v150
v_max_f32 v148, v148, v150
v_sub_f32 v147, v147, v148
v_sub_f32 v144, v144, v148
v_exp_f32 v144, v144
v_sub_f32 v145, v145, v148
v_sub_f32 v146, v146, v148
v_exp_f32 v147, v147
v_exp_f32 v146, v146
v_exp_f32 v145, v145
v_cvt_pk_bf16_f32 v41, v146, v147
v_cvt_pk_bf16_f32 v40, v144, v145
v_sub_f32 v134, v134, v148
v_sub_f32 v133, v133, v148
s_waitcnt vmcnt(1)
v_mfma_f32_32x32x8_bf16 v[64:79], v[196:197], v[40:41], 0
v_sub_f32 v129, v129, v148
v_exp_f32 v133, v133
v_exp_f32 v129, v129
v_sub_f32 v131, v131, v148
v_mfma_f32_32x32x8_bf16 v[176:191], v[194:195], v[40:41], 0
v_sub_f32 v132, v132, v148
v_exp_f32 v132, v132
v_exp_f32 v134, v134
v_sub_f32 v128, v128, v148
s_waitcnt vmcnt(0)
v_mfma_f32_32x32x8_bf16 v[80:95], v[198:199], v[40:41], 0
v_sub_f32 v135, v135, v148
v_sub_f32 v130, v130, v148
v_exp_f32 v131, v131
v_exp_f32 v130, v130
v_mfma_f32_32x32x8_bf16 v[160:175], v[192:193], v[40:41], 0
v_exp_f32 v135, v135
v_cvt_pk_bf16_f32 v34, v132, v133
v_exp_f32 v128, v128
v_cvt_pk_bf16_f32 v33, v130, v131
v_cvt_pk_bf16_f32 v35, v134, v135
v_cvt_pk_bf16_f32 v32, v128, v129
v_sub_f32 v136, v136, v148
v_add_f32 v149, v128, v129
v_mfma_f32_32x32x16_bf16 v[80:95], v[120:123], v[32:35], v[80:95]
s_add_u32 s19, s27, 4096
v_sub_f32 v142, v142, v148
v_sub_f32 v138, v138, v148
v_sub_f32 v139, v139, v148
v_sub_f32 v143, v143, v148
v_exp_f32 v143, v143
v_mfma_f32_32x32x16_bf16 v[64:79], v[112:115], v[32:35], v[64:79]
v_exp_f32 v136, v136
v_sub_f32 v140, v140, v148
v_sub_f32 v141, v141, v148
v_exp_f32 v140, v140
v_mfma_f32_32x32x16_bf16 v[160:175], v[96:99], v[32:35], v[160:175]
v_exp_f32 v141, v141
v_sub_f32 v137, v137, v148
v_cvt_pk_bf16_f32 v38, v140, v141
v_exp_f32 v142, v142
v_mfma_f32_32x32x16_bf16 v[176:191], v[104:107], v[32:35], v[176:191]
v_cvt_pk_bf16_f32 v39, v142, v143
v_exp_f32 v137, v137
v_exp_f32 v139, v139
v_exp_f32 v138, v138
v_cvt_pk_bf16_f32 v36, v136, v137
v_cvt_pk_bf16_f32 v37, v138, v139
v_add_f32 v149, v149, v130
v_add_f32 v149, v149, v131
v_mfma_f32_32x32x16_bf16 v[160:175], v[100:103], v[36:39], v[160:175]
v_add_f32 v149, v149, v132
v_add_f32 v149, v149, v133
v_add_f32 v149, v149, v134
v_add_f32 v149, v149, v135
v_add_f32 v149, v149, v136
v_add_f32 v149, v149, v137
v_mfma_f32_32x32x16_bf16 v[64:79], v[116:119], v[36:39], v[64:79]
v_add_f32 v149, v149, v138
v_add_f32 v149, v149, v139
v_add_f32 v149, v149, v140
v_add_f32 v149, v149, v141
v_add_f32 v149, v149, v142
v_add_f32 v149, v149, v143
v_add_f32 v149, v149, v144
v_add_f32 v149, v149, v145
v_add_f32 v149, v149, v146
v_add_f32 v149, v149, v147
v_mov_b32 v150, v149
v_mfma_f32_32x32x16_bf16 v[80:95], v[124:127], v[36:39], v[80:95]
s_nop 0
v_permlane32_swap_b32 v149, v150
v_add_f32 v149, v149, v150
v_rcp_f32 v149, v149
v_mfma_f32_32x32x16_bf16 v[176:191], v[108:111], v[36:39], v[176:191]
s_nop 0
v_mul_f32 v161, v161, v149
v_mul_f32 v64, v64, v149
v_mul_f32 v167, v167, v149
v_mul_f32 v74, v74, v149
v_mul_f32 v66, v66, v149
v_mul_f32 v69, v69, v149
v_mul_f32 v67, v67, v149
v_mul_f32 v166, v166, v149
v_mul_f32 v65, v65, v149
v_mul_f32 v160, v160, v149
v_mul_f32 v71, v71, v149
v_mul_f32 v177, v177, v149
v_mul_f32 v165, v165, v149
v_mul_f32 v188, v188, v149
v_mul_f32 v170, v170, v149
v_mul_f32 v80, v80, v149
v_mul_f32 v85, v85, v149
v_cvt_pk_bf16_f32 v64, v64, v65
v_mul_f32 v178, v178, v149
v_mul_f32 v168, v168, v149
v_mul_f32 v162, v162, v149
v_mul_f32 v92, v92, v149
v_mul_f32 v84, v84, v149
v_mul_f32 v163, v163, v149
v_mul_f32 v185, v185, v149
v_cvt_pk_bf16_f32 v160, v160, v161
v_mul_f32 v73, v73, v149
v_mul_f32 v189, v189, v149
v_mul_f32 v169, v169, v149
v_mul_f32 v83, v83, v149
v_mul_f32 v172, v172, v149
v_mul_f32 v75, v75, v149
v_cvt_pk_bf16_f32 v161, v162, v163
v_mul_f32 v176, v176, v149
v_mul_f32 v91, v91, v149
v_mul_f32 v180, v180, v149
v_mul_f32 v181, v181, v149
v_cvt_pk_bf16_f32 v65, v66, v67
v_mul_f32 v164, v164, v149
v_cvt_pk_bf16_f32 v162, v164, v165
v_mul_f32 v173, v173, v149
v_mul_f32 v179, v179, v149
v_mul_f32 v190, v190, v149
v_mul_f32 v182, v182, v149
v_mul_f32 v90, v90, v149
v_mul_f32 v81, v81, v149
v_mul_f32 v89, v89, v149
v_mul_f32 v171, v171, v149
v_mul_f32 v88, v88, v149
v_mul_f32 v82, v82, v149
v_mul_f32 v68, v68, v149
v_cvt_pk_bf16_f32 v66, v68, v69
v_mul_f32 v174, v174, v149
v_mul_f32 v183, v183, v149
v_cvt_pk_bf16_f32 v164, v168, v169
v_cvt_pk_bf16_f32 v165, v170, v171
v_cvt_pk_bf16_f32 v176, v176, v177
v_mul_f32 v72, v72, v149
v_cvt_pk_bf16_f32 v177, v178, v179
v_cvt_pk_bf16_f32 v163, v166, v167
v_mul_f32 v95, v95, v149
v_mul_f32 v175, v175, v149
v_mul_f32 v79, v79, v149
v_cvt_pk_bf16_f32 v166, v172, v173
v_cvt_pk_bf16_f32 v167, v174, v175
v_cvt_pk_bf16_f32 v178, v180, v181
v_cvt_pk_bf16_f32 v179, v182, v183
v_mul_f32 v87, v87, v149
buffer_store_dwordx4 v[160:163], v0, s[4:7], s27 offen offset:0 sc1
buffer_store_dwordx4 v[164:167], v0, s[4:7], s27 offen offset:1024 sc1
buffer_store_dwordx4 v[176:179], v0, s[4:7], s27 offen offset:2048 sc1
v_mul_f32 v78, v78, v149
v_mul_f32 v76, v76, v149
v_mul_f32 v86, v86, v149
v_cvt_pk_bf16_f32 v80, v80, v81
v_mul_f32 v77, v77, v149
v_mul_f32 v70, v70, v149
v_mul_f32 v186, v186, v149
v_mul_f32 v184, v184, v149
v_mul_f32 v187, v187, v149
v_cvt_pk_bf16_f32 v81, v82, v83
v_cvt_pk_bf16_f32 v67, v70, v71
v_mul_f32 v191, v191, v149
v_cvt_pk_bf16_f32 v182, v188, v189
v_cvt_pk_bf16_f32 v83, v86, v87
v_cvt_pk_bf16_f32 v82, v84, v85
v_mul_f32 v94, v94, v149
v_cvt_pk_bf16_f32 v181, v186, v187
v_cvt_pk_bf16_f32 v180, v184, v185
v_cvt_pk_bf16_f32 v69, v74, v75
v_mul_f32 v93, v93, v149
v_cvt_pk_bf16_f32 v183, v190, v191
v_cvt_pk_bf16_f32 v68, v72, v73
v_cvt_pk_bf16_f32 v85, v90, v91
v_cvt_pk_bf16_f32 v86, v92, v93
v_cvt_pk_bf16_f32 v71, v78, v79
v_cvt_pk_bf16_f32 v87, v94, v95
v_cvt_pk_bf16_f32 v84, v88, v89
v_cvt_pk_bf16_f32 v70, v76, v77
buffer_store_dwordx4 v[180:183], v0, s[4:7], s27 offen offset:3072 sc1
buffer_store_dwordx4 v[64:67], v0, s[4:7], s19 offen offset:0 sc1
buffer_store_dwordx4 v[68:71], v0, s[4:7], s19 offen offset:1024 sc1
buffer_store_dwordx4 v[80:83], v0, s[4:7], s19 offen offset:2048 sc1
buffer_store_dwordx4 v[84:87], v0, s[4:7], s19 offen offset:3072 sc1
s_and_b32 s18, s30, 7
s_lshl_b32 s18, s18, 5
s_add_u32 s18, s18, s32
s_lshl_b32 s18, s18, 7
s_add_u32 s18, s18, 11632640
s_waitcnt vmcnt(0)
v_mov_b32 v3, s28
s_mov_b64 exec, 1
buffer_store_dword v3, off, s[4:7], s18 sc1
s_mov_b64 exec, -1
s_add_u32 s52, s52, 2
s_cmp_lt_u32 s52, 16
s_cbranch_scc1 qr_62
s_barrier
s_branch aend_58
wo_56:
s_sub_u32 s18, s39, 64
s_mul_i32 s30, s18, 3277
s_lshr_b32 s30, s30, 16
s_mul_i32 s19, s30, 20
s_sub_u32 s52, s18, s19
s_cmp_lg_u32 s16, 0
s_cbranch_scc1 ww_68
s_mul_i32 s26, s13, 1310720
s_lshl_b32 s18, s52, 6
s_add_u32 s26, s26, s18
s_load_dwordx2 s[40:41], s[0:1], 64
s_mov_b32 s42, 5242880
s_mov_b32 s43, 0x20000
s_waitcnt lgkmcnt(0)
v_lshrrev_b32 v214, 6, v0
v_mul_u32_u24 v214, 1280, v214
v_and_b32 v215, 48, v0
v_add_u32 v212, v214, v215
v_bfe_u32 v214, v0, 6, 2
v_lshrrev_b32 v215, 9, v0
v_lshl_add_u32 v214, v215, 3, v214
v_lshlrev_b32 v213, 6, v214
v_and_b32 v214, 16, v0
v_add_u32 v213, v213, v214
v_bfe_u32 v214, v0, 5, 1
v_lshl_add_u32 v213, v214, 3, v213
v_bfe_u32 v214, v0, 8, 1
v_lshl_add_u32 v213, v214, 5, v213
s_mul_i32 s18, s13, 36864
v_add_u32 v213, s18, v213
s_barrier
s_add_u32 m0, s18, 0
s_add_u32 s19, s26, 0
buffer_load_dwordx4 v212, s[40:43], s19 offen lds
s_add_u32 m0, s18, 1024
s_add_u32 s19, s26, 20480
buffer_load_dwordx4 v212, s[40:43], s19 offen lds
s_add_u32 m0, s18, 2048
s_add_u32 s19, s26, 40960
buffer_load_dwordx4 v212, s[40:43], s19 offen lds
s_add_u32 m0, s18, 3072
s_add_u32 s19, s26, 61440
buffer_load_dwordx4 v212, s[40:43], s19 offen lds
s_add_u32 m0, s18, 4096
s_add_u32 s19, s26, 81920
buffer_load_dwordx4 v212, s[40:43], s19 offen lds
s_add_u32 m0, s18, 5120
s_add_u32 s19, s26, 102400
buffer_load_dwordx4 v212, s[40:43], s19 offen lds
s_add_u32 m0, s18, 6144
s_add_u32 s19, s26, 122880
buffer_load_dwordx4 v212, s[40:43], s19 offen lds
s_add_u32 m0, s18, 7168
s_add_u32 s19, s26, 143360
buffer_load_dwordx4 v212, s[40:43], s19 offen lds
s_add_u32 m0, s18, 8192
s_add_u32 s19, s26, 163840
buffer_load_dwordx4 v212, s[40:43], s19 offen lds
s_add_u32 m0, s18, 9216
s_add_u32 s19, s26, 184320
buffer_load_dwordx4 v212, s[40:43], s19 offen lds
s_add_u32 m0, s18, 10240
s_add_u32 s19, s26, 204800
buffer_load_dwordx4 v212, s[40:43], s19 offen lds
s_add_u32 m0, s18, 11264
s_add_u32 s19, s26, 225280
buffer_load_dwordx4 v212, s[40:43], s19 offen lds
s_add_u32 m0, s18, 12288
s_add_u32 s19, s26, 245760
buffer_load_dwordx4 v212, s[40:43], s19 offen lds
s_add_u32 m0, s18, 13312
s_add_u32 s19, s26, 266240
buffer_load_dwordx4 v212, s[40:43], s19 offen lds
s_add_u32 m0, s18, 14336
s_add_u32 s19, s26, 286720
buffer_load_dwordx4 v212, s[40:43], s19 offen lds
s_add_u32 m0, s18, 15360
s_add_u32 s19, s26, 307200
buffer_load_dwordx4 v212, s[40:43], s19 offen lds
s_add_u32 m0, s18, 16384
s_add_u32 s19, s26, 327680
buffer_load_dwordx4 v212, s[40:43], s19 offen lds
s_add_u32 m0, s18, 17408
s_add_u32 s19, s26, 348160
buffer_load_dwordx4 v212, s[40:43], s19 offen lds
s_add_u32 m0, s18, 18432
s_add_u32 s19, s26, 368640
buffer_load_dwordx4 v212, s[40:43], s19 offen lds
s_add_u32 m0, s18, 19456
s_add_u32 s19, s26, 389120
buffer_load_dwordx4 v212, s[40:43], s19 offen lds
s_add_u32 m0, s18, 20480
s_add_u32 s19, s26, 409600
buffer_load_dwordx4 v212, s[40:43], s19 offen lds
s_add_u32 m0, s18, 21504
s_add_u32 s19, s26, 430080
buffer_load_dwordx4 v212, s[40:43], s19 offen lds
s_add_u32 m0, s18, 22528
s_add_u32 s19, s26, 450560
buffer_load_dwordx4 v212, s[40:43], s19 offen lds
s_add_u32 m0, s18, 23552
s_add_u32 s19, s26, 471040
buffer_load_dwordx4 v212, s[40:43], s19 offen lds
s_add_u32 m0, s18, 24576
s_add_u32 s19, s26, 491520
buffer_load_dwordx4 v212, s[40:43], s19 offen lds
s_add_u32 m0, s18, 25600
s_add_u32 s19, s26, 512000
buffer_load_dwordx4 v212, s[40:43], s19 offen lds
s_add_u32 m0, s18, 26624
s_add_u32 s19, s26, 532480
buffer_load_dwordx4 v212, s[40:43], s19 offen lds
s_add_u32 m0, s18, 27648
s_add_u32 s19, s26, 552960
buffer_load_dwordx4 v212, s[40:43], s19 offen lds
s_add_u32 m0, s18, 28672
s_add_u32 s19, s26, 573440
buffer_load_dwordx4 v212, s[40:43], s19 offen lds
s_add_u32 m0, s18, 29696
s_add_u32 s19, s26, 593920
buffer_load_dwordx4 v212, s[40:43], s19 offen lds
s_add_u32 m0, s18, 30720
s_add_u32 s19, s26, 614400
buffer_load_dwordx4 v212, s[40:43], s19 offen lds
s_add_u32 m0, s18, 31744
s_add_u32 s19, s26, 634880
buffer_load_dwordx4 v212, s[40:43], s19 offen lds
s_add_u32 m0, s18, 32768
s_add_u32 s19, s26, 655360
buffer_load_dwordx4 v212, s[40:43], s19 offen lds
s_add_u32 m0, s18, 33792
s_add_u32 s19, s26, 675840
buffer_load_dwordx4 v212, s[40:43], s19 offen lds
s_add_u32 m0, s18, 34816
s_add_u32 s19, s26, 696320
buffer_load_dwordx4 v212, s[40:43], s19 offen lds
s_add_u32 m0, s18, 35840
s_add_u32 s19, s26, 716800
buffer_load_dwordx4 v212, s[40:43], s19 offen lds
s_waitcnt vmcnt(32)
ds_read_b64_tr_b16 a[0:1], v213 offset:0
ds_read_b64_tr_b16 a[2:3], v213 offset:256
ds_read_b64_tr_b16 a[4:5], v213 offset:1024
ds_read_b64_tr_b16 a[6:7], v213 offset:1280
ds_read_b64_tr_b16 a[8:9], v213 offset:2048
ds_read_b64_tr_b16 a[10:11], v213 offset:2304
ds_read_b64_tr_b16 a[12:13], v213 offset:3072
ds_read_b64_tr_b16 a[14:15], v213 offset:3328
s_waitcnt lgkmcnt(0)
s_add_u32 m0, s18, 0
s_add_u32 s19, s26, 737280
buffer_load_dwordx4 v212, s[40:43], s19 offen lds
s_add_u32 m0, s18, 1024
s_add_u32 s19, s26, 757760
buffer_load_dwordx4 v212, s[40:43], s19 offen lds
s_add_u32 m0, s18, 2048
s_add_u32 s19, s26, 778240
buffer_load_dwordx4 v212, s[40:43], s19 offen lds
s_add_u32 m0, s18, 3072
s_add_u32 s19, s26, 798720
buffer_load_dwordx4 v212, s[40:43], s19 offen lds
s_waitcnt vmcnt(32)
ds_read_b64_tr_b16 a[16:17], v213 offset:4096
ds_read_b64_tr_b16 a[18:19], v213 offset:4352
ds_read_b64_tr_b16 a[20:21], v213 offset:5120
ds_read_b64_tr_b16 a[22:23], v213 offset:5376
ds_read_b64_tr_b16 a[24:25], v213 offset:6144
ds_read_b64_tr_b16 a[26:27], v213 offset:6400
ds_read_b64_tr_b16 a[28:29], v213 offset:7168
ds_read_b64_tr_b16 a[30:31], v213 offset:7424
s_waitcnt lgkmcnt(0)
s_add_u32 m0, s18, 4096
s_add_u32 s19, s26, 819200
buffer_load_dwordx4 v212, s[40:43], s19 offen lds
s_add_u32 m0, s18, 5120
s_add_u32 s19, s26, 839680
buffer_load_dwordx4 v212, s[40:43], s19 offen lds
s_add_u32 m0, s18, 6144
s_add_u32 s19, s26, 860160
buffer_load_dwordx4 v212, s[40:43], s19 offen lds
s_add_u32 m0, s18, 7168
s_add_u32 s19, s26, 880640
buffer_load_dwordx4 v212, s[40:43], s19 offen lds
s_waitcnt vmcnt(32)
ds_read_b64_tr_b16 a[32:33], v213 offset:8192
ds_read_b64_tr_b16 a[34:35], v213 offset:8448
ds_read_b64_tr_b16 a[36:37], v213 offset:9216
ds_read_b64_tr_b16 a[38:39], v213 offset:9472
ds_read_b64_tr_b16 a[40:41], v213 offset:10240
ds_read_b64_tr_b16 a[42:43], v213 offset:10496
ds_read_b64_tr_b16 a[44:45], v213 offset:11264
ds_read_b64_tr_b16 a[46:47], v213 offset:11520
s_waitcnt lgkmcnt(0)
s_add_u32 m0, s18, 8192
s_add_u32 s19, s26, 901120
buffer_load_dwordx4 v212, s[40:43], s19 offen lds
s_add_u32 m0, s18, 9216
s_add_u32 s19, s26, 921600
buffer_load_dwordx4 v212, s[40:43], s19 offen lds
s_add_u32 m0, s18, 10240
s_add_u32 s19, s26, 942080
buffer_load_dwordx4 v212, s[40:43], s19 offen lds
s_add_u32 m0, s18, 11264
s_add_u32 s19, s26, 962560
buffer_load_dwordx4 v212, s[40:43], s19 offen lds
s_waitcnt vmcnt(32)
ds_read_b64_tr_b16 a[48:49], v213 offset:12288
ds_read_b64_tr_b16 a[50:51], v213 offset:12544
ds_read_b64_tr_b16 a[52:53], v213 offset:13312
ds_read_b64_tr_b16 a[54:55], v213 offset:13568
ds_read_b64_tr_b16 a[56:57], v213 offset:14336
ds_read_b64_tr_b16 a[58:59], v213 offset:14592
ds_read_b64_tr_b16 a[60:61], v213 offset:15360
ds_read_b64_tr_b16 a[62:63], v213 offset:15616
s_waitcnt lgkmcnt(0)
s_add_u32 m0, s18, 12288
s_add_u32 s19, s26, 983040
buffer_load_dwordx4 v212, s[40:43], s19 offen lds
s_add_u32 m0, s18, 13312
s_add_u32 s19, s26, 1003520
buffer_load_dwordx4 v212, s[40:43], s19 offen lds
s_add_u32 m0, s18, 14336
s_add_u32 s19, s26, 1024000
buffer_load_dwordx4 v212, s[40:43], s19 offen lds
s_add_u32 m0, s18, 15360
s_add_u32 s19, s26, 1044480
buffer_load_dwordx4 v212, s[40:43], s19 offen lds
s_waitcnt vmcnt(32)
ds_read_b64_tr_b16 a[64:65], v213 offset:16384
ds_read_b64_tr_b16 a[66:67], v213 offset:16640
ds_read_b64_tr_b16 a[68:69], v213 offset:17408
ds_read_b64_tr_b16 a[70:71], v213 offset:17664
ds_read_b64_tr_b16 a[72:73], v213 offset:18432
ds_read_b64_tr_b16 a[74:75], v213 offset:18688
ds_read_b64_tr_b16 a[76:77], v213 offset:19456
ds_read_b64_tr_b16 a[78:79], v213 offset:19712
s_waitcnt lgkmcnt(0)
s_add_u32 m0, s18, 16384
s_add_u32 s19, s26, 1064960
buffer_load_dwordx4 v212, s[40:43], s19 offen lds
s_add_u32 m0, s18, 17408
s_add_u32 s19, s26, 1085440
buffer_load_dwordx4 v212, s[40:43], s19 offen lds
s_add_u32 m0, s18, 18432
s_add_u32 s19, s26, 1105920
buffer_load_dwordx4 v212, s[40:43], s19 offen lds
s_add_u32 m0, s18, 19456
s_add_u32 s19, s26, 1126400
buffer_load_dwordx4 v212, s[40:43], s19 offen lds
s_waitcnt vmcnt(32)
ds_read_b64_tr_b16 a[80:81], v213 offset:20480
ds_read_b64_tr_b16 a[82:83], v213 offset:20736
ds_read_b64_tr_b16 a[84:85], v213 offset:21504
ds_read_b64_tr_b16 a[86:87], v213 offset:21760
ds_read_b64_tr_b16 a[88:89], v213 offset:22528
ds_read_b64_tr_b16 a[90:91], v213 offset:22784
ds_read_b64_tr_b16 a[92:93], v213 offset:23552
ds_read_b64_tr_b16 a[94:95], v213 offset:23808
s_waitcnt lgkmcnt(0)
s_add_u32 m0, s18, 20480
s_add_u32 s19, s26, 1146880
buffer_load_dwordx4 v212, s[40:43], s19 offen lds
s_add_u32 m0, s18, 21504
s_add_u32 s19, s26, 1167360
buffer_load_dwordx4 v212, s[40:43], s19 offen lds
s_add_u32 m0, s18, 22528
s_add_u32 s19, s26, 1187840
buffer_load_dwordx4 v212, s[40:43], s19 offen lds
s_add_u32 m0, s18, 23552
s_add_u32 s19, s26, 1208320
buffer_load_dwordx4 v212, s[40:43], s19 offen lds
s_waitcnt vmcnt(32)
ds_read_b64_tr_b16 a[96:97], v213 offset:24576
ds_read_b64_tr_b16 a[98:99], v213 offset:24832
ds_read_b64_tr_b16 a[100:101], v213 offset:25600
ds_read_b64_tr_b16 a[102:103], v213 offset:25856
ds_read_b64_tr_b16 a[104:105], v213 offset:26624
ds_read_b64_tr_b16 a[106:107], v213 offset:26880
ds_read_b64_tr_b16 a[108:109], v213 offset:27648
ds_read_b64_tr_b16 a[110:111], v213 offset:27904
s_waitcnt lgkmcnt(0)
s_add_u32 m0, s18, 24576
s_add_u32 s19, s26, 1228800
buffer_load_dwordx4 v212, s[40:43], s19 offen lds
s_add_u32 m0, s18, 25600
s_add_u32 s19, s26, 1249280
buffer_load_dwordx4 v212, s[40:43], s19 offen lds
s_add_u32 m0, s18, 26624
s_add_u32 s19, s26, 1269760
buffer_load_dwordx4 v212, s[40:43], s19 offen lds
s_add_u32 m0, s18, 27648
s_add_u32 s19, s26, 1290240
buffer_load_dwordx4 v212, s[40:43], s19 offen lds
s_waitcnt vmcnt(32)
ds_read_b64_tr_b16 a[112:113], v213 offset:28672
ds_read_b64_tr_b16 a[114:115], v213 offset:28928
ds_read_b64_tr_b16 a[116:117], v213 offset:29696
ds_read_b64_tr_b16 a[118:119], v213 offset:29952
ds_read_b64_tr_b16 a[120:121], v213 offset:30720
ds_read_b64_tr_b16 a[122:123], v213 offset:30976
ds_read_b64_tr_b16 a[124:125], v213 offset:31744
ds_read_b64_tr_b16 a[126:127], v213 offset:32000
s_waitcnt vmcnt(28)
ds_read_b64_tr_b16 a[128:129], v213 offset:32768
ds_read_b64_tr_b16 a[130:131], v213 offset:33024
ds_read_b64_tr_b16 a[132:133], v213 offset:33792
ds_read_b64_tr_b16 a[134:135], v213 offset:34048
ds_read_b64_tr_b16 a[136:137], v213 offset:34816
ds_read_b64_tr_b16 a[138:139], v213 offset:35072
ds_read_b64_tr_b16 a[140:141], v213 offset:35840
ds_read_b64_tr_b16 a[142:143], v213 offset:36096
s_waitcnt vmcnt(24)
ds_read_b64_tr_b16 a[144:145], v213 offset:0
ds_read_b64_tr_b16 a[146:147], v213 offset:256
ds_read_b64_tr_b16 a[148:149], v213 offset:1024
ds_read_b64_tr_b16 a[150:151], v213 offset:1280
ds_read_b64_tr_b16 a[152:153], v213 offset:2048
ds_read_b64_tr_b16 a[154:155], v213 offset:2304
ds_read_b64_tr_b16 a[156:157], v213 offset:3072
ds_read_b64_tr_b16 a[158:159], v213 offset:3328
s_waitcnt vmcnt(20)
ds_read_b64_tr_b16 a[160:161], v213 offset:4096
ds_read_b64_tr_b16 a[162:163], v213 offset:4352
ds_read_b64_tr_b16 a[164:165], v213 offset:5120
ds_read_b64_tr_b16 a[166:167], v213 offset:5376
ds_read_b64_tr_b16 a[168:169], v213 offset:6144
ds_read_b64_tr_b16 a[170:171], v213 offset:6400
ds_read_b64_tr_b16 a[172:173], v213 offset:7168
ds_read_b64_tr_b16 a[174:175], v213 offset:7424
s_waitcnt vmcnt(16)
ds_read_b64_tr_b16 a[176:177], v213 offset:8192
ds_read_b64_tr_b16 a[178:179], v213 offset:8448
ds_read_b64_tr_b16 a[180:181], v213 offset:9216
ds_read_b64_tr_b16 a[182:183], v213 offset:9472
ds_read_b64_tr_b16 a[184:185], v213 offset:10240
ds_read_b64_tr_b16 a[186:187], v213 offset:10496
ds_read_b64_tr_b16 a[188:189], v213 offset:11264
ds_read_b64_tr_b16 a[190:191], v213 offset:11520
s_waitcnt vmcnt(12)
ds_read_b64_tr_b16 a[192:193], v213 offset:12288
ds_read_b64_tr_b16 a[194:195], v213 offset:12544
ds_read_b64_tr_b16 a[196:197], v213 offset:13312
ds_read_b64_tr_b16 a[198:199], v213 offset:13568
ds_read_b64_tr_b16 a[200:201], v213 offset:14336
ds_read_b64_tr_b16 a[202:203], v213 offset:14592
ds_read_b64_tr_b16 a[204:205], v213 offset:15360
ds_read_b64_tr_b16 a[206:207], v213 offset:15616
s_waitcnt vmcnt(8)
ds_read_b64_tr_b16 a[208:209], v213 offset:16384
ds_read_b64_tr_b16 a[210:211], v213 offset:16640
ds_read_b64_tr_b16 a[212:213], v213 offset:17408
ds_read_b64_tr_b16 a[214:215], v213 offset:17664
ds_read_b64_tr_b16 a[216:217], v213 offset:18432
ds_read_b64_tr_b16 a[218:219], v213 offset:18688
ds_read_b64_tr_b16 a[220:221], v213 offset:19456
ds_read_b64_tr_b16 a[222:223], v213 offset:19712
s_waitcnt vmcnt(4)
ds_read_b64_tr_b16 a[224:225], v213 offset:20480
ds_read_b64_tr_b16 a[226:227], v213 offset:20736
ds_read_b64_tr_b16 a[228:229], v213 offset:21504
ds_read_b64_tr_b16 a[230:231], v213 offset:21760
ds_read_b64_tr_b16 a[232:233], v213 offset:22528
ds_read_b64_tr_b16 a[234:235], v213 offset:22784
ds_read_b64_tr_b16 a[236:237], v213 offset:23552
ds_read_b64_tr_b16 a[238:239], v213 offset:23808
s_waitcnt vmcnt(0)
ds_read_b64_tr_b16 a[240:241], v213 offset:24576
ds_read_b64_tr_b16 a[242:243], v213 offset:24832
ds_read_b64_tr_b16 a[244:245], v213 offset:25600
ds_read_b64_tr_b16 a[246:247], v213 offset:25856
ds_read_b64_tr_b16 a[248:249], v213 offset:26624
ds_read_b64_tr_b16 a[250:251], v213 offset:26880
ds_read_b64_tr_b16 a[252:253], v213 offset:27648
ds_read_b64_tr_b16 a[254:255], v213 offset:27904
s_waitcnt lgkmcnt(0)
s_barrier
ww_68:
s_load_dwordx2 s[56:57], s[0:1], 80
s_mov_b32 s58, 2621440
s_mov_b32 s59, 0x20000
s_waitcnt lgkmcnt(0)
s_lshl_b32 s18, s13, 12
v_add_u32 v13, s18, v0
s_lshl_b32 s18, s13, 11
v_add_u32 v14, s18, v0
s_add_u32 s53, s30, 56
s_cmp_eq_u32 s30, 3
s_cselect_b32 s30, s53, s30
ws_69:
s_lshl_b32 s18, s16, 6
s_add_u32 s18, s18, s30
s_lshl_b32 s26, s18, 18
s_lshl_b32 s19, s13, 16
s_add_u32 s26, s26, s19
s_add_u32 s26, s26, 127926272
s_add_u32 s38, s18, 1
s_and_b32 s18, s18, 7
s_lshl_b32 s18, s18, 12
s_add_u32 s18, s18, s37
s_add_u32 s28, s18, 11632640
s_mul_i32 s27, s30, 40960
s_and_b32 s18, s13, 1
s_lshl_b32 s19, s52, 1
s_add_u32 s29, s18, s19
v_lshlrev_b32 v11, 3, v0
v_min_u32 v11, 896, v11
s_mov_b32 s17, 0
poll_73:
buffer_load_dword v8, v11, s[4:7], s28 offen sc1
s_add_u32 s17, s17, 1
s_cmp_gt_u32 s17, 262144
s_cbranch_scc1 L_fail
s_waitcnt vmcnt(0)
v_cmp_gt_u32 vcc, s38, v8
s_cbranch_vccz polld_74
s_sleep 2
s_branch poll_73
polld_74:
s_lshl_b32 s18, s29, 10
s_add_u32 s18, s18, s27
s_mul_i32 s19, s16, 6291456
s_add_u32 s18, s18, s19
s_add_u32 s18, s18, 88080384
s_add_u32 s19, s26, 0
buffer_load_dwordx4 v[16:19], v0, s[4:7], s19 offen offset:0 sc1
buffer_load_dwordx4 v[20:23], v0, s[4:7], s19 offen offset:1024 sc1
buffer_load_dwordx4 v[24:27], v0, s[4:7], s19 offen offset:2048 sc1
buffer_load_dwordx4 v[28:31], v0, s[4:7], s19 offen offset:3072 sc1
s_add_u32 s19, s26, 4096
buffer_load_dwordx4 v[32:35], v0, s[4:7], s19 offen offset:0 sc1
buffer_load_dwordx4 v[36:39], v0, s[4:7], s19 offen offset:1024 sc1
buffer_load_dwordx4 v[40:43], v0, s[4:7], s19 offen offset:2048 sc1
buffer_load_dwordx4 v[44:47], v0, s[4:7], s19 offen offset:3072 sc1
s_add_u32 s19, s26, 8192
buffer_load_dwordx4 v[48:51], v0, s[4:7], s19 offen offset:0 sc1
buffer_load_dwordx4 v[52:55], v0, s[4:7], s19 offen offset:1024 sc1
buffer_load_dwordx4 v[56:59], v0, s[4:7], s19 offen offset:2048 sc1
buffer_load_dwordx4 v[60:63], v0, s[4:7], s19 offen offset:3072 sc1
s_add_u32 s19, s26, 12288
buffer_load_dwordx4 v[64:67], v0, s[4:7], s19 offen offset:0 sc1
buffer_load_dwordx4 v[68:71], v0, s[4:7], s19 offen offset:1024 sc1
buffer_load_dwordx4 v[72:75], v0, s[4:7], s19 offen offset:2048 sc1
buffer_load_dwordx4 v[76:79], v0, s[4:7], s19 offen offset:3072 sc1
s_add_u32 s19, s26, 16384
buffer_load_dwordx4 v[80:83], v0, s[4:7], s19 offen offset:0 sc1
buffer_load_dwordx4 v[84:87], v0, s[4:7], s19 offen offset:1024 sc1
buffer_load_dwordx4 v[88:91], v0, s[4:7], s19 offen offset:2048 sc1
buffer_load_dwordx4 v[92:95], v0, s[4:7], s19 offen offset:3072 sc1
s_add_u32 s19, s26, 20480
buffer_load_dwordx4 v[96:99], v0, s[4:7], s19 offen offset:0 sc1
buffer_load_dwordx4 v[100:103], v0, s[4:7], s19 offen offset:1024 sc1
buffer_load_dwordx4 v[104:107], v0, s[4:7], s19 offen offset:2048 sc1
buffer_load_dwordx4 v[108:111], v0, s[4:7], s19 offen offset:3072 sc1
s_add_u32 s19, s26, 24576
buffer_load_dwordx4 v[112:115], v0, s[4:7], s19 offen offset:0 sc1
buffer_load_dwordx4 v[116:119], v0, s[4:7], s19 offen offset:1024 sc1
buffer_load_dwordx4 v[120:123], v0, s[4:7], s19 offen offset:2048 sc1
buffer_load_dwordx4 v[124:127], v0, s[4:7], s19 offen offset:3072 sc1
s_add_u32 s19, s26, 28672
buffer_load_dwordx4 v[128:131], v0, s[4:7], s19 offen offset:0 sc1
buffer_load_dwordx4 v[132:135], v0, s[4:7], s19 offen offset:1024 sc1
buffer_load_dwordx4 v[136:139], v0, s[4:7], s19 offen offset:2048 sc1
buffer_load_dwordx4 v[140:143], v0, s[4:7], s19 offen offset:3072 sc1
s_add_u32 s19, s26, 32768
buffer_load_dwordx4 v[144:147], v0, s[4:7], s19 offen offset:0 sc1
buffer_load_dwordx4 v[148:151], v0, s[4:7], s19 offen offset:1024 sc1
buffer_load_dwordx4 v[152:155], v0, s[4:7], s19 offen offset:2048 sc1
buffer_load_dwordx4 v[156:159], v0, s[4:7], s19 offen offset:3072 sc1
s_add_u32 s19, s26, 36864
buffer_load_dwordx4 v[160:163], v0, s[4:7], s19 offen offset:0 sc1
buffer_load_dwordx4 v[164:167], v0, s[4:7], s19 offen offset:1024 sc1
buffer_load_dwordx4 v[168:171], v0, s[4:7], s19 offen offset:2048 sc1
buffer_load_dwordx4 v[172:175], v0, s[4:7], s19 offen offset:3072 sc1
s_add_u32 s19, s26, 40960
buffer_load_dwordx4 v[176:179], v0, s[4:7], s19 offen offset:0 sc1
buffer_load_dwordx4 v[180:183], v0, s[4:7], s19 offen offset:1024 sc1
buffer_load_dwordx4 v[184:187], v0, s[4:7], s19 offen offset:2048 sc1
buffer_load_dwordx4 v[188:191], v0, s[4:7], s19 offen offset:3072 sc1
s_waitcnt vmcnt(43)
v_mfma_f32_32x32x16_bf16 v[192:207], a[0:3], v[16:19], 0
s_add_u32 s19, s26, 45056
buffer_load_dwordx4 v[16:19], v0, s[4:7], s19 offen offset:0 sc1
s_waitcnt vmcnt(43)
v_mfma_f32_32x32x16_bf16 v[192:207], a[4:7], v[20:23], v[192:207]
buffer_load_dwordx4 v[20:23], v0, s[4:7], s19 offen offset:1024 sc1
s_waitcnt vmcnt(43)
v_mfma_f32_32x32x16_bf16 v[192:207], a[8:11], v[24:27], v[192:207]
buffer_load_dwordx4 v[24:27], v0, s[4:7], s19 offen offset:2048 sc1
s_waitcnt vmcnt(43)
v_mfma_f32_32x32x16_bf16 v[192:207], a[12:15], v[28:31], v[192:207]
buffer_load_dwordx4 v[28:31], v0, s[4:7], s19 offen offset:3072 sc1
s_waitcnt vmcnt(43)
v_mfma_f32_32x32x16_bf16 v[192:207], a[16:19], v[32:35], v[192:207]
s_add_u32 s19, s26, 49152
buffer_load_dwordx4 v[32:35], v0, s[4:7], s19 offen offset:0 sc1
s_waitcnt vmcnt(43)
v_mfma_f32_32x32x16_bf16 v[192:207], a[20:23], v[36:39], v[192:207]
buffer_load_dwordx4 v[36:39], v0, s[4:7], s19 offen offset:1024 sc1
s_waitcnt vmcnt(43)
v_mfma_f32_32x32x16_bf16 v[192:207], a[24:27], v[40:43], v[192:207]
buffer_load_dwordx4 v[40:43], v0, s[4:7], s19 offen offset:2048 sc1
s_waitcnt vmcnt(43)
v_mfma_f32_32x32x16_bf16 v[192:207], a[28:31], v[44:47], v[192:207]
buffer_load_dwordx4 v[44:47], v0, s[4:7], s19 offen offset:3072 sc1
s_waitcnt vmcnt(43)
v_mfma_f32_32x32x16_bf16 v[192:207], a[32:35], v[48:51], v[192:207]
s_add_u32 s19, s26, 53248
buffer_load_dwordx4 v[48:51], v0, s[4:7], s19 offen offset:0 sc1
s_waitcnt vmcnt(43)
v_mfma_f32_32x32x16_bf16 v[192:207], a[36:39], v[52:55], v[192:207]
buffer_load_dwordx4 v[52:55], v0, s[4:7], s19 offen offset:1024 sc1
s_waitcnt vmcnt(43)
v_mfma_f32_32x32x16_bf16 v[192:207], a[40:43], v[56:59], v[192:207]
buffer_load_dwordx4 v[56:59], v0, s[4:7], s19 offen offset:2048 sc1
s_waitcnt vmcnt(43)
v_mfma_f32_32x32x16_bf16 v[192:207], a[44:47], v[60:63], v[192:207]
buffer_load_dwordx4 v[60:63], v0, s[4:7], s19 offen offset:3072 sc1
s_waitcnt vmcnt(43)
v_mfma_f32_32x32x16_bf16 v[192:207], a[48:51], v[64:67], v[192:207]
s_add_u32 s19, s26, 57344
buffer_load_dwordx4 v[64:67], v0, s[4:7], s19 offen offset:0 sc1
s_waitcnt vmcnt(43)
v_mfma_f32_32x32x16_bf16 v[192:207], a[52:55], v[68:71], v[192:207]
buffer_load_dwordx4 v[68:71], v0, s[4:7], s19 offen offset:1024 sc1
s_waitcnt vmcnt(43)
v_mfma_f32_32x32x16_bf16 v[192:207], a[56:59], v[72:75], v[192:207]
buffer_load_dwordx4 v[72:75], v0, s[4:7], s19 offen offset:2048 sc1
s_waitcnt vmcnt(43)
v_mfma_f32_32x32x16_bf16 v[192:207], a[60:63], v[76:79], v[192:207]
buffer_load_dwordx4 v[76:79], v0, s[4:7], s19 offen offset:3072 sc1
s_waitcnt vmcnt(43)
v_mfma_f32_32x32x16_bf16 v[192:207], a[64:67], v[80:83], v[192:207]
s_add_u32 s19, s26, 61440
buffer_load_dwordx4 v[80:83], v0, s[4:7], s19 offen offset:0 sc1
s_waitcnt vmcnt(43)
v_mfma_f32_32x32x16_bf16 v[192:207], a[68:71], v[84:87], v[192:207]
buffer_load_dwordx4 v[84:87], v0, s[4:7], s19 offen offset:1024 sc1
s_waitcnt vmcnt(43)
v_mfma_f32_32x32x16_bf16 v[192:207], a[72:75], v[88:91], v[192:207]
buffer_load_dwordx4 v[88:91], v0, s[4:7], s19 offen offset:2048 sc1
s_waitcnt vmcnt(43)
v_mfma_f32_32x32x16_bf16 v[192:207], a[76:79], v[92:95], v[192:207]
buffer_load_dwordx4 v[92:95], v0, s[4:7], s19 offen offset:3072 sc1
s_waitcnt vmcnt(43)
v_mfma_f32_32x32x16_bf16 v[192:207], a[80:83], v[96:99], v[192:207]
buffer_load_dwordx4 v[208:211], v0, s[4:7], s18 offen sc1
s_waitcnt vmcnt(43)
v_mfma_f32_32x32x16_bf16 v[192:207], a[84:87], v[100:103], v[192:207]
s_waitcnt vmcnt(42)
v_mfma_f32_32x32x16_bf16 v[192:207], a[88:91], v[104:107], v[192:207]
s_waitcnt vmcnt(41)
v_mfma_f32_32x32x16_bf16 v[192:207], a[92:95], v[108:111], v[192:207]
s_waitcnt vmcnt(40)
v_mfma_f32_32x32x16_bf16 v[192:207], a[96:99], v[112:115], v[192:207]
s_waitcnt vmcnt(39)
v_mfma_f32_32x32x16_bf16 v[192:207], a[100:103], v[116:119], v[192:207]
s_waitcnt vmcnt(38)
v_mfma_f32_32x32x16_bf16 v[192:207], a[104:107], v[120:123], v[192:207]
s_waitcnt vmcnt(37)
v_mfma_f32_32x32x16_bf16 v[192:207], a[108:111], v[124:127], v[192:207]
s_waitcnt vmcnt(36)
v_mfma_f32_32x32x16_bf16 v[192:207], a[112:115], v[128:131], v[192:207]
s_waitcnt vmcnt(35)
v_mfma_f32_32x32x16_bf16 v[192:207], a[116:119], v[132:135], v[192:207]
s_waitcnt vmcnt(34)
v_mfma_f32_32x32x16_bf16 v[192:207], a[120:123], v[136:139], v[192:207]
s_waitcnt vmcnt(33)
v_mfma_f32_32x32x16_bf16 v[192:207], a[124:127], v[140:143], v[192:207]
s_waitcnt vmcnt(32)
v_mfma_f32_32x32x16_bf16 v[192:207], a[128:131], v[144:147], v[192:207]
s_waitcnt vmcnt(31)
v_mfma_f32_32x32x16_bf16 v[192:207], a[132:135], v[148:151], v[192:207]
s_waitcnt vmcnt(30)
v_mfma_f32_32x32x16_bf16 v[192:207], a[136:139], v[152:155], v[192:207]
s_waitcnt vmcnt(29)
v_mfma_f32_32x32x16_bf16 v[192:207], a[140:143], v[156:159], v[192:207]
s_waitcnt vmcnt(28)
v_mfma_f32_32x32x16_bf16 v[192:207], a[144:147], v[160:163], v[192:207]
s_waitcnt vmcnt(27)
v_mfma_f32_32x32x16_bf16 v[192:207], a[148:151], v[164:167], v[192:207]
s_waitcnt vmcnt(26)
v_mfma_f32_32x32x16_bf16 v[192:207], a[152:155], v[168:171], v[192:207]
s_waitcnt vmcnt(25)
v_mfma_f32_32x32x16_bf16 v[192:207], a[156:159], v[172:175], v[192:207]
s_waitcnt vmcnt(24)
v_mfma_f32_32x32x16_bf16 v[192:207], a[160:163], v[176:179], v[192:207]
s_waitcnt vmcnt(23)
v_mfma_f32_32x32x16_bf16 v[192:207], a[164:167], v[180:183], v[192:207]
s_waitcnt vmcnt(22)
v_mfma_f32_32x32x16_bf16 v[192:207], a[168:171], v[184:187], v[192:207]
s_waitcnt vmcnt(21)
v_mfma_f32_32x32x16_bf16 v[192:207], a[172:175], v[188:191], v[192:207]
s_waitcnt vmcnt(20)
v_mfma_f32_32x32x16_bf16 v[192:207], a[176:179], v[16:19], v[192:207]
s_waitcnt vmcnt(19)
v_mfma_f32_32x32x16_bf16 v[192:207], a[180:183], v[20:23], v[192:207]
s_waitcnt vmcnt(18)
v_mfma_f32_32x32x16_bf16 v[192:207], a[184:187], v[24:27], v[192:207]
s_waitcnt vmcnt(17)
v_mfma_f32_32x32x16_bf16 v[192:207], a[188:191], v[28:31], v[192:207]
s_waitcnt vmcnt(16)
v_mfma_f32_32x32x16_bf16 v[192:207], a[192:195], v[32:35], v[192:207]
s_waitcnt vmcnt(15)
v_mfma_f32_32x32x16_bf16 v[192:207], a[196:199], v[36:39], v[192:207]
s_waitcnt vmcnt(14)
v_mfma_f32_32x32x16_bf16 v[192:207], a[200:203], v[40:43], v[192:207]
s_waitcnt vmcnt(13)
v_mfma_f32_32x32x16_bf16 v[192:207], a[204:207], v[44:47], v[192:207]
s_waitcnt vmcnt(12)
v_mfma_f32_32x32x16_bf16 v[192:207], a[208:211], v[48:51], v[192:207]
s_waitcnt vmcnt(11)
v_mfma_f32_32x32x16_bf16 v[192:207], a[212:215], v[52:55], v[192:207]
s_waitcnt vmcnt(10)
v_mfma_f32_32x32x16_bf16 v[192:207], a[216:219], v[56:59], v[192:207]
s_waitcnt vmcnt(9)
v_mfma_f32_32x32x16_bf16 v[192:207], a[220:223], v[60:63], v[192:207]
s_waitcnt vmcnt(8)
v_mfma_f32_32x32x16_bf16 v[192:207], a[224:227], v[64:67], v[192:207]
s_waitcnt vmcnt(7)
v_mfma_f32_32x32x16_bf16 v[192:207], a[228:231], v[68:71], v[192:207]
s_waitcnt vmcnt(6)
v_mfma_f32_32x32x16_bf16 v[192:207], a[232:235], v[72:75], v[192:207]
s_waitcnt vmcnt(5)
v_mfma_f32_32x32x16_bf16 v[192:207], a[236:239], v[76:79], v[192:207]
s_waitcnt vmcnt(4)
v_mfma_f32_32x32x16_bf16 v[192:207], a[240:243], v[80:83], v[192:207]
s_waitcnt vmcnt(3)
v_mfma_f32_32x32x16_bf16 v[192:207], a[244:247], v[84:87], v[192:207]
s_waitcnt vmcnt(2)
v_mfma_f32_32x32x16_bf16 v[192:207], a[248:251], v[88:91], v[192:207]
s_waitcnt vmcnt(1)
v_mfma_f32_32x32x16_bf16 v[192:207], a[252:255], v[92:95], v[192:207]
s_nop 11
ds_write_b128 v13, v[192:195] offset:0
ds_write_b128 v13, v[196:199] offset:1024
ds_write_b128 v13, v[200:203] offset:2048
ds_write_b128 v13, v[204:207] offset:3072
s_waitcnt lgkmcnt(0)
s_barrier
s_cmp_ge_u32 s13, 2
s_cbranch_scc1 wn_70
ds_read_b128 v[16:19], v14 offset:0
ds_read_b128 v[20:23], v14 offset:1024
ds_read_b128 v[24:27], v14 offset:4096
ds_read_b128 v[28:31], v14 offset:5120
ds_read_b128 v[32:35], v14 offset:8192
ds_read_b128 v[36:39], v14 offset:9216
ds_read_b128 v[40:43], v14 offset:12288
ds_read_b128 v[44:47], v14 offset:13312
s_waitcnt vmcnt(0)
v_lshlrev_b32 v192, 16, v208
v_and_b32 v193, 0xffff0000, v208
v_lshlrev_b32 v194, 16, v209
v_and_b32 v195, 0xffff0000, v209
v_lshlrev_b32 v196, 16, v210
v_and_b32 v197, 0xffff0000, v210
v_lshlrev_b32 v198, 16, v211
v_and_b32 v199, 0xffff0000, v211
s_waitcnt lgkmcnt(5)
v_add_f32 v16, v16, v24
s_waitcnt lgkmcnt(1)
v_add_f32 v32, v32, v40
v_add_f32 v17, v17, v25
v_add_f32 v33, v33, v41
v_add_f32 v18, v18, v26
v_add_f32 v34, v34, v42
v_add_f32 v19, v19, v27
v_add_f32 v35, v35, v43
v_add_f32 v20, v20, v28
s_waitcnt lgkmcnt(0)
v_add_f32 v36, v36, v44
v_add_f32 v21, v21, v29
v_add_f32 v37, v37, v45
v_add_f32 v22, v22, v30
v_add_f32 v38, v38, v46
v_add_f32 v23, v23, v31
v_add_f32 v39, v39, v47
v_add_f32 v16, v16, v32
v_add_f32 v17, v17, v33
v_add_f32 v18, v18, v34
v_add_f32 v19, v19, v35
v_add_f32 v20, v20, v36
v_add_f32 v21, v21, v37
v_add_f32 v22, v22, v38
v_add_f32 v23, v23, v39
v_add_f32 v16, v16, v192
v_add_f32 v17, v17, v193
v_add_f32 v18, v18, v194
v_add_f32 v19, v19, v195
v_add_f32 v20, v20, v196
v_add_f32 v21, v21, v197
v_add_f32 v22, v22, v198
v_add_f32 v23, v23, v199
v_cvt_pk_bf16_f32 v208, v16, v17
v_cvt_pk_bf16_f32 v209, v18, v19
v_cvt_pk_bf16_f32 v210, v20, v21
v_cvt_pk_bf16_f32 v211, v22, v23
s_cmp_lg_u32 s16, 0
s_cbranch_scc1 wo_71
s_add_u32 s18, s18, 3145728
buffer_store_dwordx4 v[208:211], v0, s[4:7], s18 offen sc1
s_branch wn_70
wo_71:
s_lshl_b32 s18, s29, 5
s_add_u32 s18, s18, s27
buffer_store_dwordx4 v[208:211], v5, s[56:59], s18 offen
wn_70:
s_lshl_b32 s18, s39, 7
s_add_u32 s18, s18, 11550720
s_cmp_eq_u32 s13, 0
s_cselect_b32 s22, s18, s6
s_mov_b32 s23, s38
s_waitcnt vmcnt(0)
s_barrier
v_mov_b32 v3, s23
s_mov_b64 exec, 1
buffer_store_dword v3, off, s[4:7], s22 sc1
s_mov_b64 exec, -1
s_mov_b32 s22, s6
s_add_u32 s18, s30, 3
s_cmp_lt_u32 s18, 56
s_cselect_b32 s18, s18, s53
s_add_u32 s19, s30, 4
s_cmp_lt_u32 s30, 56
s_cselect_b32 s30, s18, s19
s_cmp_lt_u32 s30, 64
s_cbranch_scc1 ws_69
s_branch aend_58
p1b_57:
s_cmp_eq_u32 s39, 144
s_cbranch_scc1 aend_58
s_cmp_lg_u32 s16, 0
s_cbranch_scc1 aend_58
s_sub_u32 s30, s50, 29
s_sub_u32 s51, s39, 145
s_lshl_b32 s18, s34, 7
s_lshl_b32 s19, s13, 5
s_add_u32 s18, s18, s19
s_mov_b32 s19, 0x3acccccd
v_bfe_u32 v198, v0, 4, 5
v_lshrrev_b32 v193, 9, v0
v_add_u32 v198, s18, v198
v_and_b32 v197, 1, v198
v_mul_u32_u24 v197, 160, v197
v_lshrrev_b32 v196, 1, v198
v_add_u32 v196, 1, v196
v_lshlrev_b32 v193, 3, v193
v_mad_u32_u24 v197, v193, v196, v197
v_mad_u32_u24 v192, v196, 16, 0
v_cvt_f32_u32 v192, v192
v_mul_f32 v198, s19, v192
v_rndne_f32 v198, v198
v_fmac_f32 v192, 0xc4200000, v198
v_mul_f32 v192, s19, v192
v_cos_f32 v192, v192
s_nop 0
v_add_f32 v192, v192, v192
v_mad_u32_u24 v194, v196, 1, 0
v_cvt_f32_u32 v194, v194
v_mul_f32 v198, s19, v194
v_rndne_f32 v198, v198
v_fmac_f32 v194, 0xc4200000, v198
v_mul_f32 v194, s19, v194
v_cos_f32 v194, v194
s_nop 0
v_add_f32 v194, v194, v194
v_mad_u32_u24 v179, v196, 3, v197
v_cvt_f32_u32 v179, v179
v_mul_f32 v198, s19, v179
v_rndne_f32 v198, v198
v_fmac_f32 v179, 0xc4200000, v198
v_mul_f32 v179, s19, v179
v_cos_f32 v179, v179
v_mad_u32_u24 v180, v196, 4, v197
v_cvt_f32_u32 v180, v180
v_mul_f32 v198, s19, v180
v_rndne_f32 v198, v198
v_fmac_f32 v180, 0xc4200000, v198
v_mul_f32 v180, s19, v180
v_cos_f32 v180, v180
s_nop 0
v_fma_f32 v181, v194, v180, -v179
v_fma_f32 v178, v194, v179, -v180
v_fma_f32 v182, v194, v181, -v180
v_fma_f32 v177, v194, v178, -v179
v_fma_f32 v183, v194, v182, -v181
v_fma_f32 v176, v194, v177, -v178
v_cvt_pk_bf16_f32 v16, v176, v177
v_cvt_pk_bf16_f32 v17, v178, v179
v_cvt_pk_bf16_f32 v18, v180, v181
v_cvt_pk_bf16_f32 v19, v182, v183
v_mad_u32_u24 v187, v196, 19, v197
v_cvt_f32_u32 v187, v187
v_mul_f32 v198, s19, v187
v_rndne_f32 v198, v198
v_fmac_f32 v187, 0xc4200000, v198
v_mul_f32 v187, s19, v187
v_cos_f32 v187, v187
v_mad_u32_u24 v188, v196, 20, v197
v_cvt_f32_u32 v188, v188
v_mul_f32 v198, s19, v188
v_rndne_f32 v198, v198
v_fmac_f32 v188, 0xc4200000, v198
v_mul_f32 v188, s19, v188
v_cos_f32 v188, v188
s_nop 0
v_fma_f32 v189, v194, v188, -v187
v_fma_f32 v186, v194, v187, -v188
v_fma_f32 v190, v194, v189, -v188
v_fma_f32 v185, v194, v186, -v187
v_fma_f32 v191, v194, v190, -v189
v_fma_f32 v184, v194, v185, -v186
v_cvt_pk_bf16_f32 v20, v184, v185
v_cvt_pk_bf16_f32 v21, v186, v187
v_cvt_pk_bf16_f32 v22, v188, v189
v_cvt_pk_bf16_f32 v23, v190, v191
v_pk_fma_f32 v[176:177], v[192:193], v[184:185], v[176:177] op_sel_hi:[0,1,1] neg_lo:[0,0,1] neg_hi:[0,0,1]
v_pk_fma_f32 v[178:179], v[192:193], v[186:187], v[178:179] op_sel_hi:[0,1,1] neg_lo:[0,0,1] neg_hi:[0,0,1]
v_pk_fma_f32 v[180:181], v[192:193], v[188:189], v[180:181] op_sel_hi:[0,1,1] neg_lo:[0,0,1] neg_hi:[0,0,1]
v_pk_fma_f32 v[182:183], v[192:193], v[190:191], v[182:183] op_sel_hi:[0,1,1] neg_lo:[0,0,1] neg_hi:[0,0,1]
v_cvt_pk_bf16_f32 v24, v176, v177
v_cvt_pk_bf16_f32 v25, v178, v179
v_cvt_pk_bf16_f32 v26, v180, v181
v_cvt_pk_bf16_f32 v27, v182, v183
v_pk_fma_f32 v[184:185], v[192:193], v[176:177], v[184:185] op_sel_hi:[0,1,1] neg_lo:[0,0,1] neg_hi:[0,0,1]
v_pk_fma_f32 v[186:187], v[192:193], v[178:179], v[186:187] op_sel_hi:[0,1,1] neg_lo:[0,0,1] neg_hi:[0,0,1]
v_pk_fma_f32 v[188:189], v[192:193], v[180:181], v[188:189] op_sel_hi:[0,1,1] neg_lo:[0,0,1] neg_hi:[0,0,1]
v_pk_fma_f32 v[190:191], v[192:193], v[182:183], v[190:191] op_sel_hi:[0,1,1] neg_lo:[0,0,1] neg_hi:[0,0,1]
v_cvt_pk_bf16_f32 v28, v184, v185
v_cvt_pk_bf16_f32 v29, v186, v187
v_cvt_pk_bf16_f32 v30, v188, v189
v_cvt_pk_bf16_f32 v31, v190, v191
v_pk_fma_f32 v[176:177], v[192:193], v[184:185], v[176:177] op_sel_hi:[0,1,1] neg_lo:[0,0,1] neg_hi:[0,0,1]
v_pk_fma_f32 v[178:179], v[192:193], v[186:187], v[178:179] op_sel_hi:[0,1,1] neg_lo:[0,0,1] neg_hi:[0,0,1]
v_pk_fma_f32 v[180:181], v[192:193], v[188:189], v[180:181] op_sel_hi:[0,1,1] neg_lo:[0,0,1] neg_hi:[0,0,1]
v_pk_fma_f32 v[182:183], v[192:193], v[190:191], v[182:183] op_sel_hi:[0,1,1] neg_lo:[0,0,1] neg_hi:[0,0,1]
v_cvt_pk_bf16_f32 v32, v176, v177
v_cvt_pk_bf16_f32 v33, v178, v179
v_cvt_pk_bf16_f32 v34, v180, v181
v_cvt_pk_bf16_f32 v35, v182, v183
v_pk_fma_f32 v[184:185], v[192:193], v[176:177], v[184:185] op_sel_hi:[0,1,1] neg_lo:[0,0,1] neg_hi:[0,0,1]
v_pk_fma_f32 v[186:187], v[192:193], v[178:179], v[186:187] op_sel_hi:[0,1,1] neg_lo:[0,0,1] neg_hi:[0,0,1]
v_pk_fma_f32 v[188:189], v[192:193], v[180:181], v[188:189] op_sel_hi:[0,1,1] neg_lo:[0,0,1] neg_hi:[0,0,1]
v_pk_fma_f32 v[190:191], v[192:193], v[182:183], v[190:191] op_sel_hi:[0,1,1] neg_lo:[0,0,1] neg_hi:[0,0,1]
v_cvt_pk_bf16_f32 v36, v184, v185
v_cvt_pk_bf16_f32 v37, v186, v187
v_cvt_pk_bf16_f32 v38, v188, v189
v_cvt_pk_bf16_f32 v39, v190, v191
v_pk_fma_f32 v[176:177], v[192:193], v[184:185], v[176:177] op_sel_hi:[0,1,1] neg_lo:[0,0,1] neg_hi:[0,0,1]
v_pk_fma_f32 v[178:179], v[192:193], v[186:187], v[178:179] op_sel_hi:[0,1,1] neg_lo:[0,0,1] neg_hi:[0,0,1]
v_pk_fma_f32 v[180:181], v[192:193], v[188:189], v[180:181] op_sel_hi:[0,1,1] neg_lo:[0,0,1] neg_hi:[0,0,1]
v_pk_fma_f32 v[182:183], v[192:193], v[190:191], v[182:183] op_sel_hi:[0,1,1] neg_lo:[0,0,1] neg_hi:[0,0,1]
v_cvt_pk_bf16_f32 v40, v176, v177
v_cvt_pk_bf16_f32 v41, v178, v179
v_cvt_pk_bf16_f32 v42, v180, v181
v_cvt_pk_bf16_f32 v43, v182, v183
v_pk_fma_f32 v[184:185], v[192:193], v[176:177], v[184:185] op_sel_hi:[0,1,1] neg_lo:[0,0,1] neg_hi:[0,0,1]
v_pk_fma_f32 v[186:187], v[192:193], v[178:179], v[186:187] op_sel_hi:[0,1,1] neg_lo:[0,0,1] neg_hi:[0,0,1]
v_pk_fma_f32 v[188:189], v[192:193], v[180:181], v[188:189] op_sel_hi:[0,1,1] neg_lo:[0,0,1] neg_hi:[0,0,1]
v_pk_fma_f32 v[190:191], v[192:193], v[182:183], v[190:191] op_sel_hi:[0,1,1] neg_lo:[0,0,1] neg_hi:[0,0,1]
v_cvt_pk_bf16_f32 v44, v184, v185
v_cvt_pk_bf16_f32 v45, v186, v187
v_cvt_pk_bf16_f32 v46, v188, v189
v_cvt_pk_bf16_f32 v47, v190, v191
v_pk_fma_f32 v[176:177], v[192:193], v[184:185], v[176:177] op_sel_hi:[0,1,1] neg_lo:[0,0,1] neg_hi:[0,0,1]
v_pk_fma_f32 v[178:179], v[192:193], v[186:187], v[178:179] op_sel_hi:[0,1,1] neg_lo:[0,0,1] neg_hi:[0,0,1]
v_pk_fma_f32 v[180:181], v[192:193], v[188:189], v[180:181] op_sel_hi:[0,1,1] neg_lo:[0,0,1] neg_hi:[0,0,1]
v_pk_fma_f32 v[182:183], v[192:193], v[190:191], v[182:183] op_sel_hi:[0,1,1] neg_lo:[0,0,1] neg_hi:[0,0,1]
v_cvt_pk_bf16_f32 v48, v176, v177
v_cvt_pk_bf16_f32 v49, v178, v179
v_cvt_pk_bf16_f32 v50, v180, v181
v_cvt_pk_bf16_f32 v51, v182, v183
v_pk_fma_f32 v[184:185], v[192:193], v[176:177], v[184:185] op_sel_hi:[0,1,1] neg_lo:[0,0,1] neg_hi:[0,0,1]
v_pk_fma_f32 v[186:187], v[192:193], v[178:179], v[186:187] op_sel_hi:[0,1,1] neg_lo:[0,0,1] neg_hi:[0,0,1]
v_pk_fma_f32 v[188:189], v[192:193], v[180:181], v[188:189] op_sel_hi:[0,1,1] neg_lo:[0,0,1] neg_hi:[0,0,1]
v_pk_fma_f32 v[190:191], v[192:193], v[182:183], v[190:191] op_sel_hi:[0,1,1] neg_lo:[0,0,1] neg_hi:[0,0,1]
v_cvt_pk_bf16_f32 v52, v184, v185
v_cvt_pk_bf16_f32 v53, v186, v187
v_cvt_pk_bf16_f32 v54, v188, v189
v_cvt_pk_bf16_f32 v55, v190, v191
v_pk_fma_f32 v[176:177], v[192:193], v[184:185], v[176:177] op_sel_hi:[0,1,1] neg_lo:[0,0,1] neg_hi:[0,0,1]
v_pk_fma_f32 v[178:179], v[192:193], v[186:187], v[178:179] op_sel_hi:[0,1,1] neg_lo:[0,0,1] neg_hi:[0,0,1]
v_pk_fma_f32 v[180:181], v[192:193], v[188:189], v[180:181] op_sel_hi:[0,1,1] neg_lo:[0,0,1] neg_hi:[0,0,1]
v_pk_fma_f32 v[182:183], v[192:193], v[190:191], v[182:183] op_sel_hi:[0,1,1] neg_lo:[0,0,1] neg_hi:[0,0,1]
v_cvt_pk_bf16_f32 v56, v176, v177
v_cvt_pk_bf16_f32 v57, v178, v179
v_cvt_pk_bf16_f32 v58, v180, v181
v_cvt_pk_bf16_f32 v59, v182, v183
v_pk_fma_f32 v[184:185], v[192:193], v[176:177], v[184:185] op_sel_hi:[0,1,1] neg_lo:[0,0,1] neg_hi:[0,0,1]
v_pk_fma_f32 v[186:187], v[192:193], v[178:179], v[186:187] op_sel_hi:[0,1,1] neg_lo:[0,0,1] neg_hi:[0,0,1]
v_pk_fma_f32 v[188:189], v[192:193], v[180:181], v[188:189] op_sel_hi:[0,1,1] neg_lo:[0,0,1] neg_hi:[0,0,1]
v_pk_fma_f32 v[190:191], v[192:193], v[182:183], v[190:191] op_sel_hi:[0,1,1] neg_lo:[0,0,1] neg_hi:[0,0,1]
v_cvt_pk_bf16_f32 v60, v184, v185
v_cvt_pk_bf16_f32 v61, v186, v187
v_cvt_pk_bf16_f32 v62, v188, v189
v_cvt_pk_bf16_f32 v63, v190, v191
v_pk_fma_f32 v[176:177], v[192:193], v[184:185], v[176:177] op_sel_hi:[0,1,1] neg_lo:[0,0,1] neg_hi:[0,0,1]
v_pk_fma_f32 v[178:179], v[192:193], v[186:187], v[178:179] op_sel_hi:[0,1,1] neg_lo:[0,0,1] neg_hi:[0,0,1]
v_pk_fma_f32 v[180:181], v[192:193], v[188:189], v[180:181] op_sel_hi:[0,1,1] neg_lo:[0,0,1] neg_hi:[0,0,1]
v_pk_fma_f32 v[182:183], v[192:193], v[190:191], v[182:183] op_sel_hi:[0,1,1] neg_lo:[0,0,1] neg_hi:[0,0,1]
v_cvt_pk_bf16_f32 v64, v176, v177
v_cvt_pk_bf16_f32 v65, v178, v179
v_cvt_pk_bf16_f32 v66, v180, v181
v_cvt_pk_bf16_f32 v67, v182, v183
v_pk_fma_f32 v[184:185], v[192:193], v[176:177], v[184:185] op_sel_hi:[0,1,1] neg_lo:[0,0,1] neg_hi:[0,0,1]
v_pk_fma_f32 v[186:187], v[192:193], v[178:179], v[186:187] op_sel_hi:[0,1,1] neg_lo:[0,0,1] neg_hi:[0,0,1]
v_pk_fma_f32 v[188:189], v[192:193], v[180:181], v[188:189] op_sel_hi:[0,1,1] neg_lo:[0,0,1] neg_hi:[0,0,1]
v_pk_fma_f32 v[190:191], v[192:193], v[182:183], v[190:191] op_sel_hi:[0,1,1] neg_lo:[0,0,1] neg_hi:[0,0,1]
v_cvt_pk_bf16_f32 v68, v184, v185
v_cvt_pk_bf16_f32 v69, v186, v187
v_cvt_pk_bf16_f32 v70, v188, v189
v_cvt_pk_bf16_f32 v71, v190, v191
v_pk_fma_f32 v[176:177], v[192:193], v[184:185], v[176:177] op_sel_hi:[0,1,1] neg_lo:[0,0,1] neg_hi:[0,0,1]
v_pk_fma_f32 v[178:179], v[192:193], v[186:187], v[178:179] op_sel_hi:[0,1,1] neg_lo:[0,0,1] neg_hi:[0,0,1]
v_pk_fma_f32 v[180:181], v[192:193], v[188:189], v[180:181] op_sel_hi:[0,1,1] neg_lo:[0,0,1] neg_hi:[0,0,1]
v_pk_fma_f32 v[182:183], v[192:193], v[190:191], v[182:183] op_sel_hi:[0,1,1] neg_lo:[0,0,1] neg_hi:[0,0,1]
v_cvt_pk_bf16_f32 v72, v176, v177
v_cvt_pk_bf16_f32 v73, v178, v179
v_cvt_pk_bf16_f32 v74, v180, v181
v_cvt_pk_bf16_f32 v75, v182, v183
v_pk_fma_f32 v[184:185], v[192:193], v[176:177], v[184:185] op_sel_hi:[0,1,1] neg_lo:[0,0,1] neg_hi:[0,0,1]
v_pk_fma_f32 v[186:187], v[192:193], v[178:179], v[186:187] op_sel_hi:[0,1,1] neg_lo:[0,0,1] neg_hi:[0,0,1]
v_pk_fma_f32 v[188:189], v[192:193], v[180:181], v[188:189] op_sel_hi:[0,1,1] neg_lo:[0,0,1] neg_hi:[0,0,1]
v_pk_fma_f32 v[190:191], v[192:193], v[182:183], v[190:191] op_sel_hi:[0,1,1] neg_lo:[0,0,1] neg_hi:[0,0,1]
v_cvt_pk_bf16_f32 v76, v184, v185
v_cvt_pk_bf16_f32 v77, v186, v187
v_cvt_pk_bf16_f32 v78, v188, v189
v_cvt_pk_bf16_f32 v79, v190, v191
v_pk_fma_f32 v[176:177], v[192:193], v[184:185], v[176:177] op_sel_hi:[0,1,1] neg_lo:[0,0,1] neg_hi:[0,0,1]
v_pk_fma_f32 v[178:179], v[192:193], v[186:187], v[178:179] op_sel_hi:[0,1,1] neg_lo:[0,0,1] neg_hi:[0,0,1]
v_pk_fma_f32 v[180:181], v[192:193], v[188:189], v[180:181] op_sel_hi:[0,1,1] neg_lo:[0,0,1] neg_hi:[0,0,1]
v_pk_fma_f32 v[182:183], v[192:193], v[190:191], v[182:183] op_sel_hi:[0,1,1] neg_lo:[0,0,1] neg_hi:[0,0,1]
v_cvt_pk_bf16_f32 v80, v176, v177
v_cvt_pk_bf16_f32 v81, v178, v179
v_cvt_pk_bf16_f32 v82, v180, v181
v_cvt_pk_bf16_f32 v83, v182, v183
v_pk_fma_f32 v[184:185], v[192:193], v[176:177], v[184:185] op_sel_hi:[0,1,1] neg_lo:[0,0,1] neg_hi:[0,0,1]
v_pk_fma_f32 v[186:187], v[192:193], v[178:179], v[186:187] op_sel_hi:[0,1,1] neg_lo:[0,0,1] neg_hi:[0,0,1]
v_pk_fma_f32 v[188:189], v[192:193], v[180:181], v[188:189] op_sel_hi:[0,1,1] neg_lo:[0,0,1] neg_hi:[0,0,1]
v_pk_fma_f32 v[190:191], v[192:193], v[182:183], v[190:191] op_sel_hi:[0,1,1] neg_lo:[0,0,1] neg_hi:[0,0,1]
v_cvt_pk_bf16_f32 v84, v184, v185
v_cvt_pk_bf16_f32 v85, v186, v187
v_cvt_pk_bf16_f32 v86, v188, v189
v_cvt_pk_bf16_f32 v87, v190, v191
v_pk_fma_f32 v[176:177], v[192:193], v[184:185], v[176:177] op_sel_hi:[0,1,1] neg_lo:[0,0,1] neg_hi:[0,0,1]
v_pk_fma_f32 v[178:179], v[192:193], v[186:187], v[178:179] op_sel_hi:[0,1,1] neg_lo:[0,0,1] neg_hi:[0,0,1]
v_pk_fma_f32 v[180:181], v[192:193], v[188:189], v[180:181] op_sel_hi:[0,1,1] neg_lo:[0,0,1] neg_hi:[0,0,1]
v_pk_fma_f32 v[182:183], v[192:193], v[190:191], v[182:183] op_sel_hi:[0,1,1] neg_lo:[0,0,1] neg_hi:[0,0,1]
v_cvt_pk_bf16_f32 v88, v176, v177
v_cvt_pk_bf16_f32 v89, v178, v179
v_cvt_pk_bf16_f32 v90, v180, v181
v_cvt_pk_bf16_f32 v91, v182, v183
v_pk_fma_f32 v[184:185], v[192:193], v[176:177], v[184:185] op_sel_hi:[0,1,1] neg_lo:[0,0,1] neg_hi:[0,0,1]
v_pk_fma_f32 v[186:187], v[192:193], v[178:179], v[186:187] op_sel_hi:[0,1,1] neg_lo:[0,0,1] neg_hi:[0,0,1]
v_pk_fma_f32 v[188:189], v[192:193], v[180:181], v[188:189] op_sel_hi:[0,1,1] neg_lo:[0,0,1] neg_hi:[0,0,1]
v_pk_fma_f32 v[190:191], v[192:193], v[182:183], v[190:191] op_sel_hi:[0,1,1] neg_lo:[0,0,1] neg_hi:[0,0,1]
v_cvt_pk_bf16_f32 v92, v184, v185
v_cvt_pk_bf16_f32 v93, v186, v187
v_cvt_pk_bf16_f32 v94, v188, v189
v_cvt_pk_bf16_f32 v95, v190, v191
s_mov_b32 s20, 323
v_mad_u32_u24 v179, v196, s20, v197
v_cvt_f32_u32 v179, v179
v_mul_f32 v198, s19, v179
v_rndne_f32 v198, v198
v_fmac_f32 v179, 0xc4200000, v198
v_mul_f32 v179, s19, v179
v_cos_f32 v179, v179
s_mov_b32 s20, 324
v_mad_u32_u24 v180, v196, s20, v197
v_cvt_f32_u32 v180, v180
v_mul_f32 v198, s19, v180
v_rndne_f32 v198, v198
v_fmac_f32 v180, 0xc4200000, v198
v_mul_f32 v180, s19, v180
v_cos_f32 v180, v180
s_nop 0
v_fma_f32 v181, v194, v180, -v179
v_fma_f32 v178, v194, v179, -v180
v_fma_f32 v182, v194, v181, -v180
v_fma_f32 v177, v194, v178, -v179
v_fma_f32 v183, v194, v182, -v181
v_fma_f32 v176, v194, v177, -v178
v_cvt_pk_bf16_f32 v96, v176, v177
v_cvt_pk_bf16_f32 v97, v178, v179
v_cvt_pk_bf16_f32 v98, v180, v181
v_cvt_pk_bf16_f32 v99, v182, v183
s_mov_b32 s20, 339
v_mad_u32_u24 v187, v196, s20, v197
v_cvt_f32_u32 v187, v187
v_mul_f32 v198, s19, v187
v_rndne_f32 v198, v198
v_fmac_f32 v187, 0xc4200000, v198
v_mul_f32 v187, s19, v187
v_cos_f32 v187, v187
s_mov_b32 s20, 340
v_mad_u32_u24 v188, v196, s20, v197
v_cvt_f32_u32 v188, v188
v_mul_f32 v198, s19, v188
v_rndne_f32 v198, v198
v_fmac_f32 v188, 0xc4200000, v198
v_mul_f32 v188, s19, v188
v_cos_f32 v188, v188
s_nop 0
v_fma_f32 v189, v194, v188, -v187
v_fma_f32 v186, v194, v187, -v188
v_fma_f32 v190, v194, v189, -v188
v_fma_f32 v185, v194, v186, -v187
v_fma_f32 v191, v194, v190, -v189
v_fma_f32 v184, v194, v185, -v186
v_cvt_pk_bf16_f32 v100, v184, v185
v_cvt_pk_bf16_f32 v101, v186, v187
v_cvt_pk_bf16_f32 v102, v188, v189
v_cvt_pk_bf16_f32 v103, v190, v191
v_pk_fma_f32 v[176:177], v[192:193], v[184:185], v[176:177] op_sel_hi:[0,1,1] neg_lo:[0,0,1] neg_hi:[0,0,1]
v_pk_fma_f32 v[178:179], v[192:193], v[186:187], v[178:179] op_sel_hi:[0,1,1] neg_lo:[0,0,1] neg_hi:[0,0,1]
v_pk_fma_f32 v[180:181], v[192:193], v[188:189], v[180:181] op_sel_hi:[0,1,1] neg_lo:[0,0,1] neg_hi:[0,0,1]
v_pk_fma_f32 v[182:183], v[192:193], v[190:191], v[182:183] op_sel_hi:[0,1,1] neg_lo:[0,0,1] neg_hi:[0,0,1]
v_cvt_pk_bf16_f32 v104, v176, v177
v_cvt_pk_bf16_f32 v105, v178, v179
v_cvt_pk_bf16_f32 v106, v180, v181
v_cvt_pk_bf16_f32 v107, v182, v183
v_pk_fma_f32 v[184:185], v[192:193], v[176:177], v[184:185] op_sel_hi:[0,1,1] neg_lo:[0,0,1] neg_hi:[0,0,1]
v_pk_fma_f32 v[186:187], v[192:193], v[178:179], v[186:187] op_sel_hi:[0,1,1] neg_lo:[0,0,1] neg_hi:[0,0,1]
v_pk_fma_f32 v[188:189], v[192:193], v[180:181], v[188:189] op_sel_hi:[0,1,1] neg_lo:[0,0,1] neg_hi:[0,0,1]
v_pk_fma_f32 v[190:191], v[192:193], v[182:183], v[190:191] op_sel_hi:[0,1,1] neg_lo:[0,0,1] neg_hi:[0,0,1]
v_cvt_pk_bf16_f32 v108, v184, v185
v_cvt_pk_bf16_f32 v109, v186, v187
v_cvt_pk_bf16_f32 v110, v188, v189
v_cvt_pk_bf16_f32 v111, v190, v191
v_pk_fma_f32 v[176:177], v[192:193], v[184:185], v[176:177] op_sel_hi:[0,1,1] neg_lo:[0,0,1] neg_hi:[0,0,1]
v_pk_fma_f32 v[178:179], v[192:193], v[186:187], v[178:179] op_sel_hi:[0,1,1] neg_lo:[0,0,1] neg_hi:[0,0,1]
v_pk_fma_f32 v[180:181], v[192:193], v[188:189], v[180:181] op_sel_hi:[0,1,1] neg_lo:[0,0,1] neg_hi:[0,0,1]
v_pk_fma_f32 v[182:183], v[192:193], v[190:191], v[182:183] op_sel_hi:[0,1,1] neg_lo:[0,0,1] neg_hi:[0,0,1]
v_cvt_pk_bf16_f32 v112, v176, v177
v_cvt_pk_bf16_f32 v113, v178, v179
v_cvt_pk_bf16_f32 v114, v180, v181
v_cvt_pk_bf16_f32 v115, v182, v183
v_pk_fma_f32 v[184:185], v[192:193], v[176:177], v[184:185] op_sel_hi:[0,1,1] neg_lo:[0,0,1] neg_hi:[0,0,1]
v_pk_fma_f32 v[186:187], v[192:193], v[178:179], v[186:187] op_sel_hi:[0,1,1] neg_lo:[0,0,1] neg_hi:[0,0,1]
v_pk_fma_f32 v[188:189], v[192:193], v[180:181], v[188:189] op_sel_hi:[0,1,1] neg_lo:[0,0,1] neg_hi:[0,0,1]
v_pk_fma_f32 v[190:191], v[192:193], v[182:183], v[190:191] op_sel_hi:[0,1,1] neg_lo:[0,0,1] neg_hi:[0,0,1]
v_cvt_pk_bf16_f32 v116, v184, v185
v_cvt_pk_bf16_f32 v117, v186, v187
v_cvt_pk_bf16_f32 v118, v188, v189
v_cvt_pk_bf16_f32 v119, v190, v191
v_pk_fma_f32 v[176:177], v[192:193], v[184:185], v[176:177] op_sel_hi:[0,1,1] neg_lo:[0,0,1] neg_hi:[0,0,1]
v_pk_fma_f32 v[178:179], v[192:193], v[186:187], v[178:179] op_sel_hi:[0,1,1] neg_lo:[0,0,1] neg_hi:[0,0,1]
v_pk_fma_f32 v[180:181], v[192:193], v[188:189], v[180:181] op_sel_hi:[0,1,1] neg_lo:[0,0,1] neg_hi:[0,0,1]
v_pk_fma_f32 v[182:183], v[192:193], v[190:191], v[182:183] op_sel_hi:[0,1,1] neg_lo:[0,0,1] neg_hi:[0,0,1]
v_cvt_pk_bf16_f32 v120, v176, v177
v_cvt_pk_bf16_f32 v121, v178, v179
v_cvt_pk_bf16_f32 v122, v180, v181
v_cvt_pk_bf16_f32 v123, v182, v183
v_pk_fma_f32 v[184:185], v[192:193], v[176:177], v[184:185] op_sel_hi:[0,1,1] neg_lo:[0,0,1] neg_hi:[0,0,1]
v_pk_fma_f32 v[186:187], v[192:193], v[178:179], v[186:187] op_sel_hi:[0,1,1] neg_lo:[0,0,1] neg_hi:[0,0,1]
v_pk_fma_f32 v[188:189], v[192:193], v[180:181], v[188:189] op_sel_hi:[0,1,1] neg_lo:[0,0,1] neg_hi:[0,0,1]
v_pk_fma_f32 v[190:191], v[192:193], v[182:183], v[190:191] op_sel_hi:[0,1,1] neg_lo:[0,0,1] neg_hi:[0,0,1]
v_cvt_pk_bf16_f32 v124, v184, v185
v_cvt_pk_bf16_f32 v125, v186, v187
v_cvt_pk_bf16_f32 v126, v188, v189
v_cvt_pk_bf16_f32 v127, v190, v191
v_pk_fma_f32 v[176:177], v[192:193], v[184:185], v[176:177] op_sel_hi:[0,1,1] neg_lo:[0,0,1] neg_hi:[0,0,1]
v_pk_fma_f32 v[178:179], v[192:193], v[186:187], v[178:179] op_sel_hi:[0,1,1] neg_lo:[0,0,1] neg_hi:[0,0,1]
v_pk_fma_f32 v[180:181], v[192:193], v[188:189], v[180:181] op_sel_hi:[0,1,1] neg_lo:[0,0,1] neg_hi:[0,0,1]
v_pk_fma_f32 v[182:183], v[192:193], v[190:191], v[182:183] op_sel_hi:[0,1,1] neg_lo:[0,0,1] neg_hi:[0,0,1]
v_cvt_pk_bf16_f32 v128, v176, v177
v_cvt_pk_bf16_f32 v129, v178, v179
v_cvt_pk_bf16_f32 v130, v180, v181
v_cvt_pk_bf16_f32 v131, v182, v183
v_pk_fma_f32 v[184:185], v[192:193], v[176:177], v[184:185] op_sel_hi:[0,1,1] neg_lo:[0,0,1] neg_hi:[0,0,1]
v_pk_fma_f32 v[186:187], v[192:193], v[178:179], v[186:187] op_sel_hi:[0,1,1] neg_lo:[0,0,1] neg_hi:[0,0,1]
v_pk_fma_f32 v[188:189], v[192:193], v[180:181], v[188:189] op_sel_hi:[0,1,1] neg_lo:[0,0,1] neg_hi:[0,0,1]
v_pk_fma_f32 v[190:191], v[192:193], v[182:183], v[190:191] op_sel_hi:[0,1,1] neg_lo:[0,0,1] neg_hi:[0,0,1]
v_cvt_pk_bf16_f32 v132, v184, v185
v_cvt_pk_bf16_f32 v133, v186, v187
v_cvt_pk_bf16_f32 v134, v188, v189
v_cvt_pk_bf16_f32 v135, v190, v191
v_pk_fma_f32 v[176:177], v[192:193], v[184:185], v[176:177] op_sel_hi:[0,1,1] neg_lo:[0,0,1] neg_hi:[0,0,1]
v_pk_fma_f32 v[178:179], v[192:193], v[186:187], v[178:179] op_sel_hi:[0,1,1] neg_lo:[0,0,1] neg_hi:[0,0,1]
v_pk_fma_f32 v[180:181], v[192:193], v[188:189], v[180:181] op_sel_hi:[0,1,1] neg_lo:[0,0,1] neg_hi:[0,0,1]
v_pk_fma_f32 v[182:183], v[192:193], v[190:191], v[182:183] op_sel_hi:[0,1,1] neg_lo:[0,0,1] neg_hi:[0,0,1]
v_cvt_pk_bf16_f32 v136, v176, v177
v_cvt_pk_bf16_f32 v137, v178, v179
v_cvt_pk_bf16_f32 v138, v180, v181
v_cvt_pk_bf16_f32 v139, v182, v183
v_pk_fma_f32 v[184:185], v[192:193], v[176:177], v[184:185] op_sel_hi:[0,1,1] neg_lo:[0,0,1] neg_hi:[0,0,1]
v_pk_fma_f32 v[186:187], v[192:193], v[178:179], v[186:187] op_sel_hi:[0,1,1] neg_lo:[0,0,1] neg_hi:[0,0,1]
v_pk_fma_f32 v[188:189], v[192:193], v[180:181], v[188:189] op_sel_hi:[0,1,1] neg_lo:[0,0,1] neg_hi:[0,0,1]
v_pk_fma_f32 v[190:191], v[192:193], v[182:183], v[190:191] op_sel_hi:[0,1,1] neg_lo:[0,0,1] neg_hi:[0,0,1]
v_cvt_pk_bf16_f32 v140, v184, v185
v_cvt_pk_bf16_f32 v141, v186, v187
v_cvt_pk_bf16_f32 v142, v188, v189
v_cvt_pk_bf16_f32 v143, v190, v191
v_pk_fma_f32 v[176:177], v[192:193], v[184:185], v[176:177] op_sel_hi:[0,1,1] neg_lo:[0,0,1] neg_hi:[0,0,1]
v_pk_fma_f32 v[178:179], v[192:193], v[186:187], v[178:179] op_sel_hi:[0,1,1] neg_lo:[0,0,1] neg_hi:[0,0,1]
v_pk_fma_f32 v[180:181], v[192:193], v[188:189], v[180:181] op_sel_hi:[0,1,1] neg_lo:[0,0,1] neg_hi:[0,0,1]
v_pk_fma_f32 v[182:183], v[192:193], v[190:191], v[182:183] op_sel_hi:[0,1,1] neg_lo:[0,0,1] neg_hi:[0,0,1]
v_cvt_pk_bf16_f32 v144, v176, v177
v_cvt_pk_bf16_f32 v145, v178, v179
v_cvt_pk_bf16_f32 v146, v180, v181
v_cvt_pk_bf16_f32 v147, v182, v183
v_pk_fma_f32 v[184:185], v[192:193], v[176:177], v[184:185] op_sel_hi:[0,1,1] neg_lo:[0,0,1] neg_hi:[0,0,1]
v_pk_fma_f32 v[186:187], v[192:193], v[178:179], v[186:187] op_sel_hi:[0,1,1] neg_lo:[0,0,1] neg_hi:[0,0,1]
v_pk_fma_f32 v[188:189], v[192:193], v[180:181], v[188:189] op_sel_hi:[0,1,1] neg_lo:[0,0,1] neg_hi:[0,0,1]
v_pk_fma_f32 v[190:191], v[192:193], v[182:183], v[190:191] op_sel_hi:[0,1,1] neg_lo:[0,0,1] neg_hi:[0,0,1]
v_cvt_pk_bf16_f32 v148, v184, v185
v_cvt_pk_bf16_f32 v149, v186, v187
v_cvt_pk_bf16_f32 v150, v188, v189
v_cvt_pk_bf16_f32 v151, v190, v191
v_pk_fma_f32 v[176:177], v[192:193], v[184:185], v[176:177] op_sel_hi:[0,1,1] neg_lo:[0,0,1] neg_hi:[0,0,1]
v_pk_fma_f32 v[178:179], v[192:193], v[186:187], v[178:179] op_sel_hi:[0,1,1] neg_lo:[0,0,1] neg_hi:[0,0,1]
v_pk_fma_f32 v[180:181], v[192:193], v[188:189], v[180:181] op_sel_hi:[0,1,1] neg_lo:[0,0,1] neg_hi:[0,0,1]
v_pk_fma_f32 v[182:183], v[192:193], v[190:191], v[182:183] op_sel_hi:[0,1,1] neg_lo:[0,0,1] neg_hi:[0,0,1]
v_cvt_pk_bf16_f32 v152, v176, v177
v_cvt_pk_bf16_f32 v153, v178, v179
v_cvt_pk_bf16_f32 v154, v180, v181
v_cvt_pk_bf16_f32 v155, v182, v183
v_pk_fma_f32 v[184:185], v[192:193], v[176:177], v[184:185] op_sel_hi:[0,1,1] neg_lo:[0,0,1] neg_hi:[0,0,1]
v_pk_fma_f32 v[186:187], v[192:193], v[178:179], v[186:187] op_sel_hi:[0,1,1] neg_lo:[0,0,1] neg_hi:[0,0,1]
v_pk_fma_f32 v[188:189], v[192:193], v[180:181], v[188:189] op_sel_hi:[0,1,1] neg_lo:[0,0,1] neg_hi:[0,0,1]
v_pk_fma_f32 v[190:191], v[192:193], v[182:183], v[190:191] op_sel_hi:[0,1,1] neg_lo:[0,0,1] neg_hi:[0,0,1]
v_cvt_pk_bf16_f32 v156, v184, v185
v_cvt_pk_bf16_f32 v157, v186, v187
v_cvt_pk_bf16_f32 v158, v188, v189
v_cvt_pk_bf16_f32 v159, v190, v191
v_pk_fma_f32 v[176:177], v[192:193], v[184:185], v[176:177] op_sel_hi:[0,1,1] neg_lo:[0,0,1] neg_hi:[0,0,1]
v_pk_fma_f32 v[178:179], v[192:193], v[186:187], v[178:179] op_sel_hi:[0,1,1] neg_lo:[0,0,1] neg_hi:[0,0,1]
v_pk_fma_f32 v[180:181], v[192:193], v[188:189], v[180:181] op_sel_hi:[0,1,1] neg_lo:[0,0,1] neg_hi:[0,0,1]
v_pk_fma_f32 v[182:183], v[192:193], v[190:191], v[182:183] op_sel_hi:[0,1,1] neg_lo:[0,0,1] neg_hi:[0,0,1]
v_cvt_pk_bf16_f32 v160, v176, v177
v_cvt_pk_bf16_f32 v161, v178, v179
v_cvt_pk_bf16_f32 v162, v180, v181
v_cvt_pk_bf16_f32 v163, v182, v183
v_pk_fma_f32 v[184:185], v[192:193], v[176:177], v[184:185] op_sel_hi:[0,1,1] neg_lo:[0,0,1] neg_hi:[0,0,1]
v_pk_fma_f32 v[186:187], v[192:193], v[178:179], v[186:187] op_sel_hi:[0,1,1] neg_lo:[0,0,1] neg_hi:[0,0,1]
v_pk_fma_f32 v[188:189], v[192:193], v[180:181], v[188:189] op_sel_hi:[0,1,1] neg_lo:[0,0,1] neg_hi:[0,0,1]
v_pk_fma_f32 v[190:191], v[192:193], v[182:183], v[190:191] op_sel_hi:[0,1,1] neg_lo:[0,0,1] neg_hi:[0,0,1]
v_cvt_pk_bf16_f32 v164, v184, v185
v_cvt_pk_bf16_f32 v165, v186, v187
v_cvt_pk_bf16_f32 v166, v188, v189
v_cvt_pk_bf16_f32 v167, v190, v191
v_pk_fma_f32 v[176:177], v[192:193], v[184:185], v[176:177] op_sel_hi:[0,1,1] neg_lo:[0,0,1] neg_hi:[0,0,1]
v_pk_fma_f32 v[178:179], v[192:193], v[186:187], v[178:179] op_sel_hi:[0,1,1] neg_lo:[0,0,1] neg_hi:[0,0,1]
v_pk_fma_f32 v[180:181], v[192:193], v[188:189], v[180:181] op_sel_hi:[0,1,1] neg_lo:[0,0,1] neg_hi:[0,0,1]
v_pk_fma_f32 v[182:183], v[192:193], v[190:191], v[182:183] op_sel_hi:[0,1,1] neg_lo:[0,0,1] neg_hi:[0,0,1]
v_cvt_pk_bf16_f32 v168, v176, v177
v_cvt_pk_bf16_f32 v169, v178, v179
v_cvt_pk_bf16_f32 v170, v180, v181
v_cvt_pk_bf16_f32 v171, v182, v183
v_pk_fma_f32 v[184:185], v[192:193], v[176:177], v[184:185] op_sel_hi:[0,1,1] neg_lo:[0,0,1] neg_hi:[0,0,1]
v_pk_fma_f32 v[186:187], v[192:193], v[178:179], v[186:187] op_sel_hi:[0,1,1] neg_lo:[0,0,1] neg_hi:[0,0,1]
v_pk_fma_f32 v[188:189], v[192:193], v[180:181], v[188:189] op_sel_hi:[0,1,1] neg_lo:[0,0,1] neg_hi:[0,0,1]
v_pk_fma_f32 v[190:191], v[192:193], v[182:183], v[190:191] op_sel_hi:[0,1,1] neg_lo:[0,0,1] neg_hi:[0,0,1]
v_cvt_pk_bf16_f32 v172, v184, v185
v_cvt_pk_bf16_f32 v173, v186, v187
v_cvt_pk_bf16_f32 v174, v188, v189
v_cvt_pk_bf16_f32 v175, v190, v191
p1q_75:
s_mul_i32 s18, s30, 21846
s_lshr_b32 s18, s18, 16
s_mul_i32 s18, s18, 3
s_sub_u32 s18, s30, s18
s_and_b32 s19, s30, 3
s_cmp_lt_u32 s30, 56
s_cselect_b32 s18, s18, s19
s_mul_i32 s18, s18, 2560
s_add_u32 s18, s18, 11558912
s_add_u32 s29, s30, 1
s_cmp_lg_u32 s13, 0
s_cbranch_scc1 polld_77
v_lshlrev_b32 v11, 3, v0
v_min_u32 v11, 2432, v11
s_mov_b32 s17, 0
poll_76:
buffer_load_dword v8, v11, s[4:7], s18 offen sc1
s_add_u32 s17, s17, 1
s_cmp_gt_u32 s17, 262144
s_cbranch_scc1 L_fail
s_waitcnt vmcnt(0)
v_cmp_gt_u32 vcc, s29, v8
s_cbranch_vccz polld_77
s_sleep 2
s_branch poll_76
polld_77:
s_barrier
s_mul_i32 s18, s30, 40960
s_add_u32 s26, s18, 91226112
s_add_u32 s26, s26, s31
s_add_u32 s27, s18, 100663296
s_add_u32 s27, s27, s33
s_add_u32 m0, s31, 2048
s_add_u32 s20, s26, 0
buffer_load_dwordx4 v0, s[4:7], s20 offen sc1 lds
s_add_u32 m0, s31, 3072
s_add_u32 s20, s26, 1024
buffer_load_dwordx4 v0, s[4:7], s20 offen sc1 lds
s_add_u32 m0, s31, 4096
s_add_u32 s20, s26, 2048
buffer_load_dwordx4 v0, s[4:7], s20 offen sc1 lds
s_add_u32 m0, s31, 5120
s_add_u32 s20, s26, 3072
buffer_load_dwordx4 v0, s[4:7], s20 offen sc1 lds
s_add_u32 m0, s31, 6144
s_add_u32 s20, s26, 4096
buffer_load_dwordx4 v0, s[4:7], s20 offen sc1 lds
s_add_u32 m0, s31, 7168
s_add_u32 s20, s26, 5120
buffer_load_dwordx4 v0, s[4:7], s20 offen sc1 lds
s_add_u32 m0, s31, 8192
s_add_u32 s20, s26, 6144
buffer_load_dwordx4 v0, s[4:7], s20 offen sc1 lds
s_add_u32 m0, s31, 9216
s_add_u32 s20, s26, 7168
buffer_load_dwordx4 v0, s[4:7], s20 offen sc1 lds
s_add_u32 m0, s31, 10240
s_add_u32 s20, s26, 8192
buffer_load_dwordx4 v0, s[4:7], s20 offen sc1 lds
s_add_u32 m0, s31, 11264
s_add_u32 s20, s26, 9216
buffer_load_dwordx4 v0, s[4:7], s20 offen sc1 lds
s_waitcnt vmcnt(0)
s_barrier
v_add_u32 v2, s31, v0
ds_read_b128 v[216:219], v2 offset:2048
ds_read_b128 v[220:223], v2 offset:3072
ds_read_b128 v[224:227], v2 offset:4096
ds_read_b128 v[196:199], v0 offset:3072
ds_read_b128 v[228:231], v2 offset:5120
ds_read_b128 v[192:195], v0 offset:2048
v_mov_b64 v[208:209], 0
ds_read_b128 v[200:203], v0 offset:4096
ds_read_b128 v[204:207], v0 offset:5120
s_waitcnt lgkmcnt(7)
v_dot2c_f32_bf16 v208, s24, v216
v_dot2c_f32_bf16 v209, v216, v216
v_dot2c_f32_bf16 v208, s24, v217
v_dot2c_f32_bf16 v209, v217, v217
v_dot2c_f32_bf16 v208, s24, v218
v_dot2c_f32_bf16 v209, v218, v218
v_dot2c_f32_bf16 v208, s24, v219
s_waitcnt lgkmcnt(5)
v_dot2c_f32_bf16 v209, v219, v219
v_dot2c_f32_bf16 v208, s24, v220
v_dot2c_f32_bf16 v209, v220, v220
v_dot2c_f32_bf16 v208, s24, v221
v_dot2c_f32_bf16 v209, v221, v221
v_dot2c_f32_bf16 v208, s24, v222
v_dot2c_f32_bf16 v209, v222, v222
v_dot2c_f32_bf16 v208, s24, v223
v_dot2c_f32_bf16 v209, v223, v223
v_dot2c_f32_bf16 v208, s24, v224
v_dot2c_f32_bf16 v209, v224, v224
s_waitcnt lgkmcnt(3)
ds_read_b128 v[216:219], v2 offset:6144
ds_read_b128 v[220:223], v2 offset:7168
v_dot2c_f32_bf16 v208, s24, v225
v_dot2c_f32_bf16 v209, v225, v225
v_dot2c_f32_bf16 v208, s24, v226
v_dot2c_f32_bf16 v209, v226, v226
v_dot2c_f32_bf16 v208, s24, v227
v_dot2c_f32_bf16 v209, v227, v227
v_dot2c_f32_bf16 v208, s24, v228
v_dot2c_f32_bf16 v209, v228, v228
v_dot2c_f32_bf16 v208, s24, v229
v_dot2c_f32_bf16 v209, v229, v229
v_dot2c_f32_bf16 v208, s24, v230
v_dot2c_f32_bf16 v209, v230, v230
v_dot2c_f32_bf16 v208, s24, v231
v_dot2c_f32_bf16 v209, v231, v231
s_waitcnt lgkmcnt(1)
ds_read_b128 v[228:231], v2 offset:9216
ds_read_b128 v[224:227], v2 offset:8192
v_dot2c_f32_bf16 v208, s24, v216
v_dot2c_f32_bf16 v209, v216, v216
v_dot2c_f32_bf16 v208, s24, v217
s_waitcnt lgkmcnt(2)
v_dot2c_f32_bf16 v209, v217, v217
v_dot2c_f32_bf16 v208, s24, v218
v_dot2c_f32_bf16 v209, v218, v218
v_dot2c_f32_bf16 v208, s24, v219
v_dot2c_f32_bf16 v209, v219, v219
v_dot2c_f32_bf16 v208, s24, v220
v_dot2c_f32_bf16 v209, v220, v220
v_dot2c_f32_bf16 v208, s24, v221
v_dot2c_f32_bf16 v209, v221, v221
v_dot2c_f32_bf16 v208, s24, v222
v_dot2c_f32_bf16 v209, v222, v222
v_dot2c_f32_bf16 v208, s24, v223
v_dot2c_f32_bf16 v209, v223, v223
s_waitcnt lgkmcnt(0)
ds_read_b128 v[216:219], v2 offset:10240
ds_read_b128 v[220:223], v2 offset:11264
v_dot2c_f32_bf16 v208, s24, v224
v_dot2c_f32_bf16 v209, v224, v224
v_dot2c_f32_bf16 v208, s24, v225
v_dot2c_f32_bf16 v209, v225, v225
v_dot2c_f32_bf16 v208, s24, v226
v_dot2c_f32_bf16 v209, v226, v226
v_dot2c_f32_bf16 v208, s24, v227
v_dot2c_f32_bf16 v209, v227, v227
v_dot2c_f32_bf16 v208, s24, v228
v_dot2c_f32_bf16 v209, v228, v228
v_dot2c_f32_bf16 v208, s24, v229
v_dot2c_f32_bf16 v209, v229, v229
v_dot2c_f32_bf16 v208, s24, v230
v_dot2c_f32_bf16 v209, v230, v230
s_waitcnt lgkmcnt(1)
v_dot2c_f32_bf16 v208, s24, v231
v_dot2c_f32_bf16 v209, v231, v231
v_dot2c_f32_bf16 v208, s24, v216
s_waitcnt lgkmcnt(0)
v_dot2c_f32_bf16 v209, v216, v216
v_dot2c_f32_bf16 v208, s24, v217
v_dot2c_f32_bf16 v209, v217, v217
v_dot2c_f32_bf16 v208, s24, v218
v_dot2c_f32_bf16 v209, v218, v218
v_dot2c_f32_bf16 v208, s24, v219
v_dot2c_f32_bf16 v209, v219, v219
v_dot2c_f32_bf16 v208, s24, v220
v_dot2c_f32_bf16 v209, v220, v220
v_dot2c_f32_bf16 v208, s24, v221
v_dot2c_f32_bf16 v209, v221, v221
v_dot2c_f32_bf16 v208, s24, v222
v_dot2c_f32_bf16 v209, v222, v222
v_dot2c_f32_bf16 v208, s24, v223
v_dot2c_f32_bf16 v209, v223, v223
v_mfma_f32_32x32x16_bf16 v[176:191], v[192:195], v[16:19], 0
s_nop 1
v_permlane32_swap_b32 v208, v209
ds_read_b128 v[192:195], v0 offset:6144
v_mfma_f32_32x32x16_bf16 v[176:191], v[196:199], v[20:23], v[176:191]
v_and_b32 v2, 0x1ff, v0
v_add_f32 v208, v208, v209
v_mfma_f32_32x32x16_bf16 v[176:191], v[200:203], v[24:27], v[176:191]
v_lshl_add_u32 v209, s13, 2, v0
ds_read_b128 v[196:199], v0 offset:7168
ds_write_b32 v209, v208 offset:0
v_mfma_f32_32x32x16_bf16 v[176:191], v[204:207], v[28:31], v[176:191]
s_waitcnt lgkmcnt(2)
ds_read_b128 v[200:203], v0 offset:8192
ds_read_b128 v[204:207], v0 offset:9216
v_mfma_f32_32x32x16_bf16 v[176:191], v[192:195], v[32:35], v[176:191]
s_waitcnt lgkmcnt(3)
v_mfma_f32_32x32x16_bf16 v[176:191], v[196:199], v[36:39], v[176:191]
s_waitcnt lgkmcnt(2)
ds_read_b128 v[192:195], v0 offset:10240
s_waitcnt lgkmcnt(2)
s_waitcnt lgkmcnt(1)
v_mfma_f32_32x32x16_bf16 v[176:191], v[200:203], v[40:43], v[176:191]
ds_read_b128 v[196:199], v0 offset:11264
s_barrier
ds_read_b128 v[208:211], v2 offset:0
v_mfma_f32_32x32x16_bf16 v[176:191], v[204:207], v[44:47], v[176:191]
ds_read_b128 v[204:207], v0 offset:13312
ds_read_b128 v[200:203], v0 offset:12288
s_waitcnt lgkmcnt(4)
v_mfma_f32_32x32x16_bf16 v[176:191], v[192:195], v[48:51], v[176:191]
s_waitcnt lgkmcnt(3)
ds_read_b128 v[212:215], v2 offset:512
ds_read_b128 v[192:195], v0 offset:14336
v_mfma_f32_32x32x16_bf16 v[176:191], v[196:199], v[52:55], v[176:191]
s_waitcnt lgkmcnt(2)
v_mfma_f32_32x32x16_bf16 v[176:191], v[200:203], v[56:59], v[176:191]
ds_read_b128 v[196:199], v0 offset:15360
ds_read_b128 v[200:203], v0 offset:16384
v_add_f32 v208, v208, v209
v_add_f32 v210, v210, v211
s_waitcnt lgkmcnt(3)
v_mfma_f32_32x32x16_bf16 v[176:191], v[204:207], v[60:63], v[176:191]
s_waitcnt lgkmcnt(2)
ds_read_b128 v[204:207], v0 offset:17408
v_add_f32 v212, v212, v213
v_add_f32 v208, v208, v210
v_mfma_f32_32x32x16_bf16 v[176:191], v[192:195], v[64:67], v[176:191]
s_waitcnt lgkmcnt(2)
v_mfma_f32_32x32x16_bf16 v[176:191], v[196:199], v[68:71], v[176:191]
v_mul_f32 v208, 0x3acccccd, v208
s_waitcnt lgkmcnt(1)
ds_read_b128 v[192:195], v0 offset:18432
v_add_f32 v214, v214, v215
s_waitcnt lgkmcnt(1)
v_mfma_f32_32x32x16_bf16 v[176:191], v[200:203], v[72:75], v[176:191]
v_lshrrev_b32 v209, 2, v0
ds_read_b128 v[196:199], v0 offset:19456
v_mfma_f32_32x32x16_bf16 v[176:191], v[204:207], v[76:79], v[176:191]
ds_read_b128 v[200:203], v0 offset:20480
ds_read_b128 v[204:207], v0 offset:21504
v_add_f32 v212, v212, v214
v_mul_f32 v212, 0x3acccccd, v212
s_waitcnt lgkmcnt(3)
v_mfma_f32_32x32x16_bf16 v[176:191], v[192:195], v[80:83], v[176:191]
v_fma_f32 v212, -v208, v208, v212
s_waitcnt lgkmcnt(2)
v_max_f32 v212, 0, v212
v_add_f32 v212, 0x3727c5ac, v212
v_mfma_f32_32x32x16_bf16 v[176:191], v[196:199], v[84:87], v[176:191]
ds_read_b128 v[192:195], v0 offset:22528
s_waitcnt lgkmcnt(2)
v_bfe_u32 v210, v0, 5, 5
v_lshl_add_u32 v209, s13, 8, v209
v_mfma_f32_32x32x16_bf16 v[176:191], v[200:203], v[88:91], v[176:191]
ds_read_b128 v[196:199], v0 offset:23552
ds_read_b128 v[200:203], v0 offset:24576
v_rsq_f32 v212, v212
s_waitcnt lgkmcnt(3)
v_and_b32 v210, 16, v210
v_mfma_f32_32x32x16_bf16 v[176:191], v[204:207], v[92:95], v[176:191]
ds_read_b128 v[204:207], v0 offset:25600
s_waitcnt lgkmcnt(3)
v_mul_f32 v208, v212, v208
v_mfma_f32_32x32x16_bf16 v[176:191], v[192:195], v[96:99], v[176:191]
v_lshl_add_u32 v210, s13, 8, v210
v_permlane32_swap_b32 v212, v208
s_waitcnt lgkmcnt(2)
ds_read_b128 v[192:195], v0 offset:26624
v_mfma_f32_32x32x16_bf16 v[176:191], v[196:199], v[100:103], v[176:191]
ds_write_b32 v209, v212 offset:1024
s_waitcnt lgkmcnt(3)
s_waitcnt lgkmcnt(2)
v_mfma_f32_32x32x16_bf16 v[176:191], v[200:203], v[104:107], v[176:191]
ds_read_b128 v[240:243], v210 offset:1216
ds_read_b128 v[196:199], v0 offset:27648
v_mfma_f32_32x32x16_bf16 v[176:191], v[204:207], v[108:111], v[176:191]
ds_read_b128 v[200:203], v0 offset:28672
s_waitcnt lgkmcnt(4)
ds_read_b128 v[232:235], v210 offset:1152
v_mfma_f32_32x32x16_bf16 v[176:191], v[192:195], v[112:115], v[176:191]
ds_read_b128 v[204:207], v0 offset:29696
ds_read_b128 v[192:195], v0 offset:30720
s_waitcnt lgkmcnt(4)
v_mfma_f32_32x32x16_bf16 v[176:191], v[196:199], v[116:119], v[176:191]
ds_read_b128 v[228:231], v210 offset:1120
s_waitcnt lgkmcnt(4)
ds_read_b128 v[216:219], v210 offset:1024
ds_read_b128 v[196:199], v0 offset:31744
v_mfma_f32_32x32x16_bf16 v[176:191], v[200:203], v[120:123], v[176:191]
v_mul_f32 v241, v241, v7
s_waitcnt lgkmcnt(3)
ds_read_b128 v[200:203], v0 offset:32768
v_mfma_f32_32x32x16_bf16 v[176:191], v[204:207], v[124:127], v[176:191]
ds_read_b128 v[220:223], v210 offset:1056
v_mfma_f32_32x32x16_bf16 v[176:191], v[192:195], v[128:131], v[176:191]
ds_read_b128 v[204:207], v0 offset:33792
s_waitcnt lgkmcnt(3)
v_mfma_f32_32x32x16_bf16 v[176:191], v[196:199], v[132:135], v[176:191]
s_waitcnt lgkmcnt(2)
ds_read_b128 v[192:195], v0 offset:34816
ds_read_b128 v[224:227], v210 offset:1088
ds_read_b128 v[196:199], v0 offset:35840
ds_read_b128 v[244:247], v210 offset:1248
v_mfma_f32_32x32x16_bf16 v[176:191], v[200:203], v[136:139], v[176:191]
s_waitcnt lgkmcnt(4)
ds_read_b128 v[200:203], v0 offset:36864
v_mfma_f32_32x32x16_bf16 v[176:191], v[204:207], v[140:143], v[176:191]
v_mul_f32 v242, v242, v7
ds_read_b128 v[236:239], v210 offset:1184
s_waitcnt lgkmcnt(5)
v_mfma_f32_32x32x16_bf16 v[176:191], v[192:195], v[144:147], v[176:191]
ds_read_b128 v[204:207], v0 offset:37888
s_waitcnt lgkmcnt(3)
ds_read_b128 v[192:195], v0 offset:38912
v_mfma_f32_32x32x16_bf16 v[176:191], v[196:199], v[148:151], v[176:191]
ds_read_b128 v[196:199], v0 offset:39936
s_waitcnt lgkmcnt(4)
s_waitcnt lgkmcnt(3)
v_mul_f32 v240, v240, v7
v_mfma_f32_32x32x16_bf16 v[176:191], v[200:203], v[152:155], v[176:191]
v_mul_f32 v247, v247, v7
v_mul_f32 v245, v245, v7
v_mul_f32 v233, v233, v7
s_waitcnt lgkmcnt(2)
v_mfma_f32_32x32x16_bf16 v[176:191], v[204:207], v[156:159], v[176:191]
ds_read_b128 v[200:203], v0 offset:40960
s_waitcnt lgkmcnt(1)
ds_read_b128 v[204:207], v0 offset:41984
v_mul_f32 v232, v232, v7
v_mfma_f32_32x32x16_bf16 v[176:191], v[192:195], v[160:163], v[176:191]
v_mul_f32 v246, v246, v7
v_mul_f32 v244, v244, v7
v_mul_f32 v236, v236, v7
v_mfma_f32_32x32x16_bf16 v[176:191], v[196:199], v[164:167], v[176:191]
s_waitcnt lgkmcnt(0)
v_mul_f32 v239, v239, v7
v_mfma_f32_32x32x16_bf16 v[176:191], v[200:203], v[168:171], v[176:191]
v_mul_f32 v238, v238, v7
v_mfma_f32_32x32x16_bf16 v[176:191], v[204:207], v[172:175], v[176:191]
s_nop 0
v_mul_f32 v237, v237, v7
v_mul_f32 v235, v235, v7
v_mul_f32 v234, v234, v7
v_mul_f32 v243, v243, v7
s_nop 6
v_pk_fma_f32 v[184:185], v[184:185], v[224:225], v[240:241] neg_lo:[0,0,1] neg_hi:[0,0,1]
v_pk_fma_f32 v[182:183], v[182:183], v[222:223], v[238:239] neg_lo:[0,0,1] neg_hi:[0,0,1]
v_pk_fma_f32 v[180:181], v[180:181], v[220:221], v[236:237] neg_lo:[0,0,1] neg_hi:[0,0,1]
v_pk_fma_f32 v[188:189], v[188:189], v[228:229], v[244:245] neg_lo:[0,0,1] neg_hi:[0,0,1]
v_pk_fma_f32 v[176:177], v[176:177], v[216:217], v[232:233] neg_lo:[0,0,1] neg_hi:[0,0,1]
v_cvt_pk_bf16_f32 v194, v180, v181
v_pk_fma_f32 v[178:179], v[178:179], v[218:219], v[234:235] neg_lo:[0,0,1] neg_hi:[0,0,1]
v_cvt_pk_bf16_f32 v198, v188, v189
v_pk_fma_f32 v[190:191], v[190:191], v[230:231], v[246:247] neg_lo:[0,0,1] neg_hi:[0,0,1]
v_cvt_pk_bf16_f32 v199, v190, v191
v_cvt_pk_bf16_f32 v195, v182, v183
v_pk_fma_f32 v[186:187], v[186:187], v[226:227], v[242:243] neg_lo:[0,0,1] neg_hi:[0,0,1]
v_cvt_pk_bf16_f32 v193, v178, v179
v_cvt_pk_bf16_f32 v196, v184, v185
v_cvt_pk_bf16_f32 v197, v186, v187
v_cvt_pk_bf16_f32 v192, v176, v177
buffer_store_dwordx4 v[192:195], v6, s[4:7], s27 offen offset:0 sc1
buffer_store_dwordx4 v[196:199], v6, s[4:7], s27 offen offset:1024 sc1
s_add_u32 s30, s30, 3
s_cmp_lt_u32 s30, 60
s_cbranch_scc1 p1q_75
s_lshl_b32 s18, s51, 7
s_add_u32 s18, s18, 11552768
s_cmp_eq_u32 s13, 0
s_cselect_b32 s22, s18, s6
s_mov_b32 s23, 1
s_waitcnt vmcnt(0)
s_barrier
v_mov_b32 v3, s23
s_mov_b64 exec, 1
buffer_store_dword v3, off, s[4:7], s22 sc1
s_mov_b64 exec, -1
s_mov_b32 s22, s6
aend_58:
s_add_u32 s16, s16, 1
s_cmp_lt_u32 s16, 2
s_cbranch_scc1 alay_44
s_endpgm
L_fail:
s_mov_b64 exec, 1
v_mov_b32 v1, 0xdead
buffer_store_dword v1, off, s[8:11], 0 offset:8 sc1
L_end:
s_endpgm
L_chain:
s_waitcnt vmcnt(0)
s_nop 4
s_bitcmp1_b32 0x55555555, s14
s_cbranch_scc0 grp_10001
s_bfm_b32 s24, s14, 0
s_and_b32 s24, s24, 0x55555555
s_bcnt1_i32_b32 s24, s24
v_and_b32 v64, 63, v0
v_and_b32 v65, 15, v64
v_lshrrev_b32 v66, 4, v64
v_lshlrev_b32 v0, 4, v64
v_and_b32 v67, 2, v64
v_mov_b32 v68, 0x4444
v_mov_b32 v69, 0xeeee
v_cmp_eq_u32 vcc, 0, v67
s_nop 1
v_cndmask_b32 v1, v69, v68, vcc
s_mul_i32 s26, s13, 24576
s_add_u32 s26, s26, 65536
v_add_u32 v2, s26, v0
v_lshrrev_b32 v67, 2, v65
v_xor_b32 v68, v66, v67
v_lshlrev_b32 v68, 3, v68
v_lshl_add_u32 v68, v65, 5, v68
s_lshl_b32 s26, s13, 10
s_add_u32 s26, s26, 10240
v_add_u32 v3, s26, v68
v_lshl_add_u32 v68, v66, 2, v67
v_and_b32 v69, 3, v65
v_xor_b32 v69, v69, v66
v_lshlrev_b32 v69, 3, v69
v_lshl_add_u32 v68, v68, 5, v69
v_add_u32 v4, 10240, v68
v_and_b32 v69, 1, v65
v_lshl_add_u32 v68, v67, 1, v69
v_lshlrev_b32 v68, 4, v68
v_lshl_add_u32 v68, v66, 7, v68
v_add_u32 v5, 8192, v68
v_bfe_u32 v69, v65, 1, 1
v_mul_u32_u24 v69, 640, v69
v_xor_b32 v6, v69, v5
s_mov_b32 s42, 0x33333333
s_mov_b32 s43, 0x33333333
s_mov_b32 s44, 0x3f803f80
s_mov_b32 s45, 0x3f803f80
s_mov_b32 s46, 0x3f803f80
s_mov_b32 s47, 0
s_mov_b32 s37, 729808896
s_mov_b32 s38, 671088640
v_lshlrev_b32 v68, 3, v65
v_lshl_add_u32 v7, v66, 12, v68
s_lshl_b32 s26, s13, 14
s_lshl_b32 s27, s14, 7
s_add_u32 s26, s26, s27
s_add_u32 s90, s26, 65536
s_lshl_b32 s26, s13, 5
s_add_u32 s93, s26, s14
s_lshl_b32 s26, s93, 12
s_add_u32 s91, s26, 65536
s_lshr_b32 s26, s93, 2
s_lshl_b32 s26, s26, 9
s_and_b32 s27, s93, 3
s_lshl_b32 s27, s27, 6
s_add_u32 s26, s26, s27
s_add_u32 s92, s26, 393216
s_lshl_b32 s26, s14, 8
s_add_u32 s22, s26, 11534336
s_lshl_b32 s26, s24, 7
s_add_u32 s26, s26, 11550720
s_cmp_lt_u32 s24, 10
s_cselect_b32 s23, s26, 268435456
s_cselect_b32 s24, s24, 0
s_cselect_b32 s25, 12582912, s23
s_lshl_b32 s24, s24, 10
s_and_b32 s26, s14, 0
s_lshl_b32 s26, s26, 12
s_add_u32 s94, s26, 425984
s_lshl_b32 s26, s14, 7
s_add_u32 s95, s26, 425984
s_mov_b32 s35, 0x3e0293ee
s_lshl_b32 s26, s14, 2
s_add_u32 s26, s26, s13
s_mul_i32 s27, s26, 18432
s_add_u32 s89, s27, 1048576
s_add_u32 s48, s4, s90
s_addc_u32 s49, s5, 0
s_add_u32 s50, s90, 65536
s_add_u32 s50, s4, s50
s_addc_u32 s51, s5, 0
s_add_u32 s52, s90, 131072
s_add_u32 s52, s4, s52
s_addc_u32 s53, s5, 0
s_add_u32 s54, s90, 196608
s_add_u32 s54, s4, s54
s_addc_u32 s55, s5, 0
s_add_u32 s56, s90, 262144
s_add_u32 s56, s4, s56
s_addc_u32 s57, s5, 0
s_add_u32 s76, s89, 4096
s_add_u32 s76, s4, s76
s_addc_u32 s77, s5, 0
s_add_u32 s78, s89, 12288
s_add_u32 s78, s4, s78
s_addc_u32 s79, s5, 0
s_add_u32 s80, s89, 20480
s_add_u32 s80, s4, s80
s_addc_u32 s81, s5, 0
s_add_u32 s60, s4, s94
s_addc_u32 s61, s5, 0
s_add_u32 s62, s4, s95
s_addc_u32 s63, s5, 0
s_add_u32 s64, s4, s91
s_addc_u32 s65, s5, 0
s_add_u32 s66, s4, s92
s_addc_u32 s67, s5, 0
v_mov_b32 v72, 0
v_mov_b32 v73, 0
s_mov_b32 s26, s90
buffer_store_dwordx2 v[72:73], v7, s[4:7], s26 offen
s_add_u32 s26, s26, 65536
buffer_store_dwordx2 v[72:73], v7, s[4:7], s26 offen
s_add_u32 s26, s26, 65536
buffer_store_dwordx2 v[72:73], v7, s[4:7], s26 offen
s_add_u32 s26, s26, 65536
buffer_store_dwordx2 v[72:73], v7, s[4:7], s26 offen
s_add_u32 s26, s26, 65536
buffer_store_dwordx2 v[72:73], v7, s[4:7], s26 offen
s_add_u32 s26, s26, 65536
buffer_store_dword v72, off, s[4:7], s95 offset:0
s_load_dwordx2 s[96:97], s[0:1], 32
s_mov_b32 s98, 10240
s_mov_b32 s99, 0x20000
s_cmp_ge_u32 s93, 80
s_cbranch_scc1 nm0_10002
s_and_b32 s26, s93, 3
s_mul_i32 s26, s26, 2560
s_lshr_b32 s27, s93, 2
s_lshl_b32 s27, s27, 6
s_add_u32 s26, s26, s27
v_bfe_u32 v68, v65, 1, 2
v_lshlrev_b32 v68, 4, v68
v_and_b32 v69, 1, v65
v_lshl_add_u32 v68, v69, 2, v68
v_and_b32 v69, 1, v66
v_mul_u32_u24 v69, 1280, v69
v_add_u32 v68, v68, v69
s_waitcnt lgkmcnt(0)
buffer_load_dword v74, v68, s[96:99], s26 offen
buffer_load_dword v75, v68, s[96:99], s26 offen offset:8
v_and_b32 v68, 32, v0
v_bfe_u32 v69, v0, 6, 1
v_lshl_add_u32 v68, v69, 8, v68
v_bfe_u32 v69, v0, 8, 1
v_lshl_add_u32 v68, v69, 4, v68
v_bfe_u32 v69, v0, 4, 1
v_lshl_add_u32 v68, v69, 3, v68
s_add_u32 s27, s92, 16384
buffer_store_dwordx2 v[72:73], v68, s[4:7], s92 offen
s_waitcnt vmcnt(1)
buffer_store_dwordx2 v[74:75], v68, s[4:7], s27 offen
nm0_10002:
s_waitcnt vmcnt(0) lgkmcnt(0)
s_barrier
s_cmp_eq_u32 s13, 0
s_cselect_b32 s26, 4, s10
v_mov_b32 v74, 1
s_mov_b64 exec, 1
buffer_atomic_add v74, off, s[8:11], s26
s_mov_b64 exec, -1
v_lshrrev_b32 v67, 3, v64
v_and_b32 v68, 7, v64
v_lshlrev_b32 v68, 4, v68
v_lshl_add_u32 v32, v67, 13, v68
v_mul_u32_u24 v67, 1280, v67
v_add_u32 v36, v67, v68
v_lshrrev_b32 v67, 1, v66
v_lshlrev_b32 v67, 4, v67
v_and_b32 v68, 1, v66
v_lshl_add_u32 v67, v68, 1, v67
v_lshrrev_b32 v68, 3, v65
v_lshl_add_u32 v67, v68, 3, v67
v_bfe_u32 v68, v65, 2, 1
v_add_u32 v67, v67, v68
v_and_b32 v69, 3, v65
v_lshlrev_b32 v40, 4, v69
v_lshl_add_u32 v40, v67, 7, v40
v_lshl_add_u32 v67, v66, 2, v68
v_lshlrev_b32 v42, 4, v69
v_lshl_add_u32 v42, v67, 7, v42
v_lshrrev_b32 v68, 3, v65
v_lshl_add_u32 v42, v68, 3, v42
s_lshl_b32 s29, s13, 12
s_and_b32 s26, s13, 1
s_lshl_b32 s26, s26, 6
s_add_u32 s26, s26, s29
v_add_u32 v40, s26, v40
v_add_u32 v42, s26, v42
v_xor_b32 v41, 4096, v40
v_xor_b32 v43, 4096, v42
v_add_u32 v33, 64512, v32
v_add_u32 v37, 9216, v36
v_add_u32 v34, 129024, v32
v_add_u32 v38, 18432, v36
v_add_u32 v35, 193536, v32
v_add_u32 v39, 27648, v36
s_lshr_b32 s28, s13, 1
s_lshl_b32 s28, s28, 7
s_lshl_b32 s27, s14, 8
s_add_u32 s27, s27, s28
s_xor_b32 s26, s13, 0
s_lshl_b32 s82, s26, 19
s_add_u32 s82, s82, s27
s_lshl_b32 s85, s14, 2
s_add_u32 s85, s85, s26
s_mul_i32 s85, s85, 40960
s_add_u32 s85, s85, s28
s_xor_b32 s26, s13, 2
s_lshl_b32 s83, s26, 19
s_add_u32 s83, s83, s27
s_lshl_b32 s86, s14, 2
s_add_u32 s86, s86, s26
s_mul_i32 s86, s86, 40960
s_add_u32 s86, s86, s28
s_and_b32 s26, s13, 1
s_add_u32 s26, s26, 8
s_lshl_b32 s84, s26, 19
s_add_u32 s84, s84, s27
s_load_dwordx2 s[68:69], s[0:1], 40
s_load_dwordx2 s[70:71], s[0:1], 48
s_load_dwordx2 s[72:73], s[0:1], 56
s_load_dwordx2 s[74:75], s[0:1], 64
s_mov_b32 s98, 5242880
s_waitcnt lgkmcnt(0)
s_mov_b64 s[96:97], s[70:71]
s_add_u32 m0, s29, 0
s_add_u32 s26, s82, 0
buffer_load_dwordx4 v32, s[96:99], s26 offen offset:0 lds
buffer_load_dwordx4 v33, s[96:99], s26 offen offset:1024 lds
buffer_load_dwordx4 v34, s[96:99], s26 offen offset:2048 lds
buffer_load_dwordx4 v35, s[96:99], s26 offen offset:3072 lds
s_add_u32 m0, s29, 16384
s_add_u32 s26, s82, 262144
buffer_load_dwordx4 v32, s[96:99], s26 offen offset:0 lds
buffer_load_dwordx4 v33, s[96:99], s26 offen offset:1024 lds
buffer_load_dwordx4 v34, s[96:99], s26 offen offset:2048 lds
buffer_load_dwordx4 v35, s[96:99], s26 offen offset:3072 lds
s_add_u32 m0, s29, 32768
s_add_u32 s26, s82, 2097152
buffer_load_dwordx4 v32, s[96:99], s26 offen offset:0 lds
buffer_load_dwordx4 v33, s[96:99], s26 offen offset:1024 lds
buffer_load_dwordx4 v34, s[96:99], s26 offen offset:2048 lds
buffer_load_dwordx4 v35, s[96:99], s26 offen offset:3072 lds
s_waitcnt vmcnt(8)
s_barrier
s_add_u32 m0, s29, 49152
s_add_u32 s26, s82, 2359296
buffer_load_dwordx4 v32, s[96:99], s26 offen offset:0 lds
buffer_load_dwordx4 v33, s[96:99], s26 offen offset:1024 lds
buffer_load_dwordx4 v34, s[96:99], s26 offen offset:2048 lds
buffer_load_dwordx4 v35, s[96:99], s26 offen offset:3072 lds
ds_read_b64_tr_b16 v[72:73], v40 offset:0
ds_read_b64_tr_b16 v[74:75], v40 offset:512
ds_read_b64_tr_b16 v[76:77], v40 offset:8
ds_read_b64_tr_b16 v[78:79], v40 offset:520
ds_read_b64_tr_b16 a[160:161], v41 offset:0
ds_read_b64_tr_b16 a[162:163], v41 offset:512
ds_read_b64_tr_b16 v[84:85], v41 offset:8
ds_read_b64_tr_b16 v[86:87], v41 offset:520
s_waitcnt lgkmcnt(6)
global_store_dwordx4 v0, v[72:75], s[76:77] offset:0
s_waitcnt lgkmcnt(4)
global_store_dwordx4 v0, v[76:79], s[76:77] offset:2048
s_waitcnt lgkmcnt(0)
ds_write_b128 v2, v[84:87] offset:6144
s_waitcnt vmcnt(10)
s_barrier
s_add_u32 m0, s29, 0
s_add_u32 s26, s83, 0
buffer_load_dwordx4 v32, s[96:99], s26 offen offset:0 lds
buffer_load_dwordx4 v33, s[96:99], s26 offen offset:1024 lds
buffer_load_dwordx4 v34, s[96:99], s26 offen offset:2048 lds
buffer_load_dwordx4 v35, s[96:99], s26 offen offset:3072 lds
ds_read_b64_tr_b16 v[72:73], v40 offset:16384
ds_read_b64_tr_b16 v[74:75], v40 offset:16896
ds_read_b64_tr_b16 v[76:77], v40 offset:16392
ds_read_b64_tr_b16 v[78:79], v40 offset:16904
ds_read_b64_tr_b16 a[164:165], v41 offset:16384
ds_read_b64_tr_b16 a[166:167], v41 offset:16896
ds_read_b64_tr_b16 v[84:85], v41 offset:16392
ds_read_b64_tr_b16 v[86:87], v41 offset:16904
s_waitcnt lgkmcnt(6)
global_store_dwordx4 v0, v[72:75], s[76:77] offset:1024
s_waitcnt lgkmcnt(4)
global_store_dwordx4 v0, v[76:79], s[76:77] offset:3072
s_waitcnt lgkmcnt(0)
ds_write_b128 v2, v[84:87] offset:7168
s_waitcnt vmcnt(12)
s_barrier
s_add_u32 m0, s29, 16384
s_add_u32 s26, s83, 262144
buffer_load_dwordx4 v32, s[96:99], s26 offen offset:0 lds
buffer_load_dwordx4 v33, s[96:99], s26 offen offset:1024 lds
buffer_load_dwordx4 v34, s[96:99], s26 offen offset:2048 lds
buffer_load_dwordx4 v35, s[96:99], s26 offen offset:3072 lds
ds_read_b64_tr_b16 a[32:33], v40 offset:32768
ds_read_b64_tr_b16 a[34:35], v40 offset:33280
ds_read_b64_tr_b16 a[40:41], v40 offset:32776
ds_read_b64_tr_b16 a[42:43], v40 offset:33288
ds_read_b64_tr_b16 a[168:169], v41 offset:32768
ds_read_b64_tr_b16 a[170:171], v41 offset:33280
ds_read_b64_tr_b16 a[176:177], v41 offset:32776
ds_read_b64_tr_b16 a[178:179], v41 offset:33288
s_waitcnt vmcnt(12) lgkmcnt(0)
s_barrier
s_add_u32 m0, s29, 32768
s_add_u32 s26, s83, 2097152
buffer_load_dwordx4 v32, s[96:99], s26 offen offset:0 lds
buffer_load_dwordx4 v33, s[96:99], s26 offen offset:1024 lds
buffer_load_dwordx4 v34, s[96:99], s26 offen offset:2048 lds
buffer_load_dwordx4 v35, s[96:99], s26 offen offset:3072 lds
ds_read_b64_tr_b16 a[36:37], v40 offset:49152
ds_read_b64_tr_b16 a[38:39], v40 offset:49664
ds_read_b64_tr_b16 a[44:45], v40 offset:49160
ds_read_b64_tr_b16 a[46:47], v40 offset:49672
ds_read_b64_tr_b16 a[172:173], v41 offset:49152
ds_read_b64_tr_b16 a[174:175], v41 offset:49664
ds_read_b64_tr_b16 a[180:181], v41 offset:49160
ds_read_b64_tr_b16 a[182:183], v41 offset:49672
s_waitcnt vmcnt(10) lgkmcnt(0)
s_barrier
s_add_u32 m0, s29, 49152
s_add_u32 s26, s83, 2359296
buffer_load_dwordx4 v32, s[96:99], s26 offen offset:0 lds
buffer_load_dwordx4 v33, s[96:99], s26 offen offset:1024 lds
buffer_load_dwordx4 v34, s[96:99], s26 offen offset:2048 lds
buffer_load_dwordx4 v35, s[96:99], s26 offen offset:3072 lds
ds_read_b64_tr_b16 v[72:73], v40 offset:0
ds_read_b64_tr_b16 v[74:75], v40 offset:512
ds_read_b64_tr_b16 a[184:185], v40 offset:8
ds_read_b64_tr_b16 a[186:187], v40 offset:520
ds_read_b64_tr_b16 a[192:193], v41 offset:0
ds_read_b64_tr_b16 a[194:195], v41 offset:512
ds_read_b64_tr_b16 a[200:201], v41 offset:8
ds_read_b64_tr_b16 a[202:203], v41 offset:520
s_waitcnt lgkmcnt(6)
ds_write_b128 v2, v[72:75] offset:8192
s_waitcnt vmcnt(8) lgkmcnt(1)
s_barrier
s_add_u32 m0, s29, 0
s_add_u32 s26, s84, 0
buffer_load_dwordx4 v32, s[96:99], s26 offen offset:0 lds
buffer_load_dwordx4 v33, s[96:99], s26 offen offset:1024 lds
buffer_load_dwordx4 v34, s[96:99], s26 offen offset:2048 lds
buffer_load_dwordx4 v35, s[96:99], s26 offen offset:3072 lds
ds_read_b64_tr_b16 v[72:73], v40 offset:16384
ds_read_b64_tr_b16 v[74:75], v40 offset:16896
ds_read_b64_tr_b16 a[188:189], v40 offset:16392
ds_read_b64_tr_b16 a[190:191], v40 offset:16904
ds_read_b64_tr_b16 a[196:197], v41 offset:16384
ds_read_b64_tr_b16 a[198:199], v41 offset:16896
ds_read_b64_tr_b16 a[204:205], v41 offset:16392
ds_read_b64_tr_b16 a[206:207], v41 offset:16904
s_waitcnt lgkmcnt(6)
ds_write_b128 v2, v[72:75] offset:9216
s_waitcnt vmcnt(8) lgkmcnt(1)
s_barrier
s_add_u32 m0, s29, 16384
s_add_u32 s26, s84, 262144
buffer_load_dwordx4 v32, s[96:99], s26 offen offset:0 lds
buffer_load_dwordx4 v33, s[96:99], s26 offen offset:1024 lds
buffer_load_dwordx4 v34, s[96:99], s26 offen offset:2048 lds
buffer_load_dwordx4 v35, s[96:99], s26 offen offset:3072 lds
ds_read_b64_tr_b16 v[72:73], v40 offset:32768
ds_read_b64_tr_b16 v[74:75], v40 offset:33280
ds_read_b64_tr_b16 v[76:77], v40 offset:32776
ds_read_b64_tr_b16 v[78:79], v40 offset:33288
ds_read_b64_tr_b16 v[80:81], v41 offset:32768
ds_read_b64_tr_b16 v[82:83], v41 offset:33280
ds_read_b64_tr_b16 a[208:209], v41 offset:32776
ds_read_b64_tr_b16 a[210:211], v41 offset:33288
s_waitcnt lgkmcnt(6)
global_store_dwordx4 v0, v[72:75], s[78:79] offset:-2048
s_waitcnt lgkmcnt(4)
ds_write_b128 v2, v[76:79] offset:10240
s_waitcnt lgkmcnt(3)
ds_write_b128 v2, v[80:83] offset:12288
s_waitcnt vmcnt(9) lgkmcnt(2)
s_barrier
s_mov_b64 s[96:97], s[72:73]
s_add_u32 m0, s29, 32768
s_add_u32 s26, s82, 0
buffer_load_dwordx4 v32, s[96:99], s26 offen offset:0 lds
buffer_load_dwordx4 v33, s[96:99], s26 offen offset:1024 lds
buffer_load_dwordx4 v34, s[96:99], s26 offen offset:2048 lds
buffer_load_dwordx4 v35, s[96:99], s26 offen offset:3072 lds
ds_read_b64_tr_b16 v[72:73], v40 offset:49152
ds_read_b64_tr_b16 v[74:75], v40 offset:49664
ds_read_b64_tr_b16 v[76:77], v40 offset:49160
ds_read_b64_tr_b16 v[78:79], v40 offset:49672
ds_read_b64_tr_b16 v[80:81], v41 offset:49152
ds_read_b64_tr_b16 v[82:83], v41 offset:49664
ds_read_b64_tr_b16 a[212:213], v41 offset:49160
ds_read_b64_tr_b16 a[214:215], v41 offset:49672
s_waitcnt lgkmcnt(6)
global_store_dwordx4 v0, v[72:75], s[78:79] offset:-1024
s_waitcnt lgkmcnt(4)
ds_write_b128 v2, v[76:79] offset:11264
s_waitcnt lgkmcnt(3)
ds_write_b128 v2, v[80:83] offset:13312
s_waitcnt vmcnt(10) lgkmcnt(2)
s_barrier
s_add_u32 m0, s29, 49152
s_add_u32 s26, s82, 262144
buffer_load_dwordx4 v32, s[96:99], s26 offen offset:0 lds
buffer_load_dwordx4 v33, s[96:99], s26 offen offset:1024 lds
buffer_load_dwordx4 v34, s[96:99], s26 offen offset:2048 lds
buffer_load_dwordx4 v35, s[96:99], s26 offen offset:3072 lds
ds_read_b64_tr_b16 v[72:73], v40 offset:0
ds_read_b64_tr_b16 v[74:75], v40 offset:512
ds_read_b64_tr_b16 a[216:217], v40 offset:8
ds_read_b64_tr_b16 a[218:219], v40 offset:520
ds_read_b64_tr_b16 a[224:225], v41 offset:0
ds_read_b64_tr_b16 a[226:227], v41 offset:512
ds_read_b64_tr_b16 v[84:85], v41 offset:8
ds_read_b64_tr_b16 v[86:87], v41 offset:520
s_waitcnt lgkmcnt(6)
ds_write_b128 v2, v[72:75] offset:14336
s_waitcnt lgkmcnt(1)
ds_write_b128 v2, v[84:87] offset:16384
s_waitcnt vmcnt(10)
s_barrier
s_add_u32 m0, s29, 0
s_add_u32 s26, s82, 2097152
buffer_load_dwordx4 v32, s[96:99], s26 offen offset:0 lds
buffer_load_dwordx4 v33, s[96:99], s26 offen offset:1024 lds
buffer_load_dwordx4 v34, s[96:99], s26 offen offset:2048 lds
buffer_load_dwordx4 v35, s[96:99], s26 offen offset:3072 lds
ds_read_b64_tr_b16 v[72:73], v40 offset:16384
ds_read_b64_tr_b16 v[74:75], v40 offset:16896
ds_read_b64_tr_b16 a[220:221], v40 offset:16392
ds_read_b64_tr_b16 a[222:223], v40 offset:16904
ds_read_b64_tr_b16 a[228:229], v41 offset:16384
ds_read_b64_tr_b16 a[230:231], v41 offset:16896
ds_read_b64_tr_b16 v[84:85], v41 offset:16392
ds_read_b64_tr_b16 v[86:87], v41 offset:16904
s_waitcnt lgkmcnt(6)
ds_write_b128 v2, v[72:75] offset:15360
s_waitcnt lgkmcnt(1)
ds_write_b128 v2, v[84:87] offset:17408
s_waitcnt vmcnt(9)
s_barrier
s_add_u32 m0, s29, 16384
s_add_u32 s26, s82, 2359296
buffer_load_dwordx4 v32, s[96:99], s26 offen offset:0 lds
buffer_load_dwordx4 v33, s[96:99], s26 offen offset:1024 lds
buffer_load_dwordx4 v34, s[96:99], s26 offen offset:2048 lds
buffer_load_dwordx4 v35, s[96:99], s26 offen offset:3072 lds
ds_read_b64_tr_b16 a[0:1], v40 offset:32768
ds_read_b64_tr_b16 a[2:3], v40 offset:33280
ds_read_b64_tr_b16 a[8:9], v40 offset:32776
ds_read_b64_tr_b16 a[10:11], v40 offset:33288
ds_read_b64_tr_b16 a[248:249], v41 offset:32768
ds_read_b64_tr_b16 a[250:251], v41 offset:33280
ds_read_b64_tr_b16 v[88:89], v41 offset:32776
ds_read_b64_tr_b16 v[90:91], v41 offset:33288
s_waitcnt vmcnt(8) lgkmcnt(0)
s_barrier
s_add_u32 m0, s29, 32768
s_add_u32 s26, s83, 0
buffer_load_dwordx4 v32, s[96:99], s26 offen offset:0 lds
buffer_load_dwordx4 v33, s[96:99], s26 offen offset:1024 lds
buffer_load_dwordx4 v34, s[96:99], s26 offen offset:2048 lds
buffer_load_dwordx4 v35, s[96:99], s26 offen offset:3072 lds
ds_read_b64_tr_b16 a[4:5], v40 offset:49152
ds_read_b64_tr_b16 a[6:7], v40 offset:49664
ds_read_b64_tr_b16 a[12:13], v40 offset:49160
ds_read_b64_tr_b16 a[14:15], v40 offset:49672
ds_read_b64_tr_b16 a[252:253], v41 offset:49152
ds_read_b64_tr_b16 a[254:255], v41 offset:49664
ds_read_b64_tr_b16 v[92:93], v41 offset:49160
ds_read_b64_tr_b16 v[94:95], v41 offset:49672
s_waitcnt vmcnt(8) lgkmcnt(0)
s_barrier
s_add_u32 m0, s29, 49152
s_add_u32 s26, s83, 262144
buffer_load_dwordx4 v32, s[96:99], s26 offen offset:0 lds
buffer_load_dwordx4 v33, s[96:99], s26 offen offset:1024 lds
buffer_load_dwordx4 v34, s[96:99], s26 offen offset:2048 lds
buffer_load_dwordx4 v35, s[96:99], s26 offen offset:3072 lds
ds_read_b64_tr_b16 a[48:49], v40 offset:0
ds_read_b64_tr_b16 a[50:51], v40 offset:512
ds_read_b64_tr_b16 v[76:77], v40 offset:8
ds_read_b64_tr_b16 v[78:79], v40 offset:520
ds_read_b64_tr_b16 v[80:81], v41 offset:0
ds_read_b64_tr_b16 v[82:83], v41 offset:512
ds_read_b64_tr_b16 v[96:97], v41 offset:8
ds_read_b64_tr_b16 v[98:99], v41 offset:520
s_waitcnt lgkmcnt(4)
ds_write_b128 v2, v[76:79] offset:0
s_waitcnt lgkmcnt(3)
ds_write_b128 v2, v[80:83] offset:22528
s_waitcnt vmcnt(8) lgkmcnt(2)
s_barrier
s_add_u32 m0, s29, 0
s_add_u32 s26, s83, 2097152
buffer_load_dwordx4 v32, s[96:99], s26 offen offset:0 lds
buffer_load_dwordx4 v33, s[96:99], s26 offen offset:1024 lds
buffer_load_dwordx4 v34, s[96:99], s26 offen offset:2048 lds
buffer_load_dwordx4 v35, s[96:99], s26 offen offset:3072 lds
ds_read_b64_tr_b16 a[52:53], v40 offset:16384
ds_read_b64_tr_b16 a[54:55], v40 offset:16896
ds_read_b64_tr_b16 v[76:77], v40 offset:16392
ds_read_b64_tr_b16 v[78:79], v40 offset:16904
ds_read_b64_tr_b16 v[80:81], v41 offset:16384
ds_read_b64_tr_b16 v[82:83], v41 offset:16896
ds_read_b64_tr_b16 v[100:101], v41 offset:16392
ds_read_b64_tr_b16 v[102:103], v41 offset:16904
s_waitcnt lgkmcnt(4)
ds_write_b128 v2, v[76:79] offset:1024
s_waitcnt lgkmcnt(3)
ds_write_b128 v2, v[80:83] offset:23552
s_waitcnt vmcnt(8) lgkmcnt(2)
s_barrier
s_add_u32 m0, s29, 16384
s_add_u32 s26, s83, 2359296
buffer_load_dwordx4 v32, s[96:99], s26 offen offset:0 lds
buffer_load_dwordx4 v33, s[96:99], s26 offen offset:1024 lds
buffer_load_dwordx4 v34, s[96:99], s26 offen offset:2048 lds
buffer_load_dwordx4 v35, s[96:99], s26 offen offset:3072 lds
ds_read_b64_tr_b16 v[104:105], v40 offset:32768
ds_read_b64_tr_b16 v[106:107], v40 offset:33280
ds_read_b64_tr_b16 v[112:113], v40 offset:32776
ds_read_b64_tr_b16 v[114:115], v40 offset:33288
ds_read_b64_tr_b16 v[136:137], v41 offset:32768
ds_read_b64_tr_b16 v[138:139], v41 offset:33280
ds_read_b64_tr_b16 v[144:145], v41 offset:32776
ds_read_b64_tr_b16 v[146:147], v41 offset:33288
s_waitcnt vmcnt(8) lgkmcnt(0)
s_barrier
s_add_u32 m0, s29, 32768
s_add_u32 s26, s84, 0
buffer_load_dwordx4 v32, s[96:99], s26 offen offset:0 lds
buffer_load_dwordx4 v33, s[96:99], s26 offen offset:1024 lds
buffer_load_dwordx4 v34, s[96:99], s26 offen offset:2048 lds
buffer_load_dwordx4 v35, s[96:99], s26 offen offset:3072 lds
ds_read_b64_tr_b16 v[108:109], v40 offset:49152
ds_read_b64_tr_b16 v[110:111], v40 offset:49664
ds_read_b64_tr_b16 v[116:117], v40 offset:49160
ds_read_b64_tr_b16 v[118:119], v40 offset:49672
ds_read_b64_tr_b16 v[140:141], v41 offset:49152
ds_read_b64_tr_b16 v[142:143], v41 offset:49664
ds_read_b64_tr_b16 v[148:149], v41 offset:49160
ds_read_b64_tr_b16 v[150:151], v41 offset:49672
s_waitcnt vmcnt(8) lgkmcnt(0)
s_barrier
s_add_u32 m0, s29, 49152
s_add_u32 s26, s84, 262144
buffer_load_dwordx4 v32, s[96:99], s26 offen offset:0 lds
buffer_load_dwordx4 v33, s[96:99], s26 offen offset:1024 lds
buffer_load_dwordx4 v34, s[96:99], s26 offen offset:2048 lds
buffer_load_dwordx4 v35, s[96:99], s26 offen offset:3072 lds
ds_read_b64_tr_b16 v[120:121], v40 offset:0
ds_read_b64_tr_b16 v[122:123], v40 offset:512
ds_read_b64_tr_b16 v[128:129], v40 offset:8
ds_read_b64_tr_b16 v[130:131], v40 offset:520
ds_read_b64_tr_b16 v[152:153], v41 offset:0
ds_read_b64_tr_b16 v[154:155], v41 offset:512
ds_read_b64_tr_b16 v[160:161], v41 offset:8
ds_read_b64_tr_b16 v[162:163], v41 offset:520
s_waitcnt vmcnt(8) lgkmcnt(0)
s_barrier
s_mov_b64 s[96:97], s[68:69]
s_add_u32 m0, s29, 0
s_add_u32 s26, s82, 0
buffer_load_dwordx4 v32, s[96:99], s26 offen offset:0 lds
buffer_load_dwordx4 v33, s[96:99], s26 offen offset:1024 lds
buffer_load_dwordx4 v34, s[96:99], s26 offen offset:2048 lds
buffer_load_dwordx4 v35, s[96:99], s26 offen offset:3072 lds
ds_read_b64_tr_b16 v[124:125], v40 offset:16384
ds_read_b64_tr_b16 v[126:127], v40 offset:16896
ds_read_b64_tr_b16 v[132:133], v40 offset:16392
ds_read_b64_tr_b16 v[134:135], v40 offset:16904
ds_read_b64_tr_b16 v[156:157], v41 offset:16384
ds_read_b64_tr_b16 v[158:159], v41 offset:16896
ds_read_b64_tr_b16 v[164:165], v41 offset:16392
ds_read_b64_tr_b16 v[166:167], v41 offset:16904
s_waitcnt vmcnt(8) lgkmcnt(0)
s_barrier
s_add_u32 m0, s29, 16384
s_add_u32 s26, s82, 262144
buffer_load_dwordx4 v32, s[96:99], s26 offen offset:0 lds
buffer_load_dwordx4 v33, s[96:99], s26 offen offset:1024 lds
buffer_load_dwordx4 v34, s[96:99], s26 offen offset:2048 lds
buffer_load_dwordx4 v35, s[96:99], s26 offen offset:3072 lds
ds_read_b64_tr_b16 v[72:73], v40 offset:32768
ds_read_b64_tr_b16 v[74:75], v40 offset:33280
ds_read_b64_tr_b16 a[232:233], v40 offset:32776
ds_read_b64_tr_b16 a[234:235], v40 offset:33288
ds_read_b64_tr_b16 a[240:241], v41 offset:32768
ds_read_b64_tr_b16 a[242:243], v41 offset:33280
ds_read_b64_tr_b16 v[84:85], v41 offset:32776
ds_read_b64_tr_b16 v[86:87], v41 offset:33288
s_waitcnt lgkmcnt(6)
ds_write_b128 v2, v[72:75] offset:18432
s_waitcnt lgkmcnt(1)
ds_write_b128 v2, v[84:87] offset:20480
s_waitcnt vmcnt(8)
s_barrier
s_add_u32 m0, s29, 32768
s_add_u32 s26, s82, 2097152
buffer_load_dwordx4 v32, s[96:99], s26 offen offset:0 lds
buffer_load_dwordx4 v33, s[96:99], s26 offen offset:1024 lds
buffer_load_dwordx4 v34, s[96:99], s26 offen offset:2048 lds
buffer_load_dwordx4 v35, s[96:99], s26 offen offset:3072 lds
ds_read_b64_tr_b16 v[72:73], v40 offset:49152
ds_read_b64_tr_b16 v[74:75], v40 offset:49664
ds_read_b64_tr_b16 a[236:237], v40 offset:49160
ds_read_b64_tr_b16 a[238:239], v40 offset:49672
ds_read_b64_tr_b16 a[244:245], v41 offset:49152
ds_read_b64_tr_b16 a[246:247], v41 offset:49664
ds_read_b64_tr_b16 v[84:85], v41 offset:49160
ds_read_b64_tr_b16 v[86:87], v41 offset:49672
s_waitcnt lgkmcnt(6)
ds_write_b128 v2, v[72:75] offset:19456
s_waitcnt lgkmcnt(1)
ds_write_b128 v2, v[84:87] offset:21504
s_waitcnt vmcnt(8)
s_barrier
s_add_u32 m0, s29, 49152
s_add_u32 s26, s82, 2359296
buffer_load_dwordx4 v32, s[96:99], s26 offen offset:0 lds
buffer_load_dwordx4 v33, s[96:99], s26 offen offset:1024 lds
buffer_load_dwordx4 v34, s[96:99], s26 offen offset:2048 lds
buffer_load_dwordx4 v35, s[96:99], s26 offen offset:3072 lds
ds_read_b64_tr_b16 v[72:73], v40 offset:0
ds_read_b64_tr_b16 v[74:75], v40 offset:512
ds_read_b64_tr_b16 v[76:77], v40 offset:8
ds_read_b64_tr_b16 v[78:79], v40 offset:520
ds_read_b64_tr_b16 a[56:57], v41 offset:0
ds_read_b64_tr_b16 a[58:59], v41 offset:512
ds_read_b64_tr_b16 a[64:65], v41 offset:8
ds_read_b64_tr_b16 a[66:67], v41 offset:520
s_waitcnt lgkmcnt(6)
global_store_dwordx4 v0, v[72:75], s[76:77] offset:-4096
s_waitcnt lgkmcnt(4)
global_store_dwordx4 v0, v[76:79], s[76:77] offset:-2048
s_waitcnt vmcnt(10) lgkmcnt(0)
s_barrier
s_add_u32 m0, s29, 0
s_add_u32 s26, s83, 0
buffer_load_dwordx4 v32, s[96:99], s26 offen offset:0 lds
buffer_load_dwordx4 v33, s[96:99], s26 offen offset:1024 lds
buffer_load_dwordx4 v34, s[96:99], s26 offen offset:2048 lds
buffer_load_dwordx4 v35, s[96:99], s26 offen offset:3072 lds
ds_read_b64_tr_b16 v[72:73], v40 offset:16384
ds_read_b64_tr_b16 v[74:75], v40 offset:16896
ds_read_b64_tr_b16 v[76:77], v40 offset:16392
ds_read_b64_tr_b16 v[78:79], v40 offset:16904
ds_read_b64_tr_b16 a[60:61], v41 offset:16384
ds_read_b64_tr_b16 a[62:63], v41 offset:16896
ds_read_b64_tr_b16 a[68:69], v41 offset:16392
ds_read_b64_tr_b16 a[70:71], v41 offset:16904
s_waitcnt lgkmcnt(6)
global_store_dwordx4 v0, v[72:75], s[76:77] offset:-3072
s_waitcnt lgkmcnt(4)
global_store_dwordx4 v0, v[76:79], s[76:77] offset:-1024
s_waitcnt vmcnt(12) lgkmcnt(0)
s_barrier
s_add_u32 m0, s29, 16384
s_add_u32 s26, s83, 262144
buffer_load_dwordx4 v32, s[96:99], s26 offen offset:0 lds
buffer_load_dwordx4 v33, s[96:99], s26 offen offset:1024 lds
buffer_load_dwordx4 v34, s[96:99], s26 offen offset:2048 lds
buffer_load_dwordx4 v35, s[96:99], s26 offen offset:3072 lds
ds_read_b64_tr_b16 a[16:17], v40 offset:32768
ds_read_b64_tr_b16 a[18:19], v40 offset:33280
ds_read_b64_tr_b16 a[24:25], v40 offset:32776
ds_read_b64_tr_b16 a[26:27], v40 offset:33288
ds_read_b64_tr_b16 a[72:73], v41 offset:32768
ds_read_b64_tr_b16 a[74:75], v41 offset:33280
ds_read_b64_tr_b16 a[80:81], v41 offset:32776
ds_read_b64_tr_b16 a[82:83], v41 offset:33288
s_waitcnt vmcnt(12) lgkmcnt(0)
s_barrier
s_add_u32 m0, s29, 32768
s_add_u32 s26, s83, 2097152
buffer_load_dwordx4 v32, s[96:99], s26 offen offset:0 lds
buffer_load_dwordx4 v33, s[96:99], s26 offen offset:1024 lds
buffer_load_dwordx4 v34, s[96:99], s26 offen offset:2048 lds
buffer_load_dwordx4 v35, s[96:99], s26 offen offset:3072 lds
ds_read_b64_tr_b16 a[20:21], v40 offset:49152
ds_read_b64_tr_b16 a[22:23], v40 offset:49664
ds_read_b64_tr_b16 a[28:29], v40 offset:49160
ds_read_b64_tr_b16 a[30:31], v40 offset:49672
ds_read_b64_tr_b16 a[76:77], v41 offset:49152
ds_read_b64_tr_b16 a[78:79], v41 offset:49664
ds_read_b64_tr_b16 a[84:85], v41 offset:49160
ds_read_b64_tr_b16 a[86:87], v41 offset:49672
s_waitcnt vmcnt(10) lgkmcnt(0)
s_barrier
s_add_u32 m0, s29, 49152
s_add_u32 s26, s83, 2359296
buffer_load_dwordx4 v32, s[96:99], s26 offen offset:0 lds
buffer_load_dwordx4 v33, s[96:99], s26 offen offset:1024 lds
buffer_load_dwordx4 v34, s[96:99], s26 offen offset:2048 lds
buffer_load_dwordx4 v35, s[96:99], s26 offen offset:3072 lds
ds_read_b64_tr_b16 a[88:89], v40 offset:0
ds_read_b64_tr_b16 a[90:91], v40 offset:512
ds_read_b64_tr_b16 v[76:77], v40 offset:8
ds_read_b64_tr_b16 v[78:79], v40 offset:520
ds_read_b64_tr_b16 a[112:113], v41 offset:0
ds_read_b64_tr_b16 a[114:115], v41 offset:512
ds_read_b64_tr_b16 a[120:121], v41 offset:8
ds_read_b64_tr_b16 a[122:123], v41 offset:520
s_waitcnt lgkmcnt(4)
ds_write_b128 v2, v[76:79] offset:2048
s_waitcnt vmcnt(8) lgkmcnt(1)
s_barrier
s_add_u32 m0, s29, 0
s_add_u32 s26, s84, 0
buffer_load_dwordx4 v32, s[96:99], s26 offen offset:0 lds
buffer_load_dwordx4 v33, s[96:99], s26 offen offset:1024 lds
buffer_load_dwordx4 v34, s[96:99], s26 offen offset:2048 lds
buffer_load_dwordx4 v35, s[96:99], s26 offen offset:3072 lds
ds_read_b64_tr_b16 a[92:93], v40 offset:16384
ds_read_b64_tr_b16 a[94:95], v40 offset:16896
ds_read_b64_tr_b16 v[76:77], v40 offset:16392
ds_read_b64_tr_b16 v[78:79], v40 offset:16904
ds_read_b64_tr_b16 a[116:117], v41 offset:16384
ds_read_b64_tr_b16 a[118:119], v41 offset:16896
ds_read_b64_tr_b16 a[124:125], v41 offset:16392
ds_read_b64_tr_b16 a[126:127], v41 offset:16904
s_waitcnt lgkmcnt(4)
ds_write_b128 v2, v[76:79] offset:3072
s_waitcnt vmcnt(8) lgkmcnt(1)
s_barrier
s_add_u32 m0, s29, 16384
s_add_u32 s26, s84, 262144
buffer_load_dwordx4 v32, s[96:99], s26 offen offset:0 lds
buffer_load_dwordx4 v33, s[96:99], s26 offen offset:1024 lds
buffer_load_dwordx4 v34, s[96:99], s26 offen offset:2048 lds
buffer_load_dwordx4 v35, s[96:99], s26 offen offset:3072 lds
ds_read_b64_tr_b16 a[96:97], v40 offset:32768
ds_read_b64_tr_b16 a[98:99], v40 offset:33280
ds_read_b64_tr_b16 a[104:105], v40 offset:32776
ds_read_b64_tr_b16 a[106:107], v40 offset:33288
ds_read_b64_tr_b16 a[128:129], v41 offset:32768
ds_read_b64_tr_b16 a[130:131], v41 offset:33280
ds_read_b64_tr_b16 v[84:85], v41 offset:32776
ds_read_b64_tr_b16 v[86:87], v41 offset:33288
s_waitcnt lgkmcnt(0)
ds_write_b128 v2, v[84:87] offset:4096
s_waitcnt vmcnt(8)
s_barrier
s_mov_b64 s[96:97], s[74:75]
s_add_u32 m0, s29, 32768
s_add_u32 s26, s85, 0
buffer_load_dwordx4 v36, s[96:99], s26 offen offset:0 lds
buffer_load_dwordx4 v37, s[96:99], s26 offen offset:1024 lds
buffer_load_dwordx4 v38, s[96:99], s26 offen offset:2048 lds
buffer_load_dwordx4 v39, s[96:99], s26 offen offset:3072 lds
ds_read_b64_tr_b16 a[100:101], v40 offset:49152
ds_read_b64_tr_b16 a[102:103], v40 offset:49664
ds_read_b64_tr_b16 a[108:109], v40 offset:49160
ds_read_b64_tr_b16 a[110:111], v40 offset:49672
ds_read_b64_tr_b16 a[132:133], v41 offset:49152
ds_read_b64_tr_b16 a[134:135], v41 offset:49664
ds_read_b64_tr_b16 v[84:85], v41 offset:49160
ds_read_b64_tr_b16 v[86:87], v41 offset:49672
s_waitcnt lgkmcnt(0)
ds_write_b128 v2, v[84:87] offset:5120
s_waitcnt vmcnt(8)
s_barrier
s_add_u32 m0, s29, 49152
s_add_u32 s26, s86, 0
buffer_load_dwordx4 v36, s[96:99], s26 offen offset:0 lds
buffer_load_dwordx4 v37, s[96:99], s26 offen offset:1024 lds
buffer_load_dwordx4 v38, s[96:99], s26 offen offset:2048 lds
buffer_load_dwordx4 v39, s[96:99], s26 offen offset:3072 lds
ds_read_b64_tr_b16 a[136:137], v40 offset:0
ds_read_b64_tr_b16 a[138:139], v40 offset:512
ds_read_b64_tr_b16 a[144:145], v40 offset:8
ds_read_b64_tr_b16 a[146:147], v40 offset:520
ds_read_b64_tr_b16 v[80:81], v41 offset:0
ds_read_b64_tr_b16 v[82:83], v41 offset:512
ds_read_b64_tr_b16 a[152:153], v41 offset:8
ds_read_b64_tr_b16 a[154:155], v41 offset:520
s_waitcnt lgkmcnt(2)
global_store_dwordx4 v0, v[80:83], s[78:79] offset:-4096
s_waitcnt vmcnt(9) lgkmcnt(0)
s_barrier
s_add_u32 m0, s29, 0
s_add_u32 s26, s85, 256
buffer_load_dwordx4 v36, s[96:99], s26 offen offset:0 lds
buffer_load_dwordx4 v37, s[96:99], s26 offen offset:1024 lds
buffer_load_dwordx4 v38, s[96:99], s26 offen offset:2048 lds
buffer_load_dwordx4 v39, s[96:99], s26 offen offset:3072 lds
ds_read_b64_tr_b16 a[140:141], v40 offset:16384
ds_read_b64_tr_b16 a[142:143], v40 offset:16896
ds_read_b64_tr_b16 a[148:149], v40 offset:16392
ds_read_b64_tr_b16 a[150:151], v40 offset:16904
ds_read_b64_tr_b16 v[80:81], v41 offset:16384
ds_read_b64_tr_b16 v[82:83], v41 offset:16896
ds_read_b64_tr_b16 a[156:157], v41 offset:16392
ds_read_b64_tr_b16 a[158:159], v41 offset:16904
s_waitcnt lgkmcnt(2)
global_store_dwordx4 v0, v[80:83], s[78:79] offset:-3072
s_waitcnt vmcnt(10) lgkmcnt(0)
s_barrier
s_add_u32 m0, s29, 16384
s_add_u32 s26, s86, 256
buffer_load_dwordx4 v36, s[96:99], s26 offen offset:0 lds
buffer_load_dwordx4 v37, s[96:99], s26 offen offset:1024 lds
buffer_load_dwordx4 v38, s[96:99], s26 offen offset:2048 lds
buffer_load_dwordx4 v39, s[96:99], s26 offen offset:3072 lds
ds_read_b64_tr_b16 v[72:73], v42 offset:32768
ds_read_b64_tr_b16 v[74:75], v42 offset:33024
ds_read_b64_tr_b16 v[76:77], v42 offset:34816
ds_read_b64_tr_b16 v[78:79], v42 offset:35072
ds_read_b64_tr_b16 v[8:9], v43 offset:32768
ds_read_b64_tr_b16 v[10:11], v43 offset:33024
ds_read_b64_tr_b16 v[12:13], v43 offset:34816
ds_read_b64_tr_b16 v[14:15], v43 offset:35072
s_waitcnt lgkmcnt(6)
global_store_dwordx4 v0, v[72:75], s[78:79] offset:0
s_waitcnt lgkmcnt(4)
global_store_dwordx4 v0, v[76:79], s[78:79] offset:1024
s_waitcnt vmcnt(12) lgkmcnt(0)
s_barrier
s_add_u32 m0, s29, 32768
s_add_u32 s26, s85, 512
buffer_load_dwordx4 v36, s[96:99], s26 offen offset:0 lds
buffer_load_dwordx4 v37, s[96:99], s26 offen offset:1024 lds
buffer_load_dwordx4 v38, s[96:99], s26 offen offset:2048 lds
buffer_load_dwordx4 v39, s[96:99], s26 offen offset:3072 lds
ds_read_b64_tr_b16 v[16:17], v42 offset:49152
ds_read_b64_tr_b16 v[18:19], v42 offset:49408
ds_read_b64_tr_b16 v[20:21], v42 offset:51200
ds_read_b64_tr_b16 v[22:23], v42 offset:51456
ds_read_b64_tr_b16 v[184:185], v43 offset:49152
ds_read_b64_tr_b16 v[186:187], v43 offset:49408
ds_read_b64_tr_b16 v[188:189], v43 offset:51200
ds_read_b64_tr_b16 v[190:191], v43 offset:51456
s_waitcnt vmcnt(11) lgkmcnt(0)
s_barrier
s_add_u32 m0, s29, 49152
s_add_u32 s26, s86, 512
buffer_load_dwordx4 v36, s[96:99], s26 offen offset:0 lds
buffer_load_dwordx4 v37, s[96:99], s26 offen offset:1024 lds
buffer_load_dwordx4 v38, s[96:99], s26 offen offset:2048 lds
buffer_load_dwordx4 v39, s[96:99], s26 offen offset:3072 lds
ds_read_b64_tr_b16 v[72:73], v42 offset:0
ds_read_b64_tr_b16 v[74:75], v42 offset:256
ds_read_b64_tr_b16 v[76:77], v42 offset:2048
ds_read_b64_tr_b16 v[78:79], v42 offset:2304
ds_read_b64_tr_b16 v[192:193], v43 offset:0
ds_read_b64_tr_b16 v[194:195], v43 offset:256
ds_read_b64_tr_b16 v[196:197], v43 offset:2048
ds_read_b64_tr_b16 v[198:199], v43 offset:2304
s_waitcnt lgkmcnt(6)
global_store_dwordx4 v0, v[72:75], s[78:79] offset:2048
s_waitcnt lgkmcnt(4)
global_store_dwordx4 v0, v[76:79], s[78:79] offset:3072
s_waitcnt vmcnt(12) lgkmcnt(0)
s_barrier
s_add_u32 m0, s29, 0
s_add_u32 s26, s85, 768
buffer_load_dwordx4 v36, s[96:99], s26 offen offset:0 lds
buffer_load_dwordx4 v37, s[96:99], s26 offen offset:1024 lds
buffer_load_dwordx4 v38, s[96:99], s26 offen offset:2048 lds
buffer_load_dwordx4 v39, s[96:99], s26 offen offset:3072 lds
ds_read_b64_tr_b16 v[24:25], v42 offset:16384
ds_read_b64_tr_b16 v[26:27], v42 offset:16640
ds_read_b64_tr_b16 v[28:29], v42 offset:18432
ds_read_b64_tr_b16 v[30:31], v42 offset:18688
ds_read_b64_tr_b16 v[200:201], v43 offset:16384
ds_read_b64_tr_b16 v[202:203], v43 offset:16640
ds_read_b64_tr_b16 v[204:205], v43 offset:18432
ds_read_b64_tr_b16 v[206:207], v43 offset:18688
s_waitcnt vmcnt(10) lgkmcnt(0)
s_barrier
s_add_u32 m0, s29, 16384
s_add_u32 s26, s86, 768
buffer_load_dwordx4 v36, s[96:99], s26 offen offset:0 lds
buffer_load_dwordx4 v37, s[96:99], s26 offen offset:1024 lds
buffer_load_dwordx4 v38, s[96:99], s26 offen offset:2048 lds
buffer_load_dwordx4 v39, s[96:99], s26 offen offset:3072 lds
ds_read_b64_tr_b16 v[168:169], v42 offset:32768
ds_read_b64_tr_b16 v[170:171], v42 offset:33024
ds_read_b64_tr_b16 v[172:173], v42 offset:34816
ds_read_b64_tr_b16 v[174:175], v42 offset:35072
ds_read_b64_tr_b16 v[48:49], v43 offset:32768
ds_read_b64_tr_b16 v[50:51], v43 offset:33024
ds_read_b64_tr_b16 v[52:53], v43 offset:34816
ds_read_b64_tr_b16 v[54:55], v43 offset:35072
s_waitcnt vmcnt(10) lgkmcnt(0)
s_barrier
s_add_u32 m0, s29, 32768
s_add_u32 s26, s85, 1024
buffer_load_dwordx4 v36, s[96:99], s26 offen offset:0 lds
buffer_load_dwordx4 v37, s[96:99], s26 offen offset:1024 lds
buffer_load_dwordx4 v38, s[96:99], s26 offen offset:2048 lds
buffer_load_dwordx4 v39, s[96:99], s26 offen offset:3072 lds
ds_read_b64_tr_b16 v[56:57], v42 offset:49152
ds_read_b64_tr_b16 v[58:59], v42 offset:49408
ds_read_b64_tr_b16 v[60:61], v42 offset:51200
ds_read_b64_tr_b16 v[62:63], v42 offset:51456
ds_read_b64_tr_b16 v[208:209], v43 offset:49152
ds_read_b64_tr_b16 v[210:211], v43 offset:49408
ds_read_b64_tr_b16 v[212:213], v43 offset:51200
ds_read_b64_tr_b16 v[214:215], v43 offset:51456
s_waitcnt vmcnt(8) lgkmcnt(0)
s_barrier
s_add_u32 m0, s29, 49152
s_add_u32 s26, s86, 1024
buffer_load_dwordx4 v36, s[96:99], s26 offen offset:0 lds
buffer_load_dwordx4 v37, s[96:99], s26 offen offset:1024 lds
buffer_load_dwordx4 v38, s[96:99], s26 offen offset:2048 lds
buffer_load_dwordx4 v39, s[96:99], s26 offen offset:3072 lds
ds_read_b64_tr_b16 v[176:177], v42 offset:0
ds_read_b64_tr_b16 v[178:179], v42 offset:256
ds_read_b64_tr_b16 v[180:181], v42 offset:2048
ds_read_b64_tr_b16 v[182:183], v42 offset:2304
ds_read_b64_tr_b16 v[216:217], v43 offset:0
ds_read_b64_tr_b16 v[218:219], v43 offset:256
ds_read_b64_tr_b16 v[220:221], v43 offset:2048
ds_read_b64_tr_b16 v[222:223], v43 offset:2304
s_waitcnt vmcnt(8) lgkmcnt(0)
s_barrier
ds_read_b64_tr_b16 v[64:65], v42 offset:16384
ds_read_b64_tr_b16 v[66:67], v42 offset:16640
ds_read_b64_tr_b16 v[68:69], v42 offset:18432
ds_read_b64_tr_b16 v[70:71], v42 offset:18688
ds_read_b64_tr_b16 v[224:225], v43 offset:16384
ds_read_b64_tr_b16 v[226:227], v43 offset:16640
ds_read_b64_tr_b16 v[228:229], v43 offset:18432
ds_read_b64_tr_b16 v[230:231], v43 offset:18688
s_waitcnt vmcnt(4) lgkmcnt(0)
s_barrier
ds_read_b64_tr_b16 v[72:73], v42 offset:32768
ds_read_b64_tr_b16 v[74:75], v42 offset:33024
ds_read_b64_tr_b16 v[76:77], v42 offset:34816
ds_read_b64_tr_b16 v[78:79], v42 offset:35072
ds_read_b64_tr_b16 v[232:233], v43 offset:32768
ds_read_b64_tr_b16 v[234:235], v43 offset:33024
ds_read_b64_tr_b16 v[236:237], v43 offset:34816
ds_read_b64_tr_b16 v[238:239], v43 offset:35072
s_waitcnt lgkmcnt(6)
global_store_dwordx4 v0, v[72:75], s[80:81] offset:-4096
s_waitcnt lgkmcnt(4)
global_store_dwordx4 v0, v[76:79], s[80:81] offset:-3072
s_waitcnt vmcnt(2) lgkmcnt(0)
s_barrier
ds_read_b64_tr_b16 v[240:241], v42 offset:49152
ds_read_b64_tr_b16 v[242:243], v42 offset:49408
ds_read_b64_tr_b16 v[244:245], v42 offset:51200
ds_read_b64_tr_b16 v[246:247], v42 offset:51456
ds_read_b64_tr_b16 v[248:249], v43 offset:49152
ds_read_b64_tr_b16 v[250:251], v43 offset:49408
ds_read_b64_tr_b16 v[252:253], v43 offset:51200
ds_read_b64_tr_b16 v[254:255], v43 offset:51456
s_waitcnt lgkmcnt(0)
s_barrier
s_mul_i32 s26, s13, 12288
v_add_u32 v44, s26, v0
ds_write_b128 v44, v[8:11] offset:16384
ds_write_b128 v44, v[12:15] offset:17408
ds_write_b128 v44, v[16:19] offset:18432
ds_write_b128 v44, v[20:23] offset:19456
ds_write_b128 v44, v[24:27] offset:20480
ds_write_b128 v44, v[28:31] offset:21504
ds_write_b128 v44, v[48:51] offset:22528
ds_write_b128 v44, v[52:55] offset:23552
ds_write_b128 v44, v[56:59] offset:24576
ds_write_b128 v44, v[60:63] offset:25600
ds_write_b128 v44, v[64:67] offset:26624
ds_write_b128 v44, v[68:71] offset:27648
s_cmp_lg_u32 s13, 0
s_cbranch_scc1 cb_10004
v_mov_b32 v44, 4
s_mov_b64 exec, 1
s_mov_b32 s30, 0
cb_10003:
buffer_load_dword v45, v44, s[8:11], 0 offen sc1
s_add_u32 s30, s30, 1
s_cmp_gt_u32 s30, 262144
s_cbranch_scc1 L_fail
s_waitcnt vmcnt(0)
v_cmp_gt_u32 vcc, 32, v45
s_cbranch_vccnz cb_10003
s_mov_b64 exec, -1
cb_10004:
s_waitcnt vmcnt(0) lgkmcnt(0)
s_barrier
s_mov_b32 s18, 0
s_mov_b32 s36, 0
s_cmp_eq_u32 s13, 1
s_cbranch_scc1 wave_10006
s_cmp_eq_u32 s13, 2
s_cbranch_scc1 wave_10007
s_cmp_eq_u32 s13, 3
s_cbranch_scc1 wave_10008
wave_10005:
layer_10009:
s_lshl_b32 s17, s36, 6
s_mul_i32 s27, s36, 35651584
s_mul_i32 s28, s14, 16384
s_add_u32 s27, s27, s28
s_add_u32 s20, s27, 16777216
s_mul_i32 s27, s17, 10240
s_add_u32 s27, s27, s24
s_add_u32 s21, s27, s25
s_mov_b32 s19, 0
s_mov_b32 s33, s6
s_add_u32 s34, s17, 1
s_add_u32 s31, s17, 63
s_add_u32 s32, s17, 64
s_mov_b32 s27, s20
v_mov_b32 v7, 0
s_add_u32 s68, s4, 413696
s_addc_u32 s69, s5, 0
s_add_u32 s72, s4, 397312
s_addc_u32 s73, s5, 0
s_add_u32 s70, s4, 417792
s_addc_u32 s71, s5, 0
s_add_u32 s74, s4, 401408
s_addc_u32 s75, s5, 0
s_add_u32 s58, s4, s20
s_addc_u32 s59, s5, 0
global_load_dwordx4 v[64:67], v0, s[76:77] offset:-4096 sc1
global_load_dwordx4 v[68:71], v0, s[76:77] offset:-3072 sc1
global_load_dwordx4 v[72:75], v0, s[76:77] offset:-2048 sc1
global_load_dwordx4 v[76:79], v0, s[76:77] offset:-1024 sc1
global_load_dwordx4 v[80:83], v0, s[76:77] offset:2048 sc1
global_load_dwordx4 v[84:87], v0, s[76:77] offset:3072 sc1
global_load_dwordx4 v[56:59], v0, s[76:77] offset:0 sc1
global_load_dwordx4 v[60:63], v0, s[76:77] offset:1024 sc1
v_mov_b64 v[8:9], 0
v_mov_b64 v[10:11], 0
v_mov_b64 v[12:13], 0
v_mov_b64 v[14:15], 0
v_mov_b64 v[16:17], 0
v_mov_b64 v[18:19], 0
v_mov_b64 v[20:21], 0
v_mov_b64 v[22:23], 0
v_mov_b64 v[24:25], 0
v_mov_b64 v[26:27], 0
v_mov_b64 v[28:29], 0
v_mov_b64 v[30:31], 0
v_cmp_gt_u32 vcc, s34, v7
s_cmp_eq_u32 vcc_hi, 0
s_cbranch_scc1 kv_10020
s_mov_b32 s30, 0
kv_10019:
v_and_b32 v7, 128, v0
buffer_load_dword v7, v7, s[4:7], s22 offen sc1
s_add_u32 s30, s30, 1
s_cmp_gt_u32 s30, 262144
s_cbranch_scc1 L_fail
s_waitcnt vmcnt(0)
v_cmp_gt_u32 vcc, s34, v7
s_cbranch_vccnz kv_10019
kv_10020:
s_barrier
global_load_dwordx4 v[48:51], v0, s[58:59] offset:0 nt sc1
global_load_dwordx4 v[52:55], v0, s[58:59] offset:1024 nt sc1
v_and_b32 v7, 255, v0
v_lshl_add_u32 v7, v7, 3, s27
global_load_dwordx4 v[32:35], v0, s[68:69] offset:-4096 sc1
global_load_dwordx4 v[36:39], v0, s[68:69] offset:0 sc1
global_load_dwordx4 v[40:43], v0, s[70:71] offset:0 sc1
s_mov_b32 s30, 0
s_waitcnt vmcnt(0)
.p2align 6
gather_10010:
s_waitcnt vmcnt(4)
rt_10015_b:
v_smfmac_f32_16x16x64_bf16 v[24:27], v[32:35], a[0:7], v1
ds_write_b128 v0, v[32:35] offset:0
v_smfmac_f32_16x16x64_bf16 v[8:11], v[32:35], v[64:71], v1
v_bitop3_b32 v44, v32, v34, s18 bitop3:0x7e
v_smfmac_f32_16x16x64_bf16 v[12:15], v[32:35], v[72:79], v1
s_waitcnt vmcnt(3)
ds_write_b128 v0, v[36:39] offset:4096
v_bitop3_b32 v45, v36, v38, s18 bitop3:0x7e
v_or_b32 v44, v44, v45
s_waitcnt vmcnt(2)
v_bitop3_b32 v45, v40, v42, s18 bitop3:0x7e
v_bitop3_b32 v44, v44, v45, s19 bitop3:0xa8
v_cmp_ne_u32 vcc, 0, v44
v_smfmac_f32_16x16x64_bf16 v[8:11], v[36:39], a[16:23], v1
ds_write_b128 v0, v[40:43] offset:8192
v_smfmac_f32_16x16x64_bf16 v[20:23], v[32:35], v[80:87], v1
s_cbranch_vccnz rt_10015
global_load_dwordx4 v[64:67], v0, s[78:79] offset:-4096 sc1
ds_read_b128 v[80:83], v2 offset:0
v_smfmac_f32_16x16x64_bf16 v[28:31], v[32:35], a[8:15], v1
global_load_dwordx4 v[68:71], v0, s[78:79] offset:-3072 sc1
ds_read_b128 v[84:87], v2 offset:1024
v_smfmac_f32_16x16x64_bf16 v[20:23], v[36:39], a[40:47], v1
s_waitcnt lgkmcnt(2)
global_load_dwordx4 v[72:75], v0, s[78:79] offset:-2048 sc1
global_load_dwordx4 v[76:79], v0, s[78:79] offset:-1024 sc1
v_smfmac_f32_16x16x64_bf16 v[16:19], v[32:35], v[56:63], v1
s_barrier
ds_read_b128 v[40:43], v0 offset:1024
v_smfmac_f32_16x16x64_bf16 v[16:19], v[36:39], a[32:39], v1
s_xor_b32 s18, s18, 1
s_waitcnt lgkmcnt(1)
ds_read_b128 v[44:47], v0 offset:5120
v_smfmac_f32_16x16x64_bf16 v[28:31], v[36:39], v[80:87], v1
ds_read_b128 v[80:83], v2 offset:2048
v_smfmac_f32_16x16x64_bf16 v[24:27], v[36:39], a[48:55], v1
s_mov_b64 s[68:69], s[72:73]
ds_read_b128 v[32:35], v0 offset:2048
v_smfmac_f32_16x16x64_bf16 v[12:15], v[36:39], a[24:31], v1
ds_read_b128 v[84:87], v2 offset:3072
s_waitcnt lgkmcnt(4)
v_smfmac_f32_16x16x64_bf16 v[8:11], v[40:43], a[56:63], v1
ds_read_b128 v[36:39], v0 offset:6144
v_smfmac_f32_16x16x64_bf16 v[12:15], v[40:43], a[64:71], v1
s_add_u32 s20, s20, 524288
s_waitcnt lgkmcnt(4)
ds_read_b128 v[40:43], v0 offset:3072
v_smfmac_f32_16x16x64_bf16 v[12:15], v[44:47], a[80:87], v1
s_add_u32 s17, s17, 1
global_load_dwordx4 v[56:59], v0, s[58:59] offset:2048 nt sc1
v_smfmac_f32_16x16x64_bf16 v[8:11], v[44:47], a[72:79], v1
s_waitcnt lgkmcnt(3)
ds_read_b128 v[44:47], v0 offset:7168
s_waitcnt lgkmcnt(3)
v_smfmac_f32_16x16x64_bf16 v[12:15], v[32:35], v[80:87], v1
s_add_u32 s21, s21, 10240
ds_read_b128 v[80:83], v2 offset:4096
v_smfmac_f32_16x16x64_bf16 v[8:11], v[32:35], a[88:95], v1
s_waitcnt lgkmcnt(3)
ds_read_b128 v[84:87], v2 offset:5120
s_waitcnt lgkmcnt(3)
v_smfmac_f32_16x16x64_bf16 v[12:15], v[36:39], a[104:111], v1
ds_read_b128 v[32:35], v0 offset:8192
v_smfmac_f32_16x16x64_bf16 v[8:11], v[36:39], a[96:103], v1
ds_read_b128 v[36:39], v0 offset:9216
v_smfmac_f32_16x16x64_bf16 v[8:11], v[40:43], a[112:119], v1
s_waitcnt lgkmcnt(4)
global_load_dwordx4 v[60:63], v0, s[58:59] offset:3072 nt sc1
v_smfmac_f32_16x16x64_bf16 v[12:15], v[40:43], a[120:127], v1
s_waitcnt lgkmcnt(2)
ds_read_b128 v[40:43], v0 offset:1024
v_smfmac_f32_16x16x64_bf16 v[12:15], v[44:47], v[80:87], v1
s_waitcnt lgkmcnt(2)
ds_read_b128 v[84:87], v2 offset:7168
v_smfmac_f32_16x16x64_bf16 v[8:11], v[44:47], a[128:135], v1
s_waitcnt vmcnt(5)
s_waitcnt lgkmcnt(2)
ds_read_b128 v[80:83], v2 offset:6144
v_smfmac_f32_16x16x64_bf16 v[12:15], v[32:35], a[144:151], v1
global_load_dword v7, v7, s[4:5] sc1
v_smfmac_f32_16x16x64_bf16 v[8:11], v[32:35], a[136:143], v1
ds_read_b128 v[32:35], v0 offset:5120
s_waitcnt vmcnt(5)
v_smfmac_f32_16x16x64_bf16 v[8:11], v[36:39], v[64:71], v1
s_nop 0
ds_read_b128 v[68:71], v2 offset:9216
s_waitcnt lgkmcnt(3)
v_smfmac_f32_16x16x64_bf16 v[12:15], v[36:39], a[152:159], v1
s_nop 0
ds_read_b128 v[64:67], v2 offset:8192
s_waitcnt lgkmcnt(3)
ds_read_b128 v[36:39], v0 offset:2048
v_add_f32 v8, v8, v10
v_smfmac_f32_16x16x64_bf16 v[20:23], v[40:43], v[80:87], v1
ds_read_b128 v[84:87], v2 offset:11264
v_mul_f32 v8, s35, v8
v_smfmac_f32_16x16x64_bf16 v[16:19], v[40:43], a[160:167], v1
s_waitcnt lgkmcnt(4)
ds_read_b128 v[40:43], v0 offset:6144
v_add_f32 v9, v9, v11
v_smfmac_f32_16x16x64_bf16 v[20:23], v[32:35], a[176:183], v1
ds_read_b128 v[80:83], v2 offset:10240
v_mul_f32 v9, s35, v9
v_add_f32 v13, v13, v15
v_cvt_pk_bf16_f32 v8, v8, v9
v_add_f32 v12, v12, v14
v_smfmac_f32_16x16x64_bf16 v[16:19], v[32:35], a[168:175], v1
s_waitcnt lgkmcnt(3)
ds_read_b128 v[32:35], v0 offset:3072
v_mul_f32 v13, s35, v13
v_smfmac_f32_16x16x64_bf16 v[16:19], v[36:39], v[64:71], v1
s_waitcnt vmcnt(3)
ds_read_b128 v[68:71], v2 offset:13312
v_mul_f32 v12, s35, v12
v_smfmac_f32_16x16x64_bf16 v[20:23], v[36:39], a[184:191], v1
s_waitcnt lgkmcnt(3)
ds_read_b128 v[36:39], v0 offset:7168
ds_read_b128 v[64:67], v2 offset:12288
v_cvt_pk_bf16_f32 v12, v12, v13
v_smfmac_f32_16x16x64_bf16 v[16:19], v[40:43], v[72:79], v1
s_waitcnt lgkmcnt(4)
ds_write2_b32 v3, v8, v12 offset0:0 offset1:128
v_smfmac_f32_16x16x64_bf16 v[20:23], v[40:43], v[80:87], v1
s_add_u32 s34, s17, 2
s_waitcnt lgkmcnt(4)
ds_read_b128 v[72:75], v2 offset:14336
v_smfmac_f32_16x16x64_bf16 v[20:23], v[32:35], a[200:207], v1
ds_read_b128 v[80:83], v2 offset:16384
v_smfmac_f32_16x16x64_bf16 v[16:19], v[32:35], a[192:199], v1
s_waitcnt lgkmcnt(4)
ds_read_b128 v[40:43], v0 offset:8192
s_mov_b64 vcc, s[42:43]
ds_read_b128 v[76:79], v2 offset:15360
v_smfmac_f32_16x16x64_bf16 v[20:23], v[36:39], a[208:215], v1
ds_read_b128 v[84:87], v2 offset:17408
s_waitcnt lgkmcnt(5)
s_barrier
ds_read_b128 v[32:35], v0 offset:9216
v_smfmac_f32_16x16x64_bf16 v[16:19], v[36:39], v[64:71], v1
ds_read_b64_tr_b16 v[10:11], v4 offset:512
s_mov_b64 s[70:71], s[74:75]
ds_read_b64_tr_b16 v[8:9], v4 offset:0
s_waitcnt lgkmcnt(6)
s_waitcnt lgkmcnt(5)
ds_read_b64_tr_b16 v[12:13], v4 offset:1024
v_smfmac_f32_16x16x64_bf16 v[20:23], v[40:43], a[216:223], v1
ds_read_b64_tr_b16 v[14:15], v4 offset:1536
s_waitcnt lgkmcnt(6)
ds_read_b128 v[68:71], v2 offset:19456
v_smfmac_f32_16x16x64_bf16 v[16:19], v[40:43], v[72:79], v1
s_waitcnt lgkmcnt(6)
ds_read_b128 v[36:39], v0 offset:8192
s_waitcnt lgkmcnt(6)
v_smfmac_f32_16x16x64_bf16 v[20:23], v[32:35], v[80:87], v1
ds_read_b128 v[64:67], v2 offset:18432
ds_read_b128 v[40:43], v0 offset:9216
v_smfmac_f32_16x16x64_bf16 v[16:19], v[32:35], a[224:231], v1
s_waitcnt lgkmcnt(6)
ds_read_b128 v[72:75], v2 offset:20480
ds_read_b128 v[32:35], v0 offset:1024
v_mfma_f32_16x16x32_bf16 v[44:47], v[48:51], v[8:11], 0
s_waitcnt lgkmcnt(6)
ds_read_b128 v[76:79], v2 offset:21504
v_add_f32 v21, v21, v23
v_add_f32 v20, v20, v22
v_bfe_u32 v48, v0, 5, 1
v_mfma_f32_16x16x32_bf16 v[44:47], v[52:55], v[12:15], v[44:47]
s_waitcnt lgkmcnt(5)
ds_read_b128 v[80:83], v2 offset:22528
v_add_f32 v17, v17, v19
v_add_f32 v16, v16, v18
v_cvt_pk_bf16_f32 v20, v20, v21
v_lshl_add_u32 v48, v48, 3, v5
v_cvt_pk_bf16_f32 v16, v16, v17
v_smfmac_f32_16x16x64_bf16 v[28:31], v[36:39], a[232:239], v1
s_waitcnt lgkmcnt(4)
ds_write2_b32 v3, v16, v20 offset0:1 offset1:129
v_cndmask_b32_dpp v44, v46, v44, vcc quad_perm:[0,1,0,1] row_mask:0xf bank_mask:0xf
v_cndmask_b32_dpp v45, v47, v45, vcc quad_perm:[0,1,0,1] row_mask:0xf bank_mask:0xf
v_smfmac_f32_16x16x64_bf16 v[24:27], v[36:39], v[64:71], v1
s_waitcnt lgkmcnt(3)
ds_write_b64 v48, v[44:45] offset:6144
v_smfmac_f32_16x16x64_bf16 v[24:27], v[40:43], a[240:247], v1
s_waitcnt lgkmcnt(3)
global_load_dwordx4 v[64:67], v0, s[78:79] offset:0 sc1
ds_read_b128 v[36:39], v0 offset:5120
v_smfmac_f32_16x16x64_bf16 v[28:31], v[40:43], v[72:79], v1
s_waitcnt lgkmcnt(3)
global_load_dwordx4 v[68:71], v0, s[78:79] offset:1024 sc1
ds_read_b128 v[84:87], v2 offset:23552
v_smfmac_f32_16x16x64_bf16 v[24:27], v[32:35], a[248:255], v1
global_load_dwordx4 v[72:75], v0, s[78:79] offset:2048 sc1
ds_read_b128 v[40:43], v0 offset:2048
v_smfmac_f32_16x16x64_bf16 v[28:31], v[32:35], v[88:95], v1
s_waitcnt lgkmcnt(3)
ds_read_b128 v[32:35], v0 offset:6144
s_barrier
ds_read_b128 v[52:55], v6 offset:7168
s_waitcnt lgkmcnt(4)
v_smfmac_f32_16x16x64_bf16 v[28:31], v[36:39], v[96:103], v1
s_waitcnt lgkmcnt(3)
ds_read_b128 v[48:51], v6 offset:6144
ds_read_b64_tr_b16 v[8:9], v4 offset:0
v_smfmac_f32_16x16x64_bf16 v[24:27], v[36:39], v[80:87], v1
s_waitcnt lgkmcnt(4)
ds_read_b128 v[36:39], v0 offset:3072
global_load_dwordx4 v[76:79], v0, s[78:79] offset:3072 sc1
ds_read_b64_tr_b16 v[10:11], v4 offset:512
v_smfmac_f32_16x16x64_bf16 v[28:31], v[40:43], v[112:119], v1
s_waitcnt lgkmcnt(5)
ds_read_b64_tr_b16 v[14:15], v4 offset:1536
ds_read_b64_tr_b16 v[18:19], v4 offset:2560
v_smfmac_f32_16x16x64_bf16 v[24:27], v[40:43], v[104:111], v1
s_waitcnt lgkmcnt(6)
ds_read_b64_tr_b16 v[12:13], v4 offset:1024
ds_read_b64_tr_b16 v[16:17], v4 offset:2048
v_smfmac_f32_16x16x64_bf16 v[28:31], v[32:35], v[128:135], v1
s_waitcnt lgkmcnt(7)
ds_read_b64_tr_b16 v[22:23], v4 offset:3584
v_add_f32 v50, v50, v54
v_add_f32 v49, v49, v53
v_smfmac_f32_16x16x64_bf16 v[24:27], v[32:35], v[120:127], v1
s_waitcnt lgkmcnt(6)
ds_read_b128 v[40:43], v0 offset:7168
v_add_f32 v48, v48, v52
v_smfmac_f32_16x16x64_bf16 v[24:27], v[36:39], v[136:143], v1
s_waitcnt lgkmcnt(5)
ds_read_b64_tr_b16 v[20:21], v4 offset:3072
v_add_f32 v51, v51, v55
v_smfmac_f32_16x16x64_bf16 v[28:31], v[36:39], v[144:151], v1
s_waitcnt lgkmcnt(4)
global_load_dwordx4 v[80:83], v0, s[80:81] offset:-4096 sc1
v_exp_f32 v51, v51
v_mfma_f32_16x16x32_bf16 v[44:47], v[8:11], v[8:11], 0
s_waitcnt lgkmcnt(3)
v_exp_f32 v49, v49
v_mfma_f32_16x16x32_bf16 v[44:47], v[12:15], v[12:15], v[44:47]
s_waitcnt lgkmcnt(1)
v_exp_f32 v50, v50
v_exp_f32 v48, v48
v_mfma_f32_16x16x32_bf16 v[44:47], v[16:19], v[16:19], v[44:47]
s_waitcnt lgkmcnt(0)
v_cvt_pk_bf16_f32 v55, v50, v51
v_cvt_pk_bf16_f32 v54, v48, v49
v_mfma_f32_16x16x32_bf16 v[44:47], v[20:23], v[20:23], v[44:47]
v_mov_b64 v[22:23], s[44:45]
v_mov_b32_dpp v50, v54 quad_perm:[2,3,2,3] row_mask:0xf bank_mask:0xf
v_mov_b32_dpp v49, v55 quad_perm:[0,1,0,1] row_mask:0xf bank_mask:0xf
v_mov_b32_dpp v51, v55 quad_perm:[2,3,2,3] row_mask:0xf bank_mask:0xf
v_smfmac_f32_16x16x64_bf16 v[24:27], v[40:43], v[152:159], v1
v_mov_b32_dpp v48, v54 quad_perm:[0,1,0,1] row_mask:0xf bank_mask:0xf
v_mov_b64 v[20:21], s[44:45]
v_smfmac_f32_16x16x64_bf16 v[28:31], v[40:43], v[160:167], v1
s_waitcnt vmcnt(7)
global_load_dwordx4 v[84:87], v0, s[80:81] offset:-3072 sc1
v_exp_f32_dpp v44, v46 quad_perm:[0,1,0,1] row_mask:0xf bank_mask:0xf
v_mfma_f32_16x16x32_bf16 v[8:11], v[56:59], v[48:51], 0
v_exp_f32_dpp v45, v47 quad_perm:[0,1,0,1] row_mask:0xf bank_mask:0xf
v_mfma_f32_16x16x32_bf16 v[16:19], v[20:23], v[48:51], 0
s_waitcnt vmcnt(7)
v_cvt_pk_bf16_f32 v53, v44, v45
v_mov_b64 v[54:55], s[46:47]
v_mfma_f32_16x16x32_bf16 v[12:15], v[60:63], v[48:51], 0
v_cvt_pk_bf16_f32 v52, v44, v45
v_cvt_pk_bf16_f32 v24, v24, v25
v_cvt_pk_bf16_f32 v25, v26, v27
v_mfma_f32_16x16x16_bf16 v[16:19], v[54:55], v[52:53], v[16:19]
s_min_u32 s34, s34, s32
v_cvt_pk_bf16_f32 v26, v28, v29
v_cvt_pk_bf16_f32 v27, v30, v31
v_mfma_f32_16x16x16_bf16 v[8:11], v[24:25], v[52:53], v[8:11]
ds_read_b128 v[28:31], v0 offset:19456
v_mov_b64 v[42:43], 0
v_mfma_f32_16x16x16_bf16 v[12:15], v[26:27], v[52:53], v[12:15]
s_waitcnt vmcnt(4)
v_bfe_u32 v32, v0, 5, 1
v_mov_b64 v[36:37], 0
v_subrev_u32 v17, s37, v16
v_rcp_f32 v18, v16
v_lshl_add_u32 v32, v32, 3, v5
v_mov_b64 v[38:39], 0
v_cmp_lt_u32 vcc, s38, v17
v_cndmask_b32 v9, v13, v9, s[42:43]
v_cndmask_b32 v8, v12, v8, s[42:43]
v_cndmask_b32 v10, v14, v10, s[42:43]
v_mul_f32 v10, v10, v18
v_cndmask_b32 v11, v15, v11, s[42:43]
v_mul_f32 v9, v9, v18
v_mul_f32 v8, v8, v18
v_mul_f32 v11, v11, v18
v_cvt_pk_bf16_f32 v12, v8, v9
v_cvt_pk_bf16_f32 v13, v10, v11
s_cbranch_vccnz rare_10011
back_10012:
ds_write_b64 v32, v[12:13] offset:0
v_mov_b32_dpp v9, v13 quad_perm:[0,1,0,1] row_mask:0xf bank_mask:0xf
v_mov_b32_dpp v10, v12 quad_perm:[2,3,2,3] row_mask:0xf bank_mask:0xf
v_mov_b32_dpp v8, v12 quad_perm:[0,1,0,1] row_mask:0xf bank_mask:0xf
v_mov_b32_dpp v11, v13 quad_perm:[2,3,2,3] row_mask:0xf bank_mask:0xf
v_mov_b64 v[54:55], 0
v_mov_b64 v[52:53], 0
v_smfmac_f32_16x16x64_bf16 v[36:39], v[8:11], v[64:71], v1
s_waitcnt vmcnt(2)
ds_read_b128 v[20:23], v0 offset:17408
global_load_dwordx4 v[64:67], v0, s[76:77] offset:-4096 sc1
ds_read_b128 v[16:19], v0 offset:16384
v_mov_b64 v[34:35], 0
v_mov_b64 v[32:33], 0
v_mov_b64 v[40:41], 0
v_smfmac_f32_16x16x64_bf16 v[52:55], v[8:11], v[176:183], v1
s_waitcnt lgkmcnt(2)
ds_read_b128 v[24:27], v0 offset:18432
s_barrier
ds_read_b128 v[56:59], v5 offset:512
global_load_dwordx4 v[68:71], v0, s[76:77] offset:-3072 sc1
ds_read_b128 v[12:15], v5 offset:1536
v_mov_b64 v[48:49], 0
v_smfmac_f32_16x16x64_bf16 v[40:43], v[8:11], v[72:79], v1
s_waitcnt vmcnt(2)
ds_read_b128 v[60:63], v5 offset:1024
v_mov_b64 v[50:51], 0
v_smfmac_f32_16x16x64_bf16 v[32:35], v[8:11], v[80:87], v1
global_load_dwordx4 v[72:75], v0, s[76:77] offset:-2048 sc1
ds_read_b128 v[80:83], v0 offset:20480
v_smfmac_f32_16x16x64_bf16 v[48:51], v[8:11], v[168:175], v1
s_waitcnt lgkmcnt(5)
s_waitcnt lgkmcnt(3)
ds_read_b128 v[84:87], v0 offset:21504
v_smfmac_f32_16x16x64_bf16 v[40:43], v[56:59], v[192:199], v1
global_load_dwordx4 v[76:79], v0, s[76:77] offset:-1024 sc1
v_smfmac_f32_16x16x64_bf16 v[36:39], v[56:59], v[16:23], v1
s_waitcnt lgkmcnt(2)
ds_read_b128 v[20:23], v0 offset:23552
v_lshrrev_b32 v44, 8, v0
v_smfmac_f32_16x16x64_bf16 v[36:39], v[60:63], v[24:31], v1
ds_read_b128 v[16:19], v0 offset:22528
v_bfe_u32 v45, v0, 1, 7
v_smfmac_f32_16x16x64_bf16 v[36:39], v[12:15], v[184:191], v1
s_waitcnt lgkmcnt(3)
ds_read_b128 v[28:31], v0 offset:25600
s_waitcnt lgkmcnt(3)
v_smfmac_f32_16x16x64_bf16 v[40:43], v[60:63], v[80:87], v1
ds_read_b128 v[24:27], v0 offset:24576
v_lshl_or_b32 v44, v44, 12, v45
v_smfmac_f32_16x16x64_bf16 v[40:43], v[12:15], v[200:207], v1
ds_read_b128 v[80:83], v0 offset:26624
v_cvt_pk_bf16_f32 v36, v36, v37
v_smfmac_f32_16x16x64_bf16 v[32:35], v[56:59], v[232:239], v1
ds_read_b128 v[84:87], v0 offset:27648
v_cvt_pk_bf16_f32 v37, v38, v39
v_and_or_b32 v36, v36, -2, s18
v_smfmac_f32_16x16x64_bf16 v[52:55], v[56:59], v[216:223], v1
global_store_dwordx2 v44, v[36:37], s[48:49]
s_waitcnt lgkmcnt(3)
v_cvt_pk_bf16_f32 v40, v40, v41
v_smfmac_f32_16x16x64_bf16 v[48:51], v[56:59], v[16:23], v1
s_waitcnt lgkmcnt(2)
s_waitcnt lgkmcnt(1)
v_and_or_b32 v40, v40, -2, s18
v_smfmac_f32_16x16x64_bf16 v[48:51], v[60:63], v[24:31], v1
v_cvt_pk_bf16_f32 v41, v42, v43
v_smfmac_f32_16x16x64_bf16 v[48:51], v[12:15], v[208:215], v1
s_waitcnt lgkmcnt(0)
global_store_dwordx2 v44, v[40:41], s[50:51]
v_smfmac_f32_16x16x64_bf16 v[32:35], v[60:63], v[240:247], v1
s_nop 1
v_smfmac_f32_16x16x64_bf16 v[52:55], v[60:63], v[80:87], v1
s_add_u32 s27, s20, 524288
s_add_u32 s58, s4, s20
v_cvt_pk_bf16_f32 v48, v48, v49
v_and_or_b32 v48, v48, -2, s18
v_cvt_pk_bf16_f32 v49, v50, v51
v_smfmac_f32_16x16x64_bf16 v[52:55], v[12:15], v[224:231], v1
s_nop 0
global_store_dwordx2 v44, v[48:49], s[52:53]
s_addc_u32 s59, s5, 0
s_mov_b32 s30, 0
v_smfmac_f32_16x16x64_bf16 v[32:35], v[12:15], v[248:255], v1
s_nop 2
v_cvt_pk_bf16_f32 v52, v52, v53
v_cvt_pk_bf16_f32 v53, v54, v55
s_mov_b32 s19, 1
v_and_or_b32 v52, v52, -2, s18
global_store_dwordx2 v44, v[52:53], s[54:55]
v_cvt_pk_bf16_f32 v32, v32, v33
v_cvt_pk_bf16_f32 v33, v34, v35
v_and_or_b32 v32, v32, -2, s18
global_store_dwordx2 v44, v[32:33], s[56:57]
v_bfe_u32 v32, v0, 6, 1
v_lshlrev_b32 v32, 4, v32
v_mov_b32 v33, 0x3f80
v_lshlrev_b32 v32, v32, v33
v_bfe_i32 v33, v0, 4, 1
v_and_b32 v45, v32, v33
v_and_b32 v47, v32, v33
v_xor_b32 v44, v32, v45
v_xor_b32 v46, v32, v45
v_and_b32 v36, 32, v0
v_bfe_u32 v37, v0, 6, 1
v_lshl_add_u32 v36, v37, 8, v36
v_bfe_u32 v37, v0, 8, 1
v_lshl_add_u32 v36, v37, 4, v36
v_bfe_u32 v37, v0, 4, 1
v_lshl_add_u32 v36, v37, 3, v36
v_and_b32 v7, 255, v0
v_lshl_add_u32 v7, v7, 3, s27
s_nop 15
s_nop 15
s_nop 15
s_nop 8
global_load_dwordx4 v[8:11], v0, s[64:65] offset:0 sc1
global_load_dwordx4 v[12:15], v0, s[64:65] offset:1024 sc1
global_load_dwordx4 v[16:19], v0, s[64:65] offset:2048 sc1
global_load_dwordx4 v[20:23], v0, s[64:65] offset:3072 sc1
chk_10023:
v_mov_b64 v[40:41], 0
v_mov_b64 v[42:43], 0
s_waitcnt vmcnt(2)
s_nop 0
v_smfmac_f32_16x16x64_bf16 v[40:43], v[44:47], v[8:15], v1
v_bitop3_b32 v32, v8, v10, s18 bitop3:0x7e
v_bitop3_b32 v33, v12, v14, s18 bitop3:0x7e
s_waitcnt vmcnt(0)
v_smfmac_f32_16x16x64_bf16 v[40:43], v[44:47], v[16:23], v1
v_bitop3_b32 v34, v16, v18, s18 bitop3:0x7e
v_bitop3_b32 v35, v20, v22, s18 bitop3:0x7e
v_or3_b32 v32, v32, v33, v34
v_bitop3_b32 v32, v32, v35, 1 bitop3:0xa8
v_cmp_ne_u32 vcc, 0, v32
s_cbranch_vccnz chk_10023_f
s_nop 1
v_add_f32_dpp v40, v40, v40 row_ror:8 row_mask:0xf bank_mask:0xf
v_add_f32_dpp v41, v41, v41 row_ror:8 row_mask:0xf bank_mask:0xf
v_add_f32_dpp v42, v42, v42 row_ror:8 row_mask:0xf bank_mask:0xf
v_add_f32_dpp v43, v43, v43 row_ror:8 row_mask:0xf bank_mask:0xf
v_cvt_pk_bf16_f32 v40, v40, v41
v_cvt_pk_bf16_f32 v41, v42, v43
v_and_or_b32 v40, v40, -2, s18
s_mov_b64 exec, 0x00ff00ff
global_store_dwordx2 v36, v[40:41], s[66:67]
s_mov_b64 exec, -1
s_branch join_10022
chk_10023_f:
global_load_dwordx4 v[8:11], v0, s[64:65] offset:0 sc1
global_load_dwordx4 v[12:15], v0, s[64:65] offset:1024 sc1
global_load_dwordx4 v[16:19], v0, s[64:65] offset:2048 sc1
global_load_dwordx4 v[20:23], v0, s[64:65] offset:3072 sc1
s_add_u32 s30, s30, 1
s_cmp_le_u32 s30, 262144
s_cbranch_scc1 chk_10023
s_branch L_fail
nored_10021:
join_10022:
s_nop 11
s_barrier
global_load_dwordx4 v[56:59], v0, s[76:77] offset:0 sc1
global_load_dwordx4 v[60:63], v0, s[76:77] offset:1024 sc1
global_load_dwordx4 v[80:83], v0, s[76:77] offset:2048 sc1
global_load_dwordx4 v[84:87], v0, s[76:77] offset:3072 sc1
s_nop 15
s_nop 15
s_nop 3
s_barrier
global_load_dwordx4 v[32:35], v0, s[68:69] offset:-4096 sc1
s_nop 10
global_load_dwordx4 v[36:39], v0, s[68:69] offset:0 sc1
s_nop 10
global_load_dwordx4 v[40:43], v0, s[70:71] offset:0 sc1
s_barrier
global_load_dwordx4 v[48:51], v0, s[58:59] offset:0 nt sc1
global_load_dwordx4 v[52:55], v0, s[58:59] offset:1024 nt sc1
v_mov_b64 v[8:9], 0
v_mov_b64 v[10:11], 0
v_mov_b64 v[12:13], 0
v_mov_b64 v[14:15], 0
v_mov_b64 v[16:17], 0
v_mov_b64 v[18:19], 0
v_mov_b64 v[20:21], 0
v_mov_b64 v[22:23], 0
v_mov_b64 v[24:25], 0
v_mov_b64 v[26:27], 0
v_mov_b64 v[28:29], 0
v_mov_b64 v[30:31], 0
s_mov_b32 s30, 0
s_cmp_eq_u32 s17, s31
s_cbranch_scc0 gather_10010
s_branch exit_10013
rt_10015:
global_load_dwordx4 v[32:35], v0, s[68:69] offset:-4096 sc1
global_load_dwordx4 v[36:39], v0, s[68:69] offset:0 sc1
global_load_dwordx4 v[40:43], v0, s[70:71] offset:0 sc1
s_add_u32 s30, s30, 1
s_cmp_gt_u32 s30, 262144
s_cbranch_scc1 L_fail
s_mov_b64 exec, 1
global_store_dword v0, v0, s[62:63]
global_store_dword v0, v0, s[62:63]
s_mov_b64 exec, -1
v_mov_b64 v[8:9], 0
v_mov_b64 v[10:11], 0
v_mov_b64 v[12:13], 0
v_mov_b64 v[14:15], 0
v_mov_b64 v[16:17], 0
v_mov_b64 v[18:19], 0
v_mov_b64 v[20:21], 0
v_mov_b64 v[22:23], 0
v_mov_b64 v[24:25], 0
v_mov_b64 v[26:27], 0
v_mov_b64 v[28:29], 0
v_mov_b64 v[30:31], 0
s_branch gather_10010
rare_10011:
ds_read_b128 v[48:51], v6 offset:6144
ds_read_b128 v[52:55], v6 offset:7168
s_waitcnt lgkmcnt(0)
v_add_f32 v48, v48, v52
v_add_f32 v49, v49, v53
v_add_f32 v50, v50, v54
v_add_f32 v51, v51, v55
v_mov_b32_dpp v46, v46 quad_perm:[0,1,0,1] row_mask:0xf bank_mask:0xf
v_mov_b32_dpp v47, v47 quad_perm:[0,1,0,1] row_mask:0xf bank_mask:0xf
v_max3_f32 v19, v48, v49, v50
v_max3_f32 v19, v19, v51, v46
v_max_f32 v19, v19, v47
s_nop 1
v_max_f32_dpp v19, v19, v19 quad_perm:[2,3,0,1] row_mask:0xf bank_mask:0xf
v_mov_b32 v44, v19
s_nop 1
v_permlane32_swap_b32 v19, v44
v_max_f32 v19, v19, v44
v_mov_b32 v44, v19
s_nop 1
v_permlane16_swap_b32 v19, v44
v_max_f32 v19, v19, v44
v_sub_f32 v48, v48, v19
v_sub_f32 v49, v49, v19
v_sub_f32 v50, v50, v19
v_sub_f32 v51, v51, v19
v_sub_f32 v46, v46, v19
v_sub_f32 v47, v47, v19
v_exp_f32 v48, v48
v_exp_f32 v49, v49
v_exp_f32 v50, v50
v_exp_f32 v51, v51
v_cvt_pk_bf16_f32 v54, v48, v49
v_cvt_pk_bf16_f32 v55, v50, v51
s_nop 0
v_mov_b32_dpp v48, v54 quad_perm:[0,1,0,1] row_mask:0xf bank_mask:0xf
v_mov_b32_dpp v49, v55 quad_perm:[0,1,0,1] row_mask:0xf bank_mask:0xf
v_mov_b32_dpp v50, v54 quad_perm:[2,3,2,3] row_mask:0xf bank_mask:0xf
v_mov_b32_dpp v51, v55 quad_perm:[2,3,2,3] row_mask:0xf bank_mask:0xf
v_mov_b64 v[20:21], s[44:45]
v_mov_b64 v[22:23], s[44:45]
v_mfma_f32_16x16x32_bf16 v[8:11], v[56:59], v[48:51], 0
v_mfma_f32_16x16x32_bf16 v[12:15], v[60:63], v[48:51], 0
v_mfma_f32_16x16x32_bf16 v[16:19], v[20:23], v[48:51], 0
v_mov_b64 v[54:55], s[46:47]
v_exp_f32_dpp v44, v46 quad_perm:[0,1,0,1] row_mask:0xf bank_mask:0xf
v_exp_f32_dpp v45, v47 quad_perm:[0,1,0,1] row_mask:0xf bank_mask:0xf
s_nop 0
v_cvt_pk_bf16_f32 v52, v44, v45
v_cvt_pk_bf16_f32 v53, v44, v45
s_nop 1
v_mfma_f32_16x16x16_bf16 v[16:19], v[54:55], v[52:53], v[16:19]
v_mfma_f32_16x16x16_bf16 v[8:11], v[24:25], v[52:53], v[8:11]
v_mfma_f32_16x16x16_bf16 v[12:15], v[26:27], v[52:53], v[12:15]
s_nop 5
v_rcp_f32 v18, v16
s_nop 0
v_cndmask_b32 v8, v12, v8, s[42:43]
v_mul_f32 v8, v8, v18
v_cndmask_b32 v9, v13, v9, s[42:43]
v_mul_f32 v9, v9, v18
v_cndmask_b32 v10, v14, v10, s[42:43]
v_mul_f32 v10, v10, v18
v_cndmask_b32 v11, v15, v11, s[42:43]
v_mul_f32 v11, v11, v18
v_cvt_pk_bf16_f32 v12, v8, v9
v_cvt_pk_bf16_f32 v13, v10, v11
s_branch back_10012
exit_10013:
global_load_dwordx4 v[32:35], v0, s[68:69] offset:-4096 sc1
global_load_dwordx4 v[36:39], v0, s[68:69] offset:0 sc1
global_load_dwordx4 v[40:43], v0, s[70:71] offset:0 sc1
s_add_u32 s30, s30, 1
s_cmp_gt_u32 s30, 262144
s_cbranch_scc1 L_fail
s_waitcnt vmcnt(2)
v_bitop3_b32 v44, v32, v34, s18 bitop3:0x7e
s_waitcnt vmcnt(1)
v_bitop3_b32 v45, v36, v38, s18 bitop3:0x7e
v_or_b32 v44, v44, v45
s_waitcnt vmcnt(0)
v_bitop3_b32 v46, v40, v42, s18 bitop3:0x7e
v_bitop3_b32 v44, v44, v46, s19 bitop3:0xa8
v_cmp_ne_u32 vcc, 0, v44
s_cbranch_vccnz exit_10013
s_add_u32 s36, s36, 1
s_cmp_lt_u32 s36, 2
s_cbranch_scc1 layer_10009
s_endpgm
wave_10006:
layer_10024:
s_lshl_b32 s17, s36, 6
s_mul_i32 s27, s36, 35651584
s_mul_i32 s28, s14, 16384
s_add_u32 s27, s27, s28
s_add_u32 s20, s27, 16781312
s_mul_i32 s27, s17, 10240
s_add_u32 s27, s27, s24
s_add_u32 s21, s27, s25
s_mov_b32 s19, 0
s_mov_b32 s33, s6
s_add_u32 s34, s17, 1
s_add_u32 s31, s17, 63
s_add_u32 s32, s17, 64
s_mov_b32 s27, s20
v_mov_b32 v7, 0
s_add_u32 s68, s4, 414720
s_addc_u32 s69, s5, 0
s_add_u32 s72, s4, 398336
s_addc_u32 s73, s5, 0
s_add_u32 s70, s4, 418816
s_addc_u32 s71, s5, 0
s_add_u32 s74, s4, 402432
s_addc_u32 s75, s5, 0
s_add_u32 s58, s4, s20
s_addc_u32 s59, s5, 0
global_load_dwordx4 v[64:67], v0, s[76:77] offset:-4096 sc1
global_load_dwordx4 v[68:71], v0, s[76:77] offset:-3072 sc1
global_load_dwordx4 v[72:75], v0, s[76:77] offset:-2048 sc1
global_load_dwordx4 v[76:79], v0, s[76:77] offset:-1024 sc1
global_load_dwordx4 v[80:83], v0, s[76:77] offset:2048 sc1
global_load_dwordx4 v[84:87], v0, s[76:77] offset:3072 sc1
global_load_dwordx4 v[56:59], v0, s[76:77] offset:0 sc1
global_load_dwordx4 v[60:63], v0, s[76:77] offset:1024 sc1
v_mov_b64 v[8:9], 0
v_mov_b64 v[10:11], 0
v_mov_b64 v[12:13], 0
v_mov_b64 v[14:15], 0
v_mov_b64 v[16:17], 0
v_mov_b64 v[18:19], 0
v_mov_b64 v[20:21], 0
v_mov_b64 v[22:23], 0
v_mov_b64 v[24:25], 0
v_mov_b64 v[26:27], 0
v_mov_b64 v[28:29], 0
v_mov_b64 v[30:31], 0
s_barrier
global_load_dwordx4 v[48:51], v0, s[58:59] offset:0 nt sc1
global_load_dwordx4 v[52:55], v0, s[58:59] offset:1024 nt sc1
v_and_b32 v7, 255, v0
v_lshl_add_u32 v7, v7, 3, s27
global_load_dwordx4 v[32:35], v0, s[68:69] offset:-4096 sc1
global_load_dwordx4 v[36:39], v0, s[68:69] offset:0 sc1
global_load_dwordx4 v[40:43], v0, s[70:71] offset:0 sc1
s_mov_b32 s30, 0
s_waitcnt vmcnt(0)
.p2align 6
gather_10025:
s_waitcnt vmcnt(4)
rt_10030_b:
v_smfmac_f32_16x16x64_bf16 v[24:27], v[32:35], a[0:7], v1
ds_write_b128 v0, v[32:35] offset:1024
v_smfmac_f32_16x16x64_bf16 v[8:11], v[32:35], v[64:71], v1
v_bitop3_b32 v44, v32, v34, s18 bitop3:0x7e
v_smfmac_f32_16x16x64_bf16 v[12:15], v[32:35], v[72:79], v1
s_waitcnt vmcnt(3)
ds_write_b128 v0, v[36:39] offset:5120
v_bitop3_b32 v45, v36, v38, s18 bitop3:0x7e
v_or_b32 v44, v44, v45
s_waitcnt vmcnt(2)
v_bitop3_b32 v45, v40, v42, s18 bitop3:0x7e
v_bitop3_b32 v44, v44, v45, s19 bitop3:0xa8
v_cmp_ne_u32 vcc, 0, v44
v_smfmac_f32_16x16x64_bf16 v[8:11], v[36:39], a[16:23], v1
ds_write_b128 v0, v[40:43] offset:9216
v_smfmac_f32_16x16x64_bf16 v[20:23], v[32:35], v[80:87], v1
s_cbranch_vccnz rt_10030
global_load_dwordx4 v[64:67], v0, s[78:79] offset:-4096 sc1
ds_read_b128 v[80:83], v2 offset:0
v_smfmac_f32_16x16x64_bf16 v[28:31], v[32:35], a[8:15], v1
global_load_dwordx4 v[68:71], v0, s[78:79] offset:-3072 sc1
ds_read_b128 v[84:87], v2 offset:1024
v_smfmac_f32_16x16x64_bf16 v[20:23], v[36:39], a[40:47], v1
s_waitcnt lgkmcnt(2)
global_load_dwordx4 v[72:75], v0, s[78:79] offset:-2048 sc1
global_load_dwordx4 v[76:79], v0, s[78:79] offset:-1024 sc1
v_smfmac_f32_16x16x64_bf16 v[16:19], v[32:35], v[56:63], v1
s_barrier
ds_read_b128 v[40:43], v0 offset:0
v_smfmac_f32_16x16x64_bf16 v[16:19], v[36:39], a[32:39], v1
s_xor_b32 s18, s18, 1
s_waitcnt lgkmcnt(1)
ds_read_b128 v[44:47], v0 offset:4096
v_smfmac_f32_16x16x64_bf16 v[28:31], v[36:39], v[80:87], v1
ds_read_b128 v[80:83], v2 offset:2048
v_smfmac_f32_16x16x64_bf16 v[24:27], v[36:39], a[48:55], v1
s_mov_b64 s[68:69], s[72:73]
ds_read_b128 v[32:35], v0 offset:3072
v_smfmac_f32_16x16x64_bf16 v[12:15], v[36:39], a[24:31], v1
ds_read_b128 v[84:87], v2 offset:3072
s_waitcnt lgkmcnt(4)
v_smfmac_f32_16x16x64_bf16 v[8:11], v[40:43], a[56:63], v1
ds_read_b128 v[36:39], v0 offset:7168
v_smfmac_f32_16x16x64_bf16 v[12:15], v[40:43], a[64:71], v1
s_add_u32 s20, s20, 524288
s_waitcnt lgkmcnt(4)
ds_read_b128 v[40:43], v0 offset:2048
v_smfmac_f32_16x16x64_bf16 v[12:15], v[44:47], a[80:87], v1
s_add_u32 s17, s17, 1
global_load_dwordx4 v[56:59], v0, s[58:59] offset:2048 nt sc1
v_smfmac_f32_16x16x64_bf16 v[8:11], v[44:47], a[72:79], v1
s_waitcnt lgkmcnt(3)
ds_read_b128 v[44:47], v0 offset:6144
s_waitcnt lgkmcnt(3)
v_smfmac_f32_16x16x64_bf16 v[12:15], v[32:35], v[80:87], v1
s_add_u32 s21, s21, 10240
ds_read_b128 v[80:83], v2 offset:4096
v_smfmac_f32_16x16x64_bf16 v[8:11], v[32:35], a[88:95], v1
s_waitcnt lgkmcnt(3)
ds_read_b128 v[84:87], v2 offset:5120
s_waitcnt lgkmcnt(3)
v_smfmac_f32_16x16x64_bf16 v[12:15], v[36:39], a[104:111], v1
ds_read_b128 v[32:35], v0 offset:9216
v_smfmac_f32_16x16x64_bf16 v[8:11], v[36:39], a[96:103], v1
ds_read_b128 v[36:39], v0 offset:8192
v_smfmac_f32_16x16x64_bf16 v[8:11], v[40:43], a[112:119], v1
s_waitcnt lgkmcnt(4)
global_load_dwordx4 v[60:63], v0, s[58:59] offset:3072 nt sc1
v_smfmac_f32_16x16x64_bf16 v[12:15], v[40:43], a[120:127], v1
s_waitcnt lgkmcnt(2)
ds_read_b128 v[40:43], v0 offset:0
v_smfmac_f32_16x16x64_bf16 v[12:15], v[44:47], v[80:87], v1
s_waitcnt lgkmcnt(2)
ds_read_b128 v[84:87], v2 offset:7168
v_smfmac_f32_16x16x64_bf16 v[8:11], v[44:47], a[128:135], v1
s_waitcnt vmcnt(5)
s_waitcnt lgkmcnt(2)
ds_read_b128 v[80:83], v2 offset:6144
v_smfmac_f32_16x16x64_bf16 v[12:15], v[32:35], a[144:151], v1
global_load_dword v7, v7, s[4:5] sc1
v_smfmac_f32_16x16x64_bf16 v[8:11], v[32:35], a[136:143], v1
ds_read_b128 v[32:35], v0 offset:4096
s_waitcnt vmcnt(5)
v_smfmac_f32_16x16x64_bf16 v[8:11], v[36:39], v[64:71], v1
s_nop 0
ds_read_b128 v[68:71], v2 offset:9216
s_waitcnt lgkmcnt(3)
v_smfmac_f32_16x16x64_bf16 v[12:15], v[36:39], a[152:159], v1
s_nop 0
ds_read_b128 v[64:67], v2 offset:8192
s_waitcnt lgkmcnt(3)
ds_read_b128 v[36:39], v0 offset:3072
v_add_f32 v8, v8, v10
v_smfmac_f32_16x16x64_bf16 v[20:23], v[40:43], v[80:87], v1
ds_read_b128 v[84:87], v2 offset:11264
v_mul_f32 v8, s35, v8
v_smfmac_f32_16x16x64_bf16 v[16:19], v[40:43], a[160:167], v1
s_waitcnt lgkmcnt(4)
ds_read_b128 v[40:43], v0 offset:7168
v_add_f32 v9, v9, v11
v_smfmac_f32_16x16x64_bf16 v[20:23], v[32:35], a[176:183], v1
ds_read_b128 v[80:83], v2 offset:10240
v_mul_f32 v9, s35, v9
v_add_f32 v13, v13, v15
v_cvt_pk_bf16_f32 v8, v8, v9
v_add_f32 v12, v12, v14
v_smfmac_f32_16x16x64_bf16 v[16:19], v[32:35], a[168:175], v1
s_waitcnt lgkmcnt(3)
ds_read_b128 v[32:35], v0 offset:2048
v_mul_f32 v13, s35, v13
v_smfmac_f32_16x16x64_bf16 v[16:19], v[36:39], v[64:71], v1
s_waitcnt vmcnt(3)
ds_read_b128 v[68:71], v2 offset:13312
v_mul_f32 v12, s35, v12
v_smfmac_f32_16x16x64_bf16 v[20:23], v[36:39], a[184:191], v1
s_waitcnt lgkmcnt(3)
ds_read_b128 v[36:39], v0 offset:6144
ds_read_b128 v[64:67], v2 offset:12288
v_cvt_pk_bf16_f32 v12, v12, v13
v_smfmac_f32_16x16x64_bf16 v[16:19], v[40:43], v[72:79], v1
s_waitcnt lgkmcnt(4)
ds_write2_b32 v3, v8, v12 offset0:0 offset1:128
v_smfmac_f32_16x16x64_bf16 v[20:23], v[40:43], v[80:87], v1
s_add_u32 s34, s17, 2
s_waitcnt lgkmcnt(4)
ds_read_b128 v[72:75], v2 offset:14336
v_smfmac_f32_16x16x64_bf16 v[20:23], v[32:35], a[200:207], v1
ds_read_b128 v[80:83], v2 offset:16384
v_smfmac_f32_16x16x64_bf16 v[16:19], v[32:35], a[192:199], v1
s_waitcnt lgkmcnt(4)
ds_read_b128 v[40:43], v0 offset:9216
s_mov_b64 vcc, s[42:43]
ds_read_b128 v[76:79], v2 offset:15360
v_smfmac_f32_16x16x64_bf16 v[20:23], v[36:39], a[208:215], v1
ds_read_b128 v[84:87], v2 offset:17408
s_waitcnt lgkmcnt(5)
s_barrier
ds_read_b128 v[32:35], v0 offset:8192
v_smfmac_f32_16x16x64_bf16 v[16:19], v[36:39], v[64:71], v1
ds_read_b64_tr_b16 v[10:11], v4 offset:512
s_mov_b64 s[70:71], s[74:75]
ds_read_b64_tr_b16 v[8:9], v4 offset:0
s_waitcnt lgkmcnt(6)
s_waitcnt lgkmcnt(5)
ds_read_b64_tr_b16 v[12:13], v4 offset:1024
v_smfmac_f32_16x16x64_bf16 v[20:23], v[40:43], a[216:223], v1
ds_read_b64_tr_b16 v[14:15], v4 offset:1536
s_waitcnt lgkmcnt(6)
ds_read_b128 v[68:71], v2 offset:19456
v_smfmac_f32_16x16x64_bf16 v[16:19], v[40:43], v[72:79], v1
s_waitcnt lgkmcnt(6)
ds_read_b128 v[36:39], v0 offset:9216
s_waitcnt lgkmcnt(6)
v_smfmac_f32_16x16x64_bf16 v[20:23], v[32:35], v[80:87], v1
ds_read_b128 v[64:67], v2 offset:18432
ds_read_b128 v[40:43], v0 offset:8192
v_smfmac_f32_16x16x64_bf16 v[16:19], v[32:35], a[224:231], v1
s_waitcnt lgkmcnt(6)
ds_read_b128 v[72:75], v2 offset:20480
ds_read_b128 v[32:35], v0 offset:0
v_mfma_f32_16x16x32_bf16 v[44:47], v[48:51], v[8:11], 0
s_waitcnt lgkmcnt(6)
ds_read_b128 v[76:79], v2 offset:21504
v_add_f32 v21, v21, v23
v_add_f32 v20, v20, v22
v_bfe_u32 v48, v0, 5, 1
v_mfma_f32_16x16x32_bf16 v[44:47], v[52:55], v[12:15], v[44:47]
s_waitcnt lgkmcnt(5)
ds_read_b128 v[80:83], v2 offset:22528
v_add_f32 v17, v17, v19
v_add_f32 v16, v16, v18
v_cvt_pk_bf16_f32 v20, v20, v21
v_lshl_add_u32 v48, v48, 3, v5
v_cvt_pk_bf16_f32 v16, v16, v17
v_smfmac_f32_16x16x64_bf16 v[28:31], v[36:39], a[232:239], v1
s_waitcnt lgkmcnt(4)
ds_write2_b32 v3, v16, v20 offset0:1 offset1:129
v_xor_b32 v48, 128, v48
v_cndmask_b32_dpp v44, v46, v44, vcc quad_perm:[0,1,0,1] row_mask:0xf bank_mask:0xf
v_cndmask_b32_dpp v45, v47, v45, vcc quad_perm:[0,1,0,1] row_mask:0xf bank_mask:0xf
v_smfmac_f32_16x16x64_bf16 v[24:27], v[36:39], v[64:71], v1
s_waitcnt lgkmcnt(3)
ds_write_b64 v48, v[44:45] offset:6656
v_smfmac_f32_16x16x64_bf16 v[24:27], v[40:43], a[240:247], v1
s_waitcnt lgkmcnt(3)
global_load_dwordx4 v[64:67], v0, s[78:79] offset:0 sc1
ds_read_b128 v[36:39], v0 offset:4096
v_smfmac_f32_16x16x64_bf16 v[28:31], v[40:43], v[72:79], v1
s_waitcnt lgkmcnt(3)
global_load_dwordx4 v[68:71], v0, s[78:79] offset:1024 sc1
ds_read_b128 v[84:87], v2 offset:23552
v_smfmac_f32_16x16x64_bf16 v[24:27], v[32:35], a[248:255], v1
global_load_dwordx4 v[72:75], v0, s[78:79] offset:2048 sc1
ds_read_b128 v[40:43], v0 offset:3072
v_smfmac_f32_16x16x64_bf16 v[28:31], v[32:35], v[88:95], v1
s_waitcnt lgkmcnt(3)
ds_read_b128 v[32:35], v0 offset:7168
s_barrier
ds_read_b128 v[52:55], v6 offset:7168
s_waitcnt lgkmcnt(4)
v_smfmac_f32_16x16x64_bf16 v[28:31], v[36:39], v[96:103], v1
s_waitcnt lgkmcnt(3)
ds_read_b128 v[48:51], v6 offset:6144
ds_read_b64_tr_b16 v[8:9], v4 offset:0
v_smfmac_f32_16x16x64_bf16 v[24:27], v[36:39], v[80:87], v1
s_waitcnt lgkmcnt(4)
ds_read_b128 v[36:39], v0 offset:2048
global_load_dwordx4 v[76:79], v0, s[78:79] offset:3072 sc1
ds_read_b64_tr_b16 v[10:11], v4 offset:512
v_smfmac_f32_16x16x64_bf16 v[28:31], v[40:43], v[112:119], v1
s_waitcnt lgkmcnt(5)
ds_read_b64_tr_b16 v[14:15], v4 offset:1536
ds_read_b64_tr_b16 v[18:19], v4 offset:2560
v_smfmac_f32_16x16x64_bf16 v[24:27], v[40:43], v[104:111], v1
s_waitcnt lgkmcnt(6)
ds_read_b64_tr_b16 v[12:13], v4 offset:1024
ds_read_b64_tr_b16 v[16:17], v4 offset:2048
v_smfmac_f32_16x16x64_bf16 v[28:31], v[32:35], v[128:135], v1
s_waitcnt lgkmcnt(7)
ds_read_b64_tr_b16 v[22:23], v4 offset:3584
v_add_f32 v50, v50, v54
v_add_f32 v49, v49, v53
v_smfmac_f32_16x16x64_bf16 v[24:27], v[32:35], v[120:127], v1
s_waitcnt lgkmcnt(6)
ds_read_b128 v[40:43], v0 offset:6144
v_add_f32 v48, v48, v52
v_smfmac_f32_16x16x64_bf16 v[24:27], v[36:39], v[136:143], v1
s_waitcnt lgkmcnt(5)
ds_read_b64_tr_b16 v[20:21], v4 offset:3072
v_add_f32 v51, v51, v55
v_smfmac_f32_16x16x64_bf16 v[28:31], v[36:39], v[144:151], v1
s_waitcnt lgkmcnt(4)
global_load_dwordx4 v[80:83], v0, s[80:81] offset:-4096 sc1
v_exp_f32 v51, v51
v_mfma_f32_16x16x32_bf16 v[44:47], v[8:11], v[8:11], 0
s_waitcnt lgkmcnt(3)
v_exp_f32 v49, v49
v_mfma_f32_16x16x32_bf16 v[44:47], v[12:15], v[12:15], v[44:47]
s_waitcnt lgkmcnt(1)
v_exp_f32 v50, v50
v_exp_f32 v48, v48
v_mfma_f32_16x16x32_bf16 v[44:47], v[16:19], v[16:19], v[44:47]
s_waitcnt lgkmcnt(0)
v_cvt_pk_bf16_f32 v55, v50, v51
v_cvt_pk_bf16_f32 v54, v48, v49
v_mfma_f32_16x16x32_bf16 v[44:47], v[20:23], v[20:23], v[44:47]
v_mov_b64 v[22:23], s[44:45]
v_mov_b32_dpp v50, v54 quad_perm:[2,3,2,3] row_mask:0xf bank_mask:0xf
v_mov_b32_dpp v49, v55 quad_perm:[0,1,0,1] row_mask:0xf bank_mask:0xf
v_mov_b32_dpp v51, v55 quad_perm:[2,3,2,3] row_mask:0xf bank_mask:0xf
v_smfmac_f32_16x16x64_bf16 v[24:27], v[40:43], v[152:159], v1
v_mov_b32_dpp v48, v54 quad_perm:[0,1,0,1] row_mask:0xf bank_mask:0xf
v_mov_b64 v[20:21], s[44:45]
v_smfmac_f32_16x16x64_bf16 v[28:31], v[40:43], v[160:167], v1
s_waitcnt vmcnt(7)
global_load_dwordx4 v[84:87], v0, s[80:81] offset:-3072 sc1
v_exp_f32_dpp v44, v46 quad_perm:[0,1,0,1] row_mask:0xf bank_mask:0xf
v_mfma_f32_16x16x32_bf16 v[8:11], v[56:59], v[48:51], 0
v_exp_f32_dpp v45, v47 quad_perm:[0,1,0,1] row_mask:0xf bank_mask:0xf
v_mfma_f32_16x16x32_bf16 v[16:19], v[20:23], v[48:51], 0
s_waitcnt vmcnt(7)
v_cvt_pk_bf16_f32 v53, v44, v45
v_mov_b64 v[54:55], s[46:47]
v_mfma_f32_16x16x32_bf16 v[12:15], v[60:63], v[48:51], 0
v_cvt_pk_bf16_f32 v52, v44, v45
v_cvt_pk_bf16_f32 v24, v24, v25
v_cvt_pk_bf16_f32 v25, v26, v27
v_mfma_f32_16x16x16_bf16 v[16:19], v[54:55], v[52:53], v[16:19]
s_min_u32 s34, s34, s32
v_cvt_pk_bf16_f32 v26, v28, v29
v_cvt_pk_bf16_f32 v27, v30, v31
v_mfma_f32_16x16x16_bf16 v[8:11], v[24:25], v[52:53], v[8:11]
ds_read_b128 v[28:31], v0 offset:31744
v_mov_b64 v[42:43], 0
v_mfma_f32_16x16x16_bf16 v[12:15], v[26:27], v[52:53], v[12:15]
s_waitcnt vmcnt(4)
v_bfe_u32 v32, v0, 5, 1
v_mov_b64 v[36:37], 0
v_subrev_u32 v17, s37, v16
v_rcp_f32 v18, v16
v_lshl_add_u32 v32, v32, 3, v5
v_mov_b64 v[38:39], 0
v_cmp_lt_u32 vcc, s38, v17
v_cndmask_b32 v9, v13, v9, s[42:43]
v_cndmask_b32 v8, v12, v8, s[42:43]
v_cndmask_b32 v10, v14, v10, s[42:43]
v_mul_f32 v10, v10, v18
v_cndmask_b32 v11, v15, v11, s[42:43]
v_mul_f32 v9, v9, v18
v_mul_f32 v8, v8, v18
v_mul_f32 v11, v11, v18
v_cvt_pk_bf16_f32 v12, v8, v9
v_cvt_pk_bf16_f32 v13, v10, v11
s_cbranch_vccnz rare_10026
back_10027:
ds_write_b64 v32, v[12:13] offset:512
v_mov_b32_dpp v9, v13 quad_perm:[0,1,0,1] row_mask:0xf bank_mask:0xf
v_mov_b32_dpp v10, v12 quad_perm:[2,3,2,3] row_mask:0xf bank_mask:0xf
v_mov_b32_dpp v8, v12 quad_perm:[0,1,0,1] row_mask:0xf bank_mask:0xf
v_mov_b32_dpp v11, v13 quad_perm:[2,3,2,3] row_mask:0xf bank_mask:0xf
v_mov_b64 v[54:55], 0
v_mov_b64 v[52:53], 0
v_smfmac_f32_16x16x64_bf16 v[36:39], v[8:11], v[64:71], v1
s_waitcnt vmcnt(2)
ds_read_b128 v[20:23], v0 offset:29696
global_load_dwordx4 v[64:67], v0, s[76:77] offset:-4096 sc1
ds_read_b128 v[16:19], v0 offset:28672
v_mov_b64 v[34:35], 0
v_mov_b64 v[32:33], 0
v_mov_b64 v[40:41], 0
v_smfmac_f32_16x16x64_bf16 v[52:55], v[8:11], v[176:183], v1
s_waitcnt lgkmcnt(2)
ds_read_b128 v[24:27], v0 offset:30720
s_barrier
ds_read_b128 v[56:59], v5 offset:0
global_load_dwordx4 v[68:71], v0, s[76:77] offset:-3072 sc1
ds_read_b128 v[12:15], v5 offset:1024
v_mov_b64 v[48:49], 0
v_smfmac_f32_16x16x64_bf16 v[40:43], v[8:11], v[72:79], v1
s_waitcnt vmcnt(2)
ds_read_b128 v[60:63], v5 offset:1536
v_mov_b64 v[50:51], 0
v_smfmac_f32_16x16x64_bf16 v[32:35], v[8:11], v[80:87], v1
global_load_dwordx4 v[72:75], v0, s[76:77] offset:-2048 sc1
ds_read_b128 v[80:83], v0 offset:32768
v_smfmac_f32_16x16x64_bf16 v[48:51], v[8:11], v[168:175], v1
s_waitcnt lgkmcnt(5)
s_waitcnt lgkmcnt(3)
ds_read_b128 v[84:87], v0 offset:33792
v_smfmac_f32_16x16x64_bf16 v[40:43], v[56:59], v[192:199], v1
global_load_dwordx4 v[76:79], v0, s[76:77] offset:-1024 sc1
v_smfmac_f32_16x16x64_bf16 v[36:39], v[56:59], v[16:23], v1
s_waitcnt lgkmcnt(2)
ds_read_b128 v[20:23], v0 offset:35840
v_lshrrev_b32 v44, 8, v0
v_smfmac_f32_16x16x64_bf16 v[36:39], v[60:63], v[24:31], v1
ds_read_b128 v[16:19], v0 offset:34816
v_bfe_u32 v45, v0, 1, 7
v_smfmac_f32_16x16x64_bf16 v[36:39], v[12:15], v[184:191], v1
s_waitcnt lgkmcnt(3)
ds_read_b128 v[28:31], v0 offset:37888
s_waitcnt lgkmcnt(3)
v_smfmac_f32_16x16x64_bf16 v[40:43], v[60:63], v[80:87], v1
ds_read_b128 v[24:27], v0 offset:36864
v_lshl_or_b32 v44, v44, 12, v45
v_smfmac_f32_16x16x64_bf16 v[40:43], v[12:15], v[200:207], v1
ds_read_b128 v[80:83], v0 offset:38912
v_cvt_pk_bf16_f32 v36, v36, v37
v_smfmac_f32_16x16x64_bf16 v[32:35], v[56:59], v[232:239], v1
ds_read_b128 v[84:87], v0 offset:39936
v_cvt_pk_bf16_f32 v37, v38, v39
v_and_or_b32 v36, v36, -2, s18
v_smfmac_f32_16x16x64_bf16 v[52:55], v[56:59], v[216:223], v1
global_store_dwordx2 v44, v[36:37], s[48:49]
s_waitcnt lgkmcnt(3)
v_cvt_pk_bf16_f32 v40, v40, v41
v_smfmac_f32_16x16x64_bf16 v[48:51], v[56:59], v[16:23], v1
s_waitcnt lgkmcnt(2)
s_waitcnt lgkmcnt(1)
v_and_or_b32 v40, v40, -2, s18
v_smfmac_f32_16x16x64_bf16 v[48:51], v[60:63], v[24:31], v1
v_cvt_pk_bf16_f32 v41, v42, v43
v_smfmac_f32_16x16x64_bf16 v[48:51], v[12:15], v[208:215], v1
s_waitcnt lgkmcnt(0)
global_store_dwordx2 v44, v[40:41], s[50:51]
v_smfmac_f32_16x16x64_bf16 v[32:35], v[60:63], v[240:247], v1
s_nop 1
v_smfmac_f32_16x16x64_bf16 v[52:55], v[60:63], v[80:87], v1
s_add_u32 s27, s20, 524288
s_add_u32 s58, s4, s20
v_cvt_pk_bf16_f32 v48, v48, v49
v_and_or_b32 v48, v48, -2, s18
v_cvt_pk_bf16_f32 v49, v50, v51
v_smfmac_f32_16x16x64_bf16 v[52:55], v[12:15], v[224:231], v1
s_nop 0
global_store_dwordx2 v44, v[48:49], s[52:53]
s_addc_u32 s59, s5, 0
s_mov_b32 s30, 0
v_smfmac_f32_16x16x64_bf16 v[32:35], v[12:15], v[248:255], v1
s_nop 2
v_cvt_pk_bf16_f32 v52, v52, v53
v_cvt_pk_bf16_f32 v53, v54, v55
s_mov_b32 s19, 1
v_and_or_b32 v52, v52, -2, s18
global_store_dwordx2 v44, v[52:53], s[54:55]
v_cvt_pk_bf16_f32 v32, v32, v33
v_cvt_pk_bf16_f32 v33, v34, v35
v_and_or_b32 v32, v32, -2, s18
global_store_dwordx2 v44, v[32:33], s[56:57]
v_bfe_u32 v32, v0, 6, 1
v_lshlrev_b32 v32, 4, v32
v_mov_b32 v33, 0x3f80
v_lshlrev_b32 v32, v32, v33
v_bfe_i32 v33, v0, 4, 1
v_and_b32 v45, v32, v33
v_and_b32 v47, v32, v33
v_xor_b32 v44, v32, v45
v_xor_b32 v46, v32, v45
v_and_b32 v36, 32, v0
v_bfe_u32 v37, v0, 6, 1
v_lshl_add_u32 v36, v37, 8, v36
v_bfe_u32 v37, v0, 8, 1
v_lshl_add_u32 v36, v37, 4, v36
v_bfe_u32 v37, v0, 4, 1
v_lshl_add_u32 v36, v37, 3, v36
v_and_b32 v7, 255, v0
v_lshl_add_u32 v7, v7, 3, s27
s_nop 15
s_nop 15
s_nop 15
s_nop 15
global_load_dwordx4 v[8:11], v0, s[64:65] offset:0 sc1
global_load_dwordx4 v[12:15], v0, s[64:65] offset:1024 sc1
global_load_dwordx4 v[16:19], v0, s[64:65] offset:2048 sc1
global_load_dwordx4 v[20:23], v0, s[64:65] offset:3072 sc1
s_nop 15
s_nop 15
s_nop 5
global_load_dwordx4 v[24:27], v0, s[64:65] offset:0 sc1
global_load_dwordx4 v[28:31], v0, s[64:65] offset:1024 sc1
global_load_dwordx4 v[48:51], v0, s[64:65] offset:2048 sc1
global_load_dwordx4 v[52:55], v0, s[64:65] offset:3072 sc1
chk_10035:
v_mov_b64 v[40:41], 0
v_mov_b64 v[42:43], 0
s_waitcnt vmcnt(6)
s_nop 0
v_smfmac_f32_16x16x64_bf16 v[40:43], v[44:47], v[8:15], v1
v_bitop3_b32 v32, v8, v10, s18 bitop3:0x7e
v_bitop3_b32 v33, v12, v14, s18 bitop3:0x7e
s_waitcnt vmcnt(4)
v_smfmac_f32_16x16x64_bf16 v[40:43], v[44:47], v[16:23], v1
v_bitop3_b32 v34, v16, v18, s18 bitop3:0x7e
v_bitop3_b32 v35, v20, v22, s18 bitop3:0x7e
v_or3_b32 v32, v32, v33, v34
v_bitop3_b32 v32, v32, v35, 1 bitop3:0xa8
v_cmp_ne_u32 vcc, 0, v32
s_cbranch_vccnz chk_10035_f
s_nop 1
v_add_f32_dpp v40, v40, v40 row_ror:8 row_mask:0xf bank_mask:0xf
v_add_f32_dpp v41, v41, v41 row_ror:8 row_mask:0xf bank_mask:0xf
v_add_f32_dpp v42, v42, v42 row_ror:8 row_mask:0xf bank_mask:0xf
v_add_f32_dpp v43, v43, v43 row_ror:8 row_mask:0xf bank_mask:0xf
v_cvt_pk_bf16_f32 v40, v40, v41
v_cvt_pk_bf16_f32 v41, v42, v43
v_and_or_b32 v40, v40, -2, s18
s_mov_b64 exec, 0x00ff00ff
global_store_dwordx2 v36, v[40:41], s[66:67]
s_mov_b64 exec, -1
s_branch join_10034
chk_10035_f:
global_load_dwordx4 v[8:11], v0, s[64:65] offset:0 sc1
global_load_dwordx4 v[12:15], v0, s[64:65] offset:1024 sc1
global_load_dwordx4 v[16:19], v0, s[64:65] offset:2048 sc1
global_load_dwordx4 v[20:23], v0, s[64:65] offset:3072 sc1
chk_10036:
v_mov_b64 v[40:41], 0
v_mov_b64 v[42:43], 0
s_waitcnt vmcnt(6)
s_nop 0
v_smfmac_f32_16x16x64_bf16 v[40:43], v[44:47], v[24:31], v1
v_bitop3_b32 v32, v24, v26, s18 bitop3:0x7e
v_bitop3_b32 v33, v28, v30, s18 bitop3:0x7e
s_waitcnt vmcnt(4)
v_smfmac_f32_16x16x64_bf16 v[40:43], v[44:47], v[48:55], v1
v_bitop3_b32 v34, v48, v50, s18 bitop3:0x7e
v_bitop3_b32 v35, v52, v54, s18 bitop3:0x7e
v_or3_b32 v32, v32, v33, v34
v_bitop3_b32 v32, v32, v35, 1 bitop3:0xa8
v_cmp_ne_u32 vcc, 0, v32
s_cbranch_vccnz chk_10036_f
s_nop 1
v_add_f32_dpp v40, v40, v40 row_ror:8 row_mask:0xf bank_mask:0xf
v_add_f32_dpp v41, v41, v41 row_ror:8 row_mask:0xf bank_mask:0xf
v_add_f32_dpp v42, v42, v42 row_ror:8 row_mask:0xf bank_mask:0xf
v_add_f32_dpp v43, v43, v43 row_ror:8 row_mask:0xf bank_mask:0xf
v_cvt_pk_bf16_f32 v40, v40, v41
v_cvt_pk_bf16_f32 v41, v42, v43
v_and_or_b32 v40, v40, -2, s18
s_mov_b64 exec, 0x00ff00ff
global_store_dwordx2 v36, v[40:41], s[66:67]
s_mov_b64 exec, -1
s_branch join_10034
chk_10036_f:
global_load_dwordx4 v[24:27], v0, s[64:65] offset:0 sc1
global_load_dwordx4 v[28:31], v0, s[64:65] offset:1024 sc1
global_load_dwordx4 v[48:51], v0, s[64:65] offset:2048 sc1
global_load_dwordx4 v[52:55], v0, s[64:65] offset:3072 sc1
s_add_u32 s30, s30, 1
s_cmp_le_u32 s30, 262144
s_cbranch_scc1 chk_10035
s_branch L_fail
nored_10033:
join_10034:
s_barrier
global_load_dwordx4 v[56:59], v0, s[76:77] offset:0 sc1
global_load_dwordx4 v[60:63], v0, s[76:77] offset:1024 sc1
global_load_dwordx4 v[80:83], v0, s[76:77] offset:2048 sc1
global_load_dwordx4 v[84:87], v0, s[76:77] offset:3072 sc1
s_nop 15
s_nop 15
s_nop 3
s_barrier
global_load_dwordx4 v[32:35], v0, s[68:69] offset:-4096 sc1
s_nop 10
global_load_dwordx4 v[36:39], v0, s[68:69] offset:0 sc1
s_nop 10
global_load_dwordx4 v[40:43], v0, s[70:71] offset:0 sc1
s_barrier
global_load_dwordx4 v[48:51], v0, s[58:59] offset:0 nt sc1
global_load_dwordx4 v[52:55], v0, s[58:59] offset:1024 nt sc1
s_waitcnt vmcnt(13)
v_mov_b64 v[8:9], 0
v_mov_b64 v[10:11], 0
s_waitcnt vmcnt(12)
v_mov_b64 v[12:13], 0
v_mov_b64 v[14:15], 0
s_waitcnt vmcnt(11)
v_mov_b64 v[16:17], 0
v_mov_b64 v[18:19], 0
s_waitcnt vmcnt(10)
v_mov_b64 v[20:21], 0
v_mov_b64 v[22:23], 0
v_mov_b64 v[24:25], 0
v_mov_b64 v[26:27], 0
v_mov_b64 v[28:29], 0
v_mov_b64 v[30:31], 0
s_mov_b32 s30, 0
s_cmp_eq_u32 s17, s31
s_cbranch_scc0 gather_10025
s_branch exit_10028
rt_10030:
global_load_dwordx4 v[32:35], v0, s[68:69] offset:-4096 sc1
global_load_dwordx4 v[36:39], v0, s[68:69] offset:0 sc1
global_load_dwordx4 v[40:43], v0, s[70:71] offset:0 sc1
s_add_u32 s30, s30, 1
s_cmp_gt_u32 s30, 262144
s_cbranch_scc1 L_fail
s_mov_b64 exec, 1
global_store_dword v0, v0, s[62:63]
global_store_dword v0, v0, s[62:63]
s_mov_b64 exec, -1
v_mov_b64 v[8:9], 0
v_mov_b64 v[10:11], 0
v_mov_b64 v[12:13], 0
v_mov_b64 v[14:15], 0
v_mov_b64 v[16:17], 0
v_mov_b64 v[18:19], 0
v_mov_b64 v[20:21], 0
v_mov_b64 v[22:23], 0
v_mov_b64 v[24:25], 0
v_mov_b64 v[26:27], 0
v_mov_b64 v[28:29], 0
v_mov_b64 v[30:31], 0
s_branch gather_10025
rare_10026:
ds_read_b128 v[48:51], v6 offset:6144
ds_read_b128 v[52:55], v6 offset:7168
s_waitcnt lgkmcnt(0)
v_add_f32 v48, v48, v52
v_add_f32 v49, v49, v53
v_add_f32 v50, v50, v54
v_add_f32 v51, v51, v55
v_mov_b32_dpp v46, v46 quad_perm:[0,1,0,1] row_mask:0xf bank_mask:0xf
v_mov_b32_dpp v47, v47 quad_perm:[0,1,0,1] row_mask:0xf bank_mask:0xf
v_max3_f32 v19, v48, v49, v50
v_max3_f32 v19, v19, v51, v46
v_max_f32 v19, v19, v47
s_nop 1
v_max_f32_dpp v19, v19, v19 quad_perm:[2,3,0,1] row_mask:0xf bank_mask:0xf
v_mov_b32 v44, v19
s_nop 1
v_permlane32_swap_b32 v19, v44
v_max_f32 v19, v19, v44
v_mov_b32 v44, v19
s_nop 1
v_permlane16_swap_b32 v19, v44
v_max_f32 v19, v19, v44
v_sub_f32 v48, v48, v19
v_sub_f32 v49, v49, v19
v_sub_f32 v50, v50, v19
v_sub_f32 v51, v51, v19
v_sub_f32 v46, v46, v19
v_sub_f32 v47, v47, v19
v_exp_f32 v48, v48
v_exp_f32 v49, v49
v_exp_f32 v50, v50
v_exp_f32 v51, v51
v_cvt_pk_bf16_f32 v54, v48, v49
v_cvt_pk_bf16_f32 v55, v50, v51
s_nop 0
v_mov_b32_dpp v48, v54 quad_perm:[0,1,0,1] row_mask:0xf bank_mask:0xf
v_mov_b32_dpp v49, v55 quad_perm:[0,1,0,1] row_mask:0xf bank_mask:0xf
v_mov_b32_dpp v50, v54 quad_perm:[2,3,2,3] row_mask:0xf bank_mask:0xf
v_mov_b32_dpp v51, v55 quad_perm:[2,3,2,3] row_mask:0xf bank_mask:0xf
v_mov_b64 v[20:21], s[44:45]
v_mov_b64 v[22:23], s[44:45]
v_mfma_f32_16x16x32_bf16 v[8:11], v[56:59], v[48:51], 0
v_mfma_f32_16x16x32_bf16 v[12:15], v[60:63], v[48:51], 0
v_mfma_f32_16x16x32_bf16 v[16:19], v[20:23], v[48:51], 0
v_mov_b64 v[54:55], s[46:47]
v_exp_f32_dpp v44, v46 quad_perm:[0,1,0,1] row_mask:0xf bank_mask:0xf
v_exp_f32_dpp v45, v47 quad_perm:[0,1,0,1] row_mask:0xf bank_mask:0xf
s_nop 0
v_cvt_pk_bf16_f32 v52, v44, v45
v_cvt_pk_bf16_f32 v53, v44, v45
s_nop 1
v_mfma_f32_16x16x16_bf16 v[16:19], v[54:55], v[52:53], v[16:19]
v_mfma_f32_16x16x16_bf16 v[8:11], v[24:25], v[52:53], v[8:11]
v_mfma_f32_16x16x16_bf16 v[12:15], v[26:27], v[52:53], v[12:15]
s_nop 5
v_rcp_f32 v18, v16
s_nop 0
v_cndmask_b32 v8, v12, v8, s[42:43]
v_mul_f32 v8, v8, v18
v_cndmask_b32 v9, v13, v9, s[42:43]
v_mul_f32 v9, v9, v18
v_cndmask_b32 v10, v14, v10, s[42:43]
v_mul_f32 v10, v10, v18
v_cndmask_b32 v11, v15, v11, s[42:43]
v_mul_f32 v11, v11, v18
v_cvt_pk_bf16_f32 v12, v8, v9
v_cvt_pk_bf16_f32 v13, v10, v11
s_branch back_10027
exit_10028:
global_load_dwordx4 v[32:35], v0, s[68:69] offset:-4096 sc1
global_load_dwordx4 v[36:39], v0, s[68:69] offset:0 sc1
global_load_dwordx4 v[40:43], v0, s[70:71] offset:0 sc1
s_add_u32 s30, s30, 1
s_cmp_gt_u32 s30, 262144
s_cbranch_scc1 L_fail
s_waitcnt vmcnt(2)
v_bitop3_b32 v44, v32, v34, s18 bitop3:0x7e
s_waitcnt vmcnt(1)
v_bitop3_b32 v45, v36, v38, s18 bitop3:0x7e
v_or_b32 v44, v44, v45
s_waitcnt vmcnt(0)
v_bitop3_b32 v46, v40, v42, s18 bitop3:0x7e
v_bitop3_b32 v44, v44, v46, s19 bitop3:0xa8
v_cmp_ne_u32 vcc, 0, v44
s_cbranch_vccnz exit_10028
s_add_u32 s36, s36, 1
s_cmp_lt_u32 s36, 2
s_cbranch_scc1 layer_10024
s_endpgm
wave_10007:
layer_10037:
s_lshl_b32 s17, s36, 6
s_mul_i32 s27, s36, 35651584
s_mul_i32 s28, s14, 16384
s_add_u32 s27, s27, s28
s_add_u32 s20, s27, 16785408
s_mul_i32 s27, s17, 10240
s_add_u32 s27, s27, s24
s_add_u32 s21, s27, s25
s_mov_b32 s19, 0
s_mov_b32 s33, s6
s_add_u32 s34, s17, 1
s_add_u32 s31, s17, 63
s_add_u32 s32, s17, 64
s_mov_b32 s27, s20
v_mov_b32 v7, 0
s_add_u32 s68, s4, 415744
s_addc_u32 s69, s5, 0
s_add_u32 s72, s4, 399360
s_addc_u32 s73, s5, 0
s_add_u32 s70, s4, 419840
s_addc_u32 s71, s5, 0
s_add_u32 s74, s4, 403456
s_addc_u32 s75, s5, 0
s_add_u32 s58, s4, s20
s_addc_u32 s59, s5, 0
global_load_dwordx4 v[64:67], v0, s[76:77] offset:-4096 sc1
global_load_dwordx4 v[68:71], v0, s[76:77] offset:-3072 sc1
global_load_dwordx4 v[72:75], v0, s[76:77] offset:-2048 sc1
global_load_dwordx4 v[76:79], v0, s[76:77] offset:-1024 sc1
global_load_dwordx4 v[80:83], v0, s[76:77] offset:2048 sc1
global_load_dwordx4 v[84:87], v0, s[76:77] offset:3072 sc1
global_load_dwordx4 v[56:59], v0, s[76:77] offset:0 sc1
global_load_dwordx4 v[60:63], v0, s[76:77] offset:1024 sc1
v_mov_b64 v[8:9], 0
v_mov_b64 v[10:11], 0
v_mov_b64 v[12:13], 0
v_mov_b64 v[14:15], 0
v_mov_b64 v[16:17], 0
v_mov_b64 v[18:19], 0
v_mov_b64 v[20:21], 0
v_mov_b64 v[22:23], 0
v_mov_b64 v[24:25], 0
v_mov_b64 v[26:27], 0
v_mov_b64 v[28:29], 0
v_mov_b64 v[30:31], 0
s_barrier
global_load_dwordx4 v[48:51], v0, s[58:59] offset:0 nt sc1
global_load_dwordx4 v[52:55], v0, s[58:59] offset:1024 nt sc1
v_and_b32 v7, 255, v0
v_lshl_add_u32 v7, v7, 3, s27
global_load_dwordx4 v[32:35], v0, s[68:69] offset:-4096 sc1
global_load_dwordx4 v[36:39], v0, s[68:69] offset:0 sc1
v_mov_b32 v45, -1
s_mov_b32 s30, 0
s_waitcnt vmcnt(0)
.p2align 6
gather_10038:
s_waitcnt vmcnt(3)
rt_10043_b:
v_smfmac_f32_16x16x64_bf16 v[24:27], v[32:35], a[0:7], v1
ds_write_b128 v0, v[32:35] offset:2048
v_smfmac_f32_16x16x64_bf16 v[8:11], v[32:35], v[64:71], v1
v_bitop3_b32 v44, v32, v34, s18 bitop3:0x7e
v_smfmac_f32_16x16x64_bf16 v[12:15], v[32:35], v[72:79], v1
s_waitcnt vmcnt(2)
ds_write_b128 v0, v[36:39] offset:6144
v_bitop3_b32 v45, v36, v38, s18 bitop3:0x7e
v_bitop3_b32 v44, v44, v45, s19 bitop3:0xa8
v_cmp_ne_u32 vcc, 0, v44
v_smfmac_f32_16x16x64_bf16 v[8:11], v[36:39], a[16:23], v1
v_smfmac_f32_16x16x64_bf16 v[20:23], v[32:35], v[80:87], v1
s_cbranch_vccnz rt_10043
global_load_dwordx4 v[64:67], v0, s[78:79] offset:-4096 sc1
ds_read_b128 v[80:83], v2 offset:0
v_smfmac_f32_16x16x64_bf16 v[28:31], v[32:35], a[8:15], v1
global_load_dwordx4 v[68:71], v0, s[78:79] offset:-3072 sc1
ds_read_b128 v[84:87], v2 offset:1024
v_smfmac_f32_16x16x64_bf16 v[20:23], v[36:39], a[40:47], v1
global_load_dwordx4 v[72:75], v0, s[78:79] offset:-2048 sc1
global_load_dwordx4 v[76:79], v0, s[78:79] offset:-1024 sc1
v_smfmac_f32_16x16x64_bf16 v[16:19], v[32:35], v[56:63], v1
s_waitcnt lgkmcnt(2)
s_barrier
ds_read_b128 v[40:43], v0 offset:3072
v_smfmac_f32_16x16x64_bf16 v[16:19], v[36:39], a[32:39], v1
s_xor_b32 s18, s18, 1
s_waitcnt lgkmcnt(1)
ds_read_b128 v[44:47], v0 offset:7168
v_smfmac_f32_16x16x64_bf16 v[28:31], v[36:39], v[80:87], v1
ds_read_b128 v[80:83], v2 offset:2048
v_smfmac_f32_16x16x64_bf16 v[24:27], v[36:39], a[48:55], v1
s_mov_b64 s[68:69], s[72:73]
ds_read_b128 v[32:35], v0 offset:0
v_smfmac_f32_16x16x64_bf16 v[12:15], v[36:39], a[24:31], v1
ds_read_b128 v[84:87], v2 offset:3072
s_waitcnt lgkmcnt(4)
v_smfmac_f32_16x16x64_bf16 v[8:11], v[40:43], a[56:63], v1
ds_read_b128 v[36:39], v0 offset:4096
v_smfmac_f32_16x16x64_bf16 v[12:15], v[40:43], a[64:71], v1
s_add_u32 s20, s20, 524288
s_waitcnt lgkmcnt(4)
ds_read_b128 v[40:43], v0 offset:1024
v_smfmac_f32_16x16x64_bf16 v[12:15], v[44:47], a[80:87], v1
s_add_u32 s17, s17, 1
global_load_dwordx4 v[56:59], v0, s[58:59] offset:2048 nt sc1
v_smfmac_f32_16x16x64_bf16 v[8:11], v[44:47], a[72:79], v1
s_waitcnt lgkmcnt(3)
ds_read_b128 v[44:47], v0 offset:5120
s_waitcnt lgkmcnt(3)
v_smfmac_f32_16x16x64_bf16 v[12:15], v[32:35], v[80:87], v1
s_add_u32 s21, s21, 10240
ds_read_b128 v[80:83], v2 offset:4096
v_smfmac_f32_16x16x64_bf16 v[8:11], v[32:35], a[88:95], v1
s_waitcnt lgkmcnt(3)
ds_read_b128 v[84:87], v2 offset:5120
s_waitcnt lgkmcnt(3)
v_smfmac_f32_16x16x64_bf16 v[12:15], v[36:39], a[104:111], v1
ds_read_b128 v[32:35], v0 offset:8192
v_smfmac_f32_16x16x64_bf16 v[8:11], v[36:39], a[96:103], v1
ds_read_b128 v[36:39], v0 offset:9216
v_smfmac_f32_16x16x64_bf16 v[8:11], v[40:43], a[112:119], v1
s_waitcnt lgkmcnt(4)
global_load_dwordx4 v[60:63], v0, s[58:59] offset:3072 nt sc1
v_smfmac_f32_16x16x64_bf16 v[12:15], v[40:43], a[120:127], v1
s_waitcnt lgkmcnt(2)
ds_read_b128 v[40:43], v0 offset:3072
v_smfmac_f32_16x16x64_bf16 v[12:15], v[44:47], v[80:87], v1
s_waitcnt lgkmcnt(2)
ds_read_b128 v[84:87], v2 offset:7168
v_smfmac_f32_16x16x64_bf16 v[8:11], v[44:47], a[128:135], v1
s_waitcnt vmcnt(5)
s_waitcnt lgkmcnt(2)
ds_read_b128 v[80:83], v2 offset:6144
v_smfmac_f32_16x16x64_bf16 v[12:15], v[32:35], a[144:151], v1
global_load_dword v7, v7, s[4:5] sc1
v_smfmac_f32_16x16x64_bf16 v[8:11], v[32:35], a[136:143], v1
ds_read_b128 v[32:35], v0 offset:7168
s_waitcnt vmcnt(5)
v_smfmac_f32_16x16x64_bf16 v[8:11], v[36:39], v[64:71], v1
s_nop 0
ds_read_b128 v[68:71], v2 offset:9216
s_waitcnt lgkmcnt(3)
v_smfmac_f32_16x16x64_bf16 v[12:15], v[36:39], a[152:159], v1
s_nop 0
ds_read_b128 v[64:67], v2 offset:8192
s_waitcnt lgkmcnt(3)
ds_read_b128 v[36:39], v0 offset:0
v_add_f32 v8, v8, v10
v_smfmac_f32_16x16x64_bf16 v[20:23], v[40:43], v[80:87], v1
ds_read_b128 v[84:87], v2 offset:11264
v_mul_f32 v8, s35, v8
v_smfmac_f32_16x16x64_bf16 v[16:19], v[40:43], a[160:167], v1
s_waitcnt lgkmcnt(4)
ds_read_b128 v[40:43], v0 offset:4096
v_add_f32 v9, v9, v11
v_smfmac_f32_16x16x64_bf16 v[20:23], v[32:35], a[176:183], v1
ds_read_b128 v[80:83], v2 offset:10240
v_mul_f32 v9, s35, v9
v_add_f32 v13, v13, v15
v_cvt_pk_bf16_f32 v8, v8, v9
v_add_f32 v12, v12, v14
v_smfmac_f32_16x16x64_bf16 v[16:19], v[32:35], a[168:175], v1
s_waitcnt lgkmcnt(3)
ds_read_b128 v[32:35], v0 offset:1024
v_mul_f32 v13, s35, v13
v_smfmac_f32_16x16x64_bf16 v[16:19], v[36:39], v[64:71], v1
s_waitcnt vmcnt(3)
ds_read_b128 v[68:71], v2 offset:13312
v_mul_f32 v12, s35, v12
v_smfmac_f32_16x16x64_bf16 v[20:23], v[36:39], a[184:191], v1
s_waitcnt lgkmcnt(3)
ds_read_b128 v[36:39], v0 offset:5120
ds_read_b128 v[64:67], v2 offset:12288
v_cvt_pk_bf16_f32 v12, v12, v13
v_smfmac_f32_16x16x64_bf16 v[16:19], v[40:43], v[72:79], v1
s_waitcnt lgkmcnt(4)
ds_write2_b32 v3, v8, v12 offset0:0 offset1:128
v_smfmac_f32_16x16x64_bf16 v[20:23], v[40:43], v[80:87], v1
s_add_u32 s34, s17, 2
s_waitcnt lgkmcnt(4)
ds_read_b128 v[72:75], v2 offset:14336
v_smfmac_f32_16x16x64_bf16 v[20:23], v[32:35], a[200:207], v1
ds_read_b128 v[80:83], v2 offset:16384
v_smfmac_f32_16x16x64_bf16 v[16:19], v[32:35], a[192:199], v1
s_waitcnt lgkmcnt(4)
ds_read_b128 v[40:43], v0 offset:8192
s_mov_b64 vcc, s[42:43]
ds_read_b128 v[76:79], v2 offset:15360
v_smfmac_f32_16x16x64_bf16 v[20:23], v[36:39], a[208:215], v1
ds_read_b128 v[84:87], v2 offset:17408
s_waitcnt lgkmcnt(5)
s_barrier
ds_read_b128 v[32:35], v0 offset:9216
v_smfmac_f32_16x16x64_bf16 v[16:19], v[36:39], v[64:71], v1
ds_read_b64_tr_b16 v[10:11], v4 offset:2560
ds_read_b64_tr_b16 v[8:9], v4 offset:2048
s_waitcnt lgkmcnt(6)
s_waitcnt lgkmcnt(5)
ds_read_b64_tr_b16 v[12:13], v4 offset:3072
v_smfmac_f32_16x16x64_bf16 v[20:23], v[40:43], a[216:223], v1
ds_read_b64_tr_b16 v[14:15], v4 offset:3584
s_waitcnt lgkmcnt(6)
ds_read_b128 v[68:71], v2 offset:19456
v_smfmac_f32_16x16x64_bf16 v[16:19], v[40:43], v[72:79], v1
s_waitcnt lgkmcnt(6)
ds_read_b128 v[36:39], v0 offset:8192
s_waitcnt lgkmcnt(6)
v_smfmac_f32_16x16x64_bf16 v[20:23], v[32:35], v[80:87], v1
ds_read_b128 v[64:67], v2 offset:18432
ds_read_b128 v[40:43], v0 offset:9216
v_smfmac_f32_16x16x64_bf16 v[16:19], v[32:35], a[224:231], v1
s_waitcnt lgkmcnt(6)
ds_read_b128 v[72:75], v2 offset:20480
ds_read_b128 v[32:35], v0 offset:3072
v_mfma_f32_16x16x32_bf16 v[44:47], v[48:51], v[8:11], 0
s_waitcnt lgkmcnt(6)
ds_read_b128 v[76:79], v2 offset:21504
v_add_f32 v21, v21, v23
v_add_f32 v20, v20, v22
v_bfe_u32 v48, v0, 5, 1
v_mfma_f32_16x16x32_bf16 v[44:47], v[52:55], v[12:15], v[44:47]
s_waitcnt lgkmcnt(5)
ds_read_b128 v[80:83], v2 offset:22528
v_add_f32 v17, v17, v19
v_add_f32 v16, v16, v18
v_cvt_pk_bf16_f32 v20, v20, v21
v_lshl_add_u32 v48, v48, 3, v5
v_cvt_pk_bf16_f32 v16, v16, v17
v_smfmac_f32_16x16x64_bf16 v[28:31], v[36:39], a[232:239], v1
s_waitcnt lgkmcnt(4)
ds_write2_b32 v3, v16, v20 offset0:1 offset1:129
v_cndmask_b32_dpp v44, v46, v44, vcc quad_perm:[0,1,0,1] row_mask:0xf bank_mask:0xf
v_cndmask_b32_dpp v45, v47, v45, vcc quad_perm:[0,1,0,1] row_mask:0xf bank_mask:0xf
v_smfmac_f32_16x16x64_bf16 v[24:27], v[36:39], v[64:71], v1
s_waitcnt lgkmcnt(3)
ds_write_b64 v48, v[44:45] offset:7168
v_smfmac_f32_16x16x64_bf16 v[24:27], v[40:43], a[240:247], v1
s_waitcnt lgkmcnt(3)
global_load_dwordx4 v[64:67], v0, s[78:79] offset:0 sc1
ds_read_b128 v[36:39], v0 offset:7168
v_smfmac_f32_16x16x64_bf16 v[28:31], v[40:43], v[72:79], v1
s_waitcnt lgkmcnt(3)
global_load_dwordx4 v[68:71], v0, s[78:79] offset:1024 sc1
ds_read_b128 v[84:87], v2 offset:23552
v_smfmac_f32_16x16x64_bf16 v[24:27], v[32:35], a[248:255], v1
global_load_dwordx4 v[72:75], v0, s[78:79] offset:2048 sc1
ds_read_b128 v[40:43], v0 offset:0
v_smfmac_f32_16x16x64_bf16 v[28:31], v[32:35], v[88:95], v1
s_waitcnt lgkmcnt(3)
ds_read_b128 v[32:35], v0 offset:4096
s_barrier
ds_read_b128 v[52:55], v6 offset:7168
s_waitcnt lgkmcnt(4)
v_smfmac_f32_16x16x64_bf16 v[28:31], v[36:39], v[96:103], v1
s_waitcnt lgkmcnt(3)
ds_read_b128 v[48:51], v6 offset:6144
ds_read_b64_tr_b16 v[8:9], v4 offset:0
v_smfmac_f32_16x16x64_bf16 v[24:27], v[36:39], v[80:87], v1
s_waitcnt lgkmcnt(4)
ds_read_b128 v[36:39], v0 offset:1024
global_load_dwordx4 v[76:79], v0, s[78:79] offset:3072 sc1
ds_read_b64_tr_b16 v[10:11], v4 offset:512
v_smfmac_f32_16x16x64_bf16 v[28:31], v[40:43], v[112:119], v1
s_waitcnt lgkmcnt(5)
ds_read_b64_tr_b16 v[14:15], v4 offset:1536
ds_read_b64_tr_b16 v[18:19], v4 offset:2560
v_smfmac_f32_16x16x64_bf16 v[24:27], v[40:43], v[104:111], v1
s_waitcnt lgkmcnt(6)
ds_read_b64_tr_b16 v[12:13], v4 offset:1024
ds_read_b64_tr_b16 v[16:17], v4 offset:2048
v_smfmac_f32_16x16x64_bf16 v[28:31], v[32:35], v[128:135], v1
s_waitcnt lgkmcnt(7)
ds_read_b64_tr_b16 v[22:23], v4 offset:3584
v_add_f32 v50, v50, v54
v_add_f32 v49, v49, v53
v_smfmac_f32_16x16x64_bf16 v[24:27], v[32:35], v[120:127], v1
s_waitcnt lgkmcnt(6)
ds_read_b128 v[40:43], v0 offset:5120
v_add_f32 v48, v48, v52
v_smfmac_f32_16x16x64_bf16 v[24:27], v[36:39], v[136:143], v1
s_waitcnt lgkmcnt(5)
ds_read_b64_tr_b16 v[20:21], v4 offset:3072
v_add_f32 v51, v51, v55
v_smfmac_f32_16x16x64_bf16 v[28:31], v[36:39], v[144:151], v1
s_waitcnt lgkmcnt(4)
global_load_dwordx4 v[80:83], v0, s[80:81] offset:-4096 sc1
v_exp_f32 v51, v51
v_mfma_f32_16x16x32_bf16 v[44:47], v[8:11], v[8:11], 0
s_waitcnt lgkmcnt(3)
v_exp_f32 v49, v49
v_mfma_f32_16x16x32_bf16 v[44:47], v[12:15], v[12:15], v[44:47]
s_waitcnt lgkmcnt(1)
v_exp_f32 v50, v50
v_exp_f32 v48, v48
v_mfma_f32_16x16x32_bf16 v[44:47], v[16:19], v[16:19], v[44:47]
s_waitcnt lgkmcnt(0)
v_cvt_pk_bf16_f32 v55, v50, v51
v_cvt_pk_bf16_f32 v54, v48, v49
v_mfma_f32_16x16x32_bf16 v[44:47], v[20:23], v[20:23], v[44:47]
v_mov_b64 v[22:23], s[44:45]
v_mov_b32_dpp v50, v54 quad_perm:[2,3,2,3] row_mask:0xf bank_mask:0xf
v_mov_b32_dpp v49, v55 quad_perm:[0,1,0,1] row_mask:0xf bank_mask:0xf
v_mov_b32_dpp v51, v55 quad_perm:[2,3,2,3] row_mask:0xf bank_mask:0xf
v_smfmac_f32_16x16x64_bf16 v[24:27], v[40:43], v[152:159], v1
v_mov_b32_dpp v48, v54 quad_perm:[0,1,0,1] row_mask:0xf bank_mask:0xf
v_mov_b64 v[20:21], s[44:45]
v_smfmac_f32_16x16x64_bf16 v[28:31], v[40:43], v[160:167], v1
s_waitcnt vmcnt(7)
global_load_dwordx4 v[84:87], v0, s[80:81] offset:-3072 sc1
v_exp_f32_dpp v44, v46 quad_perm:[0,1,0,1] row_mask:0xf bank_mask:0xf
v_mfma_f32_16x16x32_bf16 v[8:11], v[56:59], v[48:51], 0
v_exp_f32_dpp v45, v47 quad_perm:[0,1,0,1] row_mask:0xf bank_mask:0xf
v_mfma_f32_16x16x32_bf16 v[16:19], v[20:23], v[48:51], 0
s_waitcnt vmcnt(7)
v_cvt_pk_bf16_f32 v53, v44, v45
v_mov_b64 v[54:55], s[46:47]
v_mfma_f32_16x16x32_bf16 v[12:15], v[60:63], v[48:51], 0
v_cvt_pk_bf16_f32 v52, v44, v45
v_cvt_pk_bf16_f32 v24, v24, v25
v_cvt_pk_bf16_f32 v25, v26, v27
v_mfma_f32_16x16x16_bf16 v[16:19], v[54:55], v[52:53], v[16:19]
s_min_u32 s34, s34, s32
v_cvt_pk_bf16_f32 v26, v28, v29
v_cvt_pk_bf16_f32 v27, v30, v31
v_mfma_f32_16x16x16_bf16 v[8:11], v[24:25], v[52:53], v[8:11]
ds_read_b128 v[28:31], v0 offset:44032
v_mov_b64 v[42:43], 0
v_mfma_f32_16x16x16_bf16 v[12:15], v[26:27], v[52:53], v[12:15]
s_waitcnt vmcnt(4)
v_bfe_u32 v32, v0, 5, 1
v_mov_b64 v[36:37], 0
v_subrev_u32 v17, s37, v16
v_rcp_f32 v18, v16
v_lshl_add_u32 v32, v32, 3, v5
v_mov_b64 v[38:39], 0
v_cmp_lt_u32 vcc, s38, v17
v_cndmask_b32 v9, v13, v9, s[42:43]
v_cndmask_b32 v8, v12, v8, s[42:43]
v_cndmask_b32 v10, v14, v10, s[42:43]
v_mul_f32 v10, v10, v18
v_cndmask_b32 v11, v15, v11, s[42:43]
v_mul_f32 v9, v9, v18
v_mul_f32 v8, v8, v18
v_mul_f32 v11, v11, v18
v_cvt_pk_bf16_f32 v12, v8, v9
v_cvt_pk_bf16_f32 v13, v10, v11
s_cbranch_vccnz rare_10039
back_10040:
ds_write_b64 v32, v[12:13] offset:1024
v_mov_b32_dpp v9, v13 quad_perm:[0,1,0,1] row_mask:0xf bank_mask:0xf
v_mov_b32_dpp v10, v12 quad_perm:[2,3,2,3] row_mask:0xf bank_mask:0xf
v_mov_b32_dpp v8, v12 quad_perm:[0,1,0,1] row_mask:0xf bank_mask:0xf
v_mov_b32_dpp v11, v13 quad_perm:[2,3,2,3] row_mask:0xf bank_mask:0xf
v_mov_b64 v[54:55], 0
v_mov_b64 v[52:53], 0
v_smfmac_f32_16x16x64_bf16 v[36:39], v[8:11], v[64:71], v1
s_waitcnt vmcnt(2)
ds_read_b128 v[20:23], v0 offset:41984
global_load_dwordx4 v[64:67], v0, s[76:77] offset:-4096 sc1
ds_read_b128 v[16:19], v0 offset:40960
v_mov_b64 v[34:35], 0
v_mov_b64 v[32:33], 0
v_mov_b64 v[40:41], 0
v_smfmac_f32_16x16x64_bf16 v[52:55], v[8:11], v[176:183], v1
s_waitcnt lgkmcnt(2)
ds_read_b128 v[24:27], v0 offset:43008
s_barrier
ds_read_b128 v[56:59], v5 offset:1536
global_load_dwordx4 v[68:71], v0, s[76:77] offset:-3072 sc1
ds_read_b128 v[12:15], v5 offset:512
v_mov_b64 v[48:49], 0
v_smfmac_f32_16x16x64_bf16 v[40:43], v[8:11], v[72:79], v1
s_waitcnt vmcnt(2)
ds_read_b128 v[60:63], v5 offset:0
v_mov_b64 v[50:51], 0
v_smfmac_f32_16x16x64_bf16 v[32:35], v[8:11], v[80:87], v1
global_load_dwordx4 v[72:75], v0, s[76:77] offset:-2048 sc1
ds_read_b128 v[80:83], v0 offset:45056
v_smfmac_f32_16x16x64_bf16 v[48:51], v[8:11], v[168:175], v1
s_waitcnt lgkmcnt(5)
s_waitcnt lgkmcnt(3)
ds_read_b128 v[84:87], v0 offset:46080
v_smfmac_f32_16x16x64_bf16 v[40:43], v[56:59], v[192:199], v1
global_load_dwordx4 v[76:79], v0, s[76:77] offset:-1024 sc1
v_smfmac_f32_16x16x64_bf16 v[36:39], v[56:59], v[16:23], v1
s_waitcnt lgkmcnt(2)
ds_read_b128 v[20:23], v0 offset:48128
v_lshrrev_b32 v44, 8, v0
v_smfmac_f32_16x16x64_bf16 v[36:39], v[60:63], v[24:31], v1
ds_read_b128 v[16:19], v0 offset:47104
v_bfe_u32 v45, v0, 1, 7
v_smfmac_f32_16x16x64_bf16 v[36:39], v[12:15], v[184:191], v1
s_waitcnt lgkmcnt(3)
ds_read_b128 v[28:31], v0 offset:50176
s_waitcnt lgkmcnt(3)
v_smfmac_f32_16x16x64_bf16 v[40:43], v[60:63], v[80:87], v1
ds_read_b128 v[24:27], v0 offset:49152
v_lshl_or_b32 v44, v44, 12, v45
v_smfmac_f32_16x16x64_bf16 v[40:43], v[12:15], v[200:207], v1
ds_read_b128 v[80:83], v0 offset:51200
v_cvt_pk_bf16_f32 v36, v36, v37
v_smfmac_f32_16x16x64_bf16 v[32:35], v[56:59], v[232:239], v1
ds_read_b128 v[84:87], v0 offset:52224
v_cvt_pk_bf16_f32 v37, v38, v39
v_and_or_b32 v36, v36, -2, s18
v_smfmac_f32_16x16x64_bf16 v[52:55], v[56:59], v[216:223], v1
global_store_dwordx2 v44, v[36:37], s[48:49]
s_waitcnt lgkmcnt(3)
v_cvt_pk_bf16_f32 v40, v40, v41
v_smfmac_f32_16x16x64_bf16 v[48:51], v[56:59], v[16:23], v1
s_waitcnt lgkmcnt(2)
s_waitcnt lgkmcnt(1)
v_and_or_b32 v40, v40, -2, s18
v_smfmac_f32_16x16x64_bf16 v[48:51], v[60:63], v[24:31], v1
v_cvt_pk_bf16_f32 v41, v42, v43
v_smfmac_f32_16x16x64_bf16 v[48:51], v[12:15], v[208:215], v1
s_waitcnt lgkmcnt(0)
global_store_dwordx2 v44, v[40:41], s[50:51]
v_smfmac_f32_16x16x64_bf16 v[32:35], v[60:63], v[240:247], v1
s_nop 1
v_smfmac_f32_16x16x64_bf16 v[52:55], v[60:63], v[80:87], v1
s_add_u32 s27, s20, 524288
s_add_u32 s58, s4, s20
v_cvt_pk_bf16_f32 v48, v48, v49
v_and_or_b32 v48, v48, -2, s18
v_cvt_pk_bf16_f32 v49, v50, v51
v_smfmac_f32_16x16x64_bf16 v[52:55], v[12:15], v[224:231], v1
s_nop 0
global_store_dwordx2 v44, v[48:49], s[52:53]
s_addc_u32 s59, s5, 0
s_mov_b32 s30, 0
v_smfmac_f32_16x16x64_bf16 v[32:35], v[12:15], v[248:255], v1
s_nop 2
v_cvt_pk_bf16_f32 v52, v52, v53
v_cvt_pk_bf16_f32 v53, v54, v55
s_mov_b32 s19, 1
v_and_or_b32 v52, v52, -2, s18
global_store_dwordx2 v44, v[52:53], s[54:55]
v_cvt_pk_bf16_f32 v32, v32, v33
v_cvt_pk_bf16_f32 v33, v34, v35
v_and_or_b32 v32, v32, -2, s18
global_store_dwordx2 v44, v[32:33], s[56:57]
s_cmp_ge_u32 s14, 16
s_cbranch_scc1 nored_10046
v_bfe_u32 v32, v0, 6, 1
v_lshlrev_b32 v32, 4, v32
v_mov_b32 v33, 0x3f80
v_lshlrev_b32 v32, v32, v33
v_bfe_i32 v33, v0, 4, 1
v_and_b32 v45, v32, v33
v_and_b32 v47, v32, v33
v_xor_b32 v44, v32, v45
v_xor_b32 v46, v32, v45
v_and_b32 v36, 32, v0
v_bfe_u32 v37, v0, 6, 1
v_lshl_add_u32 v36, v37, 8, v36
v_bfe_u32 v37, v0, 8, 1
v_lshl_add_u32 v36, v37, 4, v36
v_bfe_u32 v37, v0, 4, 1
v_lshl_add_u32 v36, v37, 3, v36
v_and_b32 v7, 255, v0
v_lshl_add_u32 v7, v7, 3, s27
s_nop 15
s_nop 15
s_nop 15
s_nop 15
s_nop 12
global_load_dwordx4 v[8:11], v0, s[64:65] offset:0 sc1
global_load_dwordx4 v[12:15], v0, s[64:65] offset:1024 sc1
global_load_dwordx4 v[16:19], v0, s[64:65] offset:2048 sc1
global_load_dwordx4 v[20:23], v0, s[64:65] offset:3072 sc1
s_nop 15
s_nop 15
s_nop 5
global_load_dwordx4 v[24:27], v0, s[64:65] offset:0 sc1
global_load_dwordx4 v[28:31], v0, s[64:65] offset:1024 sc1
global_load_dwordx4 v[48:51], v0, s[64:65] offset:2048 sc1
global_load_dwordx4 v[52:55], v0, s[64:65] offset:3072 sc1
chk_10048:
v_mov_b64 v[40:41], 0
v_mov_b64 v[42:43], 0
s_waitcnt vmcnt(6)
s_nop 0
v_smfmac_f32_16x16x64_bf16 v[40:43], v[44:47], v[8:15], v1
v_bitop3_b32 v32, v8, v10, s18 bitop3:0x7e
v_bitop3_b32 v33, v12, v14, s18 bitop3:0x7e
s_waitcnt vmcnt(4)
v_smfmac_f32_16x16x64_bf16 v[40:43], v[44:47], v[16:23], v1
v_bitop3_b32 v34, v16, v18, s18 bitop3:0x7e
v_bitop3_b32 v35, v20, v22, s18 bitop3:0x7e
v_or3_b32 v32, v32, v33, v34
v_bitop3_b32 v32, v32, v35, 1 bitop3:0xa8
v_cmp_ne_u32 vcc, 0, v32
s_cbranch_vccnz chk_10048_f
s_nop 1
v_add_f32_dpp v40, v40, v40 row_ror:8 row_mask:0xf bank_mask:0xf
v_add_f32_dpp v41, v41, v41 row_ror:8 row_mask:0xf bank_mask:0xf
v_add_f32_dpp v42, v42, v42 row_ror:8 row_mask:0xf bank_mask:0xf
v_add_f32_dpp v43, v43, v43 row_ror:8 row_mask:0xf bank_mask:0xf
v_cvt_pk_bf16_f32 v40, v40, v41
v_cvt_pk_bf16_f32 v41, v42, v43
v_and_or_b32 v40, v40, -2, s18
s_mov_b64 exec, 0x00ff00ff
global_store_dwordx2 v36, v[40:41], s[66:67]
s_mov_b64 exec, -1
s_branch join_10047
chk_10048_f:
global_load_dwordx4 v[8:11], v0, s[64:65] offset:0 sc1
global_load_dwordx4 v[12:15], v0, s[64:65] offset:1024 sc1
global_load_dwordx4 v[16:19], v0, s[64:65] offset:2048 sc1
global_load_dwordx4 v[20:23], v0, s[64:65] offset:3072 sc1
chk_10049:
v_mov_b64 v[40:41], 0
v_mov_b64 v[42:43], 0
s_waitcnt vmcnt(6)
s_nop 0
v_smfmac_f32_16x16x64_bf16 v[40:43], v[44:47], v[24:31], v1
v_bitop3_b32 v32, v24, v26, s18 bitop3:0x7e
v_bitop3_b32 v33, v28, v30, s18 bitop3:0x7e
s_waitcnt vmcnt(4)
v_smfmac_f32_16x16x64_bf16 v[40:43], v[44:47], v[48:55], v1
v_bitop3_b32 v34, v48, v50, s18 bitop3:0x7e
v_bitop3_b32 v35, v52, v54, s18 bitop3:0x7e
v_or3_b32 v32, v32, v33, v34
v_bitop3_b32 v32, v32, v35, 1 bitop3:0xa8
v_cmp_ne_u32 vcc, 0, v32
s_cbranch_vccnz chk_10049_f
s_nop 1
v_add_f32_dpp v40, v40, v40 row_ror:8 row_mask:0xf bank_mask:0xf
v_add_f32_dpp v41, v41, v41 row_ror:8 row_mask:0xf bank_mask:0xf
v_add_f32_dpp v42, v42, v42 row_ror:8 row_mask:0xf bank_mask:0xf
v_add_f32_dpp v43, v43, v43 row_ror:8 row_mask:0xf bank_mask:0xf
v_cvt_pk_bf16_f32 v40, v40, v41
v_cvt_pk_bf16_f32 v41, v42, v43
v_and_or_b32 v40, v40, -2, s18
s_mov_b64 exec, 0x00ff00ff
global_store_dwordx2 v36, v[40:41], s[66:67]
s_mov_b64 exec, -1
s_branch join_10047
chk_10049_f:
global_load_dwordx4 v[24:27], v0, s[64:65] offset:0 sc1
global_load_dwordx4 v[28:31], v0, s[64:65] offset:1024 sc1
global_load_dwordx4 v[48:51], v0, s[64:65] offset:2048 sc1
global_load_dwordx4 v[52:55], v0, s[64:65] offset:3072 sc1
s_add_u32 s30, s30, 1
s_cmp_le_u32 s30, 262144
s_cbranch_scc1 chk_10048
s_branch L_fail
nored_10046:
v_and_b32 v7, 255, v0
v_lshl_add_u32 v7, v7, 3, s27
join_10047:
s_barrier
global_load_dwordx4 v[56:59], v0, s[76:77] offset:0 sc1
global_load_dwordx4 v[60:63], v0, s[76:77] offset:1024 sc1
global_load_dwordx4 v[80:83], v0, s[76:77] offset:2048 sc1
global_load_dwordx4 v[84:87], v0, s[76:77] offset:3072 sc1
s_nop 15
s_nop 15
s_nop 3
s_barrier
global_load_dwordx4 v[32:35], v0, s[68:69] offset:-4096 sc1
s_nop 10
global_load_dwordx4 v[36:39], v0, s[68:69] offset:0 sc1
s_barrier
global_load_dwordx4 v[48:51], v0, s[58:59] offset:0 nt sc1
global_load_dwordx4 v[52:55], v0, s[58:59] offset:1024 nt sc1
s_waitcnt vmcnt(12)
v_mov_b64 v[8:9], 0
v_mov_b64 v[10:11], 0
s_waitcnt vmcnt(11)
v_mov_b64 v[12:13], 0
v_mov_b64 v[14:15], 0
s_waitcnt vmcnt(10)
v_mov_b64 v[16:17], 0
v_mov_b64 v[18:19], 0
s_waitcnt vmcnt(9)
v_mov_b64 v[20:21], 0
v_mov_b64 v[22:23], 0
v_mov_b64 v[24:25], 0
v_mov_b64 v[26:27], 0
v_mov_b64 v[28:29], 0
v_mov_b64 v[30:31], 0
s_mov_b32 s30, 0
s_cmp_eq_u32 s17, s31
s_cbranch_scc0 gather_10038
s_branch exit_10041
rt_10043:
global_load_dwordx4 v[32:35], v0, s[68:69] offset:-4096 sc1
global_load_dwordx4 v[36:39], v0, s[68:69] offset:0 sc1
s_add_u32 s30, s30, 1
s_cmp_gt_u32 s30, 262144
s_cbranch_scc1 L_fail
s_mov_b64 exec, 1
global_store_dword v0, v0, s[62:63]
global_store_dword v0, v0, s[62:63]
s_mov_b64 exec, -1
v_mov_b64 v[8:9], 0
v_mov_b64 v[10:11], 0
v_mov_b64 v[12:13], 0
v_mov_b64 v[14:15], 0
v_mov_b64 v[16:17], 0
v_mov_b64 v[18:19], 0
v_mov_b64 v[20:21], 0
v_mov_b64 v[22:23], 0
v_mov_b64 v[24:25], 0
v_mov_b64 v[26:27], 0
v_mov_b64 v[28:29], 0
v_mov_b64 v[30:31], 0
s_branch gather_10038
rare_10039:
ds_read_b128 v[48:51], v6 offset:6144
ds_read_b128 v[52:55], v6 offset:7168
s_waitcnt lgkmcnt(0)
v_add_f32 v48, v48, v52
v_add_f32 v49, v49, v53
v_add_f32 v50, v50, v54
v_add_f32 v51, v51, v55
v_mov_b32_dpp v46, v46 quad_perm:[0,1,0,1] row_mask:0xf bank_mask:0xf
v_mov_b32_dpp v47, v47 quad_perm:[0,1,0,1] row_mask:0xf bank_mask:0xf
v_max3_f32 v19, v48, v49, v50
v_max3_f32 v19, v19, v51, v46
v_max_f32 v19, v19, v47
s_nop 1
v_max_f32_dpp v19, v19, v19 quad_perm:[2,3,0,1] row_mask:0xf bank_mask:0xf
v_mov_b32 v44, v19
s_nop 1
v_permlane32_swap_b32 v19, v44
v_max_f32 v19, v19, v44
v_mov_b32 v44, v19
s_nop 1
v_permlane16_swap_b32 v19, v44
v_max_f32 v19, v19, v44
v_sub_f32 v48, v48, v19
v_sub_f32 v49, v49, v19
v_sub_f32 v50, v50, v19
v_sub_f32 v51, v51, v19
v_sub_f32 v46, v46, v19
v_sub_f32 v47, v47, v19
v_exp_f32 v48, v48
v_exp_f32 v49, v49
v_exp_f32 v50, v50
v_exp_f32 v51, v51
v_cvt_pk_bf16_f32 v54, v48, v49
v_cvt_pk_bf16_f32 v55, v50, v51
s_nop 0
v_mov_b32_dpp v48, v54 quad_perm:[0,1,0,1] row_mask:0xf bank_mask:0xf
v_mov_b32_dpp v49, v55 quad_perm:[0,1,0,1] row_mask:0xf bank_mask:0xf
v_mov_b32_dpp v50, v54 quad_perm:[2,3,2,3] row_mask:0xf bank_mask:0xf
v_mov_b32_dpp v51, v55 quad_perm:[2,3,2,3] row_mask:0xf bank_mask:0xf
v_mov_b64 v[20:21], s[44:45]
v_mov_b64 v[22:23], s[44:45]
v_mfma_f32_16x16x32_bf16 v[8:11], v[56:59], v[48:51], 0
v_mfma_f32_16x16x32_bf16 v[12:15], v[60:63], v[48:51], 0
v_mfma_f32_16x16x32_bf16 v[16:19], v[20:23], v[48:51], 0
v_mov_b64 v[54:55], s[46:47]
v_exp_f32_dpp v44, v46 quad_perm:[0,1,0,1] row_mask:0xf bank_mask:0xf
v_exp_f32_dpp v45, v47 quad_perm:[0,1,0,1] row_mask:0xf bank_mask:0xf
s_nop 0
v_cvt_pk_bf16_f32 v52, v44, v45
v_cvt_pk_bf16_f32 v53, v44, v45
s_nop 1
v_mfma_f32_16x16x16_bf16 v[16:19], v[54:55], v[52:53], v[16:19]
v_mfma_f32_16x16x16_bf16 v[8:11], v[24:25], v[52:53], v[8:11]
v_mfma_f32_16x16x16_bf16 v[12:15], v[26:27], v[52:53], v[12:15]
s_nop 5
v_rcp_f32 v18, v16
s_nop 0
v_cndmask_b32 v8, v12, v8, s[42:43]
v_mul_f32 v8, v8, v18
v_cndmask_b32 v9, v13, v9, s[42:43]
v_mul_f32 v9, v9, v18
v_cndmask_b32 v10, v14, v10, s[42:43]
v_mul_f32 v10, v10, v18
v_cndmask_b32 v11, v15, v11, s[42:43]
v_mul_f32 v11, v11, v18
v_cvt_pk_bf16_f32 v12, v8, v9
v_cvt_pk_bf16_f32 v13, v10, v11
s_branch back_10040
exit_10041:
global_load_dwordx4 v[32:35], v0, s[68:69] offset:-4096 sc1
global_load_dwordx4 v[36:39], v0, s[68:69] offset:0 sc1
s_add_u32 s30, s30, 1
s_cmp_gt_u32 s30, 262144
s_cbranch_scc1 L_fail
s_waitcnt vmcnt(1)
v_bitop3_b32 v44, v32, v34, s18 bitop3:0x7e
s_waitcnt vmcnt(0)
v_bitop3_b32 v45, v36, v38, s18 bitop3:0x7e
v_bitop3_b32 v44, v44, v45, s19 bitop3:0xa8
v_cmp_ne_u32 vcc, 0, v44
s_cbranch_vccnz exit_10041
s_add_u32 s36, s36, 1
s_cmp_lt_u32 s36, 2
s_cbranch_scc1 layer_10037
s_endpgm
wave_10008:
layer_10050:
s_lshl_b32 s17, s36, 6
s_mul_i32 s27, s36, 35651584
s_mul_i32 s28, s14, 16384
s_add_u32 s27, s27, s28
s_add_u32 s20, s27, 16789504
s_mul_i32 s27, s17, 10240
s_add_u32 s27, s27, s24
s_add_u32 s21, s27, s25
s_mov_b32 s19, 0
s_mov_b32 s33, s6
s_add_u32 s34, s17, 1
s_add_u32 s31, s17, 63
s_add_u32 s32, s17, 64
s_mov_b32 s27, s20
v_mov_b32 v7, 0
s_add_u32 s68, s4, 416768
s_addc_u32 s69, s5, 0
s_add_u32 s72, s4, 400384
s_addc_u32 s73, s5, 0
s_add_u32 s70, s4, 420864
s_addc_u32 s71, s5, 0
s_add_u32 s74, s4, 404480
s_addc_u32 s75, s5, 0
s_add_u32 s58, s4, s20
s_addc_u32 s59, s5, 0
global_load_dwordx4 v[64:67], v0, s[76:77] offset:-4096 sc1
global_load_dwordx4 v[68:71], v0, s[76:77] offset:-3072 sc1
global_load_dwordx4 v[72:75], v0, s[76:77] offset:-2048 sc1
global_load_dwordx4 v[76:79], v0, s[76:77] offset:-1024 sc1
global_load_dwordx4 v[80:83], v0, s[76:77] offset:2048 sc1
global_load_dwordx4 v[84:87], v0, s[76:77] offset:3072 sc1
global_load_dwordx4 v[56:59], v0, s[76:77] offset:0 sc1
global_load_dwordx4 v[60:63], v0, s[76:77] offset:1024 sc1
v_mov_b64 v[8:9], 0
v_mov_b64 v[10:11], 0
v_mov_b64 v[12:13], 0
v_mov_b64 v[14:15], 0
v_mov_b64 v[16:17], 0
v_mov_b64 v[18:19], 0
v_mov_b64 v[20:21], 0
v_mov_b64 v[22:23], 0
v_mov_b64 v[24:25], 0
v_mov_b64 v[26:27], 0
v_mov_b64 v[28:29], 0
v_mov_b64 v[30:31], 0
s_barrier
global_load_dwordx4 v[48:51], v0, s[58:59] offset:0 nt sc1
global_load_dwordx4 v[52:55], v0, s[58:59] offset:1024 nt sc1
v_and_b32 v7, 128, v0
v_add_u32 v7, s22, v7
s_mov_b32 exec_hi, 0
v_and_b32 v7, 255, v0
v_lshl_add_u32 v7, v7, 3, s27
s_mov_b32 exec_hi, -1
global_load_dwordx4 v[32:35], v0, s[68:69] offset:-4096 sc1
global_load_dwordx4 v[36:39], v0, s[68:69] offset:0 sc1
s_mov_b32 s30, 0
s_waitcnt vmcnt(0)
.p2align 6
gather_10051:
s_waitcnt vmcnt(3)
rt_10056_b:
v_smfmac_f32_16x16x64_bf16 v[24:27], v[32:35], a[0:7], v1
ds_write_b128 v0, v[32:35] offset:3072
v_smfmac_f32_16x16x64_bf16 v[8:11], v[32:35], v[64:71], v1
v_bitop3_b32 v44, v32, v34, s18 bitop3:0x7e
v_smfmac_f32_16x16x64_bf16 v[12:15], v[32:35], v[72:79], v1
s_waitcnt vmcnt(2)
ds_write_b128 v0, v[36:39] offset:7168
v_bitop3_b32 v45, v36, v38, s18 bitop3:0x7e
v_bitop3_b32 v44, v44, v45, s19 bitop3:0xa8
v_cmp_ne_u32 vcc, 0, v44
v_smfmac_f32_16x16x64_bf16 v[8:11], v[36:39], a[16:23], v1
v_smfmac_f32_16x16x64_bf16 v[20:23], v[32:35], v[80:87], v1
s_cbranch_vccnz rt_10056
global_load_dwordx4 v[64:67], v0, s[78:79] offset:-4096 sc1
ds_read_b128 v[80:83], v2 offset:0
v_smfmac_f32_16x16x64_bf16 v[28:31], v[32:35], a[8:15], v1
global_load_dwordx4 v[68:71], v0, s[78:79] offset:-3072 sc1
ds_read_b128 v[84:87], v2 offset:1024
v_smfmac_f32_16x16x64_bf16 v[20:23], v[36:39], a[40:47], v1
global_load_dwordx4 v[72:75], v0, s[78:79] offset:-2048 sc1
global_load_dwordx4 v[76:79], v0, s[78:79] offset:-1024 sc1
v_smfmac_f32_16x16x64_bf16 v[16:19], v[32:35], v[56:63], v1
s_waitcnt lgkmcnt(2)
s_barrier
ds_read_b128 v[40:43], v0 offset:2048
v_smfmac_f32_16x16x64_bf16 v[16:19], v[36:39], a[32:39], v1
s_xor_b32 s18, s18, 1
s_waitcnt lgkmcnt(1)
ds_read_b128 v[44:47], v0 offset:6144
v_smfmac_f32_16x16x64_bf16 v[28:31], v[36:39], v[80:87], v1
ds_read_b128 v[80:83], v2 offset:2048
v_smfmac_f32_16x16x64_bf16 v[24:27], v[36:39], a[48:55], v1
s_mov_b64 s[68:69], s[72:73]
ds_read_b128 v[32:35], v0 offset:1024
v_smfmac_f32_16x16x64_bf16 v[12:15], v[36:39], a[24:31], v1
ds_read_b128 v[84:87], v2 offset:3072
s_waitcnt lgkmcnt(4)
v_smfmac_f32_16x16x64_bf16 v[8:11], v[40:43], a[56:63], v1
ds_read_b128 v[36:39], v0 offset:5120
v_smfmac_f32_16x16x64_bf16 v[12:15], v[40:43], a[64:71], v1
s_add_u32 s20, s20, 524288
s_waitcnt lgkmcnt(4)
ds_read_b128 v[40:43], v0 offset:0
v_smfmac_f32_16x16x64_bf16 v[12:15], v[44:47], a[80:87], v1
s_add_u32 s17, s17, 1
global_load_dwordx4 v[56:59], v0, s[58:59] offset:2048 nt sc1
v_smfmac_f32_16x16x64_bf16 v[8:11], v[44:47], a[72:79], v1
s_waitcnt lgkmcnt(3)
ds_read_b128 v[44:47], v0 offset:4096
s_waitcnt lgkmcnt(3)
v_smfmac_f32_16x16x64_bf16 v[12:15], v[32:35], v[80:87], v1
s_add_u32 s21, s21, 10240
ds_read_b128 v[80:83], v2 offset:4096
v_smfmac_f32_16x16x64_bf16 v[8:11], v[32:35], a[88:95], v1
s_waitcnt lgkmcnt(3)
ds_read_b128 v[84:87], v2 offset:5120
s_waitcnt lgkmcnt(3)
v_smfmac_f32_16x16x64_bf16 v[12:15], v[36:39], a[104:111], v1
ds_read_b128 v[32:35], v0 offset:9216
v_smfmac_f32_16x16x64_bf16 v[8:11], v[36:39], a[96:103], v1
ds_read_b128 v[36:39], v0 offset:8192
v_smfmac_f32_16x16x64_bf16 v[8:11], v[40:43], a[112:119], v1
s_waitcnt lgkmcnt(4)
global_load_dwordx4 v[60:63], v0, s[58:59] offset:3072 nt sc1
v_smfmac_f32_16x16x64_bf16 v[12:15], v[40:43], a[120:127], v1
s_waitcnt lgkmcnt(2)
ds_read_b128 v[40:43], v0 offset:2048
v_smfmac_f32_16x16x64_bf16 v[12:15], v[44:47], v[80:87], v1
s_waitcnt lgkmcnt(2)
ds_read_b128 v[84:87], v2 offset:7168
v_smfmac_f32_16x16x64_bf16 v[8:11], v[44:47], a[128:135], v1
s_waitcnt vmcnt(5)
s_waitcnt lgkmcnt(2)
ds_read_b128 v[80:83], v2 offset:6144
v_smfmac_f32_16x16x64_bf16 v[12:15], v[32:35], a[144:151], v1
global_load_dword v7, v7, s[4:5] sc1
v_smfmac_f32_16x16x64_bf16 v[8:11], v[32:35], a[136:143], v1
ds_read_b128 v[32:35], v0 offset:6144
s_waitcnt vmcnt(5)
v_smfmac_f32_16x16x64_bf16 v[8:11], v[36:39], v[64:71], v1
s_nop 0
ds_read_b128 v[68:71], v2 offset:9216
s_waitcnt lgkmcnt(3)
v_smfmac_f32_16x16x64_bf16 v[12:15], v[36:39], a[152:159], v1
s_nop 0
ds_read_b128 v[64:67], v2 offset:8192
s_waitcnt lgkmcnt(3)
ds_read_b128 v[36:39], v0 offset:1024
v_add_f32 v8, v8, v10
v_smfmac_f32_16x16x64_bf16 v[20:23], v[40:43], v[80:87], v1
ds_read_b128 v[84:87], v2 offset:11264
v_mul_f32 v8, s35, v8
v_smfmac_f32_16x16x64_bf16 v[16:19], v[40:43], a[160:167], v1
s_waitcnt lgkmcnt(4)
ds_read_b128 v[40:43], v0 offset:5120
v_add_f32 v9, v9, v11
v_smfmac_f32_16x16x64_bf16 v[20:23], v[32:35], a[176:183], v1
ds_read_b128 v[80:83], v2 offset:10240
v_mul_f32 v9, s35, v9
v_add_f32 v13, v13, v15
v_cvt_pk_bf16_f32 v8, v8, v9
v_add_f32 v12, v12, v14
v_smfmac_f32_16x16x64_bf16 v[16:19], v[32:35], a[168:175], v1
s_waitcnt lgkmcnt(3)
ds_read_b128 v[32:35], v0 offset:0
v_mul_f32 v13, s35, v13
v_smfmac_f32_16x16x64_bf16 v[16:19], v[36:39], v[64:71], v1
s_waitcnt vmcnt(3)
ds_read_b128 v[68:71], v2 offset:13312
v_mul_f32 v12, s35, v12
v_smfmac_f32_16x16x64_bf16 v[20:23], v[36:39], a[184:191], v1
s_waitcnt lgkmcnt(3)
ds_read_b128 v[36:39], v0 offset:4096
ds_read_b128 v[64:67], v2 offset:12288
v_cvt_pk_bf16_f32 v12, v12, v13
v_smfmac_f32_16x16x64_bf16 v[16:19], v[40:43], v[72:79], v1
s_waitcnt lgkmcnt(4)
ds_write2_b32 v3, v8, v12 offset0:0 offset1:128
v_smfmac_f32_16x16x64_bf16 v[20:23], v[40:43], v[80:87], v1
s_add_u32 s34, s17, 2
s_waitcnt lgkmcnt(4)
ds_read_b128 v[72:75], v2 offset:14336
v_smfmac_f32_16x16x64_bf16 v[20:23], v[32:35], a[200:207], v1
ds_read_b128 v[80:83], v2 offset:16384
v_smfmac_f32_16x16x64_bf16 v[16:19], v[32:35], a[192:199], v1
s_waitcnt lgkmcnt(4)
ds_read_b128 v[40:43], v0 offset:9216
s_mov_b64 vcc, s[42:43]
ds_read_b128 v[76:79], v2 offset:15360
v_smfmac_f32_16x16x64_bf16 v[20:23], v[36:39], a[208:215], v1
ds_read_b128 v[84:87], v2 offset:17408
s_waitcnt lgkmcnt(5)
s_barrier
ds_read_b128 v[32:35], v0 offset:8192
v_smfmac_f32_16x16x64_bf16 v[16:19], v[36:39], v[64:71], v1
ds_read_b64_tr_b16 v[10:11], v4 offset:2560
ds_read_b64_tr_b16 v[8:9], v4 offset:2048
s_waitcnt lgkmcnt(6)
s_waitcnt lgkmcnt(5)
ds_read_b64_tr_b16 v[12:13], v4 offset:3072
v_smfmac_f32_16x16x64_bf16 v[20:23], v[40:43], a[216:223], v1
ds_read_b64_tr_b16 v[14:15], v4 offset:3584
s_waitcnt lgkmcnt(6)
ds_read_b128 v[68:71], v2 offset:19456
v_smfmac_f32_16x16x64_bf16 v[16:19], v[40:43], v[72:79], v1
s_waitcnt lgkmcnt(6)
ds_read_b128 v[36:39], v0 offset:9216
s_waitcnt lgkmcnt(6)
v_smfmac_f32_16x16x64_bf16 v[20:23], v[32:35], v[80:87], v1
ds_read_b128 v[64:67], v2 offset:18432
ds_read_b128 v[40:43], v0 offset:8192
v_smfmac_f32_16x16x64_bf16 v[16:19], v[32:35], a[224:231], v1
s_waitcnt lgkmcnt(6)
ds_read_b128 v[72:75], v2 offset:20480
ds_read_b128 v[32:35], v0 offset:2048
v_mfma_f32_16x16x32_bf16 v[44:47], v[48:51], v[8:11], 0
s_waitcnt lgkmcnt(6)
ds_read_b128 v[76:79], v2 offset:21504
v_add_f32 v21, v21, v23
v_add_f32 v20, v20, v22
v_bfe_u32 v48, v0, 5, 1
v_mfma_f32_16x16x32_bf16 v[44:47], v[52:55], v[12:15], v[44:47]
s_waitcnt lgkmcnt(5)
ds_read_b128 v[80:83], v2 offset:22528
v_add_f32 v17, v17, v19
v_add_f32 v16, v16, v18
v_cvt_pk_bf16_f32 v20, v20, v21
v_lshl_add_u32 v48, v48, 3, v5
v_cvt_pk_bf16_f32 v16, v16, v17
v_smfmac_f32_16x16x64_bf16 v[28:31], v[36:39], a[232:239], v1
s_waitcnt lgkmcnt(4)
ds_write2_b32 v3, v16, v20 offset0:1 offset1:129
v_xor_b32 v48, 128, v48
v_cndmask_b32_dpp v44, v46, v44, vcc quad_perm:[0,1,0,1] row_mask:0xf bank_mask:0xf
v_cndmask_b32_dpp v45, v47, v45, vcc quad_perm:[0,1,0,1] row_mask:0xf bank_mask:0xf
v_smfmac_f32_16x16x64_bf16 v[24:27], v[36:39], v[64:71], v1
s_waitcnt lgkmcnt(3)
ds_write_b64 v48, v[44:45] offset:7680
v_smfmac_f32_16x16x64_bf16 v[24:27], v[40:43], a[240:247], v1
s_waitcnt lgkmcnt(3)
global_load_dwordx4 v[64:67], v0, s[78:79] offset:0 sc1
ds_read_b128 v[36:39], v0 offset:6144
v_smfmac_f32_16x16x64_bf16 v[28:31], v[40:43], v[72:79], v1
s_waitcnt lgkmcnt(3)
global_load_dwordx4 v[68:71], v0, s[78:79] offset:1024 sc1
ds_read_b128 v[84:87], v2 offset:23552
v_smfmac_f32_16x16x64_bf16 v[24:27], v[32:35], a[248:255], v1
global_load_dwordx4 v[72:75], v0, s[78:79] offset:2048 sc1
ds_read_b128 v[40:43], v0 offset:1024
v_smfmac_f32_16x16x64_bf16 v[28:31], v[32:35], v[88:95], v1
s_waitcnt lgkmcnt(3)
ds_read_b128 v[32:35], v0 offset:5120
s_barrier
ds_read_b128 v[52:55], v6 offset:7168
s_waitcnt lgkmcnt(4)
v_smfmac_f32_16x16x64_bf16 v[28:31], v[36:39], v[96:103], v1
s_waitcnt lgkmcnt(3)
ds_read_b128 v[48:51], v6 offset:6144
ds_read_b64_tr_b16 v[8:9], v4 offset:0
v_smfmac_f32_16x16x64_bf16 v[24:27], v[36:39], v[80:87], v1
s_waitcnt lgkmcnt(4)
ds_read_b128 v[36:39], v0 offset:0
global_load_dwordx4 v[76:79], v0, s[78:79] offset:3072 sc1
ds_read_b64_tr_b16 v[10:11], v4 offset:512
v_smfmac_f32_16x16x64_bf16 v[28:31], v[40:43], v[112:119], v1
s_waitcnt lgkmcnt(5)
ds_read_b64_tr_b16 v[14:15], v4 offset:1536
ds_read_b64_tr_b16 v[18:19], v4 offset:2560
v_smfmac_f32_16x16x64_bf16 v[24:27], v[40:43], v[104:111], v1
s_waitcnt lgkmcnt(6)
ds_read_b64_tr_b16 v[12:13], v4 offset:1024
ds_read_b64_tr_b16 v[16:17], v4 offset:2048
v_smfmac_f32_16x16x64_bf16 v[28:31], v[32:35], v[128:135], v1
s_waitcnt lgkmcnt(7)
ds_read_b64_tr_b16 v[22:23], v4 offset:3584
v_add_f32 v50, v50, v54
v_add_f32 v49, v49, v53
v_smfmac_f32_16x16x64_bf16 v[24:27], v[32:35], v[120:127], v1
s_waitcnt lgkmcnt(6)
ds_read_b128 v[40:43], v0 offset:4096
v_add_f32 v48, v48, v52
v_smfmac_f32_16x16x64_bf16 v[24:27], v[36:39], v[136:143], v1
s_waitcnt lgkmcnt(5)
ds_read_b64_tr_b16 v[20:21], v4 offset:3072
v_add_f32 v51, v51, v55
v_smfmac_f32_16x16x64_bf16 v[28:31], v[36:39], v[144:151], v1
s_waitcnt lgkmcnt(4)
global_load_dwordx4 v[80:83], v0, s[80:81] offset:-4096 sc1
v_exp_f32 v51, v51
v_mfma_f32_16x16x32_bf16 v[44:47], v[8:11], v[8:11], 0
s_waitcnt lgkmcnt(3)
v_exp_f32 v49, v49
v_mfma_f32_16x16x32_bf16 v[44:47], v[12:15], v[12:15], v[44:47]
s_waitcnt lgkmcnt(1)
v_exp_f32 v50, v50
v_exp_f32 v48, v48
v_mfma_f32_16x16x32_bf16 v[44:47], v[16:19], v[16:19], v[44:47]
s_waitcnt lgkmcnt(0)
v_cvt_pk_bf16_f32 v55, v50, v51
v_cvt_pk_bf16_f32 v54, v48, v49
v_mfma_f32_16x16x32_bf16 v[44:47], v[20:23], v[20:23], v[44:47]
v_mov_b64 v[22:23], s[44:45]
v_mov_b32_dpp v50, v54 quad_perm:[2,3,2,3] row_mask:0xf bank_mask:0xf
v_mov_b32_dpp v49, v55 quad_perm:[0,1,0,1] row_mask:0xf bank_mask:0xf
v_mov_b32_dpp v51, v55 quad_perm:[2,3,2,3] row_mask:0xf bank_mask:0xf
v_smfmac_f32_16x16x64_bf16 v[24:27], v[40:43], v[152:159], v1
v_mov_b32_dpp v48, v54 quad_perm:[0,1,0,1] row_mask:0xf bank_mask:0xf
v_mov_b64 v[20:21], s[44:45]
v_smfmac_f32_16x16x64_bf16 v[28:31], v[40:43], v[160:167], v1
s_waitcnt vmcnt(7)
global_load_dwordx4 v[84:87], v0, s[80:81] offset:-3072 sc1
v_exp_f32_dpp v44, v46 quad_perm:[0,1,0,1] row_mask:0xf bank_mask:0xf
v_mfma_f32_16x16x32_bf16 v[8:11], v[56:59], v[48:51], 0
v_exp_f32_dpp v45, v47 quad_perm:[0,1,0,1] row_mask:0xf bank_mask:0xf
v_mfma_f32_16x16x32_bf16 v[16:19], v[20:23], v[48:51], 0
s_waitcnt vmcnt(7)
v_cvt_pk_bf16_f32 v53, v44, v45
v_mov_b64 v[54:55], s[46:47]
v_mfma_f32_16x16x32_bf16 v[12:15], v[60:63], v[48:51], 0
v_cvt_pk_bf16_f32 v52, v44, v45
v_cvt_pk_bf16_f32 v24, v24, v25
v_cvt_pk_bf16_f32 v25, v26, v27
v_mfma_f32_16x16x16_bf16 v[16:19], v[54:55], v[52:53], v[16:19]
s_min_u32 s34, s34, s32
v_cvt_pk_bf16_f32 v26, v28, v29
v_cvt_pk_bf16_f32 v27, v30, v31
v_mfma_f32_16x16x16_bf16 v[8:11], v[24:25], v[52:53], v[8:11]
ds_read_b128 v[28:31], v0 offset:56320
v_mov_b64 v[42:43], 0
v_mfma_f32_16x16x16_bf16 v[12:15], v[26:27], v[52:53], v[12:15]
s_waitcnt vmcnt(4)
v_bfe_u32 v32, v0, 5, 1
v_mov_b64 v[36:37], 0
v_subrev_u32 v17, s37, v16
v_rcp_f32 v18, v16
v_lshl_add_u32 v32, v32, 3, v5
v_mov_b64 v[38:39], 0
v_cmp_lt_u32 vcc, s38, v17
v_cndmask_b32 v9, v13, v9, s[42:43]
v_cndmask_b32 v8, v12, v8, s[42:43]
v_cndmask_b32 v10, v14, v10, s[42:43]
v_mul_f32 v10, v10, v18
v_cndmask_b32 v11, v15, v11, s[42:43]
v_mul_f32 v9, v9, v18
v_mul_f32 v8, v8, v18
v_mul_f32 v11, v11, v18
v_cvt_pk_bf16_f32 v12, v8, v9
v_cvt_pk_bf16_f32 v13, v10, v11
s_cbranch_vccnz rare_10052
back_10053:
ds_write_b64 v32, v[12:13] offset:1536
v_mov_b32_dpp v9, v13 quad_perm:[0,1,0,1] row_mask:0xf bank_mask:0xf
v_mov_b32_dpp v10, v12 quad_perm:[2,3,2,3] row_mask:0xf bank_mask:0xf
v_mov_b32_dpp v8, v12 quad_perm:[0,1,0,1] row_mask:0xf bank_mask:0xf
v_mov_b32_dpp v11, v13 quad_perm:[2,3,2,3] row_mask:0xf bank_mask:0xf
v_mov_b64 v[54:55], 0
v_mov_b64 v[52:53], 0
v_smfmac_f32_16x16x64_bf16 v[36:39], v[8:11], v[64:71], v1
s_waitcnt vmcnt(2)
ds_read_b128 v[20:23], v0 offset:54272
global_load_dwordx4 v[64:67], v0, s[76:77] offset:-4096 sc1
ds_read_b128 v[16:19], v0 offset:53248
v_mov_b64 v[34:35], 0
v_mov_b64 v[32:33], 0
v_mov_b64 v[40:41], 0
v_smfmac_f32_16x16x64_bf16 v[52:55], v[8:11], v[176:183], v1
s_waitcnt lgkmcnt(2)
ds_read_b128 v[24:27], v0 offset:55296
s_barrier
ds_read_b128 v[56:59], v5 offset:1024
global_load_dwordx4 v[68:71], v0, s[76:77] offset:-3072 sc1
ds_read_b128 v[12:15], v5 offset:0
v_mov_b64 v[48:49], 0
v_smfmac_f32_16x16x64_bf16 v[40:43], v[8:11], v[72:79], v1
s_waitcnt vmcnt(2)
ds_read_b128 v[60:63], v5 offset:512
v_mov_b64 v[50:51], 0
v_smfmac_f32_16x16x64_bf16 v[32:35], v[8:11], v[80:87], v1
global_load_dwordx4 v[72:75], v0, s[76:77] offset:-2048 sc1
ds_read_b128 v[80:83], v0 offset:57344
v_smfmac_f32_16x16x64_bf16 v[48:51], v[8:11], v[168:175], v1
s_waitcnt lgkmcnt(5)
s_waitcnt lgkmcnt(3)
ds_read_b128 v[84:87], v0 offset:58368
v_smfmac_f32_16x16x64_bf16 v[40:43], v[56:59], v[192:199], v1
global_load_dwordx4 v[76:79], v0, s[76:77] offset:-1024 sc1
v_smfmac_f32_16x16x64_bf16 v[36:39], v[56:59], v[16:23], v1
s_waitcnt lgkmcnt(2)
ds_read_b128 v[20:23], v0 offset:60416
v_lshrrev_b32 v44, 8, v0
v_smfmac_f32_16x16x64_bf16 v[36:39], v[60:63], v[24:31], v1
ds_read_b128 v[16:19], v0 offset:59392
v_bfe_u32 v45, v0, 1, 7
v_smfmac_f32_16x16x64_bf16 v[36:39], v[12:15], v[184:191], v1
s_waitcnt lgkmcnt(3)
ds_read_b128 v[28:31], v0 offset:62464
s_waitcnt lgkmcnt(3)
v_smfmac_f32_16x16x64_bf16 v[40:43], v[60:63], v[80:87], v1
ds_read_b128 v[24:27], v0 offset:61440
v_lshl_or_b32 v44, v44, 12, v45
v_smfmac_f32_16x16x64_bf16 v[40:43], v[12:15], v[200:207], v1
ds_read_b128 v[80:83], v0 offset:63488
v_cvt_pk_bf16_f32 v36, v36, v37
v_smfmac_f32_16x16x64_bf16 v[32:35], v[56:59], v[232:239], v1
ds_read_b128 v[84:87], v0 offset:64512
v_cvt_pk_bf16_f32 v37, v38, v39
v_and_or_b32 v36, v36, -2, s18
v_smfmac_f32_16x16x64_bf16 v[52:55], v[56:59], v[216:223], v1
global_store_dwordx2 v44, v[36:37], s[48:49]
s_waitcnt lgkmcnt(3)
v_cvt_pk_bf16_f32 v40, v40, v41
v_smfmac_f32_16x16x64_bf16 v[48:51], v[56:59], v[16:23], v1
s_waitcnt lgkmcnt(2)
s_waitcnt lgkmcnt(1)
v_and_or_b32 v40, v40, -2, s18
v_smfmac_f32_16x16x64_bf16 v[48:51], v[60:63], v[24:31], v1
v_cvt_pk_bf16_f32 v41, v42, v43
v_smfmac_f32_16x16x64_bf16 v[48:51], v[12:15], v[208:215], v1
s_waitcnt lgkmcnt(0)
global_store_dwordx2 v44, v[40:41], s[50:51]
v_smfmac_f32_16x16x64_bf16 v[32:35], v[60:63], v[240:247], v1
s_nop 1
v_smfmac_f32_16x16x64_bf16 v[52:55], v[60:63], v[80:87], v1
s_add_u32 s27, s20, 524288
s_add_u32 s58, s4, s20
v_cvt_pk_bf16_f32 v48, v48, v49
v_and_or_b32 v48, v48, -2, s18
v_cvt_pk_bf16_f32 v49, v50, v51
v_smfmac_f32_16x16x64_bf16 v[52:55], v[12:15], v[224:231], v1
s_nop 0
global_store_dwordx2 v44, v[48:49], s[52:53]
s_addc_u32 s59, s5, 0
s_mov_b32 s30, 0
v_smfmac_f32_16x16x64_bf16 v[32:35], v[12:15], v[248:255], v1
s_nop 2
v_cvt_pk_bf16_f32 v52, v52, v53
v_cvt_pk_bf16_f32 v53, v54, v55
s_mov_b32 s19, 1
v_and_or_b32 v52, v52, -2, s18
global_store_dwordx2 v44, v[52:53], s[54:55]
v_cvt_pk_bf16_f32 v32, v32, v33
v_cvt_pk_bf16_f32 v33, v34, v35
v_and_or_b32 v32, v32, -2, s18
global_store_dwordx2 v44, v[32:33], s[56:57]
nored_10059:
v_cmp_gt_u32 vcc, s34, v7
s_cmp_eq_u32 vcc_hi, 0
s_cbranch_scc1 kv_10063
s_mov_b32 s30, 0
kv_10062:
v_and_b32 v7, 128, v0
buffer_load_dword v7, v7, s[4:7], s22 offen sc1
s_add_u32 s30, s30, 1
s_cmp_gt_u32 s30, 262144
s_cbranch_scc1 L_fail
s_waitcnt vmcnt(0)
v_cmp_gt_u32 vcc, s34, v7
s_cbranch_vccnz kv_10062
kv_10063:
v_and_b32 v7, 128, v0
v_add_u32 v7, s22, v7
s_mov_b32 exec_hi, 0
v_and_b32 v7, 255, v0
v_lshl_add_u32 v7, v7, 3, s27
s_mov_b32 exec_hi, -1
s_nop 15
s_nop 15
s_nop 15
s_nop 15
s_nop 15
s_nop 1
global_load_dwordx4 v[56:59], v0, s[76:77] offset:0 sc1
global_load_dwordx4 v[60:63], v0, s[76:77] offset:1024 sc1
global_load_dwordx4 v[80:83], v0, s[76:77] offset:2048 sc1
global_load_dwordx4 v[84:87], v0, s[76:77] offset:3072 sc1
join_10060:
s_barrier
s_nop 15
s_nop 15
s_nop 7
s_barrier
global_load_dwordx4 v[32:35], v0, s[68:69] offset:-4096 sc1
s_nop 10
global_load_dwordx4 v[36:39], v0, s[68:69] offset:0 sc1
s_barrier
global_load_dwordx4 v[48:51], v0, s[58:59] offset:0 nt sc1
global_load_dwordx4 v[52:55], v0, s[58:59] offset:1024 nt sc1
v_mov_b64 v[8:9], 0
v_mov_b64 v[10:11], 0
v_mov_b64 v[12:13], 0
v_mov_b64 v[14:15], 0
v_mov_b64 v[16:17], 0
v_mov_b64 v[18:19], 0
v_mov_b64 v[20:21], 0
v_mov_b64 v[22:23], 0
v_mov_b64 v[24:25], 0
v_mov_b64 v[26:27], 0
v_mov_b64 v[28:29], 0
v_mov_b64 v[30:31], 0
s_mov_b32 s30, 0
s_cmp_eq_u32 s17, s31
s_cbranch_scc0 gather_10051
s_branch exit_10054
rt_10056:
global_load_dwordx4 v[32:35], v0, s[68:69] offset:-4096 sc1
global_load_dwordx4 v[36:39], v0, s[68:69] offset:0 sc1
s_add_u32 s30, s30, 1
s_cmp_gt_u32 s30, 262144
s_cbranch_scc1 L_fail
s_mov_b64 exec, 1
global_store_dword v0, v0, s[62:63]
global_store_dword v0, v0, s[62:63]
s_mov_b64 exec, -1
v_mov_b64 v[8:9], 0
v_mov_b64 v[10:11], 0
v_mov_b64 v[12:13], 0
v_mov_b64 v[14:15], 0
v_mov_b64 v[16:17], 0
v_mov_b64 v[18:19], 0
v_mov_b64 v[20:21], 0
v_mov_b64 v[22:23], 0
v_mov_b64 v[24:25], 0
v_mov_b64 v[26:27], 0
v_mov_b64 v[28:29], 0
v_mov_b64 v[30:31], 0
s_branch gather_10051
rare_10052:
ds_read_b128 v[48:51], v6 offset:6144
ds_read_b128 v[52:55], v6 offset:7168
s_waitcnt lgkmcnt(0)
v_add_f32 v48, v48, v52
v_add_f32 v49, v49, v53
v_add_f32 v50, v50, v54
v_add_f32 v51, v51, v55
v_mov_b32_dpp v46, v46 quad_perm:[0,1,0,1] row_mask:0xf bank_mask:0xf
v_mov_b32_dpp v47, v47 quad_perm:[0,1,0,1] row_mask:0xf bank_mask:0xf
v_max3_f32 v19, v48, v49, v50
v_max3_f32 v19, v19, v51, v46
v_max_f32 v19, v19, v47
s_nop 1
v_max_f32_dpp v19, v19, v19 quad_perm:[2,3,0,1] row_mask:0xf bank_mask:0xf
v_mov_b32 v44, v19
s_nop 1
v_permlane32_swap_b32 v19, v44
v_max_f32 v19, v19, v44
v_mov_b32 v44, v19
s_nop 1
v_permlane16_swap_b32 v19, v44
v_max_f32 v19, v19, v44
v_sub_f32 v48, v48, v19
v_sub_f32 v49, v49, v19
v_sub_f32 v50, v50, v19
v_sub_f32 v51, v51, v19
v_sub_f32 v46, v46, v19
v_sub_f32 v47, v47, v19
v_exp_f32 v48, v48
v_exp_f32 v49, v49
v_exp_f32 v50, v50
v_exp_f32 v51, v51
v_cvt_pk_bf16_f32 v54, v48, v49
v_cvt_pk_bf16_f32 v55, v50, v51
s_nop 0
v_mov_b32_dpp v48, v54 quad_perm:[0,1,0,1] row_mask:0xf bank_mask:0xf
v_mov_b32_dpp v49, v55 quad_perm:[0,1,0,1] row_mask:0xf bank_mask:0xf
v_mov_b32_dpp v50, v54 quad_perm:[2,3,2,3] row_mask:0xf bank_mask:0xf
v_mov_b32_dpp v51, v55 quad_perm:[2,3,2,3] row_mask:0xf bank_mask:0xf
v_mov_b64 v[20:21], s[44:45]
v_mov_b64 v[22:23], s[44:45]
v_mfma_f32_16x16x32_bf16 v[8:11], v[56:59], v[48:51], 0
v_mfma_f32_16x16x32_bf16 v[12:15], v[60:63], v[48:51], 0
v_mfma_f32_16x16x32_bf16 v[16:19], v[20:23], v[48:51], 0
v_mov_b64 v[54:55], s[46:47]
v_exp_f32_dpp v44, v46 quad_perm:[0,1,0,1] row_mask:0xf bank_mask:0xf
v_exp_f32_dpp v45, v47 quad_perm:[0,1,0,1] row_mask:0xf bank_mask:0xf
s_nop 0
v_cvt_pk_bf16_f32 v52, v44, v45
v_cvt_pk_bf16_f32 v53, v44, v45
s_nop 1
v_mfma_f32_16x16x16_bf16 v[16:19], v[54:55], v[52:53], v[16:19]
v_mfma_f32_16x16x16_bf16 v[8:11], v[24:25], v[52:53], v[8:11]
v_mfma_f32_16x16x16_bf16 v[12:15], v[26:27], v[52:53], v[12:15]
s_nop 5
v_rcp_f32 v18, v16
s_nop 0
v_cndmask_b32 v8, v12, v8, s[42:43]
v_mul_f32 v8, v8, v18
v_cndmask_b32 v9, v13, v9, s[42:43]
v_mul_f32 v9, v9, v18
v_cndmask_b32 v10, v14, v10, s[42:43]
v_mul_f32 v10, v10, v18
v_cndmask_b32 v11, v15, v11, s[42:43]
v_mul_f32 v11, v11, v18
v_cvt_pk_bf16_f32 v12, v8, v9
v_cvt_pk_bf16_f32 v13, v10, v11
s_branch back_10053
exit_10054:
global_load_dwordx4 v[32:35], v0, s[68:69] offset:-4096 sc1
global_load_dwordx4 v[36:39], v0, s[68:69] offset:0 sc1
s_add_u32 s30, s30, 1
s_cmp_gt_u32 s30, 262144
s_cbranch_scc1 L_fail
s_waitcnt vmcnt(1)
v_bitop3_b32 v44, v32, v34, s18 bitop3:0x7e
s_waitcnt vmcnt(0)
v_bitop3_b32 v45, v36, v38, s18 bitop3:0x7e
v_bitop3_b32 v44, v44, v45, s19 bitop3:0xa8
v_cmp_ne_u32 vcc, 0, v44
s_cbranch_vccnz exit_10054
s_add_u32 s36, s36, 1
s_cmp_lt_u32 s36, 2
s_cbranch_scc1 layer_10050
s_endpgm
grp_10001:
s_bfm_b32 s24, s14, 0
s_and_b32 s24, s24, 0xaaaaaaaa
s_bcnt1_i32_b32 s24, s24
v_and_b32 v64, 63, v0
v_and_b32 v65, 15, v64
v_lshrrev_b32 v66, 4, v64
v_lshlrev_b32 v0, 4, v64
v_and_b32 v67, 2, v64
v_mov_b32 v68, 0x4444
v_mov_b32 v69, 0xeeee
v_cmp_eq_u32 vcc, 0, v67
s_nop 1
v_cndmask_b32 v1, v69, v68, vcc
s_mul_i32 s26, s13, 24576
s_add_u32 s26, s26, 65536
v_add_u32 v2, s26, v0
v_lshrrev_b32 v67, 2, v65
v_xor_b32 v68, v66, v67
v_lshlrev_b32 v68, 3, v68
v_lshl_add_u32 v68, v65, 5, v68
s_lshl_b32 s26, s13, 10
s_add_u32 s26, s26, 10240
v_add_u32 v3, s26, v68
v_lshl_add_u32 v68, v66, 2, v67
v_and_b32 v69, 3, v65
v_xor_b32 v69, v69, v66
v_lshlrev_b32 v69, 3, v69
v_lshl_add_u32 v68, v68, 5, v69
v_add_u32 v4, 10240, v68
v_and_b32 v69, 1, v65
v_lshl_add_u32 v68, v67, 1, v69
v_lshlrev_b32 v68, 4, v68
v_lshl_add_u32 v68, v66, 7, v68
v_add_u32 v5, 8192, v68
v_bfe_u32 v69, v65, 1, 1
v_mul_u32_u24 v69, 640, v69
v_xor_b32 v6, v69, v5
s_mov_b32 s42, 0x33333333
s_mov_b32 s43, 0x33333333
s_mov_b32 s44, 0x3f803f80
s_mov_b32 s45, 0x3f803f80
s_mov_b32 s46, 0x3f803f80
s_mov_b32 s47, 0
s_mov_b32 s37, 729808896
s_mov_b32 s38, 671088640
v_lshlrev_b32 v68, 3, v65
v_lshl_add_u32 v7, v66, 12, v68
s_lshl_b32 s26, s13, 14
s_lshl_b32 s27, s14, 7
s_add_u32 s26, s26, s27
s_add_u32 s90, s26, 65536
s_lshl_b32 s26, s13, 5
s_add_u32 s93, s26, s14
s_lshl_b32 s26, s93, 12
s_add_u32 s91, s26, 65536
s_lshr_b32 s26, s93, 2
s_lshl_b32 s26, s26, 9
s_and_b32 s27, s93, 3
s_lshl_b32 s27, s27, 6
s_add_u32 s26, s26, s27
s_add_u32 s92, s26, 393216
s_lshl_b32 s26, s14, 8
s_add_u32 s22, s26, 11534336
s_lshl_b32 s26, s24, 7
s_add_u32 s26, s26, 11550720
s_cmp_lt_u32 s24, 10
s_cselect_b32 s23, s26, 268435456
s_cselect_b32 s24, s24, 0
s_cselect_b32 s25, 12582912, s23
s_lshl_b32 s24, s24, 10
s_and_b32 s26, s14, 0
s_lshl_b32 s26, s26, 12
s_add_u32 s94, s26, 425984
s_lshl_b32 s26, s14, 7
s_add_u32 s95, s26, 425984
s_mov_b32 s35, 0x3e0293ee
s_lshl_b32 s26, s14, 2
s_add_u32 s26, s26, s13
s_mul_i32 s27, s26, 18432
s_add_u32 s89, s27, 1048576
s_add_u32 s48, s4, s90
s_addc_u32 s49, s5, 0
s_add_u32 s50, s90, 65536
s_add_u32 s50, s4, s50
s_addc_u32 s51, s5, 0
s_add_u32 s52, s90, 131072
s_add_u32 s52, s4, s52
s_addc_u32 s53, s5, 0
s_add_u32 s54, s90, 196608
s_add_u32 s54, s4, s54
s_addc_u32 s55, s5, 0
s_add_u32 s56, s90, 262144
s_add_u32 s56, s4, s56
s_addc_u32 s57, s5, 0
s_add_u32 s76, s89, 4096
s_add_u32 s76, s4, s76
s_addc_u32 s77, s5, 0
s_add_u32 s78, s89, 12288
s_add_u32 s78, s4, s78
s_addc_u32 s79, s5, 0
s_add_u32 s80, s89, 20480
s_add_u32 s80, s4, s80
s_addc_u32 s81, s5, 0
s_add_u32 s60, s4, s94
s_addc_u32 s61, s5, 0
s_add_u32 s62, s4, s95
s_addc_u32 s63, s5, 0
s_add_u32 s64, s4, s91
s_addc_u32 s65, s5, 0
s_add_u32 s66, s4, s92
s_addc_u32 s67, s5, 0
v_mov_b32 v72, 0
v_mov_b32 v73, 0
s_mov_b32 s26, s90
buffer_store_dwordx2 v[72:73], v7, s[4:7], s26 offen
s_add_u32 s26, s26, 65536
buffer_store_dwordx2 v[72:73], v7, s[4:7], s26 offen
s_add_u32 s26, s26, 65536
buffer_store_dwordx2 v[72:73], v7, s[4:7], s26 offen
s_add_u32 s26, s26, 65536
buffer_store_dwordx2 v[72:73], v7, s[4:7], s26 offen
s_add_u32 s26, s26, 65536
buffer_store_dwordx2 v[72:73], v7, s[4:7], s26 offen
s_add_u32 s26, s26, 65536
buffer_store_dword v72, off, s[4:7], s95 offset:0
s_load_dwordx2 s[96:97], s[0:1], 32
s_mov_b32 s98, 10240
s_mov_b32 s99, 0x20000
s_cmp_ge_u32 s93, 80
s_cbranch_scc1 nm0_10065
s_and_b32 s26, s93, 3
s_mul_i32 s26, s26, 2560
s_lshr_b32 s27, s93, 2
s_lshl_b32 s27, s27, 6
s_add_u32 s26, s26, s27
v_bfe_u32 v68, v65, 1, 2
v_lshlrev_b32 v68, 4, v68
v_and_b32 v69, 1, v65
v_lshl_add_u32 v68, v69, 2, v68
v_and_b32 v69, 1, v66
v_mul_u32_u24 v69, 1280, v69
v_add_u32 v68, v68, v69
s_waitcnt lgkmcnt(0)
buffer_load_dword v74, v68, s[96:99], s26 offen
buffer_load_dword v75, v68, s[96:99], s26 offen offset:8
v_and_b32 v68, 32, v0
v_bfe_u32 v69, v0, 6, 1
v_lshl_add_u32 v68, v69, 8, v68
v_bfe_u32 v69, v0, 8, 1
v_lshl_add_u32 v68, v69, 4, v68
v_bfe_u32 v69, v0, 4, 1
v_lshl_add_u32 v68, v69, 3, v68
s_add_u32 s27, s92, 16384
buffer_store_dwordx2 v[72:73], v68, s[4:7], s92 offen
s_waitcnt vmcnt(1)
buffer_store_dwordx2 v[74:75], v68, s[4:7], s27 offen
nm0_10065:
s_waitcnt vmcnt(0) lgkmcnt(0)
s_barrier
s_cmp_eq_u32 s13, 0
s_cselect_b32 s26, 4, s10
v_mov_b32 v74, 1
s_mov_b64 exec, 1
buffer_atomic_add v74, off, s[8:11], s26
s_mov_b64 exec, -1
v_lshrrev_b32 v67, 3, v64
v_and_b32 v68, 7, v64
v_lshlrev_b32 v68, 4, v68
v_lshl_add_u32 v32, v67, 13, v68
v_mul_u32_u24 v67, 1280, v67
v_add_u32 v36, v67, v68
v_lshrrev_b32 v67, 1, v66
v_lshlrev_b32 v67, 4, v67
v_and_b32 v68, 1, v66
v_lshl_add_u32 v67, v68, 1, v67
v_lshrrev_b32 v68, 3, v65
v_lshl_add_u32 v67, v68, 3, v67
v_bfe_u32 v68, v65, 2, 1
v_add_u32 v67, v67, v68
v_and_b32 v69, 3, v65
v_lshlrev_b32 v40, 4, v69
v_lshl_add_u32 v40, v67, 7, v40
v_lshl_add_u32 v67, v66, 2, v68
v_lshlrev_b32 v42, 4, v69
v_lshl_add_u32 v42, v67, 7, v42
v_lshrrev_b32 v68, 3, v65
v_lshl_add_u32 v42, v68, 3, v42
s_lshl_b32 s29, s13, 12
s_and_b32 s26, s13, 1
s_lshl_b32 s26, s26, 6
s_add_u32 s26, s26, s29
v_add_u32 v40, s26, v40
v_add_u32 v42, s26, v42
v_xor_b32 v41, 4096, v40
v_xor_b32 v43, 4096, v42
v_add_u32 v33, 64512, v32
v_add_u32 v37, 9216, v36
v_add_u32 v34, 129024, v32
v_add_u32 v38, 18432, v36
v_add_u32 v35, 193536, v32
v_add_u32 v39, 27648, v36
s_lshr_b32 s28, s13, 1
s_lshl_b32 s28, s28, 7
s_lshl_b32 s27, s14, 8
s_add_u32 s27, s27, s28
s_xor_b32 s26, s13, 0
s_lshl_b32 s82, s26, 19
s_add_u32 s82, s82, s27
s_lshl_b32 s85, s14, 2
s_add_u32 s85, s85, s26
s_mul_i32 s85, s85, 40960
s_add_u32 s85, s85, s28
s_xor_b32 s26, s13, 2
s_lshl_b32 s83, s26, 19
s_add_u32 s83, s83, s27
s_lshl_b32 s86, s14, 2
s_add_u32 s86, s86, s26
s_mul_i32 s86, s86, 40960
s_add_u32 s86, s86, s28
s_and_b32 s26, s13, 1
s_add_u32 s26, s26, 8
s_lshl_b32 s84, s26, 19
s_add_u32 s84, s84, s27
s_load_dwordx2 s[68:69], s[0:1], 40
s_load_dwordx2 s[70:71], s[0:1], 48
s_load_dwordx2 s[72:73], s[0:1], 56
s_load_dwordx2 s[74:75], s[0:1], 64
s_mov_b32 s98, 5242880
s_waitcnt lgkmcnt(0)
s_mov_b64 s[96:97], s[70:71]
s_add_u32 m0, s29, 0
s_add_u32 s26, s82, 0
buffer_load_dwordx4 v32, s[96:99], s26 offen offset:0 lds
buffer_load_dwordx4 v33, s[96:99], s26 offen offset:1024 lds
buffer_load_dwordx4 v34, s[96:99], s26 offen offset:2048 lds
buffer_load_dwordx4 v35, s[96:99], s26 offen offset:3072 lds
s_add_u32 m0, s29, 16384
s_add_u32 s26, s82, 262144
buffer_load_dwordx4 v32, s[96:99], s26 offen offset:0 lds
buffer_load_dwordx4 v33, s[96:99], s26 offen offset:1024 lds
buffer_load_dwordx4 v34, s[96:99], s26 offen offset:2048 lds
buffer_load_dwordx4 v35, s[96:99], s26 offen offset:3072 lds
s_add_u32 m0, s29, 32768
s_add_u32 s26, s82, 2097152
buffer_load_dwordx4 v32, s[96:99], s26 offen offset:0 lds
buffer_load_dwordx4 v33, s[96:99], s26 offen offset:1024 lds
buffer_load_dwordx4 v34, s[96:99], s26 offen offset:2048 lds
buffer_load_dwordx4 v35, s[96:99], s26 offen offset:3072 lds
s_waitcnt vmcnt(8)
s_barrier
s_add_u32 m0, s29, 49152
s_add_u32 s26, s82, 2359296
buffer_load_dwordx4 v32, s[96:99], s26 offen offset:0 lds
buffer_load_dwordx4 v33, s[96:99], s26 offen offset:1024 lds
buffer_load_dwordx4 v34, s[96:99], s26 offen offset:2048 lds
buffer_load_dwordx4 v35, s[96:99], s26 offen offset:3072 lds
ds_read_b64_tr_b16 v[72:73], v40 offset:0
ds_read_b64_tr_b16 v[74:75], v40 offset:512
ds_read_b64_tr_b16 v[76:77], v40 offset:8
ds_read_b64_tr_b16 v[78:79], v40 offset:520
ds_read_b64_tr_b16 v[80:81], v41 offset:0
ds_read_b64_tr_b16 v[82:83], v41 offset:512
ds_read_b64_tr_b16 a[128:129], v41 offset:8
ds_read_b64_tr_b16 a[130:131], v41 offset:520
s_waitcnt lgkmcnt(6)
global_store_dwordx4 v0, v[72:75], s[76:77] offset:0
s_waitcnt lgkmcnt(4)
global_store_dwordx4 v0, v[76:79], s[76:77] offset:2048
s_waitcnt lgkmcnt(2)
ds_write_b128 v2, v[80:83] offset:12288
s_waitcnt vmcnt(10) lgkmcnt(1)
s_barrier
s_add_u32 m0, s29, 0
s_add_u32 s26, s83, 0
buffer_load_dwordx4 v32, s[96:99], s26 offen offset:0 lds
buffer_load_dwordx4 v33, s[96:99], s26 offen offset:1024 lds
buffer_load_dwordx4 v34, s[96:99], s26 offen offset:2048 lds
buffer_load_dwordx4 v35, s[96:99], s26 offen offset:3072 lds
ds_read_b64_tr_b16 v[72:73], v40 offset:16384
ds_read_b64_tr_b16 v[74:75], v40 offset:16896
ds_read_b64_tr_b16 v[76:77], v40 offset:16392
ds_read_b64_tr_b16 v[78:79], v40 offset:16904
ds_read_b64_tr_b16 v[80:81], v41 offset:16384
ds_read_b64_tr_b16 v[82:83], v41 offset:16896
ds_read_b64_tr_b16 a[132:133], v41 offset:16392
ds_read_b64_tr_b16 a[134:135], v41 offset:16904
s_waitcnt lgkmcnt(6)
global_store_dwordx4 v0, v[72:75], s[76:77] offset:1024
s_waitcnt lgkmcnt(4)
global_store_dwordx4 v0, v[76:79], s[76:77] offset:3072
s_waitcnt lgkmcnt(2)
ds_write_b128 v2, v[80:83] offset:13312
s_waitcnt vmcnt(12) lgkmcnt(1)
s_barrier
s_add_u32 m0, s29, 16384
s_add_u32 s26, s83, 262144
buffer_load_dwordx4 v32, s[96:99], s26 offen offset:0 lds
buffer_load_dwordx4 v33, s[96:99], s26 offen offset:1024 lds
buffer_load_dwordx4 v34, s[96:99], s26 offen offset:2048 lds
buffer_load_dwordx4 v35, s[96:99], s26 offen offset:3072 lds
ds_read_b64_tr_b16 a[32:33], v40 offset:32768
ds_read_b64_tr_b16 a[34:35], v40 offset:33280
ds_read_b64_tr_b16 a[40:41], v40 offset:32776
ds_read_b64_tr_b16 a[42:43], v40 offset:33288
ds_read_b64_tr_b16 a[136:137], v41 offset:32768
ds_read_b64_tr_b16 a[138:139], v41 offset:33280
ds_read_b64_tr_b16 v[84:85], v41 offset:32776
ds_read_b64_tr_b16 v[86:87], v41 offset:33288
s_waitcnt lgkmcnt(0)
ds_write_b128 v2, v[84:87] offset:14336
s_waitcnt vmcnt(12)
s_barrier
s_add_u32 m0, s29, 32768
s_add_u32 s26, s83, 2097152
buffer_load_dwordx4 v32, s[96:99], s26 offen offset:0 lds
buffer_load_dwordx4 v33, s[96:99], s26 offen offset:1024 lds
buffer_load_dwordx4 v34, s[96:99], s26 offen offset:2048 lds
buffer_load_dwordx4 v35, s[96:99], s26 offen offset:3072 lds
ds_read_b64_tr_b16 a[36:37], v40 offset:49152
ds_read_b64_tr_b16 a[38:39], v40 offset:49664
ds_read_b64_tr_b16 a[44:45], v40 offset:49160
ds_read_b64_tr_b16 a[46:47], v40 offset:49672
ds_read_b64_tr_b16 a[140:141], v41 offset:49152
ds_read_b64_tr_b16 a[142:143], v41 offset:49664
ds_read_b64_tr_b16 v[84:85], v41 offset:49160
ds_read_b64_tr_b16 v[86:87], v41 offset:49672
s_waitcnt lgkmcnt(0)
ds_write_b128 v2, v[84:87] offset:15360
s_waitcnt vmcnt(10)
s_barrier
s_add_u32 m0, s29, 49152
s_add_u32 s26, s83, 2359296
buffer_load_dwordx4 v32, s[96:99], s26 offen offset:0 lds
buffer_load_dwordx4 v33, s[96:99], s26 offen offset:1024 lds
buffer_load_dwordx4 v34, s[96:99], s26 offen offset:2048 lds
buffer_load_dwordx4 v35, s[96:99], s26 offen offset:3072 lds
ds_read_b64_tr_b16 a[144:145], v40 offset:0
ds_read_b64_tr_b16 a[146:147], v40 offset:512
ds_read_b64_tr_b16 a[152:153], v40 offset:8
ds_read_b64_tr_b16 a[154:155], v40 offset:520
ds_read_b64_tr_b16 a[160:161], v41 offset:0
ds_read_b64_tr_b16 a[162:163], v41 offset:512
ds_read_b64_tr_b16 a[168:169], v41 offset:8
ds_read_b64_tr_b16 a[170:171], v41 offset:520
s_waitcnt vmcnt(8) lgkmcnt(0)
s_barrier
s_add_u32 m0, s29, 0
s_add_u32 s26, s84, 0
buffer_load_dwordx4 v32, s[96:99], s26 offen offset:0 lds
buffer_load_dwordx4 v33, s[96:99], s26 offen offset:1024 lds
buffer_load_dwordx4 v34, s[96:99], s26 offen offset:2048 lds
buffer_load_dwordx4 v35, s[96:99], s26 offen offset:3072 lds
ds_read_b64_tr_b16 a[148:149], v40 offset:16384
ds_read_b64_tr_b16 a[150:151], v40 offset:16896
ds_read_b64_tr_b16 a[156:157], v40 offset:16392
ds_read_b64_tr_b16 a[158:159], v40 offset:16904
ds_read_b64_tr_b16 a[164:165], v41 offset:16384
ds_read_b64_tr_b16 a[166:167], v41 offset:16896
ds_read_b64_tr_b16 a[172:173], v41 offset:16392
ds_read_b64_tr_b16 a[174:175], v41 offset:16904
s_waitcnt vmcnt(8) lgkmcnt(0)
s_barrier
s_add_u32 m0, s29, 16384
s_add_u32 s26, s84, 262144
buffer_load_dwordx4 v32, s[96:99], s26 offen offset:0 lds
buffer_load_dwordx4 v33, s[96:99], s26 offen offset:1024 lds
buffer_load_dwordx4 v34, s[96:99], s26 offen offset:2048 lds
buffer_load_dwordx4 v35, s[96:99], s26 offen offset:3072 lds
ds_read_b64_tr_b16 v[72:73], v40 offset:32768
ds_read_b64_tr_b16 v[74:75], v40 offset:33280
ds_read_b64_tr_b16 v[76:77], v40 offset:32776
ds_read_b64_tr_b16 v[78:79], v40 offset:33288
ds_read_b64_tr_b16 a[176:177], v41 offset:32768
ds_read_b64_tr_b16 a[178:179], v41 offset:33280
ds_read_b64_tr_b16 v[84:85], v41 offset:32776
ds_read_b64_tr_b16 v[86:87], v41 offset:33288
s_waitcnt lgkmcnt(6)
global_store_dwordx4 v0, v[72:75], s[78:79] offset:0
s_waitcnt lgkmcnt(4)
ds_write_b128 v2, v[76:79] offset:16384
s_waitcnt lgkmcnt(1)
ds_write_b128 v2, v[84:87] offset:18432
s_waitcnt vmcnt(9)
s_barrier
s_mov_b64 s[96:97], s[72:73]
s_add_u32 m0, s29, 32768
s_add_u32 s26, s82, 0
buffer_load_dwordx4 v32, s[96:99], s26 offen offset:0 lds
buffer_load_dwordx4 v33, s[96:99], s26 offen offset:1024 lds
buffer_load_dwordx4 v34, s[96:99], s26 offen offset:2048 lds
buffer_load_dwordx4 v35, s[96:99], s26 offen offset:3072 lds
ds_read_b64_tr_b16 v[72:73], v40 offset:49152
ds_read_b64_tr_b16 v[74:75], v40 offset:49664
ds_read_b64_tr_b16 v[76:77], v40 offset:49160
ds_read_b64_tr_b16 v[78:79], v40 offset:49672
ds_read_b64_tr_b16 a[180:181], v41 offset:49152
ds_read_b64_tr_b16 a[182:183], v41 offset:49664
ds_read_b64_tr_b16 v[84:85], v41 offset:49160
ds_read_b64_tr_b16 v[86:87], v41 offset:49672
s_waitcnt lgkmcnt(6)
global_store_dwordx4 v0, v[72:75], s[78:79] offset:1024
s_waitcnt lgkmcnt(4)
ds_write_b128 v2, v[76:79] offset:17408
s_waitcnt lgkmcnt(1)
ds_write_b128 v2, v[84:87] offset:19456
s_waitcnt vmcnt(10)
s_barrier
s_add_u32 m0, s29, 49152
s_add_u32 s26, s82, 262144
buffer_load_dwordx4 v32, s[96:99], s26 offen offset:0 lds
buffer_load_dwordx4 v33, s[96:99], s26 offen offset:1024 lds
buffer_load_dwordx4 v34, s[96:99], s26 offen offset:2048 lds
buffer_load_dwordx4 v35, s[96:99], s26 offen offset:3072 lds
ds_read_b64_tr_b16 a[184:185], v40 offset:0
ds_read_b64_tr_b16 a[186:187], v40 offset:512
ds_read_b64_tr_b16 a[192:193], v40 offset:8
ds_read_b64_tr_b16 a[194:195], v40 offset:520
ds_read_b64_tr_b16 a[200:201], v41 offset:0
ds_read_b64_tr_b16 a[202:203], v41 offset:512
ds_read_b64_tr_b16 a[208:209], v41 offset:8
ds_read_b64_tr_b16 a[210:211], v41 offset:520
s_waitcnt vmcnt(10) lgkmcnt(0)
s_barrier
s_add_u32 m0, s29, 0
s_add_u32 s26, s82, 2097152
buffer_load_dwordx4 v32, s[96:99], s26 offen offset:0 lds
buffer_load_dwordx4 v33, s[96:99], s26 offen offset:1024 lds
buffer_load_dwordx4 v34, s[96:99], s26 offen offset:2048 lds
buffer_load_dwordx4 v35, s[96:99], s26 offen offset:3072 lds
ds_read_b64_tr_b16 a[188:189], v40 offset:16384
ds_read_b64_tr_b16 a[190:191], v40 offset:16896
ds_read_b64_tr_b16 a[196:197], v40 offset:16392
ds_read_b64_tr_b16 a[198:199], v40 offset:16904
ds_read_b64_tr_b16 a[204:205], v41 offset:16384
ds_read_b64_tr_b16 a[206:207], v41 offset:16896
ds_read_b64_tr_b16 a[212:213], v41 offset:16392
ds_read_b64_tr_b16 a[214:215], v41 offset:16904
s_waitcnt vmcnt(9) lgkmcnt(0)
s_barrier
s_add_u32 m0, s29, 16384
s_add_u32 s26, s82, 2359296
buffer_load_dwordx4 v32, s[96:99], s26 offen offset:0 lds
buffer_load_dwordx4 v33, s[96:99], s26 offen offset:1024 lds
buffer_load_dwordx4 v34, s[96:99], s26 offen offset:2048 lds
buffer_load_dwordx4 v35, s[96:99], s26 offen offset:3072 lds
ds_read_b64_tr_b16 a[0:1], v40 offset:32768
ds_read_b64_tr_b16 a[2:3], v40 offset:33280
ds_read_b64_tr_b16 a[8:9], v40 offset:32776
ds_read_b64_tr_b16 a[10:11], v40 offset:33288
ds_read_b64_tr_b16 a[240:241], v41 offset:32768
ds_read_b64_tr_b16 a[242:243], v41 offset:33280
ds_read_b64_tr_b16 a[248:249], v41 offset:32776
ds_read_b64_tr_b16 a[250:251], v41 offset:33288
s_waitcnt vmcnt(8) lgkmcnt(0)
s_barrier
s_add_u32 m0, s29, 32768
s_add_u32 s26, s83, 0
buffer_load_dwordx4 v32, s[96:99], s26 offen offset:0 lds
buffer_load_dwordx4 v33, s[96:99], s26 offen offset:1024 lds
buffer_load_dwordx4 v34, s[96:99], s26 offen offset:2048 lds
buffer_load_dwordx4 v35, s[96:99], s26 offen offset:3072 lds
ds_read_b64_tr_b16 a[4:5], v40 offset:49152
ds_read_b64_tr_b16 a[6:7], v40 offset:49664
ds_read_b64_tr_b16 a[12:13], v40 offset:49160
ds_read_b64_tr_b16 a[14:15], v40 offset:49672
ds_read_b64_tr_b16 a[244:245], v41 offset:49152
ds_read_b64_tr_b16 a[246:247], v41 offset:49664
ds_read_b64_tr_b16 a[252:253], v41 offset:49160
ds_read_b64_tr_b16 a[254:255], v41 offset:49672
s_waitcnt vmcnt(8) lgkmcnt(0)
s_barrier
s_add_u32 m0, s29, 49152
s_add_u32 s26, s83, 262144
buffer_load_dwordx4 v32, s[96:99], s26 offen offset:0 lds
buffer_load_dwordx4 v33, s[96:99], s26 offen offset:1024 lds
buffer_load_dwordx4 v34, s[96:99], s26 offen offset:2048 lds
buffer_load_dwordx4 v35, s[96:99], s26 offen offset:3072 lds
ds_read_b64_tr_b16 v[72:73], v40 offset:0
ds_read_b64_tr_b16 v[74:75], v40 offset:512
ds_read_b64_tr_b16 v[76:77], v40 offset:8
ds_read_b64_tr_b16 v[78:79], v40 offset:520
ds_read_b64_tr_b16 v[80:81], v41 offset:0
ds_read_b64_tr_b16 v[82:83], v41 offset:512
ds_read_b64_tr_b16 v[88:89], v41 offset:8
ds_read_b64_tr_b16 v[90:91], v41 offset:520
s_waitcnt lgkmcnt(6)
ds_write_b128 v2, v[72:75] offset:0
s_waitcnt lgkmcnt(5)
ds_write_b128 v2, v[76:79] offset:2048
s_waitcnt lgkmcnt(4)
global_store_dwordx4 v0, v[80:83], s[78:79] offset:2048
s_waitcnt vmcnt(9) lgkmcnt(2)
s_barrier
s_add_u32 m0, s29, 0
s_add_u32 s26, s83, 2097152
buffer_load_dwordx4 v32, s[96:99], s26 offen offset:0 lds
buffer_load_dwordx4 v33, s[96:99], s26 offen offset:1024 lds
buffer_load_dwordx4 v34, s[96:99], s26 offen offset:2048 lds
buffer_load_dwordx4 v35, s[96:99], s26 offen offset:3072 lds
ds_read_b64_tr_b16 v[72:73], v40 offset:16384
ds_read_b64_tr_b16 v[74:75], v40 offset:16896
ds_read_b64_tr_b16 v[76:77], v40 offset:16392
ds_read_b64_tr_b16 v[78:79], v40 offset:16904
ds_read_b64_tr_b16 v[80:81], v41 offset:16384
ds_read_b64_tr_b16 v[82:83], v41 offset:16896
ds_read_b64_tr_b16 v[92:93], v41 offset:16392
ds_read_b64_tr_b16 v[94:95], v41 offset:16904
s_waitcnt lgkmcnt(6)
ds_write_b128 v2, v[72:75] offset:1024
s_waitcnt lgkmcnt(5)
ds_write_b128 v2, v[76:79] offset:3072
s_waitcnt lgkmcnt(4)
global_store_dwordx4 v0, v[80:83], s[78:79] offset:3072
s_waitcnt vmcnt(10) lgkmcnt(2)
s_barrier
s_add_u32 m0, s29, 16384
s_add_u32 s26, s83, 2359296
buffer_load_dwordx4 v32, s[96:99], s26 offen offset:0 lds
buffer_load_dwordx4 v33, s[96:99], s26 offen offset:1024 lds
buffer_load_dwordx4 v34, s[96:99], s26 offen offset:2048 lds
buffer_load_dwordx4 v35, s[96:99], s26 offen offset:3072 lds
ds_read_b64_tr_b16 v[96:97], v40 offset:32768
ds_read_b64_tr_b16 v[98:99], v40 offset:33280
ds_read_b64_tr_b16 v[104:105], v40 offset:32776
ds_read_b64_tr_b16 v[106:107], v40 offset:33288
ds_read_b64_tr_b16 v[128:129], v41 offset:32768
ds_read_b64_tr_b16 v[130:131], v41 offset:33280
ds_read_b64_tr_b16 v[136:137], v41 offset:32776
ds_read_b64_tr_b16 v[138:139], v41 offset:33288
s_waitcnt vmcnt(10) lgkmcnt(0)
s_barrier
s_add_u32 m0, s29, 32768
s_add_u32 s26, s84, 0
buffer_load_dwordx4 v32, s[96:99], s26 offen offset:0 lds
buffer_load_dwordx4 v33, s[96:99], s26 offen offset:1024 lds
buffer_load_dwordx4 v34, s[96:99], s26 offen offset:2048 lds
buffer_load_dwordx4 v35, s[96:99], s26 offen offset:3072 lds
ds_read_b64_tr_b16 v[100:101], v40 offset:49152
ds_read_b64_tr_b16 v[102:103], v40 offset:49664
ds_read_b64_tr_b16 v[108:109], v40 offset:49160
ds_read_b64_tr_b16 v[110:111], v40 offset:49672
ds_read_b64_tr_b16 v[132:133], v41 offset:49152
ds_read_b64_tr_b16 v[134:135], v41 offset:49664
ds_read_b64_tr_b16 v[140:141], v41 offset:49160
ds_read_b64_tr_b16 v[142:143], v41 offset:49672
s_waitcnt vmcnt(9) lgkmcnt(0)
s_barrier
s_add_u32 m0, s29, 49152
s_add_u32 s26, s84, 262144
buffer_load_dwordx4 v32, s[96:99], s26 offen offset:0 lds
buffer_load_dwordx4 v33, s[96:99], s26 offen offset:1024 lds
buffer_load_dwordx4 v34, s[96:99], s26 offen offset:2048 lds
buffer_load_dwordx4 v35, s[96:99], s26 offen offset:3072 lds
ds_read_b64_tr_b16 v[112:113], v40 offset:0
ds_read_b64_tr_b16 v[114:115], v40 offset:512
ds_read_b64_tr_b16 v[120:121], v40 offset:8
ds_read_b64_tr_b16 v[122:123], v40 offset:520
ds_read_b64_tr_b16 v[80:81], v41 offset:0
ds_read_b64_tr_b16 v[82:83], v41 offset:512
ds_read_b64_tr_b16 v[144:145], v41 offset:8
ds_read_b64_tr_b16 v[146:147], v41 offset:520
s_waitcnt lgkmcnt(2)
global_store_dwordx4 v0, v[80:83], s[80:81] offset:-4096
s_waitcnt vmcnt(9) lgkmcnt(0)
s_barrier
s_mov_b64 s[96:97], s[68:69]
s_add_u32 m0, s29, 0
s_add_u32 s26, s82, 0
buffer_load_dwordx4 v32, s[96:99], s26 offen offset:0 lds
buffer_load_dwordx4 v33, s[96:99], s26 offen offset:1024 lds
buffer_load_dwordx4 v34, s[96:99], s26 offen offset:2048 lds
buffer_load_dwordx4 v35, s[96:99], s26 offen offset:3072 lds
ds_read_b64_tr_b16 v[116:117], v40 offset:16384
ds_read_b64_tr_b16 v[118:119], v40 offset:16896
ds_read_b64_tr_b16 v[124:125], v40 offset:16392
ds_read_b64_tr_b16 v[126:127], v40 offset:16904
ds_read_b64_tr_b16 v[80:81], v41 offset:16384
ds_read_b64_tr_b16 v[82:83], v41 offset:16896
ds_read_b64_tr_b16 v[148:149], v41 offset:16392
ds_read_b64_tr_b16 v[150:151], v41 offset:16904
s_waitcnt lgkmcnt(2)
global_store_dwordx4 v0, v[80:83], s[80:81] offset:-3072
s_waitcnt vmcnt(10) lgkmcnt(0)
s_barrier
s_add_u32 m0, s29, 16384
s_add_u32 s26, s82, 262144
buffer_load_dwordx4 v32, s[96:99], s26 offen offset:0 lds
buffer_load_dwordx4 v33, s[96:99], s26 offen offset:1024 lds
buffer_load_dwordx4 v34, s[96:99], s26 offen offset:2048 lds
buffer_load_dwordx4 v35, s[96:99], s26 offen offset:3072 lds
ds_read_b64_tr_b16 a[216:217], v40 offset:32768
ds_read_b64_tr_b16 a[218:219], v40 offset:33280
ds_read_b64_tr_b16 a[224:225], v40 offset:32776
ds_read_b64_tr_b16 a[226:227], v40 offset:33288
ds_read_b64_tr_b16 a[232:233], v41 offset:32768
ds_read_b64_tr_b16 a[234:235], v41 offset:33280
ds_read_b64_tr_b16 v[84:85], v41 offset:32776
ds_read_b64_tr_b16 v[86:87], v41 offset:33288
s_waitcnt lgkmcnt(0)
ds_write_b128 v2, v[84:87] offset:20480
s_waitcnt vmcnt(10)
s_barrier
s_add_u32 m0, s29, 32768
s_add_u32 s26, s82, 2097152
buffer_load_dwordx4 v32, s[96:99], s26 offen offset:0 lds
buffer_load_dwordx4 v33, s[96:99], s26 offen offset:1024 lds
buffer_load_dwordx4 v34, s[96:99], s26 offen offset:2048 lds
buffer_load_dwordx4 v35, s[96:99], s26 offen offset:3072 lds
ds_read_b64_tr_b16 a[220:221], v40 offset:49152
ds_read_b64_tr_b16 a[222:223], v40 offset:49664
ds_read_b64_tr_b16 a[228:229], v40 offset:49160
ds_read_b64_tr_b16 a[230:231], v40 offset:49672
ds_read_b64_tr_b16 a[236:237], v41 offset:49152
ds_read_b64_tr_b16 a[238:239], v41 offset:49664
ds_read_b64_tr_b16 v[84:85], v41 offset:49160
ds_read_b64_tr_b16 v[86:87], v41 offset:49672
s_waitcnt lgkmcnt(0)
ds_write_b128 v2, v[84:87] offset:21504
s_waitcnt vmcnt(9)
s_barrier
s_add_u32 m0, s29, 49152
s_add_u32 s26, s82, 2359296
buffer_load_dwordx4 v32, s[96:99], s26 offen offset:0 lds
buffer_load_dwordx4 v33, s[96:99], s26 offen offset:1024 lds
buffer_load_dwordx4 v34, s[96:99], s26 offen offset:2048 lds
buffer_load_dwordx4 v35, s[96:99], s26 offen offset:3072 lds
ds_read_b64_tr_b16 v[72:73], v40 offset:0
ds_read_b64_tr_b16 v[74:75], v40 offset:512
ds_read_b64_tr_b16 v[76:77], v40 offset:8
ds_read_b64_tr_b16 v[78:79], v40 offset:520
ds_read_b64_tr_b16 a[48:49], v41 offset:0
ds_read_b64_tr_b16 a[50:51], v41 offset:512
ds_read_b64_tr_b16 v[84:85], v41 offset:8
ds_read_b64_tr_b16 v[86:87], v41 offset:520
s_waitcnt lgkmcnt(6)
global_store_dwordx4 v0, v[72:75], s[76:77] offset:-4096
s_waitcnt lgkmcnt(4)
global_store_dwordx4 v0, v[76:79], s[76:77] offset:-2048
s_waitcnt lgkmcnt(0)
global_store_dwordx4 v0, v[84:87], s[78:79] offset:-4096
s_waitcnt vmcnt(11)
s_barrier
s_add_u32 m0, s29, 0
s_add_u32 s26, s83, 0
buffer_load_dwordx4 v32, s[96:99], s26 offen offset:0 lds
buffer_load_dwordx4 v33, s[96:99], s26 offen offset:1024 lds
buffer_load_dwordx4 v34, s[96:99], s26 offen offset:2048 lds
buffer_load_dwordx4 v35, s[96:99], s26 offen offset:3072 lds
ds_read_b64_tr_b16 v[72:73], v40 offset:16384
ds_read_b64_tr_b16 v[74:75], v40 offset:16896
ds_read_b64_tr_b16 v[76:77], v40 offset:16392
ds_read_b64_tr_b16 v[78:79], v40 offset:16904
ds_read_b64_tr_b16 a[52:53], v41 offset:16384
ds_read_b64_tr_b16 a[54:55], v41 offset:16896
ds_read_b64_tr_b16 v[84:85], v41 offset:16392
ds_read_b64_tr_b16 v[86:87], v41 offset:16904
s_waitcnt lgkmcnt(6)
global_store_dwordx4 v0, v[72:75], s[76:77] offset:-3072
s_waitcnt lgkmcnt(4)
global_store_dwordx4 v0, v[76:79], s[76:77] offset:-1024
s_waitcnt lgkmcnt(0)
global_store_dwordx4 v0, v[84:87], s[78:79] offset:-3072
s_waitcnt vmcnt(14)
s_barrier
s_add_u32 m0, s29, 16384
s_add_u32 s26, s83, 262144
buffer_load_dwordx4 v32, s[96:99], s26 offen offset:0 lds
buffer_load_dwordx4 v33, s[96:99], s26 offen offset:1024 lds
buffer_load_dwordx4 v34, s[96:99], s26 offen offset:2048 lds
buffer_load_dwordx4 v35, s[96:99], s26 offen offset:3072 lds
ds_read_b64_tr_b16 a[16:17], v40 offset:32768
ds_read_b64_tr_b16 a[18:19], v40 offset:33280
ds_read_b64_tr_b16 a[24:25], v40 offset:32776
ds_read_b64_tr_b16 a[26:27], v40 offset:33288
ds_read_b64_tr_b16 a[56:57], v41 offset:32768
ds_read_b64_tr_b16 a[58:59], v41 offset:33280
ds_read_b64_tr_b16 a[64:65], v41 offset:32776
ds_read_b64_tr_b16 a[66:67], v41 offset:33288
s_waitcnt vmcnt(14) lgkmcnt(0)
s_barrier
s_add_u32 m0, s29, 32768
s_add_u32 s26, s83, 2097152
buffer_load_dwordx4 v32, s[96:99], s26 offen offset:0 lds
buffer_load_dwordx4 v33, s[96:99], s26 offen offset:1024 lds
buffer_load_dwordx4 v34, s[96:99], s26 offen offset:2048 lds
buffer_load_dwordx4 v35, s[96:99], s26 offen offset:3072 lds
ds_read_b64_tr_b16 a[20:21], v40 offset:49152
ds_read_b64_tr_b16 a[22:23], v40 offset:49664
ds_read_b64_tr_b16 a[28:29], v40 offset:49160
ds_read_b64_tr_b16 a[30:31], v40 offset:49672
ds_read_b64_tr_b16 a[60:61], v41 offset:49152
ds_read_b64_tr_b16 a[62:63], v41 offset:49664
ds_read_b64_tr_b16 a[68:69], v41 offset:49160
ds_read_b64_tr_b16 a[70:71], v41 offset:49672
s_waitcnt vmcnt(11) lgkmcnt(0)
s_barrier
s_add_u32 m0, s29, 49152
s_add_u32 s26, s83, 2359296
buffer_load_dwordx4 v32, s[96:99], s26 offen offset:0 lds
buffer_load_dwordx4 v33, s[96:99], s26 offen offset:1024 lds
buffer_load_dwordx4 v34, s[96:99], s26 offen offset:2048 lds
buffer_load_dwordx4 v35, s[96:99], s26 offen offset:3072 lds
ds_read_b64_tr_b16 v[72:73], v40 offset:0
ds_read_b64_tr_b16 v[74:75], v40 offset:512
ds_read_b64_tr_b16 a[72:73], v40 offset:8
ds_read_b64_tr_b16 a[74:75], v40 offset:520
ds_read_b64_tr_b16 a[88:89], v41 offset:0
ds_read_b64_tr_b16 a[90:91], v41 offset:512
ds_read_b64_tr_b16 a[96:97], v41 offset:8
ds_read_b64_tr_b16 a[98:99], v41 offset:520
s_waitcnt lgkmcnt(6)
ds_write_b128 v2, v[72:75] offset:4096
s_waitcnt vmcnt(8) lgkmcnt(1)
s_barrier
s_add_u32 m0, s29, 0
s_add_u32 s26, s84, 0
buffer_load_dwordx4 v32, s[96:99], s26 offen offset:0 lds
buffer_load_dwordx4 v33, s[96:99], s26 offen offset:1024 lds
buffer_load_dwordx4 v34, s[96:99], s26 offen offset:2048 lds
buffer_load_dwordx4 v35, s[96:99], s26 offen offset:3072 lds
ds_read_b64_tr_b16 v[72:73], v40 offset:16384
ds_read_b64_tr_b16 v[74:75], v40 offset:16896
ds_read_b64_tr_b16 a[76:77], v40 offset:16392
ds_read_b64_tr_b16 a[78:79], v40 offset:16904
ds_read_b64_tr_b16 a[92:93], v41 offset:16384
ds_read_b64_tr_b16 a[94:95], v41 offset:16896
ds_read_b64_tr_b16 a[100:101], v41 offset:16392
ds_read_b64_tr_b16 a[102:103], v41 offset:16904
s_waitcnt lgkmcnt(6)
ds_write_b128 v2, v[72:75] offset:5120
s_waitcnt vmcnt(8) lgkmcnt(1)
s_barrier
s_add_u32 m0, s29, 16384
s_add_u32 s26, s84, 262144
buffer_load_dwordx4 v32, s[96:99], s26 offen offset:0 lds
buffer_load_dwordx4 v33, s[96:99], s26 offen offset:1024 lds
buffer_load_dwordx4 v34, s[96:99], s26 offen offset:2048 lds
buffer_load_dwordx4 v35, s[96:99], s26 offen offset:3072 lds
ds_read_b64_tr_b16 a[80:81], v40 offset:32768
ds_read_b64_tr_b16 a[82:83], v40 offset:33280
ds_read_b64_tr_b16 v[76:77], v40 offset:32776
ds_read_b64_tr_b16 v[78:79], v40 offset:33288
ds_read_b64_tr_b16 v[80:81], v41 offset:32768
ds_read_b64_tr_b16 v[82:83], v41 offset:33280
ds_read_b64_tr_b16 a[104:105], v41 offset:32776
ds_read_b64_tr_b16 a[106:107], v41 offset:33288
s_waitcnt lgkmcnt(4)
ds_write_b128 v2, v[76:79] offset:6144
s_waitcnt lgkmcnt(3)
ds_write_b128 v2, v[80:83] offset:8192
s_waitcnt vmcnt(8) lgkmcnt(2)
s_barrier
s_mov_b64 s[96:97], s[74:75]
s_add_u32 m0, s29, 32768
s_add_u32 s26, s85, 0
buffer_load_dwordx4 v36, s[96:99], s26 offen offset:0 lds
buffer_load_dwordx4 v37, s[96:99], s26 offen offset:1024 lds
buffer_load_dwordx4 v38, s[96:99], s26 offen offset:2048 lds
buffer_load_dwordx4 v39, s[96:99], s26 offen offset:3072 lds
ds_read_b64_tr_b16 a[84:85], v40 offset:49152
ds_read_b64_tr_b16 a[86:87], v40 offset:49664
ds_read_b64_tr_b16 v[76:77], v40 offset:49160
ds_read_b64_tr_b16 v[78:79], v40 offset:49672
ds_read_b64_tr_b16 v[80:81], v41 offset:49152
ds_read_b64_tr_b16 v[82:83], v41 offset:49664
ds_read_b64_tr_b16 a[108:109], v41 offset:49160
ds_read_b64_tr_b16 a[110:111], v41 offset:49672
s_waitcnt lgkmcnt(4)
ds_write_b128 v2, v[76:79] offset:7168
s_waitcnt lgkmcnt(3)
ds_write_b128 v2, v[80:83] offset:9216
s_waitcnt vmcnt(8) lgkmcnt(2)
s_barrier
s_add_u32 m0, s29, 49152
s_add_u32 s26, s86, 0
buffer_load_dwordx4 v36, s[96:99], s26 offen offset:0 lds
buffer_load_dwordx4 v37, s[96:99], s26 offen offset:1024 lds
buffer_load_dwordx4 v38, s[96:99], s26 offen offset:2048 lds
buffer_load_dwordx4 v39, s[96:99], s26 offen offset:3072 lds
ds_read_b64_tr_b16 a[112:113], v40 offset:0
ds_read_b64_tr_b16 a[114:115], v40 offset:512
ds_read_b64_tr_b16 v[76:77], v40 offset:8
ds_read_b64_tr_b16 v[78:79], v40 offset:520
ds_read_b64_tr_b16 v[80:81], v41 offset:0
ds_read_b64_tr_b16 v[82:83], v41 offset:512
ds_read_b64_tr_b16 a[120:121], v41 offset:8
ds_read_b64_tr_b16 a[122:123], v41 offset:520
s_waitcnt lgkmcnt(4)
ds_write_b128 v2, v[76:79] offset:10240
s_waitcnt lgkmcnt(3)
global_store_dwordx4 v0, v[80:83], s[78:79] offset:-2048
s_waitcnt vmcnt(9) lgkmcnt(1)
s_barrier
s_add_u32 m0, s29, 0
s_add_u32 s26, s85, 256
buffer_load_dwordx4 v36, s[96:99], s26 offen offset:0 lds
buffer_load_dwordx4 v37, s[96:99], s26 offen offset:1024 lds
buffer_load_dwordx4 v38, s[96:99], s26 offen offset:2048 lds
buffer_load_dwordx4 v39, s[96:99], s26 offen offset:3072 lds
ds_read_b64_tr_b16 a[116:117], v40 offset:16384
ds_read_b64_tr_b16 a[118:119], v40 offset:16896
ds_read_b64_tr_b16 v[76:77], v40 offset:16392
ds_read_b64_tr_b16 v[78:79], v40 offset:16904
ds_read_b64_tr_b16 v[80:81], v41 offset:16384
ds_read_b64_tr_b16 v[82:83], v41 offset:16896
ds_read_b64_tr_b16 a[124:125], v41 offset:16392
ds_read_b64_tr_b16 a[126:127], v41 offset:16904
s_waitcnt lgkmcnt(4)
ds_write_b128 v2, v[76:79] offset:11264
s_waitcnt lgkmcnt(3)
global_store_dwordx4 v0, v[80:83], s[78:79] offset:-1024
s_waitcnt vmcnt(10) lgkmcnt(1)
s_barrier
s_add_u32 m0, s29, 16384
s_add_u32 s26, s86, 256
buffer_load_dwordx4 v36, s[96:99], s26 offen offset:0 lds
buffer_load_dwordx4 v37, s[96:99], s26 offen offset:1024 lds
buffer_load_dwordx4 v38, s[96:99], s26 offen offset:2048 lds
buffer_load_dwordx4 v39, s[96:99], s26 offen offset:3072 lds
ds_read_b64_tr_b16 v[72:73], v42 offset:32768
ds_read_b64_tr_b16 v[74:75], v42 offset:33024
ds_read_b64_tr_b16 v[76:77], v42 offset:34816
ds_read_b64_tr_b16 v[78:79], v42 offset:35072
ds_read_b64_tr_b16 v[8:9], v43 offset:32768
ds_read_b64_tr_b16 v[10:11], v43 offset:33024
ds_read_b64_tr_b16 v[12:13], v43 offset:34816
ds_read_b64_tr_b16 v[14:15], v43 offset:35072
s_waitcnt lgkmcnt(6)
ds_write_b128 v2, v[72:75] offset:22528
s_waitcnt lgkmcnt(5)
ds_write_b128 v2, v[76:79] offset:23552
s_waitcnt vmcnt(10) lgkmcnt(2)
s_barrier
s_add_u32 m0, s29, 32768
s_add_u32 s26, s85, 512
buffer_load_dwordx4 v36, s[96:99], s26 offen offset:0 lds
buffer_load_dwordx4 v37, s[96:99], s26 offen offset:1024 lds
buffer_load_dwordx4 v38, s[96:99], s26 offen offset:2048 lds
buffer_load_dwordx4 v39, s[96:99], s26 offen offset:3072 lds
ds_read_b64_tr_b16 v[16:17], v42 offset:49152
ds_read_b64_tr_b16 v[18:19], v42 offset:49408
ds_read_b64_tr_b16 v[20:21], v42 offset:51200
ds_read_b64_tr_b16 v[22:23], v42 offset:51456
ds_read_b64_tr_b16 v[184:185], v43 offset:49152
ds_read_b64_tr_b16 v[186:187], v43 offset:49408
ds_read_b64_tr_b16 v[188:189], v43 offset:51200
ds_read_b64_tr_b16 v[190:191], v43 offset:51456
s_waitcnt vmcnt(9) lgkmcnt(0)
s_barrier
s_add_u32 m0, s29, 49152
s_add_u32 s26, s86, 512
buffer_load_dwordx4 v36, s[96:99], s26 offen offset:0 lds
buffer_load_dwordx4 v37, s[96:99], s26 offen offset:1024 lds
buffer_load_dwordx4 v38, s[96:99], s26 offen offset:2048 lds
buffer_load_dwordx4 v39, s[96:99], s26 offen offset:3072 lds
ds_read_b64_tr_b16 v[152:153], v42 offset:0
ds_read_b64_tr_b16 v[154:155], v42 offset:256
ds_read_b64_tr_b16 v[156:157], v42 offset:2048
ds_read_b64_tr_b16 v[158:159], v42 offset:2304
ds_read_b64_tr_b16 v[24:25], v43 offset:0
ds_read_b64_tr_b16 v[26:27], v43 offset:256
ds_read_b64_tr_b16 v[28:29], v43 offset:2048
ds_read_b64_tr_b16 v[30:31], v43 offset:2304
s_waitcnt vmcnt(8) lgkmcnt(0)
s_barrier
s_add_u32 m0, s29, 0
s_add_u32 s26, s85, 768
buffer_load_dwordx4 v36, s[96:99], s26 offen offset:0 lds
buffer_load_dwordx4 v37, s[96:99], s26 offen offset:1024 lds
buffer_load_dwordx4 v38, s[96:99], s26 offen offset:2048 lds
buffer_load_dwordx4 v39, s[96:99], s26 offen offset:3072 lds
ds_read_b64_tr_b16 v[192:193], v42 offset:16384
ds_read_b64_tr_b16 v[194:195], v42 offset:16640
ds_read_b64_tr_b16 v[196:197], v42 offset:18432
ds_read_b64_tr_b16 v[198:199], v42 offset:18688
ds_read_b64_tr_b16 v[200:201], v43 offset:16384
ds_read_b64_tr_b16 v[202:203], v43 offset:16640
ds_read_b64_tr_b16 v[204:205], v43 offset:18432
ds_read_b64_tr_b16 v[206:207], v43 offset:18688
s_waitcnt vmcnt(8) lgkmcnt(0)
s_barrier
s_add_u32 m0, s29, 16384
s_add_u32 s26, s86, 768
buffer_load_dwordx4 v36, s[96:99], s26 offen offset:0 lds
buffer_load_dwordx4 v37, s[96:99], s26 offen offset:1024 lds
buffer_load_dwordx4 v38, s[96:99], s26 offen offset:2048 lds
buffer_load_dwordx4 v39, s[96:99], s26 offen offset:3072 lds
ds_read_b64_tr_b16 v[160:161], v42 offset:32768
ds_read_b64_tr_b16 v[162:163], v42 offset:33024
ds_read_b64_tr_b16 v[164:165], v42 offset:34816
ds_read_b64_tr_b16 v[166:167], v42 offset:35072
ds_read_b64_tr_b16 v[48:49], v43 offset:32768
ds_read_b64_tr_b16 v[50:51], v43 offset:33024
ds_read_b64_tr_b16 v[52:53], v43 offset:34816
ds_read_b64_tr_b16 v[54:55], v43 offset:35072
s_waitcnt vmcnt(8) lgkmcnt(0)
s_barrier
s_add_u32 m0, s29, 32768
s_add_u32 s26, s85, 1024
buffer_load_dwordx4 v36, s[96:99], s26 offen offset:0 lds
buffer_load_dwordx4 v37, s[96:99], s26 offen offset:1024 lds
buffer_load_dwordx4 v38, s[96:99], s26 offen offset:2048 lds
buffer_load_dwordx4 v39, s[96:99], s26 offen offset:3072 lds
ds_read_b64_tr_b16 v[56:57], v42 offset:49152
ds_read_b64_tr_b16 v[58:59], v42 offset:49408
ds_read_b64_tr_b16 v[60:61], v42 offset:51200
ds_read_b64_tr_b16 v[62:63], v42 offset:51456
ds_read_b64_tr_b16 v[208:209], v43 offset:49152
ds_read_b64_tr_b16 v[210:211], v43 offset:49408
ds_read_b64_tr_b16 v[212:213], v43 offset:51200
ds_read_b64_tr_b16 v[214:215], v43 offset:51456
s_waitcnt vmcnt(8) lgkmcnt(0)
s_barrier
s_add_u32 m0, s29, 49152
s_add_u32 s26, s86, 1024
buffer_load_dwordx4 v36, s[96:99], s26 offen offset:0 lds
buffer_load_dwordx4 v37, s[96:99], s26 offen offset:1024 lds
buffer_load_dwordx4 v38, s[96:99], s26 offen offset:2048 lds
buffer_load_dwordx4 v39, s[96:99], s26 offen offset:3072 lds
ds_read_b64_tr_b16 v[168:169], v42 offset:0
ds_read_b64_tr_b16 v[170:171], v42 offset:256
ds_read_b64_tr_b16 v[172:173], v42 offset:2048
ds_read_b64_tr_b16 v[174:175], v42 offset:2304
ds_read_b64_tr_b16 v[64:65], v43 offset:0
ds_read_b64_tr_b16 v[66:67], v43 offset:256
ds_read_b64_tr_b16 v[68:69], v43 offset:2048
ds_read_b64_tr_b16 v[70:71], v43 offset:2304
s_waitcnt vmcnt(8) lgkmcnt(0)
s_barrier
ds_read_b64_tr_b16 v[216:217], v42 offset:16384
ds_read_b64_tr_b16 v[218:219], v42 offset:16640
ds_read_b64_tr_b16 v[220:221], v42 offset:18432
ds_read_b64_tr_b16 v[222:223], v42 offset:18688
ds_read_b64_tr_b16 v[224:225], v43 offset:16384
ds_read_b64_tr_b16 v[226:227], v43 offset:16640
ds_read_b64_tr_b16 v[228:229], v43 offset:18432
ds_read_b64_tr_b16 v[230:231], v43 offset:18688
s_waitcnt vmcnt(4) lgkmcnt(0)
s_barrier
ds_read_b64_tr_b16 v[176:177], v42 offset:32768
ds_read_b64_tr_b16 v[178:179], v42 offset:33024
ds_read_b64_tr_b16 v[180:181], v42 offset:34816
ds_read_b64_tr_b16 v[182:183], v42 offset:35072
ds_read_b64_tr_b16 v[232:233], v43 offset:32768
ds_read_b64_tr_b16 v[234:235], v43 offset:33024
ds_read_b64_tr_b16 v[236:237], v43 offset:34816
ds_read_b64_tr_b16 v[238:239], v43 offset:35072
s_waitcnt vmcnt(0) lgkmcnt(0)
s_barrier
ds_read_b64_tr_b16 v[240:241], v42 offset:49152
ds_read_b64_tr_b16 v[242:243], v42 offset:49408
ds_read_b64_tr_b16 v[244:245], v42 offset:51200
ds_read_b64_tr_b16 v[246:247], v42 offset:51456
ds_read_b64_tr_b16 v[248:249], v43 offset:49152
ds_read_b64_tr_b16 v[250:251], v43 offset:49408
ds_read_b64_tr_b16 v[252:253], v43 offset:51200
ds_read_b64_tr_b16 v[254:255], v43 offset:51456
s_waitcnt lgkmcnt(0)
s_barrier
s_mul_i32 s26, s13, 12288
v_add_u32 v44, s26, v0
ds_write_b128 v44, v[8:11] offset:16384
ds_write_b128 v44, v[12:15] offset:17408
ds_write_b128 v44, v[16:19] offset:18432
ds_write_b128 v44, v[20:23] offset:19456
ds_write_b128 v44, v[24:27] offset:20480
ds_write_b128 v44, v[28:31] offset:21504
ds_write_b128 v44, v[48:51] offset:22528
ds_write_b128 v44, v[52:55] offset:23552
ds_write_b128 v44, v[56:59] offset:24576
ds_write_b128 v44, v[60:63] offset:25600
ds_write_b128 v44, v[64:67] offset:26624
ds_write_b128 v44, v[68:71] offset:27648
s_cmp_lg_u32 s13, 0
s_cbranch_scc1 cb_10067
v_mov_b32 v44, 4
s_mov_b64 exec, 1
s_mov_b32 s30, 0
cb_10066:
buffer_load_dword v45, v44, s[8:11], 0 offen sc1
s_add_u32 s30, s30, 1
s_cmp_gt_u32 s30, 262144
s_cbranch_scc1 L_fail
s_waitcnt vmcnt(0)
v_cmp_gt_u32 vcc, 32, v45
s_cbranch_vccnz cb_10066
s_mov_b64 exec, -1
cb_10067:
s_waitcnt vmcnt(0) lgkmcnt(0)
s_barrier
s_mov_b32 s18, 0
s_mov_b32 s36, 0
s_cmp_eq_u32 s13, 1
s_cbranch_scc1 wave_10069
s_cmp_eq_u32 s13, 2
s_cbranch_scc1 wave_10070
s_cmp_eq_u32 s13, 3
s_cbranch_scc1 wave_10071
wave_10068:
layer_10072:
s_lshl_b32 s17, s36, 6
s_mul_i32 s27, s36, 35651584
s_mul_i32 s28, s14, 16384
s_add_u32 s27, s27, s28
s_add_u32 s20, s27, 16777216
s_mul_i32 s27, s17, 10240
s_add_u32 s27, s27, s24
s_add_u32 s21, s27, s25
s_mov_b32 s19, 0
s_mov_b32 s33, s6
s_add_u32 s34, s17, 1
s_add_u32 s31, s17, 63
s_add_u32 s32, s17, 64
s_mov_b32 s27, s20
v_mov_b32 v7, 0
s_add_u32 s68, s4, 413696
s_addc_u32 s69, s5, 0
s_add_u32 s72, s4, 397312
s_addc_u32 s73, s5, 0
s_add_u32 s70, s4, 417792
s_addc_u32 s71, s5, 0
s_add_u32 s74, s4, 401408
s_addc_u32 s75, s5, 0
s_add_u32 s58, s4, s20
s_addc_u32 s59, s5, 0
global_load_dwordx4 v[64:67], v0, s[76:77] offset:-4096 sc1
global_load_dwordx4 v[68:71], v0, s[76:77] offset:-3072 sc1
global_load_dwordx4 v[72:75], v0, s[76:77] offset:-2048 sc1
global_load_dwordx4 v[76:79], v0, s[76:77] offset:-1024 sc1
global_load_dwordx4 v[80:83], v0, s[78:79] offset:-4096 sc1
global_load_dwordx4 v[84:87], v0, s[78:79] offset:-3072 sc1
global_load_dwordx4 v[48:51], v0, s[76:77] offset:2048 sc1
global_load_dwordx4 v[52:55], v0, s[76:77] offset:3072 sc1
global_load_dwordx4 v[56:59], v0, s[76:77] offset:0 sc1
global_load_dwordx4 v[60:63], v0, s[76:77] offset:1024 sc1
v_mov_b64 v[8:9], 0
v_mov_b64 v[10:11], 0
v_mov_b64 v[12:13], 0
v_mov_b64 v[14:15], 0
v_mov_b64 v[16:17], 0
v_mov_b64 v[18:19], 0
v_mov_b64 v[20:21], 0
v_mov_b64 v[22:23], 0
v_mov_b64 v[24:25], 0
v_mov_b64 v[26:27], 0
v_mov_b64 v[28:29], 0
v_mov_b64 v[30:31], 0
v_cmp_gt_u32 vcc, s34, v7
s_cmp_eq_u32 vcc_hi, 0
s_cbranch_scc1 kv_10083
s_mov_b32 s30, 0
kv_10082:
v_and_b32 v7, 128, v0
buffer_load_dword v7, v7, s[4:7], s22 offen sc1
s_add_u32 s30, s30, 1
s_cmp_gt_u32 s30, 262144
s_cbranch_scc1 L_fail
s_waitcnt vmcnt(0)
v_cmp_gt_u32 vcc, s34, v7
s_cbranch_vccnz kv_10082
kv_10083:
s_barrier
v_and_b32 v7, 511, v0
v_lshl_add_u32 v7, v7, 3, s27
global_load_dwordx4 v[32:35], v0, s[68:69] offset:-4096 sc1
global_load_dwordx4 v[36:39], v0, s[68:69] offset:0 sc1
global_load_dwordx4 v[40:43], v0, s[70:71] offset:0 sc1
s_mov_b32 s30, 0
s_waitcnt vmcnt(0)
.p2align 6
gather_10073:
s_waitcnt vmcnt(4)
rt_10078_b:
v_smfmac_f32_16x16x64_bf16 v[12:15], v[32:35], v[72:79], v1
ds_write_b128 v0, v[32:35] offset:0
v_smfmac_f32_16x16x64_bf16 v[8:11], v[32:35], v[64:71], v1
v_bitop3_b32 v44, v32, v34, s18 bitop3:0x7e
v_smfmac_f32_16x16x64_bf16 v[20:23], v[32:35], v[48:55], v1
s_waitcnt vmcnt(3)
ds_write_b128 v0, v[36:39] offset:4096
v_bitop3_b32 v45, v36, v38, s18 bitop3:0x7e
v_or_b32 v44, v44, v45
s_waitcnt vmcnt(2)
v_bitop3_b32 v45, v40, v42, s18 bitop3:0x7e
v_smfmac_f32_16x16x64_bf16 v[16:19], v[32:35], v[56:63], v1
ds_write_b128 v0, v[40:43] offset:8192
v_bitop3_b32 v44, v44, v45, s19 bitop3:0xa8
v_cmp_ne_u32 vcc, 0, v44
v_smfmac_f32_16x16x64_bf16 v[28:31], v[32:35], a[8:15], v1
s_cbranch_vccnz rt_10078
ds_read_b128 v[52:55], v2 offset:3072
v_smfmac_f32_16x16x64_bf16 v[8:11], v[36:39], a[16:23], v1
s_waitcnt lgkmcnt(2)
ds_read_b128 v[60:63], v2 offset:1024
global_load_dwordx4 v[64:67], v0, s[78:79] offset:-2048 sc1
ds_read_b128 v[56:59], v2 offset:0
v_smfmac_f32_16x16x64_bf16 v[24:27], v[32:35], a[0:7], v1
s_waitcnt lgkmcnt(3)
ds_read_b128 v[48:51], v2 offset:2048
s_barrier
ds_read_b128 v[40:43], v0 offset:1024
v_smfmac_f32_16x16x64_bf16 v[20:23], v[36:39], a[40:47], v1
s_mov_b64 s[68:69], s[72:73]
ds_read_b128 v[44:47], v0 offset:5120
global_load_dwordx4 v[68:71], v0, s[78:79] offset:-1024 sc1
v_smfmac_f32_16x16x64_bf16 v[16:19], v[36:39], a[32:39], v1
s_xor_b32 s18, s18, 1
ds_read_b128 v[32:35], v0 offset:2048
s_waitcnt lgkmcnt(4)
v_smfmac_f32_16x16x64_bf16 v[24:27], v[36:39], v[56:63], v1
ds_read_b128 v[56:59], v2 offset:4096
v_smfmac_f32_16x16x64_bf16 v[12:15], v[36:39], a[24:31], v1
ds_read_b128 v[60:63], v2 offset:5120
s_waitcnt lgkmcnt(4)
s_waitcnt vmcnt(2)
v_smfmac_f32_16x16x64_bf16 v[12:15], v[40:43], v[80:87], v1
ds_read_b128 v[84:87], v2 offset:7168
s_waitcnt lgkmcnt(4)
v_smfmac_f32_16x16x64_bf16 v[28:31], v[36:39], v[48:55], v1
ds_read_b128 v[80:83], v2 offset:6144
global_load_dwordx4 v[72:75], v0, s[78:79] offset:0 sc1
v_smfmac_f32_16x16x64_bf16 v[8:11], v[40:43], a[48:55], v1
ds_read_b128 v[36:39], v0 offset:6144
global_load_dwordx4 v[76:79], v0, s[78:79] offset:1024 sc1
v_smfmac_f32_16x16x64_bf16 v[12:15], v[44:47], a[64:71], v1
ds_read_b128 v[40:43], v0 offset:3072
s_waitcnt lgkmcnt(5)
v_smfmac_f32_16x16x64_bf16 v[8:11], v[44:47], a[56:63], v1
ds_read_b128 v[44:47], v0 offset:7168
s_waitcnt lgkmcnt(5)
v_smfmac_f32_16x16x64_bf16 v[8:11], v[32:35], v[56:63], v1
s_waitcnt lgkmcnt(3)
ds_read_b128 v[60:63], v2 offset:9216
v_smfmac_f32_16x16x64_bf16 v[12:15], v[32:35], a[72:79], v1
s_waitcnt lgkmcnt(3)
ds_read_b128 v[56:59], v2 offset:8192
v_smfmac_f32_16x16x64_bf16 v[12:15], v[36:39], v[80:87], v1
ds_read_b128 v[32:35], v0 offset:8192
v_smfmac_f32_16x16x64_bf16 v[8:11], v[36:39], a[80:87], v1
s_waitcnt lgkmcnt(4)
ds_read_b128 v[80:83], v2 offset:10240
global_load_dwordx4 v[48:51], v0, s[58:59] offset:0 nt sc1
ds_read_b128 v[84:87], v2 offset:11264
v_smfmac_f32_16x16x64_bf16 v[8:11], v[40:43], a[88:95], v1
s_add_u32 s20, s20, 524288
s_waitcnt lgkmcnt(5)
ds_read_b128 v[36:39], v0 offset:9216
v_smfmac_f32_16x16x64_bf16 v[12:15], v[40:43], a[96:103], v1
s_waitcnt lgkmcnt(4)
ds_read_b128 v[40:43], v0 offset:1024
v_smfmac_f32_16x16x64_bf16 v[8:11], v[44:47], v[56:63], v1
global_load_dwordx4 v[52:55], v0, s[58:59] offset:1024 nt sc1
ds_read_b128 v[60:63], v2 offset:13312
v_smfmac_f32_16x16x64_bf16 v[12:15], v[44:47], a[104:111], v1
s_waitcnt lgkmcnt(4)
ds_read_b128 v[56:59], v2 offset:12288
s_waitcnt lgkmcnt(4)
v_smfmac_f32_16x16x64_bf16 v[12:15], v[32:35], v[80:87], v1
s_waitcnt vmcnt(4)
ds_read_b128 v[80:83], v2 offset:14336
s_mov_b64 vcc, s[42:43]
v_smfmac_f32_16x16x64_bf16 v[8:11], v[32:35], a[112:119], v1
s_waitcnt lgkmcnt(4)
ds_read_b128 v[84:87], v2 offset:15360
v_smfmac_f32_16x16x64_bf16 v[8:11], v[36:39], v[64:71], v1
s_nop 0
ds_read_b128 v[32:35], v0 offset:5120
global_load_dwordx4 v[64:67], v0, s[78:79] offset:2048 sc1
v_smfmac_f32_16x16x64_bf16 v[12:15], v[36:39], a[120:127], v1
s_nop 0
ds_read_b128 v[36:39], v0 offset:2048
s_waitcnt lgkmcnt(4)
s_nop 0
v_add_f32 v8, v8, v10
v_smfmac_f32_16x16x64_bf16 v[16:19], v[40:43], v[56:63], v1
ds_read_b128 v[60:63], v2 offset:17408
global_load_dwordx4 v[68:71], v0, s[78:79] offset:3072 sc1
ds_read_b128 v[56:59], v2 offset:16384
v_mul_f32 v8, s35, v8
v_smfmac_f32_16x16x64_bf16 v[20:23], v[40:43], a[128:135], v1
s_waitcnt lgkmcnt(3)
ds_read_b128 v[40:43], v0 offset:6144
v_add_f32 v12, v12, v14
v_smfmac_f32_16x16x64_bf16 v[20:23], v[32:35], v[80:87], v1
s_waitcnt lgkmcnt(3)
ds_read_b128 v[80:83], v2 offset:18432
v_add_f32 v13, v13, v15
v_smfmac_f32_16x16x64_bf16 v[16:19], v[32:35], a[136:143], v1
ds_read_b128 v[32:35], v0 offset:3072
v_add_f32 v9, v9, v11
v_smfmac_f32_16x16x64_bf16 v[20:23], v[36:39], a[152:159], v1
s_waitcnt vmcnt(4)
ds_read_b128 v[84:87], v2 offset:19456
v_mul_f32 v13, s35, v13
v_mul_f32 v12, s35, v12
v_mul_f32 v9, s35, v9
v_cvt_pk_bf16_f32 v8, v8, v9
v_cvt_pk_bf16_f32 v12, v12, v13
v_smfmac_f32_16x16x64_bf16 v[16:19], v[36:39], a[144:151], v1
s_waitcnt lgkmcnt(3)
ds_read_b128 v[36:39], v0 offset:7168
ds_write2_b32 v3, v8, v12 offset0:0 offset1:128
v_smfmac_f32_16x16x64_bf16 v[16:19], v[40:43], v[72:79], v1
global_load_dwordx4 v[72:75], v0, s[80:81] offset:-4096 sc1
v_smfmac_f32_16x16x64_bf16 v[20:23], v[40:43], v[56:63], v1
s_waitcnt lgkmcnt(3)
global_load_dwordx4 v[76:79], v0, s[80:81] offset:-3072 sc1
v_smfmac_f32_16x16x64_bf16 v[20:23], v[32:35], a[168:175], v1
ds_read_b128 v[40:43], v0 offset:8192
global_load_dwordx4 v[56:59], v0, s[58:59] offset:2048 nt sc1
global_load_dwordx4 v[60:63], v0, s[58:59] offset:3072 nt sc1
v_smfmac_f32_16x16x64_bf16 v[16:19], v[32:35], a[160:167], v1
s_waitcnt lgkmcnt(1)
ds_read_b128 v[32:35], v0 offset:9216
v_smfmac_f32_16x16x64_bf16 v[16:19], v[36:39], a[176:183], v1
s_barrier
ds_read_b64_tr_b16 v[10:11], v4 offset:512
v_smfmac_f32_16x16x64_bf16 v[20:23], v[36:39], v[80:87], v1
s_waitcnt lgkmcnt(2)
ds_read_b128 v[36:39], v0 offset:8192
ds_read_b64_tr_b16 v[14:15], v4 offset:1536
v_smfmac_f32_16x16x64_bf16 v[20:23], v[40:43], a[192:199], v1
ds_read_b64_tr_b16 v[12:13], v4 offset:1024
s_waitcnt lgkmcnt(4)
ds_read_b64_tr_b16 v[8:9], v4 offset:0
v_smfmac_f32_16x16x64_bf16 v[16:19], v[40:43], a[184:191], v1
s_waitcnt vmcnt(5)
ds_read_b128 v[40:43], v0 offset:9216
v_smfmac_f32_16x16x64_bf16 v[16:19], v[32:35], a[200:207], v1
v_smfmac_f32_16x16x64_bf16 v[20:23], v[32:35], a[208:215], v1
s_waitcnt lgkmcnt(3)
ds_read_b128 v[80:83], v2 offset:20480
global_load_dword v7, v7, s[4:5] sc1
ds_read_b128 v[84:87], v2 offset:21504
v_smfmac_f32_16x16x64_bf16 v[24:27], v[36:39], a[216:223], v1
s_waitcnt lgkmcnt(3)
ds_read_b128 v[32:35], v0 offset:1024
v_add_f32 v16, v16, v18
v_mfma_f32_16x16x32_bf16 v[44:47], v[48:51], v[8:11], 0
v_bfe_u32 v48, v0, 5, 1
v_add_f32 v17, v17, v19
v_mfma_f32_16x16x32_bf16 v[44:47], v[52:55], v[12:15], v[44:47]
s_nop 0
v_lshl_add_u32 v48, v48, 3, v5
v_add_f32 v20, v20, v22
v_smfmac_f32_16x16x64_bf16 v[28:31], v[36:39], a[224:231], v1
s_waitcnt lgkmcnt(3)
ds_read_b128 v[36:39], v0 offset:5120
v_cvt_pk_bf16_f32 v16, v16, v17
v_add_f32 v21, v21, v23
v_cndmask_b32_dpp v44, v46, v44, vcc quad_perm:[0,1,0,1] row_mask:0xf bank_mask:0xf
v_cvt_pk_bf16_f32 v20, v20, v21
v_smfmac_f32_16x16x64_bf16 v[24:27], v[40:43], a[232:239], v1
s_waitcnt lgkmcnt(1)
ds_write2_b32 v3, v16, v20 offset0:1 offset1:129
v_cndmask_b32_dpp v45, v47, v45, vcc quad_perm:[0,1,0,1] row_mask:0xf bank_mask:0xf
v_smfmac_f32_16x16x64_bf16 v[28:31], v[40:43], v[80:87], v1
s_add_u32 s17, s17, 1
ds_write_b64 v48, v[44:45] offset:6144
v_smfmac_f32_16x16x64_bf16 v[24:27], v[32:35], a[240:247], v1
s_add_u32 s21, s21, 10240
ds_read_b128 v[40:43], v0 offset:2048
v_smfmac_f32_16x16x64_bf16 v[28:31], v[32:35], a[248:255], v1
s_waitcnt vmcnt(5)
ds_read_b128 v[32:35], v0 offset:6144
s_waitcnt lgkmcnt(4)
v_smfmac_f32_16x16x64_bf16 v[24:27], v[36:39], v[64:71], v1
ds_read_b128 v[80:83], v2 offset:22528
global_load_dwordx4 v[64:67], v0, s[76:77] offset:-4096 sc1
v_smfmac_f32_16x16x64_bf16 v[28:31], v[36:39], v[88:95], v1
s_waitcnt lgkmcnt(3)
ds_read_b128 v[36:39], v0 offset:3072
s_barrier
ds_read_b128 v[52:55], v6 offset:7168
s_waitcnt lgkmcnt(4)
v_smfmac_f32_16x16x64_bf16 v[28:31], v[40:43], v[104:111], v1
s_waitcnt lgkmcnt(3)
ds_read_b128 v[48:51], v6 offset:6144
v_smfmac_f32_16x16x64_bf16 v[24:27], v[40:43], v[96:103], v1
ds_read_b128 v[40:43], v0 offset:7168
ds_read_b64_tr_b16 v[16:17], v4 offset:2048
v_smfmac_f32_16x16x64_bf16 v[24:27], v[32:35], v[112:119], v1
ds_read_b64_tr_b16 v[18:19], v4 offset:2560
s_waitcnt lgkmcnt(5)
ds_read_b64_tr_b16 v[14:15], v4 offset:1536
v_smfmac_f32_16x16x64_bf16 v[28:31], v[32:35], v[120:127], v1
s_waitcnt vmcnt(2)
ds_read_b64_tr_b16 v[8:9], v4 offset:0
ds_read_b64_tr_b16 v[12:13], v4 offset:1024
v_smfmac_f32_16x16x64_bf16 v[28:31], v[36:39], v[136:143], v1
s_waitcnt lgkmcnt(6)
ds_read_b64_tr_b16 v[10:11], v4 offset:512
v_add_f32 v49, v49, v53
v_smfmac_f32_16x16x64_bf16 v[24:27], v[36:39], v[128:135], v1
s_waitcnt lgkmcnt(6)
ds_read_b64_tr_b16 v[20:21], v4 offset:3072
v_add_f32 v50, v50, v54
v_smfmac_f32_16x16x64_bf16 v[28:31], v[40:43], v[144:151], v1
ds_read_b64_tr_b16 v[22:23], v4 offset:3584
v_add_f32 v51, v51, v55
v_exp_f32 v51, v51
v_exp_f32 v49, v49
v_smfmac_f32_16x16x64_bf16 v[24:27], v[40:43], v[72:79], v1
s_waitcnt lgkmcnt(2)
ds_read_b128 v[84:87], v2 offset:23552
v_add_f32 v48, v48, v52
v_exp_f32 v48, v48
v_exp_f32 v50, v50
v_mfma_f32_16x16x32_bf16 v[44:47], v[8:11], v[8:11], 0
s_waitcnt lgkmcnt(1)
v_cvt_pk_bf16_f32 v55, v50, v51
v_cvt_pk_bf16_f32 v54, v48, v49
v_mfma_f32_16x16x32_bf16 v[44:47], v[12:15], v[12:15], v[44:47]
v_mov_b32_dpp v51, v55 quad_perm:[2,3,2,3] row_mask:0xf bank_mask:0xf
v_mov_b32_dpp v50, v54 quad_perm:[2,3,2,3] row_mask:0xf bank_mask:0xf
v_mfma_f32_16x16x32_bf16 v[44:47], v[16:19], v[16:19], v[44:47]
v_mov_b32_dpp v49, v55 quad_perm:[0,1,0,1] row_mask:0xf bank_mask:0xf
v_mov_b32_dpp v48, v54 quad_perm:[0,1,0,1] row_mask:0xf bank_mask:0xf
v_mfma_f32_16x16x32_bf16 v[44:47], v[20:23], v[20:23], v[44:47]
s_mov_b64 s[70:71], s[74:75]
v_mov_b64 v[20:21], s[44:45]
v_cvt_pk_bf16_f32 v24, v24, v25
v_mfma_f32_16x16x32_bf16 v[8:11], v[56:59], v[48:51], 0
s_add_u32 s34, s17, 2
v_mov_b64 v[22:23], s[44:45]
v_cvt_pk_bf16_f32 v25, v26, v27
v_mfma_f32_16x16x32_bf16 v[12:15], v[60:63], v[48:51], 0
v_exp_f32_dpp v44, v46 quad_perm:[0,1,0,1] row_mask:0xf bank_mask:0xf
v_exp_f32_dpp v45, v47 quad_perm:[0,1,0,1] row_mask:0xf bank_mask:0xf
v_mfma_f32_16x16x32_bf16 v[16:19], v[20:23], v[48:51], 0
s_waitcnt lgkmcnt(0)
v_cvt_pk_bf16_f32 v52, v44, v45
v_cvt_pk_bf16_f32 v53, v44, v45
v_mov_b64 v[54:55], s[46:47]
v_cvt_pk_bf16_f32 v27, v30, v31
v_mfma_f32_16x16x16_bf16 v[8:11], v[24:25], v[52:53], v[8:11]
s_mov_b32 s19, 1
global_load_dwordx4 v[68:71], v0, s[76:77] offset:-3072 sc1
v_cvt_pk_bf16_f32 v26, v28, v29
v_mfma_f32_16x16x16_bf16 v[16:19], v[54:55], v[52:53], v[16:19]
s_min_u32 s34, s34, s32
v_mov_b64 v[38:39], 0
v_mov_b64 v[36:37], 0
v_mfma_f32_16x16x16_bf16 v[12:15], v[26:27], v[52:53], v[12:15]
s_nop 0
ds_read_b128 v[28:31], v0 offset:19456
v_bfe_u32 v32, v0, 5, 1
v_mov_b64 v[34:35], 0
v_rcp_f32 v18, v16
v_subrev_u32 v17, s37, v16
v_cmp_lt_u32 vcc, s38, v17
v_lshl_add_u32 v32, v32, 3, v5
v_cndmask_b32 v9, v13, v9, s[42:43]
v_cndmask_b32 v8, v12, v8, s[42:43]
v_cndmask_b32 v10, v14, v10, s[42:43]
v_mul_f32 v10, v10, v18
v_mul_f32 v9, v9, v18
v_mul_f32 v8, v8, v18
v_cndmask_b32 v11, v15, v11, s[42:43]
v_mul_f32 v11, v11, v18
v_cvt_pk_bf16_f32 v13, v10, v11
v_cvt_pk_bf16_f32 v12, v8, v9
s_cbranch_vccnz rare_10074
back_10075:
ds_read_b128 v[16:19], v0 offset:16384
ds_write_b64 v32, v[12:13] offset:0
v_mov_b64 v[42:43], 0
v_mov_b64 v[32:33], 0
v_mov_b32_dpp v10, v12 quad_perm:[2,3,2,3] row_mask:0xf bank_mask:0xf
v_mov_b64 v[54:55], 0
v_mov_b32_dpp v8, v12 quad_perm:[0,1,0,1] row_mask:0xf bank_mask:0xf
v_mov_b32_dpp v11, v13 quad_perm:[2,3,2,3] row_mask:0xf bank_mask:0xf
v_mov_b32_dpp v9, v13 quad_perm:[0,1,0,1] row_mask:0xf bank_mask:0xf
v_mov_b64 v[52:53], 0
v_mov_b64 v[40:41], 0
v_smfmac_f32_16x16x64_bf16 v[36:39], v[8:11], v[80:87], v1
ds_read_b128 v[24:27], v0 offset:18432
global_load_dwordx4 v[72:75], v0, s[76:77] offset:-2048 sc1
ds_read_b128 v[20:23], v0 offset:17408
v_smfmac_f32_16x16x64_bf16 v[40:43], v[8:11], v[152:159], v1
s_waitcnt lgkmcnt(2)
ds_read_b128 v[80:83], v0 offset:20480
s_barrier
ds_read_b128 v[56:59], v5 offset:512
v_smfmac_f32_16x16x64_bf16 v[32:35], v[8:11], v[176:183], v1
s_add_u32 s27, s20, 524288
ds_read_b128 v[60:63], v5 offset:1024
v_mov_b64 v[48:49], 0
v_mov_b64 v[50:51], 0
v_smfmac_f32_16x16x64_bf16 v[52:55], v[8:11], v[168:175], v1
s_add_u32 s58, s4, s20
ds_read_b128 v[12:15], v5 offset:1536
v_lshrrev_b32 v44, 8, v0
v_smfmac_f32_16x16x64_bf16 v[48:51], v[8:11], v[160:167], v1
s_waitcnt lgkmcnt(4)
ds_read_b128 v[84:87], v0 offset:21504
global_load_dwordx4 v[76:79], v0, s[76:77] offset:-1024 sc1
v_bfe_u32 v45, v0, 1, 7
s_waitcnt lgkmcnt(3)
v_smfmac_f32_16x16x64_bf16 v[36:39], v[56:59], v[16:23], v1
s_addc_u32 s59, s5, 0
ds_read_b128 v[16:19], v0 offset:22528
s_waitcnt lgkmcnt(3)
v_smfmac_f32_16x16x64_bf16 v[36:39], v[60:63], v[24:31], v1
ds_read_b128 v[28:31], v0 offset:25600
s_waitcnt lgkmcnt(3)
v_smfmac_f32_16x16x64_bf16 v[36:39], v[12:15], v[184:191], v1
ds_read_b128 v[20:23], v0 offset:23552
s_waitcnt lgkmcnt(3)
v_smfmac_f32_16x16x64_bf16 v[40:43], v[56:59], v[80:87], v1
ds_read_b128 v[24:27], v0 offset:24576
v_lshl_or_b32 v44, v44, 12, v45
v_smfmac_f32_16x16x64_bf16 v[40:43], v[60:63], v[192:199], v1
s_nop 0
ds_read_b128 v[84:87], v0 offset:27648
v_cvt_pk_bf16_f32 v36, v36, v37
v_and_or_b32 v36, v36, -2, s18
v_cvt_pk_bf16_f32 v37, v38, v39
v_smfmac_f32_16x16x64_bf16 v[40:43], v[12:15], v[200:207], v1
global_store_dwordx2 v44, v[36:37], s[48:49]
s_waitcnt lgkmcnt(2)
v_smfmac_f32_16x16x64_bf16 v[48:51], v[56:59], v[16:23], v1
ds_read_b128 v[80:83], v0 offset:26624
s_waitcnt lgkmcnt(2)
v_smfmac_f32_16x16x64_bf16 v[48:51], v[60:63], v[24:31], v1
s_mov_b32 s30, 0
s_nop 0
v_cvt_pk_bf16_f32 v40, v40, v41
v_cvt_pk_bf16_f32 v41, v42, v43
v_and_or_b32 v40, v40, -2, s18
v_smfmac_f32_16x16x64_bf16 v[48:51], v[12:15], v[208:215], v1
global_store_dwordx2 v44, v[40:41], s[50:51]
s_waitcnt lgkmcnt(1)
v_smfmac_f32_16x16x64_bf16 v[32:35], v[56:59], v[232:239], v1
s_nop 0
s_waitcnt lgkmcnt(0)
v_smfmac_f32_16x16x64_bf16 v[52:55], v[56:59], v[80:87], v1
s_nop 1
v_cvt_pk_bf16_f32 v48, v48, v49
v_smfmac_f32_16x16x64_bf16 v[52:55], v[60:63], v[216:223], v1
v_and_or_b32 v48, v48, -2, s18
v_cvt_pk_bf16_f32 v49, v50, v51
v_smfmac_f32_16x16x64_bf16 v[52:55], v[12:15], v[224:231], v1
global_store_dwordx2 v44, v[48:49], s[52:53]
v_smfmac_f32_16x16x64_bf16 v[32:35], v[60:63], v[240:247], v1
s_nop 2
v_smfmac_f32_16x16x64_bf16 v[32:35], v[12:15], v[248:255], v1
s_nop 1
v_cvt_pk_bf16_f32 v52, v52, v53
v_and_or_b32 v52, v52, -2, s18
v_cvt_pk_bf16_f32 v53, v54, v55
s_nop 0
global_store_dwordx2 v44, v[52:53], s[54:55]
s_nop 0
v_cvt_pk_bf16_f32 v32, v32, v33
v_cvt_pk_bf16_f32 v33, v34, v35
v_and_or_b32 v32, v32, -2, s18
global_store_dwordx2 v44, v[32:33], s[56:57]
v_bfe_u32 v32, v0, 6, 1
v_lshlrev_b32 v32, 4, v32
v_mov_b32 v33, 0x3f80
v_lshlrev_b32 v32, v32, v33
v_bfe_i32 v33, v0, 4, 1
v_and_b32 v45, v32, v33
v_and_b32 v47, v32, v33
v_xor_b32 v44, v32, v45
v_xor_b32 v46, v32, v45
v_and_b32 v36, 32, v0
v_bfe_u32 v37, v0, 6, 1
v_lshl_add_u32 v36, v37, 8, v36
v_bfe_u32 v37, v0, 8, 1
v_lshl_add_u32 v36, v37, 4, v36
v_bfe_u32 v37, v0, 4, 1
v_lshl_add_u32 v36, v37, 3, v36
s_waitcnt vmcnt(9)
v_and_b32 v7, 511, v0
v_lshl_add_u32 v7, v7, 3, s27
s_nop 15
s_nop 15
s_nop 15
s_nop 8
global_load_dwordx4 v[8:11], v0, s[64:65] offset:0 sc1
global_load_dwordx4 v[12:15], v0, s[64:65] offset:1024 sc1
global_load_dwordx4 v[16:19], v0, s[64:65] offset:2048 sc1
global_load_dwordx4 v[20:23], v0, s[64:65] offset:3072 sc1
chk_10086:
v_mov_b64 v[40:41], 0
v_mov_b64 v[42:43], 0
s_waitcnt vmcnt(2)
s_nop 0
v_smfmac_f32_16x16x64_bf16 v[40:43], v[44:47], v[8:15], v1
v_bitop3_b32 v32, v8, v10, s18 bitop3:0x7e
v_bitop3_b32 v33, v12, v14, s18 bitop3:0x7e
s_waitcnt vmcnt(0)
v_smfmac_f32_16x16x64_bf16 v[40:43], v[44:47], v[16:23], v1
v_bitop3_b32 v34, v16, v18, s18 bitop3:0x7e
v_bitop3_b32 v35, v20, v22, s18 bitop3:0x7e
v_or3_b32 v32, v32, v33, v34
v_bitop3_b32 v32, v32, v35, 1 bitop3:0xa8
v_cmp_ne_u32 vcc, 0, v32
s_cbranch_vccnz chk_10086_f
s_nop 1
v_add_f32_dpp v40, v40, v40 row_ror:8 row_mask:0xf bank_mask:0xf
v_add_f32_dpp v41, v41, v41 row_ror:8 row_mask:0xf bank_mask:0xf
v_add_f32_dpp v42, v42, v42 row_ror:8 row_mask:0xf bank_mask:0xf
v_add_f32_dpp v43, v43, v43 row_ror:8 row_mask:0xf bank_mask:0xf
v_cvt_pk_bf16_f32 v40, v40, v41
v_cvt_pk_bf16_f32 v41, v42, v43
v_and_or_b32 v40, v40, -2, s18
s_mov_b64 exec, 0x00ff00ff
global_store_dwordx2 v36, v[40:41], s[66:67]
s_mov_b64 exec, -1
s_branch join_10085
chk_10086_f:
global_load_dwordx4 v[8:11], v0, s[64:65] offset:0 sc1
global_load_dwordx4 v[12:15], v0, s[64:65] offset:1024 sc1
global_load_dwordx4 v[16:19], v0, s[64:65] offset:2048 sc1
global_load_dwordx4 v[20:23], v0, s[64:65] offset:3072 sc1
s_add_u32 s30, s30, 1
s_cmp_le_u32 s30, 262144
s_cbranch_scc1 chk_10086
s_branch L_fail
nored_10084:
join_10085:
s_nop 11
s_barrier
global_load_dwordx4 v[56:59], v0, s[76:77] offset:0 sc1
global_load_dwordx4 v[60:63], v0, s[76:77] offset:1024 sc1
global_load_dwordx4 v[48:51], v0, s[76:77] offset:2048 sc1
global_load_dwordx4 v[52:55], v0, s[76:77] offset:3072 sc1
s_nop 15
s_nop 15
s_nop 3
s_barrier
global_load_dwordx4 v[32:35], v0, s[68:69] offset:-4096 sc1
s_nop 10
global_load_dwordx4 v[36:39], v0, s[68:69] offset:0 sc1
s_nop 10
global_load_dwordx4 v[40:43], v0, s[70:71] offset:0 sc1
s_barrier
global_load_dwordx4 v[80:83], v0, s[78:79] offset:-4096 sc1
global_load_dwordx4 v[84:87], v0, s[78:79] offset:-3072 sc1
v_mov_b64 v[8:9], 0
v_mov_b64 v[10:11], 0
v_mov_b64 v[12:13], 0
v_mov_b64 v[14:15], 0
v_mov_b64 v[16:17], 0
v_mov_b64 v[18:19], 0
v_mov_b64 v[20:21], 0
v_mov_b64 v[22:23], 0
v_mov_b64 v[24:25], 0
v_mov_b64 v[26:27], 0
v_mov_b64 v[28:29], 0
v_mov_b64 v[30:31], 0
s_mov_b32 s30, 0
s_cmp_eq_u32 s17, s31
s_cbranch_scc0 gather_10073
s_branch exit_10076
rt_10078:
global_load_dwordx4 v[32:35], v0, s[68:69] offset:-4096 sc1
global_load_dwordx4 v[36:39], v0, s[68:69] offset:0 sc1
global_load_dwordx4 v[40:43], v0, s[70:71] offset:0 sc1
s_add_u32 s30, s30, 1
s_cmp_gt_u32 s30, 262144
s_cbranch_scc1 L_fail
s_mov_b64 exec, 1
global_store_dword v0, v0, s[62:63]
global_store_dword v0, v0, s[62:63]
s_mov_b64 exec, -1
v_mov_b64 v[8:9], 0
v_mov_b64 v[10:11], 0
v_mov_b64 v[12:13], 0
v_mov_b64 v[14:15], 0
v_mov_b64 v[16:17], 0
v_mov_b64 v[18:19], 0
v_mov_b64 v[20:21], 0
v_mov_b64 v[22:23], 0
v_mov_b64 v[24:25], 0
v_mov_b64 v[26:27], 0
v_mov_b64 v[28:29], 0
v_mov_b64 v[30:31], 0
s_branch gather_10073
rare_10074:
ds_read_b128 v[48:51], v6 offset:6144
ds_read_b128 v[52:55], v6 offset:7168
s_waitcnt lgkmcnt(0)
v_add_f32 v48, v48, v52
v_add_f32 v49, v49, v53
v_add_f32 v50, v50, v54
v_add_f32 v51, v51, v55
v_mov_b32_dpp v46, v46 quad_perm:[0,1,0,1] row_mask:0xf bank_mask:0xf
v_mov_b32_dpp v47, v47 quad_perm:[0,1,0,1] row_mask:0xf bank_mask:0xf
v_max3_f32 v19, v48, v49, v50
v_max3_f32 v19, v19, v51, v46
v_max_f32 v19, v19, v47
s_nop 1
v_max_f32_dpp v19, v19, v19 quad_perm:[2,3,0,1] row_mask:0xf bank_mask:0xf
v_mov_b32 v44, v19
s_nop 1
v_permlane32_swap_b32 v19, v44
v_max_f32 v19, v19, v44
v_mov_b32 v44, v19
s_nop 1
v_permlane16_swap_b32 v19, v44
v_max_f32 v19, v19, v44
v_sub_f32 v48, v48, v19
v_sub_f32 v49, v49, v19
v_sub_f32 v50, v50, v19
v_sub_f32 v51, v51, v19
v_sub_f32 v46, v46, v19
v_sub_f32 v47, v47, v19
v_exp_f32 v48, v48
v_exp_f32 v49, v49
v_exp_f32 v50, v50
v_exp_f32 v51, v51
v_cvt_pk_bf16_f32 v54, v48, v49
v_cvt_pk_bf16_f32 v55, v50, v51
s_nop 0
v_mov_b32_dpp v48, v54 quad_perm:[0,1,0,1] row_mask:0xf bank_mask:0xf
v_mov_b32_dpp v49, v55 quad_perm:[0,1,0,1] row_mask:0xf bank_mask:0xf
v_mov_b32_dpp v50, v54 quad_perm:[2,3,2,3] row_mask:0xf bank_mask:0xf
v_mov_b32_dpp v51, v55 quad_perm:[2,3,2,3] row_mask:0xf bank_mask:0xf
v_mov_b64 v[20:21], s[44:45]
v_mov_b64 v[22:23], s[44:45]
v_mfma_f32_16x16x32_bf16 v[8:11], v[56:59], v[48:51], 0
v_mfma_f32_16x16x32_bf16 v[12:15], v[60:63], v[48:51], 0
v_mfma_f32_16x16x32_bf16 v[16:19], v[20:23], v[48:51], 0
v_mov_b64 v[54:55], s[46:47]
v_exp_f32_dpp v44, v46 quad_perm:[0,1,0,1] row_mask:0xf bank_mask:0xf
v_exp_f32_dpp v45, v47 quad_perm:[0,1,0,1] row_mask:0xf bank_mask:0xf
s_nop 0
v_cvt_pk_bf16_f32 v52, v44, v45
v_cvt_pk_bf16_f32 v53, v44, v45
s_nop 1
v_mfma_f32_16x16x16_bf16 v[16:19], v[54:55], v[52:53], v[16:19]
v_mfma_f32_16x16x16_bf16 v[8:11], v[24:25], v[52:53], v[8:11]
v_mfma_f32_16x16x16_bf16 v[12:15], v[26:27], v[52:53], v[12:15]
s_nop 5
v_rcp_f32 v18, v16
s_nop 0
v_cndmask_b32 v8, v12, v8, s[42:43]
v_mul_f32 v8, v8, v18
v_cndmask_b32 v9, v13, v9, s[42:43]
v_mul_f32 v9, v9, v18
v_cndmask_b32 v10, v14, v10, s[42:43]
v_mul_f32 v10, v10, v18
v_cndmask_b32 v11, v15, v11, s[42:43]
v_mul_f32 v11, v11, v18
v_cvt_pk_bf16_f32 v12, v8, v9
v_cvt_pk_bf16_f32 v13, v10, v11
s_branch back_10075
exit_10076:
global_load_dwordx4 v[32:35], v0, s[68:69] offset:-4096 sc1
global_load_dwordx4 v[36:39], v0, s[68:69] offset:0 sc1
global_load_dwordx4 v[40:43], v0, s[70:71] offset:0 sc1
s_add_u32 s30, s30, 1
s_cmp_gt_u32 s30, 262144
s_cbranch_scc1 L_fail
s_waitcnt vmcnt(2)
v_bitop3_b32 v44, v32, v34, s18 bitop3:0x7e
s_waitcnt vmcnt(1)
v_bitop3_b32 v45, v36, v38, s18 bitop3:0x7e
v_or_b32 v44, v44, v45
s_waitcnt vmcnt(0)
v_bitop3_b32 v46, v40, v42, s18 bitop3:0x7e
v_bitop3_b32 v44, v44, v46, s19 bitop3:0xa8
v_cmp_ne_u32 vcc, 0, v44
s_cbranch_vccnz exit_10076
ds_write_b128 v0, v[32:35] offset:0
ds_write_b128 v0, v[36:39] offset:4096
ds_write_b128 v0, v[40:43] offset:8192
s_waitcnt lgkmcnt(0)
s_barrier
s_barrier
s_add_u32 s36, s36, 1
s_cmp_lt_u32 s36, 2
s_cbranch_scc1 layer_10072
s_endpgm
wave_10069:
layer_10087:
s_lshl_b32 s17, s36, 6
s_mul_i32 s27, s36, 35651584
s_mul_i32 s28, s14, 16384
s_add_u32 s27, s27, s28
s_add_u32 s20, s27, 16781312
s_mul_i32 s27, s17, 10240
s_add_u32 s27, s27, s24
s_add_u32 s21, s27, s25
s_mov_b32 s19, 0
s_mov_b32 s33, s6
s_add_u32 s34, s17, 1
s_add_u32 s31, s17, 63
s_add_u32 s32, s17, 64
s_mov_b32 s27, s20
v_mov_b32 v7, 0
s_add_u32 s68, s4, 414720
s_addc_u32 s69, s5, 0
s_add_u32 s72, s4, 398336
s_addc_u32 s73, s5, 0
s_add_u32 s70, s4, 418816
s_addc_u32 s71, s5, 0
s_add_u32 s74, s4, 402432
s_addc_u32 s75, s5, 0
s_add_u32 s58, s4, s20
s_addc_u32 s59, s5, 0
global_load_dwordx4 v[64:67], v0, s[76:77] offset:-4096 sc1
global_load_dwordx4 v[68:71], v0, s[76:77] offset:-3072 sc1
global_load_dwordx4 v[72:75], v0, s[76:77] offset:-2048 sc1
global_load_dwordx4 v[76:79], v0, s[76:77] offset:-1024 sc1
global_load_dwordx4 v[80:83], v0, s[78:79] offset:-4096 sc1
global_load_dwordx4 v[84:87], v0, s[78:79] offset:-3072 sc1
global_load_dwordx4 v[48:51], v0, s[76:77] offset:2048 sc1
global_load_dwordx4 v[52:55], v0, s[76:77] offset:3072 sc1
global_load_dwordx4 v[56:59], v0, s[76:77] offset:0 sc1
global_load_dwordx4 v[60:63], v0, s[76:77] offset:1024 sc1
v_mov_b64 v[8:9], 0
v_mov_b64 v[10:11], 0
v_mov_b64 v[12:13], 0
v_mov_b64 v[14:15], 0
v_mov_b64 v[16:17], 0
v_mov_b64 v[18:19], 0
v_mov_b64 v[20:21], 0
v_mov_b64 v[22:23], 0
v_mov_b64 v[24:25], 0
v_mov_b64 v[26:27], 0
v_mov_b64 v[28:29], 0
v_mov_b64 v[30:31], 0
s_barrier
v_and_b32 v7, 511, v0
v_lshl_add_u32 v7, v7, 3, s27
global_load_dwordx4 v[32:35], v0, s[68:69] offset:-4096 sc1
global_load_dwordx4 v[36:39], v0, s[68:69] offset:0 sc1
global_load_dwordx4 v[40:43], v0, s[70:71] offset:0 sc1
s_mov_b32 s30, 0
s_waitcnt vmcnt(0)
.p2align 6
gather_10088:
s_waitcnt vmcnt(4)
rt_10093_b:
v_smfmac_f32_16x16x64_bf16 v[12:15], v[32:35], v[72:79], v1
ds_write_b128 v0, v[32:35] offset:1024
v_smfmac_f32_16x16x64_bf16 v[8:11], v[32:35], v[64:71], v1
v_bitop3_b32 v44, v32, v34, s18 bitop3:0x7e
v_smfmac_f32_16x16x64_bf16 v[20:23], v[32:35], v[48:55], v1
s_waitcnt vmcnt(3)
ds_write_b128 v0, v[36:39] offset:5120
v_bitop3_b32 v45, v36, v38, s18 bitop3:0x7e
v_or_b32 v44, v44, v45
s_waitcnt vmcnt(2)
v_bitop3_b32 v45, v40, v42, s18 bitop3:0x7e
v_smfmac_f32_16x16x64_bf16 v[16:19], v[32:35], v[56:63], v1
ds_write_b128 v0, v[40:43] offset:9216
v_bitop3_b32 v44, v44, v45, s19 bitop3:0xa8
v_cmp_ne_u32 vcc, 0, v44
v_smfmac_f32_16x16x64_bf16 v[28:31], v[32:35], a[8:15], v1
s_cbranch_vccnz rt_10093
ds_read_b128 v[52:55], v2 offset:3072
v_smfmac_f32_16x16x64_bf16 v[8:11], v[36:39], a[16:23], v1
s_waitcnt lgkmcnt(2)
ds_read_b128 v[60:63], v2 offset:1024
global_load_dwordx4 v[64:67], v0, s[78:79] offset:-2048 sc1
ds_read_b128 v[56:59], v2 offset:0
v_smfmac_f32_16x16x64_bf16 v[24:27], v[32:35], a[0:7], v1
s_waitcnt lgkmcnt(3)
ds_read_b128 v[48:51], v2 offset:2048
s_barrier
ds_read_b128 v[40:43], v0 offset:0
v_smfmac_f32_16x16x64_bf16 v[20:23], v[36:39], a[40:47], v1
s_mov_b64 s[68:69], s[72:73]
ds_read_b128 v[44:47], v0 offset:4096
global_load_dwordx4 v[68:71], v0, s[78:79] offset:-1024 sc1
v_smfmac_f32_16x16x64_bf16 v[16:19], v[36:39], a[32:39], v1
s_xor_b32 s18, s18, 1
ds_read_b128 v[32:35], v0 offset:3072
s_waitcnt lgkmcnt(4)
v_smfmac_f32_16x16x64_bf16 v[24:27], v[36:39], v[56:63], v1
ds_read_b128 v[56:59], v2 offset:4096
v_smfmac_f32_16x16x64_bf16 v[12:15], v[36:39], a[24:31], v1
ds_read_b128 v[60:63], v2 offset:5120
s_waitcnt lgkmcnt(4)
s_waitcnt vmcnt(2)
v_smfmac_f32_16x16x64_bf16 v[12:15], v[40:43], v[80:87], v1
ds_read_b128 v[84:87], v2 offset:7168
s_waitcnt lgkmcnt(4)
v_smfmac_f32_16x16x64_bf16 v[28:31], v[36:39], v[48:55], v1
ds_read_b128 v[80:83], v2 offset:6144
global_load_dwordx4 v[72:75], v0, s[78:79] offset:0 sc1
v_smfmac_f32_16x16x64_bf16 v[8:11], v[40:43], a[48:55], v1
ds_read_b128 v[36:39], v0 offset:7168
global_load_dwordx4 v[76:79], v0, s[78:79] offset:1024 sc1
v_smfmac_f32_16x16x64_bf16 v[12:15], v[44:47], a[64:71], v1
ds_read_b128 v[40:43], v0 offset:2048
s_waitcnt lgkmcnt(5)
v_smfmac_f32_16x16x64_bf16 v[8:11], v[44:47], a[56:63], v1
ds_read_b128 v[44:47], v0 offset:6144
s_waitcnt lgkmcnt(5)
v_smfmac_f32_16x16x64_bf16 v[8:11], v[32:35], v[56:63], v1
s_waitcnt lgkmcnt(3)
ds_read_b128 v[60:63], v2 offset:9216
v_smfmac_f32_16x16x64_bf16 v[12:15], v[32:35], a[72:79], v1
s_waitcnt lgkmcnt(3)
ds_read_b128 v[56:59], v2 offset:8192
v_smfmac_f32_16x16x64_bf16 v[12:15], v[36:39], v[80:87], v1
ds_read_b128 v[32:35], v0 offset:9216
v_smfmac_f32_16x16x64_bf16 v[8:11], v[36:39], a[80:87], v1
s_waitcnt lgkmcnt(4)
ds_read_b128 v[80:83], v2 offset:10240
global_load_dwordx4 v[48:51], v0, s[58:59] offset:0 nt sc1
ds_read_b128 v[84:87], v2 offset:11264
v_smfmac_f32_16x16x64_bf16 v[8:11], v[40:43], a[88:95], v1
s_add_u32 s20, s20, 524288
s_waitcnt lgkmcnt(5)
ds_read_b128 v[36:39], v0 offset:8192
v_smfmac_f32_16x16x64_bf16 v[12:15], v[40:43], a[96:103], v1
s_waitcnt lgkmcnt(4)
ds_read_b128 v[40:43], v0 offset:0
v_smfmac_f32_16x16x64_bf16 v[8:11], v[44:47], v[56:63], v1
global_load_dwordx4 v[52:55], v0, s[58:59] offset:1024 nt sc1
ds_read_b128 v[60:63], v2 offset:13312
v_smfmac_f32_16x16x64_bf16 v[12:15], v[44:47], a[104:111], v1
s_waitcnt lgkmcnt(4)
ds_read_b128 v[56:59], v2 offset:12288
s_waitcnt lgkmcnt(4)
v_smfmac_f32_16x16x64_bf16 v[12:15], v[32:35], v[80:87], v1
s_waitcnt vmcnt(4)
ds_read_b128 v[80:83], v2 offset:14336
s_mov_b64 vcc, s[42:43]
v_smfmac_f32_16x16x64_bf16 v[8:11], v[32:35], a[112:119], v1
s_waitcnt lgkmcnt(4)
ds_read_b128 v[84:87], v2 offset:15360
v_smfmac_f32_16x16x64_bf16 v[8:11], v[36:39], v[64:71], v1
s_nop 0
ds_read_b128 v[32:35], v0 offset:4096
global_load_dwordx4 v[64:67], v0, s[78:79] offset:2048 sc1
v_smfmac_f32_16x16x64_bf16 v[12:15], v[36:39], a[120:127], v1
s_nop 0
ds_read_b128 v[36:39], v0 offset:3072
s_waitcnt lgkmcnt(4)
s_nop 0
v_add_f32 v8, v8, v10
v_smfmac_f32_16x16x64_bf16 v[16:19], v[40:43], v[56:63], v1
ds_read_b128 v[60:63], v2 offset:17408
global_load_dwordx4 v[68:71], v0, s[78:79] offset:3072 sc1
ds_read_b128 v[56:59], v2 offset:16384
v_mul_f32 v8, s35, v8
v_smfmac_f32_16x16x64_bf16 v[20:23], v[40:43], a[128:135], v1
s_waitcnt lgkmcnt(3)
ds_read_b128 v[40:43], v0 offset:7168
v_add_f32 v12, v12, v14
v_smfmac_f32_16x16x64_bf16 v[20:23], v[32:35], v[80:87], v1
s_waitcnt lgkmcnt(3)
ds_read_b128 v[80:83], v2 offset:18432
v_add_f32 v13, v13, v15
v_smfmac_f32_16x16x64_bf16 v[16:19], v[32:35], a[136:143], v1
ds_read_b128 v[32:35], v0 offset:2048
v_add_f32 v9, v9, v11
v_smfmac_f32_16x16x64_bf16 v[20:23], v[36:39], a[152:159], v1
s_waitcnt vmcnt(4)
ds_read_b128 v[84:87], v2 offset:19456
v_mul_f32 v13, s35, v13
v_mul_f32 v12, s35, v12
v_mul_f32 v9, s35, v9
v_cvt_pk_bf16_f32 v8, v8, v9
v_cvt_pk_bf16_f32 v12, v12, v13
v_smfmac_f32_16x16x64_bf16 v[16:19], v[36:39], a[144:151], v1
s_waitcnt lgkmcnt(3)
ds_read_b128 v[36:39], v0 offset:6144
ds_write2_b32 v3, v8, v12 offset0:0 offset1:128
v_smfmac_f32_16x16x64_bf16 v[16:19], v[40:43], v[72:79], v1
global_load_dwordx4 v[72:75], v0, s[80:81] offset:-4096 sc1
v_smfmac_f32_16x16x64_bf16 v[20:23], v[40:43], v[56:63], v1
s_waitcnt lgkmcnt(3)
global_load_dwordx4 v[76:79], v0, s[80:81] offset:-3072 sc1
v_smfmac_f32_16x16x64_bf16 v[20:23], v[32:35], a[168:175], v1
ds_read_b128 v[40:43], v0 offset:9216
global_load_dwordx4 v[56:59], v0, s[58:59] offset:2048 nt sc1
global_load_dwordx4 v[60:63], v0, s[58:59] offset:3072 nt sc1
v_smfmac_f32_16x16x64_bf16 v[16:19], v[32:35], a[160:167], v1
s_waitcnt lgkmcnt(1)
ds_read_b128 v[32:35], v0 offset:8192
v_smfmac_f32_16x16x64_bf16 v[16:19], v[36:39], a[176:183], v1
s_barrier
ds_read_b64_tr_b16 v[10:11], v4 offset:512
v_smfmac_f32_16x16x64_bf16 v[20:23], v[36:39], v[80:87], v1
s_waitcnt lgkmcnt(2)
ds_read_b128 v[36:39], v0 offset:9216
ds_read_b64_tr_b16 v[14:15], v4 offset:1536
v_smfmac_f32_16x16x64_bf16 v[20:23], v[40:43], a[192:199], v1
ds_read_b64_tr_b16 v[12:13], v4 offset:1024
s_waitcnt lgkmcnt(4)
ds_read_b64_tr_b16 v[8:9], v4 offset:0
v_smfmac_f32_16x16x64_bf16 v[16:19], v[40:43], a[184:191], v1
s_waitcnt vmcnt(5)
ds_read_b128 v[40:43], v0 offset:8192
v_smfmac_f32_16x16x64_bf16 v[16:19], v[32:35], a[200:207], v1
v_smfmac_f32_16x16x64_bf16 v[20:23], v[32:35], a[208:215], v1
s_waitcnt lgkmcnt(3)
ds_read_b128 v[80:83], v2 offset:20480
global_load_dword v7, v7, s[4:5] sc1
ds_read_b128 v[84:87], v2 offset:21504
v_smfmac_f32_16x16x64_bf16 v[24:27], v[36:39], a[216:223], v1
s_waitcnt lgkmcnt(3)
ds_read_b128 v[32:35], v0 offset:0
v_add_f32 v16, v16, v18
v_mfma_f32_16x16x32_bf16 v[44:47], v[48:51], v[8:11], 0
v_bfe_u32 v48, v0, 5, 1
v_add_f32 v17, v17, v19
v_mfma_f32_16x16x32_bf16 v[44:47], v[52:55], v[12:15], v[44:47]
s_nop 0
v_lshl_add_u32 v48, v48, 3, v5
v_add_f32 v20, v20, v22
v_smfmac_f32_16x16x64_bf16 v[28:31], v[36:39], a[224:231], v1
s_waitcnt lgkmcnt(3)
ds_read_b128 v[36:39], v0 offset:4096
v_cvt_pk_bf16_f32 v16, v16, v17
v_add_f32 v21, v21, v23
v_cndmask_b32_dpp v44, v46, v44, vcc quad_perm:[0,1,0,1] row_mask:0xf bank_mask:0xf
v_cvt_pk_bf16_f32 v20, v20, v21
v_smfmac_f32_16x16x64_bf16 v[24:27], v[40:43], a[232:239], v1
s_waitcnt lgkmcnt(1)
ds_write2_b32 v3, v16, v20 offset0:1 offset1:129
v_cndmask_b32_dpp v45, v47, v45, vcc quad_perm:[0,1,0,1] row_mask:0xf bank_mask:0xf
v_xor_b32 v48, 128, v48
v_smfmac_f32_16x16x64_bf16 v[28:31], v[40:43], v[80:87], v1
s_add_u32 s17, s17, 1
ds_write_b64 v48, v[44:45] offset:6656
v_smfmac_f32_16x16x64_bf16 v[24:27], v[32:35], a[240:247], v1
s_add_u32 s21, s21, 10240
ds_read_b128 v[40:43], v0 offset:3072
v_smfmac_f32_16x16x64_bf16 v[28:31], v[32:35], a[248:255], v1
s_waitcnt vmcnt(5)
ds_read_b128 v[32:35], v0 offset:7168
s_waitcnt lgkmcnt(4)
v_smfmac_f32_16x16x64_bf16 v[24:27], v[36:39], v[64:71], v1
ds_read_b128 v[80:83], v2 offset:22528
global_load_dwordx4 v[64:67], v0, s[76:77] offset:-4096 sc1
v_smfmac_f32_16x16x64_bf16 v[28:31], v[36:39], v[88:95], v1
s_waitcnt lgkmcnt(3)
ds_read_b128 v[36:39], v0 offset:2048
s_barrier
ds_read_b128 v[52:55], v6 offset:7168
s_waitcnt lgkmcnt(4)
v_smfmac_f32_16x16x64_bf16 v[28:31], v[40:43], v[104:111], v1
s_waitcnt lgkmcnt(3)
ds_read_b128 v[48:51], v6 offset:6144
v_smfmac_f32_16x16x64_bf16 v[24:27], v[40:43], v[96:103], v1
ds_read_b128 v[40:43], v0 offset:6144
ds_read_b64_tr_b16 v[16:17], v4 offset:2048
v_smfmac_f32_16x16x64_bf16 v[24:27], v[32:35], v[112:119], v1
ds_read_b64_tr_b16 v[18:19], v4 offset:2560
s_waitcnt lgkmcnt(5)
ds_read_b64_tr_b16 v[14:15], v4 offset:1536
v_smfmac_f32_16x16x64_bf16 v[28:31], v[32:35], v[120:127], v1
s_waitcnt vmcnt(2)
ds_read_b64_tr_b16 v[8:9], v4 offset:0
ds_read_b64_tr_b16 v[12:13], v4 offset:1024
v_smfmac_f32_16x16x64_bf16 v[28:31], v[36:39], v[136:143], v1
s_waitcnt lgkmcnt(6)
ds_read_b64_tr_b16 v[10:11], v4 offset:512
v_add_f32 v49, v49, v53
v_smfmac_f32_16x16x64_bf16 v[24:27], v[36:39], v[128:135], v1
s_waitcnt lgkmcnt(6)
ds_read_b64_tr_b16 v[20:21], v4 offset:3072
v_add_f32 v50, v50, v54
v_smfmac_f32_16x16x64_bf16 v[28:31], v[40:43], v[144:151], v1
ds_read_b64_tr_b16 v[22:23], v4 offset:3584
v_add_f32 v51, v51, v55
v_exp_f32 v51, v51
v_exp_f32 v49, v49
v_smfmac_f32_16x16x64_bf16 v[24:27], v[40:43], v[72:79], v1
s_waitcnt lgkmcnt(2)
ds_read_b128 v[84:87], v2 offset:23552
v_add_f32 v48, v48, v52
v_exp_f32 v48, v48
v_exp_f32 v50, v50
v_mfma_f32_16x16x32_bf16 v[44:47], v[8:11], v[8:11], 0
s_waitcnt lgkmcnt(1)
v_cvt_pk_bf16_f32 v55, v50, v51
v_cvt_pk_bf16_f32 v54, v48, v49
v_mfma_f32_16x16x32_bf16 v[44:47], v[12:15], v[12:15], v[44:47]
v_mov_b32_dpp v51, v55 quad_perm:[2,3,2,3] row_mask:0xf bank_mask:0xf
v_mov_b32_dpp v50, v54 quad_perm:[2,3,2,3] row_mask:0xf bank_mask:0xf
v_mfma_f32_16x16x32_bf16 v[44:47], v[16:19], v[16:19], v[44:47]
v_mov_b32_dpp v49, v55 quad_perm:[0,1,0,1] row_mask:0xf bank_mask:0xf
v_mov_b32_dpp v48, v54 quad_perm:[0,1,0,1] row_mask:0xf bank_mask:0xf
v_mfma_f32_16x16x32_bf16 v[44:47], v[20:23], v[20:23], v[44:47]
s_mov_b64 s[70:71], s[74:75]
v_mov_b64 v[20:21], s[44:45]
v_cvt_pk_bf16_f32 v24, v24, v25
v_mfma_f32_16x16x32_bf16 v[8:11], v[56:59], v[48:51], 0
s_add_u32 s34, s17, 2
v_mov_b64 v[22:23], s[44:45]
v_cvt_pk_bf16_f32 v25, v26, v27
v_mfma_f32_16x16x32_bf16 v[12:15], v[60:63], v[48:51], 0
v_exp_f32_dpp v44, v46 quad_perm:[0,1,0,1] row_mask:0xf bank_mask:0xf
v_exp_f32_dpp v45, v47 quad_perm:[0,1,0,1] row_mask:0xf bank_mask:0xf
v_mfma_f32_16x16x32_bf16 v[16:19], v[20:23], v[48:51], 0
s_waitcnt lgkmcnt(0)
v_cvt_pk_bf16_f32 v52, v44, v45
v_cvt_pk_bf16_f32 v53, v44, v45
v_mov_b64 v[54:55], s[46:47]
v_cvt_pk_bf16_f32 v27, v30, v31
v_mfma_f32_16x16x16_bf16 v[8:11], v[24:25], v[52:53], v[8:11]
s_mov_b32 s19, 1
global_load_dwordx4 v[68:71], v0, s[76:77] offset:-3072 sc1
v_cvt_pk_bf16_f32 v26, v28, v29
v_mfma_f32_16x16x16_bf16 v[16:19], v[54:55], v[52:53], v[16:19]
s_min_u32 s34, s34, s32
v_mov_b64 v[38:39], 0
v_mov_b64 v[36:37], 0
v_mfma_f32_16x16x16_bf16 v[12:15], v[26:27], v[52:53], v[12:15]
s_nop 0
ds_read_b128 v[28:31], v0 offset:31744
v_bfe_u32 v32, v0, 5, 1
v_mov_b64 v[34:35], 0
v_rcp_f32 v18, v16
v_subrev_u32 v17, s37, v16
v_cmp_lt_u32 vcc, s38, v17
v_lshl_add_u32 v32, v32, 3, v5
v_cndmask_b32 v9, v13, v9, s[42:43]
v_cndmask_b32 v8, v12, v8, s[42:43]
v_cndmask_b32 v10, v14, v10, s[42:43]
v_mul_f32 v10, v10, v18
v_mul_f32 v9, v9, v18
v_mul_f32 v8, v8, v18
v_cndmask_b32 v11, v15, v11, s[42:43]
v_mul_f32 v11, v11, v18
v_cvt_pk_bf16_f32 v13, v10, v11
v_cvt_pk_bf16_f32 v12, v8, v9
s_cbranch_vccnz rare_10089
back_10090:
ds_read_b128 v[16:19], v0 offset:28672
ds_write_b64 v32, v[12:13] offset:512
v_mov_b64 v[42:43], 0
v_mov_b64 v[32:33], 0
v_mov_b32_dpp v10, v12 quad_perm:[2,3,2,3] row_mask:0xf bank_mask:0xf
v_mov_b64 v[54:55], 0
v_mov_b32_dpp v8, v12 quad_perm:[0,1,0,1] row_mask:0xf bank_mask:0xf
v_mov_b32_dpp v11, v13 quad_perm:[2,3,2,3] row_mask:0xf bank_mask:0xf
v_mov_b32_dpp v9, v13 quad_perm:[0,1,0,1] row_mask:0xf bank_mask:0xf
v_mov_b64 v[52:53], 0
v_mov_b64 v[40:41], 0
v_smfmac_f32_16x16x64_bf16 v[36:39], v[8:11], v[80:87], v1
ds_read_b128 v[24:27], v0 offset:30720
global_load_dwordx4 v[72:75], v0, s[76:77] offset:-2048 sc1
ds_read_b128 v[20:23], v0 offset:29696
v_smfmac_f32_16x16x64_bf16 v[40:43], v[8:11], v[152:159], v1
s_waitcnt lgkmcnt(2)
ds_read_b128 v[80:83], v0 offset:32768
s_barrier
ds_read_b128 v[56:59], v5 offset:0
v_smfmac_f32_16x16x64_bf16 v[32:35], v[8:11], v[176:183], v1
s_add_u32 s27, s20, 524288
ds_read_b128 v[60:63], v5 offset:1536
v_mov_b64 v[48:49], 0
v_mov_b64 v[50:51], 0
v_smfmac_f32_16x16x64_bf16 v[52:55], v[8:11], v[168:175], v1
s_add_u32 s58, s4, s20
ds_read_b128 v[12:15], v5 offset:1024
v_lshrrev_b32 v44, 8, v0
v_smfmac_f32_16x16x64_bf16 v[48:51], v[8:11], v[160:167], v1
s_waitcnt lgkmcnt(4)
ds_read_b128 v[84:87], v0 offset:33792
global_load_dwordx4 v[76:79], v0, s[76:77] offset:-1024 sc1
v_bfe_u32 v45, v0, 1, 7
s_waitcnt lgkmcnt(3)
v_smfmac_f32_16x16x64_bf16 v[36:39], v[56:59], v[16:23], v1
s_addc_u32 s59, s5, 0
ds_read_b128 v[16:19], v0 offset:34816
s_waitcnt lgkmcnt(3)
v_smfmac_f32_16x16x64_bf16 v[36:39], v[60:63], v[24:31], v1
ds_read_b128 v[28:31], v0 offset:37888
s_waitcnt lgkmcnt(3)
v_smfmac_f32_16x16x64_bf16 v[36:39], v[12:15], v[184:191], v1
ds_read_b128 v[20:23], v0 offset:35840
s_waitcnt lgkmcnt(3)
v_smfmac_f32_16x16x64_bf16 v[40:43], v[56:59], v[80:87], v1
ds_read_b128 v[24:27], v0 offset:36864
v_lshl_or_b32 v44, v44, 12, v45
v_smfmac_f32_16x16x64_bf16 v[40:43], v[60:63], v[192:199], v1
s_nop 0
ds_read_b128 v[84:87], v0 offset:39936
v_cvt_pk_bf16_f32 v36, v36, v37
v_and_or_b32 v36, v36, -2, s18
v_cvt_pk_bf16_f32 v37, v38, v39
v_smfmac_f32_16x16x64_bf16 v[40:43], v[12:15], v[200:207], v1
global_store_dwordx2 v44, v[36:37], s[48:49]
s_waitcnt lgkmcnt(2)
v_smfmac_f32_16x16x64_bf16 v[48:51], v[56:59], v[16:23], v1
ds_read_b128 v[80:83], v0 offset:38912
s_waitcnt lgkmcnt(2)
v_smfmac_f32_16x16x64_bf16 v[48:51], v[60:63], v[24:31], v1
s_mov_b32 s30, 0
s_nop 0
v_cvt_pk_bf16_f32 v40, v40, v41
v_cvt_pk_bf16_f32 v41, v42, v43
v_and_or_b32 v40, v40, -2, s18
v_smfmac_f32_16x16x64_bf16 v[48:51], v[12:15], v[208:215], v1
global_store_dwordx2 v44, v[40:41], s[50:51]
s_waitcnt lgkmcnt(1)
v_smfmac_f32_16x16x64_bf16 v[32:35], v[56:59], v[232:239], v1
s_nop 0
s_waitcnt lgkmcnt(0)
v_smfmac_f32_16x16x64_bf16 v[52:55], v[56:59], v[80:87], v1
s_nop 1
v_cvt_pk_bf16_f32 v48, v48, v49
v_smfmac_f32_16x16x64_bf16 v[52:55], v[60:63], v[216:223], v1
v_and_or_b32 v48, v48, -2, s18
v_cvt_pk_bf16_f32 v49, v50, v51
v_smfmac_f32_16x16x64_bf16 v[52:55], v[12:15], v[224:231], v1
global_store_dwordx2 v44, v[48:49], s[52:53]
v_smfmac_f32_16x16x64_bf16 v[32:35], v[60:63], v[240:247], v1
s_nop 2
v_smfmac_f32_16x16x64_bf16 v[32:35], v[12:15], v[248:255], v1
s_nop 1
v_cvt_pk_bf16_f32 v52, v52, v53
v_and_or_b32 v52, v52, -2, s18
v_cvt_pk_bf16_f32 v53, v54, v55
s_nop 0
global_store_dwordx2 v44, v[52:53], s[54:55]
s_nop 0
v_cvt_pk_bf16_f32 v32, v32, v33
v_cvt_pk_bf16_f32 v33, v34, v35
v_and_or_b32 v32, v32, -2, s18
global_store_dwordx2 v44, v[32:33], s[56:57]
v_bfe_u32 v32, v0, 6, 1
v_lshlrev_b32 v32, 4, v32
v_mov_b32 v33, 0x3f80
v_lshlrev_b32 v32, v32, v33
v_bfe_i32 v33, v0, 4, 1
v_and_b32 v45, v32, v33
v_and_b32 v47, v32, v33
v_xor_b32 v44, v32, v45
v_xor_b32 v46, v32, v45
v_and_b32 v36, 32, v0
v_bfe_u32 v37, v0, 6, 1
v_lshl_add_u32 v36, v37, 8, v36
v_bfe_u32 v37, v0, 8, 1
v_lshl_add_u32 v36, v37, 4, v36
v_bfe_u32 v37, v0, 4, 1
v_lshl_add_u32 v36, v37, 3, v36
s_waitcnt vmcnt(9)
v_and_b32 v7, 511, v0
v_lshl_add_u32 v7, v7, 3, s27
s_nop 15
s_nop 15
s_nop 15
s_nop 15
global_load_dwordx4 v[8:11], v0, s[64:65] offset:0 sc1
global_load_dwordx4 v[12:15], v0, s[64:65] offset:1024 sc1
global_load_dwordx4 v[16:19], v0, s[64:65] offset:2048 sc1
global_load_dwordx4 v[20:23], v0, s[64:65] offset:3072 sc1
s_nop 15
s_nop 15
s_nop 5
global_load_dwordx4 v[24:27], v0, s[64:65] offset:0 sc1
global_load_dwordx4 v[28:31], v0, s[64:65] offset:1024 sc1
global_load_dwordx4 v[80:83], v0, s[64:65] offset:2048 sc1
global_load_dwordx4 v[84:87], v0, s[64:65] offset:3072 sc1
chk_10098:
v_mov_b64 v[40:41], 0
v_mov_b64 v[42:43], 0
s_waitcnt vmcnt(6)
s_nop 0
v_smfmac_f32_16x16x64_bf16 v[40:43], v[44:47], v[8:15], v1
v_bitop3_b32 v32, v8, v10, s18 bitop3:0x7e
v_bitop3_b32 v33, v12, v14, s18 bitop3:0x7e
s_waitcnt vmcnt(4)
v_smfmac_f32_16x16x64_bf16 v[40:43], v[44:47], v[16:23], v1
v_bitop3_b32 v34, v16, v18, s18 bitop3:0x7e
v_bitop3_b32 v35, v20, v22, s18 bitop3:0x7e
v_or3_b32 v32, v32, v33, v34
v_bitop3_b32 v32, v32, v35, 1 bitop3:0xa8
v_cmp_ne_u32 vcc, 0, v32
s_cbranch_vccnz chk_10098_f
s_nop 1
v_add_f32_dpp v40, v40, v40 row_ror:8 row_mask:0xf bank_mask:0xf
v_add_f32_dpp v41, v41, v41 row_ror:8 row_mask:0xf bank_mask:0xf
v_add_f32_dpp v42, v42, v42 row_ror:8 row_mask:0xf bank_mask:0xf
v_add_f32_dpp v43, v43, v43 row_ror:8 row_mask:0xf bank_mask:0xf
v_cvt_pk_bf16_f32 v40, v40, v41
v_cvt_pk_bf16_f32 v41, v42, v43
v_and_or_b32 v40, v40, -2, s18
s_mov_b64 exec, 0x00ff00ff
global_store_dwordx2 v36, v[40:41], s[66:67]
s_mov_b64 exec, -1
s_branch join_10097
chk_10098_f:
global_load_dwordx4 v[8:11], v0, s[64:65] offset:0 sc1
global_load_dwordx4 v[12:15], v0, s[64:65] offset:1024 sc1
global_load_dwordx4 v[16:19], v0, s[64:65] offset:2048 sc1
global_load_dwordx4 v[20:23], v0, s[64:65] offset:3072 sc1
chk_10099:
v_mov_b64 v[40:41], 0
v_mov_b64 v[42:43], 0
s_waitcnt vmcnt(6)
s_nop 0
v_smfmac_f32_16x16x64_bf16 v[40:43], v[44:47], v[24:31], v1
v_bitop3_b32 v32, v24, v26, s18 bitop3:0x7e
v_bitop3_b32 v33, v28, v30, s18 bitop3:0x7e
s_waitcnt vmcnt(4)
v_smfmac_f32_16x16x64_bf16 v[40:43], v[44:47], v[80:87], v1
v_bitop3_b32 v34, v80, v82, s18 bitop3:0x7e
v_bitop3_b32 v35, v84, v86, s18 bitop3:0x7e
v_or3_b32 v32, v32, v33, v34
v_bitop3_b32 v32, v32, v35, 1 bitop3:0xa8
v_cmp_ne_u32 vcc, 0, v32
s_cbranch_vccnz chk_10099_f
s_nop 1
v_add_f32_dpp v40, v40, v40 row_ror:8 row_mask:0xf bank_mask:0xf
v_add_f32_dpp v41, v41, v41 row_ror:8 row_mask:0xf bank_mask:0xf
v_add_f32_dpp v42, v42, v42 row_ror:8 row_mask:0xf bank_mask:0xf
v_add_f32_dpp v43, v43, v43 row_ror:8 row_mask:0xf bank_mask:0xf
v_cvt_pk_bf16_f32 v40, v40, v41
v_cvt_pk_bf16_f32 v41, v42, v43
v_and_or_b32 v40, v40, -2, s18
s_mov_b64 exec, 0x00ff00ff
global_store_dwordx2 v36, v[40:41], s[66:67]
s_mov_b64 exec, -1
s_branch join_10097
chk_10099_f:
global_load_dwordx4 v[24:27], v0, s[64:65] offset:0 sc1
global_load_dwordx4 v[28:31], v0, s[64:65] offset:1024 sc1
global_load_dwordx4 v[80:83], v0, s[64:65] offset:2048 sc1
global_load_dwordx4 v[84:87], v0, s[64:65] offset:3072 sc1
s_add_u32 s30, s30, 1
s_cmp_le_u32 s30, 262144
s_cbranch_scc1 chk_10098
s_branch L_fail
nored_10096:
join_10097:
s_barrier
global_load_dwordx4 v[56:59], v0, s[76:77] offset:0 sc1
global_load_dwordx4 v[60:63], v0, s[76:77] offset:1024 sc1
global_load_dwordx4 v[48:51], v0, s[76:77] offset:2048 sc1
global_load_dwordx4 v[52:55], v0, s[76:77] offset:3072 sc1
s_nop 15
s_nop 15
s_nop 3
s_barrier
global_load_dwordx4 v[32:35], v0, s[68:69] offset:-4096 sc1
s_nop 10
global_load_dwordx4 v[36:39], v0, s[68:69] offset:0 sc1
s_nop 10
global_load_dwordx4 v[40:43], v0, s[70:71] offset:0 sc1
s_barrier
global_load_dwordx4 v[80:83], v0, s[78:79] offset:-4096 sc1
global_load_dwordx4 v[84:87], v0, s[78:79] offset:-3072 sc1
s_waitcnt vmcnt(13)
v_mov_b64 v[8:9], 0
v_mov_b64 v[10:11], 0
s_waitcnt vmcnt(12)
v_mov_b64 v[12:13], 0
v_mov_b64 v[14:15], 0
s_waitcnt vmcnt(11)
v_mov_b64 v[16:17], 0
v_mov_b64 v[18:19], 0
s_waitcnt vmcnt(10)
v_mov_b64 v[20:21], 0
v_mov_b64 v[22:23], 0
v_mov_b64 v[24:25], 0
v_mov_b64 v[26:27], 0
v_mov_b64 v[28:29], 0
v_mov_b64 v[30:31], 0
s_mov_b32 s30, 0
s_cmp_eq_u32 s17, s31
s_cbranch_scc0 gather_10088
s_branch exit_10091
rt_10093:
global_load_dwordx4 v[32:35], v0, s[68:69] offset:-4096 sc1
global_load_dwordx4 v[36:39], v0, s[68:69] offset:0 sc1
global_load_dwordx4 v[40:43], v0, s[70:71] offset:0 sc1
s_add_u32 s30, s30, 1
s_cmp_gt_u32 s30, 262144
s_cbranch_scc1 L_fail
s_mov_b64 exec, 1
global_store_dword v0, v0, s[62:63]
global_store_dword v0, v0, s[62:63]
s_mov_b64 exec, -1
v_mov_b64 v[8:9], 0
v_mov_b64 v[10:11], 0
v_mov_b64 v[12:13], 0
v_mov_b64 v[14:15], 0
v_mov_b64 v[16:17], 0
v_mov_b64 v[18:19], 0
v_mov_b64 v[20:21], 0
v_mov_b64 v[22:23], 0
v_mov_b64 v[24:25], 0
v_mov_b64 v[26:27], 0
v_mov_b64 v[28:29], 0
v_mov_b64 v[30:31], 0
s_branch gather_10088
rare_10089:
ds_read_b128 v[48:51], v6 offset:6144
ds_read_b128 v[52:55], v6 offset:7168
s_waitcnt lgkmcnt(0)
v_add_f32 v48, v48, v52
v_add_f32 v49, v49, v53
v_add_f32 v50, v50, v54
v_add_f32 v51, v51, v55
v_mov_b32_dpp v46, v46 quad_perm:[0,1,0,1] row_mask:0xf bank_mask:0xf
v_mov_b32_dpp v47, v47 quad_perm:[0,1,0,1] row_mask:0xf bank_mask:0xf
v_max3_f32 v19, v48, v49, v50
v_max3_f32 v19, v19, v51, v46
v_max_f32 v19, v19, v47
s_nop 1
v_max_f32_dpp v19, v19, v19 quad_perm:[2,3,0,1] row_mask:0xf bank_mask:0xf
v_mov_b32 v44, v19
s_nop 1
v_permlane32_swap_b32 v19, v44
v_max_f32 v19, v19, v44
v_mov_b32 v44, v19
s_nop 1
v_permlane16_swap_b32 v19, v44
v_max_f32 v19, v19, v44
v_sub_f32 v48, v48, v19
v_sub_f32 v49, v49, v19
v_sub_f32 v50, v50, v19
v_sub_f32 v51, v51, v19
v_sub_f32 v46, v46, v19
v_sub_f32 v47, v47, v19
v_exp_f32 v48, v48
v_exp_f32 v49, v49
v_exp_f32 v50, v50
v_exp_f32 v51, v51
v_cvt_pk_bf16_f32 v54, v48, v49
v_cvt_pk_bf16_f32 v55, v50, v51
s_nop 0
v_mov_b32_dpp v48, v54 quad_perm:[0,1,0,1] row_mask:0xf bank_mask:0xf
v_mov_b32_dpp v49, v55 quad_perm:[0,1,0,1] row_mask:0xf bank_mask:0xf
v_mov_b32_dpp v50, v54 quad_perm:[2,3,2,3] row_mask:0xf bank_mask:0xf
v_mov_b32_dpp v51, v55 quad_perm:[2,3,2,3] row_mask:0xf bank_mask:0xf
v_mov_b64 v[20:21], s[44:45]
v_mov_b64 v[22:23], s[44:45]
v_mfma_f32_16x16x32_bf16 v[8:11], v[56:59], v[48:51], 0
v_mfma_f32_16x16x32_bf16 v[12:15], v[60:63], v[48:51], 0
v_mfma_f32_16x16x32_bf16 v[16:19], v[20:23], v[48:51], 0
v_mov_b64 v[54:55], s[46:47]
v_exp_f32_dpp v44, v46 quad_perm:[0,1,0,1] row_mask:0xf bank_mask:0xf
v_exp_f32_dpp v45, v47 quad_perm:[0,1,0,1] row_mask:0xf bank_mask:0xf
s_nop 0
v_cvt_pk_bf16_f32 v52, v44, v45
v_cvt_pk_bf16_f32 v53, v44, v45
s_nop 1
v_mfma_f32_16x16x16_bf16 v[16:19], v[54:55], v[52:53], v[16:19]
v_mfma_f32_16x16x16_bf16 v[8:11], v[24:25], v[52:53], v[8:11]
v_mfma_f32_16x16x16_bf16 v[12:15], v[26:27], v[52:53], v[12:15]
s_nop 5
v_rcp_f32 v18, v16
s_nop 0
v_cndmask_b32 v8, v12, v8, s[42:43]
v_mul_f32 v8, v8, v18
v_cndmask_b32 v9, v13, v9, s[42:43]
v_mul_f32 v9, v9, v18
v_cndmask_b32 v10, v14, v10, s[42:43]
v_mul_f32 v10, v10, v18
v_cndmask_b32 v11, v15, v11, s[42:43]
v_mul_f32 v11, v11, v18
v_cvt_pk_bf16_f32 v12, v8, v9
v_cvt_pk_bf16_f32 v13, v10, v11
s_branch back_10090
exit_10091:
global_load_dwordx4 v[32:35], v0, s[68:69] offset:-4096 sc1
global_load_dwordx4 v[36:39], v0, s[68:69] offset:0 sc1
global_load_dwordx4 v[40:43], v0, s[70:71] offset:0 sc1
s_add_u32 s30, s30, 1
s_cmp_gt_u32 s30, 262144
s_cbranch_scc1 L_fail
s_waitcnt vmcnt(2)
v_bitop3_b32 v44, v32, v34, s18 bitop3:0x7e
s_waitcnt vmcnt(1)
v_bitop3_b32 v45, v36, v38, s18 bitop3:0x7e
v_or_b32 v44, v44, v45
s_waitcnt vmcnt(0)
v_bitop3_b32 v46, v40, v42, s18 bitop3:0x7e
v_bitop3_b32 v44, v44, v46, s19 bitop3:0xa8
v_cmp_ne_u32 vcc, 0, v44
s_cbranch_vccnz exit_10091
ds_write_b128 v0, v[32:35] offset:1024
ds_write_b128 v0, v[36:39] offset:5120
ds_write_b128 v0, v[40:43] offset:9216
s_waitcnt lgkmcnt(0)
s_barrier
s_barrier
s_add_u32 s36, s36, 1
s_cmp_lt_u32 s36, 2
s_cbranch_scc1 layer_10087
s_endpgm
wave_10070:
layer_10100:
s_lshl_b32 s17, s36, 6
s_mul_i32 s27, s36, 35651584
s_mul_i32 s28, s14, 16384
s_add_u32 s27, s27, s28
s_add_u32 s20, s27, 16785408
s_mul_i32 s27, s17, 10240
s_add_u32 s27, s27, s24
s_add_u32 s21, s27, s25
s_mov_b32 s19, 0
s_mov_b32 s33, s6
s_add_u32 s34, s17, 1
s_add_u32 s31, s17, 63
s_add_u32 s32, s17, 64
s_mov_b32 s27, s20
v_mov_b32 v7, 0
s_add_u32 s68, s4, 415744
s_addc_u32 s69, s5, 0
s_add_u32 s72, s4, 399360
s_addc_u32 s73, s5, 0
s_add_u32 s70, s4, 419840
s_addc_u32 s71, s5, 0
s_add_u32 s74, s4, 403456
s_addc_u32 s75, s5, 0
s_add_u32 s58, s4, s20
s_addc_u32 s59, s5, 0
global_load_dwordx4 v[64:67], v0, s[76:77] offset:-4096 sc1
global_load_dwordx4 v[68:71], v0, s[76:77] offset:-3072 sc1
global_load_dwordx4 v[72:75], v0, s[76:77] offset:-2048 sc1
global_load_dwordx4 v[76:79], v0, s[76:77] offset:-1024 sc1
global_load_dwordx4 v[80:83], v0, s[78:79] offset:-4096 sc1
global_load_dwordx4 v[84:87], v0, s[78:79] offset:-3072 sc1
global_load_dwordx4 v[48:51], v0, s[76:77] offset:2048 sc1
global_load_dwordx4 v[52:55], v0, s[76:77] offset:3072 sc1
global_load_dwordx4 v[56:59], v0, s[76:77] offset:0 sc1
global_load_dwordx4 v[60:63], v0, s[76:77] offset:1024 sc1
v_mov_b64 v[8:9], 0
v_mov_b64 v[10:11], 0
v_mov_b64 v[12:13], 0
v_mov_b64 v[14:15], 0
v_mov_b64 v[16:17], 0
v_mov_b64 v[18:19], 0
v_mov_b64 v[20:21], 0
v_mov_b64 v[22:23], 0
v_mov_b64 v[24:25], 0
v_mov_b64 v[26:27], 0
v_mov_b64 v[28:29], 0
v_mov_b64 v[30:31], 0
s_barrier
v_and_b32 v7, 511, v0
v_lshl_add_u32 v7, v7, 3, s27
global_load_dwordx4 v[32:35], v0, s[68:69] offset:-4096 sc1
global_load_dwordx4 v[36:39], v0, s[68:69] offset:0 sc1
v_mov_b32 v45, -1
s_mov_b32 s30, 0
s_waitcnt vmcnt(0)
.p2align 6
gather_10101:
s_waitcnt vmcnt(3)
rt_10106_b:
v_smfmac_f32_16x16x64_bf16 v[12:15], v[32:35], v[72:79], v1
ds_write_b128 v0, v[32:35] offset:2048
v_smfmac_f32_16x16x64_bf16 v[8:11], v[32:35], v[64:71], v1
v_bitop3_b32 v44, v32, v34, s18 bitop3:0x7e
v_smfmac_f32_16x16x64_bf16 v[20:23], v[32:35], v[48:55], v1
s_waitcnt vmcnt(2)
ds_write_b128 v0, v[36:39] offset:6144
v_bitop3_b32 v45, v36, v38, s18 bitop3:0x7e
v_smfmac_f32_16x16x64_bf16 v[16:19], v[32:35], v[56:63], v1
v_bitop3_b32 v44, v44, v45, s19 bitop3:0xa8
v_cmp_ne_u32 vcc, 0, v44
v_smfmac_f32_16x16x64_bf16 v[28:31], v[32:35], a[8:15], v1
s_cbranch_vccnz rt_10106
ds_read_b128 v[52:55], v2 offset:3072
v_smfmac_f32_16x16x64_bf16 v[8:11], v[36:39], a[16:23], v1
s_waitcnt lgkmcnt(1)
ds_read_b128 v[60:63], v2 offset:1024
global_load_dwordx4 v[64:67], v0, s[78:79] offset:-2048 sc1
ds_read_b128 v[56:59], v2 offset:0
v_smfmac_f32_16x16x64_bf16 v[24:27], v[32:35], a[0:7], v1
ds_read_b128 v[48:51], v2 offset:2048
s_barrier
ds_read_b128 v[40:43], v0 offset:3072
v_smfmac_f32_16x16x64_bf16 v[20:23], v[36:39], a[40:47], v1
s_mov_b64 s[68:69], s[72:73]
ds_read_b128 v[44:47], v0 offset:7168
global_load_dwordx4 v[68:71], v0, s[78:79] offset:-1024 sc1
v_smfmac_f32_16x16x64_bf16 v[16:19], v[36:39], a[32:39], v1
s_xor_b32 s18, s18, 1
ds_read_b128 v[32:35], v0 offset:0
s_waitcnt lgkmcnt(4)
v_smfmac_f32_16x16x64_bf16 v[24:27], v[36:39], v[56:63], v1
ds_read_b128 v[56:59], v2 offset:4096
v_smfmac_f32_16x16x64_bf16 v[12:15], v[36:39], a[24:31], v1
ds_read_b128 v[60:63], v2 offset:5120
s_waitcnt lgkmcnt(4)
s_waitcnt vmcnt(2)
v_smfmac_f32_16x16x64_bf16 v[12:15], v[40:43], v[80:87], v1
ds_read_b128 v[84:87], v2 offset:7168
s_waitcnt lgkmcnt(4)
v_smfmac_f32_16x16x64_bf16 v[28:31], v[36:39], v[48:55], v1
ds_read_b128 v[80:83], v2 offset:6144
global_load_dwordx4 v[72:75], v0, s[78:79] offset:0 sc1
v_smfmac_f32_16x16x64_bf16 v[8:11], v[40:43], a[48:55], v1
ds_read_b128 v[36:39], v0 offset:4096
global_load_dwordx4 v[76:79], v0, s[78:79] offset:1024 sc1
v_smfmac_f32_16x16x64_bf16 v[12:15], v[44:47], a[64:71], v1
ds_read_b128 v[40:43], v0 offset:1024
s_waitcnt lgkmcnt(5)
v_smfmac_f32_16x16x64_bf16 v[8:11], v[44:47], a[56:63], v1
ds_read_b128 v[44:47], v0 offset:5120
s_waitcnt lgkmcnt(5)
v_smfmac_f32_16x16x64_bf16 v[8:11], v[32:35], v[56:63], v1
s_waitcnt lgkmcnt(3)
ds_read_b128 v[60:63], v2 offset:9216
v_smfmac_f32_16x16x64_bf16 v[12:15], v[32:35], a[72:79], v1
s_waitcnt lgkmcnt(3)
ds_read_b128 v[56:59], v2 offset:8192
v_smfmac_f32_16x16x64_bf16 v[12:15], v[36:39], v[80:87], v1
ds_read_b128 v[32:35], v0 offset:8192
v_smfmac_f32_16x16x64_bf16 v[8:11], v[36:39], a[80:87], v1
s_waitcnt lgkmcnt(4)
ds_read_b128 v[80:83], v2 offset:10240
global_load_dwordx4 v[48:51], v0, s[58:59] offset:0 nt sc1
ds_read_b128 v[84:87], v2 offset:11264
v_smfmac_f32_16x16x64_bf16 v[8:11], v[40:43], a[88:95], v1
s_add_u32 s20, s20, 524288
s_waitcnt lgkmcnt(5)
ds_read_b128 v[36:39], v0 offset:9216
v_smfmac_f32_16x16x64_bf16 v[12:15], v[40:43], a[96:103], v1
s_waitcnt lgkmcnt(4)
ds_read_b128 v[40:43], v0 offset:3072
v_smfmac_f32_16x16x64_bf16 v[8:11], v[44:47], v[56:63], v1
global_load_dwordx4 v[52:55], v0, s[58:59] offset:1024 nt sc1
ds_read_b128 v[60:63], v2 offset:13312
v_smfmac_f32_16x16x64_bf16 v[12:15], v[44:47], a[104:111], v1
s_waitcnt lgkmcnt(4)
ds_read_b128 v[56:59], v2 offset:12288
s_waitcnt lgkmcnt(4)
v_smfmac_f32_16x16x64_bf16 v[12:15], v[32:35], v[80:87], v1
s_waitcnt vmcnt(4)
ds_read_b128 v[80:83], v2 offset:14336
s_mov_b64 vcc, s[42:43]
v_smfmac_f32_16x16x64_bf16 v[8:11], v[32:35], a[112:119], v1
s_waitcnt lgkmcnt(4)
ds_read_b128 v[84:87], v2 offset:15360
v_smfmac_f32_16x16x64_bf16 v[8:11], v[36:39], v[64:71], v1
s_nop 0
ds_read_b128 v[32:35], v0 offset:7168
global_load_dwordx4 v[64:67], v0, s[78:79] offset:2048 sc1
v_smfmac_f32_16x16x64_bf16 v[12:15], v[36:39], a[120:127], v1
s_nop 0
ds_read_b128 v[36:39], v0 offset:0
s_waitcnt lgkmcnt(4)
s_nop 0
v_add_f32 v8, v8, v10
v_smfmac_f32_16x16x64_bf16 v[16:19], v[40:43], v[56:63], v1
ds_read_b128 v[60:63], v2 offset:17408
global_load_dwordx4 v[68:71], v0, s[78:79] offset:3072 sc1
ds_read_b128 v[56:59], v2 offset:16384
v_mul_f32 v8, s35, v8
v_smfmac_f32_16x16x64_bf16 v[20:23], v[40:43], a[128:135], v1
s_waitcnt lgkmcnt(3)
ds_read_b128 v[40:43], v0 offset:4096
v_add_f32 v12, v12, v14
v_smfmac_f32_16x16x64_bf16 v[20:23], v[32:35], v[80:87], v1
s_waitcnt lgkmcnt(3)
ds_read_b128 v[80:83], v2 offset:18432
v_add_f32 v13, v13, v15
v_smfmac_f32_16x16x64_bf16 v[16:19], v[32:35], a[136:143], v1
ds_read_b128 v[32:35], v0 offset:1024
v_add_f32 v9, v9, v11
v_smfmac_f32_16x16x64_bf16 v[20:23], v[36:39], a[152:159], v1
s_waitcnt vmcnt(4)
ds_read_b128 v[84:87], v2 offset:19456
v_mul_f32 v13, s35, v13
v_mul_f32 v12, s35, v12
v_mul_f32 v9, s35, v9
v_cvt_pk_bf16_f32 v8, v8, v9
v_cvt_pk_bf16_f32 v12, v12, v13
v_smfmac_f32_16x16x64_bf16 v[16:19], v[36:39], a[144:151], v1
s_waitcnt lgkmcnt(3)
ds_read_b128 v[36:39], v0 offset:5120
ds_write2_b32 v3, v8, v12 offset0:0 offset1:128
v_smfmac_f32_16x16x64_bf16 v[16:19], v[40:43], v[72:79], v1
global_load_dwordx4 v[72:75], v0, s[80:81] offset:-4096 sc1
v_smfmac_f32_16x16x64_bf16 v[20:23], v[40:43], v[56:63], v1
s_waitcnt lgkmcnt(3)
global_load_dwordx4 v[76:79], v0, s[80:81] offset:-3072 sc1
v_smfmac_f32_16x16x64_bf16 v[20:23], v[32:35], a[168:175], v1
ds_read_b128 v[40:43], v0 offset:8192
global_load_dwordx4 v[56:59], v0, s[58:59] offset:2048 nt sc1
global_load_dwordx4 v[60:63], v0, s[58:59] offset:3072 nt sc1
v_smfmac_f32_16x16x64_bf16 v[16:19], v[32:35], a[160:167], v1
s_waitcnt lgkmcnt(1)
ds_read_b128 v[32:35], v0 offset:9216
v_smfmac_f32_16x16x64_bf16 v[16:19], v[36:39], a[176:183], v1
s_barrier
ds_read_b64_tr_b16 v[10:11], v4 offset:2560
v_smfmac_f32_16x16x64_bf16 v[20:23], v[36:39], v[80:87], v1
s_waitcnt lgkmcnt(2)
ds_read_b128 v[36:39], v0 offset:8192
ds_read_b64_tr_b16 v[14:15], v4 offset:3584
v_smfmac_f32_16x16x64_bf16 v[20:23], v[40:43], a[192:199], v1
ds_read_b64_tr_b16 v[12:13], v4 offset:3072
s_waitcnt lgkmcnt(4)
ds_read_b64_tr_b16 v[8:9], v4 offset:2048
v_smfmac_f32_16x16x64_bf16 v[16:19], v[40:43], a[184:191], v1
s_waitcnt vmcnt(5)
ds_read_b128 v[40:43], v0 offset:9216
v_smfmac_f32_16x16x64_bf16 v[16:19], v[32:35], a[200:207], v1
v_smfmac_f32_16x16x64_bf16 v[20:23], v[32:35], a[208:215], v1
s_waitcnt lgkmcnt(3)
ds_read_b128 v[80:83], v2 offset:20480
global_load_dword v7, v7, s[4:5] sc1
ds_read_b128 v[84:87], v2 offset:21504
v_smfmac_f32_16x16x64_bf16 v[24:27], v[36:39], a[216:223], v1
s_waitcnt lgkmcnt(3)
ds_read_b128 v[32:35], v0 offset:3072
v_add_f32 v16, v16, v18
v_mfma_f32_16x16x32_bf16 v[44:47], v[48:51], v[8:11], 0
v_bfe_u32 v48, v0, 5, 1
v_add_f32 v17, v17, v19
v_mfma_f32_16x16x32_bf16 v[44:47], v[52:55], v[12:15], v[44:47]
s_nop 0
v_lshl_add_u32 v48, v48, 3, v5
v_add_f32 v20, v20, v22
v_smfmac_f32_16x16x64_bf16 v[28:31], v[36:39], a[224:231], v1
s_waitcnt lgkmcnt(3)
ds_read_b128 v[36:39], v0 offset:7168
v_cvt_pk_bf16_f32 v16, v16, v17
v_add_f32 v21, v21, v23
v_cndmask_b32_dpp v44, v46, v44, vcc quad_perm:[0,1,0,1] row_mask:0xf bank_mask:0xf
v_cvt_pk_bf16_f32 v20, v20, v21
v_smfmac_f32_16x16x64_bf16 v[24:27], v[40:43], a[232:239], v1
s_waitcnt lgkmcnt(1)
ds_write2_b32 v3, v16, v20 offset0:1 offset1:129
v_cndmask_b32_dpp v45, v47, v45, vcc quad_perm:[0,1,0,1] row_mask:0xf bank_mask:0xf
v_smfmac_f32_16x16x64_bf16 v[28:31], v[40:43], v[80:87], v1
s_add_u32 s17, s17, 1
ds_write_b64 v48, v[44:45] offset:7168
v_smfmac_f32_16x16x64_bf16 v[24:27], v[32:35], a[240:247], v1
s_add_u32 s21, s21, 10240
ds_read_b128 v[40:43], v0 offset:0
v_smfmac_f32_16x16x64_bf16 v[28:31], v[32:35], a[248:255], v1
s_waitcnt vmcnt(5)
ds_read_b128 v[32:35], v0 offset:4096
s_waitcnt lgkmcnt(4)
v_smfmac_f32_16x16x64_bf16 v[24:27], v[36:39], v[64:71], v1
ds_read_b128 v[80:83], v2 offset:22528
global_load_dwordx4 v[64:67], v0, s[76:77] offset:-4096 sc1
v_smfmac_f32_16x16x64_bf16 v[28:31], v[36:39], v[88:95], v1
s_waitcnt lgkmcnt(3)
ds_read_b128 v[36:39], v0 offset:1024
s_barrier
ds_read_b128 v[52:55], v6 offset:7168
s_waitcnt lgkmcnt(4)
v_smfmac_f32_16x16x64_bf16 v[28:31], v[40:43], v[104:111], v1
s_waitcnt lgkmcnt(3)
ds_read_b128 v[48:51], v6 offset:6144
v_smfmac_f32_16x16x64_bf16 v[24:27], v[40:43], v[96:103], v1
ds_read_b128 v[40:43], v0 offset:5120
ds_read_b64_tr_b16 v[16:17], v4 offset:2048
v_smfmac_f32_16x16x64_bf16 v[24:27], v[32:35], v[112:119], v1
ds_read_b64_tr_b16 v[18:19], v4 offset:2560
s_waitcnt lgkmcnt(5)
ds_read_b64_tr_b16 v[14:15], v4 offset:1536
v_smfmac_f32_16x16x64_bf16 v[28:31], v[32:35], v[120:127], v1
s_waitcnt vmcnt(2)
ds_read_b64_tr_b16 v[8:9], v4 offset:0
ds_read_b64_tr_b16 v[12:13], v4 offset:1024
v_smfmac_f32_16x16x64_bf16 v[28:31], v[36:39], v[136:143], v1
s_waitcnt lgkmcnt(6)
ds_read_b64_tr_b16 v[10:11], v4 offset:512
v_add_f32 v49, v49, v53
v_smfmac_f32_16x16x64_bf16 v[24:27], v[36:39], v[128:135], v1
s_waitcnt lgkmcnt(6)
ds_read_b64_tr_b16 v[20:21], v4 offset:3072
v_add_f32 v50, v50, v54
v_smfmac_f32_16x16x64_bf16 v[28:31], v[40:43], v[144:151], v1
ds_read_b64_tr_b16 v[22:23], v4 offset:3584
v_add_f32 v51, v51, v55
v_exp_f32 v51, v51
v_exp_f32 v49, v49
v_smfmac_f32_16x16x64_bf16 v[24:27], v[40:43], v[72:79], v1
s_waitcnt lgkmcnt(2)
ds_read_b128 v[84:87], v2 offset:23552
v_add_f32 v48, v48, v52
v_exp_f32 v48, v48
v_exp_f32 v50, v50
v_mfma_f32_16x16x32_bf16 v[44:47], v[8:11], v[8:11], 0
s_waitcnt lgkmcnt(1)
v_cvt_pk_bf16_f32 v55, v50, v51
v_cvt_pk_bf16_f32 v54, v48, v49
v_mfma_f32_16x16x32_bf16 v[44:47], v[12:15], v[12:15], v[44:47]
v_mov_b32_dpp v51, v55 quad_perm:[2,3,2,3] row_mask:0xf bank_mask:0xf
v_mov_b32_dpp v50, v54 quad_perm:[2,3,2,3] row_mask:0xf bank_mask:0xf
v_mfma_f32_16x16x32_bf16 v[44:47], v[16:19], v[16:19], v[44:47]
v_mov_b32_dpp v49, v55 quad_perm:[0,1,0,1] row_mask:0xf bank_mask:0xf
v_mov_b32_dpp v48, v54 quad_perm:[0,1,0,1] row_mask:0xf bank_mask:0xf
v_mfma_f32_16x16x32_bf16 v[44:47], v[20:23], v[20:23], v[44:47]
v_mov_b64 v[20:21], s[44:45]
v_cvt_pk_bf16_f32 v24, v24, v25
v_mfma_f32_16x16x32_bf16 v[8:11], v[56:59], v[48:51], 0
s_add_u32 s34, s17, 2
v_mov_b64 v[22:23], s[44:45]
v_cvt_pk_bf16_f32 v25, v26, v27
v_mfma_f32_16x16x32_bf16 v[12:15], v[60:63], v[48:51], 0
s_nop 0
v_exp_f32_dpp v44, v46 quad_perm:[0,1,0,1] row_mask:0xf bank_mask:0xf
v_exp_f32_dpp v45, v47 quad_perm:[0,1,0,1] row_mask:0xf bank_mask:0xf
v_mfma_f32_16x16x32_bf16 v[16:19], v[20:23], v[48:51], 0
s_waitcnt lgkmcnt(0)
v_cvt_pk_bf16_f32 v52, v44, v45
v_cvt_pk_bf16_f32 v53, v44, v45
v_mov_b64 v[54:55], s[46:47]
v_cvt_pk_bf16_f32 v27, v30, v31
v_mfma_f32_16x16x16_bf16 v[8:11], v[24:25], v[52:53], v[8:11]
s_mov_b32 s19, 1
global_load_dwordx4 v[68:71], v0, s[76:77] offset:-3072 sc1
v_cvt_pk_bf16_f32 v26, v28, v29
v_mfma_f32_16x16x16_bf16 v[16:19], v[54:55], v[52:53], v[16:19]
s_min_u32 s34, s34, s32
v_mov_b64 v[38:39], 0
v_mov_b64 v[36:37], 0
v_mfma_f32_16x16x16_bf16 v[12:15], v[26:27], v[52:53], v[12:15]
s_nop 0
ds_read_b128 v[28:31], v0 offset:44032
v_bfe_u32 v32, v0, 5, 1
v_mov_b64 v[34:35], 0
v_rcp_f32 v18, v16
v_subrev_u32 v17, s37, v16
v_cmp_lt_u32 vcc, s38, v17
v_lshl_add_u32 v32, v32, 3, v5
v_cndmask_b32 v9, v13, v9, s[42:43]
v_cndmask_b32 v8, v12, v8, s[42:43]
v_cndmask_b32 v10, v14, v10, s[42:43]
v_mul_f32 v10, v10, v18
v_mul_f32 v9, v9, v18
v_mul_f32 v8, v8, v18
v_cndmask_b32 v11, v15, v11, s[42:43]
v_mul_f32 v11, v11, v18
v_cvt_pk_bf16_f32 v13, v10, v11
v_cvt_pk_bf16_f32 v12, v8, v9
s_cbranch_vccnz rare_10102
back_10103:
ds_read_b128 v[16:19], v0 offset:40960
ds_write_b64 v32, v[12:13] offset:1024
v_mov_b64 v[42:43], 0
v_mov_b64 v[32:33], 0
v_mov_b32_dpp v10, v12 quad_perm:[2,3,2,3] row_mask:0xf bank_mask:0xf
v_mov_b64 v[54:55], 0
v_mov_b32_dpp v8, v12 quad_perm:[0,1,0,1] row_mask:0xf bank_mask:0xf
v_mov_b32_dpp v11, v13 quad_perm:[2,3,2,3] row_mask:0xf bank_mask:0xf
v_mov_b32_dpp v9, v13 quad_perm:[0,1,0,1] row_mask:0xf bank_mask:0xf
v_mov_b64 v[52:53], 0
v_mov_b64 v[40:41], 0
v_smfmac_f32_16x16x64_bf16 v[36:39], v[8:11], v[80:87], v1
ds_read_b128 v[24:27], v0 offset:43008
global_load_dwordx4 v[72:75], v0, s[76:77] offset:-2048 sc1
ds_read_b128 v[20:23], v0 offset:41984
v_smfmac_f32_16x16x64_bf16 v[40:43], v[8:11], v[152:159], v1
s_waitcnt lgkmcnt(2)
ds_read_b128 v[80:83], v0 offset:45056
s_barrier
ds_read_b128 v[56:59], v5 offset:1536
v_smfmac_f32_16x16x64_bf16 v[32:35], v[8:11], v[176:183], v1
s_add_u32 s27, s20, 524288
ds_read_b128 v[60:63], v5 offset:0
v_mov_b64 v[48:49], 0
v_mov_b64 v[50:51], 0
v_smfmac_f32_16x16x64_bf16 v[52:55], v[8:11], v[168:175], v1
s_add_u32 s58, s4, s20
ds_read_b128 v[12:15], v5 offset:512
v_lshrrev_b32 v44, 8, v0
v_smfmac_f32_16x16x64_bf16 v[48:51], v[8:11], v[160:167], v1
s_waitcnt lgkmcnt(4)
ds_read_b128 v[84:87], v0 offset:46080
global_load_dwordx4 v[76:79], v0, s[76:77] offset:-1024 sc1
v_bfe_u32 v45, v0, 1, 7
s_waitcnt lgkmcnt(3)
v_smfmac_f32_16x16x64_bf16 v[36:39], v[56:59], v[16:23], v1
s_addc_u32 s59, s5, 0
ds_read_b128 v[16:19], v0 offset:47104
s_waitcnt lgkmcnt(3)
v_smfmac_f32_16x16x64_bf16 v[36:39], v[60:63], v[24:31], v1
ds_read_b128 v[28:31], v0 offset:50176
s_waitcnt lgkmcnt(3)
v_smfmac_f32_16x16x64_bf16 v[36:39], v[12:15], v[184:191], v1
ds_read_b128 v[20:23], v0 offset:48128
s_waitcnt lgkmcnt(3)
v_smfmac_f32_16x16x64_bf16 v[40:43], v[56:59], v[80:87], v1
ds_read_b128 v[24:27], v0 offset:49152
v_lshl_or_b32 v44, v44, 12, v45
v_smfmac_f32_16x16x64_bf16 v[40:43], v[60:63], v[192:199], v1
s_nop 0
ds_read_b128 v[84:87], v0 offset:52224
v_cvt_pk_bf16_f32 v36, v36, v37
v_and_or_b32 v36, v36, -2, s18
v_cvt_pk_bf16_f32 v37, v38, v39
v_smfmac_f32_16x16x64_bf16 v[40:43], v[12:15], v[200:207], v1
global_store_dwordx2 v44, v[36:37], s[48:49]
s_waitcnt lgkmcnt(2)
v_smfmac_f32_16x16x64_bf16 v[48:51], v[56:59], v[16:23], v1
ds_read_b128 v[80:83], v0 offset:51200
s_waitcnt lgkmcnt(2)
v_smfmac_f32_16x16x64_bf16 v[48:51], v[60:63], v[24:31], v1
s_mov_b32 s30, 0
s_nop 0
v_cvt_pk_bf16_f32 v40, v40, v41
v_cvt_pk_bf16_f32 v41, v42, v43
v_and_or_b32 v40, v40, -2, s18
v_smfmac_f32_16x16x64_bf16 v[48:51], v[12:15], v[208:215], v1
global_store_dwordx2 v44, v[40:41], s[50:51]
s_waitcnt lgkmcnt(1)
v_smfmac_f32_16x16x64_bf16 v[32:35], v[56:59], v[232:239], v1
s_nop 0
s_waitcnt lgkmcnt(0)
v_smfmac_f32_16x16x64_bf16 v[52:55], v[56:59], v[80:87], v1
s_nop 1
v_cvt_pk_bf16_f32 v48, v48, v49
v_smfmac_f32_16x16x64_bf16 v[52:55], v[60:63], v[216:223], v1
v_and_or_b32 v48, v48, -2, s18
v_cvt_pk_bf16_f32 v49, v50, v51
v_smfmac_f32_16x16x64_bf16 v[52:55], v[12:15], v[224:231], v1
global_store_dwordx2 v44, v[48:49], s[52:53]
v_smfmac_f32_16x16x64_bf16 v[32:35], v[60:63], v[240:247], v1
s_nop 2
v_smfmac_f32_16x16x64_bf16 v[32:35], v[12:15], v[248:255], v1
s_nop 1
v_cvt_pk_bf16_f32 v52, v52, v53
v_and_or_b32 v52, v52, -2, s18
v_cvt_pk_bf16_f32 v53, v54, v55
s_nop 0
global_store_dwordx2 v44, v[52:53], s[54:55]
s_nop 0
v_cvt_pk_bf16_f32 v32, v32, v33
v_cvt_pk_bf16_f32 v33, v34, v35
v_and_or_b32 v32, v32, -2, s18
global_store_dwordx2 v44, v[32:33], s[56:57]
s_cmp_ge_u32 s14, 16
s_cbranch_scc1 nored_10109
v_bfe_u32 v32, v0, 6, 1
v_lshlrev_b32 v32, 4, v32
v_mov_b32 v33, 0x3f80
v_lshlrev_b32 v32, v32, v33
v_bfe_i32 v33, v0, 4, 1
v_and_b32 v45, v32, v33
v_and_b32 v47, v32, v33
v_xor_b32 v44, v32, v45
v_xor_b32 v46, v32, v45
v_and_b32 v36, 32, v0
v_bfe_u32 v37, v0, 6, 1
v_lshl_add_u32 v36, v37, 8, v36
v_bfe_u32 v37, v0, 8, 1
v_lshl_add_u32 v36, v37, 4, v36
v_bfe_u32 v37, v0, 4, 1
v_lshl_add_u32 v36, v37, 3, v36
s_waitcnt vmcnt(9)
v_and_b32 v7, 511, v0
v_lshl_add_u32 v7, v7, 3, s27
s_nop 15
s_nop 15
s_nop 15
s_nop 15
s_nop 12
global_load_dwordx4 v[8:11], v0, s[64:65] offset:0 sc1
global_load_dwordx4 v[12:15], v0, s[64:65] offset:1024 sc1
global_load_dwordx4 v[16:19], v0, s[64:65] offset:2048 sc1
global_load_dwordx4 v[20:23], v0, s[64:65] offset:3072 sc1
s_nop 15
s_nop 15
s_nop 5
global_load_dwordx4 v[24:27], v0, s[64:65] offset:0 sc1
global_load_dwordx4 v[28:31], v0, s[64:65] offset:1024 sc1
global_load_dwordx4 v[80:83], v0, s[64:65] offset:2048 sc1
global_load_dwordx4 v[84:87], v0, s[64:65] offset:3072 sc1
chk_10111:
v_mov_b64 v[40:41], 0
v_mov_b64 v[42:43], 0
s_waitcnt vmcnt(6)
s_nop 0
v_smfmac_f32_16x16x64_bf16 v[40:43], v[44:47], v[8:15], v1
v_bitop3_b32 v32, v8, v10, s18 bitop3:0x7e
v_bitop3_b32 v33, v12, v14, s18 bitop3:0x7e
s_waitcnt vmcnt(4)
v_smfmac_f32_16x16x64_bf16 v[40:43], v[44:47], v[16:23], v1
v_bitop3_b32 v34, v16, v18, s18 bitop3:0x7e
v_bitop3_b32 v35, v20, v22, s18 bitop3:0x7e
v_or3_b32 v32, v32, v33, v34
v_bitop3_b32 v32, v32, v35, 1 bitop3:0xa8
v_cmp_ne_u32 vcc, 0, v32
s_cbranch_vccnz chk_10111_f
s_nop 1
v_add_f32_dpp v40, v40, v40 row_ror:8 row_mask:0xf bank_mask:0xf
v_add_f32_dpp v41, v41, v41 row_ror:8 row_mask:0xf bank_mask:0xf
v_add_f32_dpp v42, v42, v42 row_ror:8 row_mask:0xf bank_mask:0xf
v_add_f32_dpp v43, v43, v43 row_ror:8 row_mask:0xf bank_mask:0xf
v_cvt_pk_bf16_f32 v40, v40, v41
v_cvt_pk_bf16_f32 v41, v42, v43
v_and_or_b32 v40, v40, -2, s18
s_mov_b64 exec, 0x00ff00ff
global_store_dwordx2 v36, v[40:41], s[66:67]
s_mov_b64 exec, -1
s_branch join_10110
chk_10111_f:
global_load_dwordx4 v[8:11], v0, s[64:65] offset:0 sc1
global_load_dwordx4 v[12:15], v0, s[64:65] offset:1024 sc1
global_load_dwordx4 v[16:19], v0, s[64:65] offset:2048 sc1
global_load_dwordx4 v[20:23], v0, s[64:65] offset:3072 sc1
chk_10112:
v_mov_b64 v[40:41], 0
v_mov_b64 v[42:43], 0
s_waitcnt vmcnt(6)
s_nop 0
v_smfmac_f32_16x16x64_bf16 v[40:43], v[44:47], v[24:31], v1
v_bitop3_b32 v32, v24, v26, s18 bitop3:0x7e
v_bitop3_b32 v33, v28, v30, s18 bitop3:0x7e
s_waitcnt vmcnt(4)
v_smfmac_f32_16x16x64_bf16 v[40:43], v[44:47], v[80:87], v1
v_bitop3_b32 v34, v80, v82, s18 bitop3:0x7e
v_bitop3_b32 v35, v84, v86, s18 bitop3:0x7e
v_or3_b32 v32, v32, v33, v34
v_bitop3_b32 v32, v32, v35, 1 bitop3:0xa8
v_cmp_ne_u32 vcc, 0, v32
s_cbranch_vccnz chk_10112_f
s_nop 1
v_add_f32_dpp v40, v40, v40 row_ror:8 row_mask:0xf bank_mask:0xf
v_add_f32_dpp v41, v41, v41 row_ror:8 row_mask:0xf bank_mask:0xf
v_add_f32_dpp v42, v42, v42 row_ror:8 row_mask:0xf bank_mask:0xf
v_add_f32_dpp v43, v43, v43 row_ror:8 row_mask:0xf bank_mask:0xf
v_cvt_pk_bf16_f32 v40, v40, v41
v_cvt_pk_bf16_f32 v41, v42, v43
v_and_or_b32 v40, v40, -2, s18
s_mov_b64 exec, 0x00ff00ff
global_store_dwordx2 v36, v[40:41], s[66:67]
s_mov_b64 exec, -1
s_branch join_10110
chk_10112_f:
global_load_dwordx4 v[24:27], v0, s[64:65] offset:0 sc1
global_load_dwordx4 v[28:31], v0, s[64:65] offset:1024 sc1
global_load_dwordx4 v[80:83], v0, s[64:65] offset:2048 sc1
global_load_dwordx4 v[84:87], v0, s[64:65] offset:3072 sc1
s_add_u32 s30, s30, 1
s_cmp_le_u32 s30, 262144
s_cbranch_scc1 chk_10111
s_branch L_fail
nored_10109:
s_waitcnt vmcnt(9)
v_and_b32 v7, 511, v0
v_lshl_add_u32 v7, v7, 3, s27
join_10110:
s_barrier
global_load_dwordx4 v[56:59], v0, s[76:77] offset:0 sc1
global_load_dwordx4 v[60:63], v0, s[76:77] offset:1024 sc1
global_load_dwordx4 v[48:51], v0, s[76:77] offset:2048 sc1
global_load_dwordx4 v[52:55], v0, s[76:77] offset:3072 sc1
s_nop 15
s_nop 15
s_nop 3
s_barrier
global_load_dwordx4 v[32:35], v0, s[68:69] offset:-4096 sc1
s_nop 10
global_load_dwordx4 v[36:39], v0, s[68:69] offset:0 sc1
s_barrier
global_load_dwordx4 v[80:83], v0, s[78:79] offset:-4096 sc1
global_load_dwordx4 v[84:87], v0, s[78:79] offset:-3072 sc1
s_waitcnt vmcnt(12)
v_mov_b64 v[8:9], 0
v_mov_b64 v[10:11], 0
s_waitcnt vmcnt(11)
v_mov_b64 v[12:13], 0
v_mov_b64 v[14:15], 0
s_waitcnt vmcnt(10)
v_mov_b64 v[16:17], 0
v_mov_b64 v[18:19], 0
s_waitcnt vmcnt(9)
v_mov_b64 v[20:21], 0
v_mov_b64 v[22:23], 0
v_mov_b64 v[24:25], 0
v_mov_b64 v[26:27], 0
v_mov_b64 v[28:29], 0
v_mov_b64 v[30:31], 0
s_mov_b32 s30, 0
s_cmp_eq_u32 s17, s31
s_cbranch_scc0 gather_10101
s_branch exit_10104
rt_10106:
global_load_dwordx4 v[32:35], v0, s[68:69] offset:-4096 sc1
global_load_dwordx4 v[36:39], v0, s[68:69] offset:0 sc1
s_add_u32 s30, s30, 1
s_cmp_gt_u32 s30, 262144
s_cbranch_scc1 L_fail
s_mov_b64 exec, 1
global_store_dword v0, v0, s[62:63]
global_store_dword v0, v0, s[62:63]
s_mov_b64 exec, -1
v_mov_b64 v[8:9], 0
v_mov_b64 v[10:11], 0
v_mov_b64 v[12:13], 0
v_mov_b64 v[14:15], 0
v_mov_b64 v[16:17], 0
v_mov_b64 v[18:19], 0
v_mov_b64 v[20:21], 0
v_mov_b64 v[22:23], 0
v_mov_b64 v[24:25], 0
v_mov_b64 v[26:27], 0
v_mov_b64 v[28:29], 0
v_mov_b64 v[30:31], 0
s_branch gather_10101
rare_10102:
ds_read_b128 v[48:51], v6 offset:6144
ds_read_b128 v[52:55], v6 offset:7168
s_waitcnt lgkmcnt(0)
v_add_f32 v48, v48, v52
v_add_f32 v49, v49, v53
v_add_f32 v50, v50, v54
v_add_f32 v51, v51, v55
v_mov_b32_dpp v46, v46 quad_perm:[0,1,0,1] row_mask:0xf bank_mask:0xf
v_mov_b32_dpp v47, v47 quad_perm:[0,1,0,1] row_mask:0xf bank_mask:0xf
v_max3_f32 v19, v48, v49, v50
v_max3_f32 v19, v19, v51, v46
v_max_f32 v19, v19, v47
s_nop 1
v_max_f32_dpp v19, v19, v19 quad_perm:[2,3,0,1] row_mask:0xf bank_mask:0xf
v_mov_b32 v44, v19
s_nop 1
v_permlane32_swap_b32 v19, v44
v_max_f32 v19, v19, v44
v_mov_b32 v44, v19
s_nop 1
v_permlane16_swap_b32 v19, v44
v_max_f32 v19, v19, v44
v_sub_f32 v48, v48, v19
v_sub_f32 v49, v49, v19
v_sub_f32 v50, v50, v19
v_sub_f32 v51, v51, v19
v_sub_f32 v46, v46, v19
v_sub_f32 v47, v47, v19
v_exp_f32 v48, v48
v_exp_f32 v49, v49
v_exp_f32 v50, v50
v_exp_f32 v51, v51
v_cvt_pk_bf16_f32 v54, v48, v49
v_cvt_pk_bf16_f32 v55, v50, v51
s_nop 0
v_mov_b32_dpp v48, v54 quad_perm:[0,1,0,1] row_mask:0xf bank_mask:0xf
v_mov_b32_dpp v49, v55 quad_perm:[0,1,0,1] row_mask:0xf bank_mask:0xf
v_mov_b32_dpp v50, v54 quad_perm:[2,3,2,3] row_mask:0xf bank_mask:0xf
v_mov_b32_dpp v51, v55 quad_perm:[2,3,2,3] row_mask:0xf bank_mask:0xf
v_mov_b64 v[20:21], s[44:45]
v_mov_b64 v[22:23], s[44:45]
v_mfma_f32_16x16x32_bf16 v[8:11], v[56:59], v[48:51], 0
v_mfma_f32_16x16x32_bf16 v[12:15], v[60:63], v[48:51], 0
v_mfma_f32_16x16x32_bf16 v[16:19], v[20:23], v[48:51], 0
v_mov_b64 v[54:55], s[46:47]
v_exp_f32_dpp v44, v46 quad_perm:[0,1,0,1] row_mask:0xf bank_mask:0xf
v_exp_f32_dpp v45, v47 quad_perm:[0,1,0,1] row_mask:0xf bank_mask:0xf
s_nop 0
v_cvt_pk_bf16_f32 v52, v44, v45
v_cvt_pk_bf16_f32 v53, v44, v45
s_nop 1
v_mfma_f32_16x16x16_bf16 v[16:19], v[54:55], v[52:53], v[16:19]
v_mfma_f32_16x16x16_bf16 v[8:11], v[24:25], v[52:53], v[8:11]
v_mfma_f32_16x16x16_bf16 v[12:15], v[26:27], v[52:53], v[12:15]
s_nop 5
v_rcp_f32 v18, v16
s_nop 0
v_cndmask_b32 v8, v12, v8, s[42:43]
v_mul_f32 v8, v8, v18
v_cndmask_b32 v9, v13, v9, s[42:43]
v_mul_f32 v9, v9, v18
v_cndmask_b32 v10, v14, v10, s[42:43]
v_mul_f32 v10, v10, v18
v_cndmask_b32 v11, v15, v11, s[42:43]
v_mul_f32 v11, v11, v18
v_cvt_pk_bf16_f32 v12, v8, v9
v_cvt_pk_bf16_f32 v13, v10, v11
s_branch back_10103
exit_10104:
global_load_dwordx4 v[32:35], v0, s[68:69] offset:-4096 sc1
global_load_dwordx4 v[36:39], v0, s[68:69] offset:0 sc1
s_add_u32 s30, s30, 1
s_cmp_gt_u32 s30, 262144
s_cbranch_scc1 L_fail
s_waitcnt vmcnt(1)
v_bitop3_b32 v44, v32, v34, s18 bitop3:0x7e
s_waitcnt vmcnt(0)
v_bitop3_b32 v45, v36, v38, s18 bitop3:0x7e
v_bitop3_b32 v44, v44, v45, s19 bitop3:0xa8
v_cmp_ne_u32 vcc, 0, v44
s_cbranch_vccnz exit_10104
ds_write_b128 v0, v[32:35] offset:2048
ds_write_b128 v0, v[36:39] offset:6144
s_waitcnt lgkmcnt(0)
s_barrier
s_barrier
s_add_u32 s36, s36, 1
s_cmp_lt_u32 s36, 2
s_cbranch_scc1 layer_10100
s_endpgm
wave_10071:
layer_10113:
s_lshl_b32 s17, s36, 6
s_mul_i32 s27, s36, 35651584
s_mul_i32 s28, s14, 16384
s_add_u32 s27, s27, s28
s_add_u32 s20, s27, 16789504
s_mul_i32 s27, s17, 10240
s_add_u32 s27, s27, s24
s_add_u32 s21, s27, s25
s_mov_b32 s19, 0
s_mov_b32 s33, s6
s_add_u32 s34, s17, 1
s_add_u32 s31, s17, 63
s_add_u32 s32, s17, 64
s_mov_b32 s27, s20
v_mov_b32 v7, 0
s_add_u32 s68, s4, 416768
s_addc_u32 s69, s5, 0
s_add_u32 s72, s4, 400384
s_addc_u32 s73, s5, 0
s_add_u32 s70, s4, 420864
s_addc_u32 s71, s5, 0
s_add_u32 s74, s4, 404480
s_addc_u32 s75, s5, 0
s_add_u32 s58, s4, s20
s_addc_u32 s59, s5, 0
global_load_dwordx4 v[64:67], v0, s[76:77] offset:-4096 sc1
global_load_dwordx4 v[68:71], v0, s[76:77] offset:-3072 sc1
global_load_dwordx4 v[72:75], v0, s[76:77] offset:-2048 sc1
global_load_dwordx4 v[76:79], v0, s[76:77] offset:-1024 sc1
global_load_dwordx4 v[80:83], v0, s[78:79] offset:-4096 sc1
global_load_dwordx4 v[84:87], v0, s[78:79] offset:-3072 sc1
global_load_dwordx4 v[48:51], v0, s[76:77] offset:2048 sc1
global_load_dwordx4 v[52:55], v0, s[76:77] offset:3072 sc1
global_load_dwordx4 v[56:59], v0, s[76:77] offset:0 sc1
global_load_dwordx4 v[60:63], v0, s[76:77] offset:1024 sc1
v_mov_b64 v[8:9], 0
v_mov_b64 v[10:11], 0
v_mov_b64 v[12:13], 0
v_mov_b64 v[14:15], 0
v_mov_b64 v[16:17], 0
v_mov_b64 v[18:19], 0
v_mov_b64 v[20:21], 0
v_mov_b64 v[22:23], 0
v_mov_b64 v[24:25], 0
v_mov_b64 v[26:27], 0
v_mov_b64 v[28:29], 0
v_mov_b64 v[30:31], 0
s_barrier
v_and_b32 v7, 128, v0
v_add_u32 v7, s22, v7
s_mov_b32 exec_hi, 0
v_and_b32 v7, 511, v0
v_lshl_add_u32 v7, v7, 3, s27
s_mov_b32 exec_hi, -1
global_load_dwordx4 v[32:35], v0, s[68:69] offset:-4096 sc1
global_load_dwordx4 v[36:39], v0, s[68:69] offset:0 sc1
s_mov_b32 s30, 0
s_waitcnt vmcnt(0)
.p2align 6
gather_10114:
s_waitcnt vmcnt(3)
rt_10119_b:
v_smfmac_f32_16x16x64_bf16 v[12:15], v[32:35], v[72:79], v1
ds_write_b128 v0, v[32:35] offset:3072
v_smfmac_f32_16x16x64_bf16 v[8:11], v[32:35], v[64:71], v1
v_bitop3_b32 v44, v32, v34, s18 bitop3:0x7e
v_smfmac_f32_16x16x64_bf16 v[20:23], v[32:35], v[48:55], v1
s_waitcnt vmcnt(2)
ds_write_b128 v0, v[36:39] offset:7168
v_bitop3_b32 v45, v36, v38, s18 bitop3:0x7e
v_smfmac_f32_16x16x64_bf16 v[16:19], v[32:35], v[56:63], v1
v_bitop3_b32 v44, v44, v45, s19 bitop3:0xa8
v_cmp_ne_u32 vcc, 0, v44
v_smfmac_f32_16x16x64_bf16 v[28:31], v[32:35], a[8:15], v1
s_cbranch_vccnz rt_10119
ds_read_b128 v[52:55], v2 offset:3072
v_smfmac_f32_16x16x64_bf16 v[8:11], v[36:39], a[16:23], v1
s_waitcnt lgkmcnt(1)
ds_read_b128 v[60:63], v2 offset:1024
global_load_dwordx4 v[64:67], v0, s[78:79] offset:-2048 sc1
ds_read_b128 v[56:59], v2 offset:0
v_smfmac_f32_16x16x64_bf16 v[24:27], v[32:35], a[0:7], v1
ds_read_b128 v[48:51], v2 offset:2048
s_barrier
ds_read_b128 v[40:43], v0 offset:2048
v_smfmac_f32_16x16x64_bf16 v[20:23], v[36:39], a[40:47], v1
s_mov_b64 s[68:69], s[72:73]
ds_read_b128 v[44:47], v0 offset:6144
global_load_dwordx4 v[68:71], v0, s[78:79] offset:-1024 sc1
v_smfmac_f32_16x16x64_bf16 v[16:19], v[36:39], a[32:39], v1
s_xor_b32 s18, s18, 1
ds_read_b128 v[32:35], v0 offset:1024
s_waitcnt lgkmcnt(4)
v_smfmac_f32_16x16x64_bf16 v[24:27], v[36:39], v[56:63], v1
ds_read_b128 v[56:59], v2 offset:4096
v_smfmac_f32_16x16x64_bf16 v[12:15], v[36:39], a[24:31], v1
ds_read_b128 v[60:63], v2 offset:5120
s_waitcnt lgkmcnt(4)
s_waitcnt vmcnt(2)
v_smfmac_f32_16x16x64_bf16 v[12:15], v[40:43], v[80:87], v1
ds_read_b128 v[84:87], v2 offset:7168
s_waitcnt lgkmcnt(4)
v_smfmac_f32_16x16x64_bf16 v[28:31], v[36:39], v[48:55], v1
ds_read_b128 v[80:83], v2 offset:6144
global_load_dwordx4 v[72:75], v0, s[78:79] offset:0 sc1
v_smfmac_f32_16x16x64_bf16 v[8:11], v[40:43], a[48:55], v1
ds_read_b128 v[36:39], v0 offset:5120
global_load_dwordx4 v[76:79], v0, s[78:79] offset:1024 sc1
v_smfmac_f32_16x16x64_bf16 v[12:15], v[44:47], a[64:71], v1
ds_read_b128 v[40:43], v0 offset:0
s_waitcnt lgkmcnt(5)
v_smfmac_f32_16x16x64_bf16 v[8:11], v[44:47], a[56:63], v1
ds_read_b128 v[44:47], v0 offset:4096
s_waitcnt lgkmcnt(5)
v_smfmac_f32_16x16x64_bf16 v[8:11], v[32:35], v[56:63], v1
s_waitcnt lgkmcnt(3)
ds_read_b128 v[60:63], v2 offset:9216
v_smfmac_f32_16x16x64_bf16 v[12:15], v[32:35], a[72:79], v1
s_waitcnt lgkmcnt(3)
ds_read_b128 v[56:59], v2 offset:8192
v_smfmac_f32_16x16x64_bf16 v[12:15], v[36:39], v[80:87], v1
ds_read_b128 v[32:35], v0 offset:9216
v_smfmac_f32_16x16x64_bf16 v[8:11], v[36:39], a[80:87], v1
s_waitcnt lgkmcnt(4)
ds_read_b128 v[80:83], v2 offset:10240
global_load_dwordx4 v[48:51], v0, s[58:59] offset:0 nt sc1
ds_read_b128 v[84:87], v2 offset:11264
v_smfmac_f32_16x16x64_bf16 v[8:11], v[40:43], a[88:95], v1
s_add_u32 s20, s20, 524288
s_waitcnt lgkmcnt(5)
ds_read_b128 v[36:39], v0 offset:8192
v_smfmac_f32_16x16x64_bf16 v[12:15], v[40:43], a[96:103], v1
s_waitcnt lgkmcnt(4)
ds_read_b128 v[40:43], v0 offset:2048
v_smfmac_f32_16x16x64_bf16 v[8:11], v[44:47], v[56:63], v1
global_load_dwordx4 v[52:55], v0, s[58:59] offset:1024 nt sc1
ds_read_b128 v[60:63], v2 offset:13312
v_smfmac_f32_16x16x64_bf16 v[12:15], v[44:47], a[104:111], v1
s_waitcnt lgkmcnt(4)
ds_read_b128 v[56:59], v2 offset:12288
s_waitcnt lgkmcnt(4)
v_smfmac_f32_16x16x64_bf16 v[12:15], v[32:35], v[80:87], v1
s_waitcnt vmcnt(4)
ds_read_b128 v[80:83], v2 offset:14336
s_mov_b64 vcc, s[42:43]
v_smfmac_f32_16x16x64_bf16 v[8:11], v[32:35], a[112:119], v1
s_waitcnt lgkmcnt(4)
ds_read_b128 v[84:87], v2 offset:15360
v_add_u32 v44, s24, v0
v_smfmac_f32_16x16x64_bf16 v[8:11], v[36:39], v[64:71], v1
s_nop 0
ds_read_b128 v[32:35], v0 offset:6144
global_load_dwordx4 v[64:67], v0, s[78:79] offset:2048 sc1
v_smfmac_f32_16x16x64_bf16 v[12:15], v[36:39], a[120:127], v1
s_nop 0
ds_read_b128 v[36:39], v0 offset:1024
s_waitcnt lgkmcnt(4)
ds_read_b128 v[44:47], v44
v_add_f32 v8, v8, v10
v_smfmac_f32_16x16x64_bf16 v[16:19], v[40:43], v[56:63], v1
ds_read_b128 v[60:63], v2 offset:17408
global_load_dwordx4 v[68:71], v0, s[78:79] offset:3072 sc1
ds_read_b128 v[56:59], v2 offset:16384
v_mul_f32 v8, s35, v8
v_smfmac_f32_16x16x64_bf16 v[20:23], v[40:43], a[128:135], v1
s_waitcnt lgkmcnt(4)
ds_read_b128 v[40:43], v0 offset:5120
v_add_f32 v12, v12, v14
v_smfmac_f32_16x16x64_bf16 v[20:23], v[32:35], v[80:87], v1
s_waitcnt lgkmcnt(4)
ds_read_b128 v[80:83], v2 offset:18432
v_add_f32 v13, v13, v15
v_smfmac_f32_16x16x64_bf16 v[16:19], v[32:35], a[136:143], v1
ds_read_b128 v[32:35], v0 offset:0
v_add_f32 v9, v9, v11
v_smfmac_f32_16x16x64_bf16 v[20:23], v[36:39], a[152:159], v1
s_waitcnt vmcnt(4)
ds_read_b128 v[84:87], v2 offset:19456
v_mul_f32 v13, s35, v13
v_mul_f32 v12, s35, v12
v_mul_f32 v9, s35, v9
v_cvt_pk_bf16_f32 v8, v8, v9
v_cvt_pk_bf16_f32 v12, v12, v13
v_smfmac_f32_16x16x64_bf16 v[16:19], v[36:39], a[144:151], v1
s_waitcnt lgkmcnt(3)
ds_read_b128 v[36:39], v0 offset:4096
ds_write2_b32 v3, v8, v12 offset0:0 offset1:128
v_smfmac_f32_16x16x64_bf16 v[16:19], v[40:43], v[72:79], v1
global_load_dwordx4 v[72:75], v0, s[80:81] offset:-4096 sc1
v_smfmac_f32_16x16x64_bf16 v[20:23], v[40:43], v[56:63], v1
s_waitcnt lgkmcnt(3)
global_load_dwordx4 v[76:79], v0, s[80:81] offset:-3072 sc1
v_smfmac_f32_16x16x64_bf16 v[20:23], v[32:35], a[168:175], v1
ds_read_b128 v[40:43], v0 offset:9216
global_load_dwordx4 v[56:59], v0, s[58:59] offset:2048 nt sc1
global_load_dwordx4 v[60:63], v0, s[58:59] offset:3072 nt sc1
v_smfmac_f32_16x16x64_bf16 v[16:19], v[32:35], a[160:167], v1
s_waitcnt lgkmcnt(1)
ds_read_b128 v[32:35], v0 offset:8192
v_swap_b32 v45, v46
v_smfmac_f32_16x16x64_bf16 v[16:19], v[36:39], a[176:183], v1
s_barrier
ds_read_b64_tr_b16 v[10:11], v4 offset:2560
v_smfmac_f32_16x16x64_bf16 v[20:23], v[36:39], v[80:87], v1
s_waitcnt lgkmcnt(2)
ds_read_b128 v[36:39], v0 offset:9216
ds_read_b64_tr_b16 v[14:15], v4 offset:3584
v_smfmac_f32_16x16x64_bf16 v[20:23], v[40:43], a[192:199], v1
ds_read_b64_tr_b16 v[12:13], v4 offset:3072
buffer_store_dwordx4 v[44:47], v0, s[4:7], s21 offen sc1
s_waitcnt lgkmcnt(4)
ds_read_b64_tr_b16 v[8:9], v4 offset:2048
v_smfmac_f32_16x16x64_bf16 v[16:19], v[40:43], a[184:191], v1
s_waitcnt vmcnt(6)
ds_read_b128 v[40:43], v0 offset:8192
v_mov_b32 v47, s17
v_smfmac_f32_16x16x64_bf16 v[16:19], v[32:35], a[200:207], v1
s_mov_b64 exec, 1
buffer_store_dword v47, off, s[4:7], s33 sc1
s_mov_b64 exec, -1
v_smfmac_f32_16x16x64_bf16 v[20:23], v[32:35], a[208:215], v1
s_waitcnt lgkmcnt(3)
ds_read_b128 v[80:83], v2 offset:20480
global_load_dword v7, v7, s[4:5] sc1
ds_read_b128 v[84:87], v2 offset:21504
v_smfmac_f32_16x16x64_bf16 v[24:27], v[36:39], a[216:223], v1
s_waitcnt lgkmcnt(3)
ds_read_b128 v[32:35], v0 offset:2048
v_add_f32 v16, v16, v18
v_mfma_f32_16x16x32_bf16 v[44:47], v[48:51], v[8:11], 0
v_bfe_u32 v48, v0, 5, 1
v_add_f32 v17, v17, v19
v_mfma_f32_16x16x32_bf16 v[44:47], v[52:55], v[12:15], v[44:47]
s_nop 0
v_lshl_add_u32 v48, v48, 3, v5
v_add_f32 v20, v20, v22
v_smfmac_f32_16x16x64_bf16 v[28:31], v[36:39], a[224:231], v1
s_waitcnt lgkmcnt(3)
ds_read_b128 v[36:39], v0 offset:6144
v_cvt_pk_bf16_f32 v16, v16, v17
v_add_f32 v21, v21, v23
v_cndmask_b32_dpp v44, v46, v44, vcc quad_perm:[0,1,0,1] row_mask:0xf bank_mask:0xf
v_cvt_pk_bf16_f32 v20, v20, v21
v_smfmac_f32_16x16x64_bf16 v[24:27], v[40:43], a[232:239], v1
s_waitcnt lgkmcnt(1)
ds_write2_b32 v3, v16, v20 offset0:1 offset1:129
v_cndmask_b32_dpp v45, v47, v45, vcc quad_perm:[0,1,0,1] row_mask:0xf bank_mask:0xf
v_xor_b32 v48, 128, v48
v_smfmac_f32_16x16x64_bf16 v[28:31], v[40:43], v[80:87], v1
s_add_u32 s17, s17, 1
ds_write_b64 v48, v[44:45] offset:7680
v_smfmac_f32_16x16x64_bf16 v[24:27], v[32:35], a[240:247], v1
s_add_u32 s21, s21, 10240
ds_read_b128 v[40:43], v0 offset:1024
v_smfmac_f32_16x16x64_bf16 v[28:31], v[32:35], a[248:255], v1
s_waitcnt vmcnt(7)
ds_read_b128 v[32:35], v0 offset:5120
s_waitcnt lgkmcnt(4)
v_smfmac_f32_16x16x64_bf16 v[24:27], v[36:39], v[64:71], v1
ds_read_b128 v[80:83], v2 offset:22528
global_load_dwordx4 v[64:67], v0, s[76:77] offset:-4096 sc1
v_smfmac_f32_16x16x64_bf16 v[28:31], v[36:39], v[88:95], v1
s_waitcnt lgkmcnt(3)
ds_read_b128 v[36:39], v0 offset:0
s_barrier
ds_read_b128 v[52:55], v6 offset:7168
s_waitcnt lgkmcnt(4)
v_smfmac_f32_16x16x64_bf16 v[28:31], v[40:43], v[104:111], v1
s_waitcnt lgkmcnt(3)
ds_read_b128 v[48:51], v6 offset:6144
v_smfmac_f32_16x16x64_bf16 v[24:27], v[40:43], v[96:103], v1
ds_read_b128 v[40:43], v0 offset:4096
ds_read_b64_tr_b16 v[16:17], v4 offset:2048
v_smfmac_f32_16x16x64_bf16 v[24:27], v[32:35], v[112:119], v1
ds_read_b64_tr_b16 v[18:19], v4 offset:2560
s_waitcnt lgkmcnt(5)
ds_read_b64_tr_b16 v[14:15], v4 offset:1536
v_smfmac_f32_16x16x64_bf16 v[28:31], v[32:35], v[120:127], v1
s_waitcnt vmcnt(4)
ds_read_b64_tr_b16 v[8:9], v4 offset:0
ds_read_b64_tr_b16 v[12:13], v4 offset:1024
v_smfmac_f32_16x16x64_bf16 v[28:31], v[36:39], v[136:143], v1
s_waitcnt lgkmcnt(6)
ds_read_b64_tr_b16 v[10:11], v4 offset:512
v_add_f32 v49, v49, v53
v_smfmac_f32_16x16x64_bf16 v[24:27], v[36:39], v[128:135], v1
s_waitcnt lgkmcnt(6)
ds_read_b64_tr_b16 v[20:21], v4 offset:3072
v_add_f32 v50, v50, v54
v_smfmac_f32_16x16x64_bf16 v[28:31], v[40:43], v[144:151], v1
ds_read_b64_tr_b16 v[22:23], v4 offset:3584
v_add_f32 v51, v51, v55
v_exp_f32 v51, v51
v_exp_f32 v49, v49
v_smfmac_f32_16x16x64_bf16 v[24:27], v[40:43], v[72:79], v1
s_waitcnt lgkmcnt(2)
ds_read_b128 v[84:87], v2 offset:23552
v_add_f32 v48, v48, v52
v_exp_f32 v48, v48
v_exp_f32 v50, v50
v_mfma_f32_16x16x32_bf16 v[44:47], v[8:11], v[8:11], 0
s_waitcnt lgkmcnt(1)
v_cvt_pk_bf16_f32 v55, v50, v51
v_cvt_pk_bf16_f32 v54, v48, v49
v_mfma_f32_16x16x32_bf16 v[44:47], v[12:15], v[12:15], v[44:47]
v_mov_b32_dpp v51, v55 quad_perm:[2,3,2,3] row_mask:0xf bank_mask:0xf
v_mov_b32_dpp v50, v54 quad_perm:[2,3,2,3] row_mask:0xf bank_mask:0xf
v_mfma_f32_16x16x32_bf16 v[44:47], v[16:19], v[16:19], v[44:47]
v_mov_b32_dpp v49, v55 quad_perm:[0,1,0,1] row_mask:0xf bank_mask:0xf
v_mov_b32_dpp v48, v54 quad_perm:[0,1,0,1] row_mask:0xf bank_mask:0xf
v_mfma_f32_16x16x32_bf16 v[44:47], v[20:23], v[20:23], v[44:47]
v_mov_b64 v[20:21], s[44:45]
v_cvt_pk_bf16_f32 v24, v24, v25
v_mfma_f32_16x16x32_bf16 v[8:11], v[56:59], v[48:51], 0
s_add_u32 s34, s17, 2
v_mov_b64 v[22:23], s[44:45]
v_cvt_pk_bf16_f32 v25, v26, v27
v_mfma_f32_16x16x32_bf16 v[12:15], v[60:63], v[48:51], 0
s_nop 0
v_exp_f32_dpp v44, v46 quad_perm:[0,1,0,1] row_mask:0xf bank_mask:0xf
v_exp_f32_dpp v45, v47 quad_perm:[0,1,0,1] row_mask:0xf bank_mask:0xf
v_mfma_f32_16x16x32_bf16 v[16:19], v[20:23], v[48:51], 0
s_waitcnt lgkmcnt(0)
v_cvt_pk_bf16_f32 v52, v44, v45
v_cvt_pk_bf16_f32 v53, v44, v45
v_mov_b64 v[54:55], s[46:47]
v_cvt_pk_bf16_f32 v27, v30, v31
v_mfma_f32_16x16x16_bf16 v[8:11], v[24:25], v[52:53], v[8:11]
s_mov_b32 s19, 1
global_load_dwordx4 v[68:71], v0, s[76:77] offset:-3072 sc1
v_cvt_pk_bf16_f32 v26, v28, v29
v_mfma_f32_16x16x16_bf16 v[16:19], v[54:55], v[52:53], v[16:19]
s_min_u32 s34, s34, s32
v_mov_b64 v[38:39], 0
v_mov_b64 v[36:37], 0
v_mfma_f32_16x16x16_bf16 v[12:15], v[26:27], v[52:53], v[12:15]
s_nop 0
ds_read_b128 v[28:31], v0 offset:56320
v_bfe_u32 v32, v0, 5, 1
v_mov_b64 v[34:35], 0
v_rcp_f32 v18, v16
v_subrev_u32 v17, s37, v16
v_cmp_lt_u32 vcc, s38, v17
v_lshl_add_u32 v32, v32, 3, v5
v_cndmask_b32 v9, v13, v9, s[42:43]
v_cndmask_b32 v8, v12, v8, s[42:43]
v_cndmask_b32 v10, v14, v10, s[42:43]
v_mul_f32 v10, v10, v18
v_mul_f32 v9, v9, v18
v_mul_f32 v8, v8, v18
v_cndmask_b32 v11, v15, v11, s[42:43]
v_mul_f32 v11, v11, v18
v_cvt_pk_bf16_f32 v13, v10, v11
v_cvt_pk_bf16_f32 v12, v8, v9
s_cbranch_vccnz rare_10115
back_10116:
ds_read_b128 v[16:19], v0 offset:53248
ds_write_b64 v32, v[12:13] offset:1536
v_mov_b64 v[42:43], 0
v_mov_b64 v[32:33], 0
v_mov_b32_dpp v10, v12 quad_perm:[2,3,2,3] row_mask:0xf bank_mask:0xf
v_mov_b64 v[54:55], 0
v_mov_b32_dpp v8, v12 quad_perm:[0,1,0,1] row_mask:0xf bank_mask:0xf
v_mov_b32_dpp v11, v13 quad_perm:[2,3,2,3] row_mask:0xf bank_mask:0xf
v_mov_b32_dpp v9, v13 quad_perm:[0,1,0,1] row_mask:0xf bank_mask:0xf
v_mov_b64 v[52:53], 0
v_mov_b64 v[40:41], 0
v_smfmac_f32_16x16x64_bf16 v[36:39], v[8:11], v[80:87], v1
ds_read_b128 v[24:27], v0 offset:55296
global_load_dwordx4 v[72:75], v0, s[76:77] offset:-2048 sc1
ds_read_b128 v[20:23], v0 offset:54272
v_smfmac_f32_16x16x64_bf16 v[40:43], v[8:11], v[152:159], v1
s_waitcnt lgkmcnt(2)
ds_read_b128 v[80:83], v0 offset:57344
s_barrier
ds_read_b128 v[56:59], v5 offset:1024
v_smfmac_f32_16x16x64_bf16 v[32:35], v[8:11], v[176:183], v1
s_add_u32 s27, s20, 524288
ds_read_b128 v[60:63], v5 offset:512
v_mov_b64 v[48:49], 0
v_mov_b64 v[50:51], 0
v_smfmac_f32_16x16x64_bf16 v[52:55], v[8:11], v[168:175], v1
s_add_u32 s58, s4, s20
ds_read_b128 v[12:15], v5 offset:0
v_lshrrev_b32 v44, 8, v0
v_smfmac_f32_16x16x64_bf16 v[48:51], v[8:11], v[160:167], v1
s_waitcnt lgkmcnt(4)
ds_read_b128 v[84:87], v0 offset:58368
global_load_dwordx4 v[76:79], v0, s[76:77] offset:-1024 sc1
v_bfe_u32 v45, v0, 1, 7
s_waitcnt lgkmcnt(3)
v_smfmac_f32_16x16x64_bf16 v[36:39], v[56:59], v[16:23], v1
s_addc_u32 s59, s5, 0
ds_read_b128 v[16:19], v0 offset:59392
s_waitcnt lgkmcnt(3)
v_smfmac_f32_16x16x64_bf16 v[36:39], v[60:63], v[24:31], v1
ds_read_b128 v[28:31], v0 offset:62464
s_waitcnt lgkmcnt(3)
v_smfmac_f32_16x16x64_bf16 v[36:39], v[12:15], v[184:191], v1
ds_read_b128 v[20:23], v0 offset:60416
s_waitcnt lgkmcnt(3)
v_smfmac_f32_16x16x64_bf16 v[40:43], v[56:59], v[80:87], v1
ds_read_b128 v[24:27], v0 offset:61440
v_lshl_or_b32 v44, v44, 12, v45
v_smfmac_f32_16x16x64_bf16 v[40:43], v[60:63], v[192:199], v1
s_nop 0
ds_read_b128 v[84:87], v0 offset:64512
v_cvt_pk_bf16_f32 v36, v36, v37
v_and_or_b32 v36, v36, -2, s18
v_cvt_pk_bf16_f32 v37, v38, v39
v_smfmac_f32_16x16x64_bf16 v[40:43], v[12:15], v[200:207], v1
s_and_b32 s33, s17, 3
global_store_dwordx2 v44, v[36:37], s[48:49]
s_waitcnt lgkmcnt(2)
v_smfmac_f32_16x16x64_bf16 v[48:51], v[56:59], v[16:23], v1
ds_read_b128 v[80:83], v0 offset:63488
s_waitcnt lgkmcnt(2)
v_smfmac_f32_16x16x64_bf16 v[48:51], v[60:63], v[24:31], v1
s_mov_b32 s30, 0
v_cvt_pk_bf16_f32 v40, v40, v41
v_cvt_pk_bf16_f32 v41, v42, v43
v_and_or_b32 v40, v40, -2, s18
v_smfmac_f32_16x16x64_bf16 v[48:51], v[12:15], v[208:215], v1
global_store_dwordx2 v44, v[40:41], s[50:51]
s_waitcnt lgkmcnt(1)
v_smfmac_f32_16x16x64_bf16 v[32:35], v[56:59], v[232:239], v1
s_nop 0
s_waitcnt lgkmcnt(0)
v_smfmac_f32_16x16x64_bf16 v[52:55], v[56:59], v[80:87], v1
s_nop 1
v_cvt_pk_bf16_f32 v48, v48, v49
v_smfmac_f32_16x16x64_bf16 v[52:55], v[60:63], v[216:223], v1
s_cselect_b32 s33, s6, s23
v_and_or_b32 v48, v48, -2, s18
v_cvt_pk_bf16_f32 v49, v50, v51
v_smfmac_f32_16x16x64_bf16 v[52:55], v[12:15], v[224:231], v1
global_store_dwordx2 v44, v[48:49], s[52:53]
v_smfmac_f32_16x16x64_bf16 v[32:35], v[60:63], v[240:247], v1
s_nop 2
v_smfmac_f32_16x16x64_bf16 v[32:35], v[12:15], v[248:255], v1
s_nop 1
v_cvt_pk_bf16_f32 v52, v52, v53
v_and_or_b32 v52, v52, -2, s18
v_cvt_pk_bf16_f32 v53, v54, v55
s_nop 0
global_store_dwordx2 v44, v[52:53], s[54:55]
s_nop 0
v_cvt_pk_bf16_f32 v32, v32, v33
v_cvt_pk_bf16_f32 v33, v34, v35
v_and_or_b32 v32, v32, -2, s18
global_store_dwordx2 v44, v[32:33], s[56:57]
nored_10122:
s_waitcnt vmcnt(9)
v_cmp_gt_u32 vcc, s34, v7
s_cmp_eq_u32 vcc_hi, 0
s_cbranch_scc1 kv_10126
s_mov_b32 s30, 0
kv_10125:
v_and_b32 v7, 128, v0
buffer_load_dword v7, v7, s[4:7], s22 offen sc1
s_add_u32 s30, s30, 1
s_cmp_gt_u32 s30, 262144
s_cbranch_scc1 L_fail
s_waitcnt vmcnt(0)
v_cmp_gt_u32 vcc, s34, v7
s_cbranch_vccnz kv_10125
kv_10126:
v_and_b32 v7, 128, v0
v_add_u32 v7, s22, v7
s_mov_b32 exec_hi, 0
v_and_b32 v7, 511, v0
v_lshl_add_u32 v7, v7, 3, s27
s_mov_b32 exec_hi, -1
s_nop 15
s_nop 15
s_nop 15
s_nop 15
s_nop 15
s_nop 1
global_load_dwordx4 v[56:59], v0, s[76:77] offset:0 sc1
global_load_dwordx4 v[60:63], v0, s[76:77] offset:1024 sc1
global_load_dwordx4 v[48:51], v0, s[76:77] offset:2048 sc1
global_load_dwordx4 v[52:55], v0, s[76:77] offset:3072 sc1
join_10123:
s_barrier
s_nop 15
s_nop 15
s_nop 7
s_barrier
global_load_dwordx4 v[32:35], v0, s[68:69] offset:-4096 sc1
s_nop 10
global_load_dwordx4 v[36:39], v0, s[68:69] offset:0 sc1
s_barrier
global_load_dwordx4 v[80:83], v0, s[78:79] offset:-4096 sc1
global_load_dwordx4 v[84:87], v0, s[78:79] offset:-3072 sc1
v_mov_b64 v[8:9], 0
v_mov_b64 v[10:11], 0
v_mov_b64 v[12:13], 0
v_mov_b64 v[14:15], 0
v_mov_b64 v[16:17], 0
v_mov_b64 v[18:19], 0
v_mov_b64 v[20:21], 0
v_mov_b64 v[22:23], 0
v_mov_b64 v[24:25], 0
v_mov_b64 v[26:27], 0
v_mov_b64 v[28:29], 0
v_mov_b64 v[30:31], 0
s_mov_b32 s30, 0
s_cmp_eq_u32 s17, s31
s_cbranch_scc0 gather_10114
s_branch exit_10117
rt_10119:
global_load_dwordx4 v[32:35], v0, s[68:69] offset:-4096 sc1
global_load_dwordx4 v[36:39], v0, s[68:69] offset:0 sc1
s_add_u32 s30, s30, 1
s_cmp_gt_u32 s30, 262144
s_cbranch_scc1 L_fail
s_mov_b64 exec, 1
global_store_dword v0, v0, s[62:63]
global_store_dword v0, v0, s[62:63]
s_mov_b64 exec, -1
v_mov_b64 v[8:9], 0
v_mov_b64 v[10:11], 0
v_mov_b64 v[12:13], 0
v_mov_b64 v[14:15], 0
v_mov_b64 v[16:17], 0
v_mov_b64 v[18:19], 0
v_mov_b64 v[20:21], 0
v_mov_b64 v[22:23], 0
v_mov_b64 v[24:25], 0
v_mov_b64 v[26:27], 0
v_mov_b64 v[28:29], 0
v_mov_b64 v[30:31], 0
s_branch gather_10114
rare_10115:
ds_read_b128 v[48:51], v6 offset:6144
ds_read_b128 v[52:55], v6 offset:7168
s_waitcnt lgkmcnt(0)
v_add_f32 v48, v48, v52
v_add_f32 v49, v49, v53
v_add_f32 v50, v50, v54
v_add_f32 v51, v51, v55
v_mov_b32_dpp v46, v46 quad_perm:[0,1,0,1] row_mask:0xf bank_mask:0xf
v_mov_b32_dpp v47, v47 quad_perm:[0,1,0,1] row_mask:0xf bank_mask:0xf
v_max3_f32 v19, v48, v49, v50
v_max3_f32 v19, v19, v51, v46
v_max_f32 v19, v19, v47
s_nop 1
v_max_f32_dpp v19, v19, v19 quad_perm:[2,3,0,1] row_mask:0xf bank_mask:0xf
v_mov_b32 v44, v19
s_nop 1
v_permlane32_swap_b32 v19, v44
v_max_f32 v19, v19, v44
v_mov_b32 v44, v19
s_nop 1
v_permlane16_swap_b32 v19, v44
v_max_f32 v19, v19, v44
v_sub_f32 v48, v48, v19
v_sub_f32 v49, v49, v19
v_sub_f32 v50, v50, v19
v_sub_f32 v51, v51, v19
v_sub_f32 v46, v46, v19
v_sub_f32 v47, v47, v19
v_exp_f32 v48, v48
v_exp_f32 v49, v49
v_exp_f32 v50, v50
v_exp_f32 v51, v51
v_cvt_pk_bf16_f32 v54, v48, v49
v_cvt_pk_bf16_f32 v55, v50, v51
s_nop 0
v_mov_b32_dpp v48, v54 quad_perm:[0,1,0,1] row_mask:0xf bank_mask:0xf
v_mov_b32_dpp v49, v55 quad_perm:[0,1,0,1] row_mask:0xf bank_mask:0xf
v_mov_b32_dpp v50, v54 quad_perm:[2,3,2,3] row_mask:0xf bank_mask:0xf
v_mov_b32_dpp v51, v55 quad_perm:[2,3,2,3] row_mask:0xf bank_mask:0xf
v_mov_b64 v[20:21], s[44:45]
v_mov_b64 v[22:23], s[44:45]
v_mfma_f32_16x16x32_bf16 v[8:11], v[56:59], v[48:51], 0
v_mfma_f32_16x16x32_bf16 v[12:15], v[60:63], v[48:51], 0
v_mfma_f32_16x16x32_bf16 v[16:19], v[20:23], v[48:51], 0
v_mov_b64 v[54:55], s[46:47]
v_exp_f32_dpp v44, v46 quad_perm:[0,1,0,1] row_mask:0xf bank_mask:0xf
v_exp_f32_dpp v45, v47 quad_perm:[0,1,0,1] row_mask:0xf bank_mask:0xf
s_nop 0
v_cvt_pk_bf16_f32 v52, v44, v45
v_cvt_pk_bf16_f32 v53, v44, v45
s_nop 1
v_mfma_f32_16x16x16_bf16 v[16:19], v[54:55], v[52:53], v[16:19]
v_mfma_f32_16x16x16_bf16 v[8:11], v[24:25], v[52:53], v[8:11]
v_mfma_f32_16x16x16_bf16 v[12:15], v[26:27], v[52:53], v[12:15]
s_nop 5
v_rcp_f32 v18, v16
s_nop 0
v_cndmask_b32 v8, v12, v8, s[42:43]
v_mul_f32 v8, v8, v18
v_cndmask_b32 v9, v13, v9, s[42:43]
v_mul_f32 v9, v9, v18
v_cndmask_b32 v10, v14, v10, s[42:43]
v_mul_f32 v10, v10, v18
v_cndmask_b32 v11, v15, v11, s[42:43]
v_mul_f32 v11, v11, v18
v_cvt_pk_bf16_f32 v12, v8, v9
v_cvt_pk_bf16_f32 v13, v10, v11
s_branch back_10116
exit_10117:
global_load_dwordx4 v[32:35], v0, s[68:69] offset:-4096 sc1
global_load_dwordx4 v[36:39], v0, s[68:69] offset:0 sc1
s_add_u32 s30, s30, 1
s_cmp_gt_u32 s30, 262144
s_cbranch_scc1 L_fail
s_waitcnt vmcnt(1)
v_bitop3_b32 v44, v32, v34, s18 bitop3:0x7e
s_waitcnt vmcnt(0)
v_bitop3_b32 v45, v36, v38, s18 bitop3:0x7e
v_bitop3_b32 v44, v44, v45, s19 bitop3:0xa8
v_cmp_ne_u32 vcc, 0, v44
s_cbranch_vccnz exit_10117
ds_write_b128 v0, v[32:35] offset:3072
ds_write_b128 v0, v[36:39] offset:7168
s_waitcnt lgkmcnt(0)
s_barrier
v_add_u32 v44, s24, v0
ds_read_b128 v[44:47], v44
s_waitcnt lgkmcnt(0)
v_swap_b32 v45, v46
buffer_store_dwordx4 v[44:47], v0, s[4:7], s21 offen sc1
s_add_u32 s26, s17, 1
s_waitcnt vmcnt(0)
v_mov_b32 v44, s26
s_mov_b64 exec, 1
buffer_store_dword v44, off, s[4:7], s23 sc1
s_mov_b64 exec, -1
s_barrier
s_add_u32 s36, s36, 1
s_cmp_lt_u32 s36, 2
s_cbranch_scc1 layer_10113
s_endpgm
grp_10064:
s_endpgm

.section .rodata,"a"
.p2align 6
.amdhsa_kernel interleave_layers__spectral_gfnet__memory_aug_recurrent_mem_tr__prompt_kernel
  .amdhsa_next_free_vgpr 512
  .amdhsa_next_free_sgpr 102
  .amdhsa_accum_offset 256
  .amdhsa_group_segment_fixed_size 0
  .amdhsa_kernarg_size 104
  .amdhsa_user_sgpr_count 2
  .amdhsa_user_sgpr_kernarg_segment_ptr 1
  .amdhsa_system_sgpr_workgroup_id_x 1
  .amdhsa_float_denorm_mode_32 3
  .amdhsa_ieee_mode 0
.end_amdhsa_kernel
```

```asm
; @launch grid=(256,1,1) block=(256,1,1) lds=163840
.amdgcn_target "amdgcn-amd-amdhsa--gfx950"
.text
.globl interleave_layers__spectral_gfnet__memory_aug_recurrent_mem_tr__prompt_kernel
.p2align 8
.type interleave_layers__spectral_gfnet__memory_aug_recurrent_mem_tr__prompt_kernel,@function
interleave_layers__spectral_gfnet__memory_aug_recurrent_mem_tr__prompt_kernel:
s_cmp_ge_u32 s2, 256
s_cbranch_scc1 L_end
s_load_dwordx2 s[4:5], s[0:1], 96
s_load_dwordx2 s[8:9], s[0:1], 88
s_mov_b32 s6, 268435456
s_mov_b32 s7, 0x20000
s_mov_b32 s10, 256
s_mov_b32 s11, 0x20000
s_getreg_b32 s12, hwreg(HW_REG_XCC_ID, 0, 3)
v_lshrrev_b32 v1, 6, v0
s_nop 0
v_readfirstlane_b32 s13, v1
s_waitcnt lgkmcnt(0)
s_cmp_lg_u32 s13, 0
s_cbranch_scc1 reg_3
v_mov_b32 v1, 0
v_mov_b32 v2, -1
ds_write_b32 v1, v2
s_sub_u32 s15, s12, 8
s_and_b32 s15, s15, 7
s_lshl_b32 s15, s15, 4
v_mov_b32 v2, 1
s_mov_b64 exec, 1
buffer_atomic_add v2, off, s[8:11], s15 offset:16 sc0
s_mov_b64 exec, -1
s_cmp_lg_u32 s12, 7
s_cbranch_scc1 reg_6
s_waitcnt vmcnt(0)
v_readfirstlane_b32 s16, v2
s_nop 0
s_cmp_ge_u32 s16, 32
s_cbranch_scc1 reg_6
s_mov_b32 s18, 0
reg_5:
buffer_load_dword v3, off, s[8:11], 0 offset:128 sc1
s_waitcnt vmcnt(0)
v_cmp_gt_u32 vcc, 32, v3
s_cbranch_vccz reg_7
s_add_u32 s18, s18, 1
s_cmp_lt_u32 s18, 16
s_cbranch_scc1 reg_5
reg_6:
v_and_b32 v1, 15, v0
v_cmp_ne_u32 vcc, 9, v1
s_nop 1
v_cndmask_b32 v1, 10, v1, vcc
v_lshlrev_b32 v1, 4, v1
s_mov_b32 s16, 0
all_8:
buffer_load_dword v3, v1, s[8:11], 0 offen sc1
s_add_u32 s16, s16, 1
s_cmp_gt_u32 s16, 262144
s_cbranch_scc1 L_fail
all_9:
s_waitcnt vmcnt(0)
v_add_u32_dpp v4, v3, v3 quad_perm:[1,0,3,2] row_mask:0xf bank_mask:0xf
s_nop 1
v_add_u32_dpp v4, v4, v4 quad_perm:[2,3,0,1] row_mask:0xf bank_mask:0xf
s_nop 1
v_add_u32_dpp v4, v4, v4 row_ror:4 row_mask:0xf bank_mask:0xf
s_nop 1
v_add_u32_dpp v4, v4, v4 row_ror:8 row_mask:0xf bank_mask:0xf
v_cmp_ne_u32 vcc, 274, v4
s_cbranch_vccnz all_8
v_readfirstlane_b32 s17, v2
v_readlane_b32 s20, v3, 1
v_readlane_b32 s21, v3, 2
v_readlane_b32 s22, v3, 3
v_readlane_b32 s23, v3, 4
v_readlane_b32 s24, v3, 5
v_readlane_b32 s25, v3, 6
v_readlane_b32 s26, v3, 7
v_readlane_b32 s27, v3, 8
s_mov_b32 s15, 6
s_cmp_ge_u32 s25, 32
s_cselect_b32 s15, 5, s15
s_cmp_ge_u32 s24, 32
s_cselect_b32 s15, 4, s15
s_cmp_ge_u32 s23, 32
s_cselect_b32 s15, 3, s15
s_cmp_ge_u32 s22, 32
s_cselect_b32 s15, 2, s15
s_cmp_ge_u32 s21, 32
s_cselect_b32 s15, 1, s15
s_cmp_ge_u32 s20, 32
s_cselect_b32 s15, 0, s15
s_cmp_ge_u32 s27, 32
s_cselect_b32 s15, 7, s15
s_mov_b32 s16, s17
s_cmp_gt_u32 s12, 0
s_cselect_b32 s18, s20, 0
s_add_u32 s16, s16, s18
s_cmp_gt_u32 s12, 1
s_cselect_b32 s18, s21, 0
s_add_u32 s16, s16, s18
s_cmp_gt_u32 s12, 2
s_cselect_b32 s18, s22, 0
s_add_u32 s16, s16, s18
s_cmp_gt_u32 s12, 3
s_cselect_b32 s18, s23, 0
s_add_u32 s16, s16, s18
s_cmp_gt_u32 s12, 4
s_cselect_b32 s18, s24, 0
s_add_u32 s16, s16, s18
s_cmp_gt_u32 s12, 5
s_cselect_b32 s18, s25, 0
s_add_u32 s16, s16, s18
s_cmp_gt_u32 s12, 6
s_cselect_b32 s18, s26, 0
s_add_u32 s16, s16, s18
s_add_u32 s18, s16, 32
s_cmp_lt_u32 s12, s15
s_cselect_b32 s16, s18, s16
s_cmp_eq_u32 s12, s15
s_cselect_b32 s18, s17, 32
s_cmp_lt_u32 s18, 32
s_cselect_b32 s16, s18, s16
reg_7:
v_mov_b32 v1, 0
v_mov_b32 v2, s16
ds_write_b32 v1, v2
s_waitcnt lgkmcnt(0)
s_branch reg_2
reg_3:
s_cmp_lg_u32 s13, 1
s_cbranch_scc1 reg_4
s_cmp_ge_u32 s2, 18
s_cbranch_scc1 reg_4
v_lshlrev_b32 v1, 7, v0
s_lshl_b32 s15, s2, 13
s_add_u32 s15, s15, 11526144
v_mov_b32 v4, 0
buffer_store_dword v4, v1, s[4:7], s15 offen sc1
v_mov_b32 v2, 1
s_waitcnt vmcnt(0)
s_mov_b64 exec, 1
buffer_atomic_add v2, off, s[8:11], 0
s_mov_b64 exec, -1
reg_4:
s_cmp_eq_u32 s12, 7
s_cbranch_scc1 reg_2
s_load_dwordx2 s[24:25], s[0:1], 48
s_mov_b32 s26, 5242880
s_mov_b32 s27, 0x20000
s_lshl_b32 s15, s13, 3
s_sub_u32 s15, s15, 8
s_load_dwordx2 s[20:21], s[0:1], s15
s_mov_b32 s16, 1314816
s_cmp_eq_u32 s13, 1
s_cselect_b32 s22, 2621440, s16
s_cselect_b32 s16, 80, 41
s_mov_b32 s23, 0x20000
s_mul_i32 s17, s16, s2
s_lshl_b32 s17, s17, 7
s_sub_u32 s16, s16, 1
v_and_b32 v1, 63, v0
v_add_u32 v2, 64, v1
v_min_u32 v1, s16, v1
v_min_u32 v2, s16, v2
v_lshlrev_b32 v1, 7, v1
v_lshlrev_b32 v2, 7, v2
s_waitcnt lgkmcnt(0)
buffer_load_dword v3, v1, s[20:23], s17 offen
buffer_load_dword v4, v2, s[20:23], s17 offen
v_subrev_u32 v1, 64, v0
v_min_u32 v1, 159, v1
v_lshlrev_b32 v1, 7, v1
s_mul_i32 s17, s2, 20480
buffer_load_dword v5, v1, s[24:27], s17 offen
reg_2:
s_barrier
v_mov_b32 v1, 0
ds_read_b32 v2, v1
s_waitcnt lgkmcnt(0)
v_readfirstlane_b32 s14, v2
s_barrier
s_cmp_ge_u32 s14, 256
s_cbranch_scc1 L_end
s_cmp_lt_u32 s14, 32
s_cbranch_scc1 L_chain
s_sub_u32 s15, s14, 32
v_and_b32 v0, 63, v0
v_lshlrev_b32 v0, 4, v0
s_mov_b32 s24, 0x3f803f80
s_mul_i32 s31, s13, 10240
s_lshl_b32 s37, s13, 10
s_mov_b32 s22, s6
s_mov_b32 s23, 0
s_mov_b32 s16, 0
s_lshr_b32 s18, s15, 5
s_lshl_b32 s18, s18, 2
s_lshr_b32 s18, 106180896, s18
s_and_b32 s18, s18, 7
s_lshl_b32 s18, s18, 5
s_and_b32 s15, s15, 31
s_or_b32 s15, s15, s18
s_cmp_ge_u32 s15, 64
s_cbranch_scc1 roleA_11
s_and_b32 s32, s15, 31
s_cmp_ge_u32 s15, 32
s_cbranch_scc1 roleV_10
s_load_dwordx2 s[40:41], s[0:1], 8
s_mov_b32 s42, 1314816
s_mov_b32 s43, 0x20000
s_waitcnt lgkmcnt(0)
s_waitcnt vmcnt(0)
v_bfe_u32 v5, v0, 4, 2
v_lshrrev_b32 v6, 6, v0
v_mul_u32_u24 v7, 642, v5
v_lshl_add_u32 v7, v6, 2, v7
v_lshlrev_b32 v5, 4, v5
v_lshl_add_u32 v5, v6, 14, v5
s_and_b32 s18, s32, 3
s_bfe_u32 s19, s32, 0x20002
s_lshr_b32 s20, s32, 4
s_lshl_b32 s26, s20, 2
s_add_u32 s26, s26, s18
s_lshl_b32 s27, s26, 8
s_lshl_b32 s26, s26, 4
s_add_u32 s26, s26, s19
s_lshl_b32 s26, s26, 2
s_add_u32 s26, s26, s13
s_mul_i32 s26, s26, 2568
s_lshl_b32 s19, s19, 12
s_add_u32 s27, s27, s19
s_lshl_b32 s19, s13, 6
s_add_u32 s27, s27, s19
s_add_u32 s27, s27, 167772160
s_add_u32 s18, s26, 2
buffer_load_dword v32, v7, s[40:43], s18 offen offset:0
buffer_load_dword v36, v7, s[40:43], s18 offen offset:64
buffer_load_dword v40, v7, s[40:43], s18 offen offset:128
buffer_load_dword v44, v7, s[40:43], s18 offen offset:192
buffer_load_dword v48, v7, s[40:43], s18 offen offset:256
buffer_load_dword v52, v7, s[40:43], s18 offen offset:320
buffer_load_dword v56, v7, s[40:43], s18 offen offset:384
buffer_load_dword v60, v7, s[40:43], s18 offen offset:448
buffer_load_dword v64, v7, s[40:43], s18 offen offset:512
buffer_load_dword v68, v7, s[40:43], s18 offen offset:576
s_add_u32 s18, s26, 41090
buffer_load_dword v33, v7, s[40:43], s18 offen offset:0
buffer_load_dword v37, v7, s[40:43], s18 offen offset:64
buffer_load_dword v41, v7, s[40:43], s18 offen offset:128
buffer_load_dword v45, v7, s[40:43], s18 offen offset:192
buffer_load_dword v49, v7, s[40:43], s18 offen offset:256
buffer_load_dword v53, v7, s[40:43], s18 offen offset:320
buffer_load_dword v57, v7, s[40:43], s18 offen offset:384
buffer_load_dword v61, v7, s[40:43], s18 offen offset:448
buffer_load_dword v65, v7, s[40:43], s18 offen offset:512
buffer_load_dword v69, v7, s[40:43], s18 offen offset:576
s_add_u32 s18, s26, 82178
buffer_load_dword v34, v7, s[40:43], s18 offen offset:0
buffer_load_dword v38, v7, s[40:43], s18 offen offset:64
buffer_load_dword v42, v7, s[40:43], s18 offen offset:128
buffer_load_dword v46, v7, s[40:43], s18 offen offset:192
buffer_load_dword v50, v7, s[40:43], s18 offen offset:256
buffer_load_dword v54, v7, s[40:43], s18 offen offset:320
buffer_load_dword v58, v7, s[40:43], s18 offen offset:384
buffer_load_dword v62, v7, s[40:43], s18 offen offset:448
buffer_load_dword v66, v7, s[40:43], s18 offen offset:512
buffer_load_dword v70, v7, s[40:43], s18 offen offset:576
s_add_u32 s18, s26, 123266
buffer_load_dword v35, v7, s[40:43], s18 offen offset:0
buffer_load_dword v39, v7, s[40:43], s18 offen offset:64
buffer_load_dword v43, v7, s[40:43], s18 offen offset:128
buffer_load_dword v47, v7, s[40:43], s18 offen offset:192
buffer_load_dword v51, v7, s[40:43], s18 offen offset:256
buffer_load_dword v55, v7, s[40:43], s18 offen offset:320
buffer_load_dword v59, v7, s[40:43], s18 offen offset:384
buffer_load_dword v63, v7, s[40:43], s18 offen offset:448
buffer_load_dword v67, v7, s[40:43], s18 offen offset:512
buffer_load_dword v71, v7, s[40:43], s18 offen offset:576
s_waitcnt vmcnt(9)
buffer_store_dwordx4 v[32:35], v5, s[4:7], s27 offen sc1
s_add_u32 s27, s27, 262144
s_waitcnt vmcnt(9)
buffer_store_dwordx4 v[36:39], v5, s[4:7], s27 offen sc1
s_add_u32 s27, s27, 262144
s_waitcnt vmcnt(9)
buffer_store_dwordx4 v[40:43], v5, s[4:7], s27 offen sc1
s_add_u32 s27, s27, 262144
s_waitcnt vmcnt(9)
buffer_store_dwordx4 v[44:47], v5, s[4:7], s27 offen sc1
s_add_u32 s27, s27, 262144
s_waitcnt vmcnt(9)
buffer_store_dwordx4 v[48:51], v5, s[4:7], s27 offen sc1
s_add_u32 s27, s27, 262144
s_waitcnt vmcnt(9)
buffer_store_dwordx4 v[52:55], v5, s[4:7], s27 offen sc1
s_add_u32 s27, s27, 262144
s_waitcnt vmcnt(9)
buffer_store_dwordx4 v[56:59], v5, s[4:7], s27 offen sc1
s_add_u32 s27, s27, 262144
s_waitcnt vmcnt(9)
buffer_store_dwordx4 v[60:63], v5, s[4:7], s27 offen sc1
s_add_u32 s27, s27, 262144
s_waitcnt vmcnt(9)
buffer_store_dwordx4 v[64:67], v5, s[4:7], s27 offen sc1
s_add_u32 s27, s27, 262144
s_waitcnt vmcnt(9)
buffer_store_dwordx4 v[68:71], v5, s[4:7], s27 offen sc1
s_add_u32 s27, s27, 262144
s_lshl_b32 s18, s15, 7
s_add_u32 s18, s18, 11563008
s_cmp_eq_u32 s13, 0
s_cselect_b32 s22, s18, s6
s_mov_b32 s23, 1
s_waitcnt vmcnt(0)
s_barrier
v_mov_b32 v3, s23
s_mov_b64 exec, 1
buffer_store_dword v3, off, s[4:7], s22 sc1
s_mov_b64 exec, -1
s_mov_b32 s22, s6
s_lshl_b32 s26, s32, 8
s_lshl_b32 s18, s13, 6
s_add_u32 s26, s26, s18
s_load_dwordx2 s[40:41], s[0:1], 48
s_mov_b32 s42, 5242880
s_mov_b32 s43, 0x20000
s_waitcnt lgkmcnt(0)
v_lshrrev_b32 v32, 6, v0
v_mul_u32_u24 v32, 8192, v32
v_and_b32 v33, 48, v0
v_add_u32 v30, v32, v33
v_bfe_u32 v32, v0, 6, 2
v_lshrrev_b32 v33, 9, v0
v_lshl_add_u32 v32, v33, 3, v32
v_lshlrev_b32 v31, 6, v32
v_and_b32 v32, 16, v0
v_add_u32 v31, v31, v32
v_bfe_u32 v32, v0, 5, 1
v_lshl_add_u32 v31, v32, 3, v31
v_bfe_u32 v32, v0, 8, 1
v_lshl_add_u32 v31, v32, 5, v31
s_mul_i32 s18, s13, 36864
v_add_u32 v31, s18, v31
s_barrier
s_add_u32 m0, s18, 0
s_add_u32 s19, s26, 0
buffer_load_dwordx4 v30, s[40:43], s19 offen lds
s_add_u32 m0, s18, 1024
s_add_u32 s19, s26, 131072
buffer_load_dwordx4 v30, s[40:43], s19 offen lds
s_add_u32 m0, s18, 2048
s_add_u32 s19, s26, 262144
buffer_load_dwordx4 v30, s[40:43], s19 offen lds
s_add_u32 m0, s18, 3072
s_add_u32 s19, s26, 393216
buffer_load_dwordx4 v30, s[40:43], s19 offen lds
s_add_u32 m0, s18, 4096
s_add_u32 s19, s26, 524288
buffer_load_dwordx4 v30, s[40:43], s19 offen lds
s_add_u32 m0, s18, 5120
s_add_u32 s19, s26, 655360
buffer_load_dwordx4 v30, s[40:43], s19 offen lds
s_add_u32 m0, s18, 6144
s_add_u32 s19, s26, 786432
buffer_load_dwordx4 v30, s[40:43], s19 offen lds
s_add_u32 m0, s18, 7168
s_add_u32 s19, s26, 917504
buffer_load_dwordx4 v30, s[40:43], s19 offen lds
s_add_u32 m0, s18, 8192
s_add_u32 s19, s26, 1048576
buffer_load_dwordx4 v30, s[40:43], s19 offen lds
s_add_u32 m0, s18, 9216
s_add_u32 s19, s26, 1179648
buffer_load_dwordx4 v30, s[40:43], s19 offen lds
s_add_u32 m0, s18, 10240
s_add_u32 s19, s26, 1310720
buffer_load_dwordx4 v30, s[40:43], s19 offen lds
s_add_u32 m0, s18, 11264
s_add_u32 s19, s26, 1441792
buffer_load_dwordx4 v30, s[40:43], s19 offen lds
s_add_u32 m0, s18, 12288
s_add_u32 s19, s26, 1572864
buffer_load_dwordx4 v30, s[40:43], s19 offen lds
s_add_u32 m0, s18, 13312
s_add_u32 s19, s26, 1703936
buffer_load_dwordx4 v30, s[40:43], s19 offen lds
s_add_u32 m0, s18, 14336
s_add_u32 s19, s26, 1835008
buffer_load_dwordx4 v30, s[40:43], s19 offen lds
s_add_u32 m0, s18, 15360
s_add_u32 s19, s26, 1966080
buffer_load_dwordx4 v30, s[40:43], s19 offen lds
s_add_u32 m0, s18, 16384
s_add_u32 s19, s26, 2097152
buffer_load_dwordx4 v30, s[40:43], s19 offen lds
s_add_u32 m0, s18, 17408
s_add_u32 s19, s26, 2228224
buffer_load_dwordx4 v30, s[40:43], s19 offen lds
s_add_u32 m0, s18, 18432
s_add_u32 s19, s26, 2359296
buffer_load_dwordx4 v30, s[40:43], s19 offen lds
s_add_u32 m0, s18, 19456
s_add_u32 s19, s26, 2490368
buffer_load_dwordx4 v30, s[40:43], s19 offen lds
s_add_u32 m0, s18, 20480
s_add_u32 s19, s26, 2621440
buffer_load_dwordx4 v30, s[40:43], s19 offen lds
s_add_u32 m0, s18, 21504
s_add_u32 s19, s26, 2752512
buffer_load_dwordx4 v30, s[40:43], s19 offen lds
s_add_u32 m0, s18, 22528
s_add_u32 s19, s26, 2883584
buffer_load_dwordx4 v30, s[40:43], s19 offen lds
s_add_u32 m0, s18, 23552
s_add_u32 s19, s26, 3014656
buffer_load_dwordx4 v30, s[40:43], s19 offen lds
s_add_u32 m0, s18, 24576
s_add_u32 s19, s26, 3145728
buffer_load_dwordx4 v30, s[40:43], s19 offen lds
s_add_u32 m0, s18, 25600
s_add_u32 s19, s26, 3276800
buffer_load_dwordx4 v30, s[40:43], s19 offen lds
s_add_u32 m0, s18, 26624
s_add_u32 s19, s26, 3407872
buffer_load_dwordx4 v30, s[40:43], s19 offen lds
s_add_u32 m0, s18, 27648
s_add_u32 s19, s26, 3538944
buffer_load_dwordx4 v30, s[40:43], s19 offen lds
s_add_u32 m0, s18, 28672
s_add_u32 s19, s26, 3670016
buffer_load_dwordx4 v30, s[40:43], s19 offen lds
s_add_u32 m0, s18, 29696
s_add_u32 s19, s26, 3801088
buffer_load_dwordx4 v30, s[40:43], s19 offen lds
s_add_u32 m0, s18, 30720
s_add_u32 s19, s26, 3932160
buffer_load_dwordx4 v30, s[40:43], s19 offen lds
s_add_u32 m0, s18, 31744
s_add_u32 s19, s26, 4063232
buffer_load_dwordx4 v30, s[40:43], s19 offen lds
s_add_u32 m0, s18, 32768
s_add_u32 s19, s26, 4194304
buffer_load_dwordx4 v30, s[40:43], s19 offen lds
s_add_u32 m0, s18, 33792
s_add_u32 s19, s26, 4325376
buffer_load_dwordx4 v30, s[40:43], s19 offen lds
s_add_u32 m0, s18, 34816
s_add_u32 s19, s26, 4456448
buffer_load_dwordx4 v30, s[40:43], s19 offen lds
s_add_u32 m0, s18, 35840
s_add_u32 s19, s26, 4587520
buffer_load_dwordx4 v30, s[40:43], s19 offen lds
s_waitcnt vmcnt(32)
ds_read_b64_tr_b16 a[0:1], v31 offset:0
ds_read_b64_tr_b16 a[2:3], v31 offset:256
ds_read_b64_tr_b16 a[4:5], v31 offset:1024
ds_read_b64_tr_b16 a[6:7], v31 offset:1280
ds_read_b64_tr_b16 a[8:9], v31 offset:2048
ds_read_b64_tr_b16 a[10:11], v31 offset:2304
ds_read_b64_tr_b16 a[12:13], v31 offset:3072
ds_read_b64_tr_b16 a[14:15], v31 offset:3328
s_waitcnt lgkmcnt(0)
s_add_u32 m0, s18, 0
s_add_u32 s19, s26, 4718592
buffer_load_dwordx4 v30, s[40:43], s19 offen lds
s_add_u32 m0, s18, 1024
s_add_u32 s19, s26, 4849664
buffer_load_dwordx4 v30, s[40:43], s19 offen lds
s_add_u32 m0, s18, 2048
s_add_u32 s19, s26, 4980736
buffer_load_dwordx4 v30, s[40:43], s19 offen lds
s_add_u32 m0, s18, 3072
s_add_u32 s19, s26, 5111808
buffer_load_dwordx4 v30, s[40:43], s19 offen lds
s_waitcnt vmcnt(32)
ds_read_b64_tr_b16 a[16:17], v31 offset:4096
ds_read_b64_tr_b16 a[18:19], v31 offset:4352
ds_read_b64_tr_b16 a[20:21], v31 offset:5120
ds_read_b64_tr_b16 a[22:23], v31 offset:5376
ds_read_b64_tr_b16 a[24:25], v31 offset:6144
ds_read_b64_tr_b16 a[26:27], v31 offset:6400
ds_read_b64_tr_b16 a[28:29], v31 offset:7168
ds_read_b64_tr_b16 a[30:31], v31 offset:7424
s_waitcnt vmcnt(28)
ds_read_b64_tr_b16 a[32:33], v31 offset:8192
ds_read_b64_tr_b16 a[34:35], v31 offset:8448
ds_read_b64_tr_b16 a[36:37], v31 offset:9216
ds_read_b64_tr_b16 a[38:39], v31 offset:9472
ds_read_b64_tr_b16 a[40:41], v31 offset:10240
ds_read_b64_tr_b16 a[42:43], v31 offset:10496
ds_read_b64_tr_b16 a[44:45], v31 offset:11264
ds_read_b64_tr_b16 a[46:47], v31 offset:11520
s_waitcnt vmcnt(24)
ds_read_b64_tr_b16 a[48:49], v31 offset:12288
ds_read_b64_tr_b16 a[50:51], v31 offset:12544
ds_read_b64_tr_b16 a[52:53], v31 offset:13312
ds_read_b64_tr_b16 a[54:55], v31 offset:13568
ds_read_b64_tr_b16 a[56:57], v31 offset:14336
ds_read_b64_tr_b16 a[58:59], v31 offset:14592
ds_read_b64_tr_b16 a[60:61], v31 offset:15360
ds_read_b64_tr_b16 a[62:63], v31 offset:15616
s_waitcnt vmcnt(20)
ds_read_b64_tr_b16 a[64:65], v31 offset:16384
ds_read_b64_tr_b16 a[66:67], v31 offset:16640
ds_read_b64_tr_b16 a[68:69], v31 offset:17408
ds_read_b64_tr_b16 a[70:71], v31 offset:17664
ds_read_b64_tr_b16 a[72:73], v31 offset:18432
ds_read_b64_tr_b16 a[74:75], v31 offset:18688
ds_read_b64_tr_b16 a[76:77], v31 offset:19456
ds_read_b64_tr_b16 a[78:79], v31 offset:19712
s_waitcnt vmcnt(16)
ds_read_b64_tr_b16 a[80:81], v31 offset:20480
ds_read_b64_tr_b16 a[82:83], v31 offset:20736
ds_read_b64_tr_b16 a[84:85], v31 offset:21504
ds_read_b64_tr_b16 a[86:87], v31 offset:21760
ds_read_b64_tr_b16 a[88:89], v31 offset:22528
ds_read_b64_tr_b16 a[90:91], v31 offset:22784
ds_read_b64_tr_b16 a[92:93], v31 offset:23552
ds_read_b64_tr_b16 a[94:95], v31 offset:23808
s_waitcnt vmcnt(12)
ds_read_b64_tr_b16 a[96:97], v31 offset:24576
ds_read_b64_tr_b16 a[98:99], v31 offset:24832
ds_read_b64_tr_b16 a[100:101], v31 offset:25600
ds_read_b64_tr_b16 a[102:103], v31 offset:25856
ds_read_b64_tr_b16 a[104:105], v31 offset:26624
ds_read_b64_tr_b16 a[106:107], v31 offset:26880
ds_read_b64_tr_b16 a[108:109], v31 offset:27648
ds_read_b64_tr_b16 a[110:111], v31 offset:27904
s_waitcnt vmcnt(8)
ds_read_b64_tr_b16 a[112:113], v31 offset:28672
ds_read_b64_tr_b16 a[114:115], v31 offset:28928
ds_read_b64_tr_b16 a[116:117], v31 offset:29696
ds_read_b64_tr_b16 a[118:119], v31 offset:29952
ds_read_b64_tr_b16 a[120:121], v31 offset:30720
ds_read_b64_tr_b16 a[122:123], v31 offset:30976
ds_read_b64_tr_b16 a[124:125], v31 offset:31744
ds_read_b64_tr_b16 a[126:127], v31 offset:32000
s_waitcnt vmcnt(4)
ds_read_b64_tr_b16 a[128:129], v31 offset:32768
ds_read_b64_tr_b16 a[130:131], v31 offset:33024
ds_read_b64_tr_b16 a[132:133], v31 offset:33792
ds_read_b64_tr_b16 a[134:135], v31 offset:34048
ds_read_b64_tr_b16 a[136:137], v31 offset:34816
ds_read_b64_tr_b16 a[138:139], v31 offset:35072
ds_read_b64_tr_b16 a[140:141], v31 offset:35840
ds_read_b64_tr_b16 a[142:143], v31 offset:36096
s_waitcnt vmcnt(0)
ds_read_b64_tr_b16 a[144:145], v31 offset:0
ds_read_b64_tr_b16 a[146:147], v31 offset:256
ds_read_b64_tr_b16 a[148:149], v31 offset:1024
ds_read_b64_tr_b16 a[150:151], v31 offset:1280
ds_read_b64_tr_b16 a[152:153], v31 offset:2048
ds_read_b64_tr_b16 a[154:155], v31 offset:2304
ds_read_b64_tr_b16 a[156:157], v31 offset:3072
ds_read_b64_tr_b16 a[158:159], v31 offset:3328
s_waitcnt lgkmcnt(0)
s_barrier
s_load_dwordx2 s[40:41], s[0:1], 40
s_mov_b32 s42, 5242880
s_mov_b32 s43, 0x20000
s_waitcnt lgkmcnt(0)
v_lshrrev_b32 v5, 5, v0
v_lshlrev_b32 v5, 13, v5
v_bfe_u32 v6, v0, 4, 1
v_lshl_add_u32 v5, v6, 7, v5
s_lshl_b32 s18, s32, 8
s_mul_i32 s19, s13, 1310720
s_add_u32 s18, s18, s19
buffer_load_dword v24, v5, s[40:43], s18 offen
s_add_u32 s18, s18, 262144
buffer_load_dword v25, v5, s[40:43], s18 offen
s_add_u32 s18, s18, 262144
buffer_load_dword v26, v5, s[40:43], s18 offen
s_add_u32 s18, s18, 262144
buffer_load_dword v27, v5, s[40:43], s18 offen
s_add_u32 s18, s18, 262144
buffer_load_dword v28, v5, s[40:43], s18 offen
s_add_u32 s18, s18, 262144
v_mov_b32 v32, s24
v_mov_b32 v33, s24
v_mov_b32 v34, s24
v_mov_b32 v35, s24
s_nop 1
v_mfma_f32_32x32x16_bf16 v[36:51], a[0:3], v[32:35], 0
v_mfma_f32_32x32x16_bf16 v[36:51], a[4:7], v[32:35], v[36:51]
v_mfma_f32_32x32x16_bf16 v[36:51], a[8:11], v[32:35], v[36:51]
v_mfma_f32_32x32x16_bf16 v[36:51], a[12:15], v[32:35], v[36:51]
v_mfma_f32_32x32x16_bf16 v[36:51], a[16:19], v[32:35], v[36:51]
v_mfma_f32_32x32x16_bf16 v[36:51], a[20:23], v[32:35], v[36:51]
v_mfma_f32_32x32x16_bf16 v[36:51], a[24:27], v[32:35], v[36:51]
v_mfma_f32_32x32x16_bf16 v[36:51], a[28:31], v[32:35], v[36:51]
v_mfma_f32_32x32x16_bf16 v[36:51], a[32:35], v[32:35], v[36:51]
v_mfma_f32_32x32x16_bf16 v[36:51], a[36:39], v[32:35], v[36:51]
v_mfma_f32_32x32x16_bf16 v[36:51], a[40:43], v[32:35], v[36:51]
v_mfma_f32_32x32x16_bf16 v[36:51], a[44:47], v[32:35], v[36:51]
v_mfma_f32_32x32x16_bf16 v[36:51], a[48:51], v[32:35], v[36:51]
v_mfma_f32_32x32x16_bf16 v[36:51], a[52:55], v[32:35], v[36:51]
v_mfma_f32_32x32x16_bf16 v[36:51], a[56:59], v[32:35], v[36:51]
v_mfma_f32_32x32x16_bf16 v[36:51], a[60:63], v[32:35], v[36:51]
v_mfma_f32_32x32x16_bf16 v[36:51], a[64:67], v[32:35], v[36:51]
v_mfma_f32_32x32x16_bf16 v[36:51], a[68:71], v[32:35], v[36:51]
v_mfma_f32_32x32x16_bf16 v[36:51], a[72:75], v[32:35], v[36:51]
v_mfma_f32_32x32x16_bf16 v[36:51], a[76:79], v[32:35], v[36:51]
v_mfma_f32_32x32x16_bf16 v[36:51], a[80:83], v[32:35], v[36:51]
v_mfma_f32_32x32x16_bf16 v[36:51], a[84:87], v[32:35], v[36:51]
v_mfma_f32_32x32x16_bf16 v[36:51], a[88:91], v[32:35], v[36:51]
v_mfma_f32_32x32x16_bf16 v[36:51], a[92:95], v[32:35], v[36:51]
v_mfma_f32_32x32x16_bf16 v[36:51], a[96:99], v[32:35], v[36:51]
v_mfma_f32_32x32x16_bf16 v[36:51], a[100:103], v[32:35], v[36:51]
v_mfma_f32_32x32x16_bf16 v[36:51], a[104:107], v[32:35], v[36:51]
v_mfma_f32_32x32x16_bf16 v[36:51], a[108:111], v[32:35], v[36:51]
v_mfma_f32_32x32x16_bf16 v[36:51], a[112:115], v[32:35], v[36:51]
v_mfma_f32_32x32x16_bf16 v[36:51], a[116:119], v[32:35], v[36:51]
v_mfma_f32_32x32x16_bf16 v[36:51], a[120:123], v[32:35], v[36:51]
v_mfma_f32_32x32x16_bf16 v[36:51], a[124:127], v[32:35], v[36:51]
v_mfma_f32_32x32x16_bf16 v[36:51], a[128:131], v[32:35], v[36:51]
v_mfma_f32_32x32x16_bf16 v[36:51], a[132:135], v[32:35], v[36:51]
v_mfma_f32_32x32x16_bf16 v[36:51], a[136:139], v[32:35], v[36:51]
v_mfma_f32_32x32x16_bf16 v[36:51], a[140:143], v[32:35], v[36:51]
v_mfma_f32_32x32x16_bf16 v[36:51], a[144:147], v[32:35], v[36:51]
v_mfma_f32_32x32x16_bf16 v[36:51], a[148:151], v[32:35], v[36:51]
v_mfma_f32_32x32x16_bf16 v[36:51], a[152:155], v[32:35], v[36:51]
v_mfma_f32_32x32x16_bf16 v[36:51], a[156:159], v[32:35], v[36:51]
s_nop 11
v_mov_b32 v8, v36
v_mov_b32 v9, v37
v_mov_b32 v10, v38
v_mov_b32 v11, v39
v_mov_b32 v12, v40
v_mov_b32 v13, v41
v_mov_b32 v14, v42
v_mov_b32 v15, v43
v_mov_b32 v16, v44
v_mov_b32 v17, v45
v_mov_b32 v18, v46
v_mov_b32 v19, v47
v_mov_b32 v20, v48
v_mov_b32 v21, v49
v_mov_b32 v22, v50
v_mov_b32 v23, v51
v_and_b32 v5, 0x70, v0
s_waitcnt vmcnt(4)
v_lshrrev_b32 v24, 8, v0
v_lshl_add_u32 v5, v24, 7, v5
v_bfe_u32 v24, v0, 7, 1
v_lshl_add_u32 v5, v24, 12, v5
s_lshr_b32 s34, s13, 1
s_lshl_b32 s34, s34, 13
s_and_b32 s18, s13, 1
s_lshl_b32 s18, s18, 10
s_add_u32 s34, s34, s18
s_lshl_b32 s18, s32, 14
s_add_u32 s34, s34, s18
v_bfe_u32 v6, v0, 7, 2
v_mul_u32_u24 v6, 10240, v6
v_bfe_u32 v24, v0, 5, 2
v_lshl_add_u32 v6, v24, 6, v6
v_lshrrev_b32 v24, 9, v0
v_lshl_add_u32 v6, v24, 5, v6
v_and_b32 v24, 16, v0
v_add_u32 v6, v24, v6
s_lshl_b32 s51, s32, 8
s_add_u32 s51, s51, 11534336
s_mul_i32 s52, s13, 2560
s_add_u32 s52, s52, 12582912
s_add_u32 s50, s34, 110100480
s_mov_b32 s39, 0
kvlay_12:
s_mul_i32 s26, s16, 6291456
s_add_u32 s26, s26, 88080384
s_add_u32 s26, s26, s31
s_mul_i32 s54, s16, 327680
s_add_u32 s54, s54, 163577856
s_mul_i32 s27, s16, 35651584
s_add_u32 s27, s27, 16777216
s_mul_i32 s18, s32, 0
s_add_u32 s27, s27, s18
s_add_u32 s27, s27, s34
s_lshl_b32 s29, s16, 1
s_add_u32 s29, s29, 1
s_mov_b32 s28, 0
s_mov_b32 s30, 0
s_cmp_lt_u32 s30, 64
s_cselect_b32 s53, s26, s6
s_cselect_b32 s36, s54, s6
s_mov_b32 s38, 1024
v_mov_b32 v7, v0
s_add_u32 s26, s26, 40960
s_add_u32 s54, s54, 5120
s_add_u32 s30, s30, 1
v_xor_b32 v1, 40960, v0
s_mov_b32 s25, s31
s_mov_b32 s35, 131072
s_cmp_lg_u32 s13, 0
s_cbranch_scc1 polld_21
v_lshlrev_b32 v3, 3, v0
s_waitcnt vmcnt(0)
v_min_u32 v28, 1152, v3
s_mov_b32 s21, 11612160
s_mov_b32 s17, 0
poll_20:
buffer_load_dword v24, v28, s[4:7], s21 offen sc1
s_add_u32 s17, s17, 1
s_cmp_gt_u32 s17, 262144
s_cbranch_scc1 L_fail
s_waitcnt vmcnt(0)
v_cmp_gt_u32 vcc, s29, v24
s_cbranch_vccz polld_21
s_sleep 2
s_branch poll_20
polld_21:
s_barrier
s_add_u32 m0, s25, 2048
s_mov_b32 s20, s53
buffer_load_dwordx4 v7, s[4:7], s20 offen sc1 lds
s_add_u32 m0, s25, 3072
s_add_u32 s20, s20, s38
buffer_load_dwordx4 v7, s[4:7], s20 offen sc1 lds
s_add_u32 m0, s25, 4096
s_add_u32 s20, s20, s38
buffer_load_dwordx4 v7, s[4:7], s20 offen sc1 lds
s_add_u32 m0, s25, 5120
s_add_u32 s20, s20, s38
buffer_load_dwordx4 v7, s[4:7], s20 offen sc1 lds
s_add_u32 m0, s25, 6144
s_add_u32 s20, s20, s38
buffer_load_dwordx4 v7, s[4:7], s20 offen sc1 lds
s_add_u32 m0, s25, 7168
s_add_u32 s20, s20, s38
buffer_load_dwordx4 v7, s[4:7], s20 offen sc1 lds
s_add_u32 m0, s25, 8192
s_add_u32 s20, s20, s38
buffer_load_dwordx4 v7, s[4:7], s20 offen sc1 lds
s_add_u32 m0, s25, 9216
s_add_u32 s20, s20, s38
buffer_load_dwordx4 v7, s[4:7], s20 offen sc1 lds
s_add_u32 m0, s25, 10240
s_add_u32 s20, s20, s38
buffer_load_dwordx4 v7, s[4:7], s20 offen sc1 lds
s_add_u32 m0, s25, 11264
s_add_u32 s20, s20, s38
buffer_load_dwordx4 v7, s[4:7], s20 offen sc1 lds
s_add_u32 m0, s35, s37
s_add_u32 s20, s36, s37
buffer_load_dwordx4 v0, s[4:7], s20 offen sc1 lds
s_add_u32 m0, s35, 4096
s_add_u32 s20, s36, 4096
buffer_load_dwordx4 v0, s[4:7], s20 offen sc1 lds
s_waitcnt vmcnt(0)
kvx_13:
v_xor_b32 v1, 40960, v1
s_sub_u32 s25, s25, s31
s_xor_b32 s25, s25, 40960
s_add_u32 s25, s25, s31
s_xor_b32 s35, s35, 8192
s_cmp_eq_u32 s28, 1
s_cbranch_scc1 kv_15
s_cmp_eq_u32 s28, 30
s_cbranch_scc0 kv_16
s_add_u32 s29, s29, 1
kv_15:
s_waitcnt vmcnt(0)
s_barrier
v_mov_b32 v3, s23
s_mov_b64 exec, 1
buffer_store_dword v3, off, s[4:7], s22 sc1
s_mov_b64 exec, -1
s_mov_b32 s22, s6
s_cmp_lg_u32 s13, 0
s_cbranch_scc1 polld_23
v_lshlrev_b32 v3, 3, v0
v_min_u32 v28, 3968, v3
s_mov_b32 s21, 11612160
s_mov_b32 s17, 0
poll_22:
buffer_load_dword v24, v3, s[4:7], s21 offen sc1
s_add_u32 s20, s21, 8192
buffer_load_dword v25, v3, s[4:7], s20 offen sc1
s_add_u32 s20, s21, 16384
buffer_load_dword v26, v28, s[4:7], s20 offen sc1
s_add_u32 s17, s17, 1
s_cmp_gt_u32 s17, 262144
s_cbranch_scc1 L_fail
s_waitcnt vmcnt(1)
v_min_u32 v24, v24, v25
s_waitcnt vmcnt(0)
v_min_u32 v24, v24, v26
v_cmp_gt_u32 vcc, s29, v24
s_cbranch_vccz polld_23
s_sleep 2
s_branch poll_22
polld_23:
s_barrier
kv_16:
s_add_u32 s28, s28, 1
s_and_b32 s33, s28, 3
s_cmp_lt_u32 s28, 12
s_cselect_b32 s33, 1, s33
s_cmp_eq_u32 s33, 0
s_cbranch_scc1 kv_17
s_cmp_lt_u32 s30, 64
s_cselect_b32 s53, s26, s6
s_cselect_b32 s36, s54, s6
s_mov_b32 s38, 1024
v_mov_b32 v7, v0
s_add_u32 s26, s26, 40960
s_add_u32 s54, s54, 5120
s_add_u32 s30, s30, 1
kvn_14:
s_waitcnt vmcnt(3)
s_barrier
s_add_u32 m0, s25, 2048
s_mov_b32 s20, s53
buffer_load_dwordx4 v7, s[4:7], s20 offen sc1 lds
ds_read_b128 v[48:51], v1 offset:2048
ds_read_b128 v[52:55], v1 offset:3072
s_add_u32 m0, s25, 3072
s_add_u32 s20, s20, s38
buffer_load_dwordx4 v7, s[4:7], s20 offen sc1 lds
s_add_u32 m0, s25, 4096
s_add_u32 s20, s20, s38
buffer_load_dwordx4 v7, s[4:7], s20 offen sc1 lds
ds_read_b128 v[56:59], v1 offset:4096
ds_read_b128 v[60:63], v1 offset:5120
s_waitcnt lgkmcnt(3)
v_mfma_f32_32x32x16_bf16 v[32:47], a[0:3], v[48:51], 0
s_xor_b32 s18, s35, 8192
ds_read_b128 v[48:51], v1 offset:6144
v_lshrrev_b32 v2, 2, v0
s_waitcnt lgkmcnt(3)
v_mfma_f32_32x32x16_bf16 v[32:47], a[4:7], v[52:55], v[32:47]
ds_read_b128 v[52:55], v1 offset:7168
v_add_u32 v2, s18, v2
s_waitcnt lgkmcnt(3)
v_mfma_f32_32x32x16_bf16 v[32:47], a[8:11], v[56:59], v[32:47]
ds_read2st64_b32 v[64:65], v2 offset0:0 offset1:1
s_waitcnt lgkmcnt(2)
ds_read2st64_b32 v[66:67], v2 offset0:2 offset1:3
ds_read_b128 v[56:59], v1 offset:8192
v_mfma_f32_32x32x16_bf16 v[32:47], a[12:15], v[60:63], v[32:47]
ds_read_b128 v[60:63], v1 offset:9216
ds_read2st64_b32 v[74:75], v2 offset0:6 offset1:7
s_waitcnt lgkmcnt(5)
v_mfma_f32_32x32x16_bf16 v[32:47], a[16:19], v[48:51], v[32:47]
s_add_u32 m0, s25, 5120
s_add_u32 s20, s20, s38
buffer_load_dwordx4 v7, s[4:7], s20 offen sc1 lds
ds_read2st64_b32 v[72:73], v2 offset0:4 offset1:5
ds_read_b128 v[48:51], v1 offset:10240
ds_read2st64_b32 v[84:85], v2 offset0:16 offset1:17
s_waitcnt lgkmcnt(5)
v_mfma_f32_32x32x16_bf16 v[32:47], a[20:23], v[52:55], v[32:47]
s_waitcnt lgkmcnt(4)
s_add_u32 m0, s25, 6144
s_add_u32 s20, s20, s38
buffer_load_dwordx4 v7, s[4:7], s20 offen sc1 lds
v_mfma_f32_32x32x16_bf16 v[32:47], a[24:27], v[56:59], v[32:47]
ds_read_b128 v[52:55], v1 offset:11264
s_add_u32 m0, s25, 7168
s_add_u32 s20, s20, s38
buffer_load_dwordx4 v7, s[4:7], s20 offen sc1 lds
v_mfma_f32_32x32x16_bf16 v[32:47], a[28:31], v[60:63], v[32:47]
ds_read_b128 v[60:63], v1 offset:13312
s_waitcnt lgkmcnt(2)
ds_read_b128 v[56:59], v1 offset:12288
ds_read2st64_b32 v[80:81], v2 offset0:12 offset1:13
v_add_f32 v65, v65, v67
v_mfma_f32_32x32x16_bf16 v[32:47], a[32:35], v[48:51], v[32:47]
s_waitcnt lgkmcnt(3)
ds_read_b128 v[48:51], v1 offset:14336
ds_read2st64_b32 v[76:77], v2 offset0:8 offset1:9
s_add_u32 m0, s25, 8192
s_add_u32 s20, s20, s38
buffer_load_dwordx4 v7, s[4:7], s20 offen sc1 lds
v_mfma_f32_32x32x16_bf16 v[32:47], a[36:39], v[52:55], v[32:47]
s_add_u32 m0, s25, 9216
s_add_u32 s20, s20, s38
buffer_load_dwordx4 v7, s[4:7], s20 offen sc1 lds
ds_read_b128 v[52:55], v1 offset:15360
s_waitcnt lgkmcnt(4)
v_mfma_f32_32x32x16_bf16 v[32:47], a[40:43], v[56:59], v[32:47]
s_waitcnt lgkmcnt(2)
v_add_f32 v64, v64, v66
v_mov_b32 v3, s23
s_waitcnt lgkmcnt(1)
v_mfma_f32_32x32x16_bf16 v[32:47], a[44:47], v[60:63], v[32:47]
ds_read_b128 v[60:63], v1 offset:17408
ds_read_b128 v[56:59], v1 offset:16384
v_mfma_f32_32x32x16_bf16 v[32:47], a[48:51], v[48:51], v[32:47]
s_waitcnt lgkmcnt(2)
ds_read_b128 v[48:51], v1 offset:18432
ds_read2st64_b32 v[86:87], v2 offset0:18 offset1:19
v_mfma_f32_32x32x16_bf16 v[32:47], a[52:55], v[52:55], v[32:47]
ds_read2st64_b32 v[78:79], v2 offset0:10 offset1:11
s_waitcnt lgkmcnt(3)
v_mfma_f32_32x32x16_bf16 v[32:47], a[56:59], v[56:59], v[32:47]
s_waitcnt lgkmcnt(2)
ds_read_b128 v[52:55], v1 offset:19456
ds_read2st64_b32 v[82:83], v2 offset0:14 offset1:15
s_add_u32 m0, s25, 10240
s_add_u32 s20, s20, s38
buffer_load_dwordx4 v7, s[4:7], s20 offen sc1 lds
v_mfma_f32_32x32x16_bf16 v[32:47], a[60:63], v[60:63], v[32:47]
ds_read_b128 v[56:59], v1 offset:20480
s_waitcnt lgkmcnt(3)
ds_read_b128 v[60:63], v1 offset:21504
v_add_f32 v65, v65, v73
v_mfma_f32_32x32x16_bf16 v[32:47], a[64:67], v[48:51], v[32:47]
v_add_f32 v64, v64, v72
s_waitcnt lgkmcnt(3)
v_add_f32 v64, v64, v74
v_add_f32 v65, v65, v75
s_waitcnt lgkmcnt(2)
v_mfma_f32_32x32x16_bf16 v[32:47], a[68:71], v[52:55], v[32:47]
ds_read_b128 v[52:55], v1 offset:23552
ds_read_b128 v[48:51], v1 offset:22528
s_waitcnt lgkmcnt(3)
v_add_f32 v65, v65, v77
v_add_f32 v64, v64, v76
v_mfma_f32_32x32x16_bf16 v[32:47], a[72:75], v[56:59], v[32:47]
v_add_f32 v64, v64, v78
ds_read_b128 v[56:59], v1 offset:24576
s_waitcnt lgkmcnt(3)
v_mfma_f32_32x32x16_bf16 v[32:47], a[76:79], v[60:63], v[32:47]
ds_read_b128 v[60:63], v1 offset:25600
s_waitcnt lgkmcnt(3)
v_add_f32 v64, v64, v80
s_waitcnt lgkmcnt(2)
v_mfma_f32_32x32x16_bf16 v[32:47], a[80:83], v[48:51], v[32:47]
ds_read_b128 v[48:51], v1 offset:26624
s_add_u32 m0, s25, 11264
s_add_u32 s20, s20, s38
buffer_load_dwordx4 v7, s[4:7], s20 offen sc1 lds
v_mfma_f32_32x32x16_bf16 v[32:47], a[84:87], v[52:55], v[32:47]
s_waitcnt lgkmcnt(2)
ds_read_b128 v[52:55], v1 offset:27648
v_add_f32 v65, v65, v79
s_waitcnt lgkmcnt(2)
v_mfma_f32_32x32x16_bf16 v[32:47], a[88:91], v[56:59], v[32:47]
s_waitcnt lgkmcnt(1)
s_add_u32 m0, s35, s37
s_add_u32 s20, s36, s37
buffer_load_dwordx4 v0, s[4:7], s20 offen sc1 lds
v_mfma_f32_32x32x16_bf16 v[32:47], a[92:95], v[60:63], v[32:47]
ds_read_b128 v[56:59], v1 offset:28672
ds_read_b128 v[60:63], v1 offset:29696
s_waitcnt lgkmcnt(2)
v_add_f32 v64, v64, v82
v_add_f32 v65, v65, v81
v_mfma_f32_32x32x16_bf16 v[32:47], a[96:99], v[48:51], v[32:47]
s_add_u32 m0, s35, 4096
s_add_u32 s20, s36, 4096
buffer_load_dwordx4 v0, s[4:7], s20 offen sc1 lds
v_mfma_f32_32x32x16_bf16 v[32:47], a[100:103], v[52:55], v[32:47]
ds_read_b128 v[48:51], v1 offset:30720
s_waitcnt lgkmcnt(2)
ds_read_b128 v[52:55], v1 offset:31744
v_mfma_f32_32x32x16_bf16 v[32:47], a[104:107], v[56:59], v[32:47]
ds_read_b128 v[56:59], v1 offset:32768
v_add_f32 v65, v65, v83
s_waitcnt lgkmcnt(3)
v_add_f32 v64, v64, v84
v_add_f32 v65, v65, v85
v_mfma_f32_32x32x16_bf16 v[32:47], a[108:111], v[60:63], v[32:47]
s_waitcnt lgkmcnt(2)
v_add_f32 v65, v65, v87
s_waitcnt lgkmcnt(1)
v_add_f32 v64, v64, v86
v_mfma_f32_32x32x16_bf16 v[32:47], a[112:115], v[48:51], v[32:47]
s_waitcnt lgkmcnt(0)
ds_read_b128 v[48:51], v1 offset:34816
ds_read_b128 v[60:63], v1 offset:33792
v_add_f32 v64, v64, v65
v_mov_b32 v68, v64
v_mfma_f32_32x32x16_bf16 v[32:47], a[116:119], v[52:55], v[32:47]
s_waitcnt vmcnt(12)
s_barrier
s_mov_b64 exec, 1
buffer_store_dword v3, off, s[4:7], s22 sc1
s_mov_b64 exec, -1
v_mfma_f32_32x32x16_bf16 v[32:47], a[120:123], v[56:59], v[32:47]
ds_read_b128 v[52:55], v1 offset:35840
ds_read_b128 v[56:59], v1 offset:36864
s_waitcnt lgkmcnt(2)
v_mfma_f32_32x32x16_bf16 v[32:47], a[124:127], v[60:63], v[32:47]
ds_read_b128 v[60:63], v1 offset:37888
v_permlane32_swap_b32 v64, v68
v_mul_f32 v68, 0x3acccccd, v68
v_mul_f32 v64, 0x3acccccd, v64
v_mfma_f32_32x32x16_bf16 v[32:47], a[128:131], v[48:51], v[32:47]
s_waitcnt lgkmcnt(2)
v_mfma_f32_32x32x16_bf16 v[32:47], a[132:135], v[52:55], v[32:47]
s_waitcnt lgkmcnt(0)
ds_read_b128 v[48:51], v1 offset:38912
v_fma_f32 v68, -v64, v64, v68
v_max_f32 v68, 0, v68
v_add_f32 v68, 0x3727c5ac, v68
v_mfma_f32_32x32x16_bf16 v[32:47], a[136:139], v[56:59], v[32:47]
ds_read_b128 v[52:55], v1 offset:39936
v_rsq_f32 v68, v68
s_nop 0
v_mul_f32 v64, v68, v64
v_mfma_f32_32x32x16_bf16 v[32:47], a[140:143], v[60:63], v[32:47]
ds_read_b128 v[56:59], v1 offset:40960
s_waitcnt lgkmcnt(2)
v_mfma_f32_32x32x16_bf16 v[32:47], a[144:147], v[48:51], v[32:47]
ds_read_b128 v[60:63], v1 offset:41984
v_mul_f32 v78, v64, v14
v_mul_f32 v85, v64, v21
s_waitcnt lgkmcnt(2)
v_mul_f32 v75, v64, v11
v_mul_f32 v79, v64, v15
v_mfma_f32_32x32x16_bf16 v[32:47], a[148:151], v[52:55], v[32:47]
v_mul_f32 v84, v64, v20
s_waitcnt lgkmcnt(1)
v_mul_f32 v73, v64, v9
v_mul_f32 v72, v64, v8
v_mul_f32 v82, v64, v18
v_mul_f32 v87, v64, v23
v_mfma_f32_32x32x16_bf16 v[32:47], a[152:155], v[56:59], v[32:47]
s_waitcnt lgkmcnt(0)
v_mul_f32 v83, v64, v19
v_mul_f32 v74, v64, v10
v_mul_f32 v81, v64, v17
v_mul_f32 v86, v64, v22
v_mfma_f32_32x32x16_bf16 v[32:47], a[156:159], v[60:63], v[32:47]
s_nop 0
v_mul_f32 v80, v64, v16
v_mul_f32 v76, v64, v12
v_mul_f32 v77, v64, v13
s_nop 7
v_pk_fma_f32 v[40:41], v[40:41], v[68:69], v[80:81] op_sel_hi:[1,0,1] neg_lo:[0,0,1] neg_hi:[0,0,1]
v_pk_fma_f32 v[32:33], v[32:33], v[68:69], v[72:73] op_sel_hi:[1,0,1] neg_lo:[0,0,1] neg_hi:[0,0,1]
v_pk_fma_f32 v[34:35], v[34:35], v[68:69], v[74:75] op_sel_hi:[1,0,1] neg_lo:[0,0,1] neg_hi:[0,0,1]
v_pk_fma_f32 v[42:43], v[42:43], v[68:69], v[82:83] op_sel_hi:[1,0,1] neg_lo:[0,0,1] neg_hi:[0,0,1]
v_cvt_pk_bf16_f32 v48, v32, v33
v_cvt_pk_bf16_f32 v49, v34, v35
v_pk_fma_f32 v[44:45], v[44:45], v[68:69], v[84:85] op_sel_hi:[1,0,1] neg_lo:[0,0,1] neg_hi:[0,0,1]
v_pk_fma_f32 v[46:47], v[46:47], v[68:69], v[86:87] op_sel_hi:[1,0,1] neg_lo:[0,0,1] neg_hi:[0,0,1]
v_pk_fma_f32 v[36:37], v[36:37], v[68:69], v[76:77] op_sel_hi:[1,0,1] neg_lo:[0,0,1] neg_hi:[0,0,1]
v_cvt_pk_bf16_f32 v50, v36, v37
v_cvt_pk_bf16_f32 v52, v40, v41
v_cvt_pk_bf16_f32 v54, v44, v45
v_pk_fma_f32 v[38:39], v[38:39], v[68:69], v[78:79] op_sel_hi:[1,0,1] neg_lo:[0,0,1] neg_hi:[0,0,1]
v_cvt_pk_bf16_f32 v51, v38, v39
v_cvt_pk_bf16_f32 v53, v42, v43
v_cvt_pk_bf16_f32 v55, v46, v47
buffer_store_dwordx4 v[48:51], v5, s[4:7], s27 offen offset:0 sc1
buffer_store_dwordx4 v[52:55], v5, s[4:7], s27 offen offset:512 sc1
s_lshl_b32 s18, s16, 6
s_add_u32 s18, s18, s28
s_add_u32 s27, s27, 524288
s_cmp_eq_u32 s13, 0
s_cselect_b32 s22, s51, s6
s_mov_b32 s23, s18
s_cmp_lg_u32 s33, 0
s_cbranch_scc1 kvx_13
kvm_18:
v_xor_b32 v1, 40960, v1
s_sub_u32 s25, s25, s31
s_xor_b32 s25, s25, 40960
s_add_u32 s25, s25, s31
s_xor_b32 s35, s35, 8192
s_cmp_lt_u32 s30, 64
s_cselect_b32 s53, s26, s6
s_cselect_b32 s36, s54, s6
s_mov_b32 s38, 1024
v_mov_b32 v7, v0
s_add_u32 s26, s26, 40960
s_add_u32 s54, s54, 5120
s_add_u32 s30, s30, 1
s_waitcnt vmcnt(3)
s_barrier
ds_read_b128 v[48:51], v1 offset:2048
s_add_u32 m0, s25, 2048
s_mov_b32 s20, s53
buffer_load_dwordx4 v7, s[4:7], s20 offen sc1 lds
ds_read_b128 v[52:55], v1 offset:3072
ds_read_b128 v[56:59], v1 offset:4096
s_add_u32 m0, s25, 3072
s_add_u32 s20, s20, s38
buffer_load_dwordx4 v7, s[4:7], s20 offen sc1 lds
s_waitcnt lgkmcnt(2)
v_mfma_f32_32x32x16_bf16 v[32:47], a[0:3], v[48:51], 0
ds_read_b128 v[60:63], v1 offset:5120
s_waitcnt lgkmcnt(2)
s_add_u32 m0, s25, 4096
s_add_u32 s20, s20, s38
buffer_load_dwordx4 v7, s[4:7], s20 offen sc1 lds
s_waitcnt lgkmcnt(1)
v_mfma_f32_32x32x16_bf16 v[32:47], a[4:7], v[52:55], v[32:47]
s_add_u32 m0, s25, 5120
s_add_u32 s20, s20, s38
buffer_load_dwordx4 v7, s[4:7], s20 offen sc1 lds
ds_read_b128 v[48:51], v1 offset:6144
ds_read_b128 v[52:55], v1 offset:7168
v_mfma_f32_32x32x16_bf16 v[32:47], a[8:11], v[56:59], v[32:47]
ds_read_b128 v[56:59], v1 offset:8192
s_waitcnt lgkmcnt(3)
v_mfma_f32_32x32x16_bf16 v[32:47], a[12:15], v[60:63], v[32:47]
s_waitcnt lgkmcnt(2)
v_mfma_f32_32x32x16_bf16 v[32:47], a[16:19], v[48:51], v[32:47]
ds_read_b128 v[60:63], v1 offset:9216
ds_read_b128 v[48:51], v1 offset:10240
s_waitcnt lgkmcnt(2)
v_mfma_f32_32x32x16_bf16 v[32:47], a[20:23], v[52:55], v[32:47]
v_mfma_f32_32x32x16_bf16 v[32:47], a[24:27], v[56:59], v[32:47]
ds_read_b128 v[56:59], v1 offset:12288
s_waitcnt lgkmcnt(2)
ds_read_b128 v[52:55], v1 offset:11264
v_mfma_f32_32x32x16_bf16 v[32:47], a[28:31], v[60:63], v[32:47]
s_waitcnt lgkmcnt(2)
s_add_u32 m0, s25, 6144
s_add_u32 s20, s20, s38
buffer_load_dwordx4 v7, s[4:7], s20 offen sc1 lds
ds_read_b128 v[60:63], v1 offset:13312
v_mfma_f32_32x32x16_bf16 v[32:47], a[32:35], v[48:51], v[32:47]
s_waitcnt lgkmcnt(2)
s_add_u32 m0, s25, 7168
s_add_u32 s20, s20, s38
buffer_load_dwordx4 v7, s[4:7], s20 offen sc1 lds
s_waitcnt lgkmcnt(1)
v_mfma_f32_32x32x16_bf16 v[32:47], a[36:39], v[52:55], v[32:47]
ds_read_b128 v[48:51], v1 offset:14336
s_add_u32 m0, s25, 8192
s_add_u32 s20, s20, s38
buffer_load_dwordx4 v7, s[4:7], s20 offen sc1 lds
s_waitcnt lgkmcnt(1)
ds_read_b128 v[52:55], v1 offset:15360
v_mfma_f32_32x32x16_bf16 v[32:47], a[40:43], v[56:59], v[32:47]
ds_read_b128 v[56:59], v1 offset:16384
v_mfma_f32_32x32x16_bf16 v[32:47], a[44:47], v[60:63], v[32:47]
s_waitcnt lgkmcnt(2)
ds_read_b128 v[60:63], v1 offset:17408
v_mfma_f32_32x32x16_bf16 v[32:47], a[48:51], v[48:51], v[32:47]
ds_read_b128 v[48:51], v1 offset:18432
s_waitcnt lgkmcnt(2)
v_mfma_f32_32x32x16_bf16 v[32:47], a[52:55], v[52:55], v[32:47]
ds_read_b128 v[52:55], v1 offset:19456
s_add_u32 m0, s25, 9216
s_add_u32 s20, s20, s38
buffer_load_dwordx4 v7, s[4:7], s20 offen sc1 lds
s_waitcnt lgkmcnt(2)
v_mfma_f32_32x32x16_bf16 v[32:47], a[56:59], v[56:59], v[32:47]
v_mfma_f32_32x32x16_bf16 v[32:47], a[60:63], v[60:63], v[32:47]
ds_read_b128 v[60:63], v1 offset:21504
ds_read_b128 v[56:59], v1 offset:20480
s_waitcnt lgkmcnt(3)
v_mov_b32 v3, s23
v_mfma_f32_32x32x16_bf16 v[32:47], a[64:67], v[48:51], v[32:47]
s_waitcnt lgkmcnt(2)
s_add_u32 m0, s25, 10240
s_add_u32 s20, s20, s38
buffer_load_dwordx4 v7, s[4:7], s20 offen sc1 lds
ds_read_b128 v[48:51], v1 offset:22528
v_mfma_f32_32x32x16_bf16 v[32:47], a[68:71], v[52:55], v[32:47]
ds_read_b128 v[52:55], v1 offset:23552
s_waitcnt lgkmcnt(2)
v_mfma_f32_32x32x16_bf16 v[32:47], a[72:75], v[56:59], v[32:47]
v_mfma_f32_32x32x16_bf16 v[32:47], a[76:79], v[60:63], v[32:47]
s_waitcnt lgkmcnt(0)
ds_read_b128 v[56:59], v1 offset:24576
v_mfma_f32_32x32x16_bf16 v[32:47], a[80:83], v[48:51], v[32:47]
ds_read_b128 v[60:63], v1 offset:25600
s_add_u32 m0, s25, 11264
s_add_u32 s20, s20, s38
buffer_load_dwordx4 v7, s[4:7], s20 offen sc1 lds
v_mfma_f32_32x32x16_bf16 v[32:47], a[84:87], v[52:55], v[32:47]
ds_read_b128 v[48:51], v1 offset:26624
s_waitcnt lgkmcnt(2)
ds_read_b128 v[52:55], v1 offset:27648
v_mfma_f32_32x32x16_bf16 v[32:47], a[88:91], v[56:59], v[32:47]
s_waitcnt lgkmcnt(2)
ds_read_b128 v[56:59], v1 offset:28672
s_add_u32 m0, s35, s37
s_add_u32 s20, s36, s37
buffer_load_dwordx4 v0, s[4:7], s20 offen sc1 lds
v_mfma_f32_32x32x16_bf16 v[32:47], a[92:95], v[60:63], v[32:47]
ds_read_b128 v[60:63], v1 offset:29696
s_waitcnt lgkmcnt(3)
v_mfma_f32_32x32x16_bf16 v[32:47], a[96:99], v[48:51], v[32:47]
s_waitcnt lgkmcnt(1)
ds_read_b128 v[48:51], v1 offset:30720
s_add_u32 m0, s35, 4096
s_add_u32 s20, s36, 4096
buffer_load_dwordx4 v0, s[4:7], s20 offen sc1 lds
v_mfma_f32_32x32x16_bf16 v[32:47], a[100:103], v[52:55], v[32:47]
ds_read_b128 v[52:55], v1 offset:31744
v_mfma_f32_32x32x16_bf16 v[32:47], a[104:107], v[56:59], v[32:47]
s_waitcnt lgkmcnt(2)
s_waitcnt lgkmcnt(1)
v_mfma_f32_32x32x16_bf16 v[32:47], a[108:111], v[60:63], v[32:47]
ds_read_b128 v[56:59], v1 offset:32768
ds_read_b128 v[60:63], v1 offset:33792
v_mfma_f32_32x32x16_bf16 v[32:47], a[112:115], v[48:51], v[32:47]
ds_read_b128 v[48:51], v1 offset:34816
s_waitcnt lgkmcnt(3)
v_mfma_f32_32x32x16_bf16 v[32:47], a[116:119], v[52:55], v[32:47]
s_waitcnt vmcnt(12)
s_barrier
ds_read_b128 v[52:55], v1 offset:35840
s_waitcnt lgkmcnt(3)
v_mfma_f32_32x32x16_bf16 v[32:47], a[120:123], v[56:59], v[32:47]
s_mov_b64 exec, 1
buffer_store_dword v3, off, s[4:7], s22 sc1
s_mov_b64 exec, -1
s_waitcnt lgkmcnt(1)
v_mfma_f32_32x32x16_bf16 v[32:47], a[124:127], v[60:63], v[32:47]
ds_read_b128 v[56:59], v1 offset:36864
s_waitcnt lgkmcnt(1)
ds_read_b128 v[60:63], v1 offset:37888
v_mfma_f32_32x32x16_bf16 v[32:47], a[128:131], v[48:51], v[32:47]
v_mfma_f32_32x32x16_bf16 v[32:47], a[132:135], v[52:55], v[32:47]
s_waitcnt lgkmcnt(1)
ds_read_b128 v[52:55], v1 offset:39936
ds_read_b128 v[48:51], v1 offset:38912
v_mfma_f32_32x32x16_bf16 v[32:47], a[136:139], v[56:59], v[32:47]
s_waitcnt lgkmcnt(2)
v_mfma_f32_32x32x16_bf16 v[32:47], a[140:143], v[60:63], v[32:47]
ds_read_b128 v[56:59], v1 offset:40960
ds_read_b128 v[60:63], v1 offset:41984
s_waitcnt lgkmcnt(2)
v_mfma_f32_32x32x16_bf16 v[32:47], a[144:147], v[48:51], v[32:47]
v_mfma_f32_32x32x16_bf16 v[32:47], a[148:151], v[52:55], v[32:47]
s_waitcnt lgkmcnt(1)
v_mfma_f32_32x32x16_bf16 v[32:47], a[152:155], v[56:59], v[32:47]
s_waitcnt lgkmcnt(0)
v_mfma_f32_32x32x16_bf16 v[32:47], a[156:159], v[60:63], v[32:47]
s_nop 11
v_cvt_pk_bf16_f32 v49, v34, v35
v_cvt_pk_bf16_f32 v48, v32, v33
v_cvt_pk_bf16_f32 v53, v42, v43
v_cvt_pk_bf16_f32 v51, v38, v39
v_cvt_pk_bf16_f32 v54, v44, v45
v_cvt_pk_bf16_f32 v50, v36, v37
v_cvt_pk_bf16_f32 v52, v40, v41
v_cvt_pk_bf16_f32 v55, v46, v47
buffer_store_dwordx4 v[48:51], v5, s[4:7], s50 offen offset:0 sc1
buffer_store_dwordx4 v[52:55], v5, s[4:7], s50 offen offset:512 sc1
s_add_u32 s39, s39, 1
s_add_u32 s50, s50, 524288
s_add_u32 s18, s51, 8192
s_cmp_eq_u32 s13, 0
s_cselect_b32 s22, s18, s6
s_mov_b32 s23, s39
s_cmp_lt_u32 s28, 64
s_cbranch_scc1 kvx_13
s_and_b32 s18, s39, 15
s_cbranch_scc0 kvt_19
s_waitcnt vmcnt(0)
s_barrier
v_mov_b32 v3, s23
s_mov_b64 exec, 1
buffer_store_dword v3, off, s[4:7], s22 sc1
s_mov_b64 exec, -1
s_mov_b32 s22, s6
s_lshl_b32 s18, s39, 2
s_add_u32 s18, s18, 4
s_cmp_lg_u32 s13, 0
s_cbranch_scc1 polld_25
v_lshlrev_b32 v3, 3, v0
v_min_u32 v28, 1152, v3
s_mov_b32 s21, 11550720
s_mov_b32 s17, 0
poll_24:
buffer_load_dword v24, v28, s[4:7], s21 offen sc1
s_add_u32 s17, s17, 1
s_cmp_gt_u32 s17, 262144
s_cbranch_scc1 L_fail
s_waitcnt vmcnt(0)
v_cmp_gt_u32 vcc, s18, v24
s_cbranch_vccz polld_25
s_sleep 2
s_branch poll_24
polld_25:
s_barrier
s_mov_b32 s53, s52
s_mov_b32 s36, s6
s_mov_b32 s38, 256
v_mov_b32 v7, v6
s_add_u32 s52, s52, 40960
s_add_u32 m0, s25, 2048
s_mov_b32 s20, s53
buffer_load_dwordx4 v7, s[4:7], s20 offen sc1 lds
s_add_u32 m0, s25, 3072
s_add_u32 s20, s20, s38
buffer_load_dwordx4 v7, s[4:7], s20 offen sc1 lds
s_add_u32 m0, s25, 4096
s_add_u32 s20, s20, s38
buffer_load_dwordx4 v7, s[4:7], s20 offen sc1 lds
s_add_u32 m0, s25, 5120
s_add_u32 s20, s20, s38
buffer_load_dwordx4 v7, s[4:7], s20 offen sc1 lds
s_add_u32 m0, s25, 6144
s_add_u32 s20, s20, s38
buffer_load_dwordx4 v7, s[4:7], s20 offen sc1 lds
s_add_u32 m0, s25, 7168
s_add_u32 s20, s20, s38
buffer_load_dwordx4 v7, s[4:7], s20 offen sc1 lds
s_add_u32 m0, s25, 8192
s_add_u32 s20, s20, s38
buffer_load_dwordx4 v7, s[4:7], s20 offen sc1 lds
s_add_u32 m0, s25, 9216
s_add_u32 s20, s20, s38
buffer_load_dwordx4 v7, s[4:7], s20 offen sc1 lds
s_add_u32 m0, s25, 10240
s_add_u32 s20, s20, s38
buffer_load_dwordx4 v7, s[4:7], s20 offen sc1 lds
s_add_u32 m0, s25, 11264
s_add_u32 s20, s20, s38
buffer_load_dwordx4 v7, s[4:7], s20 offen sc1 lds
s_waitcnt vmcnt(0)
s_branch kvm_18
kv_17:
s_lshl_b32 s18, s39, 2
s_add_u32 s18, s18, 4
s_cmp_lg_u32 s13, 0
s_cbranch_scc1 polld_27
v_lshlrev_b32 v3, 3, v0
v_min_u32 v28, 1152, v3
s_mov_b32 s21, 11550720
s_mov_b32 s17, 0
poll_26:
buffer_load_dword v24, v28, s[4:7], s21 offen sc1
s_add_u32 s17, s17, 1
s_cmp_gt_u32 s17, 262144
s_cbranch_scc1 L_fail
s_waitcnt vmcnt(0)
v_cmp_gt_u32 vcc, s18, v24
s_cbranch_vccz polld_27
s_sleep 2
s_branch poll_26
polld_27:
s_barrier
s_mov_b32 s53, s52
s_mov_b32 s36, s6
s_mov_b32 s38, 256
v_mov_b32 v7, v6
s_add_u32 s52, s52, 40960
s_branch kvn_14
kvt_19:
s_waitcnt vmcnt(0)
s_barrier
v_mov_b32 v3, s23
s_mov_b64 exec, 1
buffer_store_dword v3, off, s[4:7], s22 sc1
s_mov_b64 exec, -1
s_mov_b32 s22, s6
s_add_u32 s16, s16, 1
s_cmp_lt_u32 s16, 2
s_cbranch_scc1 kvlay_12
s_endpgm
roleV_10:
s_load_dwordx2 s[40:41], s[0:1], 16
s_mov_b32 s42, 1314816
s_mov_b32 s43, 0x20000
s_waitcnt lgkmcnt(0)
v_bfe_u32 v6, v0, 4, 2
v_lshrrev_b32 v7, 6, v0
v_mul_u32_u24 v8, 642, v6
v_lshl_add_u32 v8, v7, 2, v8
v_lshlrev_b32 v6, 4, v6
v_lshl_add_u32 v6, v7, 14, v6
s_and_b32 s18, s32, 3
s_bfe_u32 s19, s32, 0x20002
s_lshr_b32 s20, s32, 4
s_lshl_b32 s26, s20, 2
s_add_u32 s26, s26, s18
s_lshl_b32 s27, s26, 8
s_lshl_b32 s26, s26, 4
s_add_u32 s26, s26, s19
s_lshl_b32 s26, s26, 2
s_add_u32 s26, s26, s13
s_mul_i32 s26, s26, 2568
s_lshl_b32 s19, s19, 12
s_add_u32 s27, s27, s19
s_lshl_b32 s19, s13, 6
s_add_u32 s27, s27, s19
s_add_u32 s27, s27, 167774208
s_add_u32 s18, s26, 2
buffer_load_dword v20, v8, s[40:43], s18 offen offset:0
buffer_load_dword v24, v8, s[40:43], s18 offen offset:64
buffer_load_dword v28, v8, s[40:43], s18 offen offset:128
buffer_load_dword v32, v8, s[40:43], s18 offen offset:192
buffer_load_dword v36, v8, s[40:43], s18 offen offset:256
buffer_load_dword v40, v8, s[40:43], s18 offen offset:320
buffer_load_dword v44, v8, s[40:43], s18 offen offset:384
buffer_load_dword v48, v8, s[40:43], s18 offen offset:448
buffer_load_dword v52, v8, s[40:43], s18 offen offset:512
buffer_load_dword v56, v8, s[40:43], s18 offen offset:576
s_add_u32 s18, s26, 41090
buffer_load_dword v21, v8, s[40:43], s18 offen offset:0
buffer_load_dword v25, v8, s[40:43], s18 offen offset:64
buffer_load_dword v29, v8, s[40:43], s18 offen offset:128
buffer_load_dword v33, v8, s[40:43], s18 offen offset:192
buffer_load_dword v37, v8, s[40:43], s18 offen offset:256
buffer_load_dword v41, v8, s[40:43], s18 offen offset:320
buffer_load_dword v45, v8, s[40:43], s18 offen offset:384
buffer_load_dword v49, v8, s[40:43], s18 offen offset:448
buffer_load_dword v53, v8, s[40:43], s18 offen offset:512
buffer_load_dword v57, v8, s[40:43], s18 offen offset:576
s_add_u32 s18, s26, 82178
buffer_load_dword v22, v8, s[40:43], s18 offen offset:0
buffer_load_dword v26, v8, s[40:43], s18 offen offset:64
buffer_load_dword v30, v8, s[40:43], s18 offen offset:128
buffer_load_dword v34, v8, s[40:43], s18 offen offset:192
buffer_load_dword v38, v8, s[40:43], s18 offen offset:256
buffer_load_dword v42, v8, s[40:43], s18 offen offset:320
buffer_load_dword v46, v8, s[40:43], s18 offen offset:384
buffer_load_dword v50, v8, s[40:43], s18 offen offset:448
buffer_load_dword v54, v8, s[40:43], s18 offen offset:512
buffer_load_dword v58, v8, s[40:43], s18 offen offset:576
s_add_u32 s18, s26, 123266
buffer_load_dword v23, v8, s[40:43], s18 offen offset:0
buffer_load_dword v27, v8, s[40:43], s18 offen offset:64
buffer_load_dword v31, v8, s[40:43], s18 offen offset:128
buffer_load_dword v35, v8, s[40:43], s18 offen offset:192
buffer_load_dword v39, v8, s[40:43], s18 offen offset:256
buffer_load_dword v43, v8, s[40:43], s18 offen offset:320
buffer_load_dword v47, v8, s[40:43], s18 offen offset:384
buffer_load_dword v51, v8, s[40:43], s18 offen offset:448
buffer_load_dword v55, v8, s[40:43], s18 offen offset:512
buffer_load_dword v59, v8, s[40:43], s18 offen offset:576
s_waitcnt vmcnt(9)
buffer_store_dwordx4 v[20:23], v6, s[4:7], s27 offen sc1
s_add_u32 s27, s27, 262144
s_waitcnt vmcnt(9)
buffer_store_dwordx4 v[24:27], v6, s[4:7], s27 offen sc1
s_add_u32 s27, s27, 262144
s_waitcnt vmcnt(9)
buffer_store_dwordx4 v[28:31], v6, s[4:7], s27 offen sc1
s_add_u32 s27, s27, 262144
s_waitcnt vmcnt(9)
buffer_store_dwordx4 v[32:35], v6, s[4:7], s27 offen sc1
s_add_u32 s27, s27, 262144
s_waitcnt vmcnt(9)
buffer_store_dwordx4 v[36:39], v6, s[4:7], s27 offen sc1
s_add_u32 s27, s27, 262144
s_waitcnt vmcnt(9)
buffer_store_dwordx4 v[40:43], v6, s[4:7], s27 offen sc1
s_add_u32 s27, s27, 262144
s_waitcnt vmcnt(9)
buffer_store_dwordx4 v[44:47], v6, s[4:7], s27 offen sc1
s_add_u32 s27, s27, 262144
s_waitcnt vmcnt(9)
buffer_store_dwordx4 v[48:51], v6, s[4:7], s27 offen sc1
s_add_u32 s27, s27, 262144
s_waitcnt vmcnt(9)
buffer_store_dwordx4 v[52:55], v6, s[4:7], s27 offen sc1
s_add_u32 s27, s27, 262144
s_waitcnt vmcnt(9)
buffer_store_dwordx4 v[56:59], v6, s[4:7], s27 offen sc1
s_add_u32 s27, s27, 262144
s_lshl_b32 s18, s15, 7
s_add_u32 s18, s18, 11563008
s_cmp_eq_u32 s13, 0
s_cselect_b32 s22, s18, s6
s_mov_b32 s23, 1
s_waitcnt vmcnt(0)
s_barrier
v_mov_b32 v3, s23
s_mov_b64 exec, 1
buffer_store_dword v3, off, s[4:7], s22 sc1
s_mov_b64 exec, -1
s_mov_b32 s22, s6
s_lshl_b32 s26, s32, 8
s_lshl_b32 s18, s13, 6
s_add_u32 s26, s26, s18
s_load_dwordx2 s[40:41], s[0:1], 56
s_mov_b32 s42, 5242880
s_mov_b32 s43, 0x20000
s_waitcnt lgkmcnt(0)
v_lshrrev_b32 v20, 6, v0
v_mul_u32_u24 v20, 8192, v20
v_and_b32 v21, 48, v0
v_add_u32 v18, v20, v21
v_bfe_u32 v20, v0, 6, 2
v_lshrrev_b32 v21, 9, v0
v_lshl_add_u32 v20, v21, 3, v20
v_lshlrev_b32 v19, 6, v20
v_and_b32 v20, 48, v0
v_add_u32 v19, v19, v20
v_bfe_u32 v20, v0, 8, 1
v_lshl_add_u32 v19, v20, 3, v19
s_mul_i32 s18, s13, 36864
v_add_u32 v19, s18, v19
s_barrier
s_add_u32 m0, s18, 0
s_add_u32 s19, s26, 0
buffer_load_dwordx4 v18, s[40:43], s19 offen lds
s_add_u32 m0, s18, 1024
s_add_u32 s19, s26, 131072
buffer_load_dwordx4 v18, s[40:43], s19 offen lds
s_add_u32 m0, s18, 2048
s_add_u32 s19, s26, 262144
buffer_load_dwordx4 v18, s[40:43], s19 offen lds
s_add_u32 m0, s18, 3072
s_add_u32 s19, s26, 393216
buffer_load_dwordx4 v18, s[40:43], s19 offen lds
s_add_u32 m0, s18, 4096
s_add_u32 s19, s26, 524288
buffer_load_dwordx4 v18, s[40:43], s19 offen lds
s_add_u32 m0, s18, 5120
s_add_u32 s19, s26, 655360
buffer_load_dwordx4 v18, s[40:43], s19 offen lds
s_add_u32 m0, s18, 6144
s_add_u32 s19, s26, 786432
buffer_load_dwordx4 v18, s[40:43], s19 offen lds
s_add_u32 m0, s18, 7168
s_add_u32 s19, s26, 917504
buffer_load_dwordx4 v18, s[40:43], s19 offen lds
s_add_u32 m0, s18, 8192
s_add_u32 s19, s26, 1048576
buffer_load_dwordx4 v18, s[40:43], s19 offen lds
s_add_u32 m0, s18, 9216
s_add_u32 s19, s26, 1179648
buffer_load_dwordx4 v18, s[40:43], s19 offen lds
s_add_u32 m0, s18, 10240
s_add_u32 s19, s26, 1310720
buffer_load_dwordx4 v18, s[40:43], s19 offen lds
s_add_u32 m0, s18, 11264
s_add_u32 s19, s26, 1441792
buffer_load_dwordx4 v18, s[40:43], s19 offen lds
s_add_u32 m0, s18, 12288
s_add_u32 s19, s26, 1572864
buffer_load_dwordx4 v18, s[40:43], s19 offen lds
s_add_u32 m0, s18, 13312
s_add_u32 s19, s26, 1703936
buffer_load_dwordx4 v18, s[40:43], s19 offen lds
s_add_u32 m0, s18, 14336
s_add_u32 s19, s26, 1835008
buffer_load_dwordx4 v18, s[40:43], s19 offen lds
s_add_u32 m0, s18, 15360
s_add_u32 s19, s26, 1966080
buffer_load_dwordx4 v18, s[40:43], s19 offen lds
s_add_u32 m0, s18, 16384
s_add_u32 s19, s26, 2097152
buffer_load_dwordx4 v18, s[40:43], s19 offen lds
s_add_u32 m0, s18, 17408
s_add_u32 s19, s26, 2228224
buffer_load_dwordx4 v18, s[40:43], s19 offen lds
s_add_u32 m0, s18, 18432
s_add_u32 s19, s26, 2359296
buffer_load_dwordx4 v18, s[40:43], s19 offen lds
s_add_u32 m0, s18, 19456
s_add_u32 s19, s26, 2490368
buffer_load_dwordx4 v18, s[40:43], s19 offen lds
s_add_u32 m0, s18, 20480
s_add_u32 s19, s26, 2621440
buffer_load_dwordx4 v18, s[40:43], s19 offen lds
s_add_u32 m0, s18, 21504
s_add_u32 s19, s26, 2752512
buffer_load_dwordx4 v18, s[40:43], s19 offen lds
s_add_u32 m0, s18, 22528
s_add_u32 s19, s26, 2883584
buffer_load_dwordx4 v18, s[40:43], s19 offen lds
s_add_u32 m0, s18, 23552
s_add_u32 s19, s26, 3014656
buffer_load_dwordx4 v18, s[40:43], s19 offen lds
s_add_u32 m0, s18, 24576
s_add_u32 s19, s26, 3145728
buffer_load_dwordx4 v18, s[40:43], s19 offen lds
s_add_u32 m0, s18, 25600
s_add_u32 s19, s26, 3276800
buffer_load_dwordx4 v18, s[40:43], s19 offen lds
s_add_u32 m0, s18, 26624
s_add_u32 s19, s26, 3407872
buffer_load_dwordx4 v18, s[40:43], s19 offen lds
s_add_u32 m0, s18, 27648
s_add_u32 s19, s26, 3538944
buffer_load_dwordx4 v18, s[40:43], s19 offen lds
s_add_u32 m0, s18, 28672
s_add_u32 s19, s26, 3670016
buffer_load_dwordx4 v18, s[40:43], s19 offen lds
s_add_u32 m0, s18, 29696
s_add_u32 s19, s26, 3801088
buffer_load_dwordx4 v18, s[40:43], s19 offen lds
s_add_u32 m0, s18, 30720
s_add_u32 s19, s26, 3932160
buffer_load_dwordx4 v18, s[40:43], s19 offen lds
s_add_u32 m0, s18, 31744
s_add_u32 s19, s26, 4063232
buffer_load_dwordx4 v18, s[40:43], s19 offen lds
s_add_u32 m0, s18, 32768
s_add_u32 s19, s26, 4194304
buffer_load_dwordx4 v18, s[40:43], s19 offen lds
s_add_u32 m0, s18, 33792
s_add_u32 s19, s26, 4325376
buffer_load_dwordx4 v18, s[40:43], s19 offen lds
s_add_u32 m0, s18, 34816
s_add_u32 s19, s26, 4456448
buffer_load_dwordx4 v18, s[40:43], s19 offen lds
s_add_u32 m0, s18, 35840
s_add_u32 s19, s26, 4587520
buffer_load_dwordx4 v18, s[40:43], s19 offen lds
s_waitcnt vmcnt(32)
ds_read_b64_tr_b16 a[0:1], v19 offset:0
ds_read_b64_tr_b16 a[2:3], v19 offset:256
ds_read_b64_tr_b16 a[4:5], v19 offset:1024
ds_read_b64_tr_b16 a[6:7], v19 offset:1280
ds_read_b64_tr_b16 a[8:9], v19 offset:2048
ds_read_b64_tr_b16 a[10:11], v19 offset:2304
ds_read_b64_tr_b16 a[12:13], v19 offset:3072
ds_read_b64_tr_b16 a[14:15], v19 offset:3328
s_waitcnt lgkmcnt(0)
s_add_u32 m0, s18, 0
s_add_u32 s19, s26, 4718592
buffer_load_dwordx4 v18, s[40:43], s19 offen lds
s_add_u32 m0, s18, 1024
s_add_u32 s19, s26, 4849664
buffer_load_dwordx4 v18, s[40:43], s19 offen lds
s_add_u32 m0, s18, 2048
s_add_u32 s19, s26, 4980736
buffer_load_dwordx4 v18, s[40:43], s19 offen lds
s_add_u32 m0, s18, 3072
s_add_u32 s19, s26, 5111808
buffer_load_dwordx4 v18, s[40:43], s19 offen lds
s_waitcnt vmcnt(32)
ds_read_b64_tr_b16 a[16:17], v19 offset:4096
ds_read_b64_tr_b16 a[18:19], v19 offset:4352
ds_read_b64_tr_b16 a[20:21], v19 offset:5120
ds_read_b64_tr_b16 a[22:23], v19 offset:5376
ds_read_b64_tr_b16 a[24:25], v19 offset:6144
ds_read_b64_tr_b16 a[26:27], v19 offset:6400
ds_read_b64_tr_b16 a[28:29], v19 offset:7168
ds_read_b64_tr_b16 a[30:31], v19 offset:7424
s_waitcnt vmcnt(28)
ds_read_b64_tr_b16 a[32:33], v19 offset:8192
ds_read_b64_tr_b16 a[34:35], v19 offset:8448
ds_read_b64_tr_b16 a[36:37], v19 offset:9216
ds_read_b64_tr_b16 a[38:39], v19 offset:9472
ds_read_b64_tr_b16 a[40:41], v19 offset:10240
ds_read_b64_tr_b16 a[42:43], v19 offset:10496
ds_read_b64_tr_b16 a[44:45], v19 offset:11264
ds_read_b64_tr_b16 a[46:47], v19 offset:11520
s_waitcnt vmcnt(24)
ds_read_b64_tr_b16 a[48:49], v19 offset:12288
ds_read_b64_tr_b16 a[50:51], v19 offset:12544
ds_read_b64_tr_b16 a[52:53], v19 offset:13312
ds_read_b64_tr_b16 a[54:55], v19 offset:13568
ds_read_b64_tr_b16 a[56:57], v19 offset:14336
ds_read_b64_tr_b16 a[58:59], v19 offset:14592
ds_read_b64_tr_b16 a[60:61], v19 offset:15360
ds_read_b64_tr_b16 a[62:63], v19 offset:15616
s_waitcnt vmcnt(20)
ds_read_b64_tr_b16 a[64:65], v19 offset:16384
ds_read_b64_tr_b16 a[66:67], v19 offset:16640
ds_read_b64_tr_b16 a[68:69], v19 offset:17408
ds_read_b64_tr_b16 a[70:71], v19 offset:17664
ds_read_b64_tr_b16 a[72:73], v19 offset:18432
ds_read_b64_tr_b16 a[74:75], v19 offset:18688
ds_read_b64_tr_b16 a[76:77], v19 offset:19456
ds_read_b64_tr_b16 a[78:79], v19 offset:19712
s_waitcnt vmcnt(16)
ds_read_b64_tr_b16 a[80:81], v19 offset:20480
ds_read_b64_tr_b16 a[82:83], v19 offset:20736
ds_read_b64_tr_b16 a[84:85], v19 offset:21504
ds_read_b64_tr_b16 a[86:87], v19 offset:21760
ds_read_b64_tr_b16 a[88:89], v19 offset:22528
ds_read_b64_tr_b16 a[90:91], v19 offset:22784
ds_read_b64_tr_b16 a[92:93], v19 offset:23552
ds_read_b64_tr_b16 a[94:95], v19 offset:23808
s_waitcnt vmcnt(12)
ds_read_b64_tr_b16 a[96:97], v19 offset:24576
ds_read_b64_tr_b16 a[98:99], v19 offset:24832
ds_read_b64_tr_b16 a[100:101], v19 offset:25600
ds_read_b64_tr_b16 a[102:103], v19 offset:25856
ds_read_b64_tr_b16 a[104:105], v19 offset:26624
ds_read_b64_tr_b16 a[106:107], v19 offset:26880
ds_read_b64_tr_b16 a[108:109], v19 offset:27648
ds_read_b64_tr_b16 a[110:111], v19 offset:27904
s_waitcnt vmcnt(8)
ds_read_b64_tr_b16 a[112:113], v19 offset:28672
ds_read_b64_tr_b16 a[114:115], v19 offset:28928
ds_read_b64_tr_b16 a[116:117], v19 offset:29696
ds_read_b64_tr_b16 a[118:119], v19 offset:29952
ds_read_b64_tr_b16 a[120:121], v19 offset:30720
ds_read_b64_tr_b16 a[122:123], v19 offset:30976
ds_read_b64_tr_b16 a[124:125], v19 offset:31744
ds_read_b64_tr_b16 a[126:127], v19 offset:32000
s_waitcnt vmcnt(4)
ds_read_b64_tr_b16 a[128:129], v19 offset:32768
ds_read_b64_tr_b16 a[130:131], v19 offset:33024
ds_read_b64_tr_b16 a[132:133], v19 offset:33792
ds_read_b64_tr_b16 a[134:135], v19 offset:34048
ds_read_b64_tr_b16 a[136:137], v19 offset:34816
ds_read_b64_tr_b16 a[138:139], v19 offset:35072
ds_read_b64_tr_b16 a[140:141], v19 offset:35840
ds_read_b64_tr_b16 a[142:143], v19 offset:36096
s_waitcnt vmcnt(0)
ds_read_b64_tr_b16 a[144:145], v19 offset:0
ds_read_b64_tr_b16 a[146:147], v19 offset:256
ds_read_b64_tr_b16 a[148:149], v19 offset:1024
ds_read_b64_tr_b16 a[150:151], v19 offset:1280
ds_read_b64_tr_b16 a[152:153], v19 offset:2048
ds_read_b64_tr_b16 a[154:155], v19 offset:2304
ds_read_b64_tr_b16 a[156:157], v19 offset:3072
ds_read_b64_tr_b16 a[158:159], v19 offset:3328
s_waitcnt lgkmcnt(0)
s_barrier
s_load_dwordx2 s[40:41], s[0:1], 64
s_mov_b32 s42, 5242880
s_mov_b32 s43, 0x20000
s_waitcnt lgkmcnt(0)
v_lshlrev_b32 v6, 3, v0
s_mul_i32 s18, s32, 163840
s_mul_i32 s19, s13, 40960
s_add_u32 s18, s18, s19
buffer_load_dword v12, v6, s[40:43], s18 offen
s_add_u32 s18, s18, 8192
buffer_load_dword v13, v6, s[40:43], s18 offen
s_add_u32 s18, s18, 8192
buffer_load_dword v14, v6, s[40:43], s18 offen
s_add_u32 s18, s18, 8192
buffer_load_dword v15, v6, s[40:43], s18 offen
s_add_u32 s18, s18, 8192
buffer_load_dword v16, v6, s[40:43], s18 offen
s_add_u32 s18, s18, 8192
v_mov_b32 v20, s24
v_mov_b32 v21, s24
v_mov_b32 v22, s24
v_mov_b32 v23, s24
s_nop 1
v_mfma_f32_32x32x16_bf16 v[24:39], v[20:23], a[0:3], 0
v_mfma_f32_32x32x16_bf16 v[24:39], v[20:23], a[4:7], v[24:39]
v_mfma_f32_32x32x16_bf16 v[24:39], v[20:23], a[8:11], v[24:39]
v_mfma_f32_32x32x16_bf16 v[24:39], v[20:23], a[12:15], v[24:39]
v_mfma_f32_32x32x16_bf16 v[24:39], v[20:23], a[16:19], v[24:39]
v_mfma_f32_32x32x16_bf16 v[24:39], v[20:23], a[20:23], v[24:39]
v_mfma_f32_32x32x16_bf16 v[24:39], v[20:23], a[24:27], v[24:39]
v_mfma_f32_32x32x16_bf16 v[24:39], v[20:23], a[28:31], v[24:39]
v_mfma_f32_32x32x16_bf16 v[24:39], v[20:23], a[32:35], v[24:39]
v_mfma_f32_32x32x16_bf16 v[24:39], v[20:23], a[36:39], v[24:39]
v_mfma_f32_32x32x16_bf16 v[24:39], v[20:23], a[40:43], v[24:39]
v_mfma_f32_32x32x16_bf16 v[24:39], v[20:23], a[44:47], v[24:39]
v_mfma_f32_32x32x16_bf16 v[24:39], v[20:23], a[48:51], v[24:39]
v_mfma_f32_32x32x16_bf16 v[24:39], v[20:23], a[52:55], v[24:39]
v_mfma_f32_32x32x16_bf16 v[24:39], v[20:23], a[56:59], v[24:39]
v_mfma_f32_32x32x16_bf16 v[24:39], v[20:23], a[60:63], v[24:39]
v_mfma_f32_32x32x16_bf16 v[24:39], v[20:23], a[64:67], v[24:39]
v_mfma_f32_32x32x16_bf16 v[24:39], v[20:23], a[68:71], v[24:39]
v_mfma_f32_32x32x16_bf16 v[24:39], v[20:23], a[72:75], v[24:39]
v_mfma_f32_32x32x16_bf16 v[24:39], v[20:23], a[76:79], v[24:39]
v_mfma_f32_32x32x16_bf16 v[24:39], v[20:23], a[80:83], v[24:39]
v_mfma_f32_32x32x16_bf16 v[24:39], v[20:23], a[84:87], v[24:39]
v_mfma_f32_32x32x16_bf16 v[24:39], v[20:23], a[88:91], v[24:39]
v_mfma_f32_32x32x16_bf16 v[24:39], v[20:23], a[92:95], v[24:39]
v_mfma_f32_32x32x16_bf16 v[24:39], v[20:23], a[96:99], v[24:39]
v_mfma_f32_32x32x16_bf16 v[24:39], v[20:23], a[100:103], v[24:39]
v_mfma_f32_32x32x16_bf16 v[24:39], v[20:23], a[104:107], v[24:39]
v_mfma_f32_32x32x16_bf16 v[24:39], v[20:23], a[108:111], v[24:39]
v_mfma_f32_32x32x16_bf16 v[24:39], v[20:23], a[112:115], v[24:39]
v_mfma_f32_32x32x16_bf16 v[24:39], v[20:23], a[116:119], v[24:39]
v_mfma_f32_32x32x16_bf16 v[24:39], v[20:23], a[120:123], v[24:39]
v_mfma_f32_32x32x16_bf16 v[24:39], v[20:23], a[124:127], v[24:39]
v_mfma_f32_32x32x16_bf16 v[24:39], v[20:23], a[128:131], v[24:39]
v_mfma_f32_32x32x16_bf16 v[24:39], v[20:23], a[132:135], v[24:39]
v_mfma_f32_32x32x16_bf16 v[24:39], v[20:23], a[136:139], v[24:39]
v_mfma_f32_32x32x16_bf16 v[24:39], v[20:23], a[140:143], v[24:39]
v_mfma_f32_32x32x16_bf16 v[24:39], v[20:23], a[144:147], v[24:39]
v_mfma_f32_32x32x16_bf16 v[24:39], v[20:23], a[148:151], v[24:39]
v_mfma_f32_32x32x16_bf16 v[24:39], v[20:23], a[152:155], v[24:39]
v_mfma_f32_32x32x16_bf16 v[24:39], v[20:23], a[156:159], v[24:39]
s_nop 11
v_mov_b32 v5, v24
v_and_b32 v6, 0xf0, v0
s_waitcnt vmcnt(4)
v_bfe_u32 v12, v0, 8, 1
v_lshl_add_u32 v6, v12, 10, v6
v_lshrrev_b32 v12, 9, v0
v_lshl_add_u32 v6, v12, 8, v6
s_lshl_b32 s34, s13, 12
s_add_u32 s34, s34, 2048
s_lshl_b32 s18, s32, 14
s_add_u32 s34, s34, s18
v_bfe_u32 v7, v0, 7, 2
v_mul_u32_u24 v7, 10240, v7
v_bfe_u32 v12, v0, 5, 2
v_lshl_add_u32 v7, v12, 6, v7
v_lshrrev_b32 v12, 9, v0
v_lshl_add_u32 v7, v12, 5, v7
v_and_b32 v12, 16, v0
v_add_u32 v7, v12, v7
s_lshl_b32 s51, s32, 8
s_add_u32 s51, s51, 11534464
s_mul_i32 s52, s13, 2560
s_add_u32 s52, s52, 12582912
s_add_u32 s50, s34, 110100480
s_mov_b32 s39, 0
kvlay_28:
s_mul_i32 s26, s16, 6291456
s_add_u32 s26, s26, 88080384
s_add_u32 s26, s26, s31
s_mul_i32 s54, s16, 327680
s_add_u32 s54, s54, 163577856
s_mul_i32 s27, s16, 35651584
s_add_u32 s27, s27, 16777216
s_mul_i32 s18, s32, 0
s_add_u32 s27, s27, s18
s_add_u32 s27, s27, s34
s_lshl_b32 s29, s16, 1
s_add_u32 s29, s29, 1
s_mov_b32 s28, 0
s_mov_b32 s30, 0
s_cmp_lt_u32 s30, 64
s_cselect_b32 s53, s26, s6
s_cselect_b32 s36, s54, s6
s_mov_b32 s38, 1024
v_mov_b32 v8, v0
s_add_u32 s26, s26, 40960
s_add_u32 s54, s54, 5120
s_add_u32 s30, s30, 1
v_xor_b32 v1, 40960, v0
s_mov_b32 s25, s31
s_mov_b32 s35, 131072
s_cmp_lg_u32 s13, 0
s_cbranch_scc1 polld_37
v_lshlrev_b32 v3, 3, v0
s_waitcnt vmcnt(0)
v_min_u32 v16, 1152, v3
s_mov_b32 s21, 11612160
s_mov_b32 s17, 0
poll_36:
buffer_load_dword v12, v16, s[4:7], s21 offen sc1
s_add_u32 s17, s17, 1
s_cmp_gt_u32 s17, 262144
s_cbranch_scc1 L_fail
s_waitcnt vmcnt(0)
v_cmp_gt_u32 vcc, s29, v12
s_cbranch_vccz polld_37
s_sleep 2
s_branch poll_36
polld_37:
s_barrier
s_add_u32 m0, s25, 2048
s_mov_b32 s20, s53
buffer_load_dwordx4 v8, s[4:7], s20 offen sc1 lds
s_add_u32 m0, s25, 3072
s_add_u32 s20, s20, s38
buffer_load_dwordx4 v8, s[4:7], s20 offen sc1 lds
s_add_u32 m0, s25, 4096
s_add_u32 s20, s20, s38
buffer_load_dwordx4 v8, s[4:7], s20 offen sc1 lds
s_add_u32 m0, s25, 5120
s_add_u32 s20, s20, s38
buffer_load_dwordx4 v8, s[4:7], s20 offen sc1 lds
s_add_u32 m0, s25, 6144
s_add_u32 s20, s20, s38
buffer_load_dwordx4 v8, s[4:7], s20 offen sc1 lds
s_add_u32 m0, s25, 7168
s_add_u32 s20, s20, s38
buffer_load_dwordx4 v8, s[4:7], s20 offen sc1 lds
s_add_u32 m0, s25, 8192
s_add_u32 s20, s20, s38
buffer_load_dwordx4 v8, s[4:7], s20 offen sc1 lds
s_add_u32 m0, s25, 9216
s_add_u32 s20, s20, s38
buffer_load_dwordx4 v8, s[4:7], s20 offen sc1 lds
s_add_u32 m0, s25, 10240
s_add_u32 s20, s20, s38
buffer_load_dwordx4 v8, s[4:7], s20 offen sc1 lds
s_add_u32 m0, s25, 11264
s_add_u32 s20, s20, s38
buffer_load_dwordx4 v8, s[4:7], s20 offen sc1 lds
s_add_u32 m0, s35, s37
s_add_u32 s20, s36, s37
buffer_load_dwordx4 v0, s[4:7], s20 offen sc1 lds
s_add_u32 m0, s35, 4096
s_add_u32 s20, s36, 4096
buffer_load_dwordx4 v0, s[4:7], s20 offen sc1 lds
s_waitcnt vmcnt(0)
kvx_29:
v_xor_b32 v1, 40960, v1
s_sub_u32 s25, s25, s31
s_xor_b32 s25, s25, 40960
s_add_u32 s25, s25, s31
s_xor_b32 s35, s35, 8192
s_cmp_eq_u32 s28, 1
s_cbranch_scc1 kv_31
s_cmp_eq_u32 s28, 30
s_cbranch_scc0 kv_32
s_add_u32 s29, s29, 1
kv_31:
s_waitcnt vmcnt(0)
s_barrier
v_mov_b32 v3, s23
s_mov_b64 exec, 1
buffer_store_dword v3, off, s[4:7], s22 sc1
s_mov_b64 exec, -1
s_mov_b32 s22, s6
s_cmp_lg_u32 s13, 0
s_cbranch_scc1 polld_39
v_lshlrev_b32 v3, 3, v0
v_min_u32 v16, 3968, v3
s_mov_b32 s21, 11612160
s_mov_b32 s17, 0
poll_38:
buffer_load_dword v12, v3, s[4:7], s21 offen sc1
s_add_u32 s20, s21, 8192
buffer_load_dword v13, v3, s[4:7], s20 offen sc1
s_add_u32 s20, s21, 16384
buffer_load_dword v14, v16, s[4:7], s20 offen sc1
s_add_u32 s17, s17, 1
s_cmp_gt_u32 s17, 262144
s_cbranch_scc1 L_fail
s_waitcnt vmcnt(1)
v_min_u32 v12, v12, v13
s_waitcnt vmcnt(0)
v_min_u32 v12, v12, v14
v_cmp_gt_u32 vcc, s29, v12
s_cbranch_vccz polld_39
s_sleep 2
s_branch poll_38
polld_39:
s_barrier
kv_32:
s_add_u32 s28, s28, 1
s_and_b32 s33, s28, 3
s_cmp_lt_u32 s28, 12
s_cselect_b32 s33, 1, s33
s_cmp_eq_u32 s33, 0
s_cbranch_scc1 kv_33
s_cmp_lt_u32 s30, 64
s_cselect_b32 s53, s26, s6
s_cselect_b32 s36, s54, s6
s_mov_b32 s38, 1024
v_mov_b32 v8, v0
s_add_u32 s26, s26, 40960
s_add_u32 s54, s54, 5120
s_add_u32 s30, s30, 1
kvn_30:
s_waitcnt vmcnt(3)
s_barrier
ds_read_b128 v[36:39], v1 offset:2048
s_add_u32 m0, s25, 2048
s_mov_b32 s20, s53
buffer_load_dwordx4 v8, s[4:7], s20 offen sc1 lds
ds_read_b128 v[40:43], v1 offset:3072
s_xor_b32 s18, s35, 8192
v_lshrrev_b32 v2, 2, v0
v_add_u32 v2, s18, v2
ds_read_b128 v[48:51], v1 offset:5120
s_add_u32 m0, s25, 3072
s_add_u32 s20, s20, s38
buffer_load_dwordx4 v8, s[4:7], s20 offen sc1 lds
ds_read_b128 v[44:47], v1 offset:4096
s_waitcnt lgkmcnt(3)
v_mfma_f32_32x32x16_bf16 v[20:35], v[36:39], a[0:3], 0
ds_read2st64_b32 v[62:63], v2 offset0:6 offset1:7
s_waitcnt lgkmcnt(3)
ds_read2st64_b32 v[72:73], v2 offset0:16 offset1:17
ds_read2st64_b32 v[74:75], v2 offset0:18 offset1:19
ds_read_b128 v[36:39], v1 offset:6144
v_mfma_f32_32x32x16_bf16 v[20:35], v[40:43], a[4:7], v[20:35]
s_add_u32 m0, s25, 4096
s_add_u32 s20, s20, s38
buffer_load_dwordx4 v8, s[4:7], s20 offen sc1 lds
ds_read2st64_b32 v[54:55], v2 offset0:2 offset1:3
s_waitcnt lgkmcnt(5)
ds_read2st64_b32 v[52:53], v2 offset0:0 offset1:1
v_mfma_f32_32x32x16_bf16 v[20:35], v[44:47], a[8:11], v[20:35]
ds_read_b128 v[40:43], v1 offset:7168
ds_read2st64_b32 v[60:61], v2 offset0:4 offset1:5
ds_read2st64_b32 v[66:67], v2 offset0:10 offset1:11
s_add_u32 m0, s25, 5120
s_add_u32 s20, s20, s38
buffer_load_dwordx4 v8, s[4:7], s20 offen sc1 lds
v_mfma_f32_32x32x16_bf16 v[20:35], v[48:51], a[12:15], v[20:35]
ds_read_b128 v[48:51], v1 offset:9216
s_waitcnt lgkmcnt(6)
ds_read_b128 v[44:47], v1 offset:8192
s_waitcnt lgkmcnt(5)
ds_read2st64_b32 v[70:71], v2 offset0:14 offset1:15
v_mfma_f32_32x32x16_bf16 v[20:35], v[36:39], a[16:19], v[20:35]
s_add_u32 m0, s25, 6144
s_add_u32 s20, s20, s38
buffer_load_dwordx4 v8, s[4:7], s20 offen sc1 lds
s_waitcnt lgkmcnt(3)
ds_read2st64_b32 v[68:69], v2 offset0:12 offset1:13
v_mfma_f32_32x32x16_bf16 v[20:35], v[40:43], a[20:23], v[20:35]
s_waitcnt lgkmcnt(3)
ds_read_b128 v[36:39], v1 offset:10240
s_waitcnt lgkmcnt(3)
ds_read_b128 v[40:43], v1 offset:11264
v_mfma_f32_32x32x16_bf16 v[20:35], v[44:47], a[24:27], v[20:35]
ds_read_b128 v[44:47], v1 offset:12288
v_add_f32 v52, v52, v54
ds_read2st64_b32 v[64:65], v2 offset0:8 offset1:9
v_mfma_f32_32x32x16_bf16 v[20:35], v[48:51], a[28:31], v[20:35]
s_add_u32 m0, s25, 7168
s_add_u32 s20, s20, s38
buffer_load_dwordx4 v8, s[4:7], s20 offen sc1 lds
v_add_f32 v53, v53, v55
v_add_f32 v52, v52, v60
s_waitcnt lgkmcnt(3)
v_mfma_f32_32x32x16_bf16 v[20:35], v[36:39], a[32:35], v[20:35]
ds_read_b128 v[48:51], v1 offset:13312
s_waitcnt lgkmcnt(3)
s_waitcnt lgkmcnt(2)
ds_read_b128 v[36:39], v1 offset:14336
v_mfma_f32_32x32x16_bf16 v[20:35], v[40:43], a[36:39], v[20:35]
ds_read_b128 v[40:43], v1 offset:15360
s_add_u32 m0, s25, 8192
s_add_u32 s20, s20, s38
buffer_load_dwordx4 v8, s[4:7], s20 offen sc1 lds
v_mfma_f32_32x32x16_bf16 v[20:35], v[44:47], a[40:43], v[20:35]
s_add_u32 m0, s25, 9216
s_add_u32 s20, s20, s38
buffer_load_dwordx4 v8, s[4:7], s20 offen sc1 lds
v_mov_b32 v3, s23
v_add_f32 v53, v53, v61
s_waitcnt lgkmcnt(1)
v_add_f32 v53, v53, v63
v_mfma_f32_32x32x16_bf16 v[20:35], v[48:51], a[44:47], v[20:35]
v_add_f32 v52, v52, v62
v_add_f32 v52, v52, v64
ds_read_b128 v[44:47], v1 offset:16384
v_add_f32 v53, v53, v65
v_mfma_f32_32x32x16_bf16 v[20:35], v[36:39], a[48:51], v[20:35]
s_waitcnt lgkmcnt(1)
ds_read_b128 v[48:51], v1 offset:17408
ds_read_b128 v[36:39], v1 offset:18432
v_bfe_u32 v54, v0, 5, 5
v_add_f32 v53, v53, v67
v_and_b32 v54, 16, v54
v_add_f32 v53, v53, v69
v_mfma_f32_32x32x16_bf16 v[20:35], v[40:43], a[52:55], v[20:35]
v_add_f32 v52, v52, v66
ds_read_b128 v[40:43], v1 offset:19456
s_waitcnt lgkmcnt(3)
v_mfma_f32_32x32x16_bf16 v[20:35], v[44:47], a[56:59], v[20:35]
s_waitcnt lgkmcnt(2)
v_add_f32 v52, v52, v68
s_add_u32 m0, s25, 10240
s_add_u32 s20, s20, s38
buffer_load_dwordx4 v8, s[4:7], s20 offen sc1 lds
v_mfma_f32_32x32x16_bf16 v[20:35], v[48:51], a[60:63], v[20:35]
ds_read_b128 v[44:47], v1 offset:20480
v_add_f32 v53, v53, v71
s_waitcnt lgkmcnt(2)
v_add_f32 v52, v52, v70
v_add_f32 v52, v52, v72
v_add_f32 v53, v53, v73
v_mfma_f32_32x32x16_bf16 v[20:35], v[36:39], a[64:67], v[20:35]
ds_read_b128 v[48:51], v1 offset:21504
v_add_f32 v52, v52, v74
s_waitcnt lgkmcnt(2)
v_mfma_f32_32x32x16_bf16 v[20:35], v[40:43], a[68:71], v[20:35]
ds_read_b128 v[40:43], v1 offset:23552
ds_read_b128 v[36:39], v1 offset:22528
v_add_f32 v53, v53, v75
s_waitcnt lgkmcnt(3)
v_add_f32 v52, v52, v53
v_mfma_f32_32x32x16_bf16 v[20:35], v[44:47], a[72:75], v[20:35]
v_mov_b32 v56, v52
s_nop 1
v_permlane32_swap_b32 v52, v56
s_waitcnt lgkmcnt(2)
v_mfma_f32_32x32x16_bf16 v[20:35], v[48:51], a[76:79], v[20:35]
ds_read_b128 v[44:47], v1 offset:24576
s_waitcnt lgkmcnt(1)
ds_read_b128 v[48:51], v1 offset:25600
v_mfma_f32_32x32x16_bf16 v[20:35], v[36:39], a[80:83], v[20:35]
ds_read_b128 v[36:39], v1 offset:26624
v_mul_f32 v52, 0x3acccccd, v52
v_lshrrev_b32 v53, 2, v0
v_mul_f32 v56, 0x3acccccd, v56
s_add_u32 m0, s25, 11264
s_add_u32 s20, s20, s38
buffer_load_dwordx4 v8, s[4:7], s20 offen sc1 lds
v_mfma_f32_32x32x16_bf16 v[20:35], v[40:43], a[84:87], v[20:35]
s_waitcnt lgkmcnt(2)
ds_read_b128 v[40:43], v1 offset:27648
v_fma_f32 v56, -v52, v52, v56
v_max_f32 v56, 0, v56
s_waitcnt lgkmcnt(2)
v_lshl_add_u32 v53, s13, 8, v53
v_add_f32 v56, 0x3727c5ac, v56
v_mfma_f32_32x32x16_bf16 v[20:35], v[44:47], a[88:91], v[20:35]
ds_read_b128 v[44:47], v1 offset:28672
s_add_u32 m0, s35, s37
s_add_u32 s20, s36, s37
buffer_load_dwordx4 v0, s[4:7], s20 offen sc1 lds
v_mfma_f32_32x32x16_bf16 v[20:35], v[48:51], a[92:95], v[20:35]
s_waitcnt lgkmcnt(2)
v_rsq_f32 v56, v56
ds_read_b128 v[48:51], v1 offset:29696
v_mul_f32 v52, v56, v52
v_mfma_f32_32x32x16_bf16 v[20:35], v[36:39], a[96:99], v[20:35]
ds_read_b128 v[36:39], v1 offset:30720
s_waitcnt lgkmcnt(3)
s_add_u32 m0, s35, 4096
s_add_u32 s20, s36, 4096
buffer_load_dwordx4 v0, s[4:7], s20 offen sc1 lds
v_mfma_f32_32x32x16_bf16 v[20:35], v[40:43], a[100:103], v[20:35]
ds_read_b128 v[40:43], v1 offset:31744
s_waitcnt lgkmcnt(3)
v_permlane32_swap_b32 v56, v52
v_lshl_add_u32 v54, s13, 8, v54
v_mfma_f32_32x32x16_bf16 v[20:35], v[44:47], a[104:107], v[20:35]
s_waitcnt lgkmcnt(1)
ds_read_b128 v[44:47], v1 offset:32768
ds_write_b32 v53, v56 offset:1024
ds_read_b128 v[80:83], v54 offset:1184
ds_read_b128 v[76:79], v54 offset:1152
v_mfma_f32_32x32x16_bf16 v[20:35], v[48:51], a[108:111], v[20:35]
v_mfma_f32_32x32x16_bf16 v[20:35], v[36:39], a[112:115], v[20:35]
s_waitcnt lgkmcnt(4)
ds_read_b128 v[48:51], v1 offset:33792
ds_read_b128 v[88:91], v54 offset:1248
ds_read_b128 v[36:39], v1 offset:34816
s_waitcnt lgkmcnt(6)
ds_read_b128 v[84:87], v54 offset:1216
v_mfma_f32_32x32x16_bf16 v[20:35], v[40:43], a[116:119], v[20:35]
s_waitcnt vmcnt(12)
s_barrier
s_mov_b64 exec, 1
buffer_store_dword v3, off, s[4:7], s22 sc1
s_mov_b64 exec, -1
v_mfma_f32_32x32x16_bf16 v[20:35], v[44:47], a[120:123], v[20:35]
ds_read_b128 v[40:43], v1 offset:35840
s_waitcnt lgkmcnt(4)
ds_read_b128 v[44:47], v1 offset:36864
v_mfma_f32_32x32x16_bf16 v[20:35], v[48:51], a[124:127], v[20:35]
ds_read_b128 v[48:51], v1 offset:37888
ds_read_b128 v[72:75], v54 offset:1120
s_waitcnt lgkmcnt(4)
v_mul_f32 v79, v79, v5
v_mul_f32 v86, v86, v5
v_mfma_f32_32x32x16_bf16 v[20:35], v[36:39], a[128:131], v[20:35]
s_waitcnt lgkmcnt(3)
v_mfma_f32_32x32x16_bf16 v[20:35], v[40:43], a[132:135], v[20:35]
v_mul_f32 v89, v89, v5
v_mul_f32 v90, v90, v5
s_waitcnt lgkmcnt(2)
s_waitcnt lgkmcnt(1)
ds_read_b128 v[36:39], v1 offset:38912
ds_read_b128 v[60:63], v54 offset:1024
v_mfma_f32_32x32x16_bf16 v[20:35], v[44:47], a[136:139], v[20:35]
ds_read_b128 v[40:43], v1 offset:39936
ds_read_b128 v[44:47], v1 offset:40960
ds_read_b128 v[64:67], v54 offset:1056
v_mul_f32 v87, v87, v5
v_mfma_f32_32x32x16_bf16 v[20:35], v[48:51], a[140:143], v[20:35]
ds_read_b128 v[48:51], v1 offset:41984
ds_read_b128 v[68:71], v54 offset:1088
s_waitcnt lgkmcnt(6)
v_mfma_f32_32x32x16_bf16 v[20:35], v[36:39], a[144:147], v[20:35]
s_waitcnt lgkmcnt(4)
v_mul_f32 v78, v78, v5
v_mfma_f32_32x32x16_bf16 v[20:35], v[40:43], a[148:151], v[20:35]
v_mul_f32 v76, v76, v5
v_mul_f32 v85, v85, v5
v_mul_f32 v91, v91, v5
v_mul_f32 v77, v77, v5
s_waitcnt lgkmcnt(3)
v_mul_f32 v84, v84, v5
v_mfma_f32_32x32x16_bf16 v[20:35], v[44:47], a[152:155], v[20:35]
s_waitcnt lgkmcnt(1)
v_mul_f32 v88, v88, v5
v_mul_f32 v80, v80, v5
v_mfma_f32_32x32x16_bf16 v[20:35], v[48:51], a[156:159], v[20:35]
s_waitcnt lgkmcnt(0)
v_mul_f32 v83, v83, v5
v_mul_f32 v82, v82, v5
v_mul_f32 v81, v81, v5
s_nop 7
v_pk_fma_f32 v[26:27], v[26:27], v[66:67], v[82:83] neg_lo:[0,0,1] neg_hi:[0,0,1]
v_pk_fma_f32 v[24:25], v[24:25], v[64:65], v[80:81] neg_lo:[0,0,1] neg_hi:[0,0,1]
v_pk_fma_f32 v[34:35], v[34:35], v[74:75], v[90:91] neg_lo:[0,0,1] neg_hi:[0,0,1]
v_pk_fma_f32 v[22:23], v[22:23], v[62:63], v[78:79] neg_lo:[0,0,1] neg_hi:[0,0,1]
v_cvt_pk_bf16_f32 v37, v22, v23
v_pk_fma_f32 v[30:31], v[30:31], v[70:71], v[86:87] neg_lo:[0,0,1] neg_hi:[0,0,1]
v_cvt_pk_bf16_f32 v39, v26, v27
v_pk_fma_f32 v[32:33], v[32:33], v[72:73], v[88:89] neg_lo:[0,0,1] neg_hi:[0,0,1]
v_pk_fma_f32 v[20:21], v[20:21], v[60:61], v[76:77] neg_lo:[0,0,1] neg_hi:[0,0,1]
v_pk_fma_f32 v[28:29], v[28:29], v[68:69], v[84:85] neg_lo:[0,0,1] neg_hi:[0,0,1]
v_cvt_pk_bf16_f32 v38, v24, v25
v_cvt_pk_bf16_f32 v42, v32, v33
v_cvt_pk_bf16_f32 v40, v28, v29
v_cvt_pk_bf16_f32 v41, v30, v31
v_cvt_pk_bf16_f32 v43, v34, v35
v_cvt_pk_bf16_f32 v36, v20, v21
buffer_store_dwordx4 v[36:39], v6, s[4:7], s27 offen offset:0 sc1
buffer_store_dwordx4 v[40:43], v6, s[4:7], s27 offen offset:512 sc1
s_lshl_b32 s18, s16, 6
s_add_u32 s18, s18, s28
s_add_u32 s27, s27, 524288
s_cmp_eq_u32 s13, 0
s_cselect_b32 s22, s51, s6
s_mov_b32 s23, s18
s_cmp_lg_u32 s33, 0
s_cbranch_scc1 kvx_29
kvm_34:
v_xor_b32 v1, 40960, v1
s_sub_u32 s25, s25, s31
s_xor_b32 s25, s25, 40960
s_add_u32 s25, s25, s31
s_xor_b32 s35, s35, 8192
s_cmp_lt_u32 s30, 64
s_cselect_b32 s53, s26, s6
s_cselect_b32 s36, s54, s6
s_mov_b32 s38, 1024
v_mov_b32 v8, v0
s_add_u32 s26, s26, 40960
s_add_u32 s54, s54, 5120
s_add_u32 s30, s30, 1
s_waitcnt vmcnt(3)
s_barrier
ds_read_b128 v[36:39], v1 offset:2048
s_add_u32 m0, s25, 2048
s_mov_b32 s20, s53
buffer_load_dwordx4 v8, s[4:7], s20 offen sc1 lds
ds_read_b128 v[40:43], v1 offset:3072
ds_read_b128 v[44:47], v1 offset:4096
s_add_u32 m0, s25, 3072
s_add_u32 s20, s20, s38
buffer_load_dwordx4 v8, s[4:7], s20 offen sc1 lds
s_waitcnt lgkmcnt(2)
v_mfma_f32_32x32x16_bf16 v[20:35], v[36:39], a[0:3], 0
ds_read_b128 v[48:51], v1 offset:5120
s_waitcnt lgkmcnt(2)
s_add_u32 m0, s25, 4096
s_add_u32 s20, s20, s38
buffer_load_dwordx4 v8, s[4:7], s20 offen sc1 lds
s_waitcnt lgkmcnt(1)
v_mfma_f32_32x32x16_bf16 v[20:35], v[40:43], a[4:7], v[20:35]
s_add_u32 m0, s25, 5120
s_add_u32 s20, s20, s38
buffer_load_dwordx4 v8, s[4:7], s20 offen sc1 lds
ds_read_b128 v[36:39], v1 offset:6144
ds_read_b128 v[40:43], v1 offset:7168
v_mfma_f32_32x32x16_bf16 v[20:35], v[44:47], a[8:11], v[20:35]
ds_read_b128 v[44:47], v1 offset:8192
s_waitcnt lgkmcnt(3)
v_mfma_f32_32x32x16_bf16 v[20:35], v[48:51], a[12:15], v[20:35]
s_waitcnt lgkmcnt(2)
v_mfma_f32_32x32x16_bf16 v[20:35], v[36:39], a[16:19], v[20:35]
ds_read_b128 v[48:51], v1 offset:9216
ds_read_b128 v[36:39], v1 offset:10240
s_waitcnt lgkmcnt(2)
v_mfma_f32_32x32x16_bf16 v[20:35], v[40:43], a[20:23], v[20:35]
v_mfma_f32_32x32x16_bf16 v[20:35], v[44:47], a[24:27], v[20:35]
ds_read_b128 v[44:47], v1 offset:12288
s_waitcnt lgkmcnt(2)
ds_read_b128 v[40:43], v1 offset:11264
v_mfma_f32_32x32x16_bf16 v[20:35], v[48:51], a[28:31], v[20:35]
s_waitcnt lgkmcnt(2)
s_add_u32 m0, s25, 6144
s_add_u32 s20, s20, s38
buffer_load_dwordx4 v8, s[4:7], s20 offen sc1 lds
ds_read_b128 v[48:51], v1 offset:13312
v_mfma_f32_32x32x16_bf16 v[20:35], v[36:39], a[32:35], v[20:35]
s_waitcnt lgkmcnt(2)
s_add_u32 m0, s25, 7168
s_add_u32 s20, s20, s38
buffer_load_dwordx4 v8, s[4:7], s20 offen sc1 lds
s_waitcnt lgkmcnt(1)
v_mfma_f32_32x32x16_bf16 v[20:35], v[40:43], a[36:39], v[20:35]
ds_read_b128 v[36:39], v1 offset:14336
s_add_u32 m0, s25, 8192
s_add_u32 s20, s20, s38
buffer_load_dwordx4 v8, s[4:7], s20 offen sc1 lds
s_waitcnt lgkmcnt(1)
ds_read_b128 v[40:43], v1 offset:15360
v_mfma_f32_32x32x16_bf16 v[20:35], v[44:47], a[40:43], v[20:35]
ds_read_b128 v[44:47], v1 offset:16384
v_mfma_f32_32x32x16_bf16 v[20:35], v[48:51], a[44:47], v[20:35]
s_waitcnt lgkmcnt(2)
ds_read_b128 v[48:51], v1 offset:17408
v_mfma_f32_32x32x16_bf16 v[20:35], v[36:39], a[48:51], v[20:35]
ds_read_b128 v[36:39], v1 offset:18432
s_waitcnt lgkmcnt(2)
v_mfma_f32_32x32x16_bf16 v[20:35], v[40:43], a[52:55], v[20:35]
ds_read_b128 v[40:43], v1 offset:19456
s_add_u32 m0, s25, 9216
s_add_u32 s20, s20, s38
buffer_load_dwordx4 v8, s[4:7], s20 offen sc1 lds
s_waitcnt lgkmcnt(2)
v_mfma_f32_32x32x16_bf16 v[20:35], v[44:47], a[56:59], v[20:35]
v_mfma_f32_32x32x16_bf16 v[20:35], v[48:51], a[60:63], v[20:35]
ds_read_b128 v[48:51], v1 offset:21504
ds_read_b128 v[44:47], v1 offset:20480
s_waitcnt lgkmcnt(3)
v_mov_b32 v3, s23
v_mfma_f32_32x32x16_bf16 v[20:35], v[36:39], a[64:67], v[20:35]
s_waitcnt lgkmcnt(2)
s_add_u32 m0, s25, 10240
s_add_u32 s20, s20, s38
buffer_load_dwordx4 v8, s[4:7], s20 offen sc1 lds
ds_read_b128 v[36:39], v1 offset:22528
v_mfma_f32_32x32x16_bf16 v[20:35], v[40:43], a[68:71], v[20:35]
ds_read_b128 v[40:43], v1 offset:23552
s_waitcnt lgkmcnt(2)
v_mfma_f32_32x32x16_bf16 v[20:35], v[44:47], a[72:75], v[20:35]
v_mfma_f32_32x32x16_bf16 v[20:35], v[48:51], a[76:79], v[20:35]
s_waitcnt lgkmcnt(0)
ds_read_b128 v[44:47], v1 offset:24576
v_mfma_f32_32x32x16_bf16 v[20:35], v[36:39], a[80:83], v[20:35]
ds_read_b128 v[48:51], v1 offset:25600
s_add_u32 m0, s25, 11264
s_add_u32 s20, s20, s38
buffer_load_dwordx4 v8, s[4:7], s20 offen sc1 lds
v_mfma_f32_32x32x16_bf16 v[20:35], v[40:43], a[84:87], v[20:35]
ds_read_b128 v[36:39], v1 offset:26624
s_waitcnt lgkmcnt(2)
ds_read_b128 v[40:43], v1 offset:27648
v_mfma_f32_32x32x16_bf16 v[20:35], v[44:47], a[88:91], v[20:35]
s_waitcnt lgkmcnt(2)
ds_read_b128 v[44:47], v1 offset:28672
s_add_u32 m0, s35, s37
s_add_u32 s20, s36, s37
buffer_load_dwordx4 v0, s[4:7], s20 offen sc1 lds
v_mfma_f32_32x32x16_bf16 v[20:35], v[48:51], a[92:95], v[20:35]
ds_read_b128 v[48:51], v1 offset:29696
s_waitcnt lgkmcnt(3)
v_mfma_f32_32x32x16_bf16 v[20:35], v[36:39], a[96:99], v[20:35]
s_waitcnt lgkmcnt(1)
ds_read_b128 v[36:39], v1 offset:30720
s_add_u32 m0, s35, 4096
s_add_u32 s20, s36, 4096
buffer_load_dwordx4 v0, s[4:7], s20 offen sc1 lds
v_mfma_f32_32x32x16_bf16 v[20:35], v[40:43], a[100:103], v[20:35]
ds_read_b128 v[40:43], v1 offset:31744
v_mfma_f32_32x32x16_bf16 v[20:35], v[44:47], a[104:107], v[20:35]
s_waitcnt lgkmcnt(2)
s_waitcnt lgkmcnt(1)
v_mfma_f32_32x32x16_bf16 v[20:35], v[48:51], a[108:111], v[20:35]
ds_read_b128 v[44:47], v1 offset:32768
ds_read_b128 v[48:51], v1 offset:33792
v_mfma_f32_32x32x16_bf16 v[20:35], v[36:39], a[112:115], v[20:35]
ds_read_b128 v[36:39], v1 offset:34816
s_waitcnt lgkmcnt(3)
v_mfma_f32_32x32x16_bf16 v[20:35], v[40:43], a[116:119], v[20:35]
s_waitcnt vmcnt(12)
s_barrier
ds_read_b128 v[40:43], v1 offset:35840
s_waitcnt lgkmcnt(3)
v_mfma_f32_32x32x16_bf16 v[20:35], v[44:47], a[120:123], v[20:35]
s_mov_b64 exec, 1
buffer_store_dword v3, off, s[4:7], s22 sc1
s_mov_b64 exec, -1
s_waitcnt lgkmcnt(1)
v_mfma_f32_32x32x16_bf16 v[20:35], v[48:51], a[124:127], v[20:35]
ds_read_b128 v[44:47], v1 offset:36864
s_waitcnt lgkmcnt(1)
ds_read_b128 v[48:51], v1 offset:37888
v_mfma_f32_32x32x16_bf16 v[20:35], v[36:39], a[128:131], v[20:35]
v_mfma_f32_32x32x16_bf16 v[20:35], v[40:43], a[132:135], v[20:35]
s_waitcnt lgkmcnt(1)
ds_read_b128 v[40:43], v1 offset:39936
ds_read_b128 v[36:39], v1 offset:38912
v_mfma_f32_32x32x16_bf16 v[20:35], v[44:47], a[136:139], v[20:35]
s_waitcnt lgkmcnt(2)
v_mfma_f32_32x32x16_bf16 v[20:35], v[48:51], a[140:143], v[20:35]
ds_read_b128 v[44:47], v1 offset:40960
ds_read_b128 v[48:51], v1 offset:41984
s_waitcnt lgkmcnt(2)
v_mfma_f32_32x32x16_bf16 v[20:35], v[36:39], a[144:147], v[20:35]
v_mfma_f32_32x32x16_bf16 v[20:35], v[40:43], a[148:151], v[20:35]
s_waitcnt lgkmcnt(1)
v_mfma_f32_32x32x16_bf16 v[20:35], v[44:47], a[152:155], v[20:35]
s_waitcnt lgkmcnt(0)
v_mfma_f32_32x32x16_bf16 v[20:35], v[48:51], a[156:159], v[20:35]
s_nop 11
v_cvt_pk_bf16_f32 v37, v22, v23
v_cvt_pk_bf16_f32 v36, v20, v21
v_cvt_pk_bf16_f32 v41, v30, v31
v_cvt_pk_bf16_f32 v39, v26, v27
v_cvt_pk_bf16_f32 v42, v32, v33
v_cvt_pk_bf16_f32 v38, v24, v25
v_cvt_pk_bf16_f32 v40, v28, v29
v_cvt_pk_bf16_f32 v43, v34, v35
buffer_store_dwordx4 v[36:39], v6, s[4:7], s50 offen offset:0 sc1
buffer_store_dwordx4 v[40:43], v6, s[4:7], s50 offen offset:512 sc1
s_add_u32 s39, s39, 1
s_add_u32 s50, s50, 524288
s_add_u32 s18, s51, 8192
s_cmp_eq_u32 s13, 0
s_cselect_b32 s22, s18, s6
s_mov_b32 s23, s39
s_cmp_lt_u32 s28, 64
s_cbranch_scc1 kvx_29
s_and_b32 s18, s39, 15
s_cbranch_scc0 kvt_35
s_waitcnt vmcnt(0)
s_barrier
v_mov_b32 v3, s23
s_mov_b64 exec, 1
buffer_store_dword v3, off, s[4:7], s22 sc1
s_mov_b64 exec, -1
s_mov_b32 s22, s6
s_lshl_b32 s18, s39, 2
s_add_u32 s18, s18, 4
s_cmp_lg_u32 s13, 0
s_cbranch_scc1 polld_41
v_lshlrev_b32 v3, 3, v0
v_min_u32 v16, 1152, v3
s_mov_b32 s21, 11550720
s_mov_b32 s17, 0
poll_40:
buffer_load_dword v12, v16, s[4:7], s21 offen sc1
s_add_u32 s17, s17, 1
s_cmp_gt_u32 s17, 262144
s_cbranch_scc1 L_fail
s_waitcnt vmcnt(0)
v_cmp_gt_u32 vcc, s18, v12
s_cbranch_vccz polld_41
s_sleep 2
s_branch poll_40
polld_41:
s_barrier
s_mov_b32 s53, s52
s_mov_b32 s36, s6
s_mov_b32 s38, 256
v_mov_b32 v8, v7
s_add_u32 s52, s52, 40960
s_add_u32 m0, s25, 2048
s_mov_b32 s20, s53
buffer_load_dwordx4 v8, s[4:7], s20 offen sc1 lds
s_add_u32 m0, s25, 3072
s_add_u32 s20, s20, s38
buffer_load_dwordx4 v8, s[4:7], s20 offen sc1 lds
s_add_u32 m0, s25, 4096
s_add_u32 s20, s20, s38
buffer_load_dwordx4 v8, s[4:7], s20 offen sc1 lds
s_add_u32 m0, s25, 5120
s_add_u32 s20, s20, s38
buffer_load_dwordx4 v8, s[4:7], s20 offen sc1 lds
s_add_u32 m0, s25, 6144
s_add_u32 s20, s20, s38
buffer_load_dwordx4 v8, s[4:7], s20 offen sc1 lds
s_add_u32 m0, s25, 7168
s_add_u32 s20, s20, s38
buffer_load_dwordx4 v8, s[4:7], s20 offen sc1 lds
s_add_u32 m0, s25, 8192
s_add_u32 s20, s20, s38
buffer_load_dwordx4 v8, s[4:7], s20 offen sc1 lds
s_add_u32 m0, s25, 9216
s_add_u32 s20, s20, s38
buffer_load_dwordx4 v8, s[4:7], s20 offen sc1 lds
s_add_u32 m0, s25, 10240
s_add_u32 s20, s20, s38
buffer_load_dwordx4 v8, s[4:7], s20 offen sc1 lds
s_add_u32 m0, s25, 11264
s_add_u32 s20, s20, s38
buffer_load_dwordx4 v8, s[4:7], s20 offen sc1 lds
s_waitcnt vmcnt(0)
s_branch kvm_34
kv_33:
s_lshl_b32 s18, s39, 2
s_add_u32 s18, s18, 4
s_cmp_lg_u32 s13, 0
s_cbranch_scc1 polld_43
v_lshlrev_b32 v3, 3, v0
v_min_u32 v16, 1152, v3
s_mov_b32 s21, 11550720
s_mov_b32 s17, 0
poll_42:
buffer_load_dword v12, v16, s[4:7], s21 offen sc1
s_add_u32 s17, s17, 1
s_cmp_gt_u32 s17, 262144
s_cbranch_scc1 L_fail
s_waitcnt vmcnt(0)
v_cmp_gt_u32 vcc, s18, v12
s_cbranch_vccz polld_43
s_sleep 2
s_branch poll_42
polld_43:
s_barrier
s_mov_b32 s53, s52
s_mov_b32 s36, s6
s_mov_b32 s38, 256
v_mov_b32 v8, v7
s_add_u32 s52, s52, 40960
s_branch kvn_30
kvt_35:
s_waitcnt vmcnt(0)
s_barrier
v_mov_b32 v3, s23
s_mov_b64 exec, 1
buffer_store_dword v3, off, s[4:7], s22 sc1
s_mov_b64 exec, -1
s_mov_b32 s22, s6
s_cmp_lg_u32 s16, 0
s_cbranch_scc1 kvz_44
s_cmp_ge_u32 s32, 20
s_cbranch_scc1 kvz_44
s_mov_b32 s55, s34
s_mul_i32 s30, s32, 13108
s_lshr_b32 s30, s30, 16
s_mul_i32 s18, s30, 5
s_sub_u32 s34, s32, s18
s_add_u32 s30, s30, 60
s_add_u32 s54, s32, 15
s_lshl_b32 s18, s34, 2
s_add_u32 s18, s18, s13
s_lshl_b32 s33, s18, 11
v_lshrrev_b32 v12, 9, v0
v_and_b32 v10, 0x1ff, v0
v_lshlrev_b32 v10, 1, v10
v_lshl_add_u32 v10, v12, 4, v10
s_lshl_b32 s18, s34, 7
s_lshl_b32 s19, s13, 5
s_add_u32 s18, s18, s19
s_mov_b32 s19, 0x3acccccd
v_bfe_u32 v202, v0, 4, 5
v_lshrrev_b32 v197, 9, v0
v_add_u32 v202, s18, v202
v_and_b32 v201, 1, v202
v_mul_u32_u24 v201, 160, v201
v_lshrrev_b32 v200, 1, v202
v_add_u32 v200, 1, v200
v_lshlrev_b32 v197, 3, v197
v_mad_u32_u24 v201, v197, v200, v201
v_mad_u32_u24 v196, v200, 16, 0
v_cvt_f32_u32 v196, v196
v_mul_f32 v202, s19, v196
v_rndne_f32 v202, v202
v_fmac_f32 v196, 0xc4200000, v202
v_mul_f32 v196, s19, v196
v_cos_f32 v196, v196
s_nop 0
v_add_f32 v196, v196, v196
v_mad_u32_u24 v198, v200, 1, 0
v_cvt_f32_u32 v198, v198
v_mul_f32 v202, s19, v198
v_rndne_f32 v202, v202
v_fmac_f32 v198, 0xc4200000, v202
v_mul_f32 v198, s19, v198
v_cos_f32 v198, v198
s_nop 0
v_add_f32 v198, v198, v198
v_mad_u32_u24 v183, v200, 3, v201
v_cvt_f32_u32 v183, v183
v_mul_f32 v202, s19, v183
v_rndne_f32 v202, v202
v_fmac_f32 v183, 0xc4200000, v202
v_mul_f32 v183, s19, v183
v_cos_f32 v183, v183
v_mad_u32_u24 v184, v200, 4, v201
v_cvt_f32_u32 v184, v184
v_mul_f32 v202, s19, v184
v_rndne_f32 v202, v202
v_fmac_f32 v184, 0xc4200000, v202
v_mul_f32 v184, s19, v184
v_cos_f32 v184, v184
s_nop 0
v_fma_f32 v185, v198, v184, -v183
v_fma_f32 v182, v198, v183, -v184
v_fma_f32 v186, v198, v185, -v184
v_fma_f32 v181, v198, v182, -v183
v_fma_f32 v187, v198, v186, -v185
v_fma_f32 v180, v198, v181, -v182
v_cvt_pk_bf16_f32 v20, v180, v181
v_cvt_pk_bf16_f32 v21, v182, v183
v_cvt_pk_bf16_f32 v22, v184, v185
v_cvt_pk_bf16_f32 v23, v186, v187
v_mad_u32_u24 v191, v200, 19, v201
v_cvt_f32_u32 v191, v191
v_mul_f32 v202, s19, v191
v_rndne_f32 v202, v202
v_fmac_f32 v191, 0xc4200000, v202
v_mul_f32 v191, s19, v191
v_cos_f32 v191, v191
v_mad_u32_u24 v192, v200, 20, v201
v_cvt_f32_u32 v192, v192
v_mul_f32 v202, s19, v192
v_rndne_f32 v202, v202
v_fmac_f32 v192, 0xc4200000, v202
v_mul_f32 v192, s19, v192
v_cos_f32 v192, v192
s_nop 0
v_fma_f32 v193, v198, v192, -v191
v_fma_f32 v190, v198, v191, -v192
v_fma_f32 v194, v198, v193, -v192
v_fma_f32 v189, v198, v190, -v191
v_fma_f32 v195, v198, v194, -v193
v_fma_f32 v188, v198, v189, -v190
v_cvt_pk_bf16_f32 v24, v188, v189
v_cvt_pk_bf16_f32 v25, v190, v191
v_cvt_pk_bf16_f32 v26, v192, v193
v_cvt_pk_bf16_f32 v27, v194, v195
v_pk_fma_f32 v[180:181], v[196:197], v[188:189], v[180:181] op_sel_hi:[0,1,1] neg_lo:[0,0,1] neg_hi:[0,0,1]
v_pk_fma_f32 v[182:183], v[196:197], v[190:191], v[182:183] op_sel_hi:[0,1,1] neg_lo:[0,0,1] neg_hi:[0,0,1]
v_pk_fma_f32 v[184:185], v[196:197], v[192:193], v[184:185] op_sel_hi:[0,1,1] neg_lo:[0,0,1] neg_hi:[0,0,1]
v_pk_fma_f32 v[186:187], v[196:197], v[194:195], v[186:187] op_sel_hi:[0,1,1] neg_lo:[0,0,1] neg_hi:[0,0,1]
v_cvt_pk_bf16_f32 v28, v180, v181
v_cvt_pk_bf16_f32 v29, v182, v183
v_cvt_pk_bf16_f32 v30, v184, v185
v_cvt_pk_bf16_f32 v31, v186, v187
v_pk_fma_f32 v[188:189], v[196:197], v[180:181], v[188:189] op_sel_hi:[0,1,1] neg_lo:[0,0,1] neg_hi:[0,0,1]
v_pk_fma_f32 v[190:191], v[196:197], v[182:183], v[190:191] op_sel_hi:[0,1,1] neg_lo:[0,0,1] neg_hi:[0,0,1]
v_pk_fma_f32 v[192:193], v[196:197], v[184:185], v[192:193] op_sel_hi:[0,1,1] neg_lo:[0,0,1] neg_hi:[0,0,1]
v_pk_fma_f32 v[194:195], v[196:197], v[186:187], v[194:195] op_sel_hi:[0,1,1] neg_lo:[0,0,1] neg_hi:[0,0,1]
v_cvt_pk_bf16_f32 v32, v188, v189
v_cvt_pk_bf16_f32 v33, v190, v191
v_cvt_pk_bf16_f32 v34, v192, v193
v_cvt_pk_bf16_f32 v35, v194, v195
v_pk_fma_f32 v[180:181], v[196:197], v[188:189], v[180:181] op_sel_hi:[0,1,1] neg_lo:[0,0,1] neg_hi:[0,0,1]
v_pk_fma_f32 v[182:183], v[196:197], v[190:191], v[182:183] op_sel_hi:[0,1,1] neg_lo:[0,0,1] neg_hi:[0,0,1]
v_pk_fma_f32 v[184:185], v[196:197], v[192:193], v[184:185] op_sel_hi:[0,1,1] neg_lo:[0,0,1] neg_hi:[0,0,1]
v_pk_fma_f32 v[186:187], v[196:197], v[194:195], v[186:187] op_sel_hi:[0,1,1] neg_lo:[0,0,1] neg_hi:[0,0,1]
v_cvt_pk_bf16_f32 v36, v180, v181
v_cvt_pk_bf16_f32 v37, v182, v183
v_cvt_pk_bf16_f32 v38, v184, v185
v_cvt_pk_bf16_f32 v39, v186, v187
v_pk_fma_f32 v[188:189], v[196:197], v[180:181], v[188:189] op_sel_hi:[0,1,1] neg_lo:[0,0,1] neg_hi:[0,0,1]
v_pk_fma_f32 v[190:191], v[196:197], v[182:183], v[190:191] op_sel_hi:[0,1,1] neg_lo:[0,0,1] neg_hi:[0,0,1]
v_pk_fma_f32 v[192:193], v[196:197], v[184:185], v[192:193] op_sel_hi:[0,1,1] neg_lo:[0,0,1] neg_hi:[0,0,1]
v_pk_fma_f32 v[194:195], v[196:197], v[186:187], v[194:195] op_sel_hi:[0,1,1] neg_lo:[0,0,1] neg_hi:[0,0,1]
v_cvt_pk_bf16_f32 v40, v188, v189
v_cvt_pk_bf16_f32 v41, v190, v191
v_cvt_pk_bf16_f32 v42, v192, v193
v_cvt_pk_bf16_f32 v43, v194, v195
v_pk_fma_f32 v[180:181], v[196:197], v[188:189], v[180:181] op_sel_hi:[0,1,1] neg_lo:[0,0,1] neg_hi:[0,0,1]
v_pk_fma_f32 v[182:183], v[196:197], v[190:191], v[182:183] op_sel_hi:[0,1,1] neg_lo:[0,0,1] neg_hi:[0,0,1]
v_pk_fma_f32 v[184:185], v[196:197], v[192:193], v[184:185] op_sel_hi:[0,1,1] neg_lo:[0,0,1] neg_hi:[0,0,1]
v_pk_fma_f32 v[186:187], v[196:197], v[194:195], v[186:187] op_sel_hi:[0,1,1] neg_lo:[0,0,1] neg_hi:[0,0,1]
v_cvt_pk_bf16_f32 v44, v180, v181
v_cvt_pk_bf16_f32 v45, v182, v183
v_cvt_pk_bf16_f32 v46, v184, v185
v_cvt_pk_bf16_f32 v47, v186, v187
v_pk_fma_f32 v[188:189], v[196:197], v[180:181], v[188:189] op_sel_hi:[0,1,1] neg_lo:[0,0,1] neg_hi:[0,0,1]
v_pk_fma_f32 v[190:191], v[196:197], v[182:183], v[190:191] op_sel_hi:[0,1,1] neg_lo:[0,0,1] neg_hi:[0,0,1]
v_pk_fma_f32 v[192:193], v[196:197], v[184:185], v[192:193] op_sel_hi:[0,1,1] neg_lo:[0,0,1] neg_hi:[0,0,1]
v_pk_fma_f32 v[194:195], v[196:197], v[186:187], v[194:195] op_sel_hi:[0,1,1] neg_lo:[0,0,1] neg_hi:[0,0,1]
v_cvt_pk_bf16_f32 v48, v188, v189
v_cvt_pk_bf16_f32 v49, v190, v191
v_cvt_pk_bf16_f32 v50, v192, v193
v_cvt_pk_bf16_f32 v51, v194, v195
v_pk_fma_f32 v[180:181], v[196:197], v[188:189], v[180:181] op_sel_hi:[0,1,1] neg_lo:[0,0,1] neg_hi:[0,0,1]
v_pk_fma_f32 v[182:183], v[196:197], v[190:191], v[182:183] op_sel_hi:[0,1,1] neg_lo:[0,0,1] neg_hi:[0,0,1]
v_pk_fma_f32 v[184:185], v[196:197], v[192:193], v[184:185] op_sel_hi:[0,1,1] neg_lo:[0,0,1] neg_hi:[0,0,1]
v_pk_fma_f32 v[186:187], v[196:197], v[194:195], v[186:187] op_sel_hi:[0,1,1] neg_lo:[0,0,1] neg_hi:[0,0,1]
v_cvt_pk_bf16_f32 v52, v180, v181
v_cvt_pk_bf16_f32 v53, v182, v183
v_cvt_pk_bf16_f32 v54, v184, v185
v_cvt_pk_bf16_f32 v55, v186, v187
v_pk_fma_f32 v[188:189], v[196:197], v[180:181], v[188:189] op_sel_hi:[0,1,1] neg_lo:[0,0,1] neg_hi:[0,0,1]
v_pk_fma_f32 v[190:191], v[196:197], v[182:183], v[190:191] op_sel_hi:[0,1,1] neg_lo:[0,0,1] neg_hi:[0,0,1]
v_pk_fma_f32 v[192:193], v[196:197], v[184:185], v[192:193] op_sel_hi:[0,1,1] neg_lo:[0,0,1] neg_hi:[0,0,1]
v_pk_fma_f32 v[194:195], v[196:197], v[186:187], v[194:195] op_sel_hi:[0,1,1] neg_lo:[0,0,1] neg_hi:[0,0,1]
v_cvt_pk_bf16_f32 v56, v188, v189
v_cvt_pk_bf16_f32 v57, v190, v191
v_cvt_pk_bf16_f32 v58, v192, v193
v_cvt_pk_bf16_f32 v59, v194, v195
v_pk_fma_f32 v[180:181], v[196:197], v[188:189], v[180:181] op_sel_hi:[0,1,1] neg_lo:[0,0,1] neg_hi:[0,0,1]
v_pk_fma_f32 v[182:183], v[196:197], v[190:191], v[182:183] op_sel_hi:[0,1,1] neg_lo:[0,0,1] neg_hi:[0,0,1]
v_pk_fma_f32 v[184:185], v[196:197], v[192:193], v[184:185] op_sel_hi:[0,1,1] neg_lo:[0,0,1] neg_hi:[0,0,1]
v_pk_fma_f32 v[186:187], v[196:197], v[194:195], v[186:187] op_sel_hi:[0,1,1] neg_lo:[0,0,1] neg_hi:[0,0,1]
v_cvt_pk_bf16_f32 v60, v180, v181
v_cvt_pk_bf16_f32 v61, v182, v183
v_cvt_pk_bf16_f32 v62, v184, v185
v_cvt_pk_bf16_f32 v63, v186, v187
v_pk_fma_f32 v[188:189], v[196:197], v[180:181], v[188:189] op_sel_hi:[0,1,1] neg_lo:[0,0,1] neg_hi:[0,0,1]
v_pk_fma_f32 v[190:191], v[196:197], v[182:183], v[190:191] op_sel_hi:[0,1,1] neg_lo:[0,0,1] neg_hi:[0,0,1]
v_pk_fma_f32 v[192:193], v[196:197], v[184:185], v[192:193] op_sel_hi:[0,1,1] neg_lo:[0,0,1] neg_hi:[0,0,1]
v_pk_fma_f32 v[194:195], v[196:197], v[186:187], v[194:195] op_sel_hi:[0,1,1] neg_lo:[0,0,1] neg_hi:[0,0,1]
v_cvt_pk_bf16_f32 v64, v188, v189
v_cvt_pk_bf16_f32 v65, v190, v191
v_cvt_pk_bf16_f32 v66, v192, v193
v_cvt_pk_bf16_f32 v67, v194, v195
v_pk_fma_f32 v[180:181], v[196:197], v[188:189], v[180:181] op_sel_hi:[0,1,1] neg_lo:[0,0,1] neg_hi:[0,0,1]
v_pk_fma_f32 v[182:183], v[196:197], v[190:191], v[182:183] op_sel_hi:[0,1,1] neg_lo:[0,0,1] neg_hi:[0,0,1]
v_pk_fma_f32 v[184:185], v[196:197], v[192:193], v[184:185] op_sel_hi:[0,1,1] neg_lo:[0,0,1] neg_hi:[0,0,1]
v_pk_fma_f32 v[186:187], v[196:197], v[194:195], v[186:187] op_sel_hi:[0,1,1] neg_lo:[0,0,1] neg_hi:[0,0,1]
v_cvt_pk_bf16_f32 v68, v180, v181
v_cvt_pk_bf16_f32 v69, v182, v183
v_cvt_pk_bf16_f32 v70, v184, v185
v_cvt_pk_bf16_f32 v71, v186, v187
v_pk_fma_f32 v[188:189], v[196:197], v[180:181], v[188:189] op_sel_hi:[0,1,1] neg_lo:[0,0,1] neg_hi:[0,0,1]
v_pk_fma_f32 v[190:191], v[196:197], v[182:183], v[190:191] op_sel_hi:[0,1,1] neg_lo:[0,0,1] neg_hi:[0,0,1]
v_pk_fma_f32 v[192:193], v[196:197], v[184:185], v[192:193] op_sel_hi:[0,1,1] neg_lo:[0,0,1] neg_hi:[0,0,1]
v_pk_fma_f32 v[194:195], v[196:197], v[186:187], v[194:195] op_sel_hi:[0,1,1] neg_lo:[0,0,1] neg_hi:[0,0,1]
v_cvt_pk_bf16_f32 v72, v188, v189
v_cvt_pk_bf16_f32 v73, v190, v191
v_cvt_pk_bf16_f32 v74, v192, v193
v_cvt_pk_bf16_f32 v75, v194, v195
v_pk_fma_f32 v[180:181], v[196:197], v[188:189], v[180:181] op_sel_hi:[0,1,1] neg_lo:[0,0,1] neg_hi:[0,0,1]
v_pk_fma_f32 v[182:183], v[196:197], v[190:191], v[182:183] op_sel_hi:[0,1,1] neg_lo:[0,0,1] neg_hi:[0,0,1]
v_pk_fma_f32 v[184:185], v[196:197], v[192:193], v[184:185] op_sel_hi:[0,1,1] neg_lo:[0,0,1] neg_hi:[0,0,1]
v_pk_fma_f32 v[186:187], v[196:197], v[194:195], v[186:187] op_sel_hi:[0,1,1] neg_lo:[0,0,1] neg_hi:[0,0,1]
v_cvt_pk_bf16_f32 v76, v180, v181
v_cvt_pk_bf16_f32 v77, v182, v183
v_cvt_pk_bf16_f32 v78, v184, v185
v_cvt_pk_bf16_f32 v79, v186, v187
v_pk_fma_f32 v[188:189], v[196:197], v[180:181], v[188:189] op_sel_hi:[0,1,1] neg_lo:[0,0,1] neg_hi:[0,0,1]
v_pk_fma_f32 v[190:191], v[196:197], v[182:183], v[190:191] op_sel_hi:[0,1,1] neg_lo:[0,0,1] neg_hi:[0,0,1]
v_pk_fma_f32 v[192:193], v[196:197], v[184:185], v[192:193] op_sel_hi:[0,1,1] neg_lo:[0,0,1] neg_hi:[0,0,1]
v_pk_fma_f32 v[194:195], v[196:197], v[186:187], v[194:195] op_sel_hi:[0,1,1] neg_lo:[0,0,1] neg_hi:[0,0,1]
v_cvt_pk_bf16_f32 v80, v188, v189
v_cvt_pk_bf16_f32 v81, v190, v191
v_cvt_pk_bf16_f32 v82, v192, v193
v_cvt_pk_bf16_f32 v83, v194, v195
v_pk_fma_f32 v[180:181], v[196:197], v[188:189], v[180:181] op_sel_hi:[0,1,1] neg_lo:[0,0,1] neg_hi:[0,0,1]
v_pk_fma_f32 v[182:183], v[196:197], v[190:191], v[182:183] op_sel_hi:[0,1,1] neg_lo:[0,0,1] neg_hi:[0,0,1]
v_pk_fma_f32 v[184:185], v[196:197], v[192:193], v[184:185] op_sel_hi:[0,1,1] neg_lo:[0,0,1] neg_hi:[0,0,1]
v_pk_fma_f32 v[186:187], v[196:197], v[194:195], v[186:187] op_sel_hi:[0,1,1] neg_lo:[0,0,1] neg_hi:[0,0,1]
v_cvt_pk_bf16_f32 v84, v180, v181
v_cvt_pk_bf16_f32 v85, v182, v183
v_cvt_pk_bf16_f32 v86, v184, v185
v_cvt_pk_bf16_f32 v87, v186, v187
v_pk_fma_f32 v[188:189], v[196:197], v[180:181], v[188:189] op_sel_hi:[0,1,1] neg_lo:[0,0,1] neg_hi:[0,0,1]
v_pk_fma_f32 v[190:191], v[196:197], v[182:183], v[190:191] op_sel_hi:[0,1,1] neg_lo:[0,0,1] neg_hi:[0,0,1]
v_pk_fma_f32 v[192:193], v[196:197], v[184:185], v[192:193] op_sel_hi:[0,1,1] neg_lo:[0,0,1] neg_hi:[0,0,1]
v_pk_fma_f32 v[194:195], v[196:197], v[186:187], v[194:195] op_sel_hi:[0,1,1] neg_lo:[0,0,1] neg_hi:[0,0,1]
v_cvt_pk_bf16_f32 v88, v188, v189
v_cvt_pk_bf16_f32 v89, v190, v191
v_cvt_pk_bf16_f32 v90, v192, v193
v_cvt_pk_bf16_f32 v91, v194, v195
v_pk_fma_f32 v[180:181], v[196:197], v[188:189], v[180:181] op_sel_hi:[0,1,1] neg_lo:[0,0,1] neg_hi:[0,0,1]
v_pk_fma_f32 v[182:183], v[196:197], v[190:191], v[182:183] op_sel_hi:[0,1,1] neg_lo:[0,0,1] neg_hi:[0,0,1]
v_pk_fma_f32 v[184:185], v[196:197], v[192:193], v[184:185] op_sel_hi:[0,1,1] neg_lo:[0,0,1] neg_hi:[0,0,1]
v_pk_fma_f32 v[186:187], v[196:197], v[194:195], v[186:187] op_sel_hi:[0,1,1] neg_lo:[0,0,1] neg_hi:[0,0,1]
v_cvt_pk_bf16_f32 v92, v180, v181
v_cvt_pk_bf16_f32 v93, v182, v183
v_cvt_pk_bf16_f32 v94, v184, v185
v_cvt_pk_bf16_f32 v95, v186, v187
v_pk_fma_f32 v[188:189], v[196:197], v[180:181], v[188:189] op_sel_hi:[0,1,1] neg_lo:[0,0,1] neg_hi:[0,0,1]
v_pk_fma_f32 v[190:191], v[196:197], v[182:183], v[190:191] op_sel_hi:[0,1,1] neg_lo:[0,0,1] neg_hi:[0,0,1]
v_pk_fma_f32 v[192:193], v[196:197], v[184:185], v[192:193] op_sel_hi:[0,1,1] neg_lo:[0,0,1] neg_hi:[0,0,1]
v_pk_fma_f32 v[194:195], v[196:197], v[186:187], v[194:195] op_sel_hi:[0,1,1] neg_lo:[0,0,1] neg_hi:[0,0,1]
v_cvt_pk_bf16_f32 v96, v188, v189
v_cvt_pk_bf16_f32 v97, v190, v191
v_cvt_pk_bf16_f32 v98, v192, v193
v_cvt_pk_bf16_f32 v99, v194, v195
s_mov_b32 s20, 323
v_mad_u32_u24 v183, v200, s20, v201
v_cvt_f32_u32 v183, v183
v_mul_f32 v202, s19, v183
v_rndne_f32 v202, v202
v_fmac_f32 v183, 0xc4200000, v202
v_mul_f32 v183, s19, v183
v_cos_f32 v183, v183
s_mov_b32 s20, 324
v_mad_u32_u24 v184, v200, s20, v201
v_cvt_f32_u32 v184, v184
v_mul_f32 v202, s19, v184
v_rndne_f32 v202, v202
v_fmac_f32 v184, 0xc4200000, v202
v_mul_f32 v184, s19, v184
v_cos_f32 v184, v184
s_nop 0
v_fma_f32 v185, v198, v184, -v183
v_fma_f32 v182, v198, v183, -v184
v_fma_f32 v186, v198, v185, -v184
v_fma_f32 v181, v198, v182, -v183
v_fma_f32 v187, v198, v186, -v185
v_fma_f32 v180, v198, v181, -v182
v_cvt_pk_bf16_f32 v100, v180, v181
v_cvt_pk_bf16_f32 v101, v182, v183
v_cvt_pk_bf16_f32 v102, v184, v185
v_cvt_pk_bf16_f32 v103, v186, v187
s_mov_b32 s20, 339
v_mad_u32_u24 v191, v200, s20, v201
v_cvt_f32_u32 v191, v191
v_mul_f32 v202, s19, v191
v_rndne_f32 v202, v202
v_fmac_f32 v191, 0xc4200000, v202
v_mul_f32 v191, s19, v191
v_cos_f32 v191, v191
s_mov_b32 s20, 340
v_mad_u32_u24 v192, v200, s20, v201
v_cvt_f32_u32 v192, v192
v_mul_f32 v202, s19, v192
v_rndne_f32 v202, v202
v_fmac_f32 v192, 0xc4200000, v202
v_mul_f32 v192, s19, v192
v_cos_f32 v192, v192
s_nop 0
v_fma_f32 v193, v198, v192, -v191
v_fma_f32 v190, v198, v191, -v192
v_fma_f32 v194, v198, v193, -v192
v_fma_f32 v189, v198, v190, -v191
v_fma_f32 v195, v198, v194, -v193
v_fma_f32 v188, v198, v189, -v190
v_cvt_pk_bf16_f32 v104, v188, v189
v_cvt_pk_bf16_f32 v105, v190, v191
v_cvt_pk_bf16_f32 v106, v192, v193
v_cvt_pk_bf16_f32 v107, v194, v195
v_pk_fma_f32 v[180:181], v[196:197], v[188:189], v[180:181] op_sel_hi:[0,1,1] neg_lo:[0,0,1] neg_hi:[0,0,1]
v_pk_fma_f32 v[182:183], v[196:197], v[190:191], v[182:183] op_sel_hi:[0,1,1] neg_lo:[0,0,1] neg_hi:[0,0,1]
v_pk_fma_f32 v[184:185], v[196:197], v[192:193], v[184:185] op_sel_hi:[0,1,1] neg_lo:[0,0,1] neg_hi:[0,0,1]
v_pk_fma_f32 v[186:187], v[196:197], v[194:195], v[186:187] op_sel_hi:[0,1,1] neg_lo:[0,0,1] neg_hi:[0,0,1]
v_cvt_pk_bf16_f32 v108, v180, v181
v_cvt_pk_bf16_f32 v109, v182, v183
v_cvt_pk_bf16_f32 v110, v184, v185
v_cvt_pk_bf16_f32 v111, v186, v187
v_pk_fma_f32 v[188:189], v[196:197], v[180:181], v[188:189] op_sel_hi:[0,1,1] neg_lo:[0,0,1] neg_hi:[0,0,1]
v_pk_fma_f32 v[190:191], v[196:197], v[182:183], v[190:191] op_sel_hi:[0,1,1] neg_lo:[0,0,1] neg_hi:[0,0,1]
v_pk_fma_f32 v[192:193], v[196:197], v[184:185], v[192:193] op_sel_hi:[0,1,1] neg_lo:[0,0,1] neg_hi:[0,0,1]
v_pk_fma_f32 v[194:195], v[196:197], v[186:187], v[194:195] op_sel_hi:[0,1,1] neg_lo:[0,0,1] neg_hi:[0,0,1]
v_cvt_pk_bf16_f32 v112, v188, v189
v_cvt_pk_bf16_f32 v113, v190, v191
v_cvt_pk_bf16_f32 v114, v192, v193
v_cvt_pk_bf16_f32 v115, v194, v195
v_pk_fma_f32 v[180:181], v[196:197], v[188:189], v[180:181] op_sel_hi:[0,1,1] neg_lo:[0,0,1] neg_hi:[0,0,1]
v_pk_fma_f32 v[182:183], v[196:197], v[190:191], v[182:183] op_sel_hi:[0,1,1] neg_lo:[0,0,1] neg_hi:[0,0,1]
v_pk_fma_f32 v[184:185], v[196:197], v[192:193], v[184:185] op_sel_hi:[0,1,1] neg_lo:[0,0,1] neg_hi:[0,0,1]
v_pk_fma_f32 v[186:187], v[196:197], v[194:195], v[186:187] op_sel_hi:[0,1,1] neg_lo:[0,0,1] neg_hi:[0,0,1]
v_cvt_pk_bf16_f32 v116, v180, v181
v_cvt_pk_bf16_f32 v117, v182, v183
v_cvt_pk_bf16_f32 v118, v184, v185
v_cvt_pk_bf16_f32 v119, v186, v187
v_pk_fma_f32 v[188:189], v[196:197], v[180:181], v[188:189] op_sel_hi:[0,1,1] neg_lo:[0,0,1] neg_hi:[0,0,1]
v_pk_fma_f32 v[190:191], v[196:197], v[182:183], v[190:191] op_sel_hi:[0,1,1] neg_lo:[0,0,1] neg_hi:[0,0,1]
v_pk_fma_f32 v[192:193], v[196:197], v[184:185], v[192:193] op_sel_hi:[0,1,1] neg_lo:[0,0,1] neg_hi:[0,0,1]
v_pk_fma_f32 v[194:195], v[196:197], v[186:187], v[194:195] op_sel_hi:[0,1,1] neg_lo:[0,0,1] neg_hi:[0,0,1]
v_cvt_pk_bf16_f32 v120, v188, v189
v_cvt_pk_bf16_f32 v121, v190, v191
v_cvt_pk_bf16_f32 v122, v192, v193
v_cvt_pk_bf16_f32 v123, v194, v195
v_pk_fma_f32 v[180:181], v[196:197], v[188:189], v[180:181] op_sel_hi:[0,1,1] neg_lo:[0,0,1] neg_hi:[0,0,1]
v_pk_fma_f32 v[182:183], v[196:197], v[190:191], v[182:183] op_sel_hi:[0,1,1] neg_lo:[0,0,1] neg_hi:[0,0,1]
v_pk_fma_f32 v[184:185], v[196:197], v[192:193], v[184:185] op_sel_hi:[0,1,1] neg_lo:[0,0,1] neg_hi:[0,0,1]
v_pk_fma_f32 v[186:187], v[196:197], v[194:195], v[186:187] op_sel_hi:[0,1,1] neg_lo:[0,0,1] neg_hi:[0,0,1]
v_cvt_pk_bf16_f32 v124, v180, v181
v_cvt_pk_bf16_f32 v125, v182, v183
v_cvt_pk_bf16_f32 v126, v184, v185
v_cvt_pk_bf16_f32 v127, v186, v187
v_pk_fma_f32 v[188:189], v[196:197], v[180:181], v[188:189] op_sel_hi:[0,1,1] neg_lo:[0,0,1] neg_hi:[0,0,1]
v_pk_fma_f32 v[190:191], v[196:197], v[182:183], v[190:191] op_sel_hi:[0,1,1] neg_lo:[0,0,1] neg_hi:[0,0,1]
v_pk_fma_f32 v[192:193], v[196:197], v[184:185], v[192:193] op_sel_hi:[0,1,1] neg_lo:[0,0,1] neg_hi:[0,0,1]
v_pk_fma_f32 v[194:195], v[196:197], v[186:187], v[194:195] op_sel_hi:[0,1,1] neg_lo:[0,0,1] neg_hi:[0,0,1]
v_cvt_pk_bf16_f32 v128, v188, v189
v_cvt_pk_bf16_f32 v129, v190, v191
v_cvt_pk_bf16_f32 v130, v192, v193
v_cvt_pk_bf16_f32 v131, v194, v195
v_pk_fma_f32 v[180:181], v[196:197], v[188:189], v[180:181] op_sel_hi:[0,1,1] neg_lo:[0,0,1] neg_hi:[0,0,1]
v_pk_fma_f32 v[182:183], v[196:197], v[190:191], v[182:183] op_sel_hi:[0,1,1] neg_lo:[0,0,1] neg_hi:[0,0,1]
v_pk_fma_f32 v[184:185], v[196:197], v[192:193], v[184:185] op_sel_hi:[0,1,1] neg_lo:[0,0,1] neg_hi:[0,0,1]
v_pk_fma_f32 v[186:187], v[196:197], v[194:195], v[186:187] op_sel_hi:[0,1,1] neg_lo:[0,0,1] neg_hi:[0,0,1]
v_cvt_pk_bf16_f32 v132, v180, v181
v_cvt_pk_bf16_f32 v133, v182, v183
v_cvt_pk_bf16_f32 v134, v184, v185
v_cvt_pk_bf16_f32 v135, v186, v187
v_pk_fma_f32 v[188:189], v[196:197], v[180:181], v[188:189] op_sel_hi:[0,1,1] neg_lo:[0,0,1] neg_hi:[0,0,1]
v_pk_fma_f32 v[190:191], v[196:197], v[182:183], v[190:191] op_sel_hi:[0,1,1] neg_lo:[0,0,1] neg_hi:[0,0,1]
v_pk_fma_f32 v[192:193], v[196:197], v[184:185], v[192:193] op_sel_hi:[0,1,1] neg_lo:[0,0,1] neg_hi:[0,0,1]
v_pk_fma_f32 v[194:195], v[196:197], v[186:187], v[194:195] op_sel_hi:[0,1,1] neg_lo:[0,0,1] neg_hi:[0,0,1]
v_cvt_pk_bf16_f32 v136, v188, v189
v_cvt_pk_bf16_f32 v137, v190, v191
v_cvt_pk_bf16_f32 v138, v192, v193
v_cvt_pk_bf16_f32 v139, v194, v195
v_pk_fma_f32 v[180:181], v[196:197], v[188:189], v[180:181] op_sel_hi:[0,1,1] neg_lo:[0,0,1] neg_hi:[0,0,1]
v_pk_fma_f32 v[182:183], v[196:197], v[190:191], v[182:183] op_sel_hi:[0,1,1] neg_lo:[0,0,1] neg_hi:[0,0,1]
v_pk_fma_f32 v[184:185], v[196:197], v[192:193], v[184:185] op_sel_hi:[0,1,1] neg_lo:[0,0,1] neg_hi:[0,0,1]
v_pk_fma_f32 v[186:187], v[196:197], v[194:195], v[186:187] op_sel_hi:[0,1,1] neg_lo:[0,0,1] neg_hi:[0,0,1]
v_cvt_pk_bf16_f32 v140, v180, v181
v_cvt_pk_bf16_f32 v141, v182, v183
v_cvt_pk_bf16_f32 v142, v184, v185
v_cvt_pk_bf16_f32 v143, v186, v187
v_pk_fma_f32 v[188:189], v[196:197], v[180:181], v[188:189] op_sel_hi:[0,1,1] neg_lo:[0,0,1] neg_hi:[0,0,1]
v_pk_fma_f32 v[190:191], v[196:197], v[182:183], v[190:191] op_sel_hi:[0,1,1] neg_lo:[0,0,1] neg_hi:[0,0,1]
v_pk_fma_f32 v[192:193], v[196:197], v[184:185], v[192:193] op_sel_hi:[0,1,1] neg_lo:[0,0,1] neg_hi:[0,0,1]
v_pk_fma_f32 v[194:195], v[196:197], v[186:187], v[194:195] op_sel_hi:[0,1,1] neg_lo:[0,0,1] neg_hi:[0,0,1]
v_cvt_pk_bf16_f32 v144, v188, v189
v_cvt_pk_bf16_f32 v145, v190, v191
v_cvt_pk_bf16_f32 v146, v192, v193
v_cvt_pk_bf16_f32 v147, v194, v195
v_pk_fma_f32 v[180:181], v[196:197], v[188:189], v[180:181] op_sel_hi:[0,1,1] neg_lo:[0,0,1] neg_hi:[0,0,1]
v_pk_fma_f32 v[182:183], v[196:197], v[190:191], v[182:183] op_sel_hi:[0,1,1] neg_lo:[0,0,1] neg_hi:[0,0,1]
v_pk_fma_f32 v[184:185], v[196:197], v[192:193], v[184:185] op_sel_hi:[0,1,1] neg_lo:[0,0,1] neg_hi:[0,0,1]
v_pk_fma_f32 v[186:187], v[196:197], v[194:195], v[186:187] op_sel_hi:[0,1,1] neg_lo:[0,0,1] neg_hi:[0,0,1]
v_cvt_pk_bf16_f32 v148, v180, v181
v_cvt_pk_bf16_f32 v149, v182, v183
v_cvt_pk_bf16_f32 v150, v184, v185
v_cvt_pk_bf16_f32 v151, v186, v187
v_pk_fma_f32 v[188:189], v[196:197], v[180:181], v[188:189] op_sel_hi:[0,1,1] neg_lo:[0,0,1] neg_hi:[0,0,1]
v_pk_fma_f32 v[190:191], v[196:197], v[182:183], v[190:191] op_sel_hi:[0,1,1] neg_lo:[0,0,1] neg_hi:[0,0,1]
v_pk_fma_f32 v[192:193], v[196:197], v[184:185], v[192:193] op_sel_hi:[0,1,1] neg_lo:[0,0,1] neg_hi:[0,0,1]
v_pk_fma_f32 v[194:195], v[196:197], v[186:187], v[194:195] op_sel_hi:[0,1,1] neg_lo:[0,0,1] neg_hi:[0,0,1]
v_cvt_pk_bf16_f32 v152, v188, v189
v_cvt_pk_bf16_f32 v153, v190, v191
v_cvt_pk_bf16_f32 v154, v192, v193
v_cvt_pk_bf16_f32 v155, v194, v195
v_pk_fma_f32 v[180:181], v[196:197], v[188:189], v[180:181] op_sel_hi:[0,1,1] neg_lo:[0,0,1] neg_hi:[0,0,1]
v_pk_fma_f32 v[182:183], v[196:197], v[190:191], v[182:183] op_sel_hi:[0,1,1] neg_lo:[0,0,1] neg_hi:[0,0,1]
v_pk_fma_f32 v[184:185], v[196:197], v[192:193], v[184:185] op_sel_hi:[0,1,1] neg_lo:[0,0,1] neg_hi:[0,0,1]
v_pk_fma_f32 v[186:187], v[196:197], v[194:195], v[186:187] op_sel_hi:[0,1,1] neg_lo:[0,0,1] neg_hi:[0,0,1]
v_cvt_pk_bf16_f32 v156, v180, v181
v_cvt_pk_bf16_f32 v157, v182, v183
v_cvt_pk_bf16_f32 v158, v184, v185
v_cvt_pk_bf16_f32 v159, v186, v187
v_pk_fma_f32 v[188:189], v[196:197], v[180:181], v[188:189] op_sel_hi:[0,1,1] neg_lo:[0,0,1] neg_hi:[0,0,1]
v_pk_fma_f32 v[190:191], v[196:197], v[182:183], v[190:191] op_sel_hi:[0,1,1] neg_lo:[0,0,1] neg_hi:[0,0,1]
v_pk_fma_f32 v[192:193], v[196:197], v[184:185], v[192:193] op_sel_hi:[0,1,1] neg_lo:[0,0,1] neg_hi:[0,0,1]
v_pk_fma_f32 v[194:195], v[196:197], v[186:187], v[194:195] op_sel_hi:[0,1,1] neg_lo:[0,0,1] neg_hi:[0,0,1]
v_cvt_pk_bf16_f32 v160, v188, v189
v_cvt_pk_bf16_f32 v161, v190, v191
v_cvt_pk_bf16_f32 v162, v192, v193
v_cvt_pk_bf16_f32 v163, v194, v195
v_pk_fma_f32 v[180:181], v[196:197], v[188:189], v[180:181] op_sel_hi:[0,1,1] neg_lo:[0,0,1] neg_hi:[0,0,1]
v_pk_fma_f32 v[182:183], v[196:197], v[190:191], v[182:183] op_sel_hi:[0,1,1] neg_lo:[0,0,1] neg_hi:[0,0,1]
v_pk_fma_f32 v[184:185], v[196:197], v[192:193], v[184:185] op_sel_hi:[0,1,1] neg_lo:[0,0,1] neg_hi:[0,0,1]
v_pk_fma_f32 v[186:187], v[196:197], v[194:195], v[186:187] op_sel_hi:[0,1,1] neg_lo:[0,0,1] neg_hi:[0,0,1]
v_cvt_pk_bf16_f32 v164, v180, v181
v_cvt_pk_bf16_f32 v165, v182, v183
v_cvt_pk_bf16_f32 v166, v184, v185
v_cvt_pk_bf16_f32 v167, v186, v187
v_pk_fma_f32 v[188:189], v[196:197], v[180:181], v[188:189] op_sel_hi:[0,1,1] neg_lo:[0,0,1] neg_hi:[0,0,1]
v_pk_fma_f32 v[190:191], v[196:197], v[182:183], v[190:191] op_sel_hi:[0,1,1] neg_lo:[0,0,1] neg_hi:[0,0,1]
v_pk_fma_f32 v[192:193], v[196:197], v[184:185], v[192:193] op_sel_hi:[0,1,1] neg_lo:[0,0,1] neg_hi:[0,0,1]
v_pk_fma_f32 v[194:195], v[196:197], v[186:187], v[194:195] op_sel_hi:[0,1,1] neg_lo:[0,0,1] neg_hi:[0,0,1]
v_cvt_pk_bf16_f32 v168, v188, v189
v_cvt_pk_bf16_f32 v169, v190, v191
v_cvt_pk_bf16_f32 v170, v192, v193
v_cvt_pk_bf16_f32 v171, v194, v195
v_pk_fma_f32 v[180:181], v[196:197], v[188:189], v[180:181] op_sel_hi:[0,1,1] neg_lo:[0,0,1] neg_hi:[0,0,1]
v_pk_fma_f32 v[182:183], v[196:197], v[190:191], v[182:183] op_sel_hi:[0,1,1] neg_lo:[0,0,1] neg_hi:[0,0,1]
v_pk_fma_f32 v[184:185], v[196:197], v[192:193], v[184:185] op_sel_hi:[0,1,1] neg_lo:[0,0,1] neg_hi:[0,0,1]
v_pk_fma_f32 v[186:187], v[196:197], v[194:195], v[186:187] op_sel_hi:[0,1,1] neg_lo:[0,0,1] neg_hi:[0,0,1]
v_cvt_pk_bf16_f32 v172, v180, v181
v_cvt_pk_bf16_f32 v173, v182, v183
v_cvt_pk_bf16_f32 v174, v184, v185
v_cvt_pk_bf16_f32 v175, v186, v187
v_pk_fma_f32 v[188:189], v[196:197], v[180:181], v[188:189] op_sel_hi:[0,1,1] neg_lo:[0,0,1] neg_hi:[0,0,1]
v_pk_fma_f32 v[190:191], v[196:197], v[182:183], v[190:191] op_sel_hi:[0,1,1] neg_lo:[0,0,1] neg_hi:[0,0,1]
v_pk_fma_f32 v[192:193], v[196:197], v[184:185], v[192:193] op_sel_hi:[0,1,1] neg_lo:[0,0,1] neg_hi:[0,0,1]
v_pk_fma_f32 v[194:195], v[196:197], v[186:187], v[194:195] op_sel_hi:[0,1,1] neg_lo:[0,0,1] neg_hi:[0,0,1]
v_cvt_pk_bf16_f32 v176, v188, v189
v_cvt_pk_bf16_f32 v177, v190, v191
v_cvt_pk_bf16_f32 v178, v192, v193
v_cvt_pk_bf16_f32 v179, v194, v195
v_mov_b32 v180, s24
v_mov_b32 v181, s24
v_mov_b32 v182, s24
v_mov_b32 v183, s24
s_nop 1
v_mfma_f32_32x32x16_bf16 v[184:199], v[180:183], v[20:23], 0
v_mfma_f32_32x32x16_bf16 v[184:199], v[180:183], v[24:27], v[184:199]
v_mfma_f32_32x32x16_bf16 v[184:199], v[180:183], v[28:31], v[184:199]
v_mfma_f32_32x32x16_bf16 v[184:199], v[180:183], v[32:35], v[184:199]
v_mfma_f32_32x32x16_bf16 v[184:199], v[180:183], v[36:39], v[184:199]
v_mfma_f32_32x32x16_bf16 v[184:199], v[180:183], v[40:43], v[184:199]
v_mfma_f32_32x32x16_bf16 v[184:199], v[180:183], v[44:47], v[184:199]
v_mfma_f32_32x32x16_bf16 v[184:199], v[180:183], v[48:51], v[184:199]
v_mfma_f32_32x32x16_bf16 v[184:199], v[180:183], v[52:55], v[184:199]
v_mfma_f32_32x32x16_bf16 v[184:199], v[180:183], v[56:59], v[184:199]
v_mfma_f32_32x32x16_bf16 v[184:199], v[180:183], v[60:63], v[184:199]
v_mfma_f32_32x32x16_bf16 v[184:199], v[180:183], v[64:67], v[184:199]
v_mfma_f32_32x32x16_bf16 v[184:199], v[180:183], v[68:71], v[184:199]
v_mfma_f32_32x32x16_bf16 v[184:199], v[180:183], v[72:75], v[184:199]
v_mfma_f32_32x32x16_bf16 v[184:199], v[180:183], v[76:79], v[184:199]
v_mfma_f32_32x32x16_bf16 v[184:199], v[180:183], v[80:83], v[184:199]
v_mfma_f32_32x32x16_bf16 v[184:199], v[180:183], v[84:87], v[184:199]
v_mfma_f32_32x32x16_bf16 v[184:199], v[180:183], v[88:91], v[184:199]
v_mfma_f32_32x32x16_bf16 v[184:199], v[180:183], v[92:95], v[184:199]
v_mfma_f32_32x32x16_bf16 v[184:199], v[180:183], v[96:99], v[184:199]
v_mfma_f32_32x32x16_bf16 v[184:199], v[180:183], v[100:103], v[184:199]
v_mfma_f32_32x32x16_bf16 v[184:199], v[180:183], v[104:107], v[184:199]
v_mfma_f32_32x32x16_bf16 v[184:199], v[180:183], v[108:111], v[184:199]
v_mfma_f32_32x32x16_bf16 v[184:199], v[180:183], v[112:115], v[184:199]
v_mfma_f32_32x32x16_bf16 v[184:199], v[180:183], v[116:119], v[184:199]
v_mfma_f32_32x32x16_bf16 v[184:199], v[180:183], v[120:123], v[184:199]
v_mfma_f32_32x32x16_bf16 v[184:199], v[180:183], v[124:127], v[184:199]
v_mfma_f32_32x32x16_bf16 v[184:199], v[180:183], v[128:131], v[184:199]
v_mfma_f32_32x32x16_bf16 v[184:199], v[180:183], v[132:135], v[184:199]
v_mfma_f32_32x32x16_bf16 v[184:199], v[180:183], v[136:139], v[184:199]
v_mfma_f32_32x32x16_bf16 v[184:199], v[180:183], v[140:143], v[184:199]
v_mfma_f32_32x32x16_bf16 v[184:199], v[180:183], v[144:147], v[184:199]
v_mfma_f32_32x32x16_bf16 v[184:199], v[180:183], v[148:151], v[184:199]
v_mfma_f32_32x32x16_bf16 v[184:199], v[180:183], v[152:155], v[184:199]
v_mfma_f32_32x32x16_bf16 v[184:199], v[180:183], v[156:159], v[184:199]
v_mfma_f32_32x32x16_bf16 v[184:199], v[180:183], v[160:163], v[184:199]
v_mfma_f32_32x32x16_bf16 v[184:199], v[180:183], v[164:167], v[184:199]
v_mfma_f32_32x32x16_bf16 v[184:199], v[180:183], v[168:171], v[184:199]
v_mfma_f32_32x32x16_bf16 v[184:199], v[180:183], v[172:175], v[184:199]
v_mfma_f32_32x32x16_bf16 v[184:199], v[180:183], v[176:179], v[184:199]
s_nop 11
v_mov_b32 v9, v184
p1q_45:
s_mul_i32 s18, s30, 21846
s_lshr_b32 s18, s18, 16
s_mul_i32 s18, s18, 3
s_sub_u32 s18, s30, s18
s_and_b32 s19, s30, 3
s_cmp_lt_u32 s30, 56
s_cselect_b32 s18, s18, s19
s_mul_i32 s18, s18, 2560
s_add_u32 s18, s18, 11665408
s_add_u32 s29, s30, 1
s_cmp_lg_u32 s13, 0
s_cbranch_scc1 polld_47
v_lshlrev_b32 v3, 3, v0
v_min_u32 v16, 2432, v3
s_mov_b32 s17, 0
poll_46:
buffer_load_dword v12, v16, s[4:7], s18 offen sc1
s_add_u32 s17, s17, 1
s_cmp_gt_u32 s17, 262144
s_cbranch_scc1 L_fail
s_waitcnt vmcnt(0)
v_cmp_gt_u32 vcc, s29, v12
s_cbranch_vccz polld_47
s_sleep 2
s_branch poll_46
polld_47:
s_barrier
s_mul_i32 s18, s30, 40960
s_add_u32 s26, s18, 91226112
s_add_u32 s26, s26, s31
s_add_u32 s27, s18, 100663296
s_add_u32 s27, s27, s33
s_add_u32 m0, s31, 2048
s_add_u32 s20, s26, 0
buffer_load_dwordx4 v0, s[4:7], s20 offen sc1 lds
s_add_u32 m0, s31, 3072
s_add_u32 s20, s26, 1024
buffer_load_dwordx4 v0, s[4:7], s20 offen sc1 lds
s_add_u32 m0, s31, 4096
s_add_u32 s20, s26, 2048
buffer_load_dwordx4 v0, s[4:7], s20 offen sc1 lds
s_add_u32 m0, s31, 5120
s_add_u32 s20, s26, 3072
buffer_load_dwordx4 v0, s[4:7], s20 offen sc1 lds
s_add_u32 m0, s31, 6144
s_add_u32 s20, s26, 4096
buffer_load_dwordx4 v0, s[4:7], s20 offen sc1 lds
s_add_u32 m0, s31, 7168
s_add_u32 s20, s26, 5120
buffer_load_dwordx4 v0, s[4:7], s20 offen sc1 lds
s_add_u32 m0, s31, 8192
s_add_u32 s20, s26, 6144
buffer_load_dwordx4 v0, s[4:7], s20 offen sc1 lds
s_add_u32 m0, s31, 9216
s_add_u32 s20, s26, 7168
buffer_load_dwordx4 v0, s[4:7], s20 offen sc1 lds
s_add_u32 m0, s31, 10240
s_add_u32 s20, s26, 8192
buffer_load_dwordx4 v0, s[4:7], s20 offen sc1 lds
s_add_u32 m0, s31, 11264
s_add_u32 s20, s26, 9216
buffer_load_dwordx4 v0, s[4:7], s20 offen sc1 lds
s_waitcnt vmcnt(0)
s_barrier
v_add_u32 v2, s31, v0
ds_read_b128 v[220:223], v2 offset:2048
ds_read_b128 v[224:227], v2 offset:3072
ds_read_b128 v[228:231], v2 offset:4096
ds_read_b128 v[200:203], v0 offset:3072
ds_read_b128 v[232:235], v2 offset:5120
ds_read_b128 v[196:199], v0 offset:2048
v_mov_b64 v[212:213], 0
ds_read_b128 v[204:207], v0 offset:4096
ds_read_b128 v[208:211], v0 offset:5120
s_waitcnt lgkmcnt(7)
v_dot2c_f32_bf16 v212, s24, v220
v_dot2c_f32_bf16 v213, v220, v220
v_dot2c_f32_bf16 v212, s24, v221
v_dot2c_f32_bf16 v213, v221, v221
v_dot2c_f32_bf16 v212, s24, v222
v_dot2c_f32_bf16 v213, v222, v222
v_dot2c_f32_bf16 v212, s24, v223
s_waitcnt lgkmcnt(5)
v_dot2c_f32_bf16 v213, v223, v223
v_dot2c_f32_bf16 v212, s24, v224
v_dot2c_f32_bf16 v213, v224, v224
v_dot2c_f32_bf16 v212, s24, v225
v_dot2c_f32_bf16 v213, v225, v225
v_dot2c_f32_bf16 v212, s24, v226
v_dot2c_f32_bf16 v213, v226, v226
v_dot2c_f32_bf16 v212, s24, v227
v_dot2c_f32_bf16 v213, v227, v227
v_dot2c_f32_bf16 v212, s24, v228
v_dot2c_f32_bf16 v213, v228, v228
s_waitcnt lgkmcnt(3)
ds_read_b128 v[220:223], v2 offset:6144
ds_read_b128 v[224:227], v2 offset:7168
v_dot2c_f32_bf16 v212, s24, v229
v_dot2c_f32_bf16 v213, v229, v229
v_dot2c_f32_bf16 v212, s24, v230
v_dot2c_f32_bf16 v213, v230, v230
v_dot2c_f32_bf16 v212, s24, v231
v_dot2c_f32_bf16 v213, v231, v231
v_dot2c_f32_bf16 v212, s24, v232
v_dot2c_f32_bf16 v213, v232, v232
v_dot2c_f32_bf16 v212, s24, v233
v_dot2c_f32_bf16 v213, v233, v233
v_dot2c_f32_bf16 v212, s24, v234
v_dot2c_f32_bf16 v213, v234, v234
v_dot2c_f32_bf16 v212, s24, v235
v_dot2c_f32_bf16 v213, v235, v235
s_waitcnt lgkmcnt(1)
ds_read_b128 v[232:235], v2 offset:9216
ds_read_b128 v[228:231], v2 offset:8192
v_dot2c_f32_bf16 v212, s24, v220
v_dot2c_f32_bf16 v213, v220, v220
v_dot2c_f32_bf16 v212, s24, v221
s_waitcnt lgkmcnt(2)
v_dot2c_f32_bf16 v213, v221, v221
v_dot2c_f32_bf16 v212, s24, v222
v_dot2c_f32_bf16 v213, v222, v222
v_dot2c_f32_bf16 v212, s24, v223
v_dot2c_f32_bf16 v213, v223, v223
v_dot2c_f32_bf16 v212, s24, v224
v_dot2c_f32_bf16 v213, v224, v224
v_dot2c_f32_bf16 v212, s24, v225
v_dot2c_f32_bf16 v213, v225, v225
v_dot2c_f32_bf16 v212, s24, v226
v_dot2c_f32_bf16 v213, v226, v226
v_dot2c_f32_bf16 v212, s24, v227
v_dot2c_f32_bf16 v213, v227, v227
s_waitcnt lgkmcnt(0)
ds_read_b128 v[220:223], v2 offset:10240
ds_read_b128 v[224:227], v2 offset:11264
v_dot2c_f32_bf16 v212, s24, v228
v_dot2c_f32_bf16 v213, v228, v228
v_dot2c_f32_bf16 v212, s24, v229
v_dot2c_f32_bf16 v213, v229, v229
v_dot2c_f32_bf16 v212, s24, v230
v_dot2c_f32_bf16 v213, v230, v230
v_dot2c_f32_bf16 v212, s24, v231
v_dot2c_f32_bf16 v213, v231, v231
v_dot2c_f32_bf16 v212, s24, v232
v_dot2c_f32_bf16 v213, v232, v232
v_dot2c_f32_bf16 v212, s24, v233
v_dot2c_f32_bf16 v213, v233, v233
v_dot2c_f32_bf16 v212, s24, v234
v_dot2c_f32_bf16 v213, v234, v234
s_waitcnt lgkmcnt(1)
v_dot2c_f32_bf16 v212, s24, v235
v_dot2c_f32_bf16 v213, v235, v235
v_dot2c_f32_bf16 v212, s24, v220
s_waitcnt lgkmcnt(0)
v_dot2c_f32_bf16 v213, v220, v220
v_dot2c_f32_bf16 v212, s24, v221
v_dot2c_f32_bf16 v213, v221, v221
v_dot2c_f32_bf16 v212, s24, v222
v_dot2c_f32_bf16 v213, v222, v222
v_dot2c_f32_bf16 v212, s24, v223
v_dot2c_f32_bf16 v213, v223, v223
v_dot2c_f32_bf16 v212, s24, v224
v_dot2c_f32_bf16 v213, v224, v224
v_dot2c_f32_bf16 v212, s24, v225
v_dot2c_f32_bf16 v213, v225, v225
v_dot2c_f32_bf16 v212, s24, v226
v_dot2c_f32_bf16 v213, v226, v226
v_dot2c_f32_bf16 v212, s24, v227
v_dot2c_f32_bf16 v213, v227, v227
v_mfma_f32_32x32x16_bf16 v[180:195], v[196:199], v[20:23], 0
s_nop 1
v_permlane32_swap_b32 v212, v213
ds_read_b128 v[196:199], v0 offset:6144
v_mfma_f32_32x32x16_bf16 v[180:195], v[200:203], v[24:27], v[180:195]
v_and_b32 v2, 0x1ff, v0
v_add_f32 v212, v212, v213
v_mfma_f32_32x32x16_bf16 v[180:195], v[204:207], v[28:31], v[180:195]
v_lshl_add_u32 v213, s13, 2, v0
ds_read_b128 v[200:203], v0 offset:7168
ds_write_b32 v213, v212 offset:0
v_mfma_f32_32x32x16_bf16 v[180:195], v[208:211], v[32:35], v[180:195]
s_waitcnt lgkmcnt(2)
ds_read_b128 v[204:207], v0 offset:8192
ds_read_b128 v[208:211], v0 offset:9216
v_mfma_f32_32x32x16_bf16 v[180:195], v[196:199], v[36:39], v[180:195]
s_waitcnt lgkmcnt(3)
v_mfma_f32_32x32x16_bf16 v[180:195], v[200:203], v[40:43], v[180:195]
s_waitcnt lgkmcnt(2)
ds_read_b128 v[196:199], v0 offset:10240
s_waitcnt lgkmcnt(2)
s_waitcnt lgkmcnt(1)
v_mfma_f32_32x32x16_bf16 v[180:195], v[204:207], v[44:47], v[180:195]
ds_read_b128 v[200:203], v0 offset:11264
s_barrier
ds_read_b128 v[212:215], v2 offset:0
v_mfma_f32_32x32x16_bf16 v[180:195], v[208:211], v[48:51], v[180:195]
ds_read_b128 v[208:211], v0 offset:13312
ds_read_b128 v[204:207], v0 offset:12288
s_waitcnt lgkmcnt(4)
v_mfma_f32_32x32x16_bf16 v[180:195], v[196:199], v[52:55], v[180:195]
s_waitcnt lgkmcnt(3)
ds_read_b128 v[216:219], v2 offset:512
ds_read_b128 v[196:199], v0 offset:14336
v_mfma_f32_32x32x16_bf16 v[180:195], v[200:203], v[56:59], v[180:195]
s_waitcnt lgkmcnt(2)
v_mfma_f32_32x32x16_bf16 v[180:195], v[204:207], v[60:63], v[180:195]
ds_read_b128 v[200:203], v0 offset:15360
ds_read_b128 v[204:207], v0 offset:16384
v_add_f32 v212, v212, v213
v_add_f32 v214, v214, v215
s_waitcnt lgkmcnt(3)
v_mfma_f32_32x32x16_bf16 v[180:195], v[208:211], v[64:67], v[180:195]
s_waitcnt lgkmcnt(2)
ds_read_b128 v[208:211], v0 offset:17408
v_add_f32 v216, v216, v217
v_add_f32 v212, v212, v214
v_mfma_f32_32x32x16_bf16 v[180:195], v[196:199], v[68:71], v[180:195]
s_waitcnt lgkmcnt(2)
v_mfma_f32_32x32x16_bf16 v[180:195], v[200:203], v[72:75], v[180:195]
v_mul_f32 v212, 0x3acccccd, v212
s_waitcnt lgkmcnt(1)
ds_read_b128 v[196:199], v0 offset:18432
v_add_f32 v218, v218, v219
s_waitcnt lgkmcnt(1)
v_mfma_f32_32x32x16_bf16 v[180:195], v[204:207], v[76:79], v[180:195]
v_lshrrev_b32 v213, 2, v0
ds_read_b128 v[200:203], v0 offset:19456
v_mfma_f32_32x32x16_bf16 v[180:195], v[208:211], v[80:83], v[180:195]
ds_read_b128 v[204:207], v0 offset:20480
ds_read_b128 v[208:211], v0 offset:21504
v_add_f32 v216, v216, v218
v_mul_f32 v216, 0x3acccccd, v216
s_waitcnt lgkmcnt(3)
v_mfma_f32_32x32x16_bf16 v[180:195], v[196:199], v[84:87], v[180:195]
v_fma_f32 v216, -v212, v212, v216
s_waitcnt lgkmcnt(2)
v_max_f32 v216, 0, v216
v_add_f32 v216, 0x3727c5ac, v216
v_mfma_f32_32x32x16_bf16 v[180:195], v[200:203], v[88:91], v[180:195]
ds_read_b128 v[196:199], v0 offset:22528
s_waitcnt lgkmcnt(2)
v_bfe_u32 v214, v0, 5, 5
v_lshl_add_u32 v213, s13, 8, v213
v_mfma_f32_32x32x16_bf16 v[180:195], v[204:207], v[92:95], v[180:195]
ds_read_b128 v[200:203], v0 offset:23552
ds_read_b128 v[204:207], v0 offset:24576
v_rsq_f32 v216, v216
s_waitcnt lgkmcnt(3)
v_and_b32 v214, 16, v214
v_mfma_f32_32x32x16_bf16 v[180:195], v[208:211], v[96:99], v[180:195]
ds_read_b128 v[208:211], v0 offset:25600
s_waitcnt lgkmcnt(3)
v_mul_f32 v212, v216, v212
v_mfma_f32_32x32x16_bf16 v[180:195], v[196:199], v[100:103], v[180:195]
v_lshl_add_u32 v214, s13, 8, v214
v_permlane32_swap_b32 v216, v212
s_waitcnt lgkmcnt(2)
ds_read_b128 v[196:199], v0 offset:26624
v_mfma_f32_32x32x16_bf16 v[180:195], v[200:203], v[104:107], v[180:195]
ds_write_b32 v213, v216 offset:1024
s_waitcnt lgkmcnt(3)
s_waitcnt lgkmcnt(2)
v_mfma_f32_32x32x16_bf16 v[180:195], v[204:207], v[108:111], v[180:195]
ds_read_b128 v[244:247], v214 offset:1216
ds_read_b128 v[200:203], v0 offset:27648
v_mfma_f32_32x32x16_bf16 v[180:195], v[208:211], v[112:115], v[180:195]
ds_read_b128 v[204:207], v0 offset:28672
s_waitcnt lgkmcnt(4)
ds_read_b128 v[236:239], v214 offset:1152
v_mfma_f32_32x32x16_bf16 v[180:195], v[196:199], v[116:119], v[180:195]
ds_read_b128 v[208:211], v0 offset:29696
ds_read_b128 v[196:199], v0 offset:30720
s_waitcnt lgkmcnt(4)
v_mfma_f32_32x32x16_bf16 v[180:195], v[200:203], v[120:123], v[180:195]
ds_read_b128 v[232:235], v214 offset:1120
s_waitcnt lgkmcnt(4)
ds_read_b128 v[220:223], v214 offset:1024
ds_read_b128 v[200:203], v0 offset:31744
v_mfma_f32_32x32x16_bf16 v[180:195], v[204:207], v[124:127], v[180:195]
v_mul_f32 v245, v245, v9
s_waitcnt lgkmcnt(3)
ds_read_b128 v[204:207], v0 offset:32768
v_mfma_f32_32x32x16_bf16 v[180:195], v[208:211], v[128:131], v[180:195]
ds_read_b128 v[224:227], v214 offset:1056
v_mfma_f32_32x32x16_bf16 v[180:195], v[196:199], v[132:135], v[180:195]
ds_read_b128 v[208:211], v0 offset:33792
s_waitcnt lgkmcnt(3)
v_mfma_f32_32x32x16_bf16 v[180:195], v[200:203], v[136:139], v[180:195]
s_waitcnt lgkmcnt(2)
ds_read_b128 v[196:199], v0 offset:34816
ds_read_b128 v[228:231], v214 offset:1088
ds_read_b128 v[200:203], v0 offset:35840
ds_read_b128 v[248:251], v214 offset:1248
v_mfma_f32_32x32x16_bf16 v[180:195], v[204:207], v[140:143], v[180:195]
s_waitcnt lgkmcnt(4)
ds_read_b128 v[204:207], v0 offset:36864
v_mfma_f32_32x32x16_bf16 v[180:195], v[208:211], v[144:147], v[180:195]
v_mul_f32 v246, v246, v9
ds_read_b128 v[240:243], v214 offset:1184
s_waitcnt lgkmcnt(5)
v_mfma_f32_32x32x16_bf16 v[180:195], v[196:199], v[148:151], v[180:195]
ds_read_b128 v[208:211], v0 offset:37888
s_waitcnt lgkmcnt(3)
ds_read_b128 v[196:199], v0 offset:38912
v_mfma_f32_32x32x16_bf16 v[180:195], v[200:203], v[152:155], v[180:195]
ds_read_b128 v[200:203], v0 offset:39936
s_waitcnt lgkmcnt(4)
s_waitcnt lgkmcnt(3)
v_mul_f32 v244, v244, v9
v_mfma_f32_32x32x16_bf16 v[180:195], v[204:207], v[156:159], v[180:195]
v_mul_f32 v251, v251, v9
v_mul_f32 v249, v249, v9
v_mul_f32 v237, v237, v9
s_waitcnt lgkmcnt(2)
v_mfma_f32_32x32x16_bf16 v[180:195], v[208:211], v[160:163], v[180:195]
ds_read_b128 v[204:207], v0 offset:40960
s_waitcnt lgkmcnt(1)
ds_read_b128 v[208:211], v0 offset:41984
v_mul_f32 v236, v236, v9
v_mfma_f32_32x32x16_bf16 v[180:195], v[196:199], v[164:167], v[180:195]
v_mul_f32 v250, v250, v9
v_mul_f32 v248, v248, v9
v_mul_f32 v240, v240, v9
v_mfma_f32_32x32x16_bf16 v[180:195], v[200:203], v[168:171], v[180:195]
s_waitcnt lgkmcnt(0)
v_mul_f32 v243, v243, v9
v_mfma_f32_32x32x16_bf16 v[180:195], v[204:207], v[172:175], v[180:195]
v_mul_f32 v242, v242, v9
v_mfma_f32_32x32x16_bf16 v[180:195], v[208:211], v[176:179], v[180:195]
s_nop 0
v_mul_f32 v241, v241, v9
v_mul_f32 v239, v239, v9
v_mul_f32 v238, v238, v9
v_mul_f32 v247, v247, v9
s_nop 6
v_pk_fma_f32 v[188:189], v[188:189], v[228:229], v[244:245] neg_lo:[0,0,1] neg_hi:[0,0,1]
v_pk_fma_f32 v[186:187], v[186:187], v[226:227], v[242:243] neg_lo:[0,0,1] neg_hi:[0,0,1]
v_pk_fma_f32 v[184:185], v[184:185], v[224:225], v[240:241] neg_lo:[0,0,1] neg_hi:[0,0,1]
v_pk_fma_f32 v[192:193], v[192:193], v[232:233], v[248:249] neg_lo:[0,0,1] neg_hi:[0,0,1]
v_pk_fma_f32 v[180:181], v[180:181], v[220:221], v[236:237] neg_lo:[0,0,1] neg_hi:[0,0,1]
v_cvt_pk_bf16_f32 v198, v184, v185
v_pk_fma_f32 v[182:183], v[182:183], v[222:223], v[238:239] neg_lo:[0,0,1] neg_hi:[0,0,1]
v_cvt_pk_bf16_f32 v202, v192, v193
v_pk_fma_f32 v[194:195], v[194:195], v[234:235], v[250:251] neg_lo:[0,0,1] neg_hi:[0,0,1]
v_cvt_pk_bf16_f32 v203, v194, v195
v_cvt_pk_bf16_f32 v199, v186, v187
v_pk_fma_f32 v[190:191], v[190:191], v[230:231], v[246:247] neg_lo:[0,0,1] neg_hi:[0,0,1]
v_cvt_pk_bf16_f32 v197, v182, v183
v_cvt_pk_bf16_f32 v200, v188, v189
v_cvt_pk_bf16_f32 v201, v190, v191
v_cvt_pk_bf16_f32 v196, v180, v181
buffer_store_dwordx4 v[196:199], v10, s[4:7], s27 offen offset:0 sc1
buffer_store_dwordx4 v[200:203], v10, s[4:7], s27 offen offset:1024 sc1
s_add_u32 s30, s30, 3
s_cmp_lt_u32 s30, 60
s_cbranch_scc1 p1q_45
s_lshl_b32 s18, s54, 7
s_add_u32 s18, s18, 11552768
s_cmp_eq_u32 s13, 0
s_cselect_b32 s22, s18, s6
s_mov_b32 s23, 1
s_waitcnt vmcnt(0)
s_barrier
v_mov_b32 v3, s23
s_mov_b64 exec, 1
buffer_store_dword v3, off, s[4:7], s22 sc1
s_mov_b64 exec, -1
s_mov_b32 s22, s6
s_mov_b32 s34, s55
kvz_44:
s_add_u32 s16, s16, 1
s_cmp_lt_u32 s16, 2
s_cbranch_scc1 kvlay_28
s_endpgm
roleA_11:
s_sub_u32 s39, s15, 64
s_mul_i32 s50, s39, 13108
s_lshr_b32 s50, s50, 16
s_mul_i32 s18, s50, 5
s_sub_u32 s34, s39, s18
s_waitcnt vmcnt(0)
v_bfe_u32 v5, v0, 4, 5
v_mul_u32_u24 v5, 1280, v5
v_lshrrev_b32 v8, 9, v0
v_lshl_add_u32 v5, v8, 4, v5
v_and_b32 v6, 0x1ff, v0
v_lshlrev_b32 v6, 1, v6
v_lshl_add_u32 v6, v8, 4, v6
s_load_dwordx2 s[44:45], s[0:1], 0
s_mov_b32 s46, 2621440
s_mov_b32 s47, 0x20000
s_waitcnt lgkmcnt(0)
v_lshrrev_b32 v8, 7, v0
v_lshl_add_u32 v8, s13, 3, v8
v_bfe_u32 v9, v8, 1, 3
v_lshlrev_b32 v9, 4, v9
v_xor_b32 v9, v9, v0
v_and_b32 v9, 0x70, v9
v_mul_u32_u24 v8, 1280, v8
v_add_u32 v8, v8, v9
s_mul_i32 s26, s50, 40960
s_lshl_b32 s25, s13, 10
s_add_u32 m0, s25, 2048
s_add_u32 s20, s26, 0
buffer_load_dwordx4 v8, s[44:47], s20 offen sc1 lds
s_add_u32 m0, s25, 6144
s_add_u32 s20, s26, 128
buffer_load_dwordx4 v8, s[44:47], s20 offen sc1 lds
s_add_u32 m0, s25, 10240
s_add_u32 s20, s26, 256
buffer_load_dwordx4 v8, s[44:47], s20 offen sc1 lds
s_add_u32 m0, s25, 14336
s_add_u32 s20, s26, 384
buffer_load_dwordx4 v8, s[44:47], s20 offen sc1 lds
s_add_u32 m0, s25, 18432
s_add_u32 s20, s26, 512
buffer_load_dwordx4 v8, s[44:47], s20 offen sc1 lds
s_add_u32 m0, s25, 22528
s_add_u32 s20, s26, 640
buffer_load_dwordx4 v8, s[44:47], s20 offen sc1 lds
s_add_u32 m0, s25, 26624
s_add_u32 s20, s26, 768
buffer_load_dwordx4 v8, s[44:47], s20 offen sc1 lds
s_add_u32 m0, s25, 30720
s_add_u32 s20, s26, 896
buffer_load_dwordx4 v8, s[44:47], s20 offen sc1 lds
s_add_u32 m0, s25, 34816
s_add_u32 s20, s26, 1024
buffer_load_dwordx4 v8, s[44:47], s20 offen sc1 lds
s_add_u32 m0, s25, 38912
s_add_u32 s20, s26, 1152
buffer_load_dwordx4 v8, s[44:47], s20 offen sc1 lds
s_add_u32 s26, s26, 1310720
s_add_u32 s25, s25, 40960
v_bfe_u32 v176, v0, 5, 3
v_lshrrev_b32 v9, 9, v0
v_xor_b32 v176, v176, v9
v_lshlrev_b32 v176, 4, v176
v_and_b32 v9, 0x1f0, v0
v_lshl_add_u32 v176, v9, 3, v176
v_xor_b32 v177, 32, v176
v_xor_b32 v178, 64, v176
v_xor_b32 v179, 96, v176
s_lshl_b32 s18, s34, 7
s_lshl_b32 s19, s13, 5
s_add_u32 s18, s18, s19
s_mov_b32 s19, 0x3acccccd
v_bfe_u32 v202, v0, 4, 5
v_lshrrev_b32 v197, 9, v0
v_add_u32 v202, s18, v202
v_and_b32 v201, 1, v202
v_mul_u32_u24 v201, 160, v201
v_lshrrev_b32 v200, 1, v202
v_add_u32 v200, 1, v200
v_lshlrev_b32 v197, 3, v197
v_mad_u32_u24 v201, v197, v200, v201
v_mad_u32_u24 v196, v200, 16, 0
v_cvt_f32_u32 v196, v196
v_mul_f32 v202, s19, v196
v_rndne_f32 v202, v202
v_fmac_f32 v196, 0xc4200000, v202
v_mul_f32 v196, s19, v196
v_cos_f32 v196, v196
s_nop 0
v_add_f32 v196, v196, v196
v_mad_u32_u24 v198, v200, 1, 0
v_cvt_f32_u32 v198, v198
v_mul_f32 v202, s19, v198
v_rndne_f32 v202, v202
v_fmac_f32 v198, 0xc4200000, v202
v_mul_f32 v198, s19, v198
v_cos_f32 v198, v198
s_nop 0
v_add_f32 v198, v198, v198
v_mad_u32_u24 v183, v200, 3, v201
v_cvt_f32_u32 v183, v183
v_mul_f32 v202, s19, v183
v_rndne_f32 v202, v202
v_fmac_f32 v183, 0xc4200000, v202
v_mul_f32 v183, s19, v183
v_cos_f32 v183, v183
v_mad_u32_u24 v184, v200, 4, v201
v_cvt_f32_u32 v184, v184
v_mul_f32 v202, s19, v184
v_rndne_f32 v202, v202
v_fmac_f32 v184, 0xc4200000, v202
v_mul_f32 v184, s19, v184
v_cos_f32 v184, v184
s_nop 0
v_fma_f32 v185, v198, v184, -v183
v_fma_f32 v182, v198, v183, -v184
v_fma_f32 v186, v198, v185, -v184
v_fma_f32 v181, v198, v182, -v183
v_fma_f32 v187, v198, v186, -v185
v_fma_f32 v180, v198, v181, -v182
v_cvt_pk_bf16_f32 v16, v180, v181
v_cvt_pk_bf16_f32 v17, v182, v183
v_cvt_pk_bf16_f32 v18, v184, v185
v_cvt_pk_bf16_f32 v19, v186, v187
v_mad_u32_u24 v191, v200, 19, v201
v_cvt_f32_u32 v191, v191
v_mul_f32 v202, s19, v191
v_rndne_f32 v202, v202
v_fmac_f32 v191, 0xc4200000, v202
v_mul_f32 v191, s19, v191
v_cos_f32 v191, v191
v_mad_u32_u24 v192, v200, 20, v201
v_cvt_f32_u32 v192, v192
v_mul_f32 v202, s19, v192
v_rndne_f32 v202, v202
v_fmac_f32 v192, 0xc4200000, v202
v_mul_f32 v192, s19, v192
v_cos_f32 v192, v192
s_nop 0
v_fma_f32 v193, v198, v192, -v191
v_fma_f32 v190, v198, v191, -v192
v_fma_f32 v194, v198, v193, -v192
v_fma_f32 v189, v198, v190, -v191
v_fma_f32 v195, v198, v194, -v193
v_fma_f32 v188, v198, v189, -v190
v_cvt_pk_bf16_f32 v20, v188, v189
v_cvt_pk_bf16_f32 v21, v190, v191
v_cvt_pk_bf16_f32 v22, v192, v193
v_cvt_pk_bf16_f32 v23, v194, v195
v_pk_fma_f32 v[180:181], v[196:197], v[188:189], v[180:181] op_sel_hi:[0,1,1] neg_lo:[0,0,1] neg_hi:[0,0,1]
v_pk_fma_f32 v[182:183], v[196:197], v[190:191], v[182:183] op_sel_hi:[0,1,1] neg_lo:[0,0,1] neg_hi:[0,0,1]
v_pk_fma_f32 v[184:185], v[196:197], v[192:193], v[184:185] op_sel_hi:[0,1,1] neg_lo:[0,0,1] neg_hi:[0,0,1]
v_pk_fma_f32 v[186:187], v[196:197], v[194:195], v[186:187] op_sel_hi:[0,1,1] neg_lo:[0,0,1] neg_hi:[0,0,1]
v_cvt_pk_bf16_f32 v24, v180, v181
v_cvt_pk_bf16_f32 v25, v182, v183
v_cvt_pk_bf16_f32 v26, v184, v185
v_cvt_pk_bf16_f32 v27, v186, v187
s_add_u32 m0, s25, 2048
s_add_u32 s21, s26, 0
buffer_load_dwordx4 v8, s[44:47], s21 offen lds
v_pk_fma_f32 v[188:189], v[196:197], v[180:181], v[188:189] op_sel_hi:[0,1,1] neg_lo:[0,0,1] neg_hi:[0,0,1]
v_pk_fma_f32 v[190:191], v[196:197], v[182:183], v[190:191] op_sel_hi:[0,1,1] neg_lo:[0,0,1] neg_hi:[0,0,1]
v_pk_fma_f32 v[192:193], v[196:197], v[184:185], v[192:193] op_sel_hi:[0,1,1] neg_lo:[0,0,1] neg_hi:[0,0,1]
v_pk_fma_f32 v[194:195], v[196:197], v[186:187], v[194:195] op_sel_hi:[0,1,1] neg_lo:[0,0,1] neg_hi:[0,0,1]
v_cvt_pk_bf16_f32 v28, v188, v189
v_cvt_pk_bf16_f32 v29, v190, v191
v_cvt_pk_bf16_f32 v30, v192, v193
v_cvt_pk_bf16_f32 v31, v194, v195
s_add_u32 m0, s25, 6144
s_add_u32 s21, s26, 128
buffer_load_dwordx4 v8, s[44:47], s21 offen lds
v_pk_fma_f32 v[180:181], v[196:197], v[188:189], v[180:181] op_sel_hi:[0,1,1] neg_lo:[0,0,1] neg_hi:[0,0,1]
v_pk_fma_f32 v[182:183], v[196:197], v[190:191], v[182:183] op_sel_hi:[0,1,1] neg_lo:[0,0,1] neg_hi:[0,0,1]
v_pk_fma_f32 v[184:185], v[196:197], v[192:193], v[184:185] op_sel_hi:[0,1,1] neg_lo:[0,0,1] neg_hi:[0,0,1]
v_pk_fma_f32 v[186:187], v[196:197], v[194:195], v[186:187] op_sel_hi:[0,1,1] neg_lo:[0,0,1] neg_hi:[0,0,1]
v_cvt_pk_bf16_f32 v32, v180, v181
v_cvt_pk_bf16_f32 v33, v182, v183
v_cvt_pk_bf16_f32 v34, v184, v185
v_cvt_pk_bf16_f32 v35, v186, v187
s_add_u32 m0, s25, 10240
s_add_u32 s21, s26, 256
buffer_load_dwordx4 v8, s[44:47], s21 offen lds
v_pk_fma_f32 v[188:189], v[196:197], v[180:181], v[188:189] op_sel_hi:[0,1,1] neg_lo:[0,0,1] neg_hi:[0,0,1]
v_pk_fma_f32 v[190:191], v[196:197], v[182:183], v[190:191] op_sel_hi:[0,1,1] neg_lo:[0,0,1] neg_hi:[0,0,1]
v_pk_fma_f32 v[192:193], v[196:197], v[184:185], v[192:193] op_sel_hi:[0,1,1] neg_lo:[0,0,1] neg_hi:[0,0,1]
v_pk_fma_f32 v[194:195], v[196:197], v[186:187], v[194:195] op_sel_hi:[0,1,1] neg_lo:[0,0,1] neg_hi:[0,0,1]
v_cvt_pk_bf16_f32 v36, v188, v189
v_cvt_pk_bf16_f32 v37, v190, v191
v_cvt_pk_bf16_f32 v38, v192, v193
v_cvt_pk_bf16_f32 v39, v194, v195
s_add_u32 m0, s25, 14336
s_add_u32 s21, s26, 384
buffer_load_dwordx4 v8, s[44:47], s21 offen lds
v_pk_fma_f32 v[180:181], v[196:197], v[188:189], v[180:181] op_sel_hi:[0,1,1] neg_lo:[0,0,1] neg_hi:[0,0,1]
v_pk_fma_f32 v[182:183], v[196:197], v[190:191], v[182:183] op_sel_hi:[0,1,1] neg_lo:[0,0,1] neg_hi:[0,0,1]
v_pk_fma_f32 v[184:185], v[196:197], v[192:193], v[184:185] op_sel_hi:[0,1,1] neg_lo:[0,0,1] neg_hi:[0,0,1]
v_pk_fma_f32 v[186:187], v[196:197], v[194:195], v[186:187] op_sel_hi:[0,1,1] neg_lo:[0,0,1] neg_hi:[0,0,1]
v_cvt_pk_bf16_f32 v40, v180, v181
v_cvt_pk_bf16_f32 v41, v182, v183
v_cvt_pk_bf16_f32 v42, v184, v185
v_cvt_pk_bf16_f32 v43, v186, v187
s_add_u32 m0, s25, 18432
s_add_u32 s21, s26, 512
buffer_load_dwordx4 v8, s[44:47], s21 offen lds
v_pk_fma_f32 v[188:189], v[196:197], v[180:181], v[188:189] op_sel_hi:[0,1,1] neg_lo:[0,0,1] neg_hi:[0,0,1]
v_pk_fma_f32 v[190:191], v[196:197], v[182:183], v[190:191] op_sel_hi:[0,1,1] neg_lo:[0,0,1] neg_hi:[0,0,1]
v_pk_fma_f32 v[192:193], v[196:197], v[184:185], v[192:193] op_sel_hi:[0,1,1] neg_lo:[0,0,1] neg_hi:[0,0,1]
v_pk_fma_f32 v[194:195], v[196:197], v[186:187], v[194:195] op_sel_hi:[0,1,1] neg_lo:[0,0,1] neg_hi:[0,0,1]
v_cvt_pk_bf16_f32 v44, v188, v189
v_cvt_pk_bf16_f32 v45, v190, v191
v_cvt_pk_bf16_f32 v46, v192, v193
v_cvt_pk_bf16_f32 v47, v194, v195
s_add_u32 m0, s25, 22528
s_add_u32 s21, s26, 640
buffer_load_dwordx4 v8, s[44:47], s21 offen lds
v_pk_fma_f32 v[180:181], v[196:197], v[188:189], v[180:181] op_sel_hi:[0,1,1] neg_lo:[0,0,1] neg_hi:[0,0,1]
v_pk_fma_f32 v[182:183], v[196:197], v[190:191], v[182:183] op_sel_hi:[0,1,1] neg_lo:[0,0,1] neg_hi:[0,0,1]
v_pk_fma_f32 v[184:185], v[196:197], v[192:193], v[184:185] op_sel_hi:[0,1,1] neg_lo:[0,0,1] neg_hi:[0,0,1]
v_pk_fma_f32 v[186:187], v[196:197], v[194:195], v[186:187] op_sel_hi:[0,1,1] neg_lo:[0,0,1] neg_hi:[0,0,1]
v_cvt_pk_bf16_f32 v48, v180, v181
v_cvt_pk_bf16_f32 v49, v182, v183
v_cvt_pk_bf16_f32 v50, v184, v185
v_cvt_pk_bf16_f32 v51, v186, v187
s_add_u32 m0, s25, 26624
s_add_u32 s21, s26, 768
buffer_load_dwordx4 v8, s[44:47], s21 offen lds
v_pk_fma_f32 v[188:189], v[196:197], v[180:181], v[188:189] op_sel_hi:[0,1,1] neg_lo:[0,0,1] neg_hi:[0,0,1]
v_pk_fma_f32 v[190:191], v[196:197], v[182:183], v[190:191] op_sel_hi:[0,1,1] neg_lo:[0,0,1] neg_hi:[0,0,1]
v_pk_fma_f32 v[192:193], v[196:197], v[184:185], v[192:193] op_sel_hi:[0,1,1] neg_lo:[0,0,1] neg_hi:[0,0,1]
v_pk_fma_f32 v[194:195], v[196:197], v[186:187], v[194:195] op_sel_hi:[0,1,1] neg_lo:[0,0,1] neg_hi:[0,0,1]
v_cvt_pk_bf16_f32 v52, v188, v189
v_cvt_pk_bf16_f32 v53, v190, v191
v_cvt_pk_bf16_f32 v54, v192, v193
v_cvt_pk_bf16_f32 v55, v194, v195
s_add_u32 m0, s25, 30720
s_add_u32 s21, s26, 896
buffer_load_dwordx4 v8, s[44:47], s21 offen lds
v_pk_fma_f32 v[180:181], v[196:197], v[188:189], v[180:181] op_sel_hi:[0,1,1] neg_lo:[0,0,1] neg_hi:[0,0,1]
v_pk_fma_f32 v[182:183], v[196:197], v[190:191], v[182:183] op_sel_hi:[0,1,1] neg_lo:[0,0,1] neg_hi:[0,0,1]
v_pk_fma_f32 v[184:185], v[196:197], v[192:193], v[184:185] op_sel_hi:[0,1,1] neg_lo:[0,0,1] neg_hi:[0,0,1]
v_pk_fma_f32 v[186:187], v[196:197], v[194:195], v[186:187] op_sel_hi:[0,1,1] neg_lo:[0,0,1] neg_hi:[0,0,1]
v_cvt_pk_bf16_f32 v56, v180, v181
v_cvt_pk_bf16_f32 v57, v182, v183
v_cvt_pk_bf16_f32 v58, v184, v185
v_cvt_pk_bf16_f32 v59, v186, v187
s_add_u32 m0, s25, 34816
s_add_u32 s21, s26, 1024
buffer_load_dwordx4 v8, s[44:47], s21 offen lds
v_pk_fma_f32 v[188:189], v[196:197], v[180:181], v[188:189] op_sel_hi:[0,1,1] neg_lo:[0,0,1] neg_hi:[0,0,1]
v_pk_fma_f32 v[190:191], v[196:197], v[182:183], v[190:191] op_sel_hi:[0,1,1] neg_lo:[0,0,1] neg_hi:[0,0,1]
v_pk_fma_f32 v[192:193], v[196:197], v[184:185], v[192:193] op_sel_hi:[0,1,1] neg_lo:[0,0,1] neg_hi:[0,0,1]
v_pk_fma_f32 v[194:195], v[196:197], v[186:187], v[194:195] op_sel_hi:[0,1,1] neg_lo:[0,0,1] neg_hi:[0,0,1]
v_cvt_pk_bf16_f32 v60, v188, v189
v_cvt_pk_bf16_f32 v61, v190, v191
v_cvt_pk_bf16_f32 v62, v192, v193
v_cvt_pk_bf16_f32 v63, v194, v195
s_add_u32 m0, s25, 38912
s_add_u32 s21, s26, 1152
buffer_load_dwordx4 v8, s[44:47], s21 offen lds
v_pk_fma_f32 v[180:181], v[196:197], v[188:189], v[180:181] op_sel_hi:[0,1,1] neg_lo:[0,0,1] neg_hi:[0,0,1]
v_pk_fma_f32 v[182:183], v[196:197], v[190:191], v[182:183] op_sel_hi:[0,1,1] neg_lo:[0,0,1] neg_hi:[0,0,1]
v_pk_fma_f32 v[184:185], v[196:197], v[192:193], v[184:185] op_sel_hi:[0,1,1] neg_lo:[0,0,1] neg_hi:[0,0,1]
v_pk_fma_f32 v[186:187], v[196:197], v[194:195], v[186:187] op_sel_hi:[0,1,1] neg_lo:[0,0,1] neg_hi:[0,0,1]
v_cvt_pk_bf16_f32 v64, v180, v181
v_cvt_pk_bf16_f32 v65, v182, v183
v_cvt_pk_bf16_f32 v66, v184, v185
v_cvt_pk_bf16_f32 v67, v186, v187
v_pk_fma_f32 v[188:189], v[196:197], v[180:181], v[188:189] op_sel_hi:[0,1,1] neg_lo:[0,0,1] neg_hi:[0,0,1]
v_pk_fma_f32 v[190:191], v[196:197], v[182:183], v[190:191] op_sel_hi:[0,1,1] neg_lo:[0,0,1] neg_hi:[0,0,1]
v_pk_fma_f32 v[192:193], v[196:197], v[184:185], v[192:193] op_sel_hi:[0,1,1] neg_lo:[0,0,1] neg_hi:[0,0,1]
v_pk_fma_f32 v[194:195], v[196:197], v[186:187], v[194:195] op_sel_hi:[0,1,1] neg_lo:[0,0,1] neg_hi:[0,0,1]
v_cvt_pk_bf16_f32 v68, v188, v189
v_cvt_pk_bf16_f32 v69, v190, v191
v_cvt_pk_bf16_f32 v70, v192, v193
v_cvt_pk_bf16_f32 v71, v194, v195
v_pk_fma_f32 v[180:181], v[196:197], v[188:189], v[180:181] op_sel_hi:[0,1,1] neg_lo:[0,0,1] neg_hi:[0,0,1]
v_pk_fma_f32 v[182:183], v[196:197], v[190:191], v[182:183] op_sel_hi:[0,1,1] neg_lo:[0,0,1] neg_hi:[0,0,1]
v_pk_fma_f32 v[184:185], v[196:197], v[192:193], v[184:185] op_sel_hi:[0,1,1] neg_lo:[0,0,1] neg_hi:[0,0,1]
v_pk_fma_f32 v[186:187], v[196:197], v[194:195], v[186:187] op_sel_hi:[0,1,1] neg_lo:[0,0,1] neg_hi:[0,0,1]
v_cvt_pk_bf16_f32 v72, v180, v181
v_cvt_pk_bf16_f32 v73, v182, v183
v_cvt_pk_bf16_f32 v74, v184, v185
v_cvt_pk_bf16_f32 v75, v186, v187
v_pk_fma_f32 v[188:189], v[196:197], v[180:181], v[188:189] op_sel_hi:[0,1,1] neg_lo:[0,0,1] neg_hi:[0,0,1]
v_pk_fma_f32 v[190:191], v[196:197], v[182:183], v[190:191] op_sel_hi:[0,1,1] neg_lo:[0,0,1] neg_hi:[0,0,1]
v_pk_fma_f32 v[192:193], v[196:197], v[184:185], v[192:193] op_sel_hi:[0,1,1] neg_lo:[0,0,1] neg_hi:[0,0,1]
v_pk_fma_f32 v[194:195], v[196:197], v[186:187], v[194:195] op_sel_hi:[0,1,1] neg_lo:[0,0,1] neg_hi:[0,0,1]
v_cvt_pk_bf16_f32 v76, v188, v189
v_cvt_pk_bf16_f32 v77, v190, v191
v_cvt_pk_bf16_f32 v78, v192, v193
v_cvt_pk_bf16_f32 v79, v194, v195
v_pk_fma_f32 v[180:181], v[196:197], v[188:189], v[180:181] op_sel_hi:[0,1,1] neg_lo:[0,0,1] neg_hi:[0,0,1]
v_pk_fma_f32 v[182:183], v[196:197], v[190:191], v[182:183] op_sel_hi:[0,1,1] neg_lo:[0,0,1] neg_hi:[0,0,1]
v_pk_fma_f32 v[184:185], v[196:197], v[192:193], v[184:185] op_sel_hi:[0,1,1] neg_lo:[0,0,1] neg_hi:[0,0,1]
v_pk_fma_f32 v[186:187], v[196:197], v[194:195], v[186:187] op_sel_hi:[0,1,1] neg_lo:[0,0,1] neg_hi:[0,0,1]
v_cvt_pk_bf16_f32 v80, v180, v181
v_cvt_pk_bf16_f32 v81, v182, v183
v_cvt_pk_bf16_f32 v82, v184, v185
v_cvt_pk_bf16_f32 v83, v186, v187
v_pk_fma_f32 v[188:189], v[196:197], v[180:181], v[188:189] op_sel_hi:[0,1,1] neg_lo:[0,0,1] neg_hi:[0,0,1]
v_pk_fma_f32 v[190:191], v[196:197], v[182:183], v[190:191] op_sel_hi:[0,1,1] neg_lo:[0,0,1] neg_hi:[0,0,1]
v_pk_fma_f32 v[192:193], v[196:197], v[184:185], v[192:193] op_sel_hi:[0,1,1] neg_lo:[0,0,1] neg_hi:[0,0,1]
v_pk_fma_f32 v[194:195], v[196:197], v[186:187], v[194:195] op_sel_hi:[0,1,1] neg_lo:[0,0,1] neg_hi:[0,0,1]
v_cvt_pk_bf16_f32 v84, v188, v189
v_cvt_pk_bf16_f32 v85, v190, v191
v_cvt_pk_bf16_f32 v86, v192, v193
v_cvt_pk_bf16_f32 v87, v194, v195
v_pk_fma_f32 v[180:181], v[196:197], v[188:189], v[180:181] op_sel_hi:[0,1,1] neg_lo:[0,0,1] neg_hi:[0,0,1]
v_pk_fma_f32 v[182:183], v[196:197], v[190:191], v[182:183] op_sel_hi:[0,1,1] neg_lo:[0,0,1] neg_hi:[0,0,1]
v_pk_fma_f32 v[184:185], v[196:197], v[192:193], v[184:185] op_sel_hi:[0,1,1] neg_lo:[0,0,1] neg_hi:[0,0,1]
v_pk_fma_f32 v[186:187], v[196:197], v[194:195], v[186:187] op_sel_hi:[0,1,1] neg_lo:[0,0,1] neg_hi:[0,0,1]
v_cvt_pk_bf16_f32 v88, v180, v181
v_cvt_pk_bf16_f32 v89, v182, v183
v_cvt_pk_bf16_f32 v90, v184, v185
v_cvt_pk_bf16_f32 v91, v186, v187
v_pk_fma_f32 v[188:189], v[196:197], v[180:181], v[188:189] op_sel_hi:[0,1,1] neg_lo:[0,0,1] neg_hi:[0,0,1]
v_pk_fma_f32 v[190:191], v[196:197], v[182:183], v[190:191] op_sel_hi:[0,1,1] neg_lo:[0,0,1] neg_hi:[0,0,1]
v_pk_fma_f32 v[192:193], v[196:197], v[184:185], v[192:193] op_sel_hi:[0,1,1] neg_lo:[0,0,1] neg_hi:[0,0,1]
v_pk_fma_f32 v[194:195], v[196:197], v[186:187], v[194:195] op_sel_hi:[0,1,1] neg_lo:[0,0,1] neg_hi:[0,0,1]
v_cvt_pk_bf16_f32 v92, v188, v189
v_cvt_pk_bf16_f32 v93, v190, v191
v_cvt_pk_bf16_f32 v94, v192, v193
v_cvt_pk_bf16_f32 v95, v194, v195
s_mov_b32 s20, 323
v_mad_u32_u24 v183, v200, s20, v201
v_cvt_f32_u32 v183, v183
v_mul_f32 v202, s19, v183
v_rndne_f32 v202, v202
v_fmac_f32 v183, 0xc4200000, v202
v_mul_f32 v183, s19, v183
v_cos_f32 v183, v183
s_mov_b32 s20, 324
v_mad_u32_u24 v184, v200, s20, v201
v_cvt_f32_u32 v184, v184
v_mul_f32 v202, s19, v184
v_rndne_f32 v202, v202
v_fmac_f32 v184, 0xc4200000, v202
v_mul_f32 v184, s19, v184
v_cos_f32 v184, v184
s_nop 0
v_fma_f32 v185, v198, v184, -v183
v_fma_f32 v182, v198, v183, -v184
v_fma_f32 v186, v198, v185, -v184
v_fma_f32 v181, v198, v182, -v183
v_fma_f32 v187, v198, v186, -v185
v_fma_f32 v180, v198, v181, -v182
v_cvt_pk_bf16_f32 v96, v180, v181
v_cvt_pk_bf16_f32 v97, v182, v183
v_cvt_pk_bf16_f32 v98, v184, v185
v_cvt_pk_bf16_f32 v99, v186, v187
s_mov_b32 s20, 339
v_mad_u32_u24 v191, v200, s20, v201
v_cvt_f32_u32 v191, v191
v_mul_f32 v202, s19, v191
v_rndne_f32 v202, v202
v_fmac_f32 v191, 0xc4200000, v202
v_mul_f32 v191, s19, v191
v_cos_f32 v191, v191
s_mov_b32 s20, 340
v_mad_u32_u24 v192, v200, s20, v201
v_cvt_f32_u32 v192, v192
v_mul_f32 v202, s19, v192
v_rndne_f32 v202, v202
v_fmac_f32 v192, 0xc4200000, v202
v_mul_f32 v192, s19, v192
v_cos_f32 v192, v192
s_nop 0
v_fma_f32 v193, v198, v192, -v191
v_fma_f32 v190, v198, v191, -v192
v_fma_f32 v194, v198, v193, -v192
v_fma_f32 v189, v198, v190, -v191
v_fma_f32 v195, v198, v194, -v193
v_fma_f32 v188, v198, v189, -v190
v_cvt_pk_bf16_f32 v100, v188, v189
v_cvt_pk_bf16_f32 v101, v190, v191
v_cvt_pk_bf16_f32 v102, v192, v193
v_cvt_pk_bf16_f32 v103, v194, v195
v_pk_fma_f32 v[180:181], v[196:197], v[188:189], v[180:181] op_sel_hi:[0,1,1] neg_lo:[0,0,1] neg_hi:[0,0,1]
v_pk_fma_f32 v[182:183], v[196:197], v[190:191], v[182:183] op_sel_hi:[0,1,1] neg_lo:[0,0,1] neg_hi:[0,0,1]
v_pk_fma_f32 v[184:185], v[196:197], v[192:193], v[184:185] op_sel_hi:[0,1,1] neg_lo:[0,0,1] neg_hi:[0,0,1]
v_pk_fma_f32 v[186:187], v[196:197], v[194:195], v[186:187] op_sel_hi:[0,1,1] neg_lo:[0,0,1] neg_hi:[0,0,1]
v_cvt_pk_bf16_f32 v104, v180, v181
v_cvt_pk_bf16_f32 v105, v182, v183
v_cvt_pk_bf16_f32 v106, v184, v185
v_cvt_pk_bf16_f32 v107, v186, v187
v_pk_fma_f32 v[188:189], v[196:197], v[180:181], v[188:189] op_sel_hi:[0,1,1] neg_lo:[0,0,1] neg_hi:[0,0,1]
v_pk_fma_f32 v[190:191], v[196:197], v[182:183], v[190:191] op_sel_hi:[0,1,1] neg_lo:[0,0,1] neg_hi:[0,0,1]
v_pk_fma_f32 v[192:193], v[196:197], v[184:185], v[192:193] op_sel_hi:[0,1,1] neg_lo:[0,0,1] neg_hi:[0,0,1]
v_pk_fma_f32 v[194:195], v[196:197], v[186:187], v[194:195] op_sel_hi:[0,1,1] neg_lo:[0,0,1] neg_hi:[0,0,1]
v_cvt_pk_bf16_f32 v108, v188, v189
v_cvt_pk_bf16_f32 v109, v190, v191
v_cvt_pk_bf16_f32 v110, v192, v193
v_cvt_pk_bf16_f32 v111, v194, v195
v_pk_fma_f32 v[180:181], v[196:197], v[188:189], v[180:181] op_sel_hi:[0,1,1] neg_lo:[0,0,1] neg_hi:[0,0,1]
v_pk_fma_f32 v[182:183], v[196:197], v[190:191], v[182:183] op_sel_hi:[0,1,1] neg_lo:[0,0,1] neg_hi:[0,0,1]
v_pk_fma_f32 v[184:185], v[196:197], v[192:193], v[184:185] op_sel_hi:[0,1,1] neg_lo:[0,0,1] neg_hi:[0,0,1]
v_pk_fma_f32 v[186:187], v[196:197], v[194:195], v[186:187] op_sel_hi:[0,1,1] neg_lo:[0,0,1] neg_hi:[0,0,1]
v_cvt_pk_bf16_f32 v112, v180, v181
v_cvt_pk_bf16_f32 v113, v182, v183
v_cvt_pk_bf16_f32 v114, v184, v185
v_cvt_pk_bf16_f32 v115, v186, v187
v_pk_fma_f32 v[188:189], v[196:197], v[180:181], v[188:189] op_sel_hi:[0,1,1] neg_lo:[0,0,1] neg_hi:[0,0,1]
v_pk_fma_f32 v[190:191], v[196:197], v[182:183], v[190:191] op_sel_hi:[0,1,1] neg_lo:[0,0,1] neg_hi:[0,0,1]
v_pk_fma_f32 v[192:193], v[196:197], v[184:185], v[192:193] op_sel_hi:[0,1,1] neg_lo:[0,0,1] neg_hi:[0,0,1]
v_pk_fma_f32 v[194:195], v[196:197], v[186:187], v[194:195] op_sel_hi:[0,1,1] neg_lo:[0,0,1] neg_hi:[0,0,1]
v_cvt_pk_bf16_f32 v116, v188, v189
v_cvt_pk_bf16_f32 v117, v190, v191
v_cvt_pk_bf16_f32 v118, v192, v193
v_cvt_pk_bf16_f32 v119, v194, v195
v_pk_fma_f32 v[180:181], v[196:197], v[188:189], v[180:181] op_sel_hi:[0,1,1] neg_lo:[0,0,1] neg_hi:[0,0,1]
v_pk_fma_f32 v[182:183], v[196:197], v[190:191], v[182:183] op_sel_hi:[0,1,1] neg_lo:[0,0,1] neg_hi:[0,0,1]
v_pk_fma_f32 v[184:185], v[196:197], v[192:193], v[184:185] op_sel_hi:[0,1,1] neg_lo:[0,0,1] neg_hi:[0,0,1]
v_pk_fma_f32 v[186:187], v[196:197], v[194:195], v[186:187] op_sel_hi:[0,1,1] neg_lo:[0,0,1] neg_hi:[0,0,1]
v_cvt_pk_bf16_f32 v120, v180, v181
v_cvt_pk_bf16_f32 v121, v182, v183
v_cvt_pk_bf16_f32 v122, v184, v185
v_cvt_pk_bf16_f32 v123, v186, v187
v_pk_fma_f32 v[188:189], v[196:197], v[180:181], v[188:189] op_sel_hi:[0,1,1] neg_lo:[0,0,1] neg_hi:[0,0,1]
v_pk_fma_f32 v[190:191], v[196:197], v[182:183], v[190:191] op_sel_hi:[0,1,1] neg_lo:[0,0,1] neg_hi:[0,0,1]
v_pk_fma_f32 v[192:193], v[196:197], v[184:185], v[192:193] op_sel_hi:[0,1,1] neg_lo:[0,0,1] neg_hi:[0,0,1]
v_pk_fma_f32 v[194:195], v[196:197], v[186:187], v[194:195] op_sel_hi:[0,1,1] neg_lo:[0,0,1] neg_hi:[0,0,1]
v_cvt_pk_bf16_f32 v124, v188, v189
v_cvt_pk_bf16_f32 v125, v190, v191
v_cvt_pk_bf16_f32 v126, v192, v193
v_cvt_pk_bf16_f32 v127, v194, v195
v_pk_fma_f32 v[180:181], v[196:197], v[188:189], v[180:181] op_sel_hi:[0,1,1] neg_lo:[0,0,1] neg_hi:[0,0,1]
v_pk_fma_f32 v[182:183], v[196:197], v[190:191], v[182:183] op_sel_hi:[0,1,1] neg_lo:[0,0,1] neg_hi:[0,0,1]
v_pk_fma_f32 v[184:185], v[196:197], v[192:193], v[184:185] op_sel_hi:[0,1,1] neg_lo:[0,0,1] neg_hi:[0,0,1]
v_pk_fma_f32 v[186:187], v[196:197], v[194:195], v[186:187] op_sel_hi:[0,1,1] neg_lo:[0,0,1] neg_hi:[0,0,1]
v_cvt_pk_bf16_f32 v128, v180, v181
v_cvt_pk_bf16_f32 v129, v182, v183
v_cvt_pk_bf16_f32 v130, v184, v185
v_cvt_pk_bf16_f32 v131, v186, v187
v_pk_fma_f32 v[188:189], v[196:197], v[180:181], v[188:189] op_sel_hi:[0,1,1] neg_lo:[0,0,1] neg_hi:[0,0,1]
v_pk_fma_f32 v[190:191], v[196:197], v[182:183], v[190:191] op_sel_hi:[0,1,1] neg_lo:[0,0,1] neg_hi:[0,0,1]
v_pk_fma_f32 v[192:193], v[196:197], v[184:185], v[192:193] op_sel_hi:[0,1,1] neg_lo:[0,0,1] neg_hi:[0,0,1]
v_pk_fma_f32 v[194:195], v[196:197], v[186:187], v[194:195] op_sel_hi:[0,1,1] neg_lo:[0,0,1] neg_hi:[0,0,1]
v_cvt_pk_bf16_f32 v132, v188, v189
v_cvt_pk_bf16_f32 v133, v190, v191
v_cvt_pk_bf16_f32 v134, v192, v193
v_cvt_pk_bf16_f32 v135, v194, v195
v_pk_fma_f32 v[180:181], v[196:197], v[188:189], v[180:181] op_sel_hi:[0,1,1] neg_lo:[0,0,1] neg_hi:[0,0,1]
v_pk_fma_f32 v[182:183], v[196:197], v[190:191], v[182:183] op_sel_hi:[0,1,1] neg_lo:[0,0,1] neg_hi:[0,0,1]
v_pk_fma_f32 v[184:185], v[196:197], v[192:193], v[184:185] op_sel_hi:[0,1,1] neg_lo:[0,0,1] neg_hi:[0,0,1]
v_pk_fma_f32 v[186:187], v[196:197], v[194:195], v[186:187] op_sel_hi:[0,1,1] neg_lo:[0,0,1] neg_hi:[0,0,1]
v_cvt_pk_bf16_f32 v136, v180, v181
v_cvt_pk_bf16_f32 v137, v182, v183
v_cvt_pk_bf16_f32 v138, v184, v185
v_cvt_pk_bf16_f32 v139, v186, v187
v_pk_fma_f32 v[188:189], v[196:197], v[180:181], v[188:189] op_sel_hi:[0,1,1] neg_lo:[0,0,1] neg_hi:[0,0,1]
v_pk_fma_f32 v[190:191], v[196:197], v[182:183], v[190:191] op_sel_hi:[0,1,1] neg_lo:[0,0,1] neg_hi:[0,0,1]
v_pk_fma_f32 v[192:193], v[196:197], v[184:185], v[192:193] op_sel_hi:[0,1,1] neg_lo:[0,0,1] neg_hi:[0,0,1]
v_pk_fma_f32 v[194:195], v[196:197], v[186:187], v[194:195] op_sel_hi:[0,1,1] neg_lo:[0,0,1] neg_hi:[0,0,1]
v_cvt_pk_bf16_f32 v140, v188, v189
v_cvt_pk_bf16_f32 v141, v190, v191
v_cvt_pk_bf16_f32 v142, v192, v193
v_cvt_pk_bf16_f32 v143, v194, v195
v_pk_fma_f32 v[180:181], v[196:197], v[188:189], v[180:181] op_sel_hi:[0,1,1] neg_lo:[0,0,1] neg_hi:[0,0,1]
v_pk_fma_f32 v[182:183], v[196:197], v[190:191], v[182:183] op_sel_hi:[0,1,1] neg_lo:[0,0,1] neg_hi:[0,0,1]
v_pk_fma_f32 v[184:185], v[196:197], v[192:193], v[184:185] op_sel_hi:[0,1,1] neg_lo:[0,0,1] neg_hi:[0,0,1]
v_pk_fma_f32 v[186:187], v[196:197], v[194:195], v[186:187] op_sel_hi:[0,1,1] neg_lo:[0,0,1] neg_hi:[0,0,1]
v_cvt_pk_bf16_f32 v144, v180, v181
v_cvt_pk_bf16_f32 v145, v182, v183
v_cvt_pk_bf16_f32 v146, v184, v185
v_cvt_pk_bf16_f32 v147, v186, v187
v_pk_fma_f32 v[188:189], v[196:197], v[180:181], v[188:189] op_sel_hi:[0,1,1] neg_lo:[0,0,1] neg_hi:[0,0,1]
v_pk_fma_f32 v[190:191], v[196:197], v[182:183], v[190:191] op_sel_hi:[0,1,1] neg_lo:[0,0,1] neg_hi:[0,0,1]
v_pk_fma_f32 v[192:193], v[196:197], v[184:185], v[192:193] op_sel_hi:[0,1,1] neg_lo:[0,0,1] neg_hi:[0,0,1]
v_pk_fma_f32 v[194:195], v[196:197], v[186:187], v[194:195] op_sel_hi:[0,1,1] neg_lo:[0,0,1] neg_hi:[0,0,1]
v_cvt_pk_bf16_f32 v148, v188, v189
v_cvt_pk_bf16_f32 v149, v190, v191
v_cvt_pk_bf16_f32 v150, v192, v193
v_cvt_pk_bf16_f32 v151, v194, v195
v_pk_fma_f32 v[180:181], v[196:197], v[188:189], v[180:181] op_sel_hi:[0,1,1] neg_lo:[0,0,1] neg_hi:[0,0,1]
v_pk_fma_f32 v[182:183], v[196:197], v[190:191], v[182:183] op_sel_hi:[0,1,1] neg_lo:[0,0,1] neg_hi:[0,0,1]
v_pk_fma_f32 v[184:185], v[196:197], v[192:193], v[184:185] op_sel_hi:[0,1,1] neg_lo:[0,0,1] neg_hi:[0,0,1]
v_pk_fma_f32 v[186:187], v[196:197], v[194:195], v[186:187] op_sel_hi:[0,1,1] neg_lo:[0,0,1] neg_hi:[0,0,1]
v_cvt_pk_bf16_f32 v152, v180, v181
v_cvt_pk_bf16_f32 v153, v182, v183
v_cvt_pk_bf16_f32 v154, v184, v185
v_cvt_pk_bf16_f32 v155, v186, v187
v_pk_fma_f32 v[188:189], v[196:197], v[180:181], v[188:189] op_sel_hi:[0,1,1] neg_lo:[0,0,1] neg_hi:[0,0,1]
v_pk_fma_f32 v[190:191], v[196:197], v[182:183], v[190:191] op_sel_hi:[0,1,1] neg_lo:[0,0,1] neg_hi:[0,0,1]
v_pk_fma_f32 v[192:193], v[196:197], v[184:185], v[192:193] op_sel_hi:[0,1,1] neg_lo:[0,0,1] neg_hi:[0,0,1]
v_pk_fma_f32 v[194:195], v[196:197], v[186:187], v[194:195] op_sel_hi:[0,1,1] neg_lo:[0,0,1] neg_hi:[0,0,1]
v_cvt_pk_bf16_f32 v156, v188, v189
v_cvt_pk_bf16_f32 v157, v190, v191
v_cvt_pk_bf16_f32 v158, v192, v193
v_cvt_pk_bf16_f32 v159, v194, v195
v_pk_fma_f32 v[180:181], v[196:197], v[188:189], v[180:181] op_sel_hi:[0,1,1] neg_lo:[0,0,1] neg_hi:[0,0,1]
v_pk_fma_f32 v[182:183], v[196:197], v[190:191], v[182:183] op_sel_hi:[0,1,1] neg_lo:[0,0,1] neg_hi:[0,0,1]
v_pk_fma_f32 v[184:185], v[196:197], v[192:193], v[184:185] op_sel_hi:[0,1,1] neg_lo:[0,0,1] neg_hi:[0,0,1]
v_pk_fma_f32 v[186:187], v[196:197], v[194:195], v[186:187] op_sel_hi:[0,1,1] neg_lo:[0,0,1] neg_hi:[0,0,1]
v_cvt_pk_bf16_f32 v160, v180, v181
v_cvt_pk_bf16_f32 v161, v182, v183
v_cvt_pk_bf16_f32 v162, v184, v185
v_cvt_pk_bf16_f32 v163, v186, v187
v_pk_fma_f32 v[188:189], v[196:197], v[180:181], v[188:189] op_sel_hi:[0,1,1] neg_lo:[0,0,1] neg_hi:[0,0,1]
v_pk_fma_f32 v[190:191], v[196:197], v[182:183], v[190:191] op_sel_hi:[0,1,1] neg_lo:[0,0,1] neg_hi:[0,0,1]
v_pk_fma_f32 v[192:193], v[196:197], v[184:185], v[192:193] op_sel_hi:[0,1,1] neg_lo:[0,0,1] neg_hi:[0,0,1]
v_pk_fma_f32 v[194:195], v[196:197], v[186:187], v[194:195] op_sel_hi:[0,1,1] neg_lo:[0,0,1] neg_hi:[0,0,1]
v_cvt_pk_bf16_f32 v164, v188, v189
v_cvt_pk_bf16_f32 v165, v190, v191
v_cvt_pk_bf16_f32 v166, v192, v193
v_cvt_pk_bf16_f32 v167, v194, v195
v_pk_fma_f32 v[180:181], v[196:197], v[188:189], v[180:181] op_sel_hi:[0,1,1] neg_lo:[0,0,1] neg_hi:[0,0,1]
v_pk_fma_f32 v[182:183], v[196:197], v[190:191], v[182:183] op_sel_hi:[0,1,1] neg_lo:[0,0,1] neg_hi:[0,0,1]
v_pk_fma_f32 v[184:185], v[196:197], v[192:193], v[184:185] op_sel_hi:[0,1,1] neg_lo:[0,0,1] neg_hi:[0,0,1]
v_pk_fma_f32 v[186:187], v[196:197], v[194:195], v[186:187] op_sel_hi:[0,1,1] neg_lo:[0,0,1] neg_hi:[0,0,1]
v_cvt_pk_bf16_f32 v168, v180, v181
v_cvt_pk_bf16_f32 v169, v182, v183
v_cvt_pk_bf16_f32 v170, v184, v185
v_cvt_pk_bf16_f32 v171, v186, v187
v_pk_fma_f32 v[188:189], v[196:197], v[180:181], v[188:189] op_sel_hi:[0,1,1] neg_lo:[0,0,1] neg_hi:[0,0,1]
v_pk_fma_f32 v[190:191], v[196:197], v[182:183], v[190:191] op_sel_hi:[0,1,1] neg_lo:[0,0,1] neg_hi:[0,0,1]
v_pk_fma_f32 v[192:193], v[196:197], v[184:185], v[192:193] op_sel_hi:[0,1,1] neg_lo:[0,0,1] neg_hi:[0,0,1]
v_pk_fma_f32 v[194:195], v[196:197], v[186:187], v[194:195] op_sel_hi:[0,1,1] neg_lo:[0,0,1] neg_hi:[0,0,1]
v_cvt_pk_bf16_f32 v172, v188, v189
v_cvt_pk_bf16_f32 v173, v190, v191
v_cvt_pk_bf16_f32 v174, v192, v193
v_cvt_pk_bf16_f32 v175, v194, v195
v_mov_b32 v180, s24
v_mov_b32 v181, s24
v_mov_b32 v182, s24
v_mov_b32 v183, s24
s_nop 1
v_mfma_f32_32x32x16_bf16 v[184:199], v[180:183], v[16:19], 0
v_mfma_f32_32x32x16_bf16 v[184:199], v[180:183], v[20:23], v[184:199]
v_mfma_f32_32x32x16_bf16 v[184:199], v[180:183], v[24:27], v[184:199]
v_mfma_f32_32x32x16_bf16 v[184:199], v[180:183], v[28:31], v[184:199]
v_mfma_f32_32x32x16_bf16 v[184:199], v[180:183], v[32:35], v[184:199]
v_mfma_f32_32x32x16_bf16 v[184:199], v[180:183], v[36:39], v[184:199]
v_mfma_f32_32x32x16_bf16 v[184:199], v[180:183], v[40:43], v[184:199]
v_mfma_f32_32x32x16_bf16 v[184:199], v[180:183], v[44:47], v[184:199]
v_mfma_f32_32x32x16_bf16 v[184:199], v[180:183], v[48:51], v[184:199]
v_mfma_f32_32x32x16_bf16 v[184:199], v[180:183], v[52:55], v[184:199]
v_mfma_f32_32x32x16_bf16 v[184:199], v[180:183], v[56:59], v[184:199]
v_mfma_f32_32x32x16_bf16 v[184:199], v[180:183], v[60:63], v[184:199]
v_mfma_f32_32x32x16_bf16 v[184:199], v[180:183], v[64:67], v[184:199]
v_mfma_f32_32x32x16_bf16 v[184:199], v[180:183], v[68:71], v[184:199]
v_mfma_f32_32x32x16_bf16 v[184:199], v[180:183], v[72:75], v[184:199]
v_mfma_f32_32x32x16_bf16 v[184:199], v[180:183], v[76:79], v[184:199]
v_mfma_f32_32x32x16_bf16 v[184:199], v[180:183], v[80:83], v[184:199]
v_mfma_f32_32x32x16_bf16 v[184:199], v[180:183], v[84:87], v[184:199]
v_mfma_f32_32x32x16_bf16 v[184:199], v[180:183], v[88:91], v[184:199]
v_mfma_f32_32x32x16_bf16 v[184:199], v[180:183], v[92:95], v[184:199]
v_mfma_f32_32x32x16_bf16 v[184:199], v[180:183], v[96:99], v[184:199]
v_mfma_f32_32x32x16_bf16 v[184:199], v[180:183], v[100:103], v[184:199]
v_mfma_f32_32x32x16_bf16 v[184:199], v[180:183], v[104:107], v[184:199]
v_mfma_f32_32x32x16_bf16 v[184:199], v[180:183], v[108:111], v[184:199]
v_mfma_f32_32x32x16_bf16 v[184:199], v[180:183], v[112:115], v[184:199]
v_mfma_f32_32x32x16_bf16 v[184:199], v[180:183], v[116:119], v[184:199]
v_mfma_f32_32x32x16_bf16 v[184:199], v[180:183], v[120:123], v[184:199]
v_mfma_f32_32x32x16_bf16 v[184:199], v[180:183], v[124:127], v[184:199]
v_mfma_f32_32x32x16_bf16 v[184:199], v[180:183], v[128:131], v[184:199]
v_mfma_f32_32x32x16_bf16 v[184:199], v[180:183], v[132:135], v[184:199]
v_mfma_f32_32x32x16_bf16 v[184:199], v[180:183], v[136:139], v[184:199]
v_mfma_f32_32x32x16_bf16 v[184:199], v[180:183], v[140:143], v[184:199]
v_mfma_f32_32x32x16_bf16 v[184:199], v[180:183], v[144:147], v[184:199]
v_mfma_f32_32x32x16_bf16 v[184:199], v[180:183], v[148:151], v[184:199]
v_mfma_f32_32x32x16_bf16 v[184:199], v[180:183], v[152:155], v[184:199]
v_mfma_f32_32x32x16_bf16 v[184:199], v[180:183], v[156:159], v[184:199]
v_mfma_f32_32x32x16_bf16 v[184:199], v[180:183], v[160:163], v[184:199]
v_mfma_f32_32x32x16_bf16 v[184:199], v[180:183], v[164:167], v[184:199]
v_mfma_f32_32x32x16_bf16 v[184:199], v[180:183], v[168:171], v[184:199]
v_mfma_f32_32x32x16_bf16 v[184:199], v[180:183], v[172:175], v[184:199]
s_nop 11
v_mov_b32 v7, v184
s_lshl_b32 s18, s34, 2
s_add_u32 s18, s18, s13
s_lshl_b32 s33, s18, 11
s_mul_i32 s27, s50, 40960
s_add_u32 s27, s27, s33
s_add_u32 s27, s27, 97517568
s_mov_b32 s28, 0
s_waitcnt vmcnt(0)
p1_48:
s_barrier
s_lshl_b32 s18, s13, 5
v_xor_b32 v2, s18, v176
ds_read_b128 v[220:223], v2 offset:2048
ds_read_b128 v[224:227], v2 offset:6144
ds_read_b128 v[228:231], v2 offset:10240
ds_read_b128 v[200:203], v177 offset:2048
v_mov_b64 v[212:213], 0
ds_read_b128 v[232:235], v2 offset:14336
ds_read_b128 v[204:207], v178 offset:2048
ds_read_b128 v[196:199], v176 offset:2048
ds_read_b128 v[208:211], v179 offset:2048
s_waitcnt lgkmcnt(7)
v_dot2c_f32_bf16 v212, s24, v220
v_dot2c_f32_bf16 v213, v220, v220
v_dot2c_f32_bf16 v212, s24, v221
v_dot2c_f32_bf16 v213, v221, v221
s_waitcnt lgkmcnt(6)
v_dot2c_f32_bf16 v212, s24, v222
v_dot2c_f32_bf16 v213, v222, v222
v_dot2c_f32_bf16 v212, s24, v223
v_dot2c_f32_bf16 v213, v223, v223
v_dot2c_f32_bf16 v212, s24, v224
v_dot2c_f32_bf16 v213, v224, v224
v_dot2c_f32_bf16 v212, s24, v225
v_dot2c_f32_bf16 v213, v225, v225
v_dot2c_f32_bf16 v212, s24, v226
v_dot2c_f32_bf16 v213, v226, v226
v_dot2c_f32_bf16 v212, s24, v227
v_dot2c_f32_bf16 v213, v227, v227
s_waitcnt lgkmcnt(5)
s_waitcnt lgkmcnt(3)
ds_read_b128 v[220:223], v2 offset:18432
ds_read_b128 v[224:227], v2 offset:22528
v_dot2c_f32_bf16 v212, s24, v228
v_dot2c_f32_bf16 v213, v228, v228
v_dot2c_f32_bf16 v212, s24, v229
v_dot2c_f32_bf16 v213, v229, v229
v_dot2c_f32_bf16 v212, s24, v230
v_dot2c_f32_bf16 v213, v230, v230
v_dot2c_f32_bf16 v212, s24, v231
v_dot2c_f32_bf16 v213, v231, v231
v_dot2c_f32_bf16 v212, s24, v232
v_dot2c_f32_bf16 v213, v232, v232
v_dot2c_f32_bf16 v212, s24, v233
v_dot2c_f32_bf16 v213, v233, v233
v_dot2c_f32_bf16 v212, s24, v234
v_dot2c_f32_bf16 v213, v234, v234
v_dot2c_f32_bf16 v212, s24, v235
v_dot2c_f32_bf16 v213, v235, v235
s_waitcnt lgkmcnt(1)
ds_read_b128 v[232:235], v2 offset:30720
ds_read_b128 v[228:231], v2 offset:26624
v_dot2c_f32_bf16 v212, s24, v220
v_dot2c_f32_bf16 v213, v220, v220
v_dot2c_f32_bf16 v212, s24, v221
v_dot2c_f32_bf16 v213, v221, v221
v_dot2c_f32_bf16 v212, s24, v222
v_dot2c_f32_bf16 v213, v222, v222
s_waitcnt lgkmcnt(2)
v_dot2c_f32_bf16 v212, s24, v223
v_dot2c_f32_bf16 v213, v223, v223
v_dot2c_f32_bf16 v212, s24, v224
v_dot2c_f32_bf16 v213, v224, v224
v_dot2c_f32_bf16 v212, s24, v225
v_dot2c_f32_bf16 v213, v225, v225
v_dot2c_f32_bf16 v212, s24, v226
v_dot2c_f32_bf16 v213, v226, v226
v_dot2c_f32_bf16 v212, s24, v227
v_dot2c_f32_bf16 v213, v227, v227
s_waitcnt lgkmcnt(1)
s_waitcnt lgkmcnt(0)
ds_read_b128 v[220:223], v2 offset:34816
ds_read_b128 v[224:227], v2 offset:38912
v_dot2c_f32_bf16 v212, s24, v228
v_dot2c_f32_bf16 v213, v228, v228
v_dot2c_f32_bf16 v212, s24, v229
v_dot2c_f32_bf16 v213, v229, v229
v_dot2c_f32_bf16 v212, s24, v230
v_dot2c_f32_bf16 v213, v230, v230
v_dot2c_f32_bf16 v212, s24, v231
v_dot2c_f32_bf16 v213, v231, v231
v_dot2c_f32_bf16 v212, s24, v232
v_dot2c_f32_bf16 v213, v232, v232
v_dot2c_f32_bf16 v212, s24, v233
v_dot2c_f32_bf16 v213, v233, v233
v_dot2c_f32_bf16 v212, s24, v234
v_dot2c_f32_bf16 v213, v234, v234
v_dot2c_f32_bf16 v212, s24, v235
s_waitcnt lgkmcnt(1)
v_dot2c_f32_bf16 v213, v235, v235
v_dot2c_f32_bf16 v212, s24, v220
v_dot2c_f32_bf16 v213, v220, v220
v_dot2c_f32_bf16 v212, s24, v221
v_dot2c_f32_bf16 v213, v221, v221
s_waitcnt lgkmcnt(0)
v_dot2c_f32_bf16 v212, s24, v222
v_dot2c_f32_bf16 v213, v222, v222
v_dot2c_f32_bf16 v212, s24, v223
v_dot2c_f32_bf16 v213, v223, v223
v_dot2c_f32_bf16 v212, s24, v224
v_dot2c_f32_bf16 v213, v224, v224
v_dot2c_f32_bf16 v212, s24, v225
v_dot2c_f32_bf16 v213, v225, v225
v_dot2c_f32_bf16 v212, s24, v226
v_dot2c_f32_bf16 v213, v226, v226
v_dot2c_f32_bf16 v212, s24, v227
v_dot2c_f32_bf16 v213, v227, v227
v_mfma_f32_32x32x16_bf16 v[180:195], v[196:199], v[16:19], 0
v_and_b32 v2, 0x1ff, v0
ds_read_b128 v[196:199], v176 offset:6144
v_permlane32_swap_b32 v212, v213
v_mfma_f32_32x32x16_bf16 v[180:195], v[200:203], v[20:23], v[180:195]
v_add_f32 v212, v212, v213
v_lshl_add_u32 v213, s13, 2, v0
ds_write_b32 v213, v212 offset:0
v_mfma_f32_32x32x16_bf16 v[180:195], v[204:207], v[24:27], v[180:195]
ds_read_b128 v[200:203], v177 offset:6144
s_waitcnt lgkmcnt(2)
ds_read_b128 v[204:207], v178 offset:6144
v_mfma_f32_32x32x16_bf16 v[180:195], v[208:211], v[28:31], v[180:195]
ds_read_b128 v[208:211], v179 offset:6144
v_mfma_f32_32x32x16_bf16 v[180:195], v[196:199], v[32:35], v[180:195]
s_waitcnt lgkmcnt(3)
s_barrier
ds_read_b128 v[196:199], v176 offset:10240
s_waitcnt lgkmcnt(3)
v_mfma_f32_32x32x16_bf16 v[180:195], v[200:203], v[36:39], v[180:195]
ds_read_b128 v[212:215], v2 offset:0
s_waitcnt lgkmcnt(3)
s_waitcnt lgkmcnt(2)
ds_read_b128 v[200:203], v177 offset:10240
v_mfma_f32_32x32x16_bf16 v[180:195], v[204:207], v[40:43], v[180:195]
s_waitcnt lgkmcnt(2)
ds_read_b128 v[204:207], v178 offset:10240
v_mfma_f32_32x32x16_bf16 v[180:195], v[208:211], v[44:47], v[180:195]
ds_read_b128 v[216:219], v2 offset:512
s_waitcnt lgkmcnt(3)
s_waitcnt lgkmcnt(2)
v_mfma_f32_32x32x16_bf16 v[180:195], v[196:199], v[48:51], v[180:195]
ds_read_b128 v[208:211], v179 offset:10240
v_mfma_f32_32x32x16_bf16 v[180:195], v[200:203], v[52:55], v[180:195]
s_waitcnt lgkmcnt(2)
ds_read_b128 v[196:199], v176 offset:14336
v_add_f32 v212, v212, v213
v_add_f32 v214, v214, v215
v_lshrrev_b32 v213, 2, v0
v_mfma_f32_32x32x16_bf16 v[180:195], v[204:207], v[56:59], v[180:195]
s_waitcnt lgkmcnt(1)
ds_read_b128 v[200:203], v177 offset:14336
ds_read_b128 v[204:207], v178 offset:14336
v_add_f32 v212, v212, v214
v_mfma_f32_32x32x16_bf16 v[180:195], v[208:211], v[60:63], v[180:195]
ds_read_b128 v[208:211], v179 offset:14336
v_bfe_u32 v214, v0, 5, 5
s_waitcnt lgkmcnt(3)
v_and_b32 v214, 16, v214
v_mfma_f32_32x32x16_bf16 v[180:195], v[196:199], v[64:67], v[180:195]
ds_read_b128 v[196:199], v176 offset:18432
v_add_f32 v218, v218, v219
s_waitcnt lgkmcnt(3)
v_mul_f32 v212, 0x3acccccd, v212
v_add_f32 v216, v216, v217
v_mfma_f32_32x32x16_bf16 v[180:195], v[200:203], v[68:71], v[180:195]
ds_read_b128 v[200:203], v177 offset:18432
s_waitcnt lgkmcnt(2)
v_add_f32 v216, v216, v218
v_mul_f32 v216, 0x3acccccd, v216
v_fma_f32 v216, -v212, v212, v216
v_mfma_f32_32x32x16_bf16 v[180:195], v[204:207], v[72:75], v[180:195]
v_max_f32 v216, 0, v216
v_add_f32 v216, 0x3727c5ac, v216
v_mfma_f32_32x32x16_bf16 v[180:195], v[208:211], v[76:79], v[180:195]
s_waitcnt lgkmcnt(1)
ds_read_b128 v[208:211], v179 offset:18432
ds_read_b128 v[204:207], v178 offset:18432
v_lshl_add_u32 v214, s13, 8, v214
s_waitcnt lgkmcnt(2)
v_rsq_f32 v216, v216
v_mfma_f32_32x32x16_bf16 v[180:195], v[196:199], v[80:83], v[180:195]
v_mul_f32 v212, v216, v212
v_lshl_add_u32 v213, s13, 8, v213
s_nop 0
v_permlane32_swap_b32 v216, v212
v_mfma_f32_32x32x16_bf16 v[180:195], v[200:203], v[84:87], v[180:195]
ds_read_b128 v[196:199], v176 offset:22528
ds_read_b128 v[200:203], v177 offset:22528
s_waitcnt lgkmcnt(2)
v_mfma_f32_32x32x16_bf16 v[180:195], v[204:207], v[88:91], v[180:195]
ds_write_b32 v213, v216 offset:1024
ds_read_b128 v[240:243], v214 offset:1184
ds_read_b128 v[204:207], v178 offset:22528
ds_read_b128 v[232:235], v214 offset:1120
v_mfma_f32_32x32x16_bf16 v[180:195], v[208:211], v[92:95], v[180:195]
ds_read_b128 v[208:211], v179 offset:22528
s_waitcnt lgkmcnt(6)
v_mfma_f32_32x32x16_bf16 v[180:195], v[196:199], v[96:99], v[180:195]
s_waitcnt lgkmcnt(5)
ds_read_b128 v[196:199], v176 offset:26624
v_mfma_f32_32x32x16_bf16 v[180:195], v[200:203], v[100:103], v[180:195]
s_waitcnt lgkmcnt(3)
ds_read_b128 v[220:223], v214 offset:1024
v_mfma_f32_32x32x16_bf16 v[180:195], v[204:207], v[104:107], v[180:195]
s_waitcnt lgkmcnt(2)
ds_read_b128 v[204:207], v178 offset:26624
ds_read_b128 v[200:203], v177 offset:26624
ds_read_b128 v[228:231], v214 offset:1088
s_waitcnt lgkmcnt(4)
v_mfma_f32_32x32x16_bf16 v[180:195], v[208:211], v[108:111], v[180:195]
v_mfma_f32_32x32x16_bf16 v[180:195], v[196:199], v[112:115], v[180:195]
ds_read_b128 v[196:199], v176 offset:30720
ds_read_b128 v[208:211], v179 offset:26624
s_waitcnt lgkmcnt(4)
ds_read_b128 v[244:247], v214 offset:1216
s_waitcnt lgkmcnt(4)
ds_read_b128 v[236:239], v214 offset:1152
v_mfma_f32_32x32x16_bf16 v[180:195], v[200:203], v[116:119], v[180:195]
v_mul_f32 v243, v243, v7
ds_read_b128 v[248:251], v214 offset:1248
v_mfma_f32_32x32x16_bf16 v[180:195], v[204:207], v[120:123], v[180:195]
ds_read_b128 v[200:203], v177 offset:30720
s_waitcnt lgkmcnt(4)
v_mfma_f32_32x32x16_bf16 v[180:195], v[208:211], v[124:127], v[180:195]
ds_read_b128 v[208:211], v179 offset:30720
ds_read_b128 v[204:207], v178 offset:30720
v_mul_f32 v240, v240, v7
v_mfma_f32_32x32x16_bf16 v[180:195], v[196:199], v[128:131], v[180:195]
s_waitcnt lgkmcnt(2)
v_mfma_f32_32x32x16_bf16 v[180:195], v[200:203], v[132:135], v[180:195]
ds_read_b128 v[200:203], v177 offset:34816
ds_read_b128 v[196:199], v176 offset:34816
s_waitcnt lgkmcnt(3)
s_waitcnt lgkmcnt(2)
ds_read_b128 v[224:227], v214 offset:1056
v_mfma_f32_32x32x16_bf16 v[180:195], v[204:207], v[136:139], v[180:195]
v_mul_f32 v248, v248, v7
v_mfma_f32_32x32x16_bf16 v[180:195], v[208:211], v[140:143], v[180:195]
ds_read_b128 v[208:211], v179 offset:34816
ds_read_b128 v[204:207], v178 offset:34816
s_waitcnt lgkmcnt(3)
v_mfma_f32_32x32x16_bf16 v[180:195], v[196:199], v[144:147], v[180:195]
v_mfma_f32_32x32x16_bf16 v[180:195], v[200:203], v[148:151], v[180:195]
s_waitcnt lgkmcnt(0)
ds_read_b128 v[196:199], v176 offset:38912
v_mfma_f32_32x32x16_bf16 v[180:195], v[204:207], v[152:155], v[180:195]
ds_read_b128 v[204:207], v178 offset:38912
v_mul_f32 v238, v238, v7
v_mul_f32 v239, v239, v7
ds_read_b128 v[200:203], v177 offset:38912
v_mfma_f32_32x32x16_bf16 v[180:195], v[208:211], v[156:159], v[180:195]
v_mul_f32 v250, v250, v7
v_mul_f32 v247, v247, v7
s_waitcnt lgkmcnt(2)
v_mfma_f32_32x32x16_bf16 v[180:195], v[196:199], v[160:163], v[180:195]
ds_read_b128 v[208:211], v179 offset:38912
v_mul_f32 v249, v249, v7
v_mul_f32 v241, v241, v7
s_waitcnt lgkmcnt(1)
v_mfma_f32_32x32x16_bf16 v[180:195], v[200:203], v[164:167], v[180:195]
v_mul_f32 v237, v237, v7
v_mul_f32 v242, v242, v7
v_mul_f32 v244, v244, v7
v_mul_f32 v246, v246, v7
v_mul_f32 v251, v251, v7
v_mul_f32 v245, v245, v7
v_mfma_f32_32x32x16_bf16 v[180:195], v[204:207], v[168:171], v[180:195]
s_waitcnt lgkmcnt(0)
v_mul_f32 v236, v236, v7
v_mfma_f32_32x32x16_bf16 v[180:195], v[208:211], v[172:175], v[180:195]
s_nop 11
v_pk_fma_f32 v[184:185], v[184:185], v[224:225], v[240:241] neg_lo:[0,0,1] neg_hi:[0,0,1]
v_cvt_pk_bf16_f32 v198, v184, v185
v_pk_fma_f32 v[192:193], v[192:193], v[232:233], v[248:249] neg_lo:[0,0,1] neg_hi:[0,0,1]
v_pk_fma_f32 v[182:183], v[182:183], v[222:223], v[238:239] neg_lo:[0,0,1] neg_hi:[0,0,1]
v_pk_fma_f32 v[194:195], v[194:195], v[234:235], v[250:251] neg_lo:[0,0,1] neg_hi:[0,0,1]
v_pk_fma_f32 v[188:189], v[188:189], v[228:229], v[244:245] neg_lo:[0,0,1] neg_hi:[0,0,1]
v_pk_fma_f32 v[190:191], v[190:191], v[230:231], v[246:247] neg_lo:[0,0,1] neg_hi:[0,0,1]
v_pk_fma_f32 v[186:187], v[186:187], v[226:227], v[242:243] neg_lo:[0,0,1] neg_hi:[0,0,1]
v_cvt_pk_bf16_f32 v203, v194, v195
v_cvt_pk_bf16_f32 v199, v186, v187
v_pk_fma_f32 v[180:181], v[180:181], v[220:221], v[236:237] neg_lo:[0,0,1] neg_hi:[0,0,1]
v_cvt_pk_bf16_f32 v200, v188, v189
v_cvt_pk_bf16_f32 v202, v192, v193
v_cvt_pk_bf16_f32 v197, v182, v183
v_cvt_pk_bf16_f32 v196, v180, v181
v_cvt_pk_bf16_f32 v201, v190, v191
buffer_store_dwordx4 v[196:199], v6, s[4:7], s27 offen offset:0 sc1
buffer_store_dwordx4 v[200:203], v6, s[4:7], s27 offen offset:1024 sc1
v_add_u32 v176, 40960, v176
v_add_u32 v177, 40960, v177
v_add_u32 v178, 40960, v178
v_add_u32 v179, 40960, v179
s_add_u32 s27, s27, 1310720
s_add_u32 s28, s28, 1
s_cmp_lt_u32 s28, 2
s_cbranch_scc1 p1_48
s_lshl_b32 s18, s39, 7
s_add_u32 s18, s18, 11571200
s_cmp_eq_u32 s13, 0
s_cselect_b32 s22, s18, s6
s_mov_b32 s23, 1
alay_49:
v_bfe_u32 v96, v0, 4, 4
v_lshrrev_b32 v97, 8, v0
v_lshlrev_b32 v97, 2, v97
v_lshl_add_u32 v98, s13, 4, v96
v_add_u32 v99, 0, v97
v_mul_u32_u24 v99, v99, v98
v_and_b32 v99, 63, v99
v_cvt_f32_u32 v99, v99
v_mul_f32 v99, 0x3c800000, v99
v_cos_f32 v104, v99
v_sin_f32 v112, v99
v_add_u32 v99, 1, v97
v_mul_u32_u24 v99, v99, v98
v_and_b32 v99, 63, v99
v_cvt_f32_u32 v99, v99
v_mul_f32 v99, 0x3c800000, v99
v_cos_f32 v105, v99
v_sin_f32 v113, v99
v_add_u32 v99, 2, v97
v_mul_u32_u24 v99, v99, v98
v_and_b32 v99, 63, v99
v_cvt_f32_u32 v99, v99
v_mul_f32 v99, 0x3c800000, v99
v_cos_f32 v106, v99
v_sin_f32 v114, v99
v_add_u32 v99, 3, v97
v_mul_u32_u24 v99, v99, v98
v_and_b32 v99, 63, v99
v_cvt_f32_u32 v99, v99
v_mul_f32 v99, 0x3c800000, v99
v_cos_f32 v107, v99
v_sin_f32 v115, v99
v_add_u32 v99, 16, v97
v_mul_u32_u24 v99, v99, v98
v_and_b32 v99, 63, v99
v_cvt_f32_u32 v99, v99
v_mul_f32 v99, 0x3c800000, v99
v_cos_f32 v108, v99
v_sin_f32 v116, v99
v_add_u32 v99, 17, v97
v_mul_u32_u24 v99, v99, v98
v_and_b32 v99, 63, v99
v_cvt_f32_u32 v99, v99
v_mul_f32 v99, 0x3c800000, v99
v_cos_f32 v109, v99
v_sin_f32 v117, v99
v_add_u32 v99, 18, v97
v_mul_u32_u24 v99, v99, v98
v_and_b32 v99, 63, v99
v_cvt_f32_u32 v99, v99
v_mul_f32 v99, 0x3c800000, v99
v_cos_f32 v110, v99
v_sin_f32 v118, v99
v_add_u32 v99, 19, v97
v_mul_u32_u24 v99, v99, v98
v_and_b32 v99, 63, v99
v_cvt_f32_u32 v99, v99
v_mul_f32 v99, 0x3c800000, v99
v_cos_f32 v111, v99
v_sin_f32 v119, v99
v_cvt_pk_bf16_f32 v16, v104, v105
v_cvt_pk_bf16_f32 v24, v112, v113
v_xor_b32 v32, 0x80008000, v24
v_cvt_pk_bf16_f32 v17, v106, v107
v_cvt_pk_bf16_f32 v25, v114, v115
v_xor_b32 v33, 0x80008000, v25
v_cvt_pk_bf16_f32 v18, v108, v109
v_cvt_pk_bf16_f32 v26, v116, v117
v_xor_b32 v34, 0x80008000, v26
v_cvt_pk_bf16_f32 v19, v110, v111
v_cvt_pk_bf16_f32 v27, v118, v119
v_xor_b32 v35, 0x80008000, v27
v_add_u32 v99, 32, v97
v_mul_u32_u24 v99, v99, v98
v_and_b32 v99, 63, v99
v_cvt_f32_u32 v99, v99
v_mul_f32 v99, 0x3c800000, v99
v_cos_f32 v104, v99
v_sin_f32 v112, v99
v_add_u32 v99, 33, v97
v_mul_u32_u24 v99, v99, v98
v_and_b32 v99, 63, v99
v_cvt_f32_u32 v99, v99
v_mul_f32 v99, 0x3c800000, v99
v_cos_f32 v105, v99
v_sin_f32 v113, v99
v_add_u32 v99, 34, v97
v_mul_u32_u24 v99, v99, v98
v_and_b32 v99, 63, v99
v_cvt_f32_u32 v99, v99
v_mul_f32 v99, 0x3c800000, v99
v_cos_f32 v106, v99
v_sin_f32 v114, v99
v_add_u32 v99, 35, v97
v_mul_u32_u24 v99, v99, v98
v_and_b32 v99, 63, v99
v_cvt_f32_u32 v99, v99
v_mul_f32 v99, 0x3c800000, v99
v_cos_f32 v107, v99
v_sin_f32 v115, v99
v_add_u32 v99, 48, v97
v_mul_u32_u24 v99, v99, v98
v_and_b32 v99, 63, v99
v_cvt_f32_u32 v99, v99
v_mul_f32 v99, 0x3c800000, v99
v_cos_f32 v108, v99
v_sin_f32 v116, v99
v_add_u32 v99, 49, v97
v_mul_u32_u24 v99, v99, v98
v_and_b32 v99, 63, v99
v_cvt_f32_u32 v99, v99
v_mul_f32 v99, 0x3c800000, v99
v_cos_f32 v109, v99
v_sin_f32 v117, v99
v_add_u32 v99, 50, v97
v_mul_u32_u24 v99, v99, v98
v_and_b32 v99, 63, v99
v_cvt_f32_u32 v99, v99
v_mul_f32 v99, 0x3c800000, v99
v_cos_f32 v110, v99
v_sin_f32 v118, v99
v_add_u32 v99, 51, v97
v_mul_u32_u24 v99, v99, v98
v_and_b32 v99, 63, v99
v_cvt_f32_u32 v99, v99
v_mul_f32 v99, 0x3c800000, v99
v_cos_f32 v111, v99
v_sin_f32 v119, v99
v_cvt_pk_bf16_f32 v20, v104, v105
v_cvt_pk_bf16_f32 v28, v112, v113
v_xor_b32 v36, 0x80008000, v28
v_cvt_pk_bf16_f32 v21, v106, v107
v_cvt_pk_bf16_f32 v29, v114, v115
v_xor_b32 v37, 0x80008000, v29
v_cvt_pk_bf16_f32 v22, v108, v109
v_cvt_pk_bf16_f32 v30, v116, v117
v_xor_b32 v38, 0x80008000, v30
v_cvt_pk_bf16_f32 v23, v110, v111
v_cvt_pk_bf16_f32 v31, v118, v119
v_xor_b32 v39, 0x80008000, v31
s_waitcnt vmcnt(0)
s_barrier
v_mov_b32 v3, s23
s_mov_b64 exec, 1
buffer_store_dword v3, off, s[4:7], s22 sc1
s_mov_b64 exec, -1
s_mov_b32 s22, s6
v_add_u32 v99, 0, v97
v_mul_u32_u24 v99, v99, v98
v_and_b32 v99, 2047, v99
v_cvt_f32_u32 v99, v99
v_mul_f32 v99, 0x3a000000, v99
v_cos_f32 v64, v99
v_sin_f32 v72, v99
v_add_u32 v99, 1, v97
v_mul_u32_u24 v99, v99, v98
v_and_b32 v99, 2047, v99
v_cvt_f32_u32 v99, v99
v_mul_f32 v99, 0x3a000000, v99
v_cos_f32 v65, v99
v_sin_f32 v73, v99
v_add_u32 v99, 2, v97
v_mul_u32_u24 v99, v99, v98
v_and_b32 v99, 2047, v99
v_cvt_f32_u32 v99, v99
v_mul_f32 v99, 0x3a000000, v99
v_cos_f32 v66, v99
v_sin_f32 v74, v99
v_add_u32 v99, 3, v97
v_mul_u32_u24 v99, v99, v98
v_and_b32 v99, 2047, v99
v_cvt_f32_u32 v99, v99
v_mul_f32 v99, 0x3a000000, v99
v_cos_f32 v67, v99
v_sin_f32 v75, v99
v_add_u32 v99, 16, v97
v_mul_u32_u24 v99, v99, v98
v_and_b32 v99, 2047, v99
v_cvt_f32_u32 v99, v99
v_mul_f32 v99, 0x3a000000, v99
v_cos_f32 v68, v99
v_sin_f32 v76, v99
v_add_u32 v99, 17, v97
v_mul_u32_u24 v99, v99, v98
v_and_b32 v99, 2047, v99
v_cvt_f32_u32 v99, v99
v_mul_f32 v99, 0x3a000000, v99
v_cos_f32 v69, v99
v_sin_f32 v77, v99
v_add_u32 v99, 18, v97
v_mul_u32_u24 v99, v99, v98
v_and_b32 v99, 2047, v99
v_cvt_f32_u32 v99, v99
v_mul_f32 v99, 0x3a000000, v99
v_cos_f32 v70, v99
v_sin_f32 v78, v99
v_add_u32 v99, 19, v97
v_mul_u32_u24 v99, v99, v98
v_and_b32 v99, 2047, v99
v_cvt_f32_u32 v99, v99
v_mul_f32 v99, 0x3a000000, v99
v_cos_f32 v71, v99
v_sin_f32 v79, v99
v_lshl_add_u32 v100, s13, 4, v97
v_add_u32 v98, 0, v96
v_add_u32 v99, 0, v97
v_mul_u32_u24 v99, v99, v98
v_and_b32 v99, 31, v99
v_cvt_f32_u32 v99, v99
v_mul_f32 v99, 0x3d000000, v99
v_cos_f32 v104, v99
v_sin_f32 v112, v99
v_add_u32 v99, 1, v97
v_mul_u32_u24 v99, v99, v98
v_and_b32 v99, 31, v99
v_cvt_f32_u32 v99, v99
v_mul_f32 v99, 0x3d000000, v99
v_cos_f32 v105, v99
v_sin_f32 v113, v99
v_add_u32 v99, 2, v97
v_mul_u32_u24 v99, v99, v98
v_and_b32 v99, 31, v99
v_cvt_f32_u32 v99, v99
v_mul_f32 v99, 0x3d000000, v99
v_cos_f32 v106, v99
v_sin_f32 v114, v99
v_add_u32 v99, 3, v97
v_mul_u32_u24 v99, v99, v98
v_and_b32 v99, 31, v99
v_cvt_f32_u32 v99, v99
v_mul_f32 v99, 0x3d000000, v99
v_cos_f32 v107, v99
v_sin_f32 v115, v99
v_add_u32 v99, 16, v97
v_mul_u32_u24 v99, v99, v98
v_and_b32 v99, 31, v99
v_cvt_f32_u32 v99, v99
v_mul_f32 v99, 0x3d000000, v99
v_cos_f32 v108, v99
v_sin_f32 v116, v99
v_add_u32 v99, 17, v97
v_mul_u32_u24 v99, v99, v98
v_and_b32 v99, 31, v99
v_cvt_f32_u32 v99, v99
v_mul_f32 v99, 0x3d000000, v99
v_cos_f32 v109, v99
v_sin_f32 v117, v99
v_add_u32 v99, 18, v97
v_mul_u32_u24 v99, v99, v98
v_and_b32 v99, 31, v99
v_cvt_f32_u32 v99, v99
v_mul_f32 v99, 0x3d000000, v99
v_cos_f32 v110, v99
v_sin_f32 v118, v99
v_add_u32 v99, 19, v97
v_mul_u32_u24 v99, v99, v98
v_and_b32 v99, 31, v99
v_cvt_f32_u32 v99, v99
v_mul_f32 v99, 0x3d000000, v99
v_cos_f32 v111, v99
v_sin_f32 v119, v99
v_cvt_pk_bf16_f32 v40, v104, v105
v_cvt_pk_bf16_f32 v48, v112, v113
v_xor_b32 v56, 0x80008000, v48
v_cvt_pk_bf16_f32 v41, v106, v107
v_cvt_pk_bf16_f32 v49, v114, v115
v_xor_b32 v57, 0x80008000, v49
v_cvt_pk_bf16_f32 v42, v108, v109
v_cvt_pk_bf16_f32 v50, v116, v117
v_xor_b32 v58, 0x80008000, v50
v_cvt_pk_bf16_f32 v43, v110, v111
v_cvt_pk_bf16_f32 v51, v118, v119
v_xor_b32 v59, 0x80008000, v51
v_add_u32 v99, 0, v100
v_mul_u32_u24 v99, v99, v98
v_and_b32 v99, 2047, v99
v_cvt_f32_u32 v99, v99
v_mul_f32 v99, 0x3a000000, v99
v_cos_f32 v80, v99
v_sin_f32 v88, v99
v_mul_f32 v80, 0x3a000000, v80
v_mul_f32 v88, 0x3a000000, v88
v_add_u32 v99, 1, v100
v_mul_u32_u24 v99, v99, v98
v_and_b32 v99, 2047, v99
v_cvt_f32_u32 v99, v99
v_mul_f32 v99, 0x3a000000, v99
v_cos_f32 v81, v99
v_sin_f32 v89, v99
v_mul_f32 v81, 0x3a000000, v81
v_mul_f32 v89, 0x3a000000, v89
v_add_u32 v99, 2, v100
v_mul_u32_u24 v99, v99, v98
v_and_b32 v99, 2047, v99
v_cvt_f32_u32 v99, v99
v_mul_f32 v99, 0x3a000000, v99
v_cos_f32 v82, v99
v_sin_f32 v90, v99
v_mul_f32 v82, 0x3a000000, v82
v_mul_f32 v90, 0x3a000000, v90
v_add_u32 v99, 3, v100
v_mul_u32_u24 v99, v99, v98
v_and_b32 v99, 2047, v99
v_cvt_f32_u32 v99, v99
v_mul_f32 v99, 0x3a000000, v99
v_cos_f32 v83, v99
v_sin_f32 v91, v99
v_mul_f32 v83, 0x3a000000, v83
v_mul_f32 v91, 0x3a000000, v91
v_add_u32 v98, 16, v96
v_add_u32 v99, 0, v97
v_mul_u32_u24 v99, v99, v98
v_and_b32 v99, 31, v99
v_cvt_f32_u32 v99, v99
v_mul_f32 v99, 0x3d000000, v99
v_cos_f32 v104, v99
v_sin_f32 v112, v99
v_add_u32 v99, 1, v97
v_mul_u32_u24 v99, v99, v98
v_and_b32 v99, 31, v99
v_cvt_f32_u32 v99, v99
v_mul_f32 v99, 0x3d000000, v99
v_cos_f32 v105, v99
v_sin_f32 v113, v99
v_add_u32 v99, 2, v97
v_mul_u32_u24 v99, v99, v98
v_and_b32 v99, 31, v99
v_cvt_f32_u32 v99, v99
v_mul_f32 v99, 0x3d000000, v99
v_cos_f32 v106, v99
v_sin_f32 v114, v99
v_add_u32 v99, 3, v97
v_mul_u32_u24 v99, v99, v98
v_and_b32 v99, 31, v99
v_cvt_f32_u32 v99, v99
v_mul_f32 v99, 0x3d000000, v99
v_cos_f32 v107, v99
v_sin_f32 v115, v99
v_add_u32 v99, 16, v97
v_mul_u32_u24 v99, v99, v98
v_and_b32 v99, 31, v99
v_cvt_f32_u32 v99, v99
v_mul_f32 v99, 0x3d000000, v99
v_cos_f32 v108, v99
v_sin_f32 v116, v99
v_add_u32 v99, 17, v97
v_mul_u32_u24 v99, v99, v98
v_and_b32 v99, 31, v99
v_cvt_f32_u32 v99, v99
v_mul_f32 v99, 0x3d000000, v99
v_cos_f32 v109, v99
v_sin_f32 v117, v99
v_add_u32 v99, 18, v97
v_mul_u32_u24 v99, v99, v98
v_and_b32 v99, 31, v99
v_cvt_f32_u32 v99, v99
v_mul_f32 v99, 0x3d000000, v99
v_cos_f32 v110, v99
v_sin_f32 v118, v99
v_add_u32 v99, 19, v97
v_mul_u32_u24 v99, v99, v98
v_and_b32 v99, 31, v99
v_cvt_f32_u32 v99, v99
v_mul_f32 v99, 0x3d000000, v99
v_cos_f32 v111, v99
v_sin_f32 v119, v99
v_cvt_pk_bf16_f32 v44, v104, v105
v_cvt_pk_bf16_f32 v52, v112, v113
v_xor_b32 v60, 0x80008000, v52
v_cvt_pk_bf16_f32 v45, v106, v107
v_cvt_pk_bf16_f32 v53, v114, v115
v_xor_b32 v61, 0x80008000, v53
v_cvt_pk_bf16_f32 v46, v108, v109
v_cvt_pk_bf16_f32 v54, v116, v117
v_xor_b32 v62, 0x80008000, v54
v_cvt_pk_bf16_f32 v47, v110, v111
v_cvt_pk_bf16_f32 v55, v118, v119
v_xor_b32 v63, 0x80008000, v55
v_add_u32 v99, 0, v100
v_mul_u32_u24 v99, v99, v98
v_and_b32 v99, 2047, v99
v_cvt_f32_u32 v99, v99
v_mul_f32 v99, 0x3a000000, v99
v_cos_f32 v84, v99
v_sin_f32 v92, v99
v_mul_f32 v84, 0x3a000000, v84
v_mul_f32 v92, 0x3a000000, v92
v_add_u32 v99, 1, v100
v_mul_u32_u24 v99, v99, v98
v_and_b32 v99, 2047, v99
v_cvt_f32_u32 v99, v99
v_mul_f32 v99, 0x3a000000, v99
v_cos_f32 v85, v99
v_sin_f32 v93, v99
v_mul_f32 v85, 0x3a000000, v85
v_mul_f32 v93, 0x3a000000, v93
v_add_u32 v99, 2, v100
v_mul_u32_u24 v99, v99, v98
v_and_b32 v99, 2047, v99
v_cvt_f32_u32 v99, v99
v_mul_f32 v99, 0x3a000000, v99
v_cos_f32 v86, v99
v_sin_f32 v94, v99
v_mul_f32 v86, 0x3a000000, v86
v_mul_f32 v94, 0x3a000000, v94
v_add_u32 v99, 3, v100
v_mul_u32_u24 v99, v99, v98
v_and_b32 v99, 2047, v99
v_cvt_f32_u32 v99, v99
v_mul_f32 v99, 0x3a000000, v99
v_cos_f32 v87, v99
v_sin_f32 v95, v99
v_mul_f32 v87, 0x3a000000, v87
v_mul_f32 v95, 0x3a000000, v95
v_lshrrev_b32 v98, 6, v0
v_and_b32 v99, 7, v98
v_lshlrev_b32 v99, 5, v99
v_lshl_add_u32 v98, v98, 8, v99
v_and_b32 v99, 16, v0
v_add_u32 v98, v98, v99
v_bfe_u32 v99, v0, 5, 1
v_lshl_add_u32 v224, v99, 3, v98
v_xor_b32 v225, 32, v224
v_xor_b32 v226, 64, v224
v_xor_b32 v227, 96, v224
v_xor_b32 v228, 128, v224
v_xor_b32 v229, 160, v224
v_xor_b32 v230, 192, v224
v_xor_b32 v231, 224, v224
v_lshrrev_b32 v98, 8, v0
v_bfe_u32 v99, v0, 5, 3
v_xor_b32 v99, v99, v98
v_mul_u32_u24 v98, 40960, v98
v_and_b32 v96, 16, v0
v_add_u32 v98, v98, v96
v_and_b32 v96, 3, v99
v_lshl_add_u32 v98, v96, 5, v98
v_lshrrev_b32 v99, 2, v99
v_lshl_add_u32 v232, v99, 10, v98
v_xor_b32 v99, 1, v99
v_lshl_add_u32 v233, v99, 10, v98
s_lshl_b32 s18, s13, 12
s_add_u32 s19, s18, 147456
v_add_u32 v220, s19, v0
s_mov_b32 s25, s18
s_mul_i32 s26, s16, 3145728
s_mul_i32 s19, s13, 655360
s_add_u32 s26, s26, s19
s_lshl_b32 s19, s39, 8
s_add_u32 s27, s26, s19
s_add_u32 s27, s27, 103809024
s_lshr_b32 s19, s39, 3
s_lshl_b32 s19, s19, 11
s_add_u32 s26, s26, s19
s_and_b32 s19, s39, 7
s_lshl_b32 s19, s19, 7
s_add_u32 s26, s26, s19
s_add_u32 s26, s26, 97517568
s_cmp_lg_u32 s16, 0
s_cbranch_scc1 cw_50
s_cmp_lg_u32 s13, 0
s_cbranch_scc1 polld_53
v_lshlrev_b32 v3, 3, v0
v_min_u32 v12, 3968, v3
s_mov_b32 s21, 11563008
s_mov_b32 s17, 0
poll_52:
buffer_load_dword v8, v3, s[4:7], s21 offen sc1
s_add_u32 s20, s21, 8192
buffer_load_dword v9, v3, s[4:7], s20 offen sc1
s_add_u32 s20, s21, 16384
buffer_load_dword v10, v3, s[4:7], s20 offen sc1
s_add_u32 s20, s21, 24576
buffer_load_dword v11, v12, s[4:7], s20 offen sc1
s_add_u32 s17, s17, 1
s_cmp_gt_u32 s17, 262144
s_cbranch_scc1 L_fail
s_waitcnt vmcnt(2)
v_min_u32 v8, v8, v9
s_waitcnt vmcnt(1)
v_min_u32 v8, v8, v10
s_waitcnt vmcnt(0)
v_min_u32 v8, v8, v11
v_cmp_gt_u32 vcc, 1, v8
s_cbranch_vccz polld_53
s_sleep 2
s_branch poll_52
polld_53:
s_barrier
s_add_u32 s18, s25, 145408
s_lshl_b32 s19, s39, 14
s_add_u32 s19, s19, s25
s_add_u32 s19, s19, 167772160
s_add_u32 m0, s18, 2048
s_add_u32 s20, s19, 0
buffer_load_dwordx4 v0, s[4:7], s20 offen sc1 lds
s_add_u32 m0, s18, 3072
s_add_u32 s20, s19, 1024
buffer_load_dwordx4 v0, s[4:7], s20 offen sc1 lds
s_add_u32 m0, s18, 4096
s_add_u32 s20, s19, 2048
buffer_load_dwordx4 v0, s[4:7], s20 offen sc1 lds
s_add_u32 m0, s18, 5120
s_add_u32 s20, s19, 3072
buffer_load_dwordx4 v0, s[4:7], s20 offen sc1 lds
s_branch cw_51
cw_50:
s_cmp_lg_u32 s13, 0
s_cbranch_scc1 polld_55
v_lshlrev_b32 v3, 3, v0
v_min_u32 v12, 4352, v3
s_mov_b32 s21, 11552768
s_mov_b32 s17, 0
poll_54:
buffer_load_dword v8, v12, s[4:7], s21 offen sc1
s_add_u32 s17, s17, 1
s_cmp_gt_u32 s17, 262144
s_cbranch_scc1 L_fail
s_waitcnt vmcnt(0)
v_cmp_gt_u32 vcc, 1, v8
s_cbranch_vccz polld_55
s_sleep 2
s_branch poll_54
polld_55:
s_barrier
cw_51:
s_add_u32 m0, s25, 0
s_add_u32 s20, s26, 0
buffer_load_dwordx4 v232, s[4:7], s20 offen sc1 lds
s_add_u32 m0, s25, 1024
s_add_u32 s20, s26, 163840
buffer_load_dwordx4 v233, s[4:7], s20 offen sc1 lds
s_add_u32 m0, s25, 2048
s_add_u32 s20, s26, 327680
buffer_load_dwordx4 v232, s[4:7], s20 offen sc1 lds
s_add_u32 m0, s25, 3072
s_add_u32 s20, s26, 491520
buffer_load_dwordx4 v233, s[4:7], s20 offen sc1 lds
s_lshr_b32 s18, s13, 1
s_lshl_b32 s18, s18, 10
s_and_b32 s19, s13, 1
s_lshl_b32 s19, s19, 3
s_add_u32 s18, s18, s19
v_add_u32 v234, s18, v0
v_bfe_u32 v235, v0, 4, 4
v_mul_u32_u24 v235, 40960, v235
v_lshrrev_b32 v99, 8, v0
v_lshl_add_u32 v235, v99, 4, v235
s_waitcnt vmcnt(0)
s_barrier
ds_read_b64_tr_b16 v[112:113], v225 offset:0
ds_read_b64_tr_b16 v[114:115], v225 offset:4096
ds_read_b64_tr_b16 v[98:99], v224 offset:4096
ds_read_b64_tr_b16 v[96:97], v224 offset:0
ds_read_b64_tr_b16 v[102:103], v224 offset:12288
ds_read_b64_tr_b16 v[144:145], v227 offset:0
ds_read_b64_tr_b16 v[130:131], v226 offset:4096
ds_read_b64_tr_b16 v[104:105], v228 offset:0
ds_read_b64_tr_b16 v[118:119], v225 offset:12288
ds_read_b64_tr_b16 v[100:101], v224 offset:8192
ds_read_b64_tr_b16 v[120:121], v229 offset:0
ds_read_b64_tr_b16 v[116:117], v225 offset:8192
ds_read_b64_tr_b16 v[110:111], v228 offset:12288
ds_read_b64_tr_b16 v[122:123], v229 offset:4096
ds_read_b64_tr_b16 v[108:109], v228 offset:8192
ds_read_b64_tr_b16 v[152:153], v231 offset:0
s_waitcnt lgkmcnt(14)
ds_read_b64_tr_b16 v[126:127], v229 offset:12288
v_mfma_f32_16x16x32_bf16 v[168:171], v[112:115], v[16:19], 0
s_waitcnt lgkmcnt(13)
ds_read_b64_tr_b16 v[106:107], v228 offset:4096
ds_read_b64_tr_b16 v[146:147], v227 offset:4096
v_mfma_f32_16x16x32_bf16 v[160:163], v[96:99], v[16:19], 0
ds_read_b64_tr_b16 v[128:129], v226 offset:0
ds_read_b64_tr_b16 v[134:135], v226 offset:12288
v_mfma_f32_16x16x32_bf16 v[168:171], v[96:99], v[32:35], v[168:171]
s_waitcnt lgkmcnt(13)
ds_read_b128 v[208:211], v220 offset:0
ds_read_b64_tr_b16 v[138:139], v230 offset:4096
v_mfma_f32_16x16x32_bf16 v[160:163], v[112:115], v[24:27], v[160:163]
s_waitcnt lgkmcnt(13)
ds_read_b64_tr_b16 v[136:137], v230 offset:0
ds_read_b64_tr_b16 v[140:141], v230 offset:8192
v_mfma_f32_16x16x32_bf16 v[160:163], v[100:103], v[20:23], v[160:163]
s_waitcnt lgkmcnt(13)
ds_read_b64_tr_b16 v[148:149], v227 offset:8192
ds_read_b64_tr_b16 v[124:125], v229 offset:8192
v_mfma_f32_16x16x32_bf16 v[160:163], v[116:119], v[28:31], v[160:163]
s_waitcnt lgkmcnt(13)
ds_read_b64_tr_b16 v[154:155], v231 offset:4096
ds_read_b64_tr_b16 v[142:143], v230 offset:12288
v_mfma_f32_16x16x32_bf16 v[168:171], v[116:119], v[20:23], v[168:171]
ds_read_b128 v[212:215], v220 offset:1024
ds_read_b128 v[216:219], v220 offset:2048
v_mfma_f32_16x16x32_bf16 v[168:171], v[100:103], v[36:39], v[168:171]
s_waitcnt lgkmcnt(13)
ds_read_b128 v[220:223], v220 offset:3072
v_mul_f32 v233, v161, v73
v_mfma_f32_16x16x32_bf16 v[172:175], v[120:123], v[16:19], 0
s_waitcnt lgkmcnt(13)
v_mul_f32 v232, v160, v72
v_mul_f32 v160, v160, v64
v_mfma_f32_16x16x32_bf16 v[164:167], v[104:107], v[16:19], 0
ds_read_b64_tr_b16 v[158:159], v231 offset:12288
ds_read_b64_tr_b16 v[150:151], v227 offset:12288
v_mfma_f32_16x16x32_bf16 v[172:175], v[104:107], v[32:35], v[172:175]
ds_read_b64_tr_b16 v[156:157], v231 offset:8192
v_fma_f32 v160, v168, v72, v160
v_mfma_f32_16x16x32_bf16 v[164:167], v[120:123], v[24:27], v[164:167]
s_waitcnt lgkmcnt(11)
ds_read_b64_tr_b16 v[132:133], v226 offset:8192
v_mul_f32 v161, v161, v65
v_mfma_f32_16x16x32_bf16 v[184:187], v[144:147], v[16:19], 0
s_waitcnt lgkmcnt(9)
v_fma_f32 v161, v169, v73, v161
v_fma_f32 v168, v168, v64, -v232
v_mfma_f32_16x16x32_bf16 v[164:167], v[108:111], v[20:23], v[164:167]
v_fma_f32 v169, v169, v65, -v233
v_mul_f32 v233, v163, v75
v_mfma_f32_16x16x32_bf16 v[172:175], v[124:127], v[20:23], v[172:175]
v_mul_f32 v232, v162, v74
v_mul_f32 v162, v162, v66
v_mfma_f32_16x16x32_bf16 v[164:167], v[124:127], v[28:31], v[164:167]
s_waitcnt lgkmcnt(7)
v_mul_f32 v163, v163, v67
v_cvt_pk_bf16_f32 v192, v160, v161
v_mfma_f32_16x16x32_bf16 v[172:175], v[108:111], v[36:39], v[172:175]
v_fma_f32 v162, v170, v74, v162
v_fma_f32 v170, v170, v66, -v232
v_mfma_f32_16x16x32_bf16 v[188:191], v[152:155], v[16:19], 0
s_waitcnt lgkmcnt(2)
v_fma_f32 v163, v171, v75, v163
v_mul_f32 v232, v164, v76
v_mfma_f32_16x16x32_bf16 v[180:183], v[136:139], v[16:19], 0
v_mul_f32 v164, v164, v68
v_fma_f32 v164, v172, v76, v164
v_mfma_f32_16x16x32_bf16 v[184:187], v[128:131], v[32:35], v[184:187]
v_fma_f32 v172, v172, v68, -v232
v_fma_f32 v171, v171, v67, -v233
v_mfma_f32_16x16x32_bf16 v[188:191], v[136:139], v[32:35], v[188:191]
s_waitcnt lgkmcnt(0)
v_mul_f32 v233, v165, v77
v_mul_f32 v165, v165, v69
v_mfma_f32_16x16x32_bf16 v[184:187], v[148:151], v[20:23], v[184:187]
v_fma_f32 v165, v173, v77, v165
v_mul_f32 v232, v166, v78
v_mfma_f32_16x16x32_bf16 v[176:179], v[128:131], v[16:19], 0
v_fma_f32 v173, v173, v69, -v233
v_mul_f32 v166, v166, v70
v_mfma_f32_16x16x32_bf16 v[180:183], v[152:155], v[24:27], v[180:183]
v_mul_f32 v233, v167, v79
v_fma_f32 v166, v174, v78, v166
v_mfma_f32_16x16x32_bf16 v[176:179], v[144:147], v[24:27], v[176:179]
v_cvt_pk_bf16_f32 v196, v168, v169
v_cvt_pk_bf16_f32 v198, v172, v173
v_mfma_f32_16x16x32_bf16 v[188:191], v[156:159], v[20:23], v[188:191]
v_mul_f32 v167, v167, v71
v_cvt_pk_bf16_f32 v193, v162, v163
v_mfma_f32_16x16x32_bf16 v[176:179], v[132:135], v[20:23], v[176:179]
v_cvt_pk_bf16_f32 v194, v164, v165
v_fma_f32 v167, v175, v79, v167
v_mfma_f32_16x16x32_bf16 v[176:179], v[148:151], v[28:31], v[176:179]
v_fma_f32 v175, v175, v71, -v233
v_fma_f32 v174, v174, v70, -v232
v_mfma_f32_16x16x32_bf16 v[188:191], v[140:143], v[36:39], v[188:191]
s_nop 0
v_cvt_pk_bf16_f32 v197, v170, v171
v_cvt_pk_bf16_f32 v195, v166, v167
v_mfma_f32_16x16x32_bf16 v[184:187], v[132:135], v[36:39], v[184:187]
s_nop 0
v_mul_f32 v232, v176, v72
v_mul_f32 v233, v177, v73
v_mfma_f32_16x16x32_bf16 v[164:167], v[44:47], v[192:195], 0
v_cvt_pk_bf16_f32 v199, v174, v175
v_mul_f32 v176, v176, v64
v_mfma_f32_16x16x32_bf16 v[180:183], v[140:143], v[20:23], v[180:183]
s_nop 0
v_fma_f32 v176, v184, v72, v176
v_fma_f32 v184, v184, v64, -v232
v_mfma_f32_16x16x32_bf16 v[164:167], v[52:55], v[196:199], v[164:167]
v_mul_f32 v232, v178, v74
v_mul_f32 v177, v177, v65
v_mfma_f32_16x16x32_bf16 v[168:171], v[40:43], v[196:199], 0
v_mul_f32 v178, v178, v66
v_fma_f32 v177, v185, v73, v177
v_mfma_f32_16x16x32_bf16 v[180:183], v[156:159], v[28:31], v[180:183]
v_fma_f32 v185, v185, v65, -v233
v_lshlrev_b32 v111, 16, v223
v_fma_f32 v178, v186, v74, v178
v_mfma_f32_16x16x32_bf16 v[172:175], v[44:47], v[196:199], 0
v_mul_f32 v233, v179, v75
v_mul_f32 v179, v179, v67
v_mfma_f32_16x16x32_bf16 v[168:171], v[56:59], v[192:195], v[168:171]
v_fma_f32 v179, v187, v75, v179
v_fma_f32 v186, v186, v66, -v232
v_mfma_f32_16x16x32_bf16 v[160:163], v[40:43], v[192:195], 0
v_fma_f32 v187, v187, v67, -v233
v_mul_f32 v233, v181, v77
v_mfma_f32_16x16x32_bf16 v[160:163], v[48:51], v[196:199], v[160:163]
v_cvt_pk_bf16_f32 v200, v176, v177
v_mul_f32 v232, v180, v76
v_mul_f32 v181, v181, v69
v_fma_f32 v181, v189, v77, v181
v_mul_f32 v180, v180, v68
v_fma_f32 v180, v188, v76, v180
v_mfma_f32_16x16x32_bf16 v[172:175], v[60:63], v[192:195], v[172:175]
v_fma_f32 v189, v189, v69, -v233
v_mul_f32 v233, v183, v79
v_lshlrev_b32 v97, 16, v216
v_fma_f32 v188, v188, v68, -v232
v_mul_f32 v183, v183, v71
v_fma_f32 v183, v191, v79, v183
v_cvt_pk_bf16_f32 v205, v186, v187
v_mul_f32 v232, v182, v78
v_mul_f32 v182, v182, v70
v_cvt_pk_bf16_f32 v201, v178, v179
v_fma_f32 v182, v190, v78, v182
v_cvt_pk_bf16_f32 v203, v182, v183
v_cvt_pk_bf16_f32 v202, v180, v181
v_cvt_pk_bf16_f32 v204, v184, v185
v_fma_f32 v190, v190, v70, -v232
v_mfma_f32_16x16x32_bf16 v[176:179], v[40:43], v[200:203], 0
v_lshlrev_b32 v98, 16, v209
v_lshlrev_b32 v99, 16, v217
v_mfma_f32_16x16x32_bf16 v[180:183], v[44:47], v[200:203], 0
v_mul_f32 v232, v160, v97
v_cvt_pk_bf16_f32 v206, v188, v189
v_fma_f32 v191, v191, v71, -v233
v_cvt_pk_bf16_f32 v207, v190, v191
v_lshlrev_b32 v106, 16, v213
v_and_b32 v118, 0xffff0000, v211
v_mfma_f32_16x16x32_bf16 v[188:191], v[44:47], v[204:207], 0
v_mul_f32 v233, v161, v99
v_mul_f32 v161, v161, v98
v_mfma_f32_16x16x32_bf16 v[176:179], v[48:51], v[204:207], v[176:179]
v_lshlrev_b32 v104, 16, v212
v_and_b32 v117, 0xffff0000, v218
v_lshlrev_b32 v96, 16, v208
v_mfma_f32_16x16x32_bf16 v[184:187], v[40:43], v[204:207], 0
v_mul_f32 v160, v160, v96
v_fma_f32 v161, v169, -v99, v161
v_mfma_f32_16x16x32_bf16 v[184:187], v[56:59], v[200:203], v[184:187]
v_fma_f32 v160, v168, -v97, v160
v_fma_f32 v169, v169, v98, v233
v_mfma_f32_16x16x32_bf16 v[188:191], v[60:63], v[200:203], v[188:191]
v_lshlrev_b32 v101, 16, v218
v_lshlrev_b32 v103, 16, v219
v_mfma_f32_16x16x32_bf16 v[180:183], v[52:55], v[204:207], v[180:183]
v_lshlrev_b32 v105, 16, v220
v_lshlrev_b32 v109, 16, v222
v_lshlrev_b32 v100, 16, v210
v_fma_f32 v168, v168, v96, v232
v_mul_f32 v233, v163, v103
v_lshlrev_b32 v102, 16, v211
v_mul_f32 v232, v162, v101
v_mul_f32 v163, v163, v102
v_mul_f32 v162, v162, v100
v_cvt_pk_bf16_f32 v196, v168, v169
v_fma_f32 v162, v170, -v101, v162
v_fma_f32 v163, v171, -v103, v163
v_fma_f32 v171, v171, v102, v233
v_fma_f32 v170, v170, v100, v232
v_and_b32 v126, 0xffff0000, v215
v_cvt_pk_bf16_f32 v193, v162, v163
v_and_b32 v112, 0xffff0000, v208
v_mul_f32 v232, v164, v105
v_mul_f32 v164, v164, v104
v_lshlrev_b32 v107, 16, v221
v_lshlrev_b32 v108, 16, v214
v_mul_f32 v233, v165, v107
v_mul_f32 v165, v165, v106
v_and_b32 v123, 0xffff0000, v221
v_cvt_pk_bf16_f32 v197, v170, v171
v_fma_f32 v164, v172, -v105, v164
v_fma_f32 v172, v172, v104, v232
v_fma_f32 v165, v173, -v107, v165
v_lshlrev_b32 v110, 16, v215
v_mul_f32 v232, v166, v109
v_mul_f32 v166, v166, v108
v_fma_f32 v166, v174, -v109, v166
v_fma_f32 v173, v173, v106, v233
v_mul_f32 v233, v167, v111
v_mul_f32 v167, v167, v110
v_and_b32 v113, 0xffff0000, v216
v_fma_f32 v167, v175, -v111, v167
v_and_b32 v115, 0xffff0000, v217
v_fma_f32 v174, v174, v108, v232
v_fma_f32 v175, v175, v110, v233
v_cvt_pk_bf16_f32 v192, v160, v161
v_cvt_pk_bf16_f32 v199, v174, v175
v_cvt_pk_bf16_f32 v198, v172, v173
v_mul_f32 v232, v176, v113
v_cvt_pk_bf16_f32 v194, v164, v165
v_mfma_f32_16x16x32_bf16 v[172:175], v[196:199], v[44:47], 0
v_mul_f32 v233, v177, v115
v_and_b32 v114, 0xffff0000, v209
v_mfma_f32_16x16x32_bf16 v[168:171], v[196:199], v[40:43], 0
v_cvt_pk_bf16_f32 v195, v166, v167
v_and_b32 v116, 0xffff0000, v210
v_mul_f32 v177, v177, v114
v_mfma_f32_16x16x32_bf16 v[160:163], v[192:195], v[40:43], 0
v_and_b32 v127, 0xffff0000, v223
v_mul_f32 v176, v176, v112
v_fma_f32 v176, v184, -v113, v176
v_mfma_f32_16x16x32_bf16 v[168:171], v[192:195], v[48:51], v[168:171]
v_fma_f32 v177, v185, -v115, v177
v_fma_f32 v184, v184, v112, v232
v_mfma_f32_16x16x32_bf16 v[160:163], v[196:199], v[56:59], v[160:163]
v_fma_f32 v185, v185, v114, v233
v_mul_f32 v232, v178, v117
v_and_b32 v119, 0xffff0000, v219
v_mul_f32 v178, v178, v116
v_and_b32 v125, 0xffff0000, v222
v_mfma_f32_16x16x32_bf16 v[172:175], v[192:195], v[52:55], v[172:175]
v_cvt_pk_bf16_f32 v204, v184, v185
v_mul_f32 v233, v179, v119
v_fma_f32 v178, v186, -v117, v178
v_mul_f32 v179, v179, v118
v_mfma_f32_16x16x32_bf16 v[164:167], v[192:195], v[44:47], 0
v_fma_f32 v179, v187, -v119, v179
v_fma_f32 v186, v186, v116, v232
v_and_b32 v122, 0xffff0000, v213
v_mfma_f32_16x16x32_bf16 v[164:167], v[196:199], v[60:63], v[164:167]
v_and_b32 v120, 0xffff0000, v212
v_and_b32 v121, 0xffff0000, v220
v_mul_f32 v232, v180, v121
v_and_b32 v124, 0xffff0000, v214
v_fma_f32 v187, v187, v118, v233
v_mul_f32 v233, v181, v123
v_cvt_pk_bf16_f32 v205, v186, v187
v_mul_f32 v180, v180, v120
v_mul_f32 v181, v181, v122
v_cvt_pk_bf16_f32 v201, v178, v179
v_fma_f32 v180, v188, -v121, v180
v_fma_f32 v188, v188, v120, v232
v_fma_f32 v181, v189, -v123, v181
v_fma_f32 v189, v189, v122, v233
v_mul_f32 v233, v183, v127
v_mul_f32 v232, v182, v125
v_mul_f32 v182, v182, v124
v_fma_f32 v182, v190, -v125, v182
v_mul_f32 v183, v183, v126
v_fma_f32 v183, v191, -v127, v183
v_cvt_pk_bf16_f32 v206, v188, v189
v_fma_f32 v190, v190, v124, v232
v_fma_f32 v191, v191, v126, v233
v_cvt_pk_bf16_f32 v207, v190, v191
v_cvt_pk_bf16_f32 v203, v182, v183
v_cvt_pk_bf16_f32 v200, v176, v177
v_cvt_pk_bf16_f32 v202, v180, v181
v_mul_f32 v233, v161, v89
v_mfma_f32_16x16x32_bf16 v[184:187], v[204:207], v[40:43], 0
v_mul_f32 v161, v161, v81
v_mul_f32 v232, v160, v88
v_mfma_f32_16x16x32_bf16 v[176:179], v[200:203], v[40:43], 0
v_fma_f32 v161, v169, -v89, v161
v_fma_f32 v169, v169, v81, v233
v_mfma_f32_16x16x32_bf16 v[188:191], v[204:207], v[44:47], 0
v_mul_f32 v160, v160, v80
v_fma_f32 v160, v168, -v88, v160
v_mfma_f32_16x16x32_bf16 v[176:179], v[204:207], v[56:59], v[176:179]
v_fma_f32 v168, v168, v80, v232
v_mul_f32 v233, v163, v91
v_mfma_f32_16x16x32_bf16 v[180:183], v[200:203], v[44:47], 0
v_mul_f32 v163, v163, v83
v_mul_f32 v232, v162, v90
v_fma_f32 v163, v171, -v91, v163
v_mfma_f32_16x16x32_bf16 v[180:183], v[204:207], v[60:63], v[180:183]
v_mul_f32 v162, v162, v82
v_fma_f32 v162, v170, -v90, v162
v_fma_f32 v171, v171, v83, v233
v_mfma_f32_16x16x32_bf16 v[184:187], v[200:203], v[48:51], v[184:187]
v_cvt_pk_bf16_f32 v196, v168, v169
v_mul_f32 v233, v165, v93
v_fma_f32 v170, v170, v82, v232
v_mul_f32 v232, v164, v92
v_mul_f32 v164, v164, v84
v_mul_f32 v165, v165, v85
v_fma_f32 v164, v172, -v92, v164
v_fma_f32 v165, v173, -v93, v165
v_fma_f32 v173, v173, v85, v233
v_fma_f32 v172, v172, v84, v232
v_mul_f32 v233, v167, v95
v_mul_f32 v232, v166, v94
v_mul_f32 v167, v167, v87
v_mul_f32 v166, v166, v86
v_fma_f32 v167, v175, -v95, v167
v_fma_f32 v166, v174, -v94, v166
v_fma_f32 v174, v174, v86, v232
v_mul_f32 v232, v176, v88
v_fma_f32 v175, v175, v87, v233
v_cvt_pk_bf16_f32 v194, v164, v165
v_mul_f32 v233, v177, v89
v_mul_f32 v176, v176, v80
v_mul_f32 v177, v177, v81
v_fma_f32 v176, v184, -v88, v176
v_cvt_pk_bf16_f32 v195, v166, v167
v_fma_f32 v184, v184, v80, v232
v_cvt_pk_bf16_f32 v197, v170, v171
v_mfma_f32_16x16x32_bf16 v[188:191], v[200:203], v[52:55], v[188:191]
ds_write_b64 v234, v[196:197] offset:20480
ds_write_b64 v234, v[194:195] offset:18432
v_cvt_pk_bf16_f32 v199, v174, v175
v_mul_f32 v232, v178, v90
v_mul_f32 v178, v178, v82
v_fma_f32 v177, v185, -v89, v177
v_fma_f32 v185, v185, v81, v233
v_cvt_pk_bf16_f32 v200, v176, v177
v_cvt_pk_bf16_f32 v193, v162, v163
v_fma_f32 v178, v186, -v90, v178
v_fma_f32 v186, v186, v82, v232
v_mul_f32 v233, v179, v91
v_mul_f32 v179, v179, v83
v_cvt_pk_bf16_f32 v204, v184, v185
v_mul_f32 v232, v180, v92
v_cvt_pk_bf16_f32 v192, v160, v161
v_cvt_pk_bf16_f32 v198, v172, v173
v_fma_f32 v179, v187, -v91, v179
v_fma_f32 v187, v187, v83, v233
v_mul_f32 v180, v180, v84
v_cvt_pk_bf16_f32 v205, v186, v187
v_fma_f32 v180, v188, -v92, v180
v_mul_f32 v233, v181, v93
ds_write_b64 v234, v[204:205] offset:28672
ds_write_b64 v234, v[198:199] offset:22528
ds_write_b64 v234, v[192:193] offset:16384
v_mul_f32 v181, v181, v85
v_fma_f32 v181, v189, -v93, v181
v_fma_f32 v189, v189, v85, v233
v_fma_f32 v188, v188, v84, v232
v_cvt_pk_bf16_f32 v202, v180, v181
v_mul_f32 v232, v182, v94
v_mul_f32 v233, v183, v95
v_mul_f32 v182, v182, v86
v_fma_f32 v182, v190, -v94, v182
v_mul_f32 v183, v183, v87
v_fma_f32 v183, v191, -v95, v183
v_cvt_pk_bf16_f32 v201, v178, v179
v_cvt_pk_bf16_f32 v203, v182, v183
s_waitcnt lgkmcnt(0)
ds_write_b64 v234, v[200:201] offset:24576
ds_write_b64 v234, v[202:203] offset:26624
v_fma_f32 v191, v191, v87, v233
v_fma_f32 v190, v190, v86, v232
v_cvt_pk_bf16_f32 v207, v190, v191
v_cvt_pk_bf16_f32 v206, v188, v189
s_waitcnt lgkmcnt(0)
ds_write_b64 v234, v[206:207] offset:30720
s_waitcnt lgkmcnt(0)
s_barrier
ds_read_b128 v[112:115], v0 offset:20480
ds_read_b128 v[96:99], v0 offset:16384
ds_read_b128 v[128:131], v0 offset:24576
ds_read_b128 v[104:107], v0 offset:18432
ds_read_b128 v[100:103], v0 offset:17408
ds_read_b128 v[144:147], v0 offset:28672
ds_read_b128 v[116:119], v0 offset:21504
ds_read_b128 v[120:123], v0 offset:22528
ds_read_b128 v[156:159], v0 offset:31744
s_waitcnt lgkmcnt(8)
v_mfma_f32_16x16x32_bf16 v[168:171], v[112:115], v[16:19], 0
s_waitcnt lgkmcnt(7)
v_mfma_f32_16x16x32_bf16 v[160:163], v[96:99], v[16:19], 0
ds_read_b128 v[124:127], v0 offset:23552
v_mfma_f32_16x16x32_bf16 v[168:171], v[96:99], v[24:27], v[168:171]
s_waitcnt lgkmcnt(7)
ds_read_b128 v[148:151], v0 offset:29696
v_mfma_f32_16x16x32_bf16 v[160:163], v[112:115], v[32:35], v[160:163]
v_mfma_f32_16x16x32_bf16 v[176:179], v[128:131], v[16:19], 0
s_waitcnt lgkmcnt(7)
ds_read_b128 v[152:155], v0 offset:30720
v_mfma_f32_16x16x32_bf16 v[164:167], v[104:107], v[16:19], 0
s_waitcnt lgkmcnt(6)
s_waitcnt lgkmcnt(5)
v_mfma_f32_16x16x32_bf16 v[184:187], v[144:147], v[16:19], 0
ds_read_b128 v[108:111], v0 offset:19456
v_mfma_f32_16x16x32_bf16 v[168:171], v[116:119], v[20:23], v[168:171]
v_mfma_f32_16x16x32_bf16 v[160:163], v[100:103], v[20:23], v[160:163]
ds_read_b128 v[140:143], v0 offset:27648
s_waitcnt lgkmcnt(4)
v_mfma_f32_16x16x32_bf16 v[168:171], v[100:103], v[28:31], v[168:171]
ds_read_b128 v[132:135], v0 offset:25600
v_mfma_f32_16x16x32_bf16 v[164:167], v[120:123], v[32:35], v[164:167]
v_mfma_f32_16x16x32_bf16 v[160:163], v[116:119], v[36:39], v[160:163]
s_nop 0
s_waitcnt lgkmcnt(2)
v_mfma_f32_16x16x32_bf16 v[172:175], v[120:123], v[16:19], 0
s_nop 0
ds_read_b128 v[136:139], v0 offset:26624
s_nop 0
v_mfma_f32_16x16x32_bf16 v[172:175], v[104:107], v[24:27], v[172:175]
s_nop 0
v_cvt_pk_bf16_f32 v192, v160, v161
v_mfma_f32_16x16x32_bf16 v[172:175], v[124:127], v[20:23], v[172:175]
v_mfma_f32_16x16x32_bf16 v[172:175], v[108:111], v[28:31], v[172:175]
v_mfma_f32_16x16x32_bf16 v[164:167], v[108:111], v[20:23], v[164:167]
s_waitcnt lgkmcnt(1)
v_cvt_pk_bf16_f32 v193, v162, v163
v_cvt_pk_bf16_f32 v197, v170, v171
v_mfma_f32_16x16x32_bf16 v[164:167], v[124:127], v[36:39], v[164:167]
v_mfma_f32_16x16x32_bf16 v[176:179], v[144:147], v[32:35], v[176:179]
v_cvt_pk_bf16_f32 v196, v168, v169
v_mfma_f32_16x16x32_bf16 v[176:179], v[132:135], v[20:23], v[176:179]
s_waitcnt lgkmcnt(0)
v_mfma_f32_16x16x32_bf16 v[176:179], v[148:151], v[36:39], v[176:179]
s_nop 1
v_mfma_f32_16x16x32_bf16 v[184:187], v[128:131], v[24:27], v[184:187]
s_nop 0
v_cvt_pk_bf16_f32 v195, v166, v167
s_nop 0
v_mfma_f32_16x16x32_bf16 v[180:183], v[136:139], v[16:19], 0
s_nop 0
v_cvt_pk_bf16_f32 v201, v178, v179
v_mfma_f32_16x16x32_bf16 v[180:183], v[152:155], v[32:35], v[180:183]
v_cvt_pk_bf16_f32 v199, v174, v175
v_mfma_f32_16x16x32_bf16 v[180:183], v[140:143], v[20:23], v[180:183]
v_cvt_pk_bf16_f32 v200, v176, v177
v_mfma_f32_16x16x32_bf16 v[180:183], v[156:159], v[36:39], v[180:183]
v_cvt_pk_bf16_f32 v198, v172, v173
v_mfma_f32_16x16x32_bf16 v[184:187], v[148:151], v[20:23], v[184:187]
s_nop 2
v_mfma_f32_16x16x32_bf16 v[184:187], v[132:135], v[28:31], v[184:187]
s_nop 0
v_cvt_pk_bf16_f32 v194, v164, v165
v_cvt_pk_bf16_f32 v203, v182, v183
v_mfma_f32_16x16x32_bf16 v[188:191], v[152:155], v[16:19], 0
v_cvt_pk_bf16_f32 v202, v180, v181
v_mfma_f32_16x16x32_bf16 v[188:191], v[136:139], v[24:27], v[188:191]
buffer_store_dwordx4 v[192:195], v235, s[4:7], s27 offen offset:0 sc1
v_mfma_f32_16x16x32_bf16 v[188:191], v[156:159], v[20:23], v[188:191]
v_cvt_pk_bf16_f32 v205, v186, v187
v_cvt_pk_bf16_f32 v204, v184, v185
v_mfma_f32_16x16x32_bf16 v[188:191], v[140:143], v[28:31], v[188:191]
buffer_store_dwordx4 v[196:199], v235, s[4:7], s27 offen offset:64 sc1
s_nop 2
buffer_store_dwordx4 v[200:203], v235, s[4:7], s27 offen offset:128 sc1
s_nop 2
v_cvt_pk_bf16_f32 v207, v190, v191
v_cvt_pk_bf16_f32 v206, v188, v189
buffer_store_dwordx4 v[204:207], v235, s[4:7], s27 offen offset:192 sc1
s_lshl_b32 s18, s39, 7
s_add_u32 s18, s18, 11591680
s_add_u32 s29, s16, 1
s_cmp_eq_u32 s13, 0
s_cselect_b32 s22, s18, s6
s_mov_b32 s23, s29
s_lshl_b32 s18, s34, 7
s_lshl_b32 s19, s13, 5
s_add_u32 s18, s18, s19
s_mov_b32 s19, 0x3acccccd
v_bfe_u32 v222, v0, 4, 5
v_lshrrev_b32 v217, 9, v0
v_and_b32 v220, 19, v222
v_bfe_u32 v223, v222, 2, 1
v_lshl_add_u32 v220, v223, 3, v220
v_bfe_u32 v223, v222, 3, 1
v_lshl_add_u32 v220, v223, 2, v220
v_add_u32 v220, s18, v220
v_lshlrev_b32 v217, 2, v217
v_mov_b32 v221, 0
v_mad_u32_u24 v221, v217, v220, v221
v_mad_u32_u24 v216, v220, 8, 0
v_cvt_f32_u32 v216, v216
v_mul_f32 v222, s19, v216
v_rndne_f32 v222, v222
v_fmac_f32 v216, 0xc4200000, v222
v_mul_f32 v216, s19, v216
v_cos_f32 v216, v216
s_nop 0
v_add_f32 v216, v216, v216
v_mad_u32_u24 v218, v220, 1, 0
v_cvt_f32_u32 v218, v218
v_mul_f32 v222, s19, v218
v_rndne_f32 v222, v222
v_fmac_f32 v218, 0xc4200000, v222
v_mul_f32 v218, s19, v218
v_cos_f32 v218, v218
s_nop 0
v_add_f32 v218, v218, v218
v_mad_u32_u24 v200, v220, 1, v221
v_cvt_f32_u32 v200, v200
v_mul_f32 v222, s19, v200
v_rndne_f32 v222, v222
v_fmac_f32 v200, 0xc4200000, v222
v_mul_f32 v200, s19, v200
v_sin_f32 v201, -v200
v_cos_f32 v200, v200
v_mad_u32_u24 v202, v220, 2, v221
v_cvt_f32_u32 v202, v202
v_mul_f32 v222, s19, v202
v_rndne_f32 v222, v222
v_fmac_f32 v202, 0xc4200000, v222
v_mul_f32 v202, s19, v202
v_sin_f32 v203, -v202
v_cos_f32 v202, v202
s_nop 0
v_pk_fma_f32 v[204:205], v[218:219], v[202:203], v[200:201] op_sel_hi:[0,1,1] neg_lo:[0,0,1] neg_hi:[0,0,1]
v_pk_fma_f32 v[206:207], v[218:219], v[204:205], v[202:203] op_sel_hi:[0,1,1] neg_lo:[0,0,1] neg_hi:[0,0,1]
v_cvt_pk_bf16_f32 v16, v200, v201
v_cvt_pk_bf16_f32 v17, v202, v203
v_cvt_pk_bf16_f32 v18, v204, v205
v_cvt_pk_bf16_f32 v19, v206, v207
v_mad_u32_u24 v208, v220, 9, v221
v_cvt_f32_u32 v208, v208
v_mul_f32 v222, s19, v208
v_rndne_f32 v222, v222
v_fmac_f32 v208, 0xc4200000, v222
v_mul_f32 v208, s19, v208
v_sin_f32 v209, -v208
v_cos_f32 v208, v208
v_mad_u32_u24 v210, v220, 10, v221
v_cvt_f32_u32 v210, v210
v_mul_f32 v222, s19, v210
v_rndne_f32 v222, v222
v_fmac_f32 v210, 0xc4200000, v222
v_mul_f32 v210, s19, v210
v_sin_f32 v211, -v210
v_cos_f32 v210, v210
s_nop 0
v_pk_fma_f32 v[212:213], v[218:219], v[210:211], v[208:209] op_sel_hi:[0,1,1] neg_lo:[0,0,1] neg_hi:[0,0,1]
v_pk_fma_f32 v[214:215], v[218:219], v[212:213], v[210:211] op_sel_hi:[0,1,1] neg_lo:[0,0,1] neg_hi:[0,0,1]
v_cvt_pk_bf16_f32 v20, v208, v209
v_cvt_pk_bf16_f32 v21, v210, v211
v_cvt_pk_bf16_f32 v22, v212, v213
v_cvt_pk_bf16_f32 v23, v214, v215
v_pk_fma_f32 v[200:201], v[216:217], v[208:209], v[200:201] op_sel_hi:[0,1,1] neg_lo:[0,0,1] neg_hi:[0,0,1]
v_pk_fma_f32 v[202:203], v[216:217], v[210:211], v[202:203] op_sel_hi:[0,1,1] neg_lo:[0,0,1] neg_hi:[0,0,1]
v_pk_fma_f32 v[204:205], v[216:217], v[212:213], v[204:205] op_sel_hi:[0,1,1] neg_lo:[0,0,1] neg_hi:[0,0,1]
v_pk_fma_f32 v[206:207], v[216:217], v[214:215], v[206:207] op_sel_hi:[0,1,1] neg_lo:[0,0,1] neg_hi:[0,0,1]
v_cvt_pk_bf16_f32 v24, v200, v201
v_cvt_pk_bf16_f32 v25, v202, v203
v_cvt_pk_bf16_f32 v26, v204, v205
v_cvt_pk_bf16_f32 v27, v206, v207
v_pk_fma_f32 v[208:209], v[216:217], v[200:201], v[208:209] op_sel_hi:[0,1,1] neg_lo:[0,0,1] neg_hi:[0,0,1]
v_pk_fma_f32 v[210:211], v[216:217], v[202:203], v[210:211] op_sel_hi:[0,1,1] neg_lo:[0,0,1] neg_hi:[0,0,1]
v_pk_fma_f32 v[212:213], v[216:217], v[204:205], v[212:213] op_sel_hi:[0,1,1] neg_lo:[0,0,1] neg_hi:[0,0,1]
v_pk_fma_f32 v[214:215], v[216:217], v[206:207], v[214:215] op_sel_hi:[0,1,1] neg_lo:[0,0,1] neg_hi:[0,0,1]
v_cvt_pk_bf16_f32 v28, v208, v209
v_cvt_pk_bf16_f32 v29, v210, v211
v_cvt_pk_bf16_f32 v30, v212, v213
v_cvt_pk_bf16_f32 v31, v214, v215
v_pk_fma_f32 v[200:201], v[216:217], v[208:209], v[200:201] op_sel_hi:[0,1,1] neg_lo:[0,0,1] neg_hi:[0,0,1]
v_pk_fma_f32 v[202:203], v[216:217], v[210:211], v[202:203] op_sel_hi:[0,1,1] neg_lo:[0,0,1] neg_hi:[0,0,1]
v_pk_fma_f32 v[204:205], v[216:217], v[212:213], v[204:205] op_sel_hi:[0,1,1] neg_lo:[0,0,1] neg_hi:[0,0,1]
v_pk_fma_f32 v[206:207], v[216:217], v[214:215], v[206:207] op_sel_hi:[0,1,1] neg_lo:[0,0,1] neg_hi:[0,0,1]
v_cvt_pk_bf16_f32 v32, v200, v201
v_cvt_pk_bf16_f32 v33, v202, v203
v_cvt_pk_bf16_f32 v34, v204, v205
v_cvt_pk_bf16_f32 v35, v206, v207
v_pk_fma_f32 v[208:209], v[216:217], v[200:201], v[208:209] op_sel_hi:[0,1,1] neg_lo:[0,0,1] neg_hi:[0,0,1]
v_pk_fma_f32 v[210:211], v[216:217], v[202:203], v[210:211] op_sel_hi:[0,1,1] neg_lo:[0,0,1] neg_hi:[0,0,1]
v_pk_fma_f32 v[212:213], v[216:217], v[204:205], v[212:213] op_sel_hi:[0,1,1] neg_lo:[0,0,1] neg_hi:[0,0,1]
v_pk_fma_f32 v[214:215], v[216:217], v[206:207], v[214:215] op_sel_hi:[0,1,1] neg_lo:[0,0,1] neg_hi:[0,0,1]
v_cvt_pk_bf16_f32 v36, v208, v209
v_cvt_pk_bf16_f32 v37, v210, v211
v_cvt_pk_bf16_f32 v38, v212, v213
v_cvt_pk_bf16_f32 v39, v214, v215
v_pk_fma_f32 v[200:201], v[216:217], v[208:209], v[200:201] op_sel_hi:[0,1,1] neg_lo:[0,0,1] neg_hi:[0,0,1]
v_pk_fma_f32 v[202:203], v[216:217], v[210:211], v[202:203] op_sel_hi:[0,1,1] neg_lo:[0,0,1] neg_hi:[0,0,1]
v_pk_fma_f32 v[204:205], v[216:217], v[212:213], v[204:205] op_sel_hi:[0,1,1] neg_lo:[0,0,1] neg_hi:[0,0,1]
v_pk_fma_f32 v[206:207], v[216:217], v[214:215], v[206:207] op_sel_hi:[0,1,1] neg_lo:[0,0,1] neg_hi:[0,0,1]
v_cvt_pk_bf16_f32 v40, v200, v201
v_cvt_pk_bf16_f32 v41, v202, v203
v_cvt_pk_bf16_f32 v42, v204, v205
v_cvt_pk_bf16_f32 v43, v206, v207
v_pk_fma_f32 v[208:209], v[216:217], v[200:201], v[208:209] op_sel_hi:[0,1,1] neg_lo:[0,0,1] neg_hi:[0,0,1]
v_pk_fma_f32 v[210:211], v[216:217], v[202:203], v[210:211] op_sel_hi:[0,1,1] neg_lo:[0,0,1] neg_hi:[0,0,1]
v_pk_fma_f32 v[212:213], v[216:217], v[204:205], v[212:213] op_sel_hi:[0,1,1] neg_lo:[0,0,1] neg_hi:[0,0,1]
v_pk_fma_f32 v[214:215], v[216:217], v[206:207], v[214:215] op_sel_hi:[0,1,1] neg_lo:[0,0,1] neg_hi:[0,0,1]
v_cvt_pk_bf16_f32 v44, v208, v209
v_cvt_pk_bf16_f32 v45, v210, v211
v_cvt_pk_bf16_f32 v46, v212, v213
v_cvt_pk_bf16_f32 v47, v214, v215
v_pk_fma_f32 v[200:201], v[216:217], v[208:209], v[200:201] op_sel_hi:[0,1,1] neg_lo:[0,0,1] neg_hi:[0,0,1]
v_pk_fma_f32 v[202:203], v[216:217], v[210:211], v[202:203] op_sel_hi:[0,1,1] neg_lo:[0,0,1] neg_hi:[0,0,1]
v_pk_fma_f32 v[204:205], v[216:217], v[212:213], v[204:205] op_sel_hi:[0,1,1] neg_lo:[0,0,1] neg_hi:[0,0,1]
v_pk_fma_f32 v[206:207], v[216:217], v[214:215], v[206:207] op_sel_hi:[0,1,1] neg_lo:[0,0,1] neg_hi:[0,0,1]
v_cvt_pk_bf16_f32 v48, v200, v201
v_cvt_pk_bf16_f32 v49, v202, v203
v_cvt_pk_bf16_f32 v50, v204, v205
v_cvt_pk_bf16_f32 v51, v206, v207
v_pk_fma_f32 v[208:209], v[216:217], v[200:201], v[208:209] op_sel_hi:[0,1,1] neg_lo:[0,0,1] neg_hi:[0,0,1]
v_pk_fma_f32 v[210:211], v[216:217], v[202:203], v[210:211] op_sel_hi:[0,1,1] neg_lo:[0,0,1] neg_hi:[0,0,1]
v_pk_fma_f32 v[212:213], v[216:217], v[204:205], v[212:213] op_sel_hi:[0,1,1] neg_lo:[0,0,1] neg_hi:[0,0,1]
v_pk_fma_f32 v[214:215], v[216:217], v[206:207], v[214:215] op_sel_hi:[0,1,1] neg_lo:[0,0,1] neg_hi:[0,0,1]
v_cvt_pk_bf16_f32 v52, v208, v209
v_cvt_pk_bf16_f32 v53, v210, v211
v_cvt_pk_bf16_f32 v54, v212, v213
v_cvt_pk_bf16_f32 v55, v214, v215
v_pk_fma_f32 v[200:201], v[216:217], v[208:209], v[200:201] op_sel_hi:[0,1,1] neg_lo:[0,0,1] neg_hi:[0,0,1]
v_pk_fma_f32 v[202:203], v[216:217], v[210:211], v[202:203] op_sel_hi:[0,1,1] neg_lo:[0,0,1] neg_hi:[0,0,1]
v_pk_fma_f32 v[204:205], v[216:217], v[212:213], v[204:205] op_sel_hi:[0,1,1] neg_lo:[0,0,1] neg_hi:[0,0,1]
v_pk_fma_f32 v[206:207], v[216:217], v[214:215], v[206:207] op_sel_hi:[0,1,1] neg_lo:[0,0,1] neg_hi:[0,0,1]
v_cvt_pk_bf16_f32 v56, v200, v201
v_cvt_pk_bf16_f32 v57, v202, v203
v_cvt_pk_bf16_f32 v58, v204, v205
v_cvt_pk_bf16_f32 v59, v206, v207
v_pk_fma_f32 v[208:209], v[216:217], v[200:201], v[208:209] op_sel_hi:[0,1,1] neg_lo:[0,0,1] neg_hi:[0,0,1]
v_pk_fma_f32 v[210:211], v[216:217], v[202:203], v[210:211] op_sel_hi:[0,1,1] neg_lo:[0,0,1] neg_hi:[0,0,1]
v_pk_fma_f32 v[212:213], v[216:217], v[204:205], v[212:213] op_sel_hi:[0,1,1] neg_lo:[0,0,1] neg_hi:[0,0,1]
v_pk_fma_f32 v[214:215], v[216:217], v[206:207], v[214:215] op_sel_hi:[0,1,1] neg_lo:[0,0,1] neg_hi:[0,0,1]
v_cvt_pk_bf16_f32 v60, v208, v209
v_cvt_pk_bf16_f32 v61, v210, v211
v_cvt_pk_bf16_f32 v62, v212, v213
v_cvt_pk_bf16_f32 v63, v214, v215
v_pk_fma_f32 v[200:201], v[216:217], v[208:209], v[200:201] op_sel_hi:[0,1,1] neg_lo:[0,0,1] neg_hi:[0,0,1]
v_pk_fma_f32 v[202:203], v[216:217], v[210:211], v[202:203] op_sel_hi:[0,1,1] neg_lo:[0,0,1] neg_hi:[0,0,1]
v_pk_fma_f32 v[204:205], v[216:217], v[212:213], v[204:205] op_sel_hi:[0,1,1] neg_lo:[0,0,1] neg_hi:[0,0,1]
v_pk_fma_f32 v[206:207], v[216:217], v[214:215], v[206:207] op_sel_hi:[0,1,1] neg_lo:[0,0,1] neg_hi:[0,0,1]
v_cvt_pk_bf16_f32 v64, v200, v201
v_cvt_pk_bf16_f32 v65, v202, v203
v_cvt_pk_bf16_f32 v66, v204, v205
v_cvt_pk_bf16_f32 v67, v206, v207
s_waitcnt vmcnt(0)
s_barrier
v_mov_b32 v3, s23
s_mov_b64 exec, 1
buffer_store_dword v3, off, s[4:7], s22 sc1
s_mov_b64 exec, -1
s_mov_b32 s22, s6
v_pk_fma_f32 v[208:209], v[216:217], v[200:201], v[208:209] op_sel_hi:[0,1,1] neg_lo:[0,0,1] neg_hi:[0,0,1]
v_pk_fma_f32 v[210:211], v[216:217], v[202:203], v[210:211] op_sel_hi:[0,1,1] neg_lo:[0,0,1] neg_hi:[0,0,1]
v_pk_fma_f32 v[212:213], v[216:217], v[204:205], v[212:213] op_sel_hi:[0,1,1] neg_lo:[0,0,1] neg_hi:[0,0,1]
v_pk_fma_f32 v[214:215], v[216:217], v[206:207], v[214:215] op_sel_hi:[0,1,1] neg_lo:[0,0,1] neg_hi:[0,0,1]
v_cvt_pk_bf16_f32 v68, v208, v209
v_cvt_pk_bf16_f32 v69, v210, v211
v_cvt_pk_bf16_f32 v70, v212, v213
v_cvt_pk_bf16_f32 v71, v214, v215
v_pk_fma_f32 v[200:201], v[216:217], v[208:209], v[200:201] op_sel_hi:[0,1,1] neg_lo:[0,0,1] neg_hi:[0,0,1]
v_pk_fma_f32 v[202:203], v[216:217], v[210:211], v[202:203] op_sel_hi:[0,1,1] neg_lo:[0,0,1] neg_hi:[0,0,1]
v_pk_fma_f32 v[204:205], v[216:217], v[212:213], v[204:205] op_sel_hi:[0,1,1] neg_lo:[0,0,1] neg_hi:[0,0,1]
v_pk_fma_f32 v[206:207], v[216:217], v[214:215], v[206:207] op_sel_hi:[0,1,1] neg_lo:[0,0,1] neg_hi:[0,0,1]
v_cvt_pk_bf16_f32 v72, v200, v201
v_cvt_pk_bf16_f32 v73, v202, v203
v_cvt_pk_bf16_f32 v74, v204, v205
v_cvt_pk_bf16_f32 v75, v206, v207
v_pk_fma_f32 v[208:209], v[216:217], v[200:201], v[208:209] op_sel_hi:[0,1,1] neg_lo:[0,0,1] neg_hi:[0,0,1]
v_pk_fma_f32 v[210:211], v[216:217], v[202:203], v[210:211] op_sel_hi:[0,1,1] neg_lo:[0,0,1] neg_hi:[0,0,1]
v_pk_fma_f32 v[212:213], v[216:217], v[204:205], v[212:213] op_sel_hi:[0,1,1] neg_lo:[0,0,1] neg_hi:[0,0,1]
v_pk_fma_f32 v[214:215], v[216:217], v[206:207], v[214:215] op_sel_hi:[0,1,1] neg_lo:[0,0,1] neg_hi:[0,0,1]
v_cvt_pk_bf16_f32 v76, v208, v209
v_cvt_pk_bf16_f32 v77, v210, v211
v_cvt_pk_bf16_f32 v78, v212, v213
v_cvt_pk_bf16_f32 v79, v214, v215
v_pk_fma_f32 v[200:201], v[216:217], v[208:209], v[200:201] op_sel_hi:[0,1,1] neg_lo:[0,0,1] neg_hi:[0,0,1]
v_pk_fma_f32 v[202:203], v[216:217], v[210:211], v[202:203] op_sel_hi:[0,1,1] neg_lo:[0,0,1] neg_hi:[0,0,1]
v_pk_fma_f32 v[204:205], v[216:217], v[212:213], v[204:205] op_sel_hi:[0,1,1] neg_lo:[0,0,1] neg_hi:[0,0,1]
v_pk_fma_f32 v[206:207], v[216:217], v[214:215], v[206:207] op_sel_hi:[0,1,1] neg_lo:[0,0,1] neg_hi:[0,0,1]
v_cvt_pk_bf16_f32 v80, v200, v201
v_cvt_pk_bf16_f32 v81, v202, v203
v_cvt_pk_bf16_f32 v82, v204, v205
v_cvt_pk_bf16_f32 v83, v206, v207
v_pk_fma_f32 v[208:209], v[216:217], v[200:201], v[208:209] op_sel_hi:[0,1,1] neg_lo:[0,0,1] neg_hi:[0,0,1]
v_pk_fma_f32 v[210:211], v[216:217], v[202:203], v[210:211] op_sel_hi:[0,1,1] neg_lo:[0,0,1] neg_hi:[0,0,1]
v_pk_fma_f32 v[212:213], v[216:217], v[204:205], v[212:213] op_sel_hi:[0,1,1] neg_lo:[0,0,1] neg_hi:[0,0,1]
v_pk_fma_f32 v[214:215], v[216:217], v[206:207], v[214:215] op_sel_hi:[0,1,1] neg_lo:[0,0,1] neg_hi:[0,0,1]
v_cvt_pk_bf16_f32 v84, v208, v209
v_cvt_pk_bf16_f32 v85, v210, v211
v_cvt_pk_bf16_f32 v86, v212, v213
v_cvt_pk_bf16_f32 v87, v214, v215
v_pk_fma_f32 v[200:201], v[216:217], v[208:209], v[200:201] op_sel_hi:[0,1,1] neg_lo:[0,0,1] neg_hi:[0,0,1]
v_pk_fma_f32 v[202:203], v[216:217], v[210:211], v[202:203] op_sel_hi:[0,1,1] neg_lo:[0,0,1] neg_hi:[0,0,1]
v_pk_fma_f32 v[204:205], v[216:217], v[212:213], v[204:205] op_sel_hi:[0,1,1] neg_lo:[0,0,1] neg_hi:[0,0,1]
v_pk_fma_f32 v[206:207], v[216:217], v[214:215], v[206:207] op_sel_hi:[0,1,1] neg_lo:[0,0,1] neg_hi:[0,0,1]
v_cvt_pk_bf16_f32 v88, v200, v201
v_cvt_pk_bf16_f32 v89, v202, v203
v_cvt_pk_bf16_f32 v90, v204, v205
v_cvt_pk_bf16_f32 v91, v206, v207
v_pk_fma_f32 v[208:209], v[216:217], v[200:201], v[208:209] op_sel_hi:[0,1,1] neg_lo:[0,0,1] neg_hi:[0,0,1]
v_pk_fma_f32 v[210:211], v[216:217], v[202:203], v[210:211] op_sel_hi:[0,1,1] neg_lo:[0,0,1] neg_hi:[0,0,1]
v_pk_fma_f32 v[212:213], v[216:217], v[204:205], v[212:213] op_sel_hi:[0,1,1] neg_lo:[0,0,1] neg_hi:[0,0,1]
v_pk_fma_f32 v[214:215], v[216:217], v[206:207], v[214:215] op_sel_hi:[0,1,1] neg_lo:[0,0,1] neg_hi:[0,0,1]
v_cvt_pk_bf16_f32 v92, v208, v209
v_cvt_pk_bf16_f32 v93, v210, v211
v_cvt_pk_bf16_f32 v94, v212, v213
v_cvt_pk_bf16_f32 v95, v214, v215
s_mov_b32 s20, 161
v_mad_u32_u24 v200, v220, s20, v221
v_cvt_f32_u32 v200, v200
v_mul_f32 v222, s19, v200
v_rndne_f32 v222, v222
v_fmac_f32 v200, 0xc4200000, v222
v_mul_f32 v200, s19, v200
v_sin_f32 v201, -v200
v_cos_f32 v200, v200
s_mov_b32 s20, 162
v_mad_u32_u24 v202, v220, s20, v221
v_cvt_f32_u32 v202, v202
v_mul_f32 v222, s19, v202
v_rndne_f32 v222, v222
v_fmac_f32 v202, 0xc4200000, v222
v_mul_f32 v202, s19, v202
v_sin_f32 v203, -v202
v_cos_f32 v202, v202
s_nop 0
v_pk_fma_f32 v[204:205], v[218:219], v[202:203], v[200:201] op_sel_hi:[0,1,1] neg_lo:[0,0,1] neg_hi:[0,0,1]
v_pk_fma_f32 v[206:207], v[218:219], v[204:205], v[202:203] op_sel_hi:[0,1,1] neg_lo:[0,0,1] neg_hi:[0,0,1]
v_cvt_pk_bf16_f32 v96, v200, v201
v_cvt_pk_bf16_f32 v97, v202, v203
v_cvt_pk_bf16_f32 v98, v204, v205
v_cvt_pk_bf16_f32 v99, v206, v207
s_mov_b32 s20, 169
v_mad_u32_u24 v208, v220, s20, v221
v_cvt_f32_u32 v208, v208
v_mul_f32 v222, s19, v208
v_rndne_f32 v222, v222
v_fmac_f32 v208, 0xc4200000, v222
v_mul_f32 v208, s19, v208
v_sin_f32 v209, -v208
v_cos_f32 v208, v208
s_mov_b32 s20, 170
v_mad_u32_u24 v210, v220, s20, v221
v_cvt_f32_u32 v210, v210
v_mul_f32 v222, s19, v210
v_rndne_f32 v222, v222
v_fmac_f32 v210, 0xc4200000, v222
v_mul_f32 v210, s19, v210
v_sin_f32 v211, -v210
v_cos_f32 v210, v210
s_nop 0
v_pk_fma_f32 v[212:213], v[218:219], v[210:211], v[208:209] op_sel_hi:[0,1,1] neg_lo:[0,0,1] neg_hi:[0,0,1]
v_pk_fma_f32 v[214:215], v[218:219], v[212:213], v[210:211] op_sel_hi:[0,1,1] neg_lo:[0,0,1] neg_hi:[0,0,1]
v_cvt_pk_bf16_f32 v100, v208, v209
v_cvt_pk_bf16_f32 v101, v210, v211
v_cvt_pk_bf16_f32 v102, v212, v213
v_cvt_pk_bf16_f32 v103, v214, v215
v_pk_fma_f32 v[200:201], v[216:217], v[208:209], v[200:201] op_sel_hi:[0,1,1] neg_lo:[0,0,1] neg_hi:[0,0,1]
v_pk_fma_f32 v[202:203], v[216:217], v[210:211], v[202:203] op_sel_hi:[0,1,1] neg_lo:[0,0,1] neg_hi:[0,0,1]
v_pk_fma_f32 v[204:205], v[216:217], v[212:213], v[204:205] op_sel_hi:[0,1,1] neg_lo:[0,0,1] neg_hi:[0,0,1]
v_pk_fma_f32 v[206:207], v[216:217], v[214:215], v[206:207] op_sel_hi:[0,1,1] neg_lo:[0,0,1] neg_hi:[0,0,1]
v_cvt_pk_bf16_f32 v104, v200, v201
v_cvt_pk_bf16_f32 v105, v202, v203
v_cvt_pk_bf16_f32 v106, v204, v205
v_cvt_pk_bf16_f32 v107, v206, v207
v_pk_fma_f32 v[208:209], v[216:217], v[200:201], v[208:209] op_sel_hi:[0,1,1] neg_lo:[0,0,1] neg_hi:[0,0,1]
v_pk_fma_f32 v[210:211], v[216:217], v[202:203], v[210:211] op_sel_hi:[0,1,1] neg_lo:[0,0,1] neg_hi:[0,0,1]
v_pk_fma_f32 v[212:213], v[216:217], v[204:205], v[212:213] op_sel_hi:[0,1,1] neg_lo:[0,0,1] neg_hi:[0,0,1]
v_pk_fma_f32 v[214:215], v[216:217], v[206:207], v[214:215] op_sel_hi:[0,1,1] neg_lo:[0,0,1] neg_hi:[0,0,1]
v_cvt_pk_bf16_f32 v108, v208, v209
v_cvt_pk_bf16_f32 v109, v210, v211
v_cvt_pk_bf16_f32 v110, v212, v213
v_cvt_pk_bf16_f32 v111, v214, v215
v_pk_fma_f32 v[200:201], v[216:217], v[208:209], v[200:201] op_sel_hi:[0,1,1] neg_lo:[0,0,1] neg_hi:[0,0,1]
v_pk_fma_f32 v[202:203], v[216:217], v[210:211], v[202:203] op_sel_hi:[0,1,1] neg_lo:[0,0,1] neg_hi:[0,0,1]
v_pk_fma_f32 v[204:205], v[216:217], v[212:213], v[204:205] op_sel_hi:[0,1,1] neg_lo:[0,0,1] neg_hi:[0,0,1]
v_pk_fma_f32 v[206:207], v[216:217], v[214:215], v[206:207] op_sel_hi:[0,1,1] neg_lo:[0,0,1] neg_hi:[0,0,1]
v_cvt_pk_bf16_f32 v112, v200, v201
v_cvt_pk_bf16_f32 v113, v202, v203
v_cvt_pk_bf16_f32 v114, v204, v205
v_cvt_pk_bf16_f32 v115, v206, v207
v_pk_fma_f32 v[208:209], v[216:217], v[200:201], v[208:209] op_sel_hi:[0,1,1] neg_lo:[0,0,1] neg_hi:[0,0,1]
v_pk_fma_f32 v[210:211], v[216:217], v[202:203], v[210:211] op_sel_hi:[0,1,1] neg_lo:[0,0,1] neg_hi:[0,0,1]
v_pk_fma_f32 v[212:213], v[216:217], v[204:205], v[212:213] op_sel_hi:[0,1,1] neg_lo:[0,0,1] neg_hi:[0,0,1]
v_pk_fma_f32 v[214:215], v[216:217], v[206:207], v[214:215] op_sel_hi:[0,1,1] neg_lo:[0,0,1] neg_hi:[0,0,1]
v_cvt_pk_bf16_f32 v116, v208, v209
v_cvt_pk_bf16_f32 v117, v210, v211
v_cvt_pk_bf16_f32 v118, v212, v213
v_cvt_pk_bf16_f32 v119, v214, v215
v_pk_fma_f32 v[200:201], v[216:217], v[208:209], v[200:201] op_sel_hi:[0,1,1] neg_lo:[0,0,1] neg_hi:[0,0,1]
v_pk_fma_f32 v[202:203], v[216:217], v[210:211], v[202:203] op_sel_hi:[0,1,1] neg_lo:[0,0,1] neg_hi:[0,0,1]
v_pk_fma_f32 v[204:205], v[216:217], v[212:213], v[204:205] op_sel_hi:[0,1,1] neg_lo:[0,0,1] neg_hi:[0,0,1]
v_pk_fma_f32 v[206:207], v[216:217], v[214:215], v[206:207] op_sel_hi:[0,1,1] neg_lo:[0,0,1] neg_hi:[0,0,1]
v_cvt_pk_bf16_f32 v120, v200, v201
v_cvt_pk_bf16_f32 v121, v202, v203
v_cvt_pk_bf16_f32 v122, v204, v205
v_cvt_pk_bf16_f32 v123, v206, v207
v_pk_fma_f32 v[208:209], v[216:217], v[200:201], v[208:209] op_sel_hi:[0,1,1] neg_lo:[0,0,1] neg_hi:[0,0,1]
v_pk_fma_f32 v[210:211], v[216:217], v[202:203], v[210:211] op_sel_hi:[0,1,1] neg_lo:[0,0,1] neg_hi:[0,0,1]
v_pk_fma_f32 v[212:213], v[216:217], v[204:205], v[212:213] op_sel_hi:[0,1,1] neg_lo:[0,0,1] neg_hi:[0,0,1]
v_pk_fma_f32 v[214:215], v[216:217], v[206:207], v[214:215] op_sel_hi:[0,1,1] neg_lo:[0,0,1] neg_hi:[0,0,1]
v_cvt_pk_bf16_f32 v124, v208, v209
v_cvt_pk_bf16_f32 v125, v210, v211
v_cvt_pk_bf16_f32 v126, v212, v213
v_cvt_pk_bf16_f32 v127, v214, v215
v_pk_fma_f32 v[200:201], v[216:217], v[208:209], v[200:201] op_sel_hi:[0,1,1] neg_lo:[0,0,1] neg_hi:[0,0,1]
v_pk_fma_f32 v[202:203], v[216:217], v[210:211], v[202:203] op_sel_hi:[0,1,1] neg_lo:[0,0,1] neg_hi:[0,0,1]
v_pk_fma_f32 v[204:205], v[216:217], v[212:213], v[204:205] op_sel_hi:[0,1,1] neg_lo:[0,0,1] neg_hi:[0,0,1]
v_pk_fma_f32 v[206:207], v[216:217], v[214:215], v[206:207] op_sel_hi:[0,1,1] neg_lo:[0,0,1] neg_hi:[0,0,1]
v_cvt_pk_bf16_f32 v128, v200, v201
v_cvt_pk_bf16_f32 v129, v202, v203
v_cvt_pk_bf16_f32 v130, v204, v205
v_cvt_pk_bf16_f32 v131, v206, v207
v_pk_fma_f32 v[208:209], v[216:217], v[200:201], v[208:209] op_sel_hi:[0,1,1] neg_lo:[0,0,1] neg_hi:[0,0,1]
v_pk_fma_f32 v[210:211], v[216:217], v[202:203], v[210:211] op_sel_hi:[0,1,1] neg_lo:[0,0,1] neg_hi:[0,0,1]
v_pk_fma_f32 v[212:213], v[216:217], v[204:205], v[212:213] op_sel_hi:[0,1,1] neg_lo:[0,0,1] neg_hi:[0,0,1]
v_pk_fma_f32 v[214:215], v[216:217], v[206:207], v[214:215] op_sel_hi:[0,1,1] neg_lo:[0,0,1] neg_hi:[0,0,1]
v_cvt_pk_bf16_f32 v132, v208, v209
v_cvt_pk_bf16_f32 v133, v210, v211
v_cvt_pk_bf16_f32 v134, v212, v213
v_cvt_pk_bf16_f32 v135, v214, v215
v_pk_fma_f32 v[200:201], v[216:217], v[208:209], v[200:201] op_sel_hi:[0,1,1] neg_lo:[0,0,1] neg_hi:[0,0,1]
v_pk_fma_f32 v[202:203], v[216:217], v[210:211], v[202:203] op_sel_hi:[0,1,1] neg_lo:[0,0,1] neg_hi:[0,0,1]
v_pk_fma_f32 v[204:205], v[216:217], v[212:213], v[204:205] op_sel_hi:[0,1,1] neg_lo:[0,0,1] neg_hi:[0,0,1]
v_pk_fma_f32 v[206:207], v[216:217], v[214:215], v[206:207] op_sel_hi:[0,1,1] neg_lo:[0,0,1] neg_hi:[0,0,1]
v_cvt_pk_bf16_f32 v136, v200, v201
v_cvt_pk_bf16_f32 v137, v202, v203
v_cvt_pk_bf16_f32 v138, v204, v205
v_cvt_pk_bf16_f32 v139, v206, v207
v_pk_fma_f32 v[208:209], v[216:217], v[200:201], v[208:209] op_sel_hi:[0,1,1] neg_lo:[0,0,1] neg_hi:[0,0,1]
v_pk_fma_f32 v[210:211], v[216:217], v[202:203], v[210:211] op_sel_hi:[0,1,1] neg_lo:[0,0,1] neg_hi:[0,0,1]
v_pk_fma_f32 v[212:213], v[216:217], v[204:205], v[212:213] op_sel_hi:[0,1,1] neg_lo:[0,0,1] neg_hi:[0,0,1]
v_pk_fma_f32 v[214:215], v[216:217], v[206:207], v[214:215] op_sel_hi:[0,1,1] neg_lo:[0,0,1] neg_hi:[0,0,1]
v_cvt_pk_bf16_f32 v140, v208, v209
v_cvt_pk_bf16_f32 v141, v210, v211
v_cvt_pk_bf16_f32 v142, v212, v213
v_cvt_pk_bf16_f32 v143, v214, v215
v_pk_fma_f32 v[200:201], v[216:217], v[208:209], v[200:201] op_sel_hi:[0,1,1] neg_lo:[0,0,1] neg_hi:[0,0,1]
v_pk_fma_f32 v[202:203], v[216:217], v[210:211], v[202:203] op_sel_hi:[0,1,1] neg_lo:[0,0,1] neg_hi:[0,0,1]
v_pk_fma_f32 v[204:205], v[216:217], v[212:213], v[204:205] op_sel_hi:[0,1,1] neg_lo:[0,0,1] neg_hi:[0,0,1]
v_pk_fma_f32 v[206:207], v[216:217], v[214:215], v[206:207] op_sel_hi:[0,1,1] neg_lo:[0,0,1] neg_hi:[0,0,1]
v_cvt_pk_bf16_f32 v144, v200, v201
v_cvt_pk_bf16_f32 v145, v202, v203
v_cvt_pk_bf16_f32 v146, v204, v205
v_cvt_pk_bf16_f32 v147, v206, v207
v_pk_fma_f32 v[208:209], v[216:217], v[200:201], v[208:209] op_sel_hi:[0,1,1] neg_lo:[0,0,1] neg_hi:[0,0,1]
v_pk_fma_f32 v[210:211], v[216:217], v[202:203], v[210:211] op_sel_hi:[0,1,1] neg_lo:[0,0,1] neg_hi:[0,0,1]
v_pk_fma_f32 v[212:213], v[216:217], v[204:205], v[212:213] op_sel_hi:[0,1,1] neg_lo:[0,0,1] neg_hi:[0,0,1]
v_pk_fma_f32 v[214:215], v[216:217], v[206:207], v[214:215] op_sel_hi:[0,1,1] neg_lo:[0,0,1] neg_hi:[0,0,1]
v_cvt_pk_bf16_f32 v148, v208, v209
v_cvt_pk_bf16_f32 v149, v210, v211
v_cvt_pk_bf16_f32 v150, v212, v213
v_cvt_pk_bf16_f32 v151, v214, v215
v_pk_fma_f32 v[200:201], v[216:217], v[208:209], v[200:201] op_sel_hi:[0,1,1] neg_lo:[0,0,1] neg_hi:[0,0,1]
v_pk_fma_f32 v[202:203], v[216:217], v[210:211], v[202:203] op_sel_hi:[0,1,1] neg_lo:[0,0,1] neg_hi:[0,0,1]
v_pk_fma_f32 v[204:205], v[216:217], v[212:213], v[204:205] op_sel_hi:[0,1,1] neg_lo:[0,0,1] neg_hi:[0,0,1]
v_pk_fma_f32 v[206:207], v[216:217], v[214:215], v[206:207] op_sel_hi:[0,1,1] neg_lo:[0,0,1] neg_hi:[0,0,1]
v_cvt_pk_bf16_f32 v152, v200, v201
v_cvt_pk_bf16_f32 v153, v202, v203
v_cvt_pk_bf16_f32 v154, v204, v205
v_cvt_pk_bf16_f32 v155, v206, v207
v_pk_fma_f32 v[208:209], v[216:217], v[200:201], v[208:209] op_sel_hi:[0,1,1] neg_lo:[0,0,1] neg_hi:[0,0,1]
v_pk_fma_f32 v[210:211], v[216:217], v[202:203], v[210:211] op_sel_hi:[0,1,1] neg_lo:[0,0,1] neg_hi:[0,0,1]
v_pk_fma_f32 v[212:213], v[216:217], v[204:205], v[212:213] op_sel_hi:[0,1,1] neg_lo:[0,0,1] neg_hi:[0,0,1]
v_pk_fma_f32 v[214:215], v[216:217], v[206:207], v[214:215] op_sel_hi:[0,1,1] neg_lo:[0,0,1] neg_hi:[0,0,1]
v_cvt_pk_bf16_f32 v156, v208, v209
v_cvt_pk_bf16_f32 v157, v210, v211
v_cvt_pk_bf16_f32 v158, v212, v213
v_cvt_pk_bf16_f32 v159, v214, v215
v_pk_fma_f32 v[200:201], v[216:217], v[208:209], v[200:201] op_sel_hi:[0,1,1] neg_lo:[0,0,1] neg_hi:[0,0,1]
v_pk_fma_f32 v[202:203], v[216:217], v[210:211], v[202:203] op_sel_hi:[0,1,1] neg_lo:[0,0,1] neg_hi:[0,0,1]
v_pk_fma_f32 v[204:205], v[216:217], v[212:213], v[204:205] op_sel_hi:[0,1,1] neg_lo:[0,0,1] neg_hi:[0,0,1]
v_pk_fma_f32 v[206:207], v[216:217], v[214:215], v[206:207] op_sel_hi:[0,1,1] neg_lo:[0,0,1] neg_hi:[0,0,1]
v_cvt_pk_bf16_f32 v160, v200, v201
v_cvt_pk_bf16_f32 v161, v202, v203
v_cvt_pk_bf16_f32 v162, v204, v205
v_cvt_pk_bf16_f32 v163, v206, v207
v_pk_fma_f32 v[208:209], v[216:217], v[200:201], v[208:209] op_sel_hi:[0,1,1] neg_lo:[0,0,1] neg_hi:[0,0,1]
v_pk_fma_f32 v[210:211], v[216:217], v[202:203], v[210:211] op_sel_hi:[0,1,1] neg_lo:[0,0,1] neg_hi:[0,0,1]
v_pk_fma_f32 v[212:213], v[216:217], v[204:205], v[212:213] op_sel_hi:[0,1,1] neg_lo:[0,0,1] neg_hi:[0,0,1]
v_pk_fma_f32 v[214:215], v[216:217], v[206:207], v[214:215] op_sel_hi:[0,1,1] neg_lo:[0,0,1] neg_hi:[0,0,1]
v_cvt_pk_bf16_f32 v164, v208, v209
v_cvt_pk_bf16_f32 v165, v210, v211
v_cvt_pk_bf16_f32 v166, v212, v213
v_cvt_pk_bf16_f32 v167, v214, v215
v_pk_fma_f32 v[200:201], v[216:217], v[208:209], v[200:201] op_sel_hi:[0,1,1] neg_lo:[0,0,1] neg_hi:[0,0,1]
v_pk_fma_f32 v[202:203], v[216:217], v[210:211], v[202:203] op_sel_hi:[0,1,1] neg_lo:[0,0,1] neg_hi:[0,0,1]
v_pk_fma_f32 v[204:205], v[216:217], v[212:213], v[204:205] op_sel_hi:[0,1,1] neg_lo:[0,0,1] neg_hi:[0,0,1]
v_pk_fma_f32 v[206:207], v[216:217], v[214:215], v[206:207] op_sel_hi:[0,1,1] neg_lo:[0,0,1] neg_hi:[0,0,1]
v_cvt_pk_bf16_f32 v168, v200, v201
v_cvt_pk_bf16_f32 v169, v202, v203
v_cvt_pk_bf16_f32 v170, v204, v205
v_cvt_pk_bf16_f32 v171, v206, v207
v_pk_fma_f32 v[208:209], v[216:217], v[200:201], v[208:209] op_sel_hi:[0,1,1] neg_lo:[0,0,1] neg_hi:[0,0,1]
v_pk_fma_f32 v[210:211], v[216:217], v[202:203], v[210:211] op_sel_hi:[0,1,1] neg_lo:[0,0,1] neg_hi:[0,0,1]
v_pk_fma_f32 v[212:213], v[216:217], v[204:205], v[212:213] op_sel_hi:[0,1,1] neg_lo:[0,0,1] neg_hi:[0,0,1]
v_pk_fma_f32 v[214:215], v[216:217], v[206:207], v[214:215] op_sel_hi:[0,1,1] neg_lo:[0,0,1] neg_hi:[0,0,1]
s_mov_b32 exec_lo, 0
v_mul_f32 v214, 0.5, v214
s_mov_b32 exec_lo, -1
v_cvt_pk_bf16_f32 v172, v208, v209
v_cvt_pk_bf16_f32 v173, v210, v211
v_cvt_pk_bf16_f32 v174, v212, v213
v_cvt_pk_bf16_f32 v175, v214, v215
v_and_b32 v1, 0x2f0, v0
v_bfe_u32 v3, v0, 8, 1
v_lshl_add_u32 v1, v3, 3, v1
s_mul_i32 s18, s50, 40960
s_mul_i32 s19, s16, 3145728
s_add_u32 s26, s18, s19
s_add_u32 s27, s26, s19
s_add_u32 s27, s27, s33
s_add_u32 s27, s27, 88080384
s_add_u32 s26, s26, s31
s_add_u32 s26, s26, 103809024
s_lshl_b32 s19, s16, 6
s_add_u32 s19, s19, s50
s_mul_i32 s19, s19, 5120
s_lshr_b32 s36, s33, 3
s_add_u32 s36, s36, s19
s_add_u32 s36, s36, 163577856
s_mov_b32 s43, 0x20000
s_cmp_lg_u32 s16, 0
s_cbranch_scc1 rs_56
s_mov_b64 s[40:41], s[44:45]
s_mov_b32 s42, s46
s_lshr_b32 s51, s33, 5
s_add_u32 s51, s51, s18
s_add_u32 s52, s51, 32
v_mov_b32 v13, v5
s_branch rs_57
rs_56:
s_mov_b64 s[40:41], s[4:5]
s_mov_b32 s42, s6
s_sub_u32 s51, s27, 3145728
s_add_u32 s52, s51, 1024
v_mov_b32 v13, v0
rs_57:
s_cmp_lg_u32 s13, 0
s_cbranch_scc1 polld_59
v_lshlrev_b32 v3, 3, v0
v_min_u32 v12, 3968, v3
s_mov_b32 s21, 11591680
s_mov_b32 s17, 0
poll_58:
buffer_load_dword v8, v3, s[4:7], s21 offen sc1
s_add_u32 s20, s21, 8192
buffer_load_dword v9, v3, s[4:7], s20 offen sc1
s_add_u32 s20, s21, 16384
buffer_load_dword v10, v12, s[4:7], s20 offen sc1
s_add_u32 s17, s17, 1
s_cmp_gt_u32 s17, 262144
s_cbranch_scc1 L_fail
s_waitcnt vmcnt(1)
v_min_u32 v8, v8, v9
s_waitcnt vmcnt(0)
v_min_u32 v8, v8, v10
v_cmp_gt_u32 vcc, s29, v8
s_cbranch_vccz polld_59
s_sleep 2
s_branch poll_58
polld_59:
s_barrier
s_add_u32 m0, s31, 2048
s_add_u32 s20, s26, 0
buffer_load_dwordx4 v0, s[4:7], s20 offen sc1 lds
s_add_u32 m0, s31, 3072
s_add_u32 s20, s26, 1024
buffer_load_dwordx4 v0, s[4:7], s20 offen sc1 lds
s_add_u32 m0, s31, 4096
s_add_u32 s20, s26, 2048
buffer_load_dwordx4 v0, s[4:7], s20 offen sc1 lds
s_add_u32 m0, s31, 5120
s_add_u32 s20, s26, 3072
buffer_load_dwordx4 v0, s[4:7], s20 offen sc1 lds
s_add_u32 m0, s31, 6144
s_add_u32 s20, s26, 4096
buffer_load_dwordx4 v0, s[4:7], s20 offen sc1 lds
s_add_u32 m0, s31, 7168
s_add_u32 s20, s26, 5120
buffer_load_dwordx4 v0, s[4:7], s20 offen sc1 lds
s_add_u32 m0, s31, 8192
s_add_u32 s20, s26, 6144
buffer_load_dwordx4 v0, s[4:7], s20 offen sc1 lds
s_add_u32 m0, s31, 9216
s_add_u32 s20, s26, 7168
buffer_load_dwordx4 v0, s[4:7], s20 offen sc1 lds
s_add_u32 m0, s31, 10240
s_add_u32 s20, s26, 8192
buffer_load_dwordx4 v0, s[4:7], s20 offen sc1 lds
s_add_u32 m0, s31, 11264
s_add_u32 s20, s26, 9216
buffer_load_dwordx4 v0, s[4:7], s20 offen sc1 lds
s_add_u32 s26, s26, 1310720
s_add_u32 s25, s31, 40960
s_mov_b32 s28, 0
s_waitcnt vmcnt(0)
p3_60:
s_barrier
ds_read_b64_tr_b16 v[216:217], v1 offset:2048
ds_read_b64_tr_b16 v[218:219], v1 offset:2304
ds_read_b64_tr_b16 v[222:223], v1 offset:3328
ds_read_b64_tr_b16 v[220:221], v1 offset:3072
buffer_load_dwordx4 v[176:179], v13, s[40:43], s51 offen sc1
ds_read_b64_tr_b16 v[224:225], v1 offset:4096
buffer_load_dwordx4 v[180:183], v13, s[40:43], s52 offen sc1
ds_read_b64_tr_b16 v[230:231], v1 offset:5376
ds_read_b64_tr_b16 v[226:227], v1 offset:4352
s_add_u32 m0, s25, 2048
s_add_u32 s20, s26, 0
buffer_load_dwordx4 v0, s[4:7], s20 offen sc1 lds
s_waitcnt lgkmcnt(5)
v_mfma_f32_32x32x16_bf16 v[200:215], v[16:19], v[216:219], 0
s_waitcnt lgkmcnt(4)
ds_read_b64_tr_b16 v[228:229], v1 offset:5120
ds_read_b64_tr_b16 v[218:219], v1 offset:6400
s_add_u32 m0, s25, 3072
s_add_u32 s20, s26, 1024
buffer_load_dwordx4 v0, s[4:7], s20 offen sc1 lds
s_waitcnt lgkmcnt(4)
v_mfma_f32_32x32x16_bf16 v[200:215], v[20:23], v[220:223], v[200:215]
s_add_u32 m0, s25, 4096
s_add_u32 s20, s26, 2048
buffer_load_dwordx4 v0, s[4:7], s20 offen sc1 lds
ds_read_b64_tr_b16 v[216:217], v1 offset:6144
s_waitcnt lgkmcnt(3)
ds_read_b64_tr_b16 v[222:223], v1 offset:7424
v_mfma_f32_32x32x16_bf16 v[200:215], v[24:27], v[224:227], v[200:215]
s_waitcnt lgkmcnt(3)
ds_read_b64_tr_b16 v[220:221], v1 offset:7168
ds_read_b64_tr_b16 v[224:225], v1 offset:8192
s_waitcnt lgkmcnt(4)
v_mfma_f32_32x32x16_bf16 v[200:215], v[28:31], v[228:231], v[200:215]
s_add_u32 m0, s25, 5120
s_add_u32 s20, s26, 3072
buffer_load_dwordx4 v0, s[4:7], s20 offen sc1 lds
s_waitcnt lgkmcnt(3)
ds_read_b64_tr_b16 v[226:227], v1 offset:8448
ds_read_b64_tr_b16 v[230:231], v1 offset:9472
ds_read_b64_tr_b16 v[228:229], v1 offset:9216
v_mfma_f32_32x32x16_bf16 v[200:215], v[32:35], v[216:219], v[200:215]
ds_read_b64_tr_b16 v[216:217], v1 offset:10240
s_waitcnt lgkmcnt(5)
v_mfma_f32_32x32x16_bf16 v[200:215], v[36:39], v[220:223], v[200:215]
ds_read_b64_tr_b16 v[220:221], v1 offset:11264
s_waitcnt lgkmcnt(4)
ds_read_b64_tr_b16 v[218:219], v1 offset:10496
v_mfma_f32_32x32x16_bf16 v[200:215], v[40:43], v[224:227], v[200:215]
ds_read_b64_tr_b16 v[222:223], v1 offset:11520
ds_read_b64_tr_b16 v[224:225], v1 offset:12288
s_waitcnt lgkmcnt(5)
v_mfma_f32_32x32x16_bf16 v[200:215], v[44:47], v[228:231], v[200:215]
ds_read_b64_tr_b16 v[228:229], v1 offset:13312
ds_read_b64_tr_b16 v[226:227], v1 offset:12544
s_waitcnt lgkmcnt(6)
s_waitcnt lgkmcnt(4)
ds_read_b64_tr_b16 v[230:231], v1 offset:13568
v_mfma_f32_32x32x16_bf16 v[200:215], v[48:51], v[216:219], v[200:215]
ds_read_b64_tr_b16 v[218:219], v1 offset:14592
s_add_u32 m0, s25, 6144
s_add_u32 s20, s26, 4096
buffer_load_dwordx4 v0, s[4:7], s20 offen sc1 lds
s_waitcnt lgkmcnt(5)
ds_read_b64_tr_b16 v[216:217], v1 offset:14336
v_mfma_f32_32x32x16_bf16 v[200:215], v[52:55], v[220:223], v[200:215]
ds_read_b64_tr_b16 v[222:223], v1 offset:15616
s_waitcnt lgkmcnt(4)
s_add_u32 m0, s25, 7168
s_add_u32 s20, s26, 5120
buffer_load_dwordx4 v0, s[4:7], s20 offen sc1 lds
ds_read_b64_tr_b16 v[220:221], v1 offset:15360
v_mfma_f32_32x32x16_bf16 v[200:215], v[56:59], v[224:227], v[200:215]
s_waitcnt lgkmcnt(4)
ds_read_b64_tr_b16 v[226:227], v1 offset:16640
ds_read_b64_tr_b16 v[224:225], v1 offset:16384
s_waitcnt lgkmcnt(5)
s_waitcnt lgkmcnt(4)
v_mfma_f32_32x32x16_bf16 v[200:215], v[60:63], v[228:231], v[200:215]
v_mfma_f32_32x32x16_bf16 v[200:215], v[64:67], v[216:219], v[200:215]
s_waitcnt lgkmcnt(2)
ds_read_b64_tr_b16 v[218:219], v1 offset:18688
s_waitcnt lgkmcnt(1)
ds_read_b64_tr_b16 v[230:231], v1 offset:17664
ds_read_b64_tr_b16 v[228:229], v1 offset:17408
ds_read_b64_tr_b16 v[216:217], v1 offset:18432
v_mfma_f32_32x32x16_bf16 v[200:215], v[68:71], v[220:223], v[200:215]
v_mfma_f32_32x32x16_bf16 v[200:215], v[72:75], v[224:227], v[200:215]
s_waitcnt lgkmcnt(3)
ds_read_b64_tr_b16 v[224:225], v1 offset:20480
ds_read_b64_tr_b16 v[226:227], v1 offset:20736
ds_read_b64_tr_b16 v[222:223], v1 offset:19712
s_waitcnt lgkmcnt(4)
ds_read_b64_tr_b16 v[220:221], v1 offset:19456
v_mfma_f32_32x32x16_bf16 v[200:215], v[76:79], v[228:231], v[200:215]
ds_read_b64_tr_b16 v[230:231], v1 offset:21760
s_waitcnt lgkmcnt(5)
ds_read_b64_tr_b16 v[228:229], v1 offset:21504
v_mfma_f32_32x32x16_bf16 v[200:215], v[80:83], v[216:219], v[200:215]
ds_read_b64_tr_b16 v[218:219], v1 offset:22784
s_waitcnt lgkmcnt(3)
ds_read_b64_tr_b16 v[216:217], v1 offset:22528
v_mfma_f32_32x32x16_bf16 v[200:215], v[84:87], v[220:223], v[200:215]
ds_read_b64_tr_b16 v[220:221], v1 offset:23552
s_waitcnt lgkmcnt(4)
ds_read_b64_tr_b16 v[222:223], v1 offset:23808
v_mfma_f32_32x32x16_bf16 v[200:215], v[88:91], v[224:227], v[200:215]
s_add_u32 m0, s25, 8192
s_add_u32 s20, s26, 6144
buffer_load_dwordx4 v0, s[4:7], s20 offen sc1 lds
s_waitcnt lgkmcnt(2)
ds_read_b64_tr_b16 v[224:225], v1 offset:24576
ds_read_b64_tr_b16 v[226:227], v1 offset:24832
v_mfma_f32_32x32x16_bf16 v[200:215], v[92:95], v[228:231], v[200:215]
s_waitcnt lgkmcnt(3)
ds_read_b64_tr_b16 v[230:231], v1 offset:25856
s_waitcnt lgkmcnt(3)
v_mfma_f32_32x32x16_bf16 v[200:215], v[96:99], v[216:219], v[200:215]
s_waitcnt lgkmcnt(2)
ds_read_b64_tr_b16 v[228:229], v1 offset:25600
ds_read_b64_tr_b16 v[218:219], v1 offset:26880
v_mfma_f32_32x32x16_bf16 v[200:215], v[100:103], v[220:223], v[200:215]
ds_read_b64_tr_b16 v[216:217], v1 offset:26624
ds_read_b64_tr_b16 v[222:223], v1 offset:27904
ds_read_b64_tr_b16 v[220:221], v1 offset:27648
s_waitcnt lgkmcnt(6)
v_mfma_f32_32x32x16_bf16 v[200:215], v[104:107], v[224:227], v[200:215]
s_waitcnt lgkmcnt(4)
ds_read_b64_tr_b16 v[224:225], v1 offset:28672
ds_read_b64_tr_b16 v[226:227], v1 offset:28928
s_waitcnt lgkmcnt(5)
v_mfma_f32_32x32x16_bf16 v[200:215], v[108:111], v[228:231], v[200:215]
ds_read_b64_tr_b16 v[228:229], v1 offset:29696
s_waitcnt lgkmcnt(5)
v_mfma_f32_32x32x16_bf16 v[200:215], v[112:115], v[216:219], v[200:215]
s_waitcnt lgkmcnt(4)
s_waitcnt lgkmcnt(1)
ds_read_b64_tr_b16 v[218:219], v1 offset:30976
ds_read_b64_tr_b16 v[230:231], v1 offset:29952
v_mfma_f32_32x32x16_bf16 v[200:215], v[116:119], v[220:223], v[200:215]
s_add_u32 m0, s25, 9216
s_add_u32 s20, s26, 7168
buffer_load_dwordx4 v0, s[4:7], s20 offen sc1 lds
ds_read_b64_tr_b16 v[216:217], v1 offset:30720
ds_read_b64_tr_b16 v[220:221], v1 offset:31744
s_waitcnt lgkmcnt(4)
v_mfma_f32_32x32x16_bf16 v[200:215], v[120:123], v[224:227], v[200:215]
ds_read_b64_tr_b16 v[226:227], v1 offset:33024
ds_read_b64_tr_b16 v[222:223], v1 offset:32000
ds_read_b64_tr_b16 v[224:225], v1 offset:32768
s_waitcnt lgkmcnt(5)
v_lshrrev_b32 v2, 2, v0
v_mfma_f32_32x32x16_bf16 v[200:215], v[124:127], v[228:231], v[200:215]
s_add_u32 m0, s25, 10240
s_add_u32 s20, s26, 8192
buffer_load_dwordx4 v0, s[4:7], s20 offen sc1 lds
s_waitcnt lgkmcnt(4)
ds_read_b64_tr_b16 v[228:229], v1 offset:33792
s_waitcnt lgkmcnt(4)
v_mfma_f32_32x32x16_bf16 v[200:215], v[128:131], v[216:219], v[200:215]
s_waitcnt lgkmcnt(3)
s_waitcnt lgkmcnt(2)
ds_read_b64_tr_b16 v[230:231], v1 offset:34048
ds_read_b64_tr_b16 v[216:217], v1 offset:34816
ds_read_b64_tr_b16 v[218:219], v1 offset:35072
v_mfma_f32_32x32x16_bf16 v[200:215], v[132:135], v[220:223], v[200:215]
s_waitcnt vmcnt(10)
s_waitcnt lgkmcnt(4)
ds_read_b64_tr_b16 v[220:221], v1 offset:35840
s_add_u32 m0, s25, 11264
s_add_u32 s20, s26, 9216
buffer_load_dwordx4 v0, s[4:7], s20 offen sc1 lds
v_mfma_f32_32x32x16_bf16 v[200:215], v[136:139], v[224:227], v[200:215]
ds_read_b64_tr_b16 v[222:223], v1 offset:36096
ds_read_b64_tr_b16 v[226:227], v1 offset:37120
v_and_b32 v187, 0xffff0000, v177
s_waitcnt lgkmcnt(5)
v_lshlrev_b32 v184, 16, v176
s_waitcnt vmcnt(10)
v_mfma_f32_32x32x16_bf16 v[200:215], v[140:143], v[228:231], v[200:215]
s_waitcnt lgkmcnt(3)
ds_read_b64_tr_b16 v[230:231], v1 offset:38144
ds_read_b64_tr_b16 v[224:225], v1 offset:36864
s_waitcnt lgkmcnt(4)
ds_read_b64_tr_b16 v[228:229], v1 offset:37888
v_mfma_f32_32x32x16_bf16 v[200:215], v[144:147], v[216:219], v[200:215]
s_waitcnt lgkmcnt(3)
ds_read_b64_tr_b16 v[218:219], v1 offset:39168
ds_read_b64_tr_b16 v[216:217], v1 offset:38912
v_and_b32 v199, 0xffff0000, v183
v_mfma_f32_32x32x16_bf16 v[200:215], v[148:151], v[220:223], v[200:215]
s_waitcnt lgkmcnt(4)
s_waitcnt lgkmcnt(3)
s_waitcnt lgkmcnt(2)
v_lshlrev_b32 v198, 16, v183
v_and_b32 v189, 0xffff0000, v178
v_and_b32 v197, 0xffff0000, v182
v_mfma_f32_32x32x16_bf16 v[200:215], v[152:155], v[224:227], v[200:215]
ds_read_b64_tr_b16 v[220:221], v1 offset:39936
s_waitcnt lgkmcnt(2)
ds_read_b64_tr_b16 v[224:225], v1 offset:40960
ds_read_b64_tr_b16 v[222:223], v1 offset:40192
v_mfma_f32_32x32x16_bf16 v[200:215], v[156:159], v[228:231], v[200:215]
s_waitcnt lgkmcnt(3)
ds_read_b64_tr_b16 v[230:231], v1 offset:42240
ds_read_b64_tr_b16 v[226:227], v1 offset:41216
v_mfma_f32_32x32x16_bf16 v[200:215], v[160:163], v[216:219], v[200:215]
ds_read_b64_tr_b16 v[228:229], v1 offset:41984
s_waitcnt lgkmcnt(3)
v_and_b32 v193, 0xffff0000, v180
v_lshlrev_b32 v186, 16, v177
v_and_b32 v191, 0xffff0000, v179
v_mfma_f32_32x32x16_bf16 v[200:215], v[164:167], v[220:223], v[200:215]
s_waitcnt lgkmcnt(1)
v_lshlrev_b32 v196, 16, v182
v_mfma_f32_32x32x16_bf16 v[200:215], v[168:171], v[224:227], v[200:215]
v_lshlrev_b32 v188, 16, v178
s_waitcnt lgkmcnt(0)
v_lshlrev_b32 v194, 16, v181
v_mfma_f32_32x32x16_bf16 v[200:215], v[172:175], v[228:231], v[200:215]
s_nop 0
v_lshlrev_b32 v190, 16, v179
v_lshlrev_b32 v192, 16, v180
v_and_b32 v185, 0xffff0000, v176
v_and_b32 v195, 0xffff0000, v181
v_mov_b32 v176, 0x3b4ccccd
s_nop 5
v_pk_fma_f32 v[200:201], v[200:201], v[176:177], v[184:185] op_sel_hi:[1,0,1]
v_pk_fma_f32 v[202:203], v[202:203], v[176:177], v[186:187] op_sel_hi:[1,0,1]
v_pk_fma_f32 v[204:205], v[204:205], v[176:177], v[188:189] op_sel_hi:[1,0,1]
v_pk_mul_f32 v[180:181], v[200:201], v[200:201]
v_pk_fma_f32 v[206:207], v[206:207], v[176:177], v[190:191] op_sel_hi:[1,0,1]
v_pk_add_f32 v[178:179], v[200:201], v[202:203]
v_pk_fma_f32 v[208:209], v[208:209], v[176:177], v[192:193] op_sel_hi:[1,0,1]
v_pk_add_f32 v[178:179], v[178:179], v[204:205]
v_pk_add_f32 v[178:179], v[178:179], v[206:207]
v_pk_fma_f32 v[180:181], v[202:203], v[202:203], v[180:181]
v_pk_fma_f32 v[180:181], v[204:205], v[204:205], v[180:181]
v_pk_fma_f32 v[210:211], v[210:211], v[176:177], v[194:195] op_sel_hi:[1,0,1]
v_pk_fma_f32 v[180:181], v[206:207], v[206:207], v[180:181]
v_pk_add_f32 v[178:179], v[178:179], v[208:209]
v_pk_fma_f32 v[180:181], v[208:209], v[208:209], v[180:181]
v_pk_add_f32 v[178:179], v[178:179], v[210:211]
v_pk_fma_f32 v[180:181], v[210:211], v[210:211], v[180:181]
v_pk_fma_f32 v[214:215], v[214:215], v[176:177], v[198:199] op_sel_hi:[1,0,1]
v_pk_fma_f32 v[212:213], v[212:213], v[176:177], v[196:197] op_sel_hi:[1,0,1]
v_pk_add_f32 v[178:179], v[178:179], v[212:213]
v_pk_add_f32 v[178:179], v[178:179], v[214:215]
v_pk_fma_f32 v[180:181], v[212:213], v[212:213], v[180:181]
v_add_f32 v178, v178, v179
v_pk_fma_f32 v[180:181], v[214:215], v[214:215], v[180:181]
v_add_f32 v180, v180, v181
v_cvt_pk_bf16_f32 v220, v208, v209
v_cvt_pk_bf16_f32 v221, v210, v211
v_permlane32_swap_b32 v178, v180
v_cvt_pk_bf16_f32 v223, v214, v215
v_cvt_pk_bf16_f32 v222, v212, v213
v_cvt_pk_bf16_f32 v219, v206, v207
v_cvt_pk_bf16_f32 v216, v200, v201
v_cvt_pk_bf16_f32 v218, v204, v205
v_add_f32 v178, v178, v180
v_cvt_pk_bf16_f32 v217, v202, v203
buffer_store_dwordx4 v[216:219], v0, s[4:7], s27 offen offset:0 sc1
buffer_store_dwordx4 v[220:223], v0, s[4:7], s27 offen offset:1024 sc1
buffer_store_dword v178, v2, s[4:7], s36 offen sc1
v_xor_b32 v1, 40960, v1
s_mov_b32 s26, s6
s_mov_b32 s25, s31
s_add_u32 s27, s27, 1310720
s_add_u32 s36, s36, 163840
s_add_u32 s51, s51, 1310720
s_add_u32 s52, s52, 1310720
s_add_u32 s28, s28, 1
s_lshl_b32 s18, s39, 7
s_add_u32 s18, s18, 11612160
s_lshl_b32 s19, s16, 1
s_add_u32 s19, s19, s28
s_cmp_eq_u32 s13, 0
s_cselect_b32 s22, s18, s6
s_mov_b32 s23, s19
s_waitcnt vmcnt(0)
s_barrier
v_mov_b32 v3, s23
s_mov_b64 exec, 1
buffer_store_dword v3, off, s[4:7], s22 sc1
s_mov_b64 exec, -1
s_mov_b32 s22, s6
s_cmp_lt_u32 s28, 2
s_cbranch_scc1 p3_60
s_cmp_ge_u32 s39, 144
s_cbranch_scc1 p1b_62
s_cmp_ge_u32 s39, 64
s_cbranch_scc1 wo_61
s_and_b32 s32, s39, 31
s_cmp_lg_u32 s16, 0
s_cbranch_scc1 qw_64
s_lshl_b32 s26, s32, 8
s_lshl_b32 s18, s13, 6
s_add_u32 s26, s26, s18
s_load_dwordx2 s[40:41], s[0:1], 40
s_mov_b32 s42, 5242880
s_mov_b32 s43, 0x20000
s_waitcnt lgkmcnt(0)
v_lshrrev_b32 v34, 6, v0
v_mul_u32_u24 v34, 8192, v34
v_and_b32 v35, 48, v0
v_add_u32 v32, v34, v35
v_bfe_u32 v34, v0, 6, 2
v_lshrrev_b32 v35, 9, v0
v_lshl_add_u32 v34, v35, 3, v34
v_lshlrev_b32 v33, 6, v34
v_and_b32 v34, 16, v0
v_add_u32 v33, v33, v34
v_bfe_u32 v34, v0, 5, 1
v_lshl_add_u32 v33, v34, 3, v33
v_bfe_u32 v34, v0, 8, 1
v_lshl_add_u32 v33, v34, 5, v33
s_mul_i32 s18, s13, 36864
v_add_u32 v33, s18, v33
s_barrier
s_add_u32 m0, s18, 0
s_add_u32 s19, s26, 0
buffer_load_dwordx4 v32, s[40:43], s19 offen lds
s_add_u32 m0, s18, 1024
s_add_u32 s19, s26, 131072
buffer_load_dwordx4 v32, s[40:43], s19 offen lds
s_add_u32 m0, s18, 2048
s_add_u32 s19, s26, 262144
buffer_load_dwordx4 v32, s[40:43], s19 offen lds
s_add_u32 m0, s18, 3072
s_add_u32 s19, s26, 393216
buffer_load_dwordx4 v32, s[40:43], s19 offen lds
s_add_u32 m0, s18, 4096
s_add_u32 s19, s26, 524288
buffer_load_dwordx4 v32, s[40:43], s19 offen lds
s_add_u32 m0, s18, 5120
s_add_u32 s19, s26, 655360
buffer_load_dwordx4 v32, s[40:43], s19 offen lds
s_add_u32 m0, s18, 6144
s_add_u32 s19, s26, 786432
buffer_load_dwordx4 v32, s[40:43], s19 offen lds
s_add_u32 m0, s18, 7168
s_add_u32 s19, s26, 917504
buffer_load_dwordx4 v32, s[40:43], s19 offen lds
s_add_u32 m0, s18, 8192
s_add_u32 s19, s26, 1048576
buffer_load_dwordx4 v32, s[40:43], s19 offen lds
s_add_u32 m0, s18, 9216
s_add_u32 s19, s26, 1179648
buffer_load_dwordx4 v32, s[40:43], s19 offen lds
s_add_u32 m0, s18, 10240
s_add_u32 s19, s26, 1310720
buffer_load_dwordx4 v32, s[40:43], s19 offen lds
s_add_u32 m0, s18, 11264
s_add_u32 s19, s26, 1441792
buffer_load_dwordx4 v32, s[40:43], s19 offen lds
s_add_u32 m0, s18, 12288
s_add_u32 s19, s26, 1572864
buffer_load_dwordx4 v32, s[40:43], s19 offen lds
s_add_u32 m0, s18, 13312
s_add_u32 s19, s26, 1703936
buffer_load_dwordx4 v32, s[40:43], s19 offen lds
s_add_u32 m0, s18, 14336
s_add_u32 s19, s26, 1835008
buffer_load_dwordx4 v32, s[40:43], s19 offen lds
s_add_u32 m0, s18, 15360
s_add_u32 s19, s26, 1966080
buffer_load_dwordx4 v32, s[40:43], s19 offen lds
s_add_u32 m0, s18, 16384
s_add_u32 s19, s26, 2097152
buffer_load_dwordx4 v32, s[40:43], s19 offen lds
s_add_u32 m0, s18, 17408
s_add_u32 s19, s26, 2228224
buffer_load_dwordx4 v32, s[40:43], s19 offen lds
s_add_u32 m0, s18, 18432
s_add_u32 s19, s26, 2359296
buffer_load_dwordx4 v32, s[40:43], s19 offen lds
s_add_u32 m0, s18, 19456
s_add_u32 s19, s26, 2490368
buffer_load_dwordx4 v32, s[40:43], s19 offen lds
s_add_u32 m0, s18, 20480
s_add_u32 s19, s26, 2621440
buffer_load_dwordx4 v32, s[40:43], s19 offen lds
s_add_u32 m0, s18, 21504
s_add_u32 s19, s26, 2752512
buffer_load_dwordx4 v32, s[40:43], s19 offen lds
s_add_u32 m0, s18, 22528
s_add_u32 s19, s26, 2883584
buffer_load_dwordx4 v32, s[40:43], s19 offen lds
s_add_u32 m0, s18, 23552
s_add_u32 s19, s26, 3014656
buffer_load_dwordx4 v32, s[40:43], s19 offen lds
s_add_u32 m0, s18, 24576
s_add_u32 s19, s26, 3145728
buffer_load_dwordx4 v32, s[40:43], s19 offen lds
s_add_u32 m0, s18, 25600
s_add_u32 s19, s26, 3276800
buffer_load_dwordx4 v32, s[40:43], s19 offen lds
s_add_u32 m0, s18, 26624
s_add_u32 s19, s26, 3407872
buffer_load_dwordx4 v32, s[40:43], s19 offen lds
s_add_u32 m0, s18, 27648
s_add_u32 s19, s26, 3538944
buffer_load_dwordx4 v32, s[40:43], s19 offen lds
s_add_u32 m0, s18, 28672
s_add_u32 s19, s26, 3670016
buffer_load_dwordx4 v32, s[40:43], s19 offen lds
s_add_u32 m0, s18, 29696
s_add_u32 s19, s26, 3801088
buffer_load_dwordx4 v32, s[40:43], s19 offen lds
s_add_u32 m0, s18, 30720
s_add_u32 s19, s26, 3932160
buffer_load_dwordx4 v32, s[40:43], s19 offen lds
s_add_u32 m0, s18, 31744
s_add_u32 s19, s26, 4063232
buffer_load_dwordx4 v32, s[40:43], s19 offen lds
s_add_u32 m0, s18, 32768
s_add_u32 s19, s26, 4194304
buffer_load_dwordx4 v32, s[40:43], s19 offen lds
s_add_u32 m0, s18, 33792
s_add_u32 s19, s26, 4325376
buffer_load_dwordx4 v32, s[40:43], s19 offen lds
s_add_u32 m0, s18, 34816
s_add_u32 s19, s26, 4456448
buffer_load_dwordx4 v32, s[40:43], s19 offen lds
s_add_u32 m0, s18, 35840
s_add_u32 s19, s26, 4587520
buffer_load_dwordx4 v32, s[40:43], s19 offen lds
s_waitcnt vmcnt(32)
ds_read_b64_tr_b16 a[0:1], v33 offset:0
ds_read_b64_tr_b16 a[2:3], v33 offset:256
ds_read_b64_tr_b16 a[4:5], v33 offset:1024
ds_read_b64_tr_b16 a[6:7], v33 offset:1280
ds_read_b64_tr_b16 a[8:9], v33 offset:2048
ds_read_b64_tr_b16 a[10:11], v33 offset:2304
ds_read_b64_tr_b16 a[12:13], v33 offset:3072
ds_read_b64_tr_b16 a[14:15], v33 offset:3328
s_waitcnt lgkmcnt(0)
s_add_u32 m0, s18, 0
s_add_u32 s19, s26, 4718592
buffer_load_dwordx4 v32, s[40:43], s19 offen lds
s_add_u32 m0, s18, 1024
s_add_u32 s19, s26, 4849664
buffer_load_dwordx4 v32, s[40:43], s19 offen lds
s_add_u32 m0, s18, 2048
s_add_u32 s19, s26, 4980736
buffer_load_dwordx4 v32, s[40:43], s19 offen lds
s_add_u32 m0, s18, 3072
s_add_u32 s19, s26, 5111808
buffer_load_dwordx4 v32, s[40:43], s19 offen lds
s_waitcnt vmcnt(32)
ds_read_b64_tr_b16 a[16:17], v33 offset:4096
ds_read_b64_tr_b16 a[18:19], v33 offset:4352
ds_read_b64_tr_b16 a[20:21], v33 offset:5120
ds_read_b64_tr_b16 a[22:23], v33 offset:5376
ds_read_b64_tr_b16 a[24:25], v33 offset:6144
ds_read_b64_tr_b16 a[26:27], v33 offset:6400
ds_read_b64_tr_b16 a[28:29], v33 offset:7168
ds_read_b64_tr_b16 a[30:31], v33 offset:7424
s_waitcnt vmcnt(28)
ds_read_b64_tr_b16 a[32:33], v33 offset:8192
ds_read_b64_tr_b16 a[34:35], v33 offset:8448
ds_read_b64_tr_b16 a[36:37], v33 offset:9216
ds_read_b64_tr_b16 a[38:39], v33 offset:9472
ds_read_b64_tr_b16 a[40:41], v33 offset:10240
ds_read_b64_tr_b16 a[42:43], v33 offset:10496
ds_read_b64_tr_b16 a[44:45], v33 offset:11264
ds_read_b64_tr_b16 a[46:47], v33 offset:11520
s_waitcnt vmcnt(24)
ds_read_b64_tr_b16 a[48:49], v33 offset:12288
ds_read_b64_tr_b16 a[50:51], v33 offset:12544
ds_read_b64_tr_b16 a[52:53], v33 offset:13312
ds_read_b64_tr_b16 a[54:55], v33 offset:13568
ds_read_b64_tr_b16 a[56:57], v33 offset:14336
ds_read_b64_tr_b16 a[58:59], v33 offset:14592
ds_read_b64_tr_b16 a[60:61], v33 offset:15360
ds_read_b64_tr_b16 a[62:63], v33 offset:15616
s_waitcnt vmcnt(20)
ds_read_b64_tr_b16 a[64:65], v33 offset:16384
ds_read_b64_tr_b16 a[66:67], v33 offset:16640
ds_read_b64_tr_b16 a[68:69], v33 offset:17408
ds_read_b64_tr_b16 a[70:71], v33 offset:17664
ds_read_b64_tr_b16 a[72:73], v33 offset:18432
ds_read_b64_tr_b16 a[74:75], v33 offset:18688
ds_read_b64_tr_b16 a[76:77], v33 offset:19456
ds_read_b64_tr_b16 a[78:79], v33 offset:19712
s_waitcnt vmcnt(16)
ds_read_b64_tr_b16 a[80:81], v33 offset:20480
ds_read_b64_tr_b16 a[82:83], v33 offset:20736
ds_read_b64_tr_b16 a[84:85], v33 offset:21504
ds_read_b64_tr_b16 a[86:87], v33 offset:21760
ds_read_b64_tr_b16 a[88:89], v33 offset:22528
ds_read_b64_tr_b16 a[90:91], v33 offset:22784
ds_read_b64_tr_b16 a[92:93], v33 offset:23552
ds_read_b64_tr_b16 a[94:95], v33 offset:23808
s_waitcnt vmcnt(12)
ds_read_b64_tr_b16 a[96:97], v33 offset:24576
ds_read_b64_tr_b16 a[98:99], v33 offset:24832
ds_read_b64_tr_b16 a[100:101], v33 offset:25600
ds_read_b64_tr_b16 a[102:103], v33 offset:25856
ds_read_b64_tr_b16 a[104:105], v33 offset:26624
ds_read_b64_tr_b16 a[106:107], v33 offset:26880
ds_read_b64_tr_b16 a[108:109], v33 offset:27648
ds_read_b64_tr_b16 a[110:111], v33 offset:27904
s_waitcnt vmcnt(8)
ds_read_b64_tr_b16 a[112:113], v33 offset:28672
ds_read_b64_tr_b16 a[114:115], v33 offset:28928
ds_read_b64_tr_b16 a[116:117], v33 offset:29696
ds_read_b64_tr_b16 a[118:119], v33 offset:29952
ds_read_b64_tr_b16 a[120:121], v33 offset:30720
ds_read_b64_tr_b16 a[122:123], v33 offset:30976
ds_read_b64_tr_b16 a[124:125], v33 offset:31744
ds_read_b64_tr_b16 a[126:127], v33 offset:32000
s_waitcnt vmcnt(4)
ds_read_b64_tr_b16 a[128:129], v33 offset:32768
ds_read_b64_tr_b16 a[130:131], v33 offset:33024
ds_read_b64_tr_b16 a[132:133], v33 offset:33792
ds_read_b64_tr_b16 a[134:135], v33 offset:34048
ds_read_b64_tr_b16 a[136:137], v33 offset:34816
ds_read_b64_tr_b16 a[138:139], v33 offset:35072
ds_read_b64_tr_b16 a[140:141], v33 offset:35840
ds_read_b64_tr_b16 a[142:143], v33 offset:36096
s_waitcnt vmcnt(0)
ds_read_b64_tr_b16 a[144:145], v33 offset:0
ds_read_b64_tr_b16 a[146:147], v33 offset:256
ds_read_b64_tr_b16 a[148:149], v33 offset:1024
ds_read_b64_tr_b16 a[150:151], v33 offset:1280
ds_read_b64_tr_b16 a[152:153], v33 offset:2048
ds_read_b64_tr_b16 a[154:155], v33 offset:2304
ds_read_b64_tr_b16 a[156:157], v33 offset:3072
ds_read_b64_tr_b16 a[158:159], v33 offset:3328
s_waitcnt lgkmcnt(0)
s_barrier
v_mov_b32 v32, s24
v_mov_b32 v33, s24
v_mov_b32 v34, s24
v_mov_b32 v35, s24
s_nop 1
v_mfma_f32_32x32x16_bf16 v[36:51], a[0:3], v[32:35], 0
v_mfma_f32_32x32x16_bf16 v[36:51], a[4:7], v[32:35], v[36:51]
v_mfma_f32_32x32x16_bf16 v[36:51], a[8:11], v[32:35], v[36:51]
v_mfma_f32_32x32x16_bf16 v[36:51], a[12:15], v[32:35], v[36:51]
v_mfma_f32_32x32x16_bf16 v[36:51], a[16:19], v[32:35], v[36:51]
v_mfma_f32_32x32x16_bf16 v[36:51], a[20:23], v[32:35], v[36:51]
v_mfma_f32_32x32x16_bf16 v[36:51], a[24:27], v[32:35], v[36:51]
v_mfma_f32_32x32x16_bf16 v[36:51], a[28:31], v[32:35], v[36:51]
v_mfma_f32_32x32x16_bf16 v[36:51], a[32:35], v[32:35], v[36:51]
v_mfma_f32_32x32x16_bf16 v[36:51], a[36:39], v[32:35], v[36:51]
v_mfma_f32_32x32x16_bf16 v[36:51], a[40:43], v[32:35], v[36:51]
v_mfma_f32_32x32x16_bf16 v[36:51], a[44:47], v[32:35], v[36:51]
v_mfma_f32_32x32x16_bf16 v[36:51], a[48:51], v[32:35], v[36:51]
v_mfma_f32_32x32x16_bf16 v[36:51], a[52:55], v[32:35], v[36:51]
v_mfma_f32_32x32x16_bf16 v[36:51], a[56:59], v[32:35], v[36:51]
v_mfma_f32_32x32x16_bf16 v[36:51], a[60:63], v[32:35], v[36:51]
v_mfma_f32_32x32x16_bf16 v[36:51], a[64:67], v[32:35], v[36:51]
v_mfma_f32_32x32x16_bf16 v[36:51], a[68:71], v[32:35], v[36:51]
v_mfma_f32_32x32x16_bf16 v[36:51], a[72:75], v[32:35], v[36:51]
v_mfma_f32_32x32x16_bf16 v[36:51], a[76:79], v[32:35], v[36:51]
v_mfma_f32_32x32x16_bf16 v[36:51], a[80:83], v[32:35], v[36:51]
v_mfma_f32_32x32x16_bf16 v[36:51], a[84:87], v[32:35], v[36:51]
v_mfma_f32_32x32x16_bf16 v[36:51], a[88:91], v[32:35], v[36:51]
v_mfma_f32_32x32x16_bf16 v[36:51], a[92:95], v[32:35], v[36:51]
v_mfma_f32_32x32x16_bf16 v[36:51], a[96:99], v[32:35], v[36:51]
v_mfma_f32_32x32x16_bf16 v[36:51], a[100:103], v[32:35], v[36:51]
v_mfma_f32_32x32x16_bf16 v[36:51], a[104:107], v[32:35], v[36:51]
v_mfma_f32_32x32x16_bf16 v[36:51], a[108:111], v[32:35], v[36:51]
v_mfma_f32_32x32x16_bf16 v[36:51], a[112:115], v[32:35], v[36:51]
v_mfma_f32_32x32x16_bf16 v[36:51], a[116:119], v[32:35], v[36:51]
v_mfma_f32_32x32x16_bf16 v[36:51], a[120:123], v[32:35], v[36:51]
v_mfma_f32_32x32x16_bf16 v[36:51], a[124:127], v[32:35], v[36:51]
v_mfma_f32_32x32x16_bf16 v[36:51], a[128:131], v[32:35], v[36:51]
v_mfma_f32_32x32x16_bf16 v[36:51], a[132:135], v[32:35], v[36:51]
v_mfma_f32_32x32x16_bf16 v[36:51], a[136:139], v[32:35], v[36:51]
v_mfma_f32_32x32x16_bf16 v[36:51], a[140:143], v[32:35], v[36:51]
v_mfma_f32_32x32x16_bf16 v[36:51], a[144:147], v[32:35], v[36:51]
v_mfma_f32_32x32x16_bf16 v[36:51], a[148:151], v[32:35], v[36:51]
v_mfma_f32_32x32x16_bf16 v[36:51], a[152:155], v[32:35], v[36:51]
v_mfma_f32_32x32x16_bf16 v[36:51], a[156:159], v[32:35], v[36:51]
s_nop 11
v_mov_b32 v16, v36
v_mov_b32 v17, v37
v_mov_b32 v18, v38
v_mov_b32 v19, v39
v_mov_b32 v20, v40
v_mov_b32 v21, v41
v_mov_b32 v22, v42
v_mov_b32 v23, v43
v_mov_b32 v24, v44
v_mov_b32 v25, v45
v_mov_b32 v26, v46
v_mov_b32 v27, v47
v_mov_b32 v28, v48
v_mov_b32 v29, v49
v_mov_b32 v30, v50
v_mov_b32 v31, v51
v_accvgpr_write_b32 a160, v16
v_accvgpr_write_b32 a161, v17
v_accvgpr_write_b32 a162, v18
v_accvgpr_write_b32 a163, v19
v_accvgpr_write_b32 a164, v20
v_accvgpr_write_b32 a165, v21
v_accvgpr_write_b32 a166, v22
v_accvgpr_write_b32 a167, v23
v_accvgpr_write_b32 a168, v24
v_accvgpr_write_b32 a169, v25
v_accvgpr_write_b32 a170, v26
v_accvgpr_write_b32 a171, v27
v_accvgpr_write_b32 a172, v28
v_accvgpr_write_b32 a173, v29
v_accvgpr_write_b32 a174, v30
v_accvgpr_write_b32 a175, v31
qw_64:
v_accvgpr_read_b32 v16, a160
v_accvgpr_read_b32 v17, a161
v_accvgpr_read_b32 v18, a162
v_accvgpr_read_b32 v19, a163
v_accvgpr_read_b32 v20, a164
v_accvgpr_read_b32 v21, a165
v_accvgpr_read_b32 v22, a166
v_accvgpr_read_b32 v23, a167
v_accvgpr_read_b32 v24, a168
v_accvgpr_read_b32 v25, a169
v_accvgpr_read_b32 v26, a170
v_accvgpr_read_b32 v27, a171
v_accvgpr_read_b32 v28, a172
v_accvgpr_read_b32 v29, a173
v_accvgpr_read_b32 v30, a174
v_accvgpr_read_b32 v31, a175
s_lshl_b32 s29, s16, 1
s_add_u32 s29, s29, 2
s_lshr_b32 s52, s39, 5
s_lshl_b32 s53, s32, 8
s_add_u32 s53, s53, 11534336
s_cmp_lg_u32 s13, 0
s_cbranch_scc1 polld_66
v_lshlrev_b32 v3, 3, v0
v_min_u32 v12, 3968, v3
s_mov_b32 s21, 11612160
s_mov_b32 s17, 0
poll_65:
buffer_load_dword v8, v3, s[4:7], s21 offen sc1
s_add_u32 s20, s21, 8192
buffer_load_dword v9, v3, s[4:7], s20 offen sc1
s_add_u32 s20, s21, 16384
buffer_load_dword v10, v12, s[4:7], s20 offen sc1
s_add_u32 s17, s17, 1
s_cmp_gt_u32 s17, 262144
s_cbranch_scc1 L_fail
s_waitcnt vmcnt(1)
v_min_u32 v8, v8, v9
s_waitcnt vmcnt(0)
v_min_u32 v8, v8, v10
v_cmp_gt_u32 vcc, s29, v8
s_cbranch_vccz polld_66
s_sleep 2
s_branch poll_65
polld_66:
s_barrier
qr_67:
s_mul_i32 s26, s16, 6291456
s_mul_i32 s18, s52, 163840
s_add_u32 s26, s26, s18
s_add_u32 s26, s26, s31
s_add_u32 s26, s26, 88080384
s_lshl_b32 s18, s16, 4
s_add_u32 s18, s18, s52
s_mul_i32 s18, s18, 20480
s_add_u32 s36, s18, 163577856
s_lshl_b32 s18, s13, 11
s_add_u32 s18, s18, 83968
v_add_u32 v13, s18, v0
s_mov_b32 s28, 0
v_xor_b32 v1, 40960, v0
s_mov_b32 s25, s31
s_mov_b32 s35, 131072
s_add_u32 m0, s25, 2048
s_add_u32 s20, s26, 0
buffer_load_dwordx4 v0, s[4:7], s20 offen sc1 lds
s_add_u32 m0, s25, 3072
s_add_u32 s20, s26, 1024
buffer_load_dwordx4 v0, s[4:7], s20 offen sc1 lds
s_add_u32 m0, s25, 4096
s_add_u32 s20, s26, 2048
buffer_load_dwordx4 v0, s[4:7], s20 offen sc1 lds
s_add_u32 m0, s25, 5120
s_add_u32 s20, s26, 3072
buffer_load_dwordx4 v0, s[4:7], s20 offen sc1 lds
s_add_u32 m0, s25, 6144
s_add_u32 s20, s26, 4096
buffer_load_dwordx4 v0, s[4:7], s20 offen sc1 lds
s_add_u32 m0, s25, 7168
s_add_u32 s20, s26, 5120
buffer_load_dwordx4 v0, s[4:7], s20 offen sc1 lds
s_add_u32 m0, s25, 8192
s_add_u32 s20, s26, 6144
buffer_load_dwordx4 v0, s[4:7], s20 offen sc1 lds
s_add_u32 m0, s25, 9216
s_add_u32 s20, s26, 7168
buffer_load_dwordx4 v0, s[4:7], s20 offen sc1 lds
s_add_u32 m0, s25, 10240
s_add_u32 s20, s26, 8192
buffer_load_dwordx4 v0, s[4:7], s20 offen sc1 lds
s_add_u32 m0, s25, 11264
s_add_u32 s20, s26, 9216
buffer_load_dwordx4 v0, s[4:7], s20 offen sc1 lds
s_add_u32 m0, s35, s37
s_add_u32 s20, s36, s37
buffer_load_dwordx4 v0, s[4:7], s20 offen sc1 lds
s_add_u32 m0, s35, 4096
s_add_u32 s20, s36, 4096
buffer_load_dwordx4 v0, s[4:7], s20 offen sc1 lds
s_waitcnt vmcnt(0)
qu_68:
v_xor_b32 v1, 40960, v1
s_sub_u32 s25, s25, s31
s_xor_b32 s25, s25, 40960
s_add_u32 s25, s25, s31
s_xor_b32 s35, s35, 8192
s_add_u32 s26, s26, 40960
s_add_u32 s36, s36, 5120
s_cmp_eq_u32 s28, 3
s_cselect_b32 s26, s6, s26
s_cselect_b32 s36, s6, s36
s_waitcnt vmcnt(0)
s_barrier
ds_read_b128 v[48:51], v1 offset:2048
ds_read_b128 v[52:55], v1 offset:3072
s_add_u32 m0, s25, 2048
s_add_u32 s20, s26, 0
buffer_load_dwordx4 v0, s[4:7], s20 offen sc1 lds
v_lshrrev_b32 v2, 2, v0
ds_read_b128 v[56:59], v1 offset:4096
ds_read_b128 v[60:63], v1 offset:5120
s_xor_b32 s18, s35, 8192
v_add_u32 v2, s18, v2
ds_read2st64_b32 v[72:73], v2 offset0:4 offset1:5
s_waitcnt lgkmcnt(4)
v_mfma_f32_32x32x16_bf16 v[32:47], a[0:3], v[48:51], 0
s_add_u32 m0, s25, 3072
s_add_u32 s20, s26, 1024
buffer_load_dwordx4 v0, s[4:7], s20 offen sc1 lds
ds_read_b128 v[48:51], v1 offset:6144
ds_read2st64_b32 v[66:67], v2 offset0:2 offset1:3
s_waitcnt lgkmcnt(4)
v_mfma_f32_32x32x16_bf16 v[32:47], a[4:7], v[52:55], v[32:47]
ds_read_b128 v[52:55], v1 offset:7168
ds_read2st64_b32 v[78:79], v2 offset0:10 offset1:11
s_add_u32 m0, s25, 4096
s_add_u32 s20, s26, 2048
buffer_load_dwordx4 v0, s[4:7], s20 offen sc1 lds
v_mfma_f32_32x32x16_bf16 v[32:47], a[8:11], v[56:59], v[32:47]
s_waitcnt lgkmcnt(3)
ds_read_b128 v[56:59], v1 offset:8192
ds_read2st64_b32 v[86:87], v2 offset0:18 offset1:19
v_mfma_f32_32x32x16_bf16 v[32:47], a[12:15], v[60:63], v[32:47]
ds_read_b128 v[60:63], v1 offset:9216
ds_read2st64_b32 v[64:65], v2 offset0:0 offset1:1
s_waitcnt lgkmcnt(5)
ds_read2st64_b32 v[74:75], v2 offset0:6 offset1:7
v_mfma_f32_32x32x16_bf16 v[32:47], a[16:19], v[48:51], v[32:47]
ds_read2st64_b32 v[80:81], v2 offset0:12 offset1:13
ds_read_b128 v[48:51], v1 offset:10240
ds_read2st64_b32 v[82:83], v2 offset0:14 offset1:15
ds_read2st64_b32 v[76:77], v2 offset0:8 offset1:9
v_mfma_f32_32x32x16_bf16 v[32:47], a[20:23], v[52:55], v[32:47]
ds_read_b128 v[52:55], v1 offset:11264
s_waitcnt lgkmcnt(9)
s_add_u32 m0, s25, 5120
s_add_u32 s20, s26, 3072
buffer_load_dwordx4 v0, s[4:7], s20 offen sc1 lds
v_mfma_f32_32x32x16_bf16 v[32:47], a[24:27], v[56:59], v[32:47]
s_waitcnt lgkmcnt(7)
s_add_u32 m0, s25, 6144
s_add_u32 s20, s26, 4096
buffer_load_dwordx4 v0, s[4:7], s20 offen sc1 lds
s_waitcnt lgkmcnt(6)
v_add_f32 v64, v64, v66
v_mfma_f32_32x32x16_bf16 v[32:47], a[28:31], v[60:63], v[32:47]
ds_read_b128 v[56:59], v1 offset:12288
ds_read_b128 v[60:63], v1 offset:13312
v_add_f32 v65, v65, v67
s_waitcnt lgkmcnt(5)
v_mfma_f32_32x32x16_bf16 v[32:47], a[32:35], v[48:51], v[32:47]
ds_read_b128 v[48:51], v1 offset:14336
v_add_f32 v65, v65, v73
s_waitcnt lgkmcnt(3)
v_add_f32 v65, v65, v75
v_mfma_f32_32x32x16_bf16 v[32:47], a[36:39], v[52:55], v[32:47]
s_add_u32 m0, s25, 7168
s_add_u32 s20, s26, 5120
buffer_load_dwordx4 v0, s[4:7], s20 offen sc1 lds
ds_read2st64_b32 v[84:85], v2 offset0:16 offset1:17
v_add_f32 v64, v64, v72
s_waitcnt lgkmcnt(3)
v_add_f32 v65, v65, v77
v_mfma_f32_32x32x16_bf16 v[32:47], a[40:43], v[56:59], v[32:47]
s_waitcnt lgkmcnt(2)
ds_read_b128 v[56:59], v1 offset:16384
ds_read_b128 v[52:55], v1 offset:15360
v_add_f32 v64, v64, v74
v_add_f32 v64, v64, v76
v_mfma_f32_32x32x16_bf16 v[32:47], a[44:47], v[60:63], v[32:47]
s_waitcnt lgkmcnt(3)
ds_read_b128 v[60:63], v1 offset:17408
v_add_f32 v65, v65, v79
v_mfma_f32_32x32x16_bf16 v[32:47], a[48:51], v[48:51], v[32:47]
v_add_f32 v64, v64, v78
s_add_u32 m0, s25, 8192
s_add_u32 s20, s26, 6144
buffer_load_dwordx4 v0, s[4:7], s20 offen sc1 lds
s_waitcnt lgkmcnt(1)
v_mfma_f32_32x32x16_bf16 v[32:47], a[52:55], v[52:55], v[32:47]
ds_read_b128 v[48:51], v1 offset:18432
v_add_f32 v65, v65, v81
s_waitcnt lgkmcnt(1)
ds_read_b128 v[52:55], v1 offset:19456
v_mfma_f32_32x32x16_bf16 v[32:47], a[56:59], v[56:59], v[32:47]
s_add_u32 m0, s25, 9216
s_add_u32 s20, s26, 7168
buffer_load_dwordx4 v0, s[4:7], s20 offen sc1 lds
v_mfma_f32_32x32x16_bf16 v[32:47], a[60:63], v[60:63], v[32:47]
ds_read_b128 v[60:63], v1 offset:21504
s_waitcnt lgkmcnt(2)
ds_read_b128 v[56:59], v1 offset:20480
v_mfma_f32_32x32x16_bf16 v[32:47], a[64:67], v[48:51], v[32:47]
v_add_f32 v65, v65, v83
s_waitcnt lgkmcnt(2)
ds_read_b128 v[48:51], v1 offset:22528
v_mfma_f32_32x32x16_bf16 v[32:47], a[68:71], v[52:55], v[32:47]
v_add_f32 v65, v65, v85
v_add_f32 v64, v64, v80
v_add_f32 v64, v64, v82
s_waitcnt lgkmcnt(2)
s_waitcnt lgkmcnt(1)
v_mfma_f32_32x32x16_bf16 v[32:47], a[72:75], v[56:59], v[32:47]
s_add_u32 m0, s25, 10240
s_add_u32 s20, s26, 8192
buffer_load_dwordx4 v0, s[4:7], s20 offen sc1 lds
ds_read_b128 v[52:55], v1 offset:23552
v_add_f32 v64, v64, v84
v_add_f32 v65, v65, v87
s_waitcnt lgkmcnt(1)
v_mfma_f32_32x32x16_bf16 v[32:47], a[76:79], v[60:63], v[32:47]
v_add_f32 v64, v64, v86
ds_read_b128 v[56:59], v1 offset:24576
v_mfma_f32_32x32x16_bf16 v[32:47], a[80:83], v[48:51], v[32:47]
ds_read_b128 v[60:63], v1 offset:25600
ds_read_b128 v[48:51], v1 offset:26624
v_add_f32 v64, v64, v65
v_mov_b32 v68, v64
s_waitcnt lgkmcnt(3)
v_mfma_f32_32x32x16_bf16 v[32:47], a[84:87], v[52:55], v[32:47]
s_add_u32 m0, s25, 11264
s_add_u32 s20, s26, 9216
buffer_load_dwordx4 v0, s[4:7], s20 offen sc1 lds
s_waitcnt lgkmcnt(2)
v_permlane32_swap_b32 v64, v68
v_mfma_f32_32x32x16_bf16 v[32:47], a[88:91], v[56:59], v[32:47]
ds_read_b128 v[56:59], v1 offset:28672
ds_read_b128 v[52:55], v1 offset:27648
v_mul_f32 v68, 0x3acccccd, v68
s_waitcnt lgkmcnt(3)
v_mul_f32 v64, 0x3acccccd, v64
v_fma_f32 v68, -v64, v64, v68
v_mfma_f32_32x32x16_bf16 v[32:47], a[92:95], v[60:63], v[32:47]
s_add_u32 m0, s35, s37
s_add_u32 s20, s36, s37
buffer_load_dwordx4 v0, s[4:7], s20 offen sc1 lds
ds_read_b128 v[60:63], v1 offset:29696
s_waitcnt lgkmcnt(3)
v_max_f32 v68, 0, v68
v_add_f32 v68, 0x3727c5ac, v68
v_mfma_f32_32x32x16_bf16 v[32:47], a[96:99], v[48:51], v[32:47]
ds_read_b128 v[48:51], v1 offset:30720
v_rsq_f32 v68, v68
s_waitcnt lgkmcnt(2)
v_mul_f32 v68, 0x3e0293ee, v68
v_mfma_f32_32x32x16_bf16 v[32:47], a[100:103], v[52:55], v[32:47]
s_add_u32 m0, s35, 4096
s_add_u32 s20, s36, 4096
buffer_load_dwordx4 v0, s[4:7], s20 offen sc1 lds
v_mul_f32 v64, v68, v64
s_waitcnt lgkmcnt(1)
v_mfma_f32_32x32x16_bf16 v[32:47], a[104:107], v[56:59], v[32:47]
v_mul_f32 v82, v64, v26
s_waitcnt lgkmcnt(0)
ds_read_b128 v[52:55], v1 offset:31744
ds_read_b128 v[56:59], v1 offset:32768
v_mfma_f32_32x32x16_bf16 v[32:47], a[108:111], v[60:63], v[32:47]
ds_read_b128 v[60:63], v1 offset:33792
v_mfma_f32_32x32x16_bf16 v[32:47], a[112:115], v[48:51], v[32:47]
s_waitcnt lgkmcnt(2)
v_mul_f32 v84, v64, v28
v_mul_f32 v73, v64, v17
v_mfma_f32_32x32x16_bf16 v[32:47], a[116:119], v[52:55], v[32:47]
ds_read_b128 v[52:55], v1 offset:35840
s_waitcnt lgkmcnt(2)
ds_read_b128 v[48:51], v1 offset:34816
v_mfma_f32_32x32x16_bf16 v[32:47], a[120:123], v[56:59], v[32:47]
v_mul_f32 v87, v64, v31
v_mul_f32 v77, v64, v21
v_mul_f32 v81, v64, v25
s_waitcnt lgkmcnt(2)
v_mfma_f32_32x32x16_bf16 v[32:47], a[124:127], v[60:63], v[32:47]
ds_read_b128 v[60:63], v1 offset:37888
s_waitcnt lgkmcnt(2)
s_waitcnt lgkmcnt(1)
ds_read_b128 v[56:59], v1 offset:36864
v_mfma_f32_32x32x16_bf16 v[32:47], a[128:131], v[48:51], v[32:47]
ds_read_b128 v[48:51], v1 offset:38912
v_mul_f32 v75, v64, v19
v_mfma_f32_32x32x16_bf16 v[32:47], a[132:135], v[52:55], v[32:47]
s_waitcnt lgkmcnt(1)
v_mfma_f32_32x32x16_bf16 v[32:47], a[136:139], v[56:59], v[32:47]
ds_read_b128 v[56:59], v1 offset:40960
ds_read_b128 v[52:55], v1 offset:39936
v_mul_f32 v79, v64, v23
v_mul_f32 v85, v64, v29
v_mul_f32 v76, v64, v20
v_mfma_f32_32x32x16_bf16 v[32:47], a[140:143], v[60:63], v[32:47]
s_waitcnt lgkmcnt(2)
ds_read_b128 v[60:63], v1 offset:41984
v_mul_f32 v74, v64, v18
v_mul_f32 v86, v64, v30
v_mfma_f32_32x32x16_bf16 v[32:47], a[144:147], v[48:51], v[32:47]
s_waitcnt lgkmcnt(1)
v_mfma_f32_32x32x16_bf16 v[32:47], a[148:151], v[52:55], v[32:47]
s_waitcnt lgkmcnt(0)
v_mfma_f32_32x32x16_bf16 v[32:47], a[152:155], v[56:59], v[32:47]
v_mfma_f32_32x32x16_bf16 v[32:47], a[156:159], v[60:63], v[32:47]
s_nop 0
v_mul_f32 v72, v64, v16
v_mul_f32 v78, v64, v22
v_mul_f32 v83, v64, v27
v_mul_f32 v80, v64, v24
s_nop 6
v_pk_fma_f32 v[44:45], v[44:45], v[68:69], v[84:85] op_sel_hi:[1,0,1] neg_lo:[0,0,1] neg_hi:[0,0,1]
v_pk_fma_f32 v[38:39], v[38:39], v[68:69], v[78:79] op_sel_hi:[1,0,1] neg_lo:[0,0,1] neg_hi:[0,0,1]
v_pk_fma_f32 v[42:43], v[42:43], v[68:69], v[82:83] op_sel_hi:[1,0,1] neg_lo:[0,0,1] neg_hi:[0,0,1]
v_pk_fma_f32 v[46:47], v[46:47], v[68:69], v[86:87] op_sel_hi:[1,0,1] neg_lo:[0,0,1] neg_hi:[0,0,1]
v_pk_fma_f32 v[34:35], v[34:35], v[68:69], v[74:75] op_sel_hi:[1,0,1] neg_lo:[0,0,1] neg_hi:[0,0,1]
v_pk_fma_f32 v[32:33], v[32:33], v[68:69], v[72:73] op_sel_hi:[1,0,1] neg_lo:[0,0,1] neg_hi:[0,0,1]
v_cvt_pk_bf16_f32 v51, v38, v39
v_cvt_pk_bf16_f32 v49, v34, v35
v_pk_fma_f32 v[36:37], v[36:37], v[68:69], v[76:77] op_sel_hi:[1,0,1] neg_lo:[0,0,1] neg_hi:[0,0,1]
v_cvt_pk_bf16_f32 v54, v44, v45
v_cvt_pk_bf16_f32 v50, v36, v37
v_cvt_pk_bf16_f32 v48, v32, v33
v_pk_fma_f32 v[40:41], v[40:41], v[68:69], v[80:81] op_sel_hi:[1,0,1] neg_lo:[0,0,1] neg_hi:[0,0,1]
v_cvt_pk_bf16_f32 v55, v46, v47
v_cvt_pk_bf16_f32 v53, v42, v43
v_cvt_pk_bf16_f32 v52, v40, v41
ds_write_b128 v13, v[48:51] offset:0
ds_write_b128 v13, v[52:55] offset:1024
v_add_u32 v13, 8192, v13
s_add_u32 s28, s28, 1
s_cmp_lt_u32 s28, 4
s_cbranch_scc1 qu_68
s_waitcnt lgkmcnt(0)
s_barrier
s_lshl_b32 s30, s52, 2
s_add_u32 s30, s30, s13
s_lshl_b32 s18, s16, 6
s_add_u32 s29, s18, s30
s_lshl_b32 s27, s29, 18
s_lshl_b32 s19, s32, 13
s_add_u32 s27, s27, s19
s_add_u32 s27, s27, 127926272
s_mul_i32 s18, s16, 35651584
s_mul_i32 s19, s30, 524288
s_add_u32 s18, s18, s19
s_mul_i32 s19, s32, 16384
s_add_u32 s18, s18, s19
s_add_u32 s29, s29, 1
s_mov_b32 s28, s29
s_lshl_b32 s19, s13, 13
s_add_u32 s19, s19, 83968
v_add_u32 v200, s19, v0
s_add_u32 s54, s18, 16777216
s_add_u32 s55, s18, 16781312
s_add_u32 s56, s18, 16785408
s_add_u32 s57, s18, 16789504
ds_read_b128 v[32:35], v200 offset:0
ds_read_b128 v[36:39], v200 offset:1024
ds_read_b128 v[40:43], v200 offset:2048
ds_read_b128 v[44:47], v200 offset:3072
ds_read_b128 v[48:51], v200 offset:4096
ds_read_b128 v[52:55], v200 offset:5120
ds_read_b128 v[56:59], v200 offset:6144
ds_read_b128 v[60:63], v200 offset:7168
v_and_b32 v14, 0x70, v0
v_lshrrev_b32 v200, 8, v0
v_lshl_add_u32 v14, v200, 7, v14
v_bfe_u32 v200, v0, 7, 1
v_lshl_add_u32 v14, v200, 12, v14
v_and_b32 v15, 0x70, v0
v_lshrrev_b32 v200, 8, v0
v_lshl_add_u32 v15, v200, 7, v15
v_bfe_u32 v200, v0, 7, 1
v_lshl_add_u32 v15, v200, 10, v15
v_bfe_u32 v200, v0, 4, 5
v_lshrrev_b32 v144, 9, v0
v_lshlrev_b32 v144, 2, v144
v_sub_u32 v200, v200, v144
v_mov_b32 v145, 0xf149f2ca
v_cmp_gt_i32 vcc, 0, v200
s_nop 1
v_cndmask_b32 v128, 0, v145, vcc
v_cmp_gt_i32 vcc, 1, v200
s_nop 1
v_cndmask_b32 v129, 0, v145, vcc
v_cmp_gt_i32 vcc, 2, v200
s_nop 1
v_cndmask_b32 v130, 0, v145, vcc
v_cmp_gt_i32 vcc, 3, v200
s_nop 1
v_cndmask_b32 v131, 0, v145, vcc
v_cmp_gt_i32 vcc, 8, v200
s_nop 1
v_cndmask_b32 v132, 0, v145, vcc
v_cmp_gt_i32 vcc, 9, v200
s_nop 1
v_cndmask_b32 v133, 0, v145, vcc
v_cmp_gt_i32 vcc, 10, v200
s_nop 1
v_cndmask_b32 v134, 0, v145, vcc
v_cmp_gt_i32 vcc, 11, v200
s_nop 1
v_cndmask_b32 v135, 0, v145, vcc
v_cmp_gt_i32 vcc, 16, v200
s_nop 1
v_cndmask_b32 v136, 0, v145, vcc
v_cmp_gt_i32 vcc, 17, v200
s_nop 1
v_cndmask_b32 v137, 0, v145, vcc
v_cmp_gt_i32 vcc, 18, v200
s_nop 1
v_cndmask_b32 v138, 0, v145, vcc
v_cmp_gt_i32 vcc, 19, v200
s_nop 1
v_cndmask_b32 v139, 0, v145, vcc
v_cmp_gt_i32 vcc, 24, v200
s_nop 1
v_cndmask_b32 v140, 0, v145, vcc
v_cmp_gt_i32 vcc, 25, v200
s_nop 1
v_cndmask_b32 v141, 0, v145, vcc
v_cmp_gt_i32 vcc, 26, v200
s_nop 1
v_cndmask_b32 v142, 0, v145, vcc
v_cmp_gt_i32 vcc, 27, v200
s_nop 1
v_cndmask_b32 v143, 0, v145, vcc
v_lshlrev_b32 v3, 3, v0
v_min_u32 v12, 128, v3
s_mov_b32 s17, 0
poll_69:
buffer_load_dword v8, v12, s[4:7], s53 offen sc1
s_add_u32 s17, s17, 1
s_cmp_gt_u32 s17, 262144
s_cbranch_scc1 L_fail
s_waitcnt vmcnt(0)
v_cmp_gt_u32 vcc, s29, v8
s_cbranch_vccz polld_70
s_sleep 2
s_branch poll_69
polld_70:
buffer_load_dwordx4 v[64:67], v14, s[4:7], s54 offen offset:0 sc1
buffer_load_dwordx4 v[68:71], v14, s[4:7], s54 offen offset:512 sc1
buffer_load_dwordx4 v[72:75], v14, s[4:7], s54 offen offset:1024 sc1
buffer_load_dwordx4 v[76:79], v14, s[4:7], s54 offen offset:1536 sc1
buffer_load_dwordx4 v[80:83], v14, s[4:7], s56 offen offset:0 sc1
buffer_load_dwordx4 v[84:87], v14, s[4:7], s56 offen offset:512 sc1
buffer_load_dwordx4 v[88:91], v14, s[4:7], s56 offen offset:1024 sc1
buffer_load_dwordx4 v[92:95], v14, s[4:7], s56 offen offset:1536 sc1
buffer_load_dwordx4 v[96:99], v15, s[4:7], s54 offen offset:2048 sc1
buffer_load_dwordx4 v[100:103], v15, s[4:7], s54 offen offset:2560 sc1
buffer_load_dwordx4 v[104:107], v15, s[4:7], s55 offen offset:2048 sc1
buffer_load_dwordx4 v[108:111], v15, s[4:7], s55 offen offset:2560 sc1
buffer_load_dwordx4 v[112:115], v15, s[4:7], s56 offen offset:2048 sc1
buffer_load_dwordx4 v[116:119], v15, s[4:7], s56 offen offset:2560 sc1
buffer_load_dwordx4 v[120:123], v15, s[4:7], s57 offen offset:2048 sc1
buffer_load_dwordx4 v[124:127], v15, s[4:7], s57 offen offset:2560 sc1
s_waitcnt vmcnt(15) lgkmcnt(7)
v_mfma_f32_32x32x16_bf16 v[128:143], v[64:67], v[32:35], v[128:143]
s_waitcnt vmcnt(14) lgkmcnt(6)
v_mfma_f32_32x32x16_bf16 v[128:143], v[68:71], v[36:39], v[128:143]
s_waitcnt vmcnt(13) lgkmcnt(5)
v_mfma_f32_32x32x16_bf16 v[128:143], v[72:75], v[40:43], v[128:143]
s_waitcnt vmcnt(12) lgkmcnt(4)
v_mfma_f32_32x32x16_bf16 v[128:143], v[76:79], v[44:47], v[128:143]
s_waitcnt vmcnt(11) lgkmcnt(3)
v_mfma_f32_32x32x16_bf16 v[128:143], v[80:83], v[48:51], v[128:143]
s_waitcnt vmcnt(10) lgkmcnt(2)
v_mfma_f32_32x32x16_bf16 v[128:143], v[84:87], v[52:55], v[128:143]
s_waitcnt vmcnt(9) lgkmcnt(1)
v_mfma_f32_32x32x16_bf16 v[128:143], v[88:91], v[56:59], v[128:143]
s_waitcnt vmcnt(8) lgkmcnt(0)
v_mfma_f32_32x32x16_bf16 v[128:143], v[92:95], v[60:63], v[128:143]
s_lshl_b32 s18, s16, 4
s_add_u32 s29, s18, s52
s_lshl_b32 s18, s29, 19
s_lshl_b32 s19, s32, 14
s_add_u32 s18, s18, s19
s_add_u32 s29, s29, 1
s_and_b32 s19, s13, 1
s_lshr_b32 s20, s13, 1
v_and_b32 v14, 0x170, v14
v_lshl_add_u32 v14, s19, 12, v14
v_lshl_add_u32 v14, s20, 7, v14
v_lshl_add_u32 v15, s19, 3, v15
v_lshl_add_u32 v15, s20, 9, v15
s_add_u32 s54, s18, 110100480
s_add_u32 s55, s18, 110104576
s_add_u32 s56, s18, 110108672
s_add_u32 s57, s18, 110112768
v_max3_f32 v200, v128, v129, v130
v_max3_f32 v200, v200, v131, v132
v_max3_f32 v200, v200, v133, v134
v_max3_f32 v200, v200, v135, v136
v_max3_f32 v200, v200, v137, v138
v_max3_f32 v200, v200, v139, v140
v_max3_f32 v200, v200, v141, v142
v_max_f32 v200, v200, v143
s_add_u32 s18, s53, 8192
v_lshlrev_b32 v3, 3, v0
v_min_u32 v12, 128, v3
s_mov_b32 s17, 0
poll_71:
buffer_load_dword v8, v12, s[4:7], s18 offen sc1
s_add_u32 s17, s17, 1
s_cmp_gt_u32 s17, 262144
s_cbranch_scc1 L_fail
s_waitcnt vmcnt(0)
v_cmp_gt_u32 vcc, s29, v8
s_cbranch_vccz polld_72
s_sleep 2
s_branch poll_71
polld_72:
buffer_load_dwordx4 v[64:67], v14, s[4:7], s54 offen offset:0 sc1
buffer_load_dwordx4 v[68:71], v14, s[4:7], s54 offen offset:512 sc1
buffer_load_dwordx4 v[72:75], v14, s[4:7], s54 offen offset:1024 sc1
buffer_load_dwordx4 v[76:79], v14, s[4:7], s54 offen offset:1536 sc1
buffer_load_dwordx4 v[80:83], v14, s[4:7], s56 offen offset:0 sc1
buffer_load_dwordx4 v[84:87], v14, s[4:7], s56 offen offset:512 sc1
buffer_load_dwordx4 v[88:91], v14, s[4:7], s56 offen offset:1024 sc1
buffer_load_dwordx4 v[92:95], v14, s[4:7], s56 offen offset:1536 sc1
buffer_load_dwordx2 v[192:193], v15, s[4:7], s54 offen offset:2048 sc1
buffer_load_dwordx2 v[194:195], v15, s[4:7], s55 offen offset:2048 sc1
buffer_load_dwordx2 v[196:197], v15, s[4:7], s56 offen offset:2048 sc1
buffer_load_dwordx2 v[198:199], v15, s[4:7], s57 offen offset:2048 sc1
s_waitcnt vmcnt(11)
v_mfma_f32_32x32x16_bf16 v[144:159], v[64:67], v[32:35], 0
s_waitcnt vmcnt(10)
v_mfma_f32_32x32x16_bf16 v[144:159], v[68:71], v[36:39], v[144:159]
s_waitcnt vmcnt(9)
v_mfma_f32_32x32x16_bf16 v[144:159], v[72:75], v[40:43], v[144:159]
s_waitcnt vmcnt(8)
v_mfma_f32_32x32x16_bf16 v[144:159], v[76:79], v[44:47], v[144:159]
s_waitcnt vmcnt(7)
v_mfma_f32_32x32x16_bf16 v[144:159], v[80:83], v[48:51], v[144:159]
s_waitcnt vmcnt(6)
v_mfma_f32_32x32x16_bf16 v[144:159], v[84:87], v[52:55], v[144:159]
s_waitcnt vmcnt(5)
v_mfma_f32_32x32x16_bf16 v[144:159], v[88:91], v[56:59], v[144:159]
s_waitcnt vmcnt(4)
v_mfma_f32_32x32x16_bf16 v[144:159], v[92:95], v[60:63], v[144:159]
s_nop 11
v_max3_f32 v148, v200, v144, v145
v_max3_f32 v148, v148, v146, v147
v_mov_b32 v150, v148
s_nop 1
v_permlane32_swap_b32 v148, v150
v_max_f32 v148, v148, v150
v_sub_f32 v145, v145, v148
v_sub_f32 v146, v146, v148
v_sub_f32 v144, v144, v148
v_exp_f32 v145, v145
v_sub_f32 v147, v147, v148
v_exp_f32 v146, v146
v_exp_f32 v144, v144
v_exp_f32 v147, v147
v_cvt_pk_bf16_f32 v40, v144, v145
v_cvt_pk_bf16_f32 v41, v146, v147
v_sub_f32 v132, v132, v148
v_sub_f32 v128, v128, v148
s_waitcnt vmcnt(3)
v_mfma_f32_32x32x8_bf16 v[160:175], v[192:193], v[40:41], 0
v_sub_f32 v133, v133, v148
v_sub_f32 v130, v130, v148
v_sub_f32 v134, v134, v148
v_sub_f32 v131, v131, v148
v_exp_f32 v132, v132
s_waitcnt vmcnt(0)
v_mfma_f32_32x32x8_bf16 v[80:95], v[198:199], v[40:41], 0
v_sub_f32 v129, v129, v148
v_sub_f32 v135, v135, v148
v_exp_f32 v128, v128
v_exp_f32 v133, v133
v_mfma_f32_32x32x8_bf16 v[176:191], v[194:195], v[40:41], 0
v_exp_f32 v130, v130
v_exp_f32 v135, v135
v_exp_f32 v131, v131
v_mfma_f32_32x32x8_bf16 v[64:79], v[196:197], v[40:41], 0
v_exp_f32 v129, v129
v_cvt_pk_bf16_f32 v33, v130, v131
v_cvt_pk_bf16_f32 v34, v132, v133
v_exp_f32 v134, v134
v_cvt_pk_bf16_f32 v32, v128, v129
v_cvt_pk_bf16_f32 v35, v134, v135
v_sub_f32 v136, v136, v148
v_sub_f32 v140, v140, v148
v_mfma_f32_32x32x16_bf16 v[176:191], v[104:107], v[32:35], v[176:191]
v_sub_f32 v141, v141, v148
v_sub_f32 v142, v142, v148
v_sub_f32 v139, v139, v148
v_sub_f32 v138, v138, v148
v_sub_f32 v137, v137, v148
v_sub_f32 v143, v143, v148
v_mfma_f32_32x32x16_bf16 v[64:79], v[112:115], v[32:35], v[64:79]
v_exp_f32 v139, v139
v_exp_f32 v136, v136
v_exp_f32 v141, v141
v_mfma_f32_32x32x16_bf16 v[160:175], v[96:99], v[32:35], v[160:175]
s_add_u32 s19, s27, 4096
v_exp_f32 v142, v142
v_exp_f32 v143, v143
v_exp_f32 v138, v138
v_mfma_f32_32x32x16_bf16 v[80:95], v[120:123], v[32:35], v[80:95]
v_exp_f32 v137, v137
v_cvt_pk_bf16_f32 v37, v138, v139
v_cvt_pk_bf16_f32 v36, v136, v137
v_exp_f32 v140, v140
v_cvt_pk_bf16_f32 v39, v142, v143
v_cvt_pk_bf16_f32 v38, v140, v141
v_add_f32 v149, v128, v129
v_add_f32 v149, v149, v130
v_mfma_f32_32x32x16_bf16 v[160:175], v[100:103], v[36:39], v[160:175]
v_add_f32 v149, v149, v131
v_add_f32 v149, v149, v132
v_add_f32 v149, v149, v133
v_add_f32 v149, v149, v134
v_add_f32 v149, v149, v135
v_add_f32 v149, v149, v136
v_mfma_f32_32x32x16_bf16 v[176:191], v[108:111], v[36:39], v[176:191]
v_add_f32 v149, v149, v137
v_add_f32 v149, v149, v138
v_add_f32 v149, v149, v139
v_add_f32 v149, v149, v140
v_add_f32 v149, v149, v141
v_add_f32 v149, v149, v142
v_mfma_f32_32x32x16_bf16 v[80:95], v[124:127], v[36:39], v[80:95]
v_add_f32 v149, v149, v143
v_add_f32 v149, v149, v144
v_add_f32 v149, v149, v145
v_add_f32 v149, v149, v146
v_add_f32 v149, v149, v147
v_mov_b32 v150, v149
v_mfma_f32_32x32x16_bf16 v[64:79], v[116:119], v[36:39], v[64:79]
s_nop 0
v_permlane32_swap_b32 v149, v150
v_add_f32 v149, v149, v150
v_rcp_f32 v149, v149
s_nop 0
v_mul_f32 v171, v171, v149
v_mul_f32 v167, v167, v149
v_mul_f32 v160, v160, v149
v_mul_f32 v178, v178, v149
v_mul_f32 v191, v191, v149
v_mul_f32 v172, v172, v149
v_mul_f32 v162, v162, v149
v_mul_f32 v76, v76, v149
v_mul_f32 v161, v161, v149
v_mul_f32 v78, v78, v149
v_mul_f32 v163, v163, v149
v_mul_f32 v90, v90, v149
v_mul_f32 v177, v177, v149
v_mul_f32 v71, v71, v149
v_mul_f32 v174, v174, v149
v_mul_f32 v79, v79, v149
v_cvt_pk_bf16_f32 v160, v160, v161
v_mul_f32 v190, v190, v149
v_mul_f32 v181, v181, v149
v_mul_f32 v85, v85, v149
v_mul_f32 v176, v176, v149
v_mul_f32 v179, v179, v149
v_mul_f32 v80, v80, v149
v_mul_f32 v64, v64, v149
v_mul_f32 v73, v73, v149
v_mul_f32 v168, v168, v149
v_mul_f32 v87, v87, v149
v_mul_f32 v175, v175, v149
v_mul_f32 v188, v188, v149
v_mul_f32 v86, v86, v149
v_mul_f32 v182, v182, v149
v_mul_f32 v165, v165, v149
v_mul_f32 v65, v65, v149
v_mul_f32 v180, v180, v149
v_mul_f32 v164, v164, v149
v_mul_f32 v84, v84, v149
v_mul_f32 v170, v170, v149
v_cvt_pk_bf16_f32 v176, v176, v177
v_cvt_pk_bf16_f32 v177, v178, v179
v_mul_f32 v166, v166, v149
v_mul_f32 v169, v169, v149
v_mul_f32 v184, v184, v149
v_cvt_pk_bf16_f32 v161, v162, v163
v_cvt_pk_bf16_f32 v163, v166, v167
v_mul_f32 v173, v173, v149
v_mul_f32 v88, v88, v149
v_cvt_pk_bf16_f32 v162, v164, v165
v_mul_f32 v189, v189, v149
v_mul_f32 v74, v74, v149
v_mul_f32 v82, v82, v149
v_mul_f32 v81, v81, v149
v_mul_f32 v77, v77, v149
v_cvt_pk_bf16_f32 v64, v64, v65
v_mul_f32 v183, v183, v149
v_mul_f32 v185, v185, v149
v_cvt_pk_bf16_f32 v164, v168, v169
v_mul_f32 v68, v68, v149
v_cvt_pk_bf16_f32 v179, v182, v183
v_cvt_pk_bf16_f32 v167, v174, v175
v_cvt_pk_bf16_f32 v178, v180, v181
v_mul_f32 v93, v93, v149
v_mul_f32 v187, v187, v149
v_cvt_pk_bf16_f32 v166, v172, v173
v_mul_f32 v66, v66, v149
v_cvt_pk_bf16_f32 v165, v170, v171
v_mul_f32 v67, v67, v149
v_mul_f32 v69, v69, v149
v_mul_f32 v83, v83, v149
buffer_store_dwordx4 v[160:163], v0, s[4:7], s27 offen offset:0 sc1
buffer_store_dwordx4 v[164:167], v0, s[4:7], s27 offen offset:1024 sc1
buffer_store_dwordx4 v[176:179], v0, s[4:7], s27 offen offset:2048 sc1
v_mul_f32 v94, v94, v149
v_cvt_pk_bf16_f32 v180, v184, v185
v_mul_f32 v89, v89, v149
v_cvt_pk_bf16_f32 v65, v66, v67
v_cvt_pk_bf16_f32 v182, v188, v189
v_mul_f32 v72, v72, v149
v_mul_f32 v95, v95, v149
v_mul_f32 v186, v186, v149
v_mul_f32 v92, v92, v149
v_mul_f32 v70, v70, v149
v_mul_f32 v75, v75, v149
v_cvt_pk_bf16_f32 v80, v80, v81
v_cvt_pk_bf16_f32 v81, v82, v83
v_cvt_pk_bf16_f32 v67, v70, v71
v_cvt_pk_bf16_f32 v66, v68, v69
v_cvt_pk_bf16_f32 v83, v86, v87
v_cvt_pk_bf16_f32 v183, v190, v191
v_cvt_pk_bf16_f32 v70, v76, v77
v_cvt_pk_bf16_f32 v82, v84, v85
v_cvt_pk_bf16_f32 v71, v78, v79
v_cvt_pk_bf16_f32 v87, v94, v95
v_cvt_pk_bf16_f32 v69, v74, v75
v_cvt_pk_bf16_f32 v84, v88, v89
v_mul_f32 v91, v91, v149
v_cvt_pk_bf16_f32 v86, v92, v93
v_cvt_pk_bf16_f32 v85, v90, v91
v_cvt_pk_bf16_f32 v68, v72, v73
v_cvt_pk_bf16_f32 v181, v186, v187
buffer_store_dwordx4 v[180:183], v0, s[4:7], s27 offen offset:3072 sc1
buffer_store_dwordx4 v[64:67], v0, s[4:7], s19 offen offset:0 sc1
buffer_store_dwordx4 v[68:71], v0, s[4:7], s19 offen offset:1024 sc1
buffer_store_dwordx4 v[80:83], v0, s[4:7], s19 offen offset:2048 sc1
buffer_store_dwordx4 v[84:87], v0, s[4:7], s19 offen offset:3072 sc1
s_and_b32 s18, s30, 7
s_lshl_b32 s18, s18, 5
s_add_u32 s18, s18, s32
s_lshl_b32 s18, s18, 7
s_add_u32 s18, s18, 11632640
s_waitcnt vmcnt(0)
v_mov_b32 v3, s28
s_mov_b64 exec, 1
buffer_store_dword v3, off, s[4:7], s18 sc1
s_mov_b64 exec, -1
s_add_u32 s52, s52, 2
s_cmp_lt_u32 s52, 16
s_cbranch_scc1 qr_67
s_barrier
s_branch aend_63
wo_61:
s_sub_u32 s18, s39, 64
s_mul_i32 s30, s18, 3277
s_lshr_b32 s30, s30, 16
s_mul_i32 s19, s30, 20
s_sub_u32 s52, s18, s19
s_cmp_lg_u32 s16, 0
s_cbranch_scc1 ww_73
s_mul_i32 s26, s13, 1310720
s_lshl_b32 s18, s52, 6
s_add_u32 s26, s26, s18
s_load_dwordx2 s[40:41], s[0:1], 64
s_mov_b32 s42, 5242880
s_mov_b32 s43, 0x20000
s_waitcnt lgkmcnt(0)
v_lshrrev_b32 v214, 6, v0
v_mul_u32_u24 v214, 1280, v214
v_and_b32 v215, 48, v0
v_add_u32 v212, v214, v215
v_bfe_u32 v214, v0, 6, 2
v_lshrrev_b32 v215, 9, v0
v_lshl_add_u32 v214, v215, 3, v214
v_lshlrev_b32 v213, 6, v214
v_and_b32 v214, 16, v0
v_add_u32 v213, v213, v214
v_bfe_u32 v214, v0, 5, 1
v_lshl_add_u32 v213, v214, 3, v213
v_bfe_u32 v214, v0, 8, 1
v_lshl_add_u32 v213, v214, 5, v213
s_mul_i32 s18, s13, 36864
v_add_u32 v213, s18, v213
s_barrier
s_add_u32 m0, s18, 0
s_add_u32 s19, s26, 0
buffer_load_dwordx4 v212, s[40:43], s19 offen lds
s_add_u32 m0, s18, 1024
s_add_u32 s19, s26, 20480
buffer_load_dwordx4 v212, s[40:43], s19 offen lds
s_add_u32 m0, s18, 2048
s_add_u32 s19, s26, 40960
buffer_load_dwordx4 v212, s[40:43], s19 offen lds
s_add_u32 m0, s18, 3072
s_add_u32 s19, s26, 61440
buffer_load_dwordx4 v212, s[40:43], s19 offen lds
s_add_u32 m0, s18, 4096
s_add_u32 s19, s26, 81920
buffer_load_dwordx4 v212, s[40:43], s19 offen lds
s_add_u32 m0, s18, 5120
s_add_u32 s19, s26, 102400
buffer_load_dwordx4 v212, s[40:43], s19 offen lds
s_add_u32 m0, s18, 6144
s_add_u32 s19, s26, 122880
buffer_load_dwordx4 v212, s[40:43], s19 offen lds
s_add_u32 m0, s18, 7168
s_add_u32 s19, s26, 143360
buffer_load_dwordx4 v212, s[40:43], s19 offen lds
s_add_u32 m0, s18, 8192
s_add_u32 s19, s26, 163840
buffer_load_dwordx4 v212, s[40:43], s19 offen lds
s_add_u32 m0, s18, 9216
s_add_u32 s19, s26, 184320
buffer_load_dwordx4 v212, s[40:43], s19 offen lds
s_add_u32 m0, s18, 10240
s_add_u32 s19, s26, 204800
buffer_load_dwordx4 v212, s[40:43], s19 offen lds
s_add_u32 m0, s18, 11264
s_add_u32 s19, s26, 225280
buffer_load_dwordx4 v212, s[40:43], s19 offen lds
s_add_u32 m0, s18, 12288
s_add_u32 s19, s26, 245760
buffer_load_dwordx4 v212, s[40:43], s19 offen lds
s_add_u32 m0, s18, 13312
s_add_u32 s19, s26, 266240
buffer_load_dwordx4 v212, s[40:43], s19 offen lds
s_add_u32 m0, s18, 14336
s_add_u32 s19, s26, 286720
buffer_load_dwordx4 v212, s[40:43], s19 offen lds
s_add_u32 m0, s18, 15360
s_add_u32 s19, s26, 307200
buffer_load_dwordx4 v212, s[40:43], s19 offen lds
s_add_u32 m0, s18, 16384
s_add_u32 s19, s26, 327680
buffer_load_dwordx4 v212, s[40:43], s19 offen lds
s_add_u32 m0, s18, 17408
s_add_u32 s19, s26, 348160
buffer_load_dwordx4 v212, s[40:43], s19 offen lds
s_add_u32 m0, s18, 18432
s_add_u32 s19, s26, 368640
buffer_load_dwordx4 v212, s[40:43], s19 offen lds
s_add_u32 m0, s18, 19456
s_add_u32 s19, s26, 389120
buffer_load_dwordx4 v212, s[40:43], s19 offen lds
s_add_u32 m0, s18, 20480
s_add_u32 s19, s26, 409600
buffer_load_dwordx4 v212, s[40:43], s19 offen lds
s_add_u32 m0, s18, 21504
s_add_u32 s19, s26, 430080
buffer_load_dwordx4 v212, s[40:43], s19 offen lds
s_add_u32 m0, s18, 22528
s_add_u32 s19, s26, 450560
buffer_load_dwordx4 v212, s[40:43], s19 offen lds
s_add_u32 m0, s18, 23552
s_add_u32 s19, s26, 471040
buffer_load_dwordx4 v212, s[40:43], s19 offen lds
s_add_u32 m0, s18, 24576
s_add_u32 s19, s26, 491520
buffer_load_dwordx4 v212, s[40:43], s19 offen lds
s_add_u32 m0, s18, 25600
s_add_u32 s19, s26, 512000
buffer_load_dwordx4 v212, s[40:43], s19 offen lds
s_add_u32 m0, s18, 26624
s_add_u32 s19, s26, 532480
buffer_load_dwordx4 v212, s[40:43], s19 offen lds
s_add_u32 m0, s18, 27648
s_add_u32 s19, s26, 552960
buffer_load_dwordx4 v212, s[40:43], s19 offen lds
s_add_u32 m0, s18, 28672
s_add_u32 s19, s26, 573440
buffer_load_dwordx4 v212, s[40:43], s19 offen lds
s_add_u32 m0, s18, 29696
s_add_u32 s19, s26, 593920
buffer_load_dwordx4 v212, s[40:43], s19 offen lds
s_add_u32 m0, s18, 30720
s_add_u32 s19, s26, 614400
buffer_load_dwordx4 v212, s[40:43], s19 offen lds
s_add_u32 m0, s18, 31744
s_add_u32 s19, s26, 634880
buffer_load_dwordx4 v212, s[40:43], s19 offen lds
s_add_u32 m0, s18, 32768
s_add_u32 s19, s26, 655360
buffer_load_dwordx4 v212, s[40:43], s19 offen lds
s_add_u32 m0, s18, 33792
s_add_u32 s19, s26, 675840
buffer_load_dwordx4 v212, s[40:43], s19 offen lds
s_add_u32 m0, s18, 34816
s_add_u32 s19, s26, 696320
buffer_load_dwordx4 v212, s[40:43], s19 offen lds
s_add_u32 m0, s18, 35840
s_add_u32 s19, s26, 716800
buffer_load_dwordx4 v212, s[40:43], s19 offen lds
s_waitcnt vmcnt(32)
ds_read_b64_tr_b16 a[0:1], v213 offset:0
ds_read_b64_tr_b16 a[2:3], v213 offset:256
ds_read_b64_tr_b16 a[4:5], v213 offset:1024
ds_read_b64_tr_b16 a[6:7], v213 offset:1280
ds_read_b64_tr_b16 a[8:9], v213 offset:2048
ds_read_b64_tr_b16 a[10:11], v213 offset:2304
ds_read_b64_tr_b16 a[12:13], v213 offset:3072
ds_read_b64_tr_b16 a[14:15], v213 offset:3328
s_waitcnt lgkmcnt(0)
s_add_u32 m0, s18, 0
s_add_u32 s19, s26, 737280
buffer_load_dwordx4 v212, s[40:43], s19 offen lds
s_add_u32 m0, s18, 1024
s_add_u32 s19, s26, 757760
buffer_load_dwordx4 v212, s[40:43], s19 offen lds
s_add_u32 m0, s18, 2048
s_add_u32 s19, s26, 778240
buffer_load_dwordx4 v212, s[40:43], s19 offen lds
s_add_u32 m0, s18, 3072
s_add_u32 s19, s26, 798720
buffer_load_dwordx4 v212, s[40:43], s19 offen lds
s_waitcnt vmcnt(32)
ds_read_b64_tr_b16 a[16:17], v213 offset:4096
ds_read_b64_tr_b16 a[18:19], v213 offset:4352
ds_read_b64_tr_b16 a[20:21], v213 offset:5120
ds_read_b64_tr_b16 a[22:23], v213 offset:5376
ds_read_b64_tr_b16 a[24:25], v213 offset:6144
ds_read_b64_tr_b16 a[26:27], v213 offset:6400
ds_read_b64_tr_b16 a[28:29], v213 offset:7168
ds_read_b64_tr_b16 a[30:31], v213 offset:7424
s_waitcnt lgkmcnt(0)
s_add_u32 m0, s18, 4096
s_add_u32 s19, s26, 819200
buffer_load_dwordx4 v212, s[40:43], s19 offen lds
s_add_u32 m0, s18, 5120
s_add_u32 s19, s26, 839680
buffer_load_dwordx4 v212, s[40:43], s19 offen lds
s_add_u32 m0, s18, 6144
s_add_u32 s19, s26, 860160
buffer_load_dwordx4 v212, s[40:43], s19 offen lds
s_add_u32 m0, s18, 7168
s_add_u32 s19, s26, 880640
buffer_load_dwordx4 v212, s[40:43], s19 offen lds
s_waitcnt vmcnt(32)
ds_read_b64_tr_b16 a[32:33], v213 offset:8192
ds_read_b64_tr_b16 a[34:35], v213 offset:8448
ds_read_b64_tr_b16 a[36:37], v213 offset:9216
ds_read_b64_tr_b16 a[38:39], v213 offset:9472
ds_read_b64_tr_b16 a[40:41], v213 offset:10240
ds_read_b64_tr_b16 a[42:43], v213 offset:10496
ds_read_b64_tr_b16 a[44:45], v213 offset:11264
ds_read_b64_tr_b16 a[46:47], v213 offset:11520
s_waitcnt lgkmcnt(0)
s_add_u32 m0, s18, 8192
s_add_u32 s19, s26, 901120
buffer_load_dwordx4 v212, s[40:43], s19 offen lds
s_add_u32 m0, s18, 9216
s_add_u32 s19, s26, 921600
buffer_load_dwordx4 v212, s[40:43], s19 offen lds
s_add_u32 m0, s18, 10240
s_add_u32 s19, s26, 942080
buffer_load_dwordx4 v212, s[40:43], s19 offen lds
s_add_u32 m0, s18, 11264
s_add_u32 s19, s26, 962560
buffer_load_dwordx4 v212, s[40:43], s19 offen lds
s_waitcnt vmcnt(32)
ds_read_b64_tr_b16 a[48:49], v213 offset:12288
ds_read_b64_tr_b16 a[50:51], v213 offset:12544
ds_read_b64_tr_b16 a[52:53], v213 offset:13312
ds_read_b64_tr_b16 a[54:55], v213 offset:13568
ds_read_b64_tr_b16 a[56:57], v213 offset:14336
ds_read_b64_tr_b16 a[58:59], v213 offset:14592
ds_read_b64_tr_b16 a[60:61], v213 offset:15360
ds_read_b64_tr_b16 a[62:63], v213 offset:15616
s_waitcnt lgkmcnt(0)
s_add_u32 m0, s18, 12288
s_add_u32 s19, s26, 983040
buffer_load_dwordx4 v212, s[40:43], s19 offen lds
s_add_u32 m0, s18, 13312
s_add_u32 s19, s26, 1003520
buffer_load_dwordx4 v212, s[40:43], s19 offen lds
s_add_u32 m0, s18, 14336
s_add_u32 s19, s26, 1024000
buffer_load_dwordx4 v212, s[40:43], s19 offen lds
s_add_u32 m0, s18, 15360
s_add_u32 s19, s26, 1044480
buffer_load_dwordx4 v212, s[40:43], s19 offen lds
s_waitcnt vmcnt(32)
ds_read_b64_tr_b16 a[64:65], v213 offset:16384
ds_read_b64_tr_b16 a[66:67], v213 offset:16640
ds_read_b64_tr_b16 a[68:69], v213 offset:17408
ds_read_b64_tr_b16 a[70:71], v213 offset:17664
ds_read_b64_tr_b16 a[72:73], v213 offset:18432
ds_read_b64_tr_b16 a[74:75], v213 offset:18688
ds_read_b64_tr_b16 a[76:77], v213 offset:19456
ds_read_b64_tr_b16 a[78:79], v213 offset:19712
s_waitcnt lgkmcnt(0)
s_add_u32 m0, s18, 16384
s_add_u32 s19, s26, 1064960
buffer_load_dwordx4 v212, s[40:43], s19 offen lds
s_add_u32 m0, s18, 17408
s_add_u32 s19, s26, 1085440
buffer_load_dwordx4 v212, s[40:43], s19 offen lds
s_add_u32 m0, s18, 18432
s_add_u32 s19, s26, 1105920
buffer_load_dwordx4 v212, s[40:43], s19 offen lds
s_add_u32 m0, s18, 19456
s_add_u32 s19, s26, 1126400
buffer_load_dwordx4 v212, s[40:43], s19 offen lds
s_waitcnt vmcnt(32)
ds_read_b64_tr_b16 a[80:81], v213 offset:20480
ds_read_b64_tr_b16 a[82:83], v213 offset:20736
ds_read_b64_tr_b16 a[84:85], v213 offset:21504
ds_read_b64_tr_b16 a[86:87], v213 offset:21760
ds_read_b64_tr_b16 a[88:89], v213 offset:22528
ds_read_b64_tr_b16 a[90:91], v213 offset:22784
ds_read_b64_tr_b16 a[92:93], v213 offset:23552
ds_read_b64_tr_b16 a[94:95], v213 offset:23808
s_waitcnt lgkmcnt(0)
s_add_u32 m0, s18, 20480
s_add_u32 s19, s26, 1146880
buffer_load_dwordx4 v212, s[40:43], s19 offen lds
s_add_u32 m0, s18, 21504
s_add_u32 s19, s26, 1167360
buffer_load_dwordx4 v212, s[40:43], s19 offen lds
s_add_u32 m0, s18, 22528
s_add_u32 s19, s26, 1187840
buffer_load_dwordx4 v212, s[40:43], s19 offen lds
s_add_u32 m0, s18, 23552
s_add_u32 s19, s26, 1208320
buffer_load_dwordx4 v212, s[40:43], s19 offen lds
s_waitcnt vmcnt(32)
ds_read_b64_tr_b16 a[96:97], v213 offset:24576
ds_read_b64_tr_b16 a[98:99], v213 offset:24832
ds_read_b64_tr_b16 a[100:101], v213 offset:25600
ds_read_b64_tr_b16 a[102:103], v213 offset:25856
ds_read_b64_tr_b16 a[104:105], v213 offset:26624
ds_read_b64_tr_b16 a[106:107], v213 offset:26880
ds_read_b64_tr_b16 a[108:109], v213 offset:27648
ds_read_b64_tr_b16 a[110:111], v213 offset:27904
s_waitcnt lgkmcnt(0)
s_add_u32 m0, s18, 24576
s_add_u32 s19, s26, 1228800
buffer_load_dwordx4 v212, s[40:43], s19 offen lds
s_add_u32 m0, s18, 25600
s_add_u32 s19, s26, 1249280
buffer_load_dwordx4 v212, s[40:43], s19 offen lds
s_add_u32 m0, s18, 26624
s_add_u32 s19, s26, 1269760
buffer_load_dwordx4 v212, s[40:43], s19 offen lds
s_add_u32 m0, s18, 27648
s_add_u32 s19, s26, 1290240
buffer_load_dwordx4 v212, s[40:43], s19 offen lds
s_waitcnt vmcnt(32)
ds_read_b64_tr_b16 a[112:113], v213 offset:28672
ds_read_b64_tr_b16 a[114:115], v213 offset:28928
ds_read_b64_tr_b16 a[116:117], v213 offset:29696
ds_read_b64_tr_b16 a[118:119], v213 offset:29952
ds_read_b64_tr_b16 a[120:121], v213 offset:30720
ds_read_b64_tr_b16 a[122:123], v213 offset:30976
ds_read_b64_tr_b16 a[124:125], v213 offset:31744
ds_read_b64_tr_b16 a[126:127], v213 offset:32000
s_waitcnt vmcnt(28)
ds_read_b64_tr_b16 a[128:129], v213 offset:32768
ds_read_b64_tr_b16 a[130:131], v213 offset:33024
ds_read_b64_tr_b16 a[132:133], v213 offset:33792
ds_read_b64_tr_b16 a[134:135], v213 offset:34048
ds_read_b64_tr_b16 a[136:137], v213 offset:34816
ds_read_b64_tr_b16 a[138:139], v213 offset:35072
ds_read_b64_tr_b16 a[140:141], v213 offset:35840
ds_read_b64_tr_b16 a[142:143], v213 offset:36096
s_waitcnt vmcnt(24)
ds_read_b64_tr_b16 a[144:145], v213 offset:0
ds_read_b64_tr_b16 a[146:147], v213 offset:256
ds_read_b64_tr_b16 a[148:149], v213 offset:1024
ds_read_b64_tr_b16 a[150:151], v213 offset:1280
ds_read_b64_tr_b16 a[152:153], v213 offset:2048
ds_read_b64_tr_b16 a[154:155], v213 offset:2304
ds_read_b64_tr_b16 a[156:157], v213 offset:3072
ds_read_b64_tr_b16 a[158:159], v213 offset:3328
s_waitcnt vmcnt(20)
ds_read_b64_tr_b16 a[160:161], v213 offset:4096
ds_read_b64_tr_b16 a[162:163], v213 offset:4352
ds_read_b64_tr_b16 a[164:165], v213 offset:5120
ds_read_b64_tr_b16 a[166:167], v213 offset:5376
ds_read_b64_tr_b16 a[168:169], v213 offset:6144
ds_read_b64_tr_b16 a[170:171], v213 offset:6400
ds_read_b64_tr_b16 a[172:173], v213 offset:7168
ds_read_b64_tr_b16 a[174:175], v213 offset:7424
s_waitcnt vmcnt(16)
ds_read_b64_tr_b16 a[176:177], v213 offset:8192
ds_read_b64_tr_b16 a[178:179], v213 offset:8448
ds_read_b64_tr_b16 a[180:181], v213 offset:9216
ds_read_b64_tr_b16 a[182:183], v213 offset:9472
ds_read_b64_tr_b16 a[184:185], v213 offset:10240
ds_read_b64_tr_b16 a[186:187], v213 offset:10496
ds_read_b64_tr_b16 a[188:189], v213 offset:11264
ds_read_b64_tr_b16 a[190:191], v213 offset:11520
s_waitcnt vmcnt(12)
ds_read_b64_tr_b16 a[192:193], v213 offset:12288
ds_read_b64_tr_b16 a[194:195], v213 offset:12544
ds_read_b64_tr_b16 a[196:197], v213 offset:13312
ds_read_b64_tr_b16 a[198:199], v213 offset:13568
ds_read_b64_tr_b16 a[200:201], v213 offset:14336
ds_read_b64_tr_b16 a[202:203], v213 offset:14592
ds_read_b64_tr_b16 a[204:205], v213 offset:15360
ds_read_b64_tr_b16 a[206:207], v213 offset:15616
s_waitcnt vmcnt(8)
ds_read_b64_tr_b16 a[208:209], v213 offset:16384
ds_read_b64_tr_b16 a[210:211], v213 offset:16640
ds_read_b64_tr_b16 a[212:213], v213 offset:17408
ds_read_b64_tr_b16 a[214:215], v213 offset:17664
ds_read_b64_tr_b16 a[216:217], v213 offset:18432
ds_read_b64_tr_b16 a[218:219], v213 offset:18688
ds_read_b64_tr_b16 a[220:221], v213 offset:19456
ds_read_b64_tr_b16 a[222:223], v213 offset:19712
s_waitcnt vmcnt(4)
ds_read_b64_tr_b16 a[224:225], v213 offset:20480
ds_read_b64_tr_b16 a[226:227], v213 offset:20736
ds_read_b64_tr_b16 a[228:229], v213 offset:21504
ds_read_b64_tr_b16 a[230:231], v213 offset:21760
ds_read_b64_tr_b16 a[232:233], v213 offset:22528
ds_read_b64_tr_b16 a[234:235], v213 offset:22784
ds_read_b64_tr_b16 a[236:237], v213 offset:23552
ds_read_b64_tr_b16 a[238:239], v213 offset:23808
s_waitcnt vmcnt(0)
ds_read_b64_tr_b16 a[240:241], v213 offset:24576
ds_read_b64_tr_b16 a[242:243], v213 offset:24832
ds_read_b64_tr_b16 a[244:245], v213 offset:25600
ds_read_b64_tr_b16 a[246:247], v213 offset:25856
ds_read_b64_tr_b16 a[248:249], v213 offset:26624
ds_read_b64_tr_b16 a[250:251], v213 offset:26880
ds_read_b64_tr_b16 a[252:253], v213 offset:27648
ds_read_b64_tr_b16 a[254:255], v213 offset:27904
s_waitcnt lgkmcnt(0)
s_barrier
ww_73:
s_load_dwordx2 s[56:57], s[0:1], 80
s_mov_b32 s58, 2621440
s_mov_b32 s59, 0x20000
s_waitcnt lgkmcnt(0)
s_lshl_b32 s18, s13, 12
v_add_u32 v13, s18, v0
s_lshl_b32 s18, s13, 11
v_add_u32 v14, s18, v0
s_add_u32 s53, s30, 56
s_cmp_eq_u32 s30, 3
s_cselect_b32 s30, s53, s30
ws_74:
s_lshl_b32 s18, s16, 6
s_add_u32 s18, s18, s30
s_lshl_b32 s26, s18, 18
s_lshl_b32 s19, s13, 16
s_add_u32 s26, s26, s19
s_add_u32 s26, s26, 127926272
s_add_u32 s38, s18, 1
s_and_b32 s18, s18, 7
s_lshl_b32 s18, s18, 12
s_add_u32 s18, s18, s37
s_add_u32 s28, s18, 11632640
s_mul_i32 s27, s30, 40960
s_and_b32 s18, s13, 1
s_lshl_b32 s19, s52, 1
s_add_u32 s29, s18, s19
v_lshlrev_b32 v3, 3, v0
v_min_u32 v12, 896, v3
s_mov_b32 s17, 0
poll_78:
buffer_load_dword v8, v12, s[4:7], s28 offen sc1
s_add_u32 s17, s17, 1
s_cmp_gt_u32 s17, 262144
s_cbranch_scc1 L_fail
s_waitcnt vmcnt(0)
v_cmp_gt_u32 vcc, s38, v8
s_cbranch_vccz polld_79
s_sleep 2
s_branch poll_78
polld_79:
s_lshl_b32 s18, s29, 10
s_add_u32 s18, s18, s27
s_mul_i32 s19, s16, 6291456
s_add_u32 s18, s18, s19
s_add_u32 s18, s18, 88080384
s_add_u32 s19, s26, 0
buffer_load_dwordx4 v[16:19], v0, s[4:7], s19 offen offset:0 sc1
buffer_load_dwordx4 v[20:23], v0, s[4:7], s19 offen offset:1024 sc1
buffer_load_dwordx4 v[24:27], v0, s[4:7], s19 offen offset:2048 sc1
buffer_load_dwordx4 v[28:31], v0, s[4:7], s19 offen offset:3072 sc1
s_add_u32 s19, s26, 4096
buffer_load_dwordx4 v[32:35], v0, s[4:7], s19 offen offset:0 sc1
buffer_load_dwordx4 v[36:39], v0, s[4:7], s19 offen offset:1024 sc1
buffer_load_dwordx4 v[40:43], v0, s[4:7], s19 offen offset:2048 sc1
buffer_load_dwordx4 v[44:47], v0, s[4:7], s19 offen offset:3072 sc1
s_add_u32 s19, s26, 8192
buffer_load_dwordx4 v[48:51], v0, s[4:7], s19 offen offset:0 sc1
buffer_load_dwordx4 v[52:55], v0, s[4:7], s19 offen offset:1024 sc1
buffer_load_dwordx4 v[56:59], v0, s[4:7], s19 offen offset:2048 sc1
buffer_load_dwordx4 v[60:63], v0, s[4:7], s19 offen offset:3072 sc1
s_add_u32 s19, s26, 12288
buffer_load_dwordx4 v[64:67], v0, s[4:7], s19 offen offset:0 sc1
buffer_load_dwordx4 v[68:71], v0, s[4:7], s19 offen offset:1024 sc1
buffer_load_dwordx4 v[72:75], v0, s[4:7], s19 offen offset:2048 sc1
buffer_load_dwordx4 v[76:79], v0, s[4:7], s19 offen offset:3072 sc1
s_add_u32 s19, s26, 16384
buffer_load_dwordx4 v[80:83], v0, s[4:7], s19 offen offset:0 sc1
buffer_load_dwordx4 v[84:87], v0, s[4:7], s19 offen offset:1024 sc1
buffer_load_dwordx4 v[88:91], v0, s[4:7], s19 offen offset:2048 sc1
buffer_load_dwordx4 v[92:95], v0, s[4:7], s19 offen offset:3072 sc1
s_add_u32 s19, s26, 20480
buffer_load_dwordx4 v[96:99], v0, s[4:7], s19 offen offset:0 sc1
buffer_load_dwordx4 v[100:103], v0, s[4:7], s19 offen offset:1024 sc1
buffer_load_dwordx4 v[104:107], v0, s[4:7], s19 offen offset:2048 sc1
buffer_load_dwordx4 v[108:111], v0, s[4:7], s19 offen offset:3072 sc1
s_add_u32 s19, s26, 24576
buffer_load_dwordx4 v[112:115], v0, s[4:7], s19 offen offset:0 sc1
buffer_load_dwordx4 v[116:119], v0, s[4:7], s19 offen offset:1024 sc1
buffer_load_dwordx4 v[120:123], v0, s[4:7], s19 offen offset:2048 sc1
buffer_load_dwordx4 v[124:127], v0, s[4:7], s19 offen offset:3072 sc1
s_add_u32 s19, s26, 28672
buffer_load_dwordx4 v[128:131], v0, s[4:7], s19 offen offset:0 sc1
buffer_load_dwordx4 v[132:135], v0, s[4:7], s19 offen offset:1024 sc1
buffer_load_dwordx4 v[136:139], v0, s[4:7], s19 offen offset:2048 sc1
buffer_load_dwordx4 v[140:143], v0, s[4:7], s19 offen offset:3072 sc1
s_add_u32 s19, s26, 32768
buffer_load_dwordx4 v[144:147], v0, s[4:7], s19 offen offset:0 sc1
buffer_load_dwordx4 v[148:151], v0, s[4:7], s19 offen offset:1024 sc1
buffer_load_dwordx4 v[152:155], v0, s[4:7], s19 offen offset:2048 sc1
buffer_load_dwordx4 v[156:159], v0, s[4:7], s19 offen offset:3072 sc1
s_add_u32 s19, s26, 36864
buffer_load_dwordx4 v[160:163], v0, s[4:7], s19 offen offset:0 sc1
buffer_load_dwordx4 v[164:167], v0, s[4:7], s19 offen offset:1024 sc1
buffer_load_dwordx4 v[168:171], v0, s[4:7], s19 offen offset:2048 sc1
buffer_load_dwordx4 v[172:175], v0, s[4:7], s19 offen offset:3072 sc1
s_add_u32 s19, s26, 40960
buffer_load_dwordx4 v[176:179], v0, s[4:7], s19 offen offset:0 sc1
buffer_load_dwordx4 v[180:183], v0, s[4:7], s19 offen offset:1024 sc1
buffer_load_dwordx4 v[184:187], v0, s[4:7], s19 offen offset:2048 sc1
buffer_load_dwordx4 v[188:191], v0, s[4:7], s19 offen offset:3072 sc1
s_waitcnt vmcnt(43)
v_mfma_f32_32x32x16_bf16 v[192:207], a[0:3], v[16:19], 0
s_add_u32 s19, s26, 45056
buffer_load_dwordx4 v[16:19], v0, s[4:7], s19 offen offset:0 sc1
s_waitcnt vmcnt(43)
v_mfma_f32_32x32x16_bf16 v[192:207], a[4:7], v[20:23], v[192:207]
buffer_load_dwordx4 v[20:23], v0, s[4:7], s19 offen offset:1024 sc1
s_waitcnt vmcnt(43)
v_mfma_f32_32x32x16_bf16 v[192:207], a[8:11], v[24:27], v[192:207]
buffer_load_dwordx4 v[24:27], v0, s[4:7], s19 offen offset:2048 sc1
s_waitcnt vmcnt(43)
v_mfma_f32_32x32x16_bf16 v[192:207], a[12:15], v[28:31], v[192:207]
buffer_load_dwordx4 v[28:31], v0, s[4:7], s19 offen offset:3072 sc1
s_waitcnt vmcnt(43)
v_mfma_f32_32x32x16_bf16 v[192:207], a[16:19], v[32:35], v[192:207]
s_add_u32 s19, s26, 49152
buffer_load_dwordx4 v[32:35], v0, s[4:7], s19 offen offset:0 sc1
s_waitcnt vmcnt(43)
v_mfma_f32_32x32x16_bf16 v[192:207], a[20:23], v[36:39], v[192:207]
buffer_load_dwordx4 v[36:39], v0, s[4:7], s19 offen offset:1024 sc1
s_waitcnt vmcnt(43)
v_mfma_f32_32x32x16_bf16 v[192:207], a[24:27], v[40:43], v[192:207]
buffer_load_dwordx4 v[40:43], v0, s[4:7], s19 offen offset:2048 sc1
s_waitcnt vmcnt(43)
v_mfma_f32_32x32x16_bf16 v[192:207], a[28:31], v[44:47], v[192:207]
buffer_load_dwordx4 v[44:47], v0, s[4:7], s19 offen offset:3072 sc1
s_waitcnt vmcnt(43)
v_mfma_f32_32x32x16_bf16 v[192:207], a[32:35], v[48:51], v[192:207]
s_add_u32 s19, s26, 53248
buffer_load_dwordx4 v[48:51], v0, s[4:7], s19 offen offset:0 sc1
s_waitcnt vmcnt(43)
v_mfma_f32_32x32x16_bf16 v[192:207], a[36:39], v[52:55], v[192:207]
buffer_load_dwordx4 v[52:55], v0, s[4:7], s19 offen offset:1024 sc1
s_waitcnt vmcnt(43)
v_mfma_f32_32x32x16_bf16 v[192:207], a[40:43], v[56:59], v[192:207]
buffer_load_dwordx4 v[56:59], v0, s[4:7], s19 offen offset:2048 sc1
s_waitcnt vmcnt(43)
v_mfma_f32_32x32x16_bf16 v[192:207], a[44:47], v[60:63], v[192:207]
buffer_load_dwordx4 v[60:63], v0, s[4:7], s19 offen offset:3072 sc1
s_waitcnt vmcnt(43)
v_mfma_f32_32x32x16_bf16 v[192:207], a[48:51], v[64:67], v[192:207]
s_add_u32 s19, s26, 57344
buffer_load_dwordx4 v[64:67], v0, s[4:7], s19 offen offset:0 sc1
s_waitcnt vmcnt(43)
v_mfma_f32_32x32x16_bf16 v[192:207], a[52:55], v[68:71], v[192:207]
buffer_load_dwordx4 v[68:71], v0, s[4:7], s19 offen offset:1024 sc1
s_waitcnt vmcnt(43)
v_mfma_f32_32x32x16_bf16 v[192:207], a[56:59], v[72:75], v[192:207]
buffer_load_dwordx4 v[72:75], v0, s[4:7], s19 offen offset:2048 sc1
s_waitcnt vmcnt(43)
v_mfma_f32_32x32x16_bf16 v[192:207], a[60:63], v[76:79], v[192:207]
buffer_load_dwordx4 v[76:79], v0, s[4:7], s19 offen offset:3072 sc1
s_waitcnt vmcnt(43)
v_mfma_f32_32x32x16_bf16 v[192:207], a[64:67], v[80:83], v[192:207]
s_add_u32 s19, s26, 61440
buffer_load_dwordx4 v[80:83], v0, s[4:7], s19 offen offset:0 sc1
s_waitcnt vmcnt(43)
v_mfma_f32_32x32x16_bf16 v[192:207], a[68:71], v[84:87], v[192:207]
buffer_load_dwordx4 v[84:87], v0, s[4:7], s19 offen offset:1024 sc1
s_waitcnt vmcnt(43)
v_mfma_f32_32x32x16_bf16 v[192:207], a[72:75], v[88:91], v[192:207]
buffer_load_dwordx4 v[88:91], v0, s[4:7], s19 offen offset:2048 sc1
s_waitcnt vmcnt(43)
v_mfma_f32_32x32x16_bf16 v[192:207], a[76:79], v[92:95], v[192:207]
buffer_load_dwordx4 v[92:95], v0, s[4:7], s19 offen offset:3072 sc1
s_waitcnt vmcnt(43)
v_mfma_f32_32x32x16_bf16 v[192:207], a[80:83], v[96:99], v[192:207]
buffer_load_dwordx4 v[208:211], v0, s[4:7], s18 offen sc1
s_waitcnt vmcnt(43)
v_mfma_f32_32x32x16_bf16 v[192:207], a[84:87], v[100:103], v[192:207]
s_waitcnt vmcnt(42)
v_mfma_f32_32x32x16_bf16 v[192:207], a[88:91], v[104:107], v[192:207]
s_waitcnt vmcnt(41)
v_mfma_f32_32x32x16_bf16 v[192:207], a[92:95], v[108:111], v[192:207]
s_waitcnt vmcnt(40)
v_mfma_f32_32x32x16_bf16 v[192:207], a[96:99], v[112:115], v[192:207]
s_waitcnt vmcnt(39)
v_mfma_f32_32x32x16_bf16 v[192:207], a[100:103], v[116:119], v[192:207]
s_waitcnt vmcnt(38)
v_mfma_f32_32x32x16_bf16 v[192:207], a[104:107], v[120:123], v[192:207]
s_waitcnt vmcnt(37)
v_mfma_f32_32x32x16_bf16 v[192:207], a[108:111], v[124:127], v[192:207]
s_waitcnt vmcnt(36)
v_mfma_f32_32x32x16_bf16 v[192:207], a[112:115], v[128:131], v[192:207]
s_waitcnt vmcnt(35)
v_mfma_f32_32x32x16_bf16 v[192:207], a[116:119], v[132:135], v[192:207]
s_waitcnt vmcnt(34)
v_mfma_f32_32x32x16_bf16 v[192:207], a[120:123], v[136:139], v[192:207]
s_waitcnt vmcnt(33)
v_mfma_f32_32x32x16_bf16 v[192:207], a[124:127], v[140:143], v[192:207]
s_waitcnt vmcnt(32)
v_mfma_f32_32x32x16_bf16 v[192:207], a[128:131], v[144:147], v[192:207]
s_waitcnt vmcnt(31)
v_mfma_f32_32x32x16_bf16 v[192:207], a[132:135], v[148:151], v[192:207]
s_waitcnt vmcnt(30)
v_mfma_f32_32x32x16_bf16 v[192:207], a[136:139], v[152:155], v[192:207]
s_waitcnt vmcnt(29)
v_mfma_f32_32x32x16_bf16 v[192:207], a[140:143], v[156:159], v[192:207]
s_waitcnt vmcnt(28)
v_mfma_f32_32x32x16_bf16 v[192:207], a[144:147], v[160:163], v[192:207]
s_waitcnt vmcnt(27)
v_mfma_f32_32x32x16_bf16 v[192:207], a[148:151], v[164:167], v[192:207]
s_waitcnt vmcnt(26)
v_mfma_f32_32x32x16_bf16 v[192:207], a[152:155], v[168:171], v[192:207]
s_waitcnt vmcnt(25)
v_mfma_f32_32x32x16_bf16 v[192:207], a[156:159], v[172:175], v[192:207]
s_waitcnt vmcnt(24)
v_mfma_f32_32x32x16_bf16 v[192:207], a[160:163], v[176:179], v[192:207]
s_waitcnt vmcnt(23)
v_mfma_f32_32x32x16_bf16 v[192:207], a[164:167], v[180:183], v[192:207]
s_waitcnt vmcnt(22)
v_mfma_f32_32x32x16_bf16 v[192:207], a[168:171], v[184:187], v[192:207]
s_waitcnt vmcnt(21)
v_mfma_f32_32x32x16_bf16 v[192:207], a[172:175], v[188:191], v[192:207]
s_waitcnt vmcnt(20)
v_mfma_f32_32x32x16_bf16 v[192:207], a[176:179], v[16:19], v[192:207]
s_waitcnt vmcnt(19)
v_mfma_f32_32x32x16_bf16 v[192:207], a[180:183], v[20:23], v[192:207]
s_waitcnt vmcnt(18)
v_mfma_f32_32x32x16_bf16 v[192:207], a[184:187], v[24:27], v[192:207]
s_waitcnt vmcnt(17)
v_mfma_f32_32x32x16_bf16 v[192:207], a[188:191], v[28:31], v[192:207]
s_waitcnt vmcnt(16)
v_mfma_f32_32x32x16_bf16 v[192:207], a[192:195], v[32:35], v[192:207]
s_waitcnt vmcnt(15)
v_mfma_f32_32x32x16_bf16 v[192:207], a[196:199], v[36:39], v[192:207]
s_waitcnt vmcnt(14)
v_mfma_f32_32x32x16_bf16 v[192:207], a[200:203], v[40:43], v[192:207]
s_waitcnt vmcnt(13)
v_mfma_f32_32x32x16_bf16 v[192:207], a[204:207], v[44:47], v[192:207]
s_waitcnt vmcnt(12)
v_mfma_f32_32x32x16_bf16 v[192:207], a[208:211], v[48:51], v[192:207]
s_waitcnt vmcnt(11)
v_mfma_f32_32x32x16_bf16 v[192:207], a[212:215], v[52:55], v[192:207]
s_waitcnt vmcnt(10)
v_mfma_f32_32x32x16_bf16 v[192:207], a[216:219], v[56:59], v[192:207]
s_waitcnt vmcnt(9)
v_mfma_f32_32x32x16_bf16 v[192:207], a[220:223], v[60:63], v[192:207]
s_waitcnt vmcnt(8)
v_mfma_f32_32x32x16_bf16 v[192:207], a[224:227], v[64:67], v[192:207]
s_waitcnt vmcnt(7)
v_mfma_f32_32x32x16_bf16 v[192:207], a[228:231], v[68:71], v[192:207]
s_waitcnt vmcnt(6)
v_mfma_f32_32x32x16_bf16 v[192:207], a[232:235], v[72:75], v[192:207]
s_waitcnt vmcnt(5)
v_mfma_f32_32x32x16_bf16 v[192:207], a[236:239], v[76:79], v[192:207]
s_waitcnt vmcnt(4)
v_mfma_f32_32x32x16_bf16 v[192:207], a[240:243], v[80:83], v[192:207]
s_waitcnt vmcnt(3)
v_mfma_f32_32x32x16_bf16 v[192:207], a[244:247], v[84:87], v[192:207]
s_waitcnt vmcnt(2)
v_mfma_f32_32x32x16_bf16 v[192:207], a[248:251], v[88:91], v[192:207]
s_waitcnt vmcnt(1)
v_mfma_f32_32x32x16_bf16 v[192:207], a[252:255], v[92:95], v[192:207]
s_nop 11
ds_write_b128 v13, v[192:195] offset:0
ds_write_b128 v13, v[196:199] offset:1024
ds_write_b128 v13, v[200:203] offset:2048
ds_write_b128 v13, v[204:207] offset:3072
s_waitcnt lgkmcnt(0)
s_barrier
s_cmp_ge_u32 s13, 2
s_cbranch_scc1 wn_75
ds_read_b128 v[16:19], v14 offset:0
ds_read_b128 v[20:23], v14 offset:1024
ds_read_b128 v[24:27], v14 offset:4096
ds_read_b128 v[28:31], v14 offset:5120
ds_read_b128 v[32:35], v14 offset:8192
ds_read_b128 v[36:39], v14 offset:9216
ds_read_b128 v[40:43], v14 offset:12288
ds_read_b128 v[44:47], v14 offset:13312
s_waitcnt vmcnt(0)
v_lshlrev_b32 v192, 16, v208
v_and_b32 v193, 0xffff0000, v208
v_lshlrev_b32 v194, 16, v209
v_and_b32 v195, 0xffff0000, v209
v_lshlrev_b32 v196, 16, v210
v_and_b32 v197, 0xffff0000, v210
v_lshlrev_b32 v198, 16, v211
v_and_b32 v199, 0xffff0000, v211
s_waitcnt lgkmcnt(5)
v_add_f32 v16, v16, v24
s_waitcnt lgkmcnt(1)
v_add_f32 v32, v32, v40
v_add_f32 v17, v17, v25
v_add_f32 v33, v33, v41
v_add_f32 v18, v18, v26
v_add_f32 v34, v34, v42
v_add_f32 v19, v19, v27
v_add_f32 v35, v35, v43
v_add_f32 v20, v20, v28
s_waitcnt lgkmcnt(0)
v_add_f32 v36, v36, v44
v_add_f32 v21, v21, v29
v_add_f32 v37, v37, v45
v_add_f32 v22, v22, v30
v_add_f32 v38, v38, v46
v_add_f32 v23, v23, v31
v_add_f32 v39, v39, v47
v_add_f32 v16, v16, v32
v_add_f32 v17, v17, v33
v_add_f32 v18, v18, v34
v_add_f32 v19, v19, v35
v_add_f32 v20, v20, v36
v_add_f32 v21, v21, v37
v_add_f32 v22, v22, v38
v_add_f32 v23, v23, v39
v_add_f32 v16, v16, v192
v_add_f32 v17, v17, v193
v_add_f32 v18, v18, v194
v_add_f32 v19, v19, v195
v_add_f32 v20, v20, v196
v_add_f32 v21, v21, v197
v_add_f32 v22, v22, v198
v_add_f32 v23, v23, v199
v_cvt_pk_bf16_f32 v208, v16, v17
v_cvt_pk_bf16_f32 v209, v18, v19
v_cvt_pk_bf16_f32 v210, v20, v21
v_cvt_pk_bf16_f32 v211, v22, v23
s_cmp_lg_u32 s16, 0
s_cbranch_scc1 wo_76
s_add_u32 s18, s18, 3145728
buffer_store_dwordx4 v[208:211], v0, s[4:7], s18 offen sc1
s_branch wn_75
wo_76:
s_lshl_b32 s18, s29, 5
s_add_u32 s18, s18, s27
buffer_store_dwordx4 v[208:211], v5, s[56:59], s18 offen
wn_75:
s_lshl_b32 s18, s39, 7
s_add_u32 s18, s18, 11657216
s_cmp_eq_u32 s13, 0
s_cselect_b32 s22, s18, s6
s_mov_b32 s23, s38
s_waitcnt vmcnt(0)
s_barrier
v_mov_b32 v3, s23
s_mov_b64 exec, 1
buffer_store_dword v3, off, s[4:7], s22 sc1
s_mov_b64 exec, -1
s_mov_b32 s22, s6
s_add_u32 s18, s30, 3
s_cmp_lt_u32 s18, 56
s_cselect_b32 s18, s18, s53
s_add_u32 s19, s30, 4
s_cmp_lt_u32 s30, 56
s_cselect_b32 s30, s18, s19
s_cmp_lt_u32 s30, 64
s_cbranch_scc1 ws_74
s_branch aend_63
p1b_62:
s_cmp_eq_u32 s39, 144
s_cbranch_scc1 aend_63
s_cmp_lg_u32 s16, 0
s_cbranch_scc1 aend_63
s_sub_u32 s30, s50, 29
s_sub_u32 s51, s39, 145
s_lshl_b32 s18, s34, 7
s_lshl_b32 s19, s13, 5
s_add_u32 s18, s18, s19
s_mov_b32 s19, 0x3acccccd
v_bfe_u32 v198, v0, 4, 5
v_lshrrev_b32 v193, 9, v0
v_add_u32 v198, s18, v198
v_and_b32 v197, 1, v198
v_mul_u32_u24 v197, 160, v197
v_lshrrev_b32 v196, 1, v198
v_add_u32 v196, 1, v196
v_lshlrev_b32 v193, 3, v193
v_mad_u32_u24 v197, v193, v196, v197
v_mad_u32_u24 v192, v196, 16, 0
v_cvt_f32_u32 v192, v192
v_mul_f32 v198, s19, v192
v_rndne_f32 v198, v198
v_fmac_f32 v192, 0xc4200000, v198
v_mul_f32 v192, s19, v192
v_cos_f32 v192, v192
s_nop 0
v_add_f32 v192, v192, v192
v_mad_u32_u24 v194, v196, 1, 0
v_cvt_f32_u32 v194, v194
v_mul_f32 v198, s19, v194
v_rndne_f32 v198, v198
v_fmac_f32 v194, 0xc4200000, v198
v_mul_f32 v194, s19, v194
v_cos_f32 v194, v194
s_nop 0
v_add_f32 v194, v194, v194
v_mad_u32_u24 v179, v196, 3, v197
v_cvt_f32_u32 v179, v179
v_mul_f32 v198, s19, v179
v_rndne_f32 v198, v198
v_fmac_f32 v179, 0xc4200000, v198
v_mul_f32 v179, s19, v179
v_cos_f32 v179, v179
v_mad_u32_u24 v180, v196, 4, v197
v_cvt_f32_u32 v180, v180
v_mul_f32 v198, s19, v180
v_rndne_f32 v198, v198
v_fmac_f32 v180, 0xc4200000, v198
v_mul_f32 v180, s19, v180
v_cos_f32 v180, v180
s_nop 0
v_fma_f32 v181, v194, v180, -v179
v_fma_f32 v178, v194, v179, -v180
v_fma_f32 v182, v194, v181, -v180
v_fma_f32 v177, v194, v178, -v179
v_fma_f32 v183, v194, v182, -v181
v_fma_f32 v176, v194, v177, -v178
v_cvt_pk_bf16_f32 v16, v176, v177
v_cvt_pk_bf16_f32 v17, v178, v179
v_cvt_pk_bf16_f32 v18, v180, v181
v_cvt_pk_bf16_f32 v19, v182, v183
v_mad_u32_u24 v187, v196, 19, v197
v_cvt_f32_u32 v187, v187
v_mul_f32 v198, s19, v187
v_rndne_f32 v198, v198
v_fmac_f32 v187, 0xc4200000, v198
v_mul_f32 v187, s19, v187
v_cos_f32 v187, v187
v_mad_u32_u24 v188, v196, 20, v197
v_cvt_f32_u32 v188, v188
v_mul_f32 v198, s19, v188
v_rndne_f32 v198, v198
v_fmac_f32 v188, 0xc4200000, v198
v_mul_f32 v188, s19, v188
v_cos_f32 v188, v188
s_nop 0
v_fma_f32 v189, v194, v188, -v187
v_fma_f32 v186, v194, v187, -v188
v_fma_f32 v190, v194, v189, -v188
v_fma_f32 v185, v194, v186, -v187
v_fma_f32 v191, v194, v190, -v189
v_fma_f32 v184, v194, v185, -v186
v_cvt_pk_bf16_f32 v20, v184, v185
v_cvt_pk_bf16_f32 v21, v186, v187
v_cvt_pk_bf16_f32 v22, v188, v189
v_cvt_pk_bf16_f32 v23, v190, v191
v_pk_fma_f32 v[176:177], v[192:193], v[184:185], v[176:177] op_sel_hi:[0,1,1] neg_lo:[0,0,1] neg_hi:[0,0,1]
v_pk_fma_f32 v[178:179], v[192:193], v[186:187], v[178:179] op_sel_hi:[0,1,1] neg_lo:[0,0,1] neg_hi:[0,0,1]
v_pk_fma_f32 v[180:181], v[192:193], v[188:189], v[180:181] op_sel_hi:[0,1,1] neg_lo:[0,0,1] neg_hi:[0,0,1]
v_pk_fma_f32 v[182:183], v[192:193], v[190:191], v[182:183] op_sel_hi:[0,1,1] neg_lo:[0,0,1] neg_hi:[0,0,1]
v_cvt_pk_bf16_f32 v24, v176, v177
v_cvt_pk_bf16_f32 v25, v178, v179
v_cvt_pk_bf16_f32 v26, v180, v181
v_cvt_pk_bf16_f32 v27, v182, v183
v_pk_fma_f32 v[184:185], v[192:193], v[176:177], v[184:185] op_sel_hi:[0,1,1] neg_lo:[0,0,1] neg_hi:[0,0,1]
v_pk_fma_f32 v[186:187], v[192:193], v[178:179], v[186:187] op_sel_hi:[0,1,1] neg_lo:[0,0,1] neg_hi:[0,0,1]
v_pk_fma_f32 v[188:189], v[192:193], v[180:181], v[188:189] op_sel_hi:[0,1,1] neg_lo:[0,0,1] neg_hi:[0,0,1]
v_pk_fma_f32 v[190:191], v[192:193], v[182:183], v[190:191] op_sel_hi:[0,1,1] neg_lo:[0,0,1] neg_hi:[0,0,1]
v_cvt_pk_bf16_f32 v28, v184, v185
v_cvt_pk_bf16_f32 v29, v186, v187
v_cvt_pk_bf16_f32 v30, v188, v189
v_cvt_pk_bf16_f32 v31, v190, v191
v_pk_fma_f32 v[176:177], v[192:193], v[184:185], v[176:177] op_sel_hi:[0,1,1] neg_lo:[0,0,1] neg_hi:[0,0,1]
v_pk_fma_f32 v[178:179], v[192:193], v[186:187], v[178:179] op_sel_hi:[0,1,1] neg_lo:[0,0,1] neg_hi:[0,0,1]
v_pk_fma_f32 v[180:181], v[192:193], v[188:189], v[180:181] op_sel_hi:[0,1,1] neg_lo:[0,0,1] neg_hi:[0,0,1]
v_pk_fma_f32 v[182:183], v[192:193], v[190:191], v[182:183] op_sel_hi:[0,1,1] neg_lo:[0,0,1] neg_hi:[0,0,1]
v_cvt_pk_bf16_f32 v32, v176, v177
v_cvt_pk_bf16_f32 v33, v178, v179
v_cvt_pk_bf16_f32 v34, v180, v181
v_cvt_pk_bf16_f32 v35, v182, v183
v_pk_fma_f32 v[184:185], v[192:193], v[176:177], v[184:185] op_sel_hi:[0,1,1] neg_lo:[0,0,1] neg_hi:[0,0,1]
v_pk_fma_f32 v[186:187], v[192:193], v[178:179], v[186:187] op_sel_hi:[0,1,1] neg_lo:[0,0,1] neg_hi:[0,0,1]
v_pk_fma_f32 v[188:189], v[192:193], v[180:181], v[188:189] op_sel_hi:[0,1,1] neg_lo:[0,0,1] neg_hi:[0,0,1]
v_pk_fma_f32 v[190:191], v[192:193], v[182:183], v[190:191] op_sel_hi:[0,1,1] neg_lo:[0,0,1] neg_hi:[0,0,1]
v_cvt_pk_bf16_f32 v36, v184, v185
v_cvt_pk_bf16_f32 v37, v186, v187
v_cvt_pk_bf16_f32 v38, v188, v189
v_cvt_pk_bf16_f32 v39, v190, v191
v_pk_fma_f32 v[176:177], v[192:193], v[184:185], v[176:177] op_sel_hi:[0,1,1] neg_lo:[0,0,1] neg_hi:[0,0,1]
v_pk_fma_f32 v[178:179], v[192:193], v[186:187], v[178:179] op_sel_hi:[0,1,1] neg_lo:[0,0,1] neg_hi:[0,0,1]
v_pk_fma_f32 v[180:181], v[192:193], v[188:189], v[180:181] op_sel_hi:[0,1,1] neg_lo:[0,0,1] neg_hi:[0,0,1]
v_pk_fma_f32 v[182:183], v[192:193], v[190:191], v[182:183] op_sel_hi:[0,1,1] neg_lo:[0,0,1] neg_hi:[0,0,1]
v_cvt_pk_bf16_f32 v40, v176, v177
v_cvt_pk_bf16_f32 v41, v178, v179
v_cvt_pk_bf16_f32 v42, v180, v181
v_cvt_pk_bf16_f32 v43, v182, v183
v_pk_fma_f32 v[184:185], v[192:193], v[176:177], v[184:185] op_sel_hi:[0,1,1] neg_lo:[0,0,1] neg_hi:[0,0,1]
v_pk_fma_f32 v[186:187], v[192:193], v[178:179], v[186:187] op_sel_hi:[0,1,1] neg_lo:[0,0,1] neg_hi:[0,0,1]
v_pk_fma_f32 v[188:189], v[192:193], v[180:181], v[188:189] op_sel_hi:[0,1,1] neg_lo:[0,0,1] neg_hi:[0,0,1]
v_pk_fma_f32 v[190:191], v[192:193], v[182:183], v[190:191] op_sel_hi:[0,1,1] neg_lo:[0,0,1] neg_hi:[0,0,1]
v_cvt_pk_bf16_f32 v44, v184, v185
v_cvt_pk_bf16_f32 v45, v186, v187
v_cvt_pk_bf16_f32 v46, v188, v189
v_cvt_pk_bf16_f32 v47, v190, v191
v_pk_fma_f32 v[176:177], v[192:193], v[184:185], v[176:177] op_sel_hi:[0,1,1] neg_lo:[0,0,1] neg_hi:[0,0,1]
v_pk_fma_f32 v[178:179], v[192:193], v[186:187], v[178:179] op_sel_hi:[0,1,1] neg_lo:[0,0,1] neg_hi:[0,0,1]
v_pk_fma_f32 v[180:181], v[192:193], v[188:189], v[180:181] op_sel_hi:[0,1,1] neg_lo:[0,0,1] neg_hi:[0,0,1]
v_pk_fma_f32 v[182:183], v[192:193], v[190:191], v[182:183] op_sel_hi:[0,1,1] neg_lo:[0,0,1] neg_hi:[0,0,1]
v_cvt_pk_bf16_f32 v48, v176, v177
v_cvt_pk_bf16_f32 v49, v178, v179
v_cvt_pk_bf16_f32 v50, v180, v181
v_cvt_pk_bf16_f32 v51, v182, v183
v_pk_fma_f32 v[184:185], v[192:193], v[176:177], v[184:185] op_sel_hi:[0,1,1] neg_lo:[0,0,1] neg_hi:[0,0,1]
v_pk_fma_f32 v[186:187], v[192:193], v[178:179], v[186:187] op_sel_hi:[0,1,1] neg_lo:[0,0,1] neg_hi:[0,0,1]
v_pk_fma_f32 v[188:189], v[192:193], v[180:181], v[188:189] op_sel_hi:[0,1,1] neg_lo:[0,0,1] neg_hi:[0,0,1]
v_pk_fma_f32 v[190:191], v[192:193], v[182:183], v[190:191] op_sel_hi:[0,1,1] neg_lo:[0,0,1] neg_hi:[0,0,1]
v_cvt_pk_bf16_f32 v52, v184, v185
v_cvt_pk_bf16_f32 v53, v186, v187
v_cvt_pk_bf16_f32 v54, v188, v189
v_cvt_pk_bf16_f32 v55, v190, v191
v_pk_fma_f32 v[176:177], v[192:193], v[184:185], v[176:177] op_sel_hi:[0,1,1] neg_lo:[0,0,1] neg_hi:[0,0,1]
v_pk_fma_f32 v[178:179], v[192:193], v[186:187], v[178:179] op_sel_hi:[0,1,1] neg_lo:[0,0,1] neg_hi:[0,0,1]
v_pk_fma_f32 v[180:181], v[192:193], v[188:189], v[180:181] op_sel_hi:[0,1,1] neg_lo:[0,0,1] neg_hi:[0,0,1]
v_pk_fma_f32 v[182:183], v[192:193], v[190:191], v[182:183] op_sel_hi:[0,1,1] neg_lo:[0,0,1] neg_hi:[0,0,1]
v_cvt_pk_bf16_f32 v56, v176, v177
v_cvt_pk_bf16_f32 v57, v178, v179
v_cvt_pk_bf16_f32 v58, v180, v181
v_cvt_pk_bf16_f32 v59, v182, v183
v_pk_fma_f32 v[184:185], v[192:193], v[176:177], v[184:185] op_sel_hi:[0,1,1] neg_lo:[0,0,1] neg_hi:[0,0,1]
v_pk_fma_f32 v[186:187], v[192:193], v[178:179], v[186:187] op_sel_hi:[0,1,1] neg_lo:[0,0,1] neg_hi:[0,0,1]
v_pk_fma_f32 v[188:189], v[192:193], v[180:181], v[188:189] op_sel_hi:[0,1,1] neg_lo:[0,0,1] neg_hi:[0,0,1]
v_pk_fma_f32 v[190:191], v[192:193], v[182:183], v[190:191] op_sel_hi:[0,1,1] neg_lo:[0,0,1] neg_hi:[0,0,1]
v_cvt_pk_bf16_f32 v60, v184, v185
v_cvt_pk_bf16_f32 v61, v186, v187
v_cvt_pk_bf16_f32 v62, v188, v189
v_cvt_pk_bf16_f32 v63, v190, v191
v_pk_fma_f32 v[176:177], v[192:193], v[184:185], v[176:177] op_sel_hi:[0,1,1] neg_lo:[0,0,1] neg_hi:[0,0,1]
v_pk_fma_f32 v[178:179], v[192:193], v[186:187], v[178:179] op_sel_hi:[0,1,1] neg_lo:[0,0,1] neg_hi:[0,0,1]
v_pk_fma_f32 v[180:181], v[192:193], v[188:189], v[180:181] op_sel_hi:[0,1,1] neg_lo:[0,0,1] neg_hi:[0,0,1]
v_pk_fma_f32 v[182:183], v[192:193], v[190:191], v[182:183] op_sel_hi:[0,1,1] neg_lo:[0,0,1] neg_hi:[0,0,1]
v_cvt_pk_bf16_f32 v64, v176, v177
v_cvt_pk_bf16_f32 v65, v178, v179
v_cvt_pk_bf16_f32 v66, v180, v181
v_cvt_pk_bf16_f32 v67, v182, v183
v_pk_fma_f32 v[184:185], v[192:193], v[176:177], v[184:185] op_sel_hi:[0,1,1] neg_lo:[0,0,1] neg_hi:[0,0,1]
v_pk_fma_f32 v[186:187], v[192:193], v[178:179], v[186:187] op_sel_hi:[0,1,1] neg_lo:[0,0,1] neg_hi:[0,0,1]
v_pk_fma_f32 v[188:189], v[192:193], v[180:181], v[188:189] op_sel_hi:[0,1,1] neg_lo:[0,0,1] neg_hi:[0,0,1]
v_pk_fma_f32 v[190:191], v[192:193], v[182:183], v[190:191] op_sel_hi:[0,1,1] neg_lo:[0,0,1] neg_hi:[0,0,1]
v_cvt_pk_bf16_f32 v68, v184, v185
v_cvt_pk_bf16_f32 v69, v186, v187
v_cvt_pk_bf16_f32 v70, v188, v189
v_cvt_pk_bf16_f32 v71, v190, v191
v_pk_fma_f32 v[176:177], v[192:193], v[184:185], v[176:177] op_sel_hi:[0,1,1] neg_lo:[0,0,1] neg_hi:[0,0,1]
v_pk_fma_f32 v[178:179], v[192:193], v[186:187], v[178:179] op_sel_hi:[0,1,1] neg_lo:[0,0,1] neg_hi:[0,0,1]
v_pk_fma_f32 v[180:181], v[192:193], v[188:189], v[180:181] op_sel_hi:[0,1,1] neg_lo:[0,0,1] neg_hi:[0,0,1]
v_pk_fma_f32 v[182:183], v[192:193], v[190:191], v[182:183] op_sel_hi:[0,1,1] neg_lo:[0,0,1] neg_hi:[0,0,1]
v_cvt_pk_bf16_f32 v72, v176, v177
v_cvt_pk_bf16_f32 v73, v178, v179
v_cvt_pk_bf16_f32 v74, v180, v181
v_cvt_pk_bf16_f32 v75, v182, v183
v_pk_fma_f32 v[184:185], v[192:193], v[176:177], v[184:185] op_sel_hi:[0,1,1] neg_lo:[0,0,1] neg_hi:[0,0,1]
v_pk_fma_f32 v[186:187], v[192:193], v[178:179], v[186:187] op_sel_hi:[0,1,1] neg_lo:[0,0,1] neg_hi:[0,0,1]
v_pk_fma_f32 v[188:189], v[192:193], v[180:181], v[188:189] op_sel_hi:[0,1,1] neg_lo:[0,0,1] neg_hi:[0,0,1]
v_pk_fma_f32 v[190:191], v[192:193], v[182:183], v[190:191] op_sel_hi:[0,1,1] neg_lo:[0,0,1] neg_hi:[0,0,1]
v_cvt_pk_bf16_f32 v76, v184, v185
v_cvt_pk_bf16_f32 v77, v186, v187
v_cvt_pk_bf16_f32 v78, v188, v189
v_cvt_pk_bf16_f32 v79, v190, v191
v_pk_fma_f32 v[176:177], v[192:193], v[184:185], v[176:177] op_sel_hi:[0,1,1] neg_lo:[0,0,1] neg_hi:[0,0,1]
v_pk_fma_f32 v[178:179], v[192:193], v[186:187], v[178:179] op_sel_hi:[0,1,1] neg_lo:[0,0,1] neg_hi:[0,0,1]
v_pk_fma_f32 v[180:181], v[192:193], v[188:189], v[180:181] op_sel_hi:[0,1,1] neg_lo:[0,0,1] neg_hi:[0,0,1]
v_pk_fma_f32 v[182:183], v[192:193], v[190:191], v[182:183] op_sel_hi:[0,1,1] neg_lo:[0,0,1] neg_hi:[0,0,1]
v_cvt_pk_bf16_f32 v80, v176, v177
v_cvt_pk_bf16_f32 v81, v178, v179
v_cvt_pk_bf16_f32 v82, v180, v181
v_cvt_pk_bf16_f32 v83, v182, v183
v_pk_fma_f32 v[184:185], v[192:193], v[176:177], v[184:185] op_sel_hi:[0,1,1] neg_lo:[0,0,1] neg_hi:[0,0,1]
v_pk_fma_f32 v[186:187], v[192:193], v[178:179], v[186:187] op_sel_hi:[0,1,1] neg_lo:[0,0,1] neg_hi:[0,0,1]
v_pk_fma_f32 v[188:189], v[192:193], v[180:181], v[188:189] op_sel_hi:[0,1,1] neg_lo:[0,0,1] neg_hi:[0,0,1]
v_pk_fma_f32 v[190:191], v[192:193], v[182:183], v[190:191] op_sel_hi:[0,1,1] neg_lo:[0,0,1] neg_hi:[0,0,1]
v_cvt_pk_bf16_f32 v84, v184, v185
v_cvt_pk_bf16_f32 v85, v186, v187
v_cvt_pk_bf16_f32 v86, v188, v189
v_cvt_pk_bf16_f32 v87, v190, v191
v_pk_fma_f32 v[176:177], v[192:193], v[184:185], v[176:177] op_sel_hi:[0,1,1] neg_lo:[0,0,1] neg_hi:[0,0,1]
v_pk_fma_f32 v[178:179], v[192:193], v[186:187], v[178:179] op_sel_hi:[0,1,1] neg_lo:[0,0,1] neg_hi:[0,0,1]
v_pk_fma_f32 v[180:181], v[192:193], v[188:189], v[180:181] op_sel_hi:[0,1,1] neg_lo:[0,0,1] neg_hi:[0,0,1]
v_pk_fma_f32 v[182:183], v[192:193], v[190:191], v[182:183] op_sel_hi:[0,1,1] neg_lo:[0,0,1] neg_hi:[0,0,1]
v_cvt_pk_bf16_f32 v88, v176, v177
v_cvt_pk_bf16_f32 v89, v178, v179
v_cvt_pk_bf16_f32 v90, v180, v181
v_cvt_pk_bf16_f32 v91, v182, v183
v_pk_fma_f32 v[184:185], v[192:193], v[176:177], v[184:185] op_sel_hi:[0,1,1] neg_lo:[0,0,1] neg_hi:[0,0,1]
v_pk_fma_f32 v[186:187], v[192:193], v[178:179], v[186:187] op_sel_hi:[0,1,1] neg_lo:[0,0,1] neg_hi:[0,0,1]
v_pk_fma_f32 v[188:189], v[192:193], v[180:181], v[188:189] op_sel_hi:[0,1,1] neg_lo:[0,0,1] neg_hi:[0,0,1]
v_pk_fma_f32 v[190:191], v[192:193], v[182:183], v[190:191] op_sel_hi:[0,1,1] neg_lo:[0,0,1] neg_hi:[0,0,1]
v_cvt_pk_bf16_f32 v92, v184, v185
v_cvt_pk_bf16_f32 v93, v186, v187
v_cvt_pk_bf16_f32 v94, v188, v189
v_cvt_pk_bf16_f32 v95, v190, v191
s_mov_b32 s20, 323
v_mad_u32_u24 v179, v196, s20, v197
v_cvt_f32_u32 v179, v179
v_mul_f32 v198, s19, v179
v_rndne_f32 v198, v198
v_fmac_f32 v179, 0xc4200000, v198
v_mul_f32 v179, s19, v179
v_cos_f32 v179, v179
s_mov_b32 s20, 324
v_mad_u32_u24 v180, v196, s20, v197
v_cvt_f32_u32 v180, v180
v_mul_f32 v198, s19, v180
v_rndne_f32 v198, v198
v_fmac_f32 v180, 0xc4200000, v198
v_mul_f32 v180, s19, v180
v_cos_f32 v180, v180
s_nop 0
v_fma_f32 v181, v194, v180, -v179
v_fma_f32 v178, v194, v179, -v180
v_fma_f32 v182, v194, v181, -v180
v_fma_f32 v177, v194, v178, -v179
v_fma_f32 v183, v194, v182, -v181
v_fma_f32 v176, v194, v177, -v178
v_cvt_pk_bf16_f32 v96, v176, v177
v_cvt_pk_bf16_f32 v97, v178, v179
v_cvt_pk_bf16_f32 v98, v180, v181
v_cvt_pk_bf16_f32 v99, v182, v183
s_mov_b32 s20, 339
v_mad_u32_u24 v187, v196, s20, v197
v_cvt_f32_u32 v187, v187
v_mul_f32 v198, s19, v187
v_rndne_f32 v198, v198
v_fmac_f32 v187, 0xc4200000, v198
v_mul_f32 v187, s19, v187
v_cos_f32 v187, v187
s_mov_b32 s20, 340
v_mad_u32_u24 v188, v196, s20, v197
v_cvt_f32_u32 v188, v188
v_mul_f32 v198, s19, v188
v_rndne_f32 v198, v198
v_fmac_f32 v188, 0xc4200000, v198
v_mul_f32 v188, s19, v188
v_cos_f32 v188, v188
s_nop 0
v_fma_f32 v189, v194, v188, -v187
v_fma_f32 v186, v194, v187, -v188
v_fma_f32 v190, v194, v189, -v188
v_fma_f32 v185, v194, v186, -v187
v_fma_f32 v191, v194, v190, -v189
v_fma_f32 v184, v194, v185, -v186
v_cvt_pk_bf16_f32 v100, v184, v185
v_cvt_pk_bf16_f32 v101, v186, v187
v_cvt_pk_bf16_f32 v102, v188, v189
v_cvt_pk_bf16_f32 v103, v190, v191
v_pk_fma_f32 v[176:177], v[192:193], v[184:185], v[176:177] op_sel_hi:[0,1,1] neg_lo:[0,0,1] neg_hi:[0,0,1]
v_pk_fma_f32 v[178:179], v[192:193], v[186:187], v[178:179] op_sel_hi:[0,1,1] neg_lo:[0,0,1] neg_hi:[0,0,1]
v_pk_fma_f32 v[180:181], v[192:193], v[188:189], v[180:181] op_sel_hi:[0,1,1] neg_lo:[0,0,1] neg_hi:[0,0,1]
v_pk_fma_f32 v[182:183], v[192:193], v[190:191], v[182:183] op_sel_hi:[0,1,1] neg_lo:[0,0,1] neg_hi:[0,0,1]
v_cvt_pk_bf16_f32 v104, v176, v177
v_cvt_pk_bf16_f32 v105, v178, v179
v_cvt_pk_bf16_f32 v106, v180, v181
v_cvt_pk_bf16_f32 v107, v182, v183
v_pk_fma_f32 v[184:185], v[192:193], v[176:177], v[184:185] op_sel_hi:[0,1,1] neg_lo:[0,0,1] neg_hi:[0,0,1]
v_pk_fma_f32 v[186:187], v[192:193], v[178:179], v[186:187] op_sel_hi:[0,1,1] neg_lo:[0,0,1] neg_hi:[0,0,1]
v_pk_fma_f32 v[188:189], v[192:193], v[180:181], v[188:189] op_sel_hi:[0,1,1] neg_lo:[0,0,1] neg_hi:[0,0,1]
v_pk_fma_f32 v[190:191], v[192:193], v[182:183], v[190:191] op_sel_hi:[0,1,1] neg_lo:[0,0,1] neg_hi:[0,0,1]
v_cvt_pk_bf16_f32 v108, v184, v185
v_cvt_pk_bf16_f32 v109, v186, v187
v_cvt_pk_bf16_f32 v110, v188, v189
v_cvt_pk_bf16_f32 v111, v190, v191
v_pk_fma_f32 v[176:177], v[192:193], v[184:185], v[176:177] op_sel_hi:[0,1,1] neg_lo:[0,0,1] neg_hi:[0,0,1]
v_pk_fma_f32 v[178:179], v[192:193], v[186:187], v[178:179] op_sel_hi:[0,1,1] neg_lo:[0,0,1] neg_hi:[0,0,1]
v_pk_fma_f32 v[180:181], v[192:193], v[188:189], v[180:181] op_sel_hi:[0,1,1] neg_lo:[0,0,1] neg_hi:[0,0,1]
v_pk_fma_f32 v[182:183], v[192:193], v[190:191], v[182:183] op_sel_hi:[0,1,1] neg_lo:[0,0,1] neg_hi:[0,0,1]
v_cvt_pk_bf16_f32 v112, v176, v177
v_cvt_pk_bf16_f32 v113, v178, v179
v_cvt_pk_bf16_f32 v114, v180, v181
v_cvt_pk_bf16_f32 v115, v182, v183
v_pk_fma_f32 v[184:185], v[192:193], v[176:177], v[184:185] op_sel_hi:[0,1,1] neg_lo:[0,0,1] neg_hi:[0,0,1]
v_pk_fma_f32 v[186:187], v[192:193], v[178:179], v[186:187] op_sel_hi:[0,1,1] neg_lo:[0,0,1] neg_hi:[0,0,1]
v_pk_fma_f32 v[188:189], v[192:193], v[180:181], v[188:189] op_sel_hi:[0,1,1] neg_lo:[0,0,1] neg_hi:[0,0,1]
v_pk_fma_f32 v[190:191], v[192:193], v[182:183], v[190:191] op_sel_hi:[0,1,1] neg_lo:[0,0,1] neg_hi:[0,0,1]
v_cvt_pk_bf16_f32 v116, v184, v185
v_cvt_pk_bf16_f32 v117, v186, v187
v_cvt_pk_bf16_f32 v118, v188, v189
v_cvt_pk_bf16_f32 v119, v190, v191
v_pk_fma_f32 v[176:177], v[192:193], v[184:185], v[176:177] op_sel_hi:[0,1,1] neg_lo:[0,0,1] neg_hi:[0,0,1]
v_pk_fma_f32 v[178:179], v[192:193], v[186:187], v[178:179] op_sel_hi:[0,1,1] neg_lo:[0,0,1] neg_hi:[0,0,1]
v_pk_fma_f32 v[180:181], v[192:193], v[188:189], v[180:181] op_sel_hi:[0,1,1] neg_lo:[0,0,1] neg_hi:[0,0,1]
v_pk_fma_f32 v[182:183], v[192:193], v[190:191], v[182:183] op_sel_hi:[0,1,1] neg_lo:[0,0,1] neg_hi:[0,0,1]
v_cvt_pk_bf16_f32 v120, v176, v177
v_cvt_pk_bf16_f32 v121, v178, v179
v_cvt_pk_bf16_f32 v122, v180, v181
v_cvt_pk_bf16_f32 v123, v182, v183
v_pk_fma_f32 v[184:185], v[192:193], v[176:177], v[184:185] op_sel_hi:[0,1,1] neg_lo:[0,0,1] neg_hi:[0,0,1]
v_pk_fma_f32 v[186:187], v[192:193], v[178:179], v[186:187] op_sel_hi:[0,1,1] neg_lo:[0,0,1] neg_hi:[0,0,1]
v_pk_fma_f32 v[188:189], v[192:193], v[180:181], v[188:189] op_sel_hi:[0,1,1] neg_lo:[0,0,1] neg_hi:[0,0,1]
v_pk_fma_f32 v[190:191], v[192:193], v[182:183], v[190:191] op_sel_hi:[0,1,1] neg_lo:[0,0,1] neg_hi:[0,0,1]
v_cvt_pk_bf16_f32 v124, v184, v185
v_cvt_pk_bf16_f32 v125, v186, v187
v_cvt_pk_bf16_f32 v126, v188, v189
v_cvt_pk_bf16_f32 v127, v190, v191
v_pk_fma_f32 v[176:177], v[192:193], v[184:185], v[176:177] op_sel_hi:[0,1,1] neg_lo:[0,0,1] neg_hi:[0,0,1]
v_pk_fma_f32 v[178:179], v[192:193], v[186:187], v[178:179] op_sel_hi:[0,1,1] neg_lo:[0,0,1] neg_hi:[0,0,1]
v_pk_fma_f32 v[180:181], v[192:193], v[188:189], v[180:181] op_sel_hi:[0,1,1] neg_lo:[0,0,1] neg_hi:[0,0,1]
v_pk_fma_f32 v[182:183], v[192:193], v[190:191], v[182:183] op_sel_hi:[0,1,1] neg_lo:[0,0,1] neg_hi:[0,0,1]
v_cvt_pk_bf16_f32 v128, v176, v177
v_cvt_pk_bf16_f32 v129, v178, v179
v_cvt_pk_bf16_f32 v130, v180, v181
v_cvt_pk_bf16_f32 v131, v182, v183
v_pk_fma_f32 v[184:185], v[192:193], v[176:177], v[184:185] op_sel_hi:[0,1,1] neg_lo:[0,0,1] neg_hi:[0,0,1]
v_pk_fma_f32 v[186:187], v[192:193], v[178:179], v[186:187] op_sel_hi:[0,1,1] neg_lo:[0,0,1] neg_hi:[0,0,1]
v_pk_fma_f32 v[188:189], v[192:193], v[180:181], v[188:189] op_sel_hi:[0,1,1] neg_lo:[0,0,1] neg_hi:[0,0,1]
v_pk_fma_f32 v[190:191], v[192:193], v[182:183], v[190:191] op_sel_hi:[0,1,1] neg_lo:[0,0,1] neg_hi:[0,0,1]
v_cvt_pk_bf16_f32 v132, v184, v185
v_cvt_pk_bf16_f32 v133, v186, v187
v_cvt_pk_bf16_f32 v134, v188, v189
v_cvt_pk_bf16_f32 v135, v190, v191
v_pk_fma_f32 v[176:177], v[192:193], v[184:185], v[176:177] op_sel_hi:[0,1,1] neg_lo:[0,0,1] neg_hi:[0,0,1]
v_pk_fma_f32 v[178:179], v[192:193], v[186:187], v[178:179] op_sel_hi:[0,1,1] neg_lo:[0,0,1] neg_hi:[0,0,1]
v_pk_fma_f32 v[180:181], v[192:193], v[188:189], v[180:181] op_sel_hi:[0,1,1] neg_lo:[0,0,1] neg_hi:[0,0,1]
v_pk_fma_f32 v[182:183], v[192:193], v[190:191], v[182:183] op_sel_hi:[0,1,1] neg_lo:[0,0,1] neg_hi:[0,0,1]
v_cvt_pk_bf16_f32 v136, v176, v177
v_cvt_pk_bf16_f32 v137, v178, v179
v_cvt_pk_bf16_f32 v138, v180, v181
v_cvt_pk_bf16_f32 v139, v182, v183
v_pk_fma_f32 v[184:185], v[192:193], v[176:177], v[184:185] op_sel_hi:[0,1,1] neg_lo:[0,0,1] neg_hi:[0,0,1]
v_pk_fma_f32 v[186:187], v[192:193], v[178:179], v[186:187] op_sel_hi:[0,1,1] neg_lo:[0,0,1] neg_hi:[0,0,1]
v_pk_fma_f32 v[188:189], v[192:193], v[180:181], v[188:189] op_sel_hi:[0,1,1] neg_lo:[0,0,1] neg_hi:[0,0,1]
v_pk_fma_f32 v[190:191], v[192:193], v[182:183], v[190:191] op_sel_hi:[0,1,1] neg_lo:[0,0,1] neg_hi:[0,0,1]
v_cvt_pk_bf16_f32 v140, v184, v185
v_cvt_pk_bf16_f32 v141, v186, v187
v_cvt_pk_bf16_f32 v142, v188, v189
v_cvt_pk_bf16_f32 v143, v190, v191
v_pk_fma_f32 v[176:177], v[192:193], v[184:185], v[176:177] op_sel_hi:[0,1,1] neg_lo:[0,0,1] neg_hi:[0,0,1]
v_pk_fma_f32 v[178:179], v[192:193], v[186:187], v[178:179] op_sel_hi:[0,1,1] neg_lo:[0,0,1] neg_hi:[0,0,1]
v_pk_fma_f32 v[180:181], v[192:193], v[188:189], v[180:181] op_sel_hi:[0,1,1] neg_lo:[0,0,1] neg_hi:[0,0,1]
v_pk_fma_f32 v[182:183], v[192:193], v[190:191], v[182:183] op_sel_hi:[0,1,1] neg_lo:[0,0,1] neg_hi:[0,0,1]
v_cvt_pk_bf16_f32 v144, v176, v177
v_cvt_pk_bf16_f32 v145, v178, v179
v_cvt_pk_bf16_f32 v146, v180, v181
v_cvt_pk_bf16_f32 v147, v182, v183
v_pk_fma_f32 v[184:185], v[192:193], v[176:177], v[184:185] op_sel_hi:[0,1,1] neg_lo:[0,0,1] neg_hi:[0,0,1]
v_pk_fma_f32 v[186:187], v[192:193], v[178:179], v[186:187] op_sel_hi:[0,1,1] neg_lo:[0,0,1] neg_hi:[0,0,1]
v_pk_fma_f32 v[188:189], v[192:193], v[180:181], v[188:189] op_sel_hi:[0,1,1] neg_lo:[0,0,1] neg_hi:[0,0,1]
v_pk_fma_f32 v[190:191], v[192:193], v[182:183], v[190:191] op_sel_hi:[0,1,1] neg_lo:[0,0,1] neg_hi:[0,0,1]
v_cvt_pk_bf16_f32 v148, v184, v185
v_cvt_pk_bf16_f32 v149, v186, v187
v_cvt_pk_bf16_f32 v150, v188, v189
v_cvt_pk_bf16_f32 v151, v190, v191
v_pk_fma_f32 v[176:177], v[192:193], v[184:185], v[176:177] op_sel_hi:[0,1,1] neg_lo:[0,0,1] neg_hi:[0,0,1]
v_pk_fma_f32 v[178:179], v[192:193], v[186:187], v[178:179] op_sel_hi:[0,1,1] neg_lo:[0,0,1] neg_hi:[0,0,1]
v_pk_fma_f32 v[180:181], v[192:193], v[188:189], v[180:181] op_sel_hi:[0,1,1] neg_lo:[0,0,1] neg_hi:[0,0,1]
v_pk_fma_f32 v[182:183], v[192:193], v[190:191], v[182:183] op_sel_hi:[0,1,1] neg_lo:[0,0,1] neg_hi:[0,0,1]
v_cvt_pk_bf16_f32 v152, v176, v177
v_cvt_pk_bf16_f32 v153, v178, v179
v_cvt_pk_bf16_f32 v154, v180, v181
v_cvt_pk_bf16_f32 v155, v182, v183
v_pk_fma_f32 v[184:185], v[192:193], v[176:177], v[184:185] op_sel_hi:[0,1,1] neg_lo:[0,0,1] neg_hi:[0,0,1]
v_pk_fma_f32 v[186:187], v[192:193], v[178:179], v[186:187] op_sel_hi:[0,1,1] neg_lo:[0,0,1] neg_hi:[0,0,1]
v_pk_fma_f32 v[188:189], v[192:193], v[180:181], v[188:189] op_sel_hi:[0,1,1] neg_lo:[0,0,1] neg_hi:[0,0,1]
v_pk_fma_f32 v[190:191], v[192:193], v[182:183], v[190:191] op_sel_hi:[0,1,1] neg_lo:[0,0,1] neg_hi:[0,0,1]
v_cvt_pk_bf16_f32 v156, v184, v185
v_cvt_pk_bf16_f32 v157, v186, v187
v_cvt_pk_bf16_f32 v158, v188, v189
v_cvt_pk_bf16_f32 v159, v190, v191
v_pk_fma_f32 v[176:177], v[192:193], v[184:185], v[176:177] op_sel_hi:[0,1,1] neg_lo:[0,0,1] neg_hi:[0,0,1]
v_pk_fma_f32 v[178:179], v[192:193], v[186:187], v[178:179] op_sel_hi:[0,1,1] neg_lo:[0,0,1] neg_hi:[0,0,1]
v_pk_fma_f32 v[180:181], v[192:193], v[188:189], v[180:181] op_sel_hi:[0,1,1] neg_lo:[0,0,1] neg_hi:[0,0,1]
v_pk_fma_f32 v[182:183], v[192:193], v[190:191], v[182:183] op_sel_hi:[0,1,1] neg_lo:[0,0,1] neg_hi:[0,0,1]
v_cvt_pk_bf16_f32 v160, v176, v177
v_cvt_pk_bf16_f32 v161, v178, v179
v_cvt_pk_bf16_f32 v162, v180, v181
v_cvt_pk_bf16_f32 v163, v182, v183
v_pk_fma_f32 v[184:185], v[192:193], v[176:177], v[184:185] op_sel_hi:[0,1,1] neg_lo:[0,0,1] neg_hi:[0,0,1]
v_pk_fma_f32 v[186:187], v[192:193], v[178:179], v[186:187] op_sel_hi:[0,1,1] neg_lo:[0,0,1] neg_hi:[0,0,1]
v_pk_fma_f32 v[188:189], v[192:193], v[180:181], v[188:189] op_sel_hi:[0,1,1] neg_lo:[0,0,1] neg_hi:[0,0,1]
v_pk_fma_f32 v[190:191], v[192:193], v[182:183], v[190:191] op_sel_hi:[0,1,1] neg_lo:[0,0,1] neg_hi:[0,0,1]
v_cvt_pk_bf16_f32 v164, v184, v185
v_cvt_pk_bf16_f32 v165, v186, v187
v_cvt_pk_bf16_f32 v166, v188, v189
v_cvt_pk_bf16_f32 v167, v190, v191
v_pk_fma_f32 v[176:177], v[192:193], v[184:185], v[176:177] op_sel_hi:[0,1,1] neg_lo:[0,0,1] neg_hi:[0,0,1]
v_pk_fma_f32 v[178:179], v[192:193], v[186:187], v[178:179] op_sel_hi:[0,1,1] neg_lo:[0,0,1] neg_hi:[0,0,1]
v_pk_fma_f32 v[180:181], v[192:193], v[188:189], v[180:181] op_sel_hi:[0,1,1] neg_lo:[0,0,1] neg_hi:[0,0,1]
v_pk_fma_f32 v[182:183], v[192:193], v[190:191], v[182:183] op_sel_hi:[0,1,1] neg_lo:[0,0,1] neg_hi:[0,0,1]
v_cvt_pk_bf16_f32 v168, v176, v177
v_cvt_pk_bf16_f32 v169, v178, v179
v_cvt_pk_bf16_f32 v170, v180, v181
v_cvt_pk_bf16_f32 v171, v182, v183
v_pk_fma_f32 v[184:185], v[192:193], v[176:177], v[184:185] op_sel_hi:[0,1,1] neg_lo:[0,0,1] neg_hi:[0,0,1]
v_pk_fma_f32 v[186:187], v[192:193], v[178:179], v[186:187] op_sel_hi:[0,1,1] neg_lo:[0,0,1] neg_hi:[0,0,1]
v_pk_fma_f32 v[188:189], v[192:193], v[180:181], v[188:189] op_sel_hi:[0,1,1] neg_lo:[0,0,1] neg_hi:[0,0,1]
v_pk_fma_f32 v[190:191], v[192:193], v[182:183], v[190:191] op_sel_hi:[0,1,1] neg_lo:[0,0,1] neg_hi:[0,0,1]
v_cvt_pk_bf16_f32 v172, v184, v185
v_cvt_pk_bf16_f32 v173, v186, v187
v_cvt_pk_bf16_f32 v174, v188, v189
v_cvt_pk_bf16_f32 v175, v190, v191
p1q_80:
s_mul_i32 s18, s30, 21846
s_lshr_b32 s18, s18, 16
s_mul_i32 s18, s18, 3
s_sub_u32 s18, s30, s18
s_and_b32 s19, s30, 3
s_cmp_lt_u32 s30, 56
s_cselect_b32 s18, s18, s19
s_mul_i32 s18, s18, 2560
s_add_u32 s18, s18, 11665408
s_add_u32 s29, s30, 1
s_cmp_lg_u32 s13, 0
s_cbranch_scc1 polld_82
v_lshlrev_b32 v3, 3, v0
v_min_u32 v12, 2432, v3
s_mov_b32 s17, 0
poll_81:
buffer_load_dword v8, v12, s[4:7], s18 offen sc1
s_add_u32 s17, s17, 1
s_cmp_gt_u32 s17, 262144
s_cbranch_scc1 L_fail
s_waitcnt vmcnt(0)
v_cmp_gt_u32 vcc, s29, v8
s_cbranch_vccz polld_82
s_sleep 2
s_branch poll_81
polld_82:
s_barrier
s_mul_i32 s18, s30, 40960
s_add_u32 s26, s18, 91226112
s_add_u32 s26, s26, s31
s_add_u32 s27, s18, 100663296
s_add_u32 s27, s27, s33
s_add_u32 m0, s31, 2048
s_add_u32 s20, s26, 0
buffer_load_dwordx4 v0, s[4:7], s20 offen sc1 lds
s_add_u32 m0, s31, 3072
s_add_u32 s20, s26, 1024
buffer_load_dwordx4 v0, s[4:7], s20 offen sc1 lds
s_add_u32 m0, s31, 4096
s_add_u32 s20, s26, 2048
buffer_load_dwordx4 v0, s[4:7], s20 offen sc1 lds
s_add_u32 m0, s31, 5120
s_add_u32 s20, s26, 3072
buffer_load_dwordx4 v0, s[4:7], s20 offen sc1 lds
s_add_u32 m0, s31, 6144
s_add_u32 s20, s26, 4096
buffer_load_dwordx4 v0, s[4:7], s20 offen sc1 lds
s_add_u32 m0, s31, 7168
s_add_u32 s20, s26, 5120
buffer_load_dwordx4 v0, s[4:7], s20 offen sc1 lds
s_add_u32 m0, s31, 8192
s_add_u32 s20, s26, 6144
buffer_load_dwordx4 v0, s[4:7], s20 offen sc1 lds
s_add_u32 m0, s31, 9216
s_add_u32 s20, s26, 7168
buffer_load_dwordx4 v0, s[4:7], s20 offen sc1 lds
s_add_u32 m0, s31, 10240
s_add_u32 s20, s26, 8192
buffer_load_dwordx4 v0, s[4:7], s20 offen sc1 lds
s_add_u32 m0, s31, 11264
s_add_u32 s20, s26, 9216
buffer_load_dwordx4 v0, s[4:7], s20 offen sc1 lds
s_waitcnt vmcnt(0)
s_barrier
v_add_u32 v2, s31, v0
ds_read_b128 v[216:219], v2 offset:2048
ds_read_b128 v[220:223], v2 offset:3072
ds_read_b128 v[224:227], v2 offset:4096
ds_read_b128 v[196:199], v0 offset:3072
ds_read_b128 v[228:231], v2 offset:5120
ds_read_b128 v[192:195], v0 offset:2048
v_mov_b64 v[208:209], 0
ds_read_b128 v[200:203], v0 offset:4096
ds_read_b128 v[204:207], v0 offset:5120
s_waitcnt lgkmcnt(7)
v_dot2c_f32_bf16 v208, s24, v216
v_dot2c_f32_bf16 v209, v216, v216
v_dot2c_f32_bf16 v208, s24, v217
v_dot2c_f32_bf16 v209, v217, v217
v_dot2c_f32_bf16 v208, s24, v218
v_dot2c_f32_bf16 v209, v218, v218
v_dot2c_f32_bf16 v208, s24, v219
s_waitcnt lgkmcnt(5)
v_dot2c_f32_bf16 v209, v219, v219
v_dot2c_f32_bf16 v208, s24, v220
v_dot2c_f32_bf16 v209, v220, v220
v_dot2c_f32_bf16 v208, s24, v221
v_dot2c_f32_bf16 v209, v221, v221
v_dot2c_f32_bf16 v208, s24, v222
v_dot2c_f32_bf16 v209, v222, v222
v_dot2c_f32_bf16 v208, s24, v223
v_dot2c_f32_bf16 v209, v223, v223
v_dot2c_f32_bf16 v208, s24, v224
v_dot2c_f32_bf16 v209, v224, v224
s_waitcnt lgkmcnt(3)
ds_read_b128 v[216:219], v2 offset:6144
ds_read_b128 v[220:223], v2 offset:7168
v_dot2c_f32_bf16 v208, s24, v225
v_dot2c_f32_bf16 v209, v225, v225
v_dot2c_f32_bf16 v208, s24, v226
v_dot2c_f32_bf16 v209, v226, v226
v_dot2c_f32_bf16 v208, s24, v227
v_dot2c_f32_bf16 v209, v227, v227
v_dot2c_f32_bf16 v208, s24, v228
v_dot2c_f32_bf16 v209, v228, v228
v_dot2c_f32_bf16 v208, s24, v229
v_dot2c_f32_bf16 v209, v229, v229
v_dot2c_f32_bf16 v208, s24, v230
v_dot2c_f32_bf16 v209, v230, v230
v_dot2c_f32_bf16 v208, s24, v231
v_dot2c_f32_bf16 v209, v231, v231
s_waitcnt lgkmcnt(1)
ds_read_b128 v[228:231], v2 offset:9216
ds_read_b128 v[224:227], v2 offset:8192
v_dot2c_f32_bf16 v208, s24, v216
v_dot2c_f32_bf16 v209, v216, v216
v_dot2c_f32_bf16 v208, s24, v217
s_waitcnt lgkmcnt(2)
v_dot2c_f32_bf16 v209, v217, v217
v_dot2c_f32_bf16 v208, s24, v218
v_dot2c_f32_bf16 v209, v218, v218
v_dot2c_f32_bf16 v208, s24, v219
v_dot2c_f32_bf16 v209, v219, v219
v_dot2c_f32_bf16 v208, s24, v220
v_dot2c_f32_bf16 v209, v220, v220
v_dot2c_f32_bf16 v208, s24, v221
v_dot2c_f32_bf16 v209, v221, v221
v_dot2c_f32_bf16 v208, s24, v222
v_dot2c_f32_bf16 v209, v222, v222
v_dot2c_f32_bf16 v208, s24, v223
v_dot2c_f32_bf16 v209, v223, v223
s_waitcnt lgkmcnt(0)
ds_read_b128 v[216:219], v2 offset:10240
ds_read_b128 v[220:223], v2 offset:11264
v_dot2c_f32_bf16 v208, s24, v224
v_dot2c_f32_bf16 v209, v224, v224
v_dot2c_f32_bf16 v208, s24, v225
v_dot2c_f32_bf16 v209, v225, v225
v_dot2c_f32_bf16 v208, s24, v226
v_dot2c_f32_bf16 v209, v226, v226
v_dot2c_f32_bf16 v208, s24, v227
v_dot2c_f32_bf16 v209, v227, v227
v_dot2c_f32_bf16 v208, s24, v228
v_dot2c_f32_bf16 v209, v228, v228
v_dot2c_f32_bf16 v208, s24, v229
v_dot2c_f32_bf16 v209, v229, v229
v_dot2c_f32_bf16 v208, s24, v230
v_dot2c_f32_bf16 v209, v230, v230
s_waitcnt lgkmcnt(1)
v_dot2c_f32_bf16 v208, s24, v231
v_dot2c_f32_bf16 v209, v231, v231
v_dot2c_f32_bf16 v208, s24, v216
s_waitcnt lgkmcnt(0)
v_dot2c_f32_bf16 v209, v216, v216
v_dot2c_f32_bf16 v208, s24, v217
v_dot2c_f32_bf16 v209, v217, v217
v_dot2c_f32_bf16 v208, s24, v218
v_dot2c_f32_bf16 v209, v218, v218
v_dot2c_f32_bf16 v208, s24, v219
v_dot2c_f32_bf16 v209, v219, v219
v_dot2c_f32_bf16 v208, s24, v220
v_dot2c_f32_bf16 v209, v220, v220
v_dot2c_f32_bf16 v208, s24, v221
v_dot2c_f32_bf16 v209, v221, v221
v_dot2c_f32_bf16 v208, s24, v222
v_dot2c_f32_bf16 v209, v222, v222
v_dot2c_f32_bf16 v208, s24, v223
v_dot2c_f32_bf16 v209, v223, v223
v_mfma_f32_32x32x16_bf16 v[176:191], v[192:195], v[16:19], 0
s_nop 1
v_permlane32_swap_b32 v208, v209
ds_read_b128 v[192:195], v0 offset:6144
v_mfma_f32_32x32x16_bf16 v[176:191], v[196:199], v[20:23], v[176:191]
v_and_b32 v2, 0x1ff, v0
v_add_f32 v208, v208, v209
v_mfma_f32_32x32x16_bf16 v[176:191], v[200:203], v[24:27], v[176:191]
v_lshl_add_u32 v209, s13, 2, v0
ds_read_b128 v[196:199], v0 offset:7168
ds_write_b32 v209, v208 offset:0
v_mfma_f32_32x32x16_bf16 v[176:191], v[204:207], v[28:31], v[176:191]
s_waitcnt lgkmcnt(2)
ds_read_b128 v[200:203], v0 offset:8192
ds_read_b128 v[204:207], v0 offset:9216
v_mfma_f32_32x32x16_bf16 v[176:191], v[192:195], v[32:35], v[176:191]
s_waitcnt lgkmcnt(3)
v_mfma_f32_32x32x16_bf16 v[176:191], v[196:199], v[36:39], v[176:191]
s_waitcnt lgkmcnt(2)
ds_read_b128 v[192:195], v0 offset:10240
s_waitcnt lgkmcnt(2)
s_waitcnt lgkmcnt(1)
v_mfma_f32_32x32x16_bf16 v[176:191], v[200:203], v[40:43], v[176:191]
ds_read_b128 v[196:199], v0 offset:11264
s_barrier
ds_read_b128 v[208:211], v2 offset:0
v_mfma_f32_32x32x16_bf16 v[176:191], v[204:207], v[44:47], v[176:191]
ds_read_b128 v[204:207], v0 offset:13312
ds_read_b128 v[200:203], v0 offset:12288
s_waitcnt lgkmcnt(4)
v_mfma_f32_32x32x16_bf16 v[176:191], v[192:195], v[48:51], v[176:191]
s_waitcnt lgkmcnt(3)
ds_read_b128 v[212:215], v2 offset:512
ds_read_b128 v[192:195], v0 offset:14336
v_mfma_f32_32x32x16_bf16 v[176:191], v[196:199], v[52:55], v[176:191]
s_waitcnt lgkmcnt(2)
v_mfma_f32_32x32x16_bf16 v[176:191], v[200:203], v[56:59], v[176:191]
ds_read_b128 v[196:199], v0 offset:15360
ds_read_b128 v[200:203], v0 offset:16384
v_add_f32 v208, v208, v209
v_add_f32 v210, v210, v211
s_waitcnt lgkmcnt(3)
v_mfma_f32_32x32x16_bf16 v[176:191], v[204:207], v[60:63], v[176:191]
s_waitcnt lgkmcnt(2)
ds_read_b128 v[204:207], v0 offset:17408
v_add_f32 v212, v212, v213
v_add_f32 v208, v208, v210
v_mfma_f32_32x32x16_bf16 v[176:191], v[192:195], v[64:67], v[176:191]
s_waitcnt lgkmcnt(2)
v_mfma_f32_32x32x16_bf16 v[176:191], v[196:199], v[68:71], v[176:191]
v_mul_f32 v208, 0x3acccccd, v208
s_waitcnt lgkmcnt(1)
ds_read_b128 v[192:195], v0 offset:18432
v_add_f32 v214, v214, v215
s_waitcnt lgkmcnt(1)
v_mfma_f32_32x32x16_bf16 v[176:191], v[200:203], v[72:75], v[176:191]
v_lshrrev_b32 v209, 2, v0
ds_read_b128 v[196:199], v0 offset:19456
v_mfma_f32_32x32x16_bf16 v[176:191], v[204:207], v[76:79], v[176:191]
ds_read_b128 v[200:203], v0 offset:20480
ds_read_b128 v[204:207], v0 offset:21504
v_add_f32 v212, v212, v214
v_mul_f32 v212, 0x3acccccd, v212
s_waitcnt lgkmcnt(3)
v_mfma_f32_32x32x16_bf16 v[176:191], v[192:195], v[80:83], v[176:191]
v_fma_f32 v212, -v208, v208, v212
s_waitcnt lgkmcnt(2)
v_max_f32 v212, 0, v212
v_add_f32 v212, 0x3727c5ac, v212
v_mfma_f32_32x32x16_bf16 v[176:191], v[196:199], v[84:87], v[176:191]
ds_read_b128 v[192:195], v0 offset:22528
s_waitcnt lgkmcnt(2)
v_bfe_u32 v210, v0, 5, 5
v_lshl_add_u32 v209, s13, 8, v209
v_mfma_f32_32x32x16_bf16 v[176:191], v[200:203], v[88:91], v[176:191]
ds_read_b128 v[196:199], v0 offset:23552
ds_read_b128 v[200:203], v0 offset:24576
v_rsq_f32 v212, v212
s_waitcnt lgkmcnt(3)
v_and_b32 v210, 16, v210
v_mfma_f32_32x32x16_bf16 v[176:191], v[204:207], v[92:95], v[176:191]
ds_read_b128 v[204:207], v0 offset:25600
s_waitcnt lgkmcnt(3)
v_mul_f32 v208, v212, v208
v_mfma_f32_32x32x16_bf16 v[176:191], v[192:195], v[96:99], v[176:191]
v_lshl_add_u32 v210, s13, 8, v210
v_permlane32_swap_b32 v212, v208
s_waitcnt lgkmcnt(2)
ds_read_b128 v[192:195], v0 offset:26624
v_mfma_f32_32x32x16_bf16 v[176:191], v[196:199], v[100:103], v[176:191]
ds_write_b32 v209, v212 offset:1024
s_waitcnt lgkmcnt(3)
s_waitcnt lgkmcnt(2)
v_mfma_f32_32x32x16_bf16 v[176:191], v[200:203], v[104:107], v[176:191]
ds_read_b128 v[240:243], v210 offset:1216
ds_read_b128 v[196:199], v0 offset:27648
v_mfma_f32_32x32x16_bf16 v[176:191], v[204:207], v[108:111], v[176:191]
ds_read_b128 v[200:203], v0 offset:28672
s_waitcnt lgkmcnt(4)
ds_read_b128 v[232:235], v210 offset:1152
v_mfma_f32_32x32x16_bf16 v[176:191], v[192:195], v[112:115], v[176:191]
ds_read_b128 v[204:207], v0 offset:29696
ds_read_b128 v[192:195], v0 offset:30720
s_waitcnt lgkmcnt(4)
v_mfma_f32_32x32x16_bf16 v[176:191], v[196:199], v[116:119], v[176:191]
ds_read_b128 v[228:231], v210 offset:1120
s_waitcnt lgkmcnt(4)
ds_read_b128 v[216:219], v210 offset:1024
ds_read_b128 v[196:199], v0 offset:31744
v_mfma_f32_32x32x16_bf16 v[176:191], v[200:203], v[120:123], v[176:191]
v_mul_f32 v241, v241, v7
s_waitcnt lgkmcnt(3)
ds_read_b128 v[200:203], v0 offset:32768
v_mfma_f32_32x32x16_bf16 v[176:191], v[204:207], v[124:127], v[176:191]
ds_read_b128 v[220:223], v210 offset:1056
v_mfma_f32_32x32x16_bf16 v[176:191], v[192:195], v[128:131], v[176:191]
ds_read_b128 v[204:207], v0 offset:33792
s_waitcnt lgkmcnt(3)
v_mfma_f32_32x32x16_bf16 v[176:191], v[196:199], v[132:135], v[176:191]
s_waitcnt lgkmcnt(2)
ds_read_b128 v[192:195], v0 offset:34816
ds_read_b128 v[224:227], v210 offset:1088
ds_read_b128 v[196:199], v0 offset:35840
ds_read_b128 v[244:247], v210 offset:1248
v_mfma_f32_32x32x16_bf16 v[176:191], v[200:203], v[136:139], v[176:191]
s_waitcnt lgkmcnt(4)
ds_read_b128 v[200:203], v0 offset:36864
v_mfma_f32_32x32x16_bf16 v[176:191], v[204:207], v[140:143], v[176:191]
v_mul_f32 v242, v242, v7
ds_read_b128 v[236:239], v210 offset:1184
s_waitcnt lgkmcnt(5)
v_mfma_f32_32x32x16_bf16 v[176:191], v[192:195], v[144:147], v[176:191]
ds_read_b128 v[204:207], v0 offset:37888
s_waitcnt lgkmcnt(3)
ds_read_b128 v[192:195], v0 offset:38912
v_mfma_f32_32x32x16_bf16 v[176:191], v[196:199], v[148:151], v[176:191]
ds_read_b128 v[196:199], v0 offset:39936
s_waitcnt lgkmcnt(4)
s_waitcnt lgkmcnt(3)
v_mul_f32 v240, v240, v7
v_mfma_f32_32x32x16_bf16 v[176:191], v[200:203], v[152:155], v[176:191]
v_mul_f32 v247, v247, v7
v_mul_f32 v245, v245, v7
v_mul_f32 v233, v233, v7
s_waitcnt lgkmcnt(2)
v_mfma_f32_32x32x16_bf16 v[176:191], v[204:207], v[156:159], v[176:191]
ds_read_b128 v[200:203], v0 offset:40960
s_waitcnt lgkmcnt(1)
ds_read_b128 v[204:207], v0 offset:41984
v_mul_f32 v232, v232, v7
v_mfma_f32_32x32x16_bf16 v[176:191], v[192:195], v[160:163], v[176:191]
v_mul_f32 v246, v246, v7
v_mul_f32 v244, v244, v7
v_mul_f32 v236, v236, v7
v_mfma_f32_32x32x16_bf16 v[176:191], v[196:199], v[164:167], v[176:191]
s_waitcnt lgkmcnt(0)
v_mul_f32 v239, v239, v7
v_mfma_f32_32x32x16_bf16 v[176:191], v[200:203], v[168:171], v[176:191]
v_mul_f32 v238, v238, v7
v_mfma_f32_32x32x16_bf16 v[176:191], v[204:207], v[172:175], v[176:191]
s_nop 0
v_mul_f32 v237, v237, v7
v_mul_f32 v235, v235, v7
v_mul_f32 v234, v234, v7
v_mul_f32 v243, v243, v7
s_nop 6
v_pk_fma_f32 v[184:185], v[184:185], v[224:225], v[240:241] neg_lo:[0,0,1] neg_hi:[0,0,1]
v_pk_fma_f32 v[182:183], v[182:183], v[222:223], v[238:239] neg_lo:[0,0,1] neg_hi:[0,0,1]
v_pk_fma_f32 v[180:181], v[180:181], v[220:221], v[236:237] neg_lo:[0,0,1] neg_hi:[0,0,1]
v_pk_fma_f32 v[188:189], v[188:189], v[228:229], v[244:245] neg_lo:[0,0,1] neg_hi:[0,0,1]
v_pk_fma_f32 v[176:177], v[176:177], v[216:217], v[232:233] neg_lo:[0,0,1] neg_hi:[0,0,1]
v_cvt_pk_bf16_f32 v194, v180, v181
v_pk_fma_f32 v[178:179], v[178:179], v[218:219], v[234:235] neg_lo:[0,0,1] neg_hi:[0,0,1]
v_cvt_pk_bf16_f32 v198, v188, v189
v_pk_fma_f32 v[190:191], v[190:191], v[230:231], v[246:247] neg_lo:[0,0,1] neg_hi:[0,0,1]
v_cvt_pk_bf16_f32 v199, v190, v191
v_cvt_pk_bf16_f32 v195, v182, v183
v_pk_fma_f32 v[186:187], v[186:187], v[226:227], v[242:243] neg_lo:[0,0,1] neg_hi:[0,0,1]
v_cvt_pk_bf16_f32 v193, v178, v179
v_cvt_pk_bf16_f32 v196, v184, v185
v_cvt_pk_bf16_f32 v197, v186, v187
v_cvt_pk_bf16_f32 v192, v176, v177
buffer_store_dwordx4 v[192:195], v6, s[4:7], s27 offen offset:0 sc1
buffer_store_dwordx4 v[196:199], v6, s[4:7], s27 offen offset:1024 sc1
s_add_u32 s30, s30, 3
s_cmp_lt_u32 s30, 60
s_cbranch_scc1 p1q_80
s_lshl_b32 s18, s51, 7
s_add_u32 s18, s18, 11552768
s_cmp_eq_u32 s13, 0
s_cselect_b32 s22, s18, s6
s_mov_b32 s23, 1
s_waitcnt vmcnt(0)
s_barrier
v_mov_b32 v3, s23
s_mov_b64 exec, 1
buffer_store_dword v3, off, s[4:7], s22 sc1
s_mov_b64 exec, -1
s_mov_b32 s22, s6
aend_63:
s_add_u32 s16, s16, 1
s_cmp_lt_u32 s16, 2
s_cbranch_scc1 alay_49
s_endpgm
L_fail:
s_mov_b64 exec, 1
v_mov_b32 v1, 0xdead
buffer_store_dword v1, off, s[8:11], 0 offset:4 sc1
L_end:
s_endpgm
L_chain:
s_waitcnt vmcnt(0)
s_nop 4
s_bitcmp1_b32 0x55555555, s14
s_cbranch_scc0 grp_10001
s_bfm_b32 s24, s14, 0
s_and_b32 s24, s24, 0x55555555
s_bcnt1_i32_b32 s24, s24
v_and_b32 v64, 63, v0
v_and_b32 v65, 15, v64
v_lshrrev_b32 v66, 4, v64
v_lshlrev_b32 v0, 4, v64
v_and_b32 v67, 2, v64
v_mov_b32 v68, 0x4444
v_mov_b32 v69, 0xeeee
v_cmp_eq_u32 vcc, 0, v67
s_nop 1
v_cndmask_b32 v1, v69, v68, vcc
s_mul_i32 s26, s13, 24576
s_add_u32 s26, s26, 65536
v_add_u32 v2, s26, v0
v_lshrrev_b32 v67, 2, v65
v_xor_b32 v68, v66, v67
v_lshlrev_b32 v68, 3, v68
v_lshl_add_u32 v68, v65, 5, v68
s_lshl_b32 s26, s13, 10
s_add_u32 s26, s26, 10240
v_add_u32 v3, s26, v68
v_lshl_add_u32 v68, v66, 2, v67
v_and_b32 v69, 3, v65
v_xor_b32 v69, v69, v66
v_lshlrev_b32 v69, 3, v69
v_lshl_add_u32 v68, v68, 5, v69
v_add_u32 v4, 10240, v68
v_and_b32 v69, 1, v65
v_lshl_add_u32 v68, v67, 1, v69
v_lshlrev_b32 v68, 4, v68
v_lshl_add_u32 v68, v66, 7, v68
v_add_u32 v5, 8192, v68
v_bfe_u32 v69, v65, 1, 1
v_mul_u32_u24 v69, 640, v69
v_xor_b32 v6, v69, v5
s_mov_b32 s42, 0x33333333
s_mov_b32 s43, 0x33333333
s_mov_b32 s44, 0x3f803f80
s_mov_b32 s45, 0x3f803f80
s_mov_b32 s46, 0x3f803f80
s_mov_b32 s47, 0
s_mov_b32 s37, 729808896
s_mov_b32 s38, 671088640
v_lshlrev_b32 v68, 3, v65
v_lshl_add_u32 v7, v66, 12, v68
s_lshl_b32 s26, s13, 14
s_lshl_b32 s27, s14, 7
s_add_u32 s26, s26, s27
s_add_u32 s90, s26, 65536
s_lshl_b32 s26, s13, 5
s_add_u32 s93, s26, s14
s_lshl_b32 s26, s93, 12
s_add_u32 s91, s26, 65536
s_lshr_b32 s26, s93, 2
s_lshl_b32 s26, s26, 9
s_and_b32 s27, s93, 3
s_lshl_b32 s27, s27, 6
s_add_u32 s26, s26, s27
s_add_u32 s92, s26, 393216
s_lshl_b32 s26, s14, 8
s_add_u32 s22, s26, 11534336
s_lshl_b32 s26, s24, 7
s_add_u32 s26, s26, 11550720
s_cmp_lt_u32 s24, 10
s_cselect_b32 s23, s26, 268435456
s_cselect_b32 s24, s24, 0
s_cselect_b32 s25, 12582912, s23
s_lshl_b32 s24, s24, 10
s_and_b32 s26, s14, 0
s_lshl_b32 s26, s26, 12
s_add_u32 s94, s26, 425984
s_lshl_b32 s26, s14, 7
s_add_u32 s95, s26, 425984
s_mov_b32 s35, 0x3e0293ee
s_lshl_b32 s26, s14, 2
s_add_u32 s26, s26, s13
s_mul_i32 s27, s26, 18432
s_add_u32 s89, s27, 1048576
s_add_u32 s48, s4, s90
s_addc_u32 s49, s5, 0
s_add_u32 s50, s90, 65536
s_add_u32 s50, s4, s50
s_addc_u32 s51, s5, 0
s_add_u32 s52, s90, 131072
s_add_u32 s52, s4, s52
s_addc_u32 s53, s5, 0
s_add_u32 s54, s90, 196608
s_add_u32 s54, s4, s54
s_addc_u32 s55, s5, 0
s_add_u32 s56, s90, 262144
s_add_u32 s56, s4, s56
s_addc_u32 s57, s5, 0
s_add_u32 s76, s89, 4096
s_add_u32 s76, s4, s76
s_addc_u32 s77, s5, 0
s_add_u32 s78, s89, 12288
s_add_u32 s78, s4, s78
s_addc_u32 s79, s5, 0
s_add_u32 s80, s89, 20480
s_add_u32 s80, s4, s80
s_addc_u32 s81, s5, 0
s_add_u32 s60, s4, s94
s_addc_u32 s61, s5, 0
s_add_u32 s62, s4, s95
s_addc_u32 s63, s5, 0
s_add_u32 s64, s4, s91
s_addc_u32 s65, s5, 0
s_add_u32 s66, s4, s92
s_addc_u32 s67, s5, 0
v_mov_b32 v72, 0
v_mov_b32 v73, 0
s_mov_b32 s26, s90
buffer_store_dwordx2 v[72:73], v7, s[4:7], s26 offen
s_add_u32 s26, s26, 65536
buffer_store_dwordx2 v[72:73], v7, s[4:7], s26 offen
s_add_u32 s26, s26, 65536
buffer_store_dwordx2 v[72:73], v7, s[4:7], s26 offen
s_add_u32 s26, s26, 65536
buffer_store_dwordx2 v[72:73], v7, s[4:7], s26 offen
s_add_u32 s26, s26, 65536
buffer_store_dwordx2 v[72:73], v7, s[4:7], s26 offen
s_add_u32 s26, s26, 65536
buffer_store_dword v72, off, s[4:7], s95 offset:0
s_load_dwordx2 s[96:97], s[0:1], 32
s_mov_b32 s98, 10240
s_mov_b32 s99, 0x20000
s_cmp_ge_u32 s93, 80
s_cbranch_scc1 nm0_10002
s_and_b32 s26, s93, 3
s_mul_i32 s26, s26, 2560
s_lshr_b32 s27, s93, 2
s_lshl_b32 s27, s27, 6
s_add_u32 s26, s26, s27
v_bfe_u32 v68, v65, 1, 2
v_lshlrev_b32 v68, 4, v68
v_and_b32 v69, 1, v65
v_lshl_add_u32 v68, v69, 2, v68
v_and_b32 v69, 1, v66
v_mul_u32_u24 v69, 1280, v69
v_add_u32 v68, v68, v69
s_waitcnt lgkmcnt(0)
buffer_load_dword v74, v68, s[96:99], s26 offen
buffer_load_dword v75, v68, s[96:99], s26 offen offset:8
v_and_b32 v68, 32, v0
v_bfe_u32 v69, v0, 6, 1
v_lshl_add_u32 v68, v69, 8, v68
v_bfe_u32 v69, v0, 8, 1
v_lshl_add_u32 v68, v69, 4, v68
v_bfe_u32 v69, v0, 4, 1
v_lshl_add_u32 v68, v69, 3, v68
s_add_u32 s27, s92, 16384
buffer_store_dwordx2 v[72:73], v68, s[4:7], s92 offen
s_waitcnt vmcnt(1)
buffer_store_dwordx2 v[74:75], v68, s[4:7], s27 offen
nm0_10002:
s_waitcnt vmcnt(0) lgkmcnt(0)
s_barrier
s_cmp_eq_u32 s13, 0
s_cselect_b32 s26, 144, s10
v_mov_b32 v74, 1
s_mov_b64 exec, 1
buffer_atomic_add v74, off, s[8:11], s26
s_mov_b64 exec, -1
v_lshrrev_b32 v67, 3, v64
v_and_b32 v68, 7, v64
v_lshlrev_b32 v68, 4, v68
v_lshl_add_u32 v32, v67, 13, v68
v_mul_u32_u24 v67, 1280, v67
v_add_u32 v36, v67, v68
v_lshrrev_b32 v67, 1, v66
v_lshlrev_b32 v67, 4, v67
v_and_b32 v68, 1, v66
v_lshl_add_u32 v67, v68, 1, v67
v_lshrrev_b32 v68, 3, v65
v_lshl_add_u32 v67, v68, 3, v67
v_bfe_u32 v68, v65, 2, 1
v_add_u32 v67, v67, v68
v_and_b32 v69, 3, v65
v_lshlrev_b32 v40, 4, v69
v_lshl_add_u32 v40, v67, 7, v40
v_lshl_add_u32 v67, v66, 2, v68
v_lshlrev_b32 v42, 4, v69
v_lshl_add_u32 v42, v67, 7, v42
v_lshrrev_b32 v68, 3, v65
v_lshl_add_u32 v42, v68, 3, v42
s_lshl_b32 s29, s13, 12
s_and_b32 s26, s13, 1
s_lshl_b32 s26, s26, 6
s_add_u32 s26, s26, s29
v_add_u32 v40, s26, v40
v_add_u32 v42, s26, v42
v_xor_b32 v41, 4096, v40
v_xor_b32 v43, 4096, v42
v_add_u32 v33, 64512, v32
v_add_u32 v37, 9216, v36
v_add_u32 v34, 129024, v32
v_add_u32 v38, 18432, v36
v_add_u32 v35, 193536, v32
v_add_u32 v39, 27648, v36
s_lshr_b32 s28, s13, 1
s_lshl_b32 s28, s28, 7
s_lshl_b32 s27, s14, 8
s_add_u32 s27, s27, s28
s_xor_b32 s26, s13, 0
s_lshl_b32 s82, s26, 19
s_add_u32 s82, s82, s27
s_lshl_b32 s85, s14, 2
s_add_u32 s85, s85, s26
s_mul_i32 s85, s85, 40960
s_add_u32 s85, s85, s28
s_xor_b32 s26, s13, 2
s_lshl_b32 s83, s26, 19
s_add_u32 s83, s83, s27
s_lshl_b32 s86, s14, 2
s_add_u32 s86, s86, s26
s_mul_i32 s86, s86, 40960
s_add_u32 s86, s86, s28
s_and_b32 s26, s13, 1
s_add_u32 s26, s26, 8
s_lshl_b32 s84, s26, 19
s_add_u32 s84, s84, s27
s_load_dwordx2 s[68:69], s[0:1], 40
s_load_dwordx2 s[70:71], s[0:1], 48
s_load_dwordx2 s[72:73], s[0:1], 56
s_load_dwordx2 s[74:75], s[0:1], 64
s_mov_b32 s98, 5242880
s_waitcnt lgkmcnt(0)
s_mov_b64 s[96:97], s[70:71]
s_add_u32 m0, s29, 0
s_add_u32 s26, s82, 0
buffer_load_dwordx4 v32, s[96:99], s26 offen offset:0 lds
buffer_load_dwordx4 v33, s[96:99], s26 offen offset:1024 lds
buffer_load_dwordx4 v34, s[96:99], s26 offen offset:2048 lds
buffer_load_dwordx4 v35, s[96:99], s26 offen offset:3072 lds
s_add_u32 m0, s29, 16384
s_add_u32 s26, s82, 262144
buffer_load_dwordx4 v32, s[96:99], s26 offen offset:0 lds
buffer_load_dwordx4 v33, s[96:99], s26 offen offset:1024 lds
buffer_load_dwordx4 v34, s[96:99], s26 offen offset:2048 lds
buffer_load_dwordx4 v35, s[96:99], s26 offen offset:3072 lds
s_add_u32 m0, s29, 32768
s_add_u32 s26, s82, 2097152
buffer_load_dwordx4 v32, s[96:99], s26 offen offset:0 lds
buffer_load_dwordx4 v33, s[96:99], s26 offen offset:1024 lds
buffer_load_dwordx4 v34, s[96:99], s26 offen offset:2048 lds
buffer_load_dwordx4 v35, s[96:99], s26 offen offset:3072 lds
s_waitcnt vmcnt(8)
s_barrier
s_add_u32 m0, s29, 49152
s_add_u32 s26, s82, 2359296
buffer_load_dwordx4 v32, s[96:99], s26 offen offset:0 lds
buffer_load_dwordx4 v33, s[96:99], s26 offen offset:1024 lds
buffer_load_dwordx4 v34, s[96:99], s26 offen offset:2048 lds
buffer_load_dwordx4 v35, s[96:99], s26 offen offset:3072 lds
ds_read_b64_tr_b16 v[72:73], v40 offset:0
ds_read_b64_tr_b16 v[74:75], v40 offset:512
ds_read_b64_tr_b16 v[76:77], v40 offset:8
ds_read_b64_tr_b16 v[78:79], v40 offset:520
ds_read_b64_tr_b16 a[160:161], v41 offset:0
ds_read_b64_tr_b16 a[162:163], v41 offset:512
ds_read_b64_tr_b16 v[84:85], v41 offset:8
ds_read_b64_tr_b16 v[86:87], v41 offset:520
s_waitcnt lgkmcnt(6)
global_store_dwordx4 v0, v[72:75], s[76:77] offset:0
s_waitcnt lgkmcnt(4)
global_store_dwordx4 v0, v[76:79], s[76:77] offset:2048
s_waitcnt lgkmcnt(0)
ds_write_b128 v2, v[84:87] offset:6144
s_waitcnt vmcnt(10)
s_barrier
s_add_u32 m0, s29, 0
s_add_u32 s26, s83, 0
buffer_load_dwordx4 v32, s[96:99], s26 offen offset:0 lds
buffer_load_dwordx4 v33, s[96:99], s26 offen offset:1024 lds
buffer_load_dwordx4 v34, s[96:99], s26 offen offset:2048 lds
buffer_load_dwordx4 v35, s[96:99], s26 offen offset:3072 lds
ds_read_b64_tr_b16 v[72:73], v40 offset:16384
ds_read_b64_tr_b16 v[74:75], v40 offset:16896
ds_read_b64_tr_b16 v[76:77], v40 offset:16392
ds_read_b64_tr_b16 v[78:79], v40 offset:16904
ds_read_b64_tr_b16 a[164:165], v41 offset:16384
ds_read_b64_tr_b16 a[166:167], v41 offset:16896
ds_read_b64_tr_b16 v[84:85], v41 offset:16392
ds_read_b64_tr_b16 v[86:87], v41 offset:16904
s_waitcnt lgkmcnt(6)
global_store_dwordx4 v0, v[72:75], s[76:77] offset:1024
s_waitcnt lgkmcnt(4)
global_store_dwordx4 v0, v[76:79], s[76:77] offset:3072
s_waitcnt lgkmcnt(0)
ds_write_b128 v2, v[84:87] offset:7168
s_waitcnt vmcnt(12)
s_barrier
s_add_u32 m0, s29, 16384
s_add_u32 s26, s83, 262144
buffer_load_dwordx4 v32, s[96:99], s26 offen offset:0 lds
buffer_load_dwordx4 v33, s[96:99], s26 offen offset:1024 lds
buffer_load_dwordx4 v34, s[96:99], s26 offen offset:2048 lds
buffer_load_dwordx4 v35, s[96:99], s26 offen offset:3072 lds
ds_read_b64_tr_b16 a[32:33], v40 offset:32768
ds_read_b64_tr_b16 a[34:35], v40 offset:33280
ds_read_b64_tr_b16 a[40:41], v40 offset:32776
ds_read_b64_tr_b16 a[42:43], v40 offset:33288
ds_read_b64_tr_b16 a[168:169], v41 offset:32768
ds_read_b64_tr_b16 a[170:171], v41 offset:33280
ds_read_b64_tr_b16 a[176:177], v41 offset:32776
ds_read_b64_tr_b16 a[178:179], v41 offset:33288
s_waitcnt vmcnt(12) lgkmcnt(0)
s_barrier
s_add_u32 m0, s29, 32768
s_add_u32 s26, s83, 2097152
buffer_load_dwordx4 v32, s[96:99], s26 offen offset:0 lds
buffer_load_dwordx4 v33, s[96:99], s26 offen offset:1024 lds
buffer_load_dwordx4 v34, s[96:99], s26 offen offset:2048 lds
buffer_load_dwordx4 v35, s[96:99], s26 offen offset:3072 lds
ds_read_b64_tr_b16 a[36:37], v40 offset:49152
ds_read_b64_tr_b16 a[38:39], v40 offset:49664
ds_read_b64_tr_b16 a[44:45], v40 offset:49160
ds_read_b64_tr_b16 a[46:47], v40 offset:49672
ds_read_b64_tr_b16 a[172:173], v41 offset:49152
ds_read_b64_tr_b16 a[174:175], v41 offset:49664
ds_read_b64_tr_b16 a[180:181], v41 offset:49160
ds_read_b64_tr_b16 a[182:183], v41 offset:49672
s_waitcnt vmcnt(10) lgkmcnt(0)
s_barrier
s_add_u32 m0, s29, 49152
s_add_u32 s26, s83, 2359296
buffer_load_dwordx4 v32, s[96:99], s26 offen offset:0 lds
buffer_load_dwordx4 v33, s[96:99], s26 offen offset:1024 lds
buffer_load_dwordx4 v34, s[96:99], s26 offen offset:2048 lds
buffer_load_dwordx4 v35, s[96:99], s26 offen offset:3072 lds
ds_read_b64_tr_b16 v[72:73], v40 offset:0
ds_read_b64_tr_b16 v[74:75], v40 offset:512
ds_read_b64_tr_b16 a[184:185], v40 offset:8
ds_read_b64_tr_b16 a[186:187], v40 offset:520
ds_read_b64_tr_b16 a[192:193], v41 offset:0
ds_read_b64_tr_b16 a[194:195], v41 offset:512
ds_read_b64_tr_b16 a[200:201], v41 offset:8
ds_read_b64_tr_b16 a[202:203], v41 offset:520
s_waitcnt lgkmcnt(6)
ds_write_b128 v2, v[72:75] offset:8192
s_waitcnt vmcnt(8) lgkmcnt(1)
s_barrier
s_add_u32 m0, s29, 0
s_add_u32 s26, s84, 0
buffer_load_dwordx4 v32, s[96:99], s26 offen offset:0 lds
buffer_load_dwordx4 v33, s[96:99], s26 offen offset:1024 lds
buffer_load_dwordx4 v34, s[96:99], s26 offen offset:2048 lds
buffer_load_dwordx4 v35, s[96:99], s26 offen offset:3072 lds
ds_read_b64_tr_b16 v[72:73], v40 offset:16384
ds_read_b64_tr_b16 v[74:75], v40 offset:16896
ds_read_b64_tr_b16 a[188:189], v40 offset:16392
ds_read_b64_tr_b16 a[190:191], v40 offset:16904
ds_read_b64_tr_b16 a[196:197], v41 offset:16384
ds_read_b64_tr_b16 a[198:199], v41 offset:16896
ds_read_b64_tr_b16 a[204:205], v41 offset:16392
ds_read_b64_tr_b16 a[206:207], v41 offset:16904
s_waitcnt lgkmcnt(6)
ds_write_b128 v2, v[72:75] offset:9216
s_waitcnt vmcnt(8) lgkmcnt(1)
s_barrier
s_add_u32 m0, s29, 16384
s_add_u32 s26, s84, 262144
buffer_load_dwordx4 v32, s[96:99], s26 offen offset:0 lds
buffer_load_dwordx4 v33, s[96:99], s26 offen offset:1024 lds
buffer_load_dwordx4 v34, s[96:99], s26 offen offset:2048 lds
buffer_load_dwordx4 v35, s[96:99], s26 offen offset:3072 lds
ds_read_b64_tr_b16 v[72:73], v40 offset:32768
ds_read_b64_tr_b16 v[74:75], v40 offset:33280
ds_read_b64_tr_b16 v[76:77], v40 offset:32776
ds_read_b64_tr_b16 v[78:79], v40 offset:33288
ds_read_b64_tr_b16 v[80:81], v41 offset:32768
ds_read_b64_tr_b16 v[82:83], v41 offset:33280
ds_read_b64_tr_b16 a[208:209], v41 offset:32776
ds_read_b64_tr_b16 a[210:211], v41 offset:33288
s_waitcnt lgkmcnt(6)
global_store_dwordx4 v0, v[72:75], s[78:79] offset:-2048
s_waitcnt lgkmcnt(4)
ds_write_b128 v2, v[76:79] offset:10240
s_waitcnt lgkmcnt(3)
ds_write_b128 v2, v[80:83] offset:12288
s_waitcnt vmcnt(9) lgkmcnt(2)
s_barrier
s_mov_b64 s[96:97], s[72:73]
s_add_u32 m0, s29, 32768
s_add_u32 s26, s82, 0
buffer_load_dwordx4 v32, s[96:99], s26 offen offset:0 lds
buffer_load_dwordx4 v33, s[96:99], s26 offen offset:1024 lds
buffer_load_dwordx4 v34, s[96:99], s26 offen offset:2048 lds
buffer_load_dwordx4 v35, s[96:99], s26 offen offset:3072 lds
ds_read_b64_tr_b16 v[72:73], v40 offset:49152
ds_read_b64_tr_b16 v[74:75], v40 offset:49664
ds_read_b64_tr_b16 v[76:77], v40 offset:49160
ds_read_b64_tr_b16 v[78:79], v40 offset:49672
ds_read_b64_tr_b16 v[80:81], v41 offset:49152
ds_read_b64_tr_b16 v[82:83], v41 offset:49664
ds_read_b64_tr_b16 a[212:213], v41 offset:49160
ds_read_b64_tr_b16 a[214:215], v41 offset:49672
s_waitcnt lgkmcnt(6)
global_store_dwordx4 v0, v[72:75], s[78:79] offset:-1024
s_waitcnt lgkmcnt(4)
ds_write_b128 v2, v[76:79] offset:11264
s_waitcnt lgkmcnt(3)
ds_write_b128 v2, v[80:83] offset:13312
s_waitcnt vmcnt(10) lgkmcnt(2)
s_barrier
s_add_u32 m0, s29, 49152
s_add_u32 s26, s82, 262144
buffer_load_dwordx4 v32, s[96:99], s26 offen offset:0 lds
buffer_load_dwordx4 v33, s[96:99], s26 offen offset:1024 lds
buffer_load_dwordx4 v34, s[96:99], s26 offen offset:2048 lds
buffer_load_dwordx4 v35, s[96:99], s26 offen offset:3072 lds
ds_read_b64_tr_b16 v[72:73], v40 offset:0
ds_read_b64_tr_b16 v[74:75], v40 offset:512
ds_read_b64_tr_b16 a[216:217], v40 offset:8
ds_read_b64_tr_b16 a[218:219], v40 offset:520
ds_read_b64_tr_b16 a[224:225], v41 offset:0
ds_read_b64_tr_b16 a[226:227], v41 offset:512
ds_read_b64_tr_b16 v[84:85], v41 offset:8
ds_read_b64_tr_b16 v[86:87], v41 offset:520
s_waitcnt lgkmcnt(6)
ds_write_b128 v2, v[72:75] offset:14336
s_waitcnt lgkmcnt(1)
ds_write_b128 v2, v[84:87] offset:16384
s_waitcnt vmcnt(10)
s_barrier
s_add_u32 m0, s29, 0
s_add_u32 s26, s82, 2097152
buffer_load_dwordx4 v32, s[96:99], s26 offen offset:0 lds
buffer_load_dwordx4 v33, s[96:99], s26 offen offset:1024 lds
buffer_load_dwordx4 v34, s[96:99], s26 offen offset:2048 lds
buffer_load_dwordx4 v35, s[96:99], s26 offen offset:3072 lds
ds_read_b64_tr_b16 v[72:73], v40 offset:16384
ds_read_b64_tr_b16 v[74:75], v40 offset:16896
ds_read_b64_tr_b16 a[220:221], v40 offset:16392
ds_read_b64_tr_b16 a[222:223], v40 offset:16904
ds_read_b64_tr_b16 a[228:229], v41 offset:16384
ds_read_b64_tr_b16 a[230:231], v41 offset:16896
ds_read_b64_tr_b16 v[84:85], v41 offset:16392
ds_read_b64_tr_b16 v[86:87], v41 offset:16904
s_waitcnt lgkmcnt(6)
ds_write_b128 v2, v[72:75] offset:15360
s_waitcnt lgkmcnt(1)
ds_write_b128 v2, v[84:87] offset:17408
s_waitcnt vmcnt(9)
s_barrier
s_add_u32 m0, s29, 16384
s_add_u32 s26, s82, 2359296
buffer_load_dwordx4 v32, s[96:99], s26 offen offset:0 lds
buffer_load_dwordx4 v33, s[96:99], s26 offen offset:1024 lds
buffer_load_dwordx4 v34, s[96:99], s26 offen offset:2048 lds
buffer_load_dwordx4 v35, s[96:99], s26 offen offset:3072 lds
ds_read_b64_tr_b16 a[0:1], v40 offset:32768
ds_read_b64_tr_b16 a[2:3], v40 offset:33280
ds_read_b64_tr_b16 a[8:9], v40 offset:32776
ds_read_b64_tr_b16 a[10:11], v40 offset:33288
ds_read_b64_tr_b16 a[248:249], v41 offset:32768
ds_read_b64_tr_b16 a[250:251], v41 offset:33280
ds_read_b64_tr_b16 v[88:89], v41 offset:32776
ds_read_b64_tr_b16 v[90:91], v41 offset:33288
s_waitcnt vmcnt(8) lgkmcnt(0)
s_barrier
s_add_u32 m0, s29, 32768
s_add_u32 s26, s83, 0
buffer_load_dwordx4 v32, s[96:99], s26 offen offset:0 lds
buffer_load_dwordx4 v33, s[96:99], s26 offen offset:1024 lds
buffer_load_dwordx4 v34, s[96:99], s26 offen offset:2048 lds
buffer_load_dwordx4 v35, s[96:99], s26 offen offset:3072 lds
ds_read_b64_tr_b16 a[4:5], v40 offset:49152
ds_read_b64_tr_b16 a[6:7], v40 offset:49664
ds_read_b64_tr_b16 a[12:13], v40 offset:49160
ds_read_b64_tr_b16 a[14:15], v40 offset:49672
ds_read_b64_tr_b16 a[252:253], v41 offset:49152
ds_read_b64_tr_b16 a[254:255], v41 offset:49664
ds_read_b64_tr_b16 v[92:93], v41 offset:49160
ds_read_b64_tr_b16 v[94:95], v41 offset:49672
s_waitcnt vmcnt(8) lgkmcnt(0)
s_barrier
s_add_u32 m0, s29, 49152
s_add_u32 s26, s83, 262144
buffer_load_dwordx4 v32, s[96:99], s26 offen offset:0 lds
buffer_load_dwordx4 v33, s[96:99], s26 offen offset:1024 lds
buffer_load_dwordx4 v34, s[96:99], s26 offen offset:2048 lds
buffer_load_dwordx4 v35, s[96:99], s26 offen offset:3072 lds
ds_read_b64_tr_b16 a[48:49], v40 offset:0
ds_read_b64_tr_b16 a[50:51], v40 offset:512
ds_read_b64_tr_b16 v[76:77], v40 offset:8
ds_read_b64_tr_b16 v[78:79], v40 offset:520
ds_read_b64_tr_b16 v[80:81], v41 offset:0
ds_read_b64_tr_b16 v[82:83], v41 offset:512
ds_read_b64_tr_b16 v[96:97], v41 offset:8
ds_read_b64_tr_b16 v[98:99], v41 offset:520
s_waitcnt lgkmcnt(4)
ds_write_b128 v2, v[76:79] offset:0
s_waitcnt lgkmcnt(3)
ds_write_b128 v2, v[80:83] offset:22528
s_waitcnt vmcnt(8) lgkmcnt(2)
s_barrier
s_add_u32 m0, s29, 0
s_add_u32 s26, s83, 2097152
buffer_load_dwordx4 v32, s[96:99], s26 offen offset:0 lds
buffer_load_dwordx4 v33, s[96:99], s26 offen offset:1024 lds
buffer_load_dwordx4 v34, s[96:99], s26 offen offset:2048 lds
buffer_load_dwordx4 v35, s[96:99], s26 offen offset:3072 lds
ds_read_b64_tr_b16 a[52:53], v40 offset:16384
ds_read_b64_tr_b16 a[54:55], v40 offset:16896
ds_read_b64_tr_b16 v[76:77], v40 offset:16392
ds_read_b64_tr_b16 v[78:79], v40 offset:16904
ds_read_b64_tr_b16 v[80:81], v41 offset:16384
ds_read_b64_tr_b16 v[82:83], v41 offset:16896
ds_read_b64_tr_b16 v[100:101], v41 offset:16392
ds_read_b64_tr_b16 v[102:103], v41 offset:16904
s_waitcnt lgkmcnt(4)
ds_write_b128 v2, v[76:79] offset:1024
s_waitcnt lgkmcnt(3)
ds_write_b128 v2, v[80:83] offset:23552
s_waitcnt vmcnt(8) lgkmcnt(2)
s_barrier
s_add_u32 m0, s29, 16384
s_add_u32 s26, s83, 2359296
buffer_load_dwordx4 v32, s[96:99], s26 offen offset:0 lds
buffer_load_dwordx4 v33, s[96:99], s26 offen offset:1024 lds
buffer_load_dwordx4 v34, s[96:99], s26 offen offset:2048 lds
buffer_load_dwordx4 v35, s[96:99], s26 offen offset:3072 lds
ds_read_b64_tr_b16 v[104:105], v40 offset:32768
ds_read_b64_tr_b16 v[106:107], v40 offset:33280
ds_read_b64_tr_b16 v[112:113], v40 offset:32776
ds_read_b64_tr_b16 v[114:115], v40 offset:33288
ds_read_b64_tr_b16 v[136:137], v41 offset:32768
ds_read_b64_tr_b16 v[138:139], v41 offset:33280
ds_read_b64_tr_b16 v[144:145], v41 offset:32776
ds_read_b64_tr_b16 v[146:147], v41 offset:33288
s_waitcnt vmcnt(8) lgkmcnt(0)
s_barrier
s_add_u32 m0, s29, 32768
s_add_u32 s26, s84, 0
buffer_load_dwordx4 v32, s[96:99], s26 offen offset:0 lds
buffer_load_dwordx4 v33, s[96:99], s26 offen offset:1024 lds
buffer_load_dwordx4 v34, s[96:99], s26 offen offset:2048 lds
buffer_load_dwordx4 v35, s[96:99], s26 offen offset:3072 lds
ds_read_b64_tr_b16 v[108:109], v40 offset:49152
ds_read_b64_tr_b16 v[110:111], v40 offset:49664
ds_read_b64_tr_b16 v[116:117], v40 offset:49160
ds_read_b64_tr_b16 v[118:119], v40 offset:49672
ds_read_b64_tr_b16 v[140:141], v41 offset:49152
ds_read_b64_tr_b16 v[142:143], v41 offset:49664
ds_read_b64_tr_b16 v[148:149], v41 offset:49160
ds_read_b64_tr_b16 v[150:151], v41 offset:49672
s_waitcnt vmcnt(8) lgkmcnt(0)
s_barrier
s_add_u32 m0, s29, 49152
s_add_u32 s26, s84, 262144
buffer_load_dwordx4 v32, s[96:99], s26 offen offset:0 lds
buffer_load_dwordx4 v33, s[96:99], s26 offen offset:1024 lds
buffer_load_dwordx4 v34, s[96:99], s26 offen offset:2048 lds
buffer_load_dwordx4 v35, s[96:99], s26 offen offset:3072 lds
ds_read_b64_tr_b16 v[120:121], v40 offset:0
ds_read_b64_tr_b16 v[122:123], v40 offset:512
ds_read_b64_tr_b16 v[128:129], v40 offset:8
ds_read_b64_tr_b16 v[130:131], v40 offset:520
ds_read_b64_tr_b16 v[152:153], v41 offset:0
ds_read_b64_tr_b16 v[154:155], v41 offset:512
ds_read_b64_tr_b16 v[160:161], v41 offset:8
ds_read_b64_tr_b16 v[162:163], v41 offset:520
s_waitcnt vmcnt(8) lgkmcnt(0)
s_barrier
s_mov_b64 s[96:97], s[68:69]
s_add_u32 m0, s29, 0
s_add_u32 s26, s82, 0
buffer_load_dwordx4 v32, s[96:99], s26 offen offset:0 lds
buffer_load_dwordx4 v33, s[96:99], s26 offen offset:1024 lds
buffer_load_dwordx4 v34, s[96:99], s26 offen offset:2048 lds
buffer_load_dwordx4 v35, s[96:99], s26 offen offset:3072 lds
ds_read_b64_tr_b16 v[124:125], v40 offset:16384
ds_read_b64_tr_b16 v[126:127], v40 offset:16896
ds_read_b64_tr_b16 v[132:133], v40 offset:16392
ds_read_b64_tr_b16 v[134:135], v40 offset:16904
ds_read_b64_tr_b16 v[156:157], v41 offset:16384
ds_read_b64_tr_b16 v[158:159], v41 offset:16896
ds_read_b64_tr_b16 v[164:165], v41 offset:16392
ds_read_b64_tr_b16 v[166:167], v41 offset:16904
s_waitcnt vmcnt(8) lgkmcnt(0)
s_barrier
s_add_u32 m0, s29, 16384
s_add_u32 s26, s82, 262144
buffer_load_dwordx4 v32, s[96:99], s26 offen offset:0 lds
buffer_load_dwordx4 v33, s[96:99], s26 offen offset:1024 lds
buffer_load_dwordx4 v34, s[96:99], s26 offen offset:2048 lds
buffer_load_dwordx4 v35, s[96:99], s26 offen offset:3072 lds
ds_read_b64_tr_b16 v[72:73], v40 offset:32768
ds_read_b64_tr_b16 v[74:75], v40 offset:33280
ds_read_b64_tr_b16 a[232:233], v40 offset:32776
ds_read_b64_tr_b16 a[234:235], v40 offset:33288
ds_read_b64_tr_b16 a[240:241], v41 offset:32768
ds_read_b64_tr_b16 a[242:243], v41 offset:33280
ds_read_b64_tr_b16 v[84:85], v41 offset:32776
ds_read_b64_tr_b16 v[86:87], v41 offset:33288
s_waitcnt lgkmcnt(6)
ds_write_b128 v2, v[72:75] offset:18432
s_waitcnt lgkmcnt(1)
ds_write_b128 v2, v[84:87] offset:20480
s_waitcnt vmcnt(8)
s_barrier
s_add_u32 m0, s29, 32768
s_add_u32 s26, s82, 2097152
buffer_load_dwordx4 v32, s[96:99], s26 offen offset:0 lds
buffer_load_dwordx4 v33, s[96:99], s26 offen offset:1024 lds
buffer_load_dwordx4 v34, s[96:99], s26 offen offset:2048 lds
buffer_load_dwordx4 v35, s[96:99], s26 offen offset:3072 lds
ds_read_b64_tr_b16 v[72:73], v40 offset:49152
ds_read_b64_tr_b16 v[74:75], v40 offset:49664
ds_read_b64_tr_b16 a[236:237], v40 offset:49160
ds_read_b64_tr_b16 a[238:239], v40 offset:49672
ds_read_b64_tr_b16 a[244:245], v41 offset:49152
ds_read_b64_tr_b16 a[246:247], v41 offset:49664
ds_read_b64_tr_b16 v[84:85], v41 offset:49160
ds_read_b64_tr_b16 v[86:87], v41 offset:49672
s_waitcnt lgkmcnt(6)
ds_write_b128 v2, v[72:75] offset:19456
s_waitcnt lgkmcnt(1)
ds_write_b128 v2, v[84:87] offset:21504
s_waitcnt vmcnt(8)
s_barrier
s_add_u32 m0, s29, 49152
s_add_u32 s26, s82, 2359296
buffer_load_dwordx4 v32, s[96:99], s26 offen offset:0 lds
buffer_load_dwordx4 v33, s[96:99], s26 offen offset:1024 lds
buffer_load_dwordx4 v34, s[96:99], s26 offen offset:2048 lds
buffer_load_dwordx4 v35, s[96:99], s26 offen offset:3072 lds
ds_read_b64_tr_b16 v[72:73], v40 offset:0
ds_read_b64_tr_b16 v[74:75], v40 offset:512
ds_read_b64_tr_b16 v[76:77], v40 offset:8
ds_read_b64_tr_b16 v[78:79], v40 offset:520
ds_read_b64_tr_b16 a[56:57], v41 offset:0
ds_read_b64_tr_b16 a[58:59], v41 offset:512
ds_read_b64_tr_b16 a[64:65], v41 offset:8
ds_read_b64_tr_b16 a[66:67], v41 offset:520
s_waitcnt lgkmcnt(6)
global_store_dwordx4 v0, v[72:75], s[76:77] offset:-4096
s_waitcnt lgkmcnt(4)
global_store_dwordx4 v0, v[76:79], s[76:77] offset:-2048
s_waitcnt vmcnt(10) lgkmcnt(0)
s_barrier
s_add_u32 m0, s29, 0
s_add_u32 s26, s83, 0
buffer_load_dwordx4 v32, s[96:99], s26 offen offset:0 lds
buffer_load_dwordx4 v33, s[96:99], s26 offen offset:1024 lds
buffer_load_dwordx4 v34, s[96:99], s26 offen offset:2048 lds
buffer_load_dwordx4 v35, s[96:99], s26 offen offset:3072 lds
ds_read_b64_tr_b16 v[72:73], v40 offset:16384
ds_read_b64_tr_b16 v[74:75], v40 offset:16896
ds_read_b64_tr_b16 v[76:77], v40 offset:16392
ds_read_b64_tr_b16 v[78:79], v40 offset:16904
ds_read_b64_tr_b16 a[60:61], v41 offset:16384
ds_read_b64_tr_b16 a[62:63], v41 offset:16896
ds_read_b64_tr_b16 a[68:69], v41 offset:16392
ds_read_b64_tr_b16 a[70:71], v41 offset:16904
s_waitcnt lgkmcnt(6)
global_store_dwordx4 v0, v[72:75], s[76:77] offset:-3072
s_waitcnt lgkmcnt(4)
global_store_dwordx4 v0, v[76:79], s[76:77] offset:-1024
s_waitcnt vmcnt(12) lgkmcnt(0)
s_barrier
s_add_u32 m0, s29, 16384
s_add_u32 s26, s83, 262144
buffer_load_dwordx4 v32, s[96:99], s26 offen offset:0 lds
buffer_load_dwordx4 v33, s[96:99], s26 offen offset:1024 lds
buffer_load_dwordx4 v34, s[96:99], s26 offen offset:2048 lds
buffer_load_dwordx4 v35, s[96:99], s26 offen offset:3072 lds
ds_read_b64_tr_b16 a[16:17], v40 offset:32768
ds_read_b64_tr_b16 a[18:19], v40 offset:33280
ds_read_b64_tr_b16 a[24:25], v40 offset:32776
ds_read_b64_tr_b16 a[26:27], v40 offset:33288
ds_read_b64_tr_b16 a[72:73], v41 offset:32768
ds_read_b64_tr_b16 a[74:75], v41 offset:33280
ds_read_b64_tr_b16 a[80:81], v41 offset:32776
ds_read_b64_tr_b16 a[82:83], v41 offset:33288
s_waitcnt vmcnt(12) lgkmcnt(0)
s_barrier
s_add_u32 m0, s29, 32768
s_add_u32 s26, s83, 2097152
buffer_load_dwordx4 v32, s[96:99], s26 offen offset:0 lds
buffer_load_dwordx4 v33, s[96:99], s26 offen offset:1024 lds
buffer_load_dwordx4 v34, s[96:99], s26 offen offset:2048 lds
buffer_load_dwordx4 v35, s[96:99], s26 offen offset:3072 lds
ds_read_b64_tr_b16 a[20:21], v40 offset:49152
ds_read_b64_tr_b16 a[22:23], v40 offset:49664
ds_read_b64_tr_b16 a[28:29], v40 offset:49160
ds_read_b64_tr_b16 a[30:31], v40 offset:49672
ds_read_b64_tr_b16 a[76:77], v41 offset:49152
ds_read_b64_tr_b16 a[78:79], v41 offset:49664
ds_read_b64_tr_b16 a[84:85], v41 offset:49160
ds_read_b64_tr_b16 a[86:87], v41 offset:49672
s_waitcnt vmcnt(10) lgkmcnt(0)
s_barrier
s_add_u32 m0, s29, 49152
s_add_u32 s26, s83, 2359296
buffer_load_dwordx4 v32, s[96:99], s26 offen offset:0 lds
buffer_load_dwordx4 v33, s[96:99], s26 offen offset:1024 lds
buffer_load_dwordx4 v34, s[96:99], s26 offen offset:2048 lds
buffer_load_dwordx4 v35, s[96:99], s26 offen offset:3072 lds
ds_read_b64_tr_b16 a[88:89], v40 offset:0
ds_read_b64_tr_b16 a[90:91], v40 offset:512
ds_read_b64_tr_b16 v[76:77], v40 offset:8
ds_read_b64_tr_b16 v[78:79], v40 offset:520
ds_read_b64_tr_b16 a[112:113], v41 offset:0
ds_read_b64_tr_b16 a[114:115], v41 offset:512
ds_read_b64_tr_b16 a[120:121], v41 offset:8
ds_read_b64_tr_b16 a[122:123], v41 offset:520
s_waitcnt lgkmcnt(4)
ds_write_b128 v2, v[76:79] offset:2048
s_waitcnt vmcnt(8) lgkmcnt(1)
s_barrier
s_add_u32 m0, s29, 0
s_add_u32 s26, s84, 0
buffer_load_dwordx4 v32, s[96:99], s26 offen offset:0 lds
buffer_load_dwordx4 v33, s[96:99], s26 offen offset:1024 lds
buffer_load_dwordx4 v34, s[96:99], s26 offen offset:2048 lds
buffer_load_dwordx4 v35, s[96:99], s26 offen offset:3072 lds
ds_read_b64_tr_b16 a[92:93], v40 offset:16384
ds_read_b64_tr_b16 a[94:95], v40 offset:16896
ds_read_b64_tr_b16 v[76:77], v40 offset:16392
ds_read_b64_tr_b16 v[78:79], v40 offset:16904
ds_read_b64_tr_b16 a[116:117], v41 offset:16384
ds_read_b64_tr_b16 a[118:119], v41 offset:16896
ds_read_b64_tr_b16 a[124:125], v41 offset:16392
ds_read_b64_tr_b16 a[126:127], v41 offset:16904
s_waitcnt lgkmcnt(4)
ds_write_b128 v2, v[76:79] offset:3072
s_waitcnt vmcnt(8) lgkmcnt(1)
s_barrier
s_add_u32 m0, s29, 16384
s_add_u32 s26, s84, 262144
buffer_load_dwordx4 v32, s[96:99], s26 offen offset:0 lds
buffer_load_dwordx4 v33, s[96:99], s26 offen offset:1024 lds
buffer_load_dwordx4 v34, s[96:99], s26 offen offset:2048 lds
buffer_load_dwordx4 v35, s[96:99], s26 offen offset:3072 lds
ds_read_b64_tr_b16 a[96:97], v40 offset:32768
ds_read_b64_tr_b16 a[98:99], v40 offset:33280
ds_read_b64_tr_b16 a[104:105], v40 offset:32776
ds_read_b64_tr_b16 a[106:107], v40 offset:33288
ds_read_b64_tr_b16 a[128:129], v41 offset:32768
ds_read_b64_tr_b16 a[130:131], v41 offset:33280
ds_read_b64_tr_b16 v[84:85], v41 offset:32776
ds_read_b64_tr_b16 v[86:87], v41 offset:33288
s_waitcnt lgkmcnt(0)
ds_write_b128 v2, v[84:87] offset:4096
s_waitcnt vmcnt(8)
s_barrier
s_mov_b64 s[96:97], s[74:75]
s_add_u32 m0, s29, 32768
s_add_u32 s26, s85, 0
buffer_load_dwordx4 v36, s[96:99], s26 offen offset:0 lds
buffer_load_dwordx4 v37, s[96:99], s26 offen offset:1024 lds
buffer_load_dwordx4 v38, s[96:99], s26 offen offset:2048 lds
buffer_load_dwordx4 v39, s[96:99], s26 offen offset:3072 lds
ds_read_b64_tr_b16 a[100:101], v40 offset:49152
ds_read_b64_tr_b16 a[102:103], v40 offset:49664
ds_read_b64_tr_b16 a[108:109], v40 offset:49160
ds_read_b64_tr_b16 a[110:111], v40 offset:49672
ds_read_b64_tr_b16 a[132:133], v41 offset:49152
ds_read_b64_tr_b16 a[134:135], v41 offset:49664
ds_read_b64_tr_b16 v[84:85], v41 offset:49160
ds_read_b64_tr_b16 v[86:87], v41 offset:49672
s_waitcnt lgkmcnt(0)
ds_write_b128 v2, v[84:87] offset:5120
s_waitcnt vmcnt(8)
s_barrier
s_add_u32 m0, s29, 49152
s_add_u32 s26, s86, 0
buffer_load_dwordx4 v36, s[96:99], s26 offen offset:0 lds
buffer_load_dwordx4 v37, s[96:99], s26 offen offset:1024 lds
buffer_load_dwordx4 v38, s[96:99], s26 offen offset:2048 lds
buffer_load_dwordx4 v39, s[96:99], s26 offen offset:3072 lds
ds_read_b64_tr_b16 a[136:137], v40 offset:0
ds_read_b64_tr_b16 a[138:139], v40 offset:512
ds_read_b64_tr_b16 a[144:145], v40 offset:8
ds_read_b64_tr_b16 a[146:147], v40 offset:520
ds_read_b64_tr_b16 v[80:81], v41 offset:0
ds_read_b64_tr_b16 v[82:83], v41 offset:512
ds_read_b64_tr_b16 a[152:153], v41 offset:8
ds_read_b64_tr_b16 a[154:155], v41 offset:520
s_waitcnt lgkmcnt(2)
global_store_dwordx4 v0, v[80:83], s[78:79] offset:-4096
s_waitcnt vmcnt(9) lgkmcnt(0)
s_barrier
s_add_u32 m0, s29, 0
s_add_u32 s26, s85, 256
buffer_load_dwordx4 v36, s[96:99], s26 offen offset:0 lds
buffer_load_dwordx4 v37, s[96:99], s26 offen offset:1024 lds
buffer_load_dwordx4 v38, s[96:99], s26 offen offset:2048 lds
buffer_load_dwordx4 v39, s[96:99], s26 offen offset:3072 lds
ds_read_b64_tr_b16 a[140:141], v40 offset:16384
ds_read_b64_tr_b16 a[142:143], v40 offset:16896
ds_read_b64_tr_b16 a[148:149], v40 offset:16392
ds_read_b64_tr_b16 a[150:151], v40 offset:16904
ds_read_b64_tr_b16 v[80:81], v41 offset:16384
ds_read_b64_tr_b16 v[82:83], v41 offset:16896
ds_read_b64_tr_b16 a[156:157], v41 offset:16392
ds_read_b64_tr_b16 a[158:159], v41 offset:16904
s_waitcnt lgkmcnt(2)
global_store_dwordx4 v0, v[80:83], s[78:79] offset:-3072
s_waitcnt vmcnt(10) lgkmcnt(0)
s_barrier
s_add_u32 m0, s29, 16384
s_add_u32 s26, s86, 256
buffer_load_dwordx4 v36, s[96:99], s26 offen offset:0 lds
buffer_load_dwordx4 v37, s[96:99], s26 offen offset:1024 lds
buffer_load_dwordx4 v38, s[96:99], s26 offen offset:2048 lds
buffer_load_dwordx4 v39, s[96:99], s26 offen offset:3072 lds
ds_read_b64_tr_b16 v[72:73], v42 offset:32768
ds_read_b64_tr_b16 v[74:75], v42 offset:33024
ds_read_b64_tr_b16 v[76:77], v42 offset:34816
ds_read_b64_tr_b16 v[78:79], v42 offset:35072
ds_read_b64_tr_b16 v[8:9], v43 offset:32768
ds_read_b64_tr_b16 v[10:11], v43 offset:33024
ds_read_b64_tr_b16 v[12:13], v43 offset:34816
ds_read_b64_tr_b16 v[14:15], v43 offset:35072
s_waitcnt lgkmcnt(6)
global_store_dwordx4 v0, v[72:75], s[78:79] offset:0
s_waitcnt lgkmcnt(4)
global_store_dwordx4 v0, v[76:79], s[78:79] offset:1024
s_waitcnt vmcnt(12) lgkmcnt(0)
s_barrier
s_add_u32 m0, s29, 32768
s_add_u32 s26, s85, 512
buffer_load_dwordx4 v36, s[96:99], s26 offen offset:0 lds
buffer_load_dwordx4 v37, s[96:99], s26 offen offset:1024 lds
buffer_load_dwordx4 v38, s[96:99], s26 offen offset:2048 lds
buffer_load_dwordx4 v39, s[96:99], s26 offen offset:3072 lds
ds_read_b64_tr_b16 v[16:17], v42 offset:49152
ds_read_b64_tr_b16 v[18:19], v42 offset:49408
ds_read_b64_tr_b16 v[20:21], v42 offset:51200
ds_read_b64_tr_b16 v[22:23], v42 offset:51456
ds_read_b64_tr_b16 v[184:185], v43 offset:49152
ds_read_b64_tr_b16 v[186:187], v43 offset:49408
ds_read_b64_tr_b16 v[188:189], v43 offset:51200
ds_read_b64_tr_b16 v[190:191], v43 offset:51456
s_waitcnt vmcnt(11) lgkmcnt(0)
s_barrier
s_add_u32 m0, s29, 49152
s_add_u32 s26, s86, 512
buffer_load_dwordx4 v36, s[96:99], s26 offen offset:0 lds
buffer_load_dwordx4 v37, s[96:99], s26 offen offset:1024 lds
buffer_load_dwordx4 v38, s[96:99], s26 offen offset:2048 lds
buffer_load_dwordx4 v39, s[96:99], s26 offen offset:3072 lds
ds_read_b64_tr_b16 v[72:73], v42 offset:0
ds_read_b64_tr_b16 v[74:75], v42 offset:256
ds_read_b64_tr_b16 v[76:77], v42 offset:2048
ds_read_b64_tr_b16 v[78:79], v42 offset:2304
ds_read_b64_tr_b16 v[192:193], v43 offset:0
ds_read_b64_tr_b16 v[194:195], v43 offset:256
ds_read_b64_tr_b16 v[196:197], v43 offset:2048
ds_read_b64_tr_b16 v[198:199], v43 offset:2304
s_waitcnt lgkmcnt(6)
global_store_dwordx4 v0, v[72:75], s[78:79] offset:2048
s_waitcnt lgkmcnt(4)
global_store_dwordx4 v0, v[76:79], s[78:79] offset:3072
s_waitcnt vmcnt(12) lgkmcnt(0)
s_barrier
s_add_u32 m0, s29, 0
s_add_u32 s26, s85, 768
buffer_load_dwordx4 v36, s[96:99], s26 offen offset:0 lds
buffer_load_dwordx4 v37, s[96:99], s26 offen offset:1024 lds
buffer_load_dwordx4 v38, s[96:99], s26 offen offset:2048 lds
buffer_load_dwordx4 v39, s[96:99], s26 offen offset:3072 lds
ds_read_b64_tr_b16 v[24:25], v42 offset:16384
ds_read_b64_tr_b16 v[26:27], v42 offset:16640
ds_read_b64_tr_b16 v[28:29], v42 offset:18432
ds_read_b64_tr_b16 v[30:31], v42 offset:18688
ds_read_b64_tr_b16 v[200:201], v43 offset:16384
ds_read_b64_tr_b16 v[202:203], v43 offset:16640
ds_read_b64_tr_b16 v[204:205], v43 offset:18432
ds_read_b64_tr_b16 v[206:207], v43 offset:18688
s_waitcnt vmcnt(10) lgkmcnt(0)
s_barrier
s_add_u32 m0, s29, 16384
s_add_u32 s26, s86, 768
buffer_load_dwordx4 v36, s[96:99], s26 offen offset:0 lds
buffer_load_dwordx4 v37, s[96:99], s26 offen offset:1024 lds
buffer_load_dwordx4 v38, s[96:99], s26 offen offset:2048 lds
buffer_load_dwordx4 v39, s[96:99], s26 offen offset:3072 lds
ds_read_b64_tr_b16 v[168:169], v42 offset:32768
ds_read_b64_tr_b16 v[170:171], v42 offset:33024
ds_read_b64_tr_b16 v[172:173], v42 offset:34816
ds_read_b64_tr_b16 v[174:175], v42 offset:35072
ds_read_b64_tr_b16 v[48:49], v43 offset:32768
ds_read_b64_tr_b16 v[50:51], v43 offset:33024
ds_read_b64_tr_b16 v[52:53], v43 offset:34816
ds_read_b64_tr_b16 v[54:55], v43 offset:35072
s_waitcnt vmcnt(10) lgkmcnt(0)
s_barrier
s_add_u32 m0, s29, 32768
s_add_u32 s26, s85, 1024
buffer_load_dwordx4 v36, s[96:99], s26 offen offset:0 lds
buffer_load_dwordx4 v37, s[96:99], s26 offen offset:1024 lds
buffer_load_dwordx4 v38, s[96:99], s26 offen offset:2048 lds
buffer_load_dwordx4 v39, s[96:99], s26 offen offset:3072 lds
ds_read_b64_tr_b16 v[56:57], v42 offset:49152
ds_read_b64_tr_b16 v[58:59], v42 offset:49408
ds_read_b64_tr_b16 v[60:61], v42 offset:51200
ds_read_b64_tr_b16 v[62:63], v42 offset:51456
ds_read_b64_tr_b16 v[208:209], v43 offset:49152
ds_read_b64_tr_b16 v[210:211], v43 offset:49408
ds_read_b64_tr_b16 v[212:213], v43 offset:51200
ds_read_b64_tr_b16 v[214:215], v43 offset:51456
v_lshrrev_b32 v44, 4, v0
v_and_b32 v44, 15, v44
v_lshlrev_b32 v44, 4, v44
buffer_load_dword v45, v44, s[8:11], 0 offen sc1
s_waitcnt vmcnt(9) lgkmcnt(0)
s_barrier
s_add_u32 m0, s29, 49152
s_add_u32 s26, s86, 1024
buffer_load_dwordx4 v36, s[96:99], s26 offen offset:0 lds
buffer_load_dwordx4 v37, s[96:99], s26 offen offset:1024 lds
buffer_load_dwordx4 v38, s[96:99], s26 offen offset:2048 lds
buffer_load_dwordx4 v39, s[96:99], s26 offen offset:3072 lds
ds_read_b64_tr_b16 v[176:177], v42 offset:0
ds_read_b64_tr_b16 v[178:179], v42 offset:256
ds_read_b64_tr_b16 v[180:181], v42 offset:2048
ds_read_b64_tr_b16 v[182:183], v42 offset:2304
ds_read_b64_tr_b16 v[216:217], v43 offset:0
ds_read_b64_tr_b16 v[218:219], v43 offset:256
ds_read_b64_tr_b16 v[220:221], v43 offset:2048
ds_read_b64_tr_b16 v[222:223], v43 offset:2304
s_waitcnt vmcnt(9) lgkmcnt(0)
s_barrier
ds_read_b64_tr_b16 v[64:65], v42 offset:16384
ds_read_b64_tr_b16 v[66:67], v42 offset:16640
ds_read_b64_tr_b16 v[68:69], v42 offset:18432
ds_read_b64_tr_b16 v[70:71], v42 offset:18688
ds_read_b64_tr_b16 v[224:225], v43 offset:16384
ds_read_b64_tr_b16 v[226:227], v43 offset:16640
ds_read_b64_tr_b16 v[228:229], v43 offset:18432
ds_read_b64_tr_b16 v[230:231], v43 offset:18688
s_waitcnt vmcnt(5) lgkmcnt(0)
s_barrier
ds_read_b64_tr_b16 v[72:73], v42 offset:32768
ds_read_b64_tr_b16 v[74:75], v42 offset:33024
ds_read_b64_tr_b16 v[76:77], v42 offset:34816
ds_read_b64_tr_b16 v[78:79], v42 offset:35072
ds_read_b64_tr_b16 v[232:233], v43 offset:32768
ds_read_b64_tr_b16 v[234:235], v43 offset:33024
ds_read_b64_tr_b16 v[236:237], v43 offset:34816
ds_read_b64_tr_b16 v[238:239], v43 offset:35072
s_waitcnt lgkmcnt(6)
global_store_dwordx4 v0, v[72:75], s[80:81] offset:-4096
s_waitcnt lgkmcnt(4)
global_store_dwordx4 v0, v[76:79], s[80:81] offset:-3072
s_waitcnt vmcnt(2) lgkmcnt(0)
s_barrier
ds_read_b64_tr_b16 v[240:241], v42 offset:49152
ds_read_b64_tr_b16 v[242:243], v42 offset:49408
ds_read_b64_tr_b16 v[244:245], v42 offset:51200
ds_read_b64_tr_b16 v[246:247], v42 offset:51456
ds_read_b64_tr_b16 v[248:249], v43 offset:49152
ds_read_b64_tr_b16 v[250:251], v43 offset:49408
ds_read_b64_tr_b16 v[252:253], v43 offset:51200
ds_read_b64_tr_b16 v[254:255], v43 offset:51456
s_waitcnt lgkmcnt(0)
s_barrier
s_mul_i32 s26, s13, 12288
v_add_u32 v47, s26, v0
ds_write_b128 v47, v[8:11] offset:16384
ds_write_b128 v47, v[12:15] offset:17408
ds_write_b128 v47, v[16:19] offset:18432
ds_write_b128 v47, v[20:23] offset:19456
ds_write_b128 v47, v[24:27] offset:20480
ds_write_b128 v47, v[28:31] offset:21504
ds_write_b128 v47, v[48:51] offset:22528
ds_write_b128 v47, v[52:55] offset:23552
ds_write_b128 v47, v[56:59] offset:24576
ds_write_b128 v47, v[60:63] offset:25600
ds_write_b128 v47, v[64:67] offset:26624
ds_write_b128 v47, v[68:71] offset:27648
s_mov_b32 s30, 0
s_branch all_10004
all_10003:
buffer_load_dword v45, v44, s[8:11], 0 offen sc1
s_add_u32 s30, s30, 1
s_cmp_gt_u32 s30, 262144
s_cbranch_scc1 L_fail
all_10004:
s_waitcnt vmcnt(0)
v_add_u32_dpp v46, v45, v45 quad_perm:[1,0,3,2] row_mask:0xf bank_mask:0xf
s_nop 1
v_add_u32_dpp v46, v46, v46 quad_perm:[2,3,0,1] row_mask:0xf bank_mask:0xf
s_nop 1
v_add_u32_dpp v46, v46, v46 row_ror:4 row_mask:0xf bank_mask:0xf
s_nop 1
v_add_u32_dpp v46, v46, v46 row_ror:8 row_mask:0xf bank_mask:0xf
v_cmp_ne_u32 vcc, 306, v46
s_cbranch_vccnz all_10003
s_waitcnt vmcnt(0) lgkmcnt(0)
s_barrier
s_mov_b32 s18, 0
s_mov_b32 s36, 0
s_cmp_eq_u32 s13, 1
s_cbranch_scc1 wave_10006
s_cmp_eq_u32 s13, 2
s_cbranch_scc1 wave_10007
s_cmp_eq_u32 s13, 3
s_cbranch_scc1 wave_10008
wave_10005:
layer_10009:
s_lshl_b32 s17, s36, 6
s_mul_i32 s27, s36, 35651584
s_mul_i32 s28, s14, 16384
s_add_u32 s27, s27, s28
s_add_u32 s20, s27, 16777216
s_mul_i32 s27, s17, 10240
s_add_u32 s27, s27, s24
s_add_u32 s21, s27, s25
s_mov_b32 s19, 0
s_mov_b32 s33, s6
s_add_u32 s34, s17, 1
s_add_u32 s31, s17, 63
s_add_u32 s32, s17, 64
s_mov_b32 s27, s20
v_mov_b32 v7, 0
s_add_u32 s68, s4, 413696
s_addc_u32 s69, s5, 0
s_add_u32 s72, s4, 397312
s_addc_u32 s73, s5, 0
s_add_u32 s70, s4, 417792
s_addc_u32 s71, s5, 0
s_add_u32 s74, s4, 401408
s_addc_u32 s75, s5, 0
s_add_u32 s58, s4, s20
s_addc_u32 s59, s5, 0
global_load_dwordx4 v[64:67], v0, s[76:77] offset:-4096 sc1
global_load_dwordx4 v[68:71], v0, s[76:77] offset:-3072 sc1
global_load_dwordx4 v[72:75], v0, s[76:77] offset:-2048 sc1
global_load_dwordx4 v[76:79], v0, s[76:77] offset:-1024 sc1
global_load_dwordx4 v[80:83], v0, s[76:77] offset:2048 sc1
global_load_dwordx4 v[84:87], v0, s[76:77] offset:3072 sc1
global_load_dwordx4 v[56:59], v0, s[76:77] offset:0 sc1
global_load_dwordx4 v[60:63], v0, s[76:77] offset:1024 sc1
v_mov_b64 v[8:9], 0
v_mov_b64 v[10:11], 0
v_mov_b64 v[12:13], 0
v_mov_b64 v[14:15], 0
v_mov_b64 v[16:17], 0
v_mov_b64 v[18:19], 0
v_mov_b64 v[20:21], 0
v_mov_b64 v[22:23], 0
v_mov_b64 v[24:25], 0
v_mov_b64 v[26:27], 0
v_mov_b64 v[28:29], 0
v_mov_b64 v[30:31], 0
v_cmp_gt_u32 vcc, s34, v7
s_cmp_eq_u32 vcc_hi, 0
s_cbranch_scc1 kv_10020
s_mov_b32 s30, 0
kv_10019:
v_and_b32 v7, 128, v0
buffer_load_dword v7, v7, s[4:7], s22 offen sc1
s_add_u32 s30, s30, 1
s_cmp_gt_u32 s30, 262144
s_cbranch_scc1 L_fail
s_waitcnt vmcnt(0)
v_cmp_gt_u32 vcc, s34, v7
s_cbranch_vccnz kv_10019
kv_10020:
s_barrier
global_load_dwordx4 v[48:51], v0, s[58:59] offset:0 nt sc1
global_load_dwordx4 v[52:55], v0, s[58:59] offset:1024 nt sc1
v_and_b32 v7, 255, v0
v_lshl_add_u32 v7, v7, 3, s27
global_load_dwordx4 v[32:35], v0, s[68:69] offset:-4096 sc1
global_load_dwordx4 v[36:39], v0, s[68:69] offset:0 sc1
global_load_dwordx4 v[40:43], v0, s[70:71] offset:0 sc1
s_mov_b32 s30, 0
s_waitcnt vmcnt(0)
.p2align 6
gather_10010:
s_waitcnt vmcnt(4)
rt_10015_b:
v_smfmac_f32_16x16x64_bf16 v[24:27], v[32:35], a[0:7], v1
ds_write_b128 v0, v[32:35] offset:0
v_smfmac_f32_16x16x64_bf16 v[8:11], v[32:35], v[64:71], v1
v_bitop3_b32 v44, v32, v34, s18 bitop3:0x7e
v_smfmac_f32_16x16x64_bf16 v[12:15], v[32:35], v[72:79], v1
s_waitcnt vmcnt(3)
ds_write_b128 v0, v[36:39] offset:4096
v_bitop3_b32 v45, v36, v38, s18 bitop3:0x7e
v_or_b32 v44, v44, v45
s_waitcnt vmcnt(2)
v_bitop3_b32 v45, v40, v42, s18 bitop3:0x7e
v_bitop3_b32 v44, v44, v45, s19 bitop3:0xa8
v_cmp_ne_u32 vcc, 0, v44
v_smfmac_f32_16x16x64_bf16 v[8:11], v[36:39], a[16:23], v1
ds_write_b128 v0, v[40:43] offset:8192
v_smfmac_f32_16x16x64_bf16 v[20:23], v[32:35], v[80:87], v1
s_cbranch_vccnz rt_10015
global_load_dwordx4 v[64:67], v0, s[78:79] offset:-4096 sc1
ds_read_b128 v[80:83], v2 offset:0
v_smfmac_f32_16x16x64_bf16 v[28:31], v[32:35], a[8:15], v1
global_load_dwordx4 v[68:71], v0, s[78:79] offset:-3072 sc1
ds_read_b128 v[84:87], v2 offset:1024
v_smfmac_f32_16x16x64_bf16 v[20:23], v[36:39], a[40:47], v1
s_waitcnt lgkmcnt(2)
global_load_dwordx4 v[72:75], v0, s[78:79] offset:-2048 sc1
global_load_dwordx4 v[76:79], v0, s[78:79] offset:-1024 sc1
v_smfmac_f32_16x16x64_bf16 v[16:19], v[32:35], v[56:63], v1
s_barrier
ds_read_b128 v[40:43], v0 offset:1024
v_smfmac_f32_16x16x64_bf16 v[16:19], v[36:39], a[32:39], v1
s_xor_b32 s18, s18, 1
s_waitcnt lgkmcnt(1)
ds_read_b128 v[44:47], v0 offset:5120
v_smfmac_f32_16x16x64_bf16 v[28:31], v[36:39], v[80:87], v1
ds_read_b128 v[80:83], v2 offset:2048
v_smfmac_f32_16x16x64_bf16 v[24:27], v[36:39], a[48:55], v1
s_mov_b64 s[68:69], s[72:73]
ds_read_b128 v[32:35], v0 offset:2048
v_smfmac_f32_16x16x64_bf16 v[12:15], v[36:39], a[24:31], v1
ds_read_b128 v[84:87], v2 offset:3072
s_waitcnt lgkmcnt(4)
v_smfmac_f32_16x16x64_bf16 v[8:11], v[40:43], a[56:63], v1
ds_read_b128 v[36:39], v0 offset:6144
v_smfmac_f32_16x16x64_bf16 v[12:15], v[40:43], a[64:71], v1
s_add_u32 s20, s20, 524288
s_waitcnt lgkmcnt(4)
ds_read_b128 v[40:43], v0 offset:3072
v_smfmac_f32_16x16x64_bf16 v[12:15], v[44:47], a[80:87], v1
s_add_u32 s17, s17, 1
global_load_dwordx4 v[56:59], v0, s[58:59] offset:2048 nt sc1
v_smfmac_f32_16x16x64_bf16 v[8:11], v[44:47], a[72:79], v1
s_waitcnt lgkmcnt(3)
ds_read_b128 v[44:47], v0 offset:7168
s_waitcnt lgkmcnt(3)
v_smfmac_f32_16x16x64_bf16 v[12:15], v[32:35], v[80:87], v1
s_add_u32 s21, s21, 10240
ds_read_b128 v[80:83], v2 offset:4096
v_smfmac_f32_16x16x64_bf16 v[8:11], v[32:35], a[88:95], v1
s_waitcnt lgkmcnt(3)
ds_read_b128 v[84:87], v2 offset:5120
s_waitcnt lgkmcnt(3)
v_smfmac_f32_16x16x64_bf16 v[12:15], v[36:39], a[104:111], v1
ds_read_b128 v[32:35], v0 offset:8192
v_smfmac_f32_16x16x64_bf16 v[8:11], v[36:39], a[96:103], v1
ds_read_b128 v[36:39], v0 offset:9216
v_smfmac_f32_16x16x64_bf16 v[8:11], v[40:43], a[112:119], v1
s_waitcnt lgkmcnt(4)
global_load_dwordx4 v[60:63], v0, s[58:59] offset:3072 nt sc1
v_smfmac_f32_16x16x64_bf16 v[12:15], v[40:43], a[120:127], v1
s_waitcnt lgkmcnt(2)
ds_read_b128 v[40:43], v0 offset:1024
v_smfmac_f32_16x16x64_bf16 v[12:15], v[44:47], v[80:87], v1
s_waitcnt lgkmcnt(2)
ds_read_b128 v[84:87], v2 offset:7168
v_smfmac_f32_16x16x64_bf16 v[8:11], v[44:47], a[128:135], v1
s_waitcnt vmcnt(5)
s_waitcnt lgkmcnt(2)
ds_read_b128 v[80:83], v2 offset:6144
v_smfmac_f32_16x16x64_bf16 v[12:15], v[32:35], a[144:151], v1
global_load_dword v7, v7, s[4:5] sc1
v_smfmac_f32_16x16x64_bf16 v[8:11], v[32:35], a[136:143], v1
ds_read_b128 v[32:35], v0 offset:5120
s_waitcnt vmcnt(5)
v_smfmac_f32_16x16x64_bf16 v[8:11], v[36:39], v[64:71], v1
s_nop 0
ds_read_b128 v[68:71], v2 offset:9216
s_waitcnt lgkmcnt(3)
v_smfmac_f32_16x16x64_bf16 v[12:15], v[36:39], a[152:159], v1
s_nop 0
ds_read_b128 v[64:67], v2 offset:8192
s_waitcnt lgkmcnt(3)
ds_read_b128 v[36:39], v0 offset:2048
v_add_f32 v8, v8, v10
v_smfmac_f32_16x16x64_bf16 v[20:23], v[40:43], v[80:87], v1
ds_read_b128 v[84:87], v2 offset:11264
v_mul_f32 v8, s35, v8
v_smfmac_f32_16x16x64_bf16 v[16:19], v[40:43], a[160:167], v1
s_waitcnt lgkmcnt(4)
ds_read_b128 v[40:43], v0 offset:6144
v_add_f32 v9, v9, v11
v_smfmac_f32_16x16x64_bf16 v[20:23], v[32:35], a[176:183], v1
ds_read_b128 v[80:83], v2 offset:10240
v_mul_f32 v9, s35, v9
v_add_f32 v13, v13, v15
v_cvt_pk_bf16_f32 v8, v8, v9
v_add_f32 v12, v12, v14
v_smfmac_f32_16x16x64_bf16 v[16:19], v[32:35], a[168:175], v1
s_waitcnt lgkmcnt(3)
ds_read_b128 v[32:35], v0 offset:3072
v_mul_f32 v13, s35, v13
v_smfmac_f32_16x16x64_bf16 v[16:19], v[36:39], v[64:71], v1
s_waitcnt vmcnt(3)
ds_read_b128 v[68:71], v2 offset:13312
v_mul_f32 v12, s35, v12
v_smfmac_f32_16x16x64_bf16 v[20:23], v[36:39], a[184:191], v1
s_waitcnt lgkmcnt(3)
ds_read_b128 v[36:39], v0 offset:7168
ds_read_b128 v[64:67], v2 offset:12288
v_cvt_pk_bf16_f32 v12, v12, v13
v_smfmac_f32_16x16x64_bf16 v[16:19], v[40:43], v[72:79], v1
s_waitcnt lgkmcnt(4)
ds_write2_b32 v3, v8, v12 offset0:0 offset1:128
v_smfmac_f32_16x16x64_bf16 v[20:23], v[40:43], v[80:87], v1
s_add_u32 s34, s17, 2
s_waitcnt lgkmcnt(4)
ds_read_b128 v[72:75], v2 offset:14336
v_smfmac_f32_16x16x64_bf16 v[20:23], v[32:35], a[200:207], v1
ds_read_b128 v[80:83], v2 offset:16384
v_smfmac_f32_16x16x64_bf16 v[16:19], v[32:35], a[192:199], v1
s_waitcnt lgkmcnt(4)
ds_read_b128 v[40:43], v0 offset:8192
s_mov_b64 vcc, s[42:43]
ds_read_b128 v[76:79], v2 offset:15360
v_smfmac_f32_16x16x64_bf16 v[20:23], v[36:39], a[208:215], v1
ds_read_b128 v[84:87], v2 offset:17408
s_waitcnt lgkmcnt(5)
s_barrier
ds_read_b128 v[32:35], v0 offset:9216
v_smfmac_f32_16x16x64_bf16 v[16:19], v[36:39], v[64:71], v1
ds_read_b64_tr_b16 v[10:11], v4 offset:512
s_mov_b64 s[70:71], s[74:75]
ds_read_b64_tr_b16 v[8:9], v4 offset:0
s_waitcnt lgkmcnt(6)
s_waitcnt lgkmcnt(5)
ds_read_b64_tr_b16 v[12:13], v4 offset:1024
v_smfmac_f32_16x16x64_bf16 v[20:23], v[40:43], a[216:223], v1
ds_read_b64_tr_b16 v[14:15], v4 offset:1536
s_waitcnt lgkmcnt(6)
ds_read_b128 v[68:71], v2 offset:19456
v_smfmac_f32_16x16x64_bf16 v[16:19], v[40:43], v[72:79], v1
s_waitcnt lgkmcnt(6)
ds_read_b128 v[36:39], v0 offset:8192
s_waitcnt lgkmcnt(6)
v_smfmac_f32_16x16x64_bf16 v[20:23], v[32:35], v[80:87], v1
ds_read_b128 v[64:67], v2 offset:18432
ds_read_b128 v[40:43], v0 offset:9216
v_smfmac_f32_16x16x64_bf16 v[16:19], v[32:35], a[224:231], v1
s_waitcnt lgkmcnt(6)
ds_read_b128 v[72:75], v2 offset:20480
ds_read_b128 v[32:35], v0 offset:1024
v_mfma_f32_16x16x32_bf16 v[44:47], v[48:51], v[8:11], 0
s_waitcnt lgkmcnt(6)
ds_read_b128 v[76:79], v2 offset:21504
v_add_f32 v21, v21, v23
v_add_f32 v20, v20, v22
v_bfe_u32 v48, v0, 5, 1
v_mfma_f32_16x16x32_bf16 v[44:47], v[52:55], v[12:15], v[44:47]
s_waitcnt lgkmcnt(5)
ds_read_b128 v[80:83], v2 offset:22528
v_add_f32 v17, v17, v19
v_add_f32 v16, v16, v18
v_cvt_pk_bf16_f32 v20, v20, v21
v_lshl_add_u32 v48, v48, 3, v5
v_cvt_pk_bf16_f32 v16, v16, v17
v_smfmac_f32_16x16x64_bf16 v[28:31], v[36:39], a[232:239], v1
s_waitcnt lgkmcnt(4)
ds_write2_b32 v3, v16, v20 offset0:1 offset1:129
v_cndmask_b32_dpp v44, v46, v44, vcc quad_perm:[0,1,0,1] row_mask:0xf bank_mask:0xf
v_cndmask_b32_dpp v45, v47, v45, vcc quad_perm:[0,1,0,1] row_mask:0xf bank_mask:0xf
v_smfmac_f32_16x16x64_bf16 v[24:27], v[36:39], v[64:71], v1
s_waitcnt lgkmcnt(3)
ds_write_b64 v48, v[44:45] offset:6144
v_smfmac_f32_16x16x64_bf16 v[24:27], v[40:43], a[240:247], v1
s_waitcnt lgkmcnt(3)
global_load_dwordx4 v[64:67], v0, s[78:79] offset:0 sc1
ds_read_b128 v[36:39], v0 offset:5120
v_smfmac_f32_16x16x64_bf16 v[28:31], v[40:43], v[72:79], v1
s_waitcnt lgkmcnt(3)
global_load_dwordx4 v[68:71], v0, s[78:79] offset:1024 sc1
ds_read_b128 v[84:87], v2 offset:23552
v_smfmac_f32_16x16x64_bf16 v[24:27], v[32:35], a[248:255], v1
global_load_dwordx4 v[72:75], v0, s[78:79] offset:2048 sc1
ds_read_b128 v[40:43], v0 offset:2048
v_smfmac_f32_16x16x64_bf16 v[28:31], v[32:35], v[88:95], v1
s_waitcnt lgkmcnt(3)
ds_read_b128 v[32:35], v0 offset:6144
s_barrier
ds_read_b128 v[52:55], v6 offset:7168
s_waitcnt lgkmcnt(4)
v_smfmac_f32_16x16x64_bf16 v[28:31], v[36:39], v[96:103], v1
s_waitcnt lgkmcnt(3)
ds_read_b128 v[48:51], v6 offset:6144
ds_read_b64_tr_b16 v[8:9], v4 offset:0
v_smfmac_f32_16x16x64_bf16 v[24:27], v[36:39], v[80:87], v1
s_waitcnt lgkmcnt(4)
ds_read_b128 v[36:39], v0 offset:3072
global_load_dwordx4 v[76:79], v0, s[78:79] offset:3072 sc1
ds_read_b64_tr_b16 v[10:11], v4 offset:512
v_smfmac_f32_16x16x64_bf16 v[28:31], v[40:43], v[112:119], v1
s_waitcnt lgkmcnt(5)
ds_read_b64_tr_b16 v[14:15], v4 offset:1536
ds_read_b64_tr_b16 v[18:19], v4 offset:2560
v_smfmac_f32_16x16x64_bf16 v[24:27], v[40:43], v[104:111], v1
s_waitcnt lgkmcnt(6)
ds_read_b64_tr_b16 v[12:13], v4 offset:1024
ds_read_b64_tr_b16 v[16:17], v4 offset:2048
v_smfmac_f32_16x16x64_bf16 v[28:31], v[32:35], v[128:135], v1
s_waitcnt lgkmcnt(7)
ds_read_b64_tr_b16 v[22:23], v4 offset:3584
v_add_f32 v50, v50, v54
v_add_f32 v49, v49, v53
v_smfmac_f32_16x16x64_bf16 v[24:27], v[32:35], v[120:127], v1
s_waitcnt lgkmcnt(6)
ds_read_b128 v[40:43], v0 offset:7168
v_add_f32 v48, v48, v52
v_smfmac_f32_16x16x64_bf16 v[24:27], v[36:39], v[136:143], v1
s_waitcnt lgkmcnt(5)
ds_read_b64_tr_b16 v[20:21], v4 offset:3072
v_add_f32 v51, v51, v55
v_smfmac_f32_16x16x64_bf16 v[28:31], v[36:39], v[144:151], v1
s_waitcnt lgkmcnt(4)
global_load_dwordx4 v[80:83], v0, s[80:81] offset:-4096 sc1
v_exp_f32 v51, v51
v_mfma_f32_16x16x32_bf16 v[44:47], v[8:11], v[8:11], 0
s_waitcnt lgkmcnt(3)
v_exp_f32 v49, v49
v_mfma_f32_16x16x32_bf16 v[44:47], v[12:15], v[12:15], v[44:47]
s_waitcnt lgkmcnt(1)
v_exp_f32 v50, v50
v_exp_f32 v48, v48
v_mfma_f32_16x16x32_bf16 v[44:47], v[16:19], v[16:19], v[44:47]
s_waitcnt lgkmcnt(0)
v_cvt_pk_bf16_f32 v55, v50, v51
v_cvt_pk_bf16_f32 v54, v48, v49
v_mfma_f32_16x16x32_bf16 v[44:47], v[20:23], v[20:23], v[44:47]
v_mov_b64 v[22:23], s[44:45]
v_mov_b32_dpp v50, v54 quad_perm:[2,3,2,3] row_mask:0xf bank_mask:0xf
v_mov_b32_dpp v49, v55 quad_perm:[0,1,0,1] row_mask:0xf bank_mask:0xf
v_mov_b32_dpp v51, v55 quad_perm:[2,3,2,3] row_mask:0xf bank_mask:0xf
v_smfmac_f32_16x16x64_bf16 v[24:27], v[40:43], v[152:159], v1
v_mov_b32_dpp v48, v54 quad_perm:[0,1,0,1] row_mask:0xf bank_mask:0xf
v_mov_b64 v[20:21], s[44:45]
v_smfmac_f32_16x16x64_bf16 v[28:31], v[40:43], v[160:167], v1
s_waitcnt vmcnt(7)
global_load_dwordx4 v[84:87], v0, s[80:81] offset:-3072 sc1
v_exp_f32_dpp v44, v46 quad_perm:[0,1,0,1] row_mask:0xf bank_mask:0xf
v_mfma_f32_16x16x32_bf16 v[8:11], v[56:59], v[48:51], 0
v_exp_f32_dpp v45, v47 quad_perm:[0,1,0,1] row_mask:0xf bank_mask:0xf
v_mfma_f32_16x16x32_bf16 v[16:19], v[20:23], v[48:51], 0
s_waitcnt vmcnt(7)
v_cvt_pk_bf16_f32 v53, v44, v45
v_mov_b64 v[54:55], s[46:47]
v_mfma_f32_16x16x32_bf16 v[12:15], v[60:63], v[48:51], 0
v_cvt_pk_bf16_f32 v52, v44, v45
v_cvt_pk_bf16_f32 v24, v24, v25
v_cvt_pk_bf16_f32 v25, v26, v27
v_mfma_f32_16x16x16_bf16 v[16:19], v[54:55], v[52:53], v[16:19]
s_min_u32 s34, s34, s32
v_cvt_pk_bf16_f32 v26, v28, v29
v_cvt_pk_bf16_f32 v27, v30, v31
v_mfma_f32_16x16x16_bf16 v[8:11], v[24:25], v[52:53], v[8:11]
ds_read_b128 v[28:31], v0 offset:19456
v_mov_b64 v[42:43], 0
v_mfma_f32_16x16x16_bf16 v[12:15], v[26:27], v[52:53], v[12:15]
s_waitcnt vmcnt(4)
v_bfe_u32 v32, v0, 5, 1
v_mov_b64 v[36:37], 0
v_subrev_u32 v17, s37, v16
v_rcp_f32 v18, v16
v_lshl_add_u32 v32, v32, 3, v5
v_mov_b64 v[38:39], 0
v_cmp_lt_u32 vcc, s38, v17
v_cndmask_b32 v9, v13, v9, s[42:43]
v_cndmask_b32 v8, v12, v8, s[42:43]
v_cndmask_b32 v10, v14, v10, s[42:43]
v_mul_f32 v10, v10, v18
v_cndmask_b32 v11, v15, v11, s[42:43]
v_mul_f32 v9, v9, v18
v_mul_f32 v8, v8, v18
v_mul_f32 v11, v11, v18
v_cvt_pk_bf16_f32 v12, v8, v9
v_cvt_pk_bf16_f32 v13, v10, v11
s_cbranch_vccnz rare_10011
back_10012:
ds_write_b64 v32, v[12:13] offset:0
v_mov_b32_dpp v9, v13 quad_perm:[0,1,0,1] row_mask:0xf bank_mask:0xf
v_mov_b32_dpp v10, v12 quad_perm:[2,3,2,3] row_mask:0xf bank_mask:0xf
v_mov_b32_dpp v8, v12 quad_perm:[0,1,0,1] row_mask:0xf bank_mask:0xf
v_mov_b32_dpp v11, v13 quad_perm:[2,3,2,3] row_mask:0xf bank_mask:0xf
v_mov_b64 v[54:55], 0
v_mov_b64 v[52:53], 0
v_smfmac_f32_16x16x64_bf16 v[36:39], v[8:11], v[64:71], v1
s_waitcnt vmcnt(2)
ds_read_b128 v[20:23], v0 offset:17408
global_load_dwordx4 v[64:67], v0, s[76:77] offset:-4096 sc1
ds_read_b128 v[16:19], v0 offset:16384
v_mov_b64 v[34:35], 0
v_mov_b64 v[32:33], 0
v_mov_b64 v[40:41], 0
v_smfmac_f32_16x16x64_bf16 v[52:55], v[8:11], v[176:183], v1
s_waitcnt lgkmcnt(2)
ds_read_b128 v[24:27], v0 offset:18432
s_barrier
ds_read_b128 v[56:59], v5 offset:512
global_load_dwordx4 v[68:71], v0, s[76:77] offset:-3072 sc1
ds_read_b128 v[12:15], v5 offset:1536
v_mov_b64 v[48:49], 0
v_smfmac_f32_16x16x64_bf16 v[40:43], v[8:11], v[72:79], v1
s_waitcnt vmcnt(2)
ds_read_b128 v[60:63], v5 offset:1024
v_mov_b64 v[50:51], 0
v_smfmac_f32_16x16x64_bf16 v[32:35], v[8:11], v[80:87], v1
global_load_dwordx4 v[72:75], v0, s[76:77] offset:-2048 sc1
ds_read_b128 v[80:83], v0 offset:20480
v_smfmac_f32_16x16x64_bf16 v[48:51], v[8:11], v[168:175], v1
s_waitcnt lgkmcnt(5)
s_waitcnt lgkmcnt(3)
ds_read_b128 v[84:87], v0 offset:21504
v_smfmac_f32_16x16x64_bf16 v[40:43], v[56:59], v[192:199], v1
global_load_dwordx4 v[76:79], v0, s[76:77] offset:-1024 sc1
v_smfmac_f32_16x16x64_bf16 v[36:39], v[56:59], v[16:23], v1
s_waitcnt lgkmcnt(2)
ds_read_b128 v[20:23], v0 offset:23552
v_lshrrev_b32 v44, 8, v0
v_smfmac_f32_16x16x64_bf16 v[36:39], v[60:63], v[24:31], v1
ds_read_b128 v[16:19], v0 offset:22528
v_bfe_u32 v45, v0, 1, 7
v_smfmac_f32_16x16x64_bf16 v[36:39], v[12:15], v[184:191], v1
s_waitcnt lgkmcnt(3)
ds_read_b128 v[28:31], v0 offset:25600
s_waitcnt lgkmcnt(3)
v_smfmac_f32_16x16x64_bf16 v[40:43], v[60:63], v[80:87], v1
ds_read_b128 v[24:27], v0 offset:24576
v_lshl_or_b32 v44, v44, 12, v45
v_smfmac_f32_16x16x64_bf16 v[40:43], v[12:15], v[200:207], v1
ds_read_b128 v[80:83], v0 offset:26624
v_cvt_pk_bf16_f32 v36, v36, v37
v_smfmac_f32_16x16x64_bf16 v[32:35], v[56:59], v[232:239], v1
ds_read_b128 v[84:87], v0 offset:27648
v_cvt_pk_bf16_f32 v37, v38, v39
v_and_or_b32 v36, v36, -2, s18
v_smfmac_f32_16x16x64_bf16 v[52:55], v[56:59], v[216:223], v1
global_store_dwordx2 v44, v[36:37], s[48:49]
s_waitcnt lgkmcnt(3)
v_cvt_pk_bf16_f32 v40, v40, v41
v_smfmac_f32_16x16x64_bf16 v[48:51], v[56:59], v[16:23], v1
s_waitcnt lgkmcnt(2)
s_waitcnt lgkmcnt(1)
v_and_or_b32 v40, v40, -2, s18
v_smfmac_f32_16x16x64_bf16 v[48:51], v[60:63], v[24:31], v1
v_cvt_pk_bf16_f32 v41, v42, v43
v_smfmac_f32_16x16x64_bf16 v[48:51], v[12:15], v[208:215], v1
s_waitcnt lgkmcnt(0)
global_store_dwordx2 v44, v[40:41], s[50:51]
v_smfmac_f32_16x16x64_bf16 v[32:35], v[60:63], v[240:247], v1
s_nop 1
v_smfmac_f32_16x16x64_bf16 v[52:55], v[60:63], v[80:87], v1
s_add_u32 s27, s20, 524288
s_add_u32 s58, s4, s20
v_cvt_pk_bf16_f32 v48, v48, v49
v_and_or_b32 v48, v48, -2, s18
v_cvt_pk_bf16_f32 v49, v50, v51
v_smfmac_f32_16x16x64_bf16 v[52:55], v[12:15], v[224:231], v1
s_nop 0
global_store_dwordx2 v44, v[48:49], s[52:53]
s_addc_u32 s59, s5, 0
s_mov_b32 s30, 0
v_smfmac_f32_16x16x64_bf16 v[32:35], v[12:15], v[248:255], v1
s_nop 2
v_cvt_pk_bf16_f32 v52, v52, v53
v_cvt_pk_bf16_f32 v53, v54, v55
s_mov_b32 s19, 1
v_and_or_b32 v52, v52, -2, s18
global_store_dwordx2 v44, v[52:53], s[54:55]
v_cvt_pk_bf16_f32 v32, v32, v33
v_cvt_pk_bf16_f32 v33, v34, v35
v_and_or_b32 v32, v32, -2, s18
global_store_dwordx2 v44, v[32:33], s[56:57]
v_bfe_u32 v32, v0, 6, 1
v_lshlrev_b32 v32, 4, v32
v_mov_b32 v33, 0x3f80
v_lshlrev_b32 v32, v32, v33
v_bfe_i32 v33, v0, 4, 1
v_and_b32 v45, v32, v33
v_and_b32 v47, v32, v33
v_xor_b32 v44, v32, v45
v_xor_b32 v46, v32, v45
v_and_b32 v36, 32, v0
v_bfe_u32 v37, v0, 6, 1
v_lshl_add_u32 v36, v37, 8, v36
v_bfe_u32 v37, v0, 8, 1
v_lshl_add_u32 v36, v37, 4, v36
v_bfe_u32 v37, v0, 4, 1
v_lshl_add_u32 v36, v37, 3, v36
v_and_b32 v7, 255, v0
v_lshl_add_u32 v7, v7, 3, s27
s_nop 15
s_nop 15
s_nop 15
s_nop 8
global_load_dwordx4 v[8:11], v0, s[64:65] offset:0 sc1
global_load_dwordx4 v[12:15], v0, s[64:65] offset:1024 sc1
global_load_dwordx4 v[16:19], v0, s[64:65] offset:2048 sc1
global_load_dwordx4 v[20:23], v0, s[64:65] offset:3072 sc1
chk_10023:
v_mov_b64 v[40:41], 0
v_mov_b64 v[42:43], 0
s_waitcnt vmcnt(2)
s_nop 0
v_smfmac_f32_16x16x64_bf16 v[40:43], v[44:47], v[8:15], v1
v_bitop3_b32 v32, v8, v10, s18 bitop3:0x7e
v_bitop3_b32 v33, v12, v14, s18 bitop3:0x7e
s_waitcnt vmcnt(0)
v_smfmac_f32_16x16x64_bf16 v[40:43], v[44:47], v[16:23], v1
v_bitop3_b32 v34, v16, v18, s18 bitop3:0x7e
v_bitop3_b32 v35, v20, v22, s18 bitop3:0x7e
v_or3_b32 v32, v32, v33, v34
v_bitop3_b32 v32, v32, v35, 1 bitop3:0xa8
v_cmp_ne_u32 vcc, 0, v32
s_cbranch_vccnz chk_10023_f
s_nop 1
v_add_f32_dpp v40, v40, v40 row_ror:8 row_mask:0xf bank_mask:0xf
v_add_f32_dpp v41, v41, v41 row_ror:8 row_mask:0xf bank_mask:0xf
v_add_f32_dpp v42, v42, v42 row_ror:8 row_mask:0xf bank_mask:0xf
v_add_f32_dpp v43, v43, v43 row_ror:8 row_mask:0xf bank_mask:0xf
v_cvt_pk_bf16_f32 v40, v40, v41
v_cvt_pk_bf16_f32 v41, v42, v43
v_and_or_b32 v40, v40, -2, s18
s_mov_b64 exec, 0x00ff00ff
global_store_dwordx2 v36, v[40:41], s[66:67]
s_mov_b64 exec, -1
s_branch join_10022
chk_10023_f:
global_load_dwordx4 v[8:11], v0, s[64:65] offset:0 sc1
global_load_dwordx4 v[12:15], v0, s[64:65] offset:1024 sc1
global_load_dwordx4 v[16:19], v0, s[64:65] offset:2048 sc1
global_load_dwordx4 v[20:23], v0, s[64:65] offset:3072 sc1
s_add_u32 s30, s30, 1
s_cmp_le_u32 s30, 262144
s_cbranch_scc1 chk_10023
s_branch L_fail
nored_10021:
join_10022:
s_nop 11
s_barrier
global_load_dwordx4 v[56:59], v0, s[76:77] offset:0 sc1
global_load_dwordx4 v[60:63], v0, s[76:77] offset:1024 sc1
global_load_dwordx4 v[80:83], v0, s[76:77] offset:2048 sc1
global_load_dwordx4 v[84:87], v0, s[76:77] offset:3072 sc1
s_nop 15
s_nop 15
s_nop 3
s_barrier
global_load_dwordx4 v[32:35], v0, s[68:69] offset:-4096 sc1
s_nop 10
global_load_dwordx4 v[36:39], v0, s[68:69] offset:0 sc1
s_nop 10
global_load_dwordx4 v[40:43], v0, s[70:71] offset:0 sc1
s_barrier
global_load_dwordx4 v[48:51], v0, s[58:59] offset:0 nt sc1
global_load_dwordx4 v[52:55], v0, s[58:59] offset:1024 nt sc1
v_mov_b64 v[8:9], 0
v_mov_b64 v[10:11], 0
v_mov_b64 v[12:13], 0
v_mov_b64 v[14:15], 0
v_mov_b64 v[16:17], 0
v_mov_b64 v[18:19], 0
v_mov_b64 v[20:21], 0
v_mov_b64 v[22:23], 0
v_mov_b64 v[24:25], 0
v_mov_b64 v[26:27], 0
v_mov_b64 v[28:29], 0
v_mov_b64 v[30:31], 0
s_mov_b32 s30, 0
s_cmp_eq_u32 s17, s31
s_cbranch_scc0 gather_10010
s_branch exit_10013
rt_10015:
global_load_dwordx4 v[32:35], v0, s[68:69] offset:-4096 sc1
global_load_dwordx4 v[36:39], v0, s[68:69] offset:0 sc1
global_load_dwordx4 v[40:43], v0, s[70:71] offset:0 sc1
s_add_u32 s30, s30, 1
s_cmp_gt_u32 s30, 262144
s_cbranch_scc1 L_fail
s_mov_b64 exec, 1
global_store_dword v0, v0, s[62:63]
global_store_dword v0, v0, s[62:63]
s_mov_b64 exec, -1
v_mov_b64 v[8:9], 0
v_mov_b64 v[10:11], 0
v_mov_b64 v[12:13], 0
v_mov_b64 v[14:15], 0
v_mov_b64 v[16:17], 0
v_mov_b64 v[18:19], 0
v_mov_b64 v[20:21], 0
v_mov_b64 v[22:23], 0
v_mov_b64 v[24:25], 0
v_mov_b64 v[26:27], 0
v_mov_b64 v[28:29], 0
v_mov_b64 v[30:31], 0
s_branch gather_10010
rare_10011:
ds_read_b128 v[48:51], v6 offset:6144
ds_read_b128 v[52:55], v6 offset:7168
s_waitcnt lgkmcnt(0)
v_add_f32 v48, v48, v52
v_add_f32 v49, v49, v53
v_add_f32 v50, v50, v54
v_add_f32 v51, v51, v55
v_mov_b32_dpp v46, v46 quad_perm:[0,1,0,1] row_mask:0xf bank_mask:0xf
v_mov_b32_dpp v47, v47 quad_perm:[0,1,0,1] row_mask:0xf bank_mask:0xf
v_max3_f32 v19, v48, v49, v50
v_max3_f32 v19, v19, v51, v46
v_max_f32 v19, v19, v47
s_nop 1
v_max_f32_dpp v19, v19, v19 quad_perm:[2,3,0,1] row_mask:0xf bank_mask:0xf
v_mov_b32 v44, v19
s_nop 1
v_permlane32_swap_b32 v19, v44
v_max_f32 v19, v19, v44
v_mov_b32 v44, v19
s_nop 1
v_permlane16_swap_b32 v19, v44
v_max_f32 v19, v19, v44
v_sub_f32 v48, v48, v19
v_sub_f32 v49, v49, v19
v_sub_f32 v50, v50, v19
v_sub_f32 v51, v51, v19
v_sub_f32 v46, v46, v19
v_sub_f32 v47, v47, v19
v_exp_f32 v48, v48
v_exp_f32 v49, v49
v_exp_f32 v50, v50
v_exp_f32 v51, v51
v_cvt_pk_bf16_f32 v54, v48, v49
v_cvt_pk_bf16_f32 v55, v50, v51
s_nop 0
v_mov_b32_dpp v48, v54 quad_perm:[0,1,0,1] row_mask:0xf bank_mask:0xf
v_mov_b32_dpp v49, v55 quad_perm:[0,1,0,1] row_mask:0xf bank_mask:0xf
v_mov_b32_dpp v50, v54 quad_perm:[2,3,2,3] row_mask:0xf bank_mask:0xf
v_mov_b32_dpp v51, v55 quad_perm:[2,3,2,3] row_mask:0xf bank_mask:0xf
v_mov_b64 v[20:21], s[44:45]
v_mov_b64 v[22:23], s[44:45]
v_mfma_f32_16x16x32_bf16 v[8:11], v[56:59], v[48:51], 0
v_mfma_f32_16x16x32_bf16 v[12:15], v[60:63], v[48:51], 0
v_mfma_f32_16x16x32_bf16 v[16:19], v[20:23], v[48:51], 0
v_mov_b64 v[54:55], s[46:47]
v_exp_f32_dpp v44, v46 quad_perm:[0,1,0,1] row_mask:0xf bank_mask:0xf
v_exp_f32_dpp v45, v47 quad_perm:[0,1,0,1] row_mask:0xf bank_mask:0xf
s_nop 0
v_cvt_pk_bf16_f32 v52, v44, v45
v_cvt_pk_bf16_f32 v53, v44, v45
s_nop 1
v_mfma_f32_16x16x16_bf16 v[16:19], v[54:55], v[52:53], v[16:19]
v_mfma_f32_16x16x16_bf16 v[8:11], v[24:25], v[52:53], v[8:11]
v_mfma_f32_16x16x16_bf16 v[12:15], v[26:27], v[52:53], v[12:15]
s_nop 5
v_rcp_f32 v18, v16
s_nop 0
v_cndmask_b32 v8, v12, v8, s[42:43]
v_mul_f32 v8, v8, v18
v_cndmask_b32 v9, v13, v9, s[42:43]
v_mul_f32 v9, v9, v18
v_cndmask_b32 v10, v14, v10, s[42:43]
v_mul_f32 v10, v10, v18
v_cndmask_b32 v11, v15, v11, s[42:43]
v_mul_f32 v11, v11, v18
v_cvt_pk_bf16_f32 v12, v8, v9
v_cvt_pk_bf16_f32 v13, v10, v11
s_branch back_10012
exit_10013:
global_load_dwordx4 v[32:35], v0, s[68:69] offset:-4096 sc1
global_load_dwordx4 v[36:39], v0, s[68:69] offset:0 sc1
global_load_dwordx4 v[40:43], v0, s[70:71] offset:0 sc1
s_add_u32 s30, s30, 1
s_cmp_gt_u32 s30, 262144
s_cbranch_scc1 L_fail
s_waitcnt vmcnt(2)
v_bitop3_b32 v44, v32, v34, s18 bitop3:0x7e
s_waitcnt vmcnt(1)
v_bitop3_b32 v45, v36, v38, s18 bitop3:0x7e
v_or_b32 v44, v44, v45
s_waitcnt vmcnt(0)
v_bitop3_b32 v46, v40, v42, s18 bitop3:0x7e
v_bitop3_b32 v44, v44, v46, s19 bitop3:0xa8
v_cmp_ne_u32 vcc, 0, v44
s_cbranch_vccnz exit_10013
s_add_u32 s36, s36, 1
s_cmp_lt_u32 s36, 2
s_cbranch_scc1 layer_10009
s_endpgm
wave_10006:
layer_10024:
s_lshl_b32 s17, s36, 6
s_mul_i32 s27, s36, 35651584
s_mul_i32 s28, s14, 16384
s_add_u32 s27, s27, s28
s_add_u32 s20, s27, 16781312
s_mul_i32 s27, s17, 10240
s_add_u32 s27, s27, s24
s_add_u32 s21, s27, s25
s_mov_b32 s19, 0
s_mov_b32 s33, s6
s_add_u32 s34, s17, 1
s_add_u32 s31, s17, 63
s_add_u32 s32, s17, 64
s_mov_b32 s27, s20
v_mov_b32 v7, 0
s_add_u32 s68, s4, 414720
s_addc_u32 s69, s5, 0
s_add_u32 s72, s4, 398336
s_addc_u32 s73, s5, 0
s_add_u32 s70, s4, 418816
s_addc_u32 s71, s5, 0
s_add_u32 s74, s4, 402432
s_addc_u32 s75, s5, 0
s_add_u32 s58, s4, s20
s_addc_u32 s59, s5, 0
global_load_dwordx4 v[64:67], v0, s[76:77] offset:-4096 sc1
global_load_dwordx4 v[68:71], v0, s[76:77] offset:-3072 sc1
global_load_dwordx4 v[72:75], v0, s[76:77] offset:-2048 sc1
global_load_dwordx4 v[76:79], v0, s[76:77] offset:-1024 sc1
global_load_dwordx4 v[80:83], v0, s[76:77] offset:2048 sc1
global_load_dwordx4 v[84:87], v0, s[76:77] offset:3072 sc1
global_load_dwordx4 v[56:59], v0, s[76:77] offset:0 sc1
global_load_dwordx4 v[60:63], v0, s[76:77] offset:1024 sc1
v_mov_b64 v[8:9], 0
v_mov_b64 v[10:11], 0
v_mov_b64 v[12:13], 0
v_mov_b64 v[14:15], 0
v_mov_b64 v[16:17], 0
v_mov_b64 v[18:19], 0
v_mov_b64 v[20:21], 0
v_mov_b64 v[22:23], 0
v_mov_b64 v[24:25], 0
v_mov_b64 v[26:27], 0
v_mov_b64 v[28:29], 0
v_mov_b64 v[30:31], 0
s_barrier
global_load_dwordx4 v[48:51], v0, s[58:59] offset:0 nt sc1
global_load_dwordx4 v[52:55], v0, s[58:59] offset:1024 nt sc1
v_and_b32 v7, 255, v0
v_lshl_add_u32 v7, v7, 3, s27
global_load_dwordx4 v[32:35], v0, s[68:69] offset:-4096 sc1
global_load_dwordx4 v[36:39], v0, s[68:69] offset:0 sc1
global_load_dwordx4 v[40:43], v0, s[70:71] offset:0 sc1
s_mov_b32 s30, 0
s_waitcnt vmcnt(0)
.p2align 6
gather_10025:
s_waitcnt vmcnt(4)
rt_10030_b:
v_smfmac_f32_16x16x64_bf16 v[24:27], v[32:35], a[0:7], v1
ds_write_b128 v0, v[32:35] offset:1024
v_smfmac_f32_16x16x64_bf16 v[8:11], v[32:35], v[64:71], v1
v_bitop3_b32 v44, v32, v34, s18 bitop3:0x7e
v_smfmac_f32_16x16x64_bf16 v[12:15], v[32:35], v[72:79], v1
s_waitcnt vmcnt(3)
ds_write_b128 v0, v[36:39] offset:5120
v_bitop3_b32 v45, v36, v38, s18 bitop3:0x7e
v_or_b32 v44, v44, v45
s_waitcnt vmcnt(2)
v_bitop3_b32 v45, v40, v42, s18 bitop3:0x7e
v_bitop3_b32 v44, v44, v45, s19 bitop3:0xa8
v_cmp_ne_u32 vcc, 0, v44
v_smfmac_f32_16x16x64_bf16 v[8:11], v[36:39], a[16:23], v1
ds_write_b128 v0, v[40:43] offset:9216
v_smfmac_f32_16x16x64_bf16 v[20:23], v[32:35], v[80:87], v1
s_cbranch_vccnz rt_10030
global_load_dwordx4 v[64:67], v0, s[78:79] offset:-4096 sc1
ds_read_b128 v[80:83], v2 offset:0
v_smfmac_f32_16x16x64_bf16 v[28:31], v[32:35], a[8:15], v1
global_load_dwordx4 v[68:71], v0, s[78:79] offset:-3072 sc1
ds_read_b128 v[84:87], v2 offset:1024
v_smfmac_f32_16x16x64_bf16 v[20:23], v[36:39], a[40:47], v1
s_waitcnt lgkmcnt(2)
global_load_dwordx4 v[72:75], v0, s[78:79] offset:-2048 sc1
global_load_dwordx4 v[76:79], v0, s[78:79] offset:-1024 sc1
v_smfmac_f32_16x16x64_bf16 v[16:19], v[32:35], v[56:63], v1
s_barrier
ds_read_b128 v[40:43], v0 offset:0
v_smfmac_f32_16x16x64_bf16 v[16:19], v[36:39], a[32:39], v1
s_xor_b32 s18, s18, 1
s_waitcnt lgkmcnt(1)
ds_read_b128 v[44:47], v0 offset:4096
v_smfmac_f32_16x16x64_bf16 v[28:31], v[36:39], v[80:87], v1
ds_read_b128 v[80:83], v2 offset:2048
v_smfmac_f32_16x16x64_bf16 v[24:27], v[36:39], a[48:55], v1
s_mov_b64 s[68:69], s[72:73]
ds_read_b128 v[32:35], v0 offset:3072
v_smfmac_f32_16x16x64_bf16 v[12:15], v[36:39], a[24:31], v1
ds_read_b128 v[84:87], v2 offset:3072
s_waitcnt lgkmcnt(4)
v_smfmac_f32_16x16x64_bf16 v[8:11], v[40:43], a[56:63], v1
ds_read_b128 v[36:39], v0 offset:7168
v_smfmac_f32_16x16x64_bf16 v[12:15], v[40:43], a[64:71], v1
s_add_u32 s20, s20, 524288
s_waitcnt lgkmcnt(4)
ds_read_b128 v[40:43], v0 offset:2048
v_smfmac_f32_16x16x64_bf16 v[12:15], v[44:47], a[80:87], v1
s_add_u32 s17, s17, 1
global_load_dwordx4 v[56:59], v0, s[58:59] offset:2048 nt sc1
v_smfmac_f32_16x16x64_bf16 v[8:11], v[44:47], a[72:79], v1
s_waitcnt lgkmcnt(3)
ds_read_b128 v[44:47], v0 offset:6144
s_waitcnt lgkmcnt(3)
v_smfmac_f32_16x16x64_bf16 v[12:15], v[32:35], v[80:87], v1
s_add_u32 s21, s21, 10240
ds_read_b128 v[80:83], v2 offset:4096
v_smfmac_f32_16x16x64_bf16 v[8:11], v[32:35], a[88:95], v1
s_waitcnt lgkmcnt(3)
ds_read_b128 v[84:87], v2 offset:5120
s_waitcnt lgkmcnt(3)
v_smfmac_f32_16x16x64_bf16 v[12:15], v[36:39], a[104:111], v1
ds_read_b128 v[32:35], v0 offset:9216
v_smfmac_f32_16x16x64_bf16 v[8:11], v[36:39], a[96:103], v1
ds_read_b128 v[36:39], v0 offset:8192
v_smfmac_f32_16x16x64_bf16 v[8:11], v[40:43], a[112:119], v1
s_waitcnt lgkmcnt(4)
global_load_dwordx4 v[60:63], v0, s[58:59] offset:3072 nt sc1
v_smfmac_f32_16x16x64_bf16 v[12:15], v[40:43], a[120:127], v1
s_waitcnt lgkmcnt(2)
ds_read_b128 v[40:43], v0 offset:0
v_smfmac_f32_16x16x64_bf16 v[12:15], v[44:47], v[80:87], v1
s_waitcnt lgkmcnt(2)
ds_read_b128 v[84:87], v2 offset:7168
v_smfmac_f32_16x16x64_bf16 v[8:11], v[44:47], a[128:135], v1
s_waitcnt vmcnt(5)
s_waitcnt lgkmcnt(2)
ds_read_b128 v[80:83], v2 offset:6144
v_smfmac_f32_16x16x64_bf16 v[12:15], v[32:35], a[144:151], v1
global_load_dword v7, v7, s[4:5] sc1
v_smfmac_f32_16x16x64_bf16 v[8:11], v[32:35], a[136:143], v1
ds_read_b128 v[32:35], v0 offset:4096
s_waitcnt vmcnt(5)
v_smfmac_f32_16x16x64_bf16 v[8:11], v[36:39], v[64:71], v1
s_nop 0
ds_read_b128 v[68:71], v2 offset:9216
s_waitcnt lgkmcnt(3)
v_smfmac_f32_16x16x64_bf16 v[12:15], v[36:39], a[152:159], v1
s_nop 0
ds_read_b128 v[64:67], v2 offset:8192
s_waitcnt lgkmcnt(3)
ds_read_b128 v[36:39], v0 offset:3072
v_add_f32 v8, v8, v10
v_smfmac_f32_16x16x64_bf16 v[20:23], v[40:43], v[80:87], v1
ds_read_b128 v[84:87], v2 offset:11264
v_mul_f32 v8, s35, v8
v_smfmac_f32_16x16x64_bf16 v[16:19], v[40:43], a[160:167], v1
s_waitcnt lgkmcnt(4)
ds_read_b128 v[40:43], v0 offset:7168
v_add_f32 v9, v9, v11
v_smfmac_f32_16x16x64_bf16 v[20:23], v[32:35], a[176:183], v1
ds_read_b128 v[80:83], v2 offset:10240
v_mul_f32 v9, s35, v9
v_add_f32 v13, v13, v15
v_cvt_pk_bf16_f32 v8, v8, v9
v_add_f32 v12, v12, v14
v_smfmac_f32_16x16x64_bf16 v[16:19], v[32:35], a[168:175], v1
s_waitcnt lgkmcnt(3)
ds_read_b128 v[32:35], v0 offset:2048
v_mul_f32 v13, s35, v13
v_smfmac_f32_16x16x64_bf16 v[16:19], v[36:39], v[64:71], v1
s_waitcnt vmcnt(3)
ds_read_b128 v[68:71], v2 offset:13312
v_mul_f32 v12, s35, v12
v_smfmac_f32_16x16x64_bf16 v[20:23], v[36:39], a[184:191], v1
s_waitcnt lgkmcnt(3)
ds_read_b128 v[36:39], v0 offset:6144
ds_read_b128 v[64:67], v2 offset:12288
v_cvt_pk_bf16_f32 v12, v12, v13
v_smfmac_f32_16x16x64_bf16 v[16:19], v[40:43], v[72:79], v1
s_waitcnt lgkmcnt(4)
ds_write2_b32 v3, v8, v12 offset0:0 offset1:128
v_smfmac_f32_16x16x64_bf16 v[20:23], v[40:43], v[80:87], v1
s_add_u32 s34, s17, 2
s_waitcnt lgkmcnt(4)
ds_read_b128 v[72:75], v2 offset:14336
v_smfmac_f32_16x16x64_bf16 v[20:23], v[32:35], a[200:207], v1
ds_read_b128 v[80:83], v2 offset:16384
v_smfmac_f32_16x16x64_bf16 v[16:19], v[32:35], a[192:199], v1
s_waitcnt lgkmcnt(4)
ds_read_b128 v[40:43], v0 offset:9216
s_mov_b64 vcc, s[42:43]
ds_read_b128 v[76:79], v2 offset:15360
v_smfmac_f32_16x16x64_bf16 v[20:23], v[36:39], a[208:215], v1
ds_read_b128 v[84:87], v2 offset:17408
s_waitcnt lgkmcnt(5)
s_barrier
ds_read_b128 v[32:35], v0 offset:8192
v_smfmac_f32_16x16x64_bf16 v[16:19], v[36:39], v[64:71], v1
ds_read_b64_tr_b16 v[10:11], v4 offset:512
s_mov_b64 s[70:71], s[74:75]
ds_read_b64_tr_b16 v[8:9], v4 offset:0
s_waitcnt lgkmcnt(6)
s_waitcnt lgkmcnt(5)
ds_read_b64_tr_b16 v[12:13], v4 offset:1024
v_smfmac_f32_16x16x64_bf16 v[20:23], v[40:43], a[216:223], v1
ds_read_b64_tr_b16 v[14:15], v4 offset:1536
s_waitcnt lgkmcnt(6)
ds_read_b128 v[68:71], v2 offset:19456
v_smfmac_f32_16x16x64_bf16 v[16:19], v[40:43], v[72:79], v1
s_waitcnt lgkmcnt(6)
ds_read_b128 v[36:39], v0 offset:9216
s_waitcnt lgkmcnt(6)
v_smfmac_f32_16x16x64_bf16 v[20:23], v[32:35], v[80:87], v1
ds_read_b128 v[64:67], v2 offset:18432
ds_read_b128 v[40:43], v0 offset:8192
v_smfmac_f32_16x16x64_bf16 v[16:19], v[32:35], a[224:231], v1
s_waitcnt lgkmcnt(6)
ds_read_b128 v[72:75], v2 offset:20480
ds_read_b128 v[32:35], v0 offset:0
v_mfma_f32_16x16x32_bf16 v[44:47], v[48:51], v[8:11], 0
s_waitcnt lgkmcnt(6)
ds_read_b128 v[76:79], v2 offset:21504
v_add_f32 v21, v21, v23
v_add_f32 v20, v20, v22
v_bfe_u32 v48, v0, 5, 1
v_mfma_f32_16x16x32_bf16 v[44:47], v[52:55], v[12:15], v[44:47]
s_waitcnt lgkmcnt(5)
ds_read_b128 v[80:83], v2 offset:22528
v_add_f32 v17, v17, v19
v_add_f32 v16, v16, v18
v_cvt_pk_bf16_f32 v20, v20, v21
v_lshl_add_u32 v48, v48, 3, v5
v_cvt_pk_bf16_f32 v16, v16, v17
v_smfmac_f32_16x16x64_bf16 v[28:31], v[36:39], a[232:239], v1
s_waitcnt lgkmcnt(4)
ds_write2_b32 v3, v16, v20 offset0:1 offset1:129
v_xor_b32 v48, 128, v48
v_cndmask_b32_dpp v44, v46, v44, vcc quad_perm:[0,1,0,1] row_mask:0xf bank_mask:0xf
v_cndmask_b32_dpp v45, v47, v45, vcc quad_perm:[0,1,0,1] row_mask:0xf bank_mask:0xf
v_smfmac_f32_16x16x64_bf16 v[24:27], v[36:39], v[64:71], v1
s_waitcnt lgkmcnt(3)
ds_write_b64 v48, v[44:45] offset:6656
v_smfmac_f32_16x16x64_bf16 v[24:27], v[40:43], a[240:247], v1
s_waitcnt lgkmcnt(3)
global_load_dwordx4 v[64:67], v0, s[78:79] offset:0 sc1
ds_read_b128 v[36:39], v0 offset:4096
v_smfmac_f32_16x16x64_bf16 v[28:31], v[40:43], v[72:79], v1
s_waitcnt lgkmcnt(3)
global_load_dwordx4 v[68:71], v0, s[78:79] offset:1024 sc1
ds_read_b128 v[84:87], v2 offset:23552
v_smfmac_f32_16x16x64_bf16 v[24:27], v[32:35], a[248:255], v1
global_load_dwordx4 v[72:75], v0, s[78:79] offset:2048 sc1
ds_read_b128 v[40:43], v0 offset:3072
v_smfmac_f32_16x16x64_bf16 v[28:31], v[32:35], v[88:95], v1
s_waitcnt lgkmcnt(3)
ds_read_b128 v[32:35], v0 offset:7168
s_barrier
ds_read_b128 v[52:55], v6 offset:7168
s_waitcnt lgkmcnt(4)
v_smfmac_f32_16x16x64_bf16 v[28:31], v[36:39], v[96:103], v1
s_waitcnt lgkmcnt(3)
ds_read_b128 v[48:51], v6 offset:6144
ds_read_b64_tr_b16 v[8:9], v4 offset:0
v_smfmac_f32_16x16x64_bf16 v[24:27], v[36:39], v[80:87], v1
s_waitcnt lgkmcnt(4)
ds_read_b128 v[36:39], v0 offset:2048
global_load_dwordx4 v[76:79], v0, s[78:79] offset:3072 sc1
ds_read_b64_tr_b16 v[10:11], v4 offset:512
v_smfmac_f32_16x16x64_bf16 v[28:31], v[40:43], v[112:119], v1
s_waitcnt lgkmcnt(5)
ds_read_b64_tr_b16 v[14:15], v4 offset:1536
ds_read_b64_tr_b16 v[18:19], v4 offset:2560
v_smfmac_f32_16x16x64_bf16 v[24:27], v[40:43], v[104:111], v1
s_waitcnt lgkmcnt(6)
ds_read_b64_tr_b16 v[12:13], v4 offset:1024
ds_read_b64_tr_b16 v[16:17], v4 offset:2048
v_smfmac_f32_16x16x64_bf16 v[28:31], v[32:35], v[128:135], v1
s_waitcnt lgkmcnt(7)
ds_read_b64_tr_b16 v[22:23], v4 offset:3584
v_add_f32 v50, v50, v54
v_add_f32 v49, v49, v53
v_smfmac_f32_16x16x64_bf16 v[24:27], v[32:35], v[120:127], v1
s_waitcnt lgkmcnt(6)
ds_read_b128 v[40:43], v0 offset:6144
v_add_f32 v48, v48, v52
v_smfmac_f32_16x16x64_bf16 v[24:27], v[36:39], v[136:143], v1
s_waitcnt lgkmcnt(5)
ds_read_b64_tr_b16 v[20:21], v4 offset:3072
v_add_f32 v51, v51, v55
v_smfmac_f32_16x16x64_bf16 v[28:31], v[36:39], v[144:151], v1
s_waitcnt lgkmcnt(4)
global_load_dwordx4 v[80:83], v0, s[80:81] offset:-4096 sc1
v_exp_f32 v51, v51
v_mfma_f32_16x16x32_bf16 v[44:47], v[8:11], v[8:11], 0
s_waitcnt lgkmcnt(3)
v_exp_f32 v49, v49
v_mfma_f32_16x16x32_bf16 v[44:47], v[12:15], v[12:15], v[44:47]
s_waitcnt lgkmcnt(1)
v_exp_f32 v50, v50
v_exp_f32 v48, v48
v_mfma_f32_16x16x32_bf16 v[44:47], v[16:19], v[16:19], v[44:47]
s_waitcnt lgkmcnt(0)
v_cvt_pk_bf16_f32 v55, v50, v51
v_cvt_pk_bf16_f32 v54, v48, v49
v_mfma_f32_16x16x32_bf16 v[44:47], v[20:23], v[20:23], v[44:47]
v_mov_b64 v[22:23], s[44:45]
v_mov_b32_dpp v50, v54 quad_perm:[2,3,2,3] row_mask:0xf bank_mask:0xf
v_mov_b32_dpp v49, v55 quad_perm:[0,1,0,1] row_mask:0xf bank_mask:0xf
v_mov_b32_dpp v51, v55 quad_perm:[2,3,2,3] row_mask:0xf bank_mask:0xf
v_smfmac_f32_16x16x64_bf16 v[24:27], v[40:43], v[152:159], v1
v_mov_b32_dpp v48, v54 quad_perm:[0,1,0,1] row_mask:0xf bank_mask:0xf
v_mov_b64 v[20:21], s[44:45]
v_smfmac_f32_16x16x64_bf16 v[28:31], v[40:43], v[160:167], v1
s_waitcnt vmcnt(7)
global_load_dwordx4 v[84:87], v0, s[80:81] offset:-3072 sc1
v_exp_f32_dpp v44, v46 quad_perm:[0,1,0,1] row_mask:0xf bank_mask:0xf
v_mfma_f32_16x16x32_bf16 v[8:11], v[56:59], v[48:51], 0
v_exp_f32_dpp v45, v47 quad_perm:[0,1,0,1] row_mask:0xf bank_mask:0xf
v_mfma_f32_16x16x32_bf16 v[16:19], v[20:23], v[48:51], 0
s_waitcnt vmcnt(7)
v_cvt_pk_bf16_f32 v53, v44, v45
v_mov_b64 v[54:55], s[46:47]
v_mfma_f32_16x16x32_bf16 v[12:15], v[60:63], v[48:51], 0
v_cvt_pk_bf16_f32 v52, v44, v45
v_cvt_pk_bf16_f32 v24, v24, v25
v_cvt_pk_bf16_f32 v25, v26, v27
v_mfma_f32_16x16x16_bf16 v[16:19], v[54:55], v[52:53], v[16:19]
s_min_u32 s34, s34, s32
v_cvt_pk_bf16_f32 v26, v28, v29
v_cvt_pk_bf16_f32 v27, v30, v31
v_mfma_f32_16x16x16_bf16 v[8:11], v[24:25], v[52:53], v[8:11]
ds_read_b128 v[28:31], v0 offset:31744
v_mov_b64 v[42:43], 0
v_mfma_f32_16x16x16_bf16 v[12:15], v[26:27], v[52:53], v[12:15]
s_waitcnt vmcnt(4)
v_bfe_u32 v32, v0, 5, 1
v_mov_b64 v[36:37], 0
v_subrev_u32 v17, s37, v16
v_rcp_f32 v18, v16
v_lshl_add_u32 v32, v32, 3, v5
v_mov_b64 v[38:39], 0
v_cmp_lt_u32 vcc, s38, v17
v_cndmask_b32 v9, v13, v9, s[42:43]
v_cndmask_b32 v8, v12, v8, s[42:43]
v_cndmask_b32 v10, v14, v10, s[42:43]
v_mul_f32 v10, v10, v18
v_cndmask_b32 v11, v15, v11, s[42:43]
v_mul_f32 v9, v9, v18
v_mul_f32 v8, v8, v18
v_mul_f32 v11, v11, v18
v_cvt_pk_bf16_f32 v12, v8, v9
v_cvt_pk_bf16_f32 v13, v10, v11
s_cbranch_vccnz rare_10026
back_10027:
ds_write_b64 v32, v[12:13] offset:512
v_mov_b32_dpp v9, v13 quad_perm:[0,1,0,1] row_mask:0xf bank_mask:0xf
v_mov_b32_dpp v10, v12 quad_perm:[2,3,2,3] row_mask:0xf bank_mask:0xf
v_mov_b32_dpp v8, v12 quad_perm:[0,1,0,1] row_mask:0xf bank_mask:0xf
v_mov_b32_dpp v11, v13 quad_perm:[2,3,2,3] row_mask:0xf bank_mask:0xf
v_mov_b64 v[54:55], 0
v_mov_b64 v[52:53], 0
v_smfmac_f32_16x16x64_bf16 v[36:39], v[8:11], v[64:71], v1
s_waitcnt vmcnt(2)
ds_read_b128 v[20:23], v0 offset:29696
global_load_dwordx4 v[64:67], v0, s[76:77] offset:-4096 sc1
ds_read_b128 v[16:19], v0 offset:28672
v_mov_b64 v[34:35], 0
v_mov_b64 v[32:33], 0
v_mov_b64 v[40:41], 0
v_smfmac_f32_16x16x64_bf16 v[52:55], v[8:11], v[176:183], v1
s_waitcnt lgkmcnt(2)
ds_read_b128 v[24:27], v0 offset:30720
s_barrier
ds_read_b128 v[56:59], v5 offset:0
global_load_dwordx4 v[68:71], v0, s[76:77] offset:-3072 sc1
ds_read_b128 v[12:15], v5 offset:1024
v_mov_b64 v[48:49], 0
v_smfmac_f32_16x16x64_bf16 v[40:43], v[8:11], v[72:79], v1
s_waitcnt vmcnt(2)
ds_read_b128 v[60:63], v5 offset:1536
v_mov_b64 v[50:51], 0
v_smfmac_f32_16x16x64_bf16 v[32:35], v[8:11], v[80:87], v1
global_load_dwordx4 v[72:75], v0, s[76:77] offset:-2048 sc1
ds_read_b128 v[80:83], v0 offset:32768
v_smfmac_f32_16x16x64_bf16 v[48:51], v[8:11], v[168:175], v1
s_waitcnt lgkmcnt(5)
s_waitcnt lgkmcnt(3)
ds_read_b128 v[84:87], v0 offset:33792
v_smfmac_f32_16x16x64_bf16 v[40:43], v[56:59], v[192:199], v1
global_load_dwordx4 v[76:79], v0, s[76:77] offset:-1024 sc1
v_smfmac_f32_16x16x64_bf16 v[36:39], v[56:59], v[16:23], v1
s_waitcnt lgkmcnt(2)
ds_read_b128 v[20:23], v0 offset:35840
v_lshrrev_b32 v44, 8, v0
v_smfmac_f32_16x16x64_bf16 v[36:39], v[60:63], v[24:31], v1
ds_read_b128 v[16:19], v0 offset:34816
v_bfe_u32 v45, v0, 1, 7
v_smfmac_f32_16x16x64_bf16 v[36:39], v[12:15], v[184:191], v1
s_waitcnt lgkmcnt(3)
ds_read_b128 v[28:31], v0 offset:37888
s_waitcnt lgkmcnt(3)
v_smfmac_f32_16x16x64_bf16 v[40:43], v[60:63], v[80:87], v1
ds_read_b128 v[24:27], v0 offset:36864
v_lshl_or_b32 v44, v44, 12, v45
v_smfmac_f32_16x16x64_bf16 v[40:43], v[12:15], v[200:207], v1
ds_read_b128 v[80:83], v0 offset:38912
v_cvt_pk_bf16_f32 v36, v36, v37
v_smfmac_f32_16x16x64_bf16 v[32:35], v[56:59], v[232:239], v1
ds_read_b128 v[84:87], v0 offset:39936
v_cvt_pk_bf16_f32 v37, v38, v39
v_and_or_b32 v36, v36, -2, s18
v_smfmac_f32_16x16x64_bf16 v[52:55], v[56:59], v[216:223], v1
global_store_dwordx2 v44, v[36:37], s[48:49]
s_waitcnt lgkmcnt(3)
v_cvt_pk_bf16_f32 v40, v40, v41
v_smfmac_f32_16x16x64_bf16 v[48:51], v[56:59], v[16:23], v1
s_waitcnt lgkmcnt(2)
s_waitcnt lgkmcnt(1)
v_and_or_b32 v40, v40, -2, s18
v_smfmac_f32_16x16x64_bf16 v[48:51], v[60:63], v[24:31], v1
v_cvt_pk_bf16_f32 v41, v42, v43
v_smfmac_f32_16x16x64_bf16 v[48:51], v[12:15], v[208:215], v1
s_waitcnt lgkmcnt(0)
global_store_dwordx2 v44, v[40:41], s[50:51]
v_smfmac_f32_16x16x64_bf16 v[32:35], v[60:63], v[240:247], v1
s_nop 1
v_smfmac_f32_16x16x64_bf16 v[52:55], v[60:63], v[80:87], v1
s_add_u32 s27, s20, 524288
s_add_u32 s58, s4, s20
v_cvt_pk_bf16_f32 v48, v48, v49
v_and_or_b32 v48, v48, -2, s18
v_cvt_pk_bf16_f32 v49, v50, v51
v_smfmac_f32_16x16x64_bf16 v[52:55], v[12:15], v[224:231], v1
s_nop 0
global_store_dwordx2 v44, v[48:49], s[52:53]
s_addc_u32 s59, s5, 0
s_mov_b32 s30, 0
v_smfmac_f32_16x16x64_bf16 v[32:35], v[12:15], v[248:255], v1
s_nop 2
v_cvt_pk_bf16_f32 v52, v52, v53
v_cvt_pk_bf16_f32 v53, v54, v55
s_mov_b32 s19, 1
v_and_or_b32 v52, v52, -2, s18
global_store_dwordx2 v44, v[52:53], s[54:55]
v_cvt_pk_bf16_f32 v32, v32, v33
v_cvt_pk_bf16_f32 v33, v34, v35
v_and_or_b32 v32, v32, -2, s18
global_store_dwordx2 v44, v[32:33], s[56:57]
v_bfe_u32 v32, v0, 6, 1
v_lshlrev_b32 v32, 4, v32
v_mov_b32 v33, 0x3f80
v_lshlrev_b32 v32, v32, v33
v_bfe_i32 v33, v0, 4, 1
v_and_b32 v45, v32, v33
v_and_b32 v47, v32, v33
v_xor_b32 v44, v32, v45
v_xor_b32 v46, v32, v45
v_and_b32 v36, 32, v0
v_bfe_u32 v37, v0, 6, 1
v_lshl_add_u32 v36, v37, 8, v36
v_bfe_u32 v37, v0, 8, 1
v_lshl_add_u32 v36, v37, 4, v36
v_bfe_u32 v37, v0, 4, 1
v_lshl_add_u32 v36, v37, 3, v36
v_and_b32 v7, 255, v0
v_lshl_add_u32 v7, v7, 3, s27
s_nop 15
s_nop 15
s_nop 15
s_nop 15
global_load_dwordx4 v[8:11], v0, s[64:65] offset:0 sc1
global_load_dwordx4 v[12:15], v0, s[64:65] offset:1024 sc1
global_load_dwordx4 v[16:19], v0, s[64:65] offset:2048 sc1
global_load_dwordx4 v[20:23], v0, s[64:65] offset:3072 sc1
s_nop 15
s_nop 15
s_nop 5
global_load_dwordx4 v[24:27], v0, s[64:65] offset:0 sc1
global_load_dwordx4 v[28:31], v0, s[64:65] offset:1024 sc1
global_load_dwordx4 v[48:51], v0, s[64:65] offset:2048 sc1
global_load_dwordx4 v[52:55], v0, s[64:65] offset:3072 sc1
chk_10035:
v_mov_b64 v[40:41], 0
v_mov_b64 v[42:43], 0
s_waitcnt vmcnt(6)
s_nop 0
v_smfmac_f32_16x16x64_bf16 v[40:43], v[44:47], v[8:15], v1
v_bitop3_b32 v32, v8, v10, s18 bitop3:0x7e
v_bitop3_b32 v33, v12, v14, s18 bitop3:0x7e
s_waitcnt vmcnt(4)
v_smfmac_f32_16x16x64_bf16 v[40:43], v[44:47], v[16:23], v1
v_bitop3_b32 v34, v16, v18, s18 bitop3:0x7e
v_bitop3_b32 v35, v20, v22, s18 bitop3:0x7e
v_or3_b32 v32, v32, v33, v34
v_bitop3_b32 v32, v32, v35, 1 bitop3:0xa8
v_cmp_ne_u32 vcc, 0, v32
s_cbranch_vccnz chk_10035_f
s_nop 1
v_add_f32_dpp v40, v40, v40 row_ror:8 row_mask:0xf bank_mask:0xf
v_add_f32_dpp v41, v41, v41 row_ror:8 row_mask:0xf bank_mask:0xf
v_add_f32_dpp v42, v42, v42 row_ror:8 row_mask:0xf bank_mask:0xf
v_add_f32_dpp v43, v43, v43 row_ror:8 row_mask:0xf bank_mask:0xf
v_cvt_pk_bf16_f32 v40, v40, v41
v_cvt_pk_bf16_f32 v41, v42, v43
v_and_or_b32 v40, v40, -2, s18
s_mov_b64 exec, 0x00ff00ff
global_store_dwordx2 v36, v[40:41], s[66:67]
s_mov_b64 exec, -1
s_branch join_10034
chk_10035_f:
global_load_dwordx4 v[8:11], v0, s[64:65] offset:0 sc1
global_load_dwordx4 v[12:15], v0, s[64:65] offset:1024 sc1
global_load_dwordx4 v[16:19], v0, s[64:65] offset:2048 sc1
global_load_dwordx4 v[20:23], v0, s[64:65] offset:3072 sc1
chk_10036:
v_mov_b64 v[40:41], 0
v_mov_b64 v[42:43], 0
s_waitcnt vmcnt(6)
s_nop 0
v_smfmac_f32_16x16x64_bf16 v[40:43], v[44:47], v[24:31], v1
v_bitop3_b32 v32, v24, v26, s18 bitop3:0x7e
v_bitop3_b32 v33, v28, v30, s18 bitop3:0x7e
s_waitcnt vmcnt(4)
v_smfmac_f32_16x16x64_bf16 v[40:43], v[44:47], v[48:55], v1
v_bitop3_b32 v34, v48, v50, s18 bitop3:0x7e
v_bitop3_b32 v35, v52, v54, s18 bitop3:0x7e
v_or3_b32 v32, v32, v33, v34
v_bitop3_b32 v32, v32, v35, 1 bitop3:0xa8
v_cmp_ne_u32 vcc, 0, v32
s_cbranch_vccnz chk_10036_f
s_nop 1
v_add_f32_dpp v40, v40, v40 row_ror:8 row_mask:0xf bank_mask:0xf
v_add_f32_dpp v41, v41, v41 row_ror:8 row_mask:0xf bank_mask:0xf
v_add_f32_dpp v42, v42, v42 row_ror:8 row_mask:0xf bank_mask:0xf
v_add_f32_dpp v43, v43, v43 row_ror:8 row_mask:0xf bank_mask:0xf
v_cvt_pk_bf16_f32 v40, v40, v41
v_cvt_pk_bf16_f32 v41, v42, v43
v_and_or_b32 v40, v40, -2, s18
s_mov_b64 exec, 0x00ff00ff
global_store_dwordx2 v36, v[40:41], s[66:67]
s_mov_b64 exec, -1
s_branch join_10034
chk_10036_f:
global_load_dwordx4 v[24:27], v0, s[64:65] offset:0 sc1
global_load_dwordx4 v[28:31], v0, s[64:65] offset:1024 sc1
global_load_dwordx4 v[48:51], v0, s[64:65] offset:2048 sc1
global_load_dwordx4 v[52:55], v0, s[64:65] offset:3072 sc1
s_add_u32 s30, s30, 1
s_cmp_le_u32 s30, 262144
s_cbranch_scc1 chk_10035
s_branch L_fail
nored_10033:
join_10034:
s_barrier
global_load_dwordx4 v[56:59], v0, s[76:77] offset:0 sc1
global_load_dwordx4 v[60:63], v0, s[76:77] offset:1024 sc1
global_load_dwordx4 v[80:83], v0, s[76:77] offset:2048 sc1
global_load_dwordx4 v[84:87], v0, s[76:77] offset:3072 sc1
s_nop 15
s_nop 15
s_nop 3
s_barrier
global_load_dwordx4 v[32:35], v0, s[68:69] offset:-4096 sc1
s_nop 10
global_load_dwordx4 v[36:39], v0, s[68:69] offset:0 sc1
s_nop 10
global_load_dwordx4 v[40:43], v0, s[70:71] offset:0 sc1
s_barrier
global_load_dwordx4 v[48:51], v0, s[58:59] offset:0 nt sc1
global_load_dwordx4 v[52:55], v0, s[58:59] offset:1024 nt sc1
s_waitcnt vmcnt(13)
v_mov_b64 v[8:9], 0
v_mov_b64 v[10:11], 0
s_waitcnt vmcnt(12)
v_mov_b64 v[12:13], 0
v_mov_b64 v[14:15], 0
s_waitcnt vmcnt(11)
v_mov_b64 v[16:17], 0
v_mov_b64 v[18:19], 0
s_waitcnt vmcnt(10)
v_mov_b64 v[20:21], 0
v_mov_b64 v[22:23], 0
v_mov_b64 v[24:25], 0
v_mov_b64 v[26:27], 0
v_mov_b64 v[28:29], 0
v_mov_b64 v[30:31], 0
s_mov_b32 s30, 0
s_cmp_eq_u32 s17, s31
s_cbranch_scc0 gather_10025
s_branch exit_10028
rt_10030:
global_load_dwordx4 v[32:35], v0, s[68:69] offset:-4096 sc1
global_load_dwordx4 v[36:39], v0, s[68:69] offset:0 sc1
global_load_dwordx4 v[40:43], v0, s[70:71] offset:0 sc1
s_add_u32 s30, s30, 1
s_cmp_gt_u32 s30, 262144
s_cbranch_scc1 L_fail
s_mov_b64 exec, 1
global_store_dword v0, v0, s[62:63]
global_store_dword v0, v0, s[62:63]
s_mov_b64 exec, -1
v_mov_b64 v[8:9], 0
v_mov_b64 v[10:11], 0
v_mov_b64 v[12:13], 0
v_mov_b64 v[14:15], 0
v_mov_b64 v[16:17], 0
v_mov_b64 v[18:19], 0
v_mov_b64 v[20:21], 0
v_mov_b64 v[22:23], 0
v_mov_b64 v[24:25], 0
v_mov_b64 v[26:27], 0
v_mov_b64 v[28:29], 0
v_mov_b64 v[30:31], 0
s_branch gather_10025
rare_10026:
ds_read_b128 v[48:51], v6 offset:6144
ds_read_b128 v[52:55], v6 offset:7168
s_waitcnt lgkmcnt(0)
v_add_f32 v48, v48, v52
v_add_f32 v49, v49, v53
v_add_f32 v50, v50, v54
v_add_f32 v51, v51, v55
v_mov_b32_dpp v46, v46 quad_perm:[0,1,0,1] row_mask:0xf bank_mask:0xf
v_mov_b32_dpp v47, v47 quad_perm:[0,1,0,1] row_mask:0xf bank_mask:0xf
v_max3_f32 v19, v48, v49, v50
v_max3_f32 v19, v19, v51, v46
v_max_f32 v19, v19, v47
s_nop 1
v_max_f32_dpp v19, v19, v19 quad_perm:[2,3,0,1] row_mask:0xf bank_mask:0xf
v_mov_b32 v44, v19
s_nop 1
v_permlane32_swap_b32 v19, v44
v_max_f32 v19, v19, v44
v_mov_b32 v44, v19
s_nop 1
v_permlane16_swap_b32 v19, v44
v_max_f32 v19, v19, v44
v_sub_f32 v48, v48, v19
v_sub_f32 v49, v49, v19
v_sub_f32 v50, v50, v19
v_sub_f32 v51, v51, v19
v_sub_f32 v46, v46, v19
v_sub_f32 v47, v47, v19
v_exp_f32 v48, v48
v_exp_f32 v49, v49
v_exp_f32 v50, v50
v_exp_f32 v51, v51
v_cvt_pk_bf16_f32 v54, v48, v49
v_cvt_pk_bf16_f32 v55, v50, v51
s_nop 0
v_mov_b32_dpp v48, v54 quad_perm:[0,1,0,1] row_mask:0xf bank_mask:0xf
v_mov_b32_dpp v49, v55 quad_perm:[0,1,0,1] row_mask:0xf bank_mask:0xf
v_mov_b32_dpp v50, v54 quad_perm:[2,3,2,3] row_mask:0xf bank_mask:0xf
v_mov_b32_dpp v51, v55 quad_perm:[2,3,2,3] row_mask:0xf bank_mask:0xf
v_mov_b64 v[20:21], s[44:45]
v_mov_b64 v[22:23], s[44:45]
v_mfma_f32_16x16x32_bf16 v[8:11], v[56:59], v[48:51], 0
v_mfma_f32_16x16x32_bf16 v[12:15], v[60:63], v[48:51], 0
v_mfma_f32_16x16x32_bf16 v[16:19], v[20:23], v[48:51], 0
v_mov_b64 v[54:55], s[46:47]
v_exp_f32_dpp v44, v46 quad_perm:[0,1,0,1] row_mask:0xf bank_mask:0xf
v_exp_f32_dpp v45, v47 quad_perm:[0,1,0,1] row_mask:0xf bank_mask:0xf
s_nop 0
v_cvt_pk_bf16_f32 v52, v44, v45
v_cvt_pk_bf16_f32 v53, v44, v45
s_nop 1
v_mfma_f32_16x16x16_bf16 v[16:19], v[54:55], v[52:53], v[16:19]
v_mfma_f32_16x16x16_bf16 v[8:11], v[24:25], v[52:53], v[8:11]
v_mfma_f32_16x16x16_bf16 v[12:15], v[26:27], v[52:53], v[12:15]
s_nop 5
v_rcp_f32 v18, v16
s_nop 0
v_cndmask_b32 v8, v12, v8, s[42:43]
v_mul_f32 v8, v8, v18
v_cndmask_b32 v9, v13, v9, s[42:43]
v_mul_f32 v9, v9, v18
v_cndmask_b32 v10, v14, v10, s[42:43]
v_mul_f32 v10, v10, v18
v_cndmask_b32 v11, v15, v11, s[42:43]
v_mul_f32 v11, v11, v18
v_cvt_pk_bf16_f32 v12, v8, v9
v_cvt_pk_bf16_f32 v13, v10, v11
s_branch back_10027
exit_10028:
global_load_dwordx4 v[32:35], v0, s[68:69] offset:-4096 sc1
global_load_dwordx4 v[36:39], v0, s[68:69] offset:0 sc1
global_load_dwordx4 v[40:43], v0, s[70:71] offset:0 sc1
s_add_u32 s30, s30, 1
s_cmp_gt_u32 s30, 262144
s_cbranch_scc1 L_fail
s_waitcnt vmcnt(2)
v_bitop3_b32 v44, v32, v34, s18 bitop3:0x7e
s_waitcnt vmcnt(1)
v_bitop3_b32 v45, v36, v38, s18 bitop3:0x7e
v_or_b32 v44, v44, v45
s_waitcnt vmcnt(0)
v_bitop3_b32 v46, v40, v42, s18 bitop3:0x7e
v_bitop3_b32 v44, v44, v46, s19 bitop3:0xa8
v_cmp_ne_u32 vcc, 0, v44
s_cbranch_vccnz exit_10028
s_add_u32 s36, s36, 1
s_cmp_lt_u32 s36, 2
s_cbranch_scc1 layer_10024
s_endpgm
wave_10007:
layer_10037:
s_lshl_b32 s17, s36, 6
s_mul_i32 s27, s36, 35651584
s_mul_i32 s28, s14, 16384
s_add_u32 s27, s27, s28
s_add_u32 s20, s27, 16785408
s_mul_i32 s27, s17, 10240
s_add_u32 s27, s27, s24
s_add_u32 s21, s27, s25
s_mov_b32 s19, 0
s_mov_b32 s33, s6
s_add_u32 s34, s17, 1
s_add_u32 s31, s17, 63
s_add_u32 s32, s17, 64
s_mov_b32 s27, s20
v_mov_b32 v7, 0
s_add_u32 s68, s4, 415744
s_addc_u32 s69, s5, 0
s_add_u32 s72, s4, 399360
s_addc_u32 s73, s5, 0
s_add_u32 s70, s4, 419840
s_addc_u32 s71, s5, 0
s_add_u32 s74, s4, 403456
s_addc_u32 s75, s5, 0
s_add_u32 s58, s4, s20
s_addc_u32 s59, s5, 0
global_load_dwordx4 v[64:67], v0, s[76:77] offset:-4096 sc1
global_load_dwordx4 v[68:71], v0, s[76:77] offset:-3072 sc1
global_load_dwordx4 v[72:75], v0, s[76:77] offset:-2048 sc1
global_load_dwordx4 v[76:79], v0, s[76:77] offset:-1024 sc1
global_load_dwordx4 v[80:83], v0, s[76:77] offset:2048 sc1
global_load_dwordx4 v[84:87], v0, s[76:77] offset:3072 sc1
global_load_dwordx4 v[56:59], v0, s[76:77] offset:0 sc1
global_load_dwordx4 v[60:63], v0, s[76:77] offset:1024 sc1
v_mov_b64 v[8:9], 0
v_mov_b64 v[10:11], 0
v_mov_b64 v[12:13], 0
v_mov_b64 v[14:15], 0
v_mov_b64 v[16:17], 0
v_mov_b64 v[18:19], 0
v_mov_b64 v[20:21], 0
v_mov_b64 v[22:23], 0
v_mov_b64 v[24:25], 0
v_mov_b64 v[26:27], 0
v_mov_b64 v[28:29], 0
v_mov_b64 v[30:31], 0
s_barrier
global_load_dwordx4 v[48:51], v0, s[58:59] offset:0 nt sc1
global_load_dwordx4 v[52:55], v0, s[58:59] offset:1024 nt sc1
v_and_b32 v7, 255, v0
v_lshl_add_u32 v7, v7, 3, s27
global_load_dwordx4 v[32:35], v0, s[68:69] offset:-4096 sc1
global_load_dwordx4 v[36:39], v0, s[68:69] offset:0 sc1
v_mov_b32 v45, -1
s_mov_b32 s30, 0
s_waitcnt vmcnt(0)
.p2align 6
gather_10038:
s_waitcnt vmcnt(3)
rt_10043_b:
v_smfmac_f32_16x16x64_bf16 v[24:27], v[32:35], a[0:7], v1
ds_write_b128 v0, v[32:35] offset:2048
v_smfmac_f32_16x16x64_bf16 v[8:11], v[32:35], v[64:71], v1
v_bitop3_b32 v44, v32, v34, s18 bitop3:0x7e
v_smfmac_f32_16x16x64_bf16 v[12:15], v[32:35], v[72:79], v1
s_waitcnt vmcnt(2)
ds_write_b128 v0, v[36:39] offset:6144
v_bitop3_b32 v45, v36, v38, s18 bitop3:0x7e
v_bitop3_b32 v44, v44, v45, s19 bitop3:0xa8
v_cmp_ne_u32 vcc, 0, v44
v_smfmac_f32_16x16x64_bf16 v[8:11], v[36:39], a[16:23], v1
v_smfmac_f32_16x16x64_bf16 v[20:23], v[32:35], v[80:87], v1
s_cbranch_vccnz rt_10043
global_load_dwordx4 v[64:67], v0, s[78:79] offset:-4096 sc1
ds_read_b128 v[80:83], v2 offset:0
v_smfmac_f32_16x16x64_bf16 v[28:31], v[32:35], a[8:15], v1
global_load_dwordx4 v[68:71], v0, s[78:79] offset:-3072 sc1
ds_read_b128 v[84:87], v2 offset:1024
v_smfmac_f32_16x16x64_bf16 v[20:23], v[36:39], a[40:47], v1
global_load_dwordx4 v[72:75], v0, s[78:79] offset:-2048 sc1
global_load_dwordx4 v[76:79], v0, s[78:79] offset:-1024 sc1
v_smfmac_f32_16x16x64_bf16 v[16:19], v[32:35], v[56:63], v1
s_waitcnt lgkmcnt(2)
s_barrier
ds_read_b128 v[40:43], v0 offset:3072
v_smfmac_f32_16x16x64_bf16 v[16:19], v[36:39], a[32:39], v1
s_xor_b32 s18, s18, 1
s_waitcnt lgkmcnt(1)
ds_read_b128 v[44:47], v0 offset:7168
v_smfmac_f32_16x16x64_bf16 v[28:31], v[36:39], v[80:87], v1
ds_read_b128 v[80:83], v2 offset:2048
v_smfmac_f32_16x16x64_bf16 v[24:27], v[36:39], a[48:55], v1
s_mov_b64 s[68:69], s[72:73]
ds_read_b128 v[32:35], v0 offset:0
v_smfmac_f32_16x16x64_bf16 v[12:15], v[36:39], a[24:31], v1
ds_read_b128 v[84:87], v2 offset:3072
s_waitcnt lgkmcnt(4)
v_smfmac_f32_16x16x64_bf16 v[8:11], v[40:43], a[56:63], v1
ds_read_b128 v[36:39], v0 offset:4096
v_smfmac_f32_16x16x64_bf16 v[12:15], v[40:43], a[64:71], v1
s_add_u32 s20, s20, 524288
s_waitcnt lgkmcnt(4)
ds_read_b128 v[40:43], v0 offset:1024
v_smfmac_f32_16x16x64_bf16 v[12:15], v[44:47], a[80:87], v1
s_add_u32 s17, s17, 1
global_load_dwordx4 v[56:59], v0, s[58:59] offset:2048 nt sc1
v_smfmac_f32_16x16x64_bf16 v[8:11], v[44:47], a[72:79], v1
s_waitcnt lgkmcnt(3)
ds_read_b128 v[44:47], v0 offset:5120
s_waitcnt lgkmcnt(3)
v_smfmac_f32_16x16x64_bf16 v[12:15], v[32:35], v[80:87], v1
s_add_u32 s21, s21, 10240
ds_read_b128 v[80:83], v2 offset:4096
v_smfmac_f32_16x16x64_bf16 v[8:11], v[32:35], a[88:95], v1
s_waitcnt lgkmcnt(3)
ds_read_b128 v[84:87], v2 offset:5120
s_waitcnt lgkmcnt(3)
v_smfmac_f32_16x16x64_bf16 v[12:15], v[36:39], a[104:111], v1
ds_read_b128 v[32:35], v0 offset:8192
v_smfmac_f32_16x16x64_bf16 v[8:11], v[36:39], a[96:103], v1
ds_read_b128 v[36:39], v0 offset:9216
v_smfmac_f32_16x16x64_bf16 v[8:11], v[40:43], a[112:119], v1
s_waitcnt lgkmcnt(4)
global_load_dwordx4 v[60:63], v0, s[58:59] offset:3072 nt sc1
v_smfmac_f32_16x16x64_bf16 v[12:15], v[40:43], a[120:127], v1
s_waitcnt lgkmcnt(2)
ds_read_b128 v[40:43], v0 offset:3072
v_smfmac_f32_16x16x64_bf16 v[12:15], v[44:47], v[80:87], v1
s_waitcnt lgkmcnt(2)
ds_read_b128 v[84:87], v2 offset:7168
v_smfmac_f32_16x16x64_bf16 v[8:11], v[44:47], a[128:135], v1
s_waitcnt vmcnt(5)
s_waitcnt lgkmcnt(2)
ds_read_b128 v[80:83], v2 offset:6144
v_smfmac_f32_16x16x64_bf16 v[12:15], v[32:35], a[144:151], v1
global_load_dword v7, v7, s[4:5] sc1
v_smfmac_f32_16x16x64_bf16 v[8:11], v[32:35], a[136:143], v1
ds_read_b128 v[32:35], v0 offset:7168
s_waitcnt vmcnt(5)
v_smfmac_f32_16x16x64_bf16 v[8:11], v[36:39], v[64:71], v1
s_nop 0
ds_read_b128 v[68:71], v2 offset:9216
s_waitcnt lgkmcnt(3)
v_smfmac_f32_16x16x64_bf16 v[12:15], v[36:39], a[152:159], v1
s_nop 0
ds_read_b128 v[64:67], v2 offset:8192
s_waitcnt lgkmcnt(3)
ds_read_b128 v[36:39], v0 offset:0
v_add_f32 v8, v8, v10
v_smfmac_f32_16x16x64_bf16 v[20:23], v[40:43], v[80:87], v1
ds_read_b128 v[84:87], v2 offset:11264
v_mul_f32 v8, s35, v8
v_smfmac_f32_16x16x64_bf16 v[16:19], v[40:43], a[160:167], v1
s_waitcnt lgkmcnt(4)
ds_read_b128 v[40:43], v0 offset:4096
v_add_f32 v9, v9, v11
v_smfmac_f32_16x16x64_bf16 v[20:23], v[32:35], a[176:183], v1
ds_read_b128 v[80:83], v2 offset:10240
v_mul_f32 v9, s35, v9
v_add_f32 v13, v13, v15
v_cvt_pk_bf16_f32 v8, v8, v9
v_add_f32 v12, v12, v14
v_smfmac_f32_16x16x64_bf16 v[16:19], v[32:35], a[168:175], v1
s_waitcnt lgkmcnt(3)
ds_read_b128 v[32:35], v0 offset:1024
v_mul_f32 v13, s35, v13
v_smfmac_f32_16x16x64_bf16 v[16:19], v[36:39], v[64:71], v1
s_waitcnt vmcnt(3)
ds_read_b128 v[68:71], v2 offset:13312
v_mul_f32 v12, s35, v12
v_smfmac_f32_16x16x64_bf16 v[20:23], v[36:39], a[184:191], v1
s_waitcnt lgkmcnt(3)
ds_read_b128 v[36:39], v0 offset:5120
ds_read_b128 v[64:67], v2 offset:12288
v_cvt_pk_bf16_f32 v12, v12, v13
v_smfmac_f32_16x16x64_bf16 v[16:19], v[40:43], v[72:79], v1
s_waitcnt lgkmcnt(4)
ds_write2_b32 v3, v8, v12 offset0:0 offset1:128
v_smfmac_f32_16x16x64_bf16 v[20:23], v[40:43], v[80:87], v1
s_add_u32 s34, s17, 2
s_waitcnt lgkmcnt(4)
ds_read_b128 v[72:75], v2 offset:14336
v_smfmac_f32_16x16x64_bf16 v[20:23], v[32:35], a[200:207], v1
ds_read_b128 v[80:83], v2 offset:16384
v_smfmac_f32_16x16x64_bf16 v[16:19], v[32:35], a[192:199], v1
s_waitcnt lgkmcnt(4)
ds_read_b128 v[40:43], v0 offset:8192
s_mov_b64 vcc, s[42:43]
ds_read_b128 v[76:79], v2 offset:15360
v_smfmac_f32_16x16x64_bf16 v[20:23], v[36:39], a[208:215], v1
ds_read_b128 v[84:87], v2 offset:17408
s_waitcnt lgkmcnt(5)
s_barrier
ds_read_b128 v[32:35], v0 offset:9216
v_smfmac_f32_16x16x64_bf16 v[16:19], v[36:39], v[64:71], v1
ds_read_b64_tr_b16 v[10:11], v4 offset:2560
ds_read_b64_tr_b16 v[8:9], v4 offset:2048
s_waitcnt lgkmcnt(6)
s_waitcnt lgkmcnt(5)
ds_read_b64_tr_b16 v[12:13], v4 offset:3072
v_smfmac_f32_16x16x64_bf16 v[20:23], v[40:43], a[216:223], v1
ds_read_b64_tr_b16 v[14:15], v4 offset:3584
s_waitcnt lgkmcnt(6)
ds_read_b128 v[68:71], v2 offset:19456
v_smfmac_f32_16x16x64_bf16 v[16:19], v[40:43], v[72:79], v1
s_waitcnt lgkmcnt(6)
ds_read_b128 v[36:39], v0 offset:8192
s_waitcnt lgkmcnt(6)
v_smfmac_f32_16x16x64_bf16 v[20:23], v[32:35], v[80:87], v1
ds_read_b128 v[64:67], v2 offset:18432
ds_read_b128 v[40:43], v0 offset:9216
v_smfmac_f32_16x16x64_bf16 v[16:19], v[32:35], a[224:231], v1
s_waitcnt lgkmcnt(6)
ds_read_b128 v[72:75], v2 offset:20480
ds_read_b128 v[32:35], v0 offset:3072
v_mfma_f32_16x16x32_bf16 v[44:47], v[48:51], v[8:11], 0
s_waitcnt lgkmcnt(6)
ds_read_b128 v[76:79], v2 offset:21504
v_add_f32 v21, v21, v23
v_add_f32 v20, v20, v22
v_bfe_u32 v48, v0, 5, 1
v_mfma_f32_16x16x32_bf16 v[44:47], v[52:55], v[12:15], v[44:47]
s_waitcnt lgkmcnt(5)
ds_read_b128 v[80:83], v2 offset:22528
v_add_f32 v17, v17, v19
v_add_f32 v16, v16, v18
v_cvt_pk_bf16_f32 v20, v20, v21
v_lshl_add_u32 v48, v48, 3, v5
v_cvt_pk_bf16_f32 v16, v16, v17
v_smfmac_f32_16x16x64_bf16 v[28:31], v[36:39], a[232:239], v1
s_waitcnt lgkmcnt(4)
ds_write2_b32 v3, v16, v20 offset0:1 offset1:129
v_cndmask_b32_dpp v44, v46, v44, vcc quad_perm:[0,1,0,1] row_mask:0xf bank_mask:0xf
v_cndmask_b32_dpp v45, v47, v45, vcc quad_perm:[0,1,0,1] row_mask:0xf bank_mask:0xf
v_smfmac_f32_16x16x64_bf16 v[24:27], v[36:39], v[64:71], v1
s_waitcnt lgkmcnt(3)
ds_write_b64 v48, v[44:45] offset:7168
v_smfmac_f32_16x16x64_bf16 v[24:27], v[40:43], a[240:247], v1
s_waitcnt lgkmcnt(3)
global_load_dwordx4 v[64:67], v0, s[78:79] offset:0 sc1
ds_read_b128 v[36:39], v0 offset:7168
v_smfmac_f32_16x16x64_bf16 v[28:31], v[40:43], v[72:79], v1
s_waitcnt lgkmcnt(3)
global_load_dwordx4 v[68:71], v0, s[78:79] offset:1024 sc1
ds_read_b128 v[84:87], v2 offset:23552
v_smfmac_f32_16x16x64_bf16 v[24:27], v[32:35], a[248:255], v1
global_load_dwordx4 v[72:75], v0, s[78:79] offset:2048 sc1
ds_read_b128 v[40:43], v0 offset:0
v_smfmac_f32_16x16x64_bf16 v[28:31], v[32:35], v[88:95], v1
s_waitcnt lgkmcnt(3)
ds_read_b128 v[32:35], v0 offset:4096
s_barrier
ds_read_b128 v[52:55], v6 offset:7168
s_waitcnt lgkmcnt(4)
v_smfmac_f32_16x16x64_bf16 v[28:31], v[36:39], v[96:103], v1
s_waitcnt lgkmcnt(3)
ds_read_b128 v[48:51], v6 offset:6144
ds_read_b64_tr_b16 v[8:9], v4 offset:0
v_smfmac_f32_16x16x64_bf16 v[24:27], v[36:39], v[80:87], v1
s_waitcnt lgkmcnt(4)
ds_read_b128 v[36:39], v0 offset:1024
global_load_dwordx4 v[76:79], v0, s[78:79] offset:3072 sc1
ds_read_b64_tr_b16 v[10:11], v4 offset:512
v_smfmac_f32_16x16x64_bf16 v[28:31], v[40:43], v[112:119], v1
s_waitcnt lgkmcnt(5)
ds_read_b64_tr_b16 v[14:15], v4 offset:1536
ds_read_b64_tr_b16 v[18:19], v4 offset:2560
v_smfmac_f32_16x16x64_bf16 v[24:27], v[40:43], v[104:111], v1
s_waitcnt lgkmcnt(6)
ds_read_b64_tr_b16 v[12:13], v4 offset:1024
ds_read_b64_tr_b16 v[16:17], v4 offset:2048
v_smfmac_f32_16x16x64_bf16 v[28:31], v[32:35], v[128:135], v1
s_waitcnt lgkmcnt(7)
ds_read_b64_tr_b16 v[22:23], v4 offset:3584
v_add_f32 v50, v50, v54
v_add_f32 v49, v49, v53
v_smfmac_f32_16x16x64_bf16 v[24:27], v[32:35], v[120:127], v1
s_waitcnt lgkmcnt(6)
ds_read_b128 v[40:43], v0 offset:5120
v_add_f32 v48, v48, v52
v_smfmac_f32_16x16x64_bf16 v[24:27], v[36:39], v[136:143], v1
s_waitcnt lgkmcnt(5)
ds_read_b64_tr_b16 v[20:21], v4 offset:3072
v_add_f32 v51, v51, v55
v_smfmac_f32_16x16x64_bf16 v[28:31], v[36:39], v[144:151], v1
s_waitcnt lgkmcnt(4)
global_load_dwordx4 v[80:83], v0, s[80:81] offset:-4096 sc1
v_exp_f32 v51, v51
v_mfma_f32_16x16x32_bf16 v[44:47], v[8:11], v[8:11], 0
s_waitcnt lgkmcnt(3)
v_exp_f32 v49, v49
v_mfma_f32_16x16x32_bf16 v[44:47], v[12:15], v[12:15], v[44:47]
s_waitcnt lgkmcnt(1)
v_exp_f32 v50, v50
v_exp_f32 v48, v48
v_mfma_f32_16x16x32_bf16 v[44:47], v[16:19], v[16:19], v[44:47]
s_waitcnt lgkmcnt(0)
v_cvt_pk_bf16_f32 v55, v50, v51
v_cvt_pk_bf16_f32 v54, v48, v49
v_mfma_f32_16x16x32_bf16 v[44:47], v[20:23], v[20:23], v[44:47]
v_mov_b64 v[22:23], s[44:45]
v_mov_b32_dpp v50, v54 quad_perm:[2,3,2,3] row_mask:0xf bank_mask:0xf
v_mov_b32_dpp v49, v55 quad_perm:[0,1,0,1] row_mask:0xf bank_mask:0xf
v_mov_b32_dpp v51, v55 quad_perm:[2,3,2,3] row_mask:0xf bank_mask:0xf
v_smfmac_f32_16x16x64_bf16 v[24:27], v[40:43], v[152:159], v1
v_mov_b32_dpp v48, v54 quad_perm:[0,1,0,1] row_mask:0xf bank_mask:0xf
v_mov_b64 v[20:21], s[44:45]
v_smfmac_f32_16x16x64_bf16 v[28:31], v[40:43], v[160:167], v1
s_waitcnt vmcnt(7)
global_load_dwordx4 v[84:87], v0, s[80:81] offset:-3072 sc1
v_exp_f32_dpp v44, v46 quad_perm:[0,1,0,1] row_mask:0xf bank_mask:0xf
v_mfma_f32_16x16x32_bf16 v[8:11], v[56:59], v[48:51], 0
v_exp_f32_dpp v45, v47 quad_perm:[0,1,0,1] row_mask:0xf bank_mask:0xf
v_mfma_f32_16x16x32_bf16 v[16:19], v[20:23], v[48:51], 0
s_waitcnt vmcnt(7)
v_cvt_pk_bf16_f32 v53, v44, v45
v_mov_b64 v[54:55], s[46:47]
v_mfma_f32_16x16x32_bf16 v[12:15], v[60:63], v[48:51], 0
v_cvt_pk_bf16_f32 v52, v44, v45
v_cvt_pk_bf16_f32 v24, v24, v25
v_cvt_pk_bf16_f32 v25, v26, v27
v_mfma_f32_16x16x16_bf16 v[16:19], v[54:55], v[52:53], v[16:19]
s_min_u32 s34, s34, s32
v_cvt_pk_bf16_f32 v26, v28, v29
v_cvt_pk_bf16_f32 v27, v30, v31
v_mfma_f32_16x16x16_bf16 v[8:11], v[24:25], v[52:53], v[8:11]
ds_read_b128 v[28:31], v0 offset:44032
v_mov_b64 v[42:43], 0
v_mfma_f32_16x16x16_bf16 v[12:15], v[26:27], v[52:53], v[12:15]
s_waitcnt vmcnt(4)
v_bfe_u32 v32, v0, 5, 1
v_mov_b64 v[36:37], 0
v_subrev_u32 v17, s37, v16
v_rcp_f32 v18, v16
v_lshl_add_u32 v32, v32, 3, v5
v_mov_b64 v[38:39], 0
v_cmp_lt_u32 vcc, s38, v17
v_cndmask_b32 v9, v13, v9, s[42:43]
v_cndmask_b32 v8, v12, v8, s[42:43]
v_cndmask_b32 v10, v14, v10, s[42:43]
v_mul_f32 v10, v10, v18
v_cndmask_b32 v11, v15, v11, s[42:43]
v_mul_f32 v9, v9, v18
v_mul_f32 v8, v8, v18
v_mul_f32 v11, v11, v18
v_cvt_pk_bf16_f32 v12, v8, v9
v_cvt_pk_bf16_f32 v13, v10, v11
s_cbranch_vccnz rare_10039
back_10040:
ds_write_b64 v32, v[12:13] offset:1024
v_mov_b32_dpp v9, v13 quad_perm:[0,1,0,1] row_mask:0xf bank_mask:0xf
v_mov_b32_dpp v10, v12 quad_perm:[2,3,2,3] row_mask:0xf bank_mask:0xf
v_mov_b32_dpp v8, v12 quad_perm:[0,1,0,1] row_mask:0xf bank_mask:0xf
v_mov_b32_dpp v11, v13 quad_perm:[2,3,2,3] row_mask:0xf bank_mask:0xf
v_mov_b64 v[54:55], 0
v_mov_b64 v[52:53], 0
v_smfmac_f32_16x16x64_bf16 v[36:39], v[8:11], v[64:71], v1
s_waitcnt vmcnt(2)
ds_read_b128 v[20:23], v0 offset:41984
global_load_dwordx4 v[64:67], v0, s[76:77] offset:-4096 sc1
ds_read_b128 v[16:19], v0 offset:40960
v_mov_b64 v[34:35], 0
v_mov_b64 v[32:33], 0
v_mov_b64 v[40:41], 0
v_smfmac_f32_16x16x64_bf16 v[52:55], v[8:11], v[176:183], v1
s_waitcnt lgkmcnt(2)
ds_read_b128 v[24:27], v0 offset:43008
s_barrier
ds_read_b128 v[56:59], v5 offset:1536
global_load_dwordx4 v[68:71], v0, s[76:77] offset:-3072 sc1
ds_read_b128 v[12:15], v5 offset:512
v_mov_b64 v[48:49], 0
v_smfmac_f32_16x16x64_bf16 v[40:43], v[8:11], v[72:79], v1
s_waitcnt vmcnt(2)
ds_read_b128 v[60:63], v5 offset:0
v_mov_b64 v[50:51], 0
v_smfmac_f32_16x16x64_bf16 v[32:35], v[8:11], v[80:87], v1
global_load_dwordx4 v[72:75], v0, s[76:77] offset:-2048 sc1
ds_read_b128 v[80:83], v0 offset:45056
v_smfmac_f32_16x16x64_bf16 v[48:51], v[8:11], v[168:175], v1
s_waitcnt lgkmcnt(5)
s_waitcnt lgkmcnt(3)
ds_read_b128 v[84:87], v0 offset:46080
v_smfmac_f32_16x16x64_bf16 v[40:43], v[56:59], v[192:199], v1
global_load_dwordx4 v[76:79], v0, s[76:77] offset:-1024 sc1
v_smfmac_f32_16x16x64_bf16 v[36:39], v[56:59], v[16:23], v1
s_waitcnt lgkmcnt(2)
ds_read_b128 v[20:23], v0 offset:48128
v_lshrrev_b32 v44, 8, v0
v_smfmac_f32_16x16x64_bf16 v[36:39], v[60:63], v[24:31], v1
ds_read_b128 v[16:19], v0 offset:47104
v_bfe_u32 v45, v0, 1, 7
v_smfmac_f32_16x16x64_bf16 v[36:39], v[12:15], v[184:191], v1
s_waitcnt lgkmcnt(3)
ds_read_b128 v[28:31], v0 offset:50176
s_waitcnt lgkmcnt(3)
v_smfmac_f32_16x16x64_bf16 v[40:43], v[60:63], v[80:87], v1
ds_read_b128 v[24:27], v0 offset:49152
v_lshl_or_b32 v44, v44, 12, v45
v_smfmac_f32_16x16x64_bf16 v[40:43], v[12:15], v[200:207], v1
ds_read_b128 v[80:83], v0 offset:51200
v_cvt_pk_bf16_f32 v36, v36, v37
v_smfmac_f32_16x16x64_bf16 v[32:35], v[56:59], v[232:239], v1
ds_read_b128 v[84:87], v0 offset:52224
v_cvt_pk_bf16_f32 v37, v38, v39
v_and_or_b32 v36, v36, -2, s18
v_smfmac_f32_16x16x64_bf16 v[52:55], v[56:59], v[216:223], v1
global_store_dwordx2 v44, v[36:37], s[48:49]
s_waitcnt lgkmcnt(3)
v_cvt_pk_bf16_f32 v40, v40, v41
v_smfmac_f32_16x16x64_bf16 v[48:51], v[56:59], v[16:23], v1
s_waitcnt lgkmcnt(2)
s_waitcnt lgkmcnt(1)
v_and_or_b32 v40, v40, -2, s18
v_smfmac_f32_16x16x64_bf16 v[48:51], v[60:63], v[24:31], v1
v_cvt_pk_bf16_f32 v41, v42, v43
v_smfmac_f32_16x16x64_bf16 v[48:51], v[12:15], v[208:215], v1
s_waitcnt lgkmcnt(0)
global_store_dwordx2 v44, v[40:41], s[50:51]
v_smfmac_f32_16x16x64_bf16 v[32:35], v[60:63], v[240:247], v1
s_nop 1
v_smfmac_f32_16x16x64_bf16 v[52:55], v[60:63], v[80:87], v1
s_add_u32 s27, s20, 524288
s_add_u32 s58, s4, s20
v_cvt_pk_bf16_f32 v48, v48, v49
v_and_or_b32 v48, v48, -2, s18
v_cvt_pk_bf16_f32 v49, v50, v51
v_smfmac_f32_16x16x64_bf16 v[52:55], v[12:15], v[224:231], v1
s_nop 0
global_store_dwordx2 v44, v[48:49], s[52:53]
s_addc_u32 s59, s5, 0
s_mov_b32 s30, 0
v_smfmac_f32_16x16x64_bf16 v[32:35], v[12:15], v[248:255], v1
s_nop 2
v_cvt_pk_bf16_f32 v52, v52, v53
v_cvt_pk_bf16_f32 v53, v54, v55
s_mov_b32 s19, 1
v_and_or_b32 v52, v52, -2, s18
global_store_dwordx2 v44, v[52:53], s[54:55]
v_cvt_pk_bf16_f32 v32, v32, v33
v_cvt_pk_bf16_f32 v33, v34, v35
v_and_or_b32 v32, v32, -2, s18
global_store_dwordx2 v44, v[32:33], s[56:57]
s_cmp_ge_u32 s14, 16
s_cbranch_scc1 nored_10046
v_bfe_u32 v32, v0, 6, 1
v_lshlrev_b32 v32, 4, v32
v_mov_b32 v33, 0x3f80
v_lshlrev_b32 v32, v32, v33
v_bfe_i32 v33, v0, 4, 1
v_and_b32 v45, v32, v33
v_and_b32 v47, v32, v33
v_xor_b32 v44, v32, v45
v_xor_b32 v46, v32, v45
v_and_b32 v36, 32, v0
v_bfe_u32 v37, v0, 6, 1
v_lshl_add_u32 v36, v37, 8, v36
v_bfe_u32 v37, v0, 8, 1
v_lshl_add_u32 v36, v37, 4, v36
v_bfe_u32 v37, v0, 4, 1
v_lshl_add_u32 v36, v37, 3, v36
v_and_b32 v7, 255, v0
v_lshl_add_u32 v7, v7, 3, s27
s_nop 15
s_nop 15
s_nop 15
s_nop 15
s_nop 12
global_load_dwordx4 v[8:11], v0, s[64:65] offset:0 sc1
global_load_dwordx4 v[12:15], v0, s[64:65] offset:1024 sc1
global_load_dwordx4 v[16:19], v0, s[64:65] offset:2048 sc1
global_load_dwordx4 v[20:23], v0, s[64:65] offset:3072 sc1
s_nop 15
s_nop 15
s_nop 5
global_load_dwordx4 v[24:27], v0, s[64:65] offset:0 sc1
global_load_dwordx4 v[28:31], v0, s[64:65] offset:1024 sc1
global_load_dwordx4 v[48:51], v0, s[64:65] offset:2048 sc1
global_load_dwordx4 v[52:55], v0, s[64:65] offset:3072 sc1
chk_10048:
v_mov_b64 v[40:41], 0
v_mov_b64 v[42:43], 0
s_waitcnt vmcnt(6)
s_nop 0
v_smfmac_f32_16x16x64_bf16 v[40:43], v[44:47], v[8:15], v1
v_bitop3_b32 v32, v8, v10, s18 bitop3:0x7e
v_bitop3_b32 v33, v12, v14, s18 bitop3:0x7e
s_waitcnt vmcnt(4)
v_smfmac_f32_16x16x64_bf16 v[40:43], v[44:47], v[16:23], v1
v_bitop3_b32 v34, v16, v18, s18 bitop3:0x7e
v_bitop3_b32 v35, v20, v22, s18 bitop3:0x7e
v_or3_b32 v32, v32, v33, v34
v_bitop3_b32 v32, v32, v35, 1 bitop3:0xa8
v_cmp_ne_u32 vcc, 0, v32
s_cbranch_vccnz chk_10048_f
s_nop 1
v_add_f32_dpp v40, v40, v40 row_ror:8 row_mask:0xf bank_mask:0xf
v_add_f32_dpp v41, v41, v41 row_ror:8 row_mask:0xf bank_mask:0xf
v_add_f32_dpp v42, v42, v42 row_ror:8 row_mask:0xf bank_mask:0xf
v_add_f32_dpp v43, v43, v43 row_ror:8 row_mask:0xf bank_mask:0xf
v_cvt_pk_bf16_f32 v40, v40, v41
v_cvt_pk_bf16_f32 v41, v42, v43
v_and_or_b32 v40, v40, -2, s18
s_mov_b64 exec, 0x00ff00ff
global_store_dwordx2 v36, v[40:41], s[66:67]
s_mov_b64 exec, -1
s_branch join_10047
chk_10048_f:
global_load_dwordx4 v[8:11], v0, s[64:65] offset:0 sc1
global_load_dwordx4 v[12:15], v0, s[64:65] offset:1024 sc1
global_load_dwordx4 v[16:19], v0, s[64:65] offset:2048 sc1
global_load_dwordx4 v[20:23], v0, s[64:65] offset:3072 sc1
chk_10049:
v_mov_b64 v[40:41], 0
v_mov_b64 v[42:43], 0
s_waitcnt vmcnt(6)
s_nop 0
v_smfmac_f32_16x16x64_bf16 v[40:43], v[44:47], v[24:31], v1
v_bitop3_b32 v32, v24, v26, s18 bitop3:0x7e
v_bitop3_b32 v33, v28, v30, s18 bitop3:0x7e
s_waitcnt vmcnt(4)
v_smfmac_f32_16x16x64_bf16 v[40:43], v[44:47], v[48:55], v1
v_bitop3_b32 v34, v48, v50, s18 bitop3:0x7e
v_bitop3_b32 v35, v52, v54, s18 bitop3:0x7e
v_or3_b32 v32, v32, v33, v34
v_bitop3_b32 v32, v32, v35, 1 bitop3:0xa8
v_cmp_ne_u32 vcc, 0, v32
s_cbranch_vccnz chk_10049_f
s_nop 1
v_add_f32_dpp v40, v40, v40 row_ror:8 row_mask:0xf bank_mask:0xf
v_add_f32_dpp v41, v41, v41 row_ror:8 row_mask:0xf bank_mask:0xf
v_add_f32_dpp v42, v42, v42 row_ror:8 row_mask:0xf bank_mask:0xf
v_add_f32_dpp v43, v43, v43 row_ror:8 row_mask:0xf bank_mask:0xf
v_cvt_pk_bf16_f32 v40, v40, v41
v_cvt_pk_bf16_f32 v41, v42, v43
v_and_or_b32 v40, v40, -2, s18
s_mov_b64 exec, 0x00ff00ff
global_store_dwordx2 v36, v[40:41], s[66:67]
s_mov_b64 exec, -1
s_branch join_10047
chk_10049_f:
global_load_dwordx4 v[24:27], v0, s[64:65] offset:0 sc1
global_load_dwordx4 v[28:31], v0, s[64:65] offset:1024 sc1
global_load_dwordx4 v[48:51], v0, s[64:65] offset:2048 sc1
global_load_dwordx4 v[52:55], v0, s[64:65] offset:3072 sc1
s_add_u32 s30, s30, 1
s_cmp_le_u32 s30, 262144
s_cbranch_scc1 chk_10048
s_branch L_fail
nored_10046:
v_and_b32 v7, 255, v0
v_lshl_add_u32 v7, v7, 3, s27
join_10047:
s_barrier
global_load_dwordx4 v[56:59], v0, s[76:77] offset:0 sc1
global_load_dwordx4 v[60:63], v0, s[76:77] offset:1024 sc1
global_load_dwordx4 v[80:83], v0, s[76:77] offset:2048 sc1
global_load_dwordx4 v[84:87], v0, s[76:77] offset:3072 sc1
s_nop 15
s_nop 15
s_nop 3
s_barrier
global_load_dwordx4 v[32:35], v0, s[68:69] offset:-4096 sc1
s_nop 10
global_load_dwordx4 v[36:39], v0, s[68:69] offset:0 sc1
s_barrier
global_load_dwordx4 v[48:51], v0, s[58:59] offset:0 nt sc1
global_load_dwordx4 v[52:55], v0, s[58:59] offset:1024 nt sc1
s_waitcnt vmcnt(12)
v_mov_b64 v[8:9], 0
v_mov_b64 v[10:11], 0
s_waitcnt vmcnt(11)
v_mov_b64 v[12:13], 0
v_mov_b64 v[14:15], 0
s_waitcnt vmcnt(10)
v_mov_b64 v[16:17], 0
v_mov_b64 v[18:19], 0
s_waitcnt vmcnt(9)
v_mov_b64 v[20:21], 0
v_mov_b64 v[22:23], 0
v_mov_b64 v[24:25], 0
v_mov_b64 v[26:27], 0
v_mov_b64 v[28:29], 0
v_mov_b64 v[30:31], 0
s_mov_b32 s30, 0
s_cmp_eq_u32 s17, s31
s_cbranch_scc0 gather_10038
s_branch exit_10041
rt_10043:
global_load_dwordx4 v[32:35], v0, s[68:69] offset:-4096 sc1
global_load_dwordx4 v[36:39], v0, s[68:69] offset:0 sc1
s_add_u32 s30, s30, 1
s_cmp_gt_u32 s30, 262144
s_cbranch_scc1 L_fail
s_mov_b64 exec, 1
global_store_dword v0, v0, s[62:63]
global_store_dword v0, v0, s[62:63]
s_mov_b64 exec, -1
v_mov_b64 v[8:9], 0
v_mov_b64 v[10:11], 0
v_mov_b64 v[12:13], 0
v_mov_b64 v[14:15], 0
v_mov_b64 v[16:17], 0
v_mov_b64 v[18:19], 0
v_mov_b64 v[20:21], 0
v_mov_b64 v[22:23], 0
v_mov_b64 v[24:25], 0
v_mov_b64 v[26:27], 0
v_mov_b64 v[28:29], 0
v_mov_b64 v[30:31], 0
s_branch gather_10038
rare_10039:
ds_read_b128 v[48:51], v6 offset:6144
ds_read_b128 v[52:55], v6 offset:7168
s_waitcnt lgkmcnt(0)
v_add_f32 v48, v48, v52
v_add_f32 v49, v49, v53
v_add_f32 v50, v50, v54
v_add_f32 v51, v51, v55
v_mov_b32_dpp v46, v46 quad_perm:[0,1,0,1] row_mask:0xf bank_mask:0xf
v_mov_b32_dpp v47, v47 quad_perm:[0,1,0,1] row_mask:0xf bank_mask:0xf
v_max3_f32 v19, v48, v49, v50
v_max3_f32 v19, v19, v51, v46
v_max_f32 v19, v19, v47
s_nop 1
v_max_f32_dpp v19, v19, v19 quad_perm:[2,3,0,1] row_mask:0xf bank_mask:0xf
v_mov_b32 v44, v19
s_nop 1
v_permlane32_swap_b32 v19, v44
v_max_f32 v19, v19, v44
v_mov_b32 v44, v19
s_nop 1
v_permlane16_swap_b32 v19, v44
v_max_f32 v19, v19, v44
v_sub_f32 v48, v48, v19
v_sub_f32 v49, v49, v19
v_sub_f32 v50, v50, v19
v_sub_f32 v51, v51, v19
v_sub_f32 v46, v46, v19
v_sub_f32 v47, v47, v19
v_exp_f32 v48, v48
v_exp_f32 v49, v49
v_exp_f32 v50, v50
v_exp_f32 v51, v51
v_cvt_pk_bf16_f32 v54, v48, v49
v_cvt_pk_bf16_f32 v55, v50, v51
s_nop 0
v_mov_b32_dpp v48, v54 quad_perm:[0,1,0,1] row_mask:0xf bank_mask:0xf
v_mov_b32_dpp v49, v55 quad_perm:[0,1,0,1] row_mask:0xf bank_mask:0xf
v_mov_b32_dpp v50, v54 quad_perm:[2,3,2,3] row_mask:0xf bank_mask:0xf
v_mov_b32_dpp v51, v55 quad_perm:[2,3,2,3] row_mask:0xf bank_mask:0xf
v_mov_b64 v[20:21], s[44:45]
v_mov_b64 v[22:23], s[44:45]
v_mfma_f32_16x16x32_bf16 v[8:11], v[56:59], v[48:51], 0
v_mfma_f32_16x16x32_bf16 v[12:15], v[60:63], v[48:51], 0
v_mfma_f32_16x16x32_bf16 v[16:19], v[20:23], v[48:51], 0
v_mov_b64 v[54:55], s[46:47]
v_exp_f32_dpp v44, v46 quad_perm:[0,1,0,1] row_mask:0xf bank_mask:0xf
v_exp_f32_dpp v45, v47 quad_perm:[0,1,0,1] row_mask:0xf bank_mask:0xf
s_nop 0
v_cvt_pk_bf16_f32 v52, v44, v45
v_cvt_pk_bf16_f32 v53, v44, v45
s_nop 1
v_mfma_f32_16x16x16_bf16 v[16:19], v[54:55], v[52:53], v[16:19]
v_mfma_f32_16x16x16_bf16 v[8:11], v[24:25], v[52:53], v[8:11]
v_mfma_f32_16x16x16_bf16 v[12:15], v[26:27], v[52:53], v[12:15]
s_nop 5
v_rcp_f32 v18, v16
s_nop 0
v_cndmask_b32 v8, v12, v8, s[42:43]
v_mul_f32 v8, v8, v18
v_cndmask_b32 v9, v13, v9, s[42:43]
v_mul_f32 v9, v9, v18
v_cndmask_b32 v10, v14, v10, s[42:43]
v_mul_f32 v10, v10, v18
v_cndmask_b32 v11, v15, v11, s[42:43]
v_mul_f32 v11, v11, v18
v_cvt_pk_bf16_f32 v12, v8, v9
v_cvt_pk_bf16_f32 v13, v10, v11
s_branch back_10040
exit_10041:
global_load_dwordx4 v[32:35], v0, s[68:69] offset:-4096 sc1
global_load_dwordx4 v[36:39], v0, s[68:69] offset:0 sc1
s_add_u32 s30, s30, 1
s_cmp_gt_u32 s30, 262144
s_cbranch_scc1 L_fail
s_waitcnt vmcnt(1)
v_bitop3_b32 v44, v32, v34, s18 bitop3:0x7e
s_waitcnt vmcnt(0)
v_bitop3_b32 v45, v36, v38, s18 bitop3:0x7e
v_bitop3_b32 v44, v44, v45, s19 bitop3:0xa8
v_cmp_ne_u32 vcc, 0, v44
s_cbranch_vccnz exit_10041
s_add_u32 s36, s36, 1
s_cmp_lt_u32 s36, 2
s_cbranch_scc1 layer_10037
s_endpgm
wave_10008:
layer_10050:
s_lshl_b32 s17, s36, 6
s_mul_i32 s27, s36, 35651584
s_mul_i32 s28, s14, 16384
s_add_u32 s27, s27, s28
s_add_u32 s20, s27, 16789504
s_mul_i32 s27, s17, 10240
s_add_u32 s27, s27, s24
s_add_u32 s21, s27, s25
s_mov_b32 s19, 0
s_mov_b32 s33, s6
s_add_u32 s34, s17, 1
s_add_u32 s31, s17, 63
s_add_u32 s32, s17, 64
s_mov_b32 s27, s20
v_mov_b32 v7, 0
s_add_u32 s68, s4, 416768
s_addc_u32 s69, s5, 0
s_add_u32 s72, s4, 400384
s_addc_u32 s73, s5, 0
s_add_u32 s70, s4, 420864
s_addc_u32 s71, s5, 0
s_add_u32 s74, s4, 404480
s_addc_u32 s75, s5, 0
s_add_u32 s58, s4, s20
s_addc_u32 s59, s5, 0
global_load_dwordx4 v[64:67], v0, s[76:77] offset:-4096 sc1
global_load_dwordx4 v[68:71], v0, s[76:77] offset:-3072 sc1
global_load_dwordx4 v[72:75], v0, s[76:77] offset:-2048 sc1
global_load_dwordx4 v[76:79], v0, s[76:77] offset:-1024 sc1
global_load_dwordx4 v[80:83], v0, s[76:77] offset:2048 sc1
global_load_dwordx4 v[84:87], v0, s[76:77] offset:3072 sc1
global_load_dwordx4 v[56:59], v0, s[76:77] offset:0 sc1
global_load_dwordx4 v[60:63], v0, s[76:77] offset:1024 sc1
v_mov_b64 v[8:9], 0
v_mov_b64 v[10:11], 0
v_mov_b64 v[12:13], 0
v_mov_b64 v[14:15], 0
v_mov_b64 v[16:17], 0
v_mov_b64 v[18:19], 0
v_mov_b64 v[20:21], 0
v_mov_b64 v[22:23], 0
v_mov_b64 v[24:25], 0
v_mov_b64 v[26:27], 0
v_mov_b64 v[28:29], 0
v_mov_b64 v[30:31], 0
s_barrier
global_load_dwordx4 v[48:51], v0, s[58:59] offset:0 nt sc1
global_load_dwordx4 v[52:55], v0, s[58:59] offset:1024 nt sc1
v_and_b32 v7, 128, v0
v_add_u32 v7, s22, v7
s_mov_b32 exec_hi, 0
v_and_b32 v7, 255, v0
v_lshl_add_u32 v7, v7, 3, s27
s_mov_b32 exec_hi, -1
global_load_dwordx4 v[32:35], v0, s[68:69] offset:-4096 sc1
global_load_dwordx4 v[36:39], v0, s[68:69] offset:0 sc1
s_mov_b32 s30, 0
s_waitcnt vmcnt(0)
.p2align 6
gather_10051:
s_waitcnt vmcnt(3)
rt_10056_b:
v_smfmac_f32_16x16x64_bf16 v[24:27], v[32:35], a[0:7], v1
ds_write_b128 v0, v[32:35] offset:3072
v_smfmac_f32_16x16x64_bf16 v[8:11], v[32:35], v[64:71], v1
v_bitop3_b32 v44, v32, v34, s18 bitop3:0x7e
v_smfmac_f32_16x16x64_bf16 v[12:15], v[32:35], v[72:79], v1
s_waitcnt vmcnt(2)
ds_write_b128 v0, v[36:39] offset:7168
v_bitop3_b32 v45, v36, v38, s18 bitop3:0x7e
v_bitop3_b32 v44, v44, v45, s19 bitop3:0xa8
v_cmp_ne_u32 vcc, 0, v44
v_smfmac_f32_16x16x64_bf16 v[8:11], v[36:39], a[16:23], v1
v_smfmac_f32_16x16x64_bf16 v[20:23], v[32:35], v[80:87], v1
s_cbranch_vccnz rt_10056
global_load_dwordx4 v[64:67], v0, s[78:79] offset:-4096 sc1
ds_read_b128 v[80:83], v2 offset:0
v_smfmac_f32_16x16x64_bf16 v[28:31], v[32:35], a[8:15], v1
global_load_dwordx4 v[68:71], v0, s[78:79] offset:-3072 sc1
ds_read_b128 v[84:87], v2 offset:1024
v_smfmac_f32_16x16x64_bf16 v[20:23], v[36:39], a[40:47], v1
global_load_dwordx4 v[72:75], v0, s[78:79] offset:-2048 sc1
global_load_dwordx4 v[76:79], v0, s[78:79] offset:-1024 sc1
v_smfmac_f32_16x16x64_bf16 v[16:19], v[32:35], v[56:63], v1
s_waitcnt lgkmcnt(2)
s_barrier
ds_read_b128 v[40:43], v0 offset:2048
v_smfmac_f32_16x16x64_bf16 v[16:19], v[36:39], a[32:39], v1
s_xor_b32 s18, s18, 1
s_waitcnt lgkmcnt(1)
ds_read_b128 v[44:47], v0 offset:6144
v_smfmac_f32_16x16x64_bf16 v[28:31], v[36:39], v[80:87], v1
ds_read_b128 v[80:83], v2 offset:2048
v_smfmac_f32_16x16x64_bf16 v[24:27], v[36:39], a[48:55], v1
s_mov_b64 s[68:69], s[72:73]
ds_read_b128 v[32:35], v0 offset:1024
v_smfmac_f32_16x16x64_bf16 v[12:15], v[36:39], a[24:31], v1
ds_read_b128 v[84:87], v2 offset:3072
s_waitcnt lgkmcnt(4)
v_smfmac_f32_16x16x64_bf16 v[8:11], v[40:43], a[56:63], v1
ds_read_b128 v[36:39], v0 offset:5120
v_smfmac_f32_16x16x64_bf16 v[12:15], v[40:43], a[64:71], v1
s_add_u32 s20, s20, 524288
s_waitcnt lgkmcnt(4)
ds_read_b128 v[40:43], v0 offset:0
v_smfmac_f32_16x16x64_bf16 v[12:15], v[44:47], a[80:87], v1
s_add_u32 s17, s17, 1
global_load_dwordx4 v[56:59], v0, s[58:59] offset:2048 nt sc1
v_smfmac_f32_16x16x64_bf16 v[8:11], v[44:47], a[72:79], v1
s_waitcnt lgkmcnt(3)
ds_read_b128 v[44:47], v0 offset:4096
s_waitcnt lgkmcnt(3)
v_smfmac_f32_16x16x64_bf16 v[12:15], v[32:35], v[80:87], v1
s_add_u32 s21, s21, 10240
ds_read_b128 v[80:83], v2 offset:4096
v_smfmac_f32_16x16x64_bf16 v[8:11], v[32:35], a[88:95], v1
s_waitcnt lgkmcnt(3)
ds_read_b128 v[84:87], v2 offset:5120
s_waitcnt lgkmcnt(3)
v_smfmac_f32_16x16x64_bf16 v[12:15], v[36:39], a[104:111], v1
ds_read_b128 v[32:35], v0 offset:9216
v_smfmac_f32_16x16x64_bf16 v[8:11], v[36:39], a[96:103], v1
ds_read_b128 v[36:39], v0 offset:8192
v_smfmac_f32_16x16x64_bf16 v[8:11], v[40:43], a[112:119], v1
s_waitcnt lgkmcnt(4)
global_load_dwordx4 v[60:63], v0, s[58:59] offset:3072 nt sc1
v_smfmac_f32_16x16x64_bf16 v[12:15], v[40:43], a[120:127], v1
s_waitcnt lgkmcnt(2)
ds_read_b128 v[40:43], v0 offset:2048
v_smfmac_f32_16x16x64_bf16 v[12:15], v[44:47], v[80:87], v1
s_waitcnt lgkmcnt(2)
ds_read_b128 v[84:87], v2 offset:7168
v_smfmac_f32_16x16x64_bf16 v[8:11], v[44:47], a[128:135], v1
s_waitcnt vmcnt(5)
s_waitcnt lgkmcnt(2)
ds_read_b128 v[80:83], v2 offset:6144
v_smfmac_f32_16x16x64_bf16 v[12:15], v[32:35], a[144:151], v1
global_load_dword v7, v7, s[4:5] sc1
v_smfmac_f32_16x16x64_bf16 v[8:11], v[32:35], a[136:143], v1
ds_read_b128 v[32:35], v0 offset:6144
s_waitcnt vmcnt(5)
v_smfmac_f32_16x16x64_bf16 v[8:11], v[36:39], v[64:71], v1
s_nop 0
ds_read_b128 v[68:71], v2 offset:9216
s_waitcnt lgkmcnt(3)
v_smfmac_f32_16x16x64_bf16 v[12:15], v[36:39], a[152:159], v1
s_nop 0
ds_read_b128 v[64:67], v2 offset:8192
s_waitcnt lgkmcnt(3)
ds_read_b128 v[36:39], v0 offset:1024
v_add_f32 v8, v8, v10
v_smfmac_f32_16x16x64_bf16 v[20:23], v[40:43], v[80:87], v1
ds_read_b128 v[84:87], v2 offset:11264
v_mul_f32 v8, s35, v8
v_smfmac_f32_16x16x64_bf16 v[16:19], v[40:43], a[160:167], v1
s_waitcnt lgkmcnt(4)
ds_read_b128 v[40:43], v0 offset:5120
v_add_f32 v9, v9, v11
v_smfmac_f32_16x16x64_bf16 v[20:23], v[32:35], a[176:183], v1
ds_read_b128 v[80:83], v2 offset:10240
v_mul_f32 v9, s35, v9
v_add_f32 v13, v13, v15
v_cvt_pk_bf16_f32 v8, v8, v9
v_add_f32 v12, v12, v14
v_smfmac_f32_16x16x64_bf16 v[16:19], v[32:35], a[168:175], v1
s_waitcnt lgkmcnt(3)
ds_read_b128 v[32:35], v0 offset:0
v_mul_f32 v13, s35, v13
v_smfmac_f32_16x16x64_bf16 v[16:19], v[36:39], v[64:71], v1
s_waitcnt vmcnt(3)
ds_read_b128 v[68:71], v2 offset:13312
v_mul_f32 v12, s35, v12
v_smfmac_f32_16x16x64_bf16 v[20:23], v[36:39], a[184:191], v1
s_waitcnt lgkmcnt(3)
ds_read_b128 v[36:39], v0 offset:4096
ds_read_b128 v[64:67], v2 offset:12288
v_cvt_pk_bf16_f32 v12, v12, v13
v_smfmac_f32_16x16x64_bf16 v[16:19], v[40:43], v[72:79], v1
s_waitcnt lgkmcnt(4)
ds_write2_b32 v3, v8, v12 offset0:0 offset1:128
v_smfmac_f32_16x16x64_bf16 v[20:23], v[40:43], v[80:87], v1
s_add_u32 s34, s17, 2
s_waitcnt lgkmcnt(4)
ds_read_b128 v[72:75], v2 offset:14336
v_smfmac_f32_16x16x64_bf16 v[20:23], v[32:35], a[200:207], v1
ds_read_b128 v[80:83], v2 offset:16384
v_smfmac_f32_16x16x64_bf16 v[16:19], v[32:35], a[192:199], v1
s_waitcnt lgkmcnt(4)
ds_read_b128 v[40:43], v0 offset:9216
s_mov_b64 vcc, s[42:43]
ds_read_b128 v[76:79], v2 offset:15360
v_smfmac_f32_16x16x64_bf16 v[20:23], v[36:39], a[208:215], v1
ds_read_b128 v[84:87], v2 offset:17408
s_waitcnt lgkmcnt(5)
s_barrier
ds_read_b128 v[32:35], v0 offset:8192
v_smfmac_f32_16x16x64_bf16 v[16:19], v[36:39], v[64:71], v1
ds_read_b64_tr_b16 v[10:11], v4 offset:2560
ds_read_b64_tr_b16 v[8:9], v4 offset:2048
s_waitcnt lgkmcnt(6)
s_waitcnt lgkmcnt(5)
ds_read_b64_tr_b16 v[12:13], v4 offset:3072
v_smfmac_f32_16x16x64_bf16 v[20:23], v[40:43], a[216:223], v1
ds_read_b64_tr_b16 v[14:15], v4 offset:3584
s_waitcnt lgkmcnt(6)
ds_read_b128 v[68:71], v2 offset:19456
v_smfmac_f32_16x16x64_bf16 v[16:19], v[40:43], v[72:79], v1
s_waitcnt lgkmcnt(6)
ds_read_b128 v[36:39], v0 offset:9216
s_waitcnt lgkmcnt(6)
v_smfmac_f32_16x16x64_bf16 v[20:23], v[32:35], v[80:87], v1
ds_read_b128 v[64:67], v2 offset:18432
ds_read_b128 v[40:43], v0 offset:8192
v_smfmac_f32_16x16x64_bf16 v[16:19], v[32:35], a[224:231], v1
s_waitcnt lgkmcnt(6)
ds_read_b128 v[72:75], v2 offset:20480
ds_read_b128 v[32:35], v0 offset:2048
v_mfma_f32_16x16x32_bf16 v[44:47], v[48:51], v[8:11], 0
s_waitcnt lgkmcnt(6)
ds_read_b128 v[76:79], v2 offset:21504
v_add_f32 v21, v21, v23
v_add_f32 v20, v20, v22
v_bfe_u32 v48, v0, 5, 1
v_mfma_f32_16x16x32_bf16 v[44:47], v[52:55], v[12:15], v[44:47]
s_waitcnt lgkmcnt(5)
ds_read_b128 v[80:83], v2 offset:22528
v_add_f32 v17, v17, v19
v_add_f32 v16, v16, v18
v_cvt_pk_bf16_f32 v20, v20, v21
v_lshl_add_u32 v48, v48, 3, v5
v_cvt_pk_bf16_f32 v16, v16, v17
v_smfmac_f32_16x16x64_bf16 v[28:31], v[36:39], a[232:239], v1
s_waitcnt lgkmcnt(4)
ds_write2_b32 v3, v16, v20 offset0:1 offset1:129
v_xor_b32 v48, 128, v48
v_cndmask_b32_dpp v44, v46, v44, vcc quad_perm:[0,1,0,1] row_mask:0xf bank_mask:0xf
v_cndmask_b32_dpp v45, v47, v45, vcc quad_perm:[0,1,0,1] row_mask:0xf bank_mask:0xf
v_smfmac_f32_16x16x64_bf16 v[24:27], v[36:39], v[64:71], v1
s_waitcnt lgkmcnt(3)
ds_write_b64 v48, v[44:45] offset:7680
v_smfmac_f32_16x16x64_bf16 v[24:27], v[40:43], a[240:247], v1
s_waitcnt lgkmcnt(3)
global_load_dwordx4 v[64:67], v0, s[78:79] offset:0 sc1
ds_read_b128 v[36:39], v0 offset:6144
v_smfmac_f32_16x16x64_bf16 v[28:31], v[40:43], v[72:79], v1
s_waitcnt lgkmcnt(3)
global_load_dwordx4 v[68:71], v0, s[78:79] offset:1024 sc1
ds_read_b128 v[84:87], v2 offset:23552
v_smfmac_f32_16x16x64_bf16 v[24:27], v[32:35], a[248:255], v1
global_load_dwordx4 v[72:75], v0, s[78:79] offset:2048 sc1
ds_read_b128 v[40:43], v0 offset:1024
v_smfmac_f32_16x16x64_bf16 v[28:31], v[32:35], v[88:95], v1
s_waitcnt lgkmcnt(3)
ds_read_b128 v[32:35], v0 offset:5120
s_barrier
ds_read_b128 v[52:55], v6 offset:7168
s_waitcnt lgkmcnt(4)
v_smfmac_f32_16x16x64_bf16 v[28:31], v[36:39], v[96:103], v1
s_waitcnt lgkmcnt(3)
ds_read_b128 v[48:51], v6 offset:6144
ds_read_b64_tr_b16 v[8:9], v4 offset:0
v_smfmac_f32_16x16x64_bf16 v[24:27], v[36:39], v[80:87], v1
s_waitcnt lgkmcnt(4)
ds_read_b128 v[36:39], v0 offset:0
global_load_dwordx4 v[76:79], v0, s[78:79] offset:3072 sc1
ds_read_b64_tr_b16 v[10:11], v4 offset:512
v_smfmac_f32_16x16x64_bf16 v[28:31], v[40:43], v[112:119], v1
s_waitcnt lgkmcnt(5)
ds_read_b64_tr_b16 v[14:15], v4 offset:1536
ds_read_b64_tr_b16 v[18:19], v4 offset:2560
v_smfmac_f32_16x16x64_bf16 v[24:27], v[40:43], v[104:111], v1
s_waitcnt lgkmcnt(6)
ds_read_b64_tr_b16 v[12:13], v4 offset:1024
ds_read_b64_tr_b16 v[16:17], v4 offset:2048
v_smfmac_f32_16x16x64_bf16 v[28:31], v[32:35], v[128:135], v1
s_waitcnt lgkmcnt(7)
ds_read_b64_tr_b16 v[22:23], v4 offset:3584
v_add_f32 v50, v50, v54
v_add_f32 v49, v49, v53
v_smfmac_f32_16x16x64_bf16 v[24:27], v[32:35], v[120:127], v1
s_waitcnt lgkmcnt(6)
ds_read_b128 v[40:43], v0 offset:4096
v_add_f32 v48, v48, v52
v_smfmac_f32_16x16x64_bf16 v[24:27], v[36:39], v[136:143], v1
s_waitcnt lgkmcnt(5)
ds_read_b64_tr_b16 v[20:21], v4 offset:3072
v_add_f32 v51, v51, v55
v_smfmac_f32_16x16x64_bf16 v[28:31], v[36:39], v[144:151], v1
s_waitcnt lgkmcnt(4)
global_load_dwordx4 v[80:83], v0, s[80:81] offset:-4096 sc1
v_exp_f32 v51, v51
v_mfma_f32_16x16x32_bf16 v[44:47], v[8:11], v[8:11], 0
s_waitcnt lgkmcnt(3)
v_exp_f32 v49, v49
v_mfma_f32_16x16x32_bf16 v[44:47], v[12:15], v[12:15], v[44:47]
s_waitcnt lgkmcnt(1)
v_exp_f32 v50, v50
v_exp_f32 v48, v48
v_mfma_f32_16x16x32_bf16 v[44:47], v[16:19], v[16:19], v[44:47]
s_waitcnt lgkmcnt(0)
v_cvt_pk_bf16_f32 v55, v50, v51
v_cvt_pk_bf16_f32 v54, v48, v49
v_mfma_f32_16x16x32_bf16 v[44:47], v[20:23], v[20:23], v[44:47]
v_mov_b64 v[22:23], s[44:45]
v_mov_b32_dpp v50, v54 quad_perm:[2,3,2,3] row_mask:0xf bank_mask:0xf
v_mov_b32_dpp v49, v55 quad_perm:[0,1,0,1] row_mask:0xf bank_mask:0xf
v_mov_b32_dpp v51, v55 quad_perm:[2,3,2,3] row_mask:0xf bank_mask:0xf
v_smfmac_f32_16x16x64_bf16 v[24:27], v[40:43], v[152:159], v1
v_mov_b32_dpp v48, v54 quad_perm:[0,1,0,1] row_mask:0xf bank_mask:0xf
v_mov_b64 v[20:21], s[44:45]
v_smfmac_f32_16x16x64_bf16 v[28:31], v[40:43], v[160:167], v1
s_waitcnt vmcnt(7)
global_load_dwordx4 v[84:87], v0, s[80:81] offset:-3072 sc1
v_exp_f32_dpp v44, v46 quad_perm:[0,1,0,1] row_mask:0xf bank_mask:0xf
v_mfma_f32_16x16x32_bf16 v[8:11], v[56:59], v[48:51], 0
v_exp_f32_dpp v45, v47 quad_perm:[0,1,0,1] row_mask:0xf bank_mask:0xf
v_mfma_f32_16x16x32_bf16 v[16:19], v[20:23], v[48:51], 0
s_waitcnt vmcnt(7)
v_cvt_pk_bf16_f32 v53, v44, v45
v_mov_b64 v[54:55], s[46:47]
v_mfma_f32_16x16x32_bf16 v[12:15], v[60:63], v[48:51], 0
v_cvt_pk_bf16_f32 v52, v44, v45
v_cvt_pk_bf16_f32 v24, v24, v25
v_cvt_pk_bf16_f32 v25, v26, v27
v_mfma_f32_16x16x16_bf16 v[16:19], v[54:55], v[52:53], v[16:19]
s_min_u32 s34, s34, s32
v_cvt_pk_bf16_f32 v26, v28, v29
v_cvt_pk_bf16_f32 v27, v30, v31
v_mfma_f32_16x16x16_bf16 v[8:11], v[24:25], v[52:53], v[8:11]
ds_read_b128 v[28:31], v0 offset:56320
v_mov_b64 v[42:43], 0
v_mfma_f32_16x16x16_bf16 v[12:15], v[26:27], v[52:53], v[12:15]
s_waitcnt vmcnt(4)
v_bfe_u32 v32, v0, 5, 1
v_mov_b64 v[36:37], 0
v_subrev_u32 v17, s37, v16
v_rcp_f32 v18, v16
v_lshl_add_u32 v32, v32, 3, v5
v_mov_b64 v[38:39], 0
v_cmp_lt_u32 vcc, s38, v17
v_cndmask_b32 v9, v13, v9, s[42:43]
v_cndmask_b32 v8, v12, v8, s[42:43]
v_cndmask_b32 v10, v14, v10, s[42:43]
v_mul_f32 v10, v10, v18
v_cndmask_b32 v11, v15, v11, s[42:43]
v_mul_f32 v9, v9, v18
v_mul_f32 v8, v8, v18
v_mul_f32 v11, v11, v18
v_cvt_pk_bf16_f32 v12, v8, v9
v_cvt_pk_bf16_f32 v13, v10, v11
s_cbranch_vccnz rare_10052
back_10053:
ds_write_b64 v32, v[12:13] offset:1536
v_mov_b32_dpp v9, v13 quad_perm:[0,1,0,1] row_mask:0xf bank_mask:0xf
v_mov_b32_dpp v10, v12 quad_perm:[2,3,2,3] row_mask:0xf bank_mask:0xf
v_mov_b32_dpp v8, v12 quad_perm:[0,1,0,1] row_mask:0xf bank_mask:0xf
v_mov_b32_dpp v11, v13 quad_perm:[2,3,2,3] row_mask:0xf bank_mask:0xf
v_mov_b64 v[54:55], 0
v_mov_b64 v[52:53], 0
v_smfmac_f32_16x16x64_bf16 v[36:39], v[8:11], v[64:71], v1
s_waitcnt vmcnt(2)
ds_read_b128 v[20:23], v0 offset:54272
global_load_dwordx4 v[64:67], v0, s[76:77] offset:-4096 sc1
ds_read_b128 v[16:19], v0 offset:53248
v_mov_b64 v[34:35], 0
v_mov_b64 v[32:33], 0
v_mov_b64 v[40:41], 0
v_smfmac_f32_16x16x64_bf16 v[52:55], v[8:11], v[176:183], v1
s_waitcnt lgkmcnt(2)
ds_read_b128 v[24:27], v0 offset:55296
s_barrier
ds_read_b128 v[56:59], v5 offset:1024
global_load_dwordx4 v[68:71], v0, s[76:77] offset:-3072 sc1
ds_read_b128 v[12:15], v5 offset:0
v_mov_b64 v[48:49], 0
v_smfmac_f32_16x16x64_bf16 v[40:43], v[8:11], v[72:79], v1
s_waitcnt vmcnt(2)
ds_read_b128 v[60:63], v5 offset:512
v_mov_b64 v[50:51], 0
v_smfmac_f32_16x16x64_bf16 v[32:35], v[8:11], v[80:87], v1
global_load_dwordx4 v[72:75], v0, s[76:77] offset:-2048 sc1
ds_read_b128 v[80:83], v0 offset:57344
v_smfmac_f32_16x16x64_bf16 v[48:51], v[8:11], v[168:175], v1
s_waitcnt lgkmcnt(5)
s_waitcnt lgkmcnt(3)
ds_read_b128 v[84:87], v0 offset:58368
v_smfmac_f32_16x16x64_bf16 v[40:43], v[56:59], v[192:199], v1
global_load_dwordx4 v[76:79], v0, s[76:77] offset:-1024 sc1
v_smfmac_f32_16x16x64_bf16 v[36:39], v[56:59], v[16:23], v1
s_waitcnt lgkmcnt(2)
ds_read_b128 v[20:23], v0 offset:60416
v_lshrrev_b32 v44, 8, v0
v_smfmac_f32_16x16x64_bf16 v[36:39], v[60:63], v[24:31], v1
ds_read_b128 v[16:19], v0 offset:59392
v_bfe_u32 v45, v0, 1, 7
v_smfmac_f32_16x16x64_bf16 v[36:39], v[12:15], v[184:191], v1
s_waitcnt lgkmcnt(3)
ds_read_b128 v[28:31], v0 offset:62464
s_waitcnt lgkmcnt(3)
v_smfmac_f32_16x16x64_bf16 v[40:43], v[60:63], v[80:87], v1
ds_read_b128 v[24:27], v0 offset:61440
v_lshl_or_b32 v44, v44, 12, v45
v_smfmac_f32_16x16x64_bf16 v[40:43], v[12:15], v[200:207], v1
ds_read_b128 v[80:83], v0 offset:63488
v_cvt_pk_bf16_f32 v36, v36, v37
v_smfmac_f32_16x16x64_bf16 v[32:35], v[56:59], v[232:239], v1
ds_read_b128 v[84:87], v0 offset:64512
v_cvt_pk_bf16_f32 v37, v38, v39
v_and_or_b32 v36, v36, -2, s18
v_smfmac_f32_16x16x64_bf16 v[52:55], v[56:59], v[216:223], v1
global_store_dwordx2 v44, v[36:37], s[48:49]
s_waitcnt lgkmcnt(3)
v_cvt_pk_bf16_f32 v40, v40, v41
v_smfmac_f32_16x16x64_bf16 v[48:51], v[56:59], v[16:23], v1
s_waitcnt lgkmcnt(2)
s_waitcnt lgkmcnt(1)
v_and_or_b32 v40, v40, -2, s18
v_smfmac_f32_16x16x64_bf16 v[48:51], v[60:63], v[24:31], v1
v_cvt_pk_bf16_f32 v41, v42, v43
v_smfmac_f32_16x16x64_bf16 v[48:51], v[12:15], v[208:215], v1
s_waitcnt lgkmcnt(0)
global_store_dwordx2 v44, v[40:41], s[50:51]
v_smfmac_f32_16x16x64_bf16 v[32:35], v[60:63], v[240:247], v1
s_nop 1
v_smfmac_f32_16x16x64_bf16 v[52:55], v[60:63], v[80:87], v1
s_add_u32 s27, s20, 524288
s_add_u32 s58, s4, s20
v_cvt_pk_bf16_f32 v48, v48, v49
v_and_or_b32 v48, v48, -2, s18
v_cvt_pk_bf16_f32 v49, v50, v51
v_smfmac_f32_16x16x64_bf16 v[52:55], v[12:15], v[224:231], v1
s_nop 0
global_store_dwordx2 v44, v[48:49], s[52:53]
s_addc_u32 s59, s5, 0
s_mov_b32 s30, 0
v_smfmac_f32_16x16x64_bf16 v[32:35], v[12:15], v[248:255], v1
s_nop 2
v_cvt_pk_bf16_f32 v52, v52, v53
v_cvt_pk_bf16_f32 v53, v54, v55
s_mov_b32 s19, 1
v_and_or_b32 v52, v52, -2, s18
global_store_dwordx2 v44, v[52:53], s[54:55]
v_cvt_pk_bf16_f32 v32, v32, v33
v_cvt_pk_bf16_f32 v33, v34, v35
v_and_or_b32 v32, v32, -2, s18
global_store_dwordx2 v44, v[32:33], s[56:57]
nored_10059:
v_cmp_gt_u32 vcc, s34, v7
s_cmp_eq_u32 vcc_hi, 0
s_cbranch_scc1 kv_10063
s_mov_b32 s30, 0
kv_10062:
v_and_b32 v7, 128, v0
buffer_load_dword v7, v7, s[4:7], s22 offen sc1
s_add_u32 s30, s30, 1
s_cmp_gt_u32 s30, 262144
s_cbranch_scc1 L_fail
s_waitcnt vmcnt(0)
v_cmp_gt_u32 vcc, s34, v7
s_cbranch_vccnz kv_10062
kv_10063:
v_and_b32 v7, 128, v0
v_add_u32 v7, s22, v7
s_mov_b32 exec_hi, 0
v_and_b32 v7, 255, v0
v_lshl_add_u32 v7, v7, 3, s27
s_mov_b32 exec_hi, -1
s_nop 15
s_nop 15
s_nop 15
s_nop 15
s_nop 15
s_nop 1
global_load_dwordx4 v[56:59], v0, s[76:77] offset:0 sc1
global_load_dwordx4 v[60:63], v0, s[76:77] offset:1024 sc1
global_load_dwordx4 v[80:83], v0, s[76:77] offset:2048 sc1
global_load_dwordx4 v[84:87], v0, s[76:77] offset:3072 sc1
join_10060:
s_barrier
s_nop 15
s_nop 15
s_nop 7
s_barrier
global_load_dwordx4 v[32:35], v0, s[68:69] offset:-4096 sc1
s_nop 10
global_load_dwordx4 v[36:39], v0, s[68:69] offset:0 sc1
s_barrier
global_load_dwordx4 v[48:51], v0, s[58:59] offset:0 nt sc1
global_load_dwordx4 v[52:55], v0, s[58:59] offset:1024 nt sc1
v_mov_b64 v[8:9], 0
v_mov_b64 v[10:11], 0
v_mov_b64 v[12:13], 0
v_mov_b64 v[14:15], 0
v_mov_b64 v[16:17], 0
v_mov_b64 v[18:19], 0
v_mov_b64 v[20:21], 0
v_mov_b64 v[22:23], 0
v_mov_b64 v[24:25], 0
v_mov_b64 v[26:27], 0
v_mov_b64 v[28:29], 0
v_mov_b64 v[30:31], 0
s_mov_b32 s30, 0
s_cmp_eq_u32 s17, s31
s_cbranch_scc0 gather_10051
s_branch exit_10054
rt_10056:
global_load_dwordx4 v[32:35], v0, s[68:69] offset:-4096 sc1
global_load_dwordx4 v[36:39], v0, s[68:69] offset:0 sc1
s_add_u32 s30, s30, 1
s_cmp_gt_u32 s30, 262144
s_cbranch_scc1 L_fail
s_mov_b64 exec, 1
global_store_dword v0, v0, s[62:63]
global_store_dword v0, v0, s[62:63]
s_mov_b64 exec, -1
v_mov_b64 v[8:9], 0
v_mov_b64 v[10:11], 0
v_mov_b64 v[12:13], 0
v_mov_b64 v[14:15], 0
v_mov_b64 v[16:17], 0
v_mov_b64 v[18:19], 0
v_mov_b64 v[20:21], 0
v_mov_b64 v[22:23], 0
v_mov_b64 v[24:25], 0
v_mov_b64 v[26:27], 0
v_mov_b64 v[28:29], 0
v_mov_b64 v[30:31], 0
s_branch gather_10051
rare_10052:
ds_read_b128 v[48:51], v6 offset:6144
ds_read_b128 v[52:55], v6 offset:7168
s_waitcnt lgkmcnt(0)
v_add_f32 v48, v48, v52
v_add_f32 v49, v49, v53
v_add_f32 v50, v50, v54
v_add_f32 v51, v51, v55
v_mov_b32_dpp v46, v46 quad_perm:[0,1,0,1] row_mask:0xf bank_mask:0xf
v_mov_b32_dpp v47, v47 quad_perm:[0,1,0,1] row_mask:0xf bank_mask:0xf
v_max3_f32 v19, v48, v49, v50
v_max3_f32 v19, v19, v51, v46
v_max_f32 v19, v19, v47
s_nop 1
v_max_f32_dpp v19, v19, v19 quad_perm:[2,3,0,1] row_mask:0xf bank_mask:0xf
v_mov_b32 v44, v19
s_nop 1
v_permlane32_swap_b32 v19, v44
v_max_f32 v19, v19, v44
v_mov_b32 v44, v19
s_nop 1
v_permlane16_swap_b32 v19, v44
v_max_f32 v19, v19, v44
v_sub_f32 v48, v48, v19
v_sub_f32 v49, v49, v19
v_sub_f32 v50, v50, v19
v_sub_f32 v51, v51, v19
v_sub_f32 v46, v46, v19
v_sub_f32 v47, v47, v19
v_exp_f32 v48, v48
v_exp_f32 v49, v49
v_exp_f32 v50, v50
v_exp_f32 v51, v51
v_cvt_pk_bf16_f32 v54, v48, v49
v_cvt_pk_bf16_f32 v55, v50, v51
s_nop 0
v_mov_b32_dpp v48, v54 quad_perm:[0,1,0,1] row_mask:0xf bank_mask:0xf
v_mov_b32_dpp v49, v55 quad_perm:[0,1,0,1] row_mask:0xf bank_mask:0xf
v_mov_b32_dpp v50, v54 quad_perm:[2,3,2,3] row_mask:0xf bank_mask:0xf
v_mov_b32_dpp v51, v55 quad_perm:[2,3,2,3] row_mask:0xf bank_mask:0xf
v_mov_b64 v[20:21], s[44:45]
v_mov_b64 v[22:23], s[44:45]
v_mfma_f32_16x16x32_bf16 v[8:11], v[56:59], v[48:51], 0
v_mfma_f32_16x16x32_bf16 v[12:15], v[60:63], v[48:51], 0
v_mfma_f32_16x16x32_bf16 v[16:19], v[20:23], v[48:51], 0
v_mov_b64 v[54:55], s[46:47]
v_exp_f32_dpp v44, v46 quad_perm:[0,1,0,1] row_mask:0xf bank_mask:0xf
v_exp_f32_dpp v45, v47 quad_perm:[0,1,0,1] row_mask:0xf bank_mask:0xf
s_nop 0
v_cvt_pk_bf16_f32 v52, v44, v45
v_cvt_pk_bf16_f32 v53, v44, v45
s_nop 1
v_mfma_f32_16x16x16_bf16 v[16:19], v[54:55], v[52:53], v[16:19]
v_mfma_f32_16x16x16_bf16 v[8:11], v[24:25], v[52:53], v[8:11]
v_mfma_f32_16x16x16_bf16 v[12:15], v[26:27], v[52:53], v[12:15]
s_nop 5
v_rcp_f32 v18, v16
s_nop 0
v_cndmask_b32 v8, v12, v8, s[42:43]
v_mul_f32 v8, v8, v18
v_cndmask_b32 v9, v13, v9, s[42:43]
v_mul_f32 v9, v9, v18
v_cndmask_b32 v10, v14, v10, s[42:43]
v_mul_f32 v10, v10, v18
v_cndmask_b32 v11, v15, v11, s[42:43]
v_mul_f32 v11, v11, v18
v_cvt_pk_bf16_f32 v12, v8, v9
v_cvt_pk_bf16_f32 v13, v10, v11
s_branch back_10053
exit_10054:
global_load_dwordx4 v[32:35], v0, s[68:69] offset:-4096 sc1
global_load_dwordx4 v[36:39], v0, s[68:69] offset:0 sc1
s_add_u32 s30, s30, 1
s_cmp_gt_u32 s30, 262144
s_cbranch_scc1 L_fail
s_waitcnt vmcnt(1)
v_bitop3_b32 v44, v32, v34, s18 bitop3:0x7e
s_waitcnt vmcnt(0)
v_bitop3_b32 v45, v36, v38, s18 bitop3:0x7e
v_bitop3_b32 v44, v44, v45, s19 bitop3:0xa8
v_cmp_ne_u32 vcc, 0, v44
s_cbranch_vccnz exit_10054
s_add_u32 s36, s36, 1
s_cmp_lt_u32 s36, 2
s_cbranch_scc1 layer_10050
s_endpgm
grp_10001:
s_bfm_b32 s24, s14, 0
s_and_b32 s24, s24, 0xaaaaaaaa
s_bcnt1_i32_b32 s24, s24
v_and_b32 v64, 63, v0
v_and_b32 v65, 15, v64
v_lshrrev_b32 v66, 4, v64
v_lshlrev_b32 v0, 4, v64
v_and_b32 v67, 2, v64
v_mov_b32 v68, 0x4444
v_mov_b32 v69, 0xeeee
v_cmp_eq_u32 vcc, 0, v67
s_nop 1
v_cndmask_b32 v1, v69, v68, vcc
s_mul_i32 s26, s13, 24576
s_add_u32 s26, s26, 65536
v_add_u32 v2, s26, v0
v_lshrrev_b32 v67, 2, v65
v_xor_b32 v68, v66, v67
v_lshlrev_b32 v68, 3, v68
v_lshl_add_u32 v68, v65, 5, v68
s_lshl_b32 s26, s13, 10
s_add_u32 s26, s26, 10240
v_add_u32 v3, s26, v68
v_lshl_add_u32 v68, v66, 2, v67
v_and_b32 v69, 3, v65
v_xor_b32 v69, v69, v66
v_lshlrev_b32 v69, 3, v69
v_lshl_add_u32 v68, v68, 5, v69
v_add_u32 v4, 10240, v68
v_and_b32 v69, 1, v65
v_lshl_add_u32 v68, v67, 1, v69
v_lshlrev_b32 v68, 4, v68
v_lshl_add_u32 v68, v66, 7, v68
v_add_u32 v5, 8192, v68
v_bfe_u32 v69, v65, 1, 1
v_mul_u32_u24 v69, 640, v69
v_xor_b32 v6, v69, v5
s_mov_b32 s42, 0x33333333
s_mov_b32 s43, 0x33333333
s_mov_b32 s44, 0x3f803f80
s_mov_b32 s45, 0x3f803f80
s_mov_b32 s46, 0x3f803f80
s_mov_b32 s47, 0
s_mov_b32 s37, 729808896
s_mov_b32 s38, 671088640
v_lshlrev_b32 v68, 3, v65
v_lshl_add_u32 v7, v66, 12, v68
s_lshl_b32 s26, s13, 14
s_lshl_b32 s27, s14, 7
s_add_u32 s26, s26, s27
s_add_u32 s90, s26, 65536
s_lshl_b32 s26, s13, 5
s_add_u32 s93, s26, s14
s_lshl_b32 s26, s93, 12
s_add_u32 s91, s26, 65536
s_lshr_b32 s26, s93, 2
s_lshl_b32 s26, s26, 9
s_and_b32 s27, s93, 3
s_lshl_b32 s27, s27, 6
s_add_u32 s26, s26, s27
s_add_u32 s92, s26, 393216
s_lshl_b32 s26, s14, 8
s_add_u32 s22, s26, 11534336
s_lshl_b32 s26, s24, 7
s_add_u32 s26, s26, 11550720
s_cmp_lt_u32 s24, 10
s_cselect_b32 s23, s26, 268435456
s_cselect_b32 s24, s24, 0
s_cselect_b32 s25, 12582912, s23
s_lshl_b32 s24, s24, 10
s_and_b32 s26, s14, 0
s_lshl_b32 s26, s26, 12
s_add_u32 s94, s26, 425984
s_lshl_b32 s26, s14, 7
s_add_u32 s95, s26, 425984
s_mov_b32 s35, 0x3e0293ee
s_lshl_b32 s26, s14, 2
s_add_u32 s26, s26, s13
s_mul_i32 s27, s26, 18432
s_add_u32 s89, s27, 1048576
s_add_u32 s48, s4, s90
s_addc_u32 s49, s5, 0
s_add_u32 s50, s90, 65536
s_add_u32 s50, s4, s50
s_addc_u32 s51, s5, 0
s_add_u32 s52, s90, 131072
s_add_u32 s52, s4, s52
s_addc_u32 s53, s5, 0
s_add_u32 s54, s90, 196608
s_add_u32 s54, s4, s54
s_addc_u32 s55, s5, 0
s_add_u32 s56, s90, 262144
s_add_u32 s56, s4, s56
s_addc_u32 s57, s5, 0
s_add_u32 s76, s89, 4096
s_add_u32 s76, s4, s76
s_addc_u32 s77, s5, 0
s_add_u32 s78, s89, 12288
s_add_u32 s78, s4, s78
s_addc_u32 s79, s5, 0
s_add_u32 s80, s89, 20480
s_add_u32 s80, s4, s80
s_addc_u32 s81, s5, 0
s_add_u32 s60, s4, s94
s_addc_u32 s61, s5, 0
s_add_u32 s62, s4, s95
s_addc_u32 s63, s5, 0
s_add_u32 s64, s4, s91
s_addc_u32 s65, s5, 0
s_add_u32 s66, s4, s92
s_addc_u32 s67, s5, 0
v_mov_b32 v72, 0
v_mov_b32 v73, 0
s_mov_b32 s26, s90
buffer_store_dwordx2 v[72:73], v7, s[4:7], s26 offen
s_add_u32 s26, s26, 65536
buffer_store_dwordx2 v[72:73], v7, s[4:7], s26 offen
s_add_u32 s26, s26, 65536
buffer_store_dwordx2 v[72:73], v7, s[4:7], s26 offen
s_add_u32 s26, s26, 65536
buffer_store_dwordx2 v[72:73], v7, s[4:7], s26 offen
s_add_u32 s26, s26, 65536
buffer_store_dwordx2 v[72:73], v7, s[4:7], s26 offen
s_add_u32 s26, s26, 65536
buffer_store_dword v72, off, s[4:7], s95 offset:0
s_load_dwordx2 s[96:97], s[0:1], 32
s_mov_b32 s98, 10240
s_mov_b32 s99, 0x20000
s_cmp_ge_u32 s93, 80
s_cbranch_scc1 nm0_10065
s_and_b32 s26, s93, 3
s_mul_i32 s26, s26, 2560
s_lshr_b32 s27, s93, 2
s_lshl_b32 s27, s27, 6
s_add_u32 s26, s26, s27
v_bfe_u32 v68, v65, 1, 2
v_lshlrev_b32 v68, 4, v68
v_and_b32 v69, 1, v65
v_lshl_add_u32 v68, v69, 2, v68
v_and_b32 v69, 1, v66
v_mul_u32_u24 v69, 1280, v69
v_add_u32 v68, v68, v69
s_waitcnt lgkmcnt(0)
buffer_load_dword v74, v68, s[96:99], s26 offen
buffer_load_dword v75, v68, s[96:99], s26 offen offset:8
v_and_b32 v68, 32, v0
v_bfe_u32 v69, v0, 6, 1
v_lshl_add_u32 v68, v69, 8, v68
v_bfe_u32 v69, v0, 8, 1
v_lshl_add_u32 v68, v69, 4, v68
v_bfe_u32 v69, v0, 4, 1
v_lshl_add_u32 v68, v69, 3, v68
s_add_u32 s27, s92, 16384
buffer_store_dwordx2 v[72:73], v68, s[4:7], s92 offen
s_waitcnt vmcnt(1)
buffer_store_dwordx2 v[74:75], v68, s[4:7], s27 offen
nm0_10065:
s_waitcnt vmcnt(0) lgkmcnt(0)
s_barrier
s_cmp_eq_u32 s13, 0
s_cselect_b32 s26, 144, s10
v_mov_b32 v74, 1
s_mov_b64 exec, 1
buffer_atomic_add v74, off, s[8:11], s26
s_mov_b64 exec, -1
v_lshrrev_b32 v67, 3, v64
v_and_b32 v68, 7, v64
v_lshlrev_b32 v68, 4, v68
v_lshl_add_u32 v32, v67, 13, v68
v_mul_u32_u24 v67, 1280, v67
v_add_u32 v36, v67, v68
v_lshrrev_b32 v67, 1, v66
v_lshlrev_b32 v67, 4, v67
v_and_b32 v68, 1, v66
v_lshl_add_u32 v67, v68, 1, v67
v_lshrrev_b32 v68, 3, v65
v_lshl_add_u32 v67, v68, 3, v67
v_bfe_u32 v68, v65, 2, 1
v_add_u32 v67, v67, v68
v_and_b32 v69, 3, v65
v_lshlrev_b32 v40, 4, v69
v_lshl_add_u32 v40, v67, 7, v40
v_lshl_add_u32 v67, v66, 2, v68
v_lshlrev_b32 v42, 4, v69
v_lshl_add_u32 v42, v67, 7, v42
v_lshrrev_b32 v68, 3, v65
v_lshl_add_u32 v42, v68, 3, v42
s_lshl_b32 s29, s13, 12
s_and_b32 s26, s13, 1
s_lshl_b32 s26, s26, 6
s_add_u32 s26, s26, s29
v_add_u32 v40, s26, v40
v_add_u32 v42, s26, v42
v_xor_b32 v41, 4096, v40
v_xor_b32 v43, 4096, v42
v_add_u32 v33, 64512, v32
v_add_u32 v37, 9216, v36
v_add_u32 v34, 129024, v32
v_add_u32 v38, 18432, v36
v_add_u32 v35, 193536, v32
v_add_u32 v39, 27648, v36
s_lshr_b32 s28, s13, 1
s_lshl_b32 s28, s28, 7
s_lshl_b32 s27, s14, 8
s_add_u32 s27, s27, s28
s_xor_b32 s26, s13, 0
s_lshl_b32 s82, s26, 19
s_add_u32 s82, s82, s27
s_lshl_b32 s85, s14, 2
s_add_u32 s85, s85, s26
s_mul_i32 s85, s85, 40960
s_add_u32 s85, s85, s28
s_xor_b32 s26, s13, 2
s_lshl_b32 s83, s26, 19
s_add_u32 s83, s83, s27
s_lshl_b32 s86, s14, 2
s_add_u32 s86, s86, s26
s_mul_i32 s86, s86, 40960
s_add_u32 s86, s86, s28
s_and_b32 s26, s13, 1
s_add_u32 s26, s26, 8
s_lshl_b32 s84, s26, 19
s_add_u32 s84, s84, s27
s_load_dwordx2 s[68:69], s[0:1], 40
s_load_dwordx2 s[70:71], s[0:1], 48
s_load_dwordx2 s[72:73], s[0:1], 56
s_load_dwordx2 s[74:75], s[0:1], 64
s_mov_b32 s98, 5242880
s_waitcnt lgkmcnt(0)
s_mov_b64 s[96:97], s[70:71]
s_add_u32 m0, s29, 0
s_add_u32 s26, s82, 0
buffer_load_dwordx4 v32, s[96:99], s26 offen offset:0 lds
buffer_load_dwordx4 v33, s[96:99], s26 offen offset:1024 lds
buffer_load_dwordx4 v34, s[96:99], s26 offen offset:2048 lds
buffer_load_dwordx4 v35, s[96:99], s26 offen offset:3072 lds
s_add_u32 m0, s29, 16384
s_add_u32 s26, s82, 262144
buffer_load_dwordx4 v32, s[96:99], s26 offen offset:0 lds
buffer_load_dwordx4 v33, s[96:99], s26 offen offset:1024 lds
buffer_load_dwordx4 v34, s[96:99], s26 offen offset:2048 lds
buffer_load_dwordx4 v35, s[96:99], s26 offen offset:3072 lds
s_add_u32 m0, s29, 32768
s_add_u32 s26, s82, 2097152
buffer_load_dwordx4 v32, s[96:99], s26 offen offset:0 lds
buffer_load_dwordx4 v33, s[96:99], s26 offen offset:1024 lds
buffer_load_dwordx4 v34, s[96:99], s26 offen offset:2048 lds
buffer_load_dwordx4 v35, s[96:99], s26 offen offset:3072 lds
s_waitcnt vmcnt(8)
s_barrier
s_add_u32 m0, s29, 49152
s_add_u32 s26, s82, 2359296
buffer_load_dwordx4 v32, s[96:99], s26 offen offset:0 lds
buffer_load_dwordx4 v33, s[96:99], s26 offen offset:1024 lds
buffer_load_dwordx4 v34, s[96:99], s26 offen offset:2048 lds
buffer_load_dwordx4 v35, s[96:99], s26 offen offset:3072 lds
ds_read_b64_tr_b16 v[72:73], v40 offset:0
ds_read_b64_tr_b16 v[74:75], v40 offset:512
ds_read_b64_tr_b16 v[76:77], v40 offset:8
ds_read_b64_tr_b16 v[78:79], v40 offset:520
ds_read_b64_tr_b16 v[80:81], v41 offset:0
ds_read_b64_tr_b16 v[82:83], v41 offset:512
ds_read_b64_tr_b16 a[128:129], v41 offset:8
ds_read_b64_tr_b16 a[130:131], v41 offset:520
s_waitcnt lgkmcnt(6)
global_store_dwordx4 v0, v[72:75], s[76:77] offset:0
s_waitcnt lgkmcnt(4)
global_store_dwordx4 v0, v[76:79], s[76:77] offset:2048
s_waitcnt lgkmcnt(2)
ds_write_b128 v2, v[80:83] offset:12288
s_waitcnt vmcnt(10) lgkmcnt(1)
s_barrier
s_add_u32 m0, s29, 0
s_add_u32 s26, s83, 0
buffer_load_dwordx4 v32, s[96:99], s26 offen offset:0 lds
buffer_load_dwordx4 v33, s[96:99], s26 offen offset:1024 lds
buffer_load_dwordx4 v34, s[96:99], s26 offen offset:2048 lds
buffer_load_dwordx4 v35, s[96:99], s26 offen offset:3072 lds
ds_read_b64_tr_b16 v[72:73], v40 offset:16384
ds_read_b64_tr_b16 v[74:75], v40 offset:16896
ds_read_b64_tr_b16 v[76:77], v40 offset:16392
ds_read_b64_tr_b16 v[78:79], v40 offset:16904
ds_read_b64_tr_b16 v[80:81], v41 offset:16384
ds_read_b64_tr_b16 v[82:83], v41 offset:16896
ds_read_b64_tr_b16 a[132:133], v41 offset:16392
ds_read_b64_tr_b16 a[134:135], v41 offset:16904
s_waitcnt lgkmcnt(6)
global_store_dwordx4 v0, v[72:75], s[76:77] offset:1024
s_waitcnt lgkmcnt(4)
global_store_dwordx4 v0, v[76:79], s[76:77] offset:3072
s_waitcnt lgkmcnt(2)
ds_write_b128 v2, v[80:83] offset:13312
s_waitcnt vmcnt(12) lgkmcnt(1)
s_barrier
s_add_u32 m0, s29, 16384
s_add_u32 s26, s83, 262144
buffer_load_dwordx4 v32, s[96:99], s26 offen offset:0 lds
buffer_load_dwordx4 v33, s[96:99], s26 offen offset:1024 lds
buffer_load_dwordx4 v34, s[96:99], s26 offen offset:2048 lds
buffer_load_dwordx4 v35, s[96:99], s26 offen offset:3072 lds
ds_read_b64_tr_b16 a[32:33], v40 offset:32768
ds_read_b64_tr_b16 a[34:35], v40 offset:33280
ds_read_b64_tr_b16 a[40:41], v40 offset:32776
ds_read_b64_tr_b16 a[42:43], v40 offset:33288
ds_read_b64_tr_b16 a[136:137], v41 offset:32768
ds_read_b64_tr_b16 a[138:139], v41 offset:33280
ds_read_b64_tr_b16 v[84:85], v41 offset:32776
ds_read_b64_tr_b16 v[86:87], v41 offset:33288
s_waitcnt lgkmcnt(0)
ds_write_b128 v2, v[84:87] offset:14336
s_waitcnt vmcnt(12)
s_barrier
s_add_u32 m0, s29, 32768
s_add_u32 s26, s83, 2097152
buffer_load_dwordx4 v32, s[96:99], s26 offen offset:0 lds
buffer_load_dwordx4 v33, s[96:99], s26 offen offset:1024 lds
buffer_load_dwordx4 v34, s[96:99], s26 offen offset:2048 lds
buffer_load_dwordx4 v35, s[96:99], s26 offen offset:3072 lds
ds_read_b64_tr_b16 a[36:37], v40 offset:49152
ds_read_b64_tr_b16 a[38:39], v40 offset:49664
ds_read_b64_tr_b16 a[44:45], v40 offset:49160
ds_read_b64_tr_b16 a[46:47], v40 offset:49672
ds_read_b64_tr_b16 a[140:141], v41 offset:49152
ds_read_b64_tr_b16 a[142:143], v41 offset:49664
ds_read_b64_tr_b16 v[84:85], v41 offset:49160
ds_read_b64_tr_b16 v[86:87], v41 offset:49672
s_waitcnt lgkmcnt(0)
ds_write_b128 v2, v[84:87] offset:15360
s_waitcnt vmcnt(10)
s_barrier
s_add_u32 m0, s29, 49152
s_add_u32 s26, s83, 2359296
buffer_load_dwordx4 v32, s[96:99], s26 offen offset:0 lds
buffer_load_dwordx4 v33, s[96:99], s26 offen offset:1024 lds
buffer_load_dwordx4 v34, s[96:99], s26 offen offset:2048 lds
buffer_load_dwordx4 v35, s[96:99], s26 offen offset:3072 lds
ds_read_b64_tr_b16 a[144:145], v40 offset:0
ds_read_b64_tr_b16 a[146:147], v40 offset:512
ds_read_b64_tr_b16 a[152:153], v40 offset:8
ds_read_b64_tr_b16 a[154:155], v40 offset:520
ds_read_b64_tr_b16 a[160:161], v41 offset:0
ds_read_b64_tr_b16 a[162:163], v41 offset:512
ds_read_b64_tr_b16 a[168:169], v41 offset:8
ds_read_b64_tr_b16 a[170:171], v41 offset:520
s_waitcnt vmcnt(8) lgkmcnt(0)
s_barrier
s_add_u32 m0, s29, 0
s_add_u32 s26, s84, 0
buffer_load_dwordx4 v32, s[96:99], s26 offen offset:0 lds
buffer_load_dwordx4 v33, s[96:99], s26 offen offset:1024 lds
buffer_load_dwordx4 v34, s[96:99], s26 offen offset:2048 lds
buffer_load_dwordx4 v35, s[96:99], s26 offen offset:3072 lds
ds_read_b64_tr_b16 a[148:149], v40 offset:16384
ds_read_b64_tr_b16 a[150:151], v40 offset:16896
ds_read_b64_tr_b16 a[156:157], v40 offset:16392
ds_read_b64_tr_b16 a[158:159], v40 offset:16904
ds_read_b64_tr_b16 a[164:165], v41 offset:16384
ds_read_b64_tr_b16 a[166:167], v41 offset:16896
ds_read_b64_tr_b16 a[172:173], v41 offset:16392
ds_read_b64_tr_b16 a[174:175], v41 offset:16904
s_waitcnt vmcnt(8) lgkmcnt(0)
s_barrier
s_add_u32 m0, s29, 16384
s_add_u32 s26, s84, 262144
buffer_load_dwordx4 v32, s[96:99], s26 offen offset:0 lds
buffer_load_dwordx4 v33, s[96:99], s26 offen offset:1024 lds
buffer_load_dwordx4 v34, s[96:99], s26 offen offset:2048 lds
buffer_load_dwordx4 v35, s[96:99], s26 offen offset:3072 lds
ds_read_b64_tr_b16 v[72:73], v40 offset:32768
ds_read_b64_tr_b16 v[74:75], v40 offset:33280
ds_read_b64_tr_b16 v[76:77], v40 offset:32776
ds_read_b64_tr_b16 v[78:79], v40 offset:33288
ds_read_b64_tr_b16 a[176:177], v41 offset:32768
ds_read_b64_tr_b16 a[178:179], v41 offset:33280
ds_read_b64_tr_b16 v[84:85], v41 offset:32776
ds_read_b64_tr_b16 v[86:87], v41 offset:33288
s_waitcnt lgkmcnt(6)
global_store_dwordx4 v0, v[72:75], s[78:79] offset:0
s_waitcnt lgkmcnt(4)
ds_write_b128 v2, v[76:79] offset:16384
s_waitcnt lgkmcnt(1)
ds_write_b128 v2, v[84:87] offset:18432
s_waitcnt vmcnt(9)
s_barrier
s_mov_b64 s[96:97], s[72:73]
s_add_u32 m0, s29, 32768
s_add_u32 s26, s82, 0
buffer_load_dwordx4 v32, s[96:99], s26 offen offset:0 lds
buffer_load_dwordx4 v33, s[96:99], s26 offen offset:1024 lds
buffer_load_dwordx4 v34, s[96:99], s26 offen offset:2048 lds
buffer_load_dwordx4 v35, s[96:99], s26 offen offset:3072 lds
ds_read_b64_tr_b16 v[72:73], v40 offset:49152
ds_read_b64_tr_b16 v[74:75], v40 offset:49664
ds_read_b64_tr_b16 v[76:77], v40 offset:49160
ds_read_b64_tr_b16 v[78:79], v40 offset:49672
ds_read_b64_tr_b16 a[180:181], v41 offset:49152
ds_read_b64_tr_b16 a[182:183], v41 offset:49664
ds_read_b64_tr_b16 v[84:85], v41 offset:49160
ds_read_b64_tr_b16 v[86:87], v41 offset:49672
s_waitcnt lgkmcnt(6)
global_store_dwordx4 v0, v[72:75], s[78:79] offset:1024
s_waitcnt lgkmcnt(4)
ds_write_b128 v2, v[76:79] offset:17408
s_waitcnt lgkmcnt(1)
ds_write_b128 v2, v[84:87] offset:19456
s_waitcnt vmcnt(10)
s_barrier
s_add_u32 m0, s29, 49152
s_add_u32 s26, s82, 262144
buffer_load_dwordx4 v32, s[96:99], s26 offen offset:0 lds
buffer_load_dwordx4 v33, s[96:99], s26 offen offset:1024 lds
buffer_load_dwordx4 v34, s[96:99], s26 offen offset:2048 lds
buffer_load_dwordx4 v35, s[96:99], s26 offen offset:3072 lds
ds_read_b64_tr_b16 a[184:185], v40 offset:0
ds_read_b64_tr_b16 a[186:187], v40 offset:512
ds_read_b64_tr_b16 a[192:193], v40 offset:8
ds_read_b64_tr_b16 a[194:195], v40 offset:520
ds_read_b64_tr_b16 a[200:201], v41 offset:0
ds_read_b64_tr_b16 a[202:203], v41 offset:512
ds_read_b64_tr_b16 a[208:209], v41 offset:8
ds_read_b64_tr_b16 a[210:211], v41 offset:520
s_waitcnt vmcnt(10) lgkmcnt(0)
s_barrier
s_add_u32 m0, s29, 0
s_add_u32 s26, s82, 2097152
buffer_load_dwordx4 v32, s[96:99], s26 offen offset:0 lds
buffer_load_dwordx4 v33, s[96:99], s26 offen offset:1024 lds
buffer_load_dwordx4 v34, s[96:99], s26 offen offset:2048 lds
buffer_load_dwordx4 v35, s[96:99], s26 offen offset:3072 lds
ds_read_b64_tr_b16 a[188:189], v40 offset:16384
ds_read_b64_tr_b16 a[190:191], v40 offset:16896
ds_read_b64_tr_b16 a[196:197], v40 offset:16392
ds_read_b64_tr_b16 a[198:199], v40 offset:16904
ds_read_b64_tr_b16 a[204:205], v41 offset:16384
ds_read_b64_tr_b16 a[206:207], v41 offset:16896
ds_read_b64_tr_b16 a[212:213], v41 offset:16392
ds_read_b64_tr_b16 a[214:215], v41 offset:16904
s_waitcnt vmcnt(9) lgkmcnt(0)
s_barrier
s_add_u32 m0, s29, 16384
s_add_u32 s26, s82, 2359296
buffer_load_dwordx4 v32, s[96:99], s26 offen offset:0 lds
buffer_load_dwordx4 v33, s[96:99], s26 offen offset:1024 lds
buffer_load_dwordx4 v34, s[96:99], s26 offen offset:2048 lds
buffer_load_dwordx4 v35, s[96:99], s26 offen offset:3072 lds
ds_read_b64_tr_b16 a[0:1], v40 offset:32768
ds_read_b64_tr_b16 a[2:3], v40 offset:33280
ds_read_b64_tr_b16 a[8:9], v40 offset:32776
ds_read_b64_tr_b16 a[10:11], v40 offset:33288
ds_read_b64_tr_b16 a[240:241], v41 offset:32768
ds_read_b64_tr_b16 a[242:243], v41 offset:33280
ds_read_b64_tr_b16 a[248:249], v41 offset:32776
ds_read_b64_tr_b16 a[250:251], v41 offset:33288
s_waitcnt vmcnt(8) lgkmcnt(0)
s_barrier
s_add_u32 m0, s29, 32768
s_add_u32 s26, s83, 0
buffer_load_dwordx4 v32, s[96:99], s26 offen offset:0 lds
buffer_load_dwordx4 v33, s[96:99], s26 offen offset:1024 lds
buffer_load_dwordx4 v34, s[96:99], s26 offen offset:2048 lds
buffer_load_dwordx4 v35, s[96:99], s26 offen offset:3072 lds
ds_read_b64_tr_b16 a[4:5], v40 offset:49152
ds_read_b64_tr_b16 a[6:7], v40 offset:49664
ds_read_b64_tr_b16 a[12:13], v40 offset:49160
ds_read_b64_tr_b16 a[14:15], v40 offset:49672
ds_read_b64_tr_b16 a[244:245], v41 offset:49152
ds_read_b64_tr_b16 a[246:247], v41 offset:49664
ds_read_b64_tr_b16 a[252:253], v41 offset:49160
ds_read_b64_tr_b16 a[254:255], v41 offset:49672
s_waitcnt vmcnt(8) lgkmcnt(0)
s_barrier
s_add_u32 m0, s29, 49152
s_add_u32 s26, s83, 262144
buffer_load_dwordx4 v32, s[96:99], s26 offen offset:0 lds
buffer_load_dwordx4 v33, s[96:99], s26 offen offset:1024 lds
buffer_load_dwordx4 v34, s[96:99], s26 offen offset:2048 lds
buffer_load_dwordx4 v35, s[96:99], s26 offen offset:3072 lds
ds_read_b64_tr_b16 v[72:73], v40 offset:0
ds_read_b64_tr_b16 v[74:75], v40 offset:512
ds_read_b64_tr_b16 v[76:77], v40 offset:8
ds_read_b64_tr_b16 v[78:79], v40 offset:520
ds_read_b64_tr_b16 v[80:81], v41 offset:0
ds_read_b64_tr_b16 v[82:83], v41 offset:512
ds_read_b64_tr_b16 v[88:89], v41 offset:8
ds_read_b64_tr_b16 v[90:91], v41 offset:520
s_waitcnt lgkmcnt(6)
ds_write_b128 v2, v[72:75] offset:0
s_waitcnt lgkmcnt(5)
ds_write_b128 v2, v[76:79] offset:2048
s_waitcnt lgkmcnt(4)
global_store_dwordx4 v0, v[80:83], s[78:79] offset:2048
s_waitcnt vmcnt(9) lgkmcnt(2)
s_barrier
s_add_u32 m0, s29, 0
s_add_u32 s26, s83, 2097152
buffer_load_dwordx4 v32, s[96:99], s26 offen offset:0 lds
buffer_load_dwordx4 v33, s[96:99], s26 offen offset:1024 lds
buffer_load_dwordx4 v34, s[96:99], s26 offen offset:2048 lds
buffer_load_dwordx4 v35, s[96:99], s26 offen offset:3072 lds
ds_read_b64_tr_b16 v[72:73], v40 offset:16384
ds_read_b64_tr_b16 v[74:75], v40 offset:16896
ds_read_b64_tr_b16 v[76:77], v40 offset:16392
ds_read_b64_tr_b16 v[78:79], v40 offset:16904
ds_read_b64_tr_b16 v[80:81], v41 offset:16384
ds_read_b64_tr_b16 v[82:83], v41 offset:16896
ds_read_b64_tr_b16 v[92:93], v41 offset:16392
ds_read_b64_tr_b16 v[94:95], v41 offset:16904
s_waitcnt lgkmcnt(6)
ds_write_b128 v2, v[72:75] offset:1024
s_waitcnt lgkmcnt(5)
ds_write_b128 v2, v[76:79] offset:3072
s_waitcnt lgkmcnt(4)
global_store_dwordx4 v0, v[80:83], s[78:79] offset:3072
s_waitcnt vmcnt(10) lgkmcnt(2)
s_barrier
s_add_u32 m0, s29, 16384
s_add_u32 s26, s83, 2359296
buffer_load_dwordx4 v32, s[96:99], s26 offen offset:0 lds
buffer_load_dwordx4 v33, s[96:99], s26 offen offset:1024 lds
buffer_load_dwordx4 v34, s[96:99], s26 offen offset:2048 lds
buffer_load_dwordx4 v35, s[96:99], s26 offen offset:3072 lds
ds_read_b64_tr_b16 v[96:97], v40 offset:32768
ds_read_b64_tr_b16 v[98:99], v40 offset:33280
ds_read_b64_tr_b16 v[104:105], v40 offset:32776
ds_read_b64_tr_b16 v[106:107], v40 offset:33288
ds_read_b64_tr_b16 v[128:129], v41 offset:32768
ds_read_b64_tr_b16 v[130:131], v41 offset:33280
ds_read_b64_tr_b16 v[136:137], v41 offset:32776
ds_read_b64_tr_b16 v[138:139], v41 offset:33288
s_waitcnt vmcnt(10) lgkmcnt(0)
s_barrier
s_add_u32 m0, s29, 32768
s_add_u32 s26, s84, 0
buffer_load_dwordx4 v32, s[96:99], s26 offen offset:0 lds
buffer_load_dwordx4 v33, s[96:99], s26 offen offset:1024 lds
buffer_load_dwordx4 v34, s[96:99], s26 offen offset:2048 lds
buffer_load_dwordx4 v35, s[96:99], s26 offen offset:3072 lds
ds_read_b64_tr_b16 v[100:101], v40 offset:49152
ds_read_b64_tr_b16 v[102:103], v40 offset:49664
ds_read_b64_tr_b16 v[108:109], v40 offset:49160
ds_read_b64_tr_b16 v[110:111], v40 offset:49672
ds_read_b64_tr_b16 v[132:133], v41 offset:49152
ds_read_b64_tr_b16 v[134:135], v41 offset:49664
ds_read_b64_tr_b16 v[140:141], v41 offset:49160
ds_read_b64_tr_b16 v[142:143], v41 offset:49672
s_waitcnt vmcnt(9) lgkmcnt(0)
s_barrier
s_add_u32 m0, s29, 49152
s_add_u32 s26, s84, 262144
buffer_load_dwordx4 v32, s[96:99], s26 offen offset:0 lds
buffer_load_dwordx4 v33, s[96:99], s26 offen offset:1024 lds
buffer_load_dwordx4 v34, s[96:99], s26 offen offset:2048 lds
buffer_load_dwordx4 v35, s[96:99], s26 offen offset:3072 lds
ds_read_b64_tr_b16 v[112:113], v40 offset:0
ds_read_b64_tr_b16 v[114:115], v40 offset:512
ds_read_b64_tr_b16 v[120:121], v40 offset:8
ds_read_b64_tr_b16 v[122:123], v40 offset:520
ds_read_b64_tr_b16 v[80:81], v41 offset:0
ds_read_b64_tr_b16 v[82:83], v41 offset:512
ds_read_b64_tr_b16 v[144:145], v41 offset:8
ds_read_b64_tr_b16 v[146:147], v41 offset:520
s_waitcnt lgkmcnt(2)
global_store_dwordx4 v0, v[80:83], s[80:81] offset:-4096
s_waitcnt vmcnt(9) lgkmcnt(0)
s_barrier
s_mov_b64 s[96:97], s[68:69]
s_add_u32 m0, s29, 0
s_add_u32 s26, s82, 0
buffer_load_dwordx4 v32, s[96:99], s26 offen offset:0 lds
buffer_load_dwordx4 v33, s[96:99], s26 offen offset:1024 lds
buffer_load_dwordx4 v34, s[96:99], s26 offen offset:2048 lds
buffer_load_dwordx4 v35, s[96:99], s26 offen offset:3072 lds
ds_read_b64_tr_b16 v[116:117], v40 offset:16384
ds_read_b64_tr_b16 v[118:119], v40 offset:16896
ds_read_b64_tr_b16 v[124:125], v40 offset:16392
ds_read_b64_tr_b16 v[126:127], v40 offset:16904
ds_read_b64_tr_b16 v[80:81], v41 offset:16384
ds_read_b64_tr_b16 v[82:83], v41 offset:16896
ds_read_b64_tr_b16 v[148:149], v41 offset:16392
ds_read_b64_tr_b16 v[150:151], v41 offset:16904
s_waitcnt lgkmcnt(2)
global_store_dwordx4 v0, v[80:83], s[80:81] offset:-3072
s_waitcnt vmcnt(10) lgkmcnt(0)
s_barrier
s_add_u32 m0, s29, 16384
s_add_u32 s26, s82, 262144
buffer_load_dwordx4 v32, s[96:99], s26 offen offset:0 lds
buffer_load_dwordx4 v33, s[96:99], s26 offen offset:1024 lds
buffer_load_dwordx4 v34, s[96:99], s26 offen offset:2048 lds
buffer_load_dwordx4 v35, s[96:99], s26 offen offset:3072 lds
ds_read_b64_tr_b16 a[216:217], v40 offset:32768
ds_read_b64_tr_b16 a[218:219], v40 offset:33280
ds_read_b64_tr_b16 a[224:225], v40 offset:32776
ds_read_b64_tr_b16 a[226:227], v40 offset:33288
ds_read_b64_tr_b16 a[232:233], v41 offset:32768
ds_read_b64_tr_b16 a[234:235], v41 offset:33280
ds_read_b64_tr_b16 v[84:85], v41 offset:32776
ds_read_b64_tr_b16 v[86:87], v41 offset:33288
s_waitcnt lgkmcnt(0)
ds_write_b128 v2, v[84:87] offset:20480
s_waitcnt vmcnt(10)
s_barrier
s_add_u32 m0, s29, 32768
s_add_u32 s26, s82, 2097152
buffer_load_dwordx4 v32, s[96:99], s26 offen offset:0 lds
buffer_load_dwordx4 v33, s[96:99], s26 offen offset:1024 lds
buffer_load_dwordx4 v34, s[96:99], s26 offen offset:2048 lds
buffer_load_dwordx4 v35, s[96:99], s26 offen offset:3072 lds
ds_read_b64_tr_b16 a[220:221], v40 offset:49152
ds_read_b64_tr_b16 a[222:223], v40 offset:49664
ds_read_b64_tr_b16 a[228:229], v40 offset:49160
ds_read_b64_tr_b16 a[230:231], v40 offset:49672
ds_read_b64_tr_b16 a[236:237], v41 offset:49152
ds_read_b64_tr_b16 a[238:239], v41 offset:49664
ds_read_b64_tr_b16 v[84:85], v41 offset:49160
ds_read_b64_tr_b16 v[86:87], v41 offset:49672
s_waitcnt lgkmcnt(0)
ds_write_b128 v2, v[84:87] offset:21504
s_waitcnt vmcnt(9)
s_barrier
s_add_u32 m0, s29, 49152
s_add_u32 s26, s82, 2359296
buffer_load_dwordx4 v32, s[96:99], s26 offen offset:0 lds
buffer_load_dwordx4 v33, s[96:99], s26 offen offset:1024 lds
buffer_load_dwordx4 v34, s[96:99], s26 offen offset:2048 lds
buffer_load_dwordx4 v35, s[96:99], s26 offen offset:3072 lds
ds_read_b64_tr_b16 v[72:73], v40 offset:0
ds_read_b64_tr_b16 v[74:75], v40 offset:512
ds_read_b64_tr_b16 v[76:77], v40 offset:8
ds_read_b64_tr_b16 v[78:79], v40 offset:520
ds_read_b64_tr_b16 a[48:49], v41 offset:0
ds_read_b64_tr_b16 a[50:51], v41 offset:512
ds_read_b64_tr_b16 v[84:85], v41 offset:8
ds_read_b64_tr_b16 v[86:87], v41 offset:520
s_waitcnt lgkmcnt(6)
global_store_dwordx4 v0, v[72:75], s[76:77] offset:-4096
s_waitcnt lgkmcnt(4)
global_store_dwordx4 v0, v[76:79], s[76:77] offset:-2048
s_waitcnt lgkmcnt(0)
global_store_dwordx4 v0, v[84:87], s[78:79] offset:-4096
s_waitcnt vmcnt(11)
s_barrier
s_add_u32 m0, s29, 0
s_add_u32 s26, s83, 0
buffer_load_dwordx4 v32, s[96:99], s26 offen offset:0 lds
buffer_load_dwordx4 v33, s[96:99], s26 offen offset:1024 lds
buffer_load_dwordx4 v34, s[96:99], s26 offen offset:2048 lds
buffer_load_dwordx4 v35, s[96:99], s26 offen offset:3072 lds
ds_read_b64_tr_b16 v[72:73], v40 offset:16384
ds_read_b64_tr_b16 v[74:75], v40 offset:16896
ds_read_b64_tr_b16 v[76:77], v40 offset:16392
ds_read_b64_tr_b16 v[78:79], v40 offset:16904
ds_read_b64_tr_b16 a[52:53], v41 offset:16384
ds_read_b64_tr_b16 a[54:55], v41 offset:16896
ds_read_b64_tr_b16 v[84:85], v41 offset:16392
ds_read_b64_tr_b16 v[86:87], v41 offset:16904
s_waitcnt lgkmcnt(6)
global_store_dwordx4 v0, v[72:75], s[76:77] offset:-3072
s_waitcnt lgkmcnt(4)
global_store_dwordx4 v0, v[76:79], s[76:77] offset:-1024
s_waitcnt lgkmcnt(0)
global_store_dwordx4 v0, v[84:87], s[78:79] offset:-3072
s_waitcnt vmcnt(14)
s_barrier
s_add_u32 m0, s29, 16384
s_add_u32 s26, s83, 262144
buffer_load_dwordx4 v32, s[96:99], s26 offen offset:0 lds
buffer_load_dwordx4 v33, s[96:99], s26 offen offset:1024 lds
buffer_load_dwordx4 v34, s[96:99], s26 offen offset:2048 lds
buffer_load_dwordx4 v35, s[96:99], s26 offen offset:3072 lds
ds_read_b64_tr_b16 a[16:17], v40 offset:32768
ds_read_b64_tr_b16 a[18:19], v40 offset:33280
ds_read_b64_tr_b16 a[24:25], v40 offset:32776
ds_read_b64_tr_b16 a[26:27], v40 offset:33288
ds_read_b64_tr_b16 a[56:57], v41 offset:32768
ds_read_b64_tr_b16 a[58:59], v41 offset:33280
ds_read_b64_tr_b16 a[64:65], v41 offset:32776
ds_read_b64_tr_b16 a[66:67], v41 offset:33288
s_waitcnt vmcnt(14) lgkmcnt(0)
s_barrier
s_add_u32 m0, s29, 32768
s_add_u32 s26, s83, 2097152
buffer_load_dwordx4 v32, s[96:99], s26 offen offset:0 lds
buffer_load_dwordx4 v33, s[96:99], s26 offen offset:1024 lds
buffer_load_dwordx4 v34, s[96:99], s26 offen offset:2048 lds
buffer_load_dwordx4 v35, s[96:99], s26 offen offset:3072 lds
ds_read_b64_tr_b16 a[20:21], v40 offset:49152
ds_read_b64_tr_b16 a[22:23], v40 offset:49664
ds_read_b64_tr_b16 a[28:29], v40 offset:49160
ds_read_b64_tr_b16 a[30:31], v40 offset:49672
ds_read_b64_tr_b16 a[60:61], v41 offset:49152
ds_read_b64_tr_b16 a[62:63], v41 offset:49664
ds_read_b64_tr_b16 a[68:69], v41 offset:49160
ds_read_b64_tr_b16 a[70:71], v41 offset:49672
s_waitcnt vmcnt(11) lgkmcnt(0)
s_barrier
s_add_u32 m0, s29, 49152
s_add_u32 s26, s83, 2359296
buffer_load_dwordx4 v32, s[96:99], s26 offen offset:0 lds
buffer_load_dwordx4 v33, s[96:99], s26 offen offset:1024 lds
buffer_load_dwordx4 v34, s[96:99], s26 offen offset:2048 lds
buffer_load_dwordx4 v35, s[96:99], s26 offen offset:3072 lds
ds_read_b64_tr_b16 v[72:73], v40 offset:0
ds_read_b64_tr_b16 v[74:75], v40 offset:512
ds_read_b64_tr_b16 a[72:73], v40 offset:8
ds_read_b64_tr_b16 a[74:75], v40 offset:520
ds_read_b64_tr_b16 a[88:89], v41 offset:0
ds_read_b64_tr_b16 a[90:91], v41 offset:512
ds_read_b64_tr_b16 a[96:97], v41 offset:8
ds_read_b64_tr_b16 a[98:99], v41 offset:520
s_waitcnt lgkmcnt(6)
ds_write_b128 v2, v[72:75] offset:4096
s_waitcnt vmcnt(8) lgkmcnt(1)
s_barrier
s_add_u32 m0, s29, 0
s_add_u32 s26, s84, 0
buffer_load_dwordx4 v32, s[96:99], s26 offen offset:0 lds
buffer_load_dwordx4 v33, s[96:99], s26 offen offset:1024 lds
buffer_load_dwordx4 v34, s[96:99], s26 offen offset:2048 lds
buffer_load_dwordx4 v35, s[96:99], s26 offen offset:3072 lds
ds_read_b64_tr_b16 v[72:73], v40 offset:16384
ds_read_b64_tr_b16 v[74:75], v40 offset:16896
ds_read_b64_tr_b16 a[76:77], v40 offset:16392
ds_read_b64_tr_b16 a[78:79], v40 offset:16904
ds_read_b64_tr_b16 a[92:93], v41 offset:16384
ds_read_b64_tr_b16 a[94:95], v41 offset:16896
ds_read_b64_tr_b16 a[100:101], v41 offset:16392
ds_read_b64_tr_b16 a[102:103], v41 offset:16904
s_waitcnt lgkmcnt(6)
ds_write_b128 v2, v[72:75] offset:5120
s_waitcnt vmcnt(8) lgkmcnt(1)
s_barrier
s_add_u32 m0, s29, 16384
s_add_u32 s26, s84, 262144
buffer_load_dwordx4 v32, s[96:99], s26 offen offset:0 lds
buffer_load_dwordx4 v33, s[96:99], s26 offen offset:1024 lds
buffer_load_dwordx4 v34, s[96:99], s26 offen offset:2048 lds
buffer_load_dwordx4 v35, s[96:99], s26 offen offset:3072 lds
ds_read_b64_tr_b16 a[80:81], v40 offset:32768
ds_read_b64_tr_b16 a[82:83], v40 offset:33280
ds_read_b64_tr_b16 v[76:77], v40 offset:32776
ds_read_b64_tr_b16 v[78:79], v40 offset:33288
ds_read_b64_tr_b16 v[80:81], v41 offset:32768
ds_read_b64_tr_b16 v[82:83], v41 offset:33280
ds_read_b64_tr_b16 a[104:105], v41 offset:32776
ds_read_b64_tr_b16 a[106:107], v41 offset:33288
s_waitcnt lgkmcnt(4)
ds_write_b128 v2, v[76:79] offset:6144
s_waitcnt lgkmcnt(3)
ds_write_b128 v2, v[80:83] offset:8192
s_waitcnt vmcnt(8) lgkmcnt(2)
s_barrier
s_mov_b64 s[96:97], s[74:75]
s_add_u32 m0, s29, 32768
s_add_u32 s26, s85, 0
buffer_load_dwordx4 v36, s[96:99], s26 offen offset:0 lds
buffer_load_dwordx4 v37, s[96:99], s26 offen offset:1024 lds
buffer_load_dwordx4 v38, s[96:99], s26 offen offset:2048 lds
buffer_load_dwordx4 v39, s[96:99], s26 offen offset:3072 lds
ds_read_b64_tr_b16 a[84:85], v40 offset:49152
ds_read_b64_tr_b16 a[86:87], v40 offset:49664
ds_read_b64_tr_b16 v[76:77], v40 offset:49160
ds_read_b64_tr_b16 v[78:79], v40 offset:49672
ds_read_b64_tr_b16 v[80:81], v41 offset:49152
ds_read_b64_tr_b16 v[82:83], v41 offset:49664
ds_read_b64_tr_b16 a[108:109], v41 offset:49160
ds_read_b64_tr_b16 a[110:111], v41 offset:49672
s_waitcnt lgkmcnt(4)
ds_write_b128 v2, v[76:79] offset:7168
s_waitcnt lgkmcnt(3)
ds_write_b128 v2, v[80:83] offset:9216
s_waitcnt vmcnt(8) lgkmcnt(2)
s_barrier
s_add_u32 m0, s29, 49152
s_add_u32 s26, s86, 0
buffer_load_dwordx4 v36, s[96:99], s26 offen offset:0 lds
buffer_load_dwordx4 v37, s[96:99], s26 offen offset:1024 lds
buffer_load_dwordx4 v38, s[96:99], s26 offen offset:2048 lds
buffer_load_dwordx4 v39, s[96:99], s26 offen offset:3072 lds
ds_read_b64_tr_b16 a[112:113], v40 offset:0
ds_read_b64_tr_b16 a[114:115], v40 offset:512
ds_read_b64_tr_b16 v[76:77], v40 offset:8
ds_read_b64_tr_b16 v[78:79], v40 offset:520
ds_read_b64_tr_b16 v[80:81], v41 offset:0
ds_read_b64_tr_b16 v[82:83], v41 offset:512
ds_read_b64_tr_b16 a[120:121], v41 offset:8
ds_read_b64_tr_b16 a[122:123], v41 offset:520
s_waitcnt lgkmcnt(4)
ds_write_b128 v2, v[76:79] offset:10240
s_waitcnt lgkmcnt(3)
global_store_dwordx4 v0, v[80:83], s[78:79] offset:-2048
s_waitcnt vmcnt(9) lgkmcnt(1)
s_barrier
s_add_u32 m0, s29, 0
s_add_u32 s26, s85, 256
buffer_load_dwordx4 v36, s[96:99], s26 offen offset:0 lds
buffer_load_dwordx4 v37, s[96:99], s26 offen offset:1024 lds
buffer_load_dwordx4 v38, s[96:99], s26 offen offset:2048 lds
buffer_load_dwordx4 v39, s[96:99], s26 offen offset:3072 lds
ds_read_b64_tr_b16 a[116:117], v40 offset:16384
ds_read_b64_tr_b16 a[118:119], v40 offset:16896
ds_read_b64_tr_b16 v[76:77], v40 offset:16392
ds_read_b64_tr_b16 v[78:79], v40 offset:16904
ds_read_b64_tr_b16 v[80:81], v41 offset:16384
ds_read_b64_tr_b16 v[82:83], v41 offset:16896
ds_read_b64_tr_b16 a[124:125], v41 offset:16392
ds_read_b64_tr_b16 a[126:127], v41 offset:16904
s_waitcnt lgkmcnt(4)
ds_write_b128 v2, v[76:79] offset:11264
s_waitcnt lgkmcnt(3)
global_store_dwordx4 v0, v[80:83], s[78:79] offset:-1024
s_waitcnt vmcnt(10) lgkmcnt(1)
s_barrier
s_add_u32 m0, s29, 16384
s_add_u32 s26, s86, 256
buffer_load_dwordx4 v36, s[96:99], s26 offen offset:0 lds
buffer_load_dwordx4 v37, s[96:99], s26 offen offset:1024 lds
buffer_load_dwordx4 v38, s[96:99], s26 offen offset:2048 lds
buffer_load_dwordx4 v39, s[96:99], s26 offen offset:3072 lds
ds_read_b64_tr_b16 v[72:73], v42 offset:32768
ds_read_b64_tr_b16 v[74:75], v42 offset:33024
ds_read_b64_tr_b16 v[76:77], v42 offset:34816
ds_read_b64_tr_b16 v[78:79], v42 offset:35072
ds_read_b64_tr_b16 v[8:9], v43 offset:32768
ds_read_b64_tr_b16 v[10:11], v43 offset:33024
ds_read_b64_tr_b16 v[12:13], v43 offset:34816
ds_read_b64_tr_b16 v[14:15], v43 offset:35072
s_waitcnt lgkmcnt(6)
ds_write_b128 v2, v[72:75] offset:22528
s_waitcnt lgkmcnt(5)
ds_write_b128 v2, v[76:79] offset:23552
s_waitcnt vmcnt(10) lgkmcnt(2)
s_barrier
s_add_u32 m0, s29, 32768
s_add_u32 s26, s85, 512
buffer_load_dwordx4 v36, s[96:99], s26 offen offset:0 lds
buffer_load_dwordx4 v37, s[96:99], s26 offen offset:1024 lds
buffer_load_dwordx4 v38, s[96:99], s26 offen offset:2048 lds
buffer_load_dwordx4 v39, s[96:99], s26 offen offset:3072 lds
ds_read_b64_tr_b16 v[16:17], v42 offset:49152
ds_read_b64_tr_b16 v[18:19], v42 offset:49408
ds_read_b64_tr_b16 v[20:21], v42 offset:51200
ds_read_b64_tr_b16 v[22:23], v42 offset:51456
ds_read_b64_tr_b16 v[184:185], v43 offset:49152
ds_read_b64_tr_b16 v[186:187], v43 offset:49408
ds_read_b64_tr_b16 v[188:189], v43 offset:51200
ds_read_b64_tr_b16 v[190:191], v43 offset:51456
s_waitcnt vmcnt(9) lgkmcnt(0)
s_barrier
s_add_u32 m0, s29, 49152
s_add_u32 s26, s86, 512
buffer_load_dwordx4 v36, s[96:99], s26 offen offset:0 lds
buffer_load_dwordx4 v37, s[96:99], s26 offen offset:1024 lds
buffer_load_dwordx4 v38, s[96:99], s26 offen offset:2048 lds
buffer_load_dwordx4 v39, s[96:99], s26 offen offset:3072 lds
ds_read_b64_tr_b16 v[152:153], v42 offset:0
ds_read_b64_tr_b16 v[154:155], v42 offset:256
ds_read_b64_tr_b16 v[156:157], v42 offset:2048
ds_read_b64_tr_b16 v[158:159], v42 offset:2304
ds_read_b64_tr_b16 v[24:25], v43 offset:0
ds_read_b64_tr_b16 v[26:27], v43 offset:256
ds_read_b64_tr_b16 v[28:29], v43 offset:2048
ds_read_b64_tr_b16 v[30:31], v43 offset:2304
s_waitcnt vmcnt(8) lgkmcnt(0)
s_barrier
s_add_u32 m0, s29, 0
s_add_u32 s26, s85, 768
buffer_load_dwordx4 v36, s[96:99], s26 offen offset:0 lds
buffer_load_dwordx4 v37, s[96:99], s26 offen offset:1024 lds
buffer_load_dwordx4 v38, s[96:99], s26 offen offset:2048 lds
buffer_load_dwordx4 v39, s[96:99], s26 offen offset:3072 lds
ds_read_b64_tr_b16 v[192:193], v42 offset:16384
ds_read_b64_tr_b16 v[194:195], v42 offset:16640
ds_read_b64_tr_b16 v[196:197], v42 offset:18432
ds_read_b64_tr_b16 v[198:199], v42 offset:18688
ds_read_b64_tr_b16 v[200:201], v43 offset:16384
ds_read_b64_tr_b16 v[202:203], v43 offset:16640
ds_read_b64_tr_b16 v[204:205], v43 offset:18432
ds_read_b64_tr_b16 v[206:207], v43 offset:18688
s_waitcnt vmcnt(8) lgkmcnt(0)
s_barrier
s_add_u32 m0, s29, 16384
s_add_u32 s26, s86, 768
buffer_load_dwordx4 v36, s[96:99], s26 offen offset:0 lds
buffer_load_dwordx4 v37, s[96:99], s26 offen offset:1024 lds
buffer_load_dwordx4 v38, s[96:99], s26 offen offset:2048 lds
buffer_load_dwordx4 v39, s[96:99], s26 offen offset:3072 lds
ds_read_b64_tr_b16 v[160:161], v42 offset:32768
ds_read_b64_tr_b16 v[162:163], v42 offset:33024
ds_read_b64_tr_b16 v[164:165], v42 offset:34816
ds_read_b64_tr_b16 v[166:167], v42 offset:35072
ds_read_b64_tr_b16 v[48:49], v43 offset:32768
ds_read_b64_tr_b16 v[50:51], v43 offset:33024
ds_read_b64_tr_b16 v[52:53], v43 offset:34816
ds_read_b64_tr_b16 v[54:55], v43 offset:35072
s_waitcnt vmcnt(8) lgkmcnt(0)
s_barrier
s_add_u32 m0, s29, 32768
s_add_u32 s26, s85, 1024
buffer_load_dwordx4 v36, s[96:99], s26 offen offset:0 lds
buffer_load_dwordx4 v37, s[96:99], s26 offen offset:1024 lds
buffer_load_dwordx4 v38, s[96:99], s26 offen offset:2048 lds
buffer_load_dwordx4 v39, s[96:99], s26 offen offset:3072 lds
ds_read_b64_tr_b16 v[56:57], v42 offset:49152
ds_read_b64_tr_b16 v[58:59], v42 offset:49408
ds_read_b64_tr_b16 v[60:61], v42 offset:51200
ds_read_b64_tr_b16 v[62:63], v42 offset:51456
ds_read_b64_tr_b16 v[208:209], v43 offset:49152
ds_read_b64_tr_b16 v[210:211], v43 offset:49408
ds_read_b64_tr_b16 v[212:213], v43 offset:51200
ds_read_b64_tr_b16 v[214:215], v43 offset:51456
v_lshrrev_b32 v44, 4, v0
v_and_b32 v44, 15, v44
v_lshlrev_b32 v44, 4, v44
buffer_load_dword v45, v44, s[8:11], 0 offen sc1
s_waitcnt vmcnt(9) lgkmcnt(0)
s_barrier
s_add_u32 m0, s29, 49152
s_add_u32 s26, s86, 1024
buffer_load_dwordx4 v36, s[96:99], s26 offen offset:0 lds
buffer_load_dwordx4 v37, s[96:99], s26 offen offset:1024 lds
buffer_load_dwordx4 v38, s[96:99], s26 offen offset:2048 lds
buffer_load_dwordx4 v39, s[96:99], s26 offen offset:3072 lds
ds_read_b64_tr_b16 v[168:169], v42 offset:0
ds_read_b64_tr_b16 v[170:171], v42 offset:256
ds_read_b64_tr_b16 v[172:173], v42 offset:2048
ds_read_b64_tr_b16 v[174:175], v42 offset:2304
ds_read_b64_tr_b16 v[64:65], v43 offset:0
ds_read_b64_tr_b16 v[66:67], v43 offset:256
ds_read_b64_tr_b16 v[68:69], v43 offset:2048
ds_read_b64_tr_b16 v[70:71], v43 offset:2304
s_waitcnt vmcnt(9) lgkmcnt(0)
s_barrier
ds_read_b64_tr_b16 v[216:217], v42 offset:16384
ds_read_b64_tr_b16 v[218:219], v42 offset:16640
ds_read_b64_tr_b16 v[220:221], v42 offset:18432
ds_read_b64_tr_b16 v[222:223], v42 offset:18688
ds_read_b64_tr_b16 v[224:225], v43 offset:16384
ds_read_b64_tr_b16 v[226:227], v43 offset:16640
ds_read_b64_tr_b16 v[228:229], v43 offset:18432
ds_read_b64_tr_b16 v[230:231], v43 offset:18688
s_waitcnt vmcnt(5) lgkmcnt(0)
s_barrier
ds_read_b64_tr_b16 v[176:177], v42 offset:32768
ds_read_b64_tr_b16 v[178:179], v42 offset:33024
ds_read_b64_tr_b16 v[180:181], v42 offset:34816
ds_read_b64_tr_b16 v[182:183], v42 offset:35072
ds_read_b64_tr_b16 v[232:233], v43 offset:32768
ds_read_b64_tr_b16 v[234:235], v43 offset:33024
ds_read_b64_tr_b16 v[236:237], v43 offset:34816
ds_read_b64_tr_b16 v[238:239], v43 offset:35072
s_waitcnt vmcnt(0) lgkmcnt(0)
s_barrier
ds_read_b64_tr_b16 v[240:241], v42 offset:49152
ds_read_b64_tr_b16 v[242:243], v42 offset:49408
ds_read_b64_tr_b16 v[244:245], v42 offset:51200
ds_read_b64_tr_b16 v[246:247], v42 offset:51456
ds_read_b64_tr_b16 v[248:249], v43 offset:49152
ds_read_b64_tr_b16 v[250:251], v43 offset:49408
ds_read_b64_tr_b16 v[252:253], v43 offset:51200
ds_read_b64_tr_b16 v[254:255], v43 offset:51456
s_waitcnt lgkmcnt(0)
s_barrier
s_mul_i32 s26, s13, 12288
v_add_u32 v47, s26, v0
ds_write_b128 v47, v[8:11] offset:16384
ds_write_b128 v47, v[12:15] offset:17408
ds_write_b128 v47, v[16:19] offset:18432
ds_write_b128 v47, v[20:23] offset:19456
ds_write_b128 v47, v[24:27] offset:20480
ds_write_b128 v47, v[28:31] offset:21504
ds_write_b128 v47, v[48:51] offset:22528
ds_write_b128 v47, v[52:55] offset:23552
ds_write_b128 v47, v[56:59] offset:24576
ds_write_b128 v47, v[60:63] offset:25600
ds_write_b128 v47, v[64:67] offset:26624
ds_write_b128 v47, v[68:71] offset:27648
s_mov_b32 s30, 0
s_branch all_10067
all_10066:
buffer_load_dword v45, v44, s[8:11], 0 offen sc1
s_add_u32 s30, s30, 1
s_cmp_gt_u32 s30, 262144
s_cbranch_scc1 L_fail
all_10067:
s_waitcnt vmcnt(0)
v_add_u32_dpp v46, v45, v45 quad_perm:[1,0,3,2] row_mask:0xf bank_mask:0xf
s_nop 1
v_add_u32_dpp v46, v46, v46 quad_perm:[2,3,0,1] row_mask:0xf bank_mask:0xf
s_nop 1
v_add_u32_dpp v46, v46, v46 row_ror:4 row_mask:0xf bank_mask:0xf
s_nop 1
v_add_u32_dpp v46, v46, v46 row_ror:8 row_mask:0xf bank_mask:0xf
v_cmp_ne_u32 vcc, 306, v46
s_cbranch_vccnz all_10066
s_waitcnt vmcnt(0) lgkmcnt(0)
s_barrier
s_mov_b32 s18, 0
s_mov_b32 s36, 0
s_cmp_eq_u32 s13, 1
s_cbranch_scc1 wave_10069
s_cmp_eq_u32 s13, 2
s_cbranch_scc1 wave_10070
s_cmp_eq_u32 s13, 3
s_cbranch_scc1 wave_10071
wave_10068:
layer_10072:
s_lshl_b32 s17, s36, 6
s_mul_i32 s27, s36, 35651584
s_mul_i32 s28, s14, 16384
s_add_u32 s27, s27, s28
s_add_u32 s20, s27, 16777216
s_mul_i32 s27, s17, 10240
s_add_u32 s27, s27, s24
s_add_u32 s21, s27, s25
s_mov_b32 s19, 0
s_mov_b32 s33, s6
s_add_u32 s34, s17, 1
s_add_u32 s31, s17, 63
s_add_u32 s32, s17, 64
s_mov_b32 s27, s20
v_mov_b32 v7, 0
s_add_u32 s68, s4, 413696
s_addc_u32 s69, s5, 0
s_add_u32 s72, s4, 397312
s_addc_u32 s73, s5, 0
s_add_u32 s70, s4, 417792
s_addc_u32 s71, s5, 0
s_add_u32 s74, s4, 401408
s_addc_u32 s75, s5, 0
s_add_u32 s58, s4, s20
s_addc_u32 s59, s5, 0
global_load_dwordx4 v[64:67], v0, s[76:77] offset:-4096 sc1
global_load_dwordx4 v[68:71], v0, s[76:77] offset:-3072 sc1
global_load_dwordx4 v[72:75], v0, s[76:77] offset:-2048 sc1
global_load_dwordx4 v[76:79], v0, s[76:77] offset:-1024 sc1
global_load_dwordx4 v[80:83], v0, s[78:79] offset:-4096 sc1
global_load_dwordx4 v[84:87], v0, s[78:79] offset:-3072 sc1
global_load_dwordx4 v[48:51], v0, s[76:77] offset:2048 sc1
global_load_dwordx4 v[52:55], v0, s[76:77] offset:3072 sc1
global_load_dwordx4 v[56:59], v0, s[76:77] offset:0 sc1
global_load_dwordx4 v[60:63], v0, s[76:77] offset:1024 sc1
v_mov_b64 v[8:9], 0
v_mov_b64 v[10:11], 0
v_mov_b64 v[12:13], 0
v_mov_b64 v[14:15], 0
v_mov_b64 v[16:17], 0
v_mov_b64 v[18:19], 0
v_mov_b64 v[20:21], 0
v_mov_b64 v[22:23], 0
v_mov_b64 v[24:25], 0
v_mov_b64 v[26:27], 0
v_mov_b64 v[28:29], 0
v_mov_b64 v[30:31], 0
v_cmp_gt_u32 vcc, s34, v7
s_cmp_eq_u32 vcc_hi, 0
s_cbranch_scc1 kv_10083
s_mov_b32 s30, 0
kv_10082:
v_and_b32 v7, 128, v0
buffer_load_dword v7, v7, s[4:7], s22 offen sc1
s_add_u32 s30, s30, 1
s_cmp_gt_u32 s30, 262144
s_cbranch_scc1 L_fail
s_waitcnt vmcnt(0)
v_cmp_gt_u32 vcc, s34, v7
s_cbranch_vccnz kv_10082
kv_10083:
s_barrier
v_and_b32 v7, 511, v0
v_lshl_add_u32 v7, v7, 3, s27
global_load_dwordx4 v[32:35], v0, s[68:69] offset:-4096 sc1
global_load_dwordx4 v[36:39], v0, s[68:69] offset:0 sc1
global_load_dwordx4 v[40:43], v0, s[70:71] offset:0 sc1
s_mov_b32 s30, 0
s_waitcnt vmcnt(0)
.p2align 6
gather_10073:
s_waitcnt vmcnt(4)
rt_10078_b:
v_smfmac_f32_16x16x64_bf16 v[12:15], v[32:35], v[72:79], v1
ds_write_b128 v0, v[32:35] offset:0
v_smfmac_f32_16x16x64_bf16 v[8:11], v[32:35], v[64:71], v1
v_bitop3_b32 v44, v32, v34, s18 bitop3:0x7e
v_smfmac_f32_16x16x64_bf16 v[20:23], v[32:35], v[48:55], v1
s_waitcnt vmcnt(3)
ds_write_b128 v0, v[36:39] offset:4096
v_bitop3_b32 v45, v36, v38, s18 bitop3:0x7e
v_or_b32 v44, v44, v45
s_waitcnt vmcnt(2)
v_bitop3_b32 v45, v40, v42, s18 bitop3:0x7e
v_smfmac_f32_16x16x64_bf16 v[16:19], v[32:35], v[56:63], v1
ds_write_b128 v0, v[40:43] offset:8192
v_bitop3_b32 v44, v44, v45, s19 bitop3:0xa8
v_cmp_ne_u32 vcc, 0, v44
v_smfmac_f32_16x16x64_bf16 v[28:31], v[32:35], a[8:15], v1
s_cbranch_vccnz rt_10078
ds_read_b128 v[52:55], v2 offset:3072
v_smfmac_f32_16x16x64_bf16 v[8:11], v[36:39], a[16:23], v1
s_waitcnt lgkmcnt(2)
ds_read_b128 v[60:63], v2 offset:1024
global_load_dwordx4 v[64:67], v0, s[78:79] offset:-2048 sc1
ds_read_b128 v[56:59], v2 offset:0
v_smfmac_f32_16x16x64_bf16 v[24:27], v[32:35], a[0:7], v1
s_waitcnt lgkmcnt(3)
ds_read_b128 v[48:51], v2 offset:2048
s_barrier
ds_read_b128 v[40:43], v0 offset:1024
v_smfmac_f32_16x16x64_bf16 v[20:23], v[36:39], a[40:47], v1
s_mov_b64 s[68:69], s[72:73]
ds_read_b128 v[44:47], v0 offset:5120
global_load_dwordx4 v[68:71], v0, s[78:79] offset:-1024 sc1
v_smfmac_f32_16x16x64_bf16 v[16:19], v[36:39], a[32:39], v1
s_xor_b32 s18, s18, 1
ds_read_b128 v[32:35], v0 offset:2048
s_waitcnt lgkmcnt(4)
v_smfmac_f32_16x16x64_bf16 v[24:27], v[36:39], v[56:63], v1
ds_read_b128 v[56:59], v2 offset:4096
v_smfmac_f32_16x16x64_bf16 v[12:15], v[36:39], a[24:31], v1
ds_read_b128 v[60:63], v2 offset:5120
s_waitcnt lgkmcnt(4)
s_waitcnt vmcnt(2)
v_smfmac_f32_16x16x64_bf16 v[12:15], v[40:43], v[80:87], v1
ds_read_b128 v[84:87], v2 offset:7168
s_waitcnt lgkmcnt(4)
v_smfmac_f32_16x16x64_bf16 v[28:31], v[36:39], v[48:55], v1
ds_read_b128 v[80:83], v2 offset:6144
global_load_dwordx4 v[72:75], v0, s[78:79] offset:0 sc1
v_smfmac_f32_16x16x64_bf16 v[8:11], v[40:43], a[48:55], v1
ds_read_b128 v[36:39], v0 offset:6144
global_load_dwordx4 v[76:79], v0, s[78:79] offset:1024 sc1
v_smfmac_f32_16x16x64_bf16 v[12:15], v[44:47], a[64:71], v1
ds_read_b128 v[40:43], v0 offset:3072
s_waitcnt lgkmcnt(5)
v_smfmac_f32_16x16x64_bf16 v[8:11], v[44:47], a[56:63], v1
ds_read_b128 v[44:47], v0 offset:7168
s_waitcnt lgkmcnt(5)
v_smfmac_f32_16x16x64_bf16 v[8:11], v[32:35], v[56:63], v1
s_waitcnt lgkmcnt(3)
ds_read_b128 v[60:63], v2 offset:9216
v_smfmac_f32_16x16x64_bf16 v[12:15], v[32:35], a[72:79], v1
s_waitcnt lgkmcnt(3)
ds_read_b128 v[56:59], v2 offset:8192
v_smfmac_f32_16x16x64_bf16 v[12:15], v[36:39], v[80:87], v1
ds_read_b128 v[32:35], v0 offset:8192
v_smfmac_f32_16x16x64_bf16 v[8:11], v[36:39], a[80:87], v1
s_waitcnt lgkmcnt(4)
ds_read_b128 v[80:83], v2 offset:10240
global_load_dwordx4 v[48:51], v0, s[58:59] offset:0 nt sc1
ds_read_b128 v[84:87], v2 offset:11264
v_smfmac_f32_16x16x64_bf16 v[8:11], v[40:43], a[88:95], v1
s_add_u32 s20, s20, 524288
s_waitcnt lgkmcnt(5)
ds_read_b128 v[36:39], v0 offset:9216
v_smfmac_f32_16x16x64_bf16 v[12:15], v[40:43], a[96:103], v1
s_waitcnt lgkmcnt(4)
ds_read_b128 v[40:43], v0 offset:1024
v_smfmac_f32_16x16x64_bf16 v[8:11], v[44:47], v[56:63], v1
global_load_dwordx4 v[52:55], v0, s[58:59] offset:1024 nt sc1
ds_read_b128 v[60:63], v2 offset:13312
v_smfmac_f32_16x16x64_bf16 v[12:15], v[44:47], a[104:111], v1
s_waitcnt lgkmcnt(4)
ds_read_b128 v[56:59], v2 offset:12288
s_waitcnt lgkmcnt(4)
v_smfmac_f32_16x16x64_bf16 v[12:15], v[32:35], v[80:87], v1
s_waitcnt vmcnt(4)
ds_read_b128 v[80:83], v2 offset:14336
s_mov_b64 vcc, s[42:43]
v_smfmac_f32_16x16x64_bf16 v[8:11], v[32:35], a[112:119], v1
s_waitcnt lgkmcnt(4)
ds_read_b128 v[84:87], v2 offset:15360
v_smfmac_f32_16x16x64_bf16 v[8:11], v[36:39], v[64:71], v1
s_nop 0
ds_read_b128 v[32:35], v0 offset:5120
global_load_dwordx4 v[64:67], v0, s[78:79] offset:2048 sc1
v_smfmac_f32_16x16x64_bf16 v[12:15], v[36:39], a[120:127], v1
s_nop 0
ds_read_b128 v[36:39], v0 offset:2048
s_waitcnt lgkmcnt(4)
s_nop 0
v_add_f32 v8, v8, v10
v_smfmac_f32_16x16x64_bf16 v[16:19], v[40:43], v[56:63], v1
ds_read_b128 v[60:63], v2 offset:17408
global_load_dwordx4 v[68:71], v0, s[78:79] offset:3072 sc1
ds_read_b128 v[56:59], v2 offset:16384
v_mul_f32 v8, s35, v8
v_smfmac_f32_16x16x64_bf16 v[20:23], v[40:43], a[128:135], v1
s_waitcnt lgkmcnt(3)
ds_read_b128 v[40:43], v0 offset:6144
v_add_f32 v12, v12, v14
v_smfmac_f32_16x16x64_bf16 v[20:23], v[32:35], v[80:87], v1
s_waitcnt lgkmcnt(3)
ds_read_b128 v[80:83], v2 offset:18432
v_add_f32 v13, v13, v15
v_smfmac_f32_16x16x64_bf16 v[16:19], v[32:35], a[136:143], v1
ds_read_b128 v[32:35], v0 offset:3072
v_add_f32 v9, v9, v11
v_smfmac_f32_16x16x64_bf16 v[20:23], v[36:39], a[152:159], v1
s_waitcnt vmcnt(4)
ds_read_b128 v[84:87], v2 offset:19456
v_mul_f32 v13, s35, v13
v_mul_f32 v12, s35, v12
v_mul_f32 v9, s35, v9
v_cvt_pk_bf16_f32 v8, v8, v9
v_cvt_pk_bf16_f32 v12, v12, v13
v_smfmac_f32_16x16x64_bf16 v[16:19], v[36:39], a[144:151], v1
s_waitcnt lgkmcnt(3)
ds_read_b128 v[36:39], v0 offset:7168
ds_write2_b32 v3, v8, v12 offset0:0 offset1:128
v_smfmac_f32_16x16x64_bf16 v[16:19], v[40:43], v[72:79], v1
global_load_dwordx4 v[72:75], v0, s[80:81] offset:-4096 sc1
v_smfmac_f32_16x16x64_bf16 v[20:23], v[40:43], v[56:63], v1
s_waitcnt lgkmcnt(3)
global_load_dwordx4 v[76:79], v0, s[80:81] offset:-3072 sc1
v_smfmac_f32_16x16x64_bf16 v[20:23], v[32:35], a[168:175], v1
ds_read_b128 v[40:43], v0 offset:8192
global_load_dwordx4 v[56:59], v0, s[58:59] offset:2048 nt sc1
global_load_dwordx4 v[60:63], v0, s[58:59] offset:3072 nt sc1
v_smfmac_f32_16x16x64_bf16 v[16:19], v[32:35], a[160:167], v1
s_waitcnt lgkmcnt(1)
ds_read_b128 v[32:35], v0 offset:9216
v_smfmac_f32_16x16x64_bf16 v[16:19], v[36:39], a[176:183], v1
s_barrier
ds_read_b64_tr_b16 v[10:11], v4 offset:512
v_smfmac_f32_16x16x64_bf16 v[20:23], v[36:39], v[80:87], v1
s_waitcnt lgkmcnt(2)
ds_read_b128 v[36:39], v0 offset:8192
ds_read_b64_tr_b16 v[14:15], v4 offset:1536
v_smfmac_f32_16x16x64_bf16 v[20:23], v[40:43], a[192:199], v1
ds_read_b64_tr_b16 v[12:13], v4 offset:1024
s_waitcnt lgkmcnt(4)
ds_read_b64_tr_b16 v[8:9], v4 offset:0
v_smfmac_f32_16x16x64_bf16 v[16:19], v[40:43], a[184:191], v1
s_waitcnt vmcnt(5)
ds_read_b128 v[40:43], v0 offset:9216
v_smfmac_f32_16x16x64_bf16 v[16:19], v[32:35], a[200:207], v1
v_smfmac_f32_16x16x64_bf16 v[20:23], v[32:35], a[208:215], v1
s_waitcnt lgkmcnt(3)
ds_read_b128 v[80:83], v2 offset:20480
global_load_dword v7, v7, s[4:5] sc1
ds_read_b128 v[84:87], v2 offset:21504
v_smfmac_f32_16x16x64_bf16 v[24:27], v[36:39], a[216:223], v1
s_waitcnt lgkmcnt(3)
ds_read_b128 v[32:35], v0 offset:1024
v_add_f32 v16, v16, v18
v_mfma_f32_16x16x32_bf16 v[44:47], v[48:51], v[8:11], 0
v_bfe_u32 v48, v0, 5, 1
v_add_f32 v17, v17, v19
v_mfma_f32_16x16x32_bf16 v[44:47], v[52:55], v[12:15], v[44:47]
s_nop 0
v_lshl_add_u32 v48, v48, 3, v5
v_add_f32 v20, v20, v22
v_smfmac_f32_16x16x64_bf16 v[28:31], v[36:39], a[224:231], v1
s_waitcnt lgkmcnt(3)
ds_read_b128 v[36:39], v0 offset:5120
v_cvt_pk_bf16_f32 v16, v16, v17
v_add_f32 v21, v21, v23
v_cndmask_b32_dpp v44, v46, v44, vcc quad_perm:[0,1,0,1] row_mask:0xf bank_mask:0xf
v_cvt_pk_bf16_f32 v20, v20, v21
v_smfmac_f32_16x16x64_bf16 v[24:27], v[40:43], a[232:239], v1
s_waitcnt lgkmcnt(1)
ds_write2_b32 v3, v16, v20 offset0:1 offset1:129
v_cndmask_b32_dpp v45, v47, v45, vcc quad_perm:[0,1,0,1] row_mask:0xf bank_mask:0xf
v_smfmac_f32_16x16x64_bf16 v[28:31], v[40:43], v[80:87], v1
s_add_u32 s17, s17, 1
ds_write_b64 v48, v[44:45] offset:6144
v_smfmac_f32_16x16x64_bf16 v[24:27], v[32:35], a[240:247], v1
s_add_u32 s21, s21, 10240
ds_read_b128 v[40:43], v0 offset:2048
v_smfmac_f32_16x16x64_bf16 v[28:31], v[32:35], a[248:255], v1
s_waitcnt vmcnt(5)
ds_read_b128 v[32:35], v0 offset:6144
s_waitcnt lgkmcnt(4)
v_smfmac_f32_16x16x64_bf16 v[24:27], v[36:39], v[64:71], v1
ds_read_b128 v[80:83], v2 offset:22528
global_load_dwordx4 v[64:67], v0, s[76:77] offset:-4096 sc1
v_smfmac_f32_16x16x64_bf16 v[28:31], v[36:39], v[88:95], v1
s_waitcnt lgkmcnt(3)
ds_read_b128 v[36:39], v0 offset:3072
s_barrier
ds_read_b128 v[52:55], v6 offset:7168
s_waitcnt lgkmcnt(4)
v_smfmac_f32_16x16x64_bf16 v[28:31], v[40:43], v[104:111], v1
s_waitcnt lgkmcnt(3)
ds_read_b128 v[48:51], v6 offset:6144
v_smfmac_f32_16x16x64_bf16 v[24:27], v[40:43], v[96:103], v1
ds_read_b128 v[40:43], v0 offset:7168
ds_read_b64_tr_b16 v[16:17], v4 offset:2048
v_smfmac_f32_16x16x64_bf16 v[24:27], v[32:35], v[112:119], v1
ds_read_b64_tr_b16 v[18:19], v4 offset:2560
s_waitcnt lgkmcnt(5)
ds_read_b64_tr_b16 v[14:15], v4 offset:1536
v_smfmac_f32_16x16x64_bf16 v[28:31], v[32:35], v[120:127], v1
s_waitcnt vmcnt(2)
ds_read_b64_tr_b16 v[8:9], v4 offset:0
ds_read_b64_tr_b16 v[12:13], v4 offset:1024
v_smfmac_f32_16x16x64_bf16 v[28:31], v[36:39], v[136:143], v1
s_waitcnt lgkmcnt(6)
ds_read_b64_tr_b16 v[10:11], v4 offset:512
v_add_f32 v49, v49, v53
v_smfmac_f32_16x16x64_bf16 v[24:27], v[36:39], v[128:135], v1
s_waitcnt lgkmcnt(6)
ds_read_b64_tr_b16 v[20:21], v4 offset:3072
v_add_f32 v50, v50, v54
v_smfmac_f32_16x16x64_bf16 v[28:31], v[40:43], v[144:151], v1
ds_read_b64_tr_b16 v[22:23], v4 offset:3584
v_add_f32 v51, v51, v55
v_exp_f32 v51, v51
v_exp_f32 v49, v49
v_smfmac_f32_16x16x64_bf16 v[24:27], v[40:43], v[72:79], v1
s_waitcnt lgkmcnt(2)
ds_read_b128 v[84:87], v2 offset:23552
v_add_f32 v48, v48, v52
v_exp_f32 v48, v48
v_exp_f32 v50, v50
v_mfma_f32_16x16x32_bf16 v[44:47], v[8:11], v[8:11], 0
s_waitcnt lgkmcnt(1)
v_cvt_pk_bf16_f32 v55, v50, v51
v_cvt_pk_bf16_f32 v54, v48, v49
v_mfma_f32_16x16x32_bf16 v[44:47], v[12:15], v[12:15], v[44:47]
v_mov_b32_dpp v51, v55 quad_perm:[2,3,2,3] row_mask:0xf bank_mask:0xf
v_mov_b32_dpp v50, v54 quad_perm:[2,3,2,3] row_mask:0xf bank_mask:0xf
v_mfma_f32_16x16x32_bf16 v[44:47], v[16:19], v[16:19], v[44:47]
v_mov_b32_dpp v49, v55 quad_perm:[0,1,0,1] row_mask:0xf bank_mask:0xf
v_mov_b32_dpp v48, v54 quad_perm:[0,1,0,1] row_mask:0xf bank_mask:0xf
v_mfma_f32_16x16x32_bf16 v[44:47], v[20:23], v[20:23], v[44:47]
s_mov_b64 s[70:71], s[74:75]
v_mov_b64 v[20:21], s[44:45]
v_cvt_pk_bf16_f32 v24, v24, v25
v_mfma_f32_16x16x32_bf16 v[8:11], v[56:59], v[48:51], 0
s_add_u32 s34, s17, 2
v_mov_b64 v[22:23], s[44:45]
v_cvt_pk_bf16_f32 v25, v26, v27
v_mfma_f32_16x16x32_bf16 v[12:15], v[60:63], v[48:51], 0
v_exp_f32_dpp v44, v46 quad_perm:[0,1,0,1] row_mask:0xf bank_mask:0xf
v_exp_f32_dpp v45, v47 quad_perm:[0,1,0,1] row_mask:0xf bank_mask:0xf
v_mfma_f32_16x16x32_bf16 v[16:19], v[20:23], v[48:51], 0
s_waitcnt lgkmcnt(0)
v_cvt_pk_bf16_f32 v52, v44, v45
v_cvt_pk_bf16_f32 v53, v44, v45
v_mov_b64 v[54:55], s[46:47]
v_cvt_pk_bf16_f32 v27, v30, v31
v_mfma_f32_16x16x16_bf16 v[8:11], v[24:25], v[52:53], v[8:11]
s_mov_b32 s19, 1
global_load_dwordx4 v[68:71], v0, s[76:77] offset:-3072 sc1
v_cvt_pk_bf16_f32 v26, v28, v29
v_mfma_f32_16x16x16_bf16 v[16:19], v[54:55], v[52:53], v[16:19]
s_min_u32 s34, s34, s32
v_mov_b64 v[38:39], 0
v_mov_b64 v[36:37], 0
v_mfma_f32_16x16x16_bf16 v[12:15], v[26:27], v[52:53], v[12:15]
s_nop 0
ds_read_b128 v[28:31], v0 offset:19456
v_bfe_u32 v32, v0, 5, 1
v_mov_b64 v[34:35], 0
v_rcp_f32 v18, v16
v_subrev_u32 v17, s37, v16
v_cmp_lt_u32 vcc, s38, v17
v_lshl_add_u32 v32, v32, 3, v5
v_cndmask_b32 v9, v13, v9, s[42:43]
v_cndmask_b32 v8, v12, v8, s[42:43]
v_cndmask_b32 v10, v14, v10, s[42:43]
v_mul_f32 v10, v10, v18
v_mul_f32 v9, v9, v18
v_mul_f32 v8, v8, v18
v_cndmask_b32 v11, v15, v11, s[42:43]
v_mul_f32 v11, v11, v18
v_cvt_pk_bf16_f32 v13, v10, v11
v_cvt_pk_bf16_f32 v12, v8, v9
s_cbranch_vccnz rare_10074
back_10075:
ds_read_b128 v[16:19], v0 offset:16384
ds_write_b64 v32, v[12:13] offset:0
v_mov_b64 v[42:43], 0
v_mov_b64 v[32:33], 0
v_mov_b32_dpp v10, v12 quad_perm:[2,3,2,3] row_mask:0xf bank_mask:0xf
v_mov_b64 v[54:55], 0
v_mov_b32_dpp v8, v12 quad_perm:[0,1,0,1] row_mask:0xf bank_mask:0xf
v_mov_b32_dpp v11, v13 quad_perm:[2,3,2,3] row_mask:0xf bank_mask:0xf
v_mov_b32_dpp v9, v13 quad_perm:[0,1,0,1] row_mask:0xf bank_mask:0xf
v_mov_b64 v[52:53], 0
v_mov_b64 v[40:41], 0
v_smfmac_f32_16x16x64_bf16 v[36:39], v[8:11], v[80:87], v1
ds_read_b128 v[24:27], v0 offset:18432
global_load_dwordx4 v[72:75], v0, s[76:77] offset:-2048 sc1
ds_read_b128 v[20:23], v0 offset:17408
v_smfmac_f32_16x16x64_bf16 v[40:43], v[8:11], v[152:159], v1
s_waitcnt lgkmcnt(2)
ds_read_b128 v[80:83], v0 offset:20480
s_barrier
ds_read_b128 v[56:59], v5 offset:512
v_smfmac_f32_16x16x64_bf16 v[32:35], v[8:11], v[176:183], v1
s_add_u32 s27, s20, 524288
ds_read_b128 v[60:63], v5 offset:1024
v_mov_b64 v[48:49], 0
v_mov_b64 v[50:51], 0
v_smfmac_f32_16x16x64_bf16 v[52:55], v[8:11], v[168:175], v1
s_add_u32 s58, s4, s20
ds_read_b128 v[12:15], v5 offset:1536
v_lshrrev_b32 v44, 8, v0
v_smfmac_f32_16x16x64_bf16 v[48:51], v[8:11], v[160:167], v1
s_waitcnt lgkmcnt(4)
ds_read_b128 v[84:87], v0 offset:21504
global_load_dwordx4 v[76:79], v0, s[76:77] offset:-1024 sc1
v_bfe_u32 v45, v0, 1, 7
s_waitcnt lgkmcnt(3)
v_smfmac_f32_16x16x64_bf16 v[36:39], v[56:59], v[16:23], v1
s_addc_u32 s59, s5, 0
ds_read_b128 v[16:19], v0 offset:22528
s_waitcnt lgkmcnt(3)
v_smfmac_f32_16x16x64_bf16 v[36:39], v[60:63], v[24:31], v1
ds_read_b128 v[28:31], v0 offset:25600
s_waitcnt lgkmcnt(3)
v_smfmac_f32_16x16x64_bf16 v[36:39], v[12:15], v[184:191], v1
ds_read_b128 v[20:23], v0 offset:23552
s_waitcnt lgkmcnt(3)
v_smfmac_f32_16x16x64_bf16 v[40:43], v[56:59], v[80:87], v1
ds_read_b128 v[24:27], v0 offset:24576
v_lshl_or_b32 v44, v44, 12, v45
v_smfmac_f32_16x16x64_bf16 v[40:43], v[60:63], v[192:199], v1
s_nop 0
ds_read_b128 v[84:87], v0 offset:27648
v_cvt_pk_bf16_f32 v36, v36, v37
v_and_or_b32 v36, v36, -2, s18
v_cvt_pk_bf16_f32 v37, v38, v39
v_smfmac_f32_16x16x64_bf16 v[40:43], v[12:15], v[200:207], v1
global_store_dwordx2 v44, v[36:37], s[48:49]
s_waitcnt lgkmcnt(2)
v_smfmac_f32_16x16x64_bf16 v[48:51], v[56:59], v[16:23], v1
ds_read_b128 v[80:83], v0 offset:26624
s_waitcnt lgkmcnt(2)
v_smfmac_f32_16x16x64_bf16 v[48:51], v[60:63], v[24:31], v1
s_mov_b32 s30, 0
s_nop 0
v_cvt_pk_bf16_f32 v40, v40, v41
v_cvt_pk_bf16_f32 v41, v42, v43
v_and_or_b32 v40, v40, -2, s18
v_smfmac_f32_16x16x64_bf16 v[48:51], v[12:15], v[208:215], v1
global_store_dwordx2 v44, v[40:41], s[50:51]
s_waitcnt lgkmcnt(1)
v_smfmac_f32_16x16x64_bf16 v[32:35], v[56:59], v[232:239], v1
s_nop 0
s_waitcnt lgkmcnt(0)
v_smfmac_f32_16x16x64_bf16 v[52:55], v[56:59], v[80:87], v1
s_nop 1
v_cvt_pk_bf16_f32 v48, v48, v49
v_smfmac_f32_16x16x64_bf16 v[52:55], v[60:63], v[216:223], v1
v_and_or_b32 v48, v48, -2, s18
v_cvt_pk_bf16_f32 v49, v50, v51
v_smfmac_f32_16x16x64_bf16 v[52:55], v[12:15], v[224:231], v1
global_store_dwordx2 v44, v[48:49], s[52:53]
v_smfmac_f32_16x16x64_bf16 v[32:35], v[60:63], v[240:247], v1
s_nop 2
v_smfmac_f32_16x16x64_bf16 v[32:35], v[12:15], v[248:255], v1
s_nop 1
v_cvt_pk_bf16_f32 v52, v52, v53
v_and_or_b32 v52, v52, -2, s18
v_cvt_pk_bf16_f32 v53, v54, v55
s_nop 0
global_store_dwordx2 v44, v[52:53], s[54:55]
s_nop 0
v_cvt_pk_bf16_f32 v32, v32, v33
v_cvt_pk_bf16_f32 v33, v34, v35
v_and_or_b32 v32, v32, -2, s18
global_store_dwordx2 v44, v[32:33], s[56:57]
v_bfe_u32 v32, v0, 6, 1
v_lshlrev_b32 v32, 4, v32
v_mov_b32 v33, 0x3f80
v_lshlrev_b32 v32, v32, v33
v_bfe_i32 v33, v0, 4, 1
v_and_b32 v45, v32, v33
v_and_b32 v47, v32, v33
v_xor_b32 v44, v32, v45
v_xor_b32 v46, v32, v45
v_and_b32 v36, 32, v0
v_bfe_u32 v37, v0, 6, 1
v_lshl_add_u32 v36, v37, 8, v36
v_bfe_u32 v37, v0, 8, 1
v_lshl_add_u32 v36, v37, 4, v36
v_bfe_u32 v37, v0, 4, 1
v_lshl_add_u32 v36, v37, 3, v36
s_waitcnt vmcnt(9)
v_and_b32 v7, 511, v0
v_lshl_add_u32 v7, v7, 3, s27
s_nop 15
s_nop 15
s_nop 15
s_nop 8
global_load_dwordx4 v[8:11], v0, s[64:65] offset:0 sc1
global_load_dwordx4 v[12:15], v0, s[64:65] offset:1024 sc1
global_load_dwordx4 v[16:19], v0, s[64:65] offset:2048 sc1
global_load_dwordx4 v[20:23], v0, s[64:65] offset:3072 sc1
chk_10086:
v_mov_b64 v[40:41], 0
v_mov_b64 v[42:43], 0
s_waitcnt vmcnt(2)
s_nop 0
v_smfmac_f32_16x16x64_bf16 v[40:43], v[44:47], v[8:15], v1
v_bitop3_b32 v32, v8, v10, s18 bitop3:0x7e
v_bitop3_b32 v33, v12, v14, s18 bitop3:0x7e
s_waitcnt vmcnt(0)
v_smfmac_f32_16x16x64_bf16 v[40:43], v[44:47], v[16:23], v1
v_bitop3_b32 v34, v16, v18, s18 bitop3:0x7e
v_bitop3_b32 v35, v20, v22, s18 bitop3:0x7e
v_or3_b32 v32, v32, v33, v34
v_bitop3_b32 v32, v32, v35, 1 bitop3:0xa8
v_cmp_ne_u32 vcc, 0, v32
s_cbranch_vccnz chk_10086_f
s_nop 1
v_add_f32_dpp v40, v40, v40 row_ror:8 row_mask:0xf bank_mask:0xf
v_add_f32_dpp v41, v41, v41 row_ror:8 row_mask:0xf bank_mask:0xf
v_add_f32_dpp v42, v42, v42 row_ror:8 row_mask:0xf bank_mask:0xf
v_add_f32_dpp v43, v43, v43 row_ror:8 row_mask:0xf bank_mask:0xf
v_cvt_pk_bf16_f32 v40, v40, v41
v_cvt_pk_bf16_f32 v41, v42, v43
v_and_or_b32 v40, v40, -2, s18
s_mov_b64 exec, 0x00ff00ff
global_store_dwordx2 v36, v[40:41], s[66:67]
s_mov_b64 exec, -1
s_branch join_10085
chk_10086_f:
global_load_dwordx4 v[8:11], v0, s[64:65] offset:0 sc1
global_load_dwordx4 v[12:15], v0, s[64:65] offset:1024 sc1
global_load_dwordx4 v[16:19], v0, s[64:65] offset:2048 sc1
global_load_dwordx4 v[20:23], v0, s[64:65] offset:3072 sc1
s_add_u32 s30, s30, 1
s_cmp_le_u32 s30, 262144
s_cbranch_scc1 chk_10086
s_branch L_fail
nored_10084:
join_10085:
s_nop 11
s_barrier
global_load_dwordx4 v[56:59], v0, s[76:77] offset:0 sc1
global_load_dwordx4 v[60:63], v0, s[76:77] offset:1024 sc1
global_load_dwordx4 v[48:51], v0, s[76:77] offset:2048 sc1
global_load_dwordx4 v[52:55], v0, s[76:77] offset:3072 sc1
s_nop 15
s_nop 15
s_nop 3
s_barrier
global_load_dwordx4 v[32:35], v0, s[68:69] offset:-4096 sc1
s_nop 10
global_load_dwordx4 v[36:39], v0, s[68:69] offset:0 sc1
s_nop 10
global_load_dwordx4 v[40:43], v0, s[70:71] offset:0 sc1
s_barrier
global_load_dwordx4 v[80:83], v0, s[78:79] offset:-4096 sc1
global_load_dwordx4 v[84:87], v0, s[78:79] offset:-3072 sc1
v_mov_b64 v[8:9], 0
v_mov_b64 v[10:11], 0
v_mov_b64 v[12:13], 0
v_mov_b64 v[14:15], 0
v_mov_b64 v[16:17], 0
v_mov_b64 v[18:19], 0
v_mov_b64 v[20:21], 0
v_mov_b64 v[22:23], 0
v_mov_b64 v[24:25], 0
v_mov_b64 v[26:27], 0
v_mov_b64 v[28:29], 0
v_mov_b64 v[30:31], 0
s_mov_b32 s30, 0
s_cmp_eq_u32 s17, s31
s_cbranch_scc0 gather_10073
s_branch exit_10076
rt_10078:
global_load_dwordx4 v[32:35], v0, s[68:69] offset:-4096 sc1
global_load_dwordx4 v[36:39], v0, s[68:69] offset:0 sc1
global_load_dwordx4 v[40:43], v0, s[70:71] offset:0 sc1
s_add_u32 s30, s30, 1
s_cmp_gt_u32 s30, 262144
s_cbranch_scc1 L_fail
s_mov_b64 exec, 1
global_store_dword v0, v0, s[62:63]
global_store_dword v0, v0, s[62:63]
s_mov_b64 exec, -1
v_mov_b64 v[8:9], 0
v_mov_b64 v[10:11], 0
v_mov_b64 v[12:13], 0
v_mov_b64 v[14:15], 0
v_mov_b64 v[16:17], 0
v_mov_b64 v[18:19], 0
v_mov_b64 v[20:21], 0
v_mov_b64 v[22:23], 0
v_mov_b64 v[24:25], 0
v_mov_b64 v[26:27], 0
v_mov_b64 v[28:29], 0
v_mov_b64 v[30:31], 0
s_branch gather_10073
rare_10074:
ds_read_b128 v[48:51], v6 offset:6144
ds_read_b128 v[52:55], v6 offset:7168
s_waitcnt lgkmcnt(0)
v_add_f32 v48, v48, v52
v_add_f32 v49, v49, v53
v_add_f32 v50, v50, v54
v_add_f32 v51, v51, v55
v_mov_b32_dpp v46, v46 quad_perm:[0,1,0,1] row_mask:0xf bank_mask:0xf
v_mov_b32_dpp v47, v47 quad_perm:[0,1,0,1] row_mask:0xf bank_mask:0xf
v_max3_f32 v19, v48, v49, v50
v_max3_f32 v19, v19, v51, v46
v_max_f32 v19, v19, v47
s_nop 1
v_max_f32_dpp v19, v19, v19 quad_perm:[2,3,0,1] row_mask:0xf bank_mask:0xf
v_mov_b32 v44, v19
s_nop 1
v_permlane32_swap_b32 v19, v44
v_max_f32 v19, v19, v44
v_mov_b32 v44, v19
s_nop 1
v_permlane16_swap_b32 v19, v44
v_max_f32 v19, v19, v44
v_sub_f32 v48, v48, v19
v_sub_f32 v49, v49, v19
v_sub_f32 v50, v50, v19
v_sub_f32 v51, v51, v19
v_sub_f32 v46, v46, v19
v_sub_f32 v47, v47, v19
v_exp_f32 v48, v48
v_exp_f32 v49, v49
v_exp_f32 v50, v50
v_exp_f32 v51, v51
v_cvt_pk_bf16_f32 v54, v48, v49
v_cvt_pk_bf16_f32 v55, v50, v51
s_nop 0
v_mov_b32_dpp v48, v54 quad_perm:[0,1,0,1] row_mask:0xf bank_mask:0xf
v_mov_b32_dpp v49, v55 quad_perm:[0,1,0,1] row_mask:0xf bank_mask:0xf
v_mov_b32_dpp v50, v54 quad_perm:[2,3,2,3] row_mask:0xf bank_mask:0xf
v_mov_b32_dpp v51, v55 quad_perm:[2,3,2,3] row_mask:0xf bank_mask:0xf
v_mov_b64 v[20:21], s[44:45]
v_mov_b64 v[22:23], s[44:45]
v_mfma_f32_16x16x32_bf16 v[8:11], v[56:59], v[48:51], 0
v_mfma_f32_16x16x32_bf16 v[12:15], v[60:63], v[48:51], 0
v_mfma_f32_16x16x32_bf16 v[16:19], v[20:23], v[48:51], 0
v_mov_b64 v[54:55], s[46:47]
v_exp_f32_dpp v44, v46 quad_perm:[0,1,0,1] row_mask:0xf bank_mask:0xf
v_exp_f32_dpp v45, v47 quad_perm:[0,1,0,1] row_mask:0xf bank_mask:0xf
s_nop 0
v_cvt_pk_bf16_f32 v52, v44, v45
v_cvt_pk_bf16_f32 v53, v44, v45
s_nop 1
v_mfma_f32_16x16x16_bf16 v[16:19], v[54:55], v[52:53], v[16:19]
v_mfma_f32_16x16x16_bf16 v[8:11], v[24:25], v[52:53], v[8:11]
v_mfma_f32_16x16x16_bf16 v[12:15], v[26:27], v[52:53], v[12:15]
s_nop 5
v_rcp_f32 v18, v16
s_nop 0
v_cndmask_b32 v8, v12, v8, s[42:43]
v_mul_f32 v8, v8, v18
v_cndmask_b32 v9, v13, v9, s[42:43]
v_mul_f32 v9, v9, v18
v_cndmask_b32 v10, v14, v10, s[42:43]
v_mul_f32 v10, v10, v18
v_cndmask_b32 v11, v15, v11, s[42:43]
v_mul_f32 v11, v11, v18
v_cvt_pk_bf16_f32 v12, v8, v9
v_cvt_pk_bf16_f32 v13, v10, v11
s_branch back_10075
exit_10076:
global_load_dwordx4 v[32:35], v0, s[68:69] offset:-4096 sc1
global_load_dwordx4 v[36:39], v0, s[68:69] offset:0 sc1
global_load_dwordx4 v[40:43], v0, s[70:71] offset:0 sc1
s_add_u32 s30, s30, 1
s_cmp_gt_u32 s30, 262144
s_cbranch_scc1 L_fail
s_waitcnt vmcnt(2)
v_bitop3_b32 v44, v32, v34, s18 bitop3:0x7e
s_waitcnt vmcnt(1)
v_bitop3_b32 v45, v36, v38, s18 bitop3:0x7e
v_or_b32 v44, v44, v45
s_waitcnt vmcnt(0)
v_bitop3_b32 v46, v40, v42, s18 bitop3:0x7e
v_bitop3_b32 v44, v44, v46, s19 bitop3:0xa8
v_cmp_ne_u32 vcc, 0, v44
s_cbranch_vccnz exit_10076
ds_write_b128 v0, v[32:35] offset:0
ds_write_b128 v0, v[36:39] offset:4096
ds_write_b128 v0, v[40:43] offset:8192
s_waitcnt lgkmcnt(0)
s_barrier
s_barrier
s_add_u32 s36, s36, 1
s_cmp_lt_u32 s36, 2
s_cbranch_scc1 layer_10072
s_endpgm
wave_10069:
layer_10087:
s_lshl_b32 s17, s36, 6
s_mul_i32 s27, s36, 35651584
s_mul_i32 s28, s14, 16384
s_add_u32 s27, s27, s28
s_add_u32 s20, s27, 16781312
s_mul_i32 s27, s17, 10240
s_add_u32 s27, s27, s24
s_add_u32 s21, s27, s25
s_mov_b32 s19, 0
s_mov_b32 s33, s6
s_add_u32 s34, s17, 1
s_add_u32 s31, s17, 63
s_add_u32 s32, s17, 64
s_mov_b32 s27, s20
v_mov_b32 v7, 0
s_add_u32 s68, s4, 414720
s_addc_u32 s69, s5, 0
s_add_u32 s72, s4, 398336
s_addc_u32 s73, s5, 0
s_add_u32 s70, s4, 418816
s_addc_u32 s71, s5, 0
s_add_u32 s74, s4, 402432
s_addc_u32 s75, s5, 0
s_add_u32 s58, s4, s20
s_addc_u32 s59, s5, 0
global_load_dwordx4 v[64:67], v0, s[76:77] offset:-4096 sc1
global_load_dwordx4 v[68:71], v0, s[76:77] offset:-3072 sc1
global_load_dwordx4 v[72:75], v0, s[76:77] offset:-2048 sc1
global_load_dwordx4 v[76:79], v0, s[76:77] offset:-1024 sc1
global_load_dwordx4 v[80:83], v0, s[78:79] offset:-4096 sc1
global_load_dwordx4 v[84:87], v0, s[78:79] offset:-3072 sc1
global_load_dwordx4 v[48:51], v0, s[76:77] offset:2048 sc1
global_load_dwordx4 v[52:55], v0, s[76:77] offset:3072 sc1
global_load_dwordx4 v[56:59], v0, s[76:77] offset:0 sc1
global_load_dwordx4 v[60:63], v0, s[76:77] offset:1024 sc1
v_mov_b64 v[8:9], 0
v_mov_b64 v[10:11], 0
v_mov_b64 v[12:13], 0
v_mov_b64 v[14:15], 0
v_mov_b64 v[16:17], 0
v_mov_b64 v[18:19], 0
v_mov_b64 v[20:21], 0
v_mov_b64 v[22:23], 0
v_mov_b64 v[24:25], 0
v_mov_b64 v[26:27], 0
v_mov_b64 v[28:29], 0
v_mov_b64 v[30:31], 0
s_barrier
v_and_b32 v7, 511, v0
v_lshl_add_u32 v7, v7, 3, s27
global_load_dwordx4 v[32:35], v0, s[68:69] offset:-4096 sc1
global_load_dwordx4 v[36:39], v0, s[68:69] offset:0 sc1
global_load_dwordx4 v[40:43], v0, s[70:71] offset:0 sc1
s_mov_b32 s30, 0
s_waitcnt vmcnt(0)
.p2align 6
gather_10088:
s_waitcnt vmcnt(4)
rt_10093_b:
v_smfmac_f32_16x16x64_bf16 v[12:15], v[32:35], v[72:79], v1
ds_write_b128 v0, v[32:35] offset:1024
v_smfmac_f32_16x16x64_bf16 v[8:11], v[32:35], v[64:71], v1
v_bitop3_b32 v44, v32, v34, s18 bitop3:0x7e
v_smfmac_f32_16x16x64_bf16 v[20:23], v[32:35], v[48:55], v1
s_waitcnt vmcnt(3)
ds_write_b128 v0, v[36:39] offset:5120
v_bitop3_b32 v45, v36, v38, s18 bitop3:0x7e
v_or_b32 v44, v44, v45
s_waitcnt vmcnt(2)
v_bitop3_b32 v45, v40, v42, s18 bitop3:0x7e
v_smfmac_f32_16x16x64_bf16 v[16:19], v[32:35], v[56:63], v1
ds_write_b128 v0, v[40:43] offset:9216
v_bitop3_b32 v44, v44, v45, s19 bitop3:0xa8
v_cmp_ne_u32 vcc, 0, v44
v_smfmac_f32_16x16x64_bf16 v[28:31], v[32:35], a[8:15], v1
s_cbranch_vccnz rt_10093
ds_read_b128 v[52:55], v2 offset:3072
v_smfmac_f32_16x16x64_bf16 v[8:11], v[36:39], a[16:23], v1
s_waitcnt lgkmcnt(2)
ds_read_b128 v[60:63], v2 offset:1024
global_load_dwordx4 v[64:67], v0, s[78:79] offset:-2048 sc1
ds_read_b128 v[56:59], v2 offset:0
v_smfmac_f32_16x16x64_bf16 v[24:27], v[32:35], a[0:7], v1
s_waitcnt lgkmcnt(3)
ds_read_b128 v[48:51], v2 offset:2048
s_barrier
ds_read_b128 v[40:43], v0 offset:0
v_smfmac_f32_16x16x64_bf16 v[20:23], v[36:39], a[40:47], v1
s_mov_b64 s[68:69], s[72:73]
ds_read_b128 v[44:47], v0 offset:4096
global_load_dwordx4 v[68:71], v0, s[78:79] offset:-1024 sc1
v_smfmac_f32_16x16x64_bf16 v[16:19], v[36:39], a[32:39], v1
s_xor_b32 s18, s18, 1
ds_read_b128 v[32:35], v0 offset:3072
s_waitcnt lgkmcnt(4)
v_smfmac_f32_16x16x64_bf16 v[24:27], v[36:39], v[56:63], v1
ds_read_b128 v[56:59], v2 offset:4096
v_smfmac_f32_16x16x64_bf16 v[12:15], v[36:39], a[24:31], v1
ds_read_b128 v[60:63], v2 offset:5120
s_waitcnt lgkmcnt(4)
s_waitcnt vmcnt(2)
v_smfmac_f32_16x16x64_bf16 v[12:15], v[40:43], v[80:87], v1
ds_read_b128 v[84:87], v2 offset:7168
s_waitcnt lgkmcnt(4)
v_smfmac_f32_16x16x64_bf16 v[28:31], v[36:39], v[48:55], v1
ds_read_b128 v[80:83], v2 offset:6144
global_load_dwordx4 v[72:75], v0, s[78:79] offset:0 sc1
v_smfmac_f32_16x16x64_bf16 v[8:11], v[40:43], a[48:55], v1
ds_read_b128 v[36:39], v0 offset:7168
global_load_dwordx4 v[76:79], v0, s[78:79] offset:1024 sc1
v_smfmac_f32_16x16x64_bf16 v[12:15], v[44:47], a[64:71], v1
ds_read_b128 v[40:43], v0 offset:2048
s_waitcnt lgkmcnt(5)
v_smfmac_f32_16x16x64_bf16 v[8:11], v[44:47], a[56:63], v1
ds_read_b128 v[44:47], v0 offset:6144
s_waitcnt lgkmcnt(5)
v_smfmac_f32_16x16x64_bf16 v[8:11], v[32:35], v[56:63], v1
s_waitcnt lgkmcnt(3)
ds_read_b128 v[60:63], v2 offset:9216
v_smfmac_f32_16x16x64_bf16 v[12:15], v[32:35], a[72:79], v1
s_waitcnt lgkmcnt(3)
ds_read_b128 v[56:59], v2 offset:8192
v_smfmac_f32_16x16x64_bf16 v[12:15], v[36:39], v[80:87], v1
ds_read_b128 v[32:35], v0 offset:9216
v_smfmac_f32_16x16x64_bf16 v[8:11], v[36:39], a[80:87], v1
s_waitcnt lgkmcnt(4)
ds_read_b128 v[80:83], v2 offset:10240
global_load_dwordx4 v[48:51], v0, s[58:59] offset:0 nt sc1
ds_read_b128 v[84:87], v2 offset:11264
v_smfmac_f32_16x16x64_bf16 v[8:11], v[40:43], a[88:95], v1
s_add_u32 s20, s20, 524288
s_waitcnt lgkmcnt(5)
ds_read_b128 v[36:39], v0 offset:8192
v_smfmac_f32_16x16x64_bf16 v[12:15], v[40:43], a[96:103], v1
s_waitcnt lgkmcnt(4)
ds_read_b128 v[40:43], v0 offset:0
v_smfmac_f32_16x16x64_bf16 v[8:11], v[44:47], v[56:63], v1
global_load_dwordx4 v[52:55], v0, s[58:59] offset:1024 nt sc1
ds_read_b128 v[60:63], v2 offset:13312
v_smfmac_f32_16x16x64_bf16 v[12:15], v[44:47], a[104:111], v1
s_waitcnt lgkmcnt(4)
ds_read_b128 v[56:59], v2 offset:12288
s_waitcnt lgkmcnt(4)
v_smfmac_f32_16x16x64_bf16 v[12:15], v[32:35], v[80:87], v1
s_waitcnt vmcnt(4)
ds_read_b128 v[80:83], v2 offset:14336
s_mov_b64 vcc, s[42:43]
v_smfmac_f32_16x16x64_bf16 v[8:11], v[32:35], a[112:119], v1
s_waitcnt lgkmcnt(4)
ds_read_b128 v[84:87], v2 offset:15360
v_smfmac_f32_16x16x64_bf16 v[8:11], v[36:39], v[64:71], v1
s_nop 0
ds_read_b128 v[32:35], v0 offset:4096
global_load_dwordx4 v[64:67], v0, s[78:79] offset:2048 sc1
v_smfmac_f32_16x16x64_bf16 v[12:15], v[36:39], a[120:127], v1
s_nop 0
ds_read_b128 v[36:39], v0 offset:3072
s_waitcnt lgkmcnt(4)
s_nop 0
v_add_f32 v8, v8, v10
v_smfmac_f32_16x16x64_bf16 v[16:19], v[40:43], v[56:63], v1
ds_read_b128 v[60:63], v2 offset:17408
global_load_dwordx4 v[68:71], v0, s[78:79] offset:3072 sc1
ds_read_b128 v[56:59], v2 offset:16384
v_mul_f32 v8, s35, v8
v_smfmac_f32_16x16x64_bf16 v[20:23], v[40:43], a[128:135], v1
s_waitcnt lgkmcnt(3)
ds_read_b128 v[40:43], v0 offset:7168
v_add_f32 v12, v12, v14
v_smfmac_f32_16x16x64_bf16 v[20:23], v[32:35], v[80:87], v1
s_waitcnt lgkmcnt(3)
ds_read_b128 v[80:83], v2 offset:18432
v_add_f32 v13, v13, v15
v_smfmac_f32_16x16x64_bf16 v[16:19], v[32:35], a[136:143], v1
ds_read_b128 v[32:35], v0 offset:2048
v_add_f32 v9, v9, v11
v_smfmac_f32_16x16x64_bf16 v[20:23], v[36:39], a[152:159], v1
s_waitcnt vmcnt(4)
ds_read_b128 v[84:87], v2 offset:19456
v_mul_f32 v13, s35, v13
v_mul_f32 v12, s35, v12
v_mul_f32 v9, s35, v9
v_cvt_pk_bf16_f32 v8, v8, v9
v_cvt_pk_bf16_f32 v12, v12, v13
v_smfmac_f32_16x16x64_bf16 v[16:19], v[36:39], a[144:151], v1
s_waitcnt lgkmcnt(3)
ds_read_b128 v[36:39], v0 offset:6144
ds_write2_b32 v3, v8, v12 offset0:0 offset1:128
v_smfmac_f32_16x16x64_bf16 v[16:19], v[40:43], v[72:79], v1
global_load_dwordx4 v[72:75], v0, s[80:81] offset:-4096 sc1
v_smfmac_f32_16x16x64_bf16 v[20:23], v[40:43], v[56:63], v1
s_waitcnt lgkmcnt(3)
global_load_dwordx4 v[76:79], v0, s[80:81] offset:-3072 sc1
v_smfmac_f32_16x16x64_bf16 v[20:23], v[32:35], a[168:175], v1
ds_read_b128 v[40:43], v0 offset:9216
global_load_dwordx4 v[56:59], v0, s[58:59] offset:2048 nt sc1
global_load_dwordx4 v[60:63], v0, s[58:59] offset:3072 nt sc1
v_smfmac_f32_16x16x64_bf16 v[16:19], v[32:35], a[160:167], v1
s_waitcnt lgkmcnt(1)
ds_read_b128 v[32:35], v0 offset:8192
v_smfmac_f32_16x16x64_bf16 v[16:19], v[36:39], a[176:183], v1
s_barrier
ds_read_b64_tr_b16 v[10:11], v4 offset:512
v_smfmac_f32_16x16x64_bf16 v[20:23], v[36:39], v[80:87], v1
s_waitcnt lgkmcnt(2)
ds_read_b128 v[36:39], v0 offset:9216
ds_read_b64_tr_b16 v[14:15], v4 offset:1536
v_smfmac_f32_16x16x64_bf16 v[20:23], v[40:43], a[192:199], v1
ds_read_b64_tr_b16 v[12:13], v4 offset:1024
s_waitcnt lgkmcnt(4)
ds_read_b64_tr_b16 v[8:9], v4 offset:0
v_smfmac_f32_16x16x64_bf16 v[16:19], v[40:43], a[184:191], v1
s_waitcnt vmcnt(5)
ds_read_b128 v[40:43], v0 offset:8192
v_smfmac_f32_16x16x64_bf16 v[16:19], v[32:35], a[200:207], v1
v_smfmac_f32_16x16x64_bf16 v[20:23], v[32:35], a[208:215], v1
s_waitcnt lgkmcnt(3)
ds_read_b128 v[80:83], v2 offset:20480
global_load_dword v7, v7, s[4:5] sc1
ds_read_b128 v[84:87], v2 offset:21504
v_smfmac_f32_16x16x64_bf16 v[24:27], v[36:39], a[216:223], v1
s_waitcnt lgkmcnt(3)
ds_read_b128 v[32:35], v0 offset:0
v_add_f32 v16, v16, v18
v_mfma_f32_16x16x32_bf16 v[44:47], v[48:51], v[8:11], 0
v_bfe_u32 v48, v0, 5, 1
v_add_f32 v17, v17, v19
v_mfma_f32_16x16x32_bf16 v[44:47], v[52:55], v[12:15], v[44:47]
s_nop 0
v_lshl_add_u32 v48, v48, 3, v5
v_add_f32 v20, v20, v22
v_smfmac_f32_16x16x64_bf16 v[28:31], v[36:39], a[224:231], v1
s_waitcnt lgkmcnt(3)
ds_read_b128 v[36:39], v0 offset:4096
v_cvt_pk_bf16_f32 v16, v16, v17
v_add_f32 v21, v21, v23
v_cndmask_b32_dpp v44, v46, v44, vcc quad_perm:[0,1,0,1] row_mask:0xf bank_mask:0xf
v_cvt_pk_bf16_f32 v20, v20, v21
v_smfmac_f32_16x16x64_bf16 v[24:27], v[40:43], a[232:239], v1
s_waitcnt lgkmcnt(1)
ds_write2_b32 v3, v16, v20 offset0:1 offset1:129
v_cndmask_b32_dpp v45, v47, v45, vcc quad_perm:[0,1,0,1] row_mask:0xf bank_mask:0xf
v_xor_b32 v48, 128, v48
v_smfmac_f32_16x16x64_bf16 v[28:31], v[40:43], v[80:87], v1
s_add_u32 s17, s17, 1
ds_write_b64 v48, v[44:45] offset:6656
v_smfmac_f32_16x16x64_bf16 v[24:27], v[32:35], a[240:247], v1
s_add_u32 s21, s21, 10240
ds_read_b128 v[40:43], v0 offset:3072
v_smfmac_f32_16x16x64_bf16 v[28:31], v[32:35], a[248:255], v1
s_waitcnt vmcnt(5)
ds_read_b128 v[32:35], v0 offset:7168
s_waitcnt lgkmcnt(4)
v_smfmac_f32_16x16x64_bf16 v[24:27], v[36:39], v[64:71], v1
ds_read_b128 v[80:83], v2 offset:22528
global_load_dwordx4 v[64:67], v0, s[76:77] offset:-4096 sc1
v_smfmac_f32_16x16x64_bf16 v[28:31], v[36:39], v[88:95], v1
s_waitcnt lgkmcnt(3)
ds_read_b128 v[36:39], v0 offset:2048
s_barrier
ds_read_b128 v[52:55], v6 offset:7168
s_waitcnt lgkmcnt(4)
v_smfmac_f32_16x16x64_bf16 v[28:31], v[40:43], v[104:111], v1
s_waitcnt lgkmcnt(3)
ds_read_b128 v[48:51], v6 offset:6144
v_smfmac_f32_16x16x64_bf16 v[24:27], v[40:43], v[96:103], v1
ds_read_b128 v[40:43], v0 offset:6144
ds_read_b64_tr_b16 v[16:17], v4 offset:2048
v_smfmac_f32_16x16x64_bf16 v[24:27], v[32:35], v[112:119], v1
ds_read_b64_tr_b16 v[18:19], v4 offset:2560
s_waitcnt lgkmcnt(5)
ds_read_b64_tr_b16 v[14:15], v4 offset:1536
v_smfmac_f32_16x16x64_bf16 v[28:31], v[32:35], v[120:127], v1
s_waitcnt vmcnt(2)
ds_read_b64_tr_b16 v[8:9], v4 offset:0
ds_read_b64_tr_b16 v[12:13], v4 offset:1024
v_smfmac_f32_16x16x64_bf16 v[28:31], v[36:39], v[136:143], v1
s_waitcnt lgkmcnt(6)
ds_read_b64_tr_b16 v[10:11], v4 offset:512
v_add_f32 v49, v49, v53
v_smfmac_f32_16x16x64_bf16 v[24:27], v[36:39], v[128:135], v1
s_waitcnt lgkmcnt(6)
ds_read_b64_tr_b16 v[20:21], v4 offset:3072
v_add_f32 v50, v50, v54
v_smfmac_f32_16x16x64_bf16 v[28:31], v[40:43], v[144:151], v1
ds_read_b64_tr_b16 v[22:23], v4 offset:3584
v_add_f32 v51, v51, v55
v_exp_f32 v51, v51
v_exp_f32 v49, v49
v_smfmac_f32_16x16x64_bf16 v[24:27], v[40:43], v[72:79], v1
s_waitcnt lgkmcnt(2)
ds_read_b128 v[84:87], v2 offset:23552
v_add_f32 v48, v48, v52
v_exp_f32 v48, v48
v_exp_f32 v50, v50
v_mfma_f32_16x16x32_bf16 v[44:47], v[8:11], v[8:11], 0
s_waitcnt lgkmcnt(1)
v_cvt_pk_bf16_f32 v55, v50, v51
v_cvt_pk_bf16_f32 v54, v48, v49
v_mfma_f32_16x16x32_bf16 v[44:47], v[12:15], v[12:15], v[44:47]
v_mov_b32_dpp v51, v55 quad_perm:[2,3,2,3] row_mask:0xf bank_mask:0xf
v_mov_b32_dpp v50, v54 quad_perm:[2,3,2,3] row_mask:0xf bank_mask:0xf
v_mfma_f32_16x16x32_bf16 v[44:47], v[16:19], v[16:19], v[44:47]
v_mov_b32_dpp v49, v55 quad_perm:[0,1,0,1] row_mask:0xf bank_mask:0xf
v_mov_b32_dpp v48, v54 quad_perm:[0,1,0,1] row_mask:0xf bank_mask:0xf
v_mfma_f32_16x16x32_bf16 v[44:47], v[20:23], v[20:23], v[44:47]
s_mov_b64 s[70:71], s[74:75]
v_mov_b64 v[20:21], s[44:45]
v_cvt_pk_bf16_f32 v24, v24, v25
v_mfma_f32_16x16x32_bf16 v[8:11], v[56:59], v[48:51], 0
s_add_u32 s34, s17, 2
v_mov_b64 v[22:23], s[44:45]
v_cvt_pk_bf16_f32 v25, v26, v27
v_mfma_f32_16x16x32_bf16 v[12:15], v[60:63], v[48:51], 0
v_exp_f32_dpp v44, v46 quad_perm:[0,1,0,1] row_mask:0xf bank_mask:0xf
v_exp_f32_dpp v45, v47 quad_perm:[0,1,0,1] row_mask:0xf bank_mask:0xf
v_mfma_f32_16x16x32_bf16 v[16:19], v[20:23], v[48:51], 0
s_waitcnt lgkmcnt(0)
v_cvt_pk_bf16_f32 v52, v44, v45
v_cvt_pk_bf16_f32 v53, v44, v45
v_mov_b64 v[54:55], s[46:47]
v_cvt_pk_bf16_f32 v27, v30, v31
v_mfma_f32_16x16x16_bf16 v[8:11], v[24:25], v[52:53], v[8:11]
s_mov_b32 s19, 1
global_load_dwordx4 v[68:71], v0, s[76:77] offset:-3072 sc1
v_cvt_pk_bf16_f32 v26, v28, v29
v_mfma_f32_16x16x16_bf16 v[16:19], v[54:55], v[52:53], v[16:19]
s_min_u32 s34, s34, s32
v_mov_b64 v[38:39], 0
v_mov_b64 v[36:37], 0
v_mfma_f32_16x16x16_bf16 v[12:15], v[26:27], v[52:53], v[12:15]
s_nop 0
ds_read_b128 v[28:31], v0 offset:31744
v_bfe_u32 v32, v0, 5, 1
v_mov_b64 v[34:35], 0
v_rcp_f32 v18, v16
v_subrev_u32 v17, s37, v16
v_cmp_lt_u32 vcc, s38, v17
v_lshl_add_u32 v32, v32, 3, v5
v_cndmask_b32 v9, v13, v9, s[42:43]
v_cndmask_b32 v8, v12, v8, s[42:43]
v_cndmask_b32 v10, v14, v10, s[42:43]
v_mul_f32 v10, v10, v18
v_mul_f32 v9, v9, v18
v_mul_f32 v8, v8, v18
v_cndmask_b32 v11, v15, v11, s[42:43]
v_mul_f32 v11, v11, v18
v_cvt_pk_bf16_f32 v13, v10, v11
v_cvt_pk_bf16_f32 v12, v8, v9
s_cbranch_vccnz rare_10089
back_10090:
ds_read_b128 v[16:19], v0 offset:28672
ds_write_b64 v32, v[12:13] offset:512
v_mov_b64 v[42:43], 0
v_mov_b64 v[32:33], 0
v_mov_b32_dpp v10, v12 quad_perm:[2,3,2,3] row_mask:0xf bank_mask:0xf
v_mov_b64 v[54:55], 0
v_mov_b32_dpp v8, v12 quad_perm:[0,1,0,1] row_mask:0xf bank_mask:0xf
v_mov_b32_dpp v11, v13 quad_perm:[2,3,2,3] row_mask:0xf bank_mask:0xf
v_mov_b32_dpp v9, v13 quad_perm:[0,1,0,1] row_mask:0xf bank_mask:0xf
v_mov_b64 v[52:53], 0
v_mov_b64 v[40:41], 0
v_smfmac_f32_16x16x64_bf16 v[36:39], v[8:11], v[80:87], v1
ds_read_b128 v[24:27], v0 offset:30720
global_load_dwordx4 v[72:75], v0, s[76:77] offset:-2048 sc1
ds_read_b128 v[20:23], v0 offset:29696
v_smfmac_f32_16x16x64_bf16 v[40:43], v[8:11], v[152:159], v1
s_waitcnt lgkmcnt(2)
ds_read_b128 v[80:83], v0 offset:32768
s_barrier
ds_read_b128 v[56:59], v5 offset:0
v_smfmac_f32_16x16x64_bf16 v[32:35], v[8:11], v[176:183], v1
s_add_u32 s27, s20, 524288
ds_read_b128 v[60:63], v5 offset:1536
v_mov_b64 v[48:49], 0
v_mov_b64 v[50:51], 0
v_smfmac_f32_16x16x64_bf16 v[52:55], v[8:11], v[168:175], v1
s_add_u32 s58, s4, s20
ds_read_b128 v[12:15], v5 offset:1024
v_lshrrev_b32 v44, 8, v0
v_smfmac_f32_16x16x64_bf16 v[48:51], v[8:11], v[160:167], v1
s_waitcnt lgkmcnt(4)
ds_read_b128 v[84:87], v0 offset:33792
global_load_dwordx4 v[76:79], v0, s[76:77] offset:-1024 sc1
v_bfe_u32 v45, v0, 1, 7
s_waitcnt lgkmcnt(3)
v_smfmac_f32_16x16x64_bf16 v[36:39], v[56:59], v[16:23], v1
s_addc_u32 s59, s5, 0
ds_read_b128 v[16:19], v0 offset:34816
s_waitcnt lgkmcnt(3)
v_smfmac_f32_16x16x64_bf16 v[36:39], v[60:63], v[24:31], v1
ds_read_b128 v[28:31], v0 offset:37888
s_waitcnt lgkmcnt(3)
v_smfmac_f32_16x16x64_bf16 v[36:39], v[12:15], v[184:191], v1
ds_read_b128 v[20:23], v0 offset:35840
s_waitcnt lgkmcnt(3)
v_smfmac_f32_16x16x64_bf16 v[40:43], v[56:59], v[80:87], v1
ds_read_b128 v[24:27], v0 offset:36864
v_lshl_or_b32 v44, v44, 12, v45
v_smfmac_f32_16x16x64_bf16 v[40:43], v[60:63], v[192:199], v1
s_nop 0
ds_read_b128 v[84:87], v0 offset:39936
v_cvt_pk_bf16_f32 v36, v36, v37
v_and_or_b32 v36, v36, -2, s18
v_cvt_pk_bf16_f32 v37, v38, v39
v_smfmac_f32_16x16x64_bf16 v[40:43], v[12:15], v[200:207], v1
global_store_dwordx2 v44, v[36:37], s[48:49]
s_waitcnt lgkmcnt(2)
v_smfmac_f32_16x16x64_bf16 v[48:51], v[56:59], v[16:23], v1
ds_read_b128 v[80:83], v0 offset:38912
s_waitcnt lgkmcnt(2)
v_smfmac_f32_16x16x64_bf16 v[48:51], v[60:63], v[24:31], v1
s_mov_b32 s30, 0
s_nop 0
v_cvt_pk_bf16_f32 v40, v40, v41
v_cvt_pk_bf16_f32 v41, v42, v43
v_and_or_b32 v40, v40, -2, s18
v_smfmac_f32_16x16x64_bf16 v[48:51], v[12:15], v[208:215], v1
global_store_dwordx2 v44, v[40:41], s[50:51]
s_waitcnt lgkmcnt(1)
v_smfmac_f32_16x16x64_bf16 v[32:35], v[56:59], v[232:239], v1
s_nop 0
s_waitcnt lgkmcnt(0)
v_smfmac_f32_16x16x64_bf16 v[52:55], v[56:59], v[80:87], v1
s_nop 1
v_cvt_pk_bf16_f32 v48, v48, v49
v_smfmac_f32_16x16x64_bf16 v[52:55], v[60:63], v[216:223], v1
v_and_or_b32 v48, v48, -2, s18
v_cvt_pk_bf16_f32 v49, v50, v51
v_smfmac_f32_16x16x64_bf16 v[52:55], v[12:15], v[224:231], v1
global_store_dwordx2 v44, v[48:49], s[52:53]
v_smfmac_f32_16x16x64_bf16 v[32:35], v[60:63], v[240:247], v1
s_nop 2
v_smfmac_f32_16x16x64_bf16 v[32:35], v[12:15], v[248:255], v1
s_nop 1
v_cvt_pk_bf16_f32 v52, v52, v53
v_and_or_b32 v52, v52, -2, s18
v_cvt_pk_bf16_f32 v53, v54, v55
s_nop 0
global_store_dwordx2 v44, v[52:53], s[54:55]
s_nop 0
v_cvt_pk_bf16_f32 v32, v32, v33
v_cvt_pk_bf16_f32 v33, v34, v35
v_and_or_b32 v32, v32, -2, s18
global_store_dwordx2 v44, v[32:33], s[56:57]
v_bfe_u32 v32, v0, 6, 1
v_lshlrev_b32 v32, 4, v32
v_mov_b32 v33, 0x3f80
v_lshlrev_b32 v32, v32, v33
v_bfe_i32 v33, v0, 4, 1
v_and_b32 v45, v32, v33
v_and_b32 v47, v32, v33
v_xor_b32 v44, v32, v45
v_xor_b32 v46, v32, v45
v_and_b32 v36, 32, v0
v_bfe_u32 v37, v0, 6, 1
v_lshl_add_u32 v36, v37, 8, v36
v_bfe_u32 v37, v0, 8, 1
v_lshl_add_u32 v36, v37, 4, v36
v_bfe_u32 v37, v0, 4, 1
v_lshl_add_u32 v36, v37, 3, v36
s_waitcnt vmcnt(9)
v_and_b32 v7, 511, v0
v_lshl_add_u32 v7, v7, 3, s27
s_nop 15
s_nop 15
s_nop 15
s_nop 15
global_load_dwordx4 v[8:11], v0, s[64:65] offset:0 sc1
global_load_dwordx4 v[12:15], v0, s[64:65] offset:1024 sc1
global_load_dwordx4 v[16:19], v0, s[64:65] offset:2048 sc1
global_load_dwordx4 v[20:23], v0, s[64:65] offset:3072 sc1
s_nop 15
s_nop 15
s_nop 5
global_load_dwordx4 v[24:27], v0, s[64:65] offset:0 sc1
global_load_dwordx4 v[28:31], v0, s[64:65] offset:1024 sc1
global_load_dwordx4 v[80:83], v0, s[64:65] offset:2048 sc1
global_load_dwordx4 v[84:87], v0, s[64:65] offset:3072 sc1
chk_10098:
v_mov_b64 v[40:41], 0
v_mov_b64 v[42:43], 0
s_waitcnt vmcnt(6)
s_nop 0
v_smfmac_f32_16x16x64_bf16 v[40:43], v[44:47], v[8:15], v1
v_bitop3_b32 v32, v8, v10, s18 bitop3:0x7e
v_bitop3_b32 v33, v12, v14, s18 bitop3:0x7e
s_waitcnt vmcnt(4)
v_smfmac_f32_16x16x64_bf16 v[40:43], v[44:47], v[16:23], v1
v_bitop3_b32 v34, v16, v18, s18 bitop3:0x7e
v_bitop3_b32 v35, v20, v22, s18 bitop3:0x7e
v_or3_b32 v32, v32, v33, v34
v_bitop3_b32 v32, v32, v35, 1 bitop3:0xa8
v_cmp_ne_u32 vcc, 0, v32
s_cbranch_vccnz chk_10098_f
s_nop 1
v_add_f32_dpp v40, v40, v40 row_ror:8 row_mask:0xf bank_mask:0xf
v_add_f32_dpp v41, v41, v41 row_ror:8 row_mask:0xf bank_mask:0xf
v_add_f32_dpp v42, v42, v42 row_ror:8 row_mask:0xf bank_mask:0xf
v_add_f32_dpp v43, v43, v43 row_ror:8 row_mask:0xf bank_mask:0xf
v_cvt_pk_bf16_f32 v40, v40, v41
v_cvt_pk_bf16_f32 v41, v42, v43
v_and_or_b32 v40, v40, -2, s18
s_mov_b64 exec, 0x00ff00ff
global_store_dwordx2 v36, v[40:41], s[66:67]
s_mov_b64 exec, -1
s_branch join_10097
chk_10098_f:
global_load_dwordx4 v[8:11], v0, s[64:65] offset:0 sc1
global_load_dwordx4 v[12:15], v0, s[64:65] offset:1024 sc1
global_load_dwordx4 v[16:19], v0, s[64:65] offset:2048 sc1
global_load_dwordx4 v[20:23], v0, s[64:65] offset:3072 sc1
chk_10099:
v_mov_b64 v[40:41], 0
v_mov_b64 v[42:43], 0
s_waitcnt vmcnt(6)
s_nop 0
v_smfmac_f32_16x16x64_bf16 v[40:43], v[44:47], v[24:31], v1
v_bitop3_b32 v32, v24, v26, s18 bitop3:0x7e
v_bitop3_b32 v33, v28, v30, s18 bitop3:0x7e
s_waitcnt vmcnt(4)
v_smfmac_f32_16x16x64_bf16 v[40:43], v[44:47], v[80:87], v1
v_bitop3_b32 v34, v80, v82, s18 bitop3:0x7e
v_bitop3_b32 v35, v84, v86, s18 bitop3:0x7e
v_or3_b32 v32, v32, v33, v34
v_bitop3_b32 v32, v32, v35, 1 bitop3:0xa8
v_cmp_ne_u32 vcc, 0, v32
s_cbranch_vccnz chk_10099_f
s_nop 1
v_add_f32_dpp v40, v40, v40 row_ror:8 row_mask:0xf bank_mask:0xf
v_add_f32_dpp v41, v41, v41 row_ror:8 row_mask:0xf bank_mask:0xf
v_add_f32_dpp v42, v42, v42 row_ror:8 row_mask:0xf bank_mask:0xf
v_add_f32_dpp v43, v43, v43 row_ror:8 row_mask:0xf bank_mask:0xf
v_cvt_pk_bf16_f32 v40, v40, v41
v_cvt_pk_bf16_f32 v41, v42, v43
v_and_or_b32 v40, v40, -2, s18
s_mov_b64 exec, 0x00ff00ff
global_store_dwordx2 v36, v[40:41], s[66:67]
s_mov_b64 exec, -1
s_branch join_10097
chk_10099_f:
global_load_dwordx4 v[24:27], v0, s[64:65] offset:0 sc1
global_load_dwordx4 v[28:31], v0, s[64:65] offset:1024 sc1
global_load_dwordx4 v[80:83], v0, s[64:65] offset:2048 sc1
global_load_dwordx4 v[84:87], v0, s[64:65] offset:3072 sc1
s_add_u32 s30, s30, 1
s_cmp_le_u32 s30, 262144
s_cbranch_scc1 chk_10098
s_branch L_fail
nored_10096:
join_10097:
s_barrier
global_load_dwordx4 v[56:59], v0, s[76:77] offset:0 sc1
global_load_dwordx4 v[60:63], v0, s[76:77] offset:1024 sc1
global_load_dwordx4 v[48:51], v0, s[76:77] offset:2048 sc1
global_load_dwordx4 v[52:55], v0, s[76:77] offset:3072 sc1
s_nop 15
s_nop 15
s_nop 3
s_barrier
global_load_dwordx4 v[32:35], v0, s[68:69] offset:-4096 sc1
s_nop 10
global_load_dwordx4 v[36:39], v0, s[68:69] offset:0 sc1
s_nop 10
global_load_dwordx4 v[40:43], v0, s[70:71] offset:0 sc1
s_barrier
global_load_dwordx4 v[80:83], v0, s[78:79] offset:-4096 sc1
global_load_dwordx4 v[84:87], v0, s[78:79] offset:-3072 sc1
s_waitcnt vmcnt(13)
v_mov_b64 v[8:9], 0
v_mov_b64 v[10:11], 0
s_waitcnt vmcnt(12)
v_mov_b64 v[12:13], 0
v_mov_b64 v[14:15], 0
s_waitcnt vmcnt(11)
v_mov_b64 v[16:17], 0
v_mov_b64 v[18:19], 0
s_waitcnt vmcnt(10)
v_mov_b64 v[20:21], 0
v_mov_b64 v[22:23], 0
v_mov_b64 v[24:25], 0
v_mov_b64 v[26:27], 0
v_mov_b64 v[28:29], 0
v_mov_b64 v[30:31], 0
s_mov_b32 s30, 0
s_cmp_eq_u32 s17, s31
s_cbranch_scc0 gather_10088
s_branch exit_10091
rt_10093:
global_load_dwordx4 v[32:35], v0, s[68:69] offset:-4096 sc1
global_load_dwordx4 v[36:39], v0, s[68:69] offset:0 sc1
global_load_dwordx4 v[40:43], v0, s[70:71] offset:0 sc1
s_add_u32 s30, s30, 1
s_cmp_gt_u32 s30, 262144
s_cbranch_scc1 L_fail
s_mov_b64 exec, 1
global_store_dword v0, v0, s[62:63]
global_store_dword v0, v0, s[62:63]
s_mov_b64 exec, -1
v_mov_b64 v[8:9], 0
v_mov_b64 v[10:11], 0
v_mov_b64 v[12:13], 0
v_mov_b64 v[14:15], 0
v_mov_b64 v[16:17], 0
v_mov_b64 v[18:19], 0
v_mov_b64 v[20:21], 0
v_mov_b64 v[22:23], 0
v_mov_b64 v[24:25], 0
v_mov_b64 v[26:27], 0
v_mov_b64 v[28:29], 0
v_mov_b64 v[30:31], 0
s_branch gather_10088
rare_10089:
ds_read_b128 v[48:51], v6 offset:6144
ds_read_b128 v[52:55], v6 offset:7168
s_waitcnt lgkmcnt(0)
v_add_f32 v48, v48, v52
v_add_f32 v49, v49, v53
v_add_f32 v50, v50, v54
v_add_f32 v51, v51, v55
v_mov_b32_dpp v46, v46 quad_perm:[0,1,0,1] row_mask:0xf bank_mask:0xf
v_mov_b32_dpp v47, v47 quad_perm:[0,1,0,1] row_mask:0xf bank_mask:0xf
v_max3_f32 v19, v48, v49, v50
v_max3_f32 v19, v19, v51, v46
v_max_f32 v19, v19, v47
s_nop 1
v_max_f32_dpp v19, v19, v19 quad_perm:[2,3,0,1] row_mask:0xf bank_mask:0xf
v_mov_b32 v44, v19
s_nop 1
v_permlane32_swap_b32 v19, v44
v_max_f32 v19, v19, v44
v_mov_b32 v44, v19
s_nop 1
v_permlane16_swap_b32 v19, v44
v_max_f32 v19, v19, v44
v_sub_f32 v48, v48, v19
v_sub_f32 v49, v49, v19
v_sub_f32 v50, v50, v19
v_sub_f32 v51, v51, v19
v_sub_f32 v46, v46, v19
v_sub_f32 v47, v47, v19
v_exp_f32 v48, v48
v_exp_f32 v49, v49
v_exp_f32 v50, v50
v_exp_f32 v51, v51
v_cvt_pk_bf16_f32 v54, v48, v49
v_cvt_pk_bf16_f32 v55, v50, v51
s_nop 0
v_mov_b32_dpp v48, v54 quad_perm:[0,1,0,1] row_mask:0xf bank_mask:0xf
v_mov_b32_dpp v49, v55 quad_perm:[0,1,0,1] row_mask:0xf bank_mask:0xf
v_mov_b32_dpp v50, v54 quad_perm:[2,3,2,3] row_mask:0xf bank_mask:0xf
v_mov_b32_dpp v51, v55 quad_perm:[2,3,2,3] row_mask:0xf bank_mask:0xf
v_mov_b64 v[20:21], s[44:45]
v_mov_b64 v[22:23], s[44:45]
v_mfma_f32_16x16x32_bf16 v[8:11], v[56:59], v[48:51], 0
v_mfma_f32_16x16x32_bf16 v[12:15], v[60:63], v[48:51], 0
v_mfma_f32_16x16x32_bf16 v[16:19], v[20:23], v[48:51], 0
v_mov_b64 v[54:55], s[46:47]
v_exp_f32_dpp v44, v46 quad_perm:[0,1,0,1] row_mask:0xf bank_mask:0xf
v_exp_f32_dpp v45, v47 quad_perm:[0,1,0,1] row_mask:0xf bank_mask:0xf
s_nop 0
v_cvt_pk_bf16_f32 v52, v44, v45
v_cvt_pk_bf16_f32 v53, v44, v45
s_nop 1
v_mfma_f32_16x16x16_bf16 v[16:19], v[54:55], v[52:53], v[16:19]
v_mfma_f32_16x16x16_bf16 v[8:11], v[24:25], v[52:53], v[8:11]
v_mfma_f32_16x16x16_bf16 v[12:15], v[26:27], v[52:53], v[12:15]
s_nop 5
v_rcp_f32 v18, v16
s_nop 0
v_cndmask_b32 v8, v12, v8, s[42:43]
v_mul_f32 v8, v8, v18
v_cndmask_b32 v9, v13, v9, s[42:43]
v_mul_f32 v9, v9, v18
v_cndmask_b32 v10, v14, v10, s[42:43]
v_mul_f32 v10, v10, v18
v_cndmask_b32 v11, v15, v11, s[42:43]
v_mul_f32 v11, v11, v18
v_cvt_pk_bf16_f32 v12, v8, v9
v_cvt_pk_bf16_f32 v13, v10, v11
s_branch back_10090
exit_10091:
global_load_dwordx4 v[32:35], v0, s[68:69] offset:-4096 sc1
global_load_dwordx4 v[36:39], v0, s[68:69] offset:0 sc1
global_load_dwordx4 v[40:43], v0, s[70:71] offset:0 sc1
s_add_u32 s30, s30, 1
s_cmp_gt_u32 s30, 262144
s_cbranch_scc1 L_fail
s_waitcnt vmcnt(2)
v_bitop3_b32 v44, v32, v34, s18 bitop3:0x7e
s_waitcnt vmcnt(1)
v_bitop3_b32 v45, v36, v38, s18 bitop3:0x7e
v_or_b32 v44, v44, v45
s_waitcnt vmcnt(0)
v_bitop3_b32 v46, v40, v42, s18 bitop3:0x7e
v_bitop3_b32 v44, v44, v46, s19 bitop3:0xa8
v_cmp_ne_u32 vcc, 0, v44
s_cbranch_vccnz exit_10091
ds_write_b128 v0, v[32:35] offset:1024
ds_write_b128 v0, v[36:39] offset:5120
ds_write_b128 v0, v[40:43] offset:9216
s_waitcnt lgkmcnt(0)
s_barrier
s_barrier
s_add_u32 s36, s36, 1
s_cmp_lt_u32 s36, 2
s_cbranch_scc1 layer_10087
s_endpgm
wave_10070:
layer_10100:
s_lshl_b32 s17, s36, 6
s_mul_i32 s27, s36, 35651584
s_mul_i32 s28, s14, 16384
s_add_u32 s27, s27, s28
s_add_u32 s20, s27, 16785408
s_mul_i32 s27, s17, 10240
s_add_u32 s27, s27, s24
s_add_u32 s21, s27, s25
s_mov_b32 s19, 0
s_mov_b32 s33, s6
s_add_u32 s34, s17, 1
s_add_u32 s31, s17, 63
s_add_u32 s32, s17, 64
s_mov_b32 s27, s20
v_mov_b32 v7, 0
s_add_u32 s68, s4, 415744
s_addc_u32 s69, s5, 0
s_add_u32 s72, s4, 399360
s_addc_u32 s73, s5, 0
s_add_u32 s70, s4, 419840
s_addc_u32 s71, s5, 0
s_add_u32 s74, s4, 403456
s_addc_u32 s75, s5, 0
s_add_u32 s58, s4, s20
s_addc_u32 s59, s5, 0
global_load_dwordx4 v[64:67], v0, s[76:77] offset:-4096 sc1
global_load_dwordx4 v[68:71], v0, s[76:77] offset:-3072 sc1
global_load_dwordx4 v[72:75], v0, s[76:77] offset:-2048 sc1
global_load_dwordx4 v[76:79], v0, s[76:77] offset:-1024 sc1
global_load_dwordx4 v[80:83], v0, s[78:79] offset:-4096 sc1
global_load_dwordx4 v[84:87], v0, s[78:79] offset:-3072 sc1
global_load_dwordx4 v[48:51], v0, s[76:77] offset:2048 sc1
global_load_dwordx4 v[52:55], v0, s[76:77] offset:3072 sc1
global_load_dwordx4 v[56:59], v0, s[76:77] offset:0 sc1
global_load_dwordx4 v[60:63], v0, s[76:77] offset:1024 sc1
v_mov_b64 v[8:9], 0
v_mov_b64 v[10:11], 0
v_mov_b64 v[12:13], 0
v_mov_b64 v[14:15], 0
v_mov_b64 v[16:17], 0
v_mov_b64 v[18:19], 0
v_mov_b64 v[20:21], 0
v_mov_b64 v[22:23], 0
v_mov_b64 v[24:25], 0
v_mov_b64 v[26:27], 0
v_mov_b64 v[28:29], 0
v_mov_b64 v[30:31], 0
s_barrier
v_and_b32 v7, 511, v0
v_lshl_add_u32 v7, v7, 3, s27
global_load_dwordx4 v[32:35], v0, s[68:69] offset:-4096 sc1
global_load_dwordx4 v[36:39], v0, s[68:69] offset:0 sc1
v_mov_b32 v45, -1
s_mov_b32 s30, 0
s_waitcnt vmcnt(0)
.p2align 6
gather_10101:
s_waitcnt vmcnt(3)
rt_10106_b:
v_smfmac_f32_16x16x64_bf16 v[12:15], v[32:35], v[72:79], v1
ds_write_b128 v0, v[32:35] offset:2048
v_smfmac_f32_16x16x64_bf16 v[8:11], v[32:35], v[64:71], v1
v_bitop3_b32 v44, v32, v34, s18 bitop3:0x7e
v_smfmac_f32_16x16x64_bf16 v[20:23], v[32:35], v[48:55], v1
s_waitcnt vmcnt(2)
ds_write_b128 v0, v[36:39] offset:6144
v_bitop3_b32 v45, v36, v38, s18 bitop3:0x7e
v_smfmac_f32_16x16x64_bf16 v[16:19], v[32:35], v[56:63], v1
v_bitop3_b32 v44, v44, v45, s19 bitop3:0xa8
v_cmp_ne_u32 vcc, 0, v44
v_smfmac_f32_16x16x64_bf16 v[28:31], v[32:35], a[8:15], v1
s_cbranch_vccnz rt_10106
ds_read_b128 v[52:55], v2 offset:3072
v_smfmac_f32_16x16x64_bf16 v[8:11], v[36:39], a[16:23], v1
s_waitcnt lgkmcnt(1)
ds_read_b128 v[60:63], v2 offset:1024
global_load_dwordx4 v[64:67], v0, s[78:79] offset:-2048 sc1
ds_read_b128 v[56:59], v2 offset:0
v_smfmac_f32_16x16x64_bf16 v[24:27], v[32:35], a[0:7], v1
ds_read_b128 v[48:51], v2 offset:2048
s_barrier
ds_read_b128 v[40:43], v0 offset:3072
v_smfmac_f32_16x16x64_bf16 v[20:23], v[36:39], a[40:47], v1
s_mov_b64 s[68:69], s[72:73]
ds_read_b128 v[44:47], v0 offset:7168
global_load_dwordx4 v[68:71], v0, s[78:79] offset:-1024 sc1
v_smfmac_f32_16x16x64_bf16 v[16:19], v[36:39], a[32:39], v1
s_xor_b32 s18, s18, 1
ds_read_b128 v[32:35], v0 offset:0
s_waitcnt lgkmcnt(4)
v_smfmac_f32_16x16x64_bf16 v[24:27], v[36:39], v[56:63], v1
ds_read_b128 v[56:59], v2 offset:4096
v_smfmac_f32_16x16x64_bf16 v[12:15], v[36:39], a[24:31], v1
ds_read_b128 v[60:63], v2 offset:5120
s_waitcnt lgkmcnt(4)
s_waitcnt vmcnt(2)
v_smfmac_f32_16x16x64_bf16 v[12:15], v[40:43], v[80:87], v1
ds_read_b128 v[84:87], v2 offset:7168
s_waitcnt lgkmcnt(4)
v_smfmac_f32_16x16x64_bf16 v[28:31], v[36:39], v[48:55], v1
ds_read_b128 v[80:83], v2 offset:6144
global_load_dwordx4 v[72:75], v0, s[78:79] offset:0 sc1
v_smfmac_f32_16x16x64_bf16 v[8:11], v[40:43], a[48:55], v1
ds_read_b128 v[36:39], v0 offset:4096
global_load_dwordx4 v[76:79], v0, s[78:79] offset:1024 sc1
v_smfmac_f32_16x16x64_bf16 v[12:15], v[44:47], a[64:71], v1
ds_read_b128 v[40:43], v0 offset:1024
s_waitcnt lgkmcnt(5)
v_smfmac_f32_16x16x64_bf16 v[8:11], v[44:47], a[56:63], v1
ds_read_b128 v[44:47], v0 offset:5120
s_waitcnt lgkmcnt(5)
v_smfmac_f32_16x16x64_bf16 v[8:11], v[32:35], v[56:63], v1
s_waitcnt lgkmcnt(3)
ds_read_b128 v[60:63], v2 offset:9216
v_smfmac_f32_16x16x64_bf16 v[12:15], v[32:35], a[72:79], v1
s_waitcnt lgkmcnt(3)
ds_read_b128 v[56:59], v2 offset:8192
v_smfmac_f32_16x16x64_bf16 v[12:15], v[36:39], v[80:87], v1
ds_read_b128 v[32:35], v0 offset:8192
v_smfmac_f32_16x16x64_bf16 v[8:11], v[36:39], a[80:87], v1
s_waitcnt lgkmcnt(4)
ds_read_b128 v[80:83], v2 offset:10240
global_load_dwordx4 v[48:51], v0, s[58:59] offset:0 nt sc1
ds_read_b128 v[84:87], v2 offset:11264
v_smfmac_f32_16x16x64_bf16 v[8:11], v[40:43], a[88:95], v1
s_add_u32 s20, s20, 524288
s_waitcnt lgkmcnt(5)
ds_read_b128 v[36:39], v0 offset:9216
v_smfmac_f32_16x16x64_bf16 v[12:15], v[40:43], a[96:103], v1
s_waitcnt lgkmcnt(4)
ds_read_b128 v[40:43], v0 offset:3072
v_smfmac_f32_16x16x64_bf16 v[8:11], v[44:47], v[56:63], v1
global_load_dwordx4 v[52:55], v0, s[58:59] offset:1024 nt sc1
ds_read_b128 v[60:63], v2 offset:13312
v_smfmac_f32_16x16x64_bf16 v[12:15], v[44:47], a[104:111], v1
s_waitcnt lgkmcnt(4)
ds_read_b128 v[56:59], v2 offset:12288
s_waitcnt lgkmcnt(4)
v_smfmac_f32_16x16x64_bf16 v[12:15], v[32:35], v[80:87], v1
s_waitcnt vmcnt(4)
ds_read_b128 v[80:83], v2 offset:14336
s_mov_b64 vcc, s[42:43]
v_smfmac_f32_16x16x64_bf16 v[8:11], v[32:35], a[112:119], v1
s_waitcnt lgkmcnt(4)
ds_read_b128 v[84:87], v2 offset:15360
v_smfmac_f32_16x16x64_bf16 v[8:11], v[36:39], v[64:71], v1
s_nop 0
ds_read_b128 v[32:35], v0 offset:7168
global_load_dwordx4 v[64:67], v0, s[78:79] offset:2048 sc1
v_smfmac_f32_16x16x64_bf16 v[12:15], v[36:39], a[120:127], v1
s_nop 0
ds_read_b128 v[36:39], v0 offset:0
s_waitcnt lgkmcnt(4)
s_nop 0
v_add_f32 v8, v8, v10
v_smfmac_f32_16x16x64_bf16 v[16:19], v[40:43], v[56:63], v1
ds_read_b128 v[60:63], v2 offset:17408
global_load_dwordx4 v[68:71], v0, s[78:79] offset:3072 sc1
ds_read_b128 v[56:59], v2 offset:16384
v_mul_f32 v8, s35, v8
v_smfmac_f32_16x16x64_bf16 v[20:23], v[40:43], a[128:135], v1
s_waitcnt lgkmcnt(3)
ds_read_b128 v[40:43], v0 offset:4096
v_add_f32 v12, v12, v14
v_smfmac_f32_16x16x64_bf16 v[20:23], v[32:35], v[80:87], v1
s_waitcnt lgkmcnt(3)
ds_read_b128 v[80:83], v2 offset:18432
v_add_f32 v13, v13, v15
v_smfmac_f32_16x16x64_bf16 v[16:19], v[32:35], a[136:143], v1
ds_read_b128 v[32:35], v0 offset:1024
v_add_f32 v9, v9, v11
v_smfmac_f32_16x16x64_bf16 v[20:23], v[36:39], a[152:159], v1
s_waitcnt vmcnt(4)
ds_read_b128 v[84:87], v2 offset:19456
v_mul_f32 v13, s35, v13
v_mul_f32 v12, s35, v12
v_mul_f32 v9, s35, v9
v_cvt_pk_bf16_f32 v8, v8, v9
v_cvt_pk_bf16_f32 v12, v12, v13
v_smfmac_f32_16x16x64_bf16 v[16:19], v[36:39], a[144:151], v1
s_waitcnt lgkmcnt(3)
ds_read_b128 v[36:39], v0 offset:5120
ds_write2_b32 v3, v8, v12 offset0:0 offset1:128
v_smfmac_f32_16x16x64_bf16 v[16:19], v[40:43], v[72:79], v1
global_load_dwordx4 v[72:75], v0, s[80:81] offset:-4096 sc1
v_smfmac_f32_16x16x64_bf16 v[20:23], v[40:43], v[56:63], v1
s_waitcnt lgkmcnt(3)
global_load_dwordx4 v[76:79], v0, s[80:81] offset:-3072 sc1
v_smfmac_f32_16x16x64_bf16 v[20:23], v[32:35], a[168:175], v1
ds_read_b128 v[40:43], v0 offset:8192
global_load_dwordx4 v[56:59], v0, s[58:59] offset:2048 nt sc1
global_load_dwordx4 v[60:63], v0, s[58:59] offset:3072 nt sc1
v_smfmac_f32_16x16x64_bf16 v[16:19], v[32:35], a[160:167], v1
s_waitcnt lgkmcnt(1)
ds_read_b128 v[32:35], v0 offset:9216
v_smfmac_f32_16x16x64_bf16 v[16:19], v[36:39], a[176:183], v1
s_barrier
ds_read_b64_tr_b16 v[10:11], v4 offset:2560
v_smfmac_f32_16x16x64_bf16 v[20:23], v[36:39], v[80:87], v1
s_waitcnt lgkmcnt(2)
ds_read_b128 v[36:39], v0 offset:8192
ds_read_b64_tr_b16 v[14:15], v4 offset:3584
v_smfmac_f32_16x16x64_bf16 v[20:23], v[40:43], a[192:199], v1
ds_read_b64_tr_b16 v[12:13], v4 offset:3072
s_waitcnt lgkmcnt(4)
ds_read_b64_tr_b16 v[8:9], v4 offset:2048
v_smfmac_f32_16x16x64_bf16 v[16:19], v[40:43], a[184:191], v1
s_waitcnt vmcnt(5)
ds_read_b128 v[40:43], v0 offset:9216
v_smfmac_f32_16x16x64_bf16 v[16:19], v[32:35], a[200:207], v1
v_smfmac_f32_16x16x64_bf16 v[20:23], v[32:35], a[208:215], v1
s_waitcnt lgkmcnt(3)
ds_read_b128 v[80:83], v2 offset:20480
global_load_dword v7, v7, s[4:5] sc1
ds_read_b128 v[84:87], v2 offset:21504
v_smfmac_f32_16x16x64_bf16 v[24:27], v[36:39], a[216:223], v1
s_waitcnt lgkmcnt(3)
ds_read_b128 v[32:35], v0 offset:3072
v_add_f32 v16, v16, v18
v_mfma_f32_16x16x32_bf16 v[44:47], v[48:51], v[8:11], 0
v_bfe_u32 v48, v0, 5, 1
v_add_f32 v17, v17, v19
v_mfma_f32_16x16x32_bf16 v[44:47], v[52:55], v[12:15], v[44:47]
s_nop 0
v_lshl_add_u32 v48, v48, 3, v5
v_add_f32 v20, v20, v22
v_smfmac_f32_16x16x64_bf16 v[28:31], v[36:39], a[224:231], v1
s_waitcnt lgkmcnt(3)
ds_read_b128 v[36:39], v0 offset:7168
v_cvt_pk_bf16_f32 v16, v16, v17
v_add_f32 v21, v21, v23
v_cndmask_b32_dpp v44, v46, v44, vcc quad_perm:[0,1,0,1] row_mask:0xf bank_mask:0xf
v_cvt_pk_bf16_f32 v20, v20, v21
v_smfmac_f32_16x16x64_bf16 v[24:27], v[40:43], a[232:239], v1
s_waitcnt lgkmcnt(1)
ds_write2_b32 v3, v16, v20 offset0:1 offset1:129
v_cndmask_b32_dpp v45, v47, v45, vcc quad_perm:[0,1,0,1] row_mask:0xf bank_mask:0xf
v_smfmac_f32_16x16x64_bf16 v[28:31], v[40:43], v[80:87], v1
s_add_u32 s17, s17, 1
ds_write_b64 v48, v[44:45] offset:7168
v_smfmac_f32_16x16x64_bf16 v[24:27], v[32:35], a[240:247], v1
s_add_u32 s21, s21, 10240
ds_read_b128 v[40:43], v0 offset:0
v_smfmac_f32_16x16x64_bf16 v[28:31], v[32:35], a[248:255], v1
s_waitcnt vmcnt(5)
ds_read_b128 v[32:35], v0 offset:4096
s_waitcnt lgkmcnt(4)
v_smfmac_f32_16x16x64_bf16 v[24:27], v[36:39], v[64:71], v1
ds_read_b128 v[80:83], v2 offset:22528
global_load_dwordx4 v[64:67], v0, s[76:77] offset:-4096 sc1
v_smfmac_f32_16x16x64_bf16 v[28:31], v[36:39], v[88:95], v1
s_waitcnt lgkmcnt(3)
ds_read_b128 v[36:39], v0 offset:1024
s_barrier
ds_read_b128 v[52:55], v6 offset:7168
s_waitcnt lgkmcnt(4)
v_smfmac_f32_16x16x64_bf16 v[28:31], v[40:43], v[104:111], v1
s_waitcnt lgkmcnt(3)
ds_read_b128 v[48:51], v6 offset:6144
v_smfmac_f32_16x16x64_bf16 v[24:27], v[40:43], v[96:103], v1
ds_read_b128 v[40:43], v0 offset:5120
ds_read_b64_tr_b16 v[16:17], v4 offset:2048
v_smfmac_f32_16x16x64_bf16 v[24:27], v[32:35], v[112:119], v1
ds_read_b64_tr_b16 v[18:19], v4 offset:2560
s_waitcnt lgkmcnt(5)
ds_read_b64_tr_b16 v[14:15], v4 offset:1536
v_smfmac_f32_16x16x64_bf16 v[28:31], v[32:35], v[120:127], v1
s_waitcnt vmcnt(2)
ds_read_b64_tr_b16 v[8:9], v4 offset:0
ds_read_b64_tr_b16 v[12:13], v4 offset:1024
v_smfmac_f32_16x16x64_bf16 v[28:31], v[36:39], v[136:143], v1
s_waitcnt lgkmcnt(6)
ds_read_b64_tr_b16 v[10:11], v4 offset:512
v_add_f32 v49, v49, v53
v_smfmac_f32_16x16x64_bf16 v[24:27], v[36:39], v[128:135], v1
s_waitcnt lgkmcnt(6)
ds_read_b64_tr_b16 v[20:21], v4 offset:3072
v_add_f32 v50, v50, v54
v_smfmac_f32_16x16x64_bf16 v[28:31], v[40:43], v[144:151], v1
ds_read_b64_tr_b16 v[22:23], v4 offset:3584
v_add_f32 v51, v51, v55
v_exp_f32 v51, v51
v_exp_f32 v49, v49
v_smfmac_f32_16x16x64_bf16 v[24:27], v[40:43], v[72:79], v1
s_waitcnt lgkmcnt(2)
ds_read_b128 v[84:87], v2 offset:23552
v_add_f32 v48, v48, v52
v_exp_f32 v48, v48
v_exp_f32 v50, v50
v_mfma_f32_16x16x32_bf16 v[44:47], v[8:11], v[8:11], 0
s_waitcnt lgkmcnt(1)
v_cvt_pk_bf16_f32 v55, v50, v51
v_cvt_pk_bf16_f32 v54, v48, v49
v_mfma_f32_16x16x32_bf16 v[44:47], v[12:15], v[12:15], v[44:47]
v_mov_b32_dpp v51, v55 quad_perm:[2,3,2,3] row_mask:0xf bank_mask:0xf
v_mov_b32_dpp v50, v54 quad_perm:[2,3,2,3] row_mask:0xf bank_mask:0xf
v_mfma_f32_16x16x32_bf16 v[44:47], v[16:19], v[16:19], v[44:47]
v_mov_b32_dpp v49, v55 quad_perm:[0,1,0,1] row_mask:0xf bank_mask:0xf
v_mov_b32_dpp v48, v54 quad_perm:[0,1,0,1] row_mask:0xf bank_mask:0xf
v_mfma_f32_16x16x32_bf16 v[44:47], v[20:23], v[20:23], v[44:47]
v_mov_b64 v[20:21], s[44:45]
v_cvt_pk_bf16_f32 v24, v24, v25
v_mfma_f32_16x16x32_bf16 v[8:11], v[56:59], v[48:51], 0
s_add_u32 s34, s17, 2
v_mov_b64 v[22:23], s[44:45]
v_cvt_pk_bf16_f32 v25, v26, v27
v_mfma_f32_16x16x32_bf16 v[12:15], v[60:63], v[48:51], 0
s_nop 0
v_exp_f32_dpp v44, v46 quad_perm:[0,1,0,1] row_mask:0xf bank_mask:0xf
v_exp_f32_dpp v45, v47 quad_perm:[0,1,0,1] row_mask:0xf bank_mask:0xf
v_mfma_f32_16x16x32_bf16 v[16:19], v[20:23], v[48:51], 0
s_waitcnt lgkmcnt(0)
v_cvt_pk_bf16_f32 v52, v44, v45
v_cvt_pk_bf16_f32 v53, v44, v45
v_mov_b64 v[54:55], s[46:47]
v_cvt_pk_bf16_f32 v27, v30, v31
v_mfma_f32_16x16x16_bf16 v[8:11], v[24:25], v[52:53], v[8:11]
s_mov_b32 s19, 1
global_load_dwordx4 v[68:71], v0, s[76:77] offset:-3072 sc1
v_cvt_pk_bf16_f32 v26, v28, v29
v_mfma_f32_16x16x16_bf16 v[16:19], v[54:55], v[52:53], v[16:19]
s_min_u32 s34, s34, s32
v_mov_b64 v[38:39], 0
v_mov_b64 v[36:37], 0
v_mfma_f32_16x16x16_bf16 v[12:15], v[26:27], v[52:53], v[12:15]
s_nop 0
ds_read_b128 v[28:31], v0 offset:44032
v_bfe_u32 v32, v0, 5, 1
v_mov_b64 v[34:35], 0
v_rcp_f32 v18, v16
v_subrev_u32 v17, s37, v16
v_cmp_lt_u32 vcc, s38, v17
v_lshl_add_u32 v32, v32, 3, v5
v_cndmask_b32 v9, v13, v9, s[42:43]
v_cndmask_b32 v8, v12, v8, s[42:43]
v_cndmask_b32 v10, v14, v10, s[42:43]
v_mul_f32 v10, v10, v18
v_mul_f32 v9, v9, v18
v_mul_f32 v8, v8, v18
v_cndmask_b32 v11, v15, v11, s[42:43]
v_mul_f32 v11, v11, v18
v_cvt_pk_bf16_f32 v13, v10, v11
v_cvt_pk_bf16_f32 v12, v8, v9
s_cbranch_vccnz rare_10102
back_10103:
ds_read_b128 v[16:19], v0 offset:40960
ds_write_b64 v32, v[12:13] offset:1024
v_mov_b64 v[42:43], 0
v_mov_b64 v[32:33], 0
v_mov_b32_dpp v10, v12 quad_perm:[2,3,2,3] row_mask:0xf bank_mask:0xf
v_mov_b64 v[54:55], 0
v_mov_b32_dpp v8, v12 quad_perm:[0,1,0,1] row_mask:0xf bank_mask:0xf
v_mov_b32_dpp v11, v13 quad_perm:[2,3,2,3] row_mask:0xf bank_mask:0xf
v_mov_b32_dpp v9, v13 quad_perm:[0,1,0,1] row_mask:0xf bank_mask:0xf
v_mov_b64 v[52:53], 0
v_mov_b64 v[40:41], 0
v_smfmac_f32_16x16x64_bf16 v[36:39], v[8:11], v[80:87], v1
ds_read_b128 v[24:27], v0 offset:43008
global_load_dwordx4 v[72:75], v0, s[76:77] offset:-2048 sc1
ds_read_b128 v[20:23], v0 offset:41984
v_smfmac_f32_16x16x64_bf16 v[40:43], v[8:11], v[152:159], v1
s_waitcnt lgkmcnt(2)
ds_read_b128 v[80:83], v0 offset:45056
s_barrier
ds_read_b128 v[56:59], v5 offset:1536
v_smfmac_f32_16x16x64_bf16 v[32:35], v[8:11], v[176:183], v1
s_add_u32 s27, s20, 524288
ds_read_b128 v[60:63], v5 offset:0
v_mov_b64 v[48:49], 0
v_mov_b64 v[50:51], 0
v_smfmac_f32_16x16x64_bf16 v[52:55], v[8:11], v[168:175], v1
s_add_u32 s58, s4, s20
ds_read_b128 v[12:15], v5 offset:512
v_lshrrev_b32 v44, 8, v0
v_smfmac_f32_16x16x64_bf16 v[48:51], v[8:11], v[160:167], v1
s_waitcnt lgkmcnt(4)
ds_read_b128 v[84:87], v0 offset:46080
global_load_dwordx4 v[76:79], v0, s[76:77] offset:-1024 sc1
v_bfe_u32 v45, v0, 1, 7
s_waitcnt lgkmcnt(3)
v_smfmac_f32_16x16x64_bf16 v[36:39], v[56:59], v[16:23], v1
s_addc_u32 s59, s5, 0
ds_read_b128 v[16:19], v0 offset:47104
s_waitcnt lgkmcnt(3)
v_smfmac_f32_16x16x64_bf16 v[36:39], v[60:63], v[24:31], v1
ds_read_b128 v[28:31], v0 offset:50176
s_waitcnt lgkmcnt(3)
v_smfmac_f32_16x16x64_bf16 v[36:39], v[12:15], v[184:191], v1
ds_read_b128 v[20:23], v0 offset:48128
s_waitcnt lgkmcnt(3)
v_smfmac_f32_16x16x64_bf16 v[40:43], v[56:59], v[80:87], v1
ds_read_b128 v[24:27], v0 offset:49152
v_lshl_or_b32 v44, v44, 12, v45
v_smfmac_f32_16x16x64_bf16 v[40:43], v[60:63], v[192:199], v1
s_nop 0
ds_read_b128 v[84:87], v0 offset:52224
v_cvt_pk_bf16_f32 v36, v36, v37
v_and_or_b32 v36, v36, -2, s18
v_cvt_pk_bf16_f32 v37, v38, v39
v_smfmac_f32_16x16x64_bf16 v[40:43], v[12:15], v[200:207], v1
global_store_dwordx2 v44, v[36:37], s[48:49]
s_waitcnt lgkmcnt(2)
v_smfmac_f32_16x16x64_bf16 v[48:51], v[56:59], v[16:23], v1
ds_read_b128 v[80:83], v0 offset:51200
s_waitcnt lgkmcnt(2)
v_smfmac_f32_16x16x64_bf16 v[48:51], v[60:63], v[24:31], v1
s_mov_b32 s30, 0
s_nop 0
v_cvt_pk_bf16_f32 v40, v40, v41
v_cvt_pk_bf16_f32 v41, v42, v43
v_and_or_b32 v40, v40, -2, s18
v_smfmac_f32_16x16x64_bf16 v[48:51], v[12:15], v[208:215], v1
global_store_dwordx2 v44, v[40:41], s[50:51]
s_waitcnt lgkmcnt(1)
v_smfmac_f32_16x16x64_bf16 v[32:35], v[56:59], v[232:239], v1
s_nop 0
s_waitcnt lgkmcnt(0)
v_smfmac_f32_16x16x64_bf16 v[52:55], v[56:59], v[80:87], v1
s_nop 1
v_cvt_pk_bf16_f32 v48, v48, v49
v_smfmac_f32_16x16x64_bf16 v[52:55], v[60:63], v[216:223], v1
v_and_or_b32 v48, v48, -2, s18
v_cvt_pk_bf16_f32 v49, v50, v51
v_smfmac_f32_16x16x64_bf16 v[52:55], v[12:15], v[224:231], v1
global_store_dwordx2 v44, v[48:49], s[52:53]
v_smfmac_f32_16x16x64_bf16 v[32:35], v[60:63], v[240:247], v1
s_nop 2
v_smfmac_f32_16x16x64_bf16 v[32:35], v[12:15], v[248:255], v1
s_nop 1
v_cvt_pk_bf16_f32 v52, v52, v53
v_and_or_b32 v52, v52, -2, s18
v_cvt_pk_bf16_f32 v53, v54, v55
s_nop 0
global_store_dwordx2 v44, v[52:53], s[54:55]
s_nop 0
v_cvt_pk_bf16_f32 v32, v32, v33
v_cvt_pk_bf16_f32 v33, v34, v35
v_and_or_b32 v32, v32, -2, s18
global_store_dwordx2 v44, v[32:33], s[56:57]
s_cmp_ge_u32 s14, 16
s_cbranch_scc1 nored_10109
v_bfe_u32 v32, v0, 6, 1
v_lshlrev_b32 v32, 4, v32
v_mov_b32 v33, 0x3f80
v_lshlrev_b32 v32, v32, v33
v_bfe_i32 v33, v0, 4, 1
v_and_b32 v45, v32, v33
v_and_b32 v47, v32, v33
v_xor_b32 v44, v32, v45
v_xor_b32 v46, v32, v45
v_and_b32 v36, 32, v0
v_bfe_u32 v37, v0, 6, 1
v_lshl_add_u32 v36, v37, 8, v36
v_bfe_u32 v37, v0, 8, 1
v_lshl_add_u32 v36, v37, 4, v36
v_bfe_u32 v37, v0, 4, 1
v_lshl_add_u32 v36, v37, 3, v36
s_waitcnt vmcnt(9)
v_and_b32 v7, 511, v0
v_lshl_add_u32 v7, v7, 3, s27
s_nop 15
s_nop 15
s_nop 15
s_nop 15
s_nop 12
global_load_dwordx4 v[8:11], v0, s[64:65] offset:0 sc1
global_load_dwordx4 v[12:15], v0, s[64:65] offset:1024 sc1
global_load_dwordx4 v[16:19], v0, s[64:65] offset:2048 sc1
global_load_dwordx4 v[20:23], v0, s[64:65] offset:3072 sc1
s_nop 15
s_nop 15
s_nop 5
global_load_dwordx4 v[24:27], v0, s[64:65] offset:0 sc1
global_load_dwordx4 v[28:31], v0, s[64:65] offset:1024 sc1
global_load_dwordx4 v[80:83], v0, s[64:65] offset:2048 sc1
global_load_dwordx4 v[84:87], v0, s[64:65] offset:3072 sc1
chk_10111:
v_mov_b64 v[40:41], 0
v_mov_b64 v[42:43], 0
s_waitcnt vmcnt(6)
s_nop 0
v_smfmac_f32_16x16x64_bf16 v[40:43], v[44:47], v[8:15], v1
v_bitop3_b32 v32, v8, v10, s18 bitop3:0x7e
v_bitop3_b32 v33, v12, v14, s18 bitop3:0x7e
s_waitcnt vmcnt(4)
v_smfmac_f32_16x16x64_bf16 v[40:43], v[44:47], v[16:23], v1
v_bitop3_b32 v34, v16, v18, s18 bitop3:0x7e
v_bitop3_b32 v35, v20, v22, s18 bitop3:0x7e
v_or3_b32 v32, v32, v33, v34
v_bitop3_b32 v32, v32, v35, 1 bitop3:0xa8
v_cmp_ne_u32 vcc, 0, v32
s_cbranch_vccnz chk_10111_f
s_nop 1
v_add_f32_dpp v40, v40, v40 row_ror:8 row_mask:0xf bank_mask:0xf
v_add_f32_dpp v41, v41, v41 row_ror:8 row_mask:0xf bank_mask:0xf
v_add_f32_dpp v42, v42, v42 row_ror:8 row_mask:0xf bank_mask:0xf
v_add_f32_dpp v43, v43, v43 row_ror:8 row_mask:0xf bank_mask:0xf
v_cvt_pk_bf16_f32 v40, v40, v41
v_cvt_pk_bf16_f32 v41, v42, v43
v_and_or_b32 v40, v40, -2, s18
s_mov_b64 exec, 0x00ff00ff
global_store_dwordx2 v36, v[40:41], s[66:67]
s_mov_b64 exec, -1
s_branch join_10110
chk_10111_f:
global_load_dwordx4 v[8:11], v0, s[64:65] offset:0 sc1
global_load_dwordx4 v[12:15], v0, s[64:65] offset:1024 sc1
global_load_dwordx4 v[16:19], v0, s[64:65] offset:2048 sc1
global_load_dwordx4 v[20:23], v0, s[64:65] offset:3072 sc1
chk_10112:
v_mov_b64 v[40:41], 0
v_mov_b64 v[42:43], 0
s_waitcnt vmcnt(6)
s_nop 0
v_smfmac_f32_16x16x64_bf16 v[40:43], v[44:47], v[24:31], v1
v_bitop3_b32 v32, v24, v26, s18 bitop3:0x7e
v_bitop3_b32 v33, v28, v30, s18 bitop3:0x7e
s_waitcnt vmcnt(4)
v_smfmac_f32_16x16x64_bf16 v[40:43], v[44:47], v[80:87], v1
v_bitop3_b32 v34, v80, v82, s18 bitop3:0x7e
v_bitop3_b32 v35, v84, v86, s18 bitop3:0x7e
v_or3_b32 v32, v32, v33, v34
v_bitop3_b32 v32, v32, v35, 1 bitop3:0xa8
v_cmp_ne_u32 vcc, 0, v32
s_cbranch_vccnz chk_10112_f
s_nop 1
v_add_f32_dpp v40, v40, v40 row_ror:8 row_mask:0xf bank_mask:0xf
v_add_f32_dpp v41, v41, v41 row_ror:8 row_mask:0xf bank_mask:0xf
v_add_f32_dpp v42, v42, v42 row_ror:8 row_mask:0xf bank_mask:0xf
v_add_f32_dpp v43, v43, v43 row_ror:8 row_mask:0xf bank_mask:0xf
v_cvt_pk_bf16_f32 v40, v40, v41
v_cvt_pk_bf16_f32 v41, v42, v43
v_and_or_b32 v40, v40, -2, s18
s_mov_b64 exec, 0x00ff00ff
global_store_dwordx2 v36, v[40:41], s[66:67]
s_mov_b64 exec, -1
s_branch join_10110
chk_10112_f:
global_load_dwordx4 v[24:27], v0, s[64:65] offset:0 sc1
global_load_dwordx4 v[28:31], v0, s[64:65] offset:1024 sc1
global_load_dwordx4 v[80:83], v0, s[64:65] offset:2048 sc1
global_load_dwordx4 v[84:87], v0, s[64:65] offset:3072 sc1
s_add_u32 s30, s30, 1
s_cmp_le_u32 s30, 262144
s_cbranch_scc1 chk_10111
s_branch L_fail
nored_10109:
s_waitcnt vmcnt(9)
v_and_b32 v7, 511, v0
v_lshl_add_u32 v7, v7, 3, s27
join_10110:
s_barrier
global_load_dwordx4 v[56:59], v0, s[76:77] offset:0 sc1
global_load_dwordx4 v[60:63], v0, s[76:77] offset:1024 sc1
global_load_dwordx4 v[48:51], v0, s[76:77] offset:2048 sc1
global_load_dwordx4 v[52:55], v0, s[76:77] offset:3072 sc1
s_nop 15
s_nop 15
s_nop 3
s_barrier
global_load_dwordx4 v[32:35], v0, s[68:69] offset:-4096 sc1
s_nop 10
global_load_dwordx4 v[36:39], v0, s[68:69] offset:0 sc1
s_barrier
global_load_dwordx4 v[80:83], v0, s[78:79] offset:-4096 sc1
global_load_dwordx4 v[84:87], v0, s[78:79] offset:-3072 sc1
s_waitcnt vmcnt(12)
v_mov_b64 v[8:9], 0
v_mov_b64 v[10:11], 0
s_waitcnt vmcnt(11)
v_mov_b64 v[12:13], 0
v_mov_b64 v[14:15], 0
s_waitcnt vmcnt(10)
v_mov_b64 v[16:17], 0
v_mov_b64 v[18:19], 0
s_waitcnt vmcnt(9)
v_mov_b64 v[20:21], 0
v_mov_b64 v[22:23], 0
v_mov_b64 v[24:25], 0
v_mov_b64 v[26:27], 0
v_mov_b64 v[28:29], 0
v_mov_b64 v[30:31], 0
s_mov_b32 s30, 0
s_cmp_eq_u32 s17, s31
s_cbranch_scc0 gather_10101
s_branch exit_10104
rt_10106:
global_load_dwordx4 v[32:35], v0, s[68:69] offset:-4096 sc1
global_load_dwordx4 v[36:39], v0, s[68:69] offset:0 sc1
s_add_u32 s30, s30, 1
s_cmp_gt_u32 s30, 262144
s_cbranch_scc1 L_fail
s_mov_b64 exec, 1
global_store_dword v0, v0, s[62:63]
global_store_dword v0, v0, s[62:63]
s_mov_b64 exec, -1
v_mov_b64 v[8:9], 0
v_mov_b64 v[10:11], 0
v_mov_b64 v[12:13], 0
v_mov_b64 v[14:15], 0
v_mov_b64 v[16:17], 0
v_mov_b64 v[18:19], 0
v_mov_b64 v[20:21], 0
v_mov_b64 v[22:23], 0
v_mov_b64 v[24:25], 0
v_mov_b64 v[26:27], 0
v_mov_b64 v[28:29], 0
v_mov_b64 v[30:31], 0
s_branch gather_10101
rare_10102:
ds_read_b128 v[48:51], v6 offset:6144
ds_read_b128 v[52:55], v6 offset:7168
s_waitcnt lgkmcnt(0)
v_add_f32 v48, v48, v52
v_add_f32 v49, v49, v53
v_add_f32 v50, v50, v54
v_add_f32 v51, v51, v55
v_mov_b32_dpp v46, v46 quad_perm:[0,1,0,1] row_mask:0xf bank_mask:0xf
v_mov_b32_dpp v47, v47 quad_perm:[0,1,0,1] row_mask:0xf bank_mask:0xf
v_max3_f32 v19, v48, v49, v50
v_max3_f32 v19, v19, v51, v46
v_max_f32 v19, v19, v47
s_nop 1
v_max_f32_dpp v19, v19, v19 quad_perm:[2,3,0,1] row_mask:0xf bank_mask:0xf
v_mov_b32 v44, v19
s_nop 1
v_permlane32_swap_b32 v19, v44
v_max_f32 v19, v19, v44
v_mov_b32 v44, v19
s_nop 1
v_permlane16_swap_b32 v19, v44
v_max_f32 v19, v19, v44
v_sub_f32 v48, v48, v19
v_sub_f32 v49, v49, v19
v_sub_f32 v50, v50, v19
v_sub_f32 v51, v51, v19
v_sub_f32 v46, v46, v19
v_sub_f32 v47, v47, v19
v_exp_f32 v48, v48
v_exp_f32 v49, v49
v_exp_f32 v50, v50
v_exp_f32 v51, v51
v_cvt_pk_bf16_f32 v54, v48, v49
v_cvt_pk_bf16_f32 v55, v50, v51
s_nop 0
v_mov_b32_dpp v48, v54 quad_perm:[0,1,0,1] row_mask:0xf bank_mask:0xf
v_mov_b32_dpp v49, v55 quad_perm:[0,1,0,1] row_mask:0xf bank_mask:0xf
v_mov_b32_dpp v50, v54 quad_perm:[2,3,2,3] row_mask:0xf bank_mask:0xf
v_mov_b32_dpp v51, v55 quad_perm:[2,3,2,3] row_mask:0xf bank_mask:0xf
v_mov_b64 v[20:21], s[44:45]
v_mov_b64 v[22:23], s[44:45]
v_mfma_f32_16x16x32_bf16 v[8:11], v[56:59], v[48:51], 0
v_mfma_f32_16x16x32_bf16 v[12:15], v[60:63], v[48:51], 0
v_mfma_f32_16x16x32_bf16 v[16:19], v[20:23], v[48:51], 0
v_mov_b64 v[54:55], s[46:47]
v_exp_f32_dpp v44, v46 quad_perm:[0,1,0,1] row_mask:0xf bank_mask:0xf
v_exp_f32_dpp v45, v47 quad_perm:[0,1,0,1] row_mask:0xf bank_mask:0xf
s_nop 0
v_cvt_pk_bf16_f32 v52, v44, v45
v_cvt_pk_bf16_f32 v53, v44, v45
s_nop 1
v_mfma_f32_16x16x16_bf16 v[16:19], v[54:55], v[52:53], v[16:19]
v_mfma_f32_16x16x16_bf16 v[8:11], v[24:25], v[52:53], v[8:11]
v_mfma_f32_16x16x16_bf16 v[12:15], v[26:27], v[52:53], v[12:15]
s_nop 5
v_rcp_f32 v18, v16
s_nop 0
v_cndmask_b32 v8, v12, v8, s[42:43]
v_mul_f32 v8, v8, v18
v_cndmask_b32 v9, v13, v9, s[42:43]
v_mul_f32 v9, v9, v18
v_cndmask_b32 v10, v14, v10, s[42:43]
v_mul_f32 v10, v10, v18
v_cndmask_b32 v11, v15, v11, s[42:43]
v_mul_f32 v11, v11, v18
v_cvt_pk_bf16_f32 v12, v8, v9
v_cvt_pk_bf16_f32 v13, v10, v11
s_branch back_10103
exit_10104:
global_load_dwordx4 v[32:35], v0, s[68:69] offset:-4096 sc1
global_load_dwordx4 v[36:39], v0, s[68:69] offset:0 sc1
s_add_u32 s30, s30, 1
s_cmp_gt_u32 s30, 262144
s_cbranch_scc1 L_fail
s_waitcnt vmcnt(1)
v_bitop3_b32 v44, v32, v34, s18 bitop3:0x7e
s_waitcnt vmcnt(0)
v_bitop3_b32 v45, v36, v38, s18 bitop3:0x7e
v_bitop3_b32 v44, v44, v45, s19 bitop3:0xa8
v_cmp_ne_u32 vcc, 0, v44
s_cbranch_vccnz exit_10104
ds_write_b128 v0, v[32:35] offset:2048
ds_write_b128 v0, v[36:39] offset:6144
s_waitcnt lgkmcnt(0)
s_barrier
s_barrier
s_add_u32 s36, s36, 1
s_cmp_lt_u32 s36, 2
s_cbranch_scc1 layer_10100
s_endpgm
wave_10071:
layer_10113:
s_lshl_b32 s17, s36, 6
s_mul_i32 s27, s36, 35651584
s_mul_i32 s28, s14, 16384
s_add_u32 s27, s27, s28
s_add_u32 s20, s27, 16789504
s_mul_i32 s27, s17, 10240
s_add_u32 s27, s27, s24
s_add_u32 s21, s27, s25
s_mov_b32 s19, 0
s_mov_b32 s33, s6
s_add_u32 s34, s17, 1
s_add_u32 s31, s17, 63
s_add_u32 s32, s17, 64
s_mov_b32 s27, s20
v_mov_b32 v7, 0
s_add_u32 s68, s4, 416768
s_addc_u32 s69, s5, 0
s_add_u32 s72, s4, 400384
s_addc_u32 s73, s5, 0
s_add_u32 s70, s4, 420864
s_addc_u32 s71, s5, 0
s_add_u32 s74, s4, 404480
s_addc_u32 s75, s5, 0
s_add_u32 s58, s4, s20
s_addc_u32 s59, s5, 0
global_load_dwordx4 v[64:67], v0, s[76:77] offset:-4096 sc1
global_load_dwordx4 v[68:71], v0, s[76:77] offset:-3072 sc1
global_load_dwordx4 v[72:75], v0, s[76:77] offset:-2048 sc1
global_load_dwordx4 v[76:79], v0, s[76:77] offset:-1024 sc1
global_load_dwordx4 v[80:83], v0, s[78:79] offset:-4096 sc1
global_load_dwordx4 v[84:87], v0, s[78:79] offset:-3072 sc1
global_load_dwordx4 v[48:51], v0, s[76:77] offset:2048 sc1
global_load_dwordx4 v[52:55], v0, s[76:77] offset:3072 sc1
global_load_dwordx4 v[56:59], v0, s[76:77] offset:0 sc1
global_load_dwordx4 v[60:63], v0, s[76:77] offset:1024 sc1
v_mov_b64 v[8:9], 0
v_mov_b64 v[10:11], 0
v_mov_b64 v[12:13], 0
v_mov_b64 v[14:15], 0
v_mov_b64 v[16:17], 0
v_mov_b64 v[18:19], 0
v_mov_b64 v[20:21], 0
v_mov_b64 v[22:23], 0
v_mov_b64 v[24:25], 0
v_mov_b64 v[26:27], 0
v_mov_b64 v[28:29], 0
v_mov_b64 v[30:31], 0
s_barrier
v_and_b32 v7, 128, v0
v_add_u32 v7, s22, v7
s_mov_b32 exec_hi, 0
v_and_b32 v7, 511, v0
v_lshl_add_u32 v7, v7, 3, s27
s_mov_b32 exec_hi, -1
global_load_dwordx4 v[32:35], v0, s[68:69] offset:-4096 sc1
global_load_dwordx4 v[36:39], v0, s[68:69] offset:0 sc1
s_mov_b32 s30, 0
s_waitcnt vmcnt(0)
.p2align 6
gather_10114:
s_waitcnt vmcnt(3)
rt_10119_b:
v_smfmac_f32_16x16x64_bf16 v[12:15], v[32:35], v[72:79], v1
ds_write_b128 v0, v[32:35] offset:3072
v_smfmac_f32_16x16x64_bf16 v[8:11], v[32:35], v[64:71], v1
v_bitop3_b32 v44, v32, v34, s18 bitop3:0x7e
v_smfmac_f32_16x16x64_bf16 v[20:23], v[32:35], v[48:55], v1
s_waitcnt vmcnt(2)
ds_write_b128 v0, v[36:39] offset:7168
v_bitop3_b32 v45, v36, v38, s18 bitop3:0x7e
v_smfmac_f32_16x16x64_bf16 v[16:19], v[32:35], v[56:63], v1
v_bitop3_b32 v44, v44, v45, s19 bitop3:0xa8
v_cmp_ne_u32 vcc, 0, v44
v_smfmac_f32_16x16x64_bf16 v[28:31], v[32:35], a[8:15], v1
s_cbranch_vccnz rt_10119
ds_read_b128 v[52:55], v2 offset:3072
v_smfmac_f32_16x16x64_bf16 v[8:11], v[36:39], a[16:23], v1
s_waitcnt lgkmcnt(1)
ds_read_b128 v[60:63], v2 offset:1024
global_load_dwordx4 v[64:67], v0, s[78:79] offset:-2048 sc1
ds_read_b128 v[56:59], v2 offset:0
v_smfmac_f32_16x16x64_bf16 v[24:27], v[32:35], a[0:7], v1
ds_read_b128 v[48:51], v2 offset:2048
s_barrier
ds_read_b128 v[40:43], v0 offset:2048
v_smfmac_f32_16x16x64_bf16 v[20:23], v[36:39], a[40:47], v1
s_mov_b64 s[68:69], s[72:73]
ds_read_b128 v[44:47], v0 offset:6144
global_load_dwordx4 v[68:71], v0, s[78:79] offset:-1024 sc1
v_smfmac_f32_16x16x64_bf16 v[16:19], v[36:39], a[32:39], v1
s_xor_b32 s18, s18, 1
ds_read_b128 v[32:35], v0 offset:1024
s_waitcnt lgkmcnt(4)
v_smfmac_f32_16x16x64_bf16 v[24:27], v[36:39], v[56:63], v1
ds_read_b128 v[56:59], v2 offset:4096
v_smfmac_f32_16x16x64_bf16 v[12:15], v[36:39], a[24:31], v1
ds_read_b128 v[60:63], v2 offset:5120
s_waitcnt lgkmcnt(4)
s_waitcnt vmcnt(2)
v_smfmac_f32_16x16x64_bf16 v[12:15], v[40:43], v[80:87], v1
ds_read_b128 v[84:87], v2 offset:7168
s_waitcnt lgkmcnt(4)
v_smfmac_f32_16x16x64_bf16 v[28:31], v[36:39], v[48:55], v1
ds_read_b128 v[80:83], v2 offset:6144
global_load_dwordx4 v[72:75], v0, s[78:79] offset:0 sc1
v_smfmac_f32_16x16x64_bf16 v[8:11], v[40:43], a[48:55], v1
ds_read_b128 v[36:39], v0 offset:5120
global_load_dwordx4 v[76:79], v0, s[78:79] offset:1024 sc1
v_smfmac_f32_16x16x64_bf16 v[12:15], v[44:47], a[64:71], v1
ds_read_b128 v[40:43], v0 offset:0
s_waitcnt lgkmcnt(5)
v_smfmac_f32_16x16x64_bf16 v[8:11], v[44:47], a[56:63], v1
ds_read_b128 v[44:47], v0 offset:4096
s_waitcnt lgkmcnt(5)
v_smfmac_f32_16x16x64_bf16 v[8:11], v[32:35], v[56:63], v1
s_waitcnt lgkmcnt(3)
ds_read_b128 v[60:63], v2 offset:9216
v_smfmac_f32_16x16x64_bf16 v[12:15], v[32:35], a[72:79], v1
s_waitcnt lgkmcnt(3)
ds_read_b128 v[56:59], v2 offset:8192
v_smfmac_f32_16x16x64_bf16 v[12:15], v[36:39], v[80:87], v1
ds_read_b128 v[32:35], v0 offset:9216
v_smfmac_f32_16x16x64_bf16 v[8:11], v[36:39], a[80:87], v1
s_waitcnt lgkmcnt(4)
ds_read_b128 v[80:83], v2 offset:10240
global_load_dwordx4 v[48:51], v0, s[58:59] offset:0 nt sc1
ds_read_b128 v[84:87], v2 offset:11264
v_smfmac_f32_16x16x64_bf16 v[8:11], v[40:43], a[88:95], v1
s_add_u32 s20, s20, 524288
s_waitcnt lgkmcnt(5)
ds_read_b128 v[36:39], v0 offset:8192
v_smfmac_f32_16x16x64_bf16 v[12:15], v[40:43], a[96:103], v1
s_waitcnt lgkmcnt(4)
ds_read_b128 v[40:43], v0 offset:2048
v_smfmac_f32_16x16x64_bf16 v[8:11], v[44:47], v[56:63], v1
global_load_dwordx4 v[52:55], v0, s[58:59] offset:1024 nt sc1
ds_read_b128 v[60:63], v2 offset:13312
v_smfmac_f32_16x16x64_bf16 v[12:15], v[44:47], a[104:111], v1
s_waitcnt lgkmcnt(4)
ds_read_b128 v[56:59], v2 offset:12288
s_waitcnt lgkmcnt(4)
v_smfmac_f32_16x16x64_bf16 v[12:15], v[32:35], v[80:87], v1
s_waitcnt vmcnt(4)
ds_read_b128 v[80:83], v2 offset:14336
s_mov_b64 vcc, s[42:43]
v_smfmac_f32_16x16x64_bf16 v[8:11], v[32:35], a[112:119], v1
s_waitcnt lgkmcnt(4)
ds_read_b128 v[84:87], v2 offset:15360
v_add_u32 v44, s24, v0
v_smfmac_f32_16x16x64_bf16 v[8:11], v[36:39], v[64:71], v1
s_nop 0
ds_read_b128 v[32:35], v0 offset:6144
global_load_dwordx4 v[64:67], v0, s[78:79] offset:2048 sc1
v_smfmac_f32_16x16x64_bf16 v[12:15], v[36:39], a[120:127], v1
s_nop 0
ds_read_b128 v[36:39], v0 offset:1024
s_waitcnt lgkmcnt(4)
ds_read_b128 v[44:47], v44
v_add_f32 v8, v8, v10
v_smfmac_f32_16x16x64_bf16 v[16:19], v[40:43], v[56:63], v1
ds_read_b128 v[60:63], v2 offset:17408
global_load_dwordx4 v[68:71], v0, s[78:79] offset:3072 sc1
ds_read_b128 v[56:59], v2 offset:16384
v_mul_f32 v8, s35, v8
v_smfmac_f32_16x16x64_bf16 v[20:23], v[40:43], a[128:135], v1
s_waitcnt lgkmcnt(4)
ds_read_b128 v[40:43], v0 offset:5120
v_add_f32 v12, v12, v14
v_smfmac_f32_16x16x64_bf16 v[20:23], v[32:35], v[80:87], v1
s_waitcnt lgkmcnt(4)
ds_read_b128 v[80:83], v2 offset:18432
v_add_f32 v13, v13, v15
v_smfmac_f32_16x16x64_bf16 v[16:19], v[32:35], a[136:143], v1
ds_read_b128 v[32:35], v0 offset:0
v_add_f32 v9, v9, v11
v_smfmac_f32_16x16x64_bf16 v[20:23], v[36:39], a[152:159], v1
s_waitcnt vmcnt(4)
ds_read_b128 v[84:87], v2 offset:19456
v_mul_f32 v13, s35, v13
v_mul_f32 v12, s35, v12
v_mul_f32 v9, s35, v9
v_cvt_pk_bf16_f32 v8, v8, v9
v_cvt_pk_bf16_f32 v12, v12, v13
v_smfmac_f32_16x16x64_bf16 v[16:19], v[36:39], a[144:151], v1
s_waitcnt lgkmcnt(3)
ds_read_b128 v[36:39], v0 offset:4096
ds_write2_b32 v3, v8, v12 offset0:0 offset1:128
v_smfmac_f32_16x16x64_bf16 v[16:19], v[40:43], v[72:79], v1
global_load_dwordx4 v[72:75], v0, s[80:81] offset:-4096 sc1
v_smfmac_f32_16x16x64_bf16 v[20:23], v[40:43], v[56:63], v1
s_waitcnt lgkmcnt(3)
global_load_dwordx4 v[76:79], v0, s[80:81] offset:-3072 sc1
v_smfmac_f32_16x16x64_bf16 v[20:23], v[32:35], a[168:175], v1
ds_read_b128 v[40:43], v0 offset:9216
global_load_dwordx4 v[56:59], v0, s[58:59] offset:2048 nt sc1
global_load_dwordx4 v[60:63], v0, s[58:59] offset:3072 nt sc1
v_smfmac_f32_16x16x64_bf16 v[16:19], v[32:35], a[160:167], v1
s_waitcnt lgkmcnt(1)
ds_read_b128 v[32:35], v0 offset:8192
v_swap_b32 v45, v46
v_smfmac_f32_16x16x64_bf16 v[16:19], v[36:39], a[176:183], v1
s_barrier
ds_read_b64_tr_b16 v[10:11], v4 offset:2560
v_smfmac_f32_16x16x64_bf16 v[20:23], v[36:39], v[80:87], v1
s_waitcnt lgkmcnt(2)
ds_read_b128 v[36:39], v0 offset:9216
ds_read_b64_tr_b16 v[14:15], v4 offset:3584
v_smfmac_f32_16x16x64_bf16 v[20:23], v[40:43], a[192:199], v1
ds_read_b64_tr_b16 v[12:13], v4 offset:3072
buffer_store_dwordx4 v[44:47], v0, s[4:7], s21 offen sc1
s_waitcnt lgkmcnt(4)
ds_read_b64_tr_b16 v[8:9], v4 offset:2048
v_smfmac_f32_16x16x64_bf16 v[16:19], v[40:43], a[184:191], v1
s_waitcnt vmcnt(6)
ds_read_b128 v[40:43], v0 offset:8192
v_mov_b32 v47, s17
v_smfmac_f32_16x16x64_bf16 v[16:19], v[32:35], a[200:207], v1
s_mov_b64 exec, 1
buffer_store_dword v47, off, s[4:7], s33 sc1
s_mov_b64 exec, -1
v_smfmac_f32_16x16x64_bf16 v[20:23], v[32:35], a[208:215], v1
s_waitcnt lgkmcnt(3)
ds_read_b128 v[80:83], v2 offset:20480
global_load_dword v7, v7, s[4:5] sc1
ds_read_b128 v[84:87], v2 offset:21504
v_smfmac_f32_16x16x64_bf16 v[24:27], v[36:39], a[216:223], v1
s_waitcnt lgkmcnt(3)
ds_read_b128 v[32:35], v0 offset:2048
v_add_f32 v16, v16, v18
v_mfma_f32_16x16x32_bf16 v[44:47], v[48:51], v[8:11], 0
v_bfe_u32 v48, v0, 5, 1
v_add_f32 v17, v17, v19
v_mfma_f32_16x16x32_bf16 v[44:47], v[52:55], v[12:15], v[44:47]
s_nop 0
v_lshl_add_u32 v48, v48, 3, v5
v_add_f32 v20, v20, v22
v_smfmac_f32_16x16x64_bf16 v[28:31], v[36:39], a[224:231], v1
s_waitcnt lgkmcnt(3)
ds_read_b128 v[36:39], v0 offset:6144
v_cvt_pk_bf16_f32 v16, v16, v17
v_add_f32 v21, v21, v23
v_cndmask_b32_dpp v44, v46, v44, vcc quad_perm:[0,1,0,1] row_mask:0xf bank_mask:0xf
v_cvt_pk_bf16_f32 v20, v20, v21
v_smfmac_f32_16x16x64_bf16 v[24:27], v[40:43], a[232:239], v1
s_waitcnt lgkmcnt(1)
ds_write2_b32 v3, v16, v20 offset0:1 offset1:129
v_cndmask_b32_dpp v45, v47, v45, vcc quad_perm:[0,1,0,1] row_mask:0xf bank_mask:0xf
v_xor_b32 v48, 128, v48
v_smfmac_f32_16x16x64_bf16 v[28:31], v[40:43], v[80:87], v1
s_add_u32 s17, s17, 1
ds_write_b64 v48, v[44:45] offset:7680
v_smfmac_f32_16x16x64_bf16 v[24:27], v[32:35], a[240:247], v1
s_add_u32 s21, s21, 10240
ds_read_b128 v[40:43], v0 offset:1024
v_smfmac_f32_16x16x64_bf16 v[28:31], v[32:35], a[248:255], v1
s_waitcnt vmcnt(7)
ds_read_b128 v[32:35], v0 offset:5120
s_waitcnt lgkmcnt(4)
v_smfmac_f32_16x16x64_bf16 v[24:27], v[36:39], v[64:71], v1
ds_read_b128 v[80:83], v2 offset:22528
global_load_dwordx4 v[64:67], v0, s[76:77] offset:-4096 sc1
v_smfmac_f32_16x16x64_bf16 v[28:31], v[36:39], v[88:95], v1
s_waitcnt lgkmcnt(3)
ds_read_b128 v[36:39], v0 offset:0
s_barrier
ds_read_b128 v[52:55], v6 offset:7168
s_waitcnt lgkmcnt(4)
v_smfmac_f32_16x16x64_bf16 v[28:31], v[40:43], v[104:111], v1
s_waitcnt lgkmcnt(3)
ds_read_b128 v[48:51], v6 offset:6144
v_smfmac_f32_16x16x64_bf16 v[24:27], v[40:43], v[96:103], v1
ds_read_b128 v[40:43], v0 offset:4096
ds_read_b64_tr_b16 v[16:17], v4 offset:2048
v_smfmac_f32_16x16x64_bf16 v[24:27], v[32:35], v[112:119], v1
ds_read_b64_tr_b16 v[18:19], v4 offset:2560
s_waitcnt lgkmcnt(5)
ds_read_b64_tr_b16 v[14:15], v4 offset:1536
v_smfmac_f32_16x16x64_bf16 v[28:31], v[32:35], v[120:127], v1
s_waitcnt vmcnt(4)
ds_read_b64_tr_b16 v[8:9], v4 offset:0
ds_read_b64_tr_b16 v[12:13], v4 offset:1024
v_smfmac_f32_16x16x64_bf16 v[28:31], v[36:39], v[136:143], v1
s_waitcnt lgkmcnt(6)
ds_read_b64_tr_b16 v[10:11], v4 offset:512
v_add_f32 v49, v49, v53
v_smfmac_f32_16x16x64_bf16 v[24:27], v[36:39], v[128:135], v1
s_waitcnt lgkmcnt(6)
ds_read_b64_tr_b16 v[20:21], v4 offset:3072
v_add_f32 v50, v50, v54
v_smfmac_f32_16x16x64_bf16 v[28:31], v[40:43], v[144:151], v1
ds_read_b64_tr_b16 v[22:23], v4 offset:3584
v_add_f32 v51, v51, v55
v_exp_f32 v51, v51
v_exp_f32 v49, v49
v_smfmac_f32_16x16x64_bf16 v[24:27], v[40:43], v[72:79], v1
s_waitcnt lgkmcnt(2)
ds_read_b128 v[84:87], v2 offset:23552
v_add_f32 v48, v48, v52
v_exp_f32 v48, v48
v_exp_f32 v50, v50
v_mfma_f32_16x16x32_bf16 v[44:47], v[8:11], v[8:11], 0
s_waitcnt lgkmcnt(1)
v_cvt_pk_bf16_f32 v55, v50, v51
v_cvt_pk_bf16_f32 v54, v48, v49
v_mfma_f32_16x16x32_bf16 v[44:47], v[12:15], v[12:15], v[44:47]
v_mov_b32_dpp v51, v55 quad_perm:[2,3,2,3] row_mask:0xf bank_mask:0xf
v_mov_b32_dpp v50, v54 quad_perm:[2,3,2,3] row_mask:0xf bank_mask:0xf
v_mfma_f32_16x16x32_bf16 v[44:47], v[16:19], v[16:19], v[44:47]
v_mov_b32_dpp v49, v55 quad_perm:[0,1,0,1] row_mask:0xf bank_mask:0xf
v_mov_b32_dpp v48, v54 quad_perm:[0,1,0,1] row_mask:0xf bank_mask:0xf
v_mfma_f32_16x16x32_bf16 v[44:47], v[20:23], v[20:23], v[44:47]
v_mov_b64 v[20:21], s[44:45]
v_cvt_pk_bf16_f32 v24, v24, v25
v_mfma_f32_16x16x32_bf16 v[8:11], v[56:59], v[48:51], 0
s_add_u32 s34, s17, 2
v_mov_b64 v[22:23], s[44:45]
v_cvt_pk_bf16_f32 v25, v26, v27
v_mfma_f32_16x16x32_bf16 v[12:15], v[60:63], v[48:51], 0
s_nop 0
v_exp_f32_dpp v44, v46 quad_perm:[0,1,0,1] row_mask:0xf bank_mask:0xf
v_exp_f32_dpp v45, v47 quad_perm:[0,1,0,1] row_mask:0xf bank_mask:0xf
v_mfma_f32_16x16x32_bf16 v[16:19], v[20:23], v[48:51], 0
s_waitcnt lgkmcnt(0)
v_cvt_pk_bf16_f32 v52, v44, v45
v_cvt_pk_bf16_f32 v53, v44, v45
v_mov_b64 v[54:55], s[46:47]
v_cvt_pk_bf16_f32 v27, v30, v31
v_mfma_f32_16x16x16_bf16 v[8:11], v[24:25], v[52:53], v[8:11]
s_mov_b32 s19, 1
global_load_dwordx4 v[68:71], v0, s[76:77] offset:-3072 sc1
v_cvt_pk_bf16_f32 v26, v28, v29
v_mfma_f32_16x16x16_bf16 v[16:19], v[54:55], v[52:53], v[16:19]
s_min_u32 s34, s34, s32
v_mov_b64 v[38:39], 0
v_mov_b64 v[36:37], 0
v_mfma_f32_16x16x16_bf16 v[12:15], v[26:27], v[52:53], v[12:15]
s_nop 0
ds_read_b128 v[28:31], v0 offset:56320
v_bfe_u32 v32, v0, 5, 1
v_mov_b64 v[34:35], 0
v_rcp_f32 v18, v16
v_subrev_u32 v17, s37, v16
v_cmp_lt_u32 vcc, s38, v17
v_lshl_add_u32 v32, v32, 3, v5
v_cndmask_b32 v9, v13, v9, s[42:43]
v_cndmask_b32 v8, v12, v8, s[42:43]
v_cndmask_b32 v10, v14, v10, s[42:43]
v_mul_f32 v10, v10, v18
v_mul_f32 v9, v9, v18
v_mul_f32 v8, v8, v18
v_cndmask_b32 v11, v15, v11, s[42:43]
v_mul_f32 v11, v11, v18
v_cvt_pk_bf16_f32 v13, v10, v11
v_cvt_pk_bf16_f32 v12, v8, v9
s_cbranch_vccnz rare_10115
back_10116:
ds_read_b128 v[16:19], v0 offset:53248
ds_write_b64 v32, v[12:13] offset:1536
v_mov_b64 v[42:43], 0
v_mov_b64 v[32:33], 0
v_mov_b32_dpp v10, v12 quad_perm:[2,3,2,3] row_mask:0xf bank_mask:0xf
v_mov_b64 v[54:55], 0
v_mov_b32_dpp v8, v12 quad_perm:[0,1,0,1] row_mask:0xf bank_mask:0xf
v_mov_b32_dpp v11, v13 quad_perm:[2,3,2,3] row_mask:0xf bank_mask:0xf
v_mov_b32_dpp v9, v13 quad_perm:[0,1,0,1] row_mask:0xf bank_mask:0xf
v_mov_b64 v[52:53], 0
v_mov_b64 v[40:41], 0
v_smfmac_f32_16x16x64_bf16 v[36:39], v[8:11], v[80:87], v1
ds_read_b128 v[24:27], v0 offset:55296
global_load_dwordx4 v[72:75], v0, s[76:77] offset:-2048 sc1
ds_read_b128 v[20:23], v0 offset:54272
v_smfmac_f32_16x16x64_bf16 v[40:43], v[8:11], v[152:159], v1
s_waitcnt lgkmcnt(2)
ds_read_b128 v[80:83], v0 offset:57344
s_barrier
ds_read_b128 v[56:59], v5 offset:1024
v_smfmac_f32_16x16x64_bf16 v[32:35], v[8:11], v[176:183], v1
s_add_u32 s27, s20, 524288
ds_read_b128 v[60:63], v5 offset:512
v_mov_b64 v[48:49], 0
v_mov_b64 v[50:51], 0
v_smfmac_f32_16x16x64_bf16 v[52:55], v[8:11], v[168:175], v1
s_add_u32 s58, s4, s20
ds_read_b128 v[12:15], v5 offset:0
v_lshrrev_b32 v44, 8, v0
v_smfmac_f32_16x16x64_bf16 v[48:51], v[8:11], v[160:167], v1
s_waitcnt lgkmcnt(4)
ds_read_b128 v[84:87], v0 offset:58368
global_load_dwordx4 v[76:79], v0, s[76:77] offset:-1024 sc1
v_bfe_u32 v45, v0, 1, 7
s_waitcnt lgkmcnt(3)
v_smfmac_f32_16x16x64_bf16 v[36:39], v[56:59], v[16:23], v1
s_addc_u32 s59, s5, 0
ds_read_b128 v[16:19], v0 offset:59392
s_waitcnt lgkmcnt(3)
v_smfmac_f32_16x16x64_bf16 v[36:39], v[60:63], v[24:31], v1
ds_read_b128 v[28:31], v0 offset:62464
s_waitcnt lgkmcnt(3)
v_smfmac_f32_16x16x64_bf16 v[36:39], v[12:15], v[184:191], v1
ds_read_b128 v[20:23], v0 offset:60416
s_waitcnt lgkmcnt(3)
v_smfmac_f32_16x16x64_bf16 v[40:43], v[56:59], v[80:87], v1
ds_read_b128 v[24:27], v0 offset:61440
v_lshl_or_b32 v44, v44, 12, v45
v_smfmac_f32_16x16x64_bf16 v[40:43], v[60:63], v[192:199], v1
s_nop 0
ds_read_b128 v[84:87], v0 offset:64512
v_cvt_pk_bf16_f32 v36, v36, v37
v_and_or_b32 v36, v36, -2, s18
v_cvt_pk_bf16_f32 v37, v38, v39
v_smfmac_f32_16x16x64_bf16 v[40:43], v[12:15], v[200:207], v1
s_and_b32 s33, s17, 3
global_store_dwordx2 v44, v[36:37], s[48:49]
s_waitcnt lgkmcnt(2)
v_smfmac_f32_16x16x64_bf16 v[48:51], v[56:59], v[16:23], v1
ds_read_b128 v[80:83], v0 offset:63488
s_waitcnt lgkmcnt(2)
v_smfmac_f32_16x16x64_bf16 v[48:51], v[60:63], v[24:31], v1
s_mov_b32 s30, 0
v_cvt_pk_bf16_f32 v40, v40, v41
v_cvt_pk_bf16_f32 v41, v42, v43
v_and_or_b32 v40, v40, -2, s18
v_smfmac_f32_16x16x64_bf16 v[48:51], v[12:15], v[208:215], v1
global_store_dwordx2 v44, v[40:41], s[50:51]
s_waitcnt lgkmcnt(1)
v_smfmac_f32_16x16x64_bf16 v[32:35], v[56:59], v[232:239], v1
s_nop 0
s_waitcnt lgkmcnt(0)
v_smfmac_f32_16x16x64_bf16 v[52:55], v[56:59], v[80:87], v1
s_nop 1
v_cvt_pk_bf16_f32 v48, v48, v49
v_smfmac_f32_16x16x64_bf16 v[52:55], v[60:63], v[216:223], v1
s_cselect_b32 s33, s6, s23
v_and_or_b32 v48, v48, -2, s18
v_cvt_pk_bf16_f32 v49, v50, v51
v_smfmac_f32_16x16x64_bf16 v[52:55], v[12:15], v[224:231], v1
global_store_dwordx2 v44, v[48:49], s[52:53]
v_smfmac_f32_16x16x64_bf16 v[32:35], v[60:63], v[240:247], v1
s_nop 2
v_smfmac_f32_16x16x64_bf16 v[32:35], v[12:15], v[248:255], v1
s_nop 1
v_cvt_pk_bf16_f32 v52, v52, v53
v_and_or_b32 v52, v52, -2, s18
v_cvt_pk_bf16_f32 v53, v54, v55
s_nop 0
global_store_dwordx2 v44, v[52:53], s[54:55]
s_nop 0
v_cvt_pk_bf16_f32 v32, v32, v33
v_cvt_pk_bf16_f32 v33, v34, v35
v_and_or_b32 v32, v32, -2, s18
global_store_dwordx2 v44, v[32:33], s[56:57]
nored_10122:
s_waitcnt vmcnt(9)
v_cmp_gt_u32 vcc, s34, v7
s_cmp_eq_u32 vcc_hi, 0
s_cbranch_scc1 kv_10126
s_mov_b32 s30, 0
kv_10125:
v_and_b32 v7, 128, v0
buffer_load_dword v7, v7, s[4:7], s22 offen sc1
s_add_u32 s30, s30, 1
s_cmp_gt_u32 s30, 262144
s_cbranch_scc1 L_fail
s_waitcnt vmcnt(0)
v_cmp_gt_u32 vcc, s34, v7
s_cbranch_vccnz kv_10125
kv_10126:
v_and_b32 v7, 128, v0
v_add_u32 v7, s22, v7
s_mov_b32 exec_hi, 0
v_and_b32 v7, 511, v0
v_lshl_add_u32 v7, v7, 3, s27
s_mov_b32 exec_hi, -1
s_nop 15
s_nop 15
s_nop 15
s_nop 15
s_nop 15
s_nop 1
global_load_dwordx4 v[56:59], v0, s[76:77] offset:0 sc1
global_load_dwordx4 v[60:63], v0, s[76:77] offset:1024 sc1
global_load_dwordx4 v[48:51], v0, s[76:77] offset:2048 sc1
global_load_dwordx4 v[52:55], v0, s[76:77] offset:3072 sc1
join_10123:
s_barrier
s_nop 15
s_nop 15
s_nop 7
s_barrier
global_load_dwordx4 v[32:35], v0, s[68:69] offset:-4096 sc1
s_nop 10
global_load_dwordx4 v[36:39], v0, s[68:69] offset:0 sc1
s_barrier
global_load_dwordx4 v[80:83], v0, s[78:79] offset:-4096 sc1
global_load_dwordx4 v[84:87], v0, s[78:79] offset:-3072 sc1
v_mov_b64 v[8:9], 0
v_mov_b64 v[10:11], 0
v_mov_b64 v[12:13], 0
v_mov_b64 v[14:15], 0
v_mov_b64 v[16:17], 0
v_mov_b64 v[18:19], 0
v_mov_b64 v[20:21], 0
v_mov_b64 v[22:23], 0
v_mov_b64 v[24:25], 0
v_mov_b64 v[26:27], 0
v_mov_b64 v[28:29], 0
v_mov_b64 v[30:31], 0
s_mov_b32 s30, 0
s_cmp_eq_u32 s17, s31
s_cbranch_scc0 gather_10114
s_branch exit_10117
rt_10119:
global_load_dwordx4 v[32:35], v0, s[68:69] offset:-4096 sc1
global_load_dwordx4 v[36:39], v0, s[68:69] offset:0 sc1
s_add_u32 s30, s30, 1
s_cmp_gt_u32 s30, 262144
s_cbranch_scc1 L_fail
s_mov_b64 exec, 1
global_store_dword v0, v0, s[62:63]
global_store_dword v0, v0, s[62:63]
s_mov_b64 exec, -1
v_mov_b64 v[8:9], 0
v_mov_b64 v[10:11], 0
v_mov_b64 v[12:13], 0
v_mov_b64 v[14:15], 0
v_mov_b64 v[16:17], 0
v_mov_b64 v[18:19], 0
v_mov_b64 v[20:21], 0
v_mov_b64 v[22:23], 0
v_mov_b64 v[24:25], 0
v_mov_b64 v[26:27], 0
v_mov_b64 v[28:29], 0
v_mov_b64 v[30:31], 0
s_branch gather_10114
rare_10115:
ds_read_b128 v[48:51], v6 offset:6144
ds_read_b128 v[52:55], v6 offset:7168
s_waitcnt lgkmcnt(0)
v_add_f32 v48, v48, v52
v_add_f32 v49, v49, v53
v_add_f32 v50, v50, v54
v_add_f32 v51, v51, v55
v_mov_b32_dpp v46, v46 quad_perm:[0,1,0,1] row_mask:0xf bank_mask:0xf
v_mov_b32_dpp v47, v47 quad_perm:[0,1,0,1] row_mask:0xf bank_mask:0xf
v_max3_f32 v19, v48, v49, v50
v_max3_f32 v19, v19, v51, v46
v_max_f32 v19, v19, v47
s_nop 1
v_max_f32_dpp v19, v19, v19 quad_perm:[2,3,0,1] row_mask:0xf bank_mask:0xf
v_mov_b32 v44, v19
s_nop 1
v_permlane32_swap_b32 v19, v44
v_max_f32 v19, v19, v44
v_mov_b32 v44, v19
s_nop 1
v_permlane16_swap_b32 v19, v44
v_max_f32 v19, v19, v44
v_sub_f32 v48, v48, v19
v_sub_f32 v49, v49, v19
v_sub_f32 v50, v50, v19
v_sub_f32 v51, v51, v19
v_sub_f32 v46, v46, v19
v_sub_f32 v47, v47, v19
v_exp_f32 v48, v48
v_exp_f32 v49, v49
v_exp_f32 v50, v50
v_exp_f32 v51, v51
v_cvt_pk_bf16_f32 v54, v48, v49
v_cvt_pk_bf16_f32 v55, v50, v51
s_nop 0
v_mov_b32_dpp v48, v54 quad_perm:[0,1,0,1] row_mask:0xf bank_mask:0xf
v_mov_b32_dpp v49, v55 quad_perm:[0,1,0,1] row_mask:0xf bank_mask:0xf
v_mov_b32_dpp v50, v54 quad_perm:[2,3,2,3] row_mask:0xf bank_mask:0xf
v_mov_b32_dpp v51, v55 quad_perm:[2,3,2,3] row_mask:0xf bank_mask:0xf
v_mov_b64 v[20:21], s[44:45]
v_mov_b64 v[22:23], s[44:45]
v_mfma_f32_16x16x32_bf16 v[8:11], v[56:59], v[48:51], 0
v_mfma_f32_16x16x32_bf16 v[12:15], v[60:63], v[48:51], 0
v_mfma_f32_16x16x32_bf16 v[16:19], v[20:23], v[48:51], 0
v_mov_b64 v[54:55], s[46:47]
v_exp_f32_dpp v44, v46 quad_perm:[0,1,0,1] row_mask:0xf bank_mask:0xf
v_exp_f32_dpp v45, v47 quad_perm:[0,1,0,1] row_mask:0xf bank_mask:0xf
s_nop 0
v_cvt_pk_bf16_f32 v52, v44, v45
v_cvt_pk_bf16_f32 v53, v44, v45
s_nop 1
v_mfma_f32_16x16x16_bf16 v[16:19], v[54:55], v[52:53], v[16:19]
v_mfma_f32_16x16x16_bf16 v[8:11], v[24:25], v[52:53], v[8:11]
v_mfma_f32_16x16x16_bf16 v[12:15], v[26:27], v[52:53], v[12:15]
s_nop 5
v_rcp_f32 v18, v16
s_nop 0
v_cndmask_b32 v8, v12, v8, s[42:43]
v_mul_f32 v8, v8, v18
v_cndmask_b32 v9, v13, v9, s[42:43]
v_mul_f32 v9, v9, v18
v_cndmask_b32 v10, v14, v10, s[42:43]
v_mul_f32 v10, v10, v18
v_cndmask_b32 v11, v15, v11, s[42:43]
v_mul_f32 v11, v11, v18
v_cvt_pk_bf16_f32 v12, v8, v9
v_cvt_pk_bf16_f32 v13, v10, v11
s_branch back_10116
exit_10117:
global_load_dwordx4 v[32:35], v0, s[68:69] offset:-4096 sc1
global_load_dwordx4 v[36:39], v0, s[68:69] offset:0 sc1
s_add_u32 s30, s30, 1
s_cmp_gt_u32 s30, 262144
s_cbranch_scc1 L_fail
s_waitcnt vmcnt(1)
v_bitop3_b32 v44, v32, v34, s18 bitop3:0x7e
s_waitcnt vmcnt(0)
v_bitop3_b32 v45, v36, v38, s18 bitop3:0x7e
v_bitop3_b32 v44, v44, v45, s19 bitop3:0xa8
v_cmp_ne_u32 vcc, 0, v44
s_cbranch_vccnz exit_10117
ds_write_b128 v0, v[32:35] offset:3072
ds_write_b128 v0, v[36:39] offset:7168
s_waitcnt lgkmcnt(0)
s_barrier
v_add_u32 v44, s24, v0
ds_read_b128 v[44:47], v44
s_waitcnt lgkmcnt(0)
v_swap_b32 v45, v46
buffer_store_dwordx4 v[44:47], v0, s[4:7], s21 offen sc1
s_add_u32 s26, s17, 1
s_waitcnt vmcnt(0)
v_mov_b32 v44, s26
s_mov_b64 exec, 1
buffer_store_dword v44, off, s[4:7], s23 sc1
s_mov_b64 exec, -1
s_barrier
s_add_u32 s36, s36, 1
s_cmp_lt_u32 s36, 2
s_cbranch_scc1 layer_10113
s_endpgm
grp_10064:
s_endpgm

.section .rodata,"a"
.p2align 6
.amdhsa_kernel interleave_layers__spectral_gfnet__memory_aug_recurrent_mem_tr__prompt_kernel
  .amdhsa_next_free_vgpr 512
  .amdhsa_next_free_sgpr 102
  .amdhsa_accum_offset 256
  .amdhsa_group_segment_fixed_size 0
  .amdhsa_kernarg_size 104
  .amdhsa_user_sgpr_count 2
  .amdhsa_user_sgpr_kernarg_segment_ptr 1
  .amdhsa_system_sgpr_workgroup_id_x 1
  .amdhsa_float_denorm_mode_32 3
  .amdhsa_ieee_mode 0
.end_amdhsa_kernel
```

```asm
; @launch grid=(256,1,1) block=(256,1,1) lds=163840
.amdgcn_target "amdgcn-amd-amdhsa--gfx950"
.text
.globl interleave_layers__spectral_gfnet__memory_aug_recurrent_mem_tr__prompt_kernel
.p2align 8
.type interleave_layers__spectral_gfnet__memory_aug_recurrent_mem_tr__prompt_kernel,@function
interleave_layers__spectral_gfnet__memory_aug_recurrent_mem_tr__prompt_kernel:
s_cmp_ge_u32 s2, 256
s_cbranch_scc1 L_end
s_load_dwordx2 s[4:5], s[0:1], 96
s_load_dwordx2 s[8:9], s[0:1], 88
s_mov_b32 s6, 268435456
s_mov_b32 s7, 0x20000
s_mov_b32 s10, 256
s_mov_b32 s11, 0x20000
s_getreg_b32 s12, hwreg(HW_REG_XCC_ID, 0, 3)
v_lshrrev_b32 v1, 6, v0
s_nop 0
v_readfirstlane_b32 s13, v1
s_waitcnt lgkmcnt(0)
s_cmp_lg_u32 s13, 0
s_cbranch_scc1 reg_3
v_mov_b32 v1, 0
v_mov_b32 v2, -1
ds_write_b32 v1, v2
s_sub_u32 s15, s12, 8
s_and_b32 s15, s15, 7
s_lshl_b32 s15, s15, 4
v_mov_b32 v2, 1
s_mov_b64 exec, 1
buffer_atomic_add v2, off, s[8:11], s15 offset:16 sc0
s_mov_b64 exec, -1
s_cmp_lg_u32 s12, 7
s_cbranch_scc1 reg_6
s_waitcnt vmcnt(0)
v_readfirstlane_b32 s16, v2
s_nop 0
s_cmp_ge_u32 s16, 32
s_cbranch_scc1 reg_6
s_mov_b32 s18, 0
reg_5:
buffer_load_dword v3, off, s[8:11], 0 offset:128 sc1
s_waitcnt vmcnt(0)
v_cmp_gt_u32 vcc, 32, v3
s_cbranch_vccz reg_7
s_add_u32 s18, s18, 1
s_cmp_lt_u32 s18, 16
s_cbranch_scc1 reg_5
reg_6:
v_and_b32 v1, 15, v0
v_cmp_ne_u32 vcc, 9, v1
s_nop 1
v_cndmask_b32 v1, 10, v1, vcc
v_lshlrev_b32 v1, 4, v1
s_mov_b32 s16, 0
all_8:
buffer_load_dword v3, v1, s[8:11], 0 offen sc1
s_add_u32 s16, s16, 1
s_cmp_gt_u32 s16, 262144
s_cbranch_scc1 L_fail
all_9:
s_waitcnt vmcnt(0)
v_add_u32_dpp v4, v3, v3 quad_perm:[1,0,3,2] row_mask:0xf bank_mask:0xf
s_nop 1
v_add_u32_dpp v4, v4, v4 quad_perm:[2,3,0,1] row_mask:0xf bank_mask:0xf
s_nop 1
v_add_u32_dpp v4, v4, v4 row_ror:4 row_mask:0xf bank_mask:0xf
s_nop 1
v_add_u32_dpp v4, v4, v4 row_ror:8 row_mask:0xf bank_mask:0xf
v_cmp_ne_u32 vcc, 274, v4
s_cbranch_vccnz all_8
v_readfirstlane_b32 s17, v2
v_readlane_b32 s20, v3, 1
v_readlane_b32 s21, v3, 2
v_readlane_b32 s22, v3, 3
v_readlane_b32 s23, v3, 4
v_readlane_b32 s24, v3, 5
v_readlane_b32 s25, v3, 6
v_readlane_b32 s26, v3, 7
v_readlane_b32 s27, v3, 8
s_mov_b32 s15, 6
s_cmp_ge_u32 s25, 32
s_cselect_b32 s15, 5, s15
s_cmp_ge_u32 s24, 32
s_cselect_b32 s15, 4, s15
s_cmp_ge_u32 s23, 32
s_cselect_b32 s15, 3, s15
s_cmp_ge_u32 s22, 32
s_cselect_b32 s15, 2, s15
s_cmp_ge_u32 s21, 32
s_cselect_b32 s15, 1, s15
s_cmp_ge_u32 s20, 32
s_cselect_b32 s15, 0, s15
s_cmp_ge_u32 s27, 32
s_cselect_b32 s15, 7, s15
s_mov_b32 s16, s17
s_cmp_gt_u32 s12, 0
s_cselect_b32 s18, s20, 0
s_add_u32 s16, s16, s18
s_cmp_gt_u32 s12, 1
s_cselect_b32 s18, s21, 0
s_add_u32 s16, s16, s18
s_cmp_gt_u32 s12, 2
s_cselect_b32 s18, s22, 0
s_add_u32 s16, s16, s18
s_cmp_gt_u32 s12, 3
s_cselect_b32 s18, s23, 0
s_add_u32 s16, s16, s18
s_cmp_gt_u32 s12, 4
s_cselect_b32 s18, s24, 0
s_add_u32 s16, s16, s18
s_cmp_gt_u32 s12, 5
s_cselect_b32 s18, s25, 0
s_add_u32 s16, s16, s18
s_cmp_gt_u32 s12, 6
s_cselect_b32 s18, s26, 0
s_add_u32 s16, s16, s18
s_add_u32 s18, s16, 32
s_cmp_lt_u32 s12, s15
s_cselect_b32 s16, s18, s16
s_cmp_eq_u32 s12, s15
s_cselect_b32 s18, s17, 32
s_cmp_lt_u32 s18, 32
s_cselect_b32 s16, s18, s16
reg_7:
v_mov_b32 v1, 0
v_mov_b32 v2, s16
ds_write_b32 v1, v2
s_waitcnt lgkmcnt(0)
s_branch reg_2
reg_3:
s_cmp_lg_u32 s13, 3
s_cbranch_scc1 reg_10
s_getpc_b64 s[20:21]
L_here:
s_bfe_u32 s15, s2, 0x50003
v_and_b32 v1, 63, v0
v_lshl_add_u32 v1, v1, 5, s15
v_lshlrev_b32 v1, 7, v1
v_min_u32 v1, L_last-L_here, v1
v_mov_b32 v7, s21
v_add_co_u32 v6, vcc, s20, v1
s_nop 1
v_addc_co_u32 v7, vcc, 0, v7, vcc
global_load_dword v6, v[6:7], off
reg_10:
s_cmp_lg_u32 s13, 1
s_cbranch_scc1 reg_4
s_cmp_ge_u32 s2, 18
s_cbranch_scc1 reg_4
v_lshlrev_b32 v1, 7, v0
s_lshl_b32 s15, s2, 13
s_add_u32 s15, s15, 11526144
v_mov_b32 v4, 0
buffer_store_dword v4, v1, s[4:7], s15 offen sc1
v_mov_b32 v2, 1
s_waitcnt vmcnt(0)
s_mov_b64 exec, 1
buffer_atomic_add v2, off, s[8:11], 0
s_mov_b64 exec, -1
reg_4:
s_cmp_eq_u32 s12, 7
s_cbranch_scc1 reg_2
s_load_dwordx2 s[24:25], s[0:1], 48
s_mov_b32 s26, 5242880
s_mov_b32 s27, 0x20000
s_lshl_b32 s15, s13, 3
s_sub_u32 s15, s15, 8
s_load_dwordx2 s[20:21], s[0:1], s15
s_mov_b32 s16, 1314816
s_cmp_eq_u32 s13, 1
s_cselect_b32 s22, 2621440, s16
s_cselect_b32 s16, 80, 41
s_mov_b32 s23, 0x20000
s_mul_i32 s17, s16, s2
s_lshl_b32 s17, s17, 7
s_sub_u32 s16, s16, 1
v_and_b32 v1, 63, v0
v_add_u32 v2, 64, v1
v_min_u32 v1, s16, v1
v_min_u32 v2, s16, v2
v_lshlrev_b32 v1, 7, v1
v_lshlrev_b32 v2, 7, v2
s_waitcnt lgkmcnt(0)
buffer_load_dword v3, v1, s[20:23], s17 offen
buffer_load_dword v4, v2, s[20:23], s17 offen
v_subrev_u32 v1, 64, v0
v_min_u32 v1, 159, v1
v_lshlrev_b32 v1, 7, v1
s_mul_i32 s17, s2, 20480
buffer_load_dword v5, v1, s[24:27], s17 offen
reg_2:
s_barrier
v_mov_b32 v1, 0
ds_read_b32 v2, v1
s_waitcnt lgkmcnt(0)
v_readfirstlane_b32 s14, v2
s_barrier
s_cmp_ge_u32 s14, 256
s_cbranch_scc1 L_end
s_cmp_lt_u32 s14, 32
s_cbranch_scc1 L_chain
s_sub_u32 s15, s14, 32
v_and_b32 v0, 63, v0
v_lshlrev_b32 v0, 4, v0
s_mov_b32 s24, 0x3f803f80
s_mul_i32 s31, s13, 10240
s_lshl_b32 s37, s13, 10
s_mov_b32 s22, s6
s_mov_b32 s23, 0
s_mov_b32 s16, 0
s_lshr_b32 s18, s15, 5
s_lshl_b32 s18, s18, 2
s_lshr_b32 s18, 106180896, s18
s_and_b32 s18, s18, 7
s_lshl_b32 s18, s18, 5
s_and_b32 s15, s15, 31
s_or_b32 s15, s15, s18
s_cmp_ge_u32 s15, 64
s_cbranch_scc1 roleA_12
s_and_b32 s32, s15, 31
s_cmp_ge_u32 s15, 32
s_cbranch_scc1 roleV_11
s_load_dwordx2 s[40:41], s[0:1], 8
s_mov_b32 s42, 1314816
s_mov_b32 s43, 0x20000
s_waitcnt lgkmcnt(0)
s_waitcnt vmcnt(0)
v_bfe_u32 v5, v0, 4, 2
v_lshrrev_b32 v6, 6, v0
v_mul_u32_u24 v7, 642, v5
v_lshl_add_u32 v7, v6, 2, v7
v_lshlrev_b32 v5, 4, v5
v_lshl_add_u32 v5, v6, 14, v5
s_and_b32 s18, s32, 3
s_bfe_u32 s19, s32, 0x20002
s_lshr_b32 s20, s32, 4
s_lshl_b32 s26, s20, 2
s_add_u32 s26, s26, s18
s_lshl_b32 s27, s26, 8
s_lshl_b32 s26, s26, 4
s_add_u32 s26, s26, s19
s_lshl_b32 s26, s26, 2
s_add_u32 s26, s26, s13
s_mul_i32 s26, s26, 2568
s_lshl_b32 s19, s19, 12
s_add_u32 s27, s27, s19
s_lshl_b32 s19, s13, 6
s_add_u32 s27, s27, s19
s_add_u32 s27, s27, 167772160
s_add_u32 s18, s26, 2
buffer_load_dword v32, v7, s[40:43], s18 offen offset:0
buffer_load_dword v36, v7, s[40:43], s18 offen offset:64
buffer_load_dword v40, v7, s[40:43], s18 offen offset:128
buffer_load_dword v44, v7, s[40:43], s18 offen offset:192
buffer_load_dword v48, v7, s[40:43], s18 offen offset:256
buffer_load_dword v52, v7, s[40:43], s18 offen offset:320
buffer_load_dword v56, v7, s[40:43], s18 offen offset:384
buffer_load_dword v60, v7, s[40:43], s18 offen offset:448
buffer_load_dword v64, v7, s[40:43], s18 offen offset:512
buffer_load_dword v68, v7, s[40:43], s18 offen offset:576
s_add_u32 s18, s26, 41090
buffer_load_dword v33, v7, s[40:43], s18 offen offset:0
buffer_load_dword v37, v7, s[40:43], s18 offen offset:64
buffer_load_dword v41, v7, s[40:43], s18 offen offset:128
buffer_load_dword v45, v7, s[40:43], s18 offen offset:192
buffer_load_dword v49, v7, s[40:43], s18 offen offset:256
buffer_load_dword v53, v7, s[40:43], s18 offen offset:320
buffer_load_dword v57, v7, s[40:43], s18 offen offset:384
buffer_load_dword v61, v7, s[40:43], s18 offen offset:448
buffer_load_dword v65, v7, s[40:43], s18 offen offset:512
buffer_load_dword v69, v7, s[40:43], s18 offen offset:576
s_add_u32 s18, s26, 82178
buffer_load_dword v34, v7, s[40:43], s18 offen offset:0
buffer_load_dword v38, v7, s[40:43], s18 offen offset:64
buffer_load_dword v42, v7, s[40:43], s18 offen offset:128
buffer_load_dword v46, v7, s[40:43], s18 offen offset:192
buffer_load_dword v50, v7, s[40:43], s18 offen offset:256
buffer_load_dword v54, v7, s[40:43], s18 offen offset:320
buffer_load_dword v58, v7, s[40:43], s18 offen offset:384
buffer_load_dword v62, v7, s[40:43], s18 offen offset:448
buffer_load_dword v66, v7, s[40:43], s18 offen offset:512
buffer_load_dword v70, v7, s[40:43], s18 offen offset:576
s_add_u32 s18, s26, 123266
buffer_load_dword v35, v7, s[40:43], s18 offen offset:0
buffer_load_dword v39, v7, s[40:43], s18 offen offset:64
buffer_load_dword v43, v7, s[40:43], s18 offen offset:128
buffer_load_dword v47, v7, s[40:43], s18 offen offset:192
buffer_load_dword v51, v7, s[40:43], s18 offen offset:256
buffer_load_dword v55, v7, s[40:43], s18 offen offset:320
buffer_load_dword v59, v7, s[40:43], s18 offen offset:384
buffer_load_dword v63, v7, s[40:43], s18 offen offset:448
buffer_load_dword v67, v7, s[40:43], s18 offen offset:512
buffer_load_dword v71, v7, s[40:43], s18 offen offset:576
s_waitcnt vmcnt(9)
buffer_store_dwordx4 v[32:35], v5, s[4:7], s27 offen sc1
s_add_u32 s27, s27, 262144
s_waitcnt vmcnt(9)
buffer_store_dwordx4 v[36:39], v5, s[4:7], s27 offen sc1
s_add_u32 s27, s27, 262144
s_waitcnt vmcnt(9)
buffer_store_dwordx4 v[40:43], v5, s[4:7], s27 offen sc1
s_add_u32 s27, s27, 262144
s_waitcnt vmcnt(9)
buffer_store_dwordx4 v[44:47], v5, s[4:7], s27 offen sc1
s_add_u32 s27, s27, 262144
s_waitcnt vmcnt(9)
buffer_store_dwordx4 v[48:51], v5, s[4:7], s27 offen sc1
s_add_u32 s27, s27, 262144
s_waitcnt vmcnt(9)
buffer_store_dwordx4 v[52:55], v5, s[4:7], s27 offen sc1
s_add_u32 s27, s27, 262144
s_waitcnt vmcnt(9)
buffer_store_dwordx4 v[56:59], v5, s[4:7], s27 offen sc1
s_add_u32 s27, s27, 262144
s_waitcnt vmcnt(9)
buffer_store_dwordx4 v[60:63], v5, s[4:7], s27 offen sc1
s_add_u32 s27, s27, 262144
s_waitcnt vmcnt(9)
buffer_store_dwordx4 v[64:67], v5, s[4:7], s27 offen sc1
s_add_u32 s27, s27, 262144
s_waitcnt vmcnt(9)
buffer_store_dwordx4 v[68:71], v5, s[4:7], s27 offen sc1
s_add_u32 s27, s27, 262144
s_lshl_b32 s18, s15, 7
s_add_u32 s18, s18, 11563008
s_cmp_eq_u32 s13, 0
s_cselect_b32 s22, s18, s6
s_mov_b32 s23, 1
s_waitcnt vmcnt(0)
s_barrier
v_mov_b32 v3, s23
s_mov_b64 exec, 1
buffer_store_dword v3, off, s[4:7], s22 sc1
s_mov_b64 exec, -1
s_mov_b32 s22, s6
s_lshl_b32 s26, s32, 8
s_lshl_b32 s18, s13, 6
s_add_u32 s26, s26, s18
s_load_dwordx2 s[40:41], s[0:1], 48
s_mov_b32 s42, 5242880
s_mov_b32 s43, 0x20000
s_waitcnt lgkmcnt(0)
v_lshrrev_b32 v32, 6, v0
v_mul_u32_u24 v32, 8192, v32
v_and_b32 v33, 48, v0
v_add_u32 v30, v32, v33
v_bfe_u32 v32, v0, 6, 2
v_lshrrev_b32 v33, 9, v0
v_lshl_add_u32 v32, v33, 3, v32
v_lshlrev_b32 v31, 6, v32
v_and_b32 v32, 16, v0
v_add_u32 v31, v31, v32
v_bfe_u32 v32, v0, 5, 1
v_lshl_add_u32 v31, v32, 3, v31
v_bfe_u32 v32, v0, 8, 1
v_lshl_add_u32 v31, v32, 5, v31
s_mul_i32 s18, s13, 36864
v_add_u32 v31, s18, v31
s_barrier
s_add_u32 m0, s18, 0
s_add_u32 s19, s26, 0
buffer_load_dwordx4 v30, s[40:43], s19 offen lds
s_add_u32 m0, s18, 1024
s_add_u32 s19, s26, 131072
buffer_load_dwordx4 v30, s[40:43], s19 offen lds
s_add_u32 m0, s18, 2048
s_add_u32 s19, s26, 262144
buffer_load_dwordx4 v30, s[40:43], s19 offen lds
s_add_u32 m0, s18, 3072
s_add_u32 s19, s26, 393216
buffer_load_dwordx4 v30, s[40:43], s19 offen lds
s_add_u32 m0, s18, 4096
s_add_u32 s19, s26, 524288
buffer_load_dwordx4 v30, s[40:43], s19 offen lds
s_add_u32 m0, s18, 5120
s_add_u32 s19, s26, 655360
buffer_load_dwordx4 v30, s[40:43], s19 offen lds
s_add_u32 m0, s18, 6144
s_add_u32 s19, s26, 786432
buffer_load_dwordx4 v30, s[40:43], s19 offen lds
s_add_u32 m0, s18, 7168
s_add_u32 s19, s26, 917504
buffer_load_dwordx4 v30, s[40:43], s19 offen lds
s_add_u32 m0, s18, 8192
s_add_u32 s19, s26, 1048576
buffer_load_dwordx4 v30, s[40:43], s19 offen lds
s_add_u32 m0, s18, 9216
s_add_u32 s19, s26, 1179648
buffer_load_dwordx4 v30, s[40:43], s19 offen lds
s_add_u32 m0, s18, 10240
s_add_u32 s19, s26, 1310720
buffer_load_dwordx4 v30, s[40:43], s19 offen lds
s_add_u32 m0, s18, 11264
s_add_u32 s19, s26, 1441792
buffer_load_dwordx4 v30, s[40:43], s19 offen lds
s_add_u32 m0, s18, 12288
s_add_u32 s19, s26, 1572864
buffer_load_dwordx4 v30, s[40:43], s19 offen lds
s_add_u32 m0, s18, 13312
s_add_u32 s19, s26, 1703936
buffer_load_dwordx4 v30, s[40:43], s19 offen lds
s_add_u32 m0, s18, 14336
s_add_u32 s19, s26, 1835008
buffer_load_dwordx4 v30, s[40:43], s19 offen lds
s_add_u32 m0, s18, 15360
s_add_u32 s19, s26, 1966080
buffer_load_dwordx4 v30, s[40:43], s19 offen lds
s_add_u32 m0, s18, 16384
s_add_u32 s19, s26, 2097152
buffer_load_dwordx4 v30, s[40:43], s19 offen lds
s_add_u32 m0, s18, 17408
s_add_u32 s19, s26, 2228224
buffer_load_dwordx4 v30, s[40:43], s19 offen lds
s_add_u32 m0, s18, 18432
s_add_u32 s19, s26, 2359296
buffer_load_dwordx4 v30, s[40:43], s19 offen lds
s_add_u32 m0, s18, 19456
s_add_u32 s19, s26, 2490368
buffer_load_dwordx4 v30, s[40:43], s19 offen lds
s_add_u32 m0, s18, 20480
s_add_u32 s19, s26, 2621440
buffer_load_dwordx4 v30, s[40:43], s19 offen lds
s_add_u32 m0, s18, 21504
s_add_u32 s19, s26, 2752512
buffer_load_dwordx4 v30, s[40:43], s19 offen lds
s_add_u32 m0, s18, 22528
s_add_u32 s19, s26, 2883584
buffer_load_dwordx4 v30, s[40:43], s19 offen lds
s_add_u32 m0, s18, 23552
s_add_u32 s19, s26, 3014656
buffer_load_dwordx4 v30, s[40:43], s19 offen lds
s_add_u32 m0, s18, 24576
s_add_u32 s19, s26, 3145728
buffer_load_dwordx4 v30, s[40:43], s19 offen lds
s_add_u32 m0, s18, 25600
s_add_u32 s19, s26, 3276800
buffer_load_dwordx4 v30, s[40:43], s19 offen lds
s_add_u32 m0, s18, 26624
s_add_u32 s19, s26, 3407872
buffer_load_dwordx4 v30, s[40:43], s19 offen lds
s_add_u32 m0, s18, 27648
s_add_u32 s19, s26, 3538944
buffer_load_dwordx4 v30, s[40:43], s19 offen lds
s_add_u32 m0, s18, 28672
s_add_u32 s19, s26, 3670016
buffer_load_dwordx4 v30, s[40:43], s19 offen lds
s_add_u32 m0, s18, 29696
s_add_u32 s19, s26, 3801088
buffer_load_dwordx4 v30, s[40:43], s19 offen lds
s_add_u32 m0, s18, 30720
s_add_u32 s19, s26, 3932160
buffer_load_dwordx4 v30, s[40:43], s19 offen lds
s_add_u32 m0, s18, 31744
s_add_u32 s19, s26, 4063232
buffer_load_dwordx4 v30, s[40:43], s19 offen lds
s_add_u32 m0, s18, 32768
s_add_u32 s19, s26, 4194304
buffer_load_dwordx4 v30, s[40:43], s19 offen lds
s_add_u32 m0, s18, 33792
s_add_u32 s19, s26, 4325376
buffer_load_dwordx4 v30, s[40:43], s19 offen lds
s_add_u32 m0, s18, 34816
s_add_u32 s19, s26, 4456448
buffer_load_dwordx4 v30, s[40:43], s19 offen lds
s_add_u32 m0, s18, 35840
s_add_u32 s19, s26, 4587520
buffer_load_dwordx4 v30, s[40:43], s19 offen lds
s_waitcnt vmcnt(32)
ds_read_b64_tr_b16 a[0:1], v31 offset:0
ds_read_b64_tr_b16 a[2:3], v31 offset:256
ds_read_b64_tr_b16 a[4:5], v31 offset:1024
ds_read_b64_tr_b16 a[6:7], v31 offset:1280
ds_read_b64_tr_b16 a[8:9], v31 offset:2048
ds_read_b64_tr_b16 a[10:11], v31 offset:2304
ds_read_b64_tr_b16 a[12:13], v31 offset:3072
ds_read_b64_tr_b16 a[14:15], v31 offset:3328
s_waitcnt lgkmcnt(0)
s_add_u32 m0, s18, 0
s_add_u32 s19, s26, 4718592
buffer_load_dwordx4 v30, s[40:43], s19 offen lds
s_add_u32 m0, s18, 1024
s_add_u32 s19, s26, 4849664
buffer_load_dwordx4 v30, s[40:43], s19 offen lds
s_add_u32 m0, s18, 2048
s_add_u32 s19, s26, 4980736
buffer_load_dwordx4 v30, s[40:43], s19 offen lds
s_add_u32 m0, s18, 3072
s_add_u32 s19, s26, 5111808
buffer_load_dwordx4 v30, s[40:43], s19 offen lds
s_waitcnt vmcnt(32)
ds_read_b64_tr_b16 a[16:17], v31 offset:4096
ds_read_b64_tr_b16 a[18:19], v31 offset:4352
ds_read_b64_tr_b16 a[20:21], v31 offset:5120
ds_read_b64_tr_b16 a[22:23], v31 offset:5376
ds_read_b64_tr_b16 a[24:25], v31 offset:6144
ds_read_b64_tr_b16 a[26:27], v31 offset:6400
ds_read_b64_tr_b16 a[28:29], v31 offset:7168
ds_read_b64_tr_b16 a[30:31], v31 offset:7424
s_waitcnt vmcnt(28)
ds_read_b64_tr_b16 a[32:33], v31 offset:8192
ds_read_b64_tr_b16 a[34:35], v31 offset:8448
ds_read_b64_tr_b16 a[36:37], v31 offset:9216
ds_read_b64_tr_b16 a[38:39], v31 offset:9472
ds_read_b64_tr_b16 a[40:41], v31 offset:10240
ds_read_b64_tr_b16 a[42:43], v31 offset:10496
ds_read_b64_tr_b16 a[44:45], v31 offset:11264
ds_read_b64_tr_b16 a[46:47], v31 offset:11520
s_waitcnt vmcnt(24)
ds_read_b64_tr_b16 a[48:49], v31 offset:12288
ds_read_b64_tr_b16 a[50:51], v31 offset:12544
ds_read_b64_tr_b16 a[52:53], v31 offset:13312
ds_read_b64_tr_b16 a[54:55], v31 offset:13568
ds_read_b64_tr_b16 a[56:57], v31 offset:14336
ds_read_b64_tr_b16 a[58:59], v31 offset:14592
ds_read_b64_tr_b16 a[60:61], v31 offset:15360
ds_read_b64_tr_b16 a[62:63], v31 offset:15616
s_waitcnt vmcnt(20)
ds_read_b64_tr_b16 a[64:65], v31 offset:16384
ds_read_b64_tr_b16 a[66:67], v31 offset:16640
ds_read_b64_tr_b16 a[68:69], v31 offset:17408
ds_read_b64_tr_b16 a[70:71], v31 offset:17664
ds_read_b64_tr_b16 a[72:73], v31 offset:18432
ds_read_b64_tr_b16 a[74:75], v31 offset:18688
ds_read_b64_tr_b16 a[76:77], v31 offset:19456
ds_read_b64_tr_b16 a[78:79], v31 offset:19712
s_waitcnt vmcnt(16)
ds_read_b64_tr_b16 a[80:81], v31 offset:20480
ds_read_b64_tr_b16 a[82:83], v31 offset:20736
ds_read_b64_tr_b16 a[84:85], v31 offset:21504
ds_read_b64_tr_b16 a[86:87], v31 offset:21760
ds_read_b64_tr_b16 a[88:89], v31 offset:22528
ds_read_b64_tr_b16 a[90:91], v31 offset:22784
ds_read_b64_tr_b16 a[92:93], v31 offset:23552
ds_read_b64_tr_b16 a[94:95], v31 offset:23808
s_waitcnt vmcnt(12)
ds_read_b64_tr_b16 a[96:97], v31 offset:24576
ds_read_b64_tr_b16 a[98:99], v31 offset:24832
ds_read_b64_tr_b16 a[100:101], v31 offset:25600
ds_read_b64_tr_b16 a[102:103], v31 offset:25856
ds_read_b64_tr_b16 a[104:105], v31 offset:26624
ds_read_b64_tr_b16 a[106:107], v31 offset:26880
ds_read_b64_tr_b16 a[108:109], v31 offset:27648
ds_read_b64_tr_b16 a[110:111], v31 offset:27904
s_waitcnt vmcnt(8)
ds_read_b64_tr_b16 a[112:113], v31 offset:28672
ds_read_b64_tr_b16 a[114:115], v31 offset:28928
ds_read_b64_tr_b16 a[116:117], v31 offset:29696
ds_read_b64_tr_b16 a[118:119], v31 offset:29952
ds_read_b64_tr_b16 a[120:121], v31 offset:30720
ds_read_b64_tr_b16 a[122:123], v31 offset:30976
ds_read_b64_tr_b16 a[124:125], v31 offset:31744
ds_read_b64_tr_b16 a[126:127], v31 offset:32000
s_waitcnt vmcnt(4)
ds_read_b64_tr_b16 a[128:129], v31 offset:32768
ds_read_b64_tr_b16 a[130:131], v31 offset:33024
ds_read_b64_tr_b16 a[132:133], v31 offset:33792
ds_read_b64_tr_b16 a[134:135], v31 offset:34048
ds_read_b64_tr_b16 a[136:137], v31 offset:34816
ds_read_b64_tr_b16 a[138:139], v31 offset:35072
ds_read_b64_tr_b16 a[140:141], v31 offset:35840
ds_read_b64_tr_b16 a[142:143], v31 offset:36096
s_waitcnt vmcnt(0)
ds_read_b64_tr_b16 a[144:145], v31 offset:0
ds_read_b64_tr_b16 a[146:147], v31 offset:256
ds_read_b64_tr_b16 a[148:149], v31 offset:1024
ds_read_b64_tr_b16 a[150:151], v31 offset:1280
ds_read_b64_tr_b16 a[152:153], v31 offset:2048
ds_read_b64_tr_b16 a[154:155], v31 offset:2304
ds_read_b64_tr_b16 a[156:157], v31 offset:3072
ds_read_b64_tr_b16 a[158:159], v31 offset:3328
s_waitcnt lgkmcnt(0)
s_barrier
s_load_dwordx2 s[40:41], s[0:1], 40
s_mov_b32 s42, 5242880
s_mov_b32 s43, 0x20000
s_waitcnt lgkmcnt(0)
v_lshrrev_b32 v5, 5, v0
v_lshlrev_b32 v5, 13, v5
v_bfe_u32 v6, v0, 4, 1
v_lshl_add_u32 v5, v6, 7, v5
s_lshl_b32 s18, s32, 8
s_mul_i32 s19, s13, 1310720
s_add_u32 s18, s18, s19
buffer_load_dword v24, v5, s[40:43], s18 offen
s_add_u32 s18, s18, 262144
buffer_load_dword v25, v5, s[40:43], s18 offen
s_add_u32 s18, s18, 262144
buffer_load_dword v26, v5, s[40:43], s18 offen
s_add_u32 s18, s18, 262144
buffer_load_dword v27, v5, s[40:43], s18 offen
s_add_u32 s18, s18, 262144
buffer_load_dword v28, v5, s[40:43], s18 offen
s_add_u32 s18, s18, 262144
v_mov_b32 v32, s24
v_mov_b32 v33, s24
v_mov_b32 v34, s24
v_mov_b32 v35, s24
s_nop 1
v_mfma_f32_32x32x16_bf16 v[36:51], a[0:3], v[32:35], 0
v_mfma_f32_32x32x16_bf16 v[36:51], a[4:7], v[32:35], v[36:51]
v_mfma_f32_32x32x16_bf16 v[36:51], a[8:11], v[32:35], v[36:51]
v_mfma_f32_32x32x16_bf16 v[36:51], a[12:15], v[32:35], v[36:51]
v_mfma_f32_32x32x16_bf16 v[36:51], a[16:19], v[32:35], v[36:51]
v_mfma_f32_32x32x16_bf16 v[36:51], a[20:23], v[32:35], v[36:51]
v_mfma_f32_32x32x16_bf16 v[36:51], a[24:27], v[32:35], v[36:51]
v_mfma_f32_32x32x16_bf16 v[36:51], a[28:31], v[32:35], v[36:51]
v_mfma_f32_32x32x16_bf16 v[36:51], a[32:35], v[32:35], v[36:51]
v_mfma_f32_32x32x16_bf16 v[36:51], a[36:39], v[32:35], v[36:51]
v_mfma_f32_32x32x16_bf16 v[36:51], a[40:43], v[32:35], v[36:51]
v_mfma_f32_32x32x16_bf16 v[36:51], a[44:47], v[32:35], v[36:51]
v_mfma_f32_32x32x16_bf16 v[36:51], a[48:51], v[32:35], v[36:51]
v_mfma_f32_32x32x16_bf16 v[36:51], a[52:55], v[32:35], v[36:51]
v_mfma_f32_32x32x16_bf16 v[36:51], a[56:59], v[32:35], v[36:51]
v_mfma_f32_32x32x16_bf16 v[36:51], a[60:63], v[32:35], v[36:51]
v_mfma_f32_32x32x16_bf16 v[36:51], a[64:67], v[32:35], v[36:51]
v_mfma_f32_32x32x16_bf16 v[36:51], a[68:71], v[32:35], v[36:51]
v_mfma_f32_32x32x16_bf16 v[36:51], a[72:75], v[32:35], v[36:51]
v_mfma_f32_32x32x16_bf16 v[36:51], a[76:79], v[32:35], v[36:51]
v_mfma_f32_32x32x16_bf16 v[36:51], a[80:83], v[32:35], v[36:51]
v_mfma_f32_32x32x16_bf16 v[36:51], a[84:87], v[32:35], v[36:51]
v_mfma_f32_32x32x16_bf16 v[36:51], a[88:91], v[32:35], v[36:51]
v_mfma_f32_32x32x16_bf16 v[36:51], a[92:95], v[32:35], v[36:51]
v_mfma_f32_32x32x16_bf16 v[36:51], a[96:99], v[32:35], v[36:51]
v_mfma_f32_32x32x16_bf16 v[36:51], a[100:103], v[32:35], v[36:51]
v_mfma_f32_32x32x16_bf16 v[36:51], a[104:107], v[32:35], v[36:51]
v_mfma_f32_32x32x16_bf16 v[36:51], a[108:111], v[32:35], v[36:51]
v_mfma_f32_32x32x16_bf16 v[36:51], a[112:115], v[32:35], v[36:51]
v_mfma_f32_32x32x16_bf16 v[36:51], a[116:119], v[32:35], v[36:51]
v_mfma_f32_32x32x16_bf16 v[36:51], a[120:123], v[32:35], v[36:51]
v_mfma_f32_32x32x16_bf16 v[36:51], a[124:127], v[32:35], v[36:51]
v_mfma_f32_32x32x16_bf16 v[36:51], a[128:131], v[32:35], v[36:51]
v_mfma_f32_32x32x16_bf16 v[36:51], a[132:135], v[32:35], v[36:51]
v_mfma_f32_32x32x16_bf16 v[36:51], a[136:139], v[32:35], v[36:51]
v_mfma_f32_32x32x16_bf16 v[36:51], a[140:143], v[32:35], v[36:51]
v_mfma_f32_32x32x16_bf16 v[36:51], a[144:147], v[32:35], v[36:51]
v_mfma_f32_32x32x16_bf16 v[36:51], a[148:151], v[32:35], v[36:51]
v_mfma_f32_32x32x16_bf16 v[36:51], a[152:155], v[32:35], v[36:51]
v_mfma_f32_32x32x16_bf16 v[36:51], a[156:159], v[32:35], v[36:51]
s_nop 11
v_mov_b32 v8, v36
v_mov_b32 v9, v37
v_mov_b32 v10, v38
v_mov_b32 v11, v39
v_mov_b32 v12, v40
v_mov_b32 v13, v41
v_mov_b32 v14, v42
v_mov_b32 v15, v43
v_mov_b32 v16, v44
v_mov_b32 v17, v45
v_mov_b32 v18, v46
v_mov_b32 v19, v47
v_mov_b32 v20, v48
v_mov_b32 v21, v49
v_mov_b32 v22, v50
v_mov_b32 v23, v51
v_and_b32 v5, 0x70, v0
s_waitcnt vmcnt(4)
v_lshrrev_b32 v24, 8, v0
v_lshl_add_u32 v5, v24, 7, v5
v_bfe_u32 v24, v0, 7, 1
v_lshl_add_u32 v5, v24, 12, v5
s_lshr_b32 s34, s13, 1
s_lshl_b32 s34, s34, 13
s_and_b32 s18, s13, 1
s_lshl_b32 s18, s18, 10
s_add_u32 s34, s34, s18
s_lshl_b32 s18, s32, 14
s_add_u32 s34, s34, s18
v_bfe_u32 v6, v0, 7, 2
v_mul_u32_u24 v6, 10240, v6
v_bfe_u32 v24, v0, 5, 2
v_lshl_add_u32 v6, v24, 6, v6
v_lshrrev_b32 v24, 9, v0
v_lshl_add_u32 v6, v24, 5, v6
v_and_b32 v24, 16, v0
v_add_u32 v6, v24, v6
s_lshl_b32 s51, s32, 8
s_add_u32 s51, s51, 11534336
s_mul_i32 s52, s13, 2560
s_add_u32 s52, s52, 12582912
s_add_u32 s50, s34, 110100480
s_mov_b32 s39, 0
kvlay_13:
s_mul_i32 s26, s16, 6291456
s_add_u32 s26, s26, 88080384
s_add_u32 s26, s26, s31
s_mul_i32 s54, s16, 327680
s_add_u32 s54, s54, 163577856
s_mul_i32 s27, s16, 35651584
s_add_u32 s27, s27, 16777216
s_mul_i32 s18, s32, 0
s_add_u32 s27, s27, s18
s_add_u32 s27, s27, s34
s_lshl_b32 s29, s16, 1
s_add_u32 s29, s29, 1
s_mov_b32 s28, 0
s_mov_b32 s30, 0
s_cmp_lt_u32 s30, 64
s_cselect_b32 s53, s26, s6
s_cselect_b32 s36, s54, s6
s_mov_b32 s38, 1024
v_mov_b32 v7, v0
s_add_u32 s26, s26, 40960
s_add_u32 s54, s54, 5120
s_add_u32 s30, s30, 1
v_xor_b32 v1, 40960, v0
s_mov_b32 s25, s31
s_mov_b32 s35, 131072
s_cmp_lg_u32 s13, 0
s_cbranch_scc1 polld_22
v_lshlrev_b32 v3, 3, v0
s_waitcnt vmcnt(0)
v_min_u32 v28, 1152, v3
s_mov_b32 s21, 11612160
s_mov_b32 s17, 0
poll_21:
buffer_load_dword v24, v28, s[4:7], s21 offen sc1
s_add_u32 s17, s17, 1
s_cmp_gt_u32 s17, 262144
s_cbranch_scc1 L_fail
s_waitcnt vmcnt(0)
v_cmp_gt_u32 vcc, s29, v24
s_cbranch_vccz polld_22
s_sleep 2
s_branch poll_21
polld_22:
s_barrier
s_add_u32 m0, s25, 2048
s_mov_b32 s20, s53
buffer_load_dwordx4 v7, s[4:7], s20 offen sc1 lds
s_add_u32 m0, s25, 3072
s_add_u32 s20, s20, s38
buffer_load_dwordx4 v7, s[4:7], s20 offen sc1 lds
s_add_u32 m0, s25, 4096
s_add_u32 s20, s20, s38
buffer_load_dwordx4 v7, s[4:7], s20 offen sc1 lds
s_add_u32 m0, s25, 5120
s_add_u32 s20, s20, s38
buffer_load_dwordx4 v7, s[4:7], s20 offen sc1 lds
s_add_u32 m0, s25, 6144
s_add_u32 s20, s20, s38
buffer_load_dwordx4 v7, s[4:7], s20 offen sc1 lds
s_add_u32 m0, s25, 7168
s_add_u32 s20, s20, s38
buffer_load_dwordx4 v7, s[4:7], s20 offen sc1 lds
s_add_u32 m0, s25, 8192
s_add_u32 s20, s20, s38
buffer_load_dwordx4 v7, s[4:7], s20 offen sc1 lds
s_add_u32 m0, s25, 9216
s_add_u32 s20, s20, s38
buffer_load_dwordx4 v7, s[4:7], s20 offen sc1 lds
s_add_u32 m0, s25, 10240
s_add_u32 s20, s20, s38
buffer_load_dwordx4 v7, s[4:7], s20 offen sc1 lds
s_add_u32 m0, s25, 11264
s_add_u32 s20, s20, s38
buffer_load_dwordx4 v7, s[4:7], s20 offen sc1 lds
s_add_u32 m0, s35, s37
s_add_u32 s20, s36, s37
buffer_load_dwordx4 v0, s[4:7], s20 offen sc1 lds
s_add_u32 m0, s35, 4096
s_add_u32 s20, s36, 4096
buffer_load_dwordx4 v0, s[4:7], s20 offen sc1 lds
s_waitcnt vmcnt(0)
kvx_14:
v_xor_b32 v1, 40960, v1
s_sub_u32 s25, s25, s31
s_xor_b32 s25, s25, 40960
s_add_u32 s25, s25, s31
s_xor_b32 s35, s35, 8192
s_cmp_eq_u32 s28, 1
s_cbranch_scc1 kv_16
s_cmp_eq_u32 s28, 30
s_cbranch_scc0 kv_17
s_add_u32 s29, s29, 1
kv_16:
s_waitcnt vmcnt(0)
s_barrier
v_mov_b32 v3, s23
s_mov_b64 exec, 1
buffer_store_dword v3, off, s[4:7], s22 sc1
s_mov_b64 exec, -1
s_mov_b32 s22, s6
s_cmp_lg_u32 s13, 0
s_cbranch_scc1 polld_24
v_lshlrev_b32 v3, 3, v0
v_min_u32 v28, 3968, v3
s_mov_b32 s21, 11612160
s_mov_b32 s17, 0
poll_23:
buffer_load_dword v24, v3, s[4:7], s21 offen sc1
s_add_u32 s20, s21, 8192
buffer_load_dword v25, v3, s[4:7], s20 offen sc1
s_add_u32 s20, s21, 16384
buffer_load_dword v26, v28, s[4:7], s20 offen sc1
s_add_u32 s17, s17, 1
s_cmp_gt_u32 s17, 262144
s_cbranch_scc1 L_fail
s_waitcnt vmcnt(1)
v_min_u32 v24, v24, v25
s_waitcnt vmcnt(0)
v_min_u32 v24, v24, v26
v_cmp_gt_u32 vcc, s29, v24
s_cbranch_vccz polld_24
s_sleep 2
s_branch poll_23
polld_24:
s_barrier
kv_17:
s_add_u32 s28, s28, 1
s_and_b32 s33, s28, 3
s_cmp_lt_u32 s28, 12
s_cselect_b32 s33, 1, s33
s_cmp_eq_u32 s33, 0
s_cbranch_scc1 kv_18
s_cmp_lt_u32 s30, 64
s_cselect_b32 s53, s26, s6
s_cselect_b32 s36, s54, s6
s_mov_b32 s38, 1024
v_mov_b32 v7, v0
s_add_u32 s26, s26, 40960
s_add_u32 s54, s54, 5120
s_add_u32 s30, s30, 1
kvn_15:
s_waitcnt vmcnt(3)
s_barrier
s_add_u32 m0, s25, 2048
s_mov_b32 s20, s53
buffer_load_dwordx4 v7, s[4:7], s20 offen sc1 lds
ds_read_b128 v[48:51], v1 offset:2048
ds_read_b128 v[52:55], v1 offset:3072
s_add_u32 m0, s25, 3072
s_add_u32 s20, s20, s38
buffer_load_dwordx4 v7, s[4:7], s20 offen sc1 lds
s_add_u32 m0, s25, 4096
s_add_u32 s20, s20, s38
buffer_load_dwordx4 v7, s[4:7], s20 offen sc1 lds
ds_read_b128 v[56:59], v1 offset:4096
ds_read_b128 v[60:63], v1 offset:5120
s_waitcnt lgkmcnt(3)
v_mfma_f32_32x32x16_bf16 v[32:47], a[0:3], v[48:51], 0
s_xor_b32 s18, s35, 8192
ds_read_b128 v[48:51], v1 offset:6144
v_lshrrev_b32 v2, 2, v0
s_waitcnt lgkmcnt(3)
v_mfma_f32_32x32x16_bf16 v[32:47], a[4:7], v[52:55], v[32:47]
ds_read_b128 v[52:55], v1 offset:7168
v_add_u32 v2, s18, v2
s_waitcnt lgkmcnt(3)
v_mfma_f32_32x32x16_bf16 v[32:47], a[8:11], v[56:59], v[32:47]
ds_read2st64_b32 v[64:65], v2 offset0:0 offset1:1
s_waitcnt lgkmcnt(2)
ds_read2st64_b32 v[66:67], v2 offset0:2 offset1:3
ds_read_b128 v[56:59], v1 offset:8192
v_mfma_f32_32x32x16_bf16 v[32:47], a[12:15], v[60:63], v[32:47]
ds_read_b128 v[60:63], v1 offset:9216
ds_read2st64_b32 v[74:75], v2 offset0:6 offset1:7
s_waitcnt lgkmcnt(5)
v_mfma_f32_32x32x16_bf16 v[32:47], a[16:19], v[48:51], v[32:47]
s_add_u32 m0, s25, 5120
s_add_u32 s20, s20, s38
buffer_load_dwordx4 v7, s[4:7], s20 offen sc1 lds
ds_read2st64_b32 v[72:73], v2 offset0:4 offset1:5
ds_read_b128 v[48:51], v1 offset:10240
ds_read2st64_b32 v[84:85], v2 offset0:16 offset1:17
s_waitcnt lgkmcnt(5)
v_mfma_f32_32x32x16_bf16 v[32:47], a[20:23], v[52:55], v[32:47]
s_waitcnt lgkmcnt(4)
s_add_u32 m0, s25, 6144
s_add_u32 s20, s20, s38
buffer_load_dwordx4 v7, s[4:7], s20 offen sc1 lds
v_mfma_f32_32x32x16_bf16 v[32:47], a[24:27], v[56:59], v[32:47]
ds_read_b128 v[52:55], v1 offset:11264
s_add_u32 m0, s25, 7168
s_add_u32 s20, s20, s38
buffer_load_dwordx4 v7, s[4:7], s20 offen sc1 lds
v_mfma_f32_32x32x16_bf16 v[32:47], a[28:31], v[60:63], v[32:47]
ds_read_b128 v[60:63], v1 offset:13312
s_waitcnt lgkmcnt(2)
ds_read_b128 v[56:59], v1 offset:12288
ds_read2st64_b32 v[80:81], v2 offset0:12 offset1:13
v_add_f32 v65, v65, v67
v_mfma_f32_32x32x16_bf16 v[32:47], a[32:35], v[48:51], v[32:47]
s_waitcnt lgkmcnt(3)
ds_read_b128 v[48:51], v1 offset:14336
ds_read2st64_b32 v[76:77], v2 offset0:8 offset1:9
s_add_u32 m0, s25, 8192
s_add_u32 s20, s20, s38
buffer_load_dwordx4 v7, s[4:7], s20 offen sc1 lds
v_mfma_f32_32x32x16_bf16 v[32:47], a[36:39], v[52:55], v[32:47]
s_add_u32 m0, s25, 9216
s_add_u32 s20, s20, s38
buffer_load_dwordx4 v7, s[4:7], s20 offen sc1 lds
ds_read_b128 v[52:55], v1 offset:15360
s_waitcnt lgkmcnt(4)
v_mfma_f32_32x32x16_bf16 v[32:47], a[40:43], v[56:59], v[32:47]
s_waitcnt lgkmcnt(2)
v_add_f32 v64, v64, v66
v_mov_b32 v3, s23
s_waitcnt lgkmcnt(1)
v_mfma_f32_32x32x16_bf16 v[32:47], a[44:47], v[60:63], v[32:47]
ds_read_b128 v[60:63], v1 offset:17408
ds_read_b128 v[56:59], v1 offset:16384
v_mfma_f32_32x32x16_bf16 v[32:47], a[48:51], v[48:51], v[32:47]
s_waitcnt lgkmcnt(2)
ds_read_b128 v[48:51], v1 offset:18432
ds_read2st64_b32 v[86:87], v2 offset0:18 offset1:19
v_mfma_f32_32x32x16_bf16 v[32:47], a[52:55], v[52:55], v[32:47]
ds_read2st64_b32 v[78:79], v2 offset0:10 offset1:11
s_waitcnt lgkmcnt(3)
v_mfma_f32_32x32x16_bf16 v[32:47], a[56:59], v[56:59], v[32:47]
s_waitcnt lgkmcnt(2)
ds_read_b128 v[52:55], v1 offset:19456
ds_read2st64_b32 v[82:83], v2 offset0:14 offset1:15
s_add_u32 m0, s25, 10240
s_add_u32 s20, s20, s38
buffer_load_dwordx4 v7, s[4:7], s20 offen sc1 lds
v_mfma_f32_32x32x16_bf16 v[32:47], a[60:63], v[60:63], v[32:47]
ds_read_b128 v[56:59], v1 offset:20480
s_waitcnt lgkmcnt(3)
ds_read_b128 v[60:63], v1 offset:21504
v_add_f32 v65, v65, v73
v_mfma_f32_32x32x16_bf16 v[32:47], a[64:67], v[48:51], v[32:47]
v_add_f32 v64, v64, v72
s_waitcnt lgkmcnt(3)
v_add_f32 v64, v64, v74
v_add_f32 v65, v65, v75
s_waitcnt lgkmcnt(2)
v_mfma_f32_32x32x16_bf16 v[32:47], a[68:71], v[52:55], v[32:47]
ds_read_b128 v[52:55], v1 offset:23552
ds_read_b128 v[48:51], v1 offset:22528
s_waitcnt lgkmcnt(3)
v_add_f32 v65, v65, v77
v_add_f32 v64, v64, v76
v_mfma_f32_32x32x16_bf16 v[32:47], a[72:75], v[56:59], v[32:47]
v_add_f32 v64, v64, v78
ds_read_b128 v[56:59], v1 offset:24576
s_waitcnt lgkmcnt(3)
v_mfma_f32_32x32x16_bf16 v[32:47], a[76:79], v[60:63], v[32:47]
ds_read_b128 v[60:63], v1 offset:25600
s_waitcnt lgkmcnt(3)
v_add_f32 v64, v64, v80
s_waitcnt lgkmcnt(2)
v_mfma_f32_32x32x16_bf16 v[32:47], a[80:83], v[48:51], v[32:47]
ds_read_b128 v[48:51], v1 offset:26624
s_add_u32 m0, s25, 11264
s_add_u32 s20, s20, s38
buffer_load_dwordx4 v7, s[4:7], s20 offen sc1 lds
v_mfma_f32_32x32x16_bf16 v[32:47], a[84:87], v[52:55], v[32:47]
s_waitcnt lgkmcnt(2)
ds_read_b128 v[52:55], v1 offset:27648
v_add_f32 v65, v65, v79
s_waitcnt lgkmcnt(2)
v_mfma_f32_32x32x16_bf16 v[32:47], a[88:91], v[56:59], v[32:47]
s_waitcnt lgkmcnt(1)
s_add_u32 m0, s35, s37
s_add_u32 s20, s36, s37
buffer_load_dwordx4 v0, s[4:7], s20 offen sc1 lds
v_mfma_f32_32x32x16_bf16 v[32:47], a[92:95], v[60:63], v[32:47]
ds_read_b128 v[56:59], v1 offset:28672
ds_read_b128 v[60:63], v1 offset:29696
s_waitcnt lgkmcnt(2)
v_add_f32 v64, v64, v82
v_add_f32 v65, v65, v81
v_mfma_f32_32x32x16_bf16 v[32:47], a[96:99], v[48:51], v[32:47]
s_add_u32 m0, s35, 4096
s_add_u32 s20, s36, 4096
buffer_load_dwordx4 v0, s[4:7], s20 offen sc1 lds
v_mfma_f32_32x32x16_bf16 v[32:47], a[100:103], v[52:55], v[32:47]
ds_read_b128 v[48:51], v1 offset:30720
s_waitcnt lgkmcnt(2)
ds_read_b128 v[52:55], v1 offset:31744
v_mfma_f32_32x32x16_bf16 v[32:47], a[104:107], v[56:59], v[32:47]
ds_read_b128 v[56:59], v1 offset:32768
v_add_f32 v65, v65, v83
s_waitcnt lgkmcnt(3)
v_add_f32 v64, v64, v84
v_add_f32 v65, v65, v85
v_mfma_f32_32x32x16_bf16 v[32:47], a[108:111], v[60:63], v[32:47]
s_waitcnt lgkmcnt(2)
v_add_f32 v65, v65, v87
s_waitcnt lgkmcnt(1)
v_add_f32 v64, v64, v86
v_mfma_f32_32x32x16_bf16 v[32:47], a[112:115], v[48:51], v[32:47]
s_waitcnt lgkmcnt(0)
ds_read_b128 v[48:51], v1 offset:34816
ds_read_b128 v[60:63], v1 offset:33792
v_add_f32 v64, v64, v65
v_mov_b32 v68, v64
v_mfma_f32_32x32x16_bf16 v[32:47], a[116:119], v[52:55], v[32:47]
s_waitcnt vmcnt(12)
s_barrier
s_mov_b64 exec, 1
buffer_store_dword v3, off, s[4:7], s22 sc1
s_mov_b64 exec, -1
v_mfma_f32_32x32x16_bf16 v[32:47], a[120:123], v[56:59], v[32:47]
ds_read_b128 v[52:55], v1 offset:35840
ds_read_b128 v[56:59], v1 offset:36864
s_waitcnt lgkmcnt(2)
v_mfma_f32_32x32x16_bf16 v[32:47], a[124:127], v[60:63], v[32:47]
ds_read_b128 v[60:63], v1 offset:37888
v_permlane32_swap_b32 v64, v68
v_mul_f32 v68, 0x3acccccd, v68
v_mul_f32 v64, 0x3acccccd, v64
v_mfma_f32_32x32x16_bf16 v[32:47], a[128:131], v[48:51], v[32:47]
s_waitcnt lgkmcnt(2)
v_mfma_f32_32x32x16_bf16 v[32:47], a[132:135], v[52:55], v[32:47]
s_waitcnt lgkmcnt(0)
ds_read_b128 v[48:51], v1 offset:38912
v_fma_f32 v68, -v64, v64, v68
v_max_f32 v68, 0, v68
v_add_f32 v68, 0x3727c5ac, v68
v_mfma_f32_32x32x16_bf16 v[32:47], a[136:139], v[56:59], v[32:47]
ds_read_b128 v[52:55], v1 offset:39936
v_rsq_f32 v68, v68
s_nop 0
v_mul_f32 v64, v68, v64
v_mfma_f32_32x32x16_bf16 v[32:47], a[140:143], v[60:63], v[32:47]
ds_read_b128 v[56:59], v1 offset:40960
s_waitcnt lgkmcnt(2)
v_mfma_f32_32x32x16_bf16 v[32:47], a[144:147], v[48:51], v[32:47]
ds_read_b128 v[60:63], v1 offset:41984
v_mul_f32 v78, v64, v14
v_mul_f32 v85, v64, v21
s_waitcnt lgkmcnt(2)
v_mul_f32 v75, v64, v11
v_mul_f32 v79, v64, v15
v_mfma_f32_32x32x16_bf16 v[32:47], a[148:151], v[52:55], v[32:47]
v_mul_f32 v84, v64, v20
s_waitcnt lgkmcnt(1)
v_mul_f32 v73, v64, v9
v_mul_f32 v72, v64, v8
v_mul_f32 v82, v64, v18
v_mul_f32 v87, v64, v23
v_mfma_f32_32x32x16_bf16 v[32:47], a[152:155], v[56:59], v[32:47]
s_waitcnt lgkmcnt(0)
v_mul_f32 v83, v64, v19
v_mul_f32 v74, v64, v10
v_mul_f32 v81, v64, v17
v_mul_f32 v86, v64, v22
v_mfma_f32_32x32x16_bf16 v[32:47], a[156:159], v[60:63], v[32:47]
s_nop 0
v_mul_f32 v80, v64, v16
v_mul_f32 v76, v64, v12
v_mul_f32 v77, v64, v13
s_nop 7
v_pk_fma_f32 v[40:41], v[40:41], v[68:69], v[80:81] op_sel_hi:[1,0,1] neg_lo:[0,0,1] neg_hi:[0,0,1]
v_pk_fma_f32 v[32:33], v[32:33], v[68:69], v[72:73] op_sel_hi:[1,0,1] neg_lo:[0,0,1] neg_hi:[0,0,1]
v_pk_fma_f32 v[34:35], v[34:35], v[68:69], v[74:75] op_sel_hi:[1,0,1] neg_lo:[0,0,1] neg_hi:[0,0,1]
v_pk_fma_f32 v[42:43], v[42:43], v[68:69], v[82:83] op_sel_hi:[1,0,1] neg_lo:[0,0,1] neg_hi:[0,0,1]
v_cvt_pk_bf16_f32 v48, v32, v33
v_cvt_pk_bf16_f32 v49, v34, v35
v_pk_fma_f32 v[44:45], v[44:45], v[68:69], v[84:85] op_sel_hi:[1,0,1] neg_lo:[0,0,1] neg_hi:[0,0,1]
v_pk_fma_f32 v[46:47], v[46:47], v[68:69], v[86:87] op_sel_hi:[1,0,1] neg_lo:[0,0,1] neg_hi:[0,0,1]
v_pk_fma_f32 v[36:37], v[36:37], v[68:69], v[76:77] op_sel_hi:[1,0,1] neg_lo:[0,0,1] neg_hi:[0,0,1]
v_cvt_pk_bf16_f32 v50, v36, v37
v_cvt_pk_bf16_f32 v52, v40, v41
v_cvt_pk_bf16_f32 v54, v44, v45
v_pk_fma_f32 v[38:39], v[38:39], v[68:69], v[78:79] op_sel_hi:[1,0,1] neg_lo:[0,0,1] neg_hi:[0,0,1]
v_cvt_pk_bf16_f32 v51, v38, v39
v_cvt_pk_bf16_f32 v53, v42, v43
v_cvt_pk_bf16_f32 v55, v46, v47
buffer_store_dwordx4 v[48:51], v5, s[4:7], s27 offen offset:0 sc1
buffer_store_dwordx4 v[52:55], v5, s[4:7], s27 offen offset:512 sc1
s_lshl_b32 s18, s16, 6
s_add_u32 s18, s18, s28
s_add_u32 s27, s27, 524288
s_cmp_eq_u32 s13, 0
s_cselect_b32 s22, s51, s6
s_mov_b32 s23, s18
s_cmp_lg_u32 s33, 0
s_cbranch_scc1 kvx_14
kvm_19:
v_xor_b32 v1, 40960, v1
s_sub_u32 s25, s25, s31
s_xor_b32 s25, s25, 40960
s_add_u32 s25, s25, s31
s_xor_b32 s35, s35, 8192
s_cmp_lt_u32 s30, 64
s_cselect_b32 s53, s26, s6
s_cselect_b32 s36, s54, s6
s_mov_b32 s38, 1024
v_mov_b32 v7, v0
s_add_u32 s26, s26, 40960
s_add_u32 s54, s54, 5120
s_add_u32 s30, s30, 1
s_waitcnt vmcnt(3)
s_barrier
ds_read_b128 v[48:51], v1 offset:2048
s_add_u32 m0, s25, 2048
s_mov_b32 s20, s53
buffer_load_dwordx4 v7, s[4:7], s20 offen sc1 lds
ds_read_b128 v[52:55], v1 offset:3072
ds_read_b128 v[56:59], v1 offset:4096
s_add_u32 m0, s25, 3072
s_add_u32 s20, s20, s38
buffer_load_dwordx4 v7, s[4:7], s20 offen sc1 lds
s_waitcnt lgkmcnt(2)
v_mfma_f32_32x32x16_bf16 v[32:47], a[0:3], v[48:51], 0
ds_read_b128 v[60:63], v1 offset:5120
s_waitcnt lgkmcnt(2)
s_add_u32 m0, s25, 4096
s_add_u32 s20, s20, s38
buffer_load_dwordx4 v7, s[4:7], s20 offen sc1 lds
s_waitcnt lgkmcnt(1)
v_mfma_f32_32x32x16_bf16 v[32:47], a[4:7], v[52:55], v[32:47]
s_add_u32 m0, s25, 5120
s_add_u32 s20, s20, s38
buffer_load_dwordx4 v7, s[4:7], s20 offen sc1 lds
ds_read_b128 v[48:51], v1 offset:6144
ds_read_b128 v[52:55], v1 offset:7168
v_mfma_f32_32x32x16_bf16 v[32:47], a[8:11], v[56:59], v[32:47]
ds_read_b128 v[56:59], v1 offset:8192
s_waitcnt lgkmcnt(3)
v_mfma_f32_32x32x16_bf16 v[32:47], a[12:15], v[60:63], v[32:47]
s_waitcnt lgkmcnt(2)
v_mfma_f32_32x32x16_bf16 v[32:47], a[16:19], v[48:51], v[32:47]
ds_read_b128 v[60:63], v1 offset:9216
ds_read_b128 v[48:51], v1 offset:10240
s_waitcnt lgkmcnt(2)
v_mfma_f32_32x32x16_bf16 v[32:47], a[20:23], v[52:55], v[32:47]
v_mfma_f32_32x32x16_bf16 v[32:47], a[24:27], v[56:59], v[32:47]
ds_read_b128 v[56:59], v1 offset:12288
s_waitcnt lgkmcnt(2)
ds_read_b128 v[52:55], v1 offset:11264
v_mfma_f32_32x32x16_bf16 v[32:47], a[28:31], v[60:63], v[32:47]
s_waitcnt lgkmcnt(2)
s_add_u32 m0, s25, 6144
s_add_u32 s20, s20, s38
buffer_load_dwordx4 v7, s[4:7], s20 offen sc1 lds
ds_read_b128 v[60:63], v1 offset:13312
v_mfma_f32_32x32x16_bf16 v[32:47], a[32:35], v[48:51], v[32:47]
s_waitcnt lgkmcnt(2)
s_add_u32 m0, s25, 7168
s_add_u32 s20, s20, s38
buffer_load_dwordx4 v7, s[4:7], s20 offen sc1 lds
s_waitcnt lgkmcnt(1)
v_mfma_f32_32x32x16_bf16 v[32:47], a[36:39], v[52:55], v[32:47]
ds_read_b128 v[48:51], v1 offset:14336
s_add_u32 m0, s25, 8192
s_add_u32 s20, s20, s38
buffer_load_dwordx4 v7, s[4:7], s20 offen sc1 lds
s_waitcnt lgkmcnt(1)
ds_read_b128 v[52:55], v1 offset:15360
v_mfma_f32_32x32x16_bf16 v[32:47], a[40:43], v[56:59], v[32:47]
ds_read_b128 v[56:59], v1 offset:16384
v_mfma_f32_32x32x16_bf16 v[32:47], a[44:47], v[60:63], v[32:47]
s_waitcnt lgkmcnt(2)
ds_read_b128 v[60:63], v1 offset:17408
v_mfma_f32_32x32x16_bf16 v[32:47], a[48:51], v[48:51], v[32:47]
ds_read_b128 v[48:51], v1 offset:18432
s_waitcnt lgkmcnt(2)
v_mfma_f32_32x32x16_bf16 v[32:47], a[52:55], v[52:55], v[32:47]
ds_read_b128 v[52:55], v1 offset:19456
s_add_u32 m0, s25, 9216
s_add_u32 s20, s20, s38
buffer_load_dwordx4 v7, s[4:7], s20 offen sc1 lds
s_waitcnt lgkmcnt(2)
v_mfma_f32_32x32x16_bf16 v[32:47], a[56:59], v[56:59], v[32:47]
v_mfma_f32_32x32x16_bf16 v[32:47], a[60:63], v[60:63], v[32:47]
ds_read_b128 v[60:63], v1 offset:21504
ds_read_b128 v[56:59], v1 offset:20480
s_waitcnt lgkmcnt(3)
v_mov_b32 v3, s23
v_mfma_f32_32x32x16_bf16 v[32:47], a[64:67], v[48:51], v[32:47]
s_waitcnt lgkmcnt(2)
s_add_u32 m0, s25, 10240
s_add_u32 s20, s20, s38
buffer_load_dwordx4 v7, s[4:7], s20 offen sc1 lds
ds_read_b128 v[48:51], v1 offset:22528
v_mfma_f32_32x32x16_bf16 v[32:47], a[68:71], v[52:55], v[32:47]
ds_read_b128 v[52:55], v1 offset:23552
s_waitcnt lgkmcnt(2)
v_mfma_f32_32x32x16_bf16 v[32:47], a[72:75], v[56:59], v[32:47]
v_mfma_f32_32x32x16_bf16 v[32:47], a[76:79], v[60:63], v[32:47]
s_waitcnt lgkmcnt(0)
ds_read_b128 v[56:59], v1 offset:24576
v_mfma_f32_32x32x16_bf16 v[32:47], a[80:83], v[48:51], v[32:47]
ds_read_b128 v[60:63], v1 offset:25600
s_add_u32 m0, s25, 11264
s_add_u32 s20, s20, s38
buffer_load_dwordx4 v7, s[4:7], s20 offen sc1 lds
v_mfma_f32_32x32x16_bf16 v[32:47], a[84:87], v[52:55], v[32:47]
ds_read_b128 v[48:51], v1 offset:26624
s_waitcnt lgkmcnt(2)
ds_read_b128 v[52:55], v1 offset:27648
v_mfma_f32_32x32x16_bf16 v[32:47], a[88:91], v[56:59], v[32:47]
s_waitcnt lgkmcnt(2)
ds_read_b128 v[56:59], v1 offset:28672
s_add_u32 m0, s35, s37
s_add_u32 s20, s36, s37
buffer_load_dwordx4 v0, s[4:7], s20 offen sc1 lds
v_mfma_f32_32x32x16_bf16 v[32:47], a[92:95], v[60:63], v[32:47]
ds_read_b128 v[60:63], v1 offset:29696
s_waitcnt lgkmcnt(3)
v_mfma_f32_32x32x16_bf16 v[32:47], a[96:99], v[48:51], v[32:47]
s_waitcnt lgkmcnt(1)
ds_read_b128 v[48:51], v1 offset:30720
s_add_u32 m0, s35, 4096
s_add_u32 s20, s36, 4096
buffer_load_dwordx4 v0, s[4:7], s20 offen sc1 lds
v_mfma_f32_32x32x16_bf16 v[32:47], a[100:103], v[52:55], v[32:47]
ds_read_b128 v[52:55], v1 offset:31744
v_mfma_f32_32x32x16_bf16 v[32:47], a[104:107], v[56:59], v[32:47]
s_waitcnt lgkmcnt(2)
s_waitcnt lgkmcnt(1)
v_mfma_f32_32x32x16_bf16 v[32:47], a[108:111], v[60:63], v[32:47]
ds_read_b128 v[56:59], v1 offset:32768
ds_read_b128 v[60:63], v1 offset:33792
v_mfma_f32_32x32x16_bf16 v[32:47], a[112:115], v[48:51], v[32:47]
ds_read_b128 v[48:51], v1 offset:34816
s_waitcnt lgkmcnt(3)
v_mfma_f32_32x32x16_bf16 v[32:47], a[116:119], v[52:55], v[32:47]
s_waitcnt vmcnt(12)
s_barrier
ds_read_b128 v[52:55], v1 offset:35840
s_waitcnt lgkmcnt(3)
v_mfma_f32_32x32x16_bf16 v[32:47], a[120:123], v[56:59], v[32:47]
s_mov_b64 exec, 1
buffer_store_dword v3, off, s[4:7], s22 sc1
s_mov_b64 exec, -1
s_waitcnt lgkmcnt(1)
v_mfma_f32_32x32x16_bf16 v[32:47], a[124:127], v[60:63], v[32:47]
ds_read_b128 v[56:59], v1 offset:36864
s_waitcnt lgkmcnt(1)
ds_read_b128 v[60:63], v1 offset:37888
v_mfma_f32_32x32x16_bf16 v[32:47], a[128:131], v[48:51], v[32:47]
v_mfma_f32_32x32x16_bf16 v[32:47], a[132:135], v[52:55], v[32:47]
s_waitcnt lgkmcnt(1)
ds_read_b128 v[52:55], v1 offset:39936
ds_read_b128 v[48:51], v1 offset:38912
v_mfma_f32_32x32x16_bf16 v[32:47], a[136:139], v[56:59], v[32:47]
s_waitcnt lgkmcnt(2)
v_mfma_f32_32x32x16_bf16 v[32:47], a[140:143], v[60:63], v[32:47]
ds_read_b128 v[56:59], v1 offset:40960
ds_read_b128 v[60:63], v1 offset:41984
s_waitcnt lgkmcnt(2)
v_mfma_f32_32x32x16_bf16 v[32:47], a[144:147], v[48:51], v[32:47]
v_mfma_f32_32x32x16_bf16 v[32:47], a[148:151], v[52:55], v[32:47]
s_waitcnt lgkmcnt(1)
v_mfma_f32_32x32x16_bf16 v[32:47], a[152:155], v[56:59], v[32:47]
s_waitcnt lgkmcnt(0)
v_mfma_f32_32x32x16_bf16 v[32:47], a[156:159], v[60:63], v[32:47]
s_nop 11
v_cvt_pk_bf16_f32 v49, v34, v35
v_cvt_pk_bf16_f32 v48, v32, v33
v_cvt_pk_bf16_f32 v53, v42, v43
v_cvt_pk_bf16_f32 v51, v38, v39
v_cvt_pk_bf16_f32 v54, v44, v45
v_cvt_pk_bf16_f32 v50, v36, v37
v_cvt_pk_bf16_f32 v52, v40, v41
v_cvt_pk_bf16_f32 v55, v46, v47
buffer_store_dwordx4 v[48:51], v5, s[4:7], s50 offen offset:0 sc1
buffer_store_dwordx4 v[52:55], v5, s[4:7], s50 offen offset:512 sc1
s_add_u32 s39, s39, 1
s_add_u32 s50, s50, 524288
s_add_u32 s18, s51, 8192
s_cmp_eq_u32 s13, 0
s_cselect_b32 s22, s18, s6
s_mov_b32 s23, s39
s_cmp_lt_u32 s28, 64
s_cbranch_scc1 kvx_14
s_and_b32 s18, s39, 15
s_cbranch_scc0 kvt_20
s_waitcnt vmcnt(0)
s_barrier
v_mov_b32 v3, s23
s_mov_b64 exec, 1
buffer_store_dword v3, off, s[4:7], s22 sc1
s_mov_b64 exec, -1
s_mov_b32 s22, s6
s_lshl_b32 s18, s39, 2
s_add_u32 s18, s18, 4
s_cmp_lg_u32 s13, 0
s_cbranch_scc1 polld_26
v_lshlrev_b32 v3, 3, v0
v_min_u32 v28, 1152, v3
s_mov_b32 s21, 11550720
s_mov_b32 s17, 0
poll_25:
buffer_load_dword v24, v28, s[4:7], s21 offen sc1
s_add_u32 s17, s17, 1
s_cmp_gt_u32 s17, 262144
s_cbranch_scc1 L_fail
s_waitcnt vmcnt(0)
v_cmp_gt_u32 vcc, s18, v24
s_cbranch_vccz polld_26
s_sleep 2
s_branch poll_25
polld_26:
s_barrier
s_mov_b32 s53, s52
s_mov_b32 s36, s6
s_mov_b32 s38, 256
v_mov_b32 v7, v6
s_add_u32 s52, s52, 40960
s_add_u32 m0, s25, 2048
s_mov_b32 s20, s53
buffer_load_dwordx4 v7, s[4:7], s20 offen sc1 lds
s_add_u32 m0, s25, 3072
s_add_u32 s20, s20, s38
buffer_load_dwordx4 v7, s[4:7], s20 offen sc1 lds
s_add_u32 m0, s25, 4096
s_add_u32 s20, s20, s38
buffer_load_dwordx4 v7, s[4:7], s20 offen sc1 lds
s_add_u32 m0, s25, 5120
s_add_u32 s20, s20, s38
buffer_load_dwordx4 v7, s[4:7], s20 offen sc1 lds
s_add_u32 m0, s25, 6144
s_add_u32 s20, s20, s38
buffer_load_dwordx4 v7, s[4:7], s20 offen sc1 lds
s_add_u32 m0, s25, 7168
s_add_u32 s20, s20, s38
buffer_load_dwordx4 v7, s[4:7], s20 offen sc1 lds
s_add_u32 m0, s25, 8192
s_add_u32 s20, s20, s38
buffer_load_dwordx4 v7, s[4:7], s20 offen sc1 lds
s_add_u32 m0, s25, 9216
s_add_u32 s20, s20, s38
buffer_load_dwordx4 v7, s[4:7], s20 offen sc1 lds
s_add_u32 m0, s25, 10240
s_add_u32 s20, s20, s38
buffer_load_dwordx4 v7, s[4:7], s20 offen sc1 lds
s_add_u32 m0, s25, 11264
s_add_u32 s20, s20, s38
buffer_load_dwordx4 v7, s[4:7], s20 offen sc1 lds
s_waitcnt vmcnt(0)
s_branch kvm_19
kv_18:
s_lshl_b32 s18, s39, 2
s_add_u32 s18, s18, 4
s_cmp_lg_u32 s13, 0
s_cbranch_scc1 polld_28
v_lshlrev_b32 v3, 3, v0
v_min_u32 v28, 1152, v3
s_mov_b32 s21, 11550720
s_mov_b32 s17, 0
poll_27:
buffer_load_dword v24, v28, s[4:7], s21 offen sc1
s_add_u32 s17, s17, 1
s_cmp_gt_u32 s17, 262144
s_cbranch_scc1 L_fail
s_waitcnt vmcnt(0)
v_cmp_gt_u32 vcc, s18, v24
s_cbranch_vccz polld_28
s_sleep 2
s_branch poll_27
polld_28:
s_barrier
s_mov_b32 s53, s52
s_mov_b32 s36, s6
s_mov_b32 s38, 256
v_mov_b32 v7, v6
s_add_u32 s52, s52, 40960
s_branch kvn_15
kvt_20:
s_waitcnt vmcnt(0)
s_barrier
v_mov_b32 v3, s23
s_mov_b64 exec, 1
buffer_store_dword v3, off, s[4:7], s22 sc1
s_mov_b64 exec, -1
s_mov_b32 s22, s6
s_add_u32 s16, s16, 1
s_cmp_lt_u32 s16, 2
s_cbranch_scc1 kvlay_13
s_endpgm
roleV_11:
s_load_dwordx2 s[40:41], s[0:1], 16
s_mov_b32 s42, 1314816
s_mov_b32 s43, 0x20000
s_waitcnt lgkmcnt(0)
s_waitcnt vmcnt(0)
v_bfe_u32 v6, v0, 4, 2
v_lshrrev_b32 v7, 6, v0
v_mul_u32_u24 v8, 642, v6
v_lshl_add_u32 v8, v7, 2, v8
v_lshlrev_b32 v6, 4, v6
v_lshl_add_u32 v6, v7, 14, v6
s_and_b32 s18, s32, 3
s_bfe_u32 s19, s32, 0x20002
s_lshr_b32 s20, s32, 4
s_lshl_b32 s26, s20, 2
s_add_u32 s26, s26, s18
s_lshl_b32 s27, s26, 8
s_lshl_b32 s26, s26, 4
s_add_u32 s26, s26, s19
s_lshl_b32 s26, s26, 2
s_add_u32 s26, s26, s13
s_mul_i32 s26, s26, 2568
s_lshl_b32 s19, s19, 12
s_add_u32 s27, s27, s19
s_lshl_b32 s19, s13, 6
s_add_u32 s27, s27, s19
s_add_u32 s27, s27, 167774208
s_add_u32 s18, s26, 2
buffer_load_dword v20, v8, s[40:43], s18 offen offset:0
buffer_load_dword v24, v8, s[40:43], s18 offen offset:64
buffer_load_dword v28, v8, s[40:43], s18 offen offset:128
buffer_load_dword v32, v8, s[40:43], s18 offen offset:192
buffer_load_dword v36, v8, s[40:43], s18 offen offset:256
buffer_load_dword v40, v8, s[40:43], s18 offen offset:320
buffer_load_dword v44, v8, s[40:43], s18 offen offset:384
buffer_load_dword v48, v8, s[40:43], s18 offen offset:448
buffer_load_dword v52, v8, s[40:43], s18 offen offset:512
buffer_load_dword v56, v8, s[40:43], s18 offen offset:576
s_add_u32 s18, s26, 41090
buffer_load_dword v21, v8, s[40:43], s18 offen offset:0
buffer_load_dword v25, v8, s[40:43], s18 offen offset:64
buffer_load_dword v29, v8, s[40:43], s18 offen offset:128
buffer_load_dword v33, v8, s[40:43], s18 offen offset:192
buffer_load_dword v37, v8, s[40:43], s18 offen offset:256
buffer_load_dword v41, v8, s[40:43], s18 offen offset:320
buffer_load_dword v45, v8, s[40:43], s18 offen offset:384
buffer_load_dword v49, v8, s[40:43], s18 offen offset:448
buffer_load_dword v53, v8, s[40:43], s18 offen offset:512
buffer_load_dword v57, v8, s[40:43], s18 offen offset:576
s_add_u32 s18, s26, 82178
buffer_load_dword v22, v8, s[40:43], s18 offen offset:0
buffer_load_dword v26, v8, s[40:43], s18 offen offset:64
buffer_load_dword v30, v8, s[40:43], s18 offen offset:128
buffer_load_dword v34, v8, s[40:43], s18 offen offset:192
buffer_load_dword v38, v8, s[40:43], s18 offen offset:256
buffer_load_dword v42, v8, s[40:43], s18 offen offset:320
buffer_load_dword v46, v8, s[40:43], s18 offen offset:384
buffer_load_dword v50, v8, s[40:43], s18 offen offset:448
buffer_load_dword v54, v8, s[40:43], s18 offen offset:512
buffer_load_dword v58, v8, s[40:43], s18 offen offset:576
s_add_u32 s18, s26, 123266
buffer_load_dword v23, v8, s[40:43], s18 offen offset:0
buffer_load_dword v27, v8, s[40:43], s18 offen offset:64
buffer_load_dword v31, v8, s[40:43], s18 offen offset:128
buffer_load_dword v35, v8, s[40:43], s18 offen offset:192
buffer_load_dword v39, v8, s[40:43], s18 offen offset:256
buffer_load_dword v43, v8, s[40:43], s18 offen offset:320
buffer_load_dword v47, v8, s[40:43], s18 offen offset:384
buffer_load_dword v51, v8, s[40:43], s18 offen offset:448
buffer_load_dword v55, v8, s[40:43], s18 offen offset:512
buffer_load_dword v59, v8, s[40:43], s18 offen offset:576
s_waitcnt vmcnt(9)
buffer_store_dwordx4 v[20:23], v6, s[4:7], s27 offen sc1
s_add_u32 s27, s27, 262144
s_waitcnt vmcnt(9)
buffer_store_dwordx4 v[24:27], v6, s[4:7], s27 offen sc1
s_add_u32 s27, s27, 262144
s_waitcnt vmcnt(9)
buffer_store_dwordx4 v[28:31], v6, s[4:7], s27 offen sc1
s_add_u32 s27, s27, 262144
s_waitcnt vmcnt(9)
buffer_store_dwordx4 v[32:35], v6, s[4:7], s27 offen sc1
s_add_u32 s27, s27, 262144
s_waitcnt vmcnt(9)
buffer_store_dwordx4 v[36:39], v6, s[4:7], s27 offen sc1
s_add_u32 s27, s27, 262144
s_waitcnt vmcnt(9)
buffer_store_dwordx4 v[40:43], v6, s[4:7], s27 offen sc1
s_add_u32 s27, s27, 262144
s_waitcnt vmcnt(9)
buffer_store_dwordx4 v[44:47], v6, s[4:7], s27 offen sc1
s_add_u32 s27, s27, 262144
s_waitcnt vmcnt(9)
buffer_store_dwordx4 v[48:51], v6, s[4:7], s27 offen sc1
s_add_u32 s27, s27, 262144
s_waitcnt vmcnt(9)
buffer_store_dwordx4 v[52:55], v6, s[4:7], s27 offen sc1
s_add_u32 s27, s27, 262144
s_waitcnt vmcnt(9)
buffer_store_dwordx4 v[56:59], v6, s[4:7], s27 offen sc1
s_add_u32 s27, s27, 262144
s_lshl_b32 s18, s15, 7
s_add_u32 s18, s18, 11563008
s_cmp_eq_u32 s13, 0
s_cselect_b32 s22, s18, s6
s_mov_b32 s23, 1
s_waitcnt vmcnt(0)
s_barrier
v_mov_b32 v3, s23
s_mov_b64 exec, 1
buffer_store_dword v3, off, s[4:7], s22 sc1
s_mov_b64 exec, -1
s_mov_b32 s22, s6
s_lshl_b32 s26, s32, 8
s_lshl_b32 s18, s13, 6
s_add_u32 s26, s26, s18
s_load_dwordx2 s[40:41], s[0:1], 56
s_mov_b32 s42, 5242880
s_mov_b32 s43, 0x20000
s_waitcnt lgkmcnt(0)
v_lshrrev_b32 v20, 6, v0
v_mul_u32_u24 v20, 8192, v20
v_and_b32 v21, 48, v0
v_add_u32 v18, v20, v21
v_bfe_u32 v20, v0, 6, 2
v_lshrrev_b32 v21, 9, v0
v_lshl_add_u32 v20, v21, 3, v20
v_lshlrev_b32 v19, 6, v20
v_and_b32 v20, 48, v0
v_add_u32 v19, v19, v20
v_bfe_u32 v20, v0, 8, 1
v_lshl_add_u32 v19, v20, 3, v19
s_mul_i32 s18, s13, 36864
v_add_u32 v19, s18, v19
s_barrier
s_add_u32 m0, s18, 0
s_add_u32 s19, s26, 0
buffer_load_dwordx4 v18, s[40:43], s19 offen lds
s_add_u32 m0, s18, 1024
s_add_u32 s19, s26, 131072
buffer_load_dwordx4 v18, s[40:43], s19 offen lds
s_add_u32 m0, s18, 2048
s_add_u32 s19, s26, 262144
buffer_load_dwordx4 v18, s[40:43], s19 offen lds
s_add_u32 m0, s18, 3072
s_add_u32 s19, s26, 393216
buffer_load_dwordx4 v18, s[40:43], s19 offen lds
s_add_u32 m0, s18, 4096
s_add_u32 s19, s26, 524288
buffer_load_dwordx4 v18, s[40:43], s19 offen lds
s_add_u32 m0, s18, 5120
s_add_u32 s19, s26, 655360
buffer_load_dwordx4 v18, s[40:43], s19 offen lds
s_add_u32 m0, s18, 6144
s_add_u32 s19, s26, 786432
buffer_load_dwordx4 v18, s[40:43], s19 offen lds
s_add_u32 m0, s18, 7168
s_add_u32 s19, s26, 917504
buffer_load_dwordx4 v18, s[40:43], s19 offen lds
s_add_u32 m0, s18, 8192
s_add_u32 s19, s26, 1048576
buffer_load_dwordx4 v18, s[40:43], s19 offen lds
s_add_u32 m0, s18, 9216
s_add_u32 s19, s26, 1179648
buffer_load_dwordx4 v18, s[40:43], s19 offen lds
s_add_u32 m0, s18, 10240
s_add_u32 s19, s26, 1310720
buffer_load_dwordx4 v18, s[40:43], s19 offen lds
s_add_u32 m0, s18, 11264
s_add_u32 s19, s26, 1441792
buffer_load_dwordx4 v18, s[40:43], s19 offen lds
s_add_u32 m0, s18, 12288
s_add_u32 s19, s26, 1572864
buffer_load_dwordx4 v18, s[40:43], s19 offen lds
s_add_u32 m0, s18, 13312
s_add_u32 s19, s26, 1703936
buffer_load_dwordx4 v18, s[40:43], s19 offen lds
s_add_u32 m0, s18, 14336
s_add_u32 s19, s26, 1835008
buffer_load_dwordx4 v18, s[40:43], s19 offen lds
s_add_u32 m0, s18, 15360
s_add_u32 s19, s26, 1966080
buffer_load_dwordx4 v18, s[40:43], s19 offen lds
s_add_u32 m0, s18, 16384
s_add_u32 s19, s26, 2097152
buffer_load_dwordx4 v18, s[40:43], s19 offen lds
s_add_u32 m0, s18, 17408
s_add_u32 s19, s26, 2228224
buffer_load_dwordx4 v18, s[40:43], s19 offen lds
s_add_u32 m0, s18, 18432
s_add_u32 s19, s26, 2359296
buffer_load_dwordx4 v18, s[40:43], s19 offen lds
s_add_u32 m0, s18, 19456
s_add_u32 s19, s26, 2490368
buffer_load_dwordx4 v18, s[40:43], s19 offen lds
s_add_u32 m0, s18, 20480
s_add_u32 s19, s26, 2621440
buffer_load_dwordx4 v18, s[40:43], s19 offen lds
s_add_u32 m0, s18, 21504
s_add_u32 s19, s26, 2752512
buffer_load_dwordx4 v18, s[40:43], s19 offen lds
s_add_u32 m0, s18, 22528
s_add_u32 s19, s26, 2883584
buffer_load_dwordx4 v18, s[40:43], s19 offen lds
s_add_u32 m0, s18, 23552
s_add_u32 s19, s26, 3014656
buffer_load_dwordx4 v18, s[40:43], s19 offen lds
s_add_u32 m0, s18, 24576
s_add_u32 s19, s26, 3145728
buffer_load_dwordx4 v18, s[40:43], s19 offen lds
s_add_u32 m0, s18, 25600
s_add_u32 s19, s26, 3276800
buffer_load_dwordx4 v18, s[40:43], s19 offen lds
s_add_u32 m0, s18, 26624
s_add_u32 s19, s26, 3407872
buffer_load_dwordx4 v18, s[40:43], s19 offen lds
s_add_u32 m0, s18, 27648
s_add_u32 s19, s26, 3538944
buffer_load_dwordx4 v18, s[40:43], s19 offen lds
s_add_u32 m0, s18, 28672
s_add_u32 s19, s26, 3670016
buffer_load_dwordx4 v18, s[40:43], s19 offen lds
s_add_u32 m0, s18, 29696
s_add_u32 s19, s26, 3801088
buffer_load_dwordx4 v18, s[40:43], s19 offen lds
s_add_u32 m0, s18, 30720
s_add_u32 s19, s26, 3932160
buffer_load_dwordx4 v18, s[40:43], s19 offen lds
s_add_u32 m0, s18, 31744
s_add_u32 s19, s26, 4063232
buffer_load_dwordx4 v18, s[40:43], s19 offen lds
s_add_u32 m0, s18, 32768
s_add_u32 s19, s26, 4194304
buffer_load_dwordx4 v18, s[40:43], s19 offen lds
s_add_u32 m0, s18, 33792
s_add_u32 s19, s26, 4325376
buffer_load_dwordx4 v18, s[40:43], s19 offen lds
s_add_u32 m0, s18, 34816
s_add_u32 s19, s26, 4456448
buffer_load_dwordx4 v18, s[40:43], s19 offen lds
s_add_u32 m0, s18, 35840
s_add_u32 s19, s26, 4587520
buffer_load_dwordx4 v18, s[40:43], s19 offen lds
s_waitcnt vmcnt(32)
ds_read_b64_tr_b16 a[0:1], v19 offset:0
ds_read_b64_tr_b16 a[2:3], v19 offset:256
ds_read_b64_tr_b16 a[4:5], v19 offset:1024
ds_read_b64_tr_b16 a[6:7], v19 offset:1280
ds_read_b64_tr_b16 a[8:9], v19 offset:2048
ds_read_b64_tr_b16 a[10:11], v19 offset:2304
ds_read_b64_tr_b16 a[12:13], v19 offset:3072
ds_read_b64_tr_b16 a[14:15], v19 offset:3328
s_waitcnt lgkmcnt(0)
s_add_u32 m0, s18, 0
s_add_u32 s19, s26, 4718592
buffer_load_dwordx4 v18, s[40:43], s19 offen lds
s_add_u32 m0, s18, 1024
s_add_u32 s19, s26, 4849664
buffer_load_dwordx4 v18, s[40:43], s19 offen lds
s_add_u32 m0, s18, 2048
s_add_u32 s19, s26, 4980736
buffer_load_dwordx4 v18, s[40:43], s19 offen lds
s_add_u32 m0, s18, 3072
s_add_u32 s19, s26, 5111808
buffer_load_dwordx4 v18, s[40:43], s19 offen lds
s_waitcnt vmcnt(32)
ds_read_b64_tr_b16 a[16:17], v19 offset:4096
ds_read_b64_tr_b16 a[18:19], v19 offset:4352
ds_read_b64_tr_b16 a[20:21], v19 offset:5120
ds_read_b64_tr_b16 a[22:23], v19 offset:5376
ds_read_b64_tr_b16 a[24:25], v19 offset:6144
ds_read_b64_tr_b16 a[26:27], v19 offset:6400
ds_read_b64_tr_b16 a[28:29], v19 offset:7168
ds_read_b64_tr_b16 a[30:31], v19 offset:7424
s_waitcnt vmcnt(28)
ds_read_b64_tr_b16 a[32:33], v19 offset:8192
ds_read_b64_tr_b16 a[34:35], v19 offset:8448
ds_read_b64_tr_b16 a[36:37], v19 offset:9216
ds_read_b64_tr_b16 a[38:39], v19 offset:9472
ds_read_b64_tr_b16 a[40:41], v19 offset:10240
ds_read_b64_tr_b16 a[42:43], v19 offset:10496
ds_read_b64_tr_b16 a[44:45], v19 offset:11264
ds_read_b64_tr_b16 a[46:47], v19 offset:11520
s_waitcnt vmcnt(24)
ds_read_b64_tr_b16 a[48:49], v19 offset:12288
ds_read_b64_tr_b16 a[50:51], v19 offset:12544
ds_read_b64_tr_b16 a[52:53], v19 offset:13312
ds_read_b64_tr_b16 a[54:55], v19 offset:13568
ds_read_b64_tr_b16 a[56:57], v19 offset:14336
ds_read_b64_tr_b16 a[58:59], v19 offset:14592
ds_read_b64_tr_b16 a[60:61], v19 offset:15360
ds_read_b64_tr_b16 a[62:63], v19 offset:15616
s_waitcnt vmcnt(20)
ds_read_b64_tr_b16 a[64:65], v19 offset:16384
ds_read_b64_tr_b16 a[66:67], v19 offset:16640
ds_read_b64_tr_b16 a[68:69], v19 offset:17408
ds_read_b64_tr_b16 a[70:71], v19 offset:17664
ds_read_b64_tr_b16 a[72:73], v19 offset:18432
ds_read_b64_tr_b16 a[74:75], v19 offset:18688
ds_read_b64_tr_b16 a[76:77], v19 offset:19456
ds_read_b64_tr_b16 a[78:79], v19 offset:19712
s_waitcnt vmcnt(16)
ds_read_b64_tr_b16 a[80:81], v19 offset:20480
ds_read_b64_tr_b16 a[82:83], v19 offset:20736
ds_read_b64_tr_b16 a[84:85], v19 offset:21504
ds_read_b64_tr_b16 a[86:87], v19 offset:21760
ds_read_b64_tr_b16 a[88:89], v19 offset:22528
ds_read_b64_tr_b16 a[90:91], v19 offset:22784
ds_read_b64_tr_b16 a[92:93], v19 offset:23552
ds_read_b64_tr_b16 a[94:95], v19 offset:23808
s_waitcnt vmcnt(12)
ds_read_b64_tr_b16 a[96:97], v19 offset:24576
ds_read_b64_tr_b16 a[98:99], v19 offset:24832
ds_read_b64_tr_b16 a[100:101], v19 offset:25600
ds_read_b64_tr_b16 a[102:103], v19 offset:25856
ds_read_b64_tr_b16 a[104:105], v19 offset:26624
ds_read_b64_tr_b16 a[106:107], v19 offset:26880
ds_read_b64_tr_b16 a[108:109], v19 offset:27648
ds_read_b64_tr_b16 a[110:111], v19 offset:27904
s_waitcnt vmcnt(8)
ds_read_b64_tr_b16 a[112:113], v19 offset:28672
ds_read_b64_tr_b16 a[114:115], v19 offset:28928
ds_read_b64_tr_b16 a[116:117], v19 offset:29696
ds_read_b64_tr_b16 a[118:119], v19 offset:29952
ds_read_b64_tr_b16 a[120:121], v19 offset:30720
ds_read_b64_tr_b16 a[122:123], v19 offset:30976
ds_read_b64_tr_b16 a[124:125], v19 offset:31744
ds_read_b64_tr_b16 a[126:127], v19 offset:32000
s_waitcnt vmcnt(4)
ds_read_b64_tr_b16 a[128:129], v19 offset:32768
ds_read_b64_tr_b16 a[130:131], v19 offset:33024
ds_read_b64_tr_b16 a[132:133], v19 offset:33792
ds_read_b64_tr_b16 a[134:135], v19 offset:34048
ds_read_b64_tr_b16 a[136:137], v19 offset:34816
ds_read_b64_tr_b16 a[138:139], v19 offset:35072
ds_read_b64_tr_b16 a[140:141], v19 offset:35840
ds_read_b64_tr_b16 a[142:143], v19 offset:36096
s_waitcnt vmcnt(0)
ds_read_b64_tr_b16 a[144:145], v19 offset:0
ds_read_b64_tr_b16 a[146:147], v19 offset:256
ds_read_b64_tr_b16 a[148:149], v19 offset:1024
ds_read_b64_tr_b16 a[150:151], v19 offset:1280
ds_read_b64_tr_b16 a[152:153], v19 offset:2048
ds_read_b64_tr_b16 a[154:155], v19 offset:2304
ds_read_b64_tr_b16 a[156:157], v19 offset:3072
ds_read_b64_tr_b16 a[158:159], v19 offset:3328
s_waitcnt lgkmcnt(0)
s_barrier
s_load_dwordx2 s[40:41], s[0:1], 64
s_mov_b32 s42, 5242880
s_mov_b32 s43, 0x20000
s_waitcnt lgkmcnt(0)
v_lshlrev_b32 v6, 3, v0
s_mul_i32 s18, s32, 163840
s_mul_i32 s19, s13, 40960
s_add_u32 s18, s18, s19
buffer_load_dword v12, v6, s[40:43], s18 offen
s_add_u32 s18, s18, 8192
buffer_load_dword v13, v6, s[40:43], s18 offen
s_add_u32 s18, s18, 8192
buffer_load_dword v14, v6, s[40:43], s18 offen
s_add_u32 s18, s18, 8192
buffer_load_dword v15, v6, s[40:43], s18 offen
s_add_u32 s18, s18, 8192
buffer_load_dword v16, v6, s[40:43], s18 offen
s_add_u32 s18, s18, 8192
v_mov_b32 v20, s24
v_mov_b32 v21, s24
v_mov_b32 v22, s24
v_mov_b32 v23, s24
s_nop 1
v_mfma_f32_32x32x16_bf16 v[24:39], v[20:23], a[0:3], 0
v_mfma_f32_32x32x16_bf16 v[24:39], v[20:23], a[4:7], v[24:39]
v_mfma_f32_32x32x16_bf16 v[24:39], v[20:23], a[8:11], v[24:39]
v_mfma_f32_32x32x16_bf16 v[24:39], v[20:23], a[12:15], v[24:39]
v_mfma_f32_32x32x16_bf16 v[24:39], v[20:23], a[16:19], v[24:39]
v_mfma_f32_32x32x16_bf16 v[24:39], v[20:23], a[20:23], v[24:39]
v_mfma_f32_32x32x16_bf16 v[24:39], v[20:23], a[24:27], v[24:39]
v_mfma_f32_32x32x16_bf16 v[24:39], v[20:23], a[28:31], v[24:39]
v_mfma_f32_32x32x16_bf16 v[24:39], v[20:23], a[32:35], v[24:39]
v_mfma_f32_32x32x16_bf16 v[24:39], v[20:23], a[36:39], v[24:39]
v_mfma_f32_32x32x16_bf16 v[24:39], v[20:23], a[40:43], v[24:39]
v_mfma_f32_32x32x16_bf16 v[24:39], v[20:23], a[44:47], v[24:39]
v_mfma_f32_32x32x16_bf16 v[24:39], v[20:23], a[48:51], v[24:39]
v_mfma_f32_32x32x16_bf16 v[24:39], v[20:23], a[52:55], v[24:39]
v_mfma_f32_32x32x16_bf16 v[24:39], v[20:23], a[56:59], v[24:39]
v_mfma_f32_32x32x16_bf16 v[24:39], v[20:23], a[60:63], v[24:39]
v_mfma_f32_32x32x16_bf16 v[24:39], v[20:23], a[64:67], v[24:39]
v_mfma_f32_32x32x16_bf16 v[24:39], v[20:23], a[68:71], v[24:39]
v_mfma_f32_32x32x16_bf16 v[24:39], v[20:23], a[72:75], v[24:39]
v_mfma_f32_32x32x16_bf16 v[24:39], v[20:23], a[76:79], v[24:39]
v_mfma_f32_32x32x16_bf16 v[24:39], v[20:23], a[80:83], v[24:39]
v_mfma_f32_32x32x16_bf16 v[24:39], v[20:23], a[84:87], v[24:39]
v_mfma_f32_32x32x16_bf16 v[24:39], v[20:23], a[88:91], v[24:39]
v_mfma_f32_32x32x16_bf16 v[24:39], v[20:23], a[92:95], v[24:39]
v_mfma_f32_32x32x16_bf16 v[24:39], v[20:23], a[96:99], v[24:39]
v_mfma_f32_32x32x16_bf16 v[24:39], v[20:23], a[100:103], v[24:39]
v_mfma_f32_32x32x16_bf16 v[24:39], v[20:23], a[104:107], v[24:39]
v_mfma_f32_32x32x16_bf16 v[24:39], v[20:23], a[108:111], v[24:39]
v_mfma_f32_32x32x16_bf16 v[24:39], v[20:23], a[112:115], v[24:39]
v_mfma_f32_32x32x16_bf16 v[24:39], v[20:23], a[116:119], v[24:39]
v_mfma_f32_32x32x16_bf16 v[24:39], v[20:23], a[120:123], v[24:39]
v_mfma_f32_32x32x16_bf16 v[24:39], v[20:23], a[124:127], v[24:39]
v_mfma_f32_32x32x16_bf16 v[24:39], v[20:23], a[128:131], v[24:39]
v_mfma_f32_32x32x16_bf16 v[24:39], v[20:23], a[132:135], v[24:39]
v_mfma_f32_32x32x16_bf16 v[24:39], v[20:23], a[136:139], v[24:39]
v_mfma_f32_32x32x16_bf16 v[24:39], v[20:23], a[140:143], v[24:39]
v_mfma_f32_32x32x16_bf16 v[24:39], v[20:23], a[144:147], v[24:39]
v_mfma_f32_32x32x16_bf16 v[24:39], v[20:23], a[148:151], v[24:39]
v_mfma_f32_32x32x16_bf16 v[24:39], v[20:23], a[152:155], v[24:39]
v_mfma_f32_32x32x16_bf16 v[24:39], v[20:23], a[156:159], v[24:39]
s_nop 11
v_mov_b32 v5, v24
v_and_b32 v6, 0xf0, v0
s_waitcnt vmcnt(4)
v_bfe_u32 v12, v0, 8, 1
v_lshl_add_u32 v6, v12, 10, v6
v_lshrrev_b32 v12, 9, v0
v_lshl_add_u32 v6, v12, 8, v6
s_lshl_b32 s34, s13, 12
s_add_u32 s34, s34, 2048
s_lshl_b32 s18, s32, 14
s_add_u32 s34, s34, s18
v_bfe_u32 v7, v0, 7, 2
v_mul_u32_u24 v7, 10240, v7
v_bfe_u32 v12, v0, 5, 2
v_lshl_add_u32 v7, v12, 6, v7
v_lshrrev_b32 v12, 9, v0
v_lshl_add_u32 v7, v12, 5, v7
v_and_b32 v12, 16, v0
v_add_u32 v7, v12, v7
s_lshl_b32 s51, s32, 8
s_add_u32 s51, s51, 11534464
s_mul_i32 s52, s13, 2560
s_add_u32 s52, s52, 12582912
s_add_u32 s50, s34, 110100480
s_mov_b32 s39, 0
kvlay_29:
s_mul_i32 s26, s16, 6291456
s_add_u32 s26, s26, 88080384
s_add_u32 s26, s26, s31
s_mul_i32 s54, s16, 327680
s_add_u32 s54, s54, 163577856
s_mul_i32 s27, s16, 35651584
s_add_u32 s27, s27, 16777216
s_mul_i32 s18, s32, 0
s_add_u32 s27, s27, s18
s_add_u32 s27, s27, s34
s_lshl_b32 s29, s16, 1
s_add_u32 s29, s29, 1
s_mov_b32 s28, 0
s_mov_b32 s30, 0
s_cmp_lt_u32 s30, 64
s_cselect_b32 s53, s26, s6
s_cselect_b32 s36, s54, s6
s_mov_b32 s38, 1024
v_mov_b32 v8, v0
s_add_u32 s26, s26, 40960
s_add_u32 s54, s54, 5120
s_add_u32 s30, s30, 1
v_xor_b32 v1, 40960, v0
s_mov_b32 s25, s31
s_mov_b32 s35, 131072
s_cmp_lg_u32 s13, 0
s_cbranch_scc1 polld_38
v_lshlrev_b32 v3, 3, v0
s_waitcnt vmcnt(0)
v_min_u32 v16, 1152, v3
s_mov_b32 s21, 11612160
s_mov_b32 s17, 0
poll_37:
buffer_load_dword v12, v16, s[4:7], s21 offen sc1
s_add_u32 s17, s17, 1
s_cmp_gt_u32 s17, 262144
s_cbranch_scc1 L_fail
s_waitcnt vmcnt(0)
v_cmp_gt_u32 vcc, s29, v12
s_cbranch_vccz polld_38
s_sleep 2
s_branch poll_37
polld_38:
s_barrier
s_add_u32 m0, s25, 2048
s_mov_b32 s20, s53
buffer_load_dwordx4 v8, s[4:7], s20 offen sc1 lds
s_add_u32 m0, s25, 3072
s_add_u32 s20, s20, s38
buffer_load_dwordx4 v8, s[4:7], s20 offen sc1 lds
s_add_u32 m0, s25, 4096
s_add_u32 s20, s20, s38
buffer_load_dwordx4 v8, s[4:7], s20 offen sc1 lds
s_add_u32 m0, s25, 5120
s_add_u32 s20, s20, s38
buffer_load_dwordx4 v8, s[4:7], s20 offen sc1 lds
s_add_u32 m0, s25, 6144
s_add_u32 s20, s20, s38
buffer_load_dwordx4 v8, s[4:7], s20 offen sc1 lds
s_add_u32 m0, s25, 7168
s_add_u32 s20, s20, s38
buffer_load_dwordx4 v8, s[4:7], s20 offen sc1 lds
s_add_u32 m0, s25, 8192
s_add_u32 s20, s20, s38
buffer_load_dwordx4 v8, s[4:7], s20 offen sc1 lds
s_add_u32 m0, s25, 9216
s_add_u32 s20, s20, s38
buffer_load_dwordx4 v8, s[4:7], s20 offen sc1 lds
s_add_u32 m0, s25, 10240
s_add_u32 s20, s20, s38
buffer_load_dwordx4 v8, s[4:7], s20 offen sc1 lds
s_add_u32 m0, s25, 11264
s_add_u32 s20, s20, s38
buffer_load_dwordx4 v8, s[4:7], s20 offen sc1 lds
s_add_u32 m0, s35, s37
s_add_u32 s20, s36, s37
buffer_load_dwordx4 v0, s[4:7], s20 offen sc1 lds
s_add_u32 m0, s35, 4096
s_add_u32 s20, s36, 4096
buffer_load_dwordx4 v0, s[4:7], s20 offen sc1 lds
s_waitcnt vmcnt(0)
kvx_30:
v_xor_b32 v1, 40960, v1
s_sub_u32 s25, s25, s31
s_xor_b32 s25, s25, 40960
s_add_u32 s25, s25, s31
s_xor_b32 s35, s35, 8192
s_cmp_eq_u32 s28, 1
s_cbranch_scc1 kv_32
s_cmp_eq_u32 s28, 30
s_cbranch_scc0 kv_33
s_add_u32 s29, s29, 1
kv_32:
s_waitcnt vmcnt(0)
s_barrier
v_mov_b32 v3, s23
s_mov_b64 exec, 1
buffer_store_dword v3, off, s[4:7], s22 sc1
s_mov_b64 exec, -1
s_mov_b32 s22, s6
s_cmp_lg_u32 s13, 0
s_cbranch_scc1 polld_40
v_lshlrev_b32 v3, 3, v0
v_min_u32 v16, 3968, v3
s_mov_b32 s21, 11612160
s_mov_b32 s17, 0
poll_39:
buffer_load_dword v12, v3, s[4:7], s21 offen sc1
s_add_u32 s20, s21, 8192
buffer_load_dword v13, v3, s[4:7], s20 offen sc1
s_add_u32 s20, s21, 16384
buffer_load_dword v14, v16, s[4:7], s20 offen sc1
s_add_u32 s17, s17, 1
s_cmp_gt_u32 s17, 262144
s_cbranch_scc1 L_fail
s_waitcnt vmcnt(1)
v_min_u32 v12, v12, v13
s_waitcnt vmcnt(0)
v_min_u32 v12, v12, v14
v_cmp_gt_u32 vcc, s29, v12
s_cbranch_vccz polld_40
s_sleep 2
s_branch poll_39
polld_40:
s_barrier
kv_33:
s_add_u32 s28, s28, 1
s_and_b32 s33, s28, 3
s_cmp_lt_u32 s28, 12
s_cselect_b32 s33, 1, s33
s_cmp_eq_u32 s33, 0
s_cbranch_scc1 kv_34
s_cmp_lt_u32 s30, 64
s_cselect_b32 s53, s26, s6
s_cselect_b32 s36, s54, s6
s_mov_b32 s38, 1024
v_mov_b32 v8, v0
s_add_u32 s26, s26, 40960
s_add_u32 s54, s54, 5120
s_add_u32 s30, s30, 1
kvn_31:
s_waitcnt vmcnt(3)
s_barrier
ds_read_b128 v[36:39], v1 offset:2048
s_add_u32 m0, s25, 2048
s_mov_b32 s20, s53
buffer_load_dwordx4 v8, s[4:7], s20 offen sc1 lds
ds_read_b128 v[40:43], v1 offset:3072
s_xor_b32 s18, s35, 8192
v_lshrrev_b32 v2, 2, v0
v_add_u32 v2, s18, v2
ds_read_b128 v[48:51], v1 offset:5120
s_add_u32 m0, s25, 3072
s_add_u32 s20, s20, s38
buffer_load_dwordx4 v8, s[4:7], s20 offen sc1 lds
ds_read_b128 v[44:47], v1 offset:4096
s_waitcnt lgkmcnt(3)
v_mfma_f32_32x32x16_bf16 v[20:35], v[36:39], a[0:3], 0
ds_read2st64_b32 v[62:63], v2 offset0:6 offset1:7
s_waitcnt lgkmcnt(3)
ds_read2st64_b32 v[72:73], v2 offset0:16 offset1:17
ds_read2st64_b32 v[74:75], v2 offset0:18 offset1:19
ds_read_b128 v[36:39], v1 offset:6144
v_mfma_f32_32x32x16_bf16 v[20:35], v[40:43], a[4:7], v[20:35]
s_add_u32 m0, s25, 4096
s_add_u32 s20, s20, s38
buffer_load_dwordx4 v8, s[4:7], s20 offen sc1 lds
ds_read2st64_b32 v[54:55], v2 offset0:2 offset1:3
s_waitcnt lgkmcnt(5)
ds_read2st64_b32 v[52:53], v2 offset0:0 offset1:1
v_mfma_f32_32x32x16_bf16 v[20:35], v[44:47], a[8:11], v[20:35]
ds_read_b128 v[40:43], v1 offset:7168
ds_read2st64_b32 v[60:61], v2 offset0:4 offset1:5
ds_read2st64_b32 v[66:67], v2 offset0:10 offset1:11
s_add_u32 m0, s25, 5120
s_add_u32 s20, s20, s38
buffer_load_dwordx4 v8, s[4:7], s20 offen sc1 lds
v_mfma_f32_32x32x16_bf16 v[20:35], v[48:51], a[12:15], v[20:35]
ds_read_b128 v[48:51], v1 offset:9216
s_waitcnt lgkmcnt(6)
ds_read_b128 v[44:47], v1 offset:8192
s_waitcnt lgkmcnt(5)
ds_read2st64_b32 v[70:71], v2 offset0:14 offset1:15
v_mfma_f32_32x32x16_bf16 v[20:35], v[36:39], a[16:19], v[20:35]
s_add_u32 m0, s25, 6144
s_add_u32 s20, s20, s38
buffer_load_dwordx4 v8, s[4:7], s20 offen sc1 lds
s_waitcnt lgkmcnt(3)
ds_read2st64_b32 v[68:69], v2 offset0:12 offset1:13
v_mfma_f32_32x32x16_bf16 v[20:35], v[40:43], a[20:23], v[20:35]
s_waitcnt lgkmcnt(3)
ds_read_b128 v[36:39], v1 offset:10240
s_waitcnt lgkmcnt(3)
ds_read_b128 v[40:43], v1 offset:11264
v_mfma_f32_32x32x16_bf16 v[20:35], v[44:47], a[24:27], v[20:35]
ds_read_b128 v[44:47], v1 offset:12288
v_add_f32 v52, v52, v54
ds_read2st64_b32 v[64:65], v2 offset0:8 offset1:9
v_mfma_f32_32x32x16_bf16 v[20:35], v[48:51], a[28:31], v[20:35]
s_add_u32 m0, s25, 7168
s_add_u32 s20, s20, s38
buffer_load_dwordx4 v8, s[4:7], s20 offen sc1 lds
v_add_f32 v53, v53, v55
v_add_f32 v52, v52, v60
s_waitcnt lgkmcnt(3)
v_mfma_f32_32x32x16_bf16 v[20:35], v[36:39], a[32:35], v[20:35]
ds_read_b128 v[48:51], v1 offset:13312
s_waitcnt lgkmcnt(3)
s_waitcnt lgkmcnt(2)
ds_read_b128 v[36:39], v1 offset:14336
v_mfma_f32_32x32x16_bf16 v[20:35], v[40:43], a[36:39], v[20:35]
ds_read_b128 v[40:43], v1 offset:15360
s_add_u32 m0, s25, 8192
s_add_u32 s20, s20, s38
buffer_load_dwordx4 v8, s[4:7], s20 offen sc1 lds
v_mfma_f32_32x32x16_bf16 v[20:35], v[44:47], a[40:43], v[20:35]
s_add_u32 m0, s25, 9216
s_add_u32 s20, s20, s38
buffer_load_dwordx4 v8, s[4:7], s20 offen sc1 lds
v_mov_b32 v3, s23
v_add_f32 v53, v53, v61
s_waitcnt lgkmcnt(1)
v_add_f32 v53, v53, v63
v_mfma_f32_32x32x16_bf16 v[20:35], v[48:51], a[44:47], v[20:35]
v_add_f32 v52, v52, v62
v_add_f32 v52, v52, v64
ds_read_b128 v[44:47], v1 offset:16384
v_add_f32 v53, v53, v65
v_mfma_f32_32x32x16_bf16 v[20:35], v[36:39], a[48:51], v[20:35]
s_waitcnt lgkmcnt(1)
ds_read_b128 v[48:51], v1 offset:17408
ds_read_b128 v[36:39], v1 offset:18432
v_bfe_u32 v54, v0, 5, 5
v_add_f32 v53, v53, v67
v_and_b32 v54, 16, v54
v_add_f32 v53, v53, v69
v_mfma_f32_32x32x16_bf16 v[20:35], v[40:43], a[52:55], v[20:35]
v_add_f32 v52, v52, v66
ds_read_b128 v[40:43], v1 offset:19456
s_waitcnt lgkmcnt(3)
v_mfma_f32_32x32x16_bf16 v[20:35], v[44:47], a[56:59], v[20:35]
s_waitcnt lgkmcnt(2)
v_add_f32 v52, v52, v68
s_add_u32 m0, s25, 10240
s_add_u32 s20, s20, s38
buffer_load_dwordx4 v8, s[4:7], s20 offen sc1 lds
v_mfma_f32_32x32x16_bf16 v[20:35], v[48:51], a[60:63], v[20:35]
ds_read_b128 v[44:47], v1 offset:20480
v_add_f32 v53, v53, v71
s_waitcnt lgkmcnt(2)
v_add_f32 v52, v52, v70
v_add_f32 v52, v52, v72
v_add_f32 v53, v53, v73
v_mfma_f32_32x32x16_bf16 v[20:35], v[36:39], a[64:67], v[20:35]
ds_read_b128 v[48:51], v1 offset:21504
v_add_f32 v52, v52, v74
s_waitcnt lgkmcnt(2)
v_mfma_f32_32x32x16_bf16 v[20:35], v[40:43], a[68:71], v[20:35]
ds_read_b128 v[40:43], v1 offset:23552
ds_read_b128 v[36:39], v1 offset:22528
v_add_f32 v53, v53, v75
s_waitcnt lgkmcnt(3)
v_add_f32 v52, v52, v53
v_mfma_f32_32x32x16_bf16 v[20:35], v[44:47], a[72:75], v[20:35]
v_mov_b32 v56, v52
s_nop 1
v_permlane32_swap_b32 v52, v56
s_waitcnt lgkmcnt(2)
v_mfma_f32_32x32x16_bf16 v[20:35], v[48:51], a[76:79], v[20:35]
ds_read_b128 v[44:47], v1 offset:24576
s_waitcnt lgkmcnt(1)
ds_read_b128 v[48:51], v1 offset:25600
v_mfma_f32_32x32x16_bf16 v[20:35], v[36:39], a[80:83], v[20:35]
ds_read_b128 v[36:39], v1 offset:26624
v_mul_f32 v52, 0x3acccccd, v52
v_lshrrev_b32 v53, 2, v0
v_mul_f32 v56, 0x3acccccd, v56
s_add_u32 m0, s25, 11264
s_add_u32 s20, s20, s38
buffer_load_dwordx4 v8, s[4:7], s20 offen sc1 lds
v_mfma_f32_32x32x16_bf16 v[20:35], v[40:43], a[84:87], v[20:35]
s_waitcnt lgkmcnt(2)
ds_read_b128 v[40:43], v1 offset:27648
v_fma_f32 v56, -v52, v52, v56
v_max_f32 v56, 0, v56
s_waitcnt lgkmcnt(2)
v_lshl_add_u32 v53, s13, 8, v53
v_add_f32 v56, 0x3727c5ac, v56
v_mfma_f32_32x32x16_bf16 v[20:35], v[44:47], a[88:91], v[20:35]
ds_read_b128 v[44:47], v1 offset:28672
s_add_u32 m0, s35, s37
s_add_u32 s20, s36, s37
buffer_load_dwordx4 v0, s[4:7], s20 offen sc1 lds
v_mfma_f32_32x32x16_bf16 v[20:35], v[48:51], a[92:95], v[20:35]
s_waitcnt lgkmcnt(2)
v_rsq_f32 v56, v56
ds_read_b128 v[48:51], v1 offset:29696
v_mul_f32 v52, v56, v52
v_mfma_f32_32x32x16_bf16 v[20:35], v[36:39], a[96:99], v[20:35]
ds_read_b128 v[36:39], v1 offset:30720
s_waitcnt lgkmcnt(3)
s_add_u32 m0, s35, 4096
s_add_u32 s20, s36, 4096
buffer_load_dwordx4 v0, s[4:7], s20 offen sc1 lds
v_mfma_f32_32x32x16_bf16 v[20:35], v[40:43], a[100:103], v[20:35]
ds_read_b128 v[40:43], v1 offset:31744
s_waitcnt lgkmcnt(3)
v_permlane32_swap_b32 v56, v52
v_lshl_add_u32 v54, s13, 8, v54
v_mfma_f32_32x32x16_bf16 v[20:35], v[44:47], a[104:107], v[20:35]
s_waitcnt lgkmcnt(1)
ds_read_b128 v[44:47], v1 offset:32768
ds_write_b32 v53, v56 offset:1024
ds_read_b128 v[80:83], v54 offset:1184
ds_read_b128 v[76:79], v54 offset:1152
v_mfma_f32_32x32x16_bf16 v[20:35], v[48:51], a[108:111], v[20:35]
v_mfma_f32_32x32x16_bf16 v[20:35], v[36:39], a[112:115], v[20:35]
s_waitcnt lgkmcnt(4)
ds_read_b128 v[48:51], v1 offset:33792
ds_read_b128 v[88:91], v54 offset:1248
ds_read_b128 v[36:39], v1 offset:34816
s_waitcnt lgkmcnt(6)
ds_read_b128 v[84:87], v54 offset:1216
v_mfma_f32_32x32x16_bf16 v[20:35], v[40:43], a[116:119], v[20:35]
s_waitcnt vmcnt(12)
s_barrier
s_mov_b64 exec, 1
buffer_store_dword v3, off, s[4:7], s22 sc1
s_mov_b64 exec, -1
v_mfma_f32_32x32x16_bf16 v[20:35], v[44:47], a[120:123], v[20:35]
ds_read_b128 v[40:43], v1 offset:35840
s_waitcnt lgkmcnt(4)
ds_read_b128 v[44:47], v1 offset:36864
v_mfma_f32_32x32x16_bf16 v[20:35], v[48:51], a[124:127], v[20:35]
ds_read_b128 v[48:51], v1 offset:37888
ds_read_b128 v[72:75], v54 offset:1120
s_waitcnt lgkmcnt(4)
v_mul_f32 v79, v79, v5
v_mul_f32 v86, v86, v5
v_mfma_f32_32x32x16_bf16 v[20:35], v[36:39], a[128:131], v[20:35]
s_waitcnt lgkmcnt(3)
v_mfma_f32_32x32x16_bf16 v[20:35], v[40:43], a[132:135], v[20:35]
v_mul_f32 v89, v89, v5
v_mul_f32 v90, v90, v5
s_waitcnt lgkmcnt(2)
s_waitcnt lgkmcnt(1)
ds_read_b128 v[36:39], v1 offset:38912
ds_read_b128 v[60:63], v54 offset:1024
v_mfma_f32_32x32x16_bf16 v[20:35], v[44:47], a[136:139], v[20:35]
ds_read_b128 v[40:43], v1 offset:39936
ds_read_b128 v[44:47], v1 offset:40960
ds_read_b128 v[64:67], v54 offset:1056
v_mul_f32 v87, v87, v5
v_mfma_f32_32x32x16_bf16 v[20:35], v[48:51], a[140:143], v[20:35]
ds_read_b128 v[48:51], v1 offset:41984
ds_read_b128 v[68:71], v54 offset:1088
s_waitcnt lgkmcnt(6)
v_mfma_f32_32x32x16_bf16 v[20:35], v[36:39], a[144:147], v[20:35]
s_waitcnt lgkmcnt(4)
v_mul_f32 v78, v78, v5
v_mfma_f32_32x32x16_bf16 v[20:35], v[40:43], a[148:151], v[20:35]
v_mul_f32 v76, v76, v5
v_mul_f32 v85, v85, v5
v_mul_f32 v91, v91, v5
v_mul_f32 v77, v77, v5
s_waitcnt lgkmcnt(3)
v_mul_f32 v84, v84, v5
v_mfma_f32_32x32x16_bf16 v[20:35], v[44:47], a[152:155], v[20:35]
s_waitcnt lgkmcnt(1)
v_mul_f32 v88, v88, v5
v_mul_f32 v80, v80, v5
v_mfma_f32_32x32x16_bf16 v[20:35], v[48:51], a[156:159], v[20:35]
s_waitcnt lgkmcnt(0)
v_mul_f32 v83, v83, v5
v_mul_f32 v82, v82, v5
v_mul_f32 v81, v81, v5
s_nop 7
v_pk_fma_f32 v[26:27], v[26:27], v[66:67], v[82:83] neg_lo:[0,0,1] neg_hi:[0,0,1]
v_pk_fma_f32 v[24:25], v[24:25], v[64:65], v[80:81] neg_lo:[0,0,1] neg_hi:[0,0,1]
v_pk_fma_f32 v[34:35], v[34:35], v[74:75], v[90:91] neg_lo:[0,0,1] neg_hi:[0,0,1]
v_pk_fma_f32 v[22:23], v[22:23], v[62:63], v[78:79] neg_lo:[0,0,1] neg_hi:[0,0,1]
v_cvt_pk_bf16_f32 v37, v22, v23
v_pk_fma_f32 v[30:31], v[30:31], v[70:71], v[86:87] neg_lo:[0,0,1] neg_hi:[0,0,1]
v_cvt_pk_bf16_f32 v39, v26, v27
v_pk_fma_f32 v[32:33], v[32:33], v[72:73], v[88:89] neg_lo:[0,0,1] neg_hi:[0,0,1]
v_pk_fma_f32 v[20:21], v[20:21], v[60:61], v[76:77] neg_lo:[0,0,1] neg_hi:[0,0,1]
v_pk_fma_f32 v[28:29], v[28:29], v[68:69], v[84:85] neg_lo:[0,0,1] neg_hi:[0,0,1]
v_cvt_pk_bf16_f32 v38, v24, v25
v_cvt_pk_bf16_f32 v42, v32, v33
v_cvt_pk_bf16_f32 v40, v28, v29
v_cvt_pk_bf16_f32 v41, v30, v31
v_cvt_pk_bf16_f32 v43, v34, v35
v_cvt_pk_bf16_f32 v36, v20, v21
buffer_store_dwordx4 v[36:39], v6, s[4:7], s27 offen offset:0 sc1
buffer_store_dwordx4 v[40:43], v6, s[4:7], s27 offen offset:512 sc1
s_lshl_b32 s18, s16, 6
s_add_u32 s18, s18, s28
s_add_u32 s27, s27, 524288
s_cmp_eq_u32 s13, 0
s_cselect_b32 s22, s51, s6
s_mov_b32 s23, s18
s_cmp_lg_u32 s33, 0
s_cbranch_scc1 kvx_30
kvm_35:
v_xor_b32 v1, 40960, v1
s_sub_u32 s25, s25, s31
s_xor_b32 s25, s25, 40960
s_add_u32 s25, s25, s31
s_xor_b32 s35, s35, 8192
s_cmp_lt_u32 s30, 64
s_cselect_b32 s53, s26, s6
s_cselect_b32 s36, s54, s6
s_mov_b32 s38, 1024
v_mov_b32 v8, v0
s_add_u32 s26, s26, 40960
s_add_u32 s54, s54, 5120
s_add_u32 s30, s30, 1
s_waitcnt vmcnt(3)
s_barrier
ds_read_b128 v[36:39], v1 offset:2048
s_add_u32 m0, s25, 2048
s_mov_b32 s20, s53
buffer_load_dwordx4 v8, s[4:7], s20 offen sc1 lds
ds_read_b128 v[40:43], v1 offset:3072
ds_read_b128 v[44:47], v1 offset:4096
s_add_u32 m0, s25, 3072
s_add_u32 s20, s20, s38
buffer_load_dwordx4 v8, s[4:7], s20 offen sc1 lds
s_waitcnt lgkmcnt(2)
v_mfma_f32_32x32x16_bf16 v[20:35], v[36:39], a[0:3], 0
ds_read_b128 v[48:51], v1 offset:5120
s_waitcnt lgkmcnt(2)
s_add_u32 m0, s25, 4096
s_add_u32 s20, s20, s38
buffer_load_dwordx4 v8, s[4:7], s20 offen sc1 lds
s_waitcnt lgkmcnt(1)
v_mfma_f32_32x32x16_bf16 v[20:35], v[40:43], a[4:7], v[20:35]
s_add_u32 m0, s25, 5120
s_add_u32 s20, s20, s38
buffer_load_dwordx4 v8, s[4:7], s20 offen sc1 lds
ds_read_b128 v[36:39], v1 offset:6144
ds_read_b128 v[40:43], v1 offset:7168
v_mfma_f32_32x32x16_bf16 v[20:35], v[44:47], a[8:11], v[20:35]
ds_read_b128 v[44:47], v1 offset:8192
s_waitcnt lgkmcnt(3)
v_mfma_f32_32x32x16_bf16 v[20:35], v[48:51], a[12:15], v[20:35]
s_waitcnt lgkmcnt(2)
v_mfma_f32_32x32x16_bf16 v[20:35], v[36:39], a[16:19], v[20:35]
ds_read_b128 v[48:51], v1 offset:9216
ds_read_b128 v[36:39], v1 offset:10240
s_waitcnt lgkmcnt(2)
v_mfma_f32_32x32x16_bf16 v[20:35], v[40:43], a[20:23], v[20:35]
v_mfma_f32_32x32x16_bf16 v[20:35], v[44:47], a[24:27], v[20:35]
ds_read_b128 v[44:47], v1 offset:12288
s_waitcnt lgkmcnt(2)
ds_read_b128 v[40:43], v1 offset:11264
v_mfma_f32_32x32x16_bf16 v[20:35], v[48:51], a[28:31], v[20:35]
s_waitcnt lgkmcnt(2)
s_add_u32 m0, s25, 6144
s_add_u32 s20, s20, s38
buffer_load_dwordx4 v8, s[4:7], s20 offen sc1 lds
ds_read_b128 v[48:51], v1 offset:13312
v_mfma_f32_32x32x16_bf16 v[20:35], v[36:39], a[32:35], v[20:35]
s_waitcnt lgkmcnt(2)
s_add_u32 m0, s25, 7168
s_add_u32 s20, s20, s38
buffer_load_dwordx4 v8, s[4:7], s20 offen sc1 lds
s_waitcnt lgkmcnt(1)
v_mfma_f32_32x32x16_bf16 v[20:35], v[40:43], a[36:39], v[20:35]
ds_read_b128 v[36:39], v1 offset:14336
s_add_u32 m0, s25, 8192
s_add_u32 s20, s20, s38
buffer_load_dwordx4 v8, s[4:7], s20 offen sc1 lds
s_waitcnt lgkmcnt(1)
ds_read_b128 v[40:43], v1 offset:15360
v_mfma_f32_32x32x16_bf16 v[20:35], v[44:47], a[40:43], v[20:35]
ds_read_b128 v[44:47], v1 offset:16384
v_mfma_f32_32x32x16_bf16 v[20:35], v[48:51], a[44:47], v[20:35]
s_waitcnt lgkmcnt(2)
ds_read_b128 v[48:51], v1 offset:17408
v_mfma_f32_32x32x16_bf16 v[20:35], v[36:39], a[48:51], v[20:35]
ds_read_b128 v[36:39], v1 offset:18432
s_waitcnt lgkmcnt(2)
v_mfma_f32_32x32x16_bf16 v[20:35], v[40:43], a[52:55], v[20:35]
ds_read_b128 v[40:43], v1 offset:19456
s_add_u32 m0, s25, 9216
s_add_u32 s20, s20, s38
buffer_load_dwordx4 v8, s[4:7], s20 offen sc1 lds
s_waitcnt lgkmcnt(2)
v_mfma_f32_32x32x16_bf16 v[20:35], v[44:47], a[56:59], v[20:35]
v_mfma_f32_32x32x16_bf16 v[20:35], v[48:51], a[60:63], v[20:35]
ds_read_b128 v[48:51], v1 offset:21504
ds_read_b128 v[44:47], v1 offset:20480
s_waitcnt lgkmcnt(3)
v_mov_b32 v3, s23
v_mfma_f32_32x32x16_bf16 v[20:35], v[36:39], a[64:67], v[20:35]
s_waitcnt lgkmcnt(2)
s_add_u32 m0, s25, 10240
s_add_u32 s20, s20, s38
buffer_load_dwordx4 v8, s[4:7], s20 offen sc1 lds
ds_read_b128 v[36:39], v1 offset:22528
v_mfma_f32_32x32x16_bf16 v[20:35], v[40:43], a[68:71], v[20:35]
ds_read_b128 v[40:43], v1 offset:23552
s_waitcnt lgkmcnt(2)
v_mfma_f32_32x32x16_bf16 v[20:35], v[44:47], a[72:75], v[20:35]
v_mfma_f32_32x32x16_bf16 v[20:35], v[48:51], a[76:79], v[20:35]
s_waitcnt lgkmcnt(0)
ds_read_b128 v[44:47], v1 offset:24576
v_mfma_f32_32x32x16_bf16 v[20:35], v[36:39], a[80:83], v[20:35]
ds_read_b128 v[48:51], v1 offset:25600
s_add_u32 m0, s25, 11264
s_add_u32 s20, s20, s38
buffer_load_dwordx4 v8, s[4:7], s20 offen sc1 lds
v_mfma_f32_32x32x16_bf16 v[20:35], v[40:43], a[84:87], v[20:35]
ds_read_b128 v[36:39], v1 offset:26624
s_waitcnt lgkmcnt(2)
ds_read_b128 v[40:43], v1 offset:27648
v_mfma_f32_32x32x16_bf16 v[20:35], v[44:47], a[88:91], v[20:35]
s_waitcnt lgkmcnt(2)
ds_read_b128 v[44:47], v1 offset:28672
s_add_u32 m0, s35, s37
s_add_u32 s20, s36, s37
buffer_load_dwordx4 v0, s[4:7], s20 offen sc1 lds
v_mfma_f32_32x32x16_bf16 v[20:35], v[48:51], a[92:95], v[20:35]
ds_read_b128 v[48:51], v1 offset:29696
s_waitcnt lgkmcnt(3)
v_mfma_f32_32x32x16_bf16 v[20:35], v[36:39], a[96:99], v[20:35]
s_waitcnt lgkmcnt(1)
ds_read_b128 v[36:39], v1 offset:30720
s_add_u32 m0, s35, 4096
s_add_u32 s20, s36, 4096
buffer_load_dwordx4 v0, s[4:7], s20 offen sc1 lds
v_mfma_f32_32x32x16_bf16 v[20:35], v[40:43], a[100:103], v[20:35]
ds_read_b128 v[40:43], v1 offset:31744
v_mfma_f32_32x32x16_bf16 v[20:35], v[44:47], a[104:107], v[20:35]
s_waitcnt lgkmcnt(2)
s_waitcnt lgkmcnt(1)
v_mfma_f32_32x32x16_bf16 v[20:35], v[48:51], a[108:111], v[20:35]
ds_read_b128 v[44:47], v1 offset:32768
ds_read_b128 v[48:51], v1 offset:33792
v_mfma_f32_32x32x16_bf16 v[20:35], v[36:39], a[112:115], v[20:35]
ds_read_b128 v[36:39], v1 offset:34816
s_waitcnt lgkmcnt(3)
v_mfma_f32_32x32x16_bf16 v[20:35], v[40:43], a[116:119], v[20:35]
s_waitcnt vmcnt(12)
s_barrier
ds_read_b128 v[40:43], v1 offset:35840
s_waitcnt lgkmcnt(3)
v_mfma_f32_32x32x16_bf16 v[20:35], v[44:47], a[120:123], v[20:35]
s_mov_b64 exec, 1
buffer_store_dword v3, off, s[4:7], s22 sc1
s_mov_b64 exec, -1
s_waitcnt lgkmcnt(1)
v_mfma_f32_32x32x16_bf16 v[20:35], v[48:51], a[124:127], v[20:35]
ds_read_b128 v[44:47], v1 offset:36864
s_waitcnt lgkmcnt(1)
ds_read_b128 v[48:51], v1 offset:37888
v_mfma_f32_32x32x16_bf16 v[20:35], v[36:39], a[128:131], v[20:35]
v_mfma_f32_32x32x16_bf16 v[20:35], v[40:43], a[132:135], v[20:35]
s_waitcnt lgkmcnt(1)
ds_read_b128 v[40:43], v1 offset:39936
ds_read_b128 v[36:39], v1 offset:38912
v_mfma_f32_32x32x16_bf16 v[20:35], v[44:47], a[136:139], v[20:35]
s_waitcnt lgkmcnt(2)
v_mfma_f32_32x32x16_bf16 v[20:35], v[48:51], a[140:143], v[20:35]
ds_read_b128 v[44:47], v1 offset:40960
ds_read_b128 v[48:51], v1 offset:41984
s_waitcnt lgkmcnt(2)
v_mfma_f32_32x32x16_bf16 v[20:35], v[36:39], a[144:147], v[20:35]
v_mfma_f32_32x32x16_bf16 v[20:35], v[40:43], a[148:151], v[20:35]
s_waitcnt lgkmcnt(1)
v_mfma_f32_32x32x16_bf16 v[20:35], v[44:47], a[152:155], v[20:35]
s_waitcnt lgkmcnt(0)
v_mfma_f32_32x32x16_bf16 v[20:35], v[48:51], a[156:159], v[20:35]
s_nop 11
v_cvt_pk_bf16_f32 v37, v22, v23
v_cvt_pk_bf16_f32 v36, v20, v21
v_cvt_pk_bf16_f32 v41, v30, v31
v_cvt_pk_bf16_f32 v39, v26, v27
v_cvt_pk_bf16_f32 v42, v32, v33
v_cvt_pk_bf16_f32 v38, v24, v25
v_cvt_pk_bf16_f32 v40, v28, v29
v_cvt_pk_bf16_f32 v43, v34, v35
buffer_store_dwordx4 v[36:39], v6, s[4:7], s50 offen offset:0 sc1
buffer_store_dwordx4 v[40:43], v6, s[4:7], s50 offen offset:512 sc1
s_add_u32 s39, s39, 1
s_add_u32 s50, s50, 524288
s_add_u32 s18, s51, 8192
s_cmp_eq_u32 s13, 0
s_cselect_b32 s22, s18, s6
s_mov_b32 s23, s39
s_cmp_lt_u32 s28, 64
s_cbranch_scc1 kvx_30
s_and_b32 s18, s39, 15
s_cbranch_scc0 kvt_36
s_waitcnt vmcnt(0)
s_barrier
v_mov_b32 v3, s23
s_mov_b64 exec, 1
buffer_store_dword v3, off, s[4:7], s22 sc1
s_mov_b64 exec, -1
s_mov_b32 s22, s6
s_lshl_b32 s18, s39, 2
s_add_u32 s18, s18, 4
s_cmp_lg_u32 s13, 0
s_cbranch_scc1 polld_42
v_lshlrev_b32 v3, 3, v0
v_min_u32 v16, 1152, v3
s_mov_b32 s21, 11550720
s_mov_b32 s17, 0
poll_41:
buffer_load_dword v12, v16, s[4:7], s21 offen sc1
s_add_u32 s17, s17, 1
s_cmp_gt_u32 s17, 262144
s_cbranch_scc1 L_fail
s_waitcnt vmcnt(0)
v_cmp_gt_u32 vcc, s18, v12
s_cbranch_vccz polld_42
s_sleep 2
s_branch poll_41
polld_42:
s_barrier
s_mov_b32 s53, s52
s_mov_b32 s36, s6
s_mov_b32 s38, 256
v_mov_b32 v8, v7
s_add_u32 s52, s52, 40960
s_add_u32 m0, s25, 2048
s_mov_b32 s20, s53
buffer_load_dwordx4 v8, s[4:7], s20 offen sc1 lds
s_add_u32 m0, s25, 3072
s_add_u32 s20, s20, s38
buffer_load_dwordx4 v8, s[4:7], s20 offen sc1 lds
s_add_u32 m0, s25, 4096
s_add_u32 s20, s20, s38
buffer_load_dwordx4 v8, s[4:7], s20 offen sc1 lds
s_add_u32 m0, s25, 5120
s_add_u32 s20, s20, s38
buffer_load_dwordx4 v8, s[4:7], s20 offen sc1 lds
s_add_u32 m0, s25, 6144
s_add_u32 s20, s20, s38
buffer_load_dwordx4 v8, s[4:7], s20 offen sc1 lds
s_add_u32 m0, s25, 7168
s_add_u32 s20, s20, s38
buffer_load_dwordx4 v8, s[4:7], s20 offen sc1 lds
s_add_u32 m0, s25, 8192
s_add_u32 s20, s20, s38
buffer_load_dwordx4 v8, s[4:7], s20 offen sc1 lds
s_add_u32 m0, s25, 9216
s_add_u32 s20, s20, s38
buffer_load_dwordx4 v8, s[4:7], s20 offen sc1 lds
s_add_u32 m0, s25, 10240
s_add_u32 s20, s20, s38
buffer_load_dwordx4 v8, s[4:7], s20 offen sc1 lds
s_add_u32 m0, s25, 11264
s_add_u32 s20, s20, s38
buffer_load_dwordx4 v8, s[4:7], s20 offen sc1 lds
s_waitcnt vmcnt(0)
s_branch kvm_35
kv_34:
s_lshl_b32 s18, s39, 2
s_add_u32 s18, s18, 4
s_cmp_lg_u32 s13, 0
s_cbranch_scc1 polld_44
v_lshlrev_b32 v3, 3, v0
v_min_u32 v16, 1152, v3
s_mov_b32 s21, 11550720
s_mov_b32 s17, 0
poll_43:
buffer_load_dword v12, v16, s[4:7], s21 offen sc1
s_add_u32 s17, s17, 1
s_cmp_gt_u32 s17, 262144
s_cbranch_scc1 L_fail
s_waitcnt vmcnt(0)
v_cmp_gt_u32 vcc, s18, v12
s_cbranch_vccz polld_44
s_sleep 2
s_branch poll_43
polld_44:
s_barrier
s_mov_b32 s53, s52
s_mov_b32 s36, s6
s_mov_b32 s38, 256
v_mov_b32 v8, v7
s_add_u32 s52, s52, 40960
s_branch kvn_31
kvt_36:
s_waitcnt vmcnt(0)
s_barrier
v_mov_b32 v3, s23
s_mov_b64 exec, 1
buffer_store_dword v3, off, s[4:7], s22 sc1
s_mov_b64 exec, -1
s_mov_b32 s22, s6
s_cmp_lg_u32 s16, 0
s_cbranch_scc1 kvz_45
s_cmp_ge_u32 s32, 20
s_cbranch_scc1 kvz_45
s_mov_b32 s55, s34
s_mul_i32 s30, s32, 13108
s_lshr_b32 s30, s30, 16
s_mul_i32 s18, s30, 5
s_sub_u32 s34, s32, s18
s_add_u32 s30, s30, 60
s_add_u32 s54, s32, 15
s_lshl_b32 s18, s34, 2
s_add_u32 s18, s18, s13
s_lshl_b32 s33, s18, 11
v_lshrrev_b32 v12, 9, v0
v_and_b32 v10, 0x1ff, v0
v_lshlrev_b32 v10, 1, v10
v_lshl_add_u32 v10, v12, 4, v10
s_lshl_b32 s18, s34, 7
s_lshl_b32 s19, s13, 5
s_add_u32 s18, s18, s19
s_mov_b32 s19, 0x3acccccd
v_bfe_u32 v202, v0, 4, 5
v_lshrrev_b32 v197, 9, v0
v_add_u32 v202, s18, v202
v_and_b32 v201, 1, v202
v_mul_u32_u24 v201, 160, v201
v_lshrrev_b32 v200, 1, v202
v_add_u32 v200, 1, v200
v_lshlrev_b32 v197, 3, v197
v_mad_u32_u24 v201, v197, v200, v201
v_mad_u32_u24 v196, v200, 16, 0
v_cvt_f32_u32 v196, v196
v_mul_f32 v202, s19, v196
v_rndne_f32 v202, v202
v_fmac_f32 v196, 0xc4200000, v202
v_mul_f32 v196, s19, v196
v_cos_f32 v196, v196
s_nop 0
v_add_f32 v196, v196, v196
v_mad_u32_u24 v198, v200, 1, 0
v_cvt_f32_u32 v198, v198
v_mul_f32 v202, s19, v198
v_rndne_f32 v202, v202
v_fmac_f32 v198, 0xc4200000, v202
v_mul_f32 v198, s19, v198
v_cos_f32 v198, v198
s_nop 0
v_add_f32 v198, v198, v198
v_mad_u32_u24 v183, v200, 3, v201
v_cvt_f32_u32 v183, v183
v_mul_f32 v202, s19, v183
v_rndne_f32 v202, v202
v_fmac_f32 v183, 0xc4200000, v202
v_mul_f32 v183, s19, v183
v_cos_f32 v183, v183
v_mad_u32_u24 v184, v200, 4, v201
v_cvt_f32_u32 v184, v184
v_mul_f32 v202, s19, v184
v_rndne_f32 v202, v202
v_fmac_f32 v184, 0xc4200000, v202
v_mul_f32 v184, s19, v184
v_cos_f32 v184, v184
s_nop 0
v_fma_f32 v185, v198, v184, -v183
v_fma_f32 v182, v198, v183, -v184
v_fma_f32 v186, v198, v185, -v184
v_fma_f32 v181, v198, v182, -v183
v_fma_f32 v187, v198, v186, -v185
v_fma_f32 v180, v198, v181, -v182
v_cvt_pk_bf16_f32 v20, v180, v181
v_cvt_pk_bf16_f32 v21, v182, v183
v_cvt_pk_bf16_f32 v22, v184, v185
v_cvt_pk_bf16_f32 v23, v186, v187
v_mad_u32_u24 v191, v200, 19, v201
v_cvt_f32_u32 v191, v191
v_mul_f32 v202, s19, v191
v_rndne_f32 v202, v202
v_fmac_f32 v191, 0xc4200000, v202
v_mul_f32 v191, s19, v191
v_cos_f32 v191, v191
v_mad_u32_u24 v192, v200, 20, v201
v_cvt_f32_u32 v192, v192
v_mul_f32 v202, s19, v192
v_rndne_f32 v202, v202
v_fmac_f32 v192, 0xc4200000, v202
v_mul_f32 v192, s19, v192
v_cos_f32 v192, v192
s_nop 0
v_fma_f32 v193, v198, v192, -v191
v_fma_f32 v190, v198, v191, -v192
v_fma_f32 v194, v198, v193, -v192
v_fma_f32 v189, v198, v190, -v191
v_fma_f32 v195, v198, v194, -v193
v_fma_f32 v188, v198, v189, -v190
v_cvt_pk_bf16_f32 v24, v188, v189
v_cvt_pk_bf16_f32 v25, v190, v191
v_cvt_pk_bf16_f32 v26, v192, v193
v_cvt_pk_bf16_f32 v27, v194, v195
v_pk_fma_f32 v[180:181], v[196:197], v[188:189], v[180:181] op_sel_hi:[0,1,1] neg_lo:[0,0,1] neg_hi:[0,0,1]
v_pk_fma_f32 v[182:183], v[196:197], v[190:191], v[182:183] op_sel_hi:[0,1,1] neg_lo:[0,0,1] neg_hi:[0,0,1]
v_pk_fma_f32 v[184:185], v[196:197], v[192:193], v[184:185] op_sel_hi:[0,1,1] neg_lo:[0,0,1] neg_hi:[0,0,1]
v_pk_fma_f32 v[186:187], v[196:197], v[194:195], v[186:187] op_sel_hi:[0,1,1] neg_lo:[0,0,1] neg_hi:[0,0,1]
v_cvt_pk_bf16_f32 v28, v180, v181
v_cvt_pk_bf16_f32 v29, v182, v183
v_cvt_pk_bf16_f32 v30, v184, v185
v_cvt_pk_bf16_f32 v31, v186, v187
v_pk_fma_f32 v[188:189], v[196:197], v[180:181], v[188:189] op_sel_hi:[0,1,1] neg_lo:[0,0,1] neg_hi:[0,0,1]
v_pk_fma_f32 v[190:191], v[196:197], v[182:183], v[190:191] op_sel_hi:[0,1,1] neg_lo:[0,0,1] neg_hi:[0,0,1]
v_pk_fma_f32 v[192:193], v[196:197], v[184:185], v[192:193] op_sel_hi:[0,1,1] neg_lo:[0,0,1] neg_hi:[0,0,1]
v_pk_fma_f32 v[194:195], v[196:197], v[186:187], v[194:195] op_sel_hi:[0,1,1] neg_lo:[0,0,1] neg_hi:[0,0,1]
v_cvt_pk_bf16_f32 v32, v188, v189
v_cvt_pk_bf16_f32 v33, v190, v191
v_cvt_pk_bf16_f32 v34, v192, v193
v_cvt_pk_bf16_f32 v35, v194, v195
v_pk_fma_f32 v[180:181], v[196:197], v[188:189], v[180:181] op_sel_hi:[0,1,1] neg_lo:[0,0,1] neg_hi:[0,0,1]
v_pk_fma_f32 v[182:183], v[196:197], v[190:191], v[182:183] op_sel_hi:[0,1,1] neg_lo:[0,0,1] neg_hi:[0,0,1]
v_pk_fma_f32 v[184:185], v[196:197], v[192:193], v[184:185] op_sel_hi:[0,1,1] neg_lo:[0,0,1] neg_hi:[0,0,1]
v_pk_fma_f32 v[186:187], v[196:197], v[194:195], v[186:187] op_sel_hi:[0,1,1] neg_lo:[0,0,1] neg_hi:[0,0,1]
v_cvt_pk_bf16_f32 v36, v180, v181
v_cvt_pk_bf16_f32 v37, v182, v183
v_cvt_pk_bf16_f32 v38, v184, v185
v_cvt_pk_bf16_f32 v39, v186, v187
v_pk_fma_f32 v[188:189], v[196:197], v[180:181], v[188:189] op_sel_hi:[0,1,1] neg_lo:[0,0,1] neg_hi:[0,0,1]
v_pk_fma_f32 v[190:191], v[196:197], v[182:183], v[190:191] op_sel_hi:[0,1,1] neg_lo:[0,0,1] neg_hi:[0,0,1]
v_pk_fma_f32 v[192:193], v[196:197], v[184:185], v[192:193] op_sel_hi:[0,1,1] neg_lo:[0,0,1] neg_hi:[0,0,1]
v_pk_fma_f32 v[194:195], v[196:197], v[186:187], v[194:195] op_sel_hi:[0,1,1] neg_lo:[0,0,1] neg_hi:[0,0,1]
v_cvt_pk_bf16_f32 v40, v188, v189
v_cvt_pk_bf16_f32 v41, v190, v191
v_cvt_pk_bf16_f32 v42, v192, v193
v_cvt_pk_bf16_f32 v43, v194, v195
v_pk_fma_f32 v[180:181], v[196:197], v[188:189], v[180:181] op_sel_hi:[0,1,1] neg_lo:[0,0,1] neg_hi:[0,0,1]
v_pk_fma_f32 v[182:183], v[196:197], v[190:191], v[182:183] op_sel_hi:[0,1,1] neg_lo:[0,0,1] neg_hi:[0,0,1]
v_pk_fma_f32 v[184:185], v[196:197], v[192:193], v[184:185] op_sel_hi:[0,1,1] neg_lo:[0,0,1] neg_hi:[0,0,1]
v_pk_fma_f32 v[186:187], v[196:197], v[194:195], v[186:187] op_sel_hi:[0,1,1] neg_lo:[0,0,1] neg_hi:[0,0,1]
v_cvt_pk_bf16_f32 v44, v180, v181
v_cvt_pk_bf16_f32 v45, v182, v183
v_cvt_pk_bf16_f32 v46, v184, v185
v_cvt_pk_bf16_f32 v47, v186, v187
v_pk_fma_f32 v[188:189], v[196:197], v[180:181], v[188:189] op_sel_hi:[0,1,1] neg_lo:[0,0,1] neg_hi:[0,0,1]
v_pk_fma_f32 v[190:191], v[196:197], v[182:183], v[190:191] op_sel_hi:[0,1,1] neg_lo:[0,0,1] neg_hi:[0,0,1]
v_pk_fma_f32 v[192:193], v[196:197], v[184:185], v[192:193] op_sel_hi:[0,1,1] neg_lo:[0,0,1] neg_hi:[0,0,1]
v_pk_fma_f32 v[194:195], v[196:197], v[186:187], v[194:195] op_sel_hi:[0,1,1] neg_lo:[0,0,1] neg_hi:[0,0,1]
v_cvt_pk_bf16_f32 v48, v188, v189
v_cvt_pk_bf16_f32 v49, v190, v191
v_cvt_pk_bf16_f32 v50, v192, v193
v_cvt_pk_bf16_f32 v51, v194, v195
v_pk_fma_f32 v[180:181], v[196:197], v[188:189], v[180:181] op_sel_hi:[0,1,1] neg_lo:[0,0,1] neg_hi:[0,0,1]
v_pk_fma_f32 v[182:183], v[196:197], v[190:191], v[182:183] op_sel_hi:[0,1,1] neg_lo:[0,0,1] neg_hi:[0,0,1]
v_pk_fma_f32 v[184:185], v[196:197], v[192:193], v[184:185] op_sel_hi:[0,1,1] neg_lo:[0,0,1] neg_hi:[0,0,1]
v_pk_fma_f32 v[186:187], v[196:197], v[194:195], v[186:187] op_sel_hi:[0,1,1] neg_lo:[0,0,1] neg_hi:[0,0,1]
v_cvt_pk_bf16_f32 v52, v180, v181
v_cvt_pk_bf16_f32 v53, v182, v183
v_cvt_pk_bf16_f32 v54, v184, v185
v_cvt_pk_bf16_f32 v55, v186, v187
v_pk_fma_f32 v[188:189], v[196:197], v[180:181], v[188:189] op_sel_hi:[0,1,1] neg_lo:[0,0,1] neg_hi:[0,0,1]
v_pk_fma_f32 v[190:191], v[196:197], v[182:183], v[190:191] op_sel_hi:[0,1,1] neg_lo:[0,0,1] neg_hi:[0,0,1]
v_pk_fma_f32 v[192:193], v[196:197], v[184:185], v[192:193] op_sel_hi:[0,1,1] neg_lo:[0,0,1] neg_hi:[0,0,1]
v_pk_fma_f32 v[194:195], v[196:197], v[186:187], v[194:195] op_sel_hi:[0,1,1] neg_lo:[0,0,1] neg_hi:[0,0,1]
v_cvt_pk_bf16_f32 v56, v188, v189
v_cvt_pk_bf16_f32 v57, v190, v191
v_cvt_pk_bf16_f32 v58, v192, v193
v_cvt_pk_bf16_f32 v59, v194, v195
v_pk_fma_f32 v[180:181], v[196:197], v[188:189], v[180:181] op_sel_hi:[0,1,1] neg_lo:[0,0,1] neg_hi:[0,0,1]
v_pk_fma_f32 v[182:183], v[196:197], v[190:191], v[182:183] op_sel_hi:[0,1,1] neg_lo:[0,0,1] neg_hi:[0,0,1]
v_pk_fma_f32 v[184:185], v[196:197], v[192:193], v[184:185] op_sel_hi:[0,1,1] neg_lo:[0,0,1] neg_hi:[0,0,1]
v_pk_fma_f32 v[186:187], v[196:197], v[194:195], v[186:187] op_sel_hi:[0,1,1] neg_lo:[0,0,1] neg_hi:[0,0,1]
v_cvt_pk_bf16_f32 v60, v180, v181
v_cvt_pk_bf16_f32 v61, v182, v183
v_cvt_pk_bf16_f32 v62, v184, v185
v_cvt_pk_bf16_f32 v63, v186, v187
v_pk_fma_f32 v[188:189], v[196:197], v[180:181], v[188:189] op_sel_hi:[0,1,1] neg_lo:[0,0,1] neg_hi:[0,0,1]
v_pk_fma_f32 v[190:191], v[196:197], v[182:183], v[190:191] op_sel_hi:[0,1,1] neg_lo:[0,0,1] neg_hi:[0,0,1]
v_pk_fma_f32 v[192:193], v[196:197], v[184:185], v[192:193] op_sel_hi:[0,1,1] neg_lo:[0,0,1] neg_hi:[0,0,1]
v_pk_fma_f32 v[194:195], v[196:197], v[186:187], v[194:195] op_sel_hi:[0,1,1] neg_lo:[0,0,1] neg_hi:[0,0,1]
v_cvt_pk_bf16_f32 v64, v188, v189
v_cvt_pk_bf16_f32 v65, v190, v191
v_cvt_pk_bf16_f32 v66, v192, v193
v_cvt_pk_bf16_f32 v67, v194, v195
v_pk_fma_f32 v[180:181], v[196:197], v[188:189], v[180:181] op_sel_hi:[0,1,1] neg_lo:[0,0,1] neg_hi:[0,0,1]
v_pk_fma_f32 v[182:183], v[196:197], v[190:191], v[182:183] op_sel_hi:[0,1,1] neg_lo:[0,0,1] neg_hi:[0,0,1]
v_pk_fma_f32 v[184:185], v[196:197], v[192:193], v[184:185] op_sel_hi:[0,1,1] neg_lo:[0,0,1] neg_hi:[0,0,1]
v_pk_fma_f32 v[186:187], v[196:197], v[194:195], v[186:187] op_sel_hi:[0,1,1] neg_lo:[0,0,1] neg_hi:[0,0,1]
v_cvt_pk_bf16_f32 v68, v180, v181
v_cvt_pk_bf16_f32 v69, v182, v183
v_cvt_pk_bf16_f32 v70, v184, v185
v_cvt_pk_bf16_f32 v71, v186, v187
v_pk_fma_f32 v[188:189], v[196:197], v[180:181], v[188:189] op_sel_hi:[0,1,1] neg_lo:[0,0,1] neg_hi:[0,0,1]
v_pk_fma_f32 v[190:191], v[196:197], v[182:183], v[190:191] op_sel_hi:[0,1,1] neg_lo:[0,0,1] neg_hi:[0,0,1]
v_pk_fma_f32 v[192:193], v[196:197], v[184:185], v[192:193] op_sel_hi:[0,1,1] neg_lo:[0,0,1] neg_hi:[0,0,1]
v_pk_fma_f32 v[194:195], v[196:197], v[186:187], v[194:195] op_sel_hi:[0,1,1] neg_lo:[0,0,1] neg_hi:[0,0,1]
v_cvt_pk_bf16_f32 v72, v188, v189
v_cvt_pk_bf16_f32 v73, v190, v191
v_cvt_pk_bf16_f32 v74, v192, v193
v_cvt_pk_bf16_f32 v75, v194, v195
v_pk_fma_f32 v[180:181], v[196:197], v[188:189], v[180:181] op_sel_hi:[0,1,1] neg_lo:[0,0,1] neg_hi:[0,0,1]
v_pk_fma_f32 v[182:183], v[196:197], v[190:191], v[182:183] op_sel_hi:[0,1,1] neg_lo:[0,0,1] neg_hi:[0,0,1]
v_pk_fma_f32 v[184:185], v[196:197], v[192:193], v[184:185] op_sel_hi:[0,1,1] neg_lo:[0,0,1] neg_hi:[0,0,1]
v_pk_fma_f32 v[186:187], v[196:197], v[194:195], v[186:187] op_sel_hi:[0,1,1] neg_lo:[0,0,1] neg_hi:[0,0,1]
v_cvt_pk_bf16_f32 v76, v180, v181
v_cvt_pk_bf16_f32 v77, v182, v183
v_cvt_pk_bf16_f32 v78, v184, v185
v_cvt_pk_bf16_f32 v79, v186, v187
v_pk_fma_f32 v[188:189], v[196:197], v[180:181], v[188:189] op_sel_hi:[0,1,1] neg_lo:[0,0,1] neg_hi:[0,0,1]
v_pk_fma_f32 v[190:191], v[196:197], v[182:183], v[190:191] op_sel_hi:[0,1,1] neg_lo:[0,0,1] neg_hi:[0,0,1]
v_pk_fma_f32 v[192:193], v[196:197], v[184:185], v[192:193] op_sel_hi:[0,1,1] neg_lo:[0,0,1] neg_hi:[0,0,1]
v_pk_fma_f32 v[194:195], v[196:197], v[186:187], v[194:195] op_sel_hi:[0,1,1] neg_lo:[0,0,1] neg_hi:[0,0,1]
v_cvt_pk_bf16_f32 v80, v188, v189
v_cvt_pk_bf16_f32 v81, v190, v191
v_cvt_pk_bf16_f32 v82, v192, v193
v_cvt_pk_bf16_f32 v83, v194, v195
v_pk_fma_f32 v[180:181], v[196:197], v[188:189], v[180:181] op_sel_hi:[0,1,1] neg_lo:[0,0,1] neg_hi:[0,0,1]
v_pk_fma_f32 v[182:183], v[196:197], v[190:191], v[182:183] op_sel_hi:[0,1,1] neg_lo:[0,0,1] neg_hi:[0,0,1]
v_pk_fma_f32 v[184:185], v[196:197], v[192:193], v[184:185] op_sel_hi:[0,1,1] neg_lo:[0,0,1] neg_hi:[0,0,1]
v_pk_fma_f32 v[186:187], v[196:197], v[194:195], v[186:187] op_sel_hi:[0,1,1] neg_lo:[0,0,1] neg_hi:[0,0,1]
v_cvt_pk_bf16_f32 v84, v180, v181
v_cvt_pk_bf16_f32 v85, v182, v183
v_cvt_pk_bf16_f32 v86, v184, v185
v_cvt_pk_bf16_f32 v87, v186, v187
v_pk_fma_f32 v[188:189], v[196:197], v[180:181], v[188:189] op_sel_hi:[0,1,1] neg_lo:[0,0,1] neg_hi:[0,0,1]
v_pk_fma_f32 v[190:191], v[196:197], v[182:183], v[190:191] op_sel_hi:[0,1,1] neg_lo:[0,0,1] neg_hi:[0,0,1]
v_pk_fma_f32 v[192:193], v[196:197], v[184:185], v[192:193] op_sel_hi:[0,1,1] neg_lo:[0,0,1] neg_hi:[0,0,1]
v_pk_fma_f32 v[194:195], v[196:197], v[186:187], v[194:195] op_sel_hi:[0,1,1] neg_lo:[0,0,1] neg_hi:[0,0,1]
v_cvt_pk_bf16_f32 v88, v188, v189
v_cvt_pk_bf16_f32 v89, v190, v191
v_cvt_pk_bf16_f32 v90, v192, v193
v_cvt_pk_bf16_f32 v91, v194, v195
v_pk_fma_f32 v[180:181], v[196:197], v[188:189], v[180:181] op_sel_hi:[0,1,1] neg_lo:[0,0,1] neg_hi:[0,0,1]
v_pk_fma_f32 v[182:183], v[196:197], v[190:191], v[182:183] op_sel_hi:[0,1,1] neg_lo:[0,0,1] neg_hi:[0,0,1]
v_pk_fma_f32 v[184:185], v[196:197], v[192:193], v[184:185] op_sel_hi:[0,1,1] neg_lo:[0,0,1] neg_hi:[0,0,1]
v_pk_fma_f32 v[186:187], v[196:197], v[194:195], v[186:187] op_sel_hi:[0,1,1] neg_lo:[0,0,1] neg_hi:[0,0,1]
v_cvt_pk_bf16_f32 v92, v180, v181
v_cvt_pk_bf16_f32 v93, v182, v183
v_cvt_pk_bf16_f32 v94, v184, v185
v_cvt_pk_bf16_f32 v95, v186, v187
v_pk_fma_f32 v[188:189], v[196:197], v[180:181], v[188:189] op_sel_hi:[0,1,1] neg_lo:[0,0,1] neg_hi:[0,0,1]
v_pk_fma_f32 v[190:191], v[196:197], v[182:183], v[190:191] op_sel_hi:[0,1,1] neg_lo:[0,0,1] neg_hi:[0,0,1]
v_pk_fma_f32 v[192:193], v[196:197], v[184:185], v[192:193] op_sel_hi:[0,1,1] neg_lo:[0,0,1] neg_hi:[0,0,1]
v_pk_fma_f32 v[194:195], v[196:197], v[186:187], v[194:195] op_sel_hi:[0,1,1] neg_lo:[0,0,1] neg_hi:[0,0,1]
v_cvt_pk_bf16_f32 v96, v188, v189
v_cvt_pk_bf16_f32 v97, v190, v191
v_cvt_pk_bf16_f32 v98, v192, v193
v_cvt_pk_bf16_f32 v99, v194, v195
s_mov_b32 s20, 323
v_mad_u32_u24 v183, v200, s20, v201
v_cvt_f32_u32 v183, v183
v_mul_f32 v202, s19, v183
v_rndne_f32 v202, v202
v_fmac_f32 v183, 0xc4200000, v202
v_mul_f32 v183, s19, v183
v_cos_f32 v183, v183
s_mov_b32 s20, 324
v_mad_u32_u24 v184, v200, s20, v201
v_cvt_f32_u32 v184, v184
v_mul_f32 v202, s19, v184
v_rndne_f32 v202, v202
v_fmac_f32 v184, 0xc4200000, v202
v_mul_f32 v184, s19, v184
v_cos_f32 v184, v184
s_nop 0
v_fma_f32 v185, v198, v184, -v183
v_fma_f32 v182, v198, v183, -v184
v_fma_f32 v186, v198, v185, -v184
v_fma_f32 v181, v198, v182, -v183
v_fma_f32 v187, v198, v186, -v185
v_fma_f32 v180, v198, v181, -v182
v_cvt_pk_bf16_f32 v100, v180, v181
v_cvt_pk_bf16_f32 v101, v182, v183
v_cvt_pk_bf16_f32 v102, v184, v185
v_cvt_pk_bf16_f32 v103, v186, v187
s_mov_b32 s20, 339
v_mad_u32_u24 v191, v200, s20, v201
v_cvt_f32_u32 v191, v191
v_mul_f32 v202, s19, v191
v_rndne_f32 v202, v202
v_fmac_f32 v191, 0xc4200000, v202
v_mul_f32 v191, s19, v191
v_cos_f32 v191, v191
s_mov_b32 s20, 340
v_mad_u32_u24 v192, v200, s20, v201
v_cvt_f32_u32 v192, v192
v_mul_f32 v202, s19, v192
v_rndne_f32 v202, v202
v_fmac_f32 v192, 0xc4200000, v202
v_mul_f32 v192, s19, v192
v_cos_f32 v192, v192
s_nop 0
v_fma_f32 v193, v198, v192, -v191
v_fma_f32 v190, v198, v191, -v192
v_fma_f32 v194, v198, v193, -v192
v_fma_f32 v189, v198, v190, -v191
v_fma_f32 v195, v198, v194, -v193
v_fma_f32 v188, v198, v189, -v190
v_cvt_pk_bf16_f32 v104, v188, v189
v_cvt_pk_bf16_f32 v105, v190, v191
v_cvt_pk_bf16_f32 v106, v192, v193
v_cvt_pk_bf16_f32 v107, v194, v195
v_pk_fma_f32 v[180:181], v[196:197], v[188:189], v[180:181] op_sel_hi:[0,1,1] neg_lo:[0,0,1] neg_hi:[0,0,1]
v_pk_fma_f32 v[182:183], v[196:197], v[190:191], v[182:183] op_sel_hi:[0,1,1] neg_lo:[0,0,1] neg_hi:[0,0,1]
v_pk_fma_f32 v[184:185], v[196:197], v[192:193], v[184:185] op_sel_hi:[0,1,1] neg_lo:[0,0,1] neg_hi:[0,0,1]
v_pk_fma_f32 v[186:187], v[196:197], v[194:195], v[186:187] op_sel_hi:[0,1,1] neg_lo:[0,0,1] neg_hi:[0,0,1]
v_cvt_pk_bf16_f32 v108, v180, v181
v_cvt_pk_bf16_f32 v109, v182, v183
v_cvt_pk_bf16_f32 v110, v184, v185
v_cvt_pk_bf16_f32 v111, v186, v187
v_pk_fma_f32 v[188:189], v[196:197], v[180:181], v[188:189] op_sel_hi:[0,1,1] neg_lo:[0,0,1] neg_hi:[0,0,1]
v_pk_fma_f32 v[190:191], v[196:197], v[182:183], v[190:191] op_sel_hi:[0,1,1] neg_lo:[0,0,1] neg_hi:[0,0,1]
v_pk_fma_f32 v[192:193], v[196:197], v[184:185], v[192:193] op_sel_hi:[0,1,1] neg_lo:[0,0,1] neg_hi:[0,0,1]
v_pk_fma_f32 v[194:195], v[196:197], v[186:187], v[194:195] op_sel_hi:[0,1,1] neg_lo:[0,0,1] neg_hi:[0,0,1]
v_cvt_pk_bf16_f32 v112, v188, v189
v_cvt_pk_bf16_f32 v113, v190, v191
v_cvt_pk_bf16_f32 v114, v192, v193
v_cvt_pk_bf16_f32 v115, v194, v195
v_pk_fma_f32 v[180:181], v[196:197], v[188:189], v[180:181] op_sel_hi:[0,1,1] neg_lo:[0,0,1] neg_hi:[0,0,1]
v_pk_fma_f32 v[182:183], v[196:197], v[190:191], v[182:183] op_sel_hi:[0,1,1] neg_lo:[0,0,1] neg_hi:[0,0,1]
v_pk_fma_f32 v[184:185], v[196:197], v[192:193], v[184:185] op_sel_hi:[0,1,1] neg_lo:[0,0,1] neg_hi:[0,0,1]
v_pk_fma_f32 v[186:187], v[196:197], v[194:195], v[186:187] op_sel_hi:[0,1,1] neg_lo:[0,0,1] neg_hi:[0,0,1]
v_cvt_pk_bf16_f32 v116, v180, v181
v_cvt_pk_bf16_f32 v117, v182, v183
v_cvt_pk_bf16_f32 v118, v184, v185
v_cvt_pk_bf16_f32 v119, v186, v187
v_pk_fma_f32 v[188:189], v[196:197], v[180:181], v[188:189] op_sel_hi:[0,1,1] neg_lo:[0,0,1] neg_hi:[0,0,1]
v_pk_fma_f32 v[190:191], v[196:197], v[182:183], v[190:191] op_sel_hi:[0,1,1] neg_lo:[0,0,1] neg_hi:[0,0,1]
v_pk_fma_f32 v[192:193], v[196:197], v[184:185], v[192:193] op_sel_hi:[0,1,1] neg_lo:[0,0,1] neg_hi:[0,0,1]
v_pk_fma_f32 v[194:195], v[196:197], v[186:187], v[194:195] op_sel_hi:[0,1,1] neg_lo:[0,0,1] neg_hi:[0,0,1]
v_cvt_pk_bf16_f32 v120, v188, v189
v_cvt_pk_bf16_f32 v121, v190, v191
v_cvt_pk_bf16_f32 v122, v192, v193
v_cvt_pk_bf16_f32 v123, v194, v195
v_pk_fma_f32 v[180:181], v[196:197], v[188:189], v[180:181] op_sel_hi:[0,1,1] neg_lo:[0,0,1] neg_hi:[0,0,1]
v_pk_fma_f32 v[182:183], v[196:197], v[190:191], v[182:183] op_sel_hi:[0,1,1] neg_lo:[0,0,1] neg_hi:[0,0,1]
v_pk_fma_f32 v[184:185], v[196:197], v[192:193], v[184:185] op_sel_hi:[0,1,1] neg_lo:[0,0,1] neg_hi:[0,0,1]
v_pk_fma_f32 v[186:187], v[196:197], v[194:195], v[186:187] op_sel_hi:[0,1,1] neg_lo:[0,0,1] neg_hi:[0,0,1]
v_cvt_pk_bf16_f32 v124, v180, v181
v_cvt_pk_bf16_f32 v125, v182, v183
v_cvt_pk_bf16_f32 v126, v184, v185
v_cvt_pk_bf16_f32 v127, v186, v187
v_pk_fma_f32 v[188:189], v[196:197], v[180:181], v[188:189] op_sel_hi:[0,1,1] neg_lo:[0,0,1] neg_hi:[0,0,1]
v_pk_fma_f32 v[190:191], v[196:197], v[182:183], v[190:191] op_sel_hi:[0,1,1] neg_lo:[0,0,1] neg_hi:[0,0,1]
v_pk_fma_f32 v[192:193], v[196:197], v[184:185], v[192:193] op_sel_hi:[0,1,1] neg_lo:[0,0,1] neg_hi:[0,0,1]
v_pk_fma_f32 v[194:195], v[196:197], v[186:187], v[194:195] op_sel_hi:[0,1,1] neg_lo:[0,0,1] neg_hi:[0,0,1]
v_cvt_pk_bf16_f32 v128, v188, v189
v_cvt_pk_bf16_f32 v129, v190, v191
v_cvt_pk_bf16_f32 v130, v192, v193
v_cvt_pk_bf16_f32 v131, v194, v195
v_pk_fma_f32 v[180:181], v[196:197], v[188:189], v[180:181] op_sel_hi:[0,1,1] neg_lo:[0,0,1] neg_hi:[0,0,1]
v_pk_fma_f32 v[182:183], v[196:197], v[190:191], v[182:183] op_sel_hi:[0,1,1] neg_lo:[0,0,1] neg_hi:[0,0,1]
v_pk_fma_f32 v[184:185], v[196:197], v[192:193], v[184:185] op_sel_hi:[0,1,1] neg_lo:[0,0,1] neg_hi:[0,0,1]
v_pk_fma_f32 v[186:187], v[196:197], v[194:195], v[186:187] op_sel_hi:[0,1,1] neg_lo:[0,0,1] neg_hi:[0,0,1]
v_cvt_pk_bf16_f32 v132, v180, v181
v_cvt_pk_bf16_f32 v133, v182, v183
v_cvt_pk_bf16_f32 v134, v184, v185
v_cvt_pk_bf16_f32 v135, v186, v187
v_pk_fma_f32 v[188:189], v[196:197], v[180:181], v[188:189] op_sel_hi:[0,1,1] neg_lo:[0,0,1] neg_hi:[0,0,1]
v_pk_fma_f32 v[190:191], v[196:197], v[182:183], v[190:191] op_sel_hi:[0,1,1] neg_lo:[0,0,1] neg_hi:[0,0,1]
v_pk_fma_f32 v[192:193], v[196:197], v[184:185], v[192:193] op_sel_hi:[0,1,1] neg_lo:[0,0,1] neg_hi:[0,0,1]
v_pk_fma_f32 v[194:195], v[196:197], v[186:187], v[194:195] op_sel_hi:[0,1,1] neg_lo:[0,0,1] neg_hi:[0,0,1]
v_cvt_pk_bf16_f32 v136, v188, v189
v_cvt_pk_bf16_f32 v137, v190, v191
v_cvt_pk_bf16_f32 v138, v192, v193
v_cvt_pk_bf16_f32 v139, v194, v195
v_pk_fma_f32 v[180:181], v[196:197], v[188:189], v[180:181] op_sel_hi:[0,1,1] neg_lo:[0,0,1] neg_hi:[0,0,1]
v_pk_fma_f32 v[182:183], v[196:197], v[190:191], v[182:183] op_sel_hi:[0,1,1] neg_lo:[0,0,1] neg_hi:[0,0,1]
v_pk_fma_f32 v[184:185], v[196:197], v[192:193], v[184:185] op_sel_hi:[0,1,1] neg_lo:[0,0,1] neg_hi:[0,0,1]
v_pk_fma_f32 v[186:187], v[196:197], v[194:195], v[186:187] op_sel_hi:[0,1,1] neg_lo:[0,0,1] neg_hi:[0,0,1]
v_cvt_pk_bf16_f32 v140, v180, v181
v_cvt_pk_bf16_f32 v141, v182, v183
v_cvt_pk_bf16_f32 v142, v184, v185
v_cvt_pk_bf16_f32 v143, v186, v187
v_pk_fma_f32 v[188:189], v[196:197], v[180:181], v[188:189] op_sel_hi:[0,1,1] neg_lo:[0,0,1] neg_hi:[0,0,1]
v_pk_fma_f32 v[190:191], v[196:197], v[182:183], v[190:191] op_sel_hi:[0,1,1] neg_lo:[0,0,1] neg_hi:[0,0,1]
v_pk_fma_f32 v[192:193], v[196:197], v[184:185], v[192:193] op_sel_hi:[0,1,1] neg_lo:[0,0,1] neg_hi:[0,0,1]
v_pk_fma_f32 v[194:195], v[196:197], v[186:187], v[194:195] op_sel_hi:[0,1,1] neg_lo:[0,0,1] neg_hi:[0,0,1]
v_cvt_pk_bf16_f32 v144, v188, v189
v_cvt_pk_bf16_f32 v145, v190, v191
v_cvt_pk_bf16_f32 v146, v192, v193
v_cvt_pk_bf16_f32 v147, v194, v195
v_pk_fma_f32 v[180:181], v[196:197], v[188:189], v[180:181] op_sel_hi:[0,1,1] neg_lo:[0,0,1] neg_hi:[0,0,1]
v_pk_fma_f32 v[182:183], v[196:197], v[190:191], v[182:183] op_sel_hi:[0,1,1] neg_lo:[0,0,1] neg_hi:[0,0,1]
v_pk_fma_f32 v[184:185], v[196:197], v[192:193], v[184:185] op_sel_hi:[0,1,1] neg_lo:[0,0,1] neg_hi:[0,0,1]
v_pk_fma_f32 v[186:187], v[196:197], v[194:195], v[186:187] op_sel_hi:[0,1,1] neg_lo:[0,0,1] neg_hi:[0,0,1]
v_cvt_pk_bf16_f32 v148, v180, v181
v_cvt_pk_bf16_f32 v149, v182, v183
v_cvt_pk_bf16_f32 v150, v184, v185
v_cvt_pk_bf16_f32 v151, v186, v187
v_pk_fma_f32 v[188:189], v[196:197], v[180:181], v[188:189] op_sel_hi:[0,1,1] neg_lo:[0,0,1] neg_hi:[0,0,1]
v_pk_fma_f32 v[190:191], v[196:197], v[182:183], v[190:191] op_sel_hi:[0,1,1] neg_lo:[0,0,1] neg_hi:[0,0,1]
v_pk_fma_f32 v[192:193], v[196:197], v[184:185], v[192:193] op_sel_hi:[0,1,1] neg_lo:[0,0,1] neg_hi:[0,0,1]
v_pk_fma_f32 v[194:195], v[196:197], v[186:187], v[194:195] op_sel_hi:[0,1,1] neg_lo:[0,0,1] neg_hi:[0,0,1]
v_cvt_pk_bf16_f32 v152, v188, v189
v_cvt_pk_bf16_f32 v153, v190, v191
v_cvt_pk_bf16_f32 v154, v192, v193
v_cvt_pk_bf16_f32 v155, v194, v195
v_pk_fma_f32 v[180:181], v[196:197], v[188:189], v[180:181] op_sel_hi:[0,1,1] neg_lo:[0,0,1] neg_hi:[0,0,1]
v_pk_fma_f32 v[182:183], v[196:197], v[190:191], v[182:183] op_sel_hi:[0,1,1] neg_lo:[0,0,1] neg_hi:[0,0,1]
v_pk_fma_f32 v[184:185], v[196:197], v[192:193], v[184:185] op_sel_hi:[0,1,1] neg_lo:[0,0,1] neg_hi:[0,0,1]
v_pk_fma_f32 v[186:187], v[196:197], v[194:195], v[186:187] op_sel_hi:[0,1,1] neg_lo:[0,0,1] neg_hi:[0,0,1]
v_cvt_pk_bf16_f32 v156, v180, v181
v_cvt_pk_bf16_f32 v157, v182, v183
v_cvt_pk_bf16_f32 v158, v184, v185
v_cvt_pk_bf16_f32 v159, v186, v187
v_pk_fma_f32 v[188:189], v[196:197], v[180:181], v[188:189] op_sel_hi:[0,1,1] neg_lo:[0,0,1] neg_hi:[0,0,1]
v_pk_fma_f32 v[190:191], v[196:197], v[182:183], v[190:191] op_sel_hi:[0,1,1] neg_lo:[0,0,1] neg_hi:[0,0,1]
v_pk_fma_f32 v[192:193], v[196:197], v[184:185], v[192:193] op_sel_hi:[0,1,1] neg_lo:[0,0,1] neg_hi:[0,0,1]
v_pk_fma_f32 v[194:195], v[196:197], v[186:187], v[194:195] op_sel_hi:[0,1,1] neg_lo:[0,0,1] neg_hi:[0,0,1]
v_cvt_pk_bf16_f32 v160, v188, v189
v_cvt_pk_bf16_f32 v161, v190, v191
v_cvt_pk_bf16_f32 v162, v192, v193
v_cvt_pk_bf16_f32 v163, v194, v195
v_pk_fma_f32 v[180:181], v[196:197], v[188:189], v[180:181] op_sel_hi:[0,1,1] neg_lo:[0,0,1] neg_hi:[0,0,1]
v_pk_fma_f32 v[182:183], v[196:197], v[190:191], v[182:183] op_sel_hi:[0,1,1] neg_lo:[0,0,1] neg_hi:[0,0,1]
v_pk_fma_f32 v[184:185], v[196:197], v[192:193], v[184:185] op_sel_hi:[0,1,1] neg_lo:[0,0,1] neg_hi:[0,0,1]
v_pk_fma_f32 v[186:187], v[196:197], v[194:195], v[186:187] op_sel_hi:[0,1,1] neg_lo:[0,0,1] neg_hi:[0,0,1]
v_cvt_pk_bf16_f32 v164, v180, v181
v_cvt_pk_bf16_f32 v165, v182, v183
v_cvt_pk_bf16_f32 v166, v184, v185
v_cvt_pk_bf16_f32 v167, v186, v187
v_pk_fma_f32 v[188:189], v[196:197], v[180:181], v[188:189] op_sel_hi:[0,1,1] neg_lo:[0,0,1] neg_hi:[0,0,1]
v_pk_fma_f32 v[190:191], v[196:197], v[182:183], v[190:191] op_sel_hi:[0,1,1] neg_lo:[0,0,1] neg_hi:[0,0,1]
v_pk_fma_f32 v[192:193], v[196:197], v[184:185], v[192:193] op_sel_hi:[0,1,1] neg_lo:[0,0,1] neg_hi:[0,0,1]
v_pk_fma_f32 v[194:195], v[196:197], v[186:187], v[194:195] op_sel_hi:[0,1,1] neg_lo:[0,0,1] neg_hi:[0,0,1]
v_cvt_pk_bf16_f32 v168, v188, v189
v_cvt_pk_bf16_f32 v169, v190, v191
v_cvt_pk_bf16_f32 v170, v192, v193
v_cvt_pk_bf16_f32 v171, v194, v195
v_pk_fma_f32 v[180:181], v[196:197], v[188:189], v[180:181] op_sel_hi:[0,1,1] neg_lo:[0,0,1] neg_hi:[0,0,1]
v_pk_fma_f32 v[182:183], v[196:197], v[190:191], v[182:183] op_sel_hi:[0,1,1] neg_lo:[0,0,1] neg_hi:[0,0,1]
v_pk_fma_f32 v[184:185], v[196:197], v[192:193], v[184:185] op_sel_hi:[0,1,1] neg_lo:[0,0,1] neg_hi:[0,0,1]
v_pk_fma_f32 v[186:187], v[196:197], v[194:195], v[186:187] op_sel_hi:[0,1,1] neg_lo:[0,0,1] neg_hi:[0,0,1]
v_cvt_pk_bf16_f32 v172, v180, v181
v_cvt_pk_bf16_f32 v173, v182, v183
v_cvt_pk_bf16_f32 v174, v184, v185
v_cvt_pk_bf16_f32 v175, v186, v187
v_pk_fma_f32 v[188:189], v[196:197], v[180:181], v[188:189] op_sel_hi:[0,1,1] neg_lo:[0,0,1] neg_hi:[0,0,1]
v_pk_fma_f32 v[190:191], v[196:197], v[182:183], v[190:191] op_sel_hi:[0,1,1] neg_lo:[0,0,1] neg_hi:[0,0,1]
v_pk_fma_f32 v[192:193], v[196:197], v[184:185], v[192:193] op_sel_hi:[0,1,1] neg_lo:[0,0,1] neg_hi:[0,0,1]
v_pk_fma_f32 v[194:195], v[196:197], v[186:187], v[194:195] op_sel_hi:[0,1,1] neg_lo:[0,0,1] neg_hi:[0,0,1]
v_cvt_pk_bf16_f32 v176, v188, v189
v_cvt_pk_bf16_f32 v177, v190, v191
v_cvt_pk_bf16_f32 v178, v192, v193
v_cvt_pk_bf16_f32 v179, v194, v195
v_mov_b32 v180, s24
v_mov_b32 v181, s24
v_mov_b32 v182, s24
v_mov_b32 v183, s24
s_nop 1
v_mfma_f32_32x32x16_bf16 v[184:199], v[180:183], v[20:23], 0
v_mfma_f32_32x32x16_bf16 v[184:199], v[180:183], v[24:27], v[184:199]
v_mfma_f32_32x32x16_bf16 v[184:199], v[180:183], v[28:31], v[184:199]
v_mfma_f32_32x32x16_bf16 v[184:199], v[180:183], v[32:35], v[184:199]
v_mfma_f32_32x32x16_bf16 v[184:199], v[180:183], v[36:39], v[184:199]
v_mfma_f32_32x32x16_bf16 v[184:199], v[180:183], v[40:43], v[184:199]
v_mfma_f32_32x32x16_bf16 v[184:199], v[180:183], v[44:47], v[184:199]
v_mfma_f32_32x32x16_bf16 v[184:199], v[180:183], v[48:51], v[184:199]
v_mfma_f32_32x32x16_bf16 v[184:199], v[180:183], v[52:55], v[184:199]
v_mfma_f32_32x32x16_bf16 v[184:199], v[180:183], v[56:59], v[184:199]
v_mfma_f32_32x32x16_bf16 v[184:199], v[180:183], v[60:63], v[184:199]
v_mfma_f32_32x32x16_bf16 v[184:199], v[180:183], v[64:67], v[184:199]
v_mfma_f32_32x32x16_bf16 v[184:199], v[180:183], v[68:71], v[184:199]
v_mfma_f32_32x32x16_bf16 v[184:199], v[180:183], v[72:75], v[184:199]
v_mfma_f32_32x32x16_bf16 v[184:199], v[180:183], v[76:79], v[184:199]
v_mfma_f32_32x32x16_bf16 v[184:199], v[180:183], v[80:83], v[184:199]
v_mfma_f32_32x32x16_bf16 v[184:199], v[180:183], v[84:87], v[184:199]
v_mfma_f32_32x32x16_bf16 v[184:199], v[180:183], v[88:91], v[184:199]
v_mfma_f32_32x32x16_bf16 v[184:199], v[180:183], v[92:95], v[184:199]
v_mfma_f32_32x32x16_bf16 v[184:199], v[180:183], v[96:99], v[184:199]
v_mfma_f32_32x32x16_bf16 v[184:199], v[180:183], v[100:103], v[184:199]
v_mfma_f32_32x32x16_bf16 v[184:199], v[180:183], v[104:107], v[184:199]
v_mfma_f32_32x32x16_bf16 v[184:199], v[180:183], v[108:111], v[184:199]
v_mfma_f32_32x32x16_bf16 v[184:199], v[180:183], v[112:115], v[184:199]
v_mfma_f32_32x32x16_bf16 v[184:199], v[180:183], v[116:119], v[184:199]
v_mfma_f32_32x32x16_bf16 v[184:199], v[180:183], v[120:123], v[184:199]
v_mfma_f32_32x32x16_bf16 v[184:199], v[180:183], v[124:127], v[184:199]
v_mfma_f32_32x32x16_bf16 v[184:199], v[180:183], v[128:131], v[184:199]
v_mfma_f32_32x32x16_bf16 v[184:199], v[180:183], v[132:135], v[184:199]
v_mfma_f32_32x32x16_bf16 v[184:199], v[180:183], v[136:139], v[184:199]
v_mfma_f32_32x32x16_bf16 v[184:199], v[180:183], v[140:143], v[184:199]
v_mfma_f32_32x32x16_bf16 v[184:199], v[180:183], v[144:147], v[184:199]
v_mfma_f32_32x32x16_bf16 v[184:199], v[180:183], v[148:151], v[184:199]
v_mfma_f32_32x32x16_bf16 v[184:199], v[180:183], v[152:155], v[184:199]
v_mfma_f32_32x32x16_bf16 v[184:199], v[180:183], v[156:159], v[184:199]
v_mfma_f32_32x32x16_bf16 v[184:199], v[180:183], v[160:163], v[184:199]
v_mfma_f32_32x32x16_bf16 v[184:199], v[180:183], v[164:167], v[184:199]
v_mfma_f32_32x32x16_bf16 v[184:199], v[180:183], v[168:171], v[184:199]
v_mfma_f32_32x32x16_bf16 v[184:199], v[180:183], v[172:175], v[184:199]
v_mfma_f32_32x32x16_bf16 v[184:199], v[180:183], v[176:179], v[184:199]
s_nop 11
v_mov_b32 v9, v184
p1q_46:
s_mul_i32 s18, s30, 21846
s_lshr_b32 s18, s18, 16
s_mul_i32 s18, s18, 3
s_sub_u32 s18, s30, s18
s_and_b32 s19, s30, 3
s_cmp_lt_u32 s30, 56
s_cselect_b32 s18, s18, s19
s_mul_i32 s18, s18, 2560
s_add_u32 s18, s18, 11665408
s_add_u32 s29, s30, 1
s_cmp_lg_u32 s13, 0
s_cbranch_scc1 polld_48
v_lshlrev_b32 v3, 3, v0
v_min_u32 v16, 2432, v3
s_mov_b32 s17, 0
poll_47:
buffer_load_dword v12, v16, s[4:7], s18 offen sc1
s_add_u32 s17, s17, 1
s_cmp_gt_u32 s17, 262144
s_cbranch_scc1 L_fail
s_waitcnt vmcnt(0)
v_cmp_gt_u32 vcc, s29, v12
s_cbranch_vccz polld_48
s_sleep 2
s_branch poll_47
polld_48:
s_barrier
s_mul_i32 s18, s30, 40960
s_add_u32 s26, s18, 91226112
s_add_u32 s26, s26, s31
s_add_u32 s27, s18, 100663296
s_add_u32 s27, s27, s33
s_add_u32 m0, s31, 2048
s_add_u32 s20, s26, 0
buffer_load_dwordx4 v0, s[4:7], s20 offen sc1 lds
s_add_u32 m0, s31, 3072
s_add_u32 s20, s26, 1024
buffer_load_dwordx4 v0, s[4:7], s20 offen sc1 lds
s_add_u32 m0, s31, 4096
s_add_u32 s20, s26, 2048
buffer_load_dwordx4 v0, s[4:7], s20 offen sc1 lds
s_add_u32 m0, s31, 5120
s_add_u32 s20, s26, 3072
buffer_load_dwordx4 v0, s[4:7], s20 offen sc1 lds
s_add_u32 m0, s31, 6144
s_add_u32 s20, s26, 4096
buffer_load_dwordx4 v0, s[4:7], s20 offen sc1 lds
s_add_u32 m0, s31, 7168
s_add_u32 s20, s26, 5120
buffer_load_dwordx4 v0, s[4:7], s20 offen sc1 lds
s_add_u32 m0, s31, 8192
s_add_u32 s20, s26, 6144
buffer_load_dwordx4 v0, s[4:7], s20 offen sc1 lds
s_add_u32 m0, s31, 9216
s_add_u32 s20, s26, 7168
buffer_load_dwordx4 v0, s[4:7], s20 offen sc1 lds
s_add_u32 m0, s31, 10240
s_add_u32 s20, s26, 8192
buffer_load_dwordx4 v0, s[4:7], s20 offen sc1 lds
s_add_u32 m0, s31, 11264
s_add_u32 s20, s26, 9216
buffer_load_dwordx4 v0, s[4:7], s20 offen sc1 lds
s_waitcnt vmcnt(0)
s_barrier
v_add_u32 v2, s31, v0
ds_read_b128 v[220:223], v2 offset:2048
ds_read_b128 v[224:227], v2 offset:3072
ds_read_b128 v[228:231], v2 offset:4096
ds_read_b128 v[200:203], v0 offset:3072
ds_read_b128 v[232:235], v2 offset:5120
ds_read_b128 v[196:199], v0 offset:2048
v_mov_b64 v[212:213], 0
ds_read_b128 v[204:207], v0 offset:4096
ds_read_b128 v[208:211], v0 offset:5120
s_waitcnt lgkmcnt(7)
v_dot2c_f32_bf16 v212, s24, v220
v_dot2c_f32_bf16 v213, v220, v220
v_dot2c_f32_bf16 v212, s24, v221
v_dot2c_f32_bf16 v213, v221, v221
v_dot2c_f32_bf16 v212, s24, v222
v_dot2c_f32_bf16 v213, v222, v222
v_dot2c_f32_bf16 v212, s24, v223
s_waitcnt lgkmcnt(5)
v_dot2c_f32_bf16 v213, v223, v223
v_dot2c_f32_bf16 v212, s24, v224
v_dot2c_f32_bf16 v213, v224, v224
v_dot2c_f32_bf16 v212, s24, v225
v_dot2c_f32_bf16 v213, v225, v225
v_dot2c_f32_bf16 v212, s24, v226
v_dot2c_f32_bf16 v213, v226, v226
v_dot2c_f32_bf16 v212, s24, v227
v_dot2c_f32_bf16 v213, v227, v227
v_dot2c_f32_bf16 v212, s24, v228
v_dot2c_f32_bf16 v213, v228, v228
s_waitcnt lgkmcnt(3)
ds_read_b128 v[220:223], v2 offset:6144
ds_read_b128 v[224:227], v2 offset:7168
v_dot2c_f32_bf16 v212, s24, v229
v_dot2c_f32_bf16 v213, v229, v229
v_dot2c_f32_bf16 v212, s24, v230
v_dot2c_f32_bf16 v213, v230, v230
v_dot2c_f32_bf16 v212, s24, v231
v_dot2c_f32_bf16 v213, v231, v231
v_dot2c_f32_bf16 v212, s24, v232
v_dot2c_f32_bf16 v213, v232, v232
v_dot2c_f32_bf16 v212, s24, v233
v_dot2c_f32_bf16 v213, v233, v233
v_dot2c_f32_bf16 v212, s24, v234
v_dot2c_f32_bf16 v213, v234, v234
v_dot2c_f32_bf16 v212, s24, v235
v_dot2c_f32_bf16 v213, v235, v235
s_waitcnt lgkmcnt(1)
ds_read_b128 v[232:235], v2 offset:9216
ds_read_b128 v[228:231], v2 offset:8192
v_dot2c_f32_bf16 v212, s24, v220
v_dot2c_f32_bf16 v213, v220, v220
v_dot2c_f32_bf16 v212, s24, v221
s_waitcnt lgkmcnt(2)
v_dot2c_f32_bf16 v213, v221, v221
v_dot2c_f32_bf16 v212, s24, v222
v_dot2c_f32_bf16 v213, v222, v222
v_dot2c_f32_bf16 v212, s24, v223
v_dot2c_f32_bf16 v213, v223, v223
v_dot2c_f32_bf16 v212, s24, v224
v_dot2c_f32_bf16 v213, v224, v224
v_dot2c_f32_bf16 v212, s24, v225
v_dot2c_f32_bf16 v213, v225, v225
v_dot2c_f32_bf16 v212, s24, v226
v_dot2c_f32_bf16 v213, v226, v226
v_dot2c_f32_bf16 v212, s24, v227
v_dot2c_f32_bf16 v213, v227, v227
s_waitcnt lgkmcnt(0)
ds_read_b128 v[220:223], v2 offset:10240
ds_read_b128 v[224:227], v2 offset:11264
v_dot2c_f32_bf16 v212, s24, v228
v_dot2c_f32_bf16 v213, v228, v228
v_dot2c_f32_bf16 v212, s24, v229
v_dot2c_f32_bf16 v213, v229, v229
v_dot2c_f32_bf16 v212, s24, v230
v_dot2c_f32_bf16 v213, v230, v230
v_dot2c_f32_bf16 v212, s24, v231
v_dot2c_f32_bf16 v213, v231, v231
v_dot2c_f32_bf16 v212, s24, v232
v_dot2c_f32_bf16 v213, v232, v232
v_dot2c_f32_bf16 v212, s24, v233
v_dot2c_f32_bf16 v213, v233, v233
v_dot2c_f32_bf16 v212, s24, v234
v_dot2c_f32_bf16 v213, v234, v234
s_waitcnt lgkmcnt(1)
v_dot2c_f32_bf16 v212, s24, v235
v_dot2c_f32_bf16 v213, v235, v235
v_dot2c_f32_bf16 v212, s24, v220
s_waitcnt lgkmcnt(0)
v_dot2c_f32_bf16 v213, v220, v220
v_dot2c_f32_bf16 v212, s24, v221
v_dot2c_f32_bf16 v213, v221, v221
v_dot2c_f32_bf16 v212, s24, v222
v_dot2c_f32_bf16 v213, v222, v222
v_dot2c_f32_bf16 v212, s24, v223
v_dot2c_f32_bf16 v213, v223, v223
v_dot2c_f32_bf16 v212, s24, v224
v_dot2c_f32_bf16 v213, v224, v224
v_dot2c_f32_bf16 v212, s24, v225
v_dot2c_f32_bf16 v213, v225, v225
v_dot2c_f32_bf16 v212, s24, v226
v_dot2c_f32_bf16 v213, v226, v226
v_dot2c_f32_bf16 v212, s24, v227
v_dot2c_f32_bf16 v213, v227, v227
v_mfma_f32_32x32x16_bf16 v[180:195], v[196:199], v[20:23], 0
s_nop 1
v_permlane32_swap_b32 v212, v213
ds_read_b128 v[196:199], v0 offset:6144
v_mfma_f32_32x32x16_bf16 v[180:195], v[200:203], v[24:27], v[180:195]
v_and_b32 v2, 0x1ff, v0
v_add_f32 v212, v212, v213
v_mfma_f32_32x32x16_bf16 v[180:195], v[204:207], v[28:31], v[180:195]
v_lshl_add_u32 v213, s13, 2, v0
ds_read_b128 v[200:203], v0 offset:7168
ds_write_b32 v213, v212 offset:0
v_mfma_f32_32x32x16_bf16 v[180:195], v[208:211], v[32:35], v[180:195]
s_waitcnt lgkmcnt(2)
ds_read_b128 v[204:207], v0 offset:8192
ds_read_b128 v[208:211], v0 offset:9216
v_mfma_f32_32x32x16_bf16 v[180:195], v[196:199], v[36:39], v[180:195]
s_waitcnt lgkmcnt(3)
v_mfma_f32_32x32x16_bf16 v[180:195], v[200:203], v[40:43], v[180:195]
s_waitcnt lgkmcnt(2)
ds_read_b128 v[196:199], v0 offset:10240
s_waitcnt lgkmcnt(2)
s_waitcnt lgkmcnt(1)
v_mfma_f32_32x32x16_bf16 v[180:195], v[204:207], v[44:47], v[180:195]
ds_read_b128 v[200:203], v0 offset:11264
s_barrier
ds_read_b128 v[212:215], v2 offset:0
v_mfma_f32_32x32x16_bf16 v[180:195], v[208:211], v[48:51], v[180:195]
ds_read_b128 v[208:211], v0 offset:13312
ds_read_b128 v[204:207], v0 offset:12288
s_waitcnt lgkmcnt(4)
v_mfma_f32_32x32x16_bf16 v[180:195], v[196:199], v[52:55], v[180:195]
s_waitcnt lgkmcnt(3)
ds_read_b128 v[216:219], v2 offset:512
ds_read_b128 v[196:199], v0 offset:14336
v_mfma_f32_32x32x16_bf16 v[180:195], v[200:203], v[56:59], v[180:195]
s_waitcnt lgkmcnt(2)
v_mfma_f32_32x32x16_bf16 v[180:195], v[204:207], v[60:63], v[180:195]
ds_read_b128 v[200:203], v0 offset:15360
ds_read_b128 v[204:207], v0 offset:16384
v_add_f32 v212, v212, v213
v_add_f32 v214, v214, v215
s_waitcnt lgkmcnt(3)
v_mfma_f32_32x32x16_bf16 v[180:195], v[208:211], v[64:67], v[180:195]
s_waitcnt lgkmcnt(2)
ds_read_b128 v[208:211], v0 offset:17408
v_add_f32 v216, v216, v217
v_add_f32 v212, v212, v214
v_mfma_f32_32x32x16_bf16 v[180:195], v[196:199], v[68:71], v[180:195]
s_waitcnt lgkmcnt(2)
v_mfma_f32_32x32x16_bf16 v[180:195], v[200:203], v[72:75], v[180:195]
v_mul_f32 v212, 0x3acccccd, v212
s_waitcnt lgkmcnt(1)
ds_read_b128 v[196:199], v0 offset:18432
v_add_f32 v218, v218, v219
s_waitcnt lgkmcnt(1)
v_mfma_f32_32x32x16_bf16 v[180:195], v[204:207], v[76:79], v[180:195]
v_lshrrev_b32 v213, 2, v0
ds_read_b128 v[200:203], v0 offset:19456
v_mfma_f32_32x32x16_bf16 v[180:195], v[208:211], v[80:83], v[180:195]
ds_read_b128 v[204:207], v0 offset:20480
ds_read_b128 v[208:211], v0 offset:21504
v_add_f32 v216, v216, v218
v_mul_f32 v216, 0x3acccccd, v216
s_waitcnt lgkmcnt(3)
v_mfma_f32_32x32x16_bf16 v[180:195], v[196:199], v[84:87], v[180:195]
v_fma_f32 v216, -v212, v212, v216
s_waitcnt lgkmcnt(2)
v_max_f32 v216, 0, v216
v_add_f32 v216, 0x3727c5ac, v216
v_mfma_f32_32x32x16_bf16 v[180:195], v[200:203], v[88:91], v[180:195]
ds_read_b128 v[196:199], v0 offset:22528
s_waitcnt lgkmcnt(2)
v_bfe_u32 v214, v0, 5, 5
v_lshl_add_u32 v213, s13, 8, v213
v_mfma_f32_32x32x16_bf16 v[180:195], v[204:207], v[92:95], v[180:195]
ds_read_b128 v[200:203], v0 offset:23552
ds_read_b128 v[204:207], v0 offset:24576
v_rsq_f32 v216, v216
s_waitcnt lgkmcnt(3)
v_and_b32 v214, 16, v214
v_mfma_f32_32x32x16_bf16 v[180:195], v[208:211], v[96:99], v[180:195]
ds_read_b128 v[208:211], v0 offset:25600
s_waitcnt lgkmcnt(3)
v_mul_f32 v212, v216, v212
v_mfma_f32_32x32x16_bf16 v[180:195], v[196:199], v[100:103], v[180:195]
v_lshl_add_u32 v214, s13, 8, v214
v_permlane32_swap_b32 v216, v212
s_waitcnt lgkmcnt(2)
ds_read_b128 v[196:199], v0 offset:26624
v_mfma_f32_32x32x16_bf16 v[180:195], v[200:203], v[104:107], v[180:195]
ds_write_b32 v213, v216 offset:1024
s_waitcnt lgkmcnt(3)
s_waitcnt lgkmcnt(2)
v_mfma_f32_32x32x16_bf16 v[180:195], v[204:207], v[108:111], v[180:195]
ds_read_b128 v[244:247], v214 offset:1216
ds_read_b128 v[200:203], v0 offset:27648
v_mfma_f32_32x32x16_bf16 v[180:195], v[208:211], v[112:115], v[180:195]
ds_read_b128 v[204:207], v0 offset:28672
s_waitcnt lgkmcnt(4)
ds_read_b128 v[236:239], v214 offset:1152
v_mfma_f32_32x32x16_bf16 v[180:195], v[196:199], v[116:119], v[180:195]
ds_read_b128 v[208:211], v0 offset:29696
ds_read_b128 v[196:199], v0 offset:30720
s_waitcnt lgkmcnt(4)
v_mfma_f32_32x32x16_bf16 v[180:195], v[200:203], v[120:123], v[180:195]
ds_read_b128 v[232:235], v214 offset:1120
s_waitcnt lgkmcnt(4)
ds_read_b128 v[220:223], v214 offset:1024
ds_read_b128 v[200:203], v0 offset:31744
v_mfma_f32_32x32x16_bf16 v[180:195], v[204:207], v[124:127], v[180:195]
v_mul_f32 v245, v245, v9
s_waitcnt lgkmcnt(3)
ds_read_b128 v[204:207], v0 offset:32768
v_mfma_f32_32x32x16_bf16 v[180:195], v[208:211], v[128:131], v[180:195]
ds_read_b128 v[224:227], v214 offset:1056
v_mfma_f32_32x32x16_bf16 v[180:195], v[196:199], v[132:135], v[180:195]
ds_read_b128 v[208:211], v0 offset:33792
s_waitcnt lgkmcnt(3)
v_mfma_f32_32x32x16_bf16 v[180:195], v[200:203], v[136:139], v[180:195]
s_waitcnt lgkmcnt(2)
ds_read_b128 v[196:199], v0 offset:34816
ds_read_b128 v[228:231], v214 offset:1088
ds_read_b128 v[200:203], v0 offset:35840
ds_read_b128 v[248:251], v214 offset:1248
v_mfma_f32_32x32x16_bf16 v[180:195], v[204:207], v[140:143], v[180:195]
s_waitcnt lgkmcnt(4)
ds_read_b128 v[204:207], v0 offset:36864
v_mfma_f32_32x32x16_bf16 v[180:195], v[208:211], v[144:147], v[180:195]
v_mul_f32 v246, v246, v9
ds_read_b128 v[240:243], v214 offset:1184
s_waitcnt lgkmcnt(5)
v_mfma_f32_32x32x16_bf16 v[180:195], v[196:199], v[148:151], v[180:195]
ds_read_b128 v[208:211], v0 offset:37888
s_waitcnt lgkmcnt(3)
ds_read_b128 v[196:199], v0 offset:38912
v_mfma_f32_32x32x16_bf16 v[180:195], v[200:203], v[152:155], v[180:195]
ds_read_b128 v[200:203], v0 offset:39936
s_waitcnt lgkmcnt(4)
s_waitcnt lgkmcnt(3)
v_mul_f32 v244, v244, v9
v_mfma_f32_32x32x16_bf16 v[180:195], v[204:207], v[156:159], v[180:195]
v_mul_f32 v251, v251, v9
v_mul_f32 v249, v249, v9
v_mul_f32 v237, v237, v9
s_waitcnt lgkmcnt(2)
v_mfma_f32_32x32x16_bf16 v[180:195], v[208:211], v[160:163], v[180:195]
ds_read_b128 v[204:207], v0 offset:40960
s_waitcnt lgkmcnt(1)
ds_read_b128 v[208:211], v0 offset:41984
v_mul_f32 v236, v236, v9
v_mfma_f32_32x32x16_bf16 v[180:195], v[196:199], v[164:167], v[180:195]
v_mul_f32 v250, v250, v9
v_mul_f32 v248, v248, v9
v_mul_f32 v240, v240, v9
v_mfma_f32_32x32x16_bf16 v[180:195], v[200:203], v[168:171], v[180:195]
s_waitcnt lgkmcnt(0)
v_mul_f32 v243, v243, v9
v_mfma_f32_32x32x16_bf16 v[180:195], v[204:207], v[172:175], v[180:195]
v_mul_f32 v242, v242, v9
v_mfma_f32_32x32x16_bf16 v[180:195], v[208:211], v[176:179], v[180:195]
s_nop 0
v_mul_f32 v241, v241, v9
v_mul_f32 v239, v239, v9
v_mul_f32 v238, v238, v9
v_mul_f32 v247, v247, v9
s_nop 6
v_pk_fma_f32 v[188:189], v[188:189], v[228:229], v[244:245] neg_lo:[0,0,1] neg_hi:[0,0,1]
v_pk_fma_f32 v[186:187], v[186:187], v[226:227], v[242:243] neg_lo:[0,0,1] neg_hi:[0,0,1]
v_pk_fma_f32 v[184:185], v[184:185], v[224:225], v[240:241] neg_lo:[0,0,1] neg_hi:[0,0,1]
v_pk_fma_f32 v[192:193], v[192:193], v[232:233], v[248:249] neg_lo:[0,0,1] neg_hi:[0,0,1]
v_pk_fma_f32 v[180:181], v[180:181], v[220:221], v[236:237] neg_lo:[0,0,1] neg_hi:[0,0,1]
v_cvt_pk_bf16_f32 v198, v184, v185
v_pk_fma_f32 v[182:183], v[182:183], v[222:223], v[238:239] neg_lo:[0,0,1] neg_hi:[0,0,1]
v_cvt_pk_bf16_f32 v202, v192, v193
v_pk_fma_f32 v[194:195], v[194:195], v[234:235], v[250:251] neg_lo:[0,0,1] neg_hi:[0,0,1]
v_cvt_pk_bf16_f32 v203, v194, v195
v_cvt_pk_bf16_f32 v199, v186, v187
v_pk_fma_f32 v[190:191], v[190:191], v[230:231], v[246:247] neg_lo:[0,0,1] neg_hi:[0,0,1]
v_cvt_pk_bf16_f32 v197, v182, v183
v_cvt_pk_bf16_f32 v200, v188, v189
v_cvt_pk_bf16_f32 v201, v190, v191
v_cvt_pk_bf16_f32 v196, v180, v181
buffer_store_dwordx4 v[196:199], v10, s[4:7], s27 offen offset:0 sc1
buffer_store_dwordx4 v[200:203], v10, s[4:7], s27 offen offset:1024 sc1
s_add_u32 s30, s30, 3
s_cmp_lt_u32 s30, 60
s_cbranch_scc1 p1q_46
s_lshl_b32 s18, s54, 7
s_add_u32 s18, s18, 11552768
s_cmp_eq_u32 s13, 0
s_cselect_b32 s22, s18, s6
s_mov_b32 s23, 1
s_waitcnt vmcnt(0)
s_barrier
v_mov_b32 v3, s23
s_mov_b64 exec, 1
buffer_store_dword v3, off, s[4:7], s22 sc1
s_mov_b64 exec, -1
s_mov_b32 s22, s6
s_mov_b32 s34, s55
kvz_45:
s_add_u32 s16, s16, 1
s_cmp_lt_u32 s16, 2
s_cbranch_scc1 kvlay_29
s_endpgm
roleA_12:
s_sub_u32 s39, s15, 64
s_mul_i32 s50, s39, 13108
s_lshr_b32 s50, s50, 16
s_mul_i32 s18, s50, 5
s_sub_u32 s34, s39, s18
s_waitcnt vmcnt(0)
v_bfe_u32 v5, v0, 4, 5
v_mul_u32_u24 v5, 1280, v5
v_lshrrev_b32 v8, 9, v0
v_lshl_add_u32 v5, v8, 4, v5
v_and_b32 v6, 0x1ff, v0
v_lshlrev_b32 v6, 1, v6
v_lshl_add_u32 v6, v8, 4, v6
s_load_dwordx2 s[44:45], s[0:1], 0
s_mov_b32 s46, 2621440
s_mov_b32 s47, 0x20000
s_waitcnt lgkmcnt(0)
v_lshrrev_b32 v8, 7, v0
v_lshl_add_u32 v8, s13, 3, v8
v_bfe_u32 v9, v8, 1, 3
v_lshlrev_b32 v9, 4, v9
v_xor_b32 v9, v9, v0
v_and_b32 v9, 0x70, v9
v_mul_u32_u24 v8, 1280, v8
v_add_u32 v8, v8, v9
s_mul_i32 s26, s50, 40960
s_lshl_b32 s25, s13, 10
s_add_u32 m0, s25, 2048
s_add_u32 s20, s26, 0
buffer_load_dwordx4 v8, s[44:47], s20 offen sc1 lds
s_add_u32 m0, s25, 6144
s_add_u32 s20, s26, 128
buffer_load_dwordx4 v8, s[44:47], s20 offen sc1 lds
s_add_u32 m0, s25, 10240
s_add_u32 s20, s26, 256
buffer_load_dwordx4 v8, s[44:47], s20 offen sc1 lds
s_add_u32 m0, s25, 14336
s_add_u32 s20, s26, 384
buffer_load_dwordx4 v8, s[44:47], s20 offen sc1 lds
s_add_u32 m0, s25, 18432
s_add_u32 s20, s26, 512
buffer_load_dwordx4 v8, s[44:47], s20 offen sc1 lds
s_add_u32 m0, s25, 22528
s_add_u32 s20, s26, 640
buffer_load_dwordx4 v8, s[44:47], s20 offen sc1 lds
s_add_u32 m0, s25, 26624
s_add_u32 s20, s26, 768
buffer_load_dwordx4 v8, s[44:47], s20 offen sc1 lds
s_add_u32 m0, s25, 30720
s_add_u32 s20, s26, 896
buffer_load_dwordx4 v8, s[44:47], s20 offen sc1 lds
s_add_u32 m0, s25, 34816
s_add_u32 s20, s26, 1024
buffer_load_dwordx4 v8, s[44:47], s20 offen sc1 lds
s_add_u32 m0, s25, 38912
s_add_u32 s20, s26, 1152
buffer_load_dwordx4 v8, s[44:47], s20 offen sc1 lds
s_add_u32 s26, s26, 1310720
s_add_u32 s25, s25, 40960
v_bfe_u32 v176, v0, 5, 3
v_lshrrev_b32 v9, 9, v0
v_xor_b32 v176, v176, v9
v_lshlrev_b32 v176, 4, v176
v_and_b32 v9, 0x1f0, v0
v_lshl_add_u32 v176, v9, 3, v176
v_xor_b32 v177, 32, v176
v_xor_b32 v178, 64, v176
v_xor_b32 v179, 96, v176
s_lshl_b32 s18, s34, 7
s_lshl_b32 s19, s13, 5
s_add_u32 s18, s18, s19
s_mov_b32 s19, 0x3acccccd
v_bfe_u32 v202, v0, 4, 5
v_lshrrev_b32 v197, 9, v0
v_add_u32 v202, s18, v202
v_and_b32 v201, 1, v202
v_mul_u32_u24 v201, 160, v201
v_lshrrev_b32 v200, 1, v202
v_add_u32 v200, 1, v200
v_lshlrev_b32 v197, 3, v197
v_mad_u32_u24 v201, v197, v200, v201
v_mad_u32_u24 v196, v200, 16, 0
v_cvt_f32_u32 v196, v196
v_mul_f32 v202, s19, v196
v_rndne_f32 v202, v202
v_fmac_f32 v196, 0xc4200000, v202
v_mul_f32 v196, s19, v196
v_cos_f32 v196, v196
s_nop 0
v_add_f32 v196, v196, v196
v_mad_u32_u24 v198, v200, 1, 0
v_cvt_f32_u32 v198, v198
v_mul_f32 v202, s19, v198
v_rndne_f32 v202, v202
v_fmac_f32 v198, 0xc4200000, v202
v_mul_f32 v198, s19, v198
v_cos_f32 v198, v198
s_nop 0
v_add_f32 v198, v198, v198
v_mad_u32_u24 v183, v200, 3, v201
v_cvt_f32_u32 v183, v183
v_mul_f32 v202, s19, v183
v_rndne_f32 v202, v202
v_fmac_f32 v183, 0xc4200000, v202
v_mul_f32 v183, s19, v183
v_cos_f32 v183, v183
v_mad_u32_u24 v184, v200, 4, v201
v_cvt_f32_u32 v184, v184
v_mul_f32 v202, s19, v184
v_rndne_f32 v202, v202
v_fmac_f32 v184, 0xc4200000, v202
v_mul_f32 v184, s19, v184
v_cos_f32 v184, v184
s_nop 0
v_fma_f32 v185, v198, v184, -v183
v_fma_f32 v182, v198, v183, -v184
v_fma_f32 v186, v198, v185, -v184
v_fma_f32 v181, v198, v182, -v183
v_fma_f32 v187, v198, v186, -v185
v_fma_f32 v180, v198, v181, -v182
v_cvt_pk_bf16_f32 v16, v180, v181
v_cvt_pk_bf16_f32 v17, v182, v183
v_cvt_pk_bf16_f32 v18, v184, v185
v_cvt_pk_bf16_f32 v19, v186, v187
v_mad_u32_u24 v191, v200, 19, v201
v_cvt_f32_u32 v191, v191
v_mul_f32 v202, s19, v191
v_rndne_f32 v202, v202
v_fmac_f32 v191, 0xc4200000, v202
v_mul_f32 v191, s19, v191
v_cos_f32 v191, v191
v_mad_u32_u24 v192, v200, 20, v201
v_cvt_f32_u32 v192, v192
v_mul_f32 v202, s19, v192
v_rndne_f32 v202, v202
v_fmac_f32 v192, 0xc4200000, v202
v_mul_f32 v192, s19, v192
v_cos_f32 v192, v192
s_nop 0
v_fma_f32 v193, v198, v192, -v191
v_fma_f32 v190, v198, v191, -v192
v_fma_f32 v194, v198, v193, -v192
v_fma_f32 v189, v198, v190, -v191
v_fma_f32 v195, v198, v194, -v193
v_fma_f32 v188, v198, v189, -v190
v_cvt_pk_bf16_f32 v20, v188, v189
v_cvt_pk_bf16_f32 v21, v190, v191
v_cvt_pk_bf16_f32 v22, v192, v193
v_cvt_pk_bf16_f32 v23, v194, v195
v_pk_fma_f32 v[180:181], v[196:197], v[188:189], v[180:181] op_sel_hi:[0,1,1] neg_lo:[0,0,1] neg_hi:[0,0,1]
v_pk_fma_f32 v[182:183], v[196:197], v[190:191], v[182:183] op_sel_hi:[0,1,1] neg_lo:[0,0,1] neg_hi:[0,0,1]
v_pk_fma_f32 v[184:185], v[196:197], v[192:193], v[184:185] op_sel_hi:[0,1,1] neg_lo:[0,0,1] neg_hi:[0,0,1]
v_pk_fma_f32 v[186:187], v[196:197], v[194:195], v[186:187] op_sel_hi:[0,1,1] neg_lo:[0,0,1] neg_hi:[0,0,1]
v_cvt_pk_bf16_f32 v24, v180, v181
v_cvt_pk_bf16_f32 v25, v182, v183
v_cvt_pk_bf16_f32 v26, v184, v185
v_cvt_pk_bf16_f32 v27, v186, v187
s_add_u32 m0, s25, 2048
s_add_u32 s21, s26, 0
buffer_load_dwordx4 v8, s[44:47], s21 offen lds
v_pk_fma_f32 v[188:189], v[196:197], v[180:181], v[188:189] op_sel_hi:[0,1,1] neg_lo:[0,0,1] neg_hi:[0,0,1]
v_pk_fma_f32 v[190:191], v[196:197], v[182:183], v[190:191] op_sel_hi:[0,1,1] neg_lo:[0,0,1] neg_hi:[0,0,1]
v_pk_fma_f32 v[192:193], v[196:197], v[184:185], v[192:193] op_sel_hi:[0,1,1] neg_lo:[0,0,1] neg_hi:[0,0,1]
v_pk_fma_f32 v[194:195], v[196:197], v[186:187], v[194:195] op_sel_hi:[0,1,1] neg_lo:[0,0,1] neg_hi:[0,0,1]
v_cvt_pk_bf16_f32 v28, v188, v189
v_cvt_pk_bf16_f32 v29, v190, v191
v_cvt_pk_bf16_f32 v30, v192, v193
v_cvt_pk_bf16_f32 v31, v194, v195
s_add_u32 m0, s25, 6144
s_add_u32 s21, s26, 128
buffer_load_dwordx4 v8, s[44:47], s21 offen lds
v_pk_fma_f32 v[180:181], v[196:197], v[188:189], v[180:181] op_sel_hi:[0,1,1] neg_lo:[0,0,1] neg_hi:[0,0,1]
v_pk_fma_f32 v[182:183], v[196:197], v[190:191], v[182:183] op_sel_hi:[0,1,1] neg_lo:[0,0,1] neg_hi:[0,0,1]
v_pk_fma_f32 v[184:185], v[196:197], v[192:193], v[184:185] op_sel_hi:[0,1,1] neg_lo:[0,0,1] neg_hi:[0,0,1]
v_pk_fma_f32 v[186:187], v[196:197], v[194:195], v[186:187] op_sel_hi:[0,1,1] neg_lo:[0,0,1] neg_hi:[0,0,1]
v_cvt_pk_bf16_f32 v32, v180, v181
v_cvt_pk_bf16_f32 v33, v182, v183
v_cvt_pk_bf16_f32 v34, v184, v185
v_cvt_pk_bf16_f32 v35, v186, v187
s_add_u32 m0, s25, 10240
s_add_u32 s21, s26, 256
buffer_load_dwordx4 v8, s[44:47], s21 offen lds
v_pk_fma_f32 v[188:189], v[196:197], v[180:181], v[188:189] op_sel_hi:[0,1,1] neg_lo:[0,0,1] neg_hi:[0,0,1]
v_pk_fma_f32 v[190:191], v[196:197], v[182:183], v[190:191] op_sel_hi:[0,1,1] neg_lo:[0,0,1] neg_hi:[0,0,1]
v_pk_fma_f32 v[192:193], v[196:197], v[184:185], v[192:193] op_sel_hi:[0,1,1] neg_lo:[0,0,1] neg_hi:[0,0,1]
v_pk_fma_f32 v[194:195], v[196:197], v[186:187], v[194:195] op_sel_hi:[0,1,1] neg_lo:[0,0,1] neg_hi:[0,0,1]
v_cvt_pk_bf16_f32 v36, v188, v189
v_cvt_pk_bf16_f32 v37, v190, v191
v_cvt_pk_bf16_f32 v38, v192, v193
v_cvt_pk_bf16_f32 v39, v194, v195
s_add_u32 m0, s25, 14336
s_add_u32 s21, s26, 384
buffer_load_dwordx4 v8, s[44:47], s21 offen lds
v_pk_fma_f32 v[180:181], v[196:197], v[188:189], v[180:181] op_sel_hi:[0,1,1] neg_lo:[0,0,1] neg_hi:[0,0,1]
v_pk_fma_f32 v[182:183], v[196:197], v[190:191], v[182:183] op_sel_hi:[0,1,1] neg_lo:[0,0,1] neg_hi:[0,0,1]
v_pk_fma_f32 v[184:185], v[196:197], v[192:193], v[184:185] op_sel_hi:[0,1,1] neg_lo:[0,0,1] neg_hi:[0,0,1]
v_pk_fma_f32 v[186:187], v[196:197], v[194:195], v[186:187] op_sel_hi:[0,1,1] neg_lo:[0,0,1] neg_hi:[0,0,1]
v_cvt_pk_bf16_f32 v40, v180, v181
v_cvt_pk_bf16_f32 v41, v182, v183
v_cvt_pk_bf16_f32 v42, v184, v185
v_cvt_pk_bf16_f32 v43, v186, v187
s_add_u32 m0, s25, 18432
s_add_u32 s21, s26, 512
buffer_load_dwordx4 v8, s[44:47], s21 offen lds
v_pk_fma_f32 v[188:189], v[196:197], v[180:181], v[188:189] op_sel_hi:[0,1,1] neg_lo:[0,0,1] neg_hi:[0,0,1]
v_pk_fma_f32 v[190:191], v[196:197], v[182:183], v[190:191] op_sel_hi:[0,1,1] neg_lo:[0,0,1] neg_hi:[0,0,1]
v_pk_fma_f32 v[192:193], v[196:197], v[184:185], v[192:193] op_sel_hi:[0,1,1] neg_lo:[0,0,1] neg_hi:[0,0,1]
v_pk_fma_f32 v[194:195], v[196:197], v[186:187], v[194:195] op_sel_hi:[0,1,1] neg_lo:[0,0,1] neg_hi:[0,0,1]
v_cvt_pk_bf16_f32 v44, v188, v189
v_cvt_pk_bf16_f32 v45, v190, v191
v_cvt_pk_bf16_f32 v46, v192, v193
v_cvt_pk_bf16_f32 v47, v194, v195
s_add_u32 m0, s25, 22528
s_add_u32 s21, s26, 640
buffer_load_dwordx4 v8, s[44:47], s21 offen lds
v_pk_fma_f32 v[180:181], v[196:197], v[188:189], v[180:181] op_sel_hi:[0,1,1] neg_lo:[0,0,1] neg_hi:[0,0,1]
v_pk_fma_f32 v[182:183], v[196:197], v[190:191], v[182:183] op_sel_hi:[0,1,1] neg_lo:[0,0,1] neg_hi:[0,0,1]
v_pk_fma_f32 v[184:185], v[196:197], v[192:193], v[184:185] op_sel_hi:[0,1,1] neg_lo:[0,0,1] neg_hi:[0,0,1]
v_pk_fma_f32 v[186:187], v[196:197], v[194:195], v[186:187] op_sel_hi:[0,1,1] neg_lo:[0,0,1] neg_hi:[0,0,1]
v_cvt_pk_bf16_f32 v48, v180, v181
v_cvt_pk_bf16_f32 v49, v182, v183
v_cvt_pk_bf16_f32 v50, v184, v185
v_cvt_pk_bf16_f32 v51, v186, v187
s_add_u32 m0, s25, 26624
s_add_u32 s21, s26, 768
buffer_load_dwordx4 v8, s[44:47], s21 offen lds
v_pk_fma_f32 v[188:189], v[196:197], v[180:181], v[188:189] op_sel_hi:[0,1,1] neg_lo:[0,0,1] neg_hi:[0,0,1]
v_pk_fma_f32 v[190:191], v[196:197], v[182:183], v[190:191] op_sel_hi:[0,1,1] neg_lo:[0,0,1] neg_hi:[0,0,1]
v_pk_fma_f32 v[192:193], v[196:197], v[184:185], v[192:193] op_sel_hi:[0,1,1] neg_lo:[0,0,1] neg_hi:[0,0,1]
v_pk_fma_f32 v[194:195], v[196:197], v[186:187], v[194:195] op_sel_hi:[0,1,1] neg_lo:[0,0,1] neg_hi:[0,0,1]
v_cvt_pk_bf16_f32 v52, v188, v189
v_cvt_pk_bf16_f32 v53, v190, v191
v_cvt_pk_bf16_f32 v54, v192, v193
v_cvt_pk_bf16_f32 v55, v194, v195
s_add_u32 m0, s25, 30720
s_add_u32 s21, s26, 896
buffer_load_dwordx4 v8, s[44:47], s21 offen lds
v_pk_fma_f32 v[180:181], v[196:197], v[188:189], v[180:181] op_sel_hi:[0,1,1] neg_lo:[0,0,1] neg_hi:[0,0,1]
v_pk_fma_f32 v[182:183], v[196:197], v[190:191], v[182:183] op_sel_hi:[0,1,1] neg_lo:[0,0,1] neg_hi:[0,0,1]
v_pk_fma_f32 v[184:185], v[196:197], v[192:193], v[184:185] op_sel_hi:[0,1,1] neg_lo:[0,0,1] neg_hi:[0,0,1]
v_pk_fma_f32 v[186:187], v[196:197], v[194:195], v[186:187] op_sel_hi:[0,1,1] neg_lo:[0,0,1] neg_hi:[0,0,1]
v_cvt_pk_bf16_f32 v56, v180, v181
v_cvt_pk_bf16_f32 v57, v182, v183
v_cvt_pk_bf16_f32 v58, v184, v185
v_cvt_pk_bf16_f32 v59, v186, v187
s_add_u32 m0, s25, 34816
s_add_u32 s21, s26, 1024
buffer_load_dwordx4 v8, s[44:47], s21 offen lds
v_pk_fma_f32 v[188:189], v[196:197], v[180:181], v[188:189] op_sel_hi:[0,1,1] neg_lo:[0,0,1] neg_hi:[0,0,1]
v_pk_fma_f32 v[190:191], v[196:197], v[182:183], v[190:191] op_sel_hi:[0,1,1] neg_lo:[0,0,1] neg_hi:[0,0,1]
v_pk_fma_f32 v[192:193], v[196:197], v[184:185], v[192:193] op_sel_hi:[0,1,1] neg_lo:[0,0,1] neg_hi:[0,0,1]
v_pk_fma_f32 v[194:195], v[196:197], v[186:187], v[194:195] op_sel_hi:[0,1,1] neg_lo:[0,0,1] neg_hi:[0,0,1]
v_cvt_pk_bf16_f32 v60, v188, v189
v_cvt_pk_bf16_f32 v61, v190, v191
v_cvt_pk_bf16_f32 v62, v192, v193
v_cvt_pk_bf16_f32 v63, v194, v195
s_add_u32 m0, s25, 38912
s_add_u32 s21, s26, 1152
buffer_load_dwordx4 v8, s[44:47], s21 offen lds
v_pk_fma_f32 v[180:181], v[196:197], v[188:189], v[180:181] op_sel_hi:[0,1,1] neg_lo:[0,0,1] neg_hi:[0,0,1]
v_pk_fma_f32 v[182:183], v[196:197], v[190:191], v[182:183] op_sel_hi:[0,1,1] neg_lo:[0,0,1] neg_hi:[0,0,1]
v_pk_fma_f32 v[184:185], v[196:197], v[192:193], v[184:185] op_sel_hi:[0,1,1] neg_lo:[0,0,1] neg_hi:[0,0,1]
v_pk_fma_f32 v[186:187], v[196:197], v[194:195], v[186:187] op_sel_hi:[0,1,1] neg_lo:[0,0,1] neg_hi:[0,0,1]
v_cvt_pk_bf16_f32 v64, v180, v181
v_cvt_pk_bf16_f32 v65, v182, v183
v_cvt_pk_bf16_f32 v66, v184, v185
v_cvt_pk_bf16_f32 v67, v186, v187
v_pk_fma_f32 v[188:189], v[196:197], v[180:181], v[188:189] op_sel_hi:[0,1,1] neg_lo:[0,0,1] neg_hi:[0,0,1]
v_pk_fma_f32 v[190:191], v[196:197], v[182:183], v[190:191] op_sel_hi:[0,1,1] neg_lo:[0,0,1] neg_hi:[0,0,1]
v_pk_fma_f32 v[192:193], v[196:197], v[184:185], v[192:193] op_sel_hi:[0,1,1] neg_lo:[0,0,1] neg_hi:[0,0,1]
v_pk_fma_f32 v[194:195], v[196:197], v[186:187], v[194:195] op_sel_hi:[0,1,1] neg_lo:[0,0,1] neg_hi:[0,0,1]
v_cvt_pk_bf16_f32 v68, v188, v189
v_cvt_pk_bf16_f32 v69, v190, v191
v_cvt_pk_bf16_f32 v70, v192, v193
v_cvt_pk_bf16_f32 v71, v194, v195
v_pk_fma_f32 v[180:181], v[196:197], v[188:189], v[180:181] op_sel_hi:[0,1,1] neg_lo:[0,0,1] neg_hi:[0,0,1]
v_pk_fma_f32 v[182:183], v[196:197], v[190:191], v[182:183] op_sel_hi:[0,1,1] neg_lo:[0,0,1] neg_hi:[0,0,1]
v_pk_fma_f32 v[184:185], v[196:197], v[192:193], v[184:185] op_sel_hi:[0,1,1] neg_lo:[0,0,1] neg_hi:[0,0,1]
v_pk_fma_f32 v[186:187], v[196:197], v[194:195], v[186:187] op_sel_hi:[0,1,1] neg_lo:[0,0,1] neg_hi:[0,0,1]
v_cvt_pk_bf16_f32 v72, v180, v181
v_cvt_pk_bf16_f32 v73, v182, v183
v_cvt_pk_bf16_f32 v74, v184, v185
v_cvt_pk_bf16_f32 v75, v186, v187
v_pk_fma_f32 v[188:189], v[196:197], v[180:181], v[188:189] op_sel_hi:[0,1,1] neg_lo:[0,0,1] neg_hi:[0,0,1]
v_pk_fma_f32 v[190:191], v[196:197], v[182:183], v[190:191] op_sel_hi:[0,1,1] neg_lo:[0,0,1] neg_hi:[0,0,1]
v_pk_fma_f32 v[192:193], v[196:197], v[184:185], v[192:193] op_sel_hi:[0,1,1] neg_lo:[0,0,1] neg_hi:[0,0,1]
v_pk_fma_f32 v[194:195], v[196:197], v[186:187], v[194:195] op_sel_hi:[0,1,1] neg_lo:[0,0,1] neg_hi:[0,0,1]
v_cvt_pk_bf16_f32 v76, v188, v189
v_cvt_pk_bf16_f32 v77, v190, v191
v_cvt_pk_bf16_f32 v78, v192, v193
v_cvt_pk_bf16_f32 v79, v194, v195
v_pk_fma_f32 v[180:181], v[196:197], v[188:189], v[180:181] op_sel_hi:[0,1,1] neg_lo:[0,0,1] neg_hi:[0,0,1]
v_pk_fma_f32 v[182:183], v[196:197], v[190:191], v[182:183] op_sel_hi:[0,1,1] neg_lo:[0,0,1] neg_hi:[0,0,1]
v_pk_fma_f32 v[184:185], v[196:197], v[192:193], v[184:185] op_sel_hi:[0,1,1] neg_lo:[0,0,1] neg_hi:[0,0,1]
v_pk_fma_f32 v[186:187], v[196:197], v[194:195], v[186:187] op_sel_hi:[0,1,1] neg_lo:[0,0,1] neg_hi:[0,0,1]
v_cvt_pk_bf16_f32 v80, v180, v181
v_cvt_pk_bf16_f32 v81, v182, v183
v_cvt_pk_bf16_f32 v82, v184, v185
v_cvt_pk_bf16_f32 v83, v186, v187
v_pk_fma_f32 v[188:189], v[196:197], v[180:181], v[188:189] op_sel_hi:[0,1,1] neg_lo:[0,0,1] neg_hi:[0,0,1]
v_pk_fma_f32 v[190:191], v[196:197], v[182:183], v[190:191] op_sel_hi:[0,1,1] neg_lo:[0,0,1] neg_hi:[0,0,1]
v_pk_fma_f32 v[192:193], v[196:197], v[184:185], v[192:193] op_sel_hi:[0,1,1] neg_lo:[0,0,1] neg_hi:[0,0,1]
v_pk_fma_f32 v[194:195], v[196:197], v[186:187], v[194:195] op_sel_hi:[0,1,1] neg_lo:[0,0,1] neg_hi:[0,0,1]
v_cvt_pk_bf16_f32 v84, v188, v189
v_cvt_pk_bf16_f32 v85, v190, v191
v_cvt_pk_bf16_f32 v86, v192, v193
v_cvt_pk_bf16_f32 v87, v194, v195
v_pk_fma_f32 v[180:181], v[196:197], v[188:189], v[180:181] op_sel_hi:[0,1,1] neg_lo:[0,0,1] neg_hi:[0,0,1]
v_pk_fma_f32 v[182:183], v[196:197], v[190:191], v[182:183] op_sel_hi:[0,1,1] neg_lo:[0,0,1] neg_hi:[0,0,1]
v_pk_fma_f32 v[184:185], v[196:197], v[192:193], v[184:185] op_sel_hi:[0,1,1] neg_lo:[0,0,1] neg_hi:[0,0,1]
v_pk_fma_f32 v[186:187], v[196:197], v[194:195], v[186:187] op_sel_hi:[0,1,1] neg_lo:[0,0,1] neg_hi:[0,0,1]
v_cvt_pk_bf16_f32 v88, v180, v181
v_cvt_pk_bf16_f32 v89, v182, v183
v_cvt_pk_bf16_f32 v90, v184, v185
v_cvt_pk_bf16_f32 v91, v186, v187
v_pk_fma_f32 v[188:189], v[196:197], v[180:181], v[188:189] op_sel_hi:[0,1,1] neg_lo:[0,0,1] neg_hi:[0,0,1]
v_pk_fma_f32 v[190:191], v[196:197], v[182:183], v[190:191] op_sel_hi:[0,1,1] neg_lo:[0,0,1] neg_hi:[0,0,1]
v_pk_fma_f32 v[192:193], v[196:197], v[184:185], v[192:193] op_sel_hi:[0,1,1] neg_lo:[0,0,1] neg_hi:[0,0,1]
v_pk_fma_f32 v[194:195], v[196:197], v[186:187], v[194:195] op_sel_hi:[0,1,1] neg_lo:[0,0,1] neg_hi:[0,0,1]
v_cvt_pk_bf16_f32 v92, v188, v189
v_cvt_pk_bf16_f32 v93, v190, v191
v_cvt_pk_bf16_f32 v94, v192, v193
v_cvt_pk_bf16_f32 v95, v194, v195
s_mov_b32 s20, 323
v_mad_u32_u24 v183, v200, s20, v201
v_cvt_f32_u32 v183, v183
v_mul_f32 v202, s19, v183
v_rndne_f32 v202, v202
v_fmac_f32 v183, 0xc4200000, v202
v_mul_f32 v183, s19, v183
v_cos_f32 v183, v183
s_mov_b32 s20, 324
v_mad_u32_u24 v184, v200, s20, v201
v_cvt_f32_u32 v184, v184
v_mul_f32 v202, s19, v184
v_rndne_f32 v202, v202
v_fmac_f32 v184, 0xc4200000, v202
v_mul_f32 v184, s19, v184
v_cos_f32 v184, v184
s_nop 0
v_fma_f32 v185, v198, v184, -v183
v_fma_f32 v182, v198, v183, -v184
v_fma_f32 v186, v198, v185, -v184
v_fma_f32 v181, v198, v182, -v183
v_fma_f32 v187, v198, v186, -v185
v_fma_f32 v180, v198, v181, -v182
v_cvt_pk_bf16_f32 v96, v180, v181
v_cvt_pk_bf16_f32 v97, v182, v183
v_cvt_pk_bf16_f32 v98, v184, v185
v_cvt_pk_bf16_f32 v99, v186, v187
s_mov_b32 s20, 339
v_mad_u32_u24 v191, v200, s20, v201
v_cvt_f32_u32 v191, v191
v_mul_f32 v202, s19, v191
v_rndne_f32 v202, v202
v_fmac_f32 v191, 0xc4200000, v202
v_mul_f32 v191, s19, v191
v_cos_f32 v191, v191
s_mov_b32 s20, 340
v_mad_u32_u24 v192, v200, s20, v201
v_cvt_f32_u32 v192, v192
v_mul_f32 v202, s19, v192
v_rndne_f32 v202, v202
v_fmac_f32 v192, 0xc4200000, v202
v_mul_f32 v192, s19, v192
v_cos_f32 v192, v192
s_nop 0
v_fma_f32 v193, v198, v192, -v191
v_fma_f32 v190, v198, v191, -v192
v_fma_f32 v194, v198, v193, -v192
v_fma_f32 v189, v198, v190, -v191
v_fma_f32 v195, v198, v194, -v193
v_fma_f32 v188, v198, v189, -v190
v_cvt_pk_bf16_f32 v100, v188, v189
v_cvt_pk_bf16_f32 v101, v190, v191
v_cvt_pk_bf16_f32 v102, v192, v193
v_cvt_pk_bf16_f32 v103, v194, v195
v_pk_fma_f32 v[180:181], v[196:197], v[188:189], v[180:181] op_sel_hi:[0,1,1] neg_lo:[0,0,1] neg_hi:[0,0,1]
v_pk_fma_f32 v[182:183], v[196:197], v[190:191], v[182:183] op_sel_hi:[0,1,1] neg_lo:[0,0,1] neg_hi:[0,0,1]
v_pk_fma_f32 v[184:185], v[196:197], v[192:193], v[184:185] op_sel_hi:[0,1,1] neg_lo:[0,0,1] neg_hi:[0,0,1]
v_pk_fma_f32 v[186:187], v[196:197], v[194:195], v[186:187] op_sel_hi:[0,1,1] neg_lo:[0,0,1] neg_hi:[0,0,1]
v_cvt_pk_bf16_f32 v104, v180, v181
v_cvt_pk_bf16_f32 v105, v182, v183
v_cvt_pk_bf16_f32 v106, v184, v185
v_cvt_pk_bf16_f32 v107, v186, v187
v_pk_fma_f32 v[188:189], v[196:197], v[180:181], v[188:189] op_sel_hi:[0,1,1] neg_lo:[0,0,1] neg_hi:[0,0,1]
v_pk_fma_f32 v[190:191], v[196:197], v[182:183], v[190:191] op_sel_hi:[0,1,1] neg_lo:[0,0,1] neg_hi:[0,0,1]
v_pk_fma_f32 v[192:193], v[196:197], v[184:185], v[192:193] op_sel_hi:[0,1,1] neg_lo:[0,0,1] neg_hi:[0,0,1]
v_pk_fma_f32 v[194:195], v[196:197], v[186:187], v[194:195] op_sel_hi:[0,1,1] neg_lo:[0,0,1] neg_hi:[0,0,1]
v_cvt_pk_bf16_f32 v108, v188, v189
v_cvt_pk_bf16_f32 v109, v190, v191
v_cvt_pk_bf16_f32 v110, v192, v193
v_cvt_pk_bf16_f32 v111, v194, v195
v_pk_fma_f32 v[180:181], v[196:197], v[188:189], v[180:181] op_sel_hi:[0,1,1] neg_lo:[0,0,1] neg_hi:[0,0,1]
v_pk_fma_f32 v[182:183], v[196:197], v[190:191], v[182:183] op_sel_hi:[0,1,1] neg_lo:[0,0,1] neg_hi:[0,0,1]
v_pk_fma_f32 v[184:185], v[196:197], v[192:193], v[184:185] op_sel_hi:[0,1,1] neg_lo:[0,0,1] neg_hi:[0,0,1]
v_pk_fma_f32 v[186:187], v[196:197], v[194:195], v[186:187] op_sel_hi:[0,1,1] neg_lo:[0,0,1] neg_hi:[0,0,1]
v_cvt_pk_bf16_f32 v112, v180, v181
v_cvt_pk_bf16_f32 v113, v182, v183
v_cvt_pk_bf16_f32 v114, v184, v185
v_cvt_pk_bf16_f32 v115, v186, v187
v_pk_fma_f32 v[188:189], v[196:197], v[180:181], v[188:189] op_sel_hi:[0,1,1] neg_lo:[0,0,1] neg_hi:[0,0,1]
v_pk_fma_f32 v[190:191], v[196:197], v[182:183], v[190:191] op_sel_hi:[0,1,1] neg_lo:[0,0,1] neg_hi:[0,0,1]
v_pk_fma_f32 v[192:193], v[196:197], v[184:185], v[192:193] op_sel_hi:[0,1,1] neg_lo:[0,0,1] neg_hi:[0,0,1]
v_pk_fma_f32 v[194:195], v[196:197], v[186:187], v[194:195] op_sel_hi:[0,1,1] neg_lo:[0,0,1] neg_hi:[0,0,1]
v_cvt_pk_bf16_f32 v116, v188, v189
v_cvt_pk_bf16_f32 v117, v190, v191
v_cvt_pk_bf16_f32 v118, v192, v193
v_cvt_pk_bf16_f32 v119, v194, v195
v_pk_fma_f32 v[180:181], v[196:197], v[188:189], v[180:181] op_sel_hi:[0,1,1] neg_lo:[0,0,1] neg_hi:[0,0,1]
v_pk_fma_f32 v[182:183], v[196:197], v[190:191], v[182:183] op_sel_hi:[0,1,1] neg_lo:[0,0,1] neg_hi:[0,0,1]
v_pk_fma_f32 v[184:185], v[196:197], v[192:193], v[184:185] op_sel_hi:[0,1,1] neg_lo:[0,0,1] neg_hi:[0,0,1]
v_pk_fma_f32 v[186:187], v[196:197], v[194:195], v[186:187] op_sel_hi:[0,1,1] neg_lo:[0,0,1] neg_hi:[0,0,1]
v_cvt_pk_bf16_f32 v120, v180, v181
v_cvt_pk_bf16_f32 v121, v182, v183
v_cvt_pk_bf16_f32 v122, v184, v185
v_cvt_pk_bf16_f32 v123, v186, v187
v_pk_fma_f32 v[188:189], v[196:197], v[180:181], v[188:189] op_sel_hi:[0,1,1] neg_lo:[0,0,1] neg_hi:[0,0,1]
v_pk_fma_f32 v[190:191], v[196:197], v[182:183], v[190:191] op_sel_hi:[0,1,1] neg_lo:[0,0,1] neg_hi:[0,0,1]
v_pk_fma_f32 v[192:193], v[196:197], v[184:185], v[192:193] op_sel_hi:[0,1,1] neg_lo:[0,0,1] neg_hi:[0,0,1]
v_pk_fma_f32 v[194:195], v[196:197], v[186:187], v[194:195] op_sel_hi:[0,1,1] neg_lo:[0,0,1] neg_hi:[0,0,1]
v_cvt_pk_bf16_f32 v124, v188, v189
v_cvt_pk_bf16_f32 v125, v190, v191
v_cvt_pk_bf16_f32 v126, v192, v193
v_cvt_pk_bf16_f32 v127, v194, v195
v_pk_fma_f32 v[180:181], v[196:197], v[188:189], v[180:181] op_sel_hi:[0,1,1] neg_lo:[0,0,1] neg_hi:[0,0,1]
v_pk_fma_f32 v[182:183], v[196:197], v[190:191], v[182:183] op_sel_hi:[0,1,1] neg_lo:[0,0,1] neg_hi:[0,0,1]
v_pk_fma_f32 v[184:185], v[196:197], v[192:193], v[184:185] op_sel_hi:[0,1,1] neg_lo:[0,0,1] neg_hi:[0,0,1]
v_pk_fma_f32 v[186:187], v[196:197], v[194:195], v[186:187] op_sel_hi:[0,1,1] neg_lo:[0,0,1] neg_hi:[0,0,1]
v_cvt_pk_bf16_f32 v128, v180, v181
v_cvt_pk_bf16_f32 v129, v182, v183
v_cvt_pk_bf16_f32 v130, v184, v185
v_cvt_pk_bf16_f32 v131, v186, v187
v_pk_fma_f32 v[188:189], v[196:197], v[180:181], v[188:189] op_sel_hi:[0,1,1] neg_lo:[0,0,1] neg_hi:[0,0,1]
v_pk_fma_f32 v[190:191], v[196:197], v[182:183], v[190:191] op_sel_hi:[0,1,1] neg_lo:[0,0,1] neg_hi:[0,0,1]
v_pk_fma_f32 v[192:193], v[196:197], v[184:185], v[192:193] op_sel_hi:[0,1,1] neg_lo:[0,0,1] neg_hi:[0,0,1]
v_pk_fma_f32 v[194:195], v[196:197], v[186:187], v[194:195] op_sel_hi:[0,1,1] neg_lo:[0,0,1] neg_hi:[0,0,1]
v_cvt_pk_bf16_f32 v132, v188, v189
v_cvt_pk_bf16_f32 v133, v190, v191
v_cvt_pk_bf16_f32 v134, v192, v193
v_cvt_pk_bf16_f32 v135, v194, v195
v_pk_fma_f32 v[180:181], v[196:197], v[188:189], v[180:181] op_sel_hi:[0,1,1] neg_lo:[0,0,1] neg_hi:[0,0,1]
v_pk_fma_f32 v[182:183], v[196:197], v[190:191], v[182:183] op_sel_hi:[0,1,1] neg_lo:[0,0,1] neg_hi:[0,0,1]
v_pk_fma_f32 v[184:185], v[196:197], v[192:193], v[184:185] op_sel_hi:[0,1,1] neg_lo:[0,0,1] neg_hi:[0,0,1]
v_pk_fma_f32 v[186:187], v[196:197], v[194:195], v[186:187] op_sel_hi:[0,1,1] neg_lo:[0,0,1] neg_hi:[0,0,1]
v_cvt_pk_bf16_f32 v136, v180, v181
v_cvt_pk_bf16_f32 v137, v182, v183
v_cvt_pk_bf16_f32 v138, v184, v185
v_cvt_pk_bf16_f32 v139, v186, v187
v_pk_fma_f32 v[188:189], v[196:197], v[180:181], v[188:189] op_sel_hi:[0,1,1] neg_lo:[0,0,1] neg_hi:[0,0,1]
v_pk_fma_f32 v[190:191], v[196:197], v[182:183], v[190:191] op_sel_hi:[0,1,1] neg_lo:[0,0,1] neg_hi:[0,0,1]
v_pk_fma_f32 v[192:193], v[196:197], v[184:185], v[192:193] op_sel_hi:[0,1,1] neg_lo:[0,0,1] neg_hi:[0,0,1]
v_pk_fma_f32 v[194:195], v[196:197], v[186:187], v[194:195] op_sel_hi:[0,1,1] neg_lo:[0,0,1] neg_hi:[0,0,1]
v_cvt_pk_bf16_f32 v140, v188, v189
v_cvt_pk_bf16_f32 v141, v190, v191
v_cvt_pk_bf16_f32 v142, v192, v193
v_cvt_pk_bf16_f32 v143, v194, v195
v_pk_fma_f32 v[180:181], v[196:197], v[188:189], v[180:181] op_sel_hi:[0,1,1] neg_lo:[0,0,1] neg_hi:[0,0,1]
v_pk_fma_f32 v[182:183], v[196:197], v[190:191], v[182:183] op_sel_hi:[0,1,1] neg_lo:[0,0,1] neg_hi:[0,0,1]
v_pk_fma_f32 v[184:185], v[196:197], v[192:193], v[184:185] op_sel_hi:[0,1,1] neg_lo:[0,0,1] neg_hi:[0,0,1]
v_pk_fma_f32 v[186:187], v[196:197], v[194:195], v[186:187] op_sel_hi:[0,1,1] neg_lo:[0,0,1] neg_hi:[0,0,1]
v_cvt_pk_bf16_f32 v144, v180, v181
v_cvt_pk_bf16_f32 v145, v182, v183
v_cvt_pk_bf16_f32 v146, v184, v185
v_cvt_pk_bf16_f32 v147, v186, v187
v_pk_fma_f32 v[188:189], v[196:197], v[180:181], v[188:189] op_sel_hi:[0,1,1] neg_lo:[0,0,1] neg_hi:[0,0,1]
v_pk_fma_f32 v[190:191], v[196:197], v[182:183], v[190:191] op_sel_hi:[0,1,1] neg_lo:[0,0,1] neg_hi:[0,0,1]
v_pk_fma_f32 v[192:193], v[196:197], v[184:185], v[192:193] op_sel_hi:[0,1,1] neg_lo:[0,0,1] neg_hi:[0,0,1]
v_pk_fma_f32 v[194:195], v[196:197], v[186:187], v[194:195] op_sel_hi:[0,1,1] neg_lo:[0,0,1] neg_hi:[0,0,1]
v_cvt_pk_bf16_f32 v148, v188, v189
v_cvt_pk_bf16_f32 v149, v190, v191
v_cvt_pk_bf16_f32 v150, v192, v193
v_cvt_pk_bf16_f32 v151, v194, v195
v_pk_fma_f32 v[180:181], v[196:197], v[188:189], v[180:181] op_sel_hi:[0,1,1] neg_lo:[0,0,1] neg_hi:[0,0,1]
v_pk_fma_f32 v[182:183], v[196:197], v[190:191], v[182:183] op_sel_hi:[0,1,1] neg_lo:[0,0,1] neg_hi:[0,0,1]
v_pk_fma_f32 v[184:185], v[196:197], v[192:193], v[184:185] op_sel_hi:[0,1,1] neg_lo:[0,0,1] neg_hi:[0,0,1]
v_pk_fma_f32 v[186:187], v[196:197], v[194:195], v[186:187] op_sel_hi:[0,1,1] neg_lo:[0,0,1] neg_hi:[0,0,1]
v_cvt_pk_bf16_f32 v152, v180, v181
v_cvt_pk_bf16_f32 v153, v182, v183
v_cvt_pk_bf16_f32 v154, v184, v185
v_cvt_pk_bf16_f32 v155, v186, v187
v_pk_fma_f32 v[188:189], v[196:197], v[180:181], v[188:189] op_sel_hi:[0,1,1] neg_lo:[0,0,1] neg_hi:[0,0,1]
v_pk_fma_f32 v[190:191], v[196:197], v[182:183], v[190:191] op_sel_hi:[0,1,1] neg_lo:[0,0,1] neg_hi:[0,0,1]
v_pk_fma_f32 v[192:193], v[196:197], v[184:185], v[192:193] op_sel_hi:[0,1,1] neg_lo:[0,0,1] neg_hi:[0,0,1]
v_pk_fma_f32 v[194:195], v[196:197], v[186:187], v[194:195] op_sel_hi:[0,1,1] neg_lo:[0,0,1] neg_hi:[0,0,1]
v_cvt_pk_bf16_f32 v156, v188, v189
v_cvt_pk_bf16_f32 v157, v190, v191
v_cvt_pk_bf16_f32 v158, v192, v193
v_cvt_pk_bf16_f32 v159, v194, v195
v_pk_fma_f32 v[180:181], v[196:197], v[188:189], v[180:181] op_sel_hi:[0,1,1] neg_lo:[0,0,1] neg_hi:[0,0,1]
v_pk_fma_f32 v[182:183], v[196:197], v[190:191], v[182:183] op_sel_hi:[0,1,1] neg_lo:[0,0,1] neg_hi:[0,0,1]
v_pk_fma_f32 v[184:185], v[196:197], v[192:193], v[184:185] op_sel_hi:[0,1,1] neg_lo:[0,0,1] neg_hi:[0,0,1]
v_pk_fma_f32 v[186:187], v[196:197], v[194:195], v[186:187] op_sel_hi:[0,1,1] neg_lo:[0,0,1] neg_hi:[0,0,1]
v_cvt_pk_bf16_f32 v160, v180, v181
v_cvt_pk_bf16_f32 v161, v182, v183
v_cvt_pk_bf16_f32 v162, v184, v185
v_cvt_pk_bf16_f32 v163, v186, v187
v_pk_fma_f32 v[188:189], v[196:197], v[180:181], v[188:189] op_sel_hi:[0,1,1] neg_lo:[0,0,1] neg_hi:[0,0,1]
v_pk_fma_f32 v[190:191], v[196:197], v[182:183], v[190:191] op_sel_hi:[0,1,1] neg_lo:[0,0,1] neg_hi:[0,0,1]
v_pk_fma_f32 v[192:193], v[196:197], v[184:185], v[192:193] op_sel_hi:[0,1,1] neg_lo:[0,0,1] neg_hi:[0,0,1]
v_pk_fma_f32 v[194:195], v[196:197], v[186:187], v[194:195] op_sel_hi:[0,1,1] neg_lo:[0,0,1] neg_hi:[0,0,1]
v_cvt_pk_bf16_f32 v164, v188, v189
v_cvt_pk_bf16_f32 v165, v190, v191
v_cvt_pk_bf16_f32 v166, v192, v193
v_cvt_pk_bf16_f32 v167, v194, v195
v_pk_fma_f32 v[180:181], v[196:197], v[188:189], v[180:181] op_sel_hi:[0,1,1] neg_lo:[0,0,1] neg_hi:[0,0,1]
v_pk_fma_f32 v[182:183], v[196:197], v[190:191], v[182:183] op_sel_hi:[0,1,1] neg_lo:[0,0,1] neg_hi:[0,0,1]
v_pk_fma_f32 v[184:185], v[196:197], v[192:193], v[184:185] op_sel_hi:[0,1,1] neg_lo:[0,0,1] neg_hi:[0,0,1]
v_pk_fma_f32 v[186:187], v[196:197], v[194:195], v[186:187] op_sel_hi:[0,1,1] neg_lo:[0,0,1] neg_hi:[0,0,1]
v_cvt_pk_bf16_f32 v168, v180, v181
v_cvt_pk_bf16_f32 v169, v182, v183
v_cvt_pk_bf16_f32 v170, v184, v185
v_cvt_pk_bf16_f32 v171, v186, v187
v_pk_fma_f32 v[188:189], v[196:197], v[180:181], v[188:189] op_sel_hi:[0,1,1] neg_lo:[0,0,1] neg_hi:[0,0,1]
v_pk_fma_f32 v[190:191], v[196:197], v[182:183], v[190:191] op_sel_hi:[0,1,1] neg_lo:[0,0,1] neg_hi:[0,0,1]
v_pk_fma_f32 v[192:193], v[196:197], v[184:185], v[192:193] op_sel_hi:[0,1,1] neg_lo:[0,0,1] neg_hi:[0,0,1]
v_pk_fma_f32 v[194:195], v[196:197], v[186:187], v[194:195] op_sel_hi:[0,1,1] neg_lo:[0,0,1] neg_hi:[0,0,1]
v_cvt_pk_bf16_f32 v172, v188, v189
v_cvt_pk_bf16_f32 v173, v190, v191
v_cvt_pk_bf16_f32 v174, v192, v193
v_cvt_pk_bf16_f32 v175, v194, v195
v_mov_b32 v180, s24
v_mov_b32 v181, s24
v_mov_b32 v182, s24
v_mov_b32 v183, s24
s_nop 1
v_mfma_f32_32x32x16_bf16 v[184:199], v[180:183], v[16:19], 0
v_mfma_f32_32x32x16_bf16 v[184:199], v[180:183], v[20:23], v[184:199]
v_mfma_f32_32x32x16_bf16 v[184:199], v[180:183], v[24:27], v[184:199]
v_mfma_f32_32x32x16_bf16 v[184:199], v[180:183], v[28:31], v[184:199]
v_mfma_f32_32x32x16_bf16 v[184:199], v[180:183], v[32:35], v[184:199]
v_mfma_f32_32x32x16_bf16 v[184:199], v[180:183], v[36:39], v[184:199]
v_mfma_f32_32x32x16_bf16 v[184:199], v[180:183], v[40:43], v[184:199]
v_mfma_f32_32x32x16_bf16 v[184:199], v[180:183], v[44:47], v[184:199]
v_mfma_f32_32x32x16_bf16 v[184:199], v[180:183], v[48:51], v[184:199]
v_mfma_f32_32x32x16_bf16 v[184:199], v[180:183], v[52:55], v[184:199]
v_mfma_f32_32x32x16_bf16 v[184:199], v[180:183], v[56:59], v[184:199]
v_mfma_f32_32x32x16_bf16 v[184:199], v[180:183], v[60:63], v[184:199]
v_mfma_f32_32x32x16_bf16 v[184:199], v[180:183], v[64:67], v[184:199]
v_mfma_f32_32x32x16_bf16 v[184:199], v[180:183], v[68:71], v[184:199]
v_mfma_f32_32x32x16_bf16 v[184:199], v[180:183], v[72:75], v[184:199]
v_mfma_f32_32x32x16_bf16 v[184:199], v[180:183], v[76:79], v[184:199]
v_mfma_f32_32x32x16_bf16 v[184:199], v[180:183], v[80:83], v[184:199]
v_mfma_f32_32x32x16_bf16 v[184:199], v[180:183], v[84:87], v[184:199]
v_mfma_f32_32x32x16_bf16 v[184:199], v[180:183], v[88:91], v[184:199]
v_mfma_f32_32x32x16_bf16 v[184:199], v[180:183], v[92:95], v[184:199]
v_mfma_f32_32x32x16_bf16 v[184:199], v[180:183], v[96:99], v[184:199]
v_mfma_f32_32x32x16_bf16 v[184:199], v[180:183], v[100:103], v[184:199]
v_mfma_f32_32x32x16_bf16 v[184:199], v[180:183], v[104:107], v[184:199]
v_mfma_f32_32x32x16_bf16 v[184:199], v[180:183], v[108:111], v[184:199]
v_mfma_f32_32x32x16_bf16 v[184:199], v[180:183], v[112:115], v[184:199]
v_mfma_f32_32x32x16_bf16 v[184:199], v[180:183], v[116:119], v[184:199]
v_mfma_f32_32x32x16_bf16 v[184:199], v[180:183], v[120:123], v[184:199]
v_mfma_f32_32x32x16_bf16 v[184:199], v[180:183], v[124:127], v[184:199]
v_mfma_f32_32x32x16_bf16 v[184:199], v[180:183], v[128:131], v[184:199]
v_mfma_f32_32x32x16_bf16 v[184:199], v[180:183], v[132:135], v[184:199]
v_mfma_f32_32x32x16_bf16 v[184:199], v[180:183], v[136:139], v[184:199]
v_mfma_f32_32x32x16_bf16 v[184:199], v[180:183], v[140:143], v[184:199]
v_mfma_f32_32x32x16_bf16 v[184:199], v[180:183], v[144:147], v[184:199]
v_mfma_f32_32x32x16_bf16 v[184:199], v[180:183], v[148:151], v[184:199]
v_mfma_f32_32x32x16_bf16 v[184:199], v[180:183], v[152:155], v[184:199]
v_mfma_f32_32x32x16_bf16 v[184:199], v[180:183], v[156:159], v[184:199]
v_mfma_f32_32x32x16_bf16 v[184:199], v[180:183], v[160:163], v[184:199]
v_mfma_f32_32x32x16_bf16 v[184:199], v[180:183], v[164:167], v[184:199]
v_mfma_f32_32x32x16_bf16 v[184:199], v[180:183], v[168:171], v[184:199]
v_mfma_f32_32x32x16_bf16 v[184:199], v[180:183], v[172:175], v[184:199]
s_nop 11
v_mov_b32 v7, v184
s_lshl_b32 s18, s34, 2
s_add_u32 s18, s18, s13
s_lshl_b32 s33, s18, 11
s_mul_i32 s27, s50, 40960
s_add_u32 s27, s27, s33
s_add_u32 s27, s27, 97517568
s_mov_b32 s28, 0
s_waitcnt vmcnt(0)
p1_49:
s_barrier
s_lshl_b32 s18, s13, 5
v_xor_b32 v2, s18, v176
ds_read_b128 v[220:223], v2 offset:2048
ds_read_b128 v[224:227], v2 offset:6144
ds_read_b128 v[228:231], v2 offset:10240
ds_read_b128 v[200:203], v177 offset:2048
v_mov_b64 v[212:213], 0
ds_read_b128 v[232:235], v2 offset:14336
ds_read_b128 v[204:207], v178 offset:2048
ds_read_b128 v[196:199], v176 offset:2048
ds_read_b128 v[208:211], v179 offset:2048
s_waitcnt lgkmcnt(7)
v_dot2c_f32_bf16 v212, s24, v220
v_dot2c_f32_bf16 v213, v220, v220
v_dot2c_f32_bf16 v212, s24, v221
v_dot2c_f32_bf16 v213, v221, v221
s_waitcnt lgkmcnt(6)
v_dot2c_f32_bf16 v212, s24, v222
v_dot2c_f32_bf16 v213, v222, v222
v_dot2c_f32_bf16 v212, s24, v223
v_dot2c_f32_bf16 v213, v223, v223
v_dot2c_f32_bf16 v212, s24, v224
v_dot2c_f32_bf16 v213, v224, v224
v_dot2c_f32_bf16 v212, s24, v225
v_dot2c_f32_bf16 v213, v225, v225
v_dot2c_f32_bf16 v212, s24, v226
v_dot2c_f32_bf16 v213, v226, v226
v_dot2c_f32_bf16 v212, s24, v227
v_dot2c_f32_bf16 v213, v227, v227
s_waitcnt lgkmcnt(5)
s_waitcnt lgkmcnt(3)
ds_read_b128 v[220:223], v2 offset:18432
ds_read_b128 v[224:227], v2 offset:22528
v_dot2c_f32_bf16 v212, s24, v228
v_dot2c_f32_bf16 v213, v228, v228
v_dot2c_f32_bf16 v212, s24, v229
v_dot2c_f32_bf16 v213, v229, v229
v_dot2c_f32_bf16 v212, s24, v230
v_dot2c_f32_bf16 v213, v230, v230
v_dot2c_f32_bf16 v212, s24, v231
v_dot2c_f32_bf16 v213, v231, v231
v_dot2c_f32_bf16 v212, s24, v232
v_dot2c_f32_bf16 v213, v232, v232
v_dot2c_f32_bf16 v212, s24, v233
v_dot2c_f32_bf16 v213, v233, v233
v_dot2c_f32_bf16 v212, s24, v234
v_dot2c_f32_bf16 v213, v234, v234
v_dot2c_f32_bf16 v212, s24, v235
v_dot2c_f32_bf16 v213, v235, v235
s_waitcnt lgkmcnt(1)
ds_read_b128 v[232:235], v2 offset:30720
ds_read_b128 v[228:231], v2 offset:26624
v_dot2c_f32_bf16 v212, s24, v220
v_dot2c_f32_bf16 v213, v220, v220
v_dot2c_f32_bf16 v212, s24, v221
v_dot2c_f32_bf16 v213, v221, v221
v_dot2c_f32_bf16 v212, s24, v222
v_dot2c_f32_bf16 v213, v222, v222
s_waitcnt lgkmcnt(2)
v_dot2c_f32_bf16 v212, s24, v223
v_dot2c_f32_bf16 v213, v223, v223
v_dot2c_f32_bf16 v212, s24, v224
v_dot2c_f32_bf16 v213, v224, v224
v_dot2c_f32_bf16 v212, s24, v225
v_dot2c_f32_bf16 v213, v225, v225
v_dot2c_f32_bf16 v212, s24, v226
v_dot2c_f32_bf16 v213, v226, v226
v_dot2c_f32_bf16 v212, s24, v227
v_dot2c_f32_bf16 v213, v227, v227
s_waitcnt lgkmcnt(1)
s_waitcnt lgkmcnt(0)
ds_read_b128 v[220:223], v2 offset:34816
ds_read_b128 v[224:227], v2 offset:38912
v_dot2c_f32_bf16 v212, s24, v228
v_dot2c_f32_bf16 v213, v228, v228
v_dot2c_f32_bf16 v212, s24, v229
v_dot2c_f32_bf16 v213, v229, v229
v_dot2c_f32_bf16 v212, s24, v230
v_dot2c_f32_bf16 v213, v230, v230
v_dot2c_f32_bf16 v212, s24, v231
v_dot2c_f32_bf16 v213, v231, v231
v_dot2c_f32_bf16 v212, s24, v232
v_dot2c_f32_bf16 v213, v232, v232
v_dot2c_f32_bf16 v212, s24, v233
v_dot2c_f32_bf16 v213, v233, v233
v_dot2c_f32_bf16 v212, s24, v234
v_dot2c_f32_bf16 v213, v234, v234
v_dot2c_f32_bf16 v212, s24, v235
s_waitcnt lgkmcnt(1)
v_dot2c_f32_bf16 v213, v235, v235
v_dot2c_f32_bf16 v212, s24, v220
v_dot2c_f32_bf16 v213, v220, v220
v_dot2c_f32_bf16 v212, s24, v221
v_dot2c_f32_bf16 v213, v221, v221
s_waitcnt lgkmcnt(0)
v_dot2c_f32_bf16 v212, s24, v222
v_dot2c_f32_bf16 v213, v222, v222
v_dot2c_f32_bf16 v212, s24, v223
v_dot2c_f32_bf16 v213, v223, v223
v_dot2c_f32_bf16 v212, s24, v224
v_dot2c_f32_bf16 v213, v224, v224
v_dot2c_f32_bf16 v212, s24, v225
v_dot2c_f32_bf16 v213, v225, v225
v_dot2c_f32_bf16 v212, s24, v226
v_dot2c_f32_bf16 v213, v226, v226
v_dot2c_f32_bf16 v212, s24, v227
v_dot2c_f32_bf16 v213, v227, v227
v_mfma_f32_32x32x16_bf16 v[180:195], v[196:199], v[16:19], 0
v_and_b32 v2, 0x1ff, v0
ds_read_b128 v[196:199], v176 offset:6144
v_permlane32_swap_b32 v212, v213
v_mfma_f32_32x32x16_bf16 v[180:195], v[200:203], v[20:23], v[180:195]
v_add_f32 v212, v212, v213
v_lshl_add_u32 v213, s13, 2, v0
ds_write_b32 v213, v212 offset:0
v_mfma_f32_32x32x16_bf16 v[180:195], v[204:207], v[24:27], v[180:195]
ds_read_b128 v[200:203], v177 offset:6144
s_waitcnt lgkmcnt(2)
ds_read_b128 v[204:207], v178 offset:6144
v_mfma_f32_32x32x16_bf16 v[180:195], v[208:211], v[28:31], v[180:195]
ds_read_b128 v[208:211], v179 offset:6144
v_mfma_f32_32x32x16_bf16 v[180:195], v[196:199], v[32:35], v[180:195]
s_waitcnt lgkmcnt(3)
s_barrier
ds_read_b128 v[196:199], v176 offset:10240
s_waitcnt lgkmcnt(3)
v_mfma_f32_32x32x16_bf16 v[180:195], v[200:203], v[36:39], v[180:195]
ds_read_b128 v[212:215], v2 offset:0
s_waitcnt lgkmcnt(3)
s_waitcnt lgkmcnt(2)
ds_read_b128 v[200:203], v177 offset:10240
v_mfma_f32_32x32x16_bf16 v[180:195], v[204:207], v[40:43], v[180:195]
s_waitcnt lgkmcnt(2)
ds_read_b128 v[204:207], v178 offset:10240
v_mfma_f32_32x32x16_bf16 v[180:195], v[208:211], v[44:47], v[180:195]
ds_read_b128 v[216:219], v2 offset:512
s_waitcnt lgkmcnt(3)
s_waitcnt lgkmcnt(2)
v_mfma_f32_32x32x16_bf16 v[180:195], v[196:199], v[48:51], v[180:195]
ds_read_b128 v[208:211], v179 offset:10240
v_mfma_f32_32x32x16_bf16 v[180:195], v[200:203], v[52:55], v[180:195]
s_waitcnt lgkmcnt(2)
ds_read_b128 v[196:199], v176 offset:14336
v_add_f32 v212, v212, v213
v_add_f32 v214, v214, v215
v_lshrrev_b32 v213, 2, v0
v_mfma_f32_32x32x16_bf16 v[180:195], v[204:207], v[56:59], v[180:195]
s_waitcnt lgkmcnt(1)
ds_read_b128 v[200:203], v177 offset:14336
ds_read_b128 v[204:207], v178 offset:14336
v_add_f32 v212, v212, v214
v_mfma_f32_32x32x16_bf16 v[180:195], v[208:211], v[60:63], v[180:195]
ds_read_b128 v[208:211], v179 offset:14336
v_bfe_u32 v214, v0, 5, 5
s_waitcnt lgkmcnt(3)
v_and_b32 v214, 16, v214
v_mfma_f32_32x32x16_bf16 v[180:195], v[196:199], v[64:67], v[180:195]
ds_read_b128 v[196:199], v176 offset:18432
v_add_f32 v218, v218, v219
s_waitcnt lgkmcnt(3)
v_mul_f32 v212, 0x3acccccd, v212
v_add_f32 v216, v216, v217
v_mfma_f32_32x32x16_bf16 v[180:195], v[200:203], v[68:71], v[180:195]
ds_read_b128 v[200:203], v177 offset:18432
s_waitcnt lgkmcnt(2)
v_add_f32 v216, v216, v218
v_mul_f32 v216, 0x3acccccd, v216
v_fma_f32 v216, -v212, v212, v216
v_mfma_f32_32x32x16_bf16 v[180:195], v[204:207], v[72:75], v[180:195]
v_max_f32 v216, 0, v216
v_add_f32 v216, 0x3727c5ac, v216
v_mfma_f32_32x32x16_bf16 v[180:195], v[208:211], v[76:79], v[180:195]
s_waitcnt lgkmcnt(1)
ds_read_b128 v[208:211], v179 offset:18432
ds_read_b128 v[204:207], v178 offset:18432
v_lshl_add_u32 v214, s13, 8, v214
s_waitcnt lgkmcnt(2)
v_rsq_f32 v216, v216
v_mfma_f32_32x32x16_bf16 v[180:195], v[196:199], v[80:83], v[180:195]
v_mul_f32 v212, v216, v212
v_lshl_add_u32 v213, s13, 8, v213
s_nop 0
v_permlane32_swap_b32 v216, v212
v_mfma_f32_32x32x16_bf16 v[180:195], v[200:203], v[84:87], v[180:195]
ds_read_b128 v[196:199], v176 offset:22528
ds_read_b128 v[200:203], v177 offset:22528
s_waitcnt lgkmcnt(2)
v_mfma_f32_32x32x16_bf16 v[180:195], v[204:207], v[88:91], v[180:195]
ds_write_b32 v213, v216 offset:1024
ds_read_b128 v[240:243], v214 offset:1184
ds_read_b128 v[204:207], v178 offset:22528
ds_read_b128 v[232:235], v214 offset:1120
v_mfma_f32_32x32x16_bf16 v[180:195], v[208:211], v[92:95], v[180:195]
ds_read_b128 v[208:211], v179 offset:22528
s_waitcnt lgkmcnt(6)
v_mfma_f32_32x32x16_bf16 v[180:195], v[196:199], v[96:99], v[180:195]
s_waitcnt lgkmcnt(5)
ds_read_b128 v[196:199], v176 offset:26624
v_mfma_f32_32x32x16_bf16 v[180:195], v[200:203], v[100:103], v[180:195]
s_waitcnt lgkmcnt(3)
ds_read_b128 v[220:223], v214 offset:1024
v_mfma_f32_32x32x16_bf16 v[180:195], v[204:207], v[104:107], v[180:195]
s_waitcnt lgkmcnt(2)
ds_read_b128 v[204:207], v178 offset:26624
ds_read_b128 v[200:203], v177 offset:26624
ds_read_b128 v[228:231], v214 offset:1088
s_waitcnt lgkmcnt(4)
v_mfma_f32_32x32x16_bf16 v[180:195], v[208:211], v[108:111], v[180:195]
v_mfma_f32_32x32x16_bf16 v[180:195], v[196:199], v[112:115], v[180:195]
ds_read_b128 v[196:199], v176 offset:30720
ds_read_b128 v[208:211], v179 offset:26624
s_waitcnt lgkmcnt(4)
ds_read_b128 v[244:247], v214 offset:1216
s_waitcnt lgkmcnt(4)
ds_read_b128 v[236:239], v214 offset:1152
v_mfma_f32_32x32x16_bf16 v[180:195], v[200:203], v[116:119], v[180:195]
v_mul_f32 v243, v243, v7
ds_read_b128 v[248:251], v214 offset:1248
v_mfma_f32_32x32x16_bf16 v[180:195], v[204:207], v[120:123], v[180:195]
ds_read_b128 v[200:203], v177 offset:30720
s_waitcnt lgkmcnt(4)
v_mfma_f32_32x32x16_bf16 v[180:195], v[208:211], v[124:127], v[180:195]
ds_read_b128 v[208:211], v179 offset:30720
ds_read_b128 v[204:207], v178 offset:30720
v_mul_f32 v240, v240, v7
v_mfma_f32_32x32x16_bf16 v[180:195], v[196:199], v[128:131], v[180:195]
s_waitcnt lgkmcnt(2)
v_mfma_f32_32x32x16_bf16 v[180:195], v[200:203], v[132:135], v[180:195]
ds_read_b128 v[200:203], v177 offset:34816
ds_read_b128 v[196:199], v176 offset:34816
s_waitcnt lgkmcnt(3)
s_waitcnt lgkmcnt(2)
ds_read_b128 v[224:227], v214 offset:1056
v_mfma_f32_32x32x16_bf16 v[180:195], v[204:207], v[136:139], v[180:195]
v_mul_f32 v248, v248, v7
v_mfma_f32_32x32x16_bf16 v[180:195], v[208:211], v[140:143], v[180:195]
ds_read_b128 v[208:211], v179 offset:34816
ds_read_b128 v[204:207], v178 offset:34816
s_waitcnt lgkmcnt(3)
v_mfma_f32_32x32x16_bf16 v[180:195], v[196:199], v[144:147], v[180:195]
v_mfma_f32_32x32x16_bf16 v[180:195], v[200:203], v[148:151], v[180:195]
s_waitcnt lgkmcnt(0)
ds_read_b128 v[196:199], v176 offset:38912
v_mfma_f32_32x32x16_bf16 v[180:195], v[204:207], v[152:155], v[180:195]
ds_read_b128 v[204:207], v178 offset:38912
v_mul_f32 v238, v238, v7
v_mul_f32 v239, v239, v7
ds_read_b128 v[200:203], v177 offset:38912
v_mfma_f32_32x32x16_bf16 v[180:195], v[208:211], v[156:159], v[180:195]
v_mul_f32 v250, v250, v7
v_mul_f32 v247, v247, v7
s_waitcnt lgkmcnt(2)
v_mfma_f32_32x32x16_bf16 v[180:195], v[196:199], v[160:163], v[180:195]
ds_read_b128 v[208:211], v179 offset:38912
v_mul_f32 v249, v249, v7
v_mul_f32 v241, v241, v7
s_waitcnt lgkmcnt(1)
v_mfma_f32_32x32x16_bf16 v[180:195], v[200:203], v[164:167], v[180:195]
v_mul_f32 v237, v237, v7
v_mul_f32 v242, v242, v7
v_mul_f32 v244, v244, v7
v_mul_f32 v246, v246, v7
v_mul_f32 v251, v251, v7
v_mul_f32 v245, v245, v7
v_mfma_f32_32x32x16_bf16 v[180:195], v[204:207], v[168:171], v[180:195]
s_waitcnt lgkmcnt(0)
v_mul_f32 v236, v236, v7
v_mfma_f32_32x32x16_bf16 v[180:195], v[208:211], v[172:175], v[180:195]
s_nop 11
v_pk_fma_f32 v[184:185], v[184:185], v[224:225], v[240:241] neg_lo:[0,0,1] neg_hi:[0,0,1]
v_cvt_pk_bf16_f32 v198, v184, v185
v_pk_fma_f32 v[192:193], v[192:193], v[232:233], v[248:249] neg_lo:[0,0,1] neg_hi:[0,0,1]
v_pk_fma_f32 v[182:183], v[182:183], v[222:223], v[238:239] neg_lo:[0,0,1] neg_hi:[0,0,1]
v_pk_fma_f32 v[194:195], v[194:195], v[234:235], v[250:251] neg_lo:[0,0,1] neg_hi:[0,0,1]
v_pk_fma_f32 v[188:189], v[188:189], v[228:229], v[244:245] neg_lo:[0,0,1] neg_hi:[0,0,1]
v_pk_fma_f32 v[190:191], v[190:191], v[230:231], v[246:247] neg_lo:[0,0,1] neg_hi:[0,0,1]
v_pk_fma_f32 v[186:187], v[186:187], v[226:227], v[242:243] neg_lo:[0,0,1] neg_hi:[0,0,1]
v_cvt_pk_bf16_f32 v203, v194, v195
v_cvt_pk_bf16_f32 v199, v186, v187
v_pk_fma_f32 v[180:181], v[180:181], v[220:221], v[236:237] neg_lo:[0,0,1] neg_hi:[0,0,1]
v_cvt_pk_bf16_f32 v200, v188, v189
v_cvt_pk_bf16_f32 v202, v192, v193
v_cvt_pk_bf16_f32 v197, v182, v183
v_cvt_pk_bf16_f32 v196, v180, v181
v_cvt_pk_bf16_f32 v201, v190, v191
buffer_store_dwordx4 v[196:199], v6, s[4:7], s27 offen offset:0 sc1
buffer_store_dwordx4 v[200:203], v6, s[4:7], s27 offen offset:1024 sc1
v_add_u32 v176, 40960, v176
v_add_u32 v177, 40960, v177
v_add_u32 v178, 40960, v178
v_add_u32 v179, 40960, v179
s_add_u32 s27, s27, 1310720
s_add_u32 s28, s28, 1
s_cmp_lt_u32 s28, 2
s_cbranch_scc1 p1_49
s_lshl_b32 s18, s39, 7
s_add_u32 s18, s18, 11571200
s_cmp_eq_u32 s13, 0
s_cselect_b32 s22, s18, s6
s_mov_b32 s23, 1
alay_50:
v_bfe_u32 v96, v0, 4, 4
v_lshrrev_b32 v97, 8, v0
v_lshlrev_b32 v97, 2, v97
v_lshl_add_u32 v98, s13, 4, v96
v_add_u32 v99, 0, v97
v_mul_u32_u24 v99, v99, v98
v_and_b32 v99, 63, v99
v_cvt_f32_u32 v99, v99
v_mul_f32 v99, 0x3c800000, v99
v_cos_f32 v104, v99
v_sin_f32 v112, v99
v_add_u32 v99, 1, v97
v_mul_u32_u24 v99, v99, v98
v_and_b32 v99, 63, v99
v_cvt_f32_u32 v99, v99
v_mul_f32 v99, 0x3c800000, v99
v_cos_f32 v105, v99
v_sin_f32 v113, v99
v_add_u32 v99, 2, v97
v_mul_u32_u24 v99, v99, v98
v_and_b32 v99, 63, v99
v_cvt_f32_u32 v99, v99
v_mul_f32 v99, 0x3c800000, v99
v_cos_f32 v106, v99
v_sin_f32 v114, v99
v_add_u32 v99, 3, v97
v_mul_u32_u24 v99, v99, v98
v_and_b32 v99, 63, v99
v_cvt_f32_u32 v99, v99
v_mul_f32 v99, 0x3c800000, v99
v_cos_f32 v107, v99
v_sin_f32 v115, v99
v_add_u32 v99, 16, v97
v_mul_u32_u24 v99, v99, v98
v_and_b32 v99, 63, v99
v_cvt_f32_u32 v99, v99
v_mul_f32 v99, 0x3c800000, v99
v_cos_f32 v108, v99
v_sin_f32 v116, v99
v_add_u32 v99, 17, v97
v_mul_u32_u24 v99, v99, v98
v_and_b32 v99, 63, v99
v_cvt_f32_u32 v99, v99
v_mul_f32 v99, 0x3c800000, v99
v_cos_f32 v109, v99
v_sin_f32 v117, v99
v_add_u32 v99, 18, v97
v_mul_u32_u24 v99, v99, v98
v_and_b32 v99, 63, v99
v_cvt_f32_u32 v99, v99
v_mul_f32 v99, 0x3c800000, v99
v_cos_f32 v110, v99
v_sin_f32 v118, v99
v_add_u32 v99, 19, v97
v_mul_u32_u24 v99, v99, v98
v_and_b32 v99, 63, v99
v_cvt_f32_u32 v99, v99
v_mul_f32 v99, 0x3c800000, v99
v_cos_f32 v111, v99
v_sin_f32 v119, v99
v_cvt_pk_bf16_f32 v16, v104, v105
v_cvt_pk_bf16_f32 v24, v112, v113
v_xor_b32 v32, 0x80008000, v24
v_cvt_pk_bf16_f32 v17, v106, v107
v_cvt_pk_bf16_f32 v25, v114, v115
v_xor_b32 v33, 0x80008000, v25
v_cvt_pk_bf16_f32 v18, v108, v109
v_cvt_pk_bf16_f32 v26, v116, v117
v_xor_b32 v34, 0x80008000, v26
v_cvt_pk_bf16_f32 v19, v110, v111
v_cvt_pk_bf16_f32 v27, v118, v119
v_xor_b32 v35, 0x80008000, v27
v_add_u32 v99, 32, v97
v_mul_u32_u24 v99, v99, v98
v_and_b32 v99, 63, v99
v_cvt_f32_u32 v99, v99
v_mul_f32 v99, 0x3c800000, v99
v_cos_f32 v104, v99
v_sin_f32 v112, v99
v_add_u32 v99, 33, v97
v_mul_u32_u24 v99, v99, v98
v_and_b32 v99, 63, v99
v_cvt_f32_u32 v99, v99
v_mul_f32 v99, 0x3c800000, v99
v_cos_f32 v105, v99
v_sin_f32 v113, v99
v_add_u32 v99, 34, v97
v_mul_u32_u24 v99, v99, v98
v_and_b32 v99, 63, v99
v_cvt_f32_u32 v99, v99
v_mul_f32 v99, 0x3c800000, v99
v_cos_f32 v106, v99
v_sin_f32 v114, v99
v_add_u32 v99, 35, v97
v_mul_u32_u24 v99, v99, v98
v_and_b32 v99, 63, v99
v_cvt_f32_u32 v99, v99
v_mul_f32 v99, 0x3c800000, v99
v_cos_f32 v107, v99
v_sin_f32 v115, v99
v_add_u32 v99, 48, v97
v_mul_u32_u24 v99, v99, v98
v_and_b32 v99, 63, v99
v_cvt_f32_u32 v99, v99
v_mul_f32 v99, 0x3c800000, v99
v_cos_f32 v108, v99
v_sin_f32 v116, v99
v_add_u32 v99, 49, v97
v_mul_u32_u24 v99, v99, v98
v_and_b32 v99, 63, v99
v_cvt_f32_u32 v99, v99
v_mul_f32 v99, 0x3c800000, v99
v_cos_f32 v109, v99
v_sin_f32 v117, v99
v_add_u32 v99, 50, v97
v_mul_u32_u24 v99, v99, v98
v_and_b32 v99, 63, v99
v_cvt_f32_u32 v99, v99
v_mul_f32 v99, 0x3c800000, v99
v_cos_f32 v110, v99
v_sin_f32 v118, v99
v_add_u32 v99, 51, v97
v_mul_u32_u24 v99, v99, v98
v_and_b32 v99, 63, v99
v_cvt_f32_u32 v99, v99
v_mul_f32 v99, 0x3c800000, v99
v_cos_f32 v111, v99
v_sin_f32 v119, v99
v_cvt_pk_bf16_f32 v20, v104, v105
v_cvt_pk_bf16_f32 v28, v112, v113
v_xor_b32 v36, 0x80008000, v28
v_cvt_pk_bf16_f32 v21, v106, v107
v_cvt_pk_bf16_f32 v29, v114, v115
v_xor_b32 v37, 0x80008000, v29
v_cvt_pk_bf16_f32 v22, v108, v109
v_cvt_pk_bf16_f32 v30, v116, v117
v_xor_b32 v38, 0x80008000, v30
v_cvt_pk_bf16_f32 v23, v110, v111
v_cvt_pk_bf16_f32 v31, v118, v119
v_xor_b32 v39, 0x80008000, v31
s_waitcnt vmcnt(0)
s_barrier
v_mov_b32 v3, s23
s_mov_b64 exec, 1
buffer_store_dword v3, off, s[4:7], s22 sc1
s_mov_b64 exec, -1
s_mov_b32 s22, s6
v_add_u32 v99, 0, v97
v_mul_u32_u24 v99, v99, v98
v_and_b32 v99, 2047, v99
v_cvt_f32_u32 v99, v99
v_mul_f32 v99, 0x3a000000, v99
v_cos_f32 v64, v99
v_sin_f32 v72, v99
v_add_u32 v99, 1, v97
v_mul_u32_u24 v99, v99, v98
v_and_b32 v99, 2047, v99
v_cvt_f32_u32 v99, v99
v_mul_f32 v99, 0x3a000000, v99
v_cos_f32 v65, v99
v_sin_f32 v73, v99
v_add_u32 v99, 2, v97
v_mul_u32_u24 v99, v99, v98
v_and_b32 v99, 2047, v99
v_cvt_f32_u32 v99, v99
v_mul_f32 v99, 0x3a000000, v99
v_cos_f32 v66, v99
v_sin_f32 v74, v99
v_add_u32 v99, 3, v97
v_mul_u32_u24 v99, v99, v98
v_and_b32 v99, 2047, v99
v_cvt_f32_u32 v99, v99
v_mul_f32 v99, 0x3a000000, v99
v_cos_f32 v67, v99
v_sin_f32 v75, v99
v_add_u32 v99, 16, v97
v_mul_u32_u24 v99, v99, v98
v_and_b32 v99, 2047, v99
v_cvt_f32_u32 v99, v99
v_mul_f32 v99, 0x3a000000, v99
v_cos_f32 v68, v99
v_sin_f32 v76, v99
v_add_u32 v99, 17, v97
v_mul_u32_u24 v99, v99, v98
v_and_b32 v99, 2047, v99
v_cvt_f32_u32 v99, v99
v_mul_f32 v99, 0x3a000000, v99
v_cos_f32 v69, v99
v_sin_f32 v77, v99
v_add_u32 v99, 18, v97
v_mul_u32_u24 v99, v99, v98
v_and_b32 v99, 2047, v99
v_cvt_f32_u32 v99, v99
v_mul_f32 v99, 0x3a000000, v99
v_cos_f32 v70, v99
v_sin_f32 v78, v99
v_add_u32 v99, 19, v97
v_mul_u32_u24 v99, v99, v98
v_and_b32 v99, 2047, v99
v_cvt_f32_u32 v99, v99
v_mul_f32 v99, 0x3a000000, v99
v_cos_f32 v71, v99
v_sin_f32 v79, v99
v_lshl_add_u32 v100, s13, 4, v97
v_add_u32 v98, 0, v96
v_add_u32 v99, 0, v97
v_mul_u32_u24 v99, v99, v98
v_and_b32 v99, 31, v99
v_cvt_f32_u32 v99, v99
v_mul_f32 v99, 0x3d000000, v99
v_cos_f32 v104, v99
v_sin_f32 v112, v99
v_add_u32 v99, 1, v97
v_mul_u32_u24 v99, v99, v98
v_and_b32 v99, 31, v99
v_cvt_f32_u32 v99, v99
v_mul_f32 v99, 0x3d000000, v99
v_cos_f32 v105, v99
v_sin_f32 v113, v99
v_add_u32 v99, 2, v97
v_mul_u32_u24 v99, v99, v98
v_and_b32 v99, 31, v99
v_cvt_f32_u32 v99, v99
v_mul_f32 v99, 0x3d000000, v99
v_cos_f32 v106, v99
v_sin_f32 v114, v99
v_add_u32 v99, 3, v97
v_mul_u32_u24 v99, v99, v98
v_and_b32 v99, 31, v99
v_cvt_f32_u32 v99, v99
v_mul_f32 v99, 0x3d000000, v99
v_cos_f32 v107, v99
v_sin_f32 v115, v99
v_add_u32 v99, 16, v97
v_mul_u32_u24 v99, v99, v98
v_and_b32 v99, 31, v99
v_cvt_f32_u32 v99, v99
v_mul_f32 v99, 0x3d000000, v99
v_cos_f32 v108, v99
v_sin_f32 v116, v99
v_add_u32 v99, 17, v97
v_mul_u32_u24 v99, v99, v98
v_and_b32 v99, 31, v99
v_cvt_f32_u32 v99, v99
v_mul_f32 v99, 0x3d000000, v99
v_cos_f32 v109, v99
v_sin_f32 v117, v99
v_add_u32 v99, 18, v97
v_mul_u32_u24 v99, v99, v98
v_and_b32 v99, 31, v99
v_cvt_f32_u32 v99, v99
v_mul_f32 v99, 0x3d000000, v99
v_cos_f32 v110, v99
v_sin_f32 v118, v99
v_add_u32 v99, 19, v97
v_mul_u32_u24 v99, v99, v98
v_and_b32 v99, 31, v99
v_cvt_f32_u32 v99, v99
v_mul_f32 v99, 0x3d000000, v99
v_cos_f32 v111, v99
v_sin_f32 v119, v99
v_cvt_pk_bf16_f32 v40, v104, v105
v_cvt_pk_bf16_f32 v48, v112, v113
v_xor_b32 v56, 0x80008000, v48
v_cvt_pk_bf16_f32 v41, v106, v107
v_cvt_pk_bf16_f32 v49, v114, v115
v_xor_b32 v57, 0x80008000, v49
v_cvt_pk_bf16_f32 v42, v108, v109
v_cvt_pk_bf16_f32 v50, v116, v117
v_xor_b32 v58, 0x80008000, v50
v_cvt_pk_bf16_f32 v43, v110, v111
v_cvt_pk_bf16_f32 v51, v118, v119
v_xor_b32 v59, 0x80008000, v51
v_add_u32 v99, 0, v100
v_mul_u32_u24 v99, v99, v98
v_and_b32 v99, 2047, v99
v_cvt_f32_u32 v99, v99
v_mul_f32 v99, 0x3a000000, v99
v_cos_f32 v80, v99
v_sin_f32 v88, v99
v_mul_f32 v80, 0x3a000000, v80
v_mul_f32 v88, 0x3a000000, v88
v_add_u32 v99, 1, v100
v_mul_u32_u24 v99, v99, v98
v_and_b32 v99, 2047, v99
v_cvt_f32_u32 v99, v99
v_mul_f32 v99, 0x3a000000, v99
v_cos_f32 v81, v99
v_sin_f32 v89, v99
v_mul_f32 v81, 0x3a000000, v81
v_mul_f32 v89, 0x3a000000, v89
v_add_u32 v99, 2, v100
v_mul_u32_u24 v99, v99, v98
v_and_b32 v99, 2047, v99
v_cvt_f32_u32 v99, v99
v_mul_f32 v99, 0x3a000000, v99
v_cos_f32 v82, v99
v_sin_f32 v90, v99
v_mul_f32 v82, 0x3a000000, v82
v_mul_f32 v90, 0x3a000000, v90
v_add_u32 v99, 3, v100
v_mul_u32_u24 v99, v99, v98
v_and_b32 v99, 2047, v99
v_cvt_f32_u32 v99, v99
v_mul_f32 v99, 0x3a000000, v99
v_cos_f32 v83, v99
v_sin_f32 v91, v99
v_mul_f32 v83, 0x3a000000, v83
v_mul_f32 v91, 0x3a000000, v91
v_add_u32 v98, 16, v96
v_add_u32 v99, 0, v97
v_mul_u32_u24 v99, v99, v98
v_and_b32 v99, 31, v99
v_cvt_f32_u32 v99, v99
v_mul_f32 v99, 0x3d000000, v99
v_cos_f32 v104, v99
v_sin_f32 v112, v99
v_add_u32 v99, 1, v97
v_mul_u32_u24 v99, v99, v98
v_and_b32 v99, 31, v99
v_cvt_f32_u32 v99, v99
v_mul_f32 v99, 0x3d000000, v99
v_cos_f32 v105, v99
v_sin_f32 v113, v99
v_add_u32 v99, 2, v97
v_mul_u32_u24 v99, v99, v98
v_and_b32 v99, 31, v99
v_cvt_f32_u32 v99, v99
v_mul_f32 v99, 0x3d000000, v99
v_cos_f32 v106, v99
v_sin_f32 v114, v99
v_add_u32 v99, 3, v97
v_mul_u32_u24 v99, v99, v98
v_and_b32 v99, 31, v99
v_cvt_f32_u32 v99, v99
v_mul_f32 v99, 0x3d000000, v99
v_cos_f32 v107, v99
v_sin_f32 v115, v99
v_add_u32 v99, 16, v97
v_mul_u32_u24 v99, v99, v98
v_and_b32 v99, 31, v99
v_cvt_f32_u32 v99, v99
v_mul_f32 v99, 0x3d000000, v99
v_cos_f32 v108, v99
v_sin_f32 v116, v99
v_add_u32 v99, 17, v97
v_mul_u32_u24 v99, v99, v98
v_and_b32 v99, 31, v99
v_cvt_f32_u32 v99, v99
v_mul_f32 v99, 0x3d000000, v99
v_cos_f32 v109, v99
v_sin_f32 v117, v99
v_add_u32 v99, 18, v97
v_mul_u32_u24 v99, v99, v98
v_and_b32 v99, 31, v99
v_cvt_f32_u32 v99, v99
v_mul_f32 v99, 0x3d000000, v99
v_cos_f32 v110, v99
v_sin_f32 v118, v99
v_add_u32 v99, 19, v97
v_mul_u32_u24 v99, v99, v98
v_and_b32 v99, 31, v99
v_cvt_f32_u32 v99, v99
v_mul_f32 v99, 0x3d000000, v99
v_cos_f32 v111, v99
v_sin_f32 v119, v99
v_cvt_pk_bf16_f32 v44, v104, v105
v_cvt_pk_bf16_f32 v52, v112, v113
v_xor_b32 v60, 0x80008000, v52
v_cvt_pk_bf16_f32 v45, v106, v107
v_cvt_pk_bf16_f32 v53, v114, v115
v_xor_b32 v61, 0x80008000, v53
v_cvt_pk_bf16_f32 v46, v108, v109
v_cvt_pk_bf16_f32 v54, v116, v117
v_xor_b32 v62, 0x80008000, v54
v_cvt_pk_bf16_f32 v47, v110, v111
v_cvt_pk_bf16_f32 v55, v118, v119
v_xor_b32 v63, 0x80008000, v55
v_add_u32 v99, 0, v100
v_mul_u32_u24 v99, v99, v98
v_and_b32 v99, 2047, v99
v_cvt_f32_u32 v99, v99
v_mul_f32 v99, 0x3a000000, v99
v_cos_f32 v84, v99
v_sin_f32 v92, v99
v_mul_f32 v84, 0x3a000000, v84
v_mul_f32 v92, 0x3a000000, v92
v_add_u32 v99, 1, v100
v_mul_u32_u24 v99, v99, v98
v_and_b32 v99, 2047, v99
v_cvt_f32_u32 v99, v99
v_mul_f32 v99, 0x3a000000, v99
v_cos_f32 v85, v99
v_sin_f32 v93, v99
v_mul_f32 v85, 0x3a000000, v85
v_mul_f32 v93, 0x3a000000, v93
v_add_u32 v99, 2, v100
v_mul_u32_u24 v99, v99, v98
v_and_b32 v99, 2047, v99
v_cvt_f32_u32 v99, v99
v_mul_f32 v99, 0x3a000000, v99
v_cos_f32 v86, v99
v_sin_f32 v94, v99
v_mul_f32 v86, 0x3a000000, v86
v_mul_f32 v94, 0x3a000000, v94
v_add_u32 v99, 3, v100
v_mul_u32_u24 v99, v99, v98
v_and_b32 v99, 2047, v99
v_cvt_f32_u32 v99, v99
v_mul_f32 v99, 0x3a000000, v99
v_cos_f32 v87, v99
v_sin_f32 v95, v99
v_mul_f32 v87, 0x3a000000, v87
v_mul_f32 v95, 0x3a000000, v95
v_lshrrev_b32 v98, 6, v0
v_and_b32 v99, 7, v98
v_lshlrev_b32 v99, 5, v99
v_lshl_add_u32 v98, v98, 8, v99
v_and_b32 v99, 16, v0
v_add_u32 v98, v98, v99
v_bfe_u32 v99, v0, 5, 1
v_lshl_add_u32 v224, v99, 3, v98
v_xor_b32 v225, 32, v224
v_xor_b32 v226, 64, v224
v_xor_b32 v227, 96, v224
v_xor_b32 v228, 128, v224
v_xor_b32 v229, 160, v224
v_xor_b32 v230, 192, v224
v_xor_b32 v231, 224, v224
v_lshrrev_b32 v98, 8, v0
v_bfe_u32 v99, v0, 5, 3
v_xor_b32 v99, v99, v98
v_mul_u32_u24 v98, 40960, v98
v_and_b32 v96, 16, v0
v_add_u32 v98, v98, v96
v_and_b32 v96, 3, v99
v_lshl_add_u32 v98, v96, 5, v98
v_lshrrev_b32 v99, 2, v99
v_lshl_add_u32 v232, v99, 10, v98
v_xor_b32 v99, 1, v99
v_lshl_add_u32 v233, v99, 10, v98
s_lshl_b32 s18, s13, 12
s_add_u32 s19, s18, 147456
v_add_u32 v220, s19, v0
s_mov_b32 s25, s18
s_mul_i32 s26, s16, 3145728
s_mul_i32 s19, s13, 655360
s_add_u32 s26, s26, s19
s_lshl_b32 s19, s39, 8
s_add_u32 s27, s26, s19
s_add_u32 s27, s27, 103809024
s_lshr_b32 s19, s39, 3
s_lshl_b32 s19, s19, 11
s_add_u32 s26, s26, s19
s_and_b32 s19, s39, 7
s_lshl_b32 s19, s19, 7
s_add_u32 s26, s26, s19
s_add_u32 s26, s26, 97517568
s_cmp_lg_u32 s16, 0
s_cbranch_scc1 cw_51
s_cmp_lg_u32 s13, 0
s_cbranch_scc1 polld_54
v_lshlrev_b32 v3, 3, v0
v_min_u32 v12, 3968, v3
s_mov_b32 s21, 11563008
s_mov_b32 s17, 0
poll_53:
buffer_load_dword v8, v3, s[4:7], s21 offen sc1
s_add_u32 s20, s21, 8192
buffer_load_dword v9, v3, s[4:7], s20 offen sc1
s_add_u32 s20, s21, 16384
buffer_load_dword v10, v3, s[4:7], s20 offen sc1
s_add_u32 s20, s21, 24576
buffer_load_dword v11, v12, s[4:7], s20 offen sc1
s_add_u32 s17, s17, 1
s_cmp_gt_u32 s17, 262144
s_cbranch_scc1 L_fail
s_waitcnt vmcnt(2)
v_min_u32 v8, v8, v9
s_waitcnt vmcnt(1)
v_min_u32 v8, v8, v10
s_waitcnt vmcnt(0)
v_min_u32 v8, v8, v11
v_cmp_gt_u32 vcc, 1, v8
s_cbranch_vccz polld_54
s_sleep 2
s_branch poll_53
polld_54:
s_barrier
s_add_u32 s18, s25, 145408
s_lshl_b32 s19, s39, 14
s_add_u32 s19, s19, s25
s_add_u32 s19, s19, 167772160
s_add_u32 m0, s18, 2048
s_add_u32 s20, s19, 0
buffer_load_dwordx4 v0, s[4:7], s20 offen sc1 lds
s_add_u32 m0, s18, 3072
s_add_u32 s20, s19, 1024
buffer_load_dwordx4 v0, s[4:7], s20 offen sc1 lds
s_add_u32 m0, s18, 4096
s_add_u32 s20, s19, 2048
buffer_load_dwordx4 v0, s[4:7], s20 offen sc1 lds
s_add_u32 m0, s18, 5120
s_add_u32 s20, s19, 3072
buffer_load_dwordx4 v0, s[4:7], s20 offen sc1 lds
s_branch cw_52
cw_51:
s_cmp_lg_u32 s13, 0
s_cbranch_scc1 polld_56
v_lshlrev_b32 v3, 3, v0
v_min_u32 v12, 4352, v3
s_mov_b32 s21, 11552768
s_mov_b32 s17, 0
poll_55:
buffer_load_dword v8, v12, s[4:7], s21 offen sc1
s_add_u32 s17, s17, 1
s_cmp_gt_u32 s17, 262144
s_cbranch_scc1 L_fail
s_waitcnt vmcnt(0)
v_cmp_gt_u32 vcc, 1, v8
s_cbranch_vccz polld_56
s_sleep 2
s_branch poll_55
polld_56:
s_barrier
cw_52:
s_add_u32 m0, s25, 0
s_add_u32 s20, s26, 0
buffer_load_dwordx4 v232, s[4:7], s20 offen sc1 lds
s_add_u32 m0, s25, 1024
s_add_u32 s20, s26, 163840
buffer_load_dwordx4 v233, s[4:7], s20 offen sc1 lds
s_add_u32 m0, s25, 2048
s_add_u32 s20, s26, 327680
buffer_load_dwordx4 v232, s[4:7], s20 offen sc1 lds
s_add_u32 m0, s25, 3072
s_add_u32 s20, s26, 491520
buffer_load_dwordx4 v233, s[4:7], s20 offen sc1 lds
s_lshr_b32 s18, s13, 1
s_lshl_b32 s18, s18, 10
s_and_b32 s19, s13, 1
s_lshl_b32 s19, s19, 3
s_add_u32 s18, s18, s19
v_add_u32 v234, s18, v0
v_bfe_u32 v235, v0, 4, 4
v_mul_u32_u24 v235, 40960, v235
v_lshrrev_b32 v99, 8, v0
v_lshl_add_u32 v235, v99, 4, v235
s_waitcnt vmcnt(0)
s_barrier
ds_read_b64_tr_b16 v[112:113], v225 offset:0
ds_read_b64_tr_b16 v[114:115], v225 offset:4096
ds_read_b64_tr_b16 v[98:99], v224 offset:4096
ds_read_b64_tr_b16 v[96:97], v224 offset:0
ds_read_b64_tr_b16 v[102:103], v224 offset:12288
ds_read_b64_tr_b16 v[144:145], v227 offset:0
ds_read_b64_tr_b16 v[130:131], v226 offset:4096
ds_read_b64_tr_b16 v[104:105], v228 offset:0
ds_read_b64_tr_b16 v[118:119], v225 offset:12288
ds_read_b64_tr_b16 v[100:101], v224 offset:8192
ds_read_b64_tr_b16 v[120:121], v229 offset:0
ds_read_b64_tr_b16 v[116:117], v225 offset:8192
ds_read_b64_tr_b16 v[110:111], v228 offset:12288
ds_read_b64_tr_b16 v[122:123], v229 offset:4096
ds_read_b64_tr_b16 v[108:109], v228 offset:8192
ds_read_b64_tr_b16 v[152:153], v231 offset:0
s_waitcnt lgkmcnt(14)
ds_read_b64_tr_b16 v[126:127], v229 offset:12288
v_mfma_f32_16x16x32_bf16 v[168:171], v[112:115], v[16:19], 0
s_waitcnt lgkmcnt(13)
ds_read_b64_tr_b16 v[106:107], v228 offset:4096
ds_read_b64_tr_b16 v[146:147], v227 offset:4096
v_mfma_f32_16x16x32_bf16 v[160:163], v[96:99], v[16:19], 0
ds_read_b64_tr_b16 v[128:129], v226 offset:0
ds_read_b64_tr_b16 v[134:135], v226 offset:12288
v_mfma_f32_16x16x32_bf16 v[168:171], v[96:99], v[32:35], v[168:171]
s_waitcnt lgkmcnt(13)
ds_read_b128 v[208:211], v220 offset:0
ds_read_b64_tr_b16 v[138:139], v230 offset:4096
v_mfma_f32_16x16x32_bf16 v[160:163], v[112:115], v[24:27], v[160:163]
s_waitcnt lgkmcnt(13)
ds_read_b64_tr_b16 v[136:137], v230 offset:0
ds_read_b64_tr_b16 v[140:141], v230 offset:8192
v_mfma_f32_16x16x32_bf16 v[160:163], v[100:103], v[20:23], v[160:163]
s_waitcnt lgkmcnt(13)
ds_read_b64_tr_b16 v[148:149], v227 offset:8192
ds_read_b64_tr_b16 v[124:125], v229 offset:8192
v_mfma_f32_16x16x32_bf16 v[160:163], v[116:119], v[28:31], v[160:163]
s_waitcnt lgkmcnt(13)
ds_read_b64_tr_b16 v[154:155], v231 offset:4096
ds_read_b64_tr_b16 v[142:143], v230 offset:12288
v_mfma_f32_16x16x32_bf16 v[168:171], v[116:119], v[20:23], v[168:171]
ds_read_b128 v[212:215], v220 offset:1024
ds_read_b128 v[216:219], v220 offset:2048
v_mfma_f32_16x16x32_bf16 v[168:171], v[100:103], v[36:39], v[168:171]
s_waitcnt lgkmcnt(13)
ds_read_b128 v[220:223], v220 offset:3072
v_mul_f32 v233, v161, v73
v_mfma_f32_16x16x32_bf16 v[172:175], v[120:123], v[16:19], 0
s_waitcnt lgkmcnt(13)
v_mul_f32 v232, v160, v72
v_mul_f32 v160, v160, v64
v_mfma_f32_16x16x32_bf16 v[164:167], v[104:107], v[16:19], 0
ds_read_b64_tr_b16 v[158:159], v231 offset:12288
ds_read_b64_tr_b16 v[150:151], v227 offset:12288
v_mfma_f32_16x16x32_bf16 v[172:175], v[104:107], v[32:35], v[172:175]
ds_read_b64_tr_b16 v[156:157], v231 offset:8192
v_fma_f32 v160, v168, v72, v160
v_mfma_f32_16x16x32_bf16 v[164:167], v[120:123], v[24:27], v[164:167]
s_waitcnt lgkmcnt(11)
ds_read_b64_tr_b16 v[132:133], v226 offset:8192
v_mul_f32 v161, v161, v65
v_mfma_f32_16x16x32_bf16 v[184:187], v[144:147], v[16:19], 0
s_waitcnt lgkmcnt(9)
v_fma_f32 v161, v169, v73, v161
v_fma_f32 v168, v168, v64, -v232
v_mfma_f32_16x16x32_bf16 v[164:167], v[108:111], v[20:23], v[164:167]
v_fma_f32 v169, v169, v65, -v233
v_mul_f32 v233, v163, v75
v_mfma_f32_16x16x32_bf16 v[172:175], v[124:127], v[20:23], v[172:175]
v_mul_f32 v232, v162, v74
v_mul_f32 v162, v162, v66
v_mfma_f32_16x16x32_bf16 v[164:167], v[124:127], v[28:31], v[164:167]
s_waitcnt lgkmcnt(7)
v_mul_f32 v163, v163, v67
v_cvt_pk_bf16_f32 v192, v160, v161
v_mfma_f32_16x16x32_bf16 v[172:175], v[108:111], v[36:39], v[172:175]
v_fma_f32 v162, v170, v74, v162
v_fma_f32 v170, v170, v66, -v232
v_mfma_f32_16x16x32_bf16 v[188:191], v[152:155], v[16:19], 0
s_waitcnt lgkmcnt(2)
v_fma_f32 v163, v171, v75, v163
v_mul_f32 v232, v164, v76
v_mfma_f32_16x16x32_bf16 v[180:183], v[136:139], v[16:19], 0
v_mul_f32 v164, v164, v68
v_fma_f32 v164, v172, v76, v164
v_mfma_f32_16x16x32_bf16 v[184:187], v[128:131], v[32:35], v[184:187]
v_fma_f32 v172, v172, v68, -v232
v_fma_f32 v171, v171, v67, -v233
v_mfma_f32_16x16x32_bf16 v[188:191], v[136:139], v[32:35], v[188:191]
s_waitcnt lgkmcnt(0)
v_mul_f32 v233, v165, v77
v_mul_f32 v165, v165, v69
v_mfma_f32_16x16x32_bf16 v[184:187], v[148:151], v[20:23], v[184:187]
v_fma_f32 v165, v173, v77, v165
v_mul_f32 v232, v166, v78
v_mfma_f32_16x16x32_bf16 v[176:179], v[128:131], v[16:19], 0
v_fma_f32 v173, v173, v69, -v233
v_mul_f32 v166, v166, v70
v_mfma_f32_16x16x32_bf16 v[180:183], v[152:155], v[24:27], v[180:183]
v_mul_f32 v233, v167, v79
v_fma_f32 v166, v174, v78, v166
v_mfma_f32_16x16x32_bf16 v[176:179], v[144:147], v[24:27], v[176:179]
v_cvt_pk_bf16_f32 v196, v168, v169
v_cvt_pk_bf16_f32 v198, v172, v173
v_mfma_f32_16x16x32_bf16 v[188:191], v[156:159], v[20:23], v[188:191]
v_mul_f32 v167, v167, v71
v_cvt_pk_bf16_f32 v193, v162, v163
v_mfma_f32_16x16x32_bf16 v[176:179], v[132:135], v[20:23], v[176:179]
v_cvt_pk_bf16_f32 v194, v164, v165
v_fma_f32 v167, v175, v79, v167
v_mfma_f32_16x16x32_bf16 v[176:179], v[148:151], v[28:31], v[176:179]
v_fma_f32 v175, v175, v71, -v233
v_fma_f32 v174, v174, v70, -v232
v_mfma_f32_16x16x32_bf16 v[188:191], v[140:143], v[36:39], v[188:191]
s_nop 0
v_cvt_pk_bf16_f32 v197, v170, v171
v_cvt_pk_bf16_f32 v195, v166, v167
v_mfma_f32_16x16x32_bf16 v[184:187], v[132:135], v[36:39], v[184:187]
s_nop 0
v_mul_f32 v232, v176, v72
v_mul_f32 v233, v177, v73
v_mfma_f32_16x16x32_bf16 v[164:167], v[44:47], v[192:195], 0
v_cvt_pk_bf16_f32 v199, v174, v175
v_mul_f32 v176, v176, v64
v_mfma_f32_16x16x32_bf16 v[180:183], v[140:143], v[20:23], v[180:183]
s_nop 0
v_fma_f32 v176, v184, v72, v176
v_fma_f32 v184, v184, v64, -v232
v_mfma_f32_16x16x32_bf16 v[164:167], v[52:55], v[196:199], v[164:167]
v_mul_f32 v232, v178, v74
v_mul_f32 v177, v177, v65
v_mfma_f32_16x16x32_bf16 v[168:171], v[40:43], v[196:199], 0
v_mul_f32 v178, v178, v66
v_fma_f32 v177, v185, v73, v177
v_mfma_f32_16x16x32_bf16 v[180:183], v[156:159], v[28:31], v[180:183]
v_fma_f32 v185, v185, v65, -v233
v_lshlrev_b32 v111, 16, v223
v_fma_f32 v178, v186, v74, v178
v_mfma_f32_16x16x32_bf16 v[172:175], v[44:47], v[196:199], 0
v_mul_f32 v233, v179, v75
v_mul_f32 v179, v179, v67
v_mfma_f32_16x16x32_bf16 v[168:171], v[56:59], v[192:195], v[168:171]
v_fma_f32 v179, v187, v75, v179
v_fma_f32 v186, v186, v66, -v232
v_mfma_f32_16x16x32_bf16 v[160:163], v[40:43], v[192:195], 0
v_fma_f32 v187, v187, v67, -v233
v_mul_f32 v233, v181, v77
v_mfma_f32_16x16x32_bf16 v[160:163], v[48:51], v[196:199], v[160:163]
v_cvt_pk_bf16_f32 v200, v176, v177
v_mul_f32 v232, v180, v76
v_mul_f32 v181, v181, v69
v_fma_f32 v181, v189, v77, v181
v_mul_f32 v180, v180, v68
v_fma_f32 v180, v188, v76, v180
v_mfma_f32_16x16x32_bf16 v[172:175], v[60:63], v[192:195], v[172:175]
v_fma_f32 v189, v189, v69, -v233
v_mul_f32 v233, v183, v79
v_lshlrev_b32 v97, 16, v216
v_fma_f32 v188, v188, v68, -v232
v_mul_f32 v183, v183, v71
v_fma_f32 v183, v191, v79, v183
v_cvt_pk_bf16_f32 v205, v186, v187
v_mul_f32 v232, v182, v78
v_mul_f32 v182, v182, v70
v_cvt_pk_bf16_f32 v201, v178, v179
v_fma_f32 v182, v190, v78, v182
v_cvt_pk_bf16_f32 v203, v182, v183
v_cvt_pk_bf16_f32 v202, v180, v181
v_cvt_pk_bf16_f32 v204, v184, v185
v_fma_f32 v190, v190, v70, -v232
v_mfma_f32_16x16x32_bf16 v[176:179], v[40:43], v[200:203], 0
v_lshlrev_b32 v98, 16, v209
v_lshlrev_b32 v99, 16, v217
v_mfma_f32_16x16x32_bf16 v[180:183], v[44:47], v[200:203], 0
v_mul_f32 v232, v160, v97
v_cvt_pk_bf16_f32 v206, v188, v189
v_fma_f32 v191, v191, v71, -v233
v_cvt_pk_bf16_f32 v207, v190, v191
v_lshlrev_b32 v106, 16, v213
v_and_b32 v118, 0xffff0000, v211
v_mfma_f32_16x16x32_bf16 v[188:191], v[44:47], v[204:207], 0
v_mul_f32 v233, v161, v99
v_mul_f32 v161, v161, v98
v_mfma_f32_16x16x32_bf16 v[176:179], v[48:51], v[204:207], v[176:179]
v_lshlrev_b32 v104, 16, v212
v_and_b32 v117, 0xffff0000, v218
v_lshlrev_b32 v96, 16, v208
v_mfma_f32_16x16x32_bf16 v[184:187], v[40:43], v[204:207], 0
v_mul_f32 v160, v160, v96
v_fma_f32 v161, v169, -v99, v161
v_mfma_f32_16x16x32_bf16 v[184:187], v[56:59], v[200:203], v[184:187]
v_fma_f32 v160, v168, -v97, v160
v_fma_f32 v169, v169, v98, v233
v_mfma_f32_16x16x32_bf16 v[188:191], v[60:63], v[200:203], v[188:191]
v_lshlrev_b32 v101, 16, v218
v_lshlrev_b32 v103, 16, v219
v_mfma_f32_16x16x32_bf16 v[180:183], v[52:55], v[204:207], v[180:183]
v_lshlrev_b32 v105, 16, v220
v_lshlrev_b32 v109, 16, v222
v_lshlrev_b32 v100, 16, v210
v_fma_f32 v168, v168, v96, v232
v_mul_f32 v233, v163, v103
v_lshlrev_b32 v102, 16, v211
v_mul_f32 v232, v162, v101
v_mul_f32 v163, v163, v102
v_mul_f32 v162, v162, v100
v_cvt_pk_bf16_f32 v196, v168, v169
v_fma_f32 v162, v170, -v101, v162
v_fma_f32 v163, v171, -v103, v163
v_fma_f32 v171, v171, v102, v233
v_fma_f32 v170, v170, v100, v232
v_and_b32 v126, 0xffff0000, v215
v_cvt_pk_bf16_f32 v193, v162, v163
v_and_b32 v112, 0xffff0000, v208
v_mul_f32 v232, v164, v105
v_mul_f32 v164, v164, v104
v_lshlrev_b32 v107, 16, v221
v_lshlrev_b32 v108, 16, v214
v_mul_f32 v233, v165, v107
v_mul_f32 v165, v165, v106
v_and_b32 v123, 0xffff0000, v221
v_cvt_pk_bf16_f32 v197, v170, v171
v_fma_f32 v164, v172, -v105, v164
v_fma_f32 v172, v172, v104, v232
v_fma_f32 v165, v173, -v107, v165
v_lshlrev_b32 v110, 16, v215
v_mul_f32 v232, v166, v109
v_mul_f32 v166, v166, v108
v_fma_f32 v166, v174, -v109, v166
v_fma_f32 v173, v173, v106, v233
v_mul_f32 v233, v167, v111
v_mul_f32 v167, v167, v110
v_and_b32 v113, 0xffff0000, v216
v_fma_f32 v167, v175, -v111, v167
v_and_b32 v115, 0xffff0000, v217
v_fma_f32 v174, v174, v108, v232
v_fma_f32 v175, v175, v110, v233
v_cvt_pk_bf16_f32 v192, v160, v161
v_cvt_pk_bf16_f32 v199, v174, v175
v_cvt_pk_bf16_f32 v198, v172, v173
v_mul_f32 v232, v176, v113
v_cvt_pk_bf16_f32 v194, v164, v165
v_mfma_f32_16x16x32_bf16 v[172:175], v[196:199], v[44:47], 0
v_mul_f32 v233, v177, v115
v_and_b32 v114, 0xffff0000, v209
v_mfma_f32_16x16x32_bf16 v[168:171], v[196:199], v[40:43], 0
v_cvt_pk_bf16_f32 v195, v166, v167
v_and_b32 v116, 0xffff0000, v210
v_mul_f32 v177, v177, v114
v_mfma_f32_16x16x32_bf16 v[160:163], v[192:195], v[40:43], 0
v_and_b32 v127, 0xffff0000, v223
v_mul_f32 v176, v176, v112
v_fma_f32 v176, v184, -v113, v176
v_mfma_f32_16x16x32_bf16 v[168:171], v[192:195], v[48:51], v[168:171]
v_fma_f32 v177, v185, -v115, v177
v_fma_f32 v184, v184, v112, v232
v_mfma_f32_16x16x32_bf16 v[160:163], v[196:199], v[56:59], v[160:163]
v_fma_f32 v185, v185, v114, v233
v_mul_f32 v232, v178, v117
v_and_b32 v119, 0xffff0000, v219
v_mul_f32 v178, v178, v116
v_and_b32 v125, 0xffff0000, v222
v_mfma_f32_16x16x32_bf16 v[172:175], v[192:195], v[52:55], v[172:175]
v_cvt_pk_bf16_f32 v204, v184, v185
v_mul_f32 v233, v179, v119
v_fma_f32 v178, v186, -v117, v178
v_mul_f32 v179, v179, v118
v_mfma_f32_16x16x32_bf16 v[164:167], v[192:195], v[44:47], 0
v_fma_f32 v179, v187, -v119, v179
v_fma_f32 v186, v186, v116, v232
v_and_b32 v122, 0xffff0000, v213
v_mfma_f32_16x16x32_bf16 v[164:167], v[196:199], v[60:63], v[164:167]
v_and_b32 v120, 0xffff0000, v212
v_and_b32 v121, 0xffff0000, v220
v_mul_f32 v232, v180, v121
v_and_b32 v124, 0xffff0000, v214
v_fma_f32 v187, v187, v118, v233
v_mul_f32 v233, v181, v123
v_cvt_pk_bf16_f32 v205, v186, v187
v_mul_f32 v180, v180, v120
v_mul_f32 v181, v181, v122
v_cvt_pk_bf16_f32 v201, v178, v179
v_fma_f32 v180, v188, -v121, v180
v_fma_f32 v188, v188, v120, v232
v_fma_f32 v181, v189, -v123, v181
v_fma_f32 v189, v189, v122, v233
v_mul_f32 v233, v183, v127
v_mul_f32 v232, v182, v125
v_mul_f32 v182, v182, v124
v_fma_f32 v182, v190, -v125, v182
v_mul_f32 v183, v183, v126
v_fma_f32 v183, v191, -v127, v183
v_cvt_pk_bf16_f32 v206, v188, v189
v_fma_f32 v190, v190, v124, v232
v_fma_f32 v191, v191, v126, v233
v_cvt_pk_bf16_f32 v207, v190, v191
v_cvt_pk_bf16_f32 v203, v182, v183
v_cvt_pk_bf16_f32 v200, v176, v177
v_cvt_pk_bf16_f32 v202, v180, v181
v_mul_f32 v233, v161, v89
v_mfma_f32_16x16x32_bf16 v[184:187], v[204:207], v[40:43], 0
v_mul_f32 v161, v161, v81
v_mul_f32 v232, v160, v88
v_mfma_f32_16x16x32_bf16 v[176:179], v[200:203], v[40:43], 0
v_fma_f32 v161, v169, -v89, v161
v_fma_f32 v169, v169, v81, v233
v_mfma_f32_16x16x32_bf16 v[188:191], v[204:207], v[44:47], 0
v_mul_f32 v160, v160, v80
v_fma_f32 v160, v168, -v88, v160
v_mfma_f32_16x16x32_bf16 v[176:179], v[204:207], v[56:59], v[176:179]
v_fma_f32 v168, v168, v80, v232
v_mul_f32 v233, v163, v91
v_mfma_f32_16x16x32_bf16 v[180:183], v[200:203], v[44:47], 0
v_mul_f32 v163, v163, v83
v_mul_f32 v232, v162, v90
v_fma_f32 v163, v171, -v91, v163
v_mfma_f32_16x16x32_bf16 v[180:183], v[204:207], v[60:63], v[180:183]
v_mul_f32 v162, v162, v82
v_fma_f32 v162, v170, -v90, v162
v_fma_f32 v171, v171, v83, v233
v_mfma_f32_16x16x32_bf16 v[184:187], v[200:203], v[48:51], v[184:187]
v_cvt_pk_bf16_f32 v196, v168, v169
v_mul_f32 v233, v165, v93
v_fma_f32 v170, v170, v82, v232
v_mul_f32 v232, v164, v92
v_mul_f32 v164, v164, v84
v_mul_f32 v165, v165, v85
v_fma_f32 v164, v172, -v92, v164
v_fma_f32 v165, v173, -v93, v165
v_fma_f32 v173, v173, v85, v233
v_fma_f32 v172, v172, v84, v232
v_mul_f32 v233, v167, v95
v_mul_f32 v232, v166, v94
v_mul_f32 v167, v167, v87
v_mul_f32 v166, v166, v86
v_fma_f32 v167, v175, -v95, v167
v_fma_f32 v166, v174, -v94, v166
v_fma_f32 v174, v174, v86, v232
v_mul_f32 v232, v176, v88
v_fma_f32 v175, v175, v87, v233
v_cvt_pk_bf16_f32 v194, v164, v165
v_mul_f32 v233, v177, v89
v_mul_f32 v176, v176, v80
v_mul_f32 v177, v177, v81
v_fma_f32 v176, v184, -v88, v176
v_cvt_pk_bf16_f32 v195, v166, v167
v_fma_f32 v184, v184, v80, v232
v_cvt_pk_bf16_f32 v197, v170, v171
v_mfma_f32_16x16x32_bf16 v[188:191], v[200:203], v[52:55], v[188:191]
ds_write_b64 v234, v[196:197] offset:20480
ds_write_b64 v234, v[194:195] offset:18432
v_cvt_pk_bf16_f32 v199, v174, v175
v_mul_f32 v232, v178, v90
v_mul_f32 v178, v178, v82
v_fma_f32 v177, v185, -v89, v177
v_fma_f32 v185, v185, v81, v233
v_cvt_pk_bf16_f32 v200, v176, v177
v_cvt_pk_bf16_f32 v193, v162, v163
v_fma_f32 v178, v186, -v90, v178
v_fma_f32 v186, v186, v82, v232
v_mul_f32 v233, v179, v91
v_mul_f32 v179, v179, v83
v_cvt_pk_bf16_f32 v204, v184, v185
v_mul_f32 v232, v180, v92
v_cvt_pk_bf16_f32 v192, v160, v161
v_cvt_pk_bf16_f32 v198, v172, v173
v_fma_f32 v179, v187, -v91, v179
v_fma_f32 v187, v187, v83, v233
v_mul_f32 v180, v180, v84
v_cvt_pk_bf16_f32 v205, v186, v187
v_fma_f32 v180, v188, -v92, v180
v_mul_f32 v233, v181, v93
ds_write_b64 v234, v[204:205] offset:28672
ds_write_b64 v234, v[198:199] offset:22528
ds_write_b64 v234, v[192:193] offset:16384
v_mul_f32 v181, v181, v85
v_fma_f32 v181, v189, -v93, v181
v_fma_f32 v189, v189, v85, v233
v_fma_f32 v188, v188, v84, v232
v_cvt_pk_bf16_f32 v202, v180, v181
v_mul_f32 v232, v182, v94
v_mul_f32 v233, v183, v95
v_mul_f32 v182, v182, v86
v_fma_f32 v182, v190, -v94, v182
v_mul_f32 v183, v183, v87
v_fma_f32 v183, v191, -v95, v183
v_cvt_pk_bf16_f32 v201, v178, v179
v_cvt_pk_bf16_f32 v203, v182, v183
s_waitcnt lgkmcnt(0)
ds_write_b64 v234, v[200:201] offset:24576
ds_write_b64 v234, v[202:203] offset:26624
v_fma_f32 v191, v191, v87, v233
v_fma_f32 v190, v190, v86, v232
v_cvt_pk_bf16_f32 v207, v190, v191
v_cvt_pk_bf16_f32 v206, v188, v189
s_waitcnt lgkmcnt(0)
ds_write_b64 v234, v[206:207] offset:30720
s_waitcnt lgkmcnt(0)
s_barrier
ds_read_b128 v[112:115], v0 offset:20480
ds_read_b128 v[96:99], v0 offset:16384
ds_read_b128 v[128:131], v0 offset:24576
ds_read_b128 v[104:107], v0 offset:18432
ds_read_b128 v[100:103], v0 offset:17408
ds_read_b128 v[144:147], v0 offset:28672
ds_read_b128 v[116:119], v0 offset:21504
ds_read_b128 v[120:123], v0 offset:22528
ds_read_b128 v[156:159], v0 offset:31744
s_waitcnt lgkmcnt(8)
v_mfma_f32_16x16x32_bf16 v[168:171], v[112:115], v[16:19], 0
s_waitcnt lgkmcnt(7)
v_mfma_f32_16x16x32_bf16 v[160:163], v[96:99], v[16:19], 0
ds_read_b128 v[124:127], v0 offset:23552
v_mfma_f32_16x16x32_bf16 v[168:171], v[96:99], v[24:27], v[168:171]
s_waitcnt lgkmcnt(7)
ds_read_b128 v[148:151], v0 offset:29696
v_mfma_f32_16x16x32_bf16 v[160:163], v[112:115], v[32:35], v[160:163]
v_mfma_f32_16x16x32_bf16 v[176:179], v[128:131], v[16:19], 0
s_waitcnt lgkmcnt(7)
ds_read_b128 v[152:155], v0 offset:30720
v_mfma_f32_16x16x32_bf16 v[164:167], v[104:107], v[16:19], 0
s_waitcnt lgkmcnt(6)
s_waitcnt lgkmcnt(5)
v_mfma_f32_16x16x32_bf16 v[184:187], v[144:147], v[16:19], 0
ds_read_b128 v[108:111], v0 offset:19456
v_mfma_f32_16x16x32_bf16 v[168:171], v[116:119], v[20:23], v[168:171]
v_mfma_f32_16x16x32_bf16 v[160:163], v[100:103], v[20:23], v[160:163]
ds_read_b128 v[140:143], v0 offset:27648
s_waitcnt lgkmcnt(4)
v_mfma_f32_16x16x32_bf16 v[168:171], v[100:103], v[28:31], v[168:171]
ds_read_b128 v[132:135], v0 offset:25600
v_mfma_f32_16x16x32_bf16 v[164:167], v[120:123], v[32:35], v[164:167]
v_mfma_f32_16x16x32_bf16 v[160:163], v[116:119], v[36:39], v[160:163]
s_nop 0
s_waitcnt lgkmcnt(2)
v_mfma_f32_16x16x32_bf16 v[172:175], v[120:123], v[16:19], 0
s_nop 0
ds_read_b128 v[136:139], v0 offset:26624
s_nop 0
v_mfma_f32_16x16x32_bf16 v[172:175], v[104:107], v[24:27], v[172:175]
s_nop 0
v_cvt_pk_bf16_f32 v192, v160, v161
v_mfma_f32_16x16x32_bf16 v[172:175], v[124:127], v[20:23], v[172:175]
v_mfma_f32_16x16x32_bf16 v[172:175], v[108:111], v[28:31], v[172:175]
v_mfma_f32_16x16x32_bf16 v[164:167], v[108:111], v[20:23], v[164:167]
s_waitcnt lgkmcnt(1)
v_cvt_pk_bf16_f32 v193, v162, v163
v_cvt_pk_bf16_f32 v197, v170, v171
v_mfma_f32_16x16x32_bf16 v[164:167], v[124:127], v[36:39], v[164:167]
v_mfma_f32_16x16x32_bf16 v[176:179], v[144:147], v[32:35], v[176:179]
v_cvt_pk_bf16_f32 v196, v168, v169
v_mfma_f32_16x16x32_bf16 v[176:179], v[132:135], v[20:23], v[176:179]
s_waitcnt lgkmcnt(0)
v_mfma_f32_16x16x32_bf16 v[176:179], v[148:151], v[36:39], v[176:179]
s_nop 1
v_mfma_f32_16x16x32_bf16 v[184:187], v[128:131], v[24:27], v[184:187]
s_nop 0
v_cvt_pk_bf16_f32 v195, v166, v167
s_nop 0
v_mfma_f32_16x16x32_bf16 v[180:183], v[136:139], v[16:19], 0
s_nop 0
v_cvt_pk_bf16_f32 v201, v178, v179
v_mfma_f32_16x16x32_bf16 v[180:183], v[152:155], v[32:35], v[180:183]
v_cvt_pk_bf16_f32 v199, v174, v175
v_mfma_f32_16x16x32_bf16 v[180:183], v[140:143], v[20:23], v[180:183]
v_cvt_pk_bf16_f32 v200, v176, v177
v_mfma_f32_16x16x32_bf16 v[180:183], v[156:159], v[36:39], v[180:183]
v_cvt_pk_bf16_f32 v198, v172, v173
v_mfma_f32_16x16x32_bf16 v[184:187], v[148:151], v[20:23], v[184:187]
s_nop 2
v_mfma_f32_16x16x32_bf16 v[184:187], v[132:135], v[28:31], v[184:187]
s_nop 0
v_cvt_pk_bf16_f32 v194, v164, v165
v_cvt_pk_bf16_f32 v203, v182, v183
v_mfma_f32_16x16x32_bf16 v[188:191], v[152:155], v[16:19], 0
v_cvt_pk_bf16_f32 v202, v180, v181
v_mfma_f32_16x16x32_bf16 v[188:191], v[136:139], v[24:27], v[188:191]
buffer_store_dwordx4 v[192:195], v235, s[4:7], s27 offen offset:0 sc1
v_mfma_f32_16x16x32_bf16 v[188:191], v[156:159], v[20:23], v[188:191]
v_cvt_pk_bf16_f32 v205, v186, v187
v_cvt_pk_bf16_f32 v204, v184, v185
v_mfma_f32_16x16x32_bf16 v[188:191], v[140:143], v[28:31], v[188:191]
buffer_store_dwordx4 v[196:199], v235, s[4:7], s27 offen offset:64 sc1
s_nop 2
buffer_store_dwordx4 v[200:203], v235, s[4:7], s27 offen offset:128 sc1
s_nop 2
v_cvt_pk_bf16_f32 v207, v190, v191
v_cvt_pk_bf16_f32 v206, v188, v189
buffer_store_dwordx4 v[204:207], v235, s[4:7], s27 offen offset:192 sc1
s_lshl_b32 s18, s39, 7
s_add_u32 s18, s18, 11591680
s_add_u32 s29, s16, 1
s_cmp_eq_u32 s13, 0
s_cselect_b32 s22, s18, s6
s_mov_b32 s23, s29
s_lshl_b32 s18, s34, 7
s_lshl_b32 s19, s13, 5
s_add_u32 s18, s18, s19
s_mov_b32 s19, 0x3acccccd
v_bfe_u32 v222, v0, 4, 5
v_lshrrev_b32 v217, 9, v0
v_and_b32 v220, 19, v222
v_bfe_u32 v223, v222, 2, 1
v_lshl_add_u32 v220, v223, 3, v220
v_bfe_u32 v223, v222, 3, 1
v_lshl_add_u32 v220, v223, 2, v220
v_add_u32 v220, s18, v220
v_lshlrev_b32 v217, 2, v217
v_mov_b32 v221, 0
v_mad_u32_u24 v221, v217, v220, v221
v_mad_u32_u24 v216, v220, 8, 0
v_cvt_f32_u32 v216, v216
v_mul_f32 v222, s19, v216
v_rndne_f32 v222, v222
v_fmac_f32 v216, 0xc4200000, v222
v_mul_f32 v216, s19, v216
v_cos_f32 v216, v216
s_nop 0
v_add_f32 v216, v216, v216
v_mad_u32_u24 v218, v220, 1, 0
v_cvt_f32_u32 v218, v218
v_mul_f32 v222, s19, v218
v_rndne_f32 v222, v222
v_fmac_f32 v218, 0xc4200000, v222
v_mul_f32 v218, s19, v218
v_cos_f32 v218, v218
s_nop 0
v_add_f32 v218, v218, v218
v_mad_u32_u24 v200, v220, 1, v221
v_cvt_f32_u32 v200, v200
v_mul_f32 v222, s19, v200
v_rndne_f32 v222, v222
v_fmac_f32 v200, 0xc4200000, v222
v_mul_f32 v200, s19, v200
v_sin_f32 v201, -v200
v_cos_f32 v200, v200
v_mad_u32_u24 v202, v220, 2, v221
v_cvt_f32_u32 v202, v202
v_mul_f32 v222, s19, v202
v_rndne_f32 v222, v222
v_fmac_f32 v202, 0xc4200000, v222
v_mul_f32 v202, s19, v202
v_sin_f32 v203, -v202
v_cos_f32 v202, v202
s_nop 0
v_pk_fma_f32 v[204:205], v[218:219], v[202:203], v[200:201] op_sel_hi:[0,1,1] neg_lo:[0,0,1] neg_hi:[0,0,1]
v_pk_fma_f32 v[206:207], v[218:219], v[204:205], v[202:203] op_sel_hi:[0,1,1] neg_lo:[0,0,1] neg_hi:[0,0,1]
v_cvt_pk_bf16_f32 v16, v200, v201
v_cvt_pk_bf16_f32 v17, v202, v203
v_cvt_pk_bf16_f32 v18, v204, v205
v_cvt_pk_bf16_f32 v19, v206, v207
v_mad_u32_u24 v208, v220, 9, v221
v_cvt_f32_u32 v208, v208
v_mul_f32 v222, s19, v208
v_rndne_f32 v222, v222
v_fmac_f32 v208, 0xc4200000, v222
v_mul_f32 v208, s19, v208
v_sin_f32 v209, -v208
v_cos_f32 v208, v208
v_mad_u32_u24 v210, v220, 10, v221
v_cvt_f32_u32 v210, v210
v_mul_f32 v222, s19, v210
v_rndne_f32 v222, v222
v_fmac_f32 v210, 0xc4200000, v222
v_mul_f32 v210, s19, v210
v_sin_f32 v211, -v210
v_cos_f32 v210, v210
s_nop 0
v_pk_fma_f32 v[212:213], v[218:219], v[210:211], v[208:209] op_sel_hi:[0,1,1] neg_lo:[0,0,1] neg_hi:[0,0,1]
v_pk_fma_f32 v[214:215], v[218:219], v[212:213], v[210:211] op_sel_hi:[0,1,1] neg_lo:[0,0,1] neg_hi:[0,0,1]
v_cvt_pk_bf16_f32 v20, v208, v209
v_cvt_pk_bf16_f32 v21, v210, v211
v_cvt_pk_bf16_f32 v22, v212, v213
v_cvt_pk_bf16_f32 v23, v214, v215
v_pk_fma_f32 v[200:201], v[216:217], v[208:209], v[200:201] op_sel_hi:[0,1,1] neg_lo:[0,0,1] neg_hi:[0,0,1]
v_pk_fma_f32 v[202:203], v[216:217], v[210:211], v[202:203] op_sel_hi:[0,1,1] neg_lo:[0,0,1] neg_hi:[0,0,1]
v_pk_fma_f32 v[204:205], v[216:217], v[212:213], v[204:205] op_sel_hi:[0,1,1] neg_lo:[0,0,1] neg_hi:[0,0,1]
v_pk_fma_f32 v[206:207], v[216:217], v[214:215], v[206:207] op_sel_hi:[0,1,1] neg_lo:[0,0,1] neg_hi:[0,0,1]
v_cvt_pk_bf16_f32 v24, v200, v201
v_cvt_pk_bf16_f32 v25, v202, v203
v_cvt_pk_bf16_f32 v26, v204, v205
v_cvt_pk_bf16_f32 v27, v206, v207
v_pk_fma_f32 v[208:209], v[216:217], v[200:201], v[208:209] op_sel_hi:[0,1,1] neg_lo:[0,0,1] neg_hi:[0,0,1]
v_pk_fma_f32 v[210:211], v[216:217], v[202:203], v[210:211] op_sel_hi:[0,1,1] neg_lo:[0,0,1] neg_hi:[0,0,1]
v_pk_fma_f32 v[212:213], v[216:217], v[204:205], v[212:213] op_sel_hi:[0,1,1] neg_lo:[0,0,1] neg_hi:[0,0,1]
v_pk_fma_f32 v[214:215], v[216:217], v[206:207], v[214:215] op_sel_hi:[0,1,1] neg_lo:[0,0,1] neg_hi:[0,0,1]
v_cvt_pk_bf16_f32 v28, v208, v209
v_cvt_pk_bf16_f32 v29, v210, v211
v_cvt_pk_bf16_f32 v30, v212, v213
v_cvt_pk_bf16_f32 v31, v214, v215
v_pk_fma_f32 v[200:201], v[216:217], v[208:209], v[200:201] op_sel_hi:[0,1,1] neg_lo:[0,0,1] neg_hi:[0,0,1]
v_pk_fma_f32 v[202:203], v[216:217], v[210:211], v[202:203] op_sel_hi:[0,1,1] neg_lo:[0,0,1] neg_hi:[0,0,1]
v_pk_fma_f32 v[204:205], v[216:217], v[212:213], v[204:205] op_sel_hi:[0,1,1] neg_lo:[0,0,1] neg_hi:[0,0,1]
v_pk_fma_f32 v[206:207], v[216:217], v[214:215], v[206:207] op_sel_hi:[0,1,1] neg_lo:[0,0,1] neg_hi:[0,0,1]
v_cvt_pk_bf16_f32 v32, v200, v201
v_cvt_pk_bf16_f32 v33, v202, v203
v_cvt_pk_bf16_f32 v34, v204, v205
v_cvt_pk_bf16_f32 v35, v206, v207
v_pk_fma_f32 v[208:209], v[216:217], v[200:201], v[208:209] op_sel_hi:[0,1,1] neg_lo:[0,0,1] neg_hi:[0,0,1]
v_pk_fma_f32 v[210:211], v[216:217], v[202:203], v[210:211] op_sel_hi:[0,1,1] neg_lo:[0,0,1] neg_hi:[0,0,1]
v_pk_fma_f32 v[212:213], v[216:217], v[204:205], v[212:213] op_sel_hi:[0,1,1] neg_lo:[0,0,1] neg_hi:[0,0,1]
v_pk_fma_f32 v[214:215], v[216:217], v[206:207], v[214:215] op_sel_hi:[0,1,1] neg_lo:[0,0,1] neg_hi:[0,0,1]
v_cvt_pk_bf16_f32 v36, v208, v209
v_cvt_pk_bf16_f32 v37, v210, v211
v_cvt_pk_bf16_f32 v38, v212, v213
v_cvt_pk_bf16_f32 v39, v214, v215
v_pk_fma_f32 v[200:201], v[216:217], v[208:209], v[200:201] op_sel_hi:[0,1,1] neg_lo:[0,0,1] neg_hi:[0,0,1]
v_pk_fma_f32 v[202:203], v[216:217], v[210:211], v[202:203] op_sel_hi:[0,1,1] neg_lo:[0,0,1] neg_hi:[0,0,1]
v_pk_fma_f32 v[204:205], v[216:217], v[212:213], v[204:205] op_sel_hi:[0,1,1] neg_lo:[0,0,1] neg_hi:[0,0,1]
v_pk_fma_f32 v[206:207], v[216:217], v[214:215], v[206:207] op_sel_hi:[0,1,1] neg_lo:[0,0,1] neg_hi:[0,0,1]
v_cvt_pk_bf16_f32 v40, v200, v201
v_cvt_pk_bf16_f32 v41, v202, v203
v_cvt_pk_bf16_f32 v42, v204, v205
v_cvt_pk_bf16_f32 v43, v206, v207
v_pk_fma_f32 v[208:209], v[216:217], v[200:201], v[208:209] op_sel_hi:[0,1,1] neg_lo:[0,0,1] neg_hi:[0,0,1]
v_pk_fma_f32 v[210:211], v[216:217], v[202:203], v[210:211] op_sel_hi:[0,1,1] neg_lo:[0,0,1] neg_hi:[0,0,1]
v_pk_fma_f32 v[212:213], v[216:217], v[204:205], v[212:213] op_sel_hi:[0,1,1] neg_lo:[0,0,1] neg_hi:[0,0,1]
v_pk_fma_f32 v[214:215], v[216:217], v[206:207], v[214:215] op_sel_hi:[0,1,1] neg_lo:[0,0,1] neg_hi:[0,0,1]
v_cvt_pk_bf16_f32 v44, v208, v209
v_cvt_pk_bf16_f32 v45, v210, v211
v_cvt_pk_bf16_f32 v46, v212, v213
v_cvt_pk_bf16_f32 v47, v214, v215
v_pk_fma_f32 v[200:201], v[216:217], v[208:209], v[200:201] op_sel_hi:[0,1,1] neg_lo:[0,0,1] neg_hi:[0,0,1]
v_pk_fma_f32 v[202:203], v[216:217], v[210:211], v[202:203] op_sel_hi:[0,1,1] neg_lo:[0,0,1] neg_hi:[0,0,1]
v_pk_fma_f32 v[204:205], v[216:217], v[212:213], v[204:205] op_sel_hi:[0,1,1] neg_lo:[0,0,1] neg_hi:[0,0,1]
v_pk_fma_f32 v[206:207], v[216:217], v[214:215], v[206:207] op_sel_hi:[0,1,1] neg_lo:[0,0,1] neg_hi:[0,0,1]
v_cvt_pk_bf16_f32 v48, v200, v201
v_cvt_pk_bf16_f32 v49, v202, v203
v_cvt_pk_bf16_f32 v50, v204, v205
v_cvt_pk_bf16_f32 v51, v206, v207
v_pk_fma_f32 v[208:209], v[216:217], v[200:201], v[208:209] op_sel_hi:[0,1,1] neg_lo:[0,0,1] neg_hi:[0,0,1]
v_pk_fma_f32 v[210:211], v[216:217], v[202:203], v[210:211] op_sel_hi:[0,1,1] neg_lo:[0,0,1] neg_hi:[0,0,1]
v_pk_fma_f32 v[212:213], v[216:217], v[204:205], v[212:213] op_sel_hi:[0,1,1] neg_lo:[0,0,1] neg_hi:[0,0,1]
v_pk_fma_f32 v[214:215], v[216:217], v[206:207], v[214:215] op_sel_hi:[0,1,1] neg_lo:[0,0,1] neg_hi:[0,0,1]
v_cvt_pk_bf16_f32 v52, v208, v209
v_cvt_pk_bf16_f32 v53, v210, v211
v_cvt_pk_bf16_f32 v54, v212, v213
v_cvt_pk_bf16_f32 v55, v214, v215
v_pk_fma_f32 v[200:201], v[216:217], v[208:209], v[200:201] op_sel_hi:[0,1,1] neg_lo:[0,0,1] neg_hi:[0,0,1]
v_pk_fma_f32 v[202:203], v[216:217], v[210:211], v[202:203] op_sel_hi:[0,1,1] neg_lo:[0,0,1] neg_hi:[0,0,1]
v_pk_fma_f32 v[204:205], v[216:217], v[212:213], v[204:205] op_sel_hi:[0,1,1] neg_lo:[0,0,1] neg_hi:[0,0,1]
v_pk_fma_f32 v[206:207], v[216:217], v[214:215], v[206:207] op_sel_hi:[0,1,1] neg_lo:[0,0,1] neg_hi:[0,0,1]
v_cvt_pk_bf16_f32 v56, v200, v201
v_cvt_pk_bf16_f32 v57, v202, v203
v_cvt_pk_bf16_f32 v58, v204, v205
v_cvt_pk_bf16_f32 v59, v206, v207
v_pk_fma_f32 v[208:209], v[216:217], v[200:201], v[208:209] op_sel_hi:[0,1,1] neg_lo:[0,0,1] neg_hi:[0,0,1]
v_pk_fma_f32 v[210:211], v[216:217], v[202:203], v[210:211] op_sel_hi:[0,1,1] neg_lo:[0,0,1] neg_hi:[0,0,1]
v_pk_fma_f32 v[212:213], v[216:217], v[204:205], v[212:213] op_sel_hi:[0,1,1] neg_lo:[0,0,1] neg_hi:[0,0,1]
v_pk_fma_f32 v[214:215], v[216:217], v[206:207], v[214:215] op_sel_hi:[0,1,1] neg_lo:[0,0,1] neg_hi:[0,0,1]
v_cvt_pk_bf16_f32 v60, v208, v209
v_cvt_pk_bf16_f32 v61, v210, v211
v_cvt_pk_bf16_f32 v62, v212, v213
v_cvt_pk_bf16_f32 v63, v214, v215
v_pk_fma_f32 v[200:201], v[216:217], v[208:209], v[200:201] op_sel_hi:[0,1,1] neg_lo:[0,0,1] neg_hi:[0,0,1]
v_pk_fma_f32 v[202:203], v[216:217], v[210:211], v[202:203] op_sel_hi:[0,1,1] neg_lo:[0,0,1] neg_hi:[0,0,1]
v_pk_fma_f32 v[204:205], v[216:217], v[212:213], v[204:205] op_sel_hi:[0,1,1] neg_lo:[0,0,1] neg_hi:[0,0,1]
v_pk_fma_f32 v[206:207], v[216:217], v[214:215], v[206:207] op_sel_hi:[0,1,1] neg_lo:[0,0,1] neg_hi:[0,0,1]
v_cvt_pk_bf16_f32 v64, v200, v201
v_cvt_pk_bf16_f32 v65, v202, v203
v_cvt_pk_bf16_f32 v66, v204, v205
v_cvt_pk_bf16_f32 v67, v206, v207
s_waitcnt vmcnt(0)
s_barrier
v_mov_b32 v3, s23
s_mov_b64 exec, 1
buffer_store_dword v3, off, s[4:7], s22 sc1
s_mov_b64 exec, -1
s_mov_b32 s22, s6
v_pk_fma_f32 v[208:209], v[216:217], v[200:201], v[208:209] op_sel_hi:[0,1,1] neg_lo:[0,0,1] neg_hi:[0,0,1]
v_pk_fma_f32 v[210:211], v[216:217], v[202:203], v[210:211] op_sel_hi:[0,1,1] neg_lo:[0,0,1] neg_hi:[0,0,1]
v_pk_fma_f32 v[212:213], v[216:217], v[204:205], v[212:213] op_sel_hi:[0,1,1] neg_lo:[0,0,1] neg_hi:[0,0,1]
v_pk_fma_f32 v[214:215], v[216:217], v[206:207], v[214:215] op_sel_hi:[0,1,1] neg_lo:[0,0,1] neg_hi:[0,0,1]
v_cvt_pk_bf16_f32 v68, v208, v209
v_cvt_pk_bf16_f32 v69, v210, v211
v_cvt_pk_bf16_f32 v70, v212, v213
v_cvt_pk_bf16_f32 v71, v214, v215
v_pk_fma_f32 v[200:201], v[216:217], v[208:209], v[200:201] op_sel_hi:[0,1,1] neg_lo:[0,0,1] neg_hi:[0,0,1]
v_pk_fma_f32 v[202:203], v[216:217], v[210:211], v[202:203] op_sel_hi:[0,1,1] neg_lo:[0,0,1] neg_hi:[0,0,1]
v_pk_fma_f32 v[204:205], v[216:217], v[212:213], v[204:205] op_sel_hi:[0,1,1] neg_lo:[0,0,1] neg_hi:[0,0,1]
v_pk_fma_f32 v[206:207], v[216:217], v[214:215], v[206:207] op_sel_hi:[0,1,1] neg_lo:[0,0,1] neg_hi:[0,0,1]
v_cvt_pk_bf16_f32 v72, v200, v201
v_cvt_pk_bf16_f32 v73, v202, v203
v_cvt_pk_bf16_f32 v74, v204, v205
v_cvt_pk_bf16_f32 v75, v206, v207
v_pk_fma_f32 v[208:209], v[216:217], v[200:201], v[208:209] op_sel_hi:[0,1,1] neg_lo:[0,0,1] neg_hi:[0,0,1]
v_pk_fma_f32 v[210:211], v[216:217], v[202:203], v[210:211] op_sel_hi:[0,1,1] neg_lo:[0,0,1] neg_hi:[0,0,1]
v_pk_fma_f32 v[212:213], v[216:217], v[204:205], v[212:213] op_sel_hi:[0,1,1] neg_lo:[0,0,1] neg_hi:[0,0,1]
v_pk_fma_f32 v[214:215], v[216:217], v[206:207], v[214:215] op_sel_hi:[0,1,1] neg_lo:[0,0,1] neg_hi:[0,0,1]
v_cvt_pk_bf16_f32 v76, v208, v209
v_cvt_pk_bf16_f32 v77, v210, v211
v_cvt_pk_bf16_f32 v78, v212, v213
v_cvt_pk_bf16_f32 v79, v214, v215
v_pk_fma_f32 v[200:201], v[216:217], v[208:209], v[200:201] op_sel_hi:[0,1,1] neg_lo:[0,0,1] neg_hi:[0,0,1]
v_pk_fma_f32 v[202:203], v[216:217], v[210:211], v[202:203] op_sel_hi:[0,1,1] neg_lo:[0,0,1] neg_hi:[0,0,1]
v_pk_fma_f32 v[204:205], v[216:217], v[212:213], v[204:205] op_sel_hi:[0,1,1] neg_lo:[0,0,1] neg_hi:[0,0,1]
v_pk_fma_f32 v[206:207], v[216:217], v[214:215], v[206:207] op_sel_hi:[0,1,1] neg_lo:[0,0,1] neg_hi:[0,0,1]
v_cvt_pk_bf16_f32 v80, v200, v201
v_cvt_pk_bf16_f32 v81, v202, v203
v_cvt_pk_bf16_f32 v82, v204, v205
v_cvt_pk_bf16_f32 v83, v206, v207
v_pk_fma_f32 v[208:209], v[216:217], v[200:201], v[208:209] op_sel_hi:[0,1,1] neg_lo:[0,0,1] neg_hi:[0,0,1]
v_pk_fma_f32 v[210:211], v[216:217], v[202:203], v[210:211] op_sel_hi:[0,1,1] neg_lo:[0,0,1] neg_hi:[0,0,1]
v_pk_fma_f32 v[212:213], v[216:217], v[204:205], v[212:213] op_sel_hi:[0,1,1] neg_lo:[0,0,1] neg_hi:[0,0,1]
v_pk_fma_f32 v[214:215], v[216:217], v[206:207], v[214:215] op_sel_hi:[0,1,1] neg_lo:[0,0,1] neg_hi:[0,0,1]
v_cvt_pk_bf16_f32 v84, v208, v209
v_cvt_pk_bf16_f32 v85, v210, v211
v_cvt_pk_bf16_f32 v86, v212, v213
v_cvt_pk_bf16_f32 v87, v214, v215
v_pk_fma_f32 v[200:201], v[216:217], v[208:209], v[200:201] op_sel_hi:[0,1,1] neg_lo:[0,0,1] neg_hi:[0,0,1]
v_pk_fma_f32 v[202:203], v[216:217], v[210:211], v[202:203] op_sel_hi:[0,1,1] neg_lo:[0,0,1] neg_hi:[0,0,1]
v_pk_fma_f32 v[204:205], v[216:217], v[212:213], v[204:205] op_sel_hi:[0,1,1] neg_lo:[0,0,1] neg_hi:[0,0,1]
v_pk_fma_f32 v[206:207], v[216:217], v[214:215], v[206:207] op_sel_hi:[0,1,1] neg_lo:[0,0,1] neg_hi:[0,0,1]
v_cvt_pk_bf16_f32 v88, v200, v201
v_cvt_pk_bf16_f32 v89, v202, v203
v_cvt_pk_bf16_f32 v90, v204, v205
v_cvt_pk_bf16_f32 v91, v206, v207
v_pk_fma_f32 v[208:209], v[216:217], v[200:201], v[208:209] op_sel_hi:[0,1,1] neg_lo:[0,0,1] neg_hi:[0,0,1]
v_pk_fma_f32 v[210:211], v[216:217], v[202:203], v[210:211] op_sel_hi:[0,1,1] neg_lo:[0,0,1] neg_hi:[0,0,1]
v_pk_fma_f32 v[212:213], v[216:217], v[204:205], v[212:213] op_sel_hi:[0,1,1] neg_lo:[0,0,1] neg_hi:[0,0,1]
v_pk_fma_f32 v[214:215], v[216:217], v[206:207], v[214:215] op_sel_hi:[0,1,1] neg_lo:[0,0,1] neg_hi:[0,0,1]
v_cvt_pk_bf16_f32 v92, v208, v209
v_cvt_pk_bf16_f32 v93, v210, v211
v_cvt_pk_bf16_f32 v94, v212, v213
v_cvt_pk_bf16_f32 v95, v214, v215
s_mov_b32 s20, 161
v_mad_u32_u24 v200, v220, s20, v221
v_cvt_f32_u32 v200, v200
v_mul_f32 v222, s19, v200
v_rndne_f32 v222, v222
v_fmac_f32 v200, 0xc4200000, v222
v_mul_f32 v200, s19, v200
v_sin_f32 v201, -v200
v_cos_f32 v200, v200
s_mov_b32 s20, 162
v_mad_u32_u24 v202, v220, s20, v221
v_cvt_f32_u32 v202, v202
v_mul_f32 v222, s19, v202
v_rndne_f32 v222, v222
v_fmac_f32 v202, 0xc4200000, v222
v_mul_f32 v202, s19, v202
v_sin_f32 v203, -v202
v_cos_f32 v202, v202
s_nop 0
v_pk_fma_f32 v[204:205], v[218:219], v[202:203], v[200:201] op_sel_hi:[0,1,1] neg_lo:[0,0,1] neg_hi:[0,0,1]
v_pk_fma_f32 v[206:207], v[218:219], v[204:205], v[202:203] op_sel_hi:[0,1,1] neg_lo:[0,0,1] neg_hi:[0,0,1]
v_cvt_pk_bf16_f32 v96, v200, v201
v_cvt_pk_bf16_f32 v97, v202, v203
v_cvt_pk_bf16_f32 v98, v204, v205
v_cvt_pk_bf16_f32 v99, v206, v207
s_mov_b32 s20, 169
v_mad_u32_u24 v208, v220, s20, v221
v_cvt_f32_u32 v208, v208
v_mul_f32 v222, s19, v208
v_rndne_f32 v222, v222
v_fmac_f32 v208, 0xc4200000, v222
v_mul_f32 v208, s19, v208
v_sin_f32 v209, -v208
v_cos_f32 v208, v208
s_mov_b32 s20, 170
v_mad_u32_u24 v210, v220, s20, v221
v_cvt_f32_u32 v210, v210
v_mul_f32 v222, s19, v210
v_rndne_f32 v222, v222
v_fmac_f32 v210, 0xc4200000, v222
v_mul_f32 v210, s19, v210
v_sin_f32 v211, -v210
v_cos_f32 v210, v210
s_nop 0
v_pk_fma_f32 v[212:213], v[218:219], v[210:211], v[208:209] op_sel_hi:[0,1,1] neg_lo:[0,0,1] neg_hi:[0,0,1]
v_pk_fma_f32 v[214:215], v[218:219], v[212:213], v[210:211] op_sel_hi:[0,1,1] neg_lo:[0,0,1] neg_hi:[0,0,1]
v_cvt_pk_bf16_f32 v100, v208, v209
v_cvt_pk_bf16_f32 v101, v210, v211
v_cvt_pk_bf16_f32 v102, v212, v213
v_cvt_pk_bf16_f32 v103, v214, v215
v_pk_fma_f32 v[200:201], v[216:217], v[208:209], v[200:201] op_sel_hi:[0,1,1] neg_lo:[0,0,1] neg_hi:[0,0,1]
v_pk_fma_f32 v[202:203], v[216:217], v[210:211], v[202:203] op_sel_hi:[0,1,1] neg_lo:[0,0,1] neg_hi:[0,0,1]
v_pk_fma_f32 v[204:205], v[216:217], v[212:213], v[204:205] op_sel_hi:[0,1,1] neg_lo:[0,0,1] neg_hi:[0,0,1]
v_pk_fma_f32 v[206:207], v[216:217], v[214:215], v[206:207] op_sel_hi:[0,1,1] neg_lo:[0,0,1] neg_hi:[0,0,1]
v_cvt_pk_bf16_f32 v104, v200, v201
v_cvt_pk_bf16_f32 v105, v202, v203
v_cvt_pk_bf16_f32 v106, v204, v205
v_cvt_pk_bf16_f32 v107, v206, v207
v_pk_fma_f32 v[208:209], v[216:217], v[200:201], v[208:209] op_sel_hi:[0,1,1] neg_lo:[0,0,1] neg_hi:[0,0,1]
v_pk_fma_f32 v[210:211], v[216:217], v[202:203], v[210:211] op_sel_hi:[0,1,1] neg_lo:[0,0,1] neg_hi:[0,0,1]
v_pk_fma_f32 v[212:213], v[216:217], v[204:205], v[212:213] op_sel_hi:[0,1,1] neg_lo:[0,0,1] neg_hi:[0,0,1]
v_pk_fma_f32 v[214:215], v[216:217], v[206:207], v[214:215] op_sel_hi:[0,1,1] neg_lo:[0,0,1] neg_hi:[0,0,1]
v_cvt_pk_bf16_f32 v108, v208, v209
v_cvt_pk_bf16_f32 v109, v210, v211
v_cvt_pk_bf16_f32 v110, v212, v213
v_cvt_pk_bf16_f32 v111, v214, v215
v_pk_fma_f32 v[200:201], v[216:217], v[208:209], v[200:201] op_sel_hi:[0,1,1] neg_lo:[0,0,1] neg_hi:[0,0,1]
v_pk_fma_f32 v[202:203], v[216:217], v[210:211], v[202:203] op_sel_hi:[0,1,1] neg_lo:[0,0,1] neg_hi:[0,0,1]
v_pk_fma_f32 v[204:205], v[216:217], v[212:213], v[204:205] op_sel_hi:[0,1,1] neg_lo:[0,0,1] neg_hi:[0,0,1]
v_pk_fma_f32 v[206:207], v[216:217], v[214:215], v[206:207] op_sel_hi:[0,1,1] neg_lo:[0,0,1] neg_hi:[0,0,1]
v_cvt_pk_bf16_f32 v112, v200, v201
v_cvt_pk_bf16_f32 v113, v202, v203
v_cvt_pk_bf16_f32 v114, v204, v205
v_cvt_pk_bf16_f32 v115, v206, v207
v_pk_fma_f32 v[208:209], v[216:217], v[200:201], v[208:209] op_sel_hi:[0,1,1] neg_lo:[0,0,1] neg_hi:[0,0,1]
v_pk_fma_f32 v[210:211], v[216:217], v[202:203], v[210:211] op_sel_hi:[0,1,1] neg_lo:[0,0,1] neg_hi:[0,0,1]
v_pk_fma_f32 v[212:213], v[216:217], v[204:205], v[212:213] op_sel_hi:[0,1,1] neg_lo:[0,0,1] neg_hi:[0,0,1]
v_pk_fma_f32 v[214:215], v[216:217], v[206:207], v[214:215] op_sel_hi:[0,1,1] neg_lo:[0,0,1] neg_hi:[0,0,1]
v_cvt_pk_bf16_f32 v116, v208, v209
v_cvt_pk_bf16_f32 v117, v210, v211
v_cvt_pk_bf16_f32 v118, v212, v213
v_cvt_pk_bf16_f32 v119, v214, v215
v_pk_fma_f32 v[200:201], v[216:217], v[208:209], v[200:201] op_sel_hi:[0,1,1] neg_lo:[0,0,1] neg_hi:[0,0,1]
v_pk_fma_f32 v[202:203], v[216:217], v[210:211], v[202:203] op_sel_hi:[0,1,1] neg_lo:[0,0,1] neg_hi:[0,0,1]
v_pk_fma_f32 v[204:205], v[216:217], v[212:213], v[204:205] op_sel_hi:[0,1,1] neg_lo:[0,0,1] neg_hi:[0,0,1]
v_pk_fma_f32 v[206:207], v[216:217], v[214:215], v[206:207] op_sel_hi:[0,1,1] neg_lo:[0,0,1] neg_hi:[0,0,1]
v_cvt_pk_bf16_f32 v120, v200, v201
v_cvt_pk_bf16_f32 v121, v202, v203
v_cvt_pk_bf16_f32 v122, v204, v205
v_cvt_pk_bf16_f32 v123, v206, v207
v_pk_fma_f32 v[208:209], v[216:217], v[200:201], v[208:209] op_sel_hi:[0,1,1] neg_lo:[0,0,1] neg_hi:[0,0,1]
v_pk_fma_f32 v[210:211], v[216:217], v[202:203], v[210:211] op_sel_hi:[0,1,1] neg_lo:[0,0,1] neg_hi:[0,0,1]
v_pk_fma_f32 v[212:213], v[216:217], v[204:205], v[212:213] op_sel_hi:[0,1,1] neg_lo:[0,0,1] neg_hi:[0,0,1]
v_pk_fma_f32 v[214:215], v[216:217], v[206:207], v[214:215] op_sel_hi:[0,1,1] neg_lo:[0,0,1] neg_hi:[0,0,1]
v_cvt_pk_bf16_f32 v124, v208, v209
v_cvt_pk_bf16_f32 v125, v210, v211
v_cvt_pk_bf16_f32 v126, v212, v213
v_cvt_pk_bf16_f32 v127, v214, v215
v_pk_fma_f32 v[200:201], v[216:217], v[208:209], v[200:201] op_sel_hi:[0,1,1] neg_lo:[0,0,1] neg_hi:[0,0,1]
v_pk_fma_f32 v[202:203], v[216:217], v[210:211], v[202:203] op_sel_hi:[0,1,1] neg_lo:[0,0,1] neg_hi:[0,0,1]
v_pk_fma_f32 v[204:205], v[216:217], v[212:213], v[204:205] op_sel_hi:[0,1,1] neg_lo:[0,0,1] neg_hi:[0,0,1]
v_pk_fma_f32 v[206:207], v[216:217], v[214:215], v[206:207] op_sel_hi:[0,1,1] neg_lo:[0,0,1] neg_hi:[0,0,1]
v_cvt_pk_bf16_f32 v128, v200, v201
v_cvt_pk_bf16_f32 v129, v202, v203
v_cvt_pk_bf16_f32 v130, v204, v205
v_cvt_pk_bf16_f32 v131, v206, v207
v_pk_fma_f32 v[208:209], v[216:217], v[200:201], v[208:209] op_sel_hi:[0,1,1] neg_lo:[0,0,1] neg_hi:[0,0,1]
v_pk_fma_f32 v[210:211], v[216:217], v[202:203], v[210:211] op_sel_hi:[0,1,1] neg_lo:[0,0,1] neg_hi:[0,0,1]
v_pk_fma_f32 v[212:213], v[216:217], v[204:205], v[212:213] op_sel_hi:[0,1,1] neg_lo:[0,0,1] neg_hi:[0,0,1]
v_pk_fma_f32 v[214:215], v[216:217], v[206:207], v[214:215] op_sel_hi:[0,1,1] neg_lo:[0,0,1] neg_hi:[0,0,1]
v_cvt_pk_bf16_f32 v132, v208, v209
v_cvt_pk_bf16_f32 v133, v210, v211
v_cvt_pk_bf16_f32 v134, v212, v213
v_cvt_pk_bf16_f32 v135, v214, v215
v_pk_fma_f32 v[200:201], v[216:217], v[208:209], v[200:201] op_sel_hi:[0,1,1] neg_lo:[0,0,1] neg_hi:[0,0,1]
v_pk_fma_f32 v[202:203], v[216:217], v[210:211], v[202:203] op_sel_hi:[0,1,1] neg_lo:[0,0,1] neg_hi:[0,0,1]
v_pk_fma_f32 v[204:205], v[216:217], v[212:213], v[204:205] op_sel_hi:[0,1,1] neg_lo:[0,0,1] neg_hi:[0,0,1]
v_pk_fma_f32 v[206:207], v[216:217], v[214:215], v[206:207] op_sel_hi:[0,1,1] neg_lo:[0,0,1] neg_hi:[0,0,1]
v_cvt_pk_bf16_f32 v136, v200, v201
v_cvt_pk_bf16_f32 v137, v202, v203
v_cvt_pk_bf16_f32 v138, v204, v205
v_cvt_pk_bf16_f32 v139, v206, v207
v_pk_fma_f32 v[208:209], v[216:217], v[200:201], v[208:209] op_sel_hi:[0,1,1] neg_lo:[0,0,1] neg_hi:[0,0,1]
v_pk_fma_f32 v[210:211], v[216:217], v[202:203], v[210:211] op_sel_hi:[0,1,1] neg_lo:[0,0,1] neg_hi:[0,0,1]
v_pk_fma_f32 v[212:213], v[216:217], v[204:205], v[212:213] op_sel_hi:[0,1,1] neg_lo:[0,0,1] neg_hi:[0,0,1]
v_pk_fma_f32 v[214:215], v[216:217], v[206:207], v[214:215] op_sel_hi:[0,1,1] neg_lo:[0,0,1] neg_hi:[0,0,1]
v_cvt_pk_bf16_f32 v140, v208, v209
v_cvt_pk_bf16_f32 v141, v210, v211
v_cvt_pk_bf16_f32 v142, v212, v213
v_cvt_pk_bf16_f32 v143, v214, v215
v_pk_fma_f32 v[200:201], v[216:217], v[208:209], v[200:201] op_sel_hi:[0,1,1] neg_lo:[0,0,1] neg_hi:[0,0,1]
v_pk_fma_f32 v[202:203], v[216:217], v[210:211], v[202:203] op_sel_hi:[0,1,1] neg_lo:[0,0,1] neg_hi:[0,0,1]
v_pk_fma_f32 v[204:205], v[216:217], v[212:213], v[204:205] op_sel_hi:[0,1,1] neg_lo:[0,0,1] neg_hi:[0,0,1]
v_pk_fma_f32 v[206:207], v[216:217], v[214:215], v[206:207] op_sel_hi:[0,1,1] neg_lo:[0,0,1] neg_hi:[0,0,1]
v_cvt_pk_bf16_f32 v144, v200, v201
v_cvt_pk_bf16_f32 v145, v202, v203
v_cvt_pk_bf16_f32 v146, v204, v205
v_cvt_pk_bf16_f32 v147, v206, v207
v_pk_fma_f32 v[208:209], v[216:217], v[200:201], v[208:209] op_sel_hi:[0,1,1] neg_lo:[0,0,1] neg_hi:[0,0,1]
v_pk_fma_f32 v[210:211], v[216:217], v[202:203], v[210:211] op_sel_hi:[0,1,1] neg_lo:[0,0,1] neg_hi:[0,0,1]
v_pk_fma_f32 v[212:213], v[216:217], v[204:205], v[212:213] op_sel_hi:[0,1,1] neg_lo:[0,0,1] neg_hi:[0,0,1]
v_pk_fma_f32 v[214:215], v[216:217], v[206:207], v[214:215] op_sel_hi:[0,1,1] neg_lo:[0,0,1] neg_hi:[0,0,1]
v_cvt_pk_bf16_f32 v148, v208, v209
v_cvt_pk_bf16_f32 v149, v210, v211
v_cvt_pk_bf16_f32 v150, v212, v213
v_cvt_pk_bf16_f32 v151, v214, v215
v_pk_fma_f32 v[200:201], v[216:217], v[208:209], v[200:201] op_sel_hi:[0,1,1] neg_lo:[0,0,1] neg_hi:[0,0,1]
v_pk_fma_f32 v[202:203], v[216:217], v[210:211], v[202:203] op_sel_hi:[0,1,1] neg_lo:[0,0,1] neg_hi:[0,0,1]
v_pk_fma_f32 v[204:205], v[216:217], v[212:213], v[204:205] op_sel_hi:[0,1,1] neg_lo:[0,0,1] neg_hi:[0,0,1]
v_pk_fma_f32 v[206:207], v[216:217], v[214:215], v[206:207] op_sel_hi:[0,1,1] neg_lo:[0,0,1] neg_hi:[0,0,1]
v_cvt_pk_bf16_f32 v152, v200, v201
v_cvt_pk_bf16_f32 v153, v202, v203
v_cvt_pk_bf16_f32 v154, v204, v205
v_cvt_pk_bf16_f32 v155, v206, v207
v_pk_fma_f32 v[208:209], v[216:217], v[200:201], v[208:209] op_sel_hi:[0,1,1] neg_lo:[0,0,1] neg_hi:[0,0,1]
v_pk_fma_f32 v[210:211], v[216:217], v[202:203], v[210:211] op_sel_hi:[0,1,1] neg_lo:[0,0,1] neg_hi:[0,0,1]
v_pk_fma_f32 v[212:213], v[216:217], v[204:205], v[212:213] op_sel_hi:[0,1,1] neg_lo:[0,0,1] neg_hi:[0,0,1]
v_pk_fma_f32 v[214:215], v[216:217], v[206:207], v[214:215] op_sel_hi:[0,1,1] neg_lo:[0,0,1] neg_hi:[0,0,1]
v_cvt_pk_bf16_f32 v156, v208, v209
v_cvt_pk_bf16_f32 v157, v210, v211
v_cvt_pk_bf16_f32 v158, v212, v213
v_cvt_pk_bf16_f32 v159, v214, v215
v_pk_fma_f32 v[200:201], v[216:217], v[208:209], v[200:201] op_sel_hi:[0,1,1] neg_lo:[0,0,1] neg_hi:[0,0,1]
v_pk_fma_f32 v[202:203], v[216:217], v[210:211], v[202:203] op_sel_hi:[0,1,1] neg_lo:[0,0,1] neg_hi:[0,0,1]
v_pk_fma_f32 v[204:205], v[216:217], v[212:213], v[204:205] op_sel_hi:[0,1,1] neg_lo:[0,0,1] neg_hi:[0,0,1]
v_pk_fma_f32 v[206:207], v[216:217], v[214:215], v[206:207] op_sel_hi:[0,1,1] neg_lo:[0,0,1] neg_hi:[0,0,1]
v_cvt_pk_bf16_f32 v160, v200, v201
v_cvt_pk_bf16_f32 v161, v202, v203
v_cvt_pk_bf16_f32 v162, v204, v205
v_cvt_pk_bf16_f32 v163, v206, v207
v_pk_fma_f32 v[208:209], v[216:217], v[200:201], v[208:209] op_sel_hi:[0,1,1] neg_lo:[0,0,1] neg_hi:[0,0,1]
v_pk_fma_f32 v[210:211], v[216:217], v[202:203], v[210:211] op_sel_hi:[0,1,1] neg_lo:[0,0,1] neg_hi:[0,0,1]
v_pk_fma_f32 v[212:213], v[216:217], v[204:205], v[212:213] op_sel_hi:[0,1,1] neg_lo:[0,0,1] neg_hi:[0,0,1]
v_pk_fma_f32 v[214:215], v[216:217], v[206:207], v[214:215] op_sel_hi:[0,1,1] neg_lo:[0,0,1] neg_hi:[0,0,1]
v_cvt_pk_bf16_f32 v164, v208, v209
v_cvt_pk_bf16_f32 v165, v210, v211
v_cvt_pk_bf16_f32 v166, v212, v213
v_cvt_pk_bf16_f32 v167, v214, v215
v_pk_fma_f32 v[200:201], v[216:217], v[208:209], v[200:201] op_sel_hi:[0,1,1] neg_lo:[0,0,1] neg_hi:[0,0,1]
v_pk_fma_f32 v[202:203], v[216:217], v[210:211], v[202:203] op_sel_hi:[0,1,1] neg_lo:[0,0,1] neg_hi:[0,0,1]
v_pk_fma_f32 v[204:205], v[216:217], v[212:213], v[204:205] op_sel_hi:[0,1,1] neg_lo:[0,0,1] neg_hi:[0,0,1]
v_pk_fma_f32 v[206:207], v[216:217], v[214:215], v[206:207] op_sel_hi:[0,1,1] neg_lo:[0,0,1] neg_hi:[0,0,1]
v_cvt_pk_bf16_f32 v168, v200, v201
v_cvt_pk_bf16_f32 v169, v202, v203
v_cvt_pk_bf16_f32 v170, v204, v205
v_cvt_pk_bf16_f32 v171, v206, v207
v_pk_fma_f32 v[208:209], v[216:217], v[200:201], v[208:209] op_sel_hi:[0,1,1] neg_lo:[0,0,1] neg_hi:[0,0,1]
v_pk_fma_f32 v[210:211], v[216:217], v[202:203], v[210:211] op_sel_hi:[0,1,1] neg_lo:[0,0,1] neg_hi:[0,0,1]
v_pk_fma_f32 v[212:213], v[216:217], v[204:205], v[212:213] op_sel_hi:[0,1,1] neg_lo:[0,0,1] neg_hi:[0,0,1]
v_pk_fma_f32 v[214:215], v[216:217], v[206:207], v[214:215] op_sel_hi:[0,1,1] neg_lo:[0,0,1] neg_hi:[0,0,1]
s_mov_b32 exec_lo, 0
v_mul_f32 v214, 0.5, v214
s_mov_b32 exec_lo, -1
v_cvt_pk_bf16_f32 v172, v208, v209
v_cvt_pk_bf16_f32 v173, v210, v211
v_cvt_pk_bf16_f32 v174, v212, v213
v_cvt_pk_bf16_f32 v175, v214, v215
v_and_b32 v1, 0x2f0, v0
v_bfe_u32 v3, v0, 8, 1
v_lshl_add_u32 v1, v3, 3, v1
s_mul_i32 s18, s50, 40960
s_mul_i32 s19, s16, 3145728
s_add_u32 s26, s18, s19
s_add_u32 s27, s26, s19
s_add_u32 s27, s27, s33
s_add_u32 s27, s27, 88080384
s_add_u32 s26, s26, s31
s_add_u32 s26, s26, 103809024
s_lshl_b32 s19, s16, 6
s_add_u32 s19, s19, s50
s_mul_i32 s19, s19, 5120
s_lshr_b32 s36, s33, 3
s_add_u32 s36, s36, s19
s_add_u32 s36, s36, 163577856
s_mov_b32 s43, 0x20000
s_cmp_lg_u32 s16, 0
s_cbranch_scc1 rs_57
s_mov_b64 s[40:41], s[44:45]
s_mov_b32 s42, s46
s_lshr_b32 s51, s33, 5
s_add_u32 s51, s51, s18
s_add_u32 s52, s51, 32
v_mov_b32 v13, v5
s_branch rs_58
rs_57:
s_mov_b64 s[40:41], s[4:5]
s_mov_b32 s42, s6
s_sub_u32 s51, s27, 3145728
s_add_u32 s52, s51, 1024
v_mov_b32 v13, v0
rs_58:
s_cmp_lg_u32 s13, 0
s_cbranch_scc1 polld_60
v_lshlrev_b32 v3, 3, v0
v_min_u32 v12, 3968, v3
s_mov_b32 s21, 11591680
s_mov_b32 s17, 0
poll_59:
buffer_load_dword v8, v3, s[4:7], s21 offen sc1
s_add_u32 s20, s21, 8192
buffer_load_dword v9, v3, s[4:7], s20 offen sc1
s_add_u32 s20, s21, 16384
buffer_load_dword v10, v12, s[4:7], s20 offen sc1
s_add_u32 s17, s17, 1
s_cmp_gt_u32 s17, 262144
s_cbranch_scc1 L_fail
s_waitcnt vmcnt(1)
v_min_u32 v8, v8, v9
s_waitcnt vmcnt(0)
v_min_u32 v8, v8, v10
v_cmp_gt_u32 vcc, s29, v8
s_cbranch_vccz polld_60
s_sleep 2
s_branch poll_59
polld_60:
s_barrier
s_add_u32 m0, s31, 2048
s_add_u32 s20, s26, 0
buffer_load_dwordx4 v0, s[4:7], s20 offen sc1 lds
s_add_u32 m0, s31, 3072
s_add_u32 s20, s26, 1024
buffer_load_dwordx4 v0, s[4:7], s20 offen sc1 lds
s_add_u32 m0, s31, 4096
s_add_u32 s20, s26, 2048
buffer_load_dwordx4 v0, s[4:7], s20 offen sc1 lds
s_add_u32 m0, s31, 5120
s_add_u32 s20, s26, 3072
buffer_load_dwordx4 v0, s[4:7], s20 offen sc1 lds
s_add_u32 m0, s31, 6144
s_add_u32 s20, s26, 4096
buffer_load_dwordx4 v0, s[4:7], s20 offen sc1 lds
s_add_u32 m0, s31, 7168
s_add_u32 s20, s26, 5120
buffer_load_dwordx4 v0, s[4:7], s20 offen sc1 lds
s_add_u32 m0, s31, 8192
s_add_u32 s20, s26, 6144
buffer_load_dwordx4 v0, s[4:7], s20 offen sc1 lds
s_add_u32 m0, s31, 9216
s_add_u32 s20, s26, 7168
buffer_load_dwordx4 v0, s[4:7], s20 offen sc1 lds
s_add_u32 m0, s31, 10240
s_add_u32 s20, s26, 8192
buffer_load_dwordx4 v0, s[4:7], s20 offen sc1 lds
s_add_u32 m0, s31, 11264
s_add_u32 s20, s26, 9216
buffer_load_dwordx4 v0, s[4:7], s20 offen sc1 lds
s_add_u32 s26, s26, 1310720
s_add_u32 s25, s31, 40960
s_mov_b32 s28, 0
s_waitcnt vmcnt(0)
p3_61:
s_barrier
ds_read_b64_tr_b16 v[216:217], v1 offset:2048
ds_read_b64_tr_b16 v[218:219], v1 offset:2304
ds_read_b64_tr_b16 v[222:223], v1 offset:3328
ds_read_b64_tr_b16 v[220:221], v1 offset:3072
buffer_load_dwordx4 v[176:179], v13, s[40:43], s51 offen sc1
ds_read_b64_tr_b16 v[224:225], v1 offset:4096
buffer_load_dwordx4 v[180:183], v13, s[40:43], s52 offen sc1
ds_read_b64_tr_b16 v[230:231], v1 offset:5376
ds_read_b64_tr_b16 v[226:227], v1 offset:4352
s_add_u32 m0, s25, 2048
s_add_u32 s20, s26, 0
buffer_load_dwordx4 v0, s[4:7], s20 offen sc1 lds
s_waitcnt lgkmcnt(5)
v_mfma_f32_32x32x16_bf16 v[200:215], v[16:19], v[216:219], 0
s_waitcnt lgkmcnt(4)
ds_read_b64_tr_b16 v[228:229], v1 offset:5120
ds_read_b64_tr_b16 v[218:219], v1 offset:6400
s_add_u32 m0, s25, 3072
s_add_u32 s20, s26, 1024
buffer_load_dwordx4 v0, s[4:7], s20 offen sc1 lds
s_waitcnt lgkmcnt(4)
v_mfma_f32_32x32x16_bf16 v[200:215], v[20:23], v[220:223], v[200:215]
s_add_u32 m0, s25, 4096
s_add_u32 s20, s26, 2048
buffer_load_dwordx4 v0, s[4:7], s20 offen sc1 lds
ds_read_b64_tr_b16 v[216:217], v1 offset:6144
s_waitcnt lgkmcnt(3)
ds_read_b64_tr_b16 v[222:223], v1 offset:7424
v_mfma_f32_32x32x16_bf16 v[200:215], v[24:27], v[224:227], v[200:215]
s_waitcnt lgkmcnt(3)
ds_read_b64_tr_b16 v[220:221], v1 offset:7168
ds_read_b64_tr_b16 v[224:225], v1 offset:8192
s_waitcnt lgkmcnt(4)
v_mfma_f32_32x32x16_bf16 v[200:215], v[28:31], v[228:231], v[200:215]
s_add_u32 m0, s25, 5120
s_add_u32 s20, s26, 3072
buffer_load_dwordx4 v0, s[4:7], s20 offen sc1 lds
s_waitcnt lgkmcnt(3)
ds_read_b64_tr_b16 v[226:227], v1 offset:8448
ds_read_b64_tr_b16 v[230:231], v1 offset:9472
ds_read_b64_tr_b16 v[228:229], v1 offset:9216
v_mfma_f32_32x32x16_bf16 v[200:215], v[32:35], v[216:219], v[200:215]
ds_read_b64_tr_b16 v[216:217], v1 offset:10240
s_waitcnt lgkmcnt(5)
v_mfma_f32_32x32x16_bf16 v[200:215], v[36:39], v[220:223], v[200:215]
ds_read_b64_tr_b16 v[220:221], v1 offset:11264
s_waitcnt lgkmcnt(4)
ds_read_b64_tr_b16 v[218:219], v1 offset:10496
v_mfma_f32_32x32x16_bf16 v[200:215], v[40:43], v[224:227], v[200:215]
ds_read_b64_tr_b16 v[222:223], v1 offset:11520
ds_read_b64_tr_b16 v[224:225], v1 offset:12288
s_waitcnt lgkmcnt(5)
v_mfma_f32_32x32x16_bf16 v[200:215], v[44:47], v[228:231], v[200:215]
ds_read_b64_tr_b16 v[228:229], v1 offset:13312
ds_read_b64_tr_b16 v[226:227], v1 offset:12544
s_waitcnt lgkmcnt(6)
s_waitcnt lgkmcnt(4)
ds_read_b64_tr_b16 v[230:231], v1 offset:13568
v_mfma_f32_32x32x16_bf16 v[200:215], v[48:51], v[216:219], v[200:215]
ds_read_b64_tr_b16 v[218:219], v1 offset:14592
s_add_u32 m0, s25, 6144
s_add_u32 s20, s26, 4096
buffer_load_dwordx4 v0, s[4:7], s20 offen sc1 lds
s_waitcnt lgkmcnt(5)
ds_read_b64_tr_b16 v[216:217], v1 offset:14336
v_mfma_f32_32x32x16_bf16 v[200:215], v[52:55], v[220:223], v[200:215]
ds_read_b64_tr_b16 v[222:223], v1 offset:15616
s_waitcnt lgkmcnt(4)
s_add_u32 m0, s25, 7168
s_add_u32 s20, s26, 5120
buffer_load_dwordx4 v0, s[4:7], s20 offen sc1 lds
ds_read_b64_tr_b16 v[220:221], v1 offset:15360
v_mfma_f32_32x32x16_bf16 v[200:215], v[56:59], v[224:227], v[200:215]
s_waitcnt lgkmcnt(4)
ds_read_b64_tr_b16 v[226:227], v1 offset:16640
ds_read_b64_tr_b16 v[224:225], v1 offset:16384
s_waitcnt lgkmcnt(5)
s_waitcnt lgkmcnt(4)
v_mfma_f32_32x32x16_bf16 v[200:215], v[60:63], v[228:231], v[200:215]
v_mfma_f32_32x32x16_bf16 v[200:215], v[64:67], v[216:219], v[200:215]
s_waitcnt lgkmcnt(2)
ds_read_b64_tr_b16 v[218:219], v1 offset:18688
s_waitcnt lgkmcnt(1)
ds_read_b64_tr_b16 v[230:231], v1 offset:17664
ds_read_b64_tr_b16 v[228:229], v1 offset:17408
ds_read_b64_tr_b16 v[216:217], v1 offset:18432
v_mfma_f32_32x32x16_bf16 v[200:215], v[68:71], v[220:223], v[200:215]
v_mfma_f32_32x32x16_bf16 v[200:215], v[72:75], v[224:227], v[200:215]
s_waitcnt lgkmcnt(3)
ds_read_b64_tr_b16 v[224:225], v1 offset:20480
ds_read_b64_tr_b16 v[226:227], v1 offset:20736
ds_read_b64_tr_b16 v[222:223], v1 offset:19712
s_waitcnt lgkmcnt(4)
ds_read_b64_tr_b16 v[220:221], v1 offset:19456
v_mfma_f32_32x32x16_bf16 v[200:215], v[76:79], v[228:231], v[200:215]
ds_read_b64_tr_b16 v[230:231], v1 offset:21760
s_waitcnt lgkmcnt(5)
ds_read_b64_tr_b16 v[228:229], v1 offset:21504
v_mfma_f32_32x32x16_bf16 v[200:215], v[80:83], v[216:219], v[200:215]
ds_read_b64_tr_b16 v[218:219], v1 offset:22784
s_waitcnt lgkmcnt(3)
ds_read_b64_tr_b16 v[216:217], v1 offset:22528
v_mfma_f32_32x32x16_bf16 v[200:215], v[84:87], v[220:223], v[200:215]
ds_read_b64_tr_b16 v[220:221], v1 offset:23552
s_waitcnt lgkmcnt(4)
ds_read_b64_tr_b16 v[222:223], v1 offset:23808
v_mfma_f32_32x32x16_bf16 v[200:215], v[88:91], v[224:227], v[200:215]
s_add_u32 m0, s25, 8192
s_add_u32 s20, s26, 6144
buffer_load_dwordx4 v0, s[4:7], s20 offen sc1 lds
s_waitcnt lgkmcnt(2)
ds_read_b64_tr_b16 v[224:225], v1 offset:24576
ds_read_b64_tr_b16 v[226:227], v1 offset:24832
v_mfma_f32_32x32x16_bf16 v[200:215], v[92:95], v[228:231], v[200:215]
s_waitcnt lgkmcnt(3)
ds_read_b64_tr_b16 v[230:231], v1 offset:25856
s_waitcnt lgkmcnt(3)
v_mfma_f32_32x32x16_bf16 v[200:215], v[96:99], v[216:219], v[200:215]
s_waitcnt lgkmcnt(2)
ds_read_b64_tr_b16 v[228:229], v1 offset:25600
ds_read_b64_tr_b16 v[218:219], v1 offset:26880
v_mfma_f32_32x32x16_bf16 v[200:215], v[100:103], v[220:223], v[200:215]
ds_read_b64_tr_b16 v[216:217], v1 offset:26624
ds_read_b64_tr_b16 v[222:223], v1 offset:27904
ds_read_b64_tr_b16 v[220:221], v1 offset:27648
s_waitcnt lgkmcnt(6)
v_mfma_f32_32x32x16_bf16 v[200:215], v[104:107], v[224:227], v[200:215]
s_waitcnt lgkmcnt(4)
ds_read_b64_tr_b16 v[224:225], v1 offset:28672
ds_read_b64_tr_b16 v[226:227], v1 offset:28928
s_waitcnt lgkmcnt(5)
v_mfma_f32_32x32x16_bf16 v[200:215], v[108:111], v[228:231], v[200:215]
ds_read_b64_tr_b16 v[228:229], v1 offset:29696
s_waitcnt lgkmcnt(5)
v_mfma_f32_32x32x16_bf16 v[200:215], v[112:115], v[216:219], v[200:215]
s_waitcnt lgkmcnt(4)
s_waitcnt lgkmcnt(1)
ds_read_b64_tr_b16 v[218:219], v1 offset:30976
ds_read_b64_tr_b16 v[230:231], v1 offset:29952
v_mfma_f32_32x32x16_bf16 v[200:215], v[116:119], v[220:223], v[200:215]
s_add_u32 m0, s25, 9216
s_add_u32 s20, s26, 7168
buffer_load_dwordx4 v0, s[4:7], s20 offen sc1 lds
ds_read_b64_tr_b16 v[216:217], v1 offset:30720
ds_read_b64_tr_b16 v[220:221], v1 offset:31744
s_waitcnt lgkmcnt(4)
v_mfma_f32_32x32x16_bf16 v[200:215], v[120:123], v[224:227], v[200:215]
ds_read_b64_tr_b16 v[226:227], v1 offset:33024
ds_read_b64_tr_b16 v[222:223], v1 offset:32000
ds_read_b64_tr_b16 v[224:225], v1 offset:32768
s_waitcnt lgkmcnt(5)
v_lshrrev_b32 v2, 2, v0
v_mfma_f32_32x32x16_bf16 v[200:215], v[124:127], v[228:231], v[200:215]
s_add_u32 m0, s25, 10240
s_add_u32 s20, s26, 8192
buffer_load_dwordx4 v0, s[4:7], s20 offen sc1 lds
s_waitcnt lgkmcnt(4)
ds_read_b64_tr_b16 v[228:229], v1 offset:33792
s_waitcnt lgkmcnt(4)
v_mfma_f32_32x32x16_bf16 v[200:215], v[128:131], v[216:219], v[200:215]
s_waitcnt lgkmcnt(3)
s_waitcnt lgkmcnt(2)
ds_read_b64_tr_b16 v[230:231], v1 offset:34048
ds_read_b64_tr_b16 v[216:217], v1 offset:34816
ds_read_b64_tr_b16 v[218:219], v1 offset:35072
v_mfma_f32_32x32x16_bf16 v[200:215], v[132:135], v[220:223], v[200:215]
s_waitcnt vmcnt(10)
s_waitcnt lgkmcnt(4)
ds_read_b64_tr_b16 v[220:221], v1 offset:35840
s_add_u32 m0, s25, 11264
s_add_u32 s20, s26, 9216
buffer_load_dwordx4 v0, s[4:7], s20 offen sc1 lds
v_mfma_f32_32x32x16_bf16 v[200:215], v[136:139], v[224:227], v[200:215]
ds_read_b64_tr_b16 v[222:223], v1 offset:36096
ds_read_b64_tr_b16 v[226:227], v1 offset:37120
v_and_b32 v187, 0xffff0000, v177
s_waitcnt lgkmcnt(5)
v_lshlrev_b32 v184, 16, v176
s_waitcnt vmcnt(10)
v_mfma_f32_32x32x16_bf16 v[200:215], v[140:143], v[228:231], v[200:215]
s_waitcnt lgkmcnt(3)
ds_read_b64_tr_b16 v[230:231], v1 offset:38144
ds_read_b64_tr_b16 v[224:225], v1 offset:36864
s_waitcnt lgkmcnt(4)
ds_read_b64_tr_b16 v[228:229], v1 offset:37888
v_mfma_f32_32x32x16_bf16 v[200:215], v[144:147], v[216:219], v[200:215]
s_waitcnt lgkmcnt(3)
ds_read_b64_tr_b16 v[218:219], v1 offset:39168
ds_read_b64_tr_b16 v[216:217], v1 offset:38912
v_and_b32 v199, 0xffff0000, v183
v_mfma_f32_32x32x16_bf16 v[200:215], v[148:151], v[220:223], v[200:215]
s_waitcnt lgkmcnt(4)
s_waitcnt lgkmcnt(3)
s_waitcnt lgkmcnt(2)
v_lshlrev_b32 v198, 16, v183
v_and_b32 v189, 0xffff0000, v178
v_and_b32 v197, 0xffff0000, v182
v_mfma_f32_32x32x16_bf16 v[200:215], v[152:155], v[224:227], v[200:215]
ds_read_b64_tr_b16 v[220:221], v1 offset:39936
s_waitcnt lgkmcnt(2)
ds_read_b64_tr_b16 v[224:225], v1 offset:40960
ds_read_b64_tr_b16 v[222:223], v1 offset:40192
v_mfma_f32_32x32x16_bf16 v[200:215], v[156:159], v[228:231], v[200:215]
s_waitcnt lgkmcnt(3)
ds_read_b64_tr_b16 v[230:231], v1 offset:42240
ds_read_b64_tr_b16 v[226:227], v1 offset:41216
v_mfma_f32_32x32x16_bf16 v[200:215], v[160:163], v[216:219], v[200:215]
ds_read_b64_tr_b16 v[228:229], v1 offset:41984
s_waitcnt lgkmcnt(3)
v_and_b32 v193, 0xffff0000, v180
v_lshlrev_b32 v186, 16, v177
v_and_b32 v191, 0xffff0000, v179
v_mfma_f32_32x32x16_bf16 v[200:215], v[164:167], v[220:223], v[200:215]
s_waitcnt lgkmcnt(1)
v_lshlrev_b32 v196, 16, v182
v_mfma_f32_32x32x16_bf16 v[200:215], v[168:171], v[224:227], v[200:215]
v_lshlrev_b32 v188, 16, v178
s_waitcnt lgkmcnt(0)
v_lshlrev_b32 v194, 16, v181
v_mfma_f32_32x32x16_bf16 v[200:215], v[172:175], v[228:231], v[200:215]
s_nop 0
v_lshlrev_b32 v190, 16, v179
v_lshlrev_b32 v192, 16, v180
v_and_b32 v185, 0xffff0000, v176
v_and_b32 v195, 0xffff0000, v181
v_mov_b32 v176, 0x3b4ccccd
s_nop 5
v_pk_fma_f32 v[200:201], v[200:201], v[176:177], v[184:185] op_sel_hi:[1,0,1]
v_pk_fma_f32 v[202:203], v[202:203], v[176:177], v[186:187] op_sel_hi:[1,0,1]
v_pk_fma_f32 v[204:205], v[204:205], v[176:177], v[188:189] op_sel_hi:[1,0,1]
v_pk_mul_f32 v[180:181], v[200:201], v[200:201]
v_pk_fma_f32 v[206:207], v[206:207], v[176:177], v[190:191] op_sel_hi:[1,0,1]
v_pk_add_f32 v[178:179], v[200:201], v[202:203]
v_pk_fma_f32 v[208:209], v[208:209], v[176:177], v[192:193] op_sel_hi:[1,0,1]
v_pk_add_f32 v[178:179], v[178:179], v[204:205]
v_pk_add_f32 v[178:179], v[178:179], v[206:207]
v_pk_fma_f32 v[180:181], v[202:203], v[202:203], v[180:181]
v_pk_fma_f32 v[180:181], v[204:205], v[204:205], v[180:181]
v_pk_fma_f32 v[210:211], v[210:211], v[176:177], v[194:195] op_sel_hi:[1,0,1]
v_pk_fma_f32 v[180:181], v[206:207], v[206:207], v[180:181]
v_pk_add_f32 v[178:179], v[178:179], v[208:209]
v_pk_fma_f32 v[180:181], v[208:209], v[208:209], v[180:181]
v_pk_add_f32 v[178:179], v[178:179], v[210:211]
v_pk_fma_f32 v[180:181], v[210:211], v[210:211], v[180:181]
v_pk_fma_f32 v[214:215], v[214:215], v[176:177], v[198:199] op_sel_hi:[1,0,1]
v_pk_fma_f32 v[212:213], v[212:213], v[176:177], v[196:197] op_sel_hi:[1,0,1]
v_pk_add_f32 v[178:179], v[178:179], v[212:213]
v_pk_add_f32 v[178:179], v[178:179], v[214:215]
v_pk_fma_f32 v[180:181], v[212:213], v[212:213], v[180:181]
v_add_f32 v178, v178, v179
v_pk_fma_f32 v[180:181], v[214:215], v[214:215], v[180:181]
v_add_f32 v180, v180, v181
v_cvt_pk_bf16_f32 v220, v208, v209
v_cvt_pk_bf16_f32 v221, v210, v211
v_permlane32_swap_b32 v178, v180
v_cvt_pk_bf16_f32 v223, v214, v215
v_cvt_pk_bf16_f32 v222, v212, v213
v_cvt_pk_bf16_f32 v219, v206, v207
v_cvt_pk_bf16_f32 v216, v200, v201
v_cvt_pk_bf16_f32 v218, v204, v205
v_add_f32 v178, v178, v180
v_cvt_pk_bf16_f32 v217, v202, v203
buffer_store_dwordx4 v[216:219], v0, s[4:7], s27 offen offset:0 sc1
buffer_store_dwordx4 v[220:223], v0, s[4:7], s27 offen offset:1024 sc1
buffer_store_dword v178, v2, s[4:7], s36 offen sc1
v_xor_b32 v1, 40960, v1
s_mov_b32 s26, s6
s_mov_b32 s25, s31
s_add_u32 s27, s27, 1310720
s_add_u32 s36, s36, 163840
s_add_u32 s51, s51, 1310720
s_add_u32 s52, s52, 1310720
s_add_u32 s28, s28, 1
s_lshl_b32 s18, s39, 7
s_add_u32 s18, s18, 11612160
s_lshl_b32 s19, s16, 1
s_add_u32 s19, s19, s28
s_cmp_eq_u32 s13, 0
s_cselect_b32 s22, s18, s6
s_mov_b32 s23, s19
s_waitcnt vmcnt(0)
s_barrier
v_mov_b32 v3, s23
s_mov_b64 exec, 1
buffer_store_dword v3, off, s[4:7], s22 sc1
s_mov_b64 exec, -1
s_mov_b32 s22, s6
s_cmp_lt_u32 s28, 2
s_cbranch_scc1 p3_61
s_cmp_ge_u32 s39, 144
s_cbranch_scc1 p1b_63
s_cmp_ge_u32 s39, 64
s_cbranch_scc1 wo_62
s_and_b32 s32, s39, 31
s_cmp_lg_u32 s16, 0
s_cbranch_scc1 qw_65
s_lshl_b32 s26, s32, 8
s_lshl_b32 s18, s13, 6
s_add_u32 s26, s26, s18
s_load_dwordx2 s[40:41], s[0:1], 40
s_mov_b32 s42, 5242880
s_mov_b32 s43, 0x20000
s_waitcnt lgkmcnt(0)
v_lshrrev_b32 v34, 6, v0
v_mul_u32_u24 v34, 8192, v34
v_and_b32 v35, 48, v0
v_add_u32 v32, v34, v35
v_bfe_u32 v34, v0, 6, 2
v_lshrrev_b32 v35, 9, v0
v_lshl_add_u32 v34, v35, 3, v34
v_lshlrev_b32 v33, 6, v34
v_and_b32 v34, 16, v0
v_add_u32 v33, v33, v34
v_bfe_u32 v34, v0, 5, 1
v_lshl_add_u32 v33, v34, 3, v33
v_bfe_u32 v34, v0, 8, 1
v_lshl_add_u32 v33, v34, 5, v33
s_mul_i32 s18, s13, 36864
v_add_u32 v33, s18, v33
s_barrier
s_add_u32 m0, s18, 0
s_add_u32 s19, s26, 0
buffer_load_dwordx4 v32, s[40:43], s19 offen lds
s_add_u32 m0, s18, 1024
s_add_u32 s19, s26, 131072
buffer_load_dwordx4 v32, s[40:43], s19 offen lds
s_add_u32 m0, s18, 2048
s_add_u32 s19, s26, 262144
buffer_load_dwordx4 v32, s[40:43], s19 offen lds
s_add_u32 m0, s18, 3072
s_add_u32 s19, s26, 393216
buffer_load_dwordx4 v32, s[40:43], s19 offen lds
s_add_u32 m0, s18, 4096
s_add_u32 s19, s26, 524288
buffer_load_dwordx4 v32, s[40:43], s19 offen lds
s_add_u32 m0, s18, 5120
s_add_u32 s19, s26, 655360
buffer_load_dwordx4 v32, s[40:43], s19 offen lds
s_add_u32 m0, s18, 6144
s_add_u32 s19, s26, 786432
buffer_load_dwordx4 v32, s[40:43], s19 offen lds
s_add_u32 m0, s18, 7168
s_add_u32 s19, s26, 917504
buffer_load_dwordx4 v32, s[40:43], s19 offen lds
s_add_u32 m0, s18, 8192
s_add_u32 s19, s26, 1048576
buffer_load_dwordx4 v32, s[40:43], s19 offen lds
s_add_u32 m0, s18, 9216
s_add_u32 s19, s26, 1179648
buffer_load_dwordx4 v32, s[40:43], s19 offen lds
s_add_u32 m0, s18, 10240
s_add_u32 s19, s26, 1310720
buffer_load_dwordx4 v32, s[40:43], s19 offen lds
s_add_u32 m0, s18, 11264
s_add_u32 s19, s26, 1441792
buffer_load_dwordx4 v32, s[40:43], s19 offen lds
s_add_u32 m0, s18, 12288
s_add_u32 s19, s26, 1572864
buffer_load_dwordx4 v32, s[40:43], s19 offen lds
s_add_u32 m0, s18, 13312
s_add_u32 s19, s26, 1703936
buffer_load_dwordx4 v32, s[40:43], s19 offen lds
s_add_u32 m0, s18, 14336
s_add_u32 s19, s26, 1835008
buffer_load_dwordx4 v32, s[40:43], s19 offen lds
s_add_u32 m0, s18, 15360
s_add_u32 s19, s26, 1966080
buffer_load_dwordx4 v32, s[40:43], s19 offen lds
s_add_u32 m0, s18, 16384
s_add_u32 s19, s26, 2097152
buffer_load_dwordx4 v32, s[40:43], s19 offen lds
s_add_u32 m0, s18, 17408
s_add_u32 s19, s26, 2228224
buffer_load_dwordx4 v32, s[40:43], s19 offen lds
s_add_u32 m0, s18, 18432
s_add_u32 s19, s26, 2359296
buffer_load_dwordx4 v32, s[40:43], s19 offen lds
s_add_u32 m0, s18, 19456
s_add_u32 s19, s26, 2490368
buffer_load_dwordx4 v32, s[40:43], s19 offen lds
s_add_u32 m0, s18, 20480
s_add_u32 s19, s26, 2621440
buffer_load_dwordx4 v32, s[40:43], s19 offen lds
s_add_u32 m0, s18, 21504
s_add_u32 s19, s26, 2752512
buffer_load_dwordx4 v32, s[40:43], s19 offen lds
s_add_u32 m0, s18, 22528
s_add_u32 s19, s26, 2883584
buffer_load_dwordx4 v32, s[40:43], s19 offen lds
s_add_u32 m0, s18, 23552
s_add_u32 s19, s26, 3014656
buffer_load_dwordx4 v32, s[40:43], s19 offen lds
s_add_u32 m0, s18, 24576
s_add_u32 s19, s26, 3145728
buffer_load_dwordx4 v32, s[40:43], s19 offen lds
s_add_u32 m0, s18, 25600
s_add_u32 s19, s26, 3276800
buffer_load_dwordx4 v32, s[40:43], s19 offen lds
s_add_u32 m0, s18, 26624
s_add_u32 s19, s26, 3407872
buffer_load_dwordx4 v32, s[40:43], s19 offen lds
s_add_u32 m0, s18, 27648
s_add_u32 s19, s26, 3538944
buffer_load_dwordx4 v32, s[40:43], s19 offen lds
s_add_u32 m0, s18, 28672
s_add_u32 s19, s26, 3670016
buffer_load_dwordx4 v32, s[40:43], s19 offen lds
s_add_u32 m0, s18, 29696
s_add_u32 s19, s26, 3801088
buffer_load_dwordx4 v32, s[40:43], s19 offen lds
s_add_u32 m0, s18, 30720
s_add_u32 s19, s26, 3932160
buffer_load_dwordx4 v32, s[40:43], s19 offen lds
s_add_u32 m0, s18, 31744
s_add_u32 s19, s26, 4063232
buffer_load_dwordx4 v32, s[40:43], s19 offen lds
s_add_u32 m0, s18, 32768
s_add_u32 s19, s26, 4194304
buffer_load_dwordx4 v32, s[40:43], s19 offen lds
s_add_u32 m0, s18, 33792
s_add_u32 s19, s26, 4325376
buffer_load_dwordx4 v32, s[40:43], s19 offen lds
s_add_u32 m0, s18, 34816
s_add_u32 s19, s26, 4456448
buffer_load_dwordx4 v32, s[40:43], s19 offen lds
s_add_u32 m0, s18, 35840
s_add_u32 s19, s26, 4587520
buffer_load_dwordx4 v32, s[40:43], s19 offen lds
s_waitcnt vmcnt(32)
ds_read_b64_tr_b16 a[0:1], v33 offset:0
ds_read_b64_tr_b16 a[2:3], v33 offset:256
ds_read_b64_tr_b16 a[4:5], v33 offset:1024
ds_read_b64_tr_b16 a[6:7], v33 offset:1280
ds_read_b64_tr_b16 a[8:9], v33 offset:2048
ds_read_b64_tr_b16 a[10:11], v33 offset:2304
ds_read_b64_tr_b16 a[12:13], v33 offset:3072
ds_read_b64_tr_b16 a[14:15], v33 offset:3328
s_waitcnt lgkmcnt(0)
s_add_u32 m0, s18, 0
s_add_u32 s19, s26, 4718592
buffer_load_dwordx4 v32, s[40:43], s19 offen lds
s_add_u32 m0, s18, 1024
s_add_u32 s19, s26, 4849664
buffer_load_dwordx4 v32, s[40:43], s19 offen lds
s_add_u32 m0, s18, 2048
s_add_u32 s19, s26, 4980736
buffer_load_dwordx4 v32, s[40:43], s19 offen lds
s_add_u32 m0, s18, 3072
s_add_u32 s19, s26, 5111808
buffer_load_dwordx4 v32, s[40:43], s19 offen lds
s_waitcnt vmcnt(32)
ds_read_b64_tr_b16 a[16:17], v33 offset:4096
ds_read_b64_tr_b16 a[18:19], v33 offset:4352
ds_read_b64_tr_b16 a[20:21], v33 offset:5120
ds_read_b64_tr_b16 a[22:23], v33 offset:5376
ds_read_b64_tr_b16 a[24:25], v33 offset:6144
ds_read_b64_tr_b16 a[26:27], v33 offset:6400
ds_read_b64_tr_b16 a[28:29], v33 offset:7168
ds_read_b64_tr_b16 a[30:31], v33 offset:7424
s_waitcnt vmcnt(28)
ds_read_b64_tr_b16 a[32:33], v33 offset:8192
ds_read_b64_tr_b16 a[34:35], v33 offset:8448
ds_read_b64_tr_b16 a[36:37], v33 offset:9216
ds_read_b64_tr_b16 a[38:39], v33 offset:9472
ds_read_b64_tr_b16 a[40:41], v33 offset:10240
ds_read_b64_tr_b16 a[42:43], v33 offset:10496
ds_read_b64_tr_b16 a[44:45], v33 offset:11264
ds_read_b64_tr_b16 a[46:47], v33 offset:11520
s_waitcnt vmcnt(24)
ds_read_b64_tr_b16 a[48:49], v33 offset:12288
ds_read_b64_tr_b16 a[50:51], v33 offset:12544
ds_read_b64_tr_b16 a[52:53], v33 offset:13312
ds_read_b64_tr_b16 a[54:55], v33 offset:13568
ds_read_b64_tr_b16 a[56:57], v33 offset:14336
ds_read_b64_tr_b16 a[58:59], v33 offset:14592
ds_read_b64_tr_b16 a[60:61], v33 offset:15360
ds_read_b64_tr_b16 a[62:63], v33 offset:15616
s_waitcnt vmcnt(20)
ds_read_b64_tr_b16 a[64:65], v33 offset:16384
ds_read_b64_tr_b16 a[66:67], v33 offset:16640
ds_read_b64_tr_b16 a[68:69], v33 offset:17408
ds_read_b64_tr_b16 a[70:71], v33 offset:17664
ds_read_b64_tr_b16 a[72:73], v33 offset:18432
ds_read_b64_tr_b16 a[74:75], v33 offset:18688
ds_read_b64_tr_b16 a[76:77], v33 offset:19456
ds_read_b64_tr_b16 a[78:79], v33 offset:19712
s_waitcnt vmcnt(16)
ds_read_b64_tr_b16 a[80:81], v33 offset:20480
ds_read_b64_tr_b16 a[82:83], v33 offset:20736
ds_read_b64_tr_b16 a[84:85], v33 offset:21504
ds_read_b64_tr_b16 a[86:87], v33 offset:21760
ds_read_b64_tr_b16 a[88:89], v33 offset:22528
ds_read_b64_tr_b16 a[90:91], v33 offset:22784
ds_read_b64_tr_b16 a[92:93], v33 offset:23552
ds_read_b64_tr_b16 a[94:95], v33 offset:23808
s_waitcnt vmcnt(12)
ds_read_b64_tr_b16 a[96:97], v33 offset:24576
ds_read_b64_tr_b16 a[98:99], v33 offset:24832
ds_read_b64_tr_b16 a[100:101], v33 offset:25600
ds_read_b64_tr_b16 a[102:103], v33 offset:25856
ds_read_b64_tr_b16 a[104:105], v33 offset:26624
ds_read_b64_tr_b16 a[106:107], v33 offset:26880
ds_read_b64_tr_b16 a[108:109], v33 offset:27648
ds_read_b64_tr_b16 a[110:111], v33 offset:27904
s_waitcnt vmcnt(8)
ds_read_b64_tr_b16 a[112:113], v33 offset:28672
ds_read_b64_tr_b16 a[114:115], v33 offset:28928
ds_read_b64_tr_b16 a[116:117], v33 offset:29696
ds_read_b64_tr_b16 a[118:119], v33 offset:29952
ds_read_b64_tr_b16 a[120:121], v33 offset:30720
ds_read_b64_tr_b16 a[122:123], v33 offset:30976
ds_read_b64_tr_b16 a[124:125], v33 offset:31744
ds_read_b64_tr_b16 a[126:127], v33 offset:32000
s_waitcnt vmcnt(4)
ds_read_b64_tr_b16 a[128:129], v33 offset:32768
ds_read_b64_tr_b16 a[130:131], v33 offset:33024
ds_read_b64_tr_b16 a[132:133], v33 offset:33792
ds_read_b64_tr_b16 a[134:135], v33 offset:34048
ds_read_b64_tr_b16 a[136:137], v33 offset:34816
ds_read_b64_tr_b16 a[138:139], v33 offset:35072
ds_read_b64_tr_b16 a[140:141], v33 offset:35840
ds_read_b64_tr_b16 a[142:143], v33 offset:36096
s_waitcnt vmcnt(0)
ds_read_b64_tr_b16 a[144:145], v33 offset:0
ds_read_b64_tr_b16 a[146:147], v33 offset:256
ds_read_b64_tr_b16 a[148:149], v33 offset:1024
ds_read_b64_tr_b16 a[150:151], v33 offset:1280
ds_read_b64_tr_b16 a[152:153], v33 offset:2048
ds_read_b64_tr_b16 a[154:155], v33 offset:2304
ds_read_b64_tr_b16 a[156:157], v33 offset:3072
ds_read_b64_tr_b16 a[158:159], v33 offset:3328
s_waitcnt lgkmcnt(0)
s_barrier
v_mov_b32 v32, s24
v_mov_b32 v33, s24
v_mov_b32 v34, s24
v_mov_b32 v35, s24
s_nop 1
v_mfma_f32_32x32x16_bf16 v[36:51], a[0:3], v[32:35], 0
v_mfma_f32_32x32x16_bf16 v[36:51], a[4:7], v[32:35], v[36:51]
v_mfma_f32_32x32x16_bf16 v[36:51], a[8:11], v[32:35], v[36:51]
v_mfma_f32_32x32x16_bf16 v[36:51], a[12:15], v[32:35], v[36:51]
v_mfma_f32_32x32x16_bf16 v[36:51], a[16:19], v[32:35], v[36:51]
v_mfma_f32_32x32x16_bf16 v[36:51], a[20:23], v[32:35], v[36:51]
v_mfma_f32_32x32x16_bf16 v[36:51], a[24:27], v[32:35], v[36:51]
v_mfma_f32_32x32x16_bf16 v[36:51], a[28:31], v[32:35], v[36:51]
v_mfma_f32_32x32x16_bf16 v[36:51], a[32:35], v[32:35], v[36:51]
v_mfma_f32_32x32x16_bf16 v[36:51], a[36:39], v[32:35], v[36:51]
v_mfma_f32_32x32x16_bf16 v[36:51], a[40:43], v[32:35], v[36:51]
v_mfma_f32_32x32x16_bf16 v[36:51], a[44:47], v[32:35], v[36:51]
v_mfma_f32_32x32x16_bf16 v[36:51], a[48:51], v[32:35], v[36:51]
v_mfma_f32_32x32x16_bf16 v[36:51], a[52:55], v[32:35], v[36:51]
v_mfma_f32_32x32x16_bf16 v[36:51], a[56:59], v[32:35], v[36:51]
v_mfma_f32_32x32x16_bf16 v[36:51], a[60:63], v[32:35], v[36:51]
v_mfma_f32_32x32x16_bf16 v[36:51], a[64:67], v[32:35], v[36:51]
v_mfma_f32_32x32x16_bf16 v[36:51], a[68:71], v[32:35], v[36:51]
v_mfma_f32_32x32x16_bf16 v[36:51], a[72:75], v[32:35], v[36:51]
v_mfma_f32_32x32x16_bf16 v[36:51], a[76:79], v[32:35], v[36:51]
v_mfma_f32_32x32x16_bf16 v[36:51], a[80:83], v[32:35], v[36:51]
v_mfma_f32_32x32x16_bf16 v[36:51], a[84:87], v[32:35], v[36:51]
v_mfma_f32_32x32x16_bf16 v[36:51], a[88:91], v[32:35], v[36:51]
v_mfma_f32_32x32x16_bf16 v[36:51], a[92:95], v[32:35], v[36:51]
v_mfma_f32_32x32x16_bf16 v[36:51], a[96:99], v[32:35], v[36:51]
v_mfma_f32_32x32x16_bf16 v[36:51], a[100:103], v[32:35], v[36:51]
v_mfma_f32_32x32x16_bf16 v[36:51], a[104:107], v[32:35], v[36:51]
v_mfma_f32_32x32x16_bf16 v[36:51], a[108:111], v[32:35], v[36:51]
v_mfma_f32_32x32x16_bf16 v[36:51], a[112:115], v[32:35], v[36:51]
v_mfma_f32_32x32x16_bf16 v[36:51], a[116:119], v[32:35], v[36:51]
v_mfma_f32_32x32x16_bf16 v[36:51], a[120:123], v[32:35], v[36:51]
v_mfma_f32_32x32x16_bf16 v[36:51], a[124:127], v[32:35], v[36:51]
v_mfma_f32_32x32x16_bf16 v[36:51], a[128:131], v[32:35], v[36:51]
v_mfma_f32_32x32x16_bf16 v[36:51], a[132:135], v[32:35], v[36:51]
v_mfma_f32_32x32x16_bf16 v[36:51], a[136:139], v[32:35], v[36:51]
v_mfma_f32_32x32x16_bf16 v[36:51], a[140:143], v[32:35], v[36:51]
v_mfma_f32_32x32x16_bf16 v[36:51], a[144:147], v[32:35], v[36:51]
v_mfma_f32_32x32x16_bf16 v[36:51], a[148:151], v[32:35], v[36:51]
v_mfma_f32_32x32x16_bf16 v[36:51], a[152:155], v[32:35], v[36:51]
v_mfma_f32_32x32x16_bf16 v[36:51], a[156:159], v[32:35], v[36:51]
s_nop 11
v_mov_b32 v16, v36
v_mov_b32 v17, v37
v_mov_b32 v18, v38
v_mov_b32 v19, v39
v_mov_b32 v20, v40
v_mov_b32 v21, v41
v_mov_b32 v22, v42
v_mov_b32 v23, v43
v_mov_b32 v24, v44
v_mov_b32 v25, v45
v_mov_b32 v26, v46
v_mov_b32 v27, v47
v_mov_b32 v28, v48
v_mov_b32 v29, v49
v_mov_b32 v30, v50
v_mov_b32 v31, v51
v_accvgpr_write_b32 a160, v16
v_accvgpr_write_b32 a161, v17
v_accvgpr_write_b32 a162, v18
v_accvgpr_write_b32 a163, v19
v_accvgpr_write_b32 a164, v20
v_accvgpr_write_b32 a165, v21
v_accvgpr_write_b32 a166, v22
v_accvgpr_write_b32 a167, v23
v_accvgpr_write_b32 a168, v24
v_accvgpr_write_b32 a169, v25
v_accvgpr_write_b32 a170, v26
v_accvgpr_write_b32 a171, v27
v_accvgpr_write_b32 a172, v28
v_accvgpr_write_b32 a173, v29
v_accvgpr_write_b32 a174, v30
v_accvgpr_write_b32 a175, v31
qw_65:
v_accvgpr_read_b32 v16, a160
v_accvgpr_read_b32 v17, a161
v_accvgpr_read_b32 v18, a162
v_accvgpr_read_b32 v19, a163
v_accvgpr_read_b32 v20, a164
v_accvgpr_read_b32 v21, a165
v_accvgpr_read_b32 v22, a166
v_accvgpr_read_b32 v23, a167
v_accvgpr_read_b32 v24, a168
v_accvgpr_read_b32 v25, a169
v_accvgpr_read_b32 v26, a170
v_accvgpr_read_b32 v27, a171
v_accvgpr_read_b32 v28, a172
v_accvgpr_read_b32 v29, a173
v_accvgpr_read_b32 v30, a174
v_accvgpr_read_b32 v31, a175
s_lshl_b32 s29, s16, 1
s_add_u32 s29, s29, 2
s_lshr_b32 s52, s39, 5
s_lshl_b32 s53, s32, 8
s_add_u32 s53, s53, 11534336
s_cmp_lg_u32 s13, 0
s_cbranch_scc1 polld_67
v_lshlrev_b32 v3, 3, v0
v_min_u32 v12, 3968, v3
s_mov_b32 s21, 11612160
s_mov_b32 s17, 0
poll_66:
buffer_load_dword v8, v3, s[4:7], s21 offen sc1
s_add_u32 s20, s21, 8192
buffer_load_dword v9, v3, s[4:7], s20 offen sc1
s_add_u32 s20, s21, 16384
buffer_load_dword v10, v12, s[4:7], s20 offen sc1
s_add_u32 s17, s17, 1
s_cmp_gt_u32 s17, 262144
s_cbranch_scc1 L_fail
s_waitcnt vmcnt(1)
v_min_u32 v8, v8, v9
s_waitcnt vmcnt(0)
v_min_u32 v8, v8, v10
v_cmp_gt_u32 vcc, s29, v8
s_cbranch_vccz polld_67
s_sleep 2
s_branch poll_66
polld_67:
s_barrier
qr_68:
s_mul_i32 s26, s16, 6291456
s_mul_i32 s18, s52, 163840
s_add_u32 s26, s26, s18
s_add_u32 s26, s26, s31
s_add_u32 s26, s26, 88080384
s_lshl_b32 s18, s16, 4
s_add_u32 s18, s18, s52
s_mul_i32 s18, s18, 20480
s_add_u32 s36, s18, 163577856
s_lshl_b32 s18, s13, 11
s_add_u32 s18, s18, 83968
v_add_u32 v13, s18, v0
s_mov_b32 s28, 0
v_xor_b32 v1, 40960, v0
s_mov_b32 s25, s31
s_mov_b32 s35, 131072
s_add_u32 m0, s25, 2048
s_add_u32 s20, s26, 0
buffer_load_dwordx4 v0, s[4:7], s20 offen sc1 lds
s_add_u32 m0, s25, 3072
s_add_u32 s20, s26, 1024
buffer_load_dwordx4 v0, s[4:7], s20 offen sc1 lds
s_add_u32 m0, s25, 4096
s_add_u32 s20, s26, 2048
buffer_load_dwordx4 v0, s[4:7], s20 offen sc1 lds
s_add_u32 m0, s25, 5120
s_add_u32 s20, s26, 3072
buffer_load_dwordx4 v0, s[4:7], s20 offen sc1 lds
s_add_u32 m0, s25, 6144
s_add_u32 s20, s26, 4096
buffer_load_dwordx4 v0, s[4:7], s20 offen sc1 lds
s_add_u32 m0, s25, 7168
s_add_u32 s20, s26, 5120
buffer_load_dwordx4 v0, s[4:7], s20 offen sc1 lds
s_add_u32 m0, s25, 8192
s_add_u32 s20, s26, 6144
buffer_load_dwordx4 v0, s[4:7], s20 offen sc1 lds
s_add_u32 m0, s25, 9216
s_add_u32 s20, s26, 7168
buffer_load_dwordx4 v0, s[4:7], s20 offen sc1 lds
s_add_u32 m0, s25, 10240
s_add_u32 s20, s26, 8192
buffer_load_dwordx4 v0, s[4:7], s20 offen sc1 lds
s_add_u32 m0, s25, 11264
s_add_u32 s20, s26, 9216
buffer_load_dwordx4 v0, s[4:7], s20 offen sc1 lds
s_add_u32 m0, s35, s37
s_add_u32 s20, s36, s37
buffer_load_dwordx4 v0, s[4:7], s20 offen sc1 lds
s_add_u32 m0, s35, 4096
s_add_u32 s20, s36, 4096
buffer_load_dwordx4 v0, s[4:7], s20 offen sc1 lds
s_waitcnt vmcnt(0)
qu_69:
v_xor_b32 v1, 40960, v1
s_sub_u32 s25, s25, s31
s_xor_b32 s25, s25, 40960
s_add_u32 s25, s25, s31
s_xor_b32 s35, s35, 8192
s_add_u32 s26, s26, 40960
s_add_u32 s36, s36, 5120
s_cmp_eq_u32 s28, 3
s_cselect_b32 s26, s6, s26
s_cselect_b32 s36, s6, s36
s_waitcnt vmcnt(0)
s_barrier
ds_read_b128 v[48:51], v1 offset:2048
ds_read_b128 v[52:55], v1 offset:3072
s_add_u32 m0, s25, 2048
s_add_u32 s20, s26, 0
buffer_load_dwordx4 v0, s[4:7], s20 offen sc1 lds
v_lshrrev_b32 v2, 2, v0
ds_read_b128 v[56:59], v1 offset:4096
ds_read_b128 v[60:63], v1 offset:5120
s_xor_b32 s18, s35, 8192
v_add_u32 v2, s18, v2
ds_read2st64_b32 v[72:73], v2 offset0:4 offset1:5
s_waitcnt lgkmcnt(4)
v_mfma_f32_32x32x16_bf16 v[32:47], a[0:3], v[48:51], 0
s_add_u32 m0, s25, 3072
s_add_u32 s20, s26, 1024
buffer_load_dwordx4 v0, s[4:7], s20 offen sc1 lds
ds_read_b128 v[48:51], v1 offset:6144
ds_read2st64_b32 v[66:67], v2 offset0:2 offset1:3
s_waitcnt lgkmcnt(4)
v_mfma_f32_32x32x16_bf16 v[32:47], a[4:7], v[52:55], v[32:47]
ds_read_b128 v[52:55], v1 offset:7168
ds_read2st64_b32 v[78:79], v2 offset0:10 offset1:11
s_add_u32 m0, s25, 4096
s_add_u32 s20, s26, 2048
buffer_load_dwordx4 v0, s[4:7], s20 offen sc1 lds
v_mfma_f32_32x32x16_bf16 v[32:47], a[8:11], v[56:59], v[32:47]
s_waitcnt lgkmcnt(3)
ds_read_b128 v[56:59], v1 offset:8192
ds_read2st64_b32 v[86:87], v2 offset0:18 offset1:19
v_mfma_f32_32x32x16_bf16 v[32:47], a[12:15], v[60:63], v[32:47]
ds_read_b128 v[60:63], v1 offset:9216
ds_read2st64_b32 v[64:65], v2 offset0:0 offset1:1
s_waitcnt lgkmcnt(5)
ds_read2st64_b32 v[74:75], v2 offset0:6 offset1:7
v_mfma_f32_32x32x16_bf16 v[32:47], a[16:19], v[48:51], v[32:47]
ds_read2st64_b32 v[80:81], v2 offset0:12 offset1:13
ds_read_b128 v[48:51], v1 offset:10240
ds_read2st64_b32 v[82:83], v2 offset0:14 offset1:15
ds_read2st64_b32 v[76:77], v2 offset0:8 offset1:9
v_mfma_f32_32x32x16_bf16 v[32:47], a[20:23], v[52:55], v[32:47]
ds_read_b128 v[52:55], v1 offset:11264
s_waitcnt lgkmcnt(9)
s_add_u32 m0, s25, 5120
s_add_u32 s20, s26, 3072
buffer_load_dwordx4 v0, s[4:7], s20 offen sc1 lds
v_mfma_f32_32x32x16_bf16 v[32:47], a[24:27], v[56:59], v[32:47]
s_waitcnt lgkmcnt(7)
s_add_u32 m0, s25, 6144
s_add_u32 s20, s26, 4096
buffer_load_dwordx4 v0, s[4:7], s20 offen sc1 lds
s_waitcnt lgkmcnt(6)
v_add_f32 v64, v64, v66
v_mfma_f32_32x32x16_bf16 v[32:47], a[28:31], v[60:63], v[32:47]
ds_read_b128 v[56:59], v1 offset:12288
ds_read_b128 v[60:63], v1 offset:13312
v_add_f32 v65, v65, v67
s_waitcnt lgkmcnt(5)
v_mfma_f32_32x32x16_bf16 v[32:47], a[32:35], v[48:51], v[32:47]
ds_read_b128 v[48:51], v1 offset:14336
v_add_f32 v65, v65, v73
s_waitcnt lgkmcnt(3)
v_add_f32 v65, v65, v75
v_mfma_f32_32x32x16_bf16 v[32:47], a[36:39], v[52:55], v[32:47]
s_add_u32 m0, s25, 7168
s_add_u32 s20, s26, 5120
buffer_load_dwordx4 v0, s[4:7], s20 offen sc1 lds
ds_read2st64_b32 v[84:85], v2 offset0:16 offset1:17
v_add_f32 v64, v64, v72
s_waitcnt lgkmcnt(3)
v_add_f32 v65, v65, v77
v_mfma_f32_32x32x16_bf16 v[32:47], a[40:43], v[56:59], v[32:47]
s_waitcnt lgkmcnt(2)
ds_read_b128 v[56:59], v1 offset:16384
ds_read_b128 v[52:55], v1 offset:15360
v_add_f32 v64, v64, v74
v_add_f32 v64, v64, v76
v_mfma_f32_32x32x16_bf16 v[32:47], a[44:47], v[60:63], v[32:47]
s_waitcnt lgkmcnt(3)
ds_read_b128 v[60:63], v1 offset:17408
v_add_f32 v65, v65, v79
v_mfma_f32_32x32x16_bf16 v[32:47], a[48:51], v[48:51], v[32:47]
v_add_f32 v64, v64, v78
s_add_u32 m0, s25, 8192
s_add_u32 s20, s26, 6144
buffer_load_dwordx4 v0, s[4:7], s20 offen sc1 lds
s_waitcnt lgkmcnt(1)
v_mfma_f32_32x32x16_bf16 v[32:47], a[52:55], v[52:55], v[32:47]
ds_read_b128 v[48:51], v1 offset:18432
v_add_f32 v65, v65, v81
s_waitcnt lgkmcnt(1)
ds_read_b128 v[52:55], v1 offset:19456
v_mfma_f32_32x32x16_bf16 v[32:47], a[56:59], v[56:59], v[32:47]
s_add_u32 m0, s25, 9216
s_add_u32 s20, s26, 7168
buffer_load_dwordx4 v0, s[4:7], s20 offen sc1 lds
v_mfma_f32_32x32x16_bf16 v[32:47], a[60:63], v[60:63], v[32:47]
ds_read_b128 v[60:63], v1 offset:21504
s_waitcnt lgkmcnt(2)
ds_read_b128 v[56:59], v1 offset:20480
v_mfma_f32_32x32x16_bf16 v[32:47], a[64:67], v[48:51], v[32:47]
v_add_f32 v65, v65, v83
s_waitcnt lgkmcnt(2)
ds_read_b128 v[48:51], v1 offset:22528
v_mfma_f32_32x32x16_bf16 v[32:47], a[68:71], v[52:55], v[32:47]
v_add_f32 v65, v65, v85
v_add_f32 v64, v64, v80
v_add_f32 v64, v64, v82
s_waitcnt lgkmcnt(2)
s_waitcnt lgkmcnt(1)
v_mfma_f32_32x32x16_bf16 v[32:47], a[72:75], v[56:59], v[32:47]
s_add_u32 m0, s25, 10240
s_add_u32 s20, s26, 8192
buffer_load_dwordx4 v0, s[4:7], s20 offen sc1 lds
ds_read_b128 v[52:55], v1 offset:23552
v_add_f32 v64, v64, v84
v_add_f32 v65, v65, v87
s_waitcnt lgkmcnt(1)
v_mfma_f32_32x32x16_bf16 v[32:47], a[76:79], v[60:63], v[32:47]
v_add_f32 v64, v64, v86
ds_read_b128 v[56:59], v1 offset:24576
v_mfma_f32_32x32x16_bf16 v[32:47], a[80:83], v[48:51], v[32:47]
ds_read_b128 v[60:63], v1 offset:25600
ds_read_b128 v[48:51], v1 offset:26624
v_add_f32 v64, v64, v65
v_mov_b32 v68, v64
s_waitcnt lgkmcnt(3)
v_mfma_f32_32x32x16_bf16 v[32:47], a[84:87], v[52:55], v[32:47]
s_add_u32 m0, s25, 11264
s_add_u32 s20, s26, 9216
buffer_load_dwordx4 v0, s[4:7], s20 offen sc1 lds
s_waitcnt lgkmcnt(2)
v_permlane32_swap_b32 v64, v68
v_mfma_f32_32x32x16_bf16 v[32:47], a[88:91], v[56:59], v[32:47]
ds_read_b128 v[56:59], v1 offset:28672
ds_read_b128 v[52:55], v1 offset:27648
v_mul_f32 v68, 0x3acccccd, v68
s_waitcnt lgkmcnt(3)
v_mul_f32 v64, 0x3acccccd, v64
v_fma_f32 v68, -v64, v64, v68
v_mfma_f32_32x32x16_bf16 v[32:47], a[92:95], v[60:63], v[32:47]
s_add_u32 m0, s35, s37
s_add_u32 s20, s36, s37
buffer_load_dwordx4 v0, s[4:7], s20 offen sc1 lds
ds_read_b128 v[60:63], v1 offset:29696
s_waitcnt lgkmcnt(3)
v_max_f32 v68, 0, v68
v_add_f32 v68, 0x3727c5ac, v68
v_mfma_f32_32x32x16_bf16 v[32:47], a[96:99], v[48:51], v[32:47]
ds_read_b128 v[48:51], v1 offset:30720
v_rsq_f32 v68, v68
s_waitcnt lgkmcnt(2)
v_mul_f32 v68, 0x3e0293ee, v68
v_mfma_f32_32x32x16_bf16 v[32:47], a[100:103], v[52:55], v[32:47]
s_add_u32 m0, s35, 4096
s_add_u32 s20, s36, 4096
buffer_load_dwordx4 v0, s[4:7], s20 offen sc1 lds
v_mul_f32 v64, v68, v64
s_waitcnt lgkmcnt(1)
v_mfma_f32_32x32x16_bf16 v[32:47], a[104:107], v[56:59], v[32:47]
v_mul_f32 v82, v64, v26
s_waitcnt lgkmcnt(0)
ds_read_b128 v[52:55], v1 offset:31744
ds_read_b128 v[56:59], v1 offset:32768
v_mfma_f32_32x32x16_bf16 v[32:47], a[108:111], v[60:63], v[32:47]
ds_read_b128 v[60:63], v1 offset:33792
v_mfma_f32_32x32x16_bf16 v[32:47], a[112:115], v[48:51], v[32:47]
s_waitcnt lgkmcnt(2)
v_mul_f32 v84, v64, v28
v_mul_f32 v73, v64, v17
v_mfma_f32_32x32x16_bf16 v[32:47], a[116:119], v[52:55], v[32:47]
ds_read_b128 v[52:55], v1 offset:35840
s_waitcnt lgkmcnt(2)
ds_read_b128 v[48:51], v1 offset:34816
v_mfma_f32_32x32x16_bf16 v[32:47], a[120:123], v[56:59], v[32:47]
v_mul_f32 v87, v64, v31
v_mul_f32 v77, v64, v21
v_mul_f32 v81, v64, v25
s_waitcnt lgkmcnt(2)
v_mfma_f32_32x32x16_bf16 v[32:47], a[124:127], v[60:63], v[32:47]
ds_read_b128 v[60:63], v1 offset:37888
s_waitcnt lgkmcnt(2)
s_waitcnt lgkmcnt(1)
ds_read_b128 v[56:59], v1 offset:36864
v_mfma_f32_32x32x16_bf16 v[32:47], a[128:131], v[48:51], v[32:47]
ds_read_b128 v[48:51], v1 offset:38912
v_mul_f32 v75, v64, v19
v_mfma_f32_32x32x16_bf16 v[32:47], a[132:135], v[52:55], v[32:47]
s_waitcnt lgkmcnt(1)
v_mfma_f32_32x32x16_bf16 v[32:47], a[136:139], v[56:59], v[32:47]
ds_read_b128 v[56:59], v1 offset:40960
ds_read_b128 v[52:55], v1 offset:39936
v_mul_f32 v79, v64, v23
v_mul_f32 v85, v64, v29
v_mul_f32 v76, v64, v20
v_mfma_f32_32x32x16_bf16 v[32:47], a[140:143], v[60:63], v[32:47]
s_waitcnt lgkmcnt(2)
ds_read_b128 v[60:63], v1 offset:41984
v_mul_f32 v74, v64, v18
v_mul_f32 v86, v64, v30
v_mfma_f32_32x32x16_bf16 v[32:47], a[144:147], v[48:51], v[32:47]
s_waitcnt lgkmcnt(1)
v_mfma_f32_32x32x16_bf16 v[32:47], a[148:151], v[52:55], v[32:47]
s_waitcnt lgkmcnt(0)
v_mfma_f32_32x32x16_bf16 v[32:47], a[152:155], v[56:59], v[32:47]
v_mfma_f32_32x32x16_bf16 v[32:47], a[156:159], v[60:63], v[32:47]
s_nop 0
v_mul_f32 v72, v64, v16
v_mul_f32 v78, v64, v22
v_mul_f32 v83, v64, v27
v_mul_f32 v80, v64, v24
s_nop 6
v_pk_fma_f32 v[44:45], v[44:45], v[68:69], v[84:85] op_sel_hi:[1,0,1] neg_lo:[0,0,1] neg_hi:[0,0,1]
v_pk_fma_f32 v[38:39], v[38:39], v[68:69], v[78:79] op_sel_hi:[1,0,1] neg_lo:[0,0,1] neg_hi:[0,0,1]
v_pk_fma_f32 v[42:43], v[42:43], v[68:69], v[82:83] op_sel_hi:[1,0,1] neg_lo:[0,0,1] neg_hi:[0,0,1]
v_pk_fma_f32 v[46:47], v[46:47], v[68:69], v[86:87] op_sel_hi:[1,0,1] neg_lo:[0,0,1] neg_hi:[0,0,1]
v_pk_fma_f32 v[34:35], v[34:35], v[68:69], v[74:75] op_sel_hi:[1,0,1] neg_lo:[0,0,1] neg_hi:[0,0,1]
v_pk_fma_f32 v[32:33], v[32:33], v[68:69], v[72:73] op_sel_hi:[1,0,1] neg_lo:[0,0,1] neg_hi:[0,0,1]
v_cvt_pk_bf16_f32 v51, v38, v39
v_cvt_pk_bf16_f32 v49, v34, v35
v_pk_fma_f32 v[36:37], v[36:37], v[68:69], v[76:77] op_sel_hi:[1,0,1] neg_lo:[0,0,1] neg_hi:[0,0,1]
v_cvt_pk_bf16_f32 v54, v44, v45
v_cvt_pk_bf16_f32 v50, v36, v37
v_cvt_pk_bf16_f32 v48, v32, v33
v_pk_fma_f32 v[40:41], v[40:41], v[68:69], v[80:81] op_sel_hi:[1,0,1] neg_lo:[0,0,1] neg_hi:[0,0,1]
v_cvt_pk_bf16_f32 v55, v46, v47
v_cvt_pk_bf16_f32 v53, v42, v43
v_cvt_pk_bf16_f32 v52, v40, v41
ds_write_b128 v13, v[48:51] offset:0
ds_write_b128 v13, v[52:55] offset:1024
v_add_u32 v13, 8192, v13
s_add_u32 s28, s28, 1
s_cmp_lt_u32 s28, 4
s_cbranch_scc1 qu_69
s_waitcnt lgkmcnt(0)
s_barrier
s_lshl_b32 s30, s52, 2
s_add_u32 s30, s30, s13
s_lshl_b32 s18, s16, 6
s_add_u32 s29, s18, s30
s_lshl_b32 s27, s29, 18
s_lshl_b32 s19, s32, 13
s_add_u32 s27, s27, s19
s_add_u32 s27, s27, 127926272
s_mul_i32 s18, s16, 35651584
s_mul_i32 s19, s30, 524288
s_add_u32 s18, s18, s19
s_mul_i32 s19, s32, 16384
s_add_u32 s18, s18, s19
s_add_u32 s29, s29, 1
s_mov_b32 s28, s29
s_lshl_b32 s19, s13, 13
s_add_u32 s19, s19, 83968
v_add_u32 v200, s19, v0
s_add_u32 s54, s18, 16777216
s_add_u32 s55, s18, 16781312
s_add_u32 s56, s18, 16785408
s_add_u32 s57, s18, 16789504
ds_read_b128 v[32:35], v200 offset:0
ds_read_b128 v[36:39], v200 offset:1024
ds_read_b128 v[40:43], v200 offset:2048
ds_read_b128 v[44:47], v200 offset:3072
ds_read_b128 v[48:51], v200 offset:4096
ds_read_b128 v[52:55], v200 offset:5120
ds_read_b128 v[56:59], v200 offset:6144
ds_read_b128 v[60:63], v200 offset:7168
v_and_b32 v14, 0x70, v0
v_lshrrev_b32 v200, 8, v0
v_lshl_add_u32 v14, v200, 7, v14
v_bfe_u32 v200, v0, 7, 1
v_lshl_add_u32 v14, v200, 12, v14
v_and_b32 v15, 0x70, v0
v_lshrrev_b32 v200, 8, v0
v_lshl_add_u32 v15, v200, 7, v15
v_bfe_u32 v200, v0, 7, 1
v_lshl_add_u32 v15, v200, 10, v15
v_bfe_u32 v200, v0, 4, 5
v_lshrrev_b32 v144, 9, v0
v_lshlrev_b32 v144, 2, v144
v_sub_u32 v200, v200, v144
v_mov_b32 v145, 0xf149f2ca
v_cmp_gt_i32 vcc, 0, v200
s_nop 1
v_cndmask_b32 v128, 0, v145, vcc
v_cmp_gt_i32 vcc, 1, v200
s_nop 1
v_cndmask_b32 v129, 0, v145, vcc
v_cmp_gt_i32 vcc, 2, v200
s_nop 1
v_cndmask_b32 v130, 0, v145, vcc
v_cmp_gt_i32 vcc, 3, v200
s_nop 1
v_cndmask_b32 v131, 0, v145, vcc
v_cmp_gt_i32 vcc, 8, v200
s_nop 1
v_cndmask_b32 v132, 0, v145, vcc
v_cmp_gt_i32 vcc, 9, v200
s_nop 1
v_cndmask_b32 v133, 0, v145, vcc
v_cmp_gt_i32 vcc, 10, v200
s_nop 1
v_cndmask_b32 v134, 0, v145, vcc
v_cmp_gt_i32 vcc, 11, v200
s_nop 1
v_cndmask_b32 v135, 0, v145, vcc
v_cmp_gt_i32 vcc, 16, v200
s_nop 1
v_cndmask_b32 v136, 0, v145, vcc
v_cmp_gt_i32 vcc, 17, v200
s_nop 1
v_cndmask_b32 v137, 0, v145, vcc
v_cmp_gt_i32 vcc, 18, v200
s_nop 1
v_cndmask_b32 v138, 0, v145, vcc
v_cmp_gt_i32 vcc, 19, v200
s_nop 1
v_cndmask_b32 v139, 0, v145, vcc
v_cmp_gt_i32 vcc, 24, v200
s_nop 1
v_cndmask_b32 v140, 0, v145, vcc
v_cmp_gt_i32 vcc, 25, v200
s_nop 1
v_cndmask_b32 v141, 0, v145, vcc
v_cmp_gt_i32 vcc, 26, v200
s_nop 1
v_cndmask_b32 v142, 0, v145, vcc
v_cmp_gt_i32 vcc, 27, v200
s_nop 1
v_cndmask_b32 v143, 0, v145, vcc
v_lshlrev_b32 v3, 3, v0
v_min_u32 v12, 128, v3
s_mov_b32 s17, 0
poll_70:
buffer_load_dword v8, v12, s[4:7], s53 offen sc1
s_add_u32 s17, s17, 1
s_cmp_gt_u32 s17, 262144
s_cbranch_scc1 L_fail
s_waitcnt vmcnt(0)
v_cmp_gt_u32 vcc, s29, v8
s_cbranch_vccz polld_71
s_sleep 2
s_branch poll_70
polld_71:
buffer_load_dwordx4 v[64:67], v14, s[4:7], s54 offen offset:0 sc1
buffer_load_dwordx4 v[68:71], v14, s[4:7], s54 offen offset:512 sc1
buffer_load_dwordx4 v[72:75], v14, s[4:7], s54 offen offset:1024 sc1
buffer_load_dwordx4 v[76:79], v14, s[4:7], s54 offen offset:1536 sc1
buffer_load_dwordx4 v[80:83], v14, s[4:7], s56 offen offset:0 sc1
buffer_load_dwordx4 v[84:87], v14, s[4:7], s56 offen offset:512 sc1
buffer_load_dwordx4 v[88:91], v14, s[4:7], s56 offen offset:1024 sc1
buffer_load_dwordx4 v[92:95], v14, s[4:7], s56 offen offset:1536 sc1
buffer_load_dwordx4 v[96:99], v15, s[4:7], s54 offen offset:2048 sc1
buffer_load_dwordx4 v[100:103], v15, s[4:7], s54 offen offset:2560 sc1
buffer_load_dwordx4 v[104:107], v15, s[4:7], s55 offen offset:2048 sc1
buffer_load_dwordx4 v[108:111], v15, s[4:7], s55 offen offset:2560 sc1
buffer_load_dwordx4 v[112:115], v15, s[4:7], s56 offen offset:2048 sc1
buffer_load_dwordx4 v[116:119], v15, s[4:7], s56 offen offset:2560 sc1
buffer_load_dwordx4 v[120:123], v15, s[4:7], s57 offen offset:2048 sc1
buffer_load_dwordx4 v[124:127], v15, s[4:7], s57 offen offset:2560 sc1
s_waitcnt vmcnt(15) lgkmcnt(7)
v_mfma_f32_32x32x16_bf16 v[128:143], v[64:67], v[32:35], v[128:143]
s_waitcnt vmcnt(14) lgkmcnt(6)
v_mfma_f32_32x32x16_bf16 v[128:143], v[68:71], v[36:39], v[128:143]
s_waitcnt vmcnt(13) lgkmcnt(5)
v_mfma_f32_32x32x16_bf16 v[128:143], v[72:75], v[40:43], v[128:143]
s_waitcnt vmcnt(12) lgkmcnt(4)
v_mfma_f32_32x32x16_bf16 v[128:143], v[76:79], v[44:47], v[128:143]
s_waitcnt vmcnt(11) lgkmcnt(3)
v_mfma_f32_32x32x16_bf16 v[128:143], v[80:83], v[48:51], v[128:143]
s_waitcnt vmcnt(10) lgkmcnt(2)
v_mfma_f32_32x32x16_bf16 v[128:143], v[84:87], v[52:55], v[128:143]
s_waitcnt vmcnt(9) lgkmcnt(1)
v_mfma_f32_32x32x16_bf16 v[128:143], v[88:91], v[56:59], v[128:143]
s_waitcnt vmcnt(8) lgkmcnt(0)
v_mfma_f32_32x32x16_bf16 v[128:143], v[92:95], v[60:63], v[128:143]
s_lshl_b32 s18, s16, 4
s_add_u32 s29, s18, s52
s_lshl_b32 s18, s29, 19
s_lshl_b32 s19, s32, 14
s_add_u32 s18, s18, s19
s_add_u32 s29, s29, 1
s_and_b32 s19, s13, 1
s_lshr_b32 s20, s13, 1
v_and_b32 v14, 0x170, v14
v_lshl_add_u32 v14, s19, 12, v14
v_lshl_add_u32 v14, s20, 7, v14
v_lshl_add_u32 v15, s19, 3, v15
v_lshl_add_u32 v15, s20, 9, v15
s_add_u32 s54, s18, 110100480
s_add_u32 s55, s18, 110104576
s_add_u32 s56, s18, 110108672
s_add_u32 s57, s18, 110112768
v_max3_f32 v200, v128, v129, v130
v_max3_f32 v200, v200, v131, v132
v_max3_f32 v200, v200, v133, v134
v_max3_f32 v200, v200, v135, v136
v_max3_f32 v200, v200, v137, v138
v_max3_f32 v200, v200, v139, v140
v_max3_f32 v200, v200, v141, v142
v_max_f32 v200, v200, v143
s_add_u32 s18, s53, 8192
v_lshlrev_b32 v3, 3, v0
v_min_u32 v12, 128, v3
s_mov_b32 s17, 0
poll_72:
buffer_load_dword v8, v12, s[4:7], s18 offen sc1
s_add_u32 s17, s17, 1
s_cmp_gt_u32 s17, 262144
s_cbranch_scc1 L_fail
s_waitcnt vmcnt(0)
v_cmp_gt_u32 vcc, s29, v8
s_cbranch_vccz polld_73
s_sleep 2
s_branch poll_72
polld_73:
buffer_load_dwordx4 v[64:67], v14, s[4:7], s54 offen offset:0 sc1
buffer_load_dwordx4 v[68:71], v14, s[4:7], s54 offen offset:512 sc1
buffer_load_dwordx4 v[72:75], v14, s[4:7], s54 offen offset:1024 sc1
buffer_load_dwordx4 v[76:79], v14, s[4:7], s54 offen offset:1536 sc1
buffer_load_dwordx4 v[80:83], v14, s[4:7], s56 offen offset:0 sc1
buffer_load_dwordx4 v[84:87], v14, s[4:7], s56 offen offset:512 sc1
buffer_load_dwordx4 v[88:91], v14, s[4:7], s56 offen offset:1024 sc1
buffer_load_dwordx4 v[92:95], v14, s[4:7], s56 offen offset:1536 sc1
buffer_load_dwordx2 v[192:193], v15, s[4:7], s54 offen offset:2048 sc1
buffer_load_dwordx2 v[194:195], v15, s[4:7], s55 offen offset:2048 sc1
buffer_load_dwordx2 v[196:197], v15, s[4:7], s56 offen offset:2048 sc1
buffer_load_dwordx2 v[198:199], v15, s[4:7], s57 offen offset:2048 sc1
s_waitcnt vmcnt(11)
v_mfma_f32_32x32x16_bf16 v[144:159], v[64:67], v[32:35], 0
s_waitcnt vmcnt(10)
v_mfma_f32_32x32x16_bf16 v[144:159], v[68:71], v[36:39], v[144:159]
s_waitcnt vmcnt(9)
v_mfma_f32_32x32x16_bf16 v[144:159], v[72:75], v[40:43], v[144:159]
s_waitcnt vmcnt(8)
v_mfma_f32_32x32x16_bf16 v[144:159], v[76:79], v[44:47], v[144:159]
s_waitcnt vmcnt(7)
v_mfma_f32_32x32x16_bf16 v[144:159], v[80:83], v[48:51], v[144:159]
s_waitcnt vmcnt(6)
v_mfma_f32_32x32x16_bf16 v[144:159], v[84:87], v[52:55], v[144:159]
s_waitcnt vmcnt(5)
v_mfma_f32_32x32x16_bf16 v[144:159], v[88:91], v[56:59], v[144:159]
s_waitcnt vmcnt(4)
v_mfma_f32_32x32x16_bf16 v[144:159], v[92:95], v[60:63], v[144:159]
s_nop 11
v_max3_f32 v148, v200, v144, v145
v_max3_f32 v148, v148, v146, v147
v_mov_b32 v150, v148
s_nop 1
v_permlane32_swap_b32 v148, v150
v_max_f32 v148, v148, v150
v_sub_f32 v145, v145, v148
v_sub_f32 v146, v146, v148
v_sub_f32 v144, v144, v148
v_exp_f32 v145, v145
v_sub_f32 v147, v147, v148
v_exp_f32 v146, v146
v_exp_f32 v144, v144
v_exp_f32 v147, v147
v_cvt_pk_bf16_f32 v40, v144, v145
v_cvt_pk_bf16_f32 v41, v146, v147
v_sub_f32 v132, v132, v148
v_sub_f32 v128, v128, v148
s_waitcnt vmcnt(3)
v_mfma_f32_32x32x8_bf16 v[160:175], v[192:193], v[40:41], 0
v_sub_f32 v133, v133, v148
v_sub_f32 v130, v130, v148
v_sub_f32 v134, v134, v148
v_sub_f32 v131, v131, v148
v_exp_f32 v132, v132
s_waitcnt vmcnt(0)
v_mfma_f32_32x32x8_bf16 v[80:95], v[198:199], v[40:41], 0
v_sub_f32 v129, v129, v148
v_sub_f32 v135, v135, v148
v_exp_f32 v128, v128
v_exp_f32 v133, v133
v_mfma_f32_32x32x8_bf16 v[176:191], v[194:195], v[40:41], 0
v_exp_f32 v130, v130
v_exp_f32 v135, v135
v_exp_f32 v131, v131
v_mfma_f32_32x32x8_bf16 v[64:79], v[196:197], v[40:41], 0
v_exp_f32 v129, v129
v_cvt_pk_bf16_f32 v33, v130, v131
v_cvt_pk_bf16_f32 v34, v132, v133
v_exp_f32 v134, v134
v_cvt_pk_bf16_f32 v32, v128, v129
v_cvt_pk_bf16_f32 v35, v134, v135
v_sub_f32 v136, v136, v148
v_sub_f32 v140, v140, v148
v_mfma_f32_32x32x16_bf16 v[176:191], v[104:107], v[32:35], v[176:191]
v_sub_f32 v141, v141, v148
v_sub_f32 v142, v142, v148
v_sub_f32 v139, v139, v148
v_sub_f32 v138, v138, v148
v_sub_f32 v137, v137, v148
v_sub_f32 v143, v143, v148
v_mfma_f32_32x32x16_bf16 v[64:79], v[112:115], v[32:35], v[64:79]
v_exp_f32 v139, v139
v_exp_f32 v136, v136
v_exp_f32 v141, v141
v_mfma_f32_32x32x16_bf16 v[160:175], v[96:99], v[32:35], v[160:175]
s_add_u32 s19, s27, 4096
v_exp_f32 v142, v142
v_exp_f32 v143, v143
v_exp_f32 v138, v138
v_mfma_f32_32x32x16_bf16 v[80:95], v[120:123], v[32:35], v[80:95]
v_exp_f32 v137, v137
v_cvt_pk_bf16_f32 v37, v138, v139
v_cvt_pk_bf16_f32 v36, v136, v137
v_exp_f32 v140, v140
v_cvt_pk_bf16_f32 v39, v142, v143
v_cvt_pk_bf16_f32 v38, v140, v141
v_add_f32 v149, v128, v129
v_add_f32 v149, v149, v130
v_mfma_f32_32x32x16_bf16 v[160:175], v[100:103], v[36:39], v[160:175]
v_add_f32 v149, v149, v131
v_add_f32 v149, v149, v132
v_add_f32 v149, v149, v133
v_add_f32 v149, v149, v134
v_add_f32 v149, v149, v135
v_add_f32 v149, v149, v136
v_mfma_f32_32x32x16_bf16 v[176:191], v[108:111], v[36:39], v[176:191]
v_add_f32 v149, v149, v137
v_add_f32 v149, v149, v138
v_add_f32 v149, v149, v139
v_add_f32 v149, v149, v140
v_add_f32 v149, v149, v141
v_add_f32 v149, v149, v142
v_mfma_f32_32x32x16_bf16 v[80:95], v[124:127], v[36:39], v[80:95]
v_add_f32 v149, v149, v143
v_add_f32 v149, v149, v144
v_add_f32 v149, v149, v145
v_add_f32 v149, v149, v146
v_add_f32 v149, v149, v147
v_mov_b32 v150, v149
v_mfma_f32_32x32x16_bf16 v[64:79], v[116:119], v[36:39], v[64:79]
s_nop 0
v_permlane32_swap_b32 v149, v150
v_add_f32 v149, v149, v150
v_rcp_f32 v149, v149
s_nop 0
v_mul_f32 v171, v171, v149
v_mul_f32 v167, v167, v149
v_mul_f32 v160, v160, v149
v_mul_f32 v178, v178, v149
v_mul_f32 v191, v191, v149
v_mul_f32 v172, v172, v149
v_mul_f32 v162, v162, v149
v_mul_f32 v76, v76, v149
v_mul_f32 v161, v161, v149
v_mul_f32 v78, v78, v149
v_mul_f32 v163, v163, v149
v_mul_f32 v90, v90, v149
v_mul_f32 v177, v177, v149
v_mul_f32 v71, v71, v149
v_mul_f32 v174, v174, v149
v_mul_f32 v79, v79, v149
v_cvt_pk_bf16_f32 v160, v160, v161
v_mul_f32 v190, v190, v149
v_mul_f32 v181, v181, v149
v_mul_f32 v85, v85, v149
v_mul_f32 v176, v176, v149
v_mul_f32 v179, v179, v149
v_mul_f32 v80, v80, v149
v_mul_f32 v64, v64, v149
v_mul_f32 v73, v73, v149
v_mul_f32 v168, v168, v149
v_mul_f32 v87, v87, v149
v_mul_f32 v175, v175, v149
v_mul_f32 v188, v188, v149
v_mul_f32 v86, v86, v149
v_mul_f32 v182, v182, v149
v_mul_f32 v165, v165, v149
v_mul_f32 v65, v65, v149
v_mul_f32 v180, v180, v149
v_mul_f32 v164, v164, v149
v_mul_f32 v84, v84, v149
v_mul_f32 v170, v170, v149
v_cvt_pk_bf16_f32 v176, v176, v177
v_cvt_pk_bf16_f32 v177, v178, v179
v_mul_f32 v166, v166, v149
v_mul_f32 v169, v169, v149
v_mul_f32 v184, v184, v149
v_cvt_pk_bf16_f32 v161, v162, v163
v_cvt_pk_bf16_f32 v163, v166, v167
v_mul_f32 v173, v173, v149
v_mul_f32 v88, v88, v149
v_cvt_pk_bf16_f32 v162, v164, v165
v_mul_f32 v189, v189, v149
v_mul_f32 v74, v74, v149
v_mul_f32 v82, v82, v149
v_mul_f32 v81, v81, v149
v_mul_f32 v77, v77, v149
v_cvt_pk_bf16_f32 v64, v64, v65
v_mul_f32 v183, v183, v149
v_mul_f32 v185, v185, v149
v_cvt_pk_bf16_f32 v164, v168, v169
v_mul_f32 v68, v68, v149
v_cvt_pk_bf16_f32 v179, v182, v183
v_cvt_pk_bf16_f32 v167, v174, v175
v_cvt_pk_bf16_f32 v178, v180, v181
v_mul_f32 v93, v93, v149
v_mul_f32 v187, v187, v149
v_cvt_pk_bf16_f32 v166, v172, v173
v_mul_f32 v66, v66, v149
v_cvt_pk_bf16_f32 v165, v170, v171
v_mul_f32 v67, v67, v149
v_mul_f32 v69, v69, v149
v_mul_f32 v83, v83, v149
buffer_store_dwordx4 v[160:163], v0, s[4:7], s27 offen offset:0 sc1
buffer_store_dwordx4 v[164:167], v0, s[4:7], s27 offen offset:1024 sc1
buffer_store_dwordx4 v[176:179], v0, s[4:7], s27 offen offset:2048 sc1
v_mul_f32 v94, v94, v149
v_cvt_pk_bf16_f32 v180, v184, v185
v_mul_f32 v89, v89, v149
v_cvt_pk_bf16_f32 v65, v66, v67
v_cvt_pk_bf16_f32 v182, v188, v189
v_mul_f32 v72, v72, v149
v_mul_f32 v95, v95, v149
v_mul_f32 v186, v186, v149
v_mul_f32 v92, v92, v149
v_mul_f32 v70, v70, v149
v_mul_f32 v75, v75, v149
v_cvt_pk_bf16_f32 v80, v80, v81
v_cvt_pk_bf16_f32 v81, v82, v83
v_cvt_pk_bf16_f32 v67, v70, v71
v_cvt_pk_bf16_f32 v66, v68, v69
v_cvt_pk_bf16_f32 v83, v86, v87
v_cvt_pk_bf16_f32 v183, v190, v191
v_cvt_pk_bf16_f32 v70, v76, v77
v_cvt_pk_bf16_f32 v82, v84, v85
v_cvt_pk_bf16_f32 v71, v78, v79
v_cvt_pk_bf16_f32 v87, v94, v95
v_cvt_pk_bf16_f32 v69, v74, v75
v_cvt_pk_bf16_f32 v84, v88, v89
v_mul_f32 v91, v91, v149
v_cvt_pk_bf16_f32 v86, v92, v93
v_cvt_pk_bf16_f32 v85, v90, v91
v_cvt_pk_bf16_f32 v68, v72, v73
v_cvt_pk_bf16_f32 v181, v186, v187
buffer_store_dwordx4 v[180:183], v0, s[4:7], s27 offen offset:3072 sc1
buffer_store_dwordx4 v[64:67], v0, s[4:7], s19 offen offset:0 sc1
buffer_store_dwordx4 v[68:71], v0, s[4:7], s19 offen offset:1024 sc1
buffer_store_dwordx4 v[80:83], v0, s[4:7], s19 offen offset:2048 sc1
buffer_store_dwordx4 v[84:87], v0, s[4:7], s19 offen offset:3072 sc1
s_and_b32 s18, s30, 7
s_lshl_b32 s18, s18, 5
s_add_u32 s18, s18, s32
s_lshl_b32 s18, s18, 7
s_add_u32 s18, s18, 11632640
s_waitcnt vmcnt(0)
v_mov_b32 v3, s28
s_mov_b64 exec, 1
buffer_store_dword v3, off, s[4:7], s18 sc1
s_mov_b64 exec, -1
s_add_u32 s52, s52, 2
s_cmp_lt_u32 s52, 16
s_cbranch_scc1 qr_68
s_barrier
s_branch aend_64
wo_62:
s_sub_u32 s18, s39, 64
s_mul_i32 s30, s18, 3277
s_lshr_b32 s30, s30, 16
s_mul_i32 s19, s30, 20
s_sub_u32 s52, s18, s19
s_cmp_lg_u32 s16, 0
s_cbranch_scc1 ww_74
s_mul_i32 s26, s13, 1310720
s_lshl_b32 s18, s52, 6
s_add_u32 s26, s26, s18
s_load_dwordx2 s[40:41], s[0:1], 64
s_mov_b32 s42, 5242880
s_mov_b32 s43, 0x20000
s_waitcnt lgkmcnt(0)
v_lshrrev_b32 v214, 6, v0
v_mul_u32_u24 v214, 1280, v214
v_and_b32 v215, 48, v0
v_add_u32 v212, v214, v215
v_bfe_u32 v214, v0, 6, 2
v_lshrrev_b32 v215, 9, v0
v_lshl_add_u32 v214, v215, 3, v214
v_lshlrev_b32 v213, 6, v214
v_and_b32 v214, 16, v0
v_add_u32 v213, v213, v214
v_bfe_u32 v214, v0, 5, 1
v_lshl_add_u32 v213, v214, 3, v213
v_bfe_u32 v214, v0, 8, 1
v_lshl_add_u32 v213, v214, 5, v213
s_mul_i32 s18, s13, 36864
v_add_u32 v213, s18, v213
s_barrier
s_add_u32 m0, s18, 0
s_add_u32 s19, s26, 0
buffer_load_dwordx4 v212, s[40:43], s19 offen lds
s_add_u32 m0, s18, 1024
s_add_u32 s19, s26, 20480
buffer_load_dwordx4 v212, s[40:43], s19 offen lds
s_add_u32 m0, s18, 2048
s_add_u32 s19, s26, 40960
buffer_load_dwordx4 v212, s[40:43], s19 offen lds
s_add_u32 m0, s18, 3072
s_add_u32 s19, s26, 61440
buffer_load_dwordx4 v212, s[40:43], s19 offen lds
s_add_u32 m0, s18, 4096
s_add_u32 s19, s26, 81920
buffer_load_dwordx4 v212, s[40:43], s19 offen lds
s_add_u32 m0, s18, 5120
s_add_u32 s19, s26, 102400
buffer_load_dwordx4 v212, s[40:43], s19 offen lds
s_add_u32 m0, s18, 6144
s_add_u32 s19, s26, 122880
buffer_load_dwordx4 v212, s[40:43], s19 offen lds
s_add_u32 m0, s18, 7168
s_add_u32 s19, s26, 143360
buffer_load_dwordx4 v212, s[40:43], s19 offen lds
s_add_u32 m0, s18, 8192
s_add_u32 s19, s26, 163840
buffer_load_dwordx4 v212, s[40:43], s19 offen lds
s_add_u32 m0, s18, 9216
s_add_u32 s19, s26, 184320
buffer_load_dwordx4 v212, s[40:43], s19 offen lds
s_add_u32 m0, s18, 10240
s_add_u32 s19, s26, 204800
buffer_load_dwordx4 v212, s[40:43], s19 offen lds
s_add_u32 m0, s18, 11264
s_add_u32 s19, s26, 225280
buffer_load_dwordx4 v212, s[40:43], s19 offen lds
s_add_u32 m0, s18, 12288
s_add_u32 s19, s26, 245760
buffer_load_dwordx4 v212, s[40:43], s19 offen lds
s_add_u32 m0, s18, 13312
s_add_u32 s19, s26, 266240
buffer_load_dwordx4 v212, s[40:43], s19 offen lds
s_add_u32 m0, s18, 14336
s_add_u32 s19, s26, 286720
buffer_load_dwordx4 v212, s[40:43], s19 offen lds
s_add_u32 m0, s18, 15360
s_add_u32 s19, s26, 307200
buffer_load_dwordx4 v212, s[40:43], s19 offen lds
s_add_u32 m0, s18, 16384
s_add_u32 s19, s26, 327680
buffer_load_dwordx4 v212, s[40:43], s19 offen lds
s_add_u32 m0, s18, 17408
s_add_u32 s19, s26, 348160
buffer_load_dwordx4 v212, s[40:43], s19 offen lds
s_add_u32 m0, s18, 18432
s_add_u32 s19, s26, 368640
buffer_load_dwordx4 v212, s[40:43], s19 offen lds
s_add_u32 m0, s18, 19456
s_add_u32 s19, s26, 389120
buffer_load_dwordx4 v212, s[40:43], s19 offen lds
s_add_u32 m0, s18, 20480
s_add_u32 s19, s26, 409600
buffer_load_dwordx4 v212, s[40:43], s19 offen lds
s_add_u32 m0, s18, 21504
s_add_u32 s19, s26, 430080
buffer_load_dwordx4 v212, s[40:43], s19 offen lds
s_add_u32 m0, s18, 22528
s_add_u32 s19, s26, 450560
buffer_load_dwordx4 v212, s[40:43], s19 offen lds
s_add_u32 m0, s18, 23552
s_add_u32 s19, s26, 471040
buffer_load_dwordx4 v212, s[40:43], s19 offen lds
s_add_u32 m0, s18, 24576
s_add_u32 s19, s26, 491520
buffer_load_dwordx4 v212, s[40:43], s19 offen lds
s_add_u32 m0, s18, 25600
s_add_u32 s19, s26, 512000
buffer_load_dwordx4 v212, s[40:43], s19 offen lds
s_add_u32 m0, s18, 26624
s_add_u32 s19, s26, 532480
buffer_load_dwordx4 v212, s[40:43], s19 offen lds
s_add_u32 m0, s18, 27648
s_add_u32 s19, s26, 552960
buffer_load_dwordx4 v212, s[40:43], s19 offen lds
s_add_u32 m0, s18, 28672
s_add_u32 s19, s26, 573440
buffer_load_dwordx4 v212, s[40:43], s19 offen lds
s_add_u32 m0, s18, 29696
s_add_u32 s19, s26, 593920
buffer_load_dwordx4 v212, s[40:43], s19 offen lds
s_add_u32 m0, s18, 30720
s_add_u32 s19, s26, 614400
buffer_load_dwordx4 v212, s[40:43], s19 offen lds
s_add_u32 m0, s18, 31744
s_add_u32 s19, s26, 634880
buffer_load_dwordx4 v212, s[40:43], s19 offen lds
s_add_u32 m0, s18, 32768
s_add_u32 s19, s26, 655360
buffer_load_dwordx4 v212, s[40:43], s19 offen lds
s_add_u32 m0, s18, 33792
s_add_u32 s19, s26, 675840
buffer_load_dwordx4 v212, s[40:43], s19 offen lds
s_add_u32 m0, s18, 34816
s_add_u32 s19, s26, 696320
buffer_load_dwordx4 v212, s[40:43], s19 offen lds
s_add_u32 m0, s18, 35840
s_add_u32 s19, s26, 716800
buffer_load_dwordx4 v212, s[40:43], s19 offen lds
s_waitcnt vmcnt(32)
ds_read_b64_tr_b16 a[0:1], v213 offset:0
ds_read_b64_tr_b16 a[2:3], v213 offset:256
ds_read_b64_tr_b16 a[4:5], v213 offset:1024
ds_read_b64_tr_b16 a[6:7], v213 offset:1280
ds_read_b64_tr_b16 a[8:9], v213 offset:2048
ds_read_b64_tr_b16 a[10:11], v213 offset:2304
ds_read_b64_tr_b16 a[12:13], v213 offset:3072
ds_read_b64_tr_b16 a[14:15], v213 offset:3328
s_waitcnt lgkmcnt(0)
s_add_u32 m0, s18, 0
s_add_u32 s19, s26, 737280
buffer_load_dwordx4 v212, s[40:43], s19 offen lds
s_add_u32 m0, s18, 1024
s_add_u32 s19, s26, 757760
buffer_load_dwordx4 v212, s[40:43], s19 offen lds
s_add_u32 m0, s18, 2048
s_add_u32 s19, s26, 778240
buffer_load_dwordx4 v212, s[40:43], s19 offen lds
s_add_u32 m0, s18, 3072
s_add_u32 s19, s26, 798720
buffer_load_dwordx4 v212, s[40:43], s19 offen lds
s_waitcnt vmcnt(32)
ds_read_b64_tr_b16 a[16:17], v213 offset:4096
ds_read_b64_tr_b16 a[18:19], v213 offset:4352
ds_read_b64_tr_b16 a[20:21], v213 offset:5120
ds_read_b64_tr_b16 a[22:23], v213 offset:5376
ds_read_b64_tr_b16 a[24:25], v213 offset:6144
ds_read_b64_tr_b16 a[26:27], v213 offset:6400
ds_read_b64_tr_b16 a[28:29], v213 offset:7168
ds_read_b64_tr_b16 a[30:31], v213 offset:7424
s_waitcnt lgkmcnt(0)
s_add_u32 m0, s18, 4096
s_add_u32 s19, s26, 819200
buffer_load_dwordx4 v212, s[40:43], s19 offen lds
s_add_u32 m0, s18, 5120
s_add_u32 s19, s26, 839680
buffer_load_dwordx4 v212, s[40:43], s19 offen lds
s_add_u32 m0, s18, 6144
s_add_u32 s19, s26, 860160
buffer_load_dwordx4 v212, s[40:43], s19 offen lds
s_add_u32 m0, s18, 7168
s_add_u32 s19, s26, 880640
buffer_load_dwordx4 v212, s[40:43], s19 offen lds
s_waitcnt vmcnt(32)
ds_read_b64_tr_b16 a[32:33], v213 offset:8192
ds_read_b64_tr_b16 a[34:35], v213 offset:8448
ds_read_b64_tr_b16 a[36:37], v213 offset:9216
ds_read_b64_tr_b16 a[38:39], v213 offset:9472
ds_read_b64_tr_b16 a[40:41], v213 offset:10240
ds_read_b64_tr_b16 a[42:43], v213 offset:10496
ds_read_b64_tr_b16 a[44:45], v213 offset:11264
ds_read_b64_tr_b16 a[46:47], v213 offset:11520
s_waitcnt lgkmcnt(0)
s_add_u32 m0, s18, 8192
s_add_u32 s19, s26, 901120
buffer_load_dwordx4 v212, s[40:43], s19 offen lds
s_add_u32 m0, s18, 9216
s_add_u32 s19, s26, 921600
buffer_load_dwordx4 v212, s[40:43], s19 offen lds
s_add_u32 m0, s18, 10240
s_add_u32 s19, s26, 942080
buffer_load_dwordx4 v212, s[40:43], s19 offen lds
s_add_u32 m0, s18, 11264
s_add_u32 s19, s26, 962560
buffer_load_dwordx4 v212, s[40:43], s19 offen lds
s_waitcnt vmcnt(32)
ds_read_b64_tr_b16 a[48:49], v213 offset:12288
ds_read_b64_tr_b16 a[50:51], v213 offset:12544
ds_read_b64_tr_b16 a[52:53], v213 offset:13312
ds_read_b64_tr_b16 a[54:55], v213 offset:13568
ds_read_b64_tr_b16 a[56:57], v213 offset:14336
ds_read_b64_tr_b16 a[58:59], v213 offset:14592
ds_read_b64_tr_b16 a[60:61], v213 offset:15360
ds_read_b64_tr_b16 a[62:63], v213 offset:15616
s_waitcnt lgkmcnt(0)
s_add_u32 m0, s18, 12288
s_add_u32 s19, s26, 983040
buffer_load_dwordx4 v212, s[40:43], s19 offen lds
s_add_u32 m0, s18, 13312
s_add_u32 s19, s26, 1003520
buffer_load_dwordx4 v212, s[40:43], s19 offen lds
s_add_u32 m0, s18, 14336
s_add_u32 s19, s26, 1024000
buffer_load_dwordx4 v212, s[40:43], s19 offen lds
s_add_u32 m0, s18, 15360
s_add_u32 s19, s26, 1044480
buffer_load_dwordx4 v212, s[40:43], s19 offen lds
s_waitcnt vmcnt(32)
ds_read_b64_tr_b16 a[64:65], v213 offset:16384
ds_read_b64_tr_b16 a[66:67], v213 offset:16640
ds_read_b64_tr_b16 a[68:69], v213 offset:17408
ds_read_b64_tr_b16 a[70:71], v213 offset:17664
ds_read_b64_tr_b16 a[72:73], v213 offset:18432
ds_read_b64_tr_b16 a[74:75], v213 offset:18688
ds_read_b64_tr_b16 a[76:77], v213 offset:19456
ds_read_b64_tr_b16 a[78:79], v213 offset:19712
s_waitcnt lgkmcnt(0)
s_add_u32 m0, s18, 16384
s_add_u32 s19, s26, 1064960
buffer_load_dwordx4 v212, s[40:43], s19 offen lds
s_add_u32 m0, s18, 17408
s_add_u32 s19, s26, 1085440
buffer_load_dwordx4 v212, s[40:43], s19 offen lds
s_add_u32 m0, s18, 18432
s_add_u32 s19, s26, 1105920
buffer_load_dwordx4 v212, s[40:43], s19 offen lds
s_add_u32 m0, s18, 19456
s_add_u32 s19, s26, 1126400
buffer_load_dwordx4 v212, s[40:43], s19 offen lds
s_waitcnt vmcnt(32)
ds_read_b64_tr_b16 a[80:81], v213 offset:20480
ds_read_b64_tr_b16 a[82:83], v213 offset:20736
ds_read_b64_tr_b16 a[84:85], v213 offset:21504
ds_read_b64_tr_b16 a[86:87], v213 offset:21760
ds_read_b64_tr_b16 a[88:89], v213 offset:22528
ds_read_b64_tr_b16 a[90:91], v213 offset:22784
ds_read_b64_tr_b16 a[92:93], v213 offset:23552
ds_read_b64_tr_b16 a[94:95], v213 offset:23808
s_waitcnt lgkmcnt(0)
s_add_u32 m0, s18, 20480
s_add_u32 s19, s26, 1146880
buffer_load_dwordx4 v212, s[40:43], s19 offen lds
s_add_u32 m0, s18, 21504
s_add_u32 s19, s26, 1167360
buffer_load_dwordx4 v212, s[40:43], s19 offen lds
s_add_u32 m0, s18, 22528
s_add_u32 s19, s26, 1187840
buffer_load_dwordx4 v212, s[40:43], s19 offen lds
s_add_u32 m0, s18, 23552
s_add_u32 s19, s26, 1208320
buffer_load_dwordx4 v212, s[40:43], s19 offen lds
s_waitcnt vmcnt(32)
ds_read_b64_tr_b16 a[96:97], v213 offset:24576
ds_read_b64_tr_b16 a[98:99], v213 offset:24832
ds_read_b64_tr_b16 a[100:101], v213 offset:25600
ds_read_b64_tr_b16 a[102:103], v213 offset:25856
ds_read_b64_tr_b16 a[104:105], v213 offset:26624
ds_read_b64_tr_b16 a[106:107], v213 offset:26880
ds_read_b64_tr_b16 a[108:109], v213 offset:27648
ds_read_b64_tr_b16 a[110:111], v213 offset:27904
s_waitcnt lgkmcnt(0)
s_add_u32 m0, s18, 24576
s_add_u32 s19, s26, 1228800
buffer_load_dwordx4 v212, s[40:43], s19 offen lds
s_add_u32 m0, s18, 25600
s_add_u32 s19, s26, 1249280
buffer_load_dwordx4 v212, s[40:43], s19 offen lds
s_add_u32 m0, s18, 26624
s_add_u32 s19, s26, 1269760
buffer_load_dwordx4 v212, s[40:43], s19 offen lds
s_add_u32 m0, s18, 27648
s_add_u32 s19, s26, 1290240
buffer_load_dwordx4 v212, s[40:43], s19 offen lds
s_waitcnt vmcnt(32)
ds_read_b64_tr_b16 a[112:113], v213 offset:28672
ds_read_b64_tr_b16 a[114:115], v213 offset:28928
ds_read_b64_tr_b16 a[116:117], v213 offset:29696
ds_read_b64_tr_b16 a[118:119], v213 offset:29952
ds_read_b64_tr_b16 a[120:121], v213 offset:30720
ds_read_b64_tr_b16 a[122:123], v213 offset:30976
ds_read_b64_tr_b16 a[124:125], v213 offset:31744
ds_read_b64_tr_b16 a[126:127], v213 offset:32000
s_waitcnt vmcnt(28)
ds_read_b64_tr_b16 a[128:129], v213 offset:32768
ds_read_b64_tr_b16 a[130:131], v213 offset:33024
ds_read_b64_tr_b16 a[132:133], v213 offset:33792
ds_read_b64_tr_b16 a[134:135], v213 offset:34048
ds_read_b64_tr_b16 a[136:137], v213 offset:34816
ds_read_b64_tr_b16 a[138:139], v213 offset:35072
ds_read_b64_tr_b16 a[140:141], v213 offset:35840
ds_read_b64_tr_b16 a[142:143], v213 offset:36096
s_waitcnt vmcnt(24)
ds_read_b64_tr_b16 a[144:145], v213 offset:0
ds_read_b64_tr_b16 a[146:147], v213 offset:256
ds_read_b64_tr_b16 a[148:149], v213 offset:1024
ds_read_b64_tr_b16 a[150:151], v213 offset:1280
ds_read_b64_tr_b16 a[152:153], v213 offset:2048
ds_read_b64_tr_b16 a[154:155], v213 offset:2304
ds_read_b64_tr_b16 a[156:157], v213 offset:3072
ds_read_b64_tr_b16 a[158:159], v213 offset:3328
s_waitcnt vmcnt(20)
ds_read_b64_tr_b16 a[160:161], v213 offset:4096
ds_read_b64_tr_b16 a[162:163], v213 offset:4352
ds_read_b64_tr_b16 a[164:165], v213 offset:5120
ds_read_b64_tr_b16 a[166:167], v213 offset:5376
ds_read_b64_tr_b16 a[168:169], v213 offset:6144
ds_read_b64_tr_b16 a[170:171], v213 offset:6400
ds_read_b64_tr_b16 a[172:173], v213 offset:7168
ds_read_b64_tr_b16 a[174:175], v213 offset:7424
s_waitcnt vmcnt(16)
ds_read_b64_tr_b16 a[176:177], v213 offset:8192
ds_read_b64_tr_b16 a[178:179], v213 offset:8448
ds_read_b64_tr_b16 a[180:181], v213 offset:9216
ds_read_b64_tr_b16 a[182:183], v213 offset:9472
ds_read_b64_tr_b16 a[184:185], v213 offset:10240
ds_read_b64_tr_b16 a[186:187], v213 offset:10496
ds_read_b64_tr_b16 a[188:189], v213 offset:11264
ds_read_b64_tr_b16 a[190:191], v213 offset:11520
s_waitcnt vmcnt(12)
ds_read_b64_tr_b16 a[192:193], v213 offset:12288
ds_read_b64_tr_b16 a[194:195], v213 offset:12544
ds_read_b64_tr_b16 a[196:197], v213 offset:13312
ds_read_b64_tr_b16 a[198:199], v213 offset:13568
ds_read_b64_tr_b16 a[200:201], v213 offset:14336
ds_read_b64_tr_b16 a[202:203], v213 offset:14592
ds_read_b64_tr_b16 a[204:205], v213 offset:15360
ds_read_b64_tr_b16 a[206:207], v213 offset:15616
s_waitcnt vmcnt(8)
ds_read_b64_tr_b16 a[208:209], v213 offset:16384
ds_read_b64_tr_b16 a[210:211], v213 offset:16640
ds_read_b64_tr_b16 a[212:213], v213 offset:17408
ds_read_b64_tr_b16 a[214:215], v213 offset:17664
ds_read_b64_tr_b16 a[216:217], v213 offset:18432
ds_read_b64_tr_b16 a[218:219], v213 offset:18688
ds_read_b64_tr_b16 a[220:221], v213 offset:19456
ds_read_b64_tr_b16 a[222:223], v213 offset:19712
s_waitcnt vmcnt(4)
ds_read_b64_tr_b16 a[224:225], v213 offset:20480
ds_read_b64_tr_b16 a[226:227], v213 offset:20736
ds_read_b64_tr_b16 a[228:229], v213 offset:21504
ds_read_b64_tr_b16 a[230:231], v213 offset:21760
ds_read_b64_tr_b16 a[232:233], v213 offset:22528
ds_read_b64_tr_b16 a[234:235], v213 offset:22784
ds_read_b64_tr_b16 a[236:237], v213 offset:23552
ds_read_b64_tr_b16 a[238:239], v213 offset:23808
s_waitcnt vmcnt(0)
ds_read_b64_tr_b16 a[240:241], v213 offset:24576
ds_read_b64_tr_b16 a[242:243], v213 offset:24832
ds_read_b64_tr_b16 a[244:245], v213 offset:25600
ds_read_b64_tr_b16 a[246:247], v213 offset:25856
ds_read_b64_tr_b16 a[248:249], v213 offset:26624
ds_read_b64_tr_b16 a[250:251], v213 offset:26880
ds_read_b64_tr_b16 a[252:253], v213 offset:27648
ds_read_b64_tr_b16 a[254:255], v213 offset:27904
s_waitcnt lgkmcnt(0)
s_barrier
ww_74:
s_load_dwordx2 s[56:57], s[0:1], 80
s_mov_b32 s58, 2621440
s_mov_b32 s59, 0x20000
s_waitcnt lgkmcnt(0)
s_lshl_b32 s18, s13, 12
v_add_u32 v13, s18, v0
s_lshl_b32 s18, s13, 11
v_add_u32 v14, s18, v0
s_add_u32 s53, s30, 56
s_cmp_eq_u32 s30, 3
s_cselect_b32 s30, s53, s30
ws_75:
s_lshl_b32 s18, s16, 6
s_add_u32 s18, s18, s30
s_lshl_b32 s26, s18, 18
s_lshl_b32 s19, s13, 16
s_add_u32 s26, s26, s19
s_add_u32 s26, s26, 127926272
s_add_u32 s38, s18, 1
s_and_b32 s18, s18, 7
s_lshl_b32 s18, s18, 12
s_add_u32 s18, s18, s37
s_add_u32 s28, s18, 11632640
s_mul_i32 s27, s30, 40960
s_and_b32 s18, s13, 1
s_lshl_b32 s19, s52, 1
s_add_u32 s29, s18, s19
v_lshlrev_b32 v3, 3, v0
v_min_u32 v12, 896, v3
s_mov_b32 s17, 0
poll_79:
buffer_load_dword v8, v12, s[4:7], s28 offen sc1
s_add_u32 s17, s17, 1
s_cmp_gt_u32 s17, 262144
s_cbranch_scc1 L_fail
s_waitcnt vmcnt(0)
v_cmp_gt_u32 vcc, s38, v8
s_cbranch_vccz polld_80
s_sleep 2
s_branch poll_79
polld_80:
s_lshl_b32 s18, s29, 10
s_add_u32 s18, s18, s27
s_mul_i32 s19, s16, 6291456
s_add_u32 s18, s18, s19
s_add_u32 s18, s18, 88080384
s_add_u32 s19, s26, 0
buffer_load_dwordx4 v[16:19], v0, s[4:7], s19 offen offset:0 sc1
buffer_load_dwordx4 v[20:23], v0, s[4:7], s19 offen offset:1024 sc1
buffer_load_dwordx4 v[24:27], v0, s[4:7], s19 offen offset:2048 sc1
buffer_load_dwordx4 v[28:31], v0, s[4:7], s19 offen offset:3072 sc1
s_add_u32 s19, s26, 4096
buffer_load_dwordx4 v[32:35], v0, s[4:7], s19 offen offset:0 sc1
buffer_load_dwordx4 v[36:39], v0, s[4:7], s19 offen offset:1024 sc1
buffer_load_dwordx4 v[40:43], v0, s[4:7], s19 offen offset:2048 sc1
buffer_load_dwordx4 v[44:47], v0, s[4:7], s19 offen offset:3072 sc1
s_add_u32 s19, s26, 8192
buffer_load_dwordx4 v[48:51], v0, s[4:7], s19 offen offset:0 sc1
buffer_load_dwordx4 v[52:55], v0, s[4:7], s19 offen offset:1024 sc1
buffer_load_dwordx4 v[56:59], v0, s[4:7], s19 offen offset:2048 sc1
buffer_load_dwordx4 v[60:63], v0, s[4:7], s19 offen offset:3072 sc1
s_add_u32 s19, s26, 12288
buffer_load_dwordx4 v[64:67], v0, s[4:7], s19 offen offset:0 sc1
buffer_load_dwordx4 v[68:71], v0, s[4:7], s19 offen offset:1024 sc1
buffer_load_dwordx4 v[72:75], v0, s[4:7], s19 offen offset:2048 sc1
buffer_load_dwordx4 v[76:79], v0, s[4:7], s19 offen offset:3072 sc1
s_add_u32 s19, s26, 16384
buffer_load_dwordx4 v[80:83], v0, s[4:7], s19 offen offset:0 sc1
buffer_load_dwordx4 v[84:87], v0, s[4:7], s19 offen offset:1024 sc1
buffer_load_dwordx4 v[88:91], v0, s[4:7], s19 offen offset:2048 sc1
buffer_load_dwordx4 v[92:95], v0, s[4:7], s19 offen offset:3072 sc1
s_add_u32 s19, s26, 20480
buffer_load_dwordx4 v[96:99], v0, s[4:7], s19 offen offset:0 sc1
buffer_load_dwordx4 v[100:103], v0, s[4:7], s19 offen offset:1024 sc1
buffer_load_dwordx4 v[104:107], v0, s[4:7], s19 offen offset:2048 sc1
buffer_load_dwordx4 v[108:111], v0, s[4:7], s19 offen offset:3072 sc1
s_add_u32 s19, s26, 24576
buffer_load_dwordx4 v[112:115], v0, s[4:7], s19 offen offset:0 sc1
buffer_load_dwordx4 v[116:119], v0, s[4:7], s19 offen offset:1024 sc1
buffer_load_dwordx4 v[120:123], v0, s[4:7], s19 offen offset:2048 sc1
buffer_load_dwordx4 v[124:127], v0, s[4:7], s19 offen offset:3072 sc1
s_add_u32 s19, s26, 28672
buffer_load_dwordx4 v[128:131], v0, s[4:7], s19 offen offset:0 sc1
buffer_load_dwordx4 v[132:135], v0, s[4:7], s19 offen offset:1024 sc1
buffer_load_dwordx4 v[136:139], v0, s[4:7], s19 offen offset:2048 sc1
buffer_load_dwordx4 v[140:143], v0, s[4:7], s19 offen offset:3072 sc1
s_add_u32 s19, s26, 32768
buffer_load_dwordx4 v[144:147], v0, s[4:7], s19 offen offset:0 sc1
buffer_load_dwordx4 v[148:151], v0, s[4:7], s19 offen offset:1024 sc1
buffer_load_dwordx4 v[152:155], v0, s[4:7], s19 offen offset:2048 sc1
buffer_load_dwordx4 v[156:159], v0, s[4:7], s19 offen offset:3072 sc1
s_add_u32 s19, s26, 36864
buffer_load_dwordx4 v[160:163], v0, s[4:7], s19 offen offset:0 sc1
buffer_load_dwordx4 v[164:167], v0, s[4:7], s19 offen offset:1024 sc1
buffer_load_dwordx4 v[168:171], v0, s[4:7], s19 offen offset:2048 sc1
buffer_load_dwordx4 v[172:175], v0, s[4:7], s19 offen offset:3072 sc1
s_add_u32 s19, s26, 40960
buffer_load_dwordx4 v[176:179], v0, s[4:7], s19 offen offset:0 sc1
buffer_load_dwordx4 v[180:183], v0, s[4:7], s19 offen offset:1024 sc1
buffer_load_dwordx4 v[184:187], v0, s[4:7], s19 offen offset:2048 sc1
buffer_load_dwordx4 v[188:191], v0, s[4:7], s19 offen offset:3072 sc1
s_waitcnt vmcnt(43)
v_mfma_f32_32x32x16_bf16 v[192:207], a[0:3], v[16:19], 0
s_add_u32 s19, s26, 45056
buffer_load_dwordx4 v[16:19], v0, s[4:7], s19 offen offset:0 sc1
s_waitcnt vmcnt(43)
v_mfma_f32_32x32x16_bf16 v[192:207], a[4:7], v[20:23], v[192:207]
buffer_load_dwordx4 v[20:23], v0, s[4:7], s19 offen offset:1024 sc1
s_waitcnt vmcnt(43)
v_mfma_f32_32x32x16_bf16 v[192:207], a[8:11], v[24:27], v[192:207]
buffer_load_dwordx4 v[24:27], v0, s[4:7], s19 offen offset:2048 sc1
s_waitcnt vmcnt(43)
v_mfma_f32_32x32x16_bf16 v[192:207], a[12:15], v[28:31], v[192:207]
buffer_load_dwordx4 v[28:31], v0, s[4:7], s19 offen offset:3072 sc1
s_waitcnt vmcnt(43)
v_mfma_f32_32x32x16_bf16 v[192:207], a[16:19], v[32:35], v[192:207]
s_add_u32 s19, s26, 49152
buffer_load_dwordx4 v[32:35], v0, s[4:7], s19 offen offset:0 sc1
s_waitcnt vmcnt(43)
v_mfma_f32_32x32x16_bf16 v[192:207], a[20:23], v[36:39], v[192:207]
buffer_load_dwordx4 v[36:39], v0, s[4:7], s19 offen offset:1024 sc1
s_waitcnt vmcnt(43)
v_mfma_f32_32x32x16_bf16 v[192:207], a[24:27], v[40:43], v[192:207]
buffer_load_dwordx4 v[40:43], v0, s[4:7], s19 offen offset:2048 sc1
s_waitcnt vmcnt(43)
v_mfma_f32_32x32x16_bf16 v[192:207], a[28:31], v[44:47], v[192:207]
buffer_load_dwordx4 v[44:47], v0, s[4:7], s19 offen offset:3072 sc1
s_waitcnt vmcnt(43)
v_mfma_f32_32x32x16_bf16 v[192:207], a[32:35], v[48:51], v[192:207]
s_add_u32 s19, s26, 53248
buffer_load_dwordx4 v[48:51], v0, s[4:7], s19 offen offset:0 sc1
s_waitcnt vmcnt(43)
v_mfma_f32_32x32x16_bf16 v[192:207], a[36:39], v[52:55], v[192:207]
buffer_load_dwordx4 v[52:55], v0, s[4:7], s19 offen offset:1024 sc1
s_waitcnt vmcnt(43)
v_mfma_f32_32x32x16_bf16 v[192:207], a[40:43], v[56:59], v[192:207]
buffer_load_dwordx4 v[56:59], v0, s[4:7], s19 offen offset:2048 sc1
s_waitcnt vmcnt(43)
v_mfma_f32_32x32x16_bf16 v[192:207], a[44:47], v[60:63], v[192:207]
buffer_load_dwordx4 v[60:63], v0, s[4:7], s19 offen offset:3072 sc1
s_waitcnt vmcnt(43)
v_mfma_f32_32x32x16_bf16 v[192:207], a[48:51], v[64:67], v[192:207]
s_add_u32 s19, s26, 57344
buffer_load_dwordx4 v[64:67], v0, s[4:7], s19 offen offset:0 sc1
s_waitcnt vmcnt(43)
v_mfma_f32_32x32x16_bf16 v[192:207], a[52:55], v[68:71], v[192:207]
buffer_load_dwordx4 v[68:71], v0, s[4:7], s19 offen offset:1024 sc1
s_waitcnt vmcnt(43)
v_mfma_f32_32x32x16_bf16 v[192:207], a[56:59], v[72:75], v[192:207]
buffer_load_dwordx4 v[72:75], v0, s[4:7], s19 offen offset:2048 sc1
s_waitcnt vmcnt(43)
v_mfma_f32_32x32x16_bf16 v[192:207], a[60:63], v[76:79], v[192:207]
buffer_load_dwordx4 v[76:79], v0, s[4:7], s19 offen offset:3072 sc1
s_waitcnt vmcnt(43)
v_mfma_f32_32x32x16_bf16 v[192:207], a[64:67], v[80:83], v[192:207]
s_add_u32 s19, s26, 61440
buffer_load_dwordx4 v[80:83], v0, s[4:7], s19 offen offset:0 sc1
s_waitcnt vmcnt(43)
v_mfma_f32_32x32x16_bf16 v[192:207], a[68:71], v[84:87], v[192:207]
buffer_load_dwordx4 v[84:87], v0, s[4:7], s19 offen offset:1024 sc1
s_waitcnt vmcnt(43)
v_mfma_f32_32x32x16_bf16 v[192:207], a[72:75], v[88:91], v[192:207]
buffer_load_dwordx4 v[88:91], v0, s[4:7], s19 offen offset:2048 sc1
s_waitcnt vmcnt(43)
v_mfma_f32_32x32x16_bf16 v[192:207], a[76:79], v[92:95], v[192:207]
buffer_load_dwordx4 v[92:95], v0, s[4:7], s19 offen offset:3072 sc1
s_waitcnt vmcnt(43)
v_mfma_f32_32x32x16_bf16 v[192:207], a[80:83], v[96:99], v[192:207]
buffer_load_dwordx4 v[208:211], v0, s[4:7], s18 offen sc1
s_waitcnt vmcnt(43)
v_mfma_f32_32x32x16_bf16 v[192:207], a[84:87], v[100:103], v[192:207]
s_waitcnt vmcnt(42)
v_mfma_f32_32x32x16_bf16 v[192:207], a[88:91], v[104:107], v[192:207]
s_waitcnt vmcnt(41)
v_mfma_f32_32x32x16_bf16 v[192:207], a[92:95], v[108:111], v[192:207]
s_waitcnt vmcnt(40)
v_mfma_f32_32x32x16_bf16 v[192:207], a[96:99], v[112:115], v[192:207]
s_waitcnt vmcnt(39)
v_mfma_f32_32x32x16_bf16 v[192:207], a[100:103], v[116:119], v[192:207]
s_waitcnt vmcnt(38)
v_mfma_f32_32x32x16_bf16 v[192:207], a[104:107], v[120:123], v[192:207]
s_waitcnt vmcnt(37)
v_mfma_f32_32x32x16_bf16 v[192:207], a[108:111], v[124:127], v[192:207]
s_waitcnt vmcnt(36)
v_mfma_f32_32x32x16_bf16 v[192:207], a[112:115], v[128:131], v[192:207]
s_waitcnt vmcnt(35)
v_mfma_f32_32x32x16_bf16 v[192:207], a[116:119], v[132:135], v[192:207]
s_waitcnt vmcnt(34)
v_mfma_f32_32x32x16_bf16 v[192:207], a[120:123], v[136:139], v[192:207]
s_waitcnt vmcnt(33)
v_mfma_f32_32x32x16_bf16 v[192:207], a[124:127], v[140:143], v[192:207]
s_waitcnt vmcnt(32)
v_mfma_f32_32x32x16_bf16 v[192:207], a[128:131], v[144:147], v[192:207]
s_waitcnt vmcnt(31)
v_mfma_f32_32x32x16_bf16 v[192:207], a[132:135], v[148:151], v[192:207]
s_waitcnt vmcnt(30)
v_mfma_f32_32x32x16_bf16 v[192:207], a[136:139], v[152:155], v[192:207]
s_waitcnt vmcnt(29)
v_mfma_f32_32x32x16_bf16 v[192:207], a[140:143], v[156:159], v[192:207]
s_waitcnt vmcnt(28)
v_mfma_f32_32x32x16_bf16 v[192:207], a[144:147], v[160:163], v[192:207]
s_waitcnt vmcnt(27)
v_mfma_f32_32x32x16_bf16 v[192:207], a[148:151], v[164:167], v[192:207]
s_waitcnt vmcnt(26)
v_mfma_f32_32x32x16_bf16 v[192:207], a[152:155], v[168:171], v[192:207]
s_waitcnt vmcnt(25)
v_mfma_f32_32x32x16_bf16 v[192:207], a[156:159], v[172:175], v[192:207]
s_waitcnt vmcnt(24)
v_mfma_f32_32x32x16_bf16 v[192:207], a[160:163], v[176:179], v[192:207]
s_waitcnt vmcnt(23)
v_mfma_f32_32x32x16_bf16 v[192:207], a[164:167], v[180:183], v[192:207]
s_waitcnt vmcnt(22)
v_mfma_f32_32x32x16_bf16 v[192:207], a[168:171], v[184:187], v[192:207]
s_waitcnt vmcnt(21)
v_mfma_f32_32x32x16_bf16 v[192:207], a[172:175], v[188:191], v[192:207]
s_waitcnt vmcnt(20)
v_mfma_f32_32x32x16_bf16 v[192:207], a[176:179], v[16:19], v[192:207]
s_waitcnt vmcnt(19)
v_mfma_f32_32x32x16_bf16 v[192:207], a[180:183], v[20:23], v[192:207]
s_waitcnt vmcnt(18)
v_mfma_f32_32x32x16_bf16 v[192:207], a[184:187], v[24:27], v[192:207]
s_waitcnt vmcnt(17)
v_mfma_f32_32x32x16_bf16 v[192:207], a[188:191], v[28:31], v[192:207]
s_waitcnt vmcnt(16)
v_mfma_f32_32x32x16_bf16 v[192:207], a[192:195], v[32:35], v[192:207]
s_waitcnt vmcnt(15)
v_mfma_f32_32x32x16_bf16 v[192:207], a[196:199], v[36:39], v[192:207]
s_waitcnt vmcnt(14)
v_mfma_f32_32x32x16_bf16 v[192:207], a[200:203], v[40:43], v[192:207]
s_waitcnt vmcnt(13)
v_mfma_f32_32x32x16_bf16 v[192:207], a[204:207], v[44:47], v[192:207]
s_waitcnt vmcnt(12)
v_mfma_f32_32x32x16_bf16 v[192:207], a[208:211], v[48:51], v[192:207]
s_waitcnt vmcnt(11)
v_mfma_f32_32x32x16_bf16 v[192:207], a[212:215], v[52:55], v[192:207]
s_waitcnt vmcnt(10)
v_mfma_f32_32x32x16_bf16 v[192:207], a[216:219], v[56:59], v[192:207]
s_waitcnt vmcnt(9)
v_mfma_f32_32x32x16_bf16 v[192:207], a[220:223], v[60:63], v[192:207]
s_waitcnt vmcnt(8)
v_mfma_f32_32x32x16_bf16 v[192:207], a[224:227], v[64:67], v[192:207]
s_waitcnt vmcnt(7)
v_mfma_f32_32x32x16_bf16 v[192:207], a[228:231], v[68:71], v[192:207]
s_waitcnt vmcnt(6)
v_mfma_f32_32x32x16_bf16 v[192:207], a[232:235], v[72:75], v[192:207]
s_waitcnt vmcnt(5)
v_mfma_f32_32x32x16_bf16 v[192:207], a[236:239], v[76:79], v[192:207]
s_waitcnt vmcnt(4)
v_mfma_f32_32x32x16_bf16 v[192:207], a[240:243], v[80:83], v[192:207]
s_waitcnt vmcnt(3)
v_mfma_f32_32x32x16_bf16 v[192:207], a[244:247], v[84:87], v[192:207]
s_waitcnt vmcnt(2)
v_mfma_f32_32x32x16_bf16 v[192:207], a[248:251], v[88:91], v[192:207]
s_waitcnt vmcnt(1)
v_mfma_f32_32x32x16_bf16 v[192:207], a[252:255], v[92:95], v[192:207]
s_nop 11
ds_write_b128 v13, v[192:195] offset:0
ds_write_b128 v13, v[196:199] offset:1024
ds_write_b128 v13, v[200:203] offset:2048
ds_write_b128 v13, v[204:207] offset:3072
s_waitcnt lgkmcnt(0)
s_barrier
s_cmp_ge_u32 s13, 2
s_cbranch_scc1 wn_76
ds_read_b128 v[16:19], v14 offset:0
ds_read_b128 v[20:23], v14 offset:1024
ds_read_b128 v[24:27], v14 offset:4096
ds_read_b128 v[28:31], v14 offset:5120
ds_read_b128 v[32:35], v14 offset:8192
ds_read_b128 v[36:39], v14 offset:9216
ds_read_b128 v[40:43], v14 offset:12288
ds_read_b128 v[44:47], v14 offset:13312
s_waitcnt vmcnt(0)
v_lshlrev_b32 v192, 16, v208
v_and_b32 v193, 0xffff0000, v208
v_lshlrev_b32 v194, 16, v209
v_and_b32 v195, 0xffff0000, v209
v_lshlrev_b32 v196, 16, v210
v_and_b32 v197, 0xffff0000, v210
v_lshlrev_b32 v198, 16, v211
v_and_b32 v199, 0xffff0000, v211
s_waitcnt lgkmcnt(5)
v_add_f32 v16, v16, v24
s_waitcnt lgkmcnt(1)
v_add_f32 v32, v32, v40
v_add_f32 v17, v17, v25
v_add_f32 v33, v33, v41
v_add_f32 v18, v18, v26
v_add_f32 v34, v34, v42
v_add_f32 v19, v19, v27
v_add_f32 v35, v35, v43
v_add_f32 v20, v20, v28
s_waitcnt lgkmcnt(0)
v_add_f32 v36, v36, v44
v_add_f32 v21, v21, v29
v_add_f32 v37, v37, v45
v_add_f32 v22, v22, v30
v_add_f32 v38, v38, v46
v_add_f32 v23, v23, v31
v_add_f32 v39, v39, v47
v_add_f32 v16, v16, v32
v_add_f32 v17, v17, v33
v_add_f32 v18, v18, v34
v_add_f32 v19, v19, v35
v_add_f32 v20, v20, v36
v_add_f32 v21, v21, v37
v_add_f32 v22, v22, v38
v_add_f32 v23, v23, v39
v_add_f32 v16, v16, v192
v_add_f32 v17, v17, v193
v_add_f32 v18, v18, v194
v_add_f32 v19, v19, v195
v_add_f32 v20, v20, v196
v_add_f32 v21, v21, v197
v_add_f32 v22, v22, v198
v_add_f32 v23, v23, v199
v_cvt_pk_bf16_f32 v208, v16, v17
v_cvt_pk_bf16_f32 v209, v18, v19
v_cvt_pk_bf16_f32 v210, v20, v21
v_cvt_pk_bf16_f32 v211, v22, v23
s_cmp_lg_u32 s16, 0
s_cbranch_scc1 wo_77
s_add_u32 s18, s18, 3145728
buffer_store_dwordx4 v[208:211], v0, s[4:7], s18 offen sc1
s_branch wn_76
wo_77:
s_lshl_b32 s18, s29, 5
s_add_u32 s18, s18, s27
buffer_store_dwordx4 v[208:211], v5, s[56:59], s18 offen
wn_76:
s_lshl_b32 s18, s39, 7
s_add_u32 s18, s18, 11657216
s_cmp_eq_u32 s13, 0
s_cselect_b32 s22, s18, s6
s_mov_b32 s23, s38
s_waitcnt vmcnt(0)
s_barrier
v_mov_b32 v3, s23
s_mov_b64 exec, 1
buffer_store_dword v3, off, s[4:7], s22 sc1
s_mov_b64 exec, -1
s_mov_b32 s22, s6
s_add_u32 s18, s30, 3
s_cmp_lt_u32 s18, 56
s_cselect_b32 s18, s18, s53
s_add_u32 s19, s30, 4
s_cmp_lt_u32 s30, 56
s_cselect_b32 s30, s18, s19
s_cmp_lt_u32 s30, 64
s_cbranch_scc1 ws_75
s_branch aend_64
p1b_63:
s_cmp_eq_u32 s39, 144
s_cbranch_scc1 aend_64
s_cmp_lg_u32 s16, 0
s_cbranch_scc1 aend_64
s_sub_u32 s30, s50, 29
s_sub_u32 s51, s39, 145
s_lshl_b32 s18, s34, 7
s_lshl_b32 s19, s13, 5
s_add_u32 s18, s18, s19
s_mov_b32 s19, 0x3acccccd
v_bfe_u32 v198, v0, 4, 5
v_lshrrev_b32 v193, 9, v0
v_add_u32 v198, s18, v198
v_and_b32 v197, 1, v198
v_mul_u32_u24 v197, 160, v197
v_lshrrev_b32 v196, 1, v198
v_add_u32 v196, 1, v196
v_lshlrev_b32 v193, 3, v193
v_mad_u32_u24 v197, v193, v196, v197
v_mad_u32_u24 v192, v196, 16, 0
v_cvt_f32_u32 v192, v192
v_mul_f32 v198, s19, v192
v_rndne_f32 v198, v198
v_fmac_f32 v192, 0xc4200000, v198
v_mul_f32 v192, s19, v192
v_cos_f32 v192, v192
s_nop 0
v_add_f32 v192, v192, v192
v_mad_u32_u24 v194, v196, 1, 0
v_cvt_f32_u32 v194, v194
v_mul_f32 v198, s19, v194
v_rndne_f32 v198, v198
v_fmac_f32 v194, 0xc4200000, v198
v_mul_f32 v194, s19, v194
v_cos_f32 v194, v194
s_nop 0
v_add_f32 v194, v194, v194
v_mad_u32_u24 v179, v196, 3, v197
v_cvt_f32_u32 v179, v179
v_mul_f32 v198, s19, v179
v_rndne_f32 v198, v198
v_fmac_f32 v179, 0xc4200000, v198
v_mul_f32 v179, s19, v179
v_cos_f32 v179, v179
v_mad_u32_u24 v180, v196, 4, v197
v_cvt_f32_u32 v180, v180
v_mul_f32 v198, s19, v180
v_rndne_f32 v198, v198
v_fmac_f32 v180, 0xc4200000, v198
v_mul_f32 v180, s19, v180
v_cos_f32 v180, v180
s_nop 0
v_fma_f32 v181, v194, v180, -v179
v_fma_f32 v178, v194, v179, -v180
v_fma_f32 v182, v194, v181, -v180
v_fma_f32 v177, v194, v178, -v179
v_fma_f32 v183, v194, v182, -v181
v_fma_f32 v176, v194, v177, -v178
v_cvt_pk_bf16_f32 v16, v176, v177
v_cvt_pk_bf16_f32 v17, v178, v179
v_cvt_pk_bf16_f32 v18, v180, v181
v_cvt_pk_bf16_f32 v19, v182, v183
v_mad_u32_u24 v187, v196, 19, v197
v_cvt_f32_u32 v187, v187
v_mul_f32 v198, s19, v187
v_rndne_f32 v198, v198
v_fmac_f32 v187, 0xc4200000, v198
v_mul_f32 v187, s19, v187
v_cos_f32 v187, v187
v_mad_u32_u24 v188, v196, 20, v197
v_cvt_f32_u32 v188, v188
v_mul_f32 v198, s19, v188
v_rndne_f32 v198, v198
v_fmac_f32 v188, 0xc4200000, v198
v_mul_f32 v188, s19, v188
v_cos_f32 v188, v188
s_nop 0
v_fma_f32 v189, v194, v188, -v187
v_fma_f32 v186, v194, v187, -v188
v_fma_f32 v190, v194, v189, -v188
v_fma_f32 v185, v194, v186, -v187
v_fma_f32 v191, v194, v190, -v189
v_fma_f32 v184, v194, v185, -v186
v_cvt_pk_bf16_f32 v20, v184, v185
v_cvt_pk_bf16_f32 v21, v186, v187
v_cvt_pk_bf16_f32 v22, v188, v189
v_cvt_pk_bf16_f32 v23, v190, v191
v_pk_fma_f32 v[176:177], v[192:193], v[184:185], v[176:177] op_sel_hi:[0,1,1] neg_lo:[0,0,1] neg_hi:[0,0,1]
v_pk_fma_f32 v[178:179], v[192:193], v[186:187], v[178:179] op_sel_hi:[0,1,1] neg_lo:[0,0,1] neg_hi:[0,0,1]
v_pk_fma_f32 v[180:181], v[192:193], v[188:189], v[180:181] op_sel_hi:[0,1,1] neg_lo:[0,0,1] neg_hi:[0,0,1]
v_pk_fma_f32 v[182:183], v[192:193], v[190:191], v[182:183] op_sel_hi:[0,1,1] neg_lo:[0,0,1] neg_hi:[0,0,1]
v_cvt_pk_bf16_f32 v24, v176, v177
v_cvt_pk_bf16_f32 v25, v178, v179
v_cvt_pk_bf16_f32 v26, v180, v181
v_cvt_pk_bf16_f32 v27, v182, v183
v_pk_fma_f32 v[184:185], v[192:193], v[176:177], v[184:185] op_sel_hi:[0,1,1] neg_lo:[0,0,1] neg_hi:[0,0,1]
v_pk_fma_f32 v[186:187], v[192:193], v[178:179], v[186:187] op_sel_hi:[0,1,1] neg_lo:[0,0,1] neg_hi:[0,0,1]
v_pk_fma_f32 v[188:189], v[192:193], v[180:181], v[188:189] op_sel_hi:[0,1,1] neg_lo:[0,0,1] neg_hi:[0,0,1]
v_pk_fma_f32 v[190:191], v[192:193], v[182:183], v[190:191] op_sel_hi:[0,1,1] neg_lo:[0,0,1] neg_hi:[0,0,1]
v_cvt_pk_bf16_f32 v28, v184, v185
v_cvt_pk_bf16_f32 v29, v186, v187
v_cvt_pk_bf16_f32 v30, v188, v189
v_cvt_pk_bf16_f32 v31, v190, v191
v_pk_fma_f32 v[176:177], v[192:193], v[184:185], v[176:177] op_sel_hi:[0,1,1] neg_lo:[0,0,1] neg_hi:[0,0,1]
v_pk_fma_f32 v[178:179], v[192:193], v[186:187], v[178:179] op_sel_hi:[0,1,1] neg_lo:[0,0,1] neg_hi:[0,0,1]
v_pk_fma_f32 v[180:181], v[192:193], v[188:189], v[180:181] op_sel_hi:[0,1,1] neg_lo:[0,0,1] neg_hi:[0,0,1]
v_pk_fma_f32 v[182:183], v[192:193], v[190:191], v[182:183] op_sel_hi:[0,1,1] neg_lo:[0,0,1] neg_hi:[0,0,1]
v_cvt_pk_bf16_f32 v32, v176, v177
v_cvt_pk_bf16_f32 v33, v178, v179
v_cvt_pk_bf16_f32 v34, v180, v181
v_cvt_pk_bf16_f32 v35, v182, v183
v_pk_fma_f32 v[184:185], v[192:193], v[176:177], v[184:185] op_sel_hi:[0,1,1] neg_lo:[0,0,1] neg_hi:[0,0,1]
v_pk_fma_f32 v[186:187], v[192:193], v[178:179], v[186:187] op_sel_hi:[0,1,1] neg_lo:[0,0,1] neg_hi:[0,0,1]
v_pk_fma_f32 v[188:189], v[192:193], v[180:181], v[188:189] op_sel_hi:[0,1,1] neg_lo:[0,0,1] neg_hi:[0,0,1]
v_pk_fma_f32 v[190:191], v[192:193], v[182:183], v[190:191] op_sel_hi:[0,1,1] neg_lo:[0,0,1] neg_hi:[0,0,1]
v_cvt_pk_bf16_f32 v36, v184, v185
v_cvt_pk_bf16_f32 v37, v186, v187
v_cvt_pk_bf16_f32 v38, v188, v189
v_cvt_pk_bf16_f32 v39, v190, v191
v_pk_fma_f32 v[176:177], v[192:193], v[184:185], v[176:177] op_sel_hi:[0,1,1] neg_lo:[0,0,1] neg_hi:[0,0,1]
v_pk_fma_f32 v[178:179], v[192:193], v[186:187], v[178:179] op_sel_hi:[0,1,1] neg_lo:[0,0,1] neg_hi:[0,0,1]
v_pk_fma_f32 v[180:181], v[192:193], v[188:189], v[180:181] op_sel_hi:[0,1,1] neg_lo:[0,0,1] neg_hi:[0,0,1]
v_pk_fma_f32 v[182:183], v[192:193], v[190:191], v[182:183] op_sel_hi:[0,1,1] neg_lo:[0,0,1] neg_hi:[0,0,1]
v_cvt_pk_bf16_f32 v40, v176, v177
v_cvt_pk_bf16_f32 v41, v178, v179
v_cvt_pk_bf16_f32 v42, v180, v181
v_cvt_pk_bf16_f32 v43, v182, v183
v_pk_fma_f32 v[184:185], v[192:193], v[176:177], v[184:185] op_sel_hi:[0,1,1] neg_lo:[0,0,1] neg_hi:[0,0,1]
v_pk_fma_f32 v[186:187], v[192:193], v[178:179], v[186:187] op_sel_hi:[0,1,1] neg_lo:[0,0,1] neg_hi:[0,0,1]
v_pk_fma_f32 v[188:189], v[192:193], v[180:181], v[188:189] op_sel_hi:[0,1,1] neg_lo:[0,0,1] neg_hi:[0,0,1]
v_pk_fma_f32 v[190:191], v[192:193], v[182:183], v[190:191] op_sel_hi:[0,1,1] neg_lo:[0,0,1] neg_hi:[0,0,1]
v_cvt_pk_bf16_f32 v44, v184, v185
v_cvt_pk_bf16_f32 v45, v186, v187
v_cvt_pk_bf16_f32 v46, v188, v189
v_cvt_pk_bf16_f32 v47, v190, v191
v_pk_fma_f32 v[176:177], v[192:193], v[184:185], v[176:177] op_sel_hi:[0,1,1] neg_lo:[0,0,1] neg_hi:[0,0,1]
v_pk_fma_f32 v[178:179], v[192:193], v[186:187], v[178:179] op_sel_hi:[0,1,1] neg_lo:[0,0,1] neg_hi:[0,0,1]
v_pk_fma_f32 v[180:181], v[192:193], v[188:189], v[180:181] op_sel_hi:[0,1,1] neg_lo:[0,0,1] neg_hi:[0,0,1]
v_pk_fma_f32 v[182:183], v[192:193], v[190:191], v[182:183] op_sel_hi:[0,1,1] neg_lo:[0,0,1] neg_hi:[0,0,1]
v_cvt_pk_bf16_f32 v48, v176, v177
v_cvt_pk_bf16_f32 v49, v178, v179
v_cvt_pk_bf16_f32 v50, v180, v181
v_cvt_pk_bf16_f32 v51, v182, v183
v_pk_fma_f32 v[184:185], v[192:193], v[176:177], v[184:185] op_sel_hi:[0,1,1] neg_lo:[0,0,1] neg_hi:[0,0,1]
v_pk_fma_f32 v[186:187], v[192:193], v[178:179], v[186:187] op_sel_hi:[0,1,1] neg_lo:[0,0,1] neg_hi:[0,0,1]
v_pk_fma_f32 v[188:189], v[192:193], v[180:181], v[188:189] op_sel_hi:[0,1,1] neg_lo:[0,0,1] neg_hi:[0,0,1]
v_pk_fma_f32 v[190:191], v[192:193], v[182:183], v[190:191] op_sel_hi:[0,1,1] neg_lo:[0,0,1] neg_hi:[0,0,1]
v_cvt_pk_bf16_f32 v52, v184, v185
v_cvt_pk_bf16_f32 v53, v186, v187
v_cvt_pk_bf16_f32 v54, v188, v189
v_cvt_pk_bf16_f32 v55, v190, v191
v_pk_fma_f32 v[176:177], v[192:193], v[184:185], v[176:177] op_sel_hi:[0,1,1] neg_lo:[0,0,1] neg_hi:[0,0,1]
v_pk_fma_f32 v[178:179], v[192:193], v[186:187], v[178:179] op_sel_hi:[0,1,1] neg_lo:[0,0,1] neg_hi:[0,0,1]
v_pk_fma_f32 v[180:181], v[192:193], v[188:189], v[180:181] op_sel_hi:[0,1,1] neg_lo:[0,0,1] neg_hi:[0,0,1]
v_pk_fma_f32 v[182:183], v[192:193], v[190:191], v[182:183] op_sel_hi:[0,1,1] neg_lo:[0,0,1] neg_hi:[0,0,1]
v_cvt_pk_bf16_f32 v56, v176, v177
v_cvt_pk_bf16_f32 v57, v178, v179
v_cvt_pk_bf16_f32 v58, v180, v181
v_cvt_pk_bf16_f32 v59, v182, v183
v_pk_fma_f32 v[184:185], v[192:193], v[176:177], v[184:185] op_sel_hi:[0,1,1] neg_lo:[0,0,1] neg_hi:[0,0,1]
v_pk_fma_f32 v[186:187], v[192:193], v[178:179], v[186:187] op_sel_hi:[0,1,1] neg_lo:[0,0,1] neg_hi:[0,0,1]
v_pk_fma_f32 v[188:189], v[192:193], v[180:181], v[188:189] op_sel_hi:[0,1,1] neg_lo:[0,0,1] neg_hi:[0,0,1]
v_pk_fma_f32 v[190:191], v[192:193], v[182:183], v[190:191] op_sel_hi:[0,1,1] neg_lo:[0,0,1] neg_hi:[0,0,1]
v_cvt_pk_bf16_f32 v60, v184, v185
v_cvt_pk_bf16_f32 v61, v186, v187
v_cvt_pk_bf16_f32 v62, v188, v189
v_cvt_pk_bf16_f32 v63, v190, v191
v_pk_fma_f32 v[176:177], v[192:193], v[184:185], v[176:177] op_sel_hi:[0,1,1] neg_lo:[0,0,1] neg_hi:[0,0,1]
v_pk_fma_f32 v[178:179], v[192:193], v[186:187], v[178:179] op_sel_hi:[0,1,1] neg_lo:[0,0,1] neg_hi:[0,0,1]
v_pk_fma_f32 v[180:181], v[192:193], v[188:189], v[180:181] op_sel_hi:[0,1,1] neg_lo:[0,0,1] neg_hi:[0,0,1]
v_pk_fma_f32 v[182:183], v[192:193], v[190:191], v[182:183] op_sel_hi:[0,1,1] neg_lo:[0,0,1] neg_hi:[0,0,1]
v_cvt_pk_bf16_f32 v64, v176, v177
v_cvt_pk_bf16_f32 v65, v178, v179
v_cvt_pk_bf16_f32 v66, v180, v181
v_cvt_pk_bf16_f32 v67, v182, v183
v_pk_fma_f32 v[184:185], v[192:193], v[176:177], v[184:185] op_sel_hi:[0,1,1] neg_lo:[0,0,1] neg_hi:[0,0,1]
v_pk_fma_f32 v[186:187], v[192:193], v[178:179], v[186:187] op_sel_hi:[0,1,1] neg_lo:[0,0,1] neg_hi:[0,0,1]
v_pk_fma_f32 v[188:189], v[192:193], v[180:181], v[188:189] op_sel_hi:[0,1,1] neg_lo:[0,0,1] neg_hi:[0,0,1]
v_pk_fma_f32 v[190:191], v[192:193], v[182:183], v[190:191] op_sel_hi:[0,1,1] neg_lo:[0,0,1] neg_hi:[0,0,1]
v_cvt_pk_bf16_f32 v68, v184, v185
v_cvt_pk_bf16_f32 v69, v186, v187
v_cvt_pk_bf16_f32 v70, v188, v189
v_cvt_pk_bf16_f32 v71, v190, v191
v_pk_fma_f32 v[176:177], v[192:193], v[184:185], v[176:177] op_sel_hi:[0,1,1] neg_lo:[0,0,1] neg_hi:[0,0,1]
v_pk_fma_f32 v[178:179], v[192:193], v[186:187], v[178:179] op_sel_hi:[0,1,1] neg_lo:[0,0,1] neg_hi:[0,0,1]
v_pk_fma_f32 v[180:181], v[192:193], v[188:189], v[180:181] op_sel_hi:[0,1,1] neg_lo:[0,0,1] neg_hi:[0,0,1]
v_pk_fma_f32 v[182:183], v[192:193], v[190:191], v[182:183] op_sel_hi:[0,1,1] neg_lo:[0,0,1] neg_hi:[0,0,1]
v_cvt_pk_bf16_f32 v72, v176, v177
v_cvt_pk_bf16_f32 v73, v178, v179
v_cvt_pk_bf16_f32 v74, v180, v181
v_cvt_pk_bf16_f32 v75, v182, v183
v_pk_fma_f32 v[184:185], v[192:193], v[176:177], v[184:185] op_sel_hi:[0,1,1] neg_lo:[0,0,1] neg_hi:[0,0,1]
v_pk_fma_f32 v[186:187], v[192:193], v[178:179], v[186:187] op_sel_hi:[0,1,1] neg_lo:[0,0,1] neg_hi:[0,0,1]
v_pk_fma_f32 v[188:189], v[192:193], v[180:181], v[188:189] op_sel_hi:[0,1,1] neg_lo:[0,0,1] neg_hi:[0,0,1]
v_pk_fma_f32 v[190:191], v[192:193], v[182:183], v[190:191] op_sel_hi:[0,1,1] neg_lo:[0,0,1] neg_hi:[0,0,1]
v_cvt_pk_bf16_f32 v76, v184, v185
v_cvt_pk_bf16_f32 v77, v186, v187
v_cvt_pk_bf16_f32 v78, v188, v189
v_cvt_pk_bf16_f32 v79, v190, v191
v_pk_fma_f32 v[176:177], v[192:193], v[184:185], v[176:177] op_sel_hi:[0,1,1] neg_lo:[0,0,1] neg_hi:[0,0,1]
v_pk_fma_f32 v[178:179], v[192:193], v[186:187], v[178:179] op_sel_hi:[0,1,1] neg_lo:[0,0,1] neg_hi:[0,0,1]
v_pk_fma_f32 v[180:181], v[192:193], v[188:189], v[180:181] op_sel_hi:[0,1,1] neg_lo:[0,0,1] neg_hi:[0,0,1]
v_pk_fma_f32 v[182:183], v[192:193], v[190:191], v[182:183] op_sel_hi:[0,1,1] neg_lo:[0,0,1] neg_hi:[0,0,1]
v_cvt_pk_bf16_f32 v80, v176, v177
v_cvt_pk_bf16_f32 v81, v178, v179
v_cvt_pk_bf16_f32 v82, v180, v181
v_cvt_pk_bf16_f32 v83, v182, v183
v_pk_fma_f32 v[184:185], v[192:193], v[176:177], v[184:185] op_sel_hi:[0,1,1] neg_lo:[0,0,1] neg_hi:[0,0,1]
v_pk_fma_f32 v[186:187], v[192:193], v[178:179], v[186:187] op_sel_hi:[0,1,1] neg_lo:[0,0,1] neg_hi:[0,0,1]
v_pk_fma_f32 v[188:189], v[192:193], v[180:181], v[188:189] op_sel_hi:[0,1,1] neg_lo:[0,0,1] neg_hi:[0,0,1]
v_pk_fma_f32 v[190:191], v[192:193], v[182:183], v[190:191] op_sel_hi:[0,1,1] neg_lo:[0,0,1] neg_hi:[0,0,1]
v_cvt_pk_bf16_f32 v84, v184, v185
v_cvt_pk_bf16_f32 v85, v186, v187
v_cvt_pk_bf16_f32 v86, v188, v189
v_cvt_pk_bf16_f32 v87, v190, v191
v_pk_fma_f32 v[176:177], v[192:193], v[184:185], v[176:177] op_sel_hi:[0,1,1] neg_lo:[0,0,1] neg_hi:[0,0,1]
v_pk_fma_f32 v[178:179], v[192:193], v[186:187], v[178:179] op_sel_hi:[0,1,1] neg_lo:[0,0,1] neg_hi:[0,0,1]
v_pk_fma_f32 v[180:181], v[192:193], v[188:189], v[180:181] op_sel_hi:[0,1,1] neg_lo:[0,0,1] neg_hi:[0,0,1]
v_pk_fma_f32 v[182:183], v[192:193], v[190:191], v[182:183] op_sel_hi:[0,1,1] neg_lo:[0,0,1] neg_hi:[0,0,1]
v_cvt_pk_bf16_f32 v88, v176, v177
v_cvt_pk_bf16_f32 v89, v178, v179
v_cvt_pk_bf16_f32 v90, v180, v181
v_cvt_pk_bf16_f32 v91, v182, v183
v_pk_fma_f32 v[184:185], v[192:193], v[176:177], v[184:185] op_sel_hi:[0,1,1] neg_lo:[0,0,1] neg_hi:[0,0,1]
v_pk_fma_f32 v[186:187], v[192:193], v[178:179], v[186:187] op_sel_hi:[0,1,1] neg_lo:[0,0,1] neg_hi:[0,0,1]
v_pk_fma_f32 v[188:189], v[192:193], v[180:181], v[188:189] op_sel_hi:[0,1,1] neg_lo:[0,0,1] neg_hi:[0,0,1]
v_pk_fma_f32 v[190:191], v[192:193], v[182:183], v[190:191] op_sel_hi:[0,1,1] neg_lo:[0,0,1] neg_hi:[0,0,1]
v_cvt_pk_bf16_f32 v92, v184, v185
v_cvt_pk_bf16_f32 v93, v186, v187
v_cvt_pk_bf16_f32 v94, v188, v189
v_cvt_pk_bf16_f32 v95, v190, v191
s_mov_b32 s20, 323
v_mad_u32_u24 v179, v196, s20, v197
v_cvt_f32_u32 v179, v179
v_mul_f32 v198, s19, v179
v_rndne_f32 v198, v198
v_fmac_f32 v179, 0xc4200000, v198
v_mul_f32 v179, s19, v179
v_cos_f32 v179, v179
s_mov_b32 s20, 324
v_mad_u32_u24 v180, v196, s20, v197
v_cvt_f32_u32 v180, v180
v_mul_f32 v198, s19, v180
v_rndne_f32 v198, v198
v_fmac_f32 v180, 0xc4200000, v198
v_mul_f32 v180, s19, v180
v_cos_f32 v180, v180
s_nop 0
v_fma_f32 v181, v194, v180, -v179
v_fma_f32 v178, v194, v179, -v180
v_fma_f32 v182, v194, v181, -v180
v_fma_f32 v177, v194, v178, -v179
v_fma_f32 v183, v194, v182, -v181
v_fma_f32 v176, v194, v177, -v178
v_cvt_pk_bf16_f32 v96, v176, v177
v_cvt_pk_bf16_f32 v97, v178, v179
v_cvt_pk_bf16_f32 v98, v180, v181
v_cvt_pk_bf16_f32 v99, v182, v183
s_mov_b32 s20, 339
v_mad_u32_u24 v187, v196, s20, v197
v_cvt_f32_u32 v187, v187
v_mul_f32 v198, s19, v187
v_rndne_f32 v198, v198
v_fmac_f32 v187, 0xc4200000, v198
v_mul_f32 v187, s19, v187
v_cos_f32 v187, v187
s_mov_b32 s20, 340
v_mad_u32_u24 v188, v196, s20, v197
v_cvt_f32_u32 v188, v188
v_mul_f32 v198, s19, v188
v_rndne_f32 v198, v198
v_fmac_f32 v188, 0xc4200000, v198
v_mul_f32 v188, s19, v188
v_cos_f32 v188, v188
s_nop 0
v_fma_f32 v189, v194, v188, -v187
v_fma_f32 v186, v194, v187, -v188
v_fma_f32 v190, v194, v189, -v188
v_fma_f32 v185, v194, v186, -v187
v_fma_f32 v191, v194, v190, -v189
v_fma_f32 v184, v194, v185, -v186
v_cvt_pk_bf16_f32 v100, v184, v185
v_cvt_pk_bf16_f32 v101, v186, v187
v_cvt_pk_bf16_f32 v102, v188, v189
v_cvt_pk_bf16_f32 v103, v190, v191
v_pk_fma_f32 v[176:177], v[192:193], v[184:185], v[176:177] op_sel_hi:[0,1,1] neg_lo:[0,0,1] neg_hi:[0,0,1]
v_pk_fma_f32 v[178:179], v[192:193], v[186:187], v[178:179] op_sel_hi:[0,1,1] neg_lo:[0,0,1] neg_hi:[0,0,1]
v_pk_fma_f32 v[180:181], v[192:193], v[188:189], v[180:181] op_sel_hi:[0,1,1] neg_lo:[0,0,1] neg_hi:[0,0,1]
v_pk_fma_f32 v[182:183], v[192:193], v[190:191], v[182:183] op_sel_hi:[0,1,1] neg_lo:[0,0,1] neg_hi:[0,0,1]
v_cvt_pk_bf16_f32 v104, v176, v177
v_cvt_pk_bf16_f32 v105, v178, v179
v_cvt_pk_bf16_f32 v106, v180, v181
v_cvt_pk_bf16_f32 v107, v182, v183
v_pk_fma_f32 v[184:185], v[192:193], v[176:177], v[184:185] op_sel_hi:[0,1,1] neg_lo:[0,0,1] neg_hi:[0,0,1]
v_pk_fma_f32 v[186:187], v[192:193], v[178:179], v[186:187] op_sel_hi:[0,1,1] neg_lo:[0,0,1] neg_hi:[0,0,1]
v_pk_fma_f32 v[188:189], v[192:193], v[180:181], v[188:189] op_sel_hi:[0,1,1] neg_lo:[0,0,1] neg_hi:[0,0,1]
v_pk_fma_f32 v[190:191], v[192:193], v[182:183], v[190:191] op_sel_hi:[0,1,1] neg_lo:[0,0,1] neg_hi:[0,0,1]
v_cvt_pk_bf16_f32 v108, v184, v185
v_cvt_pk_bf16_f32 v109, v186, v187
v_cvt_pk_bf16_f32 v110, v188, v189
v_cvt_pk_bf16_f32 v111, v190, v191
v_pk_fma_f32 v[176:177], v[192:193], v[184:185], v[176:177] op_sel_hi:[0,1,1] neg_lo:[0,0,1] neg_hi:[0,0,1]
v_pk_fma_f32 v[178:179], v[192:193], v[186:187], v[178:179] op_sel_hi:[0,1,1] neg_lo:[0,0,1] neg_hi:[0,0,1]
v_pk_fma_f32 v[180:181], v[192:193], v[188:189], v[180:181] op_sel_hi:[0,1,1] neg_lo:[0,0,1] neg_hi:[0,0,1]
v_pk_fma_f32 v[182:183], v[192:193], v[190:191], v[182:183] op_sel_hi:[0,1,1] neg_lo:[0,0,1] neg_hi:[0,0,1]
v_cvt_pk_bf16_f32 v112, v176, v177
v_cvt_pk_bf16_f32 v113, v178, v179
v_cvt_pk_bf16_f32 v114, v180, v181
v_cvt_pk_bf16_f32 v115, v182, v183
v_pk_fma_f32 v[184:185], v[192:193], v[176:177], v[184:185] op_sel_hi:[0,1,1] neg_lo:[0,0,1] neg_hi:[0,0,1]
v_pk_fma_f32 v[186:187], v[192:193], v[178:179], v[186:187] op_sel_hi:[0,1,1] neg_lo:[0,0,1] neg_hi:[0,0,1]
v_pk_fma_f32 v[188:189], v[192:193], v[180:181], v[188:189] op_sel_hi:[0,1,1] neg_lo:[0,0,1] neg_hi:[0,0,1]
v_pk_fma_f32 v[190:191], v[192:193], v[182:183], v[190:191] op_sel_hi:[0,1,1] neg_lo:[0,0,1] neg_hi:[0,0,1]
v_cvt_pk_bf16_f32 v116, v184, v185
v_cvt_pk_bf16_f32 v117, v186, v187
v_cvt_pk_bf16_f32 v118, v188, v189
v_cvt_pk_bf16_f32 v119, v190, v191
v_pk_fma_f32 v[176:177], v[192:193], v[184:185], v[176:177] op_sel_hi:[0,1,1] neg_lo:[0,0,1] neg_hi:[0,0,1]
v_pk_fma_f32 v[178:179], v[192:193], v[186:187], v[178:179] op_sel_hi:[0,1,1] neg_lo:[0,0,1] neg_hi:[0,0,1]
v_pk_fma_f32 v[180:181], v[192:193], v[188:189], v[180:181] op_sel_hi:[0,1,1] neg_lo:[0,0,1] neg_hi:[0,0,1]
v_pk_fma_f32 v[182:183], v[192:193], v[190:191], v[182:183] op_sel_hi:[0,1,1] neg_lo:[0,0,1] neg_hi:[0,0,1]
v_cvt_pk_bf16_f32 v120, v176, v177
v_cvt_pk_bf16_f32 v121, v178, v179
v_cvt_pk_bf16_f32 v122, v180, v181
v_cvt_pk_bf16_f32 v123, v182, v183
v_pk_fma_f32 v[184:185], v[192:193], v[176:177], v[184:185] op_sel_hi:[0,1,1] neg_lo:[0,0,1] neg_hi:[0,0,1]
v_pk_fma_f32 v[186:187], v[192:193], v[178:179], v[186:187] op_sel_hi:[0,1,1] neg_lo:[0,0,1] neg_hi:[0,0,1]
v_pk_fma_f32 v[188:189], v[192:193], v[180:181], v[188:189] op_sel_hi:[0,1,1] neg_lo:[0,0,1] neg_hi:[0,0,1]
v_pk_fma_f32 v[190:191], v[192:193], v[182:183], v[190:191] op_sel_hi:[0,1,1] neg_lo:[0,0,1] neg_hi:[0,0,1]
v_cvt_pk_bf16_f32 v124, v184, v185
v_cvt_pk_bf16_f32 v125, v186, v187
v_cvt_pk_bf16_f32 v126, v188, v189
v_cvt_pk_bf16_f32 v127, v190, v191
v_pk_fma_f32 v[176:177], v[192:193], v[184:185], v[176:177] op_sel_hi:[0,1,1] neg_lo:[0,0,1] neg_hi:[0,0,1]
v_pk_fma_f32 v[178:179], v[192:193], v[186:187], v[178:179] op_sel_hi:[0,1,1] neg_lo:[0,0,1] neg_hi:[0,0,1]
v_pk_fma_f32 v[180:181], v[192:193], v[188:189], v[180:181] op_sel_hi:[0,1,1] neg_lo:[0,0,1] neg_hi:[0,0,1]
v_pk_fma_f32 v[182:183], v[192:193], v[190:191], v[182:183] op_sel_hi:[0,1,1] neg_lo:[0,0,1] neg_hi:[0,0,1]
v_cvt_pk_bf16_f32 v128, v176, v177
v_cvt_pk_bf16_f32 v129, v178, v179
v_cvt_pk_bf16_f32 v130, v180, v181
v_cvt_pk_bf16_f32 v131, v182, v183
v_pk_fma_f32 v[184:185], v[192:193], v[176:177], v[184:185] op_sel_hi:[0,1,1] neg_lo:[0,0,1] neg_hi:[0,0,1]
v_pk_fma_f32 v[186:187], v[192:193], v[178:179], v[186:187] op_sel_hi:[0,1,1] neg_lo:[0,0,1] neg_hi:[0,0,1]
v_pk_fma_f32 v[188:189], v[192:193], v[180:181], v[188:189] op_sel_hi:[0,1,1] neg_lo:[0,0,1] neg_hi:[0,0,1]
v_pk_fma_f32 v[190:191], v[192:193], v[182:183], v[190:191] op_sel_hi:[0,1,1] neg_lo:[0,0,1] neg_hi:[0,0,1]
v_cvt_pk_bf16_f32 v132, v184, v185
v_cvt_pk_bf16_f32 v133, v186, v187
v_cvt_pk_bf16_f32 v134, v188, v189
v_cvt_pk_bf16_f32 v135, v190, v191
v_pk_fma_f32 v[176:177], v[192:193], v[184:185], v[176:177] op_sel_hi:[0,1,1] neg_lo:[0,0,1] neg_hi:[0,0,1]
v_pk_fma_f32 v[178:179], v[192:193], v[186:187], v[178:179] op_sel_hi:[0,1,1] neg_lo:[0,0,1] neg_hi:[0,0,1]
v_pk_fma_f32 v[180:181], v[192:193], v[188:189], v[180:181] op_sel_hi:[0,1,1] neg_lo:[0,0,1] neg_hi:[0,0,1]
v_pk_fma_f32 v[182:183], v[192:193], v[190:191], v[182:183] op_sel_hi:[0,1,1] neg_lo:[0,0,1] neg_hi:[0,0,1]
v_cvt_pk_bf16_f32 v136, v176, v177
v_cvt_pk_bf16_f32 v137, v178, v179
v_cvt_pk_bf16_f32 v138, v180, v181
v_cvt_pk_bf16_f32 v139, v182, v183
v_pk_fma_f32 v[184:185], v[192:193], v[176:177], v[184:185] op_sel_hi:[0,1,1] neg_lo:[0,0,1] neg_hi:[0,0,1]
v_pk_fma_f32 v[186:187], v[192:193], v[178:179], v[186:187] op_sel_hi:[0,1,1] neg_lo:[0,0,1] neg_hi:[0,0,1]
v_pk_fma_f32 v[188:189], v[192:193], v[180:181], v[188:189] op_sel_hi:[0,1,1] neg_lo:[0,0,1] neg_hi:[0,0,1]
v_pk_fma_f32 v[190:191], v[192:193], v[182:183], v[190:191] op_sel_hi:[0,1,1] neg_lo:[0,0,1] neg_hi:[0,0,1]
v_cvt_pk_bf16_f32 v140, v184, v185
v_cvt_pk_bf16_f32 v141, v186, v187
v_cvt_pk_bf16_f32 v142, v188, v189
v_cvt_pk_bf16_f32 v143, v190, v191
v_pk_fma_f32 v[176:177], v[192:193], v[184:185], v[176:177] op_sel_hi:[0,1,1] neg_lo:[0,0,1] neg_hi:[0,0,1]
v_pk_fma_f32 v[178:179], v[192:193], v[186:187], v[178:179] op_sel_hi:[0,1,1] neg_lo:[0,0,1] neg_hi:[0,0,1]
v_pk_fma_f32 v[180:181], v[192:193], v[188:189], v[180:181] op_sel_hi:[0,1,1] neg_lo:[0,0,1] neg_hi:[0,0,1]
v_pk_fma_f32 v[182:183], v[192:193], v[190:191], v[182:183] op_sel_hi:[0,1,1] neg_lo:[0,0,1] neg_hi:[0,0,1]
v_cvt_pk_bf16_f32 v144, v176, v177
v_cvt_pk_bf16_f32 v145, v178, v179
v_cvt_pk_bf16_f32 v146, v180, v181
v_cvt_pk_bf16_f32 v147, v182, v183
v_pk_fma_f32 v[184:185], v[192:193], v[176:177], v[184:185] op_sel_hi:[0,1,1] neg_lo:[0,0,1] neg_hi:[0,0,1]
v_pk_fma_f32 v[186:187], v[192:193], v[178:179], v[186:187] op_sel_hi:[0,1,1] neg_lo:[0,0,1] neg_hi:[0,0,1]
v_pk_fma_f32 v[188:189], v[192:193], v[180:181], v[188:189] op_sel_hi:[0,1,1] neg_lo:[0,0,1] neg_hi:[0,0,1]
v_pk_fma_f32 v[190:191], v[192:193], v[182:183], v[190:191] op_sel_hi:[0,1,1] neg_lo:[0,0,1] neg_hi:[0,0,1]
v_cvt_pk_bf16_f32 v148, v184, v185
v_cvt_pk_bf16_f32 v149, v186, v187
v_cvt_pk_bf16_f32 v150, v188, v189
v_cvt_pk_bf16_f32 v151, v190, v191
v_pk_fma_f32 v[176:177], v[192:193], v[184:185], v[176:177] op_sel_hi:[0,1,1] neg_lo:[0,0,1] neg_hi:[0,0,1]
v_pk_fma_f32 v[178:179], v[192:193], v[186:187], v[178:179] op_sel_hi:[0,1,1] neg_lo:[0,0,1] neg_hi:[0,0,1]
v_pk_fma_f32 v[180:181], v[192:193], v[188:189], v[180:181] op_sel_hi:[0,1,1] neg_lo:[0,0,1] neg_hi:[0,0,1]
v_pk_fma_f32 v[182:183], v[192:193], v[190:191], v[182:183] op_sel_hi:[0,1,1] neg_lo:[0,0,1] neg_hi:[0,0,1]
v_cvt_pk_bf16_f32 v152, v176, v177
v_cvt_pk_bf16_f32 v153, v178, v179
v_cvt_pk_bf16_f32 v154, v180, v181
v_cvt_pk_bf16_f32 v155, v182, v183
v_pk_fma_f32 v[184:185], v[192:193], v[176:177], v[184:185] op_sel_hi:[0,1,1] neg_lo:[0,0,1] neg_hi:[0,0,1]
v_pk_fma_f32 v[186:187], v[192:193], v[178:179], v[186:187] op_sel_hi:[0,1,1] neg_lo:[0,0,1] neg_hi:[0,0,1]
v_pk_fma_f32 v[188:189], v[192:193], v[180:181], v[188:189] op_sel_hi:[0,1,1] neg_lo:[0,0,1] neg_hi:[0,0,1]
v_pk_fma_f32 v[190:191], v[192:193], v[182:183], v[190:191] op_sel_hi:[0,1,1] neg_lo:[0,0,1] neg_hi:[0,0,1]
v_cvt_pk_bf16_f32 v156, v184, v185
v_cvt_pk_bf16_f32 v157, v186, v187
v_cvt_pk_bf16_f32 v158, v188, v189
v_cvt_pk_bf16_f32 v159, v190, v191
v_pk_fma_f32 v[176:177], v[192:193], v[184:185], v[176:177] op_sel_hi:[0,1,1] neg_lo:[0,0,1] neg_hi:[0,0,1]
v_pk_fma_f32 v[178:179], v[192:193], v[186:187], v[178:179] op_sel_hi:[0,1,1] neg_lo:[0,0,1] neg_hi:[0,0,1]
v_pk_fma_f32 v[180:181], v[192:193], v[188:189], v[180:181] op_sel_hi:[0,1,1] neg_lo:[0,0,1] neg_hi:[0,0,1]
v_pk_fma_f32 v[182:183], v[192:193], v[190:191], v[182:183] op_sel_hi:[0,1,1] neg_lo:[0,0,1] neg_hi:[0,0,1]
v_cvt_pk_bf16_f32 v160, v176, v177
v_cvt_pk_bf16_f32 v161, v178, v179
v_cvt_pk_bf16_f32 v162, v180, v181
v_cvt_pk_bf16_f32 v163, v182, v183
v_pk_fma_f32 v[184:185], v[192:193], v[176:177], v[184:185] op_sel_hi:[0,1,1] neg_lo:[0,0,1] neg_hi:[0,0,1]
v_pk_fma_f32 v[186:187], v[192:193], v[178:179], v[186:187] op_sel_hi:[0,1,1] neg_lo:[0,0,1] neg_hi:[0,0,1]
v_pk_fma_f32 v[188:189], v[192:193], v[180:181], v[188:189] op_sel_hi:[0,1,1] neg_lo:[0,0,1] neg_hi:[0,0,1]
v_pk_fma_f32 v[190:191], v[192:193], v[182:183], v[190:191] op_sel_hi:[0,1,1] neg_lo:[0,0,1] neg_hi:[0,0,1]
v_cvt_pk_bf16_f32 v164, v184, v185
v_cvt_pk_bf16_f32 v165, v186, v187
v_cvt_pk_bf16_f32 v166, v188, v189
v_cvt_pk_bf16_f32 v167, v190, v191
v_pk_fma_f32 v[176:177], v[192:193], v[184:185], v[176:177] op_sel_hi:[0,1,1] neg_lo:[0,0,1] neg_hi:[0,0,1]
v_pk_fma_f32 v[178:179], v[192:193], v[186:187], v[178:179] op_sel_hi:[0,1,1] neg_lo:[0,0,1] neg_hi:[0,0,1]
v_pk_fma_f32 v[180:181], v[192:193], v[188:189], v[180:181] op_sel_hi:[0,1,1] neg_lo:[0,0,1] neg_hi:[0,0,1]
v_pk_fma_f32 v[182:183], v[192:193], v[190:191], v[182:183] op_sel_hi:[0,1,1] neg_lo:[0,0,1] neg_hi:[0,0,1]
v_cvt_pk_bf16_f32 v168, v176, v177
v_cvt_pk_bf16_f32 v169, v178, v179
v_cvt_pk_bf16_f32 v170, v180, v181
v_cvt_pk_bf16_f32 v171, v182, v183
v_pk_fma_f32 v[184:185], v[192:193], v[176:177], v[184:185] op_sel_hi:[0,1,1] neg_lo:[0,0,1] neg_hi:[0,0,1]
v_pk_fma_f32 v[186:187], v[192:193], v[178:179], v[186:187] op_sel_hi:[0,1,1] neg_lo:[0,0,1] neg_hi:[0,0,1]
v_pk_fma_f32 v[188:189], v[192:193], v[180:181], v[188:189] op_sel_hi:[0,1,1] neg_lo:[0,0,1] neg_hi:[0,0,1]
v_pk_fma_f32 v[190:191], v[192:193], v[182:183], v[190:191] op_sel_hi:[0,1,1] neg_lo:[0,0,1] neg_hi:[0,0,1]
v_cvt_pk_bf16_f32 v172, v184, v185
v_cvt_pk_bf16_f32 v173, v186, v187
v_cvt_pk_bf16_f32 v174, v188, v189
v_cvt_pk_bf16_f32 v175, v190, v191
p1q_81:
s_mul_i32 s18, s30, 21846
s_lshr_b32 s18, s18, 16
s_mul_i32 s18, s18, 3
s_sub_u32 s18, s30, s18
s_and_b32 s19, s30, 3
s_cmp_lt_u32 s30, 56
s_cselect_b32 s18, s18, s19
s_mul_i32 s18, s18, 2560
s_add_u32 s18, s18, 11665408
s_add_u32 s29, s30, 1
s_cmp_lg_u32 s13, 0
s_cbranch_scc1 polld_83
v_lshlrev_b32 v3, 3, v0
v_min_u32 v12, 2432, v3
s_mov_b32 s17, 0
poll_82:
buffer_load_dword v8, v12, s[4:7], s18 offen sc1
s_add_u32 s17, s17, 1
s_cmp_gt_u32 s17, 262144
s_cbranch_scc1 L_fail
s_waitcnt vmcnt(0)
v_cmp_gt_u32 vcc, s29, v8
s_cbranch_vccz polld_83
s_sleep 2
s_branch poll_82
polld_83:
s_barrier
s_mul_i32 s18, s30, 40960
s_add_u32 s26, s18, 91226112
s_add_u32 s26, s26, s31
s_add_u32 s27, s18, 100663296
s_add_u32 s27, s27, s33
s_add_u32 m0, s31, 2048
s_add_u32 s20, s26, 0
buffer_load_dwordx4 v0, s[4:7], s20 offen sc1 lds
s_add_u32 m0, s31, 3072
s_add_u32 s20, s26, 1024
buffer_load_dwordx4 v0, s[4:7], s20 offen sc1 lds
s_add_u32 m0, s31, 4096
s_add_u32 s20, s26, 2048
buffer_load_dwordx4 v0, s[4:7], s20 offen sc1 lds
s_add_u32 m0, s31, 5120
s_add_u32 s20, s26, 3072
buffer_load_dwordx4 v0, s[4:7], s20 offen sc1 lds
s_add_u32 m0, s31, 6144
s_add_u32 s20, s26, 4096
buffer_load_dwordx4 v0, s[4:7], s20 offen sc1 lds
s_add_u32 m0, s31, 7168
s_add_u32 s20, s26, 5120
buffer_load_dwordx4 v0, s[4:7], s20 offen sc1 lds
s_add_u32 m0, s31, 8192
s_add_u32 s20, s26, 6144
buffer_load_dwordx4 v0, s[4:7], s20 offen sc1 lds
s_add_u32 m0, s31, 9216
s_add_u32 s20, s26, 7168
buffer_load_dwordx4 v0, s[4:7], s20 offen sc1 lds
s_add_u32 m0, s31, 10240
s_add_u32 s20, s26, 8192
buffer_load_dwordx4 v0, s[4:7], s20 offen sc1 lds
s_add_u32 m0, s31, 11264
s_add_u32 s20, s26, 9216
buffer_load_dwordx4 v0, s[4:7], s20 offen sc1 lds
s_waitcnt vmcnt(0)
s_barrier
v_add_u32 v2, s31, v0
ds_read_b128 v[216:219], v2 offset:2048
ds_read_b128 v[220:223], v2 offset:3072
ds_read_b128 v[224:227], v2 offset:4096
ds_read_b128 v[196:199], v0 offset:3072
ds_read_b128 v[228:231], v2 offset:5120
ds_read_b128 v[192:195], v0 offset:2048
v_mov_b64 v[208:209], 0
ds_read_b128 v[200:203], v0 offset:4096
ds_read_b128 v[204:207], v0 offset:5120
s_waitcnt lgkmcnt(7)
v_dot2c_f32_bf16 v208, s24, v216
v_dot2c_f32_bf16 v209, v216, v216
v_dot2c_f32_bf16 v208, s24, v217
v_dot2c_f32_bf16 v209, v217, v217
v_dot2c_f32_bf16 v208, s24, v218
v_dot2c_f32_bf16 v209, v218, v218
v_dot2c_f32_bf16 v208, s24, v219
s_waitcnt lgkmcnt(5)
v_dot2c_f32_bf16 v209, v219, v219
v_dot2c_f32_bf16 v208, s24, v220
v_dot2c_f32_bf16 v209, v220, v220
v_dot2c_f32_bf16 v208, s24, v221
v_dot2c_f32_bf16 v209, v221, v221
v_dot2c_f32_bf16 v208, s24, v222
v_dot2c_f32_bf16 v209, v222, v222
v_dot2c_f32_bf16 v208, s24, v223
v_dot2c_f32_bf16 v209, v223, v223
v_dot2c_f32_bf16 v208, s24, v224
v_dot2c_f32_bf16 v209, v224, v224
s_waitcnt lgkmcnt(3)
ds_read_b128 v[216:219], v2 offset:6144
ds_read_b128 v[220:223], v2 offset:7168
v_dot2c_f32_bf16 v208, s24, v225
v_dot2c_f32_bf16 v209, v225, v225
v_dot2c_f32_bf16 v208, s24, v226
v_dot2c_f32_bf16 v209, v226, v226
v_dot2c_f32_bf16 v208, s24, v227
v_dot2c_f32_bf16 v209, v227, v227
v_dot2c_f32_bf16 v208, s24, v228
v_dot2c_f32_bf16 v209, v228, v228
v_dot2c_f32_bf16 v208, s24, v229
v_dot2c_f32_bf16 v209, v229, v229
v_dot2c_f32_bf16 v208, s24, v230
v_dot2c_f32_bf16 v209, v230, v230
v_dot2c_f32_bf16 v208, s24, v231
v_dot2c_f32_bf16 v209, v231, v231
s_waitcnt lgkmcnt(1)
ds_read_b128 v[228:231], v2 offset:9216
ds_read_b128 v[224:227], v2 offset:8192
v_dot2c_f32_bf16 v208, s24, v216
v_dot2c_f32_bf16 v209, v216, v216
v_dot2c_f32_bf16 v208, s24, v217
s_waitcnt lgkmcnt(2)
v_dot2c_f32_bf16 v209, v217, v217
v_dot2c_f32_bf16 v208, s24, v218
v_dot2c_f32_bf16 v209, v218, v218
v_dot2c_f32_bf16 v208, s24, v219
v_dot2c_f32_bf16 v209, v219, v219
v_dot2c_f32_bf16 v208, s24, v220
v_dot2c_f32_bf16 v209, v220, v220
v_dot2c_f32_bf16 v208, s24, v221
v_dot2c_f32_bf16 v209, v221, v221
v_dot2c_f32_bf16 v208, s24, v222
v_dot2c_f32_bf16 v209, v222, v222
v_dot2c_f32_bf16 v208, s24, v223
v_dot2c_f32_bf16 v209, v223, v223
s_waitcnt lgkmcnt(0)
ds_read_b128 v[216:219], v2 offset:10240
ds_read_b128 v[220:223], v2 offset:11264
v_dot2c_f32_bf16 v208, s24, v224
v_dot2c_f32_bf16 v209, v224, v224
v_dot2c_f32_bf16 v208, s24, v225
v_dot2c_f32_bf16 v209, v225, v225
v_dot2c_f32_bf16 v208, s24, v226
v_dot2c_f32_bf16 v209, v226, v226
v_dot2c_f32_bf16 v208, s24, v227
v_dot2c_f32_bf16 v209, v227, v227
v_dot2c_f32_bf16 v208, s24, v228
v_dot2c_f32_bf16 v209, v228, v228
v_dot2c_f32_bf16 v208, s24, v229
v_dot2c_f32_bf16 v209, v229, v229
v_dot2c_f32_bf16 v208, s24, v230
v_dot2c_f32_bf16 v209, v230, v230
s_waitcnt lgkmcnt(1)
v_dot2c_f32_bf16 v208, s24, v231
v_dot2c_f32_bf16 v209, v231, v231
v_dot2c_f32_bf16 v208, s24, v216
s_waitcnt lgkmcnt(0)
v_dot2c_f32_bf16 v209, v216, v216
v_dot2c_f32_bf16 v208, s24, v217
v_dot2c_f32_bf16 v209, v217, v217
v_dot2c_f32_bf16 v208, s24, v218
v_dot2c_f32_bf16 v209, v218, v218
v_dot2c_f32_bf16 v208, s24, v219
v_dot2c_f32_bf16 v209, v219, v219
v_dot2c_f32_bf16 v208, s24, v220
v_dot2c_f32_bf16 v209, v220, v220
v_dot2c_f32_bf16 v208, s24, v221
v_dot2c_f32_bf16 v209, v221, v221
v_dot2c_f32_bf16 v208, s24, v222
v_dot2c_f32_bf16 v209, v222, v222
v_dot2c_f32_bf16 v208, s24, v223
v_dot2c_f32_bf16 v209, v223, v223
v_mfma_f32_32x32x16_bf16 v[176:191], v[192:195], v[16:19], 0
s_nop 1
v_permlane32_swap_b32 v208, v209
ds_read_b128 v[192:195], v0 offset:6144
v_mfma_f32_32x32x16_bf16 v[176:191], v[196:199], v[20:23], v[176:191]
v_and_b32 v2, 0x1ff, v0
v_add_f32 v208, v208, v209
v_mfma_f32_32x32x16_bf16 v[176:191], v[200:203], v[24:27], v[176:191]
v_lshl_add_u32 v209, s13, 2, v0
ds_read_b128 v[196:199], v0 offset:7168
ds_write_b32 v209, v208 offset:0
v_mfma_f32_32x32x16_bf16 v[176:191], v[204:207], v[28:31], v[176:191]
s_waitcnt lgkmcnt(2)
ds_read_b128 v[200:203], v0 offset:8192
ds_read_b128 v[204:207], v0 offset:9216
v_mfma_f32_32x32x16_bf16 v[176:191], v[192:195], v[32:35], v[176:191]
s_waitcnt lgkmcnt(3)
v_mfma_f32_32x32x16_bf16 v[176:191], v[196:199], v[36:39], v[176:191]
s_waitcnt lgkmcnt(2)
ds_read_b128 v[192:195], v0 offset:10240
s_waitcnt lgkmcnt(2)
s_waitcnt lgkmcnt(1)
v_mfma_f32_32x32x16_bf16 v[176:191], v[200:203], v[40:43], v[176:191]
ds_read_b128 v[196:199], v0 offset:11264
s_barrier
ds_read_b128 v[208:211], v2 offset:0
v_mfma_f32_32x32x16_bf16 v[176:191], v[204:207], v[44:47], v[176:191]
ds_read_b128 v[204:207], v0 offset:13312
ds_read_b128 v[200:203], v0 offset:12288
s_waitcnt lgkmcnt(4)
v_mfma_f32_32x32x16_bf16 v[176:191], v[192:195], v[48:51], v[176:191]
s_waitcnt lgkmcnt(3)
ds_read_b128 v[212:215], v2 offset:512
ds_read_b128 v[192:195], v0 offset:14336
v_mfma_f32_32x32x16_bf16 v[176:191], v[196:199], v[52:55], v[176:191]
s_waitcnt lgkmcnt(2)
v_mfma_f32_32x32x16_bf16 v[176:191], v[200:203], v[56:59], v[176:191]
ds_read_b128 v[196:199], v0 offset:15360
ds_read_b128 v[200:203], v0 offset:16384
v_add_f32 v208, v208, v209
v_add_f32 v210, v210, v211
s_waitcnt lgkmcnt(3)
v_mfma_f32_32x32x16_bf16 v[176:191], v[204:207], v[60:63], v[176:191]
s_waitcnt lgkmcnt(2)
ds_read_b128 v[204:207], v0 offset:17408
v_add_f32 v212, v212, v213
v_add_f32 v208, v208, v210
v_mfma_f32_32x32x16_bf16 v[176:191], v[192:195], v[64:67], v[176:191]
s_waitcnt lgkmcnt(2)
v_mfma_f32_32x32x16_bf16 v[176:191], v[196:199], v[68:71], v[176:191]
v_mul_f32 v208, 0x3acccccd, v208
s_waitcnt lgkmcnt(1)
ds_read_b128 v[192:195], v0 offset:18432
v_add_f32 v214, v214, v215
s_waitcnt lgkmcnt(1)
v_mfma_f32_32x32x16_bf16 v[176:191], v[200:203], v[72:75], v[176:191]
v_lshrrev_b32 v209, 2, v0
ds_read_b128 v[196:199], v0 offset:19456
v_mfma_f32_32x32x16_bf16 v[176:191], v[204:207], v[76:79], v[176:191]
ds_read_b128 v[200:203], v0 offset:20480
ds_read_b128 v[204:207], v0 offset:21504
v_add_f32 v212, v212, v214
v_mul_f32 v212, 0x3acccccd, v212
s_waitcnt lgkmcnt(3)
v_mfma_f32_32x32x16_bf16 v[176:191], v[192:195], v[80:83], v[176:191]
v_fma_f32 v212, -v208, v208, v212
s_waitcnt lgkmcnt(2)
v_max_f32 v212, 0, v212
v_add_f32 v212, 0x3727c5ac, v212
v_mfma_f32_32x32x16_bf16 v[176:191], v[196:199], v[84:87], v[176:191]
ds_read_b128 v[192:195], v0 offset:22528
s_waitcnt lgkmcnt(2)
v_bfe_u32 v210, v0, 5, 5
v_lshl_add_u32 v209, s13, 8, v209
v_mfma_f32_32x32x16_bf16 v[176:191], v[200:203], v[88:91], v[176:191]
ds_read_b128 v[196:199], v0 offset:23552
ds_read_b128 v[200:203], v0 offset:24576
v_rsq_f32 v212, v212
s_waitcnt lgkmcnt(3)
v_and_b32 v210, 16, v210
v_mfma_f32_32x32x16_bf16 v[176:191], v[204:207], v[92:95], v[176:191]
ds_read_b128 v[204:207], v0 offset:25600
s_waitcnt lgkmcnt(3)
v_mul_f32 v208, v212, v208
v_mfma_f32_32x32x16_bf16 v[176:191], v[192:195], v[96:99], v[176:191]
v_lshl_add_u32 v210, s13, 8, v210
v_permlane32_swap_b32 v212, v208
s_waitcnt lgkmcnt(2)
ds_read_b128 v[192:195], v0 offset:26624
v_mfma_f32_32x32x16_bf16 v[176:191], v[196:199], v[100:103], v[176:191]
ds_write_b32 v209, v212 offset:1024
s_waitcnt lgkmcnt(3)
s_waitcnt lgkmcnt(2)
v_mfma_f32_32x32x16_bf16 v[176:191], v[200:203], v[104:107], v[176:191]
ds_read_b128 v[240:243], v210 offset:1216
ds_read_b128 v[196:199], v0 offset:27648
v_mfma_f32_32x32x16_bf16 v[176:191], v[204:207], v[108:111], v[176:191]
ds_read_b128 v[200:203], v0 offset:28672
s_waitcnt lgkmcnt(4)
ds_read_b128 v[232:235], v210 offset:1152
v_mfma_f32_32x32x16_bf16 v[176:191], v[192:195], v[112:115], v[176:191]
ds_read_b128 v[204:207], v0 offset:29696
ds_read_b128 v[192:195], v0 offset:30720
s_waitcnt lgkmcnt(4)
v_mfma_f32_32x32x16_bf16 v[176:191], v[196:199], v[116:119], v[176:191]
ds_read_b128 v[228:231], v210 offset:1120
s_waitcnt lgkmcnt(4)
ds_read_b128 v[216:219], v210 offset:1024
ds_read_b128 v[196:199], v0 offset:31744
v_mfma_f32_32x32x16_bf16 v[176:191], v[200:203], v[120:123], v[176:191]
v_mul_f32 v241, v241, v7
s_waitcnt lgkmcnt(3)
ds_read_b128 v[200:203], v0 offset:32768
v_mfma_f32_32x32x16_bf16 v[176:191], v[204:207], v[124:127], v[176:191]
ds_read_b128 v[220:223], v210 offset:1056
v_mfma_f32_32x32x16_bf16 v[176:191], v[192:195], v[128:131], v[176:191]
ds_read_b128 v[204:207], v0 offset:33792
s_waitcnt lgkmcnt(3)
v_mfma_f32_32x32x16_bf16 v[176:191], v[196:199], v[132:135], v[176:191]
s_waitcnt lgkmcnt(2)
ds_read_b128 v[192:195], v0 offset:34816
ds_read_b128 v[224:227], v210 offset:1088
ds_read_b128 v[196:199], v0 offset:35840
ds_read_b128 v[244:247], v210 offset:1248
v_mfma_f32_32x32x16_bf16 v[176:191], v[200:203], v[136:139], v[176:191]
s_waitcnt lgkmcnt(4)
ds_read_b128 v[200:203], v0 offset:36864
v_mfma_f32_32x32x16_bf16 v[176:191], v[204:207], v[140:143], v[176:191]
v_mul_f32 v242, v242, v7
ds_read_b128 v[236:239], v210 offset:1184
s_waitcnt lgkmcnt(5)
v_mfma_f32_32x32x16_bf16 v[176:191], v[192:195], v[144:147], v[176:191]
ds_read_b128 v[204:207], v0 offset:37888
s_waitcnt lgkmcnt(3)
ds_read_b128 v[192:195], v0 offset:38912
v_mfma_f32_32x32x16_bf16 v[176:191], v[196:199], v[148:151], v[176:191]
ds_read_b128 v[196:199], v0 offset:39936
s_waitcnt lgkmcnt(4)
s_waitcnt lgkmcnt(3)
v_mul_f32 v240, v240, v7
v_mfma_f32_32x32x16_bf16 v[176:191], v[200:203], v[152:155], v[176:191]
v_mul_f32 v247, v247, v7
v_mul_f32 v245, v245, v7
v_mul_f32 v233, v233, v7
s_waitcnt lgkmcnt(2)
v_mfma_f32_32x32x16_bf16 v[176:191], v[204:207], v[156:159], v[176:191]
ds_read_b128 v[200:203], v0 offset:40960
s_waitcnt lgkmcnt(1)
ds_read_b128 v[204:207], v0 offset:41984
v_mul_f32 v232, v232, v7
v_mfma_f32_32x32x16_bf16 v[176:191], v[192:195], v[160:163], v[176:191]
v_mul_f32 v246, v246, v7
v_mul_f32 v244, v244, v7
v_mul_f32 v236, v236, v7
v_mfma_f32_32x32x16_bf16 v[176:191], v[196:199], v[164:167], v[176:191]
s_waitcnt lgkmcnt(0)
v_mul_f32 v239, v239, v7
v_mfma_f32_32x32x16_bf16 v[176:191], v[200:203], v[168:171], v[176:191]
v_mul_f32 v238, v238, v7
v_mfma_f32_32x32x16_bf16 v[176:191], v[204:207], v[172:175], v[176:191]
s_nop 0
v_mul_f32 v237, v237, v7
v_mul_f32 v235, v235, v7
v_mul_f32 v234, v234, v7
v_mul_f32 v243, v243, v7
s_nop 6
v_pk_fma_f32 v[184:185], v[184:185], v[224:225], v[240:241] neg_lo:[0,0,1] neg_hi:[0,0,1]
v_pk_fma_f32 v[182:183], v[182:183], v[222:223], v[238:239] neg_lo:[0,0,1] neg_hi:[0,0,1]
v_pk_fma_f32 v[180:181], v[180:181], v[220:221], v[236:237] neg_lo:[0,0,1] neg_hi:[0,0,1]
v_pk_fma_f32 v[188:189], v[188:189], v[228:229], v[244:245] neg_lo:[0,0,1] neg_hi:[0,0,1]
v_pk_fma_f32 v[176:177], v[176:177], v[216:217], v[232:233] neg_lo:[0,0,1] neg_hi:[0,0,1]
v_cvt_pk_bf16_f32 v194, v180, v181
v_pk_fma_f32 v[178:179], v[178:179], v[218:219], v[234:235] neg_lo:[0,0,1] neg_hi:[0,0,1]
v_cvt_pk_bf16_f32 v198, v188, v189
v_pk_fma_f32 v[190:191], v[190:191], v[230:231], v[246:247] neg_lo:[0,0,1] neg_hi:[0,0,1]
v_cvt_pk_bf16_f32 v199, v190, v191
v_cvt_pk_bf16_f32 v195, v182, v183
v_pk_fma_f32 v[186:187], v[186:187], v[226:227], v[242:243] neg_lo:[0,0,1] neg_hi:[0,0,1]
v_cvt_pk_bf16_f32 v193, v178, v179
v_cvt_pk_bf16_f32 v196, v184, v185
v_cvt_pk_bf16_f32 v197, v186, v187
v_cvt_pk_bf16_f32 v192, v176, v177
buffer_store_dwordx4 v[192:195], v6, s[4:7], s27 offen offset:0 sc1
buffer_store_dwordx4 v[196:199], v6, s[4:7], s27 offen offset:1024 sc1
s_add_u32 s30, s30, 3
s_cmp_lt_u32 s30, 60
s_cbranch_scc1 p1q_81
s_lshl_b32 s18, s51, 7
s_add_u32 s18, s18, 11552768
s_cmp_eq_u32 s13, 0
s_cselect_b32 s22, s18, s6
s_mov_b32 s23, 1
s_waitcnt vmcnt(0)
s_barrier
v_mov_b32 v3, s23
s_mov_b64 exec, 1
buffer_store_dword v3, off, s[4:7], s22 sc1
s_mov_b64 exec, -1
s_mov_b32 s22, s6
aend_64:
s_add_u32 s16, s16, 1
s_cmp_lt_u32 s16, 2
s_cbranch_scc1 alay_50
s_endpgm
L_fail:
s_mov_b64 exec, 1
v_mov_b32 v1, 0xdead
buffer_store_dword v1, off, s[8:11], 0 offset:4 sc1
L_end:
s_endpgm
L_chain:
s_waitcnt vmcnt(0)
s_nop 4
s_bitcmp1_b32 0x55555555, s14
s_cbranch_scc0 grp_10001
s_bfm_b32 s24, s14, 0
s_and_b32 s24, s24, 0x55555555
s_bcnt1_i32_b32 s24, s24
v_and_b32 v64, 63, v0
v_and_b32 v65, 15, v64
v_lshrrev_b32 v66, 4, v64
v_lshlrev_b32 v0, 4, v64
v_and_b32 v67, 2, v64
v_mov_b32 v68, 0x4444
v_mov_b32 v69, 0xeeee
v_cmp_eq_u32 vcc, 0, v67
s_nop 1
v_cndmask_b32 v1, v69, v68, vcc
s_mul_i32 s26, s13, 24576
s_add_u32 s26, s26, 65536
v_add_u32 v2, s26, v0
v_lshrrev_b32 v67, 2, v65
v_xor_b32 v68, v66, v67
v_lshlrev_b32 v68, 3, v68
v_lshl_add_u32 v68, v65, 5, v68
s_lshl_b32 s26, s13, 10
s_add_u32 s26, s26, 10240
v_add_u32 v3, s26, v68
v_lshl_add_u32 v68, v66, 2, v67
v_and_b32 v69, 3, v65
v_xor_b32 v69, v69, v66
v_lshlrev_b32 v69, 3, v69
v_lshl_add_u32 v68, v68, 5, v69
v_add_u32 v4, 10240, v68
v_and_b32 v69, 1, v65
v_lshl_add_u32 v68, v67, 1, v69
v_lshlrev_b32 v68, 4, v68
v_lshl_add_u32 v68, v66, 7, v68
v_add_u32 v5, 8192, v68
v_bfe_u32 v69, v65, 1, 1
v_mul_u32_u24 v69, 640, v69
v_xor_b32 v6, v69, v5
s_mov_b32 s42, 0x33333333
s_mov_b32 s43, 0x33333333
s_mov_b32 s44, 0x3f803f80
s_mov_b32 s45, 0x3f803f80
s_mov_b32 s46, 0x3f803f80
s_mov_b32 s47, 0
s_mov_b32 s37, 729808896
s_mov_b32 s38, 671088640
v_lshlrev_b32 v68, 3, v65
v_lshl_add_u32 v7, v66, 12, v68
s_lshl_b32 s26, s13, 14
s_lshl_b32 s27, s14, 7
s_add_u32 s26, s26, s27
s_add_u32 s90, s26, 65536
s_lshl_b32 s26, s13, 5
s_add_u32 s93, s26, s14
s_lshl_b32 s26, s93, 12
s_add_u32 s91, s26, 65536
s_lshr_b32 s26, s93, 2
s_lshl_b32 s26, s26, 9
s_and_b32 s27, s93, 3
s_lshl_b32 s27, s27, 6
s_add_u32 s26, s26, s27
s_add_u32 s92, s26, 393216
s_lshl_b32 s26, s14, 8
s_add_u32 s22, s26, 11534336
s_lshl_b32 s26, s24, 7
s_add_u32 s26, s26, 11550720
s_cmp_lt_u32 s24, 10
s_cselect_b32 s23, s26, 268435456
s_cselect_b32 s24, s24, 0
s_cselect_b32 s25, 12582912, s23
s_lshl_b32 s24, s24, 10
s_and_b32 s26, s14, 0
s_lshl_b32 s26, s26, 12
s_add_u32 s94, s26, 425984
s_lshl_b32 s26, s14, 7
s_add_u32 s95, s26, 425984
s_mov_b32 s35, 0x3e0293ee
s_lshl_b32 s26, s14, 2
s_add_u32 s26, s26, s13
s_mul_i32 s27, s26, 18432
s_add_u32 s89, s27, 1048576
s_add_u32 s48, s4, s90
s_addc_u32 s49, s5, 0
s_add_u32 s50, s90, 65536
s_add_u32 s50, s4, s50
s_addc_u32 s51, s5, 0
s_add_u32 s52, s90, 131072
s_add_u32 s52, s4, s52
s_addc_u32 s53, s5, 0
s_add_u32 s54, s90, 196608
s_add_u32 s54, s4, s54
s_addc_u32 s55, s5, 0
s_add_u32 s56, s90, 262144
s_add_u32 s56, s4, s56
s_addc_u32 s57, s5, 0
s_add_u32 s76, s89, 4096
s_add_u32 s76, s4, s76
s_addc_u32 s77, s5, 0
s_add_u32 s78, s89, 12288
s_add_u32 s78, s4, s78
s_addc_u32 s79, s5, 0
s_add_u32 s80, s89, 20480
s_add_u32 s80, s4, s80
s_addc_u32 s81, s5, 0
s_add_u32 s60, s4, s94
s_addc_u32 s61, s5, 0
s_add_u32 s62, s4, s95
s_addc_u32 s63, s5, 0
s_add_u32 s64, s4, s91
s_addc_u32 s65, s5, 0
s_add_u32 s66, s4, s92
s_addc_u32 s67, s5, 0
v_mov_b32 v72, 0
v_mov_b32 v73, 0
s_mov_b32 s26, s90
buffer_store_dwordx2 v[72:73], v7, s[4:7], s26 offen
s_add_u32 s26, s26, 65536
buffer_store_dwordx2 v[72:73], v7, s[4:7], s26 offen
s_add_u32 s26, s26, 65536
buffer_store_dwordx2 v[72:73], v7, s[4:7], s26 offen
s_add_u32 s26, s26, 65536
buffer_store_dwordx2 v[72:73], v7, s[4:7], s26 offen
s_add_u32 s26, s26, 65536
buffer_store_dwordx2 v[72:73], v7, s[4:7], s26 offen
s_add_u32 s26, s26, 65536
buffer_store_dword v72, off, s[4:7], s95 offset:0
s_load_dwordx2 s[96:97], s[0:1], 32
s_mov_b32 s98, 10240
s_mov_b32 s99, 0x20000
s_cmp_ge_u32 s93, 80
s_cbranch_scc1 nm0_10002
s_and_b32 s26, s93, 3
s_mul_i32 s26, s26, 2560
s_lshr_b32 s27, s93, 2
s_lshl_b32 s27, s27, 6
s_add_u32 s26, s26, s27
v_bfe_u32 v68, v65, 1, 2
v_lshlrev_b32 v68, 4, v68
v_and_b32 v69, 1, v65
v_lshl_add_u32 v68, v69, 2, v68
v_and_b32 v69, 1, v66
v_mul_u32_u24 v69, 1280, v69
v_add_u32 v68, v68, v69
s_waitcnt lgkmcnt(0)
buffer_load_dword v74, v68, s[96:99], s26 offen
buffer_load_dword v75, v68, s[96:99], s26 offen offset:8
v_and_b32 v68, 32, v0
v_bfe_u32 v69, v0, 6, 1
v_lshl_add_u32 v68, v69, 8, v68
v_bfe_u32 v69, v0, 8, 1
v_lshl_add_u32 v68, v69, 4, v68
v_bfe_u32 v69, v0, 4, 1
v_lshl_add_u32 v68, v69, 3, v68
s_add_u32 s27, s92, 16384
buffer_store_dwordx2 v[72:73], v68, s[4:7], s92 offen
s_waitcnt vmcnt(1)
buffer_store_dwordx2 v[74:75], v68, s[4:7], s27 offen
nm0_10002:
s_waitcnt vmcnt(0) lgkmcnt(0)
s_barrier
s_cmp_eq_u32 s13, 0
s_cselect_b32 s26, 144, s10
v_mov_b32 v74, 1
s_mov_b64 exec, 1
buffer_atomic_add v74, off, s[8:11], s26
s_mov_b64 exec, -1
v_lshrrev_b32 v67, 3, v64
v_and_b32 v68, 7, v64
v_lshlrev_b32 v68, 4, v68
v_lshl_add_u32 v32, v67, 13, v68
v_mul_u32_u24 v67, 1280, v67
v_add_u32 v36, v67, v68
v_lshrrev_b32 v67, 1, v66
v_lshlrev_b32 v67, 4, v67
v_and_b32 v68, 1, v66
v_lshl_add_u32 v67, v68, 1, v67
v_lshrrev_b32 v68, 3, v65
v_lshl_add_u32 v67, v68, 3, v67
v_bfe_u32 v68, v65, 2, 1
v_add_u32 v67, v67, v68
v_and_b32 v69, 3, v65
v_lshlrev_b32 v40, 4, v69
v_lshl_add_u32 v40, v67, 7, v40
v_lshl_add_u32 v67, v66, 2, v68
v_lshlrev_b32 v42, 4, v69
v_lshl_add_u32 v42, v67, 7, v42
v_lshrrev_b32 v68, 3, v65
v_lshl_add_u32 v42, v68, 3, v42
s_lshl_b32 s29, s13, 12
s_and_b32 s26, s13, 1
s_lshl_b32 s26, s26, 6
s_add_u32 s26, s26, s29
v_add_u32 v40, s26, v40
v_add_u32 v42, s26, v42
v_xor_b32 v41, 4096, v40
v_xor_b32 v43, 4096, v42
v_add_u32 v33, 64512, v32
v_add_u32 v37, 9216, v36
v_add_u32 v34, 129024, v32
v_add_u32 v38, 18432, v36
v_add_u32 v35, 193536, v32
v_add_u32 v39, 27648, v36
s_lshr_b32 s28, s13, 1
s_lshl_b32 s28, s28, 7
s_lshl_b32 s27, s14, 8
s_add_u32 s27, s27, s28
s_xor_b32 s26, s13, 0
s_lshl_b32 s82, s26, 19
s_add_u32 s82, s82, s27
s_lshl_b32 s85, s14, 2
s_add_u32 s85, s85, s26
s_mul_i32 s85, s85, 40960
s_add_u32 s85, s85, s28
s_xor_b32 s26, s13, 2
s_lshl_b32 s83, s26, 19
s_add_u32 s83, s83, s27
s_lshl_b32 s86, s14, 2
s_add_u32 s86, s86, s26
s_mul_i32 s86, s86, 40960
s_add_u32 s86, s86, s28
s_and_b32 s26, s13, 1
s_add_u32 s26, s26, 8
s_lshl_b32 s84, s26, 19
s_add_u32 s84, s84, s27
s_load_dwordx2 s[68:69], s[0:1], 40
s_load_dwordx2 s[70:71], s[0:1], 48
s_load_dwordx2 s[72:73], s[0:1], 56
s_load_dwordx2 s[74:75], s[0:1], 64
s_mov_b32 s98, 5242880
s_waitcnt lgkmcnt(0)
s_mov_b64 s[96:97], s[70:71]
s_add_u32 m0, s29, 0
s_add_u32 s26, s82, 0
buffer_load_dwordx4 v32, s[96:99], s26 offen offset:0 lds
buffer_load_dwordx4 v33, s[96:99], s26 offen offset:1024 lds
buffer_load_dwordx4 v34, s[96:99], s26 offen offset:2048 lds
buffer_load_dwordx4 v35, s[96:99], s26 offen offset:3072 lds
s_add_u32 m0, s29, 16384
s_add_u32 s26, s82, 262144
buffer_load_dwordx4 v32, s[96:99], s26 offen offset:0 lds
buffer_load_dwordx4 v33, s[96:99], s26 offen offset:1024 lds
buffer_load_dwordx4 v34, s[96:99], s26 offen offset:2048 lds
buffer_load_dwordx4 v35, s[96:99], s26 offen offset:3072 lds
s_add_u32 m0, s29, 32768
s_add_u32 s26, s82, 2097152
buffer_load_dwordx4 v32, s[96:99], s26 offen offset:0 lds
buffer_load_dwordx4 v33, s[96:99], s26 offen offset:1024 lds
buffer_load_dwordx4 v34, s[96:99], s26 offen offset:2048 lds
buffer_load_dwordx4 v35, s[96:99], s26 offen offset:3072 lds
s_waitcnt vmcnt(8)
s_barrier
s_add_u32 m0, s29, 49152
s_add_u32 s26, s82, 2359296
buffer_load_dwordx4 v32, s[96:99], s26 offen offset:0 lds
buffer_load_dwordx4 v33, s[96:99], s26 offen offset:1024 lds
buffer_load_dwordx4 v34, s[96:99], s26 offen offset:2048 lds
buffer_load_dwordx4 v35, s[96:99], s26 offen offset:3072 lds
ds_read_b64_tr_b16 v[72:73], v40 offset:0
ds_read_b64_tr_b16 v[74:75], v40 offset:512
ds_read_b64_tr_b16 v[76:77], v40 offset:8
ds_read_b64_tr_b16 v[78:79], v40 offset:520
ds_read_b64_tr_b16 a[160:161], v41 offset:0
ds_read_b64_tr_b16 a[162:163], v41 offset:512
ds_read_b64_tr_b16 v[80:81], v41 offset:8
ds_read_b64_tr_b16 v[82:83], v41 offset:520
s_waitcnt lgkmcnt(6)
global_store_dwordx4 v0, v[72:75], s[76:77] offset:0
s_waitcnt lgkmcnt(4)
global_store_dwordx4 v0, v[76:79], s[76:77] offset:2048
s_waitcnt lgkmcnt(0)
ds_write_b128 v2, v[80:83] offset:6144
s_waitcnt vmcnt(10)
s_barrier
s_add_u32 m0, s29, 0
s_add_u32 s26, s83, 0
buffer_load_dwordx4 v32, s[96:99], s26 offen offset:0 lds
buffer_load_dwordx4 v33, s[96:99], s26 offen offset:1024 lds
buffer_load_dwordx4 v34, s[96:99], s26 offen offset:2048 lds
buffer_load_dwordx4 v35, s[96:99], s26 offen offset:3072 lds
ds_read_b64_tr_b16 v[72:73], v40 offset:16384
ds_read_b64_tr_b16 v[74:75], v40 offset:16896
ds_read_b64_tr_b16 v[76:77], v40 offset:16392
ds_read_b64_tr_b16 v[78:79], v40 offset:16904
ds_read_b64_tr_b16 a[164:165], v41 offset:16384
ds_read_b64_tr_b16 a[166:167], v41 offset:16896
ds_read_b64_tr_b16 v[80:81], v41 offset:16392
ds_read_b64_tr_b16 v[82:83], v41 offset:16904
s_waitcnt lgkmcnt(6)
global_store_dwordx4 v0, v[72:75], s[76:77] offset:1024
s_waitcnt lgkmcnt(4)
global_store_dwordx4 v0, v[76:79], s[76:77] offset:3072
s_waitcnt lgkmcnt(0)
ds_write_b128 v2, v[80:83] offset:7168
s_waitcnt vmcnt(12)
s_barrier
s_add_u32 m0, s29, 16384
s_add_u32 s26, s83, 262144
buffer_load_dwordx4 v32, s[96:99], s26 offen offset:0 lds
buffer_load_dwordx4 v33, s[96:99], s26 offen offset:1024 lds
buffer_load_dwordx4 v34, s[96:99], s26 offen offset:2048 lds
buffer_load_dwordx4 v35, s[96:99], s26 offen offset:3072 lds
ds_read_b64_tr_b16 a[32:33], v40 offset:32768
ds_read_b64_tr_b16 a[34:35], v40 offset:33280
ds_read_b64_tr_b16 a[40:41], v40 offset:32776
ds_read_b64_tr_b16 a[42:43], v40 offset:33288
ds_read_b64_tr_b16 a[168:169], v41 offset:32768
ds_read_b64_tr_b16 a[170:171], v41 offset:33280
ds_read_b64_tr_b16 a[176:177], v41 offset:32776
ds_read_b64_tr_b16 a[178:179], v41 offset:33288
s_waitcnt vmcnt(12) lgkmcnt(0)
s_barrier
s_add_u32 m0, s29, 32768
s_add_u32 s26, s83, 2097152
buffer_load_dwordx4 v32, s[96:99], s26 offen offset:0 lds
buffer_load_dwordx4 v33, s[96:99], s26 offen offset:1024 lds
buffer_load_dwordx4 v34, s[96:99], s26 offen offset:2048 lds
buffer_load_dwordx4 v35, s[96:99], s26 offen offset:3072 lds
ds_read_b64_tr_b16 a[36:37], v40 offset:49152
ds_read_b64_tr_b16 a[38:39], v40 offset:49664
ds_read_b64_tr_b16 a[44:45], v40 offset:49160
ds_read_b64_tr_b16 a[46:47], v40 offset:49672
ds_read_b64_tr_b16 a[172:173], v41 offset:49152
ds_read_b64_tr_b16 a[174:175], v41 offset:49664
ds_read_b64_tr_b16 a[180:181], v41 offset:49160
ds_read_b64_tr_b16 a[182:183], v41 offset:49672
s_waitcnt vmcnt(10) lgkmcnt(0)
s_barrier
s_add_u32 m0, s29, 49152
s_add_u32 s26, s83, 2359296
buffer_load_dwordx4 v32, s[96:99], s26 offen offset:0 lds
buffer_load_dwordx4 v33, s[96:99], s26 offen offset:1024 lds
buffer_load_dwordx4 v34, s[96:99], s26 offen offset:2048 lds
buffer_load_dwordx4 v35, s[96:99], s26 offen offset:3072 lds
ds_read_b64_tr_b16 v[72:73], v40 offset:0
ds_read_b64_tr_b16 v[74:75], v40 offset:512
ds_read_b64_tr_b16 a[184:185], v40 offset:8
ds_read_b64_tr_b16 a[186:187], v40 offset:520
ds_read_b64_tr_b16 a[192:193], v41 offset:0
ds_read_b64_tr_b16 a[194:195], v41 offset:512
ds_read_b64_tr_b16 a[200:201], v41 offset:8
ds_read_b64_tr_b16 a[202:203], v41 offset:520
s_waitcnt lgkmcnt(6)
ds_write_b128 v2, v[72:75] offset:8192
s_waitcnt vmcnt(8) lgkmcnt(1)
s_barrier
s_add_u32 m0, s29, 0
s_add_u32 s26, s84, 0
buffer_load_dwordx4 v32, s[96:99], s26 offen offset:0 lds
buffer_load_dwordx4 v33, s[96:99], s26 offen offset:1024 lds
buffer_load_dwordx4 v34, s[96:99], s26 offen offset:2048 lds
buffer_load_dwordx4 v35, s[96:99], s26 offen offset:3072 lds
ds_read_b64_tr_b16 v[72:73], v40 offset:16384
ds_read_b64_tr_b16 v[74:75], v40 offset:16896
ds_read_b64_tr_b16 a[188:189], v40 offset:16392
ds_read_b64_tr_b16 a[190:191], v40 offset:16904
ds_read_b64_tr_b16 a[196:197], v41 offset:16384
ds_read_b64_tr_b16 a[198:199], v41 offset:16896
ds_read_b64_tr_b16 a[204:205], v41 offset:16392
ds_read_b64_tr_b16 a[206:207], v41 offset:16904
s_waitcnt lgkmcnt(6)
ds_write_b128 v2, v[72:75] offset:9216
s_waitcnt vmcnt(8) lgkmcnt(1)
s_barrier
s_add_u32 m0, s29, 16384
s_add_u32 s26, s84, 262144
buffer_load_dwordx4 v32, s[96:99], s26 offen offset:0 lds
buffer_load_dwordx4 v33, s[96:99], s26 offen offset:1024 lds
buffer_load_dwordx4 v34, s[96:99], s26 offen offset:2048 lds
buffer_load_dwordx4 v35, s[96:99], s26 offen offset:3072 lds
ds_read_b64_tr_b16 v[72:73], v40 offset:32768
ds_read_b64_tr_b16 v[74:75], v40 offset:33280
ds_read_b64_tr_b16 v[76:77], v40 offset:32776
ds_read_b64_tr_b16 v[78:79], v40 offset:33288
ds_read_b64_tr_b16 v[80:81], v41 offset:32768
ds_read_b64_tr_b16 v[82:83], v41 offset:33280
ds_read_b64_tr_b16 a[208:209], v41 offset:32776
ds_read_b64_tr_b16 a[210:211], v41 offset:33288
s_waitcnt lgkmcnt(6)
global_store_dwordx4 v0, v[72:75], s[78:79] offset:-2048
s_waitcnt lgkmcnt(4)
ds_write_b128 v2, v[76:79] offset:10240
s_waitcnt lgkmcnt(3)
ds_write_b128 v2, v[80:83] offset:12288
s_waitcnt vmcnt(9) lgkmcnt(2)
s_barrier
s_mov_b64 s[96:97], s[72:73]
s_add_u32 m0, s29, 32768
s_add_u32 s26, s82, 0
buffer_load_dwordx4 v32, s[96:99], s26 offen offset:0 lds
buffer_load_dwordx4 v33, s[96:99], s26 offen offset:1024 lds
buffer_load_dwordx4 v34, s[96:99], s26 offen offset:2048 lds
buffer_load_dwordx4 v35, s[96:99], s26 offen offset:3072 lds
ds_read_b64_tr_b16 v[72:73], v40 offset:49152
ds_read_b64_tr_b16 v[74:75], v40 offset:49664
ds_read_b64_tr_b16 v[76:77], v40 offset:49160
ds_read_b64_tr_b16 v[78:79], v40 offset:49672
ds_read_b64_tr_b16 v[80:81], v41 offset:49152
ds_read_b64_tr_b16 v[82:83], v41 offset:49664
ds_read_b64_tr_b16 a[212:213], v41 offset:49160
ds_read_b64_tr_b16 a[214:215], v41 offset:49672
s_waitcnt lgkmcnt(6)
global_store_dwordx4 v0, v[72:75], s[78:79] offset:-1024
s_waitcnt lgkmcnt(4)
ds_write_b128 v2, v[76:79] offset:11264
s_waitcnt lgkmcnt(3)
ds_write_b128 v2, v[80:83] offset:13312
s_waitcnt vmcnt(10) lgkmcnt(2)
s_barrier
s_add_u32 m0, s29, 49152
s_add_u32 s26, s82, 262144
buffer_load_dwordx4 v32, s[96:99], s26 offen offset:0 lds
buffer_load_dwordx4 v33, s[96:99], s26 offen offset:1024 lds
buffer_load_dwordx4 v34, s[96:99], s26 offen offset:2048 lds
buffer_load_dwordx4 v35, s[96:99], s26 offen offset:3072 lds
ds_read_b64_tr_b16 v[72:73], v40 offset:0
ds_read_b64_tr_b16 v[74:75], v40 offset:512
ds_read_b64_tr_b16 a[216:217], v40 offset:8
ds_read_b64_tr_b16 a[218:219], v40 offset:520
ds_read_b64_tr_b16 a[224:225], v41 offset:0
ds_read_b64_tr_b16 a[226:227], v41 offset:512
ds_read_b64_tr_b16 v[76:77], v41 offset:8
ds_read_b64_tr_b16 v[78:79], v41 offset:520
s_waitcnt lgkmcnt(6)
ds_write_b128 v2, v[72:75] offset:14336
s_waitcnt lgkmcnt(1)
ds_write_b128 v2, v[76:79] offset:16384
s_waitcnt vmcnt(10)
s_barrier
s_add_u32 m0, s29, 0
s_add_u32 s26, s82, 2097152
buffer_load_dwordx4 v32, s[96:99], s26 offen offset:0 lds
buffer_load_dwordx4 v33, s[96:99], s26 offen offset:1024 lds
buffer_load_dwordx4 v34, s[96:99], s26 offen offset:2048 lds
buffer_load_dwordx4 v35, s[96:99], s26 offen offset:3072 lds
ds_read_b64_tr_b16 v[72:73], v40 offset:16384
ds_read_b64_tr_b16 v[74:75], v40 offset:16896
ds_read_b64_tr_b16 a[220:221], v40 offset:16392
ds_read_b64_tr_b16 a[222:223], v40 offset:16904
ds_read_b64_tr_b16 a[228:229], v41 offset:16384
ds_read_b64_tr_b16 a[230:231], v41 offset:16896
ds_read_b64_tr_b16 v[76:77], v41 offset:16392
ds_read_b64_tr_b16 v[78:79], v41 offset:16904
s_waitcnt lgkmcnt(6)
ds_write_b128 v2, v[72:75] offset:15360
s_waitcnt lgkmcnt(1)
ds_write_b128 v2, v[76:79] offset:17408
s_waitcnt vmcnt(9)
s_barrier
s_add_u32 m0, s29, 16384
s_add_u32 s26, s82, 2359296
buffer_load_dwordx4 v32, s[96:99], s26 offen offset:0 lds
buffer_load_dwordx4 v33, s[96:99], s26 offen offset:1024 lds
buffer_load_dwordx4 v34, s[96:99], s26 offen offset:2048 lds
buffer_load_dwordx4 v35, s[96:99], s26 offen offset:3072 lds
ds_read_b64_tr_b16 a[0:1], v40 offset:32768
ds_read_b64_tr_b16 a[2:3], v40 offset:33280
ds_read_b64_tr_b16 a[8:9], v40 offset:32776
ds_read_b64_tr_b16 a[10:11], v40 offset:33288
ds_read_b64_tr_b16 a[248:249], v41 offset:32768
ds_read_b64_tr_b16 a[250:251], v41 offset:33280
ds_read_b64_tr_b16 v[88:89], v41 offset:32776
ds_read_b64_tr_b16 v[90:91], v41 offset:33288
s_waitcnt vmcnt(8) lgkmcnt(0)
s_barrier
s_add_u32 m0, s29, 32768
s_add_u32 s26, s83, 0
buffer_load_dwordx4 v32, s[96:99], s26 offen offset:0 lds
buffer_load_dwordx4 v33, s[96:99], s26 offen offset:1024 lds
buffer_load_dwordx4 v34, s[96:99], s26 offen offset:2048 lds
buffer_load_dwordx4 v35, s[96:99], s26 offen offset:3072 lds
ds_read_b64_tr_b16 a[4:5], v40 offset:49152
ds_read_b64_tr_b16 a[6:7], v40 offset:49664
ds_read_b64_tr_b16 a[12:13], v40 offset:49160
ds_read_b64_tr_b16 a[14:15], v40 offset:49672
ds_read_b64_tr_b16 a[252:253], v41 offset:49152
ds_read_b64_tr_b16 a[254:255], v41 offset:49664
ds_read_b64_tr_b16 v[92:93], v41 offset:49160
ds_read_b64_tr_b16 v[94:95], v41 offset:49672
s_waitcnt vmcnt(8) lgkmcnt(0)
s_barrier
s_add_u32 m0, s29, 49152
s_add_u32 s26, s83, 262144
buffer_load_dwordx4 v32, s[96:99], s26 offen offset:0 lds
buffer_load_dwordx4 v33, s[96:99], s26 offen offset:1024 lds
buffer_load_dwordx4 v34, s[96:99], s26 offen offset:2048 lds
buffer_load_dwordx4 v35, s[96:99], s26 offen offset:3072 lds
ds_read_b64_tr_b16 a[48:49], v40 offset:0
ds_read_b64_tr_b16 a[50:51], v40 offset:512
ds_read_b64_tr_b16 v[72:73], v40 offset:8
ds_read_b64_tr_b16 v[74:75], v40 offset:520
ds_read_b64_tr_b16 v[76:77], v41 offset:0
ds_read_b64_tr_b16 v[78:79], v41 offset:512
ds_read_b64_tr_b16 v[96:97], v41 offset:8
ds_read_b64_tr_b16 v[98:99], v41 offset:520
s_waitcnt lgkmcnt(4)
ds_write_b128 v2, v[72:75] offset:0
s_waitcnt lgkmcnt(3)
ds_write_b128 v2, v[76:79] offset:22528
s_waitcnt vmcnt(8) lgkmcnt(2)
s_barrier
s_add_u32 m0, s29, 0
s_add_u32 s26, s83, 2097152
buffer_load_dwordx4 v32, s[96:99], s26 offen offset:0 lds
buffer_load_dwordx4 v33, s[96:99], s26 offen offset:1024 lds
buffer_load_dwordx4 v34, s[96:99], s26 offen offset:2048 lds
buffer_load_dwordx4 v35, s[96:99], s26 offen offset:3072 lds
ds_read_b64_tr_b16 a[52:53], v40 offset:16384
ds_read_b64_tr_b16 a[54:55], v40 offset:16896
ds_read_b64_tr_b16 v[72:73], v40 offset:16392
ds_read_b64_tr_b16 v[74:75], v40 offset:16904
ds_read_b64_tr_b16 v[76:77], v41 offset:16384
ds_read_b64_tr_b16 v[78:79], v41 offset:16896
ds_read_b64_tr_b16 v[100:101], v41 offset:16392
ds_read_b64_tr_b16 v[102:103], v41 offset:16904
s_waitcnt lgkmcnt(4)
ds_write_b128 v2, v[72:75] offset:1024
s_waitcnt lgkmcnt(3)
ds_write_b128 v2, v[76:79] offset:23552
s_waitcnt vmcnt(8) lgkmcnt(2)
s_barrier
s_add_u32 m0, s29, 16384
s_add_u32 s26, s83, 2359296
buffer_load_dwordx4 v32, s[96:99], s26 offen offset:0 lds
buffer_load_dwordx4 v33, s[96:99], s26 offen offset:1024 lds
buffer_load_dwordx4 v34, s[96:99], s26 offen offset:2048 lds
buffer_load_dwordx4 v35, s[96:99], s26 offen offset:3072 lds
ds_read_b64_tr_b16 v[104:105], v40 offset:32768
ds_read_b64_tr_b16 v[106:107], v40 offset:33280
ds_read_b64_tr_b16 v[112:113], v40 offset:32776
ds_read_b64_tr_b16 v[114:115], v40 offset:33288
ds_read_b64_tr_b16 v[136:137], v41 offset:32768
ds_read_b64_tr_b16 v[138:139], v41 offset:33280
ds_read_b64_tr_b16 v[144:145], v41 offset:32776
ds_read_b64_tr_b16 v[146:147], v41 offset:33288
s_waitcnt vmcnt(8) lgkmcnt(0)
s_barrier
s_add_u32 m0, s29, 32768
s_add_u32 s26, s84, 0
buffer_load_dwordx4 v32, s[96:99], s26 offen offset:0 lds
buffer_load_dwordx4 v33, s[96:99], s26 offen offset:1024 lds
buffer_load_dwordx4 v34, s[96:99], s26 offen offset:2048 lds
buffer_load_dwordx4 v35, s[96:99], s26 offen offset:3072 lds
ds_read_b64_tr_b16 v[108:109], v40 offset:49152
ds_read_b64_tr_b16 v[110:111], v40 offset:49664
ds_read_b64_tr_b16 v[116:117], v40 offset:49160
ds_read_b64_tr_b16 v[118:119], v40 offset:49672
ds_read_b64_tr_b16 v[140:141], v41 offset:49152
ds_read_b64_tr_b16 v[142:143], v41 offset:49664
ds_read_b64_tr_b16 v[148:149], v41 offset:49160
ds_read_b64_tr_b16 v[150:151], v41 offset:49672
s_waitcnt vmcnt(8) lgkmcnt(0)
s_barrier
s_add_u32 m0, s29, 49152
s_add_u32 s26, s84, 262144
buffer_load_dwordx4 v32, s[96:99], s26 offen offset:0 lds
buffer_load_dwordx4 v33, s[96:99], s26 offen offset:1024 lds
buffer_load_dwordx4 v34, s[96:99], s26 offen offset:2048 lds
buffer_load_dwordx4 v35, s[96:99], s26 offen offset:3072 lds
ds_read_b64_tr_b16 v[120:121], v40 offset:0
ds_read_b64_tr_b16 v[122:123], v40 offset:512
ds_read_b64_tr_b16 v[128:129], v40 offset:8
ds_read_b64_tr_b16 v[130:131], v40 offset:520
ds_read_b64_tr_b16 v[152:153], v41 offset:0
ds_read_b64_tr_b16 v[154:155], v41 offset:512
ds_read_b64_tr_b16 v[160:161], v41 offset:8
ds_read_b64_tr_b16 v[162:163], v41 offset:520
s_waitcnt vmcnt(8) lgkmcnt(0)
s_barrier
s_mov_b64 s[96:97], s[68:69]
s_add_u32 m0, s29, 0
s_add_u32 s26, s82, 0
buffer_load_dwordx4 v32, s[96:99], s26 offen offset:0 lds
buffer_load_dwordx4 v33, s[96:99], s26 offen offset:1024 lds
buffer_load_dwordx4 v34, s[96:99], s26 offen offset:2048 lds
buffer_load_dwordx4 v35, s[96:99], s26 offen offset:3072 lds
ds_read_b64_tr_b16 v[124:125], v40 offset:16384
ds_read_b64_tr_b16 v[126:127], v40 offset:16896
ds_read_b64_tr_b16 v[132:133], v40 offset:16392
ds_read_b64_tr_b16 v[134:135], v40 offset:16904
ds_read_b64_tr_b16 v[156:157], v41 offset:16384
ds_read_b64_tr_b16 v[158:159], v41 offset:16896
ds_read_b64_tr_b16 v[164:165], v41 offset:16392
ds_read_b64_tr_b16 v[166:167], v41 offset:16904
s_waitcnt vmcnt(8) lgkmcnt(0)
s_barrier
s_add_u32 m0, s29, 16384
s_add_u32 s26, s82, 262144
buffer_load_dwordx4 v32, s[96:99], s26 offen offset:0 lds
buffer_load_dwordx4 v33, s[96:99], s26 offen offset:1024 lds
buffer_load_dwordx4 v34, s[96:99], s26 offen offset:2048 lds
buffer_load_dwordx4 v35, s[96:99], s26 offen offset:3072 lds
ds_read_b64_tr_b16 v[72:73], v40 offset:32768
ds_read_b64_tr_b16 v[74:75], v40 offset:33280
ds_read_b64_tr_b16 a[232:233], v40 offset:32776
ds_read_b64_tr_b16 a[234:235], v40 offset:33288
ds_read_b64_tr_b16 a[240:241], v41 offset:32768
ds_read_b64_tr_b16 a[242:243], v41 offset:33280
ds_read_b64_tr_b16 v[76:77], v41 offset:32776
ds_read_b64_tr_b16 v[78:79], v41 offset:33288
s_waitcnt lgkmcnt(6)
ds_write_b128 v2, v[72:75] offset:18432
s_waitcnt lgkmcnt(1)
ds_write_b128 v2, v[76:79] offset:20480
s_waitcnt vmcnt(8)
s_barrier
s_add_u32 m0, s29, 32768
s_add_u32 s26, s82, 2097152
buffer_load_dwordx4 v32, s[96:99], s26 offen offset:0 lds
buffer_load_dwordx4 v33, s[96:99], s26 offen offset:1024 lds
buffer_load_dwordx4 v34, s[96:99], s26 offen offset:2048 lds
buffer_load_dwordx4 v35, s[96:99], s26 offen offset:3072 lds
ds_read_b64_tr_b16 v[72:73], v40 offset:49152
ds_read_b64_tr_b16 v[74:75], v40 offset:49664
ds_read_b64_tr_b16 a[236:237], v40 offset:49160
ds_read_b64_tr_b16 a[238:239], v40 offset:49672
ds_read_b64_tr_b16 a[244:245], v41 offset:49152
ds_read_b64_tr_b16 a[246:247], v41 offset:49664
ds_read_b64_tr_b16 v[76:77], v41 offset:49160
ds_read_b64_tr_b16 v[78:79], v41 offset:49672
s_waitcnt lgkmcnt(6)
ds_write_b128 v2, v[72:75] offset:19456
s_waitcnt lgkmcnt(1)
ds_write_b128 v2, v[76:79] offset:21504
s_waitcnt vmcnt(8)
s_barrier
s_add_u32 m0, s29, 49152
s_add_u32 s26, s82, 2359296
buffer_load_dwordx4 v32, s[96:99], s26 offen offset:0 lds
buffer_load_dwordx4 v33, s[96:99], s26 offen offset:1024 lds
buffer_load_dwordx4 v34, s[96:99], s26 offen offset:2048 lds
buffer_load_dwordx4 v35, s[96:99], s26 offen offset:3072 lds
ds_read_b64_tr_b16 v[72:73], v40 offset:0
ds_read_b64_tr_b16 v[74:75], v40 offset:512
ds_read_b64_tr_b16 v[76:77], v40 offset:8
ds_read_b64_tr_b16 v[78:79], v40 offset:520
ds_read_b64_tr_b16 a[56:57], v41 offset:0
ds_read_b64_tr_b16 a[58:59], v41 offset:512
ds_read_b64_tr_b16 a[64:65], v41 offset:8
ds_read_b64_tr_b16 a[66:67], v41 offset:520
s_waitcnt lgkmcnt(6)
global_store_dwordx4 v0, v[72:75], s[76:77] offset:-4096
s_waitcnt lgkmcnt(4)
global_store_dwordx4 v0, v[76:79], s[76:77] offset:-2048
s_waitcnt vmcnt(10) lgkmcnt(0)
s_barrier
s_add_u32 m0, s29, 0
s_add_u32 s26, s83, 0
buffer_load_dwordx4 v32, s[96:99], s26 offen offset:0 lds
buffer_load_dwordx4 v33, s[96:99], s26 offen offset:1024 lds
buffer_load_dwordx4 v34, s[96:99], s26 offen offset:2048 lds
buffer_load_dwordx4 v35, s[96:99], s26 offen offset:3072 lds
ds_read_b64_tr_b16 v[72:73], v40 offset:16384
ds_read_b64_tr_b16 v[74:75], v40 offset:16896
ds_read_b64_tr_b16 v[76:77], v40 offset:16392
ds_read_b64_tr_b16 v[78:79], v40 offset:16904
ds_read_b64_tr_b16 a[60:61], v41 offset:16384
ds_read_b64_tr_b16 a[62:63], v41 offset:16896
ds_read_b64_tr_b16 a[68:69], v41 offset:16392
ds_read_b64_tr_b16 a[70:71], v41 offset:16904
s_waitcnt lgkmcnt(6)
global_store_dwordx4 v0, v[72:75], s[76:77] offset:-3072
s_waitcnt lgkmcnt(4)
global_store_dwordx4 v0, v[76:79], s[76:77] offset:-1024
s_waitcnt vmcnt(12) lgkmcnt(0)
s_barrier
s_add_u32 m0, s29, 16384
s_add_u32 s26, s83, 262144
buffer_load_dwordx4 v32, s[96:99], s26 offen offset:0 lds
buffer_load_dwordx4 v33, s[96:99], s26 offen offset:1024 lds
buffer_load_dwordx4 v34, s[96:99], s26 offen offset:2048 lds
buffer_load_dwordx4 v35, s[96:99], s26 offen offset:3072 lds
ds_read_b64_tr_b16 a[16:17], v40 offset:32768
ds_read_b64_tr_b16 a[18:19], v40 offset:33280
ds_read_b64_tr_b16 a[24:25], v40 offset:32776
ds_read_b64_tr_b16 a[26:27], v40 offset:33288
ds_read_b64_tr_b16 a[72:73], v41 offset:32768
ds_read_b64_tr_b16 a[74:75], v41 offset:33280
ds_read_b64_tr_b16 a[80:81], v41 offset:32776
ds_read_b64_tr_b16 a[82:83], v41 offset:33288
s_waitcnt vmcnt(12) lgkmcnt(0)
s_barrier
s_add_u32 m0, s29, 32768
s_add_u32 s26, s83, 2097152
buffer_load_dwordx4 v32, s[96:99], s26 offen offset:0 lds
buffer_load_dwordx4 v33, s[96:99], s26 offen offset:1024 lds
buffer_load_dwordx4 v34, s[96:99], s26 offen offset:2048 lds
buffer_load_dwordx4 v35, s[96:99], s26 offen offset:3072 lds
ds_read_b64_tr_b16 a[20:21], v40 offset:49152
ds_read_b64_tr_b16 a[22:23], v40 offset:49664
ds_read_b64_tr_b16 a[28:29], v40 offset:49160
ds_read_b64_tr_b16 a[30:31], v40 offset:49672
ds_read_b64_tr_b16 a[76:77], v41 offset:49152
ds_read_b64_tr_b16 a[78:79], v41 offset:49664
ds_read_b64_tr_b16 a[84:85], v41 offset:49160
ds_read_b64_tr_b16 a[86:87], v41 offset:49672
s_waitcnt vmcnt(10) lgkmcnt(0)
s_barrier
s_add_u32 m0, s29, 49152
s_add_u32 s26, s83, 2359296
buffer_load_dwordx4 v32, s[96:99], s26 offen offset:0 lds
buffer_load_dwordx4 v33, s[96:99], s26 offen offset:1024 lds
buffer_load_dwordx4 v34, s[96:99], s26 offen offset:2048 lds
buffer_load_dwordx4 v35, s[96:99], s26 offen offset:3072 lds
ds_read_b64_tr_b16 a[88:89], v40 offset:0
ds_read_b64_tr_b16 a[90:91], v40 offset:512
ds_read_b64_tr_b16 v[72:73], v40 offset:8
ds_read_b64_tr_b16 v[74:75], v40 offset:520
ds_read_b64_tr_b16 a[112:113], v41 offset:0
ds_read_b64_tr_b16 a[114:115], v41 offset:512
ds_read_b64_tr_b16 a[120:121], v41 offset:8
ds_read_b64_tr_b16 a[122:123], v41 offset:520
s_waitcnt lgkmcnt(4)
ds_write_b128 v2, v[72:75] offset:2048
s_waitcnt vmcnt(8) lgkmcnt(1)
s_barrier
s_add_u32 m0, s29, 0
s_add_u32 s26, s84, 0
buffer_load_dwordx4 v32, s[96:99], s26 offen offset:0 lds
buffer_load_dwordx4 v33, s[96:99], s26 offen offset:1024 lds
buffer_load_dwordx4 v34, s[96:99], s26 offen offset:2048 lds
buffer_load_dwordx4 v35, s[96:99], s26 offen offset:3072 lds
ds_read_b64_tr_b16 a[92:93], v40 offset:16384
ds_read_b64_tr_b16 a[94:95], v40 offset:16896
ds_read_b64_tr_b16 v[72:73], v40 offset:16392
ds_read_b64_tr_b16 v[74:75], v40 offset:16904
ds_read_b64_tr_b16 a[116:117], v41 offset:16384
ds_read_b64_tr_b16 a[118:119], v41 offset:16896
ds_read_b64_tr_b16 a[124:125], v41 offset:16392
ds_read_b64_tr_b16 a[126:127], v41 offset:16904
s_waitcnt lgkmcnt(4)
ds_write_b128 v2, v[72:75] offset:3072
s_waitcnt vmcnt(8) lgkmcnt(1)
s_barrier
s_add_u32 m0, s29, 16384
s_add_u32 s26, s84, 262144
buffer_load_dwordx4 v32, s[96:99], s26 offen offset:0 lds
buffer_load_dwordx4 v33, s[96:99], s26 offen offset:1024 lds
buffer_load_dwordx4 v34, s[96:99], s26 offen offset:2048 lds
buffer_load_dwordx4 v35, s[96:99], s26 offen offset:3072 lds
ds_read_b64_tr_b16 a[96:97], v40 offset:32768
ds_read_b64_tr_b16 a[98:99], v40 offset:33280
ds_read_b64_tr_b16 a[104:105], v40 offset:32776
ds_read_b64_tr_b16 a[106:107], v40 offset:33288
ds_read_b64_tr_b16 a[128:129], v41 offset:32768
ds_read_b64_tr_b16 a[130:131], v41 offset:33280
ds_read_b64_tr_b16 v[72:73], v41 offset:32776
ds_read_b64_tr_b16 v[74:75], v41 offset:33288
s_waitcnt lgkmcnt(0)
ds_write_b128 v2, v[72:75] offset:4096
s_waitcnt vmcnt(8)
s_barrier
s_mov_b64 s[96:97], s[74:75]
s_add_u32 m0, s29, 32768
s_add_u32 s26, s85, 0
buffer_load_dwordx4 v36, s[96:99], s26 offen offset:0 lds
buffer_load_dwordx4 v37, s[96:99], s26 offen offset:1024 lds
buffer_load_dwordx4 v38, s[96:99], s26 offen offset:2048 lds
buffer_load_dwordx4 v39, s[96:99], s26 offen offset:3072 lds
ds_read_b64_tr_b16 a[100:101], v40 offset:49152
ds_read_b64_tr_b16 a[102:103], v40 offset:49664
ds_read_b64_tr_b16 a[108:109], v40 offset:49160
ds_read_b64_tr_b16 a[110:111], v40 offset:49672
ds_read_b64_tr_b16 a[132:133], v41 offset:49152
ds_read_b64_tr_b16 a[134:135], v41 offset:49664
ds_read_b64_tr_b16 v[72:73], v41 offset:49160
ds_read_b64_tr_b16 v[74:75], v41 offset:49672
s_waitcnt lgkmcnt(0)
ds_write_b128 v2, v[72:75] offset:5120
s_waitcnt vmcnt(8)
s_barrier
s_add_u32 m0, s29, 49152
s_add_u32 s26, s86, 0
buffer_load_dwordx4 v36, s[96:99], s26 offen offset:0 lds
buffer_load_dwordx4 v37, s[96:99], s26 offen offset:1024 lds
buffer_load_dwordx4 v38, s[96:99], s26 offen offset:2048 lds
buffer_load_dwordx4 v39, s[96:99], s26 offen offset:3072 lds
ds_read_b64_tr_b16 a[136:137], v40 offset:0
ds_read_b64_tr_b16 a[138:139], v40 offset:512
ds_read_b64_tr_b16 a[144:145], v40 offset:8
ds_read_b64_tr_b16 a[146:147], v40 offset:520
ds_read_b64_tr_b16 v[72:73], v41 offset:0
ds_read_b64_tr_b16 v[74:75], v41 offset:512
ds_read_b64_tr_b16 a[152:153], v41 offset:8
ds_read_b64_tr_b16 a[154:155], v41 offset:520
s_waitcnt lgkmcnt(2)
global_store_dwordx4 v0, v[72:75], s[78:79] offset:-4096
s_waitcnt vmcnt(9) lgkmcnt(0)
s_barrier
s_add_u32 m0, s29, 0
s_add_u32 s26, s85, 256
buffer_load_dwordx4 v36, s[96:99], s26 offen offset:0 lds
buffer_load_dwordx4 v37, s[96:99], s26 offen offset:1024 lds
buffer_load_dwordx4 v38, s[96:99], s26 offen offset:2048 lds
buffer_load_dwordx4 v39, s[96:99], s26 offen offset:3072 lds
ds_read_b64_tr_b16 a[140:141], v40 offset:16384
ds_read_b64_tr_b16 a[142:143], v40 offset:16896
ds_read_b64_tr_b16 a[148:149], v40 offset:16392
ds_read_b64_tr_b16 a[150:151], v40 offset:16904
ds_read_b64_tr_b16 v[72:73], v41 offset:16384
ds_read_b64_tr_b16 v[74:75], v41 offset:16896
ds_read_b64_tr_b16 a[156:157], v41 offset:16392
ds_read_b64_tr_b16 a[158:159], v41 offset:16904
s_waitcnt lgkmcnt(2)
global_store_dwordx4 v0, v[72:75], s[78:79] offset:-3072
s_waitcnt vmcnt(10) lgkmcnt(0)
s_barrier
s_add_u32 m0, s29, 16384
s_add_u32 s26, s86, 256
buffer_load_dwordx4 v36, s[96:99], s26 offen offset:0 lds
buffer_load_dwordx4 v37, s[96:99], s26 offen offset:1024 lds
buffer_load_dwordx4 v38, s[96:99], s26 offen offset:2048 lds
buffer_load_dwordx4 v39, s[96:99], s26 offen offset:3072 lds
ds_read_b64_tr_b16 v[72:73], v42 offset:32768
ds_read_b64_tr_b16 v[74:75], v42 offset:33024
ds_read_b64_tr_b16 v[76:77], v42 offset:34816
ds_read_b64_tr_b16 v[78:79], v42 offset:35072
ds_read_b64_tr_b16 v[8:9], v43 offset:32768
ds_read_b64_tr_b16 v[10:11], v43 offset:33024
ds_read_b64_tr_b16 v[12:13], v43 offset:34816
ds_read_b64_tr_b16 v[14:15], v43 offset:35072
s_waitcnt lgkmcnt(6)
global_store_dwordx4 v0, v[72:75], s[78:79] offset:0
s_waitcnt lgkmcnt(4)
global_store_dwordx4 v0, v[76:79], s[78:79] offset:1024
s_waitcnt vmcnt(12) lgkmcnt(0)
s_barrier
s_add_u32 m0, s29, 32768
s_add_u32 s26, s85, 512
buffer_load_dwordx4 v36, s[96:99], s26 offen offset:0 lds
buffer_load_dwordx4 v37, s[96:99], s26 offen offset:1024 lds
buffer_load_dwordx4 v38, s[96:99], s26 offen offset:2048 lds
buffer_load_dwordx4 v39, s[96:99], s26 offen offset:3072 lds
ds_read_b64_tr_b16 v[16:17], v42 offset:49152
ds_read_b64_tr_b16 v[18:19], v42 offset:49408
ds_read_b64_tr_b16 v[20:21], v42 offset:51200
ds_read_b64_tr_b16 v[22:23], v42 offset:51456
ds_read_b64_tr_b16 v[184:185], v43 offset:49152
ds_read_b64_tr_b16 v[186:187], v43 offset:49408
ds_read_b64_tr_b16 v[188:189], v43 offset:51200
ds_read_b64_tr_b16 v[190:191], v43 offset:51456
s_waitcnt vmcnt(11) lgkmcnt(0)
s_barrier
s_add_u32 m0, s29, 49152
s_add_u32 s26, s86, 512
buffer_load_dwordx4 v36, s[96:99], s26 offen offset:0 lds
buffer_load_dwordx4 v37, s[96:99], s26 offen offset:1024 lds
buffer_load_dwordx4 v38, s[96:99], s26 offen offset:2048 lds
buffer_load_dwordx4 v39, s[96:99], s26 offen offset:3072 lds
ds_read_b64_tr_b16 v[72:73], v42 offset:0
ds_read_b64_tr_b16 v[74:75], v42 offset:256
ds_read_b64_tr_b16 v[76:77], v42 offset:2048
ds_read_b64_tr_b16 v[78:79], v42 offset:2304
ds_read_b64_tr_b16 v[192:193], v43 offset:0
ds_read_b64_tr_b16 v[194:195], v43 offset:256
ds_read_b64_tr_b16 v[196:197], v43 offset:2048
ds_read_b64_tr_b16 v[198:199], v43 offset:2304
s_waitcnt lgkmcnt(6)
global_store_dwordx4 v0, v[72:75], s[78:79] offset:2048
s_waitcnt lgkmcnt(4)
global_store_dwordx4 v0, v[76:79], s[78:79] offset:3072
s_waitcnt vmcnt(12) lgkmcnt(0)
s_barrier
s_add_u32 m0, s29, 0
s_add_u32 s26, s85, 768
buffer_load_dwordx4 v36, s[96:99], s26 offen offset:0 lds
buffer_load_dwordx4 v37, s[96:99], s26 offen offset:1024 lds
buffer_load_dwordx4 v38, s[96:99], s26 offen offset:2048 lds
buffer_load_dwordx4 v39, s[96:99], s26 offen offset:3072 lds
ds_read_b64_tr_b16 v[24:25], v42 offset:16384
ds_read_b64_tr_b16 v[26:27], v42 offset:16640
ds_read_b64_tr_b16 v[28:29], v42 offset:18432
ds_read_b64_tr_b16 v[30:31], v42 offset:18688
ds_read_b64_tr_b16 v[200:201], v43 offset:16384
ds_read_b64_tr_b16 v[202:203], v43 offset:16640
ds_read_b64_tr_b16 v[204:205], v43 offset:18432
ds_read_b64_tr_b16 v[206:207], v43 offset:18688
s_waitcnt vmcnt(10) lgkmcnt(0)
s_barrier
s_add_u32 m0, s29, 16384
s_add_u32 s26, s86, 768
buffer_load_dwordx4 v36, s[96:99], s26 offen offset:0 lds
buffer_load_dwordx4 v37, s[96:99], s26 offen offset:1024 lds
buffer_load_dwordx4 v38, s[96:99], s26 offen offset:2048 lds
buffer_load_dwordx4 v39, s[96:99], s26 offen offset:3072 lds
ds_read_b64_tr_b16 v[168:169], v42 offset:32768
ds_read_b64_tr_b16 v[170:171], v42 offset:33024
ds_read_b64_tr_b16 v[172:173], v42 offset:34816
ds_read_b64_tr_b16 v[174:175], v42 offset:35072
ds_read_b64_tr_b16 v[48:49], v43 offset:32768
ds_read_b64_tr_b16 v[50:51], v43 offset:33024
ds_read_b64_tr_b16 v[52:53], v43 offset:34816
ds_read_b64_tr_b16 v[54:55], v43 offset:35072
s_waitcnt vmcnt(10) lgkmcnt(0)
s_barrier
s_add_u32 m0, s29, 32768
s_add_u32 s26, s85, 1024
buffer_load_dwordx4 v36, s[96:99], s26 offen offset:0 lds
buffer_load_dwordx4 v37, s[96:99], s26 offen offset:1024 lds
buffer_load_dwordx4 v38, s[96:99], s26 offen offset:2048 lds
buffer_load_dwordx4 v39, s[96:99], s26 offen offset:3072 lds
ds_read_b64_tr_b16 v[56:57], v42 offset:49152
ds_read_b64_tr_b16 v[58:59], v42 offset:49408
ds_read_b64_tr_b16 v[60:61], v42 offset:51200
ds_read_b64_tr_b16 v[62:63], v42 offset:51456
ds_read_b64_tr_b16 v[208:209], v43 offset:49152
ds_read_b64_tr_b16 v[210:211], v43 offset:49408
ds_read_b64_tr_b16 v[212:213], v43 offset:51200
ds_read_b64_tr_b16 v[214:215], v43 offset:51456
v_lshrrev_b32 v44, 4, v0
v_and_b32 v44, 15, v44
v_lshlrev_b32 v44, 4, v44
buffer_load_dword v45, v44, s[8:11], 0 offen sc1
s_waitcnt vmcnt(9) lgkmcnt(0)
s_barrier
s_add_u32 m0, s29, 49152
s_add_u32 s26, s86, 1024
buffer_load_dwordx4 v36, s[96:99], s26 offen offset:0 lds
buffer_load_dwordx4 v37, s[96:99], s26 offen offset:1024 lds
buffer_load_dwordx4 v38, s[96:99], s26 offen offset:2048 lds
buffer_load_dwordx4 v39, s[96:99], s26 offen offset:3072 lds
ds_read_b64_tr_b16 v[176:177], v42 offset:0
ds_read_b64_tr_b16 v[178:179], v42 offset:256
ds_read_b64_tr_b16 v[180:181], v42 offset:2048
ds_read_b64_tr_b16 v[182:183], v42 offset:2304
ds_read_b64_tr_b16 v[216:217], v43 offset:0
ds_read_b64_tr_b16 v[218:219], v43 offset:256
ds_read_b64_tr_b16 v[220:221], v43 offset:2048
ds_read_b64_tr_b16 v[222:223], v43 offset:2304
s_waitcnt vmcnt(9) lgkmcnt(0)
s_barrier
ds_read_b64_tr_b16 v[64:65], v42 offset:16384
ds_read_b64_tr_b16 v[66:67], v42 offset:16640
ds_read_b64_tr_b16 v[68:69], v42 offset:18432
ds_read_b64_tr_b16 v[70:71], v42 offset:18688
ds_read_b64_tr_b16 v[224:225], v43 offset:16384
ds_read_b64_tr_b16 v[226:227], v43 offset:16640
ds_read_b64_tr_b16 v[228:229], v43 offset:18432
ds_read_b64_tr_b16 v[230:231], v43 offset:18688
s_waitcnt vmcnt(5) lgkmcnt(0)
s_barrier
ds_read_b64_tr_b16 v[72:73], v42 offset:32768
ds_read_b64_tr_b16 v[74:75], v42 offset:33024
ds_read_b64_tr_b16 v[76:77], v42 offset:34816
ds_read_b64_tr_b16 v[78:79], v42 offset:35072
ds_read_b64_tr_b16 v[232:233], v43 offset:32768
ds_read_b64_tr_b16 v[234:235], v43 offset:33024
ds_read_b64_tr_b16 v[236:237], v43 offset:34816
ds_read_b64_tr_b16 v[238:239], v43 offset:35072
s_waitcnt lgkmcnt(6)
global_store_dwordx4 v0, v[72:75], s[80:81] offset:-4096
s_waitcnt lgkmcnt(4)
global_store_dwordx4 v0, v[76:79], s[80:81] offset:-3072
s_waitcnt vmcnt(2) lgkmcnt(0)
s_barrier
ds_read_b64_tr_b16 v[240:241], v42 offset:49152
ds_read_b64_tr_b16 v[242:243], v42 offset:49408
ds_read_b64_tr_b16 v[244:245], v42 offset:51200
ds_read_b64_tr_b16 v[246:247], v42 offset:51456
ds_read_b64_tr_b16 v[248:249], v43 offset:49152
ds_read_b64_tr_b16 v[250:251], v43 offset:49408
ds_read_b64_tr_b16 v[252:253], v43 offset:51200
ds_read_b64_tr_b16 v[254:255], v43 offset:51456
s_waitcnt lgkmcnt(0)
s_barrier
s_mul_i32 s26, s13, 12288
v_add_u32 v47, s26, v0
ds_write_b128 v47, v[8:11] offset:16384
ds_write_b128 v47, v[12:15] offset:17408
ds_write_b128 v47, v[16:19] offset:18432
ds_write_b128 v47, v[20:23] offset:19456
ds_write_b128 v47, v[24:27] offset:20480
ds_write_b128 v47, v[28:31] offset:21504
ds_write_b128 v47, v[48:51] offset:22528
ds_write_b128 v47, v[52:55] offset:23552
ds_write_b128 v47, v[56:59] offset:24576
ds_write_b128 v47, v[60:63] offset:25600
ds_write_b128 v47, v[64:67] offset:26624
ds_write_b128 v47, v[68:71] offset:27648
s_mov_b32 s30, 0
s_branch all_10004
all_10003:
buffer_load_dword v45, v44, s[8:11], 0 offen sc1
s_add_u32 s30, s30, 1
s_cmp_gt_u32 s30, 262144
s_cbranch_scc1 L_fail
all_10004:
s_waitcnt vmcnt(0)
v_add_u32_dpp v46, v45, v45 quad_perm:[1,0,3,2] row_mask:0xf bank_mask:0xf
s_nop 1
v_add_u32_dpp v46, v46, v46 quad_perm:[2,3,0,1] row_mask:0xf bank_mask:0xf
s_nop 1
v_add_u32_dpp v46, v46, v46 row_ror:4 row_mask:0xf bank_mask:0xf
s_nop 1
v_add_u32_dpp v46, v46, v46 row_ror:8 row_mask:0xf bank_mask:0xf
v_cmp_ne_u32 vcc, 306, v46
s_cbranch_vccnz all_10003
s_waitcnt vmcnt(0) lgkmcnt(0)
s_barrier
s_mov_b32 s18, 0
s_mov_b32 s36, 0
s_cmp_eq_u32 s13, 1
s_cbranch_scc1 wave_10006
s_cmp_eq_u32 s13, 2
s_cbranch_scc1 wave_10007
s_cmp_eq_u32 s13, 3
s_cbranch_scc1 wave_10008
wave_10005:
layer_10009:
s_lshl_b32 s17, s36, 6
s_mul_i32 s27, s36, 35651584
s_mul_i32 s28, s14, 16384
s_add_u32 s27, s27, s28
s_add_u32 s20, s27, 16777216
s_mul_i32 s27, s17, 10240
s_add_u32 s27, s27, s24
s_add_u32 s21, s27, s25
s_mov_b32 s19, 0
s_mov_b32 s33, s6
s_add_u32 s34, s17, 1
s_add_u32 s31, s17, 63
s_add_u32 s32, s17, 64
s_mov_b32 s27, s20
v_mov_b32 v7, 0
s_add_u32 s68, s4, 413696
s_addc_u32 s69, s5, 0
s_add_u32 s72, s4, 397312
s_addc_u32 s73, s5, 0
s_add_u32 s70, s4, 417792
s_addc_u32 s71, s5, 0
s_add_u32 s74, s4, 401408
s_addc_u32 s75, s5, 0
s_add_u32 s58, s4, s20
s_addc_u32 s59, s5, 0
global_load_dwordx4 v[64:67], v0, s[76:77] offset:-4096 sc1
global_load_dwordx4 v[68:71], v0, s[76:77] offset:-3072 sc1
global_load_dwordx4 v[72:75], v0, s[76:77] offset:-2048 sc1
global_load_dwordx4 v[76:79], v0, s[76:77] offset:-1024 sc1
global_load_dwordx4 v[80:83], v0, s[76:77] offset:2048 sc1
global_load_dwordx4 v[84:87], v0, s[76:77] offset:3072 sc1
global_load_dwordx4 v[56:59], v0, s[76:77] offset:0 sc1
global_load_dwordx4 v[60:63], v0, s[76:77] offset:1024 sc1
v_mov_b64 v[8:9], 0
v_mov_b64 v[10:11], 0
v_mov_b64 v[12:13], 0
v_mov_b64 v[14:15], 0
v_mov_b64 v[16:17], 0
v_mov_b64 v[18:19], 0
v_mov_b64 v[20:21], 0
v_mov_b64 v[22:23], 0
v_mov_b64 v[24:25], 0
v_mov_b64 v[26:27], 0
v_mov_b64 v[28:29], 0
v_mov_b64 v[30:31], 0
v_cmp_gt_u32 vcc, s34, v7
s_cmp_eq_u32 vcc_hi, 0
s_cbranch_scc1 kv_10020
s_mov_b32 s30, 0
kv_10019:
v_and_b32 v7, 128, v0
buffer_load_dword v7, v7, s[4:7], s22 offen sc1
s_add_u32 s30, s30, 1
s_cmp_gt_u32 s30, 262144
s_cbranch_scc1 L_fail
s_waitcnt vmcnt(0)
v_cmp_gt_u32 vcc, s34, v7
s_cbranch_vccnz kv_10019
kv_10020:
s_barrier
global_load_dwordx4 v[48:51], v0, s[58:59] offset:0 nt sc1
global_load_dwordx4 v[52:55], v0, s[58:59] offset:1024 nt sc1
v_and_b32 v7, 255, v0
v_lshl_add_u32 v7, v7, 3, s27
global_load_dwordx4 v[32:35], v0, s[68:69] offset:-4096 sc1
global_load_dwordx4 v[36:39], v0, s[68:69] offset:0 sc1
global_load_dwordx4 v[40:43], v0, s[70:71] offset:0 sc1
s_mov_b32 s30, 0
s_waitcnt vmcnt(0)
.p2align 6
gather_10010:
s_waitcnt vmcnt(4)
rt_10015_b:
v_smfmac_f32_16x16x64_bf16 v[24:27], v[32:35], a[0:7], v1
ds_write_b128 v0, v[32:35] offset:0
v_smfmac_f32_16x16x64_bf16 v[8:11], v[32:35], v[64:71], v1
v_bitop3_b32 v44, v32, v34, s18 bitop3:0x7e
v_smfmac_f32_16x16x64_bf16 v[12:15], v[32:35], v[72:79], v1
s_waitcnt vmcnt(3)
ds_write_b128 v0, v[36:39] offset:4096
v_bitop3_b32 v45, v36, v38, s18 bitop3:0x7e
v_or_b32 v44, v44, v45
s_waitcnt vmcnt(2)
v_bitop3_b32 v45, v40, v42, s18 bitop3:0x7e
v_bitop3_b32 v44, v44, v45, s19 bitop3:0xa8
v_cmp_ne_u32 vcc, 0, v44
v_smfmac_f32_16x16x64_bf16 v[8:11], v[36:39], a[16:23], v1
ds_write_b128 v0, v[40:43] offset:8192
v_smfmac_f32_16x16x64_bf16 v[20:23], v[32:35], v[80:87], v1
s_cbranch_vccnz rt_10015
global_load_dwordx4 v[64:67], v0, s[78:79] offset:-4096 sc1
ds_read_b128 v[80:83], v2 offset:0
v_smfmac_f32_16x16x64_bf16 v[28:31], v[32:35], a[8:15], v1
global_load_dwordx4 v[68:71], v0, s[78:79] offset:-3072 sc1
ds_read_b128 v[84:87], v2 offset:1024
v_smfmac_f32_16x16x64_bf16 v[20:23], v[36:39], a[40:47], v1
s_waitcnt lgkmcnt(2)
global_load_dwordx4 v[72:75], v0, s[78:79] offset:-2048 sc1
global_load_dwordx4 v[76:79], v0, s[78:79] offset:-1024 sc1
v_smfmac_f32_16x16x64_bf16 v[16:19], v[32:35], v[56:63], v1
s_barrier
ds_read_b128 v[40:43], v0 offset:1024
v_smfmac_f32_16x16x64_bf16 v[16:19], v[36:39], a[32:39], v1
s_xor_b32 s18, s18, 1
s_waitcnt lgkmcnt(1)
ds_read_b128 v[44:47], v0 offset:5120
v_smfmac_f32_16x16x64_bf16 v[28:31], v[36:39], v[80:87], v1
ds_read_b128 v[80:83], v2 offset:2048
v_smfmac_f32_16x16x64_bf16 v[24:27], v[36:39], a[48:55], v1
s_mov_b64 s[68:69], s[72:73]
ds_read_b128 v[32:35], v0 offset:2048
v_smfmac_f32_16x16x64_bf16 v[12:15], v[36:39], a[24:31], v1
ds_read_b128 v[84:87], v2 offset:3072
s_waitcnt lgkmcnt(4)
v_smfmac_f32_16x16x64_bf16 v[8:11], v[40:43], a[56:63], v1
ds_read_b128 v[36:39], v0 offset:6144
v_smfmac_f32_16x16x64_bf16 v[12:15], v[40:43], a[64:71], v1
s_add_u32 s20, s20, 524288
s_waitcnt lgkmcnt(4)
ds_read_b128 v[40:43], v0 offset:3072
v_smfmac_f32_16x16x64_bf16 v[12:15], v[44:47], a[80:87], v1
s_add_u32 s17, s17, 1
global_load_dwordx4 v[56:59], v0, s[58:59] offset:2048 nt sc1
v_smfmac_f32_16x16x64_bf16 v[8:11], v[44:47], a[72:79], v1
s_waitcnt lgkmcnt(3)
ds_read_b128 v[44:47], v0 offset:7168
s_waitcnt lgkmcnt(3)
v_smfmac_f32_16x16x64_bf16 v[12:15], v[32:35], v[80:87], v1
s_add_u32 s21, s21, 10240
ds_read_b128 v[80:83], v2 offset:4096
v_smfmac_f32_16x16x64_bf16 v[8:11], v[32:35], a[88:95], v1
s_waitcnt lgkmcnt(3)
ds_read_b128 v[84:87], v2 offset:5120
s_waitcnt lgkmcnt(3)
v_smfmac_f32_16x16x64_bf16 v[12:15], v[36:39], a[104:111], v1
ds_read_b128 v[32:35], v0 offset:8192
v_smfmac_f32_16x16x64_bf16 v[8:11], v[36:39], a[96:103], v1
ds_read_b128 v[36:39], v0 offset:9216
v_smfmac_f32_16x16x64_bf16 v[8:11], v[40:43], a[112:119], v1
s_waitcnt lgkmcnt(4)
global_load_dwordx4 v[60:63], v0, s[58:59] offset:3072 nt sc1
v_smfmac_f32_16x16x64_bf16 v[12:15], v[40:43], a[120:127], v1
s_waitcnt lgkmcnt(2)
ds_read_b128 v[40:43], v0 offset:1024
v_smfmac_f32_16x16x64_bf16 v[12:15], v[44:47], v[80:87], v1
s_waitcnt lgkmcnt(2)
ds_read_b128 v[84:87], v2 offset:7168
v_smfmac_f32_16x16x64_bf16 v[8:11], v[44:47], a[128:135], v1
s_waitcnt vmcnt(5)
s_waitcnt lgkmcnt(2)
ds_read_b128 v[80:83], v2 offset:6144
v_smfmac_f32_16x16x64_bf16 v[12:15], v[32:35], a[144:151], v1
global_load_dword v7, v7, s[4:5] sc1
v_smfmac_f32_16x16x64_bf16 v[8:11], v[32:35], a[136:143], v1
ds_read_b128 v[32:35], v0 offset:5120
s_waitcnt vmcnt(5)
v_smfmac_f32_16x16x64_bf16 v[8:11], v[36:39], v[64:71], v1
s_nop 0
ds_read_b128 v[68:71], v2 offset:9216
s_waitcnt lgkmcnt(3)
v_smfmac_f32_16x16x64_bf16 v[12:15], v[36:39], a[152:159], v1
s_nop 0
ds_read_b128 v[64:67], v2 offset:8192
s_waitcnt lgkmcnt(3)
ds_read_b128 v[36:39], v0 offset:2048
v_add_f32 v8, v8, v10
v_smfmac_f32_16x16x64_bf16 v[20:23], v[40:43], v[80:87], v1
ds_read_b128 v[84:87], v2 offset:11264
v_mul_f32 v8, s35, v8
v_smfmac_f32_16x16x64_bf16 v[16:19], v[40:43], a[160:167], v1
s_waitcnt lgkmcnt(4)
ds_read_b128 v[40:43], v0 offset:6144
v_add_f32 v9, v9, v11
v_smfmac_f32_16x16x64_bf16 v[20:23], v[32:35], a[176:183], v1
ds_read_b128 v[80:83], v2 offset:10240
v_mul_f32 v9, s35, v9
v_add_f32 v13, v13, v15
v_cvt_pk_bf16_f32 v8, v8, v9
v_add_f32 v12, v12, v14
v_smfmac_f32_16x16x64_bf16 v[16:19], v[32:35], a[168:175], v1
s_waitcnt lgkmcnt(3)
ds_read_b128 v[32:35], v0 offset:3072
v_mul_f32 v13, s35, v13
v_smfmac_f32_16x16x64_bf16 v[16:19], v[36:39], v[64:71], v1
s_waitcnt vmcnt(3)
ds_read_b128 v[68:71], v2 offset:13312
v_mul_f32 v12, s35, v12
v_smfmac_f32_16x16x64_bf16 v[20:23], v[36:39], a[184:191], v1
s_waitcnt lgkmcnt(3)
ds_read_b128 v[36:39], v0 offset:7168
ds_read_b128 v[64:67], v2 offset:12288
v_cvt_pk_bf16_f32 v12, v12, v13
v_smfmac_f32_16x16x64_bf16 v[16:19], v[40:43], v[72:79], v1
s_waitcnt lgkmcnt(4)
ds_write2_b32 v3, v8, v12 offset0:0 offset1:128
v_smfmac_f32_16x16x64_bf16 v[20:23], v[40:43], v[80:87], v1
s_add_u32 s34, s17, 2
s_waitcnt lgkmcnt(4)
ds_read_b128 v[72:75], v2 offset:14336
v_smfmac_f32_16x16x64_bf16 v[20:23], v[32:35], a[200:207], v1
ds_read_b128 v[80:83], v2 offset:16384
v_smfmac_f32_16x16x64_bf16 v[16:19], v[32:35], a[192:199], v1
s_waitcnt lgkmcnt(4)
ds_read_b128 v[40:43], v0 offset:8192
s_mov_b64 vcc, s[42:43]
ds_read_b128 v[76:79], v2 offset:15360
v_smfmac_f32_16x16x64_bf16 v[20:23], v[36:39], a[208:215], v1
ds_read_b128 v[84:87], v2 offset:17408
s_waitcnt lgkmcnt(5)
s_barrier
ds_read_b128 v[32:35], v0 offset:9216
v_smfmac_f32_16x16x64_bf16 v[16:19], v[36:39], v[64:71], v1
ds_read_b64_tr_b16 v[10:11], v4 offset:512
s_mov_b64 s[70:71], s[74:75]
ds_read_b64_tr_b16 v[8:9], v4 offset:0
s_waitcnt lgkmcnt(6)
s_waitcnt lgkmcnt(5)
ds_read_b64_tr_b16 v[12:13], v4 offset:1024
v_smfmac_f32_16x16x64_bf16 v[20:23], v[40:43], a[216:223], v1
ds_read_b64_tr_b16 v[14:15], v4 offset:1536
s_waitcnt lgkmcnt(6)
ds_read_b128 v[68:71], v2 offset:19456
v_smfmac_f32_16x16x64_bf16 v[16:19], v[40:43], v[72:79], v1
s_waitcnt lgkmcnt(6)
ds_read_b128 v[36:39], v0 offset:8192
s_waitcnt lgkmcnt(6)
v_smfmac_f32_16x16x64_bf16 v[20:23], v[32:35], v[80:87], v1
ds_read_b128 v[64:67], v2 offset:18432
ds_read_b128 v[40:43], v0 offset:9216
v_smfmac_f32_16x16x64_bf16 v[16:19], v[32:35], a[224:231], v1
s_waitcnt lgkmcnt(6)
ds_read_b128 v[72:75], v2 offset:20480
ds_read_b128 v[32:35], v0 offset:1024
v_mfma_f32_16x16x32_bf16 v[44:47], v[48:51], v[8:11], 0
s_waitcnt lgkmcnt(6)
ds_read_b128 v[76:79], v2 offset:21504
v_add_f32 v21, v21, v23
v_add_f32 v20, v20, v22
v_bfe_u32 v48, v0, 5, 1
v_mfma_f32_16x16x32_bf16 v[44:47], v[52:55], v[12:15], v[44:47]
s_waitcnt lgkmcnt(5)
ds_read_b128 v[80:83], v2 offset:22528
v_add_f32 v17, v17, v19
v_add_f32 v16, v16, v18
v_cvt_pk_bf16_f32 v20, v20, v21
v_lshl_add_u32 v48, v48, 3, v5
v_cvt_pk_bf16_f32 v16, v16, v17
v_smfmac_f32_16x16x64_bf16 v[28:31], v[36:39], a[232:239], v1
s_waitcnt lgkmcnt(4)
ds_write2_b32 v3, v16, v20 offset0:1 offset1:129
v_cndmask_b32_dpp v44, v46, v44, vcc quad_perm:[0,1,0,1] row_mask:0xf bank_mask:0xf
v_cndmask_b32_dpp v45, v47, v45, vcc quad_perm:[0,1,0,1] row_mask:0xf bank_mask:0xf
v_smfmac_f32_16x16x64_bf16 v[24:27], v[36:39], v[64:71], v1
s_waitcnt lgkmcnt(3)
ds_write_b64 v48, v[44:45] offset:6144
v_smfmac_f32_16x16x64_bf16 v[24:27], v[40:43], a[240:247], v1
s_waitcnt lgkmcnt(3)
global_load_dwordx4 v[64:67], v0, s[78:79] offset:0 sc1
ds_read_b128 v[36:39], v0 offset:5120
v_smfmac_f32_16x16x64_bf16 v[28:31], v[40:43], v[72:79], v1
s_waitcnt lgkmcnt(3)
global_load_dwordx4 v[68:71], v0, s[78:79] offset:1024 sc1
ds_read_b128 v[84:87], v2 offset:23552
v_smfmac_f32_16x16x64_bf16 v[24:27], v[32:35], a[248:255], v1
global_load_dwordx4 v[72:75], v0, s[78:79] offset:2048 sc1
ds_read_b128 v[40:43], v0 offset:2048
v_smfmac_f32_16x16x64_bf16 v[28:31], v[32:35], v[88:95], v1
s_waitcnt lgkmcnt(3)
ds_read_b128 v[32:35], v0 offset:6144
s_barrier
ds_read_b128 v[52:55], v6 offset:7168
s_waitcnt lgkmcnt(4)
v_smfmac_f32_16x16x64_bf16 v[28:31], v[36:39], v[96:103], v1
s_waitcnt lgkmcnt(3)
ds_read_b128 v[48:51], v6 offset:6144
ds_read_b64_tr_b16 v[8:9], v4 offset:0
v_smfmac_f32_16x16x64_bf16 v[24:27], v[36:39], v[80:87], v1
s_waitcnt lgkmcnt(4)
ds_read_b128 v[36:39], v0 offset:3072
global_load_dwordx4 v[76:79], v0, s[78:79] offset:3072 sc1
ds_read_b64_tr_b16 v[10:11], v4 offset:512
v_smfmac_f32_16x16x64_bf16 v[28:31], v[40:43], v[112:119], v1
s_waitcnt lgkmcnt(5)
ds_read_b64_tr_b16 v[14:15], v4 offset:1536
ds_read_b64_tr_b16 v[18:19], v4 offset:2560
v_smfmac_f32_16x16x64_bf16 v[24:27], v[40:43], v[104:111], v1
s_waitcnt lgkmcnt(6)
ds_read_b64_tr_b16 v[12:13], v4 offset:1024
ds_read_b64_tr_b16 v[16:17], v4 offset:2048
v_smfmac_f32_16x16x64_bf16 v[28:31], v[32:35], v[128:135], v1
s_waitcnt lgkmcnt(7)
ds_read_b64_tr_b16 v[22:23], v4 offset:3584
v_add_f32 v50, v50, v54
v_add_f32 v49, v49, v53
v_smfmac_f32_16x16x64_bf16 v[24:27], v[32:35], v[120:127], v1
s_waitcnt lgkmcnt(6)
ds_read_b128 v[40:43], v0 offset:7168
v_add_f32 v48, v48, v52
v_smfmac_f32_16x16x64_bf16 v[24:27], v[36:39], v[136:143], v1
s_waitcnt lgkmcnt(5)
ds_read_b64_tr_b16 v[20:21], v4 offset:3072
v_add_f32 v51, v51, v55
v_smfmac_f32_16x16x64_bf16 v[28:31], v[36:39], v[144:151], v1
s_waitcnt lgkmcnt(4)
global_load_dwordx4 v[80:83], v0, s[80:81] offset:-4096 sc1
v_exp_f32 v51, v51
v_mfma_f32_16x16x32_bf16 v[44:47], v[8:11], v[8:11], 0
s_waitcnt lgkmcnt(3)
v_exp_f32 v49, v49
v_mfma_f32_16x16x32_bf16 v[44:47], v[12:15], v[12:15], v[44:47]
s_waitcnt lgkmcnt(1)
v_exp_f32 v50, v50
v_exp_f32 v48, v48
v_mfma_f32_16x16x32_bf16 v[44:47], v[16:19], v[16:19], v[44:47]
s_waitcnt lgkmcnt(0)
v_cvt_pk_bf16_f32 v55, v50, v51
v_cvt_pk_bf16_f32 v54, v48, v49
v_mfma_f32_16x16x32_bf16 v[44:47], v[20:23], v[20:23], v[44:47]
v_mov_b64 v[22:23], s[44:45]
v_mov_b32_dpp v50, v54 quad_perm:[2,3,2,3] row_mask:0xf bank_mask:0xf
v_mov_b32_dpp v49, v55 quad_perm:[0,1,0,1] row_mask:0xf bank_mask:0xf
v_mov_b32_dpp v51, v55 quad_perm:[2,3,2,3] row_mask:0xf bank_mask:0xf
v_smfmac_f32_16x16x64_bf16 v[24:27], v[40:43], v[152:159], v1
v_mov_b32_dpp v48, v54 quad_perm:[0,1,0,1] row_mask:0xf bank_mask:0xf
v_mov_b64 v[20:21], s[44:45]
v_smfmac_f32_16x16x64_bf16 v[28:31], v[40:43], v[160:167], v1
s_waitcnt vmcnt(7)
global_load_dwordx4 v[84:87], v0, s[80:81] offset:-3072 sc1
v_exp_f32_dpp v44, v46 quad_perm:[0,1,0,1] row_mask:0xf bank_mask:0xf
v_mfma_f32_16x16x32_bf16 v[8:11], v[56:59], v[48:51], 0
v_exp_f32_dpp v45, v47 quad_perm:[0,1,0,1] row_mask:0xf bank_mask:0xf
v_mfma_f32_16x16x32_bf16 v[16:19], v[20:23], v[48:51], 0
s_waitcnt vmcnt(7)
v_cvt_pk_bf16_f32 v53, v44, v45
v_mov_b64 v[54:55], s[46:47]
v_mfma_f32_16x16x32_bf16 v[12:15], v[60:63], v[48:51], 0
v_cvt_pk_bf16_f32 v52, v44, v45
v_cvt_pk_bf16_f32 v24, v24, v25
v_cvt_pk_bf16_f32 v25, v26, v27
v_mfma_f32_16x16x16_bf16 v[16:19], v[54:55], v[52:53], v[16:19]
s_min_u32 s34, s34, s32
v_cvt_pk_bf16_f32 v26, v28, v29
v_cvt_pk_bf16_f32 v27, v30, v31
v_mfma_f32_16x16x16_bf16 v[8:11], v[24:25], v[52:53], v[8:11]
ds_read_b128 v[28:31], v0 offset:19456
v_mov_b64 v[42:43], 0
v_mfma_f32_16x16x16_bf16 v[12:15], v[26:27], v[52:53], v[12:15]
s_waitcnt vmcnt(4)
v_bfe_u32 v32, v0, 5, 1
v_mov_b64 v[36:37], 0
v_subrev_u32 v17, s37, v16
v_rcp_f32 v18, v16
v_lshl_add_u32 v32, v32, 3, v5
v_mov_b64 v[38:39], 0
v_cmp_lt_u32 vcc, s38, v17
v_cndmask_b32 v9, v13, v9, s[42:43]
v_cndmask_b32 v8, v12, v8, s[42:43]
v_cndmask_b32 v10, v14, v10, s[42:43]
v_mul_f32 v10, v10, v18
v_cndmask_b32 v11, v15, v11, s[42:43]
v_mul_f32 v9, v9, v18
v_mul_f32 v8, v8, v18
v_mul_f32 v11, v11, v18
v_cvt_pk_bf16_f32 v12, v8, v9
v_cvt_pk_bf16_f32 v13, v10, v11
s_cbranch_vccnz rare_10011
back_10012:
ds_write_b64 v32, v[12:13] offset:0
v_mov_b32_dpp v9, v13 quad_perm:[0,1,0,1] row_mask:0xf bank_mask:0xf
v_mov_b32_dpp v10, v12 quad_perm:[2,3,2,3] row_mask:0xf bank_mask:0xf
v_mov_b32_dpp v8, v12 quad_perm:[0,1,0,1] row_mask:0xf bank_mask:0xf
v_mov_b32_dpp v11, v13 quad_perm:[2,3,2,3] row_mask:0xf bank_mask:0xf
v_mov_b64 v[54:55], 0
v_mov_b64 v[52:53], 0
v_smfmac_f32_16x16x64_bf16 v[36:39], v[8:11], v[64:71], v1
s_waitcnt vmcnt(2)
ds_read_b128 v[20:23], v0 offset:17408
global_load_dwordx4 v[64:67], v0, s[76:77] offset:-4096 sc1
ds_read_b128 v[16:19], v0 offset:16384
v_mov_b64 v[34:35], 0
v_mov_b64 v[32:33], 0
v_mov_b64 v[40:41], 0
v_smfmac_f32_16x16x64_bf16 v[52:55], v[8:11], v[176:183], v1
s_waitcnt lgkmcnt(2)
ds_read_b128 v[24:27], v0 offset:18432
s_barrier
ds_read_b128 v[56:59], v5 offset:512
global_load_dwordx4 v[68:71], v0, s[76:77] offset:-3072 sc1
ds_read_b128 v[12:15], v5 offset:1536
v_mov_b64 v[48:49], 0
v_smfmac_f32_16x16x64_bf16 v[40:43], v[8:11], v[72:79], v1
s_waitcnt vmcnt(2)
ds_read_b128 v[60:63], v5 offset:1024
v_mov_b64 v[50:51], 0
v_smfmac_f32_16x16x64_bf16 v[32:35], v[8:11], v[80:87], v1
global_load_dwordx4 v[72:75], v0, s[76:77] offset:-2048 sc1
ds_read_b128 v[80:83], v0 offset:20480
v_smfmac_f32_16x16x64_bf16 v[48:51], v[8:11], v[168:175], v1
s_waitcnt lgkmcnt(5)
s_waitcnt lgkmcnt(3)
ds_read_b128 v[84:87], v0 offset:21504
v_smfmac_f32_16x16x64_bf16 v[40:43], v[56:59], v[192:199], v1
global_load_dwordx4 v[76:79], v0, s[76:77] offset:-1024 sc1
v_smfmac_f32_16x16x64_bf16 v[36:39], v[56:59], v[16:23], v1
s_waitcnt lgkmcnt(2)
ds_read_b128 v[20:23], v0 offset:23552
v_lshrrev_b32 v44, 8, v0
v_smfmac_f32_16x16x64_bf16 v[36:39], v[60:63], v[24:31], v1
ds_read_b128 v[16:19], v0 offset:22528
v_bfe_u32 v45, v0, 1, 7
v_smfmac_f32_16x16x64_bf16 v[36:39], v[12:15], v[184:191], v1
s_waitcnt lgkmcnt(3)
ds_read_b128 v[28:31], v0 offset:25600
s_waitcnt lgkmcnt(3)
v_smfmac_f32_16x16x64_bf16 v[40:43], v[60:63], v[80:87], v1
ds_read_b128 v[24:27], v0 offset:24576
v_lshl_or_b32 v44, v44, 12, v45
v_smfmac_f32_16x16x64_bf16 v[40:43], v[12:15], v[200:207], v1
ds_read_b128 v[80:83], v0 offset:26624
v_cvt_pk_bf16_f32 v36, v36, v37
v_smfmac_f32_16x16x64_bf16 v[32:35], v[56:59], v[232:239], v1
ds_read_b128 v[84:87], v0 offset:27648
v_cvt_pk_bf16_f32 v37, v38, v39
v_and_or_b32 v36, v36, -2, s18
v_smfmac_f32_16x16x64_bf16 v[52:55], v[56:59], v[216:223], v1
global_store_dwordx2 v44, v[36:37], s[48:49]
s_waitcnt lgkmcnt(3)
v_cvt_pk_bf16_f32 v40, v40, v41
v_smfmac_f32_16x16x64_bf16 v[48:51], v[56:59], v[16:23], v1
s_waitcnt lgkmcnt(2)
s_waitcnt lgkmcnt(1)
v_and_or_b32 v40, v40, -2, s18
v_smfmac_f32_16x16x64_bf16 v[48:51], v[60:63], v[24:31], v1
v_cvt_pk_bf16_f32 v41, v42, v43
v_smfmac_f32_16x16x64_bf16 v[48:51], v[12:15], v[208:215], v1
s_waitcnt lgkmcnt(0)
global_store_dwordx2 v44, v[40:41], s[50:51]
v_smfmac_f32_16x16x64_bf16 v[32:35], v[60:63], v[240:247], v1
s_nop 1
v_smfmac_f32_16x16x64_bf16 v[52:55], v[60:63], v[80:87], v1
s_add_u32 s27, s20, 524288
s_add_u32 s58, s4, s20
v_cvt_pk_bf16_f32 v48, v48, v49
v_and_or_b32 v48, v48, -2, s18
v_cvt_pk_bf16_f32 v49, v50, v51
v_smfmac_f32_16x16x64_bf16 v[52:55], v[12:15], v[224:231], v1
s_nop 0
global_store_dwordx2 v44, v[48:49], s[52:53]
s_addc_u32 s59, s5, 0
s_mov_b32 s30, 0
v_smfmac_f32_16x16x64_bf16 v[32:35], v[12:15], v[248:255], v1
s_nop 2
v_cvt_pk_bf16_f32 v52, v52, v53
v_cvt_pk_bf16_f32 v53, v54, v55
s_mov_b32 s19, 1
v_and_or_b32 v52, v52, -2, s18
global_store_dwordx2 v44, v[52:53], s[54:55]
v_cvt_pk_bf16_f32 v32, v32, v33
v_cvt_pk_bf16_f32 v33, v34, v35
v_and_or_b32 v32, v32, -2, s18
global_store_dwordx2 v44, v[32:33], s[56:57]
v_bfe_u32 v32, v0, 6, 1
v_lshlrev_b32 v32, 4, v32
v_mov_b32 v33, 0x3f80
v_lshlrev_b32 v32, v32, v33
v_bfe_i32 v33, v0, 4, 1
v_and_b32 v45, v32, v33
v_and_b32 v47, v32, v33
v_xor_b32 v44, v32, v45
v_xor_b32 v46, v32, v45
v_and_b32 v36, 32, v0
v_bfe_u32 v37, v0, 6, 1
v_lshl_add_u32 v36, v37, 8, v36
v_bfe_u32 v37, v0, 8, 1
v_lshl_add_u32 v36, v37, 4, v36
v_bfe_u32 v37, v0, 4, 1
v_lshl_add_u32 v36, v37, 3, v36
v_and_b32 v7, 255, v0
v_lshl_add_u32 v7, v7, 3, s27
s_nop 15
s_nop 15
s_nop 15
s_nop 8
global_load_dwordx4 v[8:11], v0, s[64:65] offset:0 sc1
global_load_dwordx4 v[12:15], v0, s[64:65] offset:1024 sc1
global_load_dwordx4 v[16:19], v0, s[64:65] offset:2048 sc1
global_load_dwordx4 v[20:23], v0, s[64:65] offset:3072 sc1
chk_10023:
v_mov_b64 v[40:41], 0
v_mov_b64 v[42:43], 0
s_waitcnt vmcnt(2)
s_nop 0
v_smfmac_f32_16x16x64_bf16 v[40:43], v[44:47], v[8:15], v1
v_bitop3_b32 v32, v8, v10, s18 bitop3:0x7e
v_bitop3_b32 v33, v12, v14, s18 bitop3:0x7e
s_waitcnt vmcnt(0)
v_smfmac_f32_16x16x64_bf16 v[40:43], v[44:47], v[16:23], v1
v_bitop3_b32 v34, v16, v18, s18 bitop3:0x7e
v_bitop3_b32 v35, v20, v22, s18 bitop3:0x7e
v_or3_b32 v37, v32, v33, v34
v_bitop3_b32 v37, v37, v35, 1 bitop3:0xa8
v_cmp_ne_u32 vcc, 0, v37
s_cbranch_vccnz chk_10023_f
s_nop 1
v_add_f32_dpp v40, v40, v40 row_ror:8 row_mask:0xf bank_mask:0xf
v_add_f32_dpp v41, v41, v41 row_ror:8 row_mask:0xf bank_mask:0xf
v_add_f32_dpp v42, v42, v42 row_ror:8 row_mask:0xf bank_mask:0xf
v_add_f32_dpp v43, v43, v43 row_ror:8 row_mask:0xf bank_mask:0xf
v_cvt_pk_bf16_f32 v40, v40, v41
v_cvt_pk_bf16_f32 v41, v42, v43
v_and_or_b32 v40, v40, -2, s18
s_mov_b64 exec, 0x00ff00ff
global_store_dwordx2 v36, v[40:41], s[66:67]
s_mov_b64 exec, -1
s_branch join_10022
chk_10023_f:
global_load_dwordx4 v[8:11], v0, s[64:65] offset:0 sc1
global_load_dwordx4 v[12:15], v0, s[64:65] offset:1024 sc1
global_load_dwordx4 v[16:19], v0, s[64:65] offset:2048 sc1
global_load_dwordx4 v[20:23], v0, s[64:65] offset:3072 sc1
s_add_u32 s30, s30, 1
s_cmp_le_u32 s30, 262144
s_cbranch_scc1 chk_10023
s_branch L_fail
nored_10021:
join_10022:
s_nop 11
s_barrier
global_load_dwordx4 v[56:59], v0, s[76:77] offset:0 sc1
global_load_dwordx4 v[60:63], v0, s[76:77] offset:1024 sc1
global_load_dwordx4 v[80:83], v0, s[76:77] offset:2048 sc1
global_load_dwordx4 v[84:87], v0, s[76:77] offset:3072 sc1
s_nop 15
s_nop 15
s_nop 3
s_barrier
global_load_dwordx4 v[32:35], v0, s[68:69] offset:-4096 sc1
s_nop 10
global_load_dwordx4 v[36:39], v0, s[68:69] offset:0 sc1
s_nop 10
global_load_dwordx4 v[40:43], v0, s[70:71] offset:0 sc1
s_barrier
global_load_dwordx4 v[48:51], v0, s[58:59] offset:0 nt sc1
global_load_dwordx4 v[52:55], v0, s[58:59] offset:1024 nt sc1
v_mov_b64 v[8:9], 0
v_mov_b64 v[10:11], 0
v_mov_b64 v[12:13], 0
v_mov_b64 v[14:15], 0
v_mov_b64 v[16:17], 0
v_mov_b64 v[18:19], 0
v_mov_b64 v[20:21], 0
v_mov_b64 v[22:23], 0
v_mov_b64 v[24:25], 0
v_mov_b64 v[26:27], 0
v_mov_b64 v[28:29], 0
v_mov_b64 v[30:31], 0
s_mov_b32 s30, 0
s_cmp_eq_u32 s17, s31
s_cbranch_scc0 gather_10010
s_branch exit_10013
rt_10015:
global_load_dwordx4 v[32:35], v0, s[68:69] offset:-4096 sc1
global_load_dwordx4 v[36:39], v0, s[68:69] offset:0 sc1
global_load_dwordx4 v[40:43], v0, s[70:71] offset:0 sc1
s_add_u32 s30, s30, 1
s_cmp_gt_u32 s30, 262144
s_cbranch_scc1 L_fail
s_mov_b64 exec, 1
global_store_dword v0, v0, s[62:63]
global_store_dword v0, v0, s[62:63]
s_mov_b64 exec, -1
v_mov_b64 v[8:9], 0
v_mov_b64 v[10:11], 0
v_mov_b64 v[12:13], 0
v_mov_b64 v[14:15], 0
v_mov_b64 v[16:17], 0
v_mov_b64 v[18:19], 0
v_mov_b64 v[20:21], 0
v_mov_b64 v[22:23], 0
v_mov_b64 v[24:25], 0
v_mov_b64 v[26:27], 0
v_mov_b64 v[28:29], 0
v_mov_b64 v[30:31], 0
s_branch gather_10010
rare_10011:
ds_read_b128 v[48:51], v6 offset:6144
ds_read_b128 v[52:55], v6 offset:7168
s_waitcnt lgkmcnt(0)
v_add_f32 v48, v48, v52
v_add_f32 v49, v49, v53
v_add_f32 v50, v50, v54
v_add_f32 v51, v51, v55
v_mov_b32_dpp v46, v46 quad_perm:[0,1,0,1] row_mask:0xf bank_mask:0xf
v_mov_b32_dpp v47, v47 quad_perm:[0,1,0,1] row_mask:0xf bank_mask:0xf
v_max3_f32 v19, v48, v49, v50
v_max3_f32 v19, v19, v51, v46
v_max_f32 v19, v19, v47
s_nop 1
v_max_f32_dpp v19, v19, v19 quad_perm:[2,3,0,1] row_mask:0xf bank_mask:0xf
v_mov_b32 v44, v19
s_nop 1
v_permlane32_swap_b32 v19, v44
v_max_f32 v19, v19, v44
v_mov_b32 v44, v19
s_nop 1
v_permlane16_swap_b32 v19, v44
v_max_f32 v19, v19, v44
v_sub_f32 v48, v48, v19
v_sub_f32 v49, v49, v19
v_sub_f32 v50, v50, v19
v_sub_f32 v51, v51, v19
v_sub_f32 v46, v46, v19
v_sub_f32 v47, v47, v19
v_exp_f32 v48, v48
v_exp_f32 v49, v49
v_exp_f32 v50, v50
v_exp_f32 v51, v51
v_cvt_pk_bf16_f32 v54, v48, v49
v_cvt_pk_bf16_f32 v55, v50, v51
s_nop 0
v_mov_b32_dpp v48, v54 quad_perm:[0,1,0,1] row_mask:0xf bank_mask:0xf
v_mov_b32_dpp v49, v55 quad_perm:[0,1,0,1] row_mask:0xf bank_mask:0xf
v_mov_b32_dpp v50, v54 quad_perm:[2,3,2,3] row_mask:0xf bank_mask:0xf
v_mov_b32_dpp v51, v55 quad_perm:[2,3,2,3] row_mask:0xf bank_mask:0xf
v_mov_b64 v[20:21], s[44:45]
v_mov_b64 v[22:23], s[44:45]
v_mfma_f32_16x16x32_bf16 v[8:11], v[56:59], v[48:51], 0
v_mfma_f32_16x16x32_bf16 v[12:15], v[60:63], v[48:51], 0
v_mfma_f32_16x16x32_bf16 v[16:19], v[20:23], v[48:51], 0
v_mov_b64 v[54:55], s[46:47]
v_exp_f32_dpp v44, v46 quad_perm:[0,1,0,1] row_mask:0xf bank_mask:0xf
v_exp_f32_dpp v45, v47 quad_perm:[0,1,0,1] row_mask:0xf bank_mask:0xf
s_nop 0
v_cvt_pk_bf16_f32 v52, v44, v45
v_cvt_pk_bf16_f32 v53, v44, v45
s_nop 1
v_mfma_f32_16x16x16_bf16 v[16:19], v[54:55], v[52:53], v[16:19]
v_mfma_f32_16x16x16_bf16 v[8:11], v[24:25], v[52:53], v[8:11]
v_mfma_f32_16x16x16_bf16 v[12:15], v[26:27], v[52:53], v[12:15]
s_nop 5
v_rcp_f32 v18, v16
s_nop 0
v_cndmask_b32 v8, v12, v8, s[42:43]
v_mul_f32 v8, v8, v18
v_cndmask_b32 v9, v13, v9, s[42:43]
v_mul_f32 v9, v9, v18
v_cndmask_b32 v10, v14, v10, s[42:43]
v_mul_f32 v10, v10, v18
v_cndmask_b32 v11, v15, v11, s[42:43]
v_mul_f32 v11, v11, v18
v_cvt_pk_bf16_f32 v12, v8, v9
v_cvt_pk_bf16_f32 v13, v10, v11
s_branch back_10012
exit_10013:
global_load_dwordx4 v[32:35], v0, s[68:69] offset:-4096 sc1
global_load_dwordx4 v[36:39], v0, s[68:69] offset:0 sc1
global_load_dwordx4 v[40:43], v0, s[70:71] offset:0 sc1
s_add_u32 s30, s30, 1
s_cmp_gt_u32 s30, 262144
s_cbranch_scc1 L_fail
s_waitcnt vmcnt(2)
v_bitop3_b32 v44, v32, v34, s18 bitop3:0x7e
s_waitcnt vmcnt(1)
v_bitop3_b32 v45, v36, v38, s18 bitop3:0x7e
v_or_b32 v44, v44, v45
s_waitcnt vmcnt(0)
v_bitop3_b32 v46, v40, v42, s18 bitop3:0x7e
v_bitop3_b32 v44, v44, v46, s19 bitop3:0xa8
v_cmp_ne_u32 vcc, 0, v44
s_cbranch_vccnz exit_10013
s_add_u32 s36, s36, 1
s_cmp_lt_u32 s36, 2
s_cbranch_scc1 layer_10009
s_endpgm
wave_10006:
layer_10024:
s_lshl_b32 s17, s36, 6
s_mul_i32 s27, s36, 35651584
s_mul_i32 s28, s14, 16384
s_add_u32 s27, s27, s28
s_add_u32 s20, s27, 16781312
s_mul_i32 s27, s17, 10240
s_add_u32 s27, s27, s24
s_add_u32 s21, s27, s25
s_mov_b32 s19, 0
s_mov_b32 s33, s6
s_add_u32 s34, s17, 1
s_add_u32 s31, s17, 63
s_add_u32 s32, s17, 64
s_mov_b32 s27, s20
v_mov_b32 v7, 0
s_add_u32 s68, s4, 414720
s_addc_u32 s69, s5, 0
s_add_u32 s72, s4, 398336
s_addc_u32 s73, s5, 0
s_add_u32 s70, s4, 418816
s_addc_u32 s71, s5, 0
s_add_u32 s74, s4, 402432
s_addc_u32 s75, s5, 0
s_add_u32 s58, s4, s20
s_addc_u32 s59, s5, 0
global_load_dwordx4 v[64:67], v0, s[76:77] offset:-4096 sc1
global_load_dwordx4 v[68:71], v0, s[76:77] offset:-3072 sc1
global_load_dwordx4 v[72:75], v0, s[76:77] offset:-2048 sc1
global_load_dwordx4 v[76:79], v0, s[76:77] offset:-1024 sc1
global_load_dwordx4 v[80:83], v0, s[76:77] offset:2048 sc1
global_load_dwordx4 v[84:87], v0, s[76:77] offset:3072 sc1
global_load_dwordx4 v[56:59], v0, s[76:77] offset:0 sc1
global_load_dwordx4 v[60:63], v0, s[76:77] offset:1024 sc1
v_mov_b64 v[8:9], 0
v_mov_b64 v[10:11], 0
v_mov_b64 v[12:13], 0
v_mov_b64 v[14:15], 0
v_mov_b64 v[16:17], 0
v_mov_b64 v[18:19], 0
v_mov_b64 v[20:21], 0
v_mov_b64 v[22:23], 0
v_mov_b64 v[24:25], 0
v_mov_b64 v[26:27], 0
v_mov_b64 v[28:29], 0
v_mov_b64 v[30:31], 0
s_barrier
global_load_dwordx4 v[48:51], v0, s[58:59] offset:0 nt sc1
global_load_dwordx4 v[52:55], v0, s[58:59] offset:1024 nt sc1
v_and_b32 v7, 255, v0
v_lshl_add_u32 v7, v7, 3, s27
global_load_dwordx4 v[32:35], v0, s[68:69] offset:-4096 sc1
global_load_dwordx4 v[36:39], v0, s[68:69] offset:0 sc1
global_load_dwordx4 v[40:43], v0, s[70:71] offset:0 sc1
s_mov_b32 s30, 0
s_waitcnt vmcnt(0)
.p2align 6
gather_10025:
s_waitcnt vmcnt(4)
rt_10030_b:
v_smfmac_f32_16x16x64_bf16 v[24:27], v[32:35], a[0:7], v1
ds_write_b128 v0, v[32:35] offset:1024
v_smfmac_f32_16x16x64_bf16 v[8:11], v[32:35], v[64:71], v1
v_bitop3_b32 v44, v32, v34, s18 bitop3:0x7e
v_smfmac_f32_16x16x64_bf16 v[12:15], v[32:35], v[72:79], v1
s_waitcnt vmcnt(3)
ds_write_b128 v0, v[36:39] offset:5120
v_bitop3_b32 v45, v36, v38, s18 bitop3:0x7e
v_or_b32 v44, v44, v45
s_waitcnt vmcnt(2)
v_bitop3_b32 v45, v40, v42, s18 bitop3:0x7e
v_bitop3_b32 v44, v44, v45, s19 bitop3:0xa8
v_cmp_ne_u32 vcc, 0, v44
v_smfmac_f32_16x16x64_bf16 v[8:11], v[36:39], a[16:23], v1
ds_write_b128 v0, v[40:43] offset:9216
v_smfmac_f32_16x16x64_bf16 v[20:23], v[32:35], v[80:87], v1
s_cbranch_vccnz rt_10030
global_load_dwordx4 v[64:67], v0, s[78:79] offset:-4096 sc1
ds_read_b128 v[80:83], v2 offset:0
v_smfmac_f32_16x16x64_bf16 v[28:31], v[32:35], a[8:15], v1
global_load_dwordx4 v[68:71], v0, s[78:79] offset:-3072 sc1
ds_read_b128 v[84:87], v2 offset:1024
v_smfmac_f32_16x16x64_bf16 v[20:23], v[36:39], a[40:47], v1
s_waitcnt lgkmcnt(2)
global_load_dwordx4 v[72:75], v0, s[78:79] offset:-2048 sc1
global_load_dwordx4 v[76:79], v0, s[78:79] offset:-1024 sc1
v_smfmac_f32_16x16x64_bf16 v[16:19], v[32:35], v[56:63], v1
s_barrier
ds_read_b128 v[40:43], v0 offset:0
v_smfmac_f32_16x16x64_bf16 v[16:19], v[36:39], a[32:39], v1
s_xor_b32 s18, s18, 1
s_waitcnt lgkmcnt(1)
ds_read_b128 v[44:47], v0 offset:4096
v_smfmac_f32_16x16x64_bf16 v[28:31], v[36:39], v[80:87], v1
ds_read_b128 v[80:83], v2 offset:2048
v_smfmac_f32_16x16x64_bf16 v[24:27], v[36:39], a[48:55], v1
s_mov_b64 s[68:69], s[72:73]
ds_read_b128 v[32:35], v0 offset:3072
v_smfmac_f32_16x16x64_bf16 v[12:15], v[36:39], a[24:31], v1
ds_read_b128 v[84:87], v2 offset:3072
s_waitcnt lgkmcnt(4)
v_smfmac_f32_16x16x64_bf16 v[8:11], v[40:43], a[56:63], v1
ds_read_b128 v[36:39], v0 offset:7168
v_smfmac_f32_16x16x64_bf16 v[12:15], v[40:43], a[64:71], v1
s_add_u32 s20, s20, 524288
s_waitcnt lgkmcnt(4)
ds_read_b128 v[40:43], v0 offset:2048
v_smfmac_f32_16x16x64_bf16 v[12:15], v[44:47], a[80:87], v1
s_add_u32 s17, s17, 1
global_load_dwordx4 v[56:59], v0, s[58:59] offset:2048 nt sc1
v_smfmac_f32_16x16x64_bf16 v[8:11], v[44:47], a[72:79], v1
s_waitcnt lgkmcnt(3)
ds_read_b128 v[44:47], v0 offset:6144
s_waitcnt lgkmcnt(3)
v_smfmac_f32_16x16x64_bf16 v[12:15], v[32:35], v[80:87], v1
s_add_u32 s21, s21, 10240
ds_read_b128 v[80:83], v2 offset:4096
v_smfmac_f32_16x16x64_bf16 v[8:11], v[32:35], a[88:95], v1
s_waitcnt lgkmcnt(3)
ds_read_b128 v[84:87], v2 offset:5120
s_waitcnt lgkmcnt(3)
v_smfmac_f32_16x16x64_bf16 v[12:15], v[36:39], a[104:111], v1
ds_read_b128 v[32:35], v0 offset:9216
v_smfmac_f32_16x16x64_bf16 v[8:11], v[36:39], a[96:103], v1
ds_read_b128 v[36:39], v0 offset:8192
v_smfmac_f32_16x16x64_bf16 v[8:11], v[40:43], a[112:119], v1
s_waitcnt lgkmcnt(4)
global_load_dwordx4 v[60:63], v0, s[58:59] offset:3072 nt sc1
v_smfmac_f32_16x16x64_bf16 v[12:15], v[40:43], a[120:127], v1
s_waitcnt lgkmcnt(2)
ds_read_b128 v[40:43], v0 offset:0
v_smfmac_f32_16x16x64_bf16 v[12:15], v[44:47], v[80:87], v1
s_waitcnt lgkmcnt(2)
ds_read_b128 v[84:87], v2 offset:7168
v_smfmac_f32_16x16x64_bf16 v[8:11], v[44:47], a[128:135], v1
s_waitcnt vmcnt(5)
s_waitcnt lgkmcnt(2)
ds_read_b128 v[80:83], v2 offset:6144
v_smfmac_f32_16x16x64_bf16 v[12:15], v[32:35], a[144:151], v1
global_load_dword v7, v7, s[4:5] sc1
v_smfmac_f32_16x16x64_bf16 v[8:11], v[32:35], a[136:143], v1
ds_read_b128 v[32:35], v0 offset:4096
s_waitcnt vmcnt(5)
v_smfmac_f32_16x16x64_bf16 v[8:11], v[36:39], v[64:71], v1
s_nop 0
ds_read_b128 v[68:71], v2 offset:9216
s_waitcnt lgkmcnt(3)
v_smfmac_f32_16x16x64_bf16 v[12:15], v[36:39], a[152:159], v1
s_nop 0
ds_read_b128 v[64:67], v2 offset:8192
s_waitcnt lgkmcnt(3)
ds_read_b128 v[36:39], v0 offset:3072
v_add_f32 v8, v8, v10
v_smfmac_f32_16x16x64_bf16 v[20:23], v[40:43], v[80:87], v1
ds_read_b128 v[84:87], v2 offset:11264
v_mul_f32 v8, s35, v8
v_smfmac_f32_16x16x64_bf16 v[16:19], v[40:43], a[160:167], v1
s_waitcnt lgkmcnt(4)
ds_read_b128 v[40:43], v0 offset:7168
v_add_f32 v9, v9, v11
v_smfmac_f32_16x16x64_bf16 v[20:23], v[32:35], a[176:183], v1
ds_read_b128 v[80:83], v2 offset:10240
v_mul_f32 v9, s35, v9
v_add_f32 v13, v13, v15
v_cvt_pk_bf16_f32 v8, v8, v9
v_add_f32 v12, v12, v14
v_smfmac_f32_16x16x64_bf16 v[16:19], v[32:35], a[168:175], v1
s_waitcnt lgkmcnt(3)
ds_read_b128 v[32:35], v0 offset:2048
v_mul_f32 v13, s35, v13
v_smfmac_f32_16x16x64_bf16 v[16:19], v[36:39], v[64:71], v1
s_waitcnt vmcnt(3)
ds_read_b128 v[68:71], v2 offset:13312
v_mul_f32 v12, s35, v12
v_smfmac_f32_16x16x64_bf16 v[20:23], v[36:39], a[184:191], v1
s_waitcnt lgkmcnt(3)
ds_read_b128 v[36:39], v0 offset:6144
ds_read_b128 v[64:67], v2 offset:12288
v_cvt_pk_bf16_f32 v12, v12, v13
v_smfmac_f32_16x16x64_bf16 v[16:19], v[40:43], v[72:79], v1
s_waitcnt lgkmcnt(4)
ds_write2_b32 v3, v8, v12 offset0:0 offset1:128
v_smfmac_f32_16x16x64_bf16 v[20:23], v[40:43], v[80:87], v1
s_add_u32 s34, s17, 2
s_waitcnt lgkmcnt(4)
ds_read_b128 v[72:75], v2 offset:14336
v_smfmac_f32_16x16x64_bf16 v[20:23], v[32:35], a[200:207], v1
ds_read_b128 v[80:83], v2 offset:16384
v_smfmac_f32_16x16x64_bf16 v[16:19], v[32:35], a[192:199], v1
s_waitcnt lgkmcnt(4)
ds_read_b128 v[40:43], v0 offset:9216
s_mov_b64 vcc, s[42:43]
ds_read_b128 v[76:79], v2 offset:15360
v_smfmac_f32_16x16x64_bf16 v[20:23], v[36:39], a[208:215], v1
ds_read_b128 v[84:87], v2 offset:17408
s_waitcnt lgkmcnt(5)
s_barrier
ds_read_b128 v[32:35], v0 offset:8192
v_smfmac_f32_16x16x64_bf16 v[16:19], v[36:39], v[64:71], v1
ds_read_b64_tr_b16 v[10:11], v4 offset:512
s_mov_b64 s[70:71], s[74:75]
ds_read_b64_tr_b16 v[8:9], v4 offset:0
s_waitcnt lgkmcnt(6)
s_waitcnt lgkmcnt(5)
ds_read_b64_tr_b16 v[12:13], v4 offset:1024
v_smfmac_f32_16x16x64_bf16 v[20:23], v[40:43], a[216:223], v1
ds_read_b64_tr_b16 v[14:15], v4 offset:1536
s_waitcnt lgkmcnt(6)
ds_read_b128 v[68:71], v2 offset:19456
v_smfmac_f32_16x16x64_bf16 v[16:19], v[40:43], v[72:79], v1
s_waitcnt lgkmcnt(6)
ds_read_b128 v[36:39], v0 offset:9216
s_waitcnt lgkmcnt(6)
v_smfmac_f32_16x16x64_bf16 v[20:23], v[32:35], v[80:87], v1
ds_read_b128 v[64:67], v2 offset:18432
ds_read_b128 v[40:43], v0 offset:8192
v_smfmac_f32_16x16x64_bf16 v[16:19], v[32:35], a[224:231], v1
s_waitcnt lgkmcnt(6)
ds_read_b128 v[72:75], v2 offset:20480
ds_read_b128 v[32:35], v0 offset:0
v_mfma_f32_16x16x32_bf16 v[44:47], v[48:51], v[8:11], 0
s_waitcnt lgkmcnt(6)
ds_read_b128 v[76:79], v2 offset:21504
v_add_f32 v21, v21, v23
v_add_f32 v20, v20, v22
v_bfe_u32 v48, v0, 5, 1
v_mfma_f32_16x16x32_bf16 v[44:47], v[52:55], v[12:15], v[44:47]
s_waitcnt lgkmcnt(5)
ds_read_b128 v[80:83], v2 offset:22528
v_add_f32 v17, v17, v19
v_add_f32 v16, v16, v18
v_cvt_pk_bf16_f32 v20, v20, v21
v_lshl_add_u32 v48, v48, 3, v5
v_cvt_pk_bf16_f32 v16, v16, v17
v_smfmac_f32_16x16x64_bf16 v[28:31], v[36:39], a[232:239], v1
s_waitcnt lgkmcnt(4)
ds_write2_b32 v3, v16, v20 offset0:1 offset1:129
v_xor_b32 v48, 128, v48
v_cndmask_b32_dpp v44, v46, v44, vcc quad_perm:[0,1,0,1] row_mask:0xf bank_mask:0xf
v_cndmask_b32_dpp v45, v47, v45, vcc quad_perm:[0,1,0,1] row_mask:0xf bank_mask:0xf
v_smfmac_f32_16x16x64_bf16 v[24:27], v[36:39], v[64:71], v1
s_waitcnt lgkmcnt(3)
ds_write_b64 v48, v[44:45] offset:6656
v_smfmac_f32_16x16x64_bf16 v[24:27], v[40:43], a[240:247], v1
s_waitcnt lgkmcnt(3)
global_load_dwordx4 v[64:67], v0, s[78:79] offset:0 sc1
ds_read_b128 v[36:39], v0 offset:4096
v_smfmac_f32_16x16x64_bf16 v[28:31], v[40:43], v[72:79], v1
s_waitcnt lgkmcnt(3)
global_load_dwordx4 v[68:71], v0, s[78:79] offset:1024 sc1
ds_read_b128 v[84:87], v2 offset:23552
v_smfmac_f32_16x16x64_bf16 v[24:27], v[32:35], a[248:255], v1
global_load_dwordx4 v[72:75], v0, s[78:79] offset:2048 sc1
ds_read_b128 v[40:43], v0 offset:3072
v_smfmac_f32_16x16x64_bf16 v[28:31], v[32:35], v[88:95], v1
s_waitcnt lgkmcnt(3)
ds_read_b128 v[32:35], v0 offset:7168
s_barrier
ds_read_b128 v[52:55], v6 offset:7168
s_waitcnt lgkmcnt(4)
v_smfmac_f32_16x16x64_bf16 v[28:31], v[36:39], v[96:103], v1
s_waitcnt lgkmcnt(3)
ds_read_b128 v[48:51], v6 offset:6144
ds_read_b64_tr_b16 v[8:9], v4 offset:0
v_smfmac_f32_16x16x64_bf16 v[24:27], v[36:39], v[80:87], v1
s_waitcnt lgkmcnt(4)
ds_read_b128 v[36:39], v0 offset:2048
global_load_dwordx4 v[76:79], v0, s[78:79] offset:3072 sc1
ds_read_b64_tr_b16 v[10:11], v4 offset:512
v_smfmac_f32_16x16x64_bf16 v[28:31], v[40:43], v[112:119], v1
s_waitcnt lgkmcnt(5)
ds_read_b64_tr_b16 v[14:15], v4 offset:1536
ds_read_b64_tr_b16 v[18:19], v4 offset:2560
v_smfmac_f32_16x16x64_bf16 v[24:27], v[40:43], v[104:111], v1
s_waitcnt lgkmcnt(6)
ds_read_b64_tr_b16 v[12:13], v4 offset:1024
ds_read_b64_tr_b16 v[16:17], v4 offset:2048
v_smfmac_f32_16x16x64_bf16 v[28:31], v[32:35], v[128:135], v1
s_waitcnt lgkmcnt(7)
ds_read_b64_tr_b16 v[22:23], v4 offset:3584
v_add_f32 v50, v50, v54
v_add_f32 v49, v49, v53
v_smfmac_f32_16x16x64_bf16 v[24:27], v[32:35], v[120:127], v1
s_waitcnt lgkmcnt(6)
ds_read_b128 v[40:43], v0 offset:6144
v_add_f32 v48, v48, v52
v_smfmac_f32_16x16x64_bf16 v[24:27], v[36:39], v[136:143], v1
s_waitcnt lgkmcnt(5)
ds_read_b64_tr_b16 v[20:21], v4 offset:3072
v_add_f32 v51, v51, v55
v_smfmac_f32_16x16x64_bf16 v[28:31], v[36:39], v[144:151], v1
s_waitcnt lgkmcnt(4)
global_load_dwordx4 v[80:83], v0, s[80:81] offset:-4096 sc1
v_exp_f32 v51, v51
v_mfma_f32_16x16x32_bf16 v[44:47], v[8:11], v[8:11], 0
s_waitcnt lgkmcnt(3)
v_exp_f32 v49, v49
v_mfma_f32_16x16x32_bf16 v[44:47], v[12:15], v[12:15], v[44:47]
s_waitcnt lgkmcnt(1)
v_exp_f32 v50, v50
v_exp_f32 v48, v48
v_mfma_f32_16x16x32_bf16 v[44:47], v[16:19], v[16:19], v[44:47]
s_waitcnt lgkmcnt(0)
v_cvt_pk_bf16_f32 v55, v50, v51
v_cvt_pk_bf16_f32 v54, v48, v49
v_mfma_f32_16x16x32_bf16 v[44:47], v[20:23], v[20:23], v[44:47]
v_mov_b64 v[22:23], s[44:45]
v_mov_b32_dpp v50, v54 quad_perm:[2,3,2,3] row_mask:0xf bank_mask:0xf
v_mov_b32_dpp v49, v55 quad_perm:[0,1,0,1] row_mask:0xf bank_mask:0xf
v_mov_b32_dpp v51, v55 quad_perm:[2,3,2,3] row_mask:0xf bank_mask:0xf
v_smfmac_f32_16x16x64_bf16 v[24:27], v[40:43], v[152:159], v1
v_mov_b32_dpp v48, v54 quad_perm:[0,1,0,1] row_mask:0xf bank_mask:0xf
v_mov_b64 v[20:21], s[44:45]
v_smfmac_f32_16x16x64_bf16 v[28:31], v[40:43], v[160:167], v1
s_waitcnt vmcnt(7)
global_load_dwordx4 v[84:87], v0, s[80:81] offset:-3072 sc1
v_exp_f32_dpp v44, v46 quad_perm:[0,1,0,1] row_mask:0xf bank_mask:0xf
v_mfma_f32_16x16x32_bf16 v[8:11], v[56:59], v[48:51], 0
v_exp_f32_dpp v45, v47 quad_perm:[0,1,0,1] row_mask:0xf bank_mask:0xf
v_mfma_f32_16x16x32_bf16 v[16:19], v[20:23], v[48:51], 0
s_waitcnt vmcnt(7)
v_cvt_pk_bf16_f32 v53, v44, v45
v_mov_b64 v[54:55], s[46:47]
v_mfma_f32_16x16x32_bf16 v[12:15], v[60:63], v[48:51], 0
v_cvt_pk_bf16_f32 v52, v44, v45
v_cvt_pk_bf16_f32 v24, v24, v25
v_cvt_pk_bf16_f32 v25, v26, v27
v_mfma_f32_16x16x16_bf16 v[16:19], v[54:55], v[52:53], v[16:19]
s_min_u32 s34, s34, s32
v_cvt_pk_bf16_f32 v26, v28, v29
v_cvt_pk_bf16_f32 v27, v30, v31
v_mfma_f32_16x16x16_bf16 v[8:11], v[24:25], v[52:53], v[8:11]
ds_read_b128 v[28:31], v0 offset:31744
v_mov_b64 v[42:43], 0
v_mfma_f32_16x16x16_bf16 v[12:15], v[26:27], v[52:53], v[12:15]
s_waitcnt vmcnt(4)
v_bfe_u32 v32, v0, 5, 1
v_mov_b64 v[36:37], 0
v_subrev_u32 v17, s37, v16
v_rcp_f32 v18, v16
v_lshl_add_u32 v32, v32, 3, v5
v_mov_b64 v[38:39], 0
v_cmp_lt_u32 vcc, s38, v17
v_cndmask_b32 v9, v13, v9, s[42:43]
v_cndmask_b32 v8, v12, v8, s[42:43]
v_cndmask_b32 v10, v14, v10, s[42:43]
v_mul_f32 v10, v10, v18
v_cndmask_b32 v11, v15, v11, s[42:43]
v_mul_f32 v9, v9, v18
v_mul_f32 v8, v8, v18
v_mul_f32 v11, v11, v18
v_cvt_pk_bf16_f32 v12, v8, v9
v_cvt_pk_bf16_f32 v13, v10, v11
s_cbranch_vccnz rare_10026
back_10027:
ds_write_b64 v32, v[12:13] offset:512
v_mov_b32_dpp v9, v13 quad_perm:[0,1,0,1] row_mask:0xf bank_mask:0xf
v_mov_b32_dpp v10, v12 quad_perm:[2,3,2,3] row_mask:0xf bank_mask:0xf
v_mov_b32_dpp v8, v12 quad_perm:[0,1,0,1] row_mask:0xf bank_mask:0xf
v_mov_b32_dpp v11, v13 quad_perm:[2,3,2,3] row_mask:0xf bank_mask:0xf
v_mov_b64 v[54:55], 0
v_mov_b64 v[52:53], 0
v_smfmac_f32_16x16x64_bf16 v[36:39], v[8:11], v[64:71], v1
s_waitcnt vmcnt(2)
ds_read_b128 v[20:23], v0 offset:29696
global_load_dwordx4 v[64:67], v0, s[76:77] offset:-4096 sc1
ds_read_b128 v[16:19], v0 offset:28672
v_mov_b64 v[34:35], 0
v_mov_b64 v[32:33], 0
v_mov_b64 v[40:41], 0
v_smfmac_f32_16x16x64_bf16 v[52:55], v[8:11], v[176:183], v1
s_waitcnt lgkmcnt(2)
ds_read_b128 v[24:27], v0 offset:30720
s_barrier
ds_read_b128 v[56:59], v5 offset:0
global_load_dwordx4 v[68:71], v0, s[76:77] offset:-3072 sc1
ds_read_b128 v[12:15], v5 offset:1024
v_mov_b64 v[48:49], 0
v_smfmac_f32_16x16x64_bf16 v[40:43], v[8:11], v[72:79], v1
s_waitcnt vmcnt(2)
ds_read_b128 v[60:63], v5 offset:1536
v_mov_b64 v[50:51], 0
v_smfmac_f32_16x16x64_bf16 v[32:35], v[8:11], v[80:87], v1
global_load_dwordx4 v[72:75], v0, s[76:77] offset:-2048 sc1
ds_read_b128 v[80:83], v0 offset:32768
v_smfmac_f32_16x16x64_bf16 v[48:51], v[8:11], v[168:175], v1
s_waitcnt lgkmcnt(5)
s_waitcnt lgkmcnt(3)
ds_read_b128 v[84:87], v0 offset:33792
v_smfmac_f32_16x16x64_bf16 v[40:43], v[56:59], v[192:199], v1
global_load_dwordx4 v[76:79], v0, s[76:77] offset:-1024 sc1
v_smfmac_f32_16x16x64_bf16 v[36:39], v[56:59], v[16:23], v1
s_waitcnt lgkmcnt(2)
ds_read_b128 v[20:23], v0 offset:35840
v_lshrrev_b32 v44, 8, v0
v_smfmac_f32_16x16x64_bf16 v[36:39], v[60:63], v[24:31], v1
ds_read_b128 v[16:19], v0 offset:34816
v_bfe_u32 v45, v0, 1, 7
v_smfmac_f32_16x16x64_bf16 v[36:39], v[12:15], v[184:191], v1
s_waitcnt lgkmcnt(3)
ds_read_b128 v[28:31], v0 offset:37888
s_waitcnt lgkmcnt(3)
v_smfmac_f32_16x16x64_bf16 v[40:43], v[60:63], v[80:87], v1
ds_read_b128 v[24:27], v0 offset:36864
v_lshl_or_b32 v44, v44, 12, v45
v_smfmac_f32_16x16x64_bf16 v[40:43], v[12:15], v[200:207], v1
ds_read_b128 v[80:83], v0 offset:38912
v_cvt_pk_bf16_f32 v36, v36, v37
v_smfmac_f32_16x16x64_bf16 v[32:35], v[56:59], v[232:239], v1
ds_read_b128 v[84:87], v0 offset:39936
v_cvt_pk_bf16_f32 v37, v38, v39
v_and_or_b32 v36, v36, -2, s18
v_smfmac_f32_16x16x64_bf16 v[52:55], v[56:59], v[216:223], v1
global_store_dwordx2 v44, v[36:37], s[48:49]
s_waitcnt lgkmcnt(3)
v_cvt_pk_bf16_f32 v40, v40, v41
v_smfmac_f32_16x16x64_bf16 v[48:51], v[56:59], v[16:23], v1
s_waitcnt lgkmcnt(2)
s_waitcnt lgkmcnt(1)
v_and_or_b32 v40, v40, -2, s18
v_smfmac_f32_16x16x64_bf16 v[48:51], v[60:63], v[24:31], v1
v_cvt_pk_bf16_f32 v41, v42, v43
v_smfmac_f32_16x16x64_bf16 v[48:51], v[12:15], v[208:215], v1
s_waitcnt lgkmcnt(0)
global_store_dwordx2 v44, v[40:41], s[50:51]
v_smfmac_f32_16x16x64_bf16 v[32:35], v[60:63], v[240:247], v1
s_nop 1
v_smfmac_f32_16x16x64_bf16 v[52:55], v[60:63], v[80:87], v1
s_add_u32 s27, s20, 524288
s_add_u32 s58, s4, s20
v_cvt_pk_bf16_f32 v48, v48, v49
v_and_or_b32 v48, v48, -2, s18
v_cvt_pk_bf16_f32 v49, v50, v51
v_smfmac_f32_16x16x64_bf16 v[52:55], v[12:15], v[224:231], v1
s_nop 0
global_store_dwordx2 v44, v[48:49], s[52:53]
s_addc_u32 s59, s5, 0
s_mov_b32 s30, 0
v_smfmac_f32_16x16x64_bf16 v[32:35], v[12:15], v[248:255], v1
s_nop 2
v_cvt_pk_bf16_f32 v52, v52, v53
v_cvt_pk_bf16_f32 v53, v54, v55
s_mov_b32 s19, 1
v_and_or_b32 v52, v52, -2, s18
global_store_dwordx2 v44, v[52:53], s[54:55]
v_cvt_pk_bf16_f32 v32, v32, v33
v_cvt_pk_bf16_f32 v33, v34, v35
v_and_or_b32 v32, v32, -2, s18
global_store_dwordx2 v44, v[32:33], s[56:57]
v_bfe_u32 v32, v0, 6, 1
v_lshlrev_b32 v32, 4, v32
v_mov_b32 v33, 0x3f80
v_lshlrev_b32 v32, v32, v33
v_bfe_i32 v33, v0, 4, 1
v_and_b32 v45, v32, v33
v_and_b32 v47, v32, v33
v_xor_b32 v44, v32, v45
v_xor_b32 v46, v32, v45
v_and_b32 v36, 32, v0
v_bfe_u32 v37, v0, 6, 1
v_lshl_add_u32 v36, v37, 8, v36
v_bfe_u32 v37, v0, 8, 1
v_lshl_add_u32 v36, v37, 4, v36
v_bfe_u32 v37, v0, 4, 1
v_lshl_add_u32 v36, v37, 3, v36
v_and_b32 v7, 255, v0
v_lshl_add_u32 v7, v7, 3, s27
s_nop 15
s_nop 15
s_nop 15
s_nop 15
global_load_dwordx4 v[8:11], v0, s[64:65] offset:0 sc1
global_load_dwordx4 v[12:15], v0, s[64:65] offset:1024 sc1
global_load_dwordx4 v[16:19], v0, s[64:65] offset:2048 sc1
global_load_dwordx4 v[20:23], v0, s[64:65] offset:3072 sc1
s_nop 15
s_nop 15
s_nop 5
global_load_dwordx4 v[24:27], v0, s[64:65] offset:0 sc1
global_load_dwordx4 v[28:31], v0, s[64:65] offset:1024 sc1
global_load_dwordx4 v[48:51], v0, s[64:65] offset:2048 sc1
global_load_dwordx4 v[52:55], v0, s[64:65] offset:3072 sc1
chk_10035:
v_mov_b64 v[40:41], 0
v_mov_b64 v[42:43], 0
s_waitcnt vmcnt(6)
s_nop 0
v_smfmac_f32_16x16x64_bf16 v[40:43], v[44:47], v[8:15], v1
v_bitop3_b32 v32, v8, v10, s18 bitop3:0x7e
v_bitop3_b32 v33, v12, v14, s18 bitop3:0x7e
s_waitcnt vmcnt(4)
v_smfmac_f32_16x16x64_bf16 v[40:43], v[44:47], v[16:23], v1
v_bitop3_b32 v34, v16, v18, s18 bitop3:0x7e
v_bitop3_b32 v35, v20, v22, s18 bitop3:0x7e
v_or3_b32 v37, v32, v33, v34
v_bitop3_b32 v37, v37, v35, 1 bitop3:0xa8
v_cmp_ne_u32 vcc, 0, v37
s_cbranch_vccnz chk_10035_f
s_nop 1
v_add_f32_dpp v40, v40, v40 row_ror:8 row_mask:0xf bank_mask:0xf
v_add_f32_dpp v41, v41, v41 row_ror:8 row_mask:0xf bank_mask:0xf
v_add_f32_dpp v42, v42, v42 row_ror:8 row_mask:0xf bank_mask:0xf
v_add_f32_dpp v43, v43, v43 row_ror:8 row_mask:0xf bank_mask:0xf
v_cvt_pk_bf16_f32 v40, v40, v41
v_cvt_pk_bf16_f32 v41, v42, v43
v_and_or_b32 v40, v40, -2, s18
s_mov_b64 exec, 0x00ff00ff
global_store_dwordx2 v36, v[40:41], s[66:67]
s_mov_b64 exec, -1
s_branch join_10034
chk_10035_f:
global_load_dwordx4 v[8:11], v0, s[64:65] offset:0 sc1
global_load_dwordx4 v[12:15], v0, s[64:65] offset:1024 sc1
global_load_dwordx4 v[16:19], v0, s[64:65] offset:2048 sc1
global_load_dwordx4 v[20:23], v0, s[64:65] offset:3072 sc1
chk_10036:
v_mov_b64 v[40:41], 0
v_mov_b64 v[42:43], 0
s_waitcnt vmcnt(6)
s_nop 0
v_smfmac_f32_16x16x64_bf16 v[40:43], v[44:47], v[24:31], v1
v_bitop3_b32 v32, v24, v26, s18 bitop3:0x7e
v_bitop3_b32 v33, v28, v30, s18 bitop3:0x7e
s_waitcnt vmcnt(4)
v_smfmac_f32_16x16x64_bf16 v[40:43], v[44:47], v[48:55], v1
v_bitop3_b32 v34, v48, v50, s18 bitop3:0x7e
v_bitop3_b32 v35, v52, v54, s18 bitop3:0x7e
v_or3_b32 v37, v32, v33, v34
v_bitop3_b32 v37, v37, v35, 1 bitop3:0xa8
v_cmp_ne_u32 vcc, 0, v37
s_cbranch_vccnz chk_10036_f
s_nop 1
v_add_f32_dpp v40, v40, v40 row_ror:8 row_mask:0xf bank_mask:0xf
v_add_f32_dpp v41, v41, v41 row_ror:8 row_mask:0xf bank_mask:0xf
v_add_f32_dpp v42, v42, v42 row_ror:8 row_mask:0xf bank_mask:0xf
v_add_f32_dpp v43, v43, v43 row_ror:8 row_mask:0xf bank_mask:0xf
v_cvt_pk_bf16_f32 v40, v40, v41
v_cvt_pk_bf16_f32 v41, v42, v43
v_and_or_b32 v40, v40, -2, s18
s_mov_b64 exec, 0x00ff00ff
global_store_dwordx2 v36, v[40:41], s[66:67]
s_mov_b64 exec, -1
s_branch join_10034
chk_10036_f:
global_load_dwordx4 v[24:27], v0, s[64:65] offset:0 sc1
global_load_dwordx4 v[28:31], v0, s[64:65] offset:1024 sc1
global_load_dwordx4 v[48:51], v0, s[64:65] offset:2048 sc1
global_load_dwordx4 v[52:55], v0, s[64:65] offset:3072 sc1
s_add_u32 s30, s30, 1
s_cmp_le_u32 s30, 262144
s_cbranch_scc1 chk_10035
s_branch L_fail
nored_10033:
join_10034:
s_barrier
global_load_dwordx4 v[56:59], v0, s[76:77] offset:0 sc1
global_load_dwordx4 v[60:63], v0, s[76:77] offset:1024 sc1
global_load_dwordx4 v[80:83], v0, s[76:77] offset:2048 sc1
global_load_dwordx4 v[84:87], v0, s[76:77] offset:3072 sc1
s_nop 15
s_nop 15
s_nop 3
s_barrier
global_load_dwordx4 v[32:35], v0, s[68:69] offset:-4096 sc1
s_nop 10
global_load_dwordx4 v[36:39], v0, s[68:69] offset:0 sc1
s_nop 10
global_load_dwordx4 v[40:43], v0, s[70:71] offset:0 sc1
s_barrier
global_load_dwordx4 v[48:51], v0, s[58:59] offset:0 nt sc1
global_load_dwordx4 v[52:55], v0, s[58:59] offset:1024 nt sc1
s_waitcnt vmcnt(13)
v_mov_b64 v[8:9], 0
v_mov_b64 v[10:11], 0
s_waitcnt vmcnt(12)
v_mov_b64 v[12:13], 0
v_mov_b64 v[14:15], 0
s_waitcnt vmcnt(11)
v_mov_b64 v[16:17], 0
v_mov_b64 v[18:19], 0
s_waitcnt vmcnt(10)
v_mov_b64 v[20:21], 0
v_mov_b64 v[22:23], 0
v_mov_b64 v[24:25], 0
v_mov_b64 v[26:27], 0
v_mov_b64 v[28:29], 0
v_mov_b64 v[30:31], 0
s_mov_b32 s30, 0
s_cmp_eq_u32 s17, s31
s_cbranch_scc0 gather_10025
s_branch exit_10028
rt_10030:
global_load_dwordx4 v[32:35], v0, s[68:69] offset:-4096 sc1
global_load_dwordx4 v[36:39], v0, s[68:69] offset:0 sc1
global_load_dwordx4 v[40:43], v0, s[70:71] offset:0 sc1
s_add_u32 s30, s30, 1
s_cmp_gt_u32 s30, 262144
s_cbranch_scc1 L_fail
s_mov_b64 exec, 1
global_store_dword v0, v0, s[62:63]
global_store_dword v0, v0, s[62:63]
s_mov_b64 exec, -1
v_mov_b64 v[8:9], 0
v_mov_b64 v[10:11], 0
v_mov_b64 v[12:13], 0
v_mov_b64 v[14:15], 0
v_mov_b64 v[16:17], 0
v_mov_b64 v[18:19], 0
v_mov_b64 v[20:21], 0
v_mov_b64 v[22:23], 0
v_mov_b64 v[24:25], 0
v_mov_b64 v[26:27], 0
v_mov_b64 v[28:29], 0
v_mov_b64 v[30:31], 0
s_branch gather_10025
rare_10026:
ds_read_b128 v[48:51], v6 offset:6144
ds_read_b128 v[52:55], v6 offset:7168
s_waitcnt lgkmcnt(0)
v_add_f32 v48, v48, v52
v_add_f32 v49, v49, v53
v_add_f32 v50, v50, v54
v_add_f32 v51, v51, v55
v_mov_b32_dpp v46, v46 quad_perm:[0,1,0,1] row_mask:0xf bank_mask:0xf
v_mov_b32_dpp v47, v47 quad_perm:[0,1,0,1] row_mask:0xf bank_mask:0xf
v_max3_f32 v19, v48, v49, v50
v_max3_f32 v19, v19, v51, v46
v_max_f32 v19, v19, v47
s_nop 1
v_max_f32_dpp v19, v19, v19 quad_perm:[2,3,0,1] row_mask:0xf bank_mask:0xf
v_mov_b32 v44, v19
s_nop 1
v_permlane32_swap_b32 v19, v44
v_max_f32 v19, v19, v44
v_mov_b32 v44, v19
s_nop 1
v_permlane16_swap_b32 v19, v44
v_max_f32 v19, v19, v44
v_sub_f32 v48, v48, v19
v_sub_f32 v49, v49, v19
v_sub_f32 v50, v50, v19
v_sub_f32 v51, v51, v19
v_sub_f32 v46, v46, v19
v_sub_f32 v47, v47, v19
v_exp_f32 v48, v48
v_exp_f32 v49, v49
v_exp_f32 v50, v50
v_exp_f32 v51, v51
v_cvt_pk_bf16_f32 v54, v48, v49
v_cvt_pk_bf16_f32 v55, v50, v51
s_nop 0
v_mov_b32_dpp v48, v54 quad_perm:[0,1,0,1] row_mask:0xf bank_mask:0xf
v_mov_b32_dpp v49, v55 quad_perm:[0,1,0,1] row_mask:0xf bank_mask:0xf
v_mov_b32_dpp v50, v54 quad_perm:[2,3,2,3] row_mask:0xf bank_mask:0xf
v_mov_b32_dpp v51, v55 quad_perm:[2,3,2,3] row_mask:0xf bank_mask:0xf
v_mov_b64 v[20:21], s[44:45]
v_mov_b64 v[22:23], s[44:45]
v_mfma_f32_16x16x32_bf16 v[8:11], v[56:59], v[48:51], 0
v_mfma_f32_16x16x32_bf16 v[12:15], v[60:63], v[48:51], 0
v_mfma_f32_16x16x32_bf16 v[16:19], v[20:23], v[48:51], 0
v_mov_b64 v[54:55], s[46:47]
v_exp_f32_dpp v44, v46 quad_perm:[0,1,0,1] row_mask:0xf bank_mask:0xf
v_exp_f32_dpp v45, v47 quad_perm:[0,1,0,1] row_mask:0xf bank_mask:0xf
s_nop 0
v_cvt_pk_bf16_f32 v52, v44, v45
v_cvt_pk_bf16_f32 v53, v44, v45
s_nop 1
v_mfma_f32_16x16x16_bf16 v[16:19], v[54:55], v[52:53], v[16:19]
v_mfma_f32_16x16x16_bf16 v[8:11], v[24:25], v[52:53], v[8:11]
v_mfma_f32_16x16x16_bf16 v[12:15], v[26:27], v[52:53], v[12:15]
s_nop 5
v_rcp_f32 v18, v16
s_nop 0
v_cndmask_b32 v8, v12, v8, s[42:43]
v_mul_f32 v8, v8, v18
v_cndmask_b32 v9, v13, v9, s[42:43]
v_mul_f32 v9, v9, v18
v_cndmask_b32 v10, v14, v10, s[42:43]
v_mul_f32 v10, v10, v18
v_cndmask_b32 v11, v15, v11, s[42:43]
v_mul_f32 v11, v11, v18
v_cvt_pk_bf16_f32 v12, v8, v9
v_cvt_pk_bf16_f32 v13, v10, v11
s_branch back_10027
exit_10028:
global_load_dwordx4 v[32:35], v0, s[68:69] offset:-4096 sc1
global_load_dwordx4 v[36:39], v0, s[68:69] offset:0 sc1
global_load_dwordx4 v[40:43], v0, s[70:71] offset:0 sc1
s_add_u32 s30, s30, 1
s_cmp_gt_u32 s30, 262144
s_cbranch_scc1 L_fail
s_waitcnt vmcnt(2)
v_bitop3_b32 v44, v32, v34, s18 bitop3:0x7e
s_waitcnt vmcnt(1)
v_bitop3_b32 v45, v36, v38, s18 bitop3:0x7e
v_or_b32 v44, v44, v45
s_waitcnt vmcnt(0)
v_bitop3_b32 v46, v40, v42, s18 bitop3:0x7e
v_bitop3_b32 v44, v44, v46, s19 bitop3:0xa8
v_cmp_ne_u32 vcc, 0, v44
s_cbranch_vccnz exit_10028
s_add_u32 s36, s36, 1
s_cmp_lt_u32 s36, 2
s_cbranch_scc1 layer_10024
s_endpgm
wave_10007:
layer_10037:
s_lshl_b32 s17, s36, 6
s_mul_i32 s27, s36, 35651584
s_mul_i32 s28, s14, 16384
s_add_u32 s27, s27, s28
s_add_u32 s20, s27, 16785408
s_mul_i32 s27, s17, 10240
s_add_u32 s27, s27, s24
s_add_u32 s21, s27, s25
s_mov_b32 s19, 0
s_mov_b32 s33, s6
s_add_u32 s34, s17, 1
s_add_u32 s31, s17, 63
s_add_u32 s32, s17, 64
s_mov_b32 s27, s20
v_mov_b32 v7, 0
s_add_u32 s68, s4, 415744
s_addc_u32 s69, s5, 0
s_add_u32 s72, s4, 399360
s_addc_u32 s73, s5, 0
s_add_u32 s70, s4, 419840
s_addc_u32 s71, s5, 0
s_add_u32 s74, s4, 403456
s_addc_u32 s75, s5, 0
s_add_u32 s58, s4, s20
s_addc_u32 s59, s5, 0
global_load_dwordx4 v[64:67], v0, s[76:77] offset:-4096 sc1
global_load_dwordx4 v[68:71], v0, s[76:77] offset:-3072 sc1
global_load_dwordx4 v[72:75], v0, s[76:77] offset:-2048 sc1
global_load_dwordx4 v[76:79], v0, s[76:77] offset:-1024 sc1
global_load_dwordx4 v[80:83], v0, s[76:77] offset:2048 sc1
global_load_dwordx4 v[84:87], v0, s[76:77] offset:3072 sc1
global_load_dwordx4 v[56:59], v0, s[76:77] offset:0 sc1
global_load_dwordx4 v[60:63], v0, s[76:77] offset:1024 sc1
v_mov_b64 v[8:9], 0
v_mov_b64 v[10:11], 0
v_mov_b64 v[12:13], 0
v_mov_b64 v[14:15], 0
v_mov_b64 v[16:17], 0
v_mov_b64 v[18:19], 0
v_mov_b64 v[20:21], 0
v_mov_b64 v[22:23], 0
v_mov_b64 v[24:25], 0
v_mov_b64 v[26:27], 0
v_mov_b64 v[28:29], 0
v_mov_b64 v[30:31], 0
s_barrier
global_load_dwordx4 v[48:51], v0, s[58:59] offset:0 nt sc1
global_load_dwordx4 v[52:55], v0, s[58:59] offset:1024 nt sc1
v_and_b32 v7, 255, v0
v_lshl_add_u32 v7, v7, 3, s27
global_load_dwordx4 v[32:35], v0, s[68:69] offset:-4096 sc1
global_load_dwordx4 v[36:39], v0, s[68:69] offset:0 sc1
v_mov_b32 v45, -1
s_mov_b32 s30, 0
s_waitcnt vmcnt(0)
.p2align 6
gather_10038:
s_waitcnt vmcnt(3)
rt_10043_b:
v_smfmac_f32_16x16x64_bf16 v[24:27], v[32:35], a[0:7], v1
ds_write_b128 v0, v[32:35] offset:2048
v_smfmac_f32_16x16x64_bf16 v[8:11], v[32:35], v[64:71], v1
v_bitop3_b32 v44, v32, v34, s18 bitop3:0x7e
v_smfmac_f32_16x16x64_bf16 v[12:15], v[32:35], v[72:79], v1
s_waitcnt vmcnt(2)
ds_write_b128 v0, v[36:39] offset:6144
v_bitop3_b32 v45, v36, v38, s18 bitop3:0x7e
v_bitop3_b32 v44, v44, v45, s19 bitop3:0xa8
v_cmp_ne_u32 vcc, 0, v44
v_smfmac_f32_16x16x64_bf16 v[8:11], v[36:39], a[16:23], v1
v_smfmac_f32_16x16x64_bf16 v[20:23], v[32:35], v[80:87], v1
s_cbranch_vccnz rt_10043
global_load_dwordx4 v[64:67], v0, s[78:79] offset:-4096 sc1
ds_read_b128 v[80:83], v2 offset:0
v_smfmac_f32_16x16x64_bf16 v[28:31], v[32:35], a[8:15], v1
global_load_dwordx4 v[68:71], v0, s[78:79] offset:-3072 sc1
ds_read_b128 v[84:87], v2 offset:1024
v_smfmac_f32_16x16x64_bf16 v[20:23], v[36:39], a[40:47], v1
global_load_dwordx4 v[72:75], v0, s[78:79] offset:-2048 sc1
global_load_dwordx4 v[76:79], v0, s[78:79] offset:-1024 sc1
v_smfmac_f32_16x16x64_bf16 v[16:19], v[32:35], v[56:63], v1
s_waitcnt lgkmcnt(2)
s_barrier
ds_read_b128 v[40:43], v0 offset:3072
v_smfmac_f32_16x16x64_bf16 v[16:19], v[36:39], a[32:39], v1
s_xor_b32 s18, s18, 1
s_waitcnt lgkmcnt(1)
ds_read_b128 v[44:47], v0 offset:7168
v_smfmac_f32_16x16x64_bf16 v[28:31], v[36:39], v[80:87], v1
ds_read_b128 v[80:83], v2 offset:2048
v_smfmac_f32_16x16x64_bf16 v[24:27], v[36:39], a[48:55], v1
s_mov_b64 s[68:69], s[72:73]
ds_read_b128 v[32:35], v0 offset:0
v_smfmac_f32_16x16x64_bf16 v[12:15], v[36:39], a[24:31], v1
ds_read_b128 v[84:87], v2 offset:3072
s_waitcnt lgkmcnt(4)
v_smfmac_f32_16x16x64_bf16 v[8:11], v[40:43], a[56:63], v1
ds_read_b128 v[36:39], v0 offset:4096
v_smfmac_f32_16x16x64_bf16 v[12:15], v[40:43], a[64:71], v1
s_add_u32 s20, s20, 524288
s_waitcnt lgkmcnt(4)
ds_read_b128 v[40:43], v0 offset:1024
v_smfmac_f32_16x16x64_bf16 v[12:15], v[44:47], a[80:87], v1
s_add_u32 s17, s17, 1
global_load_dwordx4 v[56:59], v0, s[58:59] offset:2048 nt sc1
v_smfmac_f32_16x16x64_bf16 v[8:11], v[44:47], a[72:79], v1
s_waitcnt lgkmcnt(3)
ds_read_b128 v[44:47], v0 offset:5120
s_waitcnt lgkmcnt(3)
v_smfmac_f32_16x16x64_bf16 v[12:15], v[32:35], v[80:87], v1
s_add_u32 s21, s21, 10240
ds_read_b128 v[80:83], v2 offset:4096
v_smfmac_f32_16x16x64_bf16 v[8:11], v[32:35], a[88:95], v1
s_waitcnt lgkmcnt(3)
ds_read_b128 v[84:87], v2 offset:5120
s_waitcnt lgkmcnt(3)
v_smfmac_f32_16x16x64_bf16 v[12:15], v[36:39], a[104:111], v1
ds_read_b128 v[32:35], v0 offset:8192
v_smfmac_f32_16x16x64_bf16 v[8:11], v[36:39], a[96:103], v1
ds_read_b128 v[36:39], v0 offset:9216
v_smfmac_f32_16x16x64_bf16 v[8:11], v[40:43], a[112:119], v1
s_waitcnt lgkmcnt(4)
global_load_dwordx4 v[60:63], v0, s[58:59] offset:3072 nt sc1
v_smfmac_f32_16x16x64_bf16 v[12:15], v[40:43], a[120:127], v1
s_waitcnt lgkmcnt(2)
ds_read_b128 v[40:43], v0 offset:3072
v_smfmac_f32_16x16x64_bf16 v[12:15], v[44:47], v[80:87], v1
s_waitcnt lgkmcnt(2)
ds_read_b128 v[84:87], v2 offset:7168
v_smfmac_f32_16x16x64_bf16 v[8:11], v[44:47], a[128:135], v1
s_waitcnt vmcnt(5)
s_waitcnt lgkmcnt(2)
ds_read_b128 v[80:83], v2 offset:6144
v_smfmac_f32_16x16x64_bf16 v[12:15], v[32:35], a[144:151], v1
global_load_dword v7, v7, s[4:5] sc1
v_smfmac_f32_16x16x64_bf16 v[8:11], v[32:35], a[136:143], v1
ds_read_b128 v[32:35], v0 offset:7168
s_waitcnt vmcnt(5)
v_smfmac_f32_16x16x64_bf16 v[8:11], v[36:39], v[64:71], v1
s_nop 0
ds_read_b128 v[68:71], v2 offset:9216
s_waitcnt lgkmcnt(3)
v_smfmac_f32_16x16x64_bf16 v[12:15], v[36:39], a[152:159], v1
s_nop 0
ds_read_b128 v[64:67], v2 offset:8192
s_waitcnt lgkmcnt(3)
ds_read_b128 v[36:39], v0 offset:0
v_add_f32 v8, v8, v10
v_smfmac_f32_16x16x64_bf16 v[20:23], v[40:43], v[80:87], v1
ds_read_b128 v[84:87], v2 offset:11264
v_mul_f32 v8, s35, v8
v_smfmac_f32_16x16x64_bf16 v[16:19], v[40:43], a[160:167], v1
s_waitcnt lgkmcnt(4)
ds_read_b128 v[40:43], v0 offset:4096
v_add_f32 v9, v9, v11
v_smfmac_f32_16x16x64_bf16 v[20:23], v[32:35], a[176:183], v1
ds_read_b128 v[80:83], v2 offset:10240
v_mul_f32 v9, s35, v9
v_add_f32 v13, v13, v15
v_cvt_pk_bf16_f32 v8, v8, v9
v_add_f32 v12, v12, v14
v_smfmac_f32_16x16x64_bf16 v[16:19], v[32:35], a[168:175], v1
s_waitcnt lgkmcnt(3)
ds_read_b128 v[32:35], v0 offset:1024
v_mul_f32 v13, s35, v13
v_smfmac_f32_16x16x64_bf16 v[16:19], v[36:39], v[64:71], v1
s_waitcnt vmcnt(3)
ds_read_b128 v[68:71], v2 offset:13312
v_mul_f32 v12, s35, v12
v_smfmac_f32_16x16x64_bf16 v[20:23], v[36:39], a[184:191], v1
s_waitcnt lgkmcnt(3)
ds_read_b128 v[36:39], v0 offset:5120
ds_read_b128 v[64:67], v2 offset:12288
v_cvt_pk_bf16_f32 v12, v12, v13
v_smfmac_f32_16x16x64_bf16 v[16:19], v[40:43], v[72:79], v1
s_waitcnt lgkmcnt(4)
ds_write2_b32 v3, v8, v12 offset0:0 offset1:128
v_smfmac_f32_16x16x64_bf16 v[20:23], v[40:43], v[80:87], v1
s_add_u32 s34, s17, 2
s_waitcnt lgkmcnt(4)
ds_read_b128 v[72:75], v2 offset:14336
v_smfmac_f32_16x16x64_bf16 v[20:23], v[32:35], a[200:207], v1
ds_read_b128 v[80:83], v2 offset:16384
v_smfmac_f32_16x16x64_bf16 v[16:19], v[32:35], a[192:199], v1
s_waitcnt lgkmcnt(4)
ds_read_b128 v[40:43], v0 offset:8192
s_mov_b64 vcc, s[42:43]
ds_read_b128 v[76:79], v2 offset:15360
v_smfmac_f32_16x16x64_bf16 v[20:23], v[36:39], a[208:215], v1
ds_read_b128 v[84:87], v2 offset:17408
s_waitcnt lgkmcnt(5)
s_barrier
ds_read_b128 v[32:35], v0 offset:9216
v_smfmac_f32_16x16x64_bf16 v[16:19], v[36:39], v[64:71], v1
ds_read_b64_tr_b16 v[10:11], v4 offset:2560
ds_read_b64_tr_b16 v[8:9], v4 offset:2048
s_waitcnt lgkmcnt(6)
s_waitcnt lgkmcnt(5)
ds_read_b64_tr_b16 v[12:13], v4 offset:3072
v_smfmac_f32_16x16x64_bf16 v[20:23], v[40:43], a[216:223], v1
ds_read_b64_tr_b16 v[14:15], v4 offset:3584
s_waitcnt lgkmcnt(6)
ds_read_b128 v[68:71], v2 offset:19456
v_smfmac_f32_16x16x64_bf16 v[16:19], v[40:43], v[72:79], v1
s_waitcnt lgkmcnt(6)
ds_read_b128 v[36:39], v0 offset:8192
s_waitcnt lgkmcnt(6)
v_smfmac_f32_16x16x64_bf16 v[20:23], v[32:35], v[80:87], v1
ds_read_b128 v[64:67], v2 offset:18432
ds_read_b128 v[40:43], v0 offset:9216
v_smfmac_f32_16x16x64_bf16 v[16:19], v[32:35], a[224:231], v1
s_waitcnt lgkmcnt(6)
ds_read_b128 v[72:75], v2 offset:20480
ds_read_b128 v[32:35], v0 offset:3072
v_mfma_f32_16x16x32_bf16 v[44:47], v[48:51], v[8:11], 0
s_waitcnt lgkmcnt(6)
ds_read_b128 v[76:79], v2 offset:21504
v_add_f32 v21, v21, v23
v_add_f32 v20, v20, v22
v_bfe_u32 v48, v0, 5, 1
v_mfma_f32_16x16x32_bf16 v[44:47], v[52:55], v[12:15], v[44:47]
s_waitcnt lgkmcnt(5)
ds_read_b128 v[80:83], v2 offset:22528
v_add_f32 v17, v17, v19
v_add_f32 v16, v16, v18
v_cvt_pk_bf16_f32 v20, v20, v21
v_lshl_add_u32 v48, v48, 3, v5
v_cvt_pk_bf16_f32 v16, v16, v17
v_smfmac_f32_16x16x64_bf16 v[28:31], v[36:39], a[232:239], v1
s_waitcnt lgkmcnt(4)
ds_write2_b32 v3, v16, v20 offset0:1 offset1:129
v_cndmask_b32_dpp v44, v46, v44, vcc quad_perm:[0,1,0,1] row_mask:0xf bank_mask:0xf
v_cndmask_b32_dpp v45, v47, v45, vcc quad_perm:[0,1,0,1] row_mask:0xf bank_mask:0xf
v_smfmac_f32_16x16x64_bf16 v[24:27], v[36:39], v[64:71], v1
s_waitcnt lgkmcnt(3)
ds_write_b64 v48, v[44:45] offset:7168
v_smfmac_f32_16x16x64_bf16 v[24:27], v[40:43], a[240:247], v1
s_waitcnt lgkmcnt(3)
global_load_dwordx4 v[64:67], v0, s[78:79] offset:0 sc1
ds_read_b128 v[36:39], v0 offset:7168
v_smfmac_f32_16x16x64_bf16 v[28:31], v[40:43], v[72:79], v1
s_waitcnt lgkmcnt(3)
global_load_dwordx4 v[68:71], v0, s[78:79] offset:1024 sc1
ds_read_b128 v[84:87], v2 offset:23552
v_smfmac_f32_16x16x64_bf16 v[24:27], v[32:35], a[248:255], v1
global_load_dwordx4 v[72:75], v0, s[78:79] offset:2048 sc1
ds_read_b128 v[40:43], v0 offset:0
v_smfmac_f32_16x16x64_bf16 v[28:31], v[32:35], v[88:95], v1
s_waitcnt lgkmcnt(3)
ds_read_b128 v[32:35], v0 offset:4096
s_barrier
ds_read_b128 v[52:55], v6 offset:7168
s_waitcnt lgkmcnt(4)
v_smfmac_f32_16x16x64_bf16 v[28:31], v[36:39], v[96:103], v1
s_waitcnt lgkmcnt(3)
ds_read_b128 v[48:51], v6 offset:6144
ds_read_b64_tr_b16 v[8:9], v4 offset:0
v_smfmac_f32_16x16x64_bf16 v[24:27], v[36:39], v[80:87], v1
s_waitcnt lgkmcnt(4)
ds_read_b128 v[36:39], v0 offset:1024
global_load_dwordx4 v[76:79], v0, s[78:79] offset:3072 sc1
ds_read_b64_tr_b16 v[10:11], v4 offset:512
v_smfmac_f32_16x16x64_bf16 v[28:31], v[40:43], v[112:119], v1
s_waitcnt lgkmcnt(5)
ds_read_b64_tr_b16 v[14:15], v4 offset:1536
ds_read_b64_tr_b16 v[18:19], v4 offset:2560
v_smfmac_f32_16x16x64_bf16 v[24:27], v[40:43], v[104:111], v1
s_waitcnt lgkmcnt(6)
ds_read_b64_tr_b16 v[12:13], v4 offset:1024
ds_read_b64_tr_b16 v[16:17], v4 offset:2048
v_smfmac_f32_16x16x64_bf16 v[28:31], v[32:35], v[128:135], v1
s_waitcnt lgkmcnt(7)
ds_read_b64_tr_b16 v[22:23], v4 offset:3584
v_add_f32 v50, v50, v54
v_add_f32 v49, v49, v53
v_smfmac_f32_16x16x64_bf16 v[24:27], v[32:35], v[120:127], v1
s_waitcnt lgkmcnt(6)
ds_read_b128 v[40:43], v0 offset:5120
v_add_f32 v48, v48, v52
v_smfmac_f32_16x16x64_bf16 v[24:27], v[36:39], v[136:143], v1
s_waitcnt lgkmcnt(5)
ds_read_b64_tr_b16 v[20:21], v4 offset:3072
v_add_f32 v51, v51, v55
v_smfmac_f32_16x16x64_bf16 v[28:31], v[36:39], v[144:151], v1
s_waitcnt lgkmcnt(4)
global_load_dwordx4 v[80:83], v0, s[80:81] offset:-4096 sc1
v_exp_f32 v51, v51
v_mfma_f32_16x16x32_bf16 v[44:47], v[8:11], v[8:11], 0
s_waitcnt lgkmcnt(3)
v_exp_f32 v49, v49
v_mfma_f32_16x16x32_bf16 v[44:47], v[12:15], v[12:15], v[44:47]
s_waitcnt lgkmcnt(1)
v_exp_f32 v50, v50
v_exp_f32 v48, v48
v_mfma_f32_16x16x32_bf16 v[44:47], v[16:19], v[16:19], v[44:47]
s_waitcnt lgkmcnt(0)
v_cvt_pk_bf16_f32 v55, v50, v51
v_cvt_pk_bf16_f32 v54, v48, v49
v_mfma_f32_16x16x32_bf16 v[44:47], v[20:23], v[20:23], v[44:47]
v_mov_b64 v[22:23], s[44:45]
v_mov_b32_dpp v50, v54 quad_perm:[2,3,2,3] row_mask:0xf bank_mask:0xf
v_mov_b32_dpp v49, v55 quad_perm:[0,1,0,1] row_mask:0xf bank_mask:0xf
v_mov_b32_dpp v51, v55 quad_perm:[2,3,2,3] row_mask:0xf bank_mask:0xf
v_smfmac_f32_16x16x64_bf16 v[24:27], v[40:43], v[152:159], v1
v_mov_b32_dpp v48, v54 quad_perm:[0,1,0,1] row_mask:0xf bank_mask:0xf
v_mov_b64 v[20:21], s[44:45]
v_smfmac_f32_16x16x64_bf16 v[28:31], v[40:43], v[160:167], v1
s_waitcnt vmcnt(7)
global_load_dwordx4 v[84:87], v0, s[80:81] offset:-3072 sc1
v_exp_f32_dpp v44, v46 quad_perm:[0,1,0,1] row_mask:0xf bank_mask:0xf
v_mfma_f32_16x16x32_bf16 v[8:11], v[56:59], v[48:51], 0
v_exp_f32_dpp v45, v47 quad_perm:[0,1,0,1] row_mask:0xf bank_mask:0xf
v_mfma_f32_16x16x32_bf16 v[16:19], v[20:23], v[48:51], 0
s_waitcnt vmcnt(7)
v_cvt_pk_bf16_f32 v53, v44, v45
v_mov_b64 v[54:55], s[46:47]
v_mfma_f32_16x16x32_bf16 v[12:15], v[60:63], v[48:51], 0
v_cvt_pk_bf16_f32 v52, v44, v45
v_cvt_pk_bf16_f32 v24, v24, v25
v_cvt_pk_bf16_f32 v25, v26, v27
v_mfma_f32_16x16x16_bf16 v[16:19], v[54:55], v[52:53], v[16:19]
s_min_u32 s34, s34, s32
v_cvt_pk_bf16_f32 v26, v28, v29
v_cvt_pk_bf16_f32 v27, v30, v31
v_mfma_f32_16x16x16_bf16 v[8:11], v[24:25], v[52:53], v[8:11]
ds_read_b128 v[28:31], v0 offset:44032
v_mov_b64 v[42:43], 0
v_mfma_f32_16x16x16_bf16 v[12:15], v[26:27], v[52:53], v[12:15]
s_waitcnt vmcnt(4)
v_bfe_u32 v32, v0, 5, 1
v_mov_b64 v[36:37], 0
v_subrev_u32 v17, s37, v16
v_rcp_f32 v18, v16
v_lshl_add_u32 v32, v32, 3, v5
v_mov_b64 v[38:39], 0
v_cmp_lt_u32 vcc, s38, v17
v_cndmask_b32 v9, v13, v9, s[42:43]
v_cndmask_b32 v8, v12, v8, s[42:43]
v_cndmask_b32 v10, v14, v10, s[42:43]
v_mul_f32 v10, v10, v18
v_cndmask_b32 v11, v15, v11, s[42:43]
v_mul_f32 v9, v9, v18
v_mul_f32 v8, v8, v18
v_mul_f32 v11, v11, v18
v_cvt_pk_bf16_f32 v12, v8, v9
v_cvt_pk_bf16_f32 v13, v10, v11
s_cbranch_vccnz rare_10039
back_10040:
ds_write_b64 v32, v[12:13] offset:1024
v_mov_b32_dpp v9, v13 quad_perm:[0,1,0,1] row_mask:0xf bank_mask:0xf
v_mov_b32_dpp v10, v12 quad_perm:[2,3,2,3] row_mask:0xf bank_mask:0xf
v_mov_b32_dpp v8, v12 quad_perm:[0,1,0,1] row_mask:0xf bank_mask:0xf
v_mov_b32_dpp v11, v13 quad_perm:[2,3,2,3] row_mask:0xf bank_mask:0xf
v_mov_b64 v[54:55], 0
v_mov_b64 v[52:53], 0
v_smfmac_f32_16x16x64_bf16 v[36:39], v[8:11], v[64:71], v1
s_waitcnt vmcnt(2)
ds_read_b128 v[20:23], v0 offset:41984
global_load_dwordx4 v[64:67], v0, s[76:77] offset:-4096 sc1
ds_read_b128 v[16:19], v0 offset:40960
v_mov_b64 v[34:35], 0
v_mov_b64 v[32:33], 0
v_mov_b64 v[40:41], 0
v_smfmac_f32_16x16x64_bf16 v[52:55], v[8:11], v[176:183], v1
s_waitcnt lgkmcnt(2)
ds_read_b128 v[24:27], v0 offset:43008
s_barrier
ds_read_b128 v[56:59], v5 offset:1536
global_load_dwordx4 v[68:71], v0, s[76:77] offset:-3072 sc1
ds_read_b128 v[12:15], v5 offset:512
v_mov_b64 v[48:49], 0
v_smfmac_f32_16x16x64_bf16 v[40:43], v[8:11], v[72:79], v1
s_waitcnt vmcnt(2)
ds_read_b128 v[60:63], v5 offset:0
v_mov_b64 v[50:51], 0
v_smfmac_f32_16x16x64_bf16 v[32:35], v[8:11], v[80:87], v1
global_load_dwordx4 v[72:75], v0, s[76:77] offset:-2048 sc1
ds_read_b128 v[80:83], v0 offset:45056
v_smfmac_f32_16x16x64_bf16 v[48:51], v[8:11], v[168:175], v1
s_waitcnt lgkmcnt(5)
s_waitcnt lgkmcnt(3)
ds_read_b128 v[84:87], v0 offset:46080
v_smfmac_f32_16x16x64_bf16 v[40:43], v[56:59], v[192:199], v1
global_load_dwordx4 v[76:79], v0, s[76:77] offset:-1024 sc1
v_smfmac_f32_16x16x64_bf16 v[36:39], v[56:59], v[16:23], v1
s_waitcnt lgkmcnt(2)
ds_read_b128 v[20:23], v0 offset:48128
v_lshrrev_b32 v44, 8, v0
v_smfmac_f32_16x16x64_bf16 v[36:39], v[60:63], v[24:31], v1
ds_read_b128 v[16:19], v0 offset:47104
v_bfe_u32 v45, v0, 1, 7
v_smfmac_f32_16x16x64_bf16 v[36:39], v[12:15], v[184:191], v1
s_waitcnt lgkmcnt(3)
ds_read_b128 v[28:31], v0 offset:50176
s_waitcnt lgkmcnt(3)
v_smfmac_f32_16x16x64_bf16 v[40:43], v[60:63], v[80:87], v1
ds_read_b128 v[24:27], v0 offset:49152
v_lshl_or_b32 v44, v44, 12, v45
v_smfmac_f32_16x16x64_bf16 v[40:43], v[12:15], v[200:207], v1
ds_read_b128 v[80:83], v0 offset:51200
v_cvt_pk_bf16_f32 v36, v36, v37
v_smfmac_f32_16x16x64_bf16 v[32:35], v[56:59], v[232:239], v1
ds_read_b128 v[84:87], v0 offset:52224
v_cvt_pk_bf16_f32 v37, v38, v39
v_and_or_b32 v36, v36, -2, s18
v_smfmac_f32_16x16x64_bf16 v[52:55], v[56:59], v[216:223], v1
global_store_dwordx2 v44, v[36:37], s[48:49]
s_waitcnt lgkmcnt(3)
v_cvt_pk_bf16_f32 v40, v40, v41
v_smfmac_f32_16x16x64_bf16 v[48:51], v[56:59], v[16:23], v1
s_waitcnt lgkmcnt(2)
s_waitcnt lgkmcnt(1)
v_and_or_b32 v40, v40, -2, s18
v_smfmac_f32_16x16x64_bf16 v[48:51], v[60:63], v[24:31], v1
v_cvt_pk_bf16_f32 v41, v42, v43
v_smfmac_f32_16x16x64_bf16 v[48:51], v[12:15], v[208:215], v1
s_waitcnt lgkmcnt(0)
global_store_dwordx2 v44, v[40:41], s[50:51]
v_smfmac_f32_16x16x64_bf16 v[32:35], v[60:63], v[240:247], v1
s_nop 1
v_smfmac_f32_16x16x64_bf16 v[52:55], v[60:63], v[80:87], v1
s_add_u32 s27, s20, 524288
s_add_u32 s58, s4, s20
v_cvt_pk_bf16_f32 v48, v48, v49
v_and_or_b32 v48, v48, -2, s18
v_cvt_pk_bf16_f32 v49, v50, v51
v_smfmac_f32_16x16x64_bf16 v[52:55], v[12:15], v[224:231], v1
s_nop 0
global_store_dwordx2 v44, v[48:49], s[52:53]
s_addc_u32 s59, s5, 0
s_mov_b32 s30, 0
v_smfmac_f32_16x16x64_bf16 v[32:35], v[12:15], v[248:255], v1
s_nop 2
v_cvt_pk_bf16_f32 v52, v52, v53
v_cvt_pk_bf16_f32 v53, v54, v55
s_mov_b32 s19, 1
v_and_or_b32 v52, v52, -2, s18
global_store_dwordx2 v44, v[52:53], s[54:55]
v_cvt_pk_bf16_f32 v32, v32, v33
v_cvt_pk_bf16_f32 v33, v34, v35
v_and_or_b32 v32, v32, -2, s18
global_store_dwordx2 v44, v[32:33], s[56:57]
s_cmp_ge_u32 s14, 16
s_cbranch_scc1 nored_10046
v_bfe_u32 v32, v0, 6, 1
v_lshlrev_b32 v32, 4, v32
v_mov_b32 v33, 0x3f80
v_lshlrev_b32 v32, v32, v33
v_bfe_i32 v33, v0, 4, 1
v_and_b32 v45, v32, v33
v_and_b32 v47, v32, v33
v_xor_b32 v44, v32, v45
v_xor_b32 v46, v32, v45
v_and_b32 v36, 32, v0
v_bfe_u32 v37, v0, 6, 1
v_lshl_add_u32 v36, v37, 8, v36
v_bfe_u32 v37, v0, 8, 1
v_lshl_add_u32 v36, v37, 4, v36
v_bfe_u32 v37, v0, 4, 1
v_lshl_add_u32 v36, v37, 3, v36
v_and_b32 v7, 255, v0
v_lshl_add_u32 v7, v7, 3, s27
s_nop 15
s_nop 15
s_nop 15
s_nop 15
s_nop 12
global_load_dwordx4 v[8:11], v0, s[64:65] offset:0 sc1
global_load_dwordx4 v[12:15], v0, s[64:65] offset:1024 sc1
global_load_dwordx4 v[16:19], v0, s[64:65] offset:2048 sc1
global_load_dwordx4 v[20:23], v0, s[64:65] offset:3072 sc1
s_nop 15
s_nop 15
s_nop 5
global_load_dwordx4 v[24:27], v0, s[64:65] offset:0 sc1
global_load_dwordx4 v[28:31], v0, s[64:65] offset:1024 sc1
global_load_dwordx4 v[48:51], v0, s[64:65] offset:2048 sc1
global_load_dwordx4 v[52:55], v0, s[64:65] offset:3072 sc1
chk_10048:
v_mov_b64 v[40:41], 0
v_mov_b64 v[42:43], 0
s_waitcnt vmcnt(6)
s_nop 0
v_smfmac_f32_16x16x64_bf16 v[40:43], v[44:47], v[8:15], v1
v_bitop3_b32 v32, v8, v10, s18 bitop3:0x7e
v_bitop3_b32 v33, v12, v14, s18 bitop3:0x7e
s_waitcnt vmcnt(4)
v_smfmac_f32_16x16x64_bf16 v[40:43], v[44:47], v[16:23], v1
v_bitop3_b32 v34, v16, v18, s18 bitop3:0x7e
v_bitop3_b32 v35, v20, v22, s18 bitop3:0x7e
v_or3_b32 v37, v32, v33, v34
v_bitop3_b32 v37, v37, v35, 1 bitop3:0xa8
v_cmp_ne_u32 vcc, 0, v37
s_cbranch_vccnz chk_10048_f
s_nop 1
v_add_f32_dpp v40, v40, v40 row_ror:8 row_mask:0xf bank_mask:0xf
v_add_f32_dpp v41, v41, v41 row_ror:8 row_mask:0xf bank_mask:0xf
v_add_f32_dpp v42, v42, v42 row_ror:8 row_mask:0xf bank_mask:0xf
v_add_f32_dpp v43, v43, v43 row_ror:8 row_mask:0xf bank_mask:0xf
v_cvt_pk_bf16_f32 v40, v40, v41
v_cvt_pk_bf16_f32 v41, v42, v43
v_and_or_b32 v40, v40, -2, s18
s_mov_b64 exec, 0x00ff00ff
global_store_dwordx2 v36, v[40:41], s[66:67]
s_mov_b64 exec, -1
s_branch join_10047
chk_10048_f:
global_load_dwordx4 v[8:11], v0, s[64:65] offset:0 sc1
global_load_dwordx4 v[12:15], v0, s[64:65] offset:1024 sc1
global_load_dwordx4 v[16:19], v0, s[64:65] offset:2048 sc1
global_load_dwordx4 v[20:23], v0, s[64:65] offset:3072 sc1
chk_10049:
v_mov_b64 v[40:41], 0
v_mov_b64 v[42:43], 0
s_waitcnt vmcnt(6)
s_nop 0
v_smfmac_f32_16x16x64_bf16 v[40:43], v[44:47], v[24:31], v1
v_bitop3_b32 v32, v24, v26, s18 bitop3:0x7e
v_bitop3_b32 v33, v28, v30, s18 bitop3:0x7e
s_waitcnt vmcnt(4)
v_smfmac_f32_16x16x64_bf16 v[40:43], v[44:47], v[48:55], v1
v_bitop3_b32 v34, v48, v50, s18 bitop3:0x7e
v_bitop3_b32 v35, v52, v54, s18 bitop3:0x7e
v_or3_b32 v37, v32, v33, v34
v_bitop3_b32 v37, v37, v35, 1 bitop3:0xa8
v_cmp_ne_u32 vcc, 0, v37
s_cbranch_vccnz chk_10049_f
s_nop 1
v_add_f32_dpp v40, v40, v40 row_ror:8 row_mask:0xf bank_mask:0xf
v_add_f32_dpp v41, v41, v41 row_ror:8 row_mask:0xf bank_mask:0xf
v_add_f32_dpp v42, v42, v42 row_ror:8 row_mask:0xf bank_mask:0xf
v_add_f32_dpp v43, v43, v43 row_ror:8 row_mask:0xf bank_mask:0xf
v_cvt_pk_bf16_f32 v40, v40, v41
v_cvt_pk_bf16_f32 v41, v42, v43
v_and_or_b32 v40, v40, -2, s18
s_mov_b64 exec, 0x00ff00ff
global_store_dwordx2 v36, v[40:41], s[66:67]
s_mov_b64 exec, -1
s_branch join_10047
chk_10049_f:
global_load_dwordx4 v[24:27], v0, s[64:65] offset:0 sc1
global_load_dwordx4 v[28:31], v0, s[64:65] offset:1024 sc1
global_load_dwordx4 v[48:51], v0, s[64:65] offset:2048 sc1
global_load_dwordx4 v[52:55], v0, s[64:65] offset:3072 sc1
s_add_u32 s30, s30, 1
s_cmp_le_u32 s30, 262144
s_cbranch_scc1 chk_10048
s_branch L_fail
nored_10046:
v_and_b32 v7, 255, v0
v_lshl_add_u32 v7, v7, 3, s27
join_10047:
s_barrier
global_load_dwordx4 v[56:59], v0, s[76:77] offset:0 sc1
global_load_dwordx4 v[60:63], v0, s[76:77] offset:1024 sc1
global_load_dwordx4 v[80:83], v0, s[76:77] offset:2048 sc1
global_load_dwordx4 v[84:87], v0, s[76:77] offset:3072 sc1
s_nop 15
s_nop 15
s_nop 3
s_barrier
global_load_dwordx4 v[32:35], v0, s[68:69] offset:-4096 sc1
s_nop 10
global_load_dwordx4 v[36:39], v0, s[68:69] offset:0 sc1
s_barrier
global_load_dwordx4 v[48:51], v0, s[58:59] offset:0 nt sc1
global_load_dwordx4 v[52:55], v0, s[58:59] offset:1024 nt sc1
s_waitcnt vmcnt(12)
v_mov_b64 v[8:9], 0
v_mov_b64 v[10:11], 0
s_waitcnt vmcnt(11)
v_mov_b64 v[12:13], 0
v_mov_b64 v[14:15], 0
s_waitcnt vmcnt(10)
v_mov_b64 v[16:17], 0
v_mov_b64 v[18:19], 0
s_waitcnt vmcnt(9)
v_mov_b64 v[20:21], 0
v_mov_b64 v[22:23], 0
v_mov_b64 v[24:25], 0
v_mov_b64 v[26:27], 0
v_mov_b64 v[28:29], 0
v_mov_b64 v[30:31], 0
s_mov_b32 s30, 0
s_cmp_eq_u32 s17, s31
s_cbranch_scc0 gather_10038
s_branch exit_10041
rt_10043:
global_load_dwordx4 v[32:35], v0, s[68:69] offset:-4096 sc1
global_load_dwordx4 v[36:39], v0, s[68:69] offset:0 sc1
s_add_u32 s30, s30, 1
s_cmp_gt_u32 s30, 262144
s_cbranch_scc1 L_fail
s_mov_b64 exec, 1
global_store_dword v0, v0, s[62:63]
global_store_dword v0, v0, s[62:63]
s_mov_b64 exec, -1
v_mov_b64 v[8:9], 0
v_mov_b64 v[10:11], 0
v_mov_b64 v[12:13], 0
v_mov_b64 v[14:15], 0
v_mov_b64 v[16:17], 0
v_mov_b64 v[18:19], 0
v_mov_b64 v[20:21], 0
v_mov_b64 v[22:23], 0
v_mov_b64 v[24:25], 0
v_mov_b64 v[26:27], 0
v_mov_b64 v[28:29], 0
v_mov_b64 v[30:31], 0
s_branch gather_10038
rare_10039:
ds_read_b128 v[48:51], v6 offset:6144
ds_read_b128 v[52:55], v6 offset:7168
s_waitcnt lgkmcnt(0)
v_add_f32 v48, v48, v52
v_add_f32 v49, v49, v53
v_add_f32 v50, v50, v54
v_add_f32 v51, v51, v55
v_mov_b32_dpp v46, v46 quad_perm:[0,1,0,1] row_mask:0xf bank_mask:0xf
v_mov_b32_dpp v47, v47 quad_perm:[0,1,0,1] row_mask:0xf bank_mask:0xf
v_max3_f32 v19, v48, v49, v50
v_max3_f32 v19, v19, v51, v46
v_max_f32 v19, v19, v47
s_nop 1
v_max_f32_dpp v19, v19, v19 quad_perm:[2,3,0,1] row_mask:0xf bank_mask:0xf
v_mov_b32 v44, v19
s_nop 1
v_permlane32_swap_b32 v19, v44
v_max_f32 v19, v19, v44
v_mov_b32 v44, v19
s_nop 1
v_permlane16_swap_b32 v19, v44
v_max_f32 v19, v19, v44
v_sub_f32 v48, v48, v19
v_sub_f32 v49, v49, v19
v_sub_f32 v50, v50, v19
v_sub_f32 v51, v51, v19
v_sub_f32 v46, v46, v19
v_sub_f32 v47, v47, v19
v_exp_f32 v48, v48
v_exp_f32 v49, v49
v_exp_f32 v50, v50
v_exp_f32 v51, v51
v_cvt_pk_bf16_f32 v54, v48, v49
v_cvt_pk_bf16_f32 v55, v50, v51
s_nop 0
v_mov_b32_dpp v48, v54 quad_perm:[0,1,0,1] row_mask:0xf bank_mask:0xf
v_mov_b32_dpp v49, v55 quad_perm:[0,1,0,1] row_mask:0xf bank_mask:0xf
v_mov_b32_dpp v50, v54 quad_perm:[2,3,2,3] row_mask:0xf bank_mask:0xf
v_mov_b32_dpp v51, v55 quad_perm:[2,3,2,3] row_mask:0xf bank_mask:0xf
v_mov_b64 v[20:21], s[44:45]
v_mov_b64 v[22:23], s[44:45]
v_mfma_f32_16x16x32_bf16 v[8:11], v[56:59], v[48:51], 0
v_mfma_f32_16x16x32_bf16 v[12:15], v[60:63], v[48:51], 0
v_mfma_f32_16x16x32_bf16 v[16:19], v[20:23], v[48:51], 0
v_mov_b64 v[54:55], s[46:47]
v_exp_f32_dpp v44, v46 quad_perm:[0,1,0,1] row_mask:0xf bank_mask:0xf
v_exp_f32_dpp v45, v47 quad_perm:[0,1,0,1] row_mask:0xf bank_mask:0xf
s_nop 0
v_cvt_pk_bf16_f32 v52, v44, v45
v_cvt_pk_bf16_f32 v53, v44, v45
s_nop 1
v_mfma_f32_16x16x16_bf16 v[16:19], v[54:55], v[52:53], v[16:19]
v_mfma_f32_16x16x16_bf16 v[8:11], v[24:25], v[52:53], v[8:11]
v_mfma_f32_16x16x16_bf16 v[12:15], v[26:27], v[52:53], v[12:15]
s_nop 5
v_rcp_f32 v18, v16
s_nop 0
v_cndmask_b32 v8, v12, v8, s[42:43]
v_mul_f32 v8, v8, v18
v_cndmask_b32 v9, v13, v9, s[42:43]
v_mul_f32 v9, v9, v18
v_cndmask_b32 v10, v14, v10, s[42:43]
v_mul_f32 v10, v10, v18
v_cndmask_b32 v11, v15, v11, s[42:43]
v_mul_f32 v11, v11, v18
v_cvt_pk_bf16_f32 v12, v8, v9
v_cvt_pk_bf16_f32 v13, v10, v11
s_branch back_10040
exit_10041:
global_load_dwordx4 v[32:35], v0, s[68:69] offset:-4096 sc1
global_load_dwordx4 v[36:39], v0, s[68:69] offset:0 sc1
s_add_u32 s30, s30, 1
s_cmp_gt_u32 s30, 262144
s_cbranch_scc1 L_fail
s_waitcnt vmcnt(1)
v_bitop3_b32 v44, v32, v34, s18 bitop3:0x7e
s_waitcnt vmcnt(0)
v_bitop3_b32 v45, v36, v38, s18 bitop3:0x7e
v_bitop3_b32 v44, v44, v45, s19 bitop3:0xa8
v_cmp_ne_u32 vcc, 0, v44
s_cbranch_vccnz exit_10041
s_add_u32 s36, s36, 1
s_cmp_lt_u32 s36, 2
s_cbranch_scc1 layer_10037
s_endpgm
wave_10008:
layer_10050:
s_lshl_b32 s17, s36, 6
s_mul_i32 s27, s36, 35651584
s_mul_i32 s28, s14, 16384
s_add_u32 s27, s27, s28
s_add_u32 s20, s27, 16789504
s_mul_i32 s27, s17, 10240
s_add_u32 s27, s27, s24
s_add_u32 s21, s27, s25
s_mov_b32 s19, 0
s_mov_b32 s33, s6
s_add_u32 s34, s17, 1
s_add_u32 s31, s17, 63
s_add_u32 s32, s17, 64
s_mov_b32 s27, s20
v_mov_b32 v7, 0
s_add_u32 s68, s4, 416768
s_addc_u32 s69, s5, 0
s_add_u32 s72, s4, 400384
s_addc_u32 s73, s5, 0
s_add_u32 s70, s4, 420864
s_addc_u32 s71, s5, 0
s_add_u32 s74, s4, 404480
s_addc_u32 s75, s5, 0
s_add_u32 s58, s4, s20
s_addc_u32 s59, s5, 0
global_load_dwordx4 v[64:67], v0, s[76:77] offset:-4096 sc1
global_load_dwordx4 v[68:71], v0, s[76:77] offset:-3072 sc1
global_load_dwordx4 v[72:75], v0, s[76:77] offset:-2048 sc1
global_load_dwordx4 v[76:79], v0, s[76:77] offset:-1024 sc1
global_load_dwordx4 v[80:83], v0, s[76:77] offset:2048 sc1
global_load_dwordx4 v[84:87], v0, s[76:77] offset:3072 sc1
global_load_dwordx4 v[56:59], v0, s[76:77] offset:0 sc1
global_load_dwordx4 v[60:63], v0, s[76:77] offset:1024 sc1
v_mov_b64 v[8:9], 0
v_mov_b64 v[10:11], 0
v_mov_b64 v[12:13], 0
v_mov_b64 v[14:15], 0
v_mov_b64 v[16:17], 0
v_mov_b64 v[18:19], 0
v_mov_b64 v[20:21], 0
v_mov_b64 v[22:23], 0
v_mov_b64 v[24:25], 0
v_mov_b64 v[26:27], 0
v_mov_b64 v[28:29], 0
v_mov_b64 v[30:31], 0
s_barrier
global_load_dwordx4 v[48:51], v0, s[58:59] offset:0 nt sc1
global_load_dwordx4 v[52:55], v0, s[58:59] offset:1024 nt sc1
v_and_b32 v7, 128, v0
v_add_u32 v7, s22, v7
s_mov_b32 exec_hi, 0
v_and_b32 v7, 255, v0
v_lshl_add_u32 v7, v7, 3, s27
s_mov_b32 exec_hi, -1
global_load_dwordx4 v[32:35], v0, s[68:69] offset:-4096 sc1
global_load_dwordx4 v[36:39], v0, s[68:69] offset:0 sc1
s_mov_b32 s30, 0
s_waitcnt vmcnt(0)
.p2align 6
gather_10051:
s_waitcnt vmcnt(3)
rt_10056_b:
v_smfmac_f32_16x16x64_bf16 v[24:27], v[32:35], a[0:7], v1
ds_write_b128 v0, v[32:35] offset:3072
v_smfmac_f32_16x16x64_bf16 v[8:11], v[32:35], v[64:71], v1
v_bitop3_b32 v44, v32, v34, s18 bitop3:0x7e
v_smfmac_f32_16x16x64_bf16 v[12:15], v[32:35], v[72:79], v1
s_waitcnt vmcnt(2)
ds_write_b128 v0, v[36:39] offset:7168
v_bitop3_b32 v45, v36, v38, s18 bitop3:0x7e
v_bitop3_b32 v44, v44, v45, s19 bitop3:0xa8
v_cmp_ne_u32 vcc, 0, v44
v_smfmac_f32_16x16x64_bf16 v[8:11], v[36:39], a[16:23], v1
v_smfmac_f32_16x16x64_bf16 v[20:23], v[32:35], v[80:87], v1
s_cbranch_vccnz rt_10056
global_load_dwordx4 v[64:67], v0, s[78:79] offset:-4096 sc1
ds_read_b128 v[80:83], v2 offset:0
v_smfmac_f32_16x16x64_bf16 v[28:31], v[32:35], a[8:15], v1
global_load_dwordx4 v[68:71], v0, s[78:79] offset:-3072 sc1
ds_read_b128 v[84:87], v2 offset:1024
v_smfmac_f32_16x16x64_bf16 v[20:23], v[36:39], a[40:47], v1
global_load_dwordx4 v[72:75], v0, s[78:79] offset:-2048 sc1
global_load_dwordx4 v[76:79], v0, s[78:79] offset:-1024 sc1
v_smfmac_f32_16x16x64_bf16 v[16:19], v[32:35], v[56:63], v1
s_waitcnt lgkmcnt(2)
s_barrier
ds_read_b128 v[40:43], v0 offset:2048
v_smfmac_f32_16x16x64_bf16 v[16:19], v[36:39], a[32:39], v1
s_xor_b32 s18, s18, 1
s_waitcnt lgkmcnt(1)
ds_read_b128 v[44:47], v0 offset:6144
v_smfmac_f32_16x16x64_bf16 v[28:31], v[36:39], v[80:87], v1
ds_read_b128 v[80:83], v2 offset:2048
v_smfmac_f32_16x16x64_bf16 v[24:27], v[36:39], a[48:55], v1
s_mov_b64 s[68:69], s[72:73]
ds_read_b128 v[32:35], v0 offset:1024
v_smfmac_f32_16x16x64_bf16 v[12:15], v[36:39], a[24:31], v1
ds_read_b128 v[84:87], v2 offset:3072
s_waitcnt lgkmcnt(4)
v_smfmac_f32_16x16x64_bf16 v[8:11], v[40:43], a[56:63], v1
ds_read_b128 v[36:39], v0 offset:5120
v_smfmac_f32_16x16x64_bf16 v[12:15], v[40:43], a[64:71], v1
s_add_u32 s20, s20, 524288
s_waitcnt lgkmcnt(4)
ds_read_b128 v[40:43], v0 offset:0
v_smfmac_f32_16x16x64_bf16 v[12:15], v[44:47], a[80:87], v1
s_add_u32 s17, s17, 1
global_load_dwordx4 v[56:59], v0, s[58:59] offset:2048 nt sc1
v_smfmac_f32_16x16x64_bf16 v[8:11], v[44:47], a[72:79], v1
s_waitcnt lgkmcnt(3)
ds_read_b128 v[44:47], v0 offset:4096
s_waitcnt lgkmcnt(3)
v_smfmac_f32_16x16x64_bf16 v[12:15], v[32:35], v[80:87], v1
s_add_u32 s21, s21, 10240
ds_read_b128 v[80:83], v2 offset:4096
v_smfmac_f32_16x16x64_bf16 v[8:11], v[32:35], a[88:95], v1
s_waitcnt lgkmcnt(3)
ds_read_b128 v[84:87], v2 offset:5120
s_waitcnt lgkmcnt(3)
v_smfmac_f32_16x16x64_bf16 v[12:15], v[36:39], a[104:111], v1
ds_read_b128 v[32:35], v0 offset:9216
v_smfmac_f32_16x16x64_bf16 v[8:11], v[36:39], a[96:103], v1
ds_read_b128 v[36:39], v0 offset:8192
v_smfmac_f32_16x16x64_bf16 v[8:11], v[40:43], a[112:119], v1
s_waitcnt lgkmcnt(4)
global_load_dwordx4 v[60:63], v0, s[58:59] offset:3072 nt sc1
v_smfmac_f32_16x16x64_bf16 v[12:15], v[40:43], a[120:127], v1
s_waitcnt lgkmcnt(2)
ds_read_b128 v[40:43], v0 offset:2048
v_smfmac_f32_16x16x64_bf16 v[12:15], v[44:47], v[80:87], v1
s_waitcnt lgkmcnt(2)
ds_read_b128 v[84:87], v2 offset:7168
v_smfmac_f32_16x16x64_bf16 v[8:11], v[44:47], a[128:135], v1
s_waitcnt vmcnt(5)
s_waitcnt lgkmcnt(2)
ds_read_b128 v[80:83], v2 offset:6144
v_smfmac_f32_16x16x64_bf16 v[12:15], v[32:35], a[144:151], v1
global_load_dword v7, v7, s[4:5] sc1
v_smfmac_f32_16x16x64_bf16 v[8:11], v[32:35], a[136:143], v1
ds_read_b128 v[32:35], v0 offset:6144
s_waitcnt vmcnt(5)
v_smfmac_f32_16x16x64_bf16 v[8:11], v[36:39], v[64:71], v1
s_nop 0
ds_read_b128 v[68:71], v2 offset:9216
s_waitcnt lgkmcnt(3)
v_smfmac_f32_16x16x64_bf16 v[12:15], v[36:39], a[152:159], v1
s_nop 0
ds_read_b128 v[64:67], v2 offset:8192
s_waitcnt lgkmcnt(3)
ds_read_b128 v[36:39], v0 offset:1024
v_add_f32 v8, v8, v10
v_smfmac_f32_16x16x64_bf16 v[20:23], v[40:43], v[80:87], v1
ds_read_b128 v[84:87], v2 offset:11264
v_mul_f32 v8, s35, v8
v_smfmac_f32_16x16x64_bf16 v[16:19], v[40:43], a[160:167], v1
s_waitcnt lgkmcnt(4)
ds_read_b128 v[40:43], v0 offset:5120
v_add_f32 v9, v9, v11
v_smfmac_f32_16x16x64_bf16 v[20:23], v[32:35], a[176:183], v1
ds_read_b128 v[80:83], v2 offset:10240
v_mul_f32 v9, s35, v9
v_add_f32 v13, v13, v15
v_cvt_pk_bf16_f32 v8, v8, v9
v_add_f32 v12, v12, v14
v_smfmac_f32_16x16x64_bf16 v[16:19], v[32:35], a[168:175], v1
s_waitcnt lgkmcnt(3)
ds_read_b128 v[32:35], v0 offset:0
v_mul_f32 v13, s35, v13
v_smfmac_f32_16x16x64_bf16 v[16:19], v[36:39], v[64:71], v1
s_waitcnt vmcnt(3)
ds_read_b128 v[68:71], v2 offset:13312
v_mul_f32 v12, s35, v12
v_smfmac_f32_16x16x64_bf16 v[20:23], v[36:39], a[184:191], v1
s_waitcnt lgkmcnt(3)
ds_read_b128 v[36:39], v0 offset:4096
ds_read_b128 v[64:67], v2 offset:12288
v_cvt_pk_bf16_f32 v12, v12, v13
v_smfmac_f32_16x16x64_bf16 v[16:19], v[40:43], v[72:79], v1
s_waitcnt lgkmcnt(4)
ds_write2_b32 v3, v8, v12 offset0:0 offset1:128
v_smfmac_f32_16x16x64_bf16 v[20:23], v[40:43], v[80:87], v1
s_add_u32 s34, s17, 2
s_waitcnt lgkmcnt(4)
ds_read_b128 v[72:75], v2 offset:14336
v_smfmac_f32_16x16x64_bf16 v[20:23], v[32:35], a[200:207], v1
ds_read_b128 v[80:83], v2 offset:16384
v_smfmac_f32_16x16x64_bf16 v[16:19], v[32:35], a[192:199], v1
s_waitcnt lgkmcnt(4)
ds_read_b128 v[40:43], v0 offset:9216
s_mov_b64 vcc, s[42:43]
ds_read_b128 v[76:79], v2 offset:15360
v_smfmac_f32_16x16x64_bf16 v[20:23], v[36:39], a[208:215], v1
ds_read_b128 v[84:87], v2 offset:17408
s_waitcnt lgkmcnt(5)
s_barrier
ds_read_b128 v[32:35], v0 offset:8192
v_smfmac_f32_16x16x64_bf16 v[16:19], v[36:39], v[64:71], v1
ds_read_b64_tr_b16 v[10:11], v4 offset:2560
ds_read_b64_tr_b16 v[8:9], v4 offset:2048
s_waitcnt lgkmcnt(6)
s_waitcnt lgkmcnt(5)
ds_read_b64_tr_b16 v[12:13], v4 offset:3072
v_smfmac_f32_16x16x64_bf16 v[20:23], v[40:43], a[216:223], v1
ds_read_b64_tr_b16 v[14:15], v4 offset:3584
s_waitcnt lgkmcnt(6)
ds_read_b128 v[68:71], v2 offset:19456
v_smfmac_f32_16x16x64_bf16 v[16:19], v[40:43], v[72:79], v1
s_waitcnt lgkmcnt(6)
ds_read_b128 v[36:39], v0 offset:9216
s_waitcnt lgkmcnt(6)
v_smfmac_f32_16x16x64_bf16 v[20:23], v[32:35], v[80:87], v1
ds_read_b128 v[64:67], v2 offset:18432
ds_read_b128 v[40:43], v0 offset:8192
v_smfmac_f32_16x16x64_bf16 v[16:19], v[32:35], a[224:231], v1
s_waitcnt lgkmcnt(6)
ds_read_b128 v[72:75], v2 offset:20480
ds_read_b128 v[32:35], v0 offset:2048
v_mfma_f32_16x16x32_bf16 v[44:47], v[48:51], v[8:11], 0
s_waitcnt lgkmcnt(6)
ds_read_b128 v[76:79], v2 offset:21504
v_add_f32 v21, v21, v23
v_add_f32 v20, v20, v22
v_bfe_u32 v48, v0, 5, 1
v_mfma_f32_16x16x32_bf16 v[44:47], v[52:55], v[12:15], v[44:47]
s_waitcnt lgkmcnt(5)
ds_read_b128 v[80:83], v2 offset:22528
v_add_f32 v17, v17, v19
v_add_f32 v16, v16, v18
v_cvt_pk_bf16_f32 v20, v20, v21
v_lshl_add_u32 v48, v48, 3, v5
v_cvt_pk_bf16_f32 v16, v16, v17
v_smfmac_f32_16x16x64_bf16 v[28:31], v[36:39], a[232:239], v1
s_waitcnt lgkmcnt(4)
ds_write2_b32 v3, v16, v20 offset0:1 offset1:129
v_xor_b32 v48, 128, v48
v_cndmask_b32_dpp v44, v46, v44, vcc quad_perm:[0,1,0,1] row_mask:0xf bank_mask:0xf
v_cndmask_b32_dpp v45, v47, v45, vcc quad_perm:[0,1,0,1] row_mask:0xf bank_mask:0xf
v_smfmac_f32_16x16x64_bf16 v[24:27], v[36:39], v[64:71], v1
s_waitcnt lgkmcnt(3)
ds_write_b64 v48, v[44:45] offset:7680
v_smfmac_f32_16x16x64_bf16 v[24:27], v[40:43], a[240:247], v1
s_waitcnt lgkmcnt(3)
global_load_dwordx4 v[64:67], v0, s[78:79] offset:0 sc1
ds_read_b128 v[36:39], v0 offset:6144
v_smfmac_f32_16x16x64_bf16 v[28:31], v[40:43], v[72:79], v1
s_waitcnt lgkmcnt(3)
global_load_dwordx4 v[68:71], v0, s[78:79] offset:1024 sc1
ds_read_b128 v[84:87], v2 offset:23552
v_smfmac_f32_16x16x64_bf16 v[24:27], v[32:35], a[248:255], v1
global_load_dwordx4 v[72:75], v0, s[78:79] offset:2048 sc1
ds_read_b128 v[40:43], v0 offset:1024
v_smfmac_f32_16x16x64_bf16 v[28:31], v[32:35], v[88:95], v1
s_waitcnt lgkmcnt(3)
ds_read_b128 v[32:35], v0 offset:5120
s_barrier
ds_read_b128 v[52:55], v6 offset:7168
s_waitcnt lgkmcnt(4)
v_smfmac_f32_16x16x64_bf16 v[28:31], v[36:39], v[96:103], v1
s_waitcnt lgkmcnt(3)
ds_read_b128 v[48:51], v6 offset:6144
ds_read_b64_tr_b16 v[8:9], v4 offset:0
v_smfmac_f32_16x16x64_bf16 v[24:27], v[36:39], v[80:87], v1
s_waitcnt lgkmcnt(4)
ds_read_b128 v[36:39], v0 offset:0
global_load_dwordx4 v[76:79], v0, s[78:79] offset:3072 sc1
ds_read_b64_tr_b16 v[10:11], v4 offset:512
v_smfmac_f32_16x16x64_bf16 v[28:31], v[40:43], v[112:119], v1
s_waitcnt lgkmcnt(5)
ds_read_b64_tr_b16 v[14:15], v4 offset:1536
ds_read_b64_tr_b16 v[18:19], v4 offset:2560
v_smfmac_f32_16x16x64_bf16 v[24:27], v[40:43], v[104:111], v1
s_waitcnt lgkmcnt(6)
ds_read_b64_tr_b16 v[12:13], v4 offset:1024
ds_read_b64_tr_b16 v[16:17], v4 offset:2048
v_smfmac_f32_16x16x64_bf16 v[28:31], v[32:35], v[128:135], v1
s_waitcnt lgkmcnt(7)
ds_read_b64_tr_b16 v[22:23], v4 offset:3584
v_add_f32 v50, v50, v54
v_add_f32 v49, v49, v53
v_smfmac_f32_16x16x64_bf16 v[24:27], v[32:35], v[120:127], v1
s_waitcnt lgkmcnt(6)
ds_read_b128 v[40:43], v0 offset:4096
v_add_f32 v48, v48, v52
v_smfmac_f32_16x16x64_bf16 v[24:27], v[36:39], v[136:143], v1
s_waitcnt lgkmcnt(5)
ds_read_b64_tr_b16 v[20:21], v4 offset:3072
v_add_f32 v51, v51, v55
v_smfmac_f32_16x16x64_bf16 v[28:31], v[36:39], v[144:151], v1
s_waitcnt lgkmcnt(4)
global_load_dwordx4 v[80:83], v0, s[80:81] offset:-4096 sc1
v_exp_f32 v51, v51
v_mfma_f32_16x16x32_bf16 v[44:47], v[8:11], v[8:11], 0
s_waitcnt lgkmcnt(3)
v_exp_f32 v49, v49
v_mfma_f32_16x16x32_bf16 v[44:47], v[12:15], v[12:15], v[44:47]
s_waitcnt lgkmcnt(1)
v_exp_f32 v50, v50
v_exp_f32 v48, v48
v_mfma_f32_16x16x32_bf16 v[44:47], v[16:19], v[16:19], v[44:47]
s_waitcnt lgkmcnt(0)
v_cvt_pk_bf16_f32 v55, v50, v51
v_cvt_pk_bf16_f32 v54, v48, v49
v_mfma_f32_16x16x32_bf16 v[44:47], v[20:23], v[20:23], v[44:47]
v_mov_b64 v[22:23], s[44:45]
v_mov_b32_dpp v50, v54 quad_perm:[2,3,2,3] row_mask:0xf bank_mask:0xf
v_mov_b32_dpp v49, v55 quad_perm:[0,1,0,1] row_mask:0xf bank_mask:0xf
v_mov_b32_dpp v51, v55 quad_perm:[2,3,2,3] row_mask:0xf bank_mask:0xf
v_smfmac_f32_16x16x64_bf16 v[24:27], v[40:43], v[152:159], v1
v_mov_b32_dpp v48, v54 quad_perm:[0,1,0,1] row_mask:0xf bank_mask:0xf
v_mov_b64 v[20:21], s[44:45]
v_smfmac_f32_16x16x64_bf16 v[28:31], v[40:43], v[160:167], v1
s_waitcnt vmcnt(7)
global_load_dwordx4 v[84:87], v0, s[80:81] offset:-3072 sc1
v_exp_f32_dpp v44, v46 quad_perm:[0,1,0,1] row_mask:0xf bank_mask:0xf
v_mfma_f32_16x16x32_bf16 v[8:11], v[56:59], v[48:51], 0
v_exp_f32_dpp v45, v47 quad_perm:[0,1,0,1] row_mask:0xf bank_mask:0xf
v_mfma_f32_16x16x32_bf16 v[16:19], v[20:23], v[48:51], 0
s_waitcnt vmcnt(7)
v_cvt_pk_bf16_f32 v53, v44, v45
v_mov_b64 v[54:55], s[46:47]
v_mfma_f32_16x16x32_bf16 v[12:15], v[60:63], v[48:51], 0
v_cvt_pk_bf16_f32 v52, v44, v45
v_cvt_pk_bf16_f32 v24, v24, v25
v_cvt_pk_bf16_f32 v25, v26, v27
v_mfma_f32_16x16x16_bf16 v[16:19], v[54:55], v[52:53], v[16:19]
s_min_u32 s34, s34, s32
v_cvt_pk_bf16_f32 v26, v28, v29
v_cvt_pk_bf16_f32 v27, v30, v31
v_mfma_f32_16x16x16_bf16 v[8:11], v[24:25], v[52:53], v[8:11]
ds_read_b128 v[28:31], v0 offset:56320
v_mov_b64 v[42:43], 0
v_mfma_f32_16x16x16_bf16 v[12:15], v[26:27], v[52:53], v[12:15]
s_waitcnt vmcnt(4)
v_bfe_u32 v32, v0, 5, 1
v_mov_b64 v[36:37], 0
v_subrev_u32 v17, s37, v16
v_rcp_f32 v18, v16
v_lshl_add_u32 v32, v32, 3, v5
v_mov_b64 v[38:39], 0
v_cmp_lt_u32 vcc, s38, v17
v_cndmask_b32 v9, v13, v9, s[42:43]
v_cndmask_b32 v8, v12, v8, s[42:43]
v_cndmask_b32 v10, v14, v10, s[42:43]
v_mul_f32 v10, v10, v18
v_cndmask_b32 v11, v15, v11, s[42:43]
v_mul_f32 v9, v9, v18
v_mul_f32 v8, v8, v18
v_mul_f32 v11, v11, v18
v_cvt_pk_bf16_f32 v12, v8, v9
v_cvt_pk_bf16_f32 v13, v10, v11
s_cbranch_vccnz rare_10052
back_10053:
ds_write_b64 v32, v[12:13] offset:1536
v_mov_b32_dpp v9, v13 quad_perm:[0,1,0,1] row_mask:0xf bank_mask:0xf
v_mov_b32_dpp v10, v12 quad_perm:[2,3,2,3] row_mask:0xf bank_mask:0xf
v_mov_b32_dpp v8, v12 quad_perm:[0,1,0,1] row_mask:0xf bank_mask:0xf
v_mov_b32_dpp v11, v13 quad_perm:[2,3,2,3] row_mask:0xf bank_mask:0xf
v_mov_b64 v[54:55], 0
v_mov_b64 v[52:53], 0
v_smfmac_f32_16x16x64_bf16 v[36:39], v[8:11], v[64:71], v1
s_waitcnt vmcnt(2)
ds_read_b128 v[20:23], v0 offset:54272
global_load_dwordx4 v[64:67], v0, s[76:77] offset:-4096 sc1
ds_read_b128 v[16:19], v0 offset:53248
v_mov_b64 v[34:35], 0
v_mov_b64 v[32:33], 0
v_mov_b64 v[40:41], 0
v_smfmac_f32_16x16x64_bf16 v[52:55], v[8:11], v[176:183], v1
s_waitcnt lgkmcnt(2)
ds_read_b128 v[24:27], v0 offset:55296
s_barrier
ds_read_b128 v[56:59], v5 offset:1024
global_load_dwordx4 v[68:71], v0, s[76:77] offset:-3072 sc1
ds_read_b128 v[12:15], v5 offset:0
v_mov_b64 v[48:49], 0
v_smfmac_f32_16x16x64_bf16 v[40:43], v[8:11], v[72:79], v1
s_waitcnt vmcnt(2)
ds_read_b128 v[60:63], v5 offset:512
v_mov_b64 v[50:51], 0
v_smfmac_f32_16x16x64_bf16 v[32:35], v[8:11], v[80:87], v1
global_load_dwordx4 v[72:75], v0, s[76:77] offset:-2048 sc1
ds_read_b128 v[80:83], v0 offset:57344
v_smfmac_f32_16x16x64_bf16 v[48:51], v[8:11], v[168:175], v1
s_waitcnt lgkmcnt(5)
s_waitcnt lgkmcnt(3)
ds_read_b128 v[84:87], v0 offset:58368
v_smfmac_f32_16x16x64_bf16 v[40:43], v[56:59], v[192:199], v1
global_load_dwordx4 v[76:79], v0, s[76:77] offset:-1024 sc1
v_smfmac_f32_16x16x64_bf16 v[36:39], v[56:59], v[16:23], v1
s_waitcnt lgkmcnt(2)
ds_read_b128 v[20:23], v0 offset:60416
v_lshrrev_b32 v44, 8, v0
v_smfmac_f32_16x16x64_bf16 v[36:39], v[60:63], v[24:31], v1
ds_read_b128 v[16:19], v0 offset:59392
v_bfe_u32 v45, v0, 1, 7
v_smfmac_f32_16x16x64_bf16 v[36:39], v[12:15], v[184:191], v1
s_waitcnt lgkmcnt(3)
ds_read_b128 v[28:31], v0 offset:62464
s_waitcnt lgkmcnt(3)
v_smfmac_f32_16x16x64_bf16 v[40:43], v[60:63], v[80:87], v1
ds_read_b128 v[24:27], v0 offset:61440
v_lshl_or_b32 v44, v44, 12, v45
v_smfmac_f32_16x16x64_bf16 v[40:43], v[12:15], v[200:207], v1
ds_read_b128 v[80:83], v0 offset:63488
v_cvt_pk_bf16_f32 v36, v36, v37
v_smfmac_f32_16x16x64_bf16 v[32:35], v[56:59], v[232:239], v1
ds_read_b128 v[84:87], v0 offset:64512
v_cvt_pk_bf16_f32 v37, v38, v39
v_and_or_b32 v36, v36, -2, s18
v_smfmac_f32_16x16x64_bf16 v[52:55], v[56:59], v[216:223], v1
global_store_dwordx2 v44, v[36:37], s[48:49]
s_waitcnt lgkmcnt(3)
v_cvt_pk_bf16_f32 v40, v40, v41
v_smfmac_f32_16x16x64_bf16 v[48:51], v[56:59], v[16:23], v1
s_waitcnt lgkmcnt(2)
s_waitcnt lgkmcnt(1)
v_and_or_b32 v40, v40, -2, s18
v_smfmac_f32_16x16x64_bf16 v[48:51], v[60:63], v[24:31], v1
v_cvt_pk_bf16_f32 v41, v42, v43
v_smfmac_f32_16x16x64_bf16 v[48:51], v[12:15], v[208:215], v1
s_waitcnt lgkmcnt(0)
global_store_dwordx2 v44, v[40:41], s[50:51]
v_smfmac_f32_16x16x64_bf16 v[32:35], v[60:63], v[240:247], v1
s_nop 1
v_smfmac_f32_16x16x64_bf16 v[52:55], v[60:63], v[80:87], v1
s_add_u32 s27, s20, 524288
s_add_u32 s58, s4, s20
v_cvt_pk_bf16_f32 v48, v48, v49
v_and_or_b32 v48, v48, -2, s18
v_cvt_pk_bf16_f32 v49, v50, v51
v_smfmac_f32_16x16x64_bf16 v[52:55], v[12:15], v[224:231], v1
s_nop 0
global_store_dwordx2 v44, v[48:49], s[52:53]
s_addc_u32 s59, s5, 0
s_mov_b32 s30, 0
v_smfmac_f32_16x16x64_bf16 v[32:35], v[12:15], v[248:255], v1
s_nop 2
v_cvt_pk_bf16_f32 v52, v52, v53
v_cvt_pk_bf16_f32 v53, v54, v55
s_mov_b32 s19, 1
v_and_or_b32 v52, v52, -2, s18
global_store_dwordx2 v44, v[52:53], s[54:55]
v_cvt_pk_bf16_f32 v32, v32, v33
v_cvt_pk_bf16_f32 v33, v34, v35
v_and_or_b32 v32, v32, -2, s18
global_store_dwordx2 v44, v[32:33], s[56:57]
nored_10059:
v_cmp_gt_u32 vcc, s34, v7
s_cmp_eq_u32 vcc_hi, 0
s_cbranch_scc1 kv_10063
s_mov_b32 s30, 0
kv_10062:
v_and_b32 v7, 128, v0
buffer_load_dword v7, v7, s[4:7], s22 offen sc1
s_add_u32 s30, s30, 1
s_cmp_gt_u32 s30, 262144
s_cbranch_scc1 L_fail
s_waitcnt vmcnt(0)
v_cmp_gt_u32 vcc, s34, v7
s_cbranch_vccnz kv_10062
kv_10063:
v_and_b32 v7, 128, v0
v_add_u32 v7, s22, v7
s_mov_b32 exec_hi, 0
v_and_b32 v7, 255, v0
v_lshl_add_u32 v7, v7, 3, s27
s_mov_b32 exec_hi, -1
s_nop 15
s_nop 15
s_nop 15
s_nop 15
s_nop 15
s_nop 1
global_load_dwordx4 v[56:59], v0, s[76:77] offset:0 sc1
global_load_dwordx4 v[60:63], v0, s[76:77] offset:1024 sc1
global_load_dwordx4 v[80:83], v0, s[76:77] offset:2048 sc1
global_load_dwordx4 v[84:87], v0, s[76:77] offset:3072 sc1
join_10060:
s_barrier
s_nop 15
s_nop 15
s_nop 7
s_barrier
global_load_dwordx4 v[32:35], v0, s[68:69] offset:-4096 sc1
s_nop 10
global_load_dwordx4 v[36:39], v0, s[68:69] offset:0 sc1
s_barrier
global_load_dwordx4 v[48:51], v0, s[58:59] offset:0 nt sc1
global_load_dwordx4 v[52:55], v0, s[58:59] offset:1024 nt sc1
v_mov_b64 v[8:9], 0
v_mov_b64 v[10:11], 0
v_mov_b64 v[12:13], 0
v_mov_b64 v[14:15], 0
v_mov_b64 v[16:17], 0
v_mov_b64 v[18:19], 0
v_mov_b64 v[20:21], 0
v_mov_b64 v[22:23], 0
v_mov_b64 v[24:25], 0
v_mov_b64 v[26:27], 0
v_mov_b64 v[28:29], 0
v_mov_b64 v[30:31], 0
s_mov_b32 s30, 0
s_cmp_eq_u32 s17, s31
s_cbranch_scc0 gather_10051
s_branch exit_10054
rt_10056:
global_load_dwordx4 v[32:35], v0, s[68:69] offset:-4096 sc1
global_load_dwordx4 v[36:39], v0, s[68:69] offset:0 sc1
s_add_u32 s30, s30, 1
s_cmp_gt_u32 s30, 262144
s_cbranch_scc1 L_fail
s_mov_b64 exec, 1
global_store_dword v0, v0, s[62:63]
global_store_dword v0, v0, s[62:63]
s_mov_b64 exec, -1
v_mov_b64 v[8:9], 0
v_mov_b64 v[10:11], 0
v_mov_b64 v[12:13], 0
v_mov_b64 v[14:15], 0
v_mov_b64 v[16:17], 0
v_mov_b64 v[18:19], 0
v_mov_b64 v[20:21], 0
v_mov_b64 v[22:23], 0
v_mov_b64 v[24:25], 0
v_mov_b64 v[26:27], 0
v_mov_b64 v[28:29], 0
v_mov_b64 v[30:31], 0
s_branch gather_10051
rare_10052:
ds_read_b128 v[48:51], v6 offset:6144
ds_read_b128 v[52:55], v6 offset:7168
s_waitcnt lgkmcnt(0)
v_add_f32 v48, v48, v52
v_add_f32 v49, v49, v53
v_add_f32 v50, v50, v54
v_add_f32 v51, v51, v55
v_mov_b32_dpp v46, v46 quad_perm:[0,1,0,1] row_mask:0xf bank_mask:0xf
v_mov_b32_dpp v47, v47 quad_perm:[0,1,0,1] row_mask:0xf bank_mask:0xf
v_max3_f32 v19, v48, v49, v50
v_max3_f32 v19, v19, v51, v46
v_max_f32 v19, v19, v47
s_nop 1
v_max_f32_dpp v19, v19, v19 quad_perm:[2,3,0,1] row_mask:0xf bank_mask:0xf
v_mov_b32 v44, v19
s_nop 1
v_permlane32_swap_b32 v19, v44
v_max_f32 v19, v19, v44
v_mov_b32 v44, v19
s_nop 1
v_permlane16_swap_b32 v19, v44
v_max_f32 v19, v19, v44
v_sub_f32 v48, v48, v19
v_sub_f32 v49, v49, v19
v_sub_f32 v50, v50, v19
v_sub_f32 v51, v51, v19
v_sub_f32 v46, v46, v19
v_sub_f32 v47, v47, v19
v_exp_f32 v48, v48
v_exp_f32 v49, v49
v_exp_f32 v50, v50
v_exp_f32 v51, v51
v_cvt_pk_bf16_f32 v54, v48, v49
v_cvt_pk_bf16_f32 v55, v50, v51
s_nop 0
v_mov_b32_dpp v48, v54 quad_perm:[0,1,0,1] row_mask:0xf bank_mask:0xf
v_mov_b32_dpp v49, v55 quad_perm:[0,1,0,1] row_mask:0xf bank_mask:0xf
v_mov_b32_dpp v50, v54 quad_perm:[2,3,2,3] row_mask:0xf bank_mask:0xf
v_mov_b32_dpp v51, v55 quad_perm:[2,3,2,3] row_mask:0xf bank_mask:0xf
v_mov_b64 v[20:21], s[44:45]
v_mov_b64 v[22:23], s[44:45]
v_mfma_f32_16x16x32_bf16 v[8:11], v[56:59], v[48:51], 0
v_mfma_f32_16x16x32_bf16 v[12:15], v[60:63], v[48:51], 0
v_mfma_f32_16x16x32_bf16 v[16:19], v[20:23], v[48:51], 0
v_mov_b64 v[54:55], s[46:47]
v_exp_f32_dpp v44, v46 quad_perm:[0,1,0,1] row_mask:0xf bank_mask:0xf
v_exp_f32_dpp v45, v47 quad_perm:[0,1,0,1] row_mask:0xf bank_mask:0xf
s_nop 0
v_cvt_pk_bf16_f32 v52, v44, v45
v_cvt_pk_bf16_f32 v53, v44, v45
s_nop 1
v_mfma_f32_16x16x16_bf16 v[16:19], v[54:55], v[52:53], v[16:19]
v_mfma_f32_16x16x16_bf16 v[8:11], v[24:25], v[52:53], v[8:11]
v_mfma_f32_16x16x16_bf16 v[12:15], v[26:27], v[52:53], v[12:15]
s_nop 5
v_rcp_f32 v18, v16
s_nop 0
v_cndmask_b32 v8, v12, v8, s[42:43]
v_mul_f32 v8, v8, v18
v_cndmask_b32 v9, v13, v9, s[42:43]
v_mul_f32 v9, v9, v18
v_cndmask_b32 v10, v14, v10, s[42:43]
v_mul_f32 v10, v10, v18
v_cndmask_b32 v11, v15, v11, s[42:43]
v_mul_f32 v11, v11, v18
v_cvt_pk_bf16_f32 v12, v8, v9
v_cvt_pk_bf16_f32 v13, v10, v11
s_branch back_10053
exit_10054:
global_load_dwordx4 v[32:35], v0, s[68:69] offset:-4096 sc1
global_load_dwordx4 v[36:39], v0, s[68:69] offset:0 sc1
s_add_u32 s30, s30, 1
s_cmp_gt_u32 s30, 262144
s_cbranch_scc1 L_fail
s_waitcnt vmcnt(1)
v_bitop3_b32 v44, v32, v34, s18 bitop3:0x7e
s_waitcnt vmcnt(0)
v_bitop3_b32 v45, v36, v38, s18 bitop3:0x7e
v_bitop3_b32 v44, v44, v45, s19 bitop3:0xa8
v_cmp_ne_u32 vcc, 0, v44
s_cbranch_vccnz exit_10054
s_add_u32 s36, s36, 1
s_cmp_lt_u32 s36, 2
s_cbranch_scc1 layer_10050
s_endpgm
grp_10001:
s_bfm_b32 s24, s14, 0
s_and_b32 s24, s24, 0xaaaaaaaa
s_bcnt1_i32_b32 s24, s24
v_and_b32 v64, 63, v0
v_and_b32 v65, 15, v64
v_lshrrev_b32 v66, 4, v64
v_lshlrev_b32 v0, 4, v64
v_and_b32 v67, 2, v64
v_mov_b32 v68, 0x4444
v_mov_b32 v69, 0xeeee
v_cmp_eq_u32 vcc, 0, v67
s_nop 1
v_cndmask_b32 v1, v69, v68, vcc
s_mul_i32 s26, s13, 24576
s_add_u32 s26, s26, 65536
v_add_u32 v2, s26, v0
v_lshrrev_b32 v67, 2, v65
v_xor_b32 v68, v66, v67
v_lshlrev_b32 v68, 3, v68
v_lshl_add_u32 v68, v65, 5, v68
s_lshl_b32 s26, s13, 10
s_add_u32 s26, s26, 10240
v_add_u32 v3, s26, v68
v_lshl_add_u32 v68, v66, 2, v67
v_and_b32 v69, 3, v65
v_xor_b32 v69, v69, v66
v_lshlrev_b32 v69, 3, v69
v_lshl_add_u32 v68, v68, 5, v69
v_add_u32 v4, 10240, v68
v_and_b32 v69, 1, v65
v_lshl_add_u32 v68, v67, 1, v69
v_lshlrev_b32 v68, 4, v68
v_lshl_add_u32 v68, v66, 7, v68
v_add_u32 v5, 8192, v68
v_bfe_u32 v69, v65, 1, 1
v_mul_u32_u24 v69, 640, v69
v_xor_b32 v6, v69, v5
s_mov_b32 s42, 0x33333333
s_mov_b32 s43, 0x33333333
s_mov_b32 s44, 0x3f803f80
s_mov_b32 s45, 0x3f803f80
s_mov_b32 s46, 0x3f803f80
s_mov_b32 s47, 0
s_mov_b32 s37, 729808896
s_mov_b32 s38, 671088640
v_lshlrev_b32 v68, 3, v65
v_lshl_add_u32 v7, v66, 12, v68
s_lshl_b32 s26, s13, 14
s_lshl_b32 s27, s14, 7
s_add_u32 s26, s26, s27
s_add_u32 s90, s26, 65536
s_lshl_b32 s26, s13, 5
s_add_u32 s93, s26, s14
s_lshl_b32 s26, s93, 12
s_add_u32 s91, s26, 65536
s_lshr_b32 s26, s93, 2
s_lshl_b32 s26, s26, 9
s_and_b32 s27, s93, 3
s_lshl_b32 s27, s27, 6
s_add_u32 s26, s26, s27
s_add_u32 s92, s26, 393216
s_lshl_b32 s26, s14, 8
s_add_u32 s22, s26, 11534336
s_lshl_b32 s26, s24, 7
s_add_u32 s26, s26, 11550720
s_cmp_lt_u32 s24, 10
s_cselect_b32 s23, s26, 268435456
s_cselect_b32 s24, s24, 0
s_cselect_b32 s25, 12582912, s23
s_lshl_b32 s24, s24, 10
s_and_b32 s26, s14, 0
s_lshl_b32 s26, s26, 12
s_add_u32 s94, s26, 425984
s_lshl_b32 s26, s14, 7
s_add_u32 s95, s26, 425984
s_mov_b32 s35, 0x3e0293ee
s_lshl_b32 s26, s14, 2
s_add_u32 s26, s26, s13
s_mul_i32 s27, s26, 18432
s_add_u32 s89, s27, 1048576
s_add_u32 s48, s4, s90
s_addc_u32 s49, s5, 0
s_add_u32 s50, s90, 65536
s_add_u32 s50, s4, s50
s_addc_u32 s51, s5, 0
s_add_u32 s52, s90, 131072
s_add_u32 s52, s4, s52
s_addc_u32 s53, s5, 0
s_add_u32 s54, s90, 196608
s_add_u32 s54, s4, s54
s_addc_u32 s55, s5, 0
s_add_u32 s56, s90, 262144
s_add_u32 s56, s4, s56
s_addc_u32 s57, s5, 0
s_add_u32 s76, s89, 4096
s_add_u32 s76, s4, s76
s_addc_u32 s77, s5, 0
s_add_u32 s78, s89, 12288
s_add_u32 s78, s4, s78
s_addc_u32 s79, s5, 0
s_add_u32 s80, s89, 20480
s_add_u32 s80, s4, s80
s_addc_u32 s81, s5, 0
s_add_u32 s60, s4, s94
s_addc_u32 s61, s5, 0
s_add_u32 s62, s4, s95
s_addc_u32 s63, s5, 0
s_add_u32 s64, s4, s91
s_addc_u32 s65, s5, 0
s_add_u32 s66, s4, s92
s_addc_u32 s67, s5, 0
v_mov_b32 v72, 0
v_mov_b32 v73, 0
s_mov_b32 s26, s90
buffer_store_dwordx2 v[72:73], v7, s[4:7], s26 offen
s_add_u32 s26, s26, 65536
buffer_store_dwordx2 v[72:73], v7, s[4:7], s26 offen
s_add_u32 s26, s26, 65536
buffer_store_dwordx2 v[72:73], v7, s[4:7], s26 offen
s_add_u32 s26, s26, 65536
buffer_store_dwordx2 v[72:73], v7, s[4:7], s26 offen
s_add_u32 s26, s26, 65536
buffer_store_dwordx2 v[72:73], v7, s[4:7], s26 offen
s_add_u32 s26, s26, 65536
buffer_store_dword v72, off, s[4:7], s95 offset:0
s_load_dwordx2 s[96:97], s[0:1], 32
s_mov_b32 s98, 10240
s_mov_b32 s99, 0x20000
s_cmp_ge_u32 s93, 80
s_cbranch_scc1 nm0_10065
s_and_b32 s26, s93, 3
s_mul_i32 s26, s26, 2560
s_lshr_b32 s27, s93, 2
s_lshl_b32 s27, s27, 6
s_add_u32 s26, s26, s27
v_bfe_u32 v68, v65, 1, 2
v_lshlrev_b32 v68, 4, v68
v_and_b32 v69, 1, v65
v_lshl_add_u32 v68, v69, 2, v68
v_and_b32 v69, 1, v66
v_mul_u32_u24 v69, 1280, v69
v_add_u32 v68, v68, v69
s_waitcnt lgkmcnt(0)
buffer_load_dword v74, v68, s[96:99], s26 offen
buffer_load_dword v75, v68, s[96:99], s26 offen offset:8
v_and_b32 v68, 32, v0
v_bfe_u32 v69, v0, 6, 1
v_lshl_add_u32 v68, v69, 8, v68
v_bfe_u32 v69, v0, 8, 1
v_lshl_add_u32 v68, v69, 4, v68
v_bfe_u32 v69, v0, 4, 1
v_lshl_add_u32 v68, v69, 3, v68
s_add_u32 s27, s92, 16384
buffer_store_dwordx2 v[72:73], v68, s[4:7], s92 offen
s_waitcnt vmcnt(1)
buffer_store_dwordx2 v[74:75], v68, s[4:7], s27 offen
nm0_10065:
s_waitcnt vmcnt(0) lgkmcnt(0)
s_barrier
s_cmp_eq_u32 s13, 0
s_cselect_b32 s26, 144, s10
v_mov_b32 v74, 1
s_mov_b64 exec, 1
buffer_atomic_add v74, off, s[8:11], s26
s_mov_b64 exec, -1
v_lshrrev_b32 v67, 3, v64
v_and_b32 v68, 7, v64
v_lshlrev_b32 v68, 4, v68
v_lshl_add_u32 v32, v67, 13, v68
v_mul_u32_u24 v67, 1280, v67
v_add_u32 v36, v67, v68
v_lshrrev_b32 v67, 1, v66
v_lshlrev_b32 v67, 4, v67
v_and_b32 v68, 1, v66
v_lshl_add_u32 v67, v68, 1, v67
v_lshrrev_b32 v68, 3, v65
v_lshl_add_u32 v67, v68, 3, v67
v_bfe_u32 v68, v65, 2, 1
v_add_u32 v67, v67, v68
v_and_b32 v69, 3, v65
v_lshlrev_b32 v40, 4, v69
v_lshl_add_u32 v40, v67, 7, v40
v_lshl_add_u32 v67, v66, 2, v68
v_lshlrev_b32 v42, 4, v69
v_lshl_add_u32 v42, v67, 7, v42
v_lshrrev_b32 v68, 3, v65
v_lshl_add_u32 v42, v68, 3, v42
s_lshl_b32 s29, s13, 12
s_and_b32 s26, s13, 1
s_lshl_b32 s26, s26, 6
s_add_u32 s26, s26, s29
v_add_u32 v40, s26, v40
v_add_u32 v42, s26, v42
v_xor_b32 v41, 4096, v40
v_xor_b32 v43, 4096, v42
v_add_u32 v33, 64512, v32
v_add_u32 v37, 9216, v36
v_add_u32 v34, 129024, v32
v_add_u32 v38, 18432, v36
v_add_u32 v35, 193536, v32
v_add_u32 v39, 27648, v36
s_lshr_b32 s28, s13, 1
s_lshl_b32 s28, s28, 7
s_lshl_b32 s27, s14, 8
s_add_u32 s27, s27, s28
s_xor_b32 s26, s13, 0
s_lshl_b32 s82, s26, 19
s_add_u32 s82, s82, s27
s_lshl_b32 s85, s14, 2
s_add_u32 s85, s85, s26
s_mul_i32 s85, s85, 40960
s_add_u32 s85, s85, s28
s_xor_b32 s26, s13, 2
s_lshl_b32 s83, s26, 19
s_add_u32 s83, s83, s27
s_lshl_b32 s86, s14, 2
s_add_u32 s86, s86, s26
s_mul_i32 s86, s86, 40960
s_add_u32 s86, s86, s28
s_and_b32 s26, s13, 1
s_add_u32 s26, s26, 8
s_lshl_b32 s84, s26, 19
s_add_u32 s84, s84, s27
s_load_dwordx2 s[68:69], s[0:1], 40
s_load_dwordx2 s[70:71], s[0:1], 48
s_load_dwordx2 s[72:73], s[0:1], 56
s_load_dwordx2 s[74:75], s[0:1], 64
s_mov_b32 s98, 5242880
s_waitcnt lgkmcnt(0)
s_mov_b64 s[96:97], s[70:71]
s_add_u32 m0, s29, 0
s_add_u32 s26, s82, 0
buffer_load_dwordx4 v32, s[96:99], s26 offen offset:0 lds
buffer_load_dwordx4 v33, s[96:99], s26 offen offset:1024 lds
buffer_load_dwordx4 v34, s[96:99], s26 offen offset:2048 lds
buffer_load_dwordx4 v35, s[96:99], s26 offen offset:3072 lds
s_add_u32 m0, s29, 16384
s_add_u32 s26, s82, 262144
buffer_load_dwordx4 v32, s[96:99], s26 offen offset:0 lds
buffer_load_dwordx4 v33, s[96:99], s26 offen offset:1024 lds
buffer_load_dwordx4 v34, s[96:99], s26 offen offset:2048 lds
buffer_load_dwordx4 v35, s[96:99], s26 offen offset:3072 lds
s_add_u32 m0, s29, 32768
s_add_u32 s26, s82, 2097152
buffer_load_dwordx4 v32, s[96:99], s26 offen offset:0 lds
buffer_load_dwordx4 v33, s[96:99], s26 offen offset:1024 lds
buffer_load_dwordx4 v34, s[96:99], s26 offen offset:2048 lds
buffer_load_dwordx4 v35, s[96:99], s26 offen offset:3072 lds
s_waitcnt vmcnt(8)
s_barrier
s_add_u32 m0, s29, 49152
s_add_u32 s26, s82, 2359296
buffer_load_dwordx4 v32, s[96:99], s26 offen offset:0 lds
buffer_load_dwordx4 v33, s[96:99], s26 offen offset:1024 lds
buffer_load_dwordx4 v34, s[96:99], s26 offen offset:2048 lds
buffer_load_dwordx4 v35, s[96:99], s26 offen offset:3072 lds
ds_read_b64_tr_b16 v[72:73], v40 offset:0
ds_read_b64_tr_b16 v[74:75], v40 offset:512
ds_read_b64_tr_b16 v[76:77], v40 offset:8
ds_read_b64_tr_b16 v[78:79], v40 offset:520
ds_read_b64_tr_b16 v[80:81], v41 offset:0
ds_read_b64_tr_b16 v[82:83], v41 offset:512
ds_read_b64_tr_b16 a[128:129], v41 offset:8
ds_read_b64_tr_b16 a[130:131], v41 offset:520
s_waitcnt lgkmcnt(6)
global_store_dwordx4 v0, v[72:75], s[76:77] offset:0
s_waitcnt lgkmcnt(4)
global_store_dwordx4 v0, v[76:79], s[76:77] offset:2048
s_waitcnt lgkmcnt(2)
ds_write_b128 v2, v[80:83] offset:12288
s_waitcnt vmcnt(10) lgkmcnt(1)
s_barrier
s_add_u32 m0, s29, 0
s_add_u32 s26, s83, 0
buffer_load_dwordx4 v32, s[96:99], s26 offen offset:0 lds
buffer_load_dwordx4 v33, s[96:99], s26 offen offset:1024 lds
buffer_load_dwordx4 v34, s[96:99], s26 offen offset:2048 lds
buffer_load_dwordx4 v35, s[96:99], s26 offen offset:3072 lds
ds_read_b64_tr_b16 v[72:73], v40 offset:16384
ds_read_b64_tr_b16 v[74:75], v40 offset:16896
ds_read_b64_tr_b16 v[76:77], v40 offset:16392
ds_read_b64_tr_b16 v[78:79], v40 offset:16904
ds_read_b64_tr_b16 v[80:81], v41 offset:16384
ds_read_b64_tr_b16 v[82:83], v41 offset:16896
ds_read_b64_tr_b16 a[132:133], v41 offset:16392
ds_read_b64_tr_b16 a[134:135], v41 offset:16904
s_waitcnt lgkmcnt(6)
global_store_dwordx4 v0, v[72:75], s[76:77] offset:1024
s_waitcnt lgkmcnt(4)
global_store_dwordx4 v0, v[76:79], s[76:77] offset:3072
s_waitcnt lgkmcnt(2)
ds_write_b128 v2, v[80:83] offset:13312
s_waitcnt vmcnt(12) lgkmcnt(1)
s_barrier
s_add_u32 m0, s29, 16384
s_add_u32 s26, s83, 262144
buffer_load_dwordx4 v32, s[96:99], s26 offen offset:0 lds
buffer_load_dwordx4 v33, s[96:99], s26 offen offset:1024 lds
buffer_load_dwordx4 v34, s[96:99], s26 offen offset:2048 lds
buffer_load_dwordx4 v35, s[96:99], s26 offen offset:3072 lds
ds_read_b64_tr_b16 a[32:33], v40 offset:32768
ds_read_b64_tr_b16 a[34:35], v40 offset:33280
ds_read_b64_tr_b16 a[40:41], v40 offset:32776
ds_read_b64_tr_b16 a[42:43], v40 offset:33288
ds_read_b64_tr_b16 a[136:137], v41 offset:32768
ds_read_b64_tr_b16 a[138:139], v41 offset:33280
ds_read_b64_tr_b16 v[72:73], v41 offset:32776
ds_read_b64_tr_b16 v[74:75], v41 offset:33288
s_waitcnt lgkmcnt(0)
ds_write_b128 v2, v[72:75] offset:14336
s_waitcnt vmcnt(12)
s_barrier
s_add_u32 m0, s29, 32768
s_add_u32 s26, s83, 2097152
buffer_load_dwordx4 v32, s[96:99], s26 offen offset:0 lds
buffer_load_dwordx4 v33, s[96:99], s26 offen offset:1024 lds
buffer_load_dwordx4 v34, s[96:99], s26 offen offset:2048 lds
buffer_load_dwordx4 v35, s[96:99], s26 offen offset:3072 lds
ds_read_b64_tr_b16 a[36:37], v40 offset:49152
ds_read_b64_tr_b16 a[38:39], v40 offset:49664
ds_read_b64_tr_b16 a[44:45], v40 offset:49160
ds_read_b64_tr_b16 a[46:47], v40 offset:49672
ds_read_b64_tr_b16 a[140:141], v41 offset:49152
ds_read_b64_tr_b16 a[142:143], v41 offset:49664
ds_read_b64_tr_b16 v[72:73], v41 offset:49160
ds_read_b64_tr_b16 v[74:75], v41 offset:49672
s_waitcnt lgkmcnt(0)
ds_write_b128 v2, v[72:75] offset:15360
s_waitcnt vmcnt(10)
s_barrier
s_add_u32 m0, s29, 49152
s_add_u32 s26, s83, 2359296
buffer_load_dwordx4 v32, s[96:99], s26 offen offset:0 lds
buffer_load_dwordx4 v33, s[96:99], s26 offen offset:1024 lds
buffer_load_dwordx4 v34, s[96:99], s26 offen offset:2048 lds
buffer_load_dwordx4 v35, s[96:99], s26 offen offset:3072 lds
ds_read_b64_tr_b16 a[144:145], v40 offset:0
ds_read_b64_tr_b16 a[146:147], v40 offset:512
ds_read_b64_tr_b16 a[152:153], v40 offset:8
ds_read_b64_tr_b16 a[154:155], v40 offset:520
ds_read_b64_tr_b16 a[160:161], v41 offset:0
ds_read_b64_tr_b16 a[162:163], v41 offset:512
ds_read_b64_tr_b16 a[168:169], v41 offset:8
ds_read_b64_tr_b16 a[170:171], v41 offset:520
s_waitcnt vmcnt(8) lgkmcnt(0)
s_barrier
s_add_u32 m0, s29, 0
s_add_u32 s26, s84, 0
buffer_load_dwordx4 v32, s[96:99], s26 offen offset:0 lds
buffer_load_dwordx4 v33, s[96:99], s26 offen offset:1024 lds
buffer_load_dwordx4 v34, s[96:99], s26 offen offset:2048 lds
buffer_load_dwordx4 v35, s[96:99], s26 offen offset:3072 lds
ds_read_b64_tr_b16 a[148:149], v40 offset:16384
ds_read_b64_tr_b16 a[150:151], v40 offset:16896
ds_read_b64_tr_b16 a[156:157], v40 offset:16392
ds_read_b64_tr_b16 a[158:159], v40 offset:16904
ds_read_b64_tr_b16 a[164:165], v41 offset:16384
ds_read_b64_tr_b16 a[166:167], v41 offset:16896
ds_read_b64_tr_b16 a[172:173], v41 offset:16392
ds_read_b64_tr_b16 a[174:175], v41 offset:16904
s_waitcnt vmcnt(8) lgkmcnt(0)
s_barrier
s_add_u32 m0, s29, 16384
s_add_u32 s26, s84, 262144
buffer_load_dwordx4 v32, s[96:99], s26 offen offset:0 lds
buffer_load_dwordx4 v33, s[96:99], s26 offen offset:1024 lds
buffer_load_dwordx4 v34, s[96:99], s26 offen offset:2048 lds
buffer_load_dwordx4 v35, s[96:99], s26 offen offset:3072 lds
ds_read_b64_tr_b16 v[72:73], v40 offset:32768
ds_read_b64_tr_b16 v[74:75], v40 offset:33280
ds_read_b64_tr_b16 v[76:77], v40 offset:32776
ds_read_b64_tr_b16 v[78:79], v40 offset:33288
ds_read_b64_tr_b16 a[176:177], v41 offset:32768
ds_read_b64_tr_b16 a[178:179], v41 offset:33280
ds_read_b64_tr_b16 v[80:81], v41 offset:32776
ds_read_b64_tr_b16 v[82:83], v41 offset:33288
s_waitcnt lgkmcnt(6)
global_store_dwordx4 v0, v[72:75], s[78:79] offset:0
s_waitcnt lgkmcnt(4)
ds_write_b128 v2, v[76:79] offset:16384
s_waitcnt lgkmcnt(1)
ds_write_b128 v2, v[80:83] offset:18432
s_waitcnt vmcnt(9)
s_barrier
s_mov_b64 s[96:97], s[72:73]
s_add_u32 m0, s29, 32768
s_add_u32 s26, s82, 0
buffer_load_dwordx4 v32, s[96:99], s26 offen offset:0 lds
buffer_load_dwordx4 v33, s[96:99], s26 offen offset:1024 lds
buffer_load_dwordx4 v34, s[96:99], s26 offen offset:2048 lds
buffer_load_dwordx4 v35, s[96:99], s26 offen offset:3072 lds
ds_read_b64_tr_b16 v[72:73], v40 offset:49152
ds_read_b64_tr_b16 v[74:75], v40 offset:49664
ds_read_b64_tr_b16 v[76:77], v40 offset:49160
ds_read_b64_tr_b16 v[78:79], v40 offset:49672
ds_read_b64_tr_b16 a[180:181], v41 offset:49152
ds_read_b64_tr_b16 a[182:183], v41 offset:49664
ds_read_b64_tr_b16 v[80:81], v41 offset:49160
ds_read_b64_tr_b16 v[82:83], v41 offset:49672
s_waitcnt lgkmcnt(6)
global_store_dwordx4 v0, v[72:75], s[78:79] offset:1024
s_waitcnt lgkmcnt(4)
ds_write_b128 v2, v[76:79] offset:17408
s_waitcnt lgkmcnt(1)
ds_write_b128 v2, v[80:83] offset:19456
s_waitcnt vmcnt(10)
s_barrier
s_add_u32 m0, s29, 49152
s_add_u32 s26, s82, 262144
buffer_load_dwordx4 v32, s[96:99], s26 offen offset:0 lds
buffer_load_dwordx4 v33, s[96:99], s26 offen offset:1024 lds
buffer_load_dwordx4 v34, s[96:99], s26 offen offset:2048 lds
buffer_load_dwordx4 v35, s[96:99], s26 offen offset:3072 lds
ds_read_b64_tr_b16 a[184:185], v40 offset:0
ds_read_b64_tr_b16 a[186:187], v40 offset:512
ds_read_b64_tr_b16 a[192:193], v40 offset:8
ds_read_b64_tr_b16 a[194:195], v40 offset:520
ds_read_b64_tr_b16 a[200:201], v41 offset:0
ds_read_b64_tr_b16 a[202:203], v41 offset:512
ds_read_b64_tr_b16 a[208:209], v41 offset:8
ds_read_b64_tr_b16 a[210:211], v41 offset:520
s_waitcnt vmcnt(10) lgkmcnt(0)
s_barrier
s_add_u32 m0, s29, 0
s_add_u32 s26, s82, 2097152
buffer_load_dwordx4 v32, s[96:99], s26 offen offset:0 lds
buffer_load_dwordx4 v33, s[96:99], s26 offen offset:1024 lds
buffer_load_dwordx4 v34, s[96:99], s26 offen offset:2048 lds
buffer_load_dwordx4 v35, s[96:99], s26 offen offset:3072 lds
ds_read_b64_tr_b16 a[188:189], v40 offset:16384
ds_read_b64_tr_b16 a[190:191], v40 offset:16896
ds_read_b64_tr_b16 a[196:197], v40 offset:16392
ds_read_b64_tr_b16 a[198:199], v40 offset:16904
ds_read_b64_tr_b16 a[204:205], v41 offset:16384
ds_read_b64_tr_b16 a[206:207], v41 offset:16896
ds_read_b64_tr_b16 a[212:213], v41 offset:16392
ds_read_b64_tr_b16 a[214:215], v41 offset:16904
s_waitcnt vmcnt(9) lgkmcnt(0)
s_barrier
s_add_u32 m0, s29, 16384
s_add_u32 s26, s82, 2359296
buffer_load_dwordx4 v32, s[96:99], s26 offen offset:0 lds
buffer_load_dwordx4 v33, s[96:99], s26 offen offset:1024 lds
buffer_load_dwordx4 v34, s[96:99], s26 offen offset:2048 lds
buffer_load_dwordx4 v35, s[96:99], s26 offen offset:3072 lds
ds_read_b64_tr_b16 a[0:1], v40 offset:32768
ds_read_b64_tr_b16 a[2:3], v40 offset:33280
ds_read_b64_tr_b16 a[8:9], v40 offset:32776
ds_read_b64_tr_b16 a[10:11], v40 offset:33288
ds_read_b64_tr_b16 a[240:241], v41 offset:32768
ds_read_b64_tr_b16 a[242:243], v41 offset:33280
ds_read_b64_tr_b16 a[248:249], v41 offset:32776
ds_read_b64_tr_b16 a[250:251], v41 offset:33288
s_waitcnt vmcnt(8) lgkmcnt(0)
s_barrier
s_add_u32 m0, s29, 32768
s_add_u32 s26, s83, 0
buffer_load_dwordx4 v32, s[96:99], s26 offen offset:0 lds
buffer_load_dwordx4 v33, s[96:99], s26 offen offset:1024 lds
buffer_load_dwordx4 v34, s[96:99], s26 offen offset:2048 lds
buffer_load_dwordx4 v35, s[96:99], s26 offen offset:3072 lds
ds_read_b64_tr_b16 a[4:5], v40 offset:49152
ds_read_b64_tr_b16 a[6:7], v40 offset:49664
ds_read_b64_tr_b16 a[12:13], v40 offset:49160
ds_read_b64_tr_b16 a[14:15], v40 offset:49672
ds_read_b64_tr_b16 a[244:245], v41 offset:49152
ds_read_b64_tr_b16 a[246:247], v41 offset:49664
ds_read_b64_tr_b16 a[252:253], v41 offset:49160
ds_read_b64_tr_b16 a[254:255], v41 offset:49672
s_waitcnt vmcnt(8) lgkmcnt(0)
s_barrier
s_add_u32 m0, s29, 49152
s_add_u32 s26, s83, 262144
buffer_load_dwordx4 v32, s[96:99], s26 offen offset:0 lds
buffer_load_dwordx4 v33, s[96:99], s26 offen offset:1024 lds
buffer_load_dwordx4 v34, s[96:99], s26 offen offset:2048 lds
buffer_load_dwordx4 v35, s[96:99], s26 offen offset:3072 lds
ds_read_b64_tr_b16 v[72:73], v40 offset:0
ds_read_b64_tr_b16 v[74:75], v40 offset:512
ds_read_b64_tr_b16 v[76:77], v40 offset:8
ds_read_b64_tr_b16 v[78:79], v40 offset:520
ds_read_b64_tr_b16 v[80:81], v41 offset:0
ds_read_b64_tr_b16 v[82:83], v41 offset:512
ds_read_b64_tr_b16 v[88:89], v41 offset:8
ds_read_b64_tr_b16 v[90:91], v41 offset:520
s_waitcnt lgkmcnt(6)
ds_write_b128 v2, v[72:75] offset:0
s_waitcnt lgkmcnt(5)
ds_write_b128 v2, v[76:79] offset:2048
s_waitcnt lgkmcnt(4)
global_store_dwordx4 v0, v[80:83], s[78:79] offset:2048
s_waitcnt vmcnt(9) lgkmcnt(2)
s_barrier
s_add_u32 m0, s29, 0
s_add_u32 s26, s83, 2097152
buffer_load_dwordx4 v32, s[96:99], s26 offen offset:0 lds
buffer_load_dwordx4 v33, s[96:99], s26 offen offset:1024 lds
buffer_load_dwordx4 v34, s[96:99], s26 offen offset:2048 lds
buffer_load_dwordx4 v35, s[96:99], s26 offen offset:3072 lds
ds_read_b64_tr_b16 v[72:73], v40 offset:16384
ds_read_b64_tr_b16 v[74:75], v40 offset:16896
ds_read_b64_tr_b16 v[76:77], v40 offset:16392
ds_read_b64_tr_b16 v[78:79], v40 offset:16904
ds_read_b64_tr_b16 v[80:81], v41 offset:16384
ds_read_b64_tr_b16 v[82:83], v41 offset:16896
ds_read_b64_tr_b16 v[92:93], v41 offset:16392
ds_read_b64_tr_b16 v[94:95], v41 offset:16904
s_waitcnt lgkmcnt(6)
ds_write_b128 v2, v[72:75] offset:1024
s_waitcnt lgkmcnt(5)
ds_write_b128 v2, v[76:79] offset:3072
s_waitcnt lgkmcnt(4)
global_store_dwordx4 v0, v[80:83], s[78:79] offset:3072
s_waitcnt vmcnt(10) lgkmcnt(2)
s_barrier
s_add_u32 m0, s29, 16384
s_add_u32 s26, s83, 2359296
buffer_load_dwordx4 v32, s[96:99], s26 offen offset:0 lds
buffer_load_dwordx4 v33, s[96:99], s26 offen offset:1024 lds
buffer_load_dwordx4 v34, s[96:99], s26 offen offset:2048 lds
buffer_load_dwordx4 v35, s[96:99], s26 offen offset:3072 lds
ds_read_b64_tr_b16 v[96:97], v40 offset:32768
ds_read_b64_tr_b16 v[98:99], v40 offset:33280
ds_read_b64_tr_b16 v[104:105], v40 offset:32776
ds_read_b64_tr_b16 v[106:107], v40 offset:33288
ds_read_b64_tr_b16 v[128:129], v41 offset:32768
ds_read_b64_tr_b16 v[130:131], v41 offset:33280
ds_read_b64_tr_b16 v[136:137], v41 offset:32776
ds_read_b64_tr_b16 v[138:139], v41 offset:33288
s_waitcnt vmcnt(10) lgkmcnt(0)
s_barrier
s_add_u32 m0, s29, 32768
s_add_u32 s26, s84, 0
buffer_load_dwordx4 v32, s[96:99], s26 offen offset:0 lds
buffer_load_dwordx4 v33, s[96:99], s26 offen offset:1024 lds
buffer_load_dwordx4 v34, s[96:99], s26 offen offset:2048 lds
buffer_load_dwordx4 v35, s[96:99], s26 offen offset:3072 lds
ds_read_b64_tr_b16 v[100:101], v40 offset:49152
ds_read_b64_tr_b16 v[102:103], v40 offset:49664
ds_read_b64_tr_b16 v[108:109], v40 offset:49160
ds_read_b64_tr_b16 v[110:111], v40 offset:49672
ds_read_b64_tr_b16 v[132:133], v41 offset:49152
ds_read_b64_tr_b16 v[134:135], v41 offset:49664
ds_read_b64_tr_b16 v[140:141], v41 offset:49160
ds_read_b64_tr_b16 v[142:143], v41 offset:49672
s_waitcnt vmcnt(9) lgkmcnt(0)
s_barrier
s_add_u32 m0, s29, 49152
s_add_u32 s26, s84, 262144
buffer_load_dwordx4 v32, s[96:99], s26 offen offset:0 lds
buffer_load_dwordx4 v33, s[96:99], s26 offen offset:1024 lds
buffer_load_dwordx4 v34, s[96:99], s26 offen offset:2048 lds
buffer_load_dwordx4 v35, s[96:99], s26 offen offset:3072 lds
ds_read_b64_tr_b16 v[112:113], v40 offset:0
ds_read_b64_tr_b16 v[114:115], v40 offset:512
ds_read_b64_tr_b16 v[120:121], v40 offset:8
ds_read_b64_tr_b16 v[122:123], v40 offset:520
ds_read_b64_tr_b16 v[72:73], v41 offset:0
ds_read_b64_tr_b16 v[74:75], v41 offset:512
ds_read_b64_tr_b16 v[144:145], v41 offset:8
ds_read_b64_tr_b16 v[146:147], v41 offset:520
s_waitcnt lgkmcnt(2)
global_store_dwordx4 v0, v[72:75], s[80:81] offset:-4096
s_waitcnt vmcnt(9) lgkmcnt(0)
s_barrier
s_mov_b64 s[96:97], s[68:69]
s_add_u32 m0, s29, 0
s_add_u32 s26, s82, 0
buffer_load_dwordx4 v32, s[96:99], s26 offen offset:0 lds
buffer_load_dwordx4 v33, s[96:99], s26 offen offset:1024 lds
buffer_load_dwordx4 v34, s[96:99], s26 offen offset:2048 lds
buffer_load_dwordx4 v35, s[96:99], s26 offen offset:3072 lds
ds_read_b64_tr_b16 v[116:117], v40 offset:16384
ds_read_b64_tr_b16 v[118:119], v40 offset:16896
ds_read_b64_tr_b16 v[124:125], v40 offset:16392
ds_read_b64_tr_b16 v[126:127], v40 offset:16904
ds_read_b64_tr_b16 v[72:73], v41 offset:16384
ds_read_b64_tr_b16 v[74:75], v41 offset:16896
ds_read_b64_tr_b16 v[148:149], v41 offset:16392
ds_read_b64_tr_b16 v[150:151], v41 offset:16904
s_waitcnt lgkmcnt(2)
global_store_dwordx4 v0, v[72:75], s[80:81] offset:-3072
s_waitcnt vmcnt(10) lgkmcnt(0)
s_barrier
s_add_u32 m0, s29, 16384
s_add_u32 s26, s82, 262144
buffer_load_dwordx4 v32, s[96:99], s26 offen offset:0 lds
buffer_load_dwordx4 v33, s[96:99], s26 offen offset:1024 lds
buffer_load_dwordx4 v34, s[96:99], s26 offen offset:2048 lds
buffer_load_dwordx4 v35, s[96:99], s26 offen offset:3072 lds
ds_read_b64_tr_b16 a[216:217], v40 offset:32768
ds_read_b64_tr_b16 a[218:219], v40 offset:33280
ds_read_b64_tr_b16 a[224:225], v40 offset:32776
ds_read_b64_tr_b16 a[226:227], v40 offset:33288
ds_read_b64_tr_b16 a[232:233], v41 offset:32768
ds_read_b64_tr_b16 a[234:235], v41 offset:33280
ds_read_b64_tr_b16 v[72:73], v41 offset:32776
ds_read_b64_tr_b16 v[74:75], v41 offset:33288
s_waitcnt lgkmcnt(0)
ds_write_b128 v2, v[72:75] offset:20480
s_waitcnt vmcnt(10)
s_barrier
s_add_u32 m0, s29, 32768
s_add_u32 s26, s82, 2097152
buffer_load_dwordx4 v32, s[96:99], s26 offen offset:0 lds
buffer_load_dwordx4 v33, s[96:99], s26 offen offset:1024 lds
buffer_load_dwordx4 v34, s[96:99], s26 offen offset:2048 lds
buffer_load_dwordx4 v35, s[96:99], s26 offen offset:3072 lds
ds_read_b64_tr_b16 a[220:221], v40 offset:49152
ds_read_b64_tr_b16 a[222:223], v40 offset:49664
ds_read_b64_tr_b16 a[228:229], v40 offset:49160
ds_read_b64_tr_b16 a[230:231], v40 offset:49672
ds_read_b64_tr_b16 a[236:237], v41 offset:49152
ds_read_b64_tr_b16 a[238:239], v41 offset:49664
ds_read_b64_tr_b16 v[72:73], v41 offset:49160
ds_read_b64_tr_b16 v[74:75], v41 offset:49672
s_waitcnt lgkmcnt(0)
ds_write_b128 v2, v[72:75] offset:21504
s_waitcnt vmcnt(9)
s_barrier
s_add_u32 m0, s29, 49152
s_add_u32 s26, s82, 2359296
buffer_load_dwordx4 v32, s[96:99], s26 offen offset:0 lds
buffer_load_dwordx4 v33, s[96:99], s26 offen offset:1024 lds
buffer_load_dwordx4 v34, s[96:99], s26 offen offset:2048 lds
buffer_load_dwordx4 v35, s[96:99], s26 offen offset:3072 lds
ds_read_b64_tr_b16 v[72:73], v40 offset:0
ds_read_b64_tr_b16 v[74:75], v40 offset:512
ds_read_b64_tr_b16 v[76:77], v40 offset:8
ds_read_b64_tr_b16 v[78:79], v40 offset:520
ds_read_b64_tr_b16 a[48:49], v41 offset:0
ds_read_b64_tr_b16 a[50:51], v41 offset:512
ds_read_b64_tr_b16 v[80:81], v41 offset:8
ds_read_b64_tr_b16 v[82:83], v41 offset:520
s_waitcnt lgkmcnt(6)
global_store_dwordx4 v0, v[72:75], s[76:77] offset:-4096
s_waitcnt lgkmcnt(4)
global_store_dwordx4 v0, v[76:79], s[76:77] offset:-2048
s_waitcnt lgkmcnt(0)
global_store_dwordx4 v0, v[80:83], s[78:79] offset:-4096
s_waitcnt vmcnt(11)
s_barrier
s_add_u32 m0, s29, 0
s_add_u32 s26, s83, 0
buffer_load_dwordx4 v32, s[96:99], s26 offen offset:0 lds
buffer_load_dwordx4 v33, s[96:99], s26 offen offset:1024 lds
buffer_load_dwordx4 v34, s[96:99], s26 offen offset:2048 lds
buffer_load_dwordx4 v35, s[96:99], s26 offen offset:3072 lds
ds_read_b64_tr_b16 v[72:73], v40 offset:16384
ds_read_b64_tr_b16 v[74:75], v40 offset:16896
ds_read_b64_tr_b16 v[76:77], v40 offset:16392
ds_read_b64_tr_b16 v[78:79], v40 offset:16904
ds_read_b64_tr_b16 a[52:53], v41 offset:16384
ds_read_b64_tr_b16 a[54:55], v41 offset:16896
ds_read_b64_tr_b16 v[80:81], v41 offset:16392
ds_read_b64_tr_b16 v[82:83], v41 offset:16904
s_waitcnt lgkmcnt(6)
global_store_dwordx4 v0, v[72:75], s[76:77] offset:-3072
s_waitcnt lgkmcnt(4)
global_store_dwordx4 v0, v[76:79], s[76:77] offset:-1024
s_waitcnt lgkmcnt(0)
global_store_dwordx4 v0, v[80:83], s[78:79] offset:-3072
s_waitcnt vmcnt(14)
s_barrier
s_add_u32 m0, s29, 16384
s_add_u32 s26, s83, 262144
buffer_load_dwordx4 v32, s[96:99], s26 offen offset:0 lds
buffer_load_dwordx4 v33, s[96:99], s26 offen offset:1024 lds
buffer_load_dwordx4 v34, s[96:99], s26 offen offset:2048 lds
buffer_load_dwordx4 v35, s[96:99], s26 offen offset:3072 lds
ds_read_b64_tr_b16 a[16:17], v40 offset:32768
ds_read_b64_tr_b16 a[18:19], v40 offset:33280
ds_read_b64_tr_b16 a[24:25], v40 offset:32776
ds_read_b64_tr_b16 a[26:27], v40 offset:33288
ds_read_b64_tr_b16 a[56:57], v41 offset:32768
ds_read_b64_tr_b16 a[58:59], v41 offset:33280
ds_read_b64_tr_b16 a[64:65], v41 offset:32776
ds_read_b64_tr_b16 a[66:67], v41 offset:33288
s_waitcnt vmcnt(14) lgkmcnt(0)
s_barrier
s_add_u32 m0, s29, 32768
s_add_u32 s26, s83, 2097152
buffer_load_dwordx4 v32, s[96:99], s26 offen offset:0 lds
buffer_load_dwordx4 v33, s[96:99], s26 offen offset:1024 lds
buffer_load_dwordx4 v34, s[96:99], s26 offen offset:2048 lds
buffer_load_dwordx4 v35, s[96:99], s26 offen offset:3072 lds
ds_read_b64_tr_b16 a[20:21], v40 offset:49152
ds_read_b64_tr_b16 a[22:23], v40 offset:49664
ds_read_b64_tr_b16 a[28:29], v40 offset:49160
ds_read_b64_tr_b16 a[30:31], v40 offset:49672
ds_read_b64_tr_b16 a[60:61], v41 offset:49152
ds_read_b64_tr_b16 a[62:63], v41 offset:49664
ds_read_b64_tr_b16 a[68:69], v41 offset:49160
ds_read_b64_tr_b16 a[70:71], v41 offset:49672
s_waitcnt vmcnt(11) lgkmcnt(0)
s_barrier
s_add_u32 m0, s29, 49152
s_add_u32 s26, s83, 2359296
buffer_load_dwordx4 v32, s[96:99], s26 offen offset:0 lds
buffer_load_dwordx4 v33, s[96:99], s26 offen offset:1024 lds
buffer_load_dwordx4 v34, s[96:99], s26 offen offset:2048 lds
buffer_load_dwordx4 v35, s[96:99], s26 offen offset:3072 lds
ds_read_b64_tr_b16 v[72:73], v40 offset:0
ds_read_b64_tr_b16 v[74:75], v40 offset:512
ds_read_b64_tr_b16 a[72:73], v40 offset:8
ds_read_b64_tr_b16 a[74:75], v40 offset:520
ds_read_b64_tr_b16 a[88:89], v41 offset:0
ds_read_b64_tr_b16 a[90:91], v41 offset:512
ds_read_b64_tr_b16 a[96:97], v41 offset:8
ds_read_b64_tr_b16 a[98:99], v41 offset:520
s_waitcnt lgkmcnt(6)
ds_write_b128 v2, v[72:75] offset:4096
s_waitcnt vmcnt(8) lgkmcnt(1)
s_barrier
s_add_u32 m0, s29, 0
s_add_u32 s26, s84, 0
buffer_load_dwordx4 v32, s[96:99], s26 offen offset:0 lds
buffer_load_dwordx4 v33, s[96:99], s26 offen offset:1024 lds
buffer_load_dwordx4 v34, s[96:99], s26 offen offset:2048 lds
buffer_load_dwordx4 v35, s[96:99], s26 offen offset:3072 lds
ds_read_b64_tr_b16 v[72:73], v40 offset:16384
ds_read_b64_tr_b16 v[74:75], v40 offset:16896
ds_read_b64_tr_b16 a[76:77], v40 offset:16392
ds_read_b64_tr_b16 a[78:79], v40 offset:16904
ds_read_b64_tr_b16 a[92:93], v41 offset:16384
ds_read_b64_tr_b16 a[94:95], v41 offset:16896
ds_read_b64_tr_b16 a[100:101], v41 offset:16392
ds_read_b64_tr_b16 a[102:103], v41 offset:16904
s_waitcnt lgkmcnt(6)
ds_write_b128 v2, v[72:75] offset:5120
s_waitcnt vmcnt(8) lgkmcnt(1)
s_barrier
s_add_u32 m0, s29, 16384
s_add_u32 s26, s84, 262144
buffer_load_dwordx4 v32, s[96:99], s26 offen offset:0 lds
buffer_load_dwordx4 v33, s[96:99], s26 offen offset:1024 lds
buffer_load_dwordx4 v34, s[96:99], s26 offen offset:2048 lds
buffer_load_dwordx4 v35, s[96:99], s26 offen offset:3072 lds
ds_read_b64_tr_b16 a[80:81], v40 offset:32768
ds_read_b64_tr_b16 a[82:83], v40 offset:33280
ds_read_b64_tr_b16 v[72:73], v40 offset:32776
ds_read_b64_tr_b16 v[74:75], v40 offset:33288
ds_read_b64_tr_b16 v[76:77], v41 offset:32768
ds_read_b64_tr_b16 v[78:79], v41 offset:33280
ds_read_b64_tr_b16 a[104:105], v41 offset:32776
ds_read_b64_tr_b16 a[106:107], v41 offset:33288
s_waitcnt lgkmcnt(4)
ds_write_b128 v2, v[72:75] offset:6144
s_waitcnt lgkmcnt(3)
ds_write_b128 v2, v[76:79] offset:8192
s_waitcnt vmcnt(8) lgkmcnt(2)
s_barrier
s_mov_b64 s[96:97], s[74:75]
s_add_u32 m0, s29, 32768
s_add_u32 s26, s85, 0
buffer_load_dwordx4 v36, s[96:99], s26 offen offset:0 lds
buffer_load_dwordx4 v37, s[96:99], s26 offen offset:1024 lds
buffer_load_dwordx4 v38, s[96:99], s26 offen offset:2048 lds
buffer_load_dwordx4 v39, s[96:99], s26 offen offset:3072 lds
ds_read_b64_tr_b16 a[84:85], v40 offset:49152
ds_read_b64_tr_b16 a[86:87], v40 offset:49664
ds_read_b64_tr_b16 v[72:73], v40 offset:49160
ds_read_b64_tr_b16 v[74:75], v40 offset:49672
ds_read_b64_tr_b16 v[76:77], v41 offset:49152
ds_read_b64_tr_b16 v[78:79], v41 offset:49664
ds_read_b64_tr_b16 a[108:109], v41 offset:49160
ds_read_b64_tr_b16 a[110:111], v41 offset:49672
s_waitcnt lgkmcnt(4)
ds_write_b128 v2, v[72:75] offset:7168
s_waitcnt lgkmcnt(3)
ds_write_b128 v2, v[76:79] offset:9216
s_waitcnt vmcnt(8) lgkmcnt(2)
s_barrier
s_add_u32 m0, s29, 49152
s_add_u32 s26, s86, 0
buffer_load_dwordx4 v36, s[96:99], s26 offen offset:0 lds
buffer_load_dwordx4 v37, s[96:99], s26 offen offset:1024 lds
buffer_load_dwordx4 v38, s[96:99], s26 offen offset:2048 lds
buffer_load_dwordx4 v39, s[96:99], s26 offen offset:3072 lds
ds_read_b64_tr_b16 a[112:113], v40 offset:0
ds_read_b64_tr_b16 a[114:115], v40 offset:512
ds_read_b64_tr_b16 v[72:73], v40 offset:8
ds_read_b64_tr_b16 v[74:75], v40 offset:520
ds_read_b64_tr_b16 v[76:77], v41 offset:0
ds_read_b64_tr_b16 v[78:79], v41 offset:512
ds_read_b64_tr_b16 a[120:121], v41 offset:8
ds_read_b64_tr_b16 a[122:123], v41 offset:520
s_waitcnt lgkmcnt(4)
ds_write_b128 v2, v[72:75] offset:10240
s_waitcnt lgkmcnt(3)
global_store_dwordx4 v0, v[76:79], s[78:79] offset:-2048
s_waitcnt vmcnt(9) lgkmcnt(1)
s_barrier
s_add_u32 m0, s29, 0
s_add_u32 s26, s85, 256
buffer_load_dwordx4 v36, s[96:99], s26 offen offset:0 lds
buffer_load_dwordx4 v37, s[96:99], s26 offen offset:1024 lds
buffer_load_dwordx4 v38, s[96:99], s26 offen offset:2048 lds
buffer_load_dwordx4 v39, s[96:99], s26 offen offset:3072 lds
ds_read_b64_tr_b16 a[116:117], v40 offset:16384
ds_read_b64_tr_b16 a[118:119], v40 offset:16896
ds_read_b64_tr_b16 v[72:73], v40 offset:16392
ds_read_b64_tr_b16 v[74:75], v40 offset:16904
ds_read_b64_tr_b16 v[76:77], v41 offset:16384
ds_read_b64_tr_b16 v[78:79], v41 offset:16896
ds_read_b64_tr_b16 a[124:125], v41 offset:16392
ds_read_b64_tr_b16 a[126:127], v41 offset:16904
s_waitcnt lgkmcnt(4)
ds_write_b128 v2, v[72:75] offset:11264
s_waitcnt lgkmcnt(3)
global_store_dwordx4 v0, v[76:79], s[78:79] offset:-1024
s_waitcnt vmcnt(10) lgkmcnt(1)
s_barrier
s_add_u32 m0, s29, 16384
s_add_u32 s26, s86, 256
buffer_load_dwordx4 v36, s[96:99], s26 offen offset:0 lds
buffer_load_dwordx4 v37, s[96:99], s26 offen offset:1024 lds
buffer_load_dwordx4 v38, s[96:99], s26 offen offset:2048 lds
buffer_load_dwordx4 v39, s[96:99], s26 offen offset:3072 lds
ds_read_b64_tr_b16 v[72:73], v42 offset:32768
ds_read_b64_tr_b16 v[74:75], v42 offset:33024
ds_read_b64_tr_b16 v[76:77], v42 offset:34816
ds_read_b64_tr_b16 v[78:79], v42 offset:35072
ds_read_b64_tr_b16 v[8:9], v43 offset:32768
ds_read_b64_tr_b16 v[10:11], v43 offset:33024
ds_read_b64_tr_b16 v[12:13], v43 offset:34816
ds_read_b64_tr_b16 v[14:15], v43 offset:35072
s_waitcnt lgkmcnt(6)
ds_write_b128 v2, v[72:75] offset:22528
s_waitcnt lgkmcnt(5)
ds_write_b128 v2, v[76:79] offset:23552
s_waitcnt vmcnt(10) lgkmcnt(2)
s_barrier
s_add_u32 m0, s29, 32768
s_add_u32 s26, s85, 512
buffer_load_dwordx4 v36, s[96:99], s26 offen offset:0 lds
buffer_load_dwordx4 v37, s[96:99], s26 offen offset:1024 lds
buffer_load_dwordx4 v38, s[96:99], s26 offen offset:2048 lds
buffer_load_dwordx4 v39, s[96:99], s26 offen offset:3072 lds
ds_read_b64_tr_b16 v[16:17], v42 offset:49152
ds_read_b64_tr_b16 v[18:19], v42 offset:49408
ds_read_b64_tr_b16 v[20:21], v42 offset:51200
ds_read_b64_tr_b16 v[22:23], v42 offset:51456
ds_read_b64_tr_b16 v[184:185], v43 offset:49152
ds_read_b64_tr_b16 v[186:187], v43 offset:49408
ds_read_b64_tr_b16 v[188:189], v43 offset:51200
ds_read_b64_tr_b16 v[190:191], v43 offset:51456
s_waitcnt vmcnt(9) lgkmcnt(0)
s_barrier
s_add_u32 m0, s29, 49152
s_add_u32 s26, s86, 512
buffer_load_dwordx4 v36, s[96:99], s26 offen offset:0 lds
buffer_load_dwordx4 v37, s[96:99], s26 offen offset:1024 lds
buffer_load_dwordx4 v38, s[96:99], s26 offen offset:2048 lds
buffer_load_dwordx4 v39, s[96:99], s26 offen offset:3072 lds
ds_read_b64_tr_b16 v[152:153], v42 offset:0
ds_read_b64_tr_b16 v[154:155], v42 offset:256
ds_read_b64_tr_b16 v[156:157], v42 offset:2048
ds_read_b64_tr_b16 v[158:159], v42 offset:2304
ds_read_b64_tr_b16 v[24:25], v43 offset:0
ds_read_b64_tr_b16 v[26:27], v43 offset:256
ds_read_b64_tr_b16 v[28:29], v43 offset:2048
ds_read_b64_tr_b16 v[30:31], v43 offset:2304
s_waitcnt vmcnt(8) lgkmcnt(0)
s_barrier
s_add_u32 m0, s29, 0
s_add_u32 s26, s85, 768
buffer_load_dwordx4 v36, s[96:99], s26 offen offset:0 lds
buffer_load_dwordx4 v37, s[96:99], s26 offen offset:1024 lds
buffer_load_dwordx4 v38, s[96:99], s26 offen offset:2048 lds
buffer_load_dwordx4 v39, s[96:99], s26 offen offset:3072 lds
ds_read_b64_tr_b16 v[192:193], v42 offset:16384
ds_read_b64_tr_b16 v[194:195], v42 offset:16640
ds_read_b64_tr_b16 v[196:197], v42 offset:18432
ds_read_b64_tr_b16 v[198:199], v42 offset:18688
ds_read_b64_tr_b16 v[200:201], v43 offset:16384
ds_read_b64_tr_b16 v[202:203], v43 offset:16640
ds_read_b64_tr_b16 v[204:205], v43 offset:18432
ds_read_b64_tr_b16 v[206:207], v43 offset:18688
s_waitcnt vmcnt(8) lgkmcnt(0)
s_barrier
s_add_u32 m0, s29, 16384
s_add_u32 s26, s86, 768
buffer_load_dwordx4 v36, s[96:99], s26 offen offset:0 lds
buffer_load_dwordx4 v37, s[96:99], s26 offen offset:1024 lds
buffer_load_dwordx4 v38, s[96:99], s26 offen offset:2048 lds
buffer_load_dwordx4 v39, s[96:99], s26 offen offset:3072 lds
ds_read_b64_tr_b16 v[160:161], v42 offset:32768
ds_read_b64_tr_b16 v[162:163], v42 offset:33024
ds_read_b64_tr_b16 v[164:165], v42 offset:34816
ds_read_b64_tr_b16 v[166:167], v42 offset:35072
ds_read_b64_tr_b16 v[48:49], v43 offset:32768
ds_read_b64_tr_b16 v[50:51], v43 offset:33024
ds_read_b64_tr_b16 v[52:53], v43 offset:34816
ds_read_b64_tr_b16 v[54:55], v43 offset:35072
s_waitcnt vmcnt(8) lgkmcnt(0)
s_barrier
s_add_u32 m0, s29, 32768
s_add_u32 s26, s85, 1024
buffer_load_dwordx4 v36, s[96:99], s26 offen offset:0 lds
buffer_load_dwordx4 v37, s[96:99], s26 offen offset:1024 lds
buffer_load_dwordx4 v38, s[96:99], s26 offen offset:2048 lds
buffer_load_dwordx4 v39, s[96:99], s26 offen offset:3072 lds
ds_read_b64_tr_b16 v[56:57], v42 offset:49152
ds_read_b64_tr_b16 v[58:59], v42 offset:49408
ds_read_b64_tr_b16 v[60:61], v42 offset:51200
ds_read_b64_tr_b16 v[62:63], v42 offset:51456
ds_read_b64_tr_b16 v[208:209], v43 offset:49152
ds_read_b64_tr_b16 v[210:211], v43 offset:49408
ds_read_b64_tr_b16 v[212:213], v43 offset:51200
ds_read_b64_tr_b16 v[214:215], v43 offset:51456
v_lshrrev_b32 v44, 4, v0
v_and_b32 v44, 15, v44
v_lshlrev_b32 v44, 4, v44
buffer_load_dword v45, v44, s[8:11], 0 offen sc1
s_waitcnt vmcnt(9) lgkmcnt(0)
s_barrier
s_add_u32 m0, s29, 49152
s_add_u32 s26, s86, 1024
buffer_load_dwordx4 v36, s[96:99], s26 offen offset:0 lds
buffer_load_dwordx4 v37, s[96:99], s26 offen offset:1024 lds
buffer_load_dwordx4 v38, s[96:99], s26 offen offset:2048 lds
buffer_load_dwordx4 v39, s[96:99], s26 offen offset:3072 lds
ds_read_b64_tr_b16 v[168:169], v42 offset:0
ds_read_b64_tr_b16 v[170:171], v42 offset:256
ds_read_b64_tr_b16 v[172:173], v42 offset:2048
ds_read_b64_tr_b16 v[174:175], v42 offset:2304
ds_read_b64_tr_b16 v[64:65], v43 offset:0
ds_read_b64_tr_b16 v[66:67], v43 offset:256
ds_read_b64_tr_b16 v[68:69], v43 offset:2048
ds_read_b64_tr_b16 v[70:71], v43 offset:2304
s_waitcnt vmcnt(9) lgkmcnt(0)
s_barrier
ds_read_b64_tr_b16 v[216:217], v42 offset:16384
ds_read_b64_tr_b16 v[218:219], v42 offset:16640
ds_read_b64_tr_b16 v[220:221], v42 offset:18432
ds_read_b64_tr_b16 v[222:223], v42 offset:18688
ds_read_b64_tr_b16 v[224:225], v43 offset:16384
ds_read_b64_tr_b16 v[226:227], v43 offset:16640
ds_read_b64_tr_b16 v[228:229], v43 offset:18432
ds_read_b64_tr_b16 v[230:231], v43 offset:18688
s_waitcnt vmcnt(5) lgkmcnt(0)
s_barrier
ds_read_b64_tr_b16 v[176:177], v42 offset:32768
ds_read_b64_tr_b16 v[178:179], v42 offset:33024
ds_read_b64_tr_b16 v[180:181], v42 offset:34816
ds_read_b64_tr_b16 v[182:183], v42 offset:35072
ds_read_b64_tr_b16 v[232:233], v43 offset:32768
ds_read_b64_tr_b16 v[234:235], v43 offset:33024
ds_read_b64_tr_b16 v[236:237], v43 offset:34816
ds_read_b64_tr_b16 v[238:239], v43 offset:35072
s_waitcnt vmcnt(0) lgkmcnt(0)
s_barrier
ds_read_b64_tr_b16 v[240:241], v42 offset:49152
ds_read_b64_tr_b16 v[242:243], v42 offset:49408
ds_read_b64_tr_b16 v[244:245], v42 offset:51200
ds_read_b64_tr_b16 v[246:247], v42 offset:51456
ds_read_b64_tr_b16 v[248:249], v43 offset:49152
ds_read_b64_tr_b16 v[250:251], v43 offset:49408
ds_read_b64_tr_b16 v[252:253], v43 offset:51200
ds_read_b64_tr_b16 v[254:255], v43 offset:51456
s_waitcnt lgkmcnt(0)
s_barrier
s_mul_i32 s26, s13, 12288
v_add_u32 v47, s26, v0
ds_write_b128 v47, v[8:11] offset:16384
ds_write_b128 v47, v[12:15] offset:17408
ds_write_b128 v47, v[16:19] offset:18432
ds_write_b128 v47, v[20:23] offset:19456
ds_write_b128 v47, v[24:27] offset:20480
ds_write_b128 v47, v[28:31] offset:21504
ds_write_b128 v47, v[48:51] offset:22528
ds_write_b128 v47, v[52:55] offset:23552
ds_write_b128 v47, v[56:59] offset:24576
ds_write_b128 v47, v[60:63] offset:25600
ds_write_b128 v47, v[64:67] offset:26624
ds_write_b128 v47, v[68:71] offset:27648
s_mov_b32 s30, 0
s_branch all_10067
all_10066:
buffer_load_dword v45, v44, s[8:11], 0 offen sc1
s_add_u32 s30, s30, 1
s_cmp_gt_u32 s30, 262144
s_cbranch_scc1 L_fail
all_10067:
s_waitcnt vmcnt(0)
v_add_u32_dpp v46, v45, v45 quad_perm:[1,0,3,2] row_mask:0xf bank_mask:0xf
s_nop 1
v_add_u32_dpp v46, v46, v46 quad_perm:[2,3,0,1] row_mask:0xf bank_mask:0xf
s_nop 1
v_add_u32_dpp v46, v46, v46 row_ror:4 row_mask:0xf bank_mask:0xf
s_nop 1
v_add_u32_dpp v46, v46, v46 row_ror:8 row_mask:0xf bank_mask:0xf
v_cmp_ne_u32 vcc, 306, v46
s_cbranch_vccnz all_10066
s_waitcnt vmcnt(0) lgkmcnt(0)
s_barrier
s_mov_b32 s18, 0
s_mov_b32 s36, 0
s_cmp_eq_u32 s13, 1
s_cbranch_scc1 wave_10069
s_cmp_eq_u32 s13, 2
s_cbranch_scc1 wave_10070
s_cmp_eq_u32 s13, 3
s_cbranch_scc1 wave_10071
wave_10068:
layer_10072:
s_lshl_b32 s17, s36, 6
s_mul_i32 s27, s36, 35651584
s_mul_i32 s28, s14, 16384
s_add_u32 s27, s27, s28
s_add_u32 s20, s27, 16777216
s_mul_i32 s27, s17, 10240
s_add_u32 s27, s27, s24
s_add_u32 s21, s27, s25
s_mov_b32 s19, 0
s_mov_b32 s33, s6
s_add_u32 s34, s17, 1
s_add_u32 s31, s17, 63
s_add_u32 s32, s17, 64
s_mov_b32 s27, s20
v_mov_b32 v7, 0
s_add_u32 s68, s4, 413696
s_addc_u32 s69, s5, 0
s_add_u32 s72, s4, 397312
s_addc_u32 s73, s5, 0
s_add_u32 s70, s4, 417792
s_addc_u32 s71, s5, 0
s_add_u32 s74, s4, 401408
s_addc_u32 s75, s5, 0
s_add_u32 s58, s4, s20
s_addc_u32 s59, s5, 0
global_load_dwordx4 v[64:67], v0, s[76:77] offset:-4096 sc1
global_load_dwordx4 v[68:71], v0, s[76:77] offset:-3072 sc1
global_load_dwordx4 v[72:75], v0, s[76:77] offset:-2048 sc1
global_load_dwordx4 v[76:79], v0, s[76:77] offset:-1024 sc1
global_load_dwordx4 v[80:83], v0, s[78:79] offset:-4096 sc1
global_load_dwordx4 v[84:87], v0, s[78:79] offset:-3072 sc1
global_load_dwordx4 v[48:51], v0, s[76:77] offset:2048 sc1
global_load_dwordx4 v[52:55], v0, s[76:77] offset:3072 sc1
global_load_dwordx4 v[56:59], v0, s[76:77] offset:0 sc1
global_load_dwordx4 v[60:63], v0, s[76:77] offset:1024 sc1
v_mov_b64 v[8:9], 0
v_mov_b64 v[10:11], 0
v_mov_b64 v[12:13], 0
v_mov_b64 v[14:15], 0
v_mov_b64 v[16:17], 0
v_mov_b64 v[18:19], 0
v_mov_b64 v[20:21], 0
v_mov_b64 v[22:23], 0
v_mov_b64 v[24:25], 0
v_mov_b64 v[26:27], 0
v_mov_b64 v[28:29], 0
v_mov_b64 v[30:31], 0
v_cmp_gt_u32 vcc, s34, v7
s_cmp_eq_u32 vcc_hi, 0
s_cbranch_scc1 kv_10083
s_mov_b32 s30, 0
kv_10082:
v_and_b32 v7, 128, v0
buffer_load_dword v7, v7, s[4:7], s22 offen sc1
s_add_u32 s30, s30, 1
s_cmp_gt_u32 s30, 262144
s_cbranch_scc1 L_fail
s_waitcnt vmcnt(0)
v_cmp_gt_u32 vcc, s34, v7
s_cbranch_vccnz kv_10082
kv_10083:
s_barrier
v_and_b32 v7, 511, v0
v_lshl_add_u32 v7, v7, 3, s27
global_load_dwordx4 v[32:35], v0, s[68:69] offset:-4096 sc1
global_load_dwordx4 v[36:39], v0, s[68:69] offset:0 sc1
global_load_dwordx4 v[40:43], v0, s[70:71] offset:0 sc1
s_mov_b32 s30, 0
s_waitcnt vmcnt(0)
.p2align 6
gather_10073:
s_waitcnt vmcnt(4)
rt_10078_b:
v_smfmac_f32_16x16x64_bf16 v[12:15], v[32:35], v[72:79], v1
ds_write_b128 v0, v[32:35] offset:0
v_smfmac_f32_16x16x64_bf16 v[8:11], v[32:35], v[64:71], v1
v_bitop3_b32 v44, v32, v34, s18 bitop3:0x7e
v_smfmac_f32_16x16x64_bf16 v[20:23], v[32:35], v[48:55], v1
s_waitcnt vmcnt(3)
ds_write_b128 v0, v[36:39] offset:4096
v_bitop3_b32 v45, v36, v38, s18 bitop3:0x7e
v_or_b32 v44, v44, v45
s_waitcnt vmcnt(2)
v_bitop3_b32 v45, v40, v42, s18 bitop3:0x7e
v_smfmac_f32_16x16x64_bf16 v[16:19], v[32:35], v[56:63], v1
ds_write_b128 v0, v[40:43] offset:8192
v_bitop3_b32 v44, v44, v45, s19 bitop3:0xa8
v_cmp_ne_u32 vcc, 0, v44
v_smfmac_f32_16x16x64_bf16 v[28:31], v[32:35], a[8:15], v1
s_cbranch_vccnz rt_10078
ds_read_b128 v[52:55], v2 offset:3072
v_smfmac_f32_16x16x64_bf16 v[8:11], v[36:39], a[16:23], v1
s_waitcnt lgkmcnt(2)
ds_read_b128 v[60:63], v2 offset:1024
global_load_dwordx4 v[64:67], v0, s[78:79] offset:-2048 sc1
ds_read_b128 v[56:59], v2 offset:0
v_smfmac_f32_16x16x64_bf16 v[24:27], v[32:35], a[0:7], v1
s_waitcnt lgkmcnt(3)
ds_read_b128 v[48:51], v2 offset:2048
s_barrier
ds_read_b128 v[40:43], v0 offset:1024
v_smfmac_f32_16x16x64_bf16 v[20:23], v[36:39], a[40:47], v1
s_mov_b64 s[68:69], s[72:73]
ds_read_b128 v[44:47], v0 offset:5120
global_load_dwordx4 v[68:71], v0, s[78:79] offset:-1024 sc1
v_smfmac_f32_16x16x64_bf16 v[16:19], v[36:39], a[32:39], v1
s_xor_b32 s18, s18, 1
ds_read_b128 v[32:35], v0 offset:2048
s_waitcnt lgkmcnt(4)
v_smfmac_f32_16x16x64_bf16 v[24:27], v[36:39], v[56:63], v1
ds_read_b128 v[56:59], v2 offset:4096
v_smfmac_f32_16x16x64_bf16 v[12:15], v[36:39], a[24:31], v1
ds_read_b128 v[60:63], v2 offset:5120
s_waitcnt lgkmcnt(4)
s_waitcnt vmcnt(2)
v_smfmac_f32_16x16x64_bf16 v[12:15], v[40:43], v[80:87], v1
ds_read_b128 v[84:87], v2 offset:7168
s_waitcnt lgkmcnt(4)
v_smfmac_f32_16x16x64_bf16 v[28:31], v[36:39], v[48:55], v1
ds_read_b128 v[80:83], v2 offset:6144
global_load_dwordx4 v[72:75], v0, s[78:79] offset:0 sc1
v_smfmac_f32_16x16x64_bf16 v[8:11], v[40:43], a[48:55], v1
ds_read_b128 v[36:39], v0 offset:6144
global_load_dwordx4 v[76:79], v0, s[78:79] offset:1024 sc1
v_smfmac_f32_16x16x64_bf16 v[12:15], v[44:47], a[64:71], v1
ds_read_b128 v[40:43], v0 offset:3072
s_waitcnt lgkmcnt(5)
v_smfmac_f32_16x16x64_bf16 v[8:11], v[44:47], a[56:63], v1
ds_read_b128 v[44:47], v0 offset:7168
s_waitcnt lgkmcnt(5)
v_smfmac_f32_16x16x64_bf16 v[8:11], v[32:35], v[56:63], v1
s_waitcnt lgkmcnt(3)
ds_read_b128 v[60:63], v2 offset:9216
v_smfmac_f32_16x16x64_bf16 v[12:15], v[32:35], a[72:79], v1
s_waitcnt lgkmcnt(3)
ds_read_b128 v[56:59], v2 offset:8192
v_smfmac_f32_16x16x64_bf16 v[12:15], v[36:39], v[80:87], v1
ds_read_b128 v[32:35], v0 offset:8192
v_smfmac_f32_16x16x64_bf16 v[8:11], v[36:39], a[80:87], v1
s_waitcnt lgkmcnt(4)
ds_read_b128 v[80:83], v2 offset:10240
global_load_dwordx4 v[48:51], v0, s[58:59] offset:0 nt sc1
ds_read_b128 v[84:87], v2 offset:11264
v_smfmac_f32_16x16x64_bf16 v[8:11], v[40:43], a[88:95], v1
s_add_u32 s20, s20, 524288
s_waitcnt lgkmcnt(5)
ds_read_b128 v[36:39], v0 offset:9216
v_smfmac_f32_16x16x64_bf16 v[12:15], v[40:43], a[96:103], v1
s_waitcnt lgkmcnt(4)
ds_read_b128 v[40:43], v0 offset:1024
v_smfmac_f32_16x16x64_bf16 v[8:11], v[44:47], v[56:63], v1
global_load_dwordx4 v[52:55], v0, s[58:59] offset:1024 nt sc1
ds_read_b128 v[60:63], v2 offset:13312
v_smfmac_f32_16x16x64_bf16 v[12:15], v[44:47], a[104:111], v1
s_waitcnt lgkmcnt(4)
ds_read_b128 v[56:59], v2 offset:12288
s_waitcnt lgkmcnt(4)
v_smfmac_f32_16x16x64_bf16 v[12:15], v[32:35], v[80:87], v1
s_waitcnt vmcnt(4)
ds_read_b128 v[80:83], v2 offset:14336
s_mov_b64 vcc, s[42:43]
v_smfmac_f32_16x16x64_bf16 v[8:11], v[32:35], a[112:119], v1
s_waitcnt lgkmcnt(4)
ds_read_b128 v[84:87], v2 offset:15360
v_smfmac_f32_16x16x64_bf16 v[8:11], v[36:39], v[64:71], v1
s_nop 0
ds_read_b128 v[32:35], v0 offset:5120
global_load_dwordx4 v[64:67], v0, s[78:79] offset:2048 sc1
v_smfmac_f32_16x16x64_bf16 v[12:15], v[36:39], a[120:127], v1
s_nop 0
ds_read_b128 v[36:39], v0 offset:2048
s_waitcnt lgkmcnt(4)
s_nop 0
v_add_f32 v8, v8, v10
v_smfmac_f32_16x16x64_bf16 v[16:19], v[40:43], v[56:63], v1
ds_read_b128 v[60:63], v2 offset:17408
global_load_dwordx4 v[68:71], v0, s[78:79] offset:3072 sc1
ds_read_b128 v[56:59], v2 offset:16384
v_mul_f32 v8, s35, v8
v_smfmac_f32_16x16x64_bf16 v[20:23], v[40:43], a[128:135], v1
s_waitcnt lgkmcnt(3)
ds_read_b128 v[40:43], v0 offset:6144
v_add_f32 v12, v12, v14
v_smfmac_f32_16x16x64_bf16 v[20:23], v[32:35], v[80:87], v1
s_waitcnt lgkmcnt(3)
ds_read_b128 v[80:83], v2 offset:18432
v_add_f32 v13, v13, v15
v_smfmac_f32_16x16x64_bf16 v[16:19], v[32:35], a[136:143], v1
ds_read_b128 v[32:35], v0 offset:3072
v_add_f32 v9, v9, v11
v_smfmac_f32_16x16x64_bf16 v[20:23], v[36:39], a[152:159], v1
s_waitcnt vmcnt(4)
ds_read_b128 v[84:87], v2 offset:19456
v_mul_f32 v13, s35, v13
v_mul_f32 v12, s35, v12
v_mul_f32 v9, s35, v9
v_cvt_pk_bf16_f32 v8, v8, v9
v_cvt_pk_bf16_f32 v12, v12, v13
v_smfmac_f32_16x16x64_bf16 v[16:19], v[36:39], a[144:151], v1
s_waitcnt lgkmcnt(3)
ds_read_b128 v[36:39], v0 offset:7168
ds_write2_b32 v3, v8, v12 offset0:0 offset1:128
v_smfmac_f32_16x16x64_bf16 v[16:19], v[40:43], v[72:79], v1
global_load_dwordx4 v[72:75], v0, s[80:81] offset:-4096 sc1
v_smfmac_f32_16x16x64_bf16 v[20:23], v[40:43], v[56:63], v1
s_waitcnt lgkmcnt(3)
global_load_dwordx4 v[76:79], v0, s[80:81] offset:-3072 sc1
v_smfmac_f32_16x16x64_bf16 v[20:23], v[32:35], a[168:175], v1
ds_read_b128 v[40:43], v0 offset:8192
global_load_dwordx4 v[56:59], v0, s[58:59] offset:2048 nt sc1
global_load_dwordx4 v[60:63], v0, s[58:59] offset:3072 nt sc1
v_smfmac_f32_16x16x64_bf16 v[16:19], v[32:35], a[160:167], v1
s_waitcnt lgkmcnt(1)
ds_read_b128 v[32:35], v0 offset:9216
v_smfmac_f32_16x16x64_bf16 v[16:19], v[36:39], a[176:183], v1
s_barrier
ds_read_b64_tr_b16 v[10:11], v4 offset:512
v_smfmac_f32_16x16x64_bf16 v[20:23], v[36:39], v[80:87], v1
s_waitcnt lgkmcnt(2)
ds_read_b128 v[36:39], v0 offset:8192
ds_read_b64_tr_b16 v[14:15], v4 offset:1536
v_smfmac_f32_16x16x64_bf16 v[20:23], v[40:43], a[192:199], v1
ds_read_b64_tr_b16 v[12:13], v4 offset:1024
s_waitcnt lgkmcnt(4)
ds_read_b64_tr_b16 v[8:9], v4 offset:0
v_smfmac_f32_16x16x64_bf16 v[16:19], v[40:43], a[184:191], v1
s_waitcnt vmcnt(5)
ds_read_b128 v[40:43], v0 offset:9216
v_smfmac_f32_16x16x64_bf16 v[16:19], v[32:35], a[200:207], v1
v_smfmac_f32_16x16x64_bf16 v[20:23], v[32:35], a[208:215], v1
s_waitcnt lgkmcnt(3)
ds_read_b128 v[80:83], v2 offset:20480
global_load_dword v7, v7, s[4:5] sc1
ds_read_b128 v[84:87], v2 offset:21504
v_smfmac_f32_16x16x64_bf16 v[24:27], v[36:39], a[216:223], v1
s_waitcnt lgkmcnt(3)
ds_read_b128 v[32:35], v0 offset:1024
v_add_f32 v16, v16, v18
v_mfma_f32_16x16x32_bf16 v[44:47], v[48:51], v[8:11], 0
v_bfe_u32 v48, v0, 5, 1
v_add_f32 v17, v17, v19
v_mfma_f32_16x16x32_bf16 v[44:47], v[52:55], v[12:15], v[44:47]
s_nop 0
v_lshl_add_u32 v48, v48, 3, v5
v_add_f32 v20, v20, v22
v_smfmac_f32_16x16x64_bf16 v[28:31], v[36:39], a[224:231], v1
s_waitcnt lgkmcnt(3)
ds_read_b128 v[36:39], v0 offset:5120
v_cvt_pk_bf16_f32 v16, v16, v17
v_add_f32 v21, v21, v23
v_cndmask_b32_dpp v44, v46, v44, vcc quad_perm:[0,1,0,1] row_mask:0xf bank_mask:0xf
v_cvt_pk_bf16_f32 v20, v20, v21
v_smfmac_f32_16x16x64_bf16 v[24:27], v[40:43], a[232:239], v1
s_waitcnt lgkmcnt(1)
ds_write2_b32 v3, v16, v20 offset0:1 offset1:129
v_cndmask_b32_dpp v45, v47, v45, vcc quad_perm:[0,1,0,1] row_mask:0xf bank_mask:0xf
v_smfmac_f32_16x16x64_bf16 v[28:31], v[40:43], v[80:87], v1
s_add_u32 s17, s17, 1
ds_write_b64 v48, v[44:45] offset:6144
v_smfmac_f32_16x16x64_bf16 v[24:27], v[32:35], a[240:247], v1
s_add_u32 s21, s21, 10240
ds_read_b128 v[40:43], v0 offset:2048
v_smfmac_f32_16x16x64_bf16 v[28:31], v[32:35], a[248:255], v1
s_waitcnt vmcnt(5)
ds_read_b128 v[32:35], v0 offset:6144
s_waitcnt lgkmcnt(4)
v_smfmac_f32_16x16x64_bf16 v[24:27], v[36:39], v[64:71], v1
ds_read_b128 v[80:83], v2 offset:22528
global_load_dwordx4 v[64:67], v0, s[76:77] offset:-4096 sc1
v_smfmac_f32_16x16x64_bf16 v[28:31], v[36:39], v[88:95], v1
s_waitcnt lgkmcnt(3)
ds_read_b128 v[36:39], v0 offset:3072
s_barrier
ds_read_b128 v[52:55], v6 offset:7168
s_waitcnt lgkmcnt(4)
v_smfmac_f32_16x16x64_bf16 v[28:31], v[40:43], v[104:111], v1
s_waitcnt lgkmcnt(3)
ds_read_b128 v[48:51], v6 offset:6144
v_smfmac_f32_16x16x64_bf16 v[24:27], v[40:43], v[96:103], v1
ds_read_b128 v[40:43], v0 offset:7168
ds_read_b64_tr_b16 v[16:17], v4 offset:2048
v_smfmac_f32_16x16x64_bf16 v[24:27], v[32:35], v[112:119], v1
ds_read_b64_tr_b16 v[18:19], v4 offset:2560
s_waitcnt lgkmcnt(5)
ds_read_b64_tr_b16 v[14:15], v4 offset:1536
v_smfmac_f32_16x16x64_bf16 v[28:31], v[32:35], v[120:127], v1
s_waitcnt vmcnt(2)
ds_read_b64_tr_b16 v[8:9], v4 offset:0
ds_read_b64_tr_b16 v[12:13], v4 offset:1024
v_smfmac_f32_16x16x64_bf16 v[28:31], v[36:39], v[136:143], v1
s_waitcnt lgkmcnt(6)
ds_read_b64_tr_b16 v[10:11], v4 offset:512
v_add_f32 v49, v49, v53
v_smfmac_f32_16x16x64_bf16 v[24:27], v[36:39], v[128:135], v1
s_waitcnt lgkmcnt(6)
ds_read_b64_tr_b16 v[20:21], v4 offset:3072
v_add_f32 v50, v50, v54
v_smfmac_f32_16x16x64_bf16 v[28:31], v[40:43], v[144:151], v1
ds_read_b64_tr_b16 v[22:23], v4 offset:3584
v_add_f32 v51, v51, v55
v_exp_f32 v51, v51
v_exp_f32 v49, v49
v_smfmac_f32_16x16x64_bf16 v[24:27], v[40:43], v[72:79], v1
s_waitcnt lgkmcnt(2)
ds_read_b128 v[84:87], v2 offset:23552
v_add_f32 v48, v48, v52
v_exp_f32 v48, v48
v_exp_f32 v50, v50
v_mfma_f32_16x16x32_bf16 v[44:47], v[8:11], v[8:11], 0
s_waitcnt lgkmcnt(1)
v_cvt_pk_bf16_f32 v55, v50, v51
v_cvt_pk_bf16_f32 v54, v48, v49
v_mfma_f32_16x16x32_bf16 v[44:47], v[12:15], v[12:15], v[44:47]
v_mov_b32_dpp v51, v55 quad_perm:[2,3,2,3] row_mask:0xf bank_mask:0xf
v_mov_b32_dpp v50, v54 quad_perm:[2,3,2,3] row_mask:0xf bank_mask:0xf
v_mfma_f32_16x16x32_bf16 v[44:47], v[16:19], v[16:19], v[44:47]
v_mov_b32_dpp v49, v55 quad_perm:[0,1,0,1] row_mask:0xf bank_mask:0xf
v_mov_b32_dpp v48, v54 quad_perm:[0,1,0,1] row_mask:0xf bank_mask:0xf
v_mfma_f32_16x16x32_bf16 v[44:47], v[20:23], v[20:23], v[44:47]
s_mov_b64 s[70:71], s[74:75]
v_mov_b64 v[20:21], s[44:45]
v_cvt_pk_bf16_f32 v24, v24, v25
v_mfma_f32_16x16x32_bf16 v[8:11], v[56:59], v[48:51], 0
s_add_u32 s34, s17, 2
v_mov_b64 v[22:23], s[44:45]
v_cvt_pk_bf16_f32 v25, v26, v27
v_mfma_f32_16x16x32_bf16 v[12:15], v[60:63], v[48:51], 0
v_exp_f32_dpp v44, v46 quad_perm:[0,1,0,1] row_mask:0xf bank_mask:0xf
v_exp_f32_dpp v45, v47 quad_perm:[0,1,0,1] row_mask:0xf bank_mask:0xf
v_mfma_f32_16x16x32_bf16 v[16:19], v[20:23], v[48:51], 0
s_waitcnt lgkmcnt(0)
v_cvt_pk_bf16_f32 v52, v44, v45
v_cvt_pk_bf16_f32 v53, v44, v45
v_mov_b64 v[54:55], s[46:47]
v_cvt_pk_bf16_f32 v27, v30, v31
v_mfma_f32_16x16x16_bf16 v[8:11], v[24:25], v[52:53], v[8:11]
s_mov_b32 s19, 1
global_load_dwordx4 v[68:71], v0, s[76:77] offset:-3072 sc1
v_cvt_pk_bf16_f32 v26, v28, v29
v_mfma_f32_16x16x16_bf16 v[16:19], v[54:55], v[52:53], v[16:19]
s_min_u32 s34, s34, s32
v_mov_b64 v[38:39], 0
v_mov_b64 v[36:37], 0
v_mfma_f32_16x16x16_bf16 v[12:15], v[26:27], v[52:53], v[12:15]
s_nop 0
ds_read_b128 v[28:31], v0 offset:19456
v_bfe_u32 v32, v0, 5, 1
v_mov_b64 v[34:35], 0
v_rcp_f32 v18, v16
v_subrev_u32 v17, s37, v16
v_cmp_lt_u32 vcc, s38, v17
v_lshl_add_u32 v32, v32, 3, v5
v_cndmask_b32 v9, v13, v9, s[42:43]
v_cndmask_b32 v8, v12, v8, s[42:43]
v_cndmask_b32 v10, v14, v10, s[42:43]
v_mul_f32 v10, v10, v18
v_mul_f32 v9, v9, v18
v_mul_f32 v8, v8, v18
v_cndmask_b32 v11, v15, v11, s[42:43]
v_mul_f32 v11, v11, v18
v_cvt_pk_bf16_f32 v13, v10, v11
v_cvt_pk_bf16_f32 v12, v8, v9
s_cbranch_vccnz rare_10074
back_10075:
ds_read_b128 v[16:19], v0 offset:16384
ds_write_b64 v32, v[12:13] offset:0
v_mov_b64 v[42:43], 0
v_mov_b64 v[32:33], 0
v_mov_b32_dpp v10, v12 quad_perm:[2,3,2,3] row_mask:0xf bank_mask:0xf
v_mov_b64 v[54:55], 0
v_mov_b32_dpp v8, v12 quad_perm:[0,1,0,1] row_mask:0xf bank_mask:0xf
v_mov_b32_dpp v11, v13 quad_perm:[2,3,2,3] row_mask:0xf bank_mask:0xf
v_mov_b32_dpp v9, v13 quad_perm:[0,1,0,1] row_mask:0xf bank_mask:0xf
v_mov_b64 v[52:53], 0
v_mov_b64 v[40:41], 0
v_smfmac_f32_16x16x64_bf16 v[36:39], v[8:11], v[80:87], v1
ds_read_b128 v[24:27], v0 offset:18432
global_load_dwordx4 v[72:75], v0, s[76:77] offset:-2048 sc1
ds_read_b128 v[20:23], v0 offset:17408
v_smfmac_f32_16x16x64_bf16 v[40:43], v[8:11], v[152:159], v1
s_waitcnt lgkmcnt(2)
ds_read_b128 v[80:83], v0 offset:20480
s_barrier
ds_read_b128 v[56:59], v5 offset:512
v_smfmac_f32_16x16x64_bf16 v[32:35], v[8:11], v[176:183], v1
s_add_u32 s27, s20, 524288
ds_read_b128 v[60:63], v5 offset:1024
v_mov_b64 v[48:49], 0
v_mov_b64 v[50:51], 0
v_smfmac_f32_16x16x64_bf16 v[52:55], v[8:11], v[168:175], v1
s_add_u32 s58, s4, s20
ds_read_b128 v[12:15], v5 offset:1536
v_lshrrev_b32 v44, 8, v0
v_smfmac_f32_16x16x64_bf16 v[48:51], v[8:11], v[160:167], v1
s_waitcnt lgkmcnt(4)
ds_read_b128 v[84:87], v0 offset:21504
global_load_dwordx4 v[76:79], v0, s[76:77] offset:-1024 sc1
v_bfe_u32 v45, v0, 1, 7
s_waitcnt lgkmcnt(3)
v_smfmac_f32_16x16x64_bf16 v[36:39], v[56:59], v[16:23], v1
s_addc_u32 s59, s5, 0
ds_read_b128 v[16:19], v0 offset:22528
s_waitcnt lgkmcnt(3)
v_smfmac_f32_16x16x64_bf16 v[36:39], v[60:63], v[24:31], v1
ds_read_b128 v[28:31], v0 offset:25600
s_waitcnt lgkmcnt(3)
v_smfmac_f32_16x16x64_bf16 v[36:39], v[12:15], v[184:191], v1
ds_read_b128 v[20:23], v0 offset:23552
s_waitcnt lgkmcnt(3)
v_smfmac_f32_16x16x64_bf16 v[40:43], v[56:59], v[80:87], v1
ds_read_b128 v[24:27], v0 offset:24576
v_lshl_or_b32 v44, v44, 12, v45
v_smfmac_f32_16x16x64_bf16 v[40:43], v[60:63], v[192:199], v1
s_nop 0
ds_read_b128 v[84:87], v0 offset:27648
v_cvt_pk_bf16_f32 v36, v36, v37
v_and_or_b32 v36, v36, -2, s18
v_cvt_pk_bf16_f32 v37, v38, v39
v_smfmac_f32_16x16x64_bf16 v[40:43], v[12:15], v[200:207], v1
global_store_dwordx2 v44, v[36:37], s[48:49]
s_waitcnt lgkmcnt(2)
v_smfmac_f32_16x16x64_bf16 v[48:51], v[56:59], v[16:23], v1
ds_read_b128 v[80:83], v0 offset:26624
s_waitcnt lgkmcnt(2)
v_smfmac_f32_16x16x64_bf16 v[48:51], v[60:63], v[24:31], v1
s_mov_b32 s30, 0
s_nop 0
v_cvt_pk_bf16_f32 v40, v40, v41
v_cvt_pk_bf16_f32 v41, v42, v43
v_and_or_b32 v40, v40, -2, s18
v_smfmac_f32_16x16x64_bf16 v[48:51], v[12:15], v[208:215], v1
global_store_dwordx2 v44, v[40:41], s[50:51]
s_waitcnt lgkmcnt(1)
v_smfmac_f32_16x16x64_bf16 v[32:35], v[56:59], v[232:239], v1
s_nop 0
s_waitcnt lgkmcnt(0)
v_smfmac_f32_16x16x64_bf16 v[52:55], v[56:59], v[80:87], v1
s_nop 1
v_cvt_pk_bf16_f32 v48, v48, v49
v_smfmac_f32_16x16x64_bf16 v[52:55], v[60:63], v[216:223], v1
v_and_or_b32 v48, v48, -2, s18
v_cvt_pk_bf16_f32 v49, v50, v51
v_smfmac_f32_16x16x64_bf16 v[52:55], v[12:15], v[224:231], v1
global_store_dwordx2 v44, v[48:49], s[52:53]
v_smfmac_f32_16x16x64_bf16 v[32:35], v[60:63], v[240:247], v1
s_nop 2
v_smfmac_f32_16x16x64_bf16 v[32:35], v[12:15], v[248:255], v1
s_nop 1
v_cvt_pk_bf16_f32 v52, v52, v53
v_and_or_b32 v52, v52, -2, s18
v_cvt_pk_bf16_f32 v53, v54, v55
s_nop 0
global_store_dwordx2 v44, v[52:53], s[54:55]
s_nop 0
v_cvt_pk_bf16_f32 v32, v32, v33
v_cvt_pk_bf16_f32 v33, v34, v35
v_and_or_b32 v32, v32, -2, s18
global_store_dwordx2 v44, v[32:33], s[56:57]
v_bfe_u32 v32, v0, 6, 1
v_lshlrev_b32 v32, 4, v32
v_mov_b32 v33, 0x3f80
v_lshlrev_b32 v32, v32, v33
v_bfe_i32 v33, v0, 4, 1
v_and_b32 v45, v32, v33
v_and_b32 v47, v32, v33
v_xor_b32 v44, v32, v45
v_xor_b32 v46, v32, v45
v_and_b32 v36, 32, v0
v_bfe_u32 v37, v0, 6, 1
v_lshl_add_u32 v36, v37, 8, v36
v_bfe_u32 v37, v0, 8, 1
v_lshl_add_u32 v36, v37, 4, v36
v_bfe_u32 v37, v0, 4, 1
v_lshl_add_u32 v36, v37, 3, v36
s_waitcnt vmcnt(9)
v_and_b32 v7, 511, v0
v_lshl_add_u32 v7, v7, 3, s27
s_nop 15
s_nop 15
s_nop 15
s_nop 8
global_load_dwordx4 v[8:11], v0, s[64:65] offset:0 sc1
global_load_dwordx4 v[12:15], v0, s[64:65] offset:1024 sc1
global_load_dwordx4 v[16:19], v0, s[64:65] offset:2048 sc1
global_load_dwordx4 v[20:23], v0, s[64:65] offset:3072 sc1
chk_10086:
v_mov_b64 v[40:41], 0
v_mov_b64 v[42:43], 0
s_waitcnt vmcnt(2)
s_nop 0
v_smfmac_f32_16x16x64_bf16 v[40:43], v[44:47], v[8:15], v1
v_bitop3_b32 v32, v8, v10, s18 bitop3:0x7e
v_bitop3_b32 v33, v12, v14, s18 bitop3:0x7e
s_waitcnt vmcnt(0)
v_smfmac_f32_16x16x64_bf16 v[40:43], v[44:47], v[16:23], v1
v_bitop3_b32 v34, v16, v18, s18 bitop3:0x7e
v_bitop3_b32 v35, v20, v22, s18 bitop3:0x7e
v_or3_b32 v37, v32, v33, v34
v_bitop3_b32 v37, v37, v35, 1 bitop3:0xa8
v_cmp_ne_u32 vcc, 0, v37
s_cbranch_vccnz chk_10086_f
s_nop 1
v_add_f32_dpp v40, v40, v40 row_ror:8 row_mask:0xf bank_mask:0xf
v_add_f32_dpp v41, v41, v41 row_ror:8 row_mask:0xf bank_mask:0xf
v_add_f32_dpp v42, v42, v42 row_ror:8 row_mask:0xf bank_mask:0xf
v_add_f32_dpp v43, v43, v43 row_ror:8 row_mask:0xf bank_mask:0xf
v_cvt_pk_bf16_f32 v40, v40, v41
v_cvt_pk_bf16_f32 v41, v42, v43
v_and_or_b32 v40, v40, -2, s18
s_mov_b64 exec, 0x00ff00ff
global_store_dwordx2 v36, v[40:41], s[66:67]
s_mov_b64 exec, -1
s_branch join_10085
chk_10086_f:
global_load_dwordx4 v[8:11], v0, s[64:65] offset:0 sc1
global_load_dwordx4 v[12:15], v0, s[64:65] offset:1024 sc1
global_load_dwordx4 v[16:19], v0, s[64:65] offset:2048 sc1
global_load_dwordx4 v[20:23], v0, s[64:65] offset:3072 sc1
s_add_u32 s30, s30, 1
s_cmp_le_u32 s30, 262144
s_cbranch_scc1 chk_10086
s_branch L_fail
nored_10084:
join_10085:
s_nop 11
s_barrier
global_load_dwordx4 v[56:59], v0, s[76:77] offset:0 sc1
global_load_dwordx4 v[60:63], v0, s[76:77] offset:1024 sc1
global_load_dwordx4 v[48:51], v0, s[76:77] offset:2048 sc1
global_load_dwordx4 v[52:55], v0, s[76:77] offset:3072 sc1
s_nop 15
s_nop 15
s_nop 3
s_barrier
global_load_dwordx4 v[32:35], v0, s[68:69] offset:-4096 sc1
s_nop 10
global_load_dwordx4 v[36:39], v0, s[68:69] offset:0 sc1
s_nop 10
global_load_dwordx4 v[40:43], v0, s[70:71] offset:0 sc1
s_barrier
global_load_dwordx4 v[80:83], v0, s[78:79] offset:-4096 sc1
global_load_dwordx4 v[84:87], v0, s[78:79] offset:-3072 sc1
v_mov_b64 v[8:9], 0
v_mov_b64 v[10:11], 0
v_mov_b64 v[12:13], 0
v_mov_b64 v[14:15], 0
v_mov_b64 v[16:17], 0
v_mov_b64 v[18:19], 0
v_mov_b64 v[20:21], 0
v_mov_b64 v[22:23], 0
v_mov_b64 v[24:25], 0
v_mov_b64 v[26:27], 0
v_mov_b64 v[28:29], 0
v_mov_b64 v[30:31], 0
s_mov_b32 s30, 0
s_cmp_eq_u32 s17, s31
s_cbranch_scc0 gather_10073
s_branch exit_10076
rt_10078:
global_load_dwordx4 v[32:35], v0, s[68:69] offset:-4096 sc1
global_load_dwordx4 v[36:39], v0, s[68:69] offset:0 sc1
global_load_dwordx4 v[40:43], v0, s[70:71] offset:0 sc1
s_add_u32 s30, s30, 1
s_cmp_gt_u32 s30, 262144
s_cbranch_scc1 L_fail
s_mov_b64 exec, 1
global_store_dword v0, v0, s[62:63]
global_store_dword v0, v0, s[62:63]
s_mov_b64 exec, -1
v_mov_b64 v[8:9], 0
v_mov_b64 v[10:11], 0
v_mov_b64 v[12:13], 0
v_mov_b64 v[14:15], 0
v_mov_b64 v[16:17], 0
v_mov_b64 v[18:19], 0
v_mov_b64 v[20:21], 0
v_mov_b64 v[22:23], 0
v_mov_b64 v[24:25], 0
v_mov_b64 v[26:27], 0
v_mov_b64 v[28:29], 0
v_mov_b64 v[30:31], 0
s_branch gather_10073
rare_10074:
ds_read_b128 v[48:51], v6 offset:6144
ds_read_b128 v[52:55], v6 offset:7168
s_waitcnt lgkmcnt(0)
v_add_f32 v48, v48, v52
v_add_f32 v49, v49, v53
v_add_f32 v50, v50, v54
v_add_f32 v51, v51, v55
v_mov_b32_dpp v46, v46 quad_perm:[0,1,0,1] row_mask:0xf bank_mask:0xf
v_mov_b32_dpp v47, v47 quad_perm:[0,1,0,1] row_mask:0xf bank_mask:0xf
v_max3_f32 v19, v48, v49, v50
v_max3_f32 v19, v19, v51, v46
v_max_f32 v19, v19, v47
s_nop 1
v_max_f32_dpp v19, v19, v19 quad_perm:[2,3,0,1] row_mask:0xf bank_mask:0xf
v_mov_b32 v44, v19
s_nop 1
v_permlane32_swap_b32 v19, v44
v_max_f32 v19, v19, v44
v_mov_b32 v44, v19
s_nop 1
v_permlane16_swap_b32 v19, v44
v_max_f32 v19, v19, v44
v_sub_f32 v48, v48, v19
v_sub_f32 v49, v49, v19
v_sub_f32 v50, v50, v19
v_sub_f32 v51, v51, v19
v_sub_f32 v46, v46, v19
v_sub_f32 v47, v47, v19
v_exp_f32 v48, v48
v_exp_f32 v49, v49
v_exp_f32 v50, v50
v_exp_f32 v51, v51
v_cvt_pk_bf16_f32 v54, v48, v49
v_cvt_pk_bf16_f32 v55, v50, v51
s_nop 0
v_mov_b32_dpp v48, v54 quad_perm:[0,1,0,1] row_mask:0xf bank_mask:0xf
v_mov_b32_dpp v49, v55 quad_perm:[0,1,0,1] row_mask:0xf bank_mask:0xf
v_mov_b32_dpp v50, v54 quad_perm:[2,3,2,3] row_mask:0xf bank_mask:0xf
v_mov_b32_dpp v51, v55 quad_perm:[2,3,2,3] row_mask:0xf bank_mask:0xf
v_mov_b64 v[20:21], s[44:45]
v_mov_b64 v[22:23], s[44:45]
v_mfma_f32_16x16x32_bf16 v[8:11], v[56:59], v[48:51], 0
v_mfma_f32_16x16x32_bf16 v[12:15], v[60:63], v[48:51], 0
v_mfma_f32_16x16x32_bf16 v[16:19], v[20:23], v[48:51], 0
v_mov_b64 v[54:55], s[46:47]
v_exp_f32_dpp v44, v46 quad_perm:[0,1,0,1] row_mask:0xf bank_mask:0xf
v_exp_f32_dpp v45, v47 quad_perm:[0,1,0,1] row_mask:0xf bank_mask:0xf
s_nop 0
v_cvt_pk_bf16_f32 v52, v44, v45
v_cvt_pk_bf16_f32 v53, v44, v45
s_nop 1
v_mfma_f32_16x16x16_bf16 v[16:19], v[54:55], v[52:53], v[16:19]
v_mfma_f32_16x16x16_bf16 v[8:11], v[24:25], v[52:53], v[8:11]
v_mfma_f32_16x16x16_bf16 v[12:15], v[26:27], v[52:53], v[12:15]
s_nop 5
v_rcp_f32 v18, v16
s_nop 0
v_cndmask_b32 v8, v12, v8, s[42:43]
v_mul_f32 v8, v8, v18
v_cndmask_b32 v9, v13, v9, s[42:43]
v_mul_f32 v9, v9, v18
v_cndmask_b32 v10, v14, v10, s[42:43]
v_mul_f32 v10, v10, v18
v_cndmask_b32 v11, v15, v11, s[42:43]
v_mul_f32 v11, v11, v18
v_cvt_pk_bf16_f32 v12, v8, v9
v_cvt_pk_bf16_f32 v13, v10, v11
s_branch back_10075
exit_10076:
global_load_dwordx4 v[32:35], v0, s[68:69] offset:-4096 sc1
global_load_dwordx4 v[36:39], v0, s[68:69] offset:0 sc1
global_load_dwordx4 v[40:43], v0, s[70:71] offset:0 sc1
s_add_u32 s30, s30, 1
s_cmp_gt_u32 s30, 262144
s_cbranch_scc1 L_fail
s_waitcnt vmcnt(2)
v_bitop3_b32 v44, v32, v34, s18 bitop3:0x7e
s_waitcnt vmcnt(1)
v_bitop3_b32 v45, v36, v38, s18 bitop3:0x7e
v_or_b32 v44, v44, v45
s_waitcnt vmcnt(0)
v_bitop3_b32 v46, v40, v42, s18 bitop3:0x7e
v_bitop3_b32 v44, v44, v46, s19 bitop3:0xa8
v_cmp_ne_u32 vcc, 0, v44
s_cbranch_vccnz exit_10076
ds_write_b128 v0, v[32:35] offset:0
ds_write_b128 v0, v[36:39] offset:4096
ds_write_b128 v0, v[40:43] offset:8192
s_waitcnt lgkmcnt(0)
s_barrier
s_barrier
s_add_u32 s36, s36, 1
s_cmp_lt_u32 s36, 2
s_cbranch_scc1 layer_10072
s_endpgm
wave_10069:
layer_10087:
s_lshl_b32 s17, s36, 6
s_mul_i32 s27, s36, 35651584
s_mul_i32 s28, s14, 16384
s_add_u32 s27, s27, s28
s_add_u32 s20, s27, 16781312
s_mul_i32 s27, s17, 10240
s_add_u32 s27, s27, s24
s_add_u32 s21, s27, s25
s_mov_b32 s19, 0
s_mov_b32 s33, s6
s_add_u32 s34, s17, 1
s_add_u32 s31, s17, 63
s_add_u32 s32, s17, 64
s_mov_b32 s27, s20
v_mov_b32 v7, 0
s_add_u32 s68, s4, 414720
s_addc_u32 s69, s5, 0
s_add_u32 s72, s4, 398336
s_addc_u32 s73, s5, 0
s_add_u32 s70, s4, 418816
s_addc_u32 s71, s5, 0
s_add_u32 s74, s4, 402432
s_addc_u32 s75, s5, 0
s_add_u32 s58, s4, s20
s_addc_u32 s59, s5, 0
global_load_dwordx4 v[64:67], v0, s[76:77] offset:-4096 sc1
global_load_dwordx4 v[68:71], v0, s[76:77] offset:-3072 sc1
global_load_dwordx4 v[72:75], v0, s[76:77] offset:-2048 sc1
global_load_dwordx4 v[76:79], v0, s[76:77] offset:-1024 sc1
global_load_dwordx4 v[80:83], v0, s[78:79] offset:-4096 sc1
global_load_dwordx4 v[84:87], v0, s[78:79] offset:-3072 sc1
global_load_dwordx4 v[48:51], v0, s[76:77] offset:2048 sc1
global_load_dwordx4 v[52:55], v0, s[76:77] offset:3072 sc1
global_load_dwordx4 v[56:59], v0, s[76:77] offset:0 sc1
global_load_dwordx4 v[60:63], v0, s[76:77] offset:1024 sc1
v_mov_b64 v[8:9], 0
v_mov_b64 v[10:11], 0
v_mov_b64 v[12:13], 0
v_mov_b64 v[14:15], 0
v_mov_b64 v[16:17], 0
v_mov_b64 v[18:19], 0
v_mov_b64 v[20:21], 0
v_mov_b64 v[22:23], 0
v_mov_b64 v[24:25], 0
v_mov_b64 v[26:27], 0
v_mov_b64 v[28:29], 0
v_mov_b64 v[30:31], 0
s_barrier
v_and_b32 v7, 511, v0
v_lshl_add_u32 v7, v7, 3, s27
global_load_dwordx4 v[32:35], v0, s[68:69] offset:-4096 sc1
global_load_dwordx4 v[36:39], v0, s[68:69] offset:0 sc1
global_load_dwordx4 v[40:43], v0, s[70:71] offset:0 sc1
s_mov_b32 s30, 0
s_waitcnt vmcnt(0)
.p2align 6
gather_10088:
s_waitcnt vmcnt(4)
rt_10093_b:
v_smfmac_f32_16x16x64_bf16 v[12:15], v[32:35], v[72:79], v1
ds_write_b128 v0, v[32:35] offset:1024
v_smfmac_f32_16x16x64_bf16 v[8:11], v[32:35], v[64:71], v1
v_bitop3_b32 v44, v32, v34, s18 bitop3:0x7e
v_smfmac_f32_16x16x64_bf16 v[20:23], v[32:35], v[48:55], v1
s_waitcnt vmcnt(3)
ds_write_b128 v0, v[36:39] offset:5120
v_bitop3_b32 v45, v36, v38, s18 bitop3:0x7e
v_or_b32 v44, v44, v45
s_waitcnt vmcnt(2)
v_bitop3_b32 v45, v40, v42, s18 bitop3:0x7e
v_smfmac_f32_16x16x64_bf16 v[16:19], v[32:35], v[56:63], v1
ds_write_b128 v0, v[40:43] offset:9216
v_bitop3_b32 v44, v44, v45, s19 bitop3:0xa8
v_cmp_ne_u32 vcc, 0, v44
v_smfmac_f32_16x16x64_bf16 v[28:31], v[32:35], a[8:15], v1
s_cbranch_vccnz rt_10093
ds_read_b128 v[52:55], v2 offset:3072
v_smfmac_f32_16x16x64_bf16 v[8:11], v[36:39], a[16:23], v1
s_waitcnt lgkmcnt(2)
ds_read_b128 v[60:63], v2 offset:1024
global_load_dwordx4 v[64:67], v0, s[78:79] offset:-2048 sc1
ds_read_b128 v[56:59], v2 offset:0
v_smfmac_f32_16x16x64_bf16 v[24:27], v[32:35], a[0:7], v1
s_waitcnt lgkmcnt(3)
ds_read_b128 v[48:51], v2 offset:2048
s_barrier
ds_read_b128 v[40:43], v0 offset:0
v_smfmac_f32_16x16x64_bf16 v[20:23], v[36:39], a[40:47], v1
s_mov_b64 s[68:69], s[72:73]
ds_read_b128 v[44:47], v0 offset:4096
global_load_dwordx4 v[68:71], v0, s[78:79] offset:-1024 sc1
v_smfmac_f32_16x16x64_bf16 v[16:19], v[36:39], a[32:39], v1
s_xor_b32 s18, s18, 1
ds_read_b128 v[32:35], v0 offset:3072
s_waitcnt lgkmcnt(4)
v_smfmac_f32_16x16x64_bf16 v[24:27], v[36:39], v[56:63], v1
ds_read_b128 v[56:59], v2 offset:4096
v_smfmac_f32_16x16x64_bf16 v[12:15], v[36:39], a[24:31], v1
ds_read_b128 v[60:63], v2 offset:5120
s_waitcnt lgkmcnt(4)
s_waitcnt vmcnt(2)
v_smfmac_f32_16x16x64_bf16 v[12:15], v[40:43], v[80:87], v1
ds_read_b128 v[84:87], v2 offset:7168
s_waitcnt lgkmcnt(4)
v_smfmac_f32_16x16x64_bf16 v[28:31], v[36:39], v[48:55], v1
ds_read_b128 v[80:83], v2 offset:6144
global_load_dwordx4 v[72:75], v0, s[78:79] offset:0 sc1
v_smfmac_f32_16x16x64_bf16 v[8:11], v[40:43], a[48:55], v1
ds_read_b128 v[36:39], v0 offset:7168
global_load_dwordx4 v[76:79], v0, s[78:79] offset:1024 sc1
v_smfmac_f32_16x16x64_bf16 v[12:15], v[44:47], a[64:71], v1
ds_read_b128 v[40:43], v0 offset:2048
s_waitcnt lgkmcnt(5)
v_smfmac_f32_16x16x64_bf16 v[8:11], v[44:47], a[56:63], v1
ds_read_b128 v[44:47], v0 offset:6144
s_waitcnt lgkmcnt(5)
v_smfmac_f32_16x16x64_bf16 v[8:11], v[32:35], v[56:63], v1
s_waitcnt lgkmcnt(3)
ds_read_b128 v[60:63], v2 offset:9216
v_smfmac_f32_16x16x64_bf16 v[12:15], v[32:35], a[72:79], v1
s_waitcnt lgkmcnt(3)
ds_read_b128 v[56:59], v2 offset:8192
v_smfmac_f32_16x16x64_bf16 v[12:15], v[36:39], v[80:87], v1
ds_read_b128 v[32:35], v0 offset:9216
v_smfmac_f32_16x16x64_bf16 v[8:11], v[36:39], a[80:87], v1
s_waitcnt lgkmcnt(4)
ds_read_b128 v[80:83], v2 offset:10240
global_load_dwordx4 v[48:51], v0, s[58:59] offset:0 nt sc1
ds_read_b128 v[84:87], v2 offset:11264
v_smfmac_f32_16x16x64_bf16 v[8:11], v[40:43], a[88:95], v1
s_add_u32 s20, s20, 524288
s_waitcnt lgkmcnt(5)
ds_read_b128 v[36:39], v0 offset:8192
v_smfmac_f32_16x16x64_bf16 v[12:15], v[40:43], a[96:103], v1
s_waitcnt lgkmcnt(4)
ds_read_b128 v[40:43], v0 offset:0
v_smfmac_f32_16x16x64_bf16 v[8:11], v[44:47], v[56:63], v1
global_load_dwordx4 v[52:55], v0, s[58:59] offset:1024 nt sc1
ds_read_b128 v[60:63], v2 offset:13312
v_smfmac_f32_16x16x64_bf16 v[12:15], v[44:47], a[104:111], v1
s_waitcnt lgkmcnt(4)
ds_read_b128 v[56:59], v2 offset:12288
s_waitcnt lgkmcnt(4)
v_smfmac_f32_16x16x64_bf16 v[12:15], v[32:35], v[80:87], v1
s_waitcnt vmcnt(4)
ds_read_b128 v[80:83], v2 offset:14336
s_mov_b64 vcc, s[42:43]
v_smfmac_f32_16x16x64_bf16 v[8:11], v[32:35], a[112:119], v1
s_waitcnt lgkmcnt(4)
ds_read_b128 v[84:87], v2 offset:15360
v_smfmac_f32_16x16x64_bf16 v[8:11], v[36:39], v[64:71], v1
s_nop 0
ds_read_b128 v[32:35], v0 offset:4096
global_load_dwordx4 v[64:67], v0, s[78:79] offset:2048 sc1
v_smfmac_f32_16x16x64_bf16 v[12:15], v[36:39], a[120:127], v1
s_nop 0
ds_read_b128 v[36:39], v0 offset:3072
s_waitcnt lgkmcnt(4)
s_nop 0
v_add_f32 v8, v8, v10
v_smfmac_f32_16x16x64_bf16 v[16:19], v[40:43], v[56:63], v1
ds_read_b128 v[60:63], v2 offset:17408
global_load_dwordx4 v[68:71], v0, s[78:79] offset:3072 sc1
ds_read_b128 v[56:59], v2 offset:16384
v_mul_f32 v8, s35, v8
v_smfmac_f32_16x16x64_bf16 v[20:23], v[40:43], a[128:135], v1
s_waitcnt lgkmcnt(3)
ds_read_b128 v[40:43], v0 offset:7168
v_add_f32 v12, v12, v14
v_smfmac_f32_16x16x64_bf16 v[20:23], v[32:35], v[80:87], v1
s_waitcnt lgkmcnt(3)
ds_read_b128 v[80:83], v2 offset:18432
v_add_f32 v13, v13, v15
v_smfmac_f32_16x16x64_bf16 v[16:19], v[32:35], a[136:143], v1
ds_read_b128 v[32:35], v0 offset:2048
v_add_f32 v9, v9, v11
v_smfmac_f32_16x16x64_bf16 v[20:23], v[36:39], a[152:159], v1
s_waitcnt vmcnt(4)
ds_read_b128 v[84:87], v2 offset:19456
v_mul_f32 v13, s35, v13
v_mul_f32 v12, s35, v12
v_mul_f32 v9, s35, v9
v_cvt_pk_bf16_f32 v8, v8, v9
v_cvt_pk_bf16_f32 v12, v12, v13
v_smfmac_f32_16x16x64_bf16 v[16:19], v[36:39], a[144:151], v1
s_waitcnt lgkmcnt(3)
ds_read_b128 v[36:39], v0 offset:6144
ds_write2_b32 v3, v8, v12 offset0:0 offset1:128
v_smfmac_f32_16x16x64_bf16 v[16:19], v[40:43], v[72:79], v1
global_load_dwordx4 v[72:75], v0, s[80:81] offset:-4096 sc1
v_smfmac_f32_16x16x64_bf16 v[20:23], v[40:43], v[56:63], v1
s_waitcnt lgkmcnt(3)
global_load_dwordx4 v[76:79], v0, s[80:81] offset:-3072 sc1
v_smfmac_f32_16x16x64_bf16 v[20:23], v[32:35], a[168:175], v1
ds_read_b128 v[40:43], v0 offset:9216
global_load_dwordx4 v[56:59], v0, s[58:59] offset:2048 nt sc1
global_load_dwordx4 v[60:63], v0, s[58:59] offset:3072 nt sc1
v_smfmac_f32_16x16x64_bf16 v[16:19], v[32:35], a[160:167], v1
s_waitcnt lgkmcnt(1)
ds_read_b128 v[32:35], v0 offset:8192
v_smfmac_f32_16x16x64_bf16 v[16:19], v[36:39], a[176:183], v1
s_barrier
ds_read_b64_tr_b16 v[10:11], v4 offset:512
v_smfmac_f32_16x16x64_bf16 v[20:23], v[36:39], v[80:87], v1
s_waitcnt lgkmcnt(2)
ds_read_b128 v[36:39], v0 offset:9216
ds_read_b64_tr_b16 v[14:15], v4 offset:1536
v_smfmac_f32_16x16x64_bf16 v[20:23], v[40:43], a[192:199], v1
ds_read_b64_tr_b16 v[12:13], v4 offset:1024
s_waitcnt lgkmcnt(4)
ds_read_b64_tr_b16 v[8:9], v4 offset:0
v_smfmac_f32_16x16x64_bf16 v[16:19], v[40:43], a[184:191], v1
s_waitcnt vmcnt(5)
ds_read_b128 v[40:43], v0 offset:8192
v_smfmac_f32_16x16x64_bf16 v[16:19], v[32:35], a[200:207], v1
v_smfmac_f32_16x16x64_bf16 v[20:23], v[32:35], a[208:215], v1
s_waitcnt lgkmcnt(3)
ds_read_b128 v[80:83], v2 offset:20480
global_load_dword v7, v7, s[4:5] sc1
ds_read_b128 v[84:87], v2 offset:21504
v_smfmac_f32_16x16x64_bf16 v[24:27], v[36:39], a[216:223], v1
s_waitcnt lgkmcnt(3)
ds_read_b128 v[32:35], v0 offset:0
v_add_f32 v16, v16, v18
v_mfma_f32_16x16x32_bf16 v[44:47], v[48:51], v[8:11], 0
v_bfe_u32 v48, v0, 5, 1
v_add_f32 v17, v17, v19
v_mfma_f32_16x16x32_bf16 v[44:47], v[52:55], v[12:15], v[44:47]
s_nop 0
v_lshl_add_u32 v48, v48, 3, v5
v_add_f32 v20, v20, v22
v_smfmac_f32_16x16x64_bf16 v[28:31], v[36:39], a[224:231], v1
s_waitcnt lgkmcnt(3)
ds_read_b128 v[36:39], v0 offset:4096
v_cvt_pk_bf16_f32 v16, v16, v17
v_add_f32 v21, v21, v23
v_cndmask_b32_dpp v44, v46, v44, vcc quad_perm:[0,1,0,1] row_mask:0xf bank_mask:0xf
v_cvt_pk_bf16_f32 v20, v20, v21
v_smfmac_f32_16x16x64_bf16 v[24:27], v[40:43], a[232:239], v1
s_waitcnt lgkmcnt(1)
ds_write2_b32 v3, v16, v20 offset0:1 offset1:129
v_cndmask_b32_dpp v45, v47, v45, vcc quad_perm:[0,1,0,1] row_mask:0xf bank_mask:0xf
v_xor_b32 v48, 128, v48
v_smfmac_f32_16x16x64_bf16 v[28:31], v[40:43], v[80:87], v1
s_add_u32 s17, s17, 1
ds_write_b64 v48, v[44:45] offset:6656
v_smfmac_f32_16x16x64_bf16 v[24:27], v[32:35], a[240:247], v1
s_add_u32 s21, s21, 10240
ds_read_b128 v[40:43], v0 offset:3072
v_smfmac_f32_16x16x64_bf16 v[28:31], v[32:35], a[248:255], v1
s_waitcnt vmcnt(5)
ds_read_b128 v[32:35], v0 offset:7168
s_waitcnt lgkmcnt(4)
v_smfmac_f32_16x16x64_bf16 v[24:27], v[36:39], v[64:71], v1
ds_read_b128 v[80:83], v2 offset:22528
global_load_dwordx4 v[64:67], v0, s[76:77] offset:-4096 sc1
v_smfmac_f32_16x16x64_bf16 v[28:31], v[36:39], v[88:95], v1
s_waitcnt lgkmcnt(3)
ds_read_b128 v[36:39], v0 offset:2048
s_barrier
ds_read_b128 v[52:55], v6 offset:7168
s_waitcnt lgkmcnt(4)
v_smfmac_f32_16x16x64_bf16 v[28:31], v[40:43], v[104:111], v1
s_waitcnt lgkmcnt(3)
ds_read_b128 v[48:51], v6 offset:6144
v_smfmac_f32_16x16x64_bf16 v[24:27], v[40:43], v[96:103], v1
ds_read_b128 v[40:43], v0 offset:6144
ds_read_b64_tr_b16 v[16:17], v4 offset:2048
v_smfmac_f32_16x16x64_bf16 v[24:27], v[32:35], v[112:119], v1
ds_read_b64_tr_b16 v[18:19], v4 offset:2560
s_waitcnt lgkmcnt(5)
ds_read_b64_tr_b16 v[14:15], v4 offset:1536
v_smfmac_f32_16x16x64_bf16 v[28:31], v[32:35], v[120:127], v1
s_waitcnt vmcnt(2)
ds_read_b64_tr_b16 v[8:9], v4 offset:0
ds_read_b64_tr_b16 v[12:13], v4 offset:1024
v_smfmac_f32_16x16x64_bf16 v[28:31], v[36:39], v[136:143], v1
s_waitcnt lgkmcnt(6)
ds_read_b64_tr_b16 v[10:11], v4 offset:512
v_add_f32 v49, v49, v53
v_smfmac_f32_16x16x64_bf16 v[24:27], v[36:39], v[128:135], v1
s_waitcnt lgkmcnt(6)
ds_read_b64_tr_b16 v[20:21], v4 offset:3072
v_add_f32 v50, v50, v54
v_smfmac_f32_16x16x64_bf16 v[28:31], v[40:43], v[144:151], v1
ds_read_b64_tr_b16 v[22:23], v4 offset:3584
v_add_f32 v51, v51, v55
v_exp_f32 v51, v51
v_exp_f32 v49, v49
v_smfmac_f32_16x16x64_bf16 v[24:27], v[40:43], v[72:79], v1
s_waitcnt lgkmcnt(2)
ds_read_b128 v[84:87], v2 offset:23552
v_add_f32 v48, v48, v52
v_exp_f32 v48, v48
v_exp_f32 v50, v50
v_mfma_f32_16x16x32_bf16 v[44:47], v[8:11], v[8:11], 0
s_waitcnt lgkmcnt(1)
v_cvt_pk_bf16_f32 v55, v50, v51
v_cvt_pk_bf16_f32 v54, v48, v49
v_mfma_f32_16x16x32_bf16 v[44:47], v[12:15], v[12:15], v[44:47]
v_mov_b32_dpp v51, v55 quad_perm:[2,3,2,3] row_mask:0xf bank_mask:0xf
v_mov_b32_dpp v50, v54 quad_perm:[2,3,2,3] row_mask:0xf bank_mask:0xf
v_mfma_f32_16x16x32_bf16 v[44:47], v[16:19], v[16:19], v[44:47]
v_mov_b32_dpp v49, v55 quad_perm:[0,1,0,1] row_mask:0xf bank_mask:0xf
v_mov_b32_dpp v48, v54 quad_perm:[0,1,0,1] row_mask:0xf bank_mask:0xf
v_mfma_f32_16x16x32_bf16 v[44:47], v[20:23], v[20:23], v[44:47]
s_mov_b64 s[70:71], s[74:75]
v_mov_b64 v[20:21], s[44:45]
v_cvt_pk_bf16_f32 v24, v24, v25
v_mfma_f32_16x16x32_bf16 v[8:11], v[56:59], v[48:51], 0
s_add_u32 s34, s17, 2
v_mov_b64 v[22:23], s[44:45]
v_cvt_pk_bf16_f32 v25, v26, v27
v_mfma_f32_16x16x32_bf16 v[12:15], v[60:63], v[48:51], 0
v_exp_f32_dpp v44, v46 quad_perm:[0,1,0,1] row_mask:0xf bank_mask:0xf
v_exp_f32_dpp v45, v47 quad_perm:[0,1,0,1] row_mask:0xf bank_mask:0xf
v_mfma_f32_16x16x32_bf16 v[16:19], v[20:23], v[48:51], 0
s_waitcnt lgkmcnt(0)
v_cvt_pk_bf16_f32 v52, v44, v45
v_cvt_pk_bf16_f32 v53, v44, v45
v_mov_b64 v[54:55], s[46:47]
v_cvt_pk_bf16_f32 v27, v30, v31
v_mfma_f32_16x16x16_bf16 v[8:11], v[24:25], v[52:53], v[8:11]
s_mov_b32 s19, 1
global_load_dwordx4 v[68:71], v0, s[76:77] offset:-3072 sc1
v_cvt_pk_bf16_f32 v26, v28, v29
v_mfma_f32_16x16x16_bf16 v[16:19], v[54:55], v[52:53], v[16:19]
s_min_u32 s34, s34, s32
v_mov_b64 v[38:39], 0
v_mov_b64 v[36:37], 0
v_mfma_f32_16x16x16_bf16 v[12:15], v[26:27], v[52:53], v[12:15]
s_nop 0
ds_read_b128 v[28:31], v0 offset:31744
v_bfe_u32 v32, v0, 5, 1
v_mov_b64 v[34:35], 0
v_rcp_f32 v18, v16
v_subrev_u32 v17, s37, v16
v_cmp_lt_u32 vcc, s38, v17
v_lshl_add_u32 v32, v32, 3, v5
v_cndmask_b32 v9, v13, v9, s[42:43]
v_cndmask_b32 v8, v12, v8, s[42:43]
v_cndmask_b32 v10, v14, v10, s[42:43]
v_mul_f32 v10, v10, v18
v_mul_f32 v9, v9, v18
v_mul_f32 v8, v8, v18
v_cndmask_b32 v11, v15, v11, s[42:43]
v_mul_f32 v11, v11, v18
v_cvt_pk_bf16_f32 v13, v10, v11
v_cvt_pk_bf16_f32 v12, v8, v9
s_cbranch_vccnz rare_10089
back_10090:
ds_read_b128 v[16:19], v0 offset:28672
ds_write_b64 v32, v[12:13] offset:512
v_mov_b64 v[42:43], 0
v_mov_b64 v[32:33], 0
v_mov_b32_dpp v10, v12 quad_perm:[2,3,2,3] row_mask:0xf bank_mask:0xf
v_mov_b64 v[54:55], 0
v_mov_b32_dpp v8, v12 quad_perm:[0,1,0,1] row_mask:0xf bank_mask:0xf
v_mov_b32_dpp v11, v13 quad_perm:[2,3,2,3] row_mask:0xf bank_mask:0xf
v_mov_b32_dpp v9, v13 quad_perm:[0,1,0,1] row_mask:0xf bank_mask:0xf
v_mov_b64 v[52:53], 0
v_mov_b64 v[40:41], 0
v_smfmac_f32_16x16x64_bf16 v[36:39], v[8:11], v[80:87], v1
ds_read_b128 v[24:27], v0 offset:30720
global_load_dwordx4 v[72:75], v0, s[76:77] offset:-2048 sc1
ds_read_b128 v[20:23], v0 offset:29696
v_smfmac_f32_16x16x64_bf16 v[40:43], v[8:11], v[152:159], v1
s_waitcnt lgkmcnt(2)
ds_read_b128 v[80:83], v0 offset:32768
s_barrier
ds_read_b128 v[56:59], v5 offset:0
v_smfmac_f32_16x16x64_bf16 v[32:35], v[8:11], v[176:183], v1
s_add_u32 s27, s20, 524288
ds_read_b128 v[60:63], v5 offset:1536
v_mov_b64 v[48:49], 0
v_mov_b64 v[50:51], 0
v_smfmac_f32_16x16x64_bf16 v[52:55], v[8:11], v[168:175], v1
s_add_u32 s58, s4, s20
ds_read_b128 v[12:15], v5 offset:1024
v_lshrrev_b32 v44, 8, v0
v_smfmac_f32_16x16x64_bf16 v[48:51], v[8:11], v[160:167], v1
s_waitcnt lgkmcnt(4)
ds_read_b128 v[84:87], v0 offset:33792
global_load_dwordx4 v[76:79], v0, s[76:77] offset:-1024 sc1
v_bfe_u32 v45, v0, 1, 7
s_waitcnt lgkmcnt(3)
v_smfmac_f32_16x16x64_bf16 v[36:39], v[56:59], v[16:23], v1
s_addc_u32 s59, s5, 0
ds_read_b128 v[16:19], v0 offset:34816
s_waitcnt lgkmcnt(3)
v_smfmac_f32_16x16x64_bf16 v[36:39], v[60:63], v[24:31], v1
ds_read_b128 v[28:31], v0 offset:37888
s_waitcnt lgkmcnt(3)
v_smfmac_f32_16x16x64_bf16 v[36:39], v[12:15], v[184:191], v1
ds_read_b128 v[20:23], v0 offset:35840
s_waitcnt lgkmcnt(3)
v_smfmac_f32_16x16x64_bf16 v[40:43], v[56:59], v[80:87], v1
ds_read_b128 v[24:27], v0 offset:36864
v_lshl_or_b32 v44, v44, 12, v45
v_smfmac_f32_16x16x64_bf16 v[40:43], v[60:63], v[192:199], v1
s_nop 0
ds_read_b128 v[84:87], v0 offset:39936
v_cvt_pk_bf16_f32 v36, v36, v37
v_and_or_b32 v36, v36, -2, s18
v_cvt_pk_bf16_f32 v37, v38, v39
v_smfmac_f32_16x16x64_bf16 v[40:43], v[12:15], v[200:207], v1
global_store_dwordx2 v44, v[36:37], s[48:49]
s_waitcnt lgkmcnt(2)
v_smfmac_f32_16x16x64_bf16 v[48:51], v[56:59], v[16:23], v1
ds_read_b128 v[80:83], v0 offset:38912
s_waitcnt lgkmcnt(2)
v_smfmac_f32_16x16x64_bf16 v[48:51], v[60:63], v[24:31], v1
s_mov_b32 s30, 0
s_nop 0
v_cvt_pk_bf16_f32 v40, v40, v41
v_cvt_pk_bf16_f32 v41, v42, v43
v_and_or_b32 v40, v40, -2, s18
v_smfmac_f32_16x16x64_bf16 v[48:51], v[12:15], v[208:215], v1
global_store_dwordx2 v44, v[40:41], s[50:51]
s_waitcnt lgkmcnt(1)
v_smfmac_f32_16x16x64_bf16 v[32:35], v[56:59], v[232:239], v1
s_nop 0
s_waitcnt lgkmcnt(0)
v_smfmac_f32_16x16x64_bf16 v[52:55], v[56:59], v[80:87], v1
s_nop 1
v_cvt_pk_bf16_f32 v48, v48, v49
v_smfmac_f32_16x16x64_bf16 v[52:55], v[60:63], v[216:223], v1
v_and_or_b32 v48, v48, -2, s18
v_cvt_pk_bf16_f32 v49, v50, v51
v_smfmac_f32_16x16x64_bf16 v[52:55], v[12:15], v[224:231], v1
global_store_dwordx2 v44, v[48:49], s[52:53]
v_smfmac_f32_16x16x64_bf16 v[32:35], v[60:63], v[240:247], v1
s_nop 2
v_smfmac_f32_16x16x64_bf16 v[32:35], v[12:15], v[248:255], v1
s_nop 1
v_cvt_pk_bf16_f32 v52, v52, v53
v_and_or_b32 v52, v52, -2, s18
v_cvt_pk_bf16_f32 v53, v54, v55
s_nop 0
global_store_dwordx2 v44, v[52:53], s[54:55]
s_nop 0
v_cvt_pk_bf16_f32 v32, v32, v33
v_cvt_pk_bf16_f32 v33, v34, v35
v_and_or_b32 v32, v32, -2, s18
global_store_dwordx2 v44, v[32:33], s[56:57]
v_bfe_u32 v32, v0, 6, 1
v_lshlrev_b32 v32, 4, v32
v_mov_b32 v33, 0x3f80
v_lshlrev_b32 v32, v32, v33
v_bfe_i32 v33, v0, 4, 1
v_and_b32 v45, v32, v33
v_and_b32 v47, v32, v33
v_xor_b32 v44, v32, v45
v_xor_b32 v46, v32, v45
v_and_b32 v36, 32, v0
v_bfe_u32 v37, v0, 6, 1
v_lshl_add_u32 v36, v37, 8, v36
v_bfe_u32 v37, v0, 8, 1
v_lshl_add_u32 v36, v37, 4, v36
v_bfe_u32 v37, v0, 4, 1
v_lshl_add_u32 v36, v37, 3, v36
s_waitcnt vmcnt(9)
v_and_b32 v7, 511, v0
v_lshl_add_u32 v7, v7, 3, s27
s_nop 15
s_nop 15
s_nop 15
s_nop 15
global_load_dwordx4 v[8:11], v0, s[64:65] offset:0 sc1
global_load_dwordx4 v[12:15], v0, s[64:65] offset:1024 sc1
global_load_dwordx4 v[16:19], v0, s[64:65] offset:2048 sc1
global_load_dwordx4 v[20:23], v0, s[64:65] offset:3072 sc1
s_nop 15
s_nop 15
s_nop 5
global_load_dwordx4 v[24:27], v0, s[64:65] offset:0 sc1
global_load_dwordx4 v[28:31], v0, s[64:65] offset:1024 sc1
global_load_dwordx4 v[80:83], v0, s[64:65] offset:2048 sc1
global_load_dwordx4 v[84:87], v0, s[64:65] offset:3072 sc1
chk_10098:
v_mov_b64 v[40:41], 0
v_mov_b64 v[42:43], 0
s_waitcnt vmcnt(6)
s_nop 0
v_smfmac_f32_16x16x64_bf16 v[40:43], v[44:47], v[8:15], v1
v_bitop3_b32 v32, v8, v10, s18 bitop3:0x7e
v_bitop3_b32 v33, v12, v14, s18 bitop3:0x7e
s_waitcnt vmcnt(4)
v_smfmac_f32_16x16x64_bf16 v[40:43], v[44:47], v[16:23], v1
v_bitop3_b32 v34, v16, v18, s18 bitop3:0x7e
v_bitop3_b32 v35, v20, v22, s18 bitop3:0x7e
v_or3_b32 v37, v32, v33, v34
v_bitop3_b32 v37, v37, v35, 1 bitop3:0xa8
v_cmp_ne_u32 vcc, 0, v37
s_cbranch_vccnz chk_10098_f
s_nop 1
v_add_f32_dpp v40, v40, v40 row_ror:8 row_mask:0xf bank_mask:0xf
v_add_f32_dpp v41, v41, v41 row_ror:8 row_mask:0xf bank_mask:0xf
v_add_f32_dpp v42, v42, v42 row_ror:8 row_mask:0xf bank_mask:0xf
v_add_f32_dpp v43, v43, v43 row_ror:8 row_mask:0xf bank_mask:0xf
v_cvt_pk_bf16_f32 v40, v40, v41
v_cvt_pk_bf16_f32 v41, v42, v43
v_and_or_b32 v40, v40, -2, s18
s_mov_b64 exec, 0x00ff00ff
global_store_dwordx2 v36, v[40:41], s[66:67]
s_mov_b64 exec, -1
s_branch join_10097
chk_10098_f:
global_load_dwordx4 v[8:11], v0, s[64:65] offset:0 sc1
global_load_dwordx4 v[12:15], v0, s[64:65] offset:1024 sc1
global_load_dwordx4 v[16:19], v0, s[64:65] offset:2048 sc1
global_load_dwordx4 v[20:23], v0, s[64:65] offset:3072 sc1
chk_10099:
v_mov_b64 v[40:41], 0
v_mov_b64 v[42:43], 0
s_waitcnt vmcnt(6)
s_nop 0
v_smfmac_f32_16x16x64_bf16 v[40:43], v[44:47], v[24:31], v1
v_bitop3_b32 v32, v24, v26, s18 bitop3:0x7e
v_bitop3_b32 v33, v28, v30, s18 bitop3:0x7e
s_waitcnt vmcnt(4)
v_smfmac_f32_16x16x64_bf16 v[40:43], v[44:47], v[80:87], v1
v_bitop3_b32 v34, v80, v82, s18 bitop3:0x7e
v_bitop3_b32 v35, v84, v86, s18 bitop3:0x7e
v_or3_b32 v37, v32, v33, v34
v_bitop3_b32 v37, v37, v35, 1 bitop3:0xa8
v_cmp_ne_u32 vcc, 0, v37
s_cbranch_vccnz chk_10099_f
s_nop 1
v_add_f32_dpp v40, v40, v40 row_ror:8 row_mask:0xf bank_mask:0xf
v_add_f32_dpp v41, v41, v41 row_ror:8 row_mask:0xf bank_mask:0xf
v_add_f32_dpp v42, v42, v42 row_ror:8 row_mask:0xf bank_mask:0xf
v_add_f32_dpp v43, v43, v43 row_ror:8 row_mask:0xf bank_mask:0xf
v_cvt_pk_bf16_f32 v40, v40, v41
v_cvt_pk_bf16_f32 v41, v42, v43
v_and_or_b32 v40, v40, -2, s18
s_mov_b64 exec, 0x00ff00ff
global_store_dwordx2 v36, v[40:41], s[66:67]
s_mov_b64 exec, -1
s_branch join_10097
chk_10099_f:
global_load_dwordx4 v[24:27], v0, s[64:65] offset:0 sc1
global_load_dwordx4 v[28:31], v0, s[64:65] offset:1024 sc1
global_load_dwordx4 v[80:83], v0, s[64:65] offset:2048 sc1
global_load_dwordx4 v[84:87], v0, s[64:65] offset:3072 sc1
s_add_u32 s30, s30, 1
s_cmp_le_u32 s30, 262144
s_cbranch_scc1 chk_10098
s_branch L_fail
nored_10096:
join_10097:
s_barrier
global_load_dwordx4 v[56:59], v0, s[76:77] offset:0 sc1
global_load_dwordx4 v[60:63], v0, s[76:77] offset:1024 sc1
global_load_dwordx4 v[48:51], v0, s[76:77] offset:2048 sc1
global_load_dwordx4 v[52:55], v0, s[76:77] offset:3072 sc1
s_nop 15
s_nop 15
s_nop 3
s_barrier
global_load_dwordx4 v[32:35], v0, s[68:69] offset:-4096 sc1
s_nop 10
global_load_dwordx4 v[36:39], v0, s[68:69] offset:0 sc1
s_nop 10
global_load_dwordx4 v[40:43], v0, s[70:71] offset:0 sc1
s_barrier
global_load_dwordx4 v[80:83], v0, s[78:79] offset:-4096 sc1
global_load_dwordx4 v[84:87], v0, s[78:79] offset:-3072 sc1
s_waitcnt vmcnt(13)
v_mov_b64 v[8:9], 0
v_mov_b64 v[10:11], 0
s_waitcnt vmcnt(12)
v_mov_b64 v[12:13], 0
v_mov_b64 v[14:15], 0
s_waitcnt vmcnt(11)
v_mov_b64 v[16:17], 0
v_mov_b64 v[18:19], 0
s_waitcnt vmcnt(10)
v_mov_b64 v[20:21], 0
v_mov_b64 v[22:23], 0
v_mov_b64 v[24:25], 0
v_mov_b64 v[26:27], 0
v_mov_b64 v[28:29], 0
v_mov_b64 v[30:31], 0
s_mov_b32 s30, 0
s_cmp_eq_u32 s17, s31
s_cbranch_scc0 gather_10088
s_branch exit_10091
rt_10093:
global_load_dwordx4 v[32:35], v0, s[68:69] offset:-4096 sc1
global_load_dwordx4 v[36:39], v0, s[68:69] offset:0 sc1
global_load_dwordx4 v[40:43], v0, s[70:71] offset:0 sc1
s_add_u32 s30, s30, 1
s_cmp_gt_u32 s30, 262144
s_cbranch_scc1 L_fail
s_mov_b64 exec, 1
global_store_dword v0, v0, s[62:63]
global_store_dword v0, v0, s[62:63]
s_mov_b64 exec, -1
v_mov_b64 v[8:9], 0
v_mov_b64 v[10:11], 0
v_mov_b64 v[12:13], 0
v_mov_b64 v[14:15], 0
v_mov_b64 v[16:17], 0
v_mov_b64 v[18:19], 0
v_mov_b64 v[20:21], 0
v_mov_b64 v[22:23], 0
v_mov_b64 v[24:25], 0
v_mov_b64 v[26:27], 0
v_mov_b64 v[28:29], 0
v_mov_b64 v[30:31], 0
s_branch gather_10088
rare_10089:
ds_read_b128 v[48:51], v6 offset:6144
ds_read_b128 v[52:55], v6 offset:7168
s_waitcnt lgkmcnt(0)
v_add_f32 v48, v48, v52
v_add_f32 v49, v49, v53
v_add_f32 v50, v50, v54
v_add_f32 v51, v51, v55
v_mov_b32_dpp v46, v46 quad_perm:[0,1,0,1] row_mask:0xf bank_mask:0xf
v_mov_b32_dpp v47, v47 quad_perm:[0,1,0,1] row_mask:0xf bank_mask:0xf
v_max3_f32 v19, v48, v49, v50
v_max3_f32 v19, v19, v51, v46
v_max_f32 v19, v19, v47
s_nop 1
v_max_f32_dpp v19, v19, v19 quad_perm:[2,3,0,1] row_mask:0xf bank_mask:0xf
v_mov_b32 v44, v19
s_nop 1
v_permlane32_swap_b32 v19, v44
v_max_f32 v19, v19, v44
v_mov_b32 v44, v19
s_nop 1
v_permlane16_swap_b32 v19, v44
v_max_f32 v19, v19, v44
v_sub_f32 v48, v48, v19
v_sub_f32 v49, v49, v19
v_sub_f32 v50, v50, v19
v_sub_f32 v51, v51, v19
v_sub_f32 v46, v46, v19
v_sub_f32 v47, v47, v19
v_exp_f32 v48, v48
v_exp_f32 v49, v49
v_exp_f32 v50, v50
v_exp_f32 v51, v51
v_cvt_pk_bf16_f32 v54, v48, v49
v_cvt_pk_bf16_f32 v55, v50, v51
s_nop 0
v_mov_b32_dpp v48, v54 quad_perm:[0,1,0,1] row_mask:0xf bank_mask:0xf
v_mov_b32_dpp v49, v55 quad_perm:[0,1,0,1] row_mask:0xf bank_mask:0xf
v_mov_b32_dpp v50, v54 quad_perm:[2,3,2,3] row_mask:0xf bank_mask:0xf
v_mov_b32_dpp v51, v55 quad_perm:[2,3,2,3] row_mask:0xf bank_mask:0xf
v_mov_b64 v[20:21], s[44:45]
v_mov_b64 v[22:23], s[44:45]
v_mfma_f32_16x16x32_bf16 v[8:11], v[56:59], v[48:51], 0
v_mfma_f32_16x16x32_bf16 v[12:15], v[60:63], v[48:51], 0
v_mfma_f32_16x16x32_bf16 v[16:19], v[20:23], v[48:51], 0
v_mov_b64 v[54:55], s[46:47]
v_exp_f32_dpp v44, v46 quad_perm:[0,1,0,1] row_mask:0xf bank_mask:0xf
v_exp_f32_dpp v45, v47 quad_perm:[0,1,0,1] row_mask:0xf bank_mask:0xf
s_nop 0
v_cvt_pk_bf16_f32 v52, v44, v45
v_cvt_pk_bf16_f32 v53, v44, v45
s_nop 1
v_mfma_f32_16x16x16_bf16 v[16:19], v[54:55], v[52:53], v[16:19]
v_mfma_f32_16x16x16_bf16 v[8:11], v[24:25], v[52:53], v[8:11]
v_mfma_f32_16x16x16_bf16 v[12:15], v[26:27], v[52:53], v[12:15]
s_nop 5
v_rcp_f32 v18, v16
s_nop 0
v_cndmask_b32 v8, v12, v8, s[42:43]
v_mul_f32 v8, v8, v18
v_cndmask_b32 v9, v13, v9, s[42:43]
v_mul_f32 v9, v9, v18
v_cndmask_b32 v10, v14, v10, s[42:43]
v_mul_f32 v10, v10, v18
v_cndmask_b32 v11, v15, v11, s[42:43]
v_mul_f32 v11, v11, v18
v_cvt_pk_bf16_f32 v12, v8, v9
v_cvt_pk_bf16_f32 v13, v10, v11
s_branch back_10090
exit_10091:
global_load_dwordx4 v[32:35], v0, s[68:69] offset:-4096 sc1
global_load_dwordx4 v[36:39], v0, s[68:69] offset:0 sc1
global_load_dwordx4 v[40:43], v0, s[70:71] offset:0 sc1
s_add_u32 s30, s30, 1
s_cmp_gt_u32 s30, 262144
s_cbranch_scc1 L_fail
s_waitcnt vmcnt(2)
v_bitop3_b32 v44, v32, v34, s18 bitop3:0x7e
s_waitcnt vmcnt(1)
v_bitop3_b32 v45, v36, v38, s18 bitop3:0x7e
v_or_b32 v44, v44, v45
s_waitcnt vmcnt(0)
v_bitop3_b32 v46, v40, v42, s18 bitop3:0x7e
v_bitop3_b32 v44, v44, v46, s19 bitop3:0xa8
v_cmp_ne_u32 vcc, 0, v44
s_cbranch_vccnz exit_10091
ds_write_b128 v0, v[32:35] offset:1024
ds_write_b128 v0, v[36:39] offset:5120
ds_write_b128 v0, v[40:43] offset:9216
s_waitcnt lgkmcnt(0)
s_barrier
s_barrier
s_add_u32 s36, s36, 1
s_cmp_lt_u32 s36, 2
s_cbranch_scc1 layer_10087
s_endpgm
wave_10070:
layer_10100:
s_lshl_b32 s17, s36, 6
s_mul_i32 s27, s36, 35651584
s_mul_i32 s28, s14, 16384
s_add_u32 s27, s27, s28
s_add_u32 s20, s27, 16785408
s_mul_i32 s27, s17, 10240
s_add_u32 s27, s27, s24
s_add_u32 s21, s27, s25
s_mov_b32 s19, 0
s_mov_b32 s33, s6
s_add_u32 s34, s17, 1
s_add_u32 s31, s17, 63
s_add_u32 s32, s17, 64
s_mov_b32 s27, s20
v_mov_b32 v7, 0
s_add_u32 s68, s4, 415744
s_addc_u32 s69, s5, 0
s_add_u32 s72, s4, 399360
s_addc_u32 s73, s5, 0
s_add_u32 s70, s4, 419840
s_addc_u32 s71, s5, 0
s_add_u32 s74, s4, 403456
s_addc_u32 s75, s5, 0
s_add_u32 s58, s4, s20
s_addc_u32 s59, s5, 0
global_load_dwordx4 v[64:67], v0, s[76:77] offset:-4096 sc1
global_load_dwordx4 v[68:71], v0, s[76:77] offset:-3072 sc1
global_load_dwordx4 v[72:75], v0, s[76:77] offset:-2048 sc1
global_load_dwordx4 v[76:79], v0, s[76:77] offset:-1024 sc1
global_load_dwordx4 v[80:83], v0, s[78:79] offset:-4096 sc1
global_load_dwordx4 v[84:87], v0, s[78:79] offset:-3072 sc1
global_load_dwordx4 v[48:51], v0, s[76:77] offset:2048 sc1
global_load_dwordx4 v[52:55], v0, s[76:77] offset:3072 sc1
global_load_dwordx4 v[56:59], v0, s[76:77] offset:0 sc1
global_load_dwordx4 v[60:63], v0, s[76:77] offset:1024 sc1
v_mov_b64 v[8:9], 0
v_mov_b64 v[10:11], 0
v_mov_b64 v[12:13], 0
v_mov_b64 v[14:15], 0
v_mov_b64 v[16:17], 0
v_mov_b64 v[18:19], 0
v_mov_b64 v[20:21], 0
v_mov_b64 v[22:23], 0
v_mov_b64 v[24:25], 0
v_mov_b64 v[26:27], 0
v_mov_b64 v[28:29], 0
v_mov_b64 v[30:31], 0
s_barrier
v_and_b32 v7, 511, v0
v_lshl_add_u32 v7, v7, 3, s27
global_load_dwordx4 v[32:35], v0, s[68:69] offset:-4096 sc1
global_load_dwordx4 v[36:39], v0, s[68:69] offset:0 sc1
v_mov_b32 v45, -1
s_mov_b32 s30, 0
s_waitcnt vmcnt(0)
.p2align 6
gather_10101:
s_waitcnt vmcnt(3)
rt_10106_b:
v_smfmac_f32_16x16x64_bf16 v[12:15], v[32:35], v[72:79], v1
ds_write_b128 v0, v[32:35] offset:2048
v_smfmac_f32_16x16x64_bf16 v[8:11], v[32:35], v[64:71], v1
v_bitop3_b32 v44, v32, v34, s18 bitop3:0x7e
v_smfmac_f32_16x16x64_bf16 v[20:23], v[32:35], v[48:55], v1
s_waitcnt vmcnt(2)
ds_write_b128 v0, v[36:39] offset:6144
v_bitop3_b32 v45, v36, v38, s18 bitop3:0x7e
v_smfmac_f32_16x16x64_bf16 v[16:19], v[32:35], v[56:63], v1
v_bitop3_b32 v44, v44, v45, s19 bitop3:0xa8
v_cmp_ne_u32 vcc, 0, v44
v_smfmac_f32_16x16x64_bf16 v[28:31], v[32:35], a[8:15], v1
s_cbranch_vccnz rt_10106
ds_read_b128 v[52:55], v2 offset:3072
v_smfmac_f32_16x16x64_bf16 v[8:11], v[36:39], a[16:23], v1
s_waitcnt lgkmcnt(1)
ds_read_b128 v[60:63], v2 offset:1024
global_load_dwordx4 v[64:67], v0, s[78:79] offset:-2048 sc1
ds_read_b128 v[56:59], v2 offset:0
v_smfmac_f32_16x16x64_bf16 v[24:27], v[32:35], a[0:7], v1
ds_read_b128 v[48:51], v2 offset:2048
s_barrier
ds_read_b128 v[40:43], v0 offset:3072
v_smfmac_f32_16x16x64_bf16 v[20:23], v[36:39], a[40:47], v1
s_mov_b64 s[68:69], s[72:73]
ds_read_b128 v[44:47], v0 offset:7168
global_load_dwordx4 v[68:71], v0, s[78:79] offset:-1024 sc1
v_smfmac_f32_16x16x64_bf16 v[16:19], v[36:39], a[32:39], v1
s_xor_b32 s18, s18, 1
ds_read_b128 v[32:35], v0 offset:0
s_waitcnt lgkmcnt(4)
v_smfmac_f32_16x16x64_bf16 v[24:27], v[36:39], v[56:63], v1
ds_read_b128 v[56:59], v2 offset:4096
v_smfmac_f32_16x16x64_bf16 v[12:15], v[36:39], a[24:31], v1
ds_read_b128 v[60:63], v2 offset:5120
s_waitcnt lgkmcnt(4)
s_waitcnt vmcnt(2)
v_smfmac_f32_16x16x64_bf16 v[12:15], v[40:43], v[80:87], v1
ds_read_b128 v[84:87], v2 offset:7168
s_waitcnt lgkmcnt(4)
v_smfmac_f32_16x16x64_bf16 v[28:31], v[36:39], v[48:55], v1
ds_read_b128 v[80:83], v2 offset:6144
global_load_dwordx4 v[72:75], v0, s[78:79] offset:0 sc1
v_smfmac_f32_16x16x64_bf16 v[8:11], v[40:43], a[48:55], v1
ds_read_b128 v[36:39], v0 offset:4096
global_load_dwordx4 v[76:79], v0, s[78:79] offset:1024 sc1
v_smfmac_f32_16x16x64_bf16 v[12:15], v[44:47], a[64:71], v1
ds_read_b128 v[40:43], v0 offset:1024
s_waitcnt lgkmcnt(5)
v_smfmac_f32_16x16x64_bf16 v[8:11], v[44:47], a[56:63], v1
ds_read_b128 v[44:47], v0 offset:5120
s_waitcnt lgkmcnt(5)
v_smfmac_f32_16x16x64_bf16 v[8:11], v[32:35], v[56:63], v1
s_waitcnt lgkmcnt(3)
ds_read_b128 v[60:63], v2 offset:9216
v_smfmac_f32_16x16x64_bf16 v[12:15], v[32:35], a[72:79], v1
s_waitcnt lgkmcnt(3)
ds_read_b128 v[56:59], v2 offset:8192
v_smfmac_f32_16x16x64_bf16 v[12:15], v[36:39], v[80:87], v1
ds_read_b128 v[32:35], v0 offset:8192
v_smfmac_f32_16x16x64_bf16 v[8:11], v[36:39], a[80:87], v1
s_waitcnt lgkmcnt(4)
ds_read_b128 v[80:83], v2 offset:10240
global_load_dwordx4 v[48:51], v0, s[58:59] offset:0 nt sc1
ds_read_b128 v[84:87], v2 offset:11264
v_smfmac_f32_16x16x64_bf16 v[8:11], v[40:43], a[88:95], v1
s_add_u32 s20, s20, 524288
s_waitcnt lgkmcnt(5)
ds_read_b128 v[36:39], v0 offset:9216
v_smfmac_f32_16x16x64_bf16 v[12:15], v[40:43], a[96:103], v1
s_waitcnt lgkmcnt(4)
ds_read_b128 v[40:43], v0 offset:3072
v_smfmac_f32_16x16x64_bf16 v[8:11], v[44:47], v[56:63], v1
global_load_dwordx4 v[52:55], v0, s[58:59] offset:1024 nt sc1
ds_read_b128 v[60:63], v2 offset:13312
v_smfmac_f32_16x16x64_bf16 v[12:15], v[44:47], a[104:111], v1
s_waitcnt lgkmcnt(4)
ds_read_b128 v[56:59], v2 offset:12288
s_waitcnt lgkmcnt(4)
v_smfmac_f32_16x16x64_bf16 v[12:15], v[32:35], v[80:87], v1
s_waitcnt vmcnt(4)
ds_read_b128 v[80:83], v2 offset:14336
s_mov_b64 vcc, s[42:43]
v_smfmac_f32_16x16x64_bf16 v[8:11], v[32:35], a[112:119], v1
s_waitcnt lgkmcnt(4)
ds_read_b128 v[84:87], v2 offset:15360
v_smfmac_f32_16x16x64_bf16 v[8:11], v[36:39], v[64:71], v1
s_nop 0
ds_read_b128 v[32:35], v0 offset:7168
global_load_dwordx4 v[64:67], v0, s[78:79] offset:2048 sc1
v_smfmac_f32_16x16x64_bf16 v[12:15], v[36:39], a[120:127], v1
s_nop 0
ds_read_b128 v[36:39], v0 offset:0
s_waitcnt lgkmcnt(4)
s_nop 0
v_add_f32 v8, v8, v10
v_smfmac_f32_16x16x64_bf16 v[16:19], v[40:43], v[56:63], v1
ds_read_b128 v[60:63], v2 offset:17408
global_load_dwordx4 v[68:71], v0, s[78:79] offset:3072 sc1
ds_read_b128 v[56:59], v2 offset:16384
v_mul_f32 v8, s35, v8
v_smfmac_f32_16x16x64_bf16 v[20:23], v[40:43], a[128:135], v1
s_waitcnt lgkmcnt(3)
ds_read_b128 v[40:43], v0 offset:4096
v_add_f32 v12, v12, v14
v_smfmac_f32_16x16x64_bf16 v[20:23], v[32:35], v[80:87], v1
s_waitcnt lgkmcnt(3)
ds_read_b128 v[80:83], v2 offset:18432
v_add_f32 v13, v13, v15
v_smfmac_f32_16x16x64_bf16 v[16:19], v[32:35], a[136:143], v1
ds_read_b128 v[32:35], v0 offset:1024
v_add_f32 v9, v9, v11
v_smfmac_f32_16x16x64_bf16 v[20:23], v[36:39], a[152:159], v1
s_waitcnt vmcnt(4)
ds_read_b128 v[84:87], v2 offset:19456
v_mul_f32 v13, s35, v13
v_mul_f32 v12, s35, v12
v_mul_f32 v9, s35, v9
v_cvt_pk_bf16_f32 v8, v8, v9
v_cvt_pk_bf16_f32 v12, v12, v13
v_smfmac_f32_16x16x64_bf16 v[16:19], v[36:39], a[144:151], v1
s_waitcnt lgkmcnt(3)
ds_read_b128 v[36:39], v0 offset:5120
ds_write2_b32 v3, v8, v12 offset0:0 offset1:128
v_smfmac_f32_16x16x64_bf16 v[16:19], v[40:43], v[72:79], v1
global_load_dwordx4 v[72:75], v0, s[80:81] offset:-4096 sc1
v_smfmac_f32_16x16x64_bf16 v[20:23], v[40:43], v[56:63], v1
s_waitcnt lgkmcnt(3)
global_load_dwordx4 v[76:79], v0, s[80:81] offset:-3072 sc1
v_smfmac_f32_16x16x64_bf16 v[20:23], v[32:35], a[168:175], v1
ds_read_b128 v[40:43], v0 offset:8192
global_load_dwordx4 v[56:59], v0, s[58:59] offset:2048 nt sc1
global_load_dwordx4 v[60:63], v0, s[58:59] offset:3072 nt sc1
v_smfmac_f32_16x16x64_bf16 v[16:19], v[32:35], a[160:167], v1
s_waitcnt lgkmcnt(1)
ds_read_b128 v[32:35], v0 offset:9216
v_smfmac_f32_16x16x64_bf16 v[16:19], v[36:39], a[176:183], v1
s_barrier
ds_read_b64_tr_b16 v[10:11], v4 offset:2560
v_smfmac_f32_16x16x64_bf16 v[20:23], v[36:39], v[80:87], v1
s_waitcnt lgkmcnt(2)
ds_read_b128 v[36:39], v0 offset:8192
ds_read_b64_tr_b16 v[14:15], v4 offset:3584
v_smfmac_f32_16x16x64_bf16 v[20:23], v[40:43], a[192:199], v1
ds_read_b64_tr_b16 v[12:13], v4 offset:3072
s_waitcnt lgkmcnt(4)
ds_read_b64_tr_b16 v[8:9], v4 offset:2048
v_smfmac_f32_16x16x64_bf16 v[16:19], v[40:43], a[184:191], v1
s_waitcnt vmcnt(5)
ds_read_b128 v[40:43], v0 offset:9216
v_smfmac_f32_16x16x64_bf16 v[16:19], v[32:35], a[200:207], v1
v_smfmac_f32_16x16x64_bf16 v[20:23], v[32:35], a[208:215], v1
s_waitcnt lgkmcnt(3)
ds_read_b128 v[80:83], v2 offset:20480
global_load_dword v7, v7, s[4:5] sc1
ds_read_b128 v[84:87], v2 offset:21504
v_smfmac_f32_16x16x64_bf16 v[24:27], v[36:39], a[216:223], v1
s_waitcnt lgkmcnt(3)
ds_read_b128 v[32:35], v0 offset:3072
v_add_f32 v16, v16, v18
v_mfma_f32_16x16x32_bf16 v[44:47], v[48:51], v[8:11], 0
v_bfe_u32 v48, v0, 5, 1
v_add_f32 v17, v17, v19
v_mfma_f32_16x16x32_bf16 v[44:47], v[52:55], v[12:15], v[44:47]
s_nop 0
v_lshl_add_u32 v48, v48, 3, v5
v_add_f32 v20, v20, v22
v_smfmac_f32_16x16x64_bf16 v[28:31], v[36:39], a[224:231], v1
s_waitcnt lgkmcnt(3)
ds_read_b128 v[36:39], v0 offset:7168
v_cvt_pk_bf16_f32 v16, v16, v17
v_add_f32 v21, v21, v23
v_cndmask_b32_dpp v44, v46, v44, vcc quad_perm:[0,1,0,1] row_mask:0xf bank_mask:0xf
v_cvt_pk_bf16_f32 v20, v20, v21
v_smfmac_f32_16x16x64_bf16 v[24:27], v[40:43], a[232:239], v1
s_waitcnt lgkmcnt(1)
ds_write2_b32 v3, v16, v20 offset0:1 offset1:129
v_cndmask_b32_dpp v45, v47, v45, vcc quad_perm:[0,1,0,1] row_mask:0xf bank_mask:0xf
v_smfmac_f32_16x16x64_bf16 v[28:31], v[40:43], v[80:87], v1
s_add_u32 s17, s17, 1
ds_write_b64 v48, v[44:45] offset:7168
v_smfmac_f32_16x16x64_bf16 v[24:27], v[32:35], a[240:247], v1
s_add_u32 s21, s21, 10240
ds_read_b128 v[40:43], v0 offset:0
v_smfmac_f32_16x16x64_bf16 v[28:31], v[32:35], a[248:255], v1
s_waitcnt vmcnt(5)
ds_read_b128 v[32:35], v0 offset:4096
s_waitcnt lgkmcnt(4)
v_smfmac_f32_16x16x64_bf16 v[24:27], v[36:39], v[64:71], v1
ds_read_b128 v[80:83], v2 offset:22528
global_load_dwordx4 v[64:67], v0, s[76:77] offset:-4096 sc1
v_smfmac_f32_16x16x64_bf16 v[28:31], v[36:39], v[88:95], v1
s_waitcnt lgkmcnt(3)
ds_read_b128 v[36:39], v0 offset:1024
s_barrier
ds_read_b128 v[52:55], v6 offset:7168
s_waitcnt lgkmcnt(4)
v_smfmac_f32_16x16x64_bf16 v[28:31], v[40:43], v[104:111], v1
s_waitcnt lgkmcnt(3)
ds_read_b128 v[48:51], v6 offset:6144
v_smfmac_f32_16x16x64_bf16 v[24:27], v[40:43], v[96:103], v1
ds_read_b128 v[40:43], v0 offset:5120
ds_read_b64_tr_b16 v[16:17], v4 offset:2048
v_smfmac_f32_16x16x64_bf16 v[24:27], v[32:35], v[112:119], v1
ds_read_b64_tr_b16 v[18:19], v4 offset:2560
s_waitcnt lgkmcnt(5)
ds_read_b64_tr_b16 v[14:15], v4 offset:1536
v_smfmac_f32_16x16x64_bf16 v[28:31], v[32:35], v[120:127], v1
s_waitcnt vmcnt(2)
ds_read_b64_tr_b16 v[8:9], v4 offset:0
ds_read_b64_tr_b16 v[12:13], v4 offset:1024
v_smfmac_f32_16x16x64_bf16 v[28:31], v[36:39], v[136:143], v1
s_waitcnt lgkmcnt(6)
ds_read_b64_tr_b16 v[10:11], v4 offset:512
v_add_f32 v49, v49, v53
v_smfmac_f32_16x16x64_bf16 v[24:27], v[36:39], v[128:135], v1
s_waitcnt lgkmcnt(6)
ds_read_b64_tr_b16 v[20:21], v4 offset:3072
v_add_f32 v50, v50, v54
v_smfmac_f32_16x16x64_bf16 v[28:31], v[40:43], v[144:151], v1
ds_read_b64_tr_b16 v[22:23], v4 offset:3584
v_add_f32 v51, v51, v55
v_exp_f32 v51, v51
v_exp_f32 v49, v49
v_smfmac_f32_16x16x64_bf16 v[24:27], v[40:43], v[72:79], v1
s_waitcnt lgkmcnt(2)
ds_read_b128 v[84:87], v2 offset:23552
v_add_f32 v48, v48, v52
v_exp_f32 v48, v48
v_exp_f32 v50, v50
v_mfma_f32_16x16x32_bf16 v[44:47], v[8:11], v[8:11], 0
s_waitcnt lgkmcnt(1)
v_cvt_pk_bf16_f32 v55, v50, v51
v_cvt_pk_bf16_f32 v54, v48, v49
v_mfma_f32_16x16x32_bf16 v[44:47], v[12:15], v[12:15], v[44:47]
v_mov_b32_dpp v51, v55 quad_perm:[2,3,2,3] row_mask:0xf bank_mask:0xf
v_mov_b32_dpp v50, v54 quad_perm:[2,3,2,3] row_mask:0xf bank_mask:0xf
v_mfma_f32_16x16x32_bf16 v[44:47], v[16:19], v[16:19], v[44:47]
v_mov_b32_dpp v49, v55 quad_perm:[0,1,0,1] row_mask:0xf bank_mask:0xf
v_mov_b32_dpp v48, v54 quad_perm:[0,1,0,1] row_mask:0xf bank_mask:0xf
v_mfma_f32_16x16x32_bf16 v[44:47], v[20:23], v[20:23], v[44:47]
v_mov_b64 v[20:21], s[44:45]
v_cvt_pk_bf16_f32 v24, v24, v25
v_mfma_f32_16x16x32_bf16 v[8:11], v[56:59], v[48:51], 0
s_add_u32 s34, s17, 2
v_mov_b64 v[22:23], s[44:45]
v_cvt_pk_bf16_f32 v25, v26, v27
v_mfma_f32_16x16x32_bf16 v[12:15], v[60:63], v[48:51], 0
s_nop 0
v_exp_f32_dpp v44, v46 quad_perm:[0,1,0,1] row_mask:0xf bank_mask:0xf
v_exp_f32_dpp v45, v47 quad_perm:[0,1,0,1] row_mask:0xf bank_mask:0xf
v_mfma_f32_16x16x32_bf16 v[16:19], v[20:23], v[48:51], 0
s_waitcnt lgkmcnt(0)
v_cvt_pk_bf16_f32 v52, v44, v45
v_cvt_pk_bf16_f32 v53, v44, v45
v_mov_b64 v[54:55], s[46:47]
v_cvt_pk_bf16_f32 v27, v30, v31
v_mfma_f32_16x16x16_bf16 v[8:11], v[24:25], v[52:53], v[8:11]
s_mov_b32 s19, 1
global_load_dwordx4 v[68:71], v0, s[76:77] offset:-3072 sc1
v_cvt_pk_bf16_f32 v26, v28, v29
v_mfma_f32_16x16x16_bf16 v[16:19], v[54:55], v[52:53], v[16:19]
s_min_u32 s34, s34, s32
v_mov_b64 v[38:39], 0
v_mov_b64 v[36:37], 0
v_mfma_f32_16x16x16_bf16 v[12:15], v[26:27], v[52:53], v[12:15]
s_nop 0
ds_read_b128 v[28:31], v0 offset:44032
v_bfe_u32 v32, v0, 5, 1
v_mov_b64 v[34:35], 0
v_rcp_f32 v18, v16
v_subrev_u32 v17, s37, v16
v_cmp_lt_u32 vcc, s38, v17
v_lshl_add_u32 v32, v32, 3, v5
v_cndmask_b32 v9, v13, v9, s[42:43]
v_cndmask_b32 v8, v12, v8, s[42:43]
v_cndmask_b32 v10, v14, v10, s[42:43]
v_mul_f32 v10, v10, v18
v_mul_f32 v9, v9, v18
v_mul_f32 v8, v8, v18
v_cndmask_b32 v11, v15, v11, s[42:43]
v_mul_f32 v11, v11, v18
v_cvt_pk_bf16_f32 v13, v10, v11
v_cvt_pk_bf16_f32 v12, v8, v9
s_cbranch_vccnz rare_10102
back_10103:
ds_read_b128 v[16:19], v0 offset:40960
ds_write_b64 v32, v[12:13] offset:1024
v_mov_b64 v[42:43], 0
v_mov_b64 v[32:33], 0
v_mov_b32_dpp v10, v12 quad_perm:[2,3,2,3] row_mask:0xf bank_mask:0xf
v_mov_b64 v[54:55], 0
v_mov_b32_dpp v8, v12 quad_perm:[0,1,0,1] row_mask:0xf bank_mask:0xf
v_mov_b32_dpp v11, v13 quad_perm:[2,3,2,3] row_mask:0xf bank_mask:0xf
v_mov_b32_dpp v9, v13 quad_perm:[0,1,0,1] row_mask:0xf bank_mask:0xf
v_mov_b64 v[52:53], 0
v_mov_b64 v[40:41], 0
v_smfmac_f32_16x16x64_bf16 v[36:39], v[8:11], v[80:87], v1
ds_read_b128 v[24:27], v0 offset:43008
global_load_dwordx4 v[72:75], v0, s[76:77] offset:-2048 sc1
ds_read_b128 v[20:23], v0 offset:41984
v_smfmac_f32_16x16x64_bf16 v[40:43], v[8:11], v[152:159], v1
s_waitcnt lgkmcnt(2)
ds_read_b128 v[80:83], v0 offset:45056
s_barrier
ds_read_b128 v[56:59], v5 offset:1536
v_smfmac_f32_16x16x64_bf16 v[32:35], v[8:11], v[176:183], v1
s_add_u32 s27, s20, 524288
ds_read_b128 v[60:63], v5 offset:0
v_mov_b64 v[48:49], 0
v_mov_b64 v[50:51], 0
v_smfmac_f32_16x16x64_bf16 v[52:55], v[8:11], v[168:175], v1
s_add_u32 s58, s4, s20
ds_read_b128 v[12:15], v5 offset:512
v_lshrrev_b32 v44, 8, v0
v_smfmac_f32_16x16x64_bf16 v[48:51], v[8:11], v[160:167], v1
s_waitcnt lgkmcnt(4)
ds_read_b128 v[84:87], v0 offset:46080
global_load_dwordx4 v[76:79], v0, s[76:77] offset:-1024 sc1
v_bfe_u32 v45, v0, 1, 7
s_waitcnt lgkmcnt(3)
v_smfmac_f32_16x16x64_bf16 v[36:39], v[56:59], v[16:23], v1
s_addc_u32 s59, s5, 0
ds_read_b128 v[16:19], v0 offset:47104
s_waitcnt lgkmcnt(3)
v_smfmac_f32_16x16x64_bf16 v[36:39], v[60:63], v[24:31], v1
ds_read_b128 v[28:31], v0 offset:50176
s_waitcnt lgkmcnt(3)
v_smfmac_f32_16x16x64_bf16 v[36:39], v[12:15], v[184:191], v1
ds_read_b128 v[20:23], v0 offset:48128
s_waitcnt lgkmcnt(3)
v_smfmac_f32_16x16x64_bf16 v[40:43], v[56:59], v[80:87], v1
ds_read_b128 v[24:27], v0 offset:49152
v_lshl_or_b32 v44, v44, 12, v45
v_smfmac_f32_16x16x64_bf16 v[40:43], v[60:63], v[192:199], v1
s_nop 0
ds_read_b128 v[84:87], v0 offset:52224
v_cvt_pk_bf16_f32 v36, v36, v37
v_and_or_b32 v36, v36, -2, s18
v_cvt_pk_bf16_f32 v37, v38, v39
v_smfmac_f32_16x16x64_bf16 v[40:43], v[12:15], v[200:207], v1
global_store_dwordx2 v44, v[36:37], s[48:49]
s_waitcnt lgkmcnt(2)
v_smfmac_f32_16x16x64_bf16 v[48:51], v[56:59], v[16:23], v1
ds_read_b128 v[80:83], v0 offset:51200
s_waitcnt lgkmcnt(2)
v_smfmac_f32_16x16x64_bf16 v[48:51], v[60:63], v[24:31], v1
s_mov_b32 s30, 0
s_nop 0
v_cvt_pk_bf16_f32 v40, v40, v41
v_cvt_pk_bf16_f32 v41, v42, v43
v_and_or_b32 v40, v40, -2, s18
v_smfmac_f32_16x16x64_bf16 v[48:51], v[12:15], v[208:215], v1
global_store_dwordx2 v44, v[40:41], s[50:51]
s_waitcnt lgkmcnt(1)
v_smfmac_f32_16x16x64_bf16 v[32:35], v[56:59], v[232:239], v1
s_nop 0
s_waitcnt lgkmcnt(0)
v_smfmac_f32_16x16x64_bf16 v[52:55], v[56:59], v[80:87], v1
s_nop 1
v_cvt_pk_bf16_f32 v48, v48, v49
v_smfmac_f32_16x16x64_bf16 v[52:55], v[60:63], v[216:223], v1
v_and_or_b32 v48, v48, -2, s18
v_cvt_pk_bf16_f32 v49, v50, v51
v_smfmac_f32_16x16x64_bf16 v[52:55], v[12:15], v[224:231], v1
global_store_dwordx2 v44, v[48:49], s[52:53]
v_smfmac_f32_16x16x64_bf16 v[32:35], v[60:63], v[240:247], v1
s_nop 2
v_smfmac_f32_16x16x64_bf16 v[32:35], v[12:15], v[248:255], v1
s_nop 1
v_cvt_pk_bf16_f32 v52, v52, v53
v_and_or_b32 v52, v52, -2, s18
v_cvt_pk_bf16_f32 v53, v54, v55
s_nop 0
global_store_dwordx2 v44, v[52:53], s[54:55]
s_nop 0
v_cvt_pk_bf16_f32 v32, v32, v33
v_cvt_pk_bf16_f32 v33, v34, v35
v_and_or_b32 v32, v32, -2, s18
global_store_dwordx2 v44, v[32:33], s[56:57]
s_cmp_ge_u32 s14, 16
s_cbranch_scc1 nored_10109
v_bfe_u32 v32, v0, 6, 1
v_lshlrev_b32 v32, 4, v32
v_mov_b32 v33, 0x3f80
v_lshlrev_b32 v32, v32, v33
v_bfe_i32 v33, v0, 4, 1
v_and_b32 v45, v32, v33
v_and_b32 v47, v32, v33
v_xor_b32 v44, v32, v45
v_xor_b32 v46, v32, v45
v_and_b32 v36, 32, v0
v_bfe_u32 v37, v0, 6, 1
v_lshl_add_u32 v36, v37, 8, v36
v_bfe_u32 v37, v0, 8, 1
v_lshl_add_u32 v36, v37, 4, v36
v_bfe_u32 v37, v0, 4, 1
v_lshl_add_u32 v36, v37, 3, v36
s_waitcnt vmcnt(9)
v_and_b32 v7, 511, v0
v_lshl_add_u32 v7, v7, 3, s27
s_nop 15
s_nop 15
s_nop 15
s_nop 15
s_nop 12
global_load_dwordx4 v[8:11], v0, s[64:65] offset:0 sc1
global_load_dwordx4 v[12:15], v0, s[64:65] offset:1024 sc1
global_load_dwordx4 v[16:19], v0, s[64:65] offset:2048 sc1
global_load_dwordx4 v[20:23], v0, s[64:65] offset:3072 sc1
s_nop 15
s_nop 15
s_nop 5
global_load_dwordx4 v[24:27], v0, s[64:65] offset:0 sc1
global_load_dwordx4 v[28:31], v0, s[64:65] offset:1024 sc1
global_load_dwordx4 v[80:83], v0, s[64:65] offset:2048 sc1
global_load_dwordx4 v[84:87], v0, s[64:65] offset:3072 sc1
chk_10111:
v_mov_b64 v[40:41], 0
v_mov_b64 v[42:43], 0
s_waitcnt vmcnt(6)
s_nop 0
v_smfmac_f32_16x16x64_bf16 v[40:43], v[44:47], v[8:15], v1
v_bitop3_b32 v32, v8, v10, s18 bitop3:0x7e
v_bitop3_b32 v33, v12, v14, s18 bitop3:0x7e
s_waitcnt vmcnt(4)
v_smfmac_f32_16x16x64_bf16 v[40:43], v[44:47], v[16:23], v1
v_bitop3_b32 v34, v16, v18, s18 bitop3:0x7e
v_bitop3_b32 v35, v20, v22, s18 bitop3:0x7e
v_or3_b32 v37, v32, v33, v34
v_bitop3_b32 v37, v37, v35, 1 bitop3:0xa8
v_cmp_ne_u32 vcc, 0, v37
s_cbranch_vccnz chk_10111_f
s_nop 1
v_add_f32_dpp v40, v40, v40 row_ror:8 row_mask:0xf bank_mask:0xf
v_add_f32_dpp v41, v41, v41 row_ror:8 row_mask:0xf bank_mask:0xf
v_add_f32_dpp v42, v42, v42 row_ror:8 row_mask:0xf bank_mask:0xf
v_add_f32_dpp v43, v43, v43 row_ror:8 row_mask:0xf bank_mask:0xf
v_cvt_pk_bf16_f32 v40, v40, v41
v_cvt_pk_bf16_f32 v41, v42, v43
v_and_or_b32 v40, v40, -2, s18
s_mov_b64 exec, 0x00ff00ff
global_store_dwordx2 v36, v[40:41], s[66:67]
s_mov_b64 exec, -1
s_branch join_10110
chk_10111_f:
global_load_dwordx4 v[8:11], v0, s[64:65] offset:0 sc1
global_load_dwordx4 v[12:15], v0, s[64:65] offset:1024 sc1
global_load_dwordx4 v[16:19], v0, s[64:65] offset:2048 sc1
global_load_dwordx4 v[20:23], v0, s[64:65] offset:3072 sc1
chk_10112:
v_mov_b64 v[40:41], 0
v_mov_b64 v[42:43], 0
s_waitcnt vmcnt(6)
s_nop 0
v_smfmac_f32_16x16x64_bf16 v[40:43], v[44:47], v[24:31], v1
v_bitop3_b32 v32, v24, v26, s18 bitop3:0x7e
v_bitop3_b32 v33, v28, v30, s18 bitop3:0x7e
s_waitcnt vmcnt(4)
v_smfmac_f32_16x16x64_bf16 v[40:43], v[44:47], v[80:87], v1
v_bitop3_b32 v34, v80, v82, s18 bitop3:0x7e
v_bitop3_b32 v35, v84, v86, s18 bitop3:0x7e
v_or3_b32 v37, v32, v33, v34
v_bitop3_b32 v37, v37, v35, 1 bitop3:0xa8
v_cmp_ne_u32 vcc, 0, v37
s_cbranch_vccnz chk_10112_f
s_nop 1
v_add_f32_dpp v40, v40, v40 row_ror:8 row_mask:0xf bank_mask:0xf
v_add_f32_dpp v41, v41, v41 row_ror:8 row_mask:0xf bank_mask:0xf
v_add_f32_dpp v42, v42, v42 row_ror:8 row_mask:0xf bank_mask:0xf
v_add_f32_dpp v43, v43, v43 row_ror:8 row_mask:0xf bank_mask:0xf
v_cvt_pk_bf16_f32 v40, v40, v41
v_cvt_pk_bf16_f32 v41, v42, v43
v_and_or_b32 v40, v40, -2, s18
s_mov_b64 exec, 0x00ff00ff
global_store_dwordx2 v36, v[40:41], s[66:67]
s_mov_b64 exec, -1
s_branch join_10110
chk_10112_f:
global_load_dwordx4 v[24:27], v0, s[64:65] offset:0 sc1
global_load_dwordx4 v[28:31], v0, s[64:65] offset:1024 sc1
global_load_dwordx4 v[80:83], v0, s[64:65] offset:2048 sc1
global_load_dwordx4 v[84:87], v0, s[64:65] offset:3072 sc1
s_add_u32 s30, s30, 1
s_cmp_le_u32 s30, 262144
s_cbranch_scc1 chk_10111
s_branch L_fail
nored_10109:
s_waitcnt vmcnt(9)
v_and_b32 v7, 511, v0
v_lshl_add_u32 v7, v7, 3, s27
join_10110:
s_barrier
global_load_dwordx4 v[56:59], v0, s[76:77] offset:0 sc1
global_load_dwordx4 v[60:63], v0, s[76:77] offset:1024 sc1
global_load_dwordx4 v[48:51], v0, s[76:77] offset:2048 sc1
global_load_dwordx4 v[52:55], v0, s[76:77] offset:3072 sc1
s_nop 15
s_nop 15
s_nop 3
s_barrier
global_load_dwordx4 v[32:35], v0, s[68:69] offset:-4096 sc1
s_nop 10
global_load_dwordx4 v[36:39], v0, s[68:69] offset:0 sc1
s_barrier
global_load_dwordx4 v[80:83], v0, s[78:79] offset:-4096 sc1
global_load_dwordx4 v[84:87], v0, s[78:79] offset:-3072 sc1
s_waitcnt vmcnt(12)
v_mov_b64 v[8:9], 0
v_mov_b64 v[10:11], 0
s_waitcnt vmcnt(11)
v_mov_b64 v[12:13], 0
v_mov_b64 v[14:15], 0
s_waitcnt vmcnt(10)
v_mov_b64 v[16:17], 0
v_mov_b64 v[18:19], 0
s_waitcnt vmcnt(9)
v_mov_b64 v[20:21], 0
v_mov_b64 v[22:23], 0
v_mov_b64 v[24:25], 0
v_mov_b64 v[26:27], 0
v_mov_b64 v[28:29], 0
v_mov_b64 v[30:31], 0
s_mov_b32 s30, 0
s_cmp_eq_u32 s17, s31
s_cbranch_scc0 gather_10101
s_branch exit_10104
rt_10106:
global_load_dwordx4 v[32:35], v0, s[68:69] offset:-4096 sc1
global_load_dwordx4 v[36:39], v0, s[68:69] offset:0 sc1
s_add_u32 s30, s30, 1
s_cmp_gt_u32 s30, 262144
s_cbranch_scc1 L_fail
s_mov_b64 exec, 1
global_store_dword v0, v0, s[62:63]
global_store_dword v0, v0, s[62:63]
s_mov_b64 exec, -1
v_mov_b64 v[8:9], 0
v_mov_b64 v[10:11], 0
v_mov_b64 v[12:13], 0
v_mov_b64 v[14:15], 0
v_mov_b64 v[16:17], 0
v_mov_b64 v[18:19], 0
v_mov_b64 v[20:21], 0
v_mov_b64 v[22:23], 0
v_mov_b64 v[24:25], 0
v_mov_b64 v[26:27], 0
v_mov_b64 v[28:29], 0
v_mov_b64 v[30:31], 0
s_branch gather_10101
rare_10102:
ds_read_b128 v[48:51], v6 offset:6144
ds_read_b128 v[52:55], v6 offset:7168
s_waitcnt lgkmcnt(0)
v_add_f32 v48, v48, v52
v_add_f32 v49, v49, v53
v_add_f32 v50, v50, v54
v_add_f32 v51, v51, v55
v_mov_b32_dpp v46, v46 quad_perm:[0,1,0,1] row_mask:0xf bank_mask:0xf
v_mov_b32_dpp v47, v47 quad_perm:[0,1,0,1] row_mask:0xf bank_mask:0xf
v_max3_f32 v19, v48, v49, v50
v_max3_f32 v19, v19, v51, v46
v_max_f32 v19, v19, v47
s_nop 1
v_max_f32_dpp v19, v19, v19 quad_perm:[2,3,0,1] row_mask:0xf bank_mask:0xf
v_mov_b32 v44, v19
s_nop 1
v_permlane32_swap_b32 v19, v44
v_max_f32 v19, v19, v44
v_mov_b32 v44, v19
s_nop 1
v_permlane16_swap_b32 v19, v44
v_max_f32 v19, v19, v44
v_sub_f32 v48, v48, v19
v_sub_f32 v49, v49, v19
v_sub_f32 v50, v50, v19
v_sub_f32 v51, v51, v19
v_sub_f32 v46, v46, v19
v_sub_f32 v47, v47, v19
v_exp_f32 v48, v48
v_exp_f32 v49, v49
v_exp_f32 v50, v50
v_exp_f32 v51, v51
v_cvt_pk_bf16_f32 v54, v48, v49
v_cvt_pk_bf16_f32 v55, v50, v51
s_nop 0
v_mov_b32_dpp v48, v54 quad_perm:[0,1,0,1] row_mask:0xf bank_mask:0xf
v_mov_b32_dpp v49, v55 quad_perm:[0,1,0,1] row_mask:0xf bank_mask:0xf
v_mov_b32_dpp v50, v54 quad_perm:[2,3,2,3] row_mask:0xf bank_mask:0xf
v_mov_b32_dpp v51, v55 quad_perm:[2,3,2,3] row_mask:0xf bank_mask:0xf
v_mov_b64 v[20:21], s[44:45]
v_mov_b64 v[22:23], s[44:45]
v_mfma_f32_16x16x32_bf16 v[8:11], v[56:59], v[48:51], 0
v_mfma_f32_16x16x32_bf16 v[12:15], v[60:63], v[48:51], 0
v_mfma_f32_16x16x32_bf16 v[16:19], v[20:23], v[48:51], 0
v_mov_b64 v[54:55], s[46:47]
v_exp_f32_dpp v44, v46 quad_perm:[0,1,0,1] row_mask:0xf bank_mask:0xf
v_exp_f32_dpp v45, v47 quad_perm:[0,1,0,1] row_mask:0xf bank_mask:0xf
s_nop 0
v_cvt_pk_bf16_f32 v52, v44, v45
v_cvt_pk_bf16_f32 v53, v44, v45
s_nop 1
v_mfma_f32_16x16x16_bf16 v[16:19], v[54:55], v[52:53], v[16:19]
v_mfma_f32_16x16x16_bf16 v[8:11], v[24:25], v[52:53], v[8:11]
v_mfma_f32_16x16x16_bf16 v[12:15], v[26:27], v[52:53], v[12:15]
s_nop 5
v_rcp_f32 v18, v16
s_nop 0
v_cndmask_b32 v8, v12, v8, s[42:43]
v_mul_f32 v8, v8, v18
v_cndmask_b32 v9, v13, v9, s[42:43]
v_mul_f32 v9, v9, v18
v_cndmask_b32 v10, v14, v10, s[42:43]
v_mul_f32 v10, v10, v18
v_cndmask_b32 v11, v15, v11, s[42:43]
v_mul_f32 v11, v11, v18
v_cvt_pk_bf16_f32 v12, v8, v9
v_cvt_pk_bf16_f32 v13, v10, v11
s_branch back_10103
exit_10104:
global_load_dwordx4 v[32:35], v0, s[68:69] offset:-4096 sc1
global_load_dwordx4 v[36:39], v0, s[68:69] offset:0 sc1
s_add_u32 s30, s30, 1
s_cmp_gt_u32 s30, 262144
s_cbranch_scc1 L_fail
s_waitcnt vmcnt(1)
v_bitop3_b32 v44, v32, v34, s18 bitop3:0x7e
s_waitcnt vmcnt(0)
v_bitop3_b32 v45, v36, v38, s18 bitop3:0x7e
v_bitop3_b32 v44, v44, v45, s19 bitop3:0xa8
v_cmp_ne_u32 vcc, 0, v44
s_cbranch_vccnz exit_10104
ds_write_b128 v0, v[32:35] offset:2048
ds_write_b128 v0, v[36:39] offset:6144
s_waitcnt lgkmcnt(0)
s_barrier
s_barrier
s_add_u32 s36, s36, 1
s_cmp_lt_u32 s36, 2
s_cbranch_scc1 layer_10100
s_endpgm
wave_10071:
layer_10113:
s_lshl_b32 s17, s36, 6
s_mul_i32 s27, s36, 35651584
s_mul_i32 s28, s14, 16384
s_add_u32 s27, s27, s28
s_add_u32 s20, s27, 16789504
s_mul_i32 s27, s17, 10240
s_add_u32 s27, s27, s24
s_add_u32 s21, s27, s25
s_mov_b32 s19, 0
s_mov_b32 s33, s6
s_add_u32 s34, s17, 1
s_add_u32 s31, s17, 63
s_add_u32 s32, s17, 64
s_mov_b32 s27, s20
v_mov_b32 v7, 0
s_add_u32 s68, s4, 416768
s_addc_u32 s69, s5, 0
s_add_u32 s72, s4, 400384
s_addc_u32 s73, s5, 0
s_add_u32 s70, s4, 420864
s_addc_u32 s71, s5, 0
s_add_u32 s74, s4, 404480
s_addc_u32 s75, s5, 0
s_add_u32 s58, s4, s20
s_addc_u32 s59, s5, 0
global_load_dwordx4 v[64:67], v0, s[76:77] offset:-4096 sc1
global_load_dwordx4 v[68:71], v0, s[76:77] offset:-3072 sc1
global_load_dwordx4 v[72:75], v0, s[76:77] offset:-2048 sc1
global_load_dwordx4 v[76:79], v0, s[76:77] offset:-1024 sc1
global_load_dwordx4 v[80:83], v0, s[78:79] offset:-4096 sc1
global_load_dwordx4 v[84:87], v0, s[78:79] offset:-3072 sc1
global_load_dwordx4 v[48:51], v0, s[76:77] offset:2048 sc1
global_load_dwordx4 v[52:55], v0, s[76:77] offset:3072 sc1
global_load_dwordx4 v[56:59], v0, s[76:77] offset:0 sc1
global_load_dwordx4 v[60:63], v0, s[76:77] offset:1024 sc1
v_mov_b64 v[8:9], 0
v_mov_b64 v[10:11], 0
v_mov_b64 v[12:13], 0
v_mov_b64 v[14:15], 0
v_mov_b64 v[16:17], 0
v_mov_b64 v[18:19], 0
v_mov_b64 v[20:21], 0
v_mov_b64 v[22:23], 0
v_mov_b64 v[24:25], 0
v_mov_b64 v[26:27], 0
v_mov_b64 v[28:29], 0
v_mov_b64 v[30:31], 0
s_barrier
v_and_b32 v7, 128, v0
v_add_u32 v7, s22, v7
s_mov_b32 exec_hi, 0
v_and_b32 v7, 511, v0
v_lshl_add_u32 v7, v7, 3, s27
s_mov_b32 exec_hi, -1
global_load_dwordx4 v[32:35], v0, s[68:69] offset:-4096 sc1
global_load_dwordx4 v[36:39], v0, s[68:69] offset:0 sc1
s_mov_b32 s30, 0
s_waitcnt vmcnt(0)
.p2align 6
gather_10114:
s_waitcnt vmcnt(3)
rt_10119_b:
v_smfmac_f32_16x16x64_bf16 v[12:15], v[32:35], v[72:79], v1
ds_write_b128 v0, v[32:35] offset:3072
v_smfmac_f32_16x16x64_bf16 v[8:11], v[32:35], v[64:71], v1
v_bitop3_b32 v44, v32, v34, s18 bitop3:0x7e
v_smfmac_f32_16x16x64_bf16 v[20:23], v[32:35], v[48:55], v1
s_waitcnt vmcnt(2)
ds_write_b128 v0, v[36:39] offset:7168
v_bitop3_b32 v45, v36, v38, s18 bitop3:0x7e
v_smfmac_f32_16x16x64_bf16 v[16:19], v[32:35], v[56:63], v1
v_bitop3_b32 v44, v44, v45, s19 bitop3:0xa8
v_cmp_ne_u32 vcc, 0, v44
v_smfmac_f32_16x16x64_bf16 v[28:31], v[32:35], a[8:15], v1
s_cbranch_vccnz rt_10119
ds_read_b128 v[52:55], v2 offset:3072
v_smfmac_f32_16x16x64_bf16 v[8:11], v[36:39], a[16:23], v1
s_waitcnt lgkmcnt(1)
ds_read_b128 v[60:63], v2 offset:1024
global_load_dwordx4 v[64:67], v0, s[78:79] offset:-2048 sc1
ds_read_b128 v[56:59], v2 offset:0
v_smfmac_f32_16x16x64_bf16 v[24:27], v[32:35], a[0:7], v1
ds_read_b128 v[48:51], v2 offset:2048
s_barrier
ds_read_b128 v[40:43], v0 offset:2048
v_smfmac_f32_16x16x64_bf16 v[20:23], v[36:39], a[40:47], v1
s_mov_b64 s[68:69], s[72:73]
ds_read_b128 v[44:47], v0 offset:6144
global_load_dwordx4 v[68:71], v0, s[78:79] offset:-1024 sc1
v_smfmac_f32_16x16x64_bf16 v[16:19], v[36:39], a[32:39], v1
s_xor_b32 s18, s18, 1
ds_read_b128 v[32:35], v0 offset:1024
s_waitcnt lgkmcnt(4)
v_smfmac_f32_16x16x64_bf16 v[24:27], v[36:39], v[56:63], v1
ds_read_b128 v[56:59], v2 offset:4096
v_smfmac_f32_16x16x64_bf16 v[12:15], v[36:39], a[24:31], v1
ds_read_b128 v[60:63], v2 offset:5120
s_waitcnt lgkmcnt(4)
s_waitcnt vmcnt(2)
v_smfmac_f32_16x16x64_bf16 v[12:15], v[40:43], v[80:87], v1
ds_read_b128 v[84:87], v2 offset:7168
s_waitcnt lgkmcnt(4)
v_smfmac_f32_16x16x64_bf16 v[28:31], v[36:39], v[48:55], v1
ds_read_b128 v[80:83], v2 offset:6144
global_load_dwordx4 v[72:75], v0, s[78:79] offset:0 sc1
v_smfmac_f32_16x16x64_bf16 v[8:11], v[40:43], a[48:55], v1
ds_read_b128 v[36:39], v0 offset:5120
global_load_dwordx4 v[76:79], v0, s[78:79] offset:1024 sc1
v_smfmac_f32_16x16x64_bf16 v[12:15], v[44:47], a[64:71], v1
ds_read_b128 v[40:43], v0 offset:0
s_waitcnt lgkmcnt(5)
v_smfmac_f32_16x16x64_bf16 v[8:11], v[44:47], a[56:63], v1
ds_read_b128 v[44:47], v0 offset:4096
s_waitcnt lgkmcnt(5)
v_smfmac_f32_16x16x64_bf16 v[8:11], v[32:35], v[56:63], v1
s_waitcnt lgkmcnt(3)
ds_read_b128 v[60:63], v2 offset:9216
v_smfmac_f32_16x16x64_bf16 v[12:15], v[32:35], a[72:79], v1
s_waitcnt lgkmcnt(3)
ds_read_b128 v[56:59], v2 offset:8192
v_smfmac_f32_16x16x64_bf16 v[12:15], v[36:39], v[80:87], v1
ds_read_b128 v[32:35], v0 offset:9216
v_smfmac_f32_16x16x64_bf16 v[8:11], v[36:39], a[80:87], v1
s_waitcnt lgkmcnt(4)
ds_read_b128 v[80:83], v2 offset:10240
global_load_dwordx4 v[48:51], v0, s[58:59] offset:0 nt sc1
ds_read_b128 v[84:87], v2 offset:11264
v_smfmac_f32_16x16x64_bf16 v[8:11], v[40:43], a[88:95], v1
s_add_u32 s20, s20, 524288
s_waitcnt lgkmcnt(5)
ds_read_b128 v[36:39], v0 offset:8192
v_smfmac_f32_16x16x64_bf16 v[12:15], v[40:43], a[96:103], v1
s_waitcnt lgkmcnt(4)
ds_read_b128 v[40:43], v0 offset:2048
v_smfmac_f32_16x16x64_bf16 v[8:11], v[44:47], v[56:63], v1
global_load_dwordx4 v[52:55], v0, s[58:59] offset:1024 nt sc1
ds_read_b128 v[60:63], v2 offset:13312
v_smfmac_f32_16x16x64_bf16 v[12:15], v[44:47], a[104:111], v1
s_waitcnt lgkmcnt(4)
ds_read_b128 v[56:59], v2 offset:12288
s_waitcnt lgkmcnt(4)
v_smfmac_f32_16x16x64_bf16 v[12:15], v[32:35], v[80:87], v1
s_waitcnt vmcnt(4)
ds_read_b128 v[80:83], v2 offset:14336
s_mov_b64 vcc, s[42:43]
v_smfmac_f32_16x16x64_bf16 v[8:11], v[32:35], a[112:119], v1
s_waitcnt lgkmcnt(4)
ds_read_b128 v[84:87], v2 offset:15360
v_add_u32 v44, s24, v0
v_smfmac_f32_16x16x64_bf16 v[8:11], v[36:39], v[64:71], v1
s_nop 0
ds_read_b128 v[32:35], v0 offset:6144
global_load_dwordx4 v[64:67], v0, s[78:79] offset:2048 sc1
v_smfmac_f32_16x16x64_bf16 v[12:15], v[36:39], a[120:127], v1
s_nop 0
ds_read_b128 v[36:39], v0 offset:1024
s_waitcnt lgkmcnt(4)
ds_read_b128 v[44:47], v44
v_add_f32 v8, v8, v10
v_smfmac_f32_16x16x64_bf16 v[16:19], v[40:43], v[56:63], v1
ds_read_b128 v[60:63], v2 offset:17408
global_load_dwordx4 v[68:71], v0, s[78:79] offset:3072 sc1
ds_read_b128 v[56:59], v2 offset:16384
v_mul_f32 v8, s35, v8
v_smfmac_f32_16x16x64_bf16 v[20:23], v[40:43], a[128:135], v1
s_waitcnt lgkmcnt(4)
ds_read_b128 v[40:43], v0 offset:5120
v_add_f32 v12, v12, v14
v_smfmac_f32_16x16x64_bf16 v[20:23], v[32:35], v[80:87], v1
s_waitcnt lgkmcnt(4)
ds_read_b128 v[80:83], v2 offset:18432
v_add_f32 v13, v13, v15
v_smfmac_f32_16x16x64_bf16 v[16:19], v[32:35], a[136:143], v1
ds_read_b128 v[32:35], v0 offset:0
v_add_f32 v9, v9, v11
v_smfmac_f32_16x16x64_bf16 v[20:23], v[36:39], a[152:159], v1
s_waitcnt vmcnt(4)
ds_read_b128 v[84:87], v2 offset:19456
v_mul_f32 v13, s35, v13
v_mul_f32 v12, s35, v12
v_mul_f32 v9, s35, v9
v_cvt_pk_bf16_f32 v8, v8, v9
v_cvt_pk_bf16_f32 v12, v12, v13
v_smfmac_f32_16x16x64_bf16 v[16:19], v[36:39], a[144:151], v1
s_waitcnt lgkmcnt(3)
ds_read_b128 v[36:39], v0 offset:4096
ds_write2_b32 v3, v8, v12 offset0:0 offset1:128
v_smfmac_f32_16x16x64_bf16 v[16:19], v[40:43], v[72:79], v1
global_load_dwordx4 v[72:75], v0, s[80:81] offset:-4096 sc1
v_smfmac_f32_16x16x64_bf16 v[20:23], v[40:43], v[56:63], v1
s_waitcnt lgkmcnt(3)
global_load_dwordx4 v[76:79], v0, s[80:81] offset:-3072 sc1
v_smfmac_f32_16x16x64_bf16 v[20:23], v[32:35], a[168:175], v1
ds_read_b128 v[40:43], v0 offset:9216
global_load_dwordx4 v[56:59], v0, s[58:59] offset:2048 nt sc1
global_load_dwordx4 v[60:63], v0, s[58:59] offset:3072 nt sc1
v_smfmac_f32_16x16x64_bf16 v[16:19], v[32:35], a[160:167], v1
s_waitcnt lgkmcnt(1)
ds_read_b128 v[32:35], v0 offset:8192
v_swap_b32 v45, v46
v_smfmac_f32_16x16x64_bf16 v[16:19], v[36:39], a[176:183], v1
s_barrier
ds_read_b64_tr_b16 v[10:11], v4 offset:2560
v_smfmac_f32_16x16x64_bf16 v[20:23], v[36:39], v[80:87], v1
s_waitcnt lgkmcnt(2)
ds_read_b128 v[36:39], v0 offset:9216
ds_read_b64_tr_b16 v[14:15], v4 offset:3584
v_smfmac_f32_16x16x64_bf16 v[20:23], v[40:43], a[192:199], v1
ds_read_b64_tr_b16 v[12:13], v4 offset:3072
buffer_store_dwordx4 v[44:47], v0, s[4:7], s21 offen sc1
s_waitcnt lgkmcnt(4)
ds_read_b64_tr_b16 v[8:9], v4 offset:2048
v_smfmac_f32_16x16x64_bf16 v[16:19], v[40:43], a[184:191], v1
s_waitcnt vmcnt(6)
ds_read_b128 v[40:43], v0 offset:8192
v_mov_b32 v47, s17
v_smfmac_f32_16x16x64_bf16 v[16:19], v[32:35], a[200:207], v1
s_mov_b64 exec, 1
buffer_store_dword v47, off, s[4:7], s33 sc1
s_mov_b64 exec, -1
v_smfmac_f32_16x16x64_bf16 v[20:23], v[32:35], a[208:215], v1
s_waitcnt lgkmcnt(3)
ds_read_b128 v[80:83], v2 offset:20480
global_load_dword v7, v7, s[4:5] sc1
ds_read_b128 v[84:87], v2 offset:21504
v_smfmac_f32_16x16x64_bf16 v[24:27], v[36:39], a[216:223], v1
s_waitcnt lgkmcnt(3)
ds_read_b128 v[32:35], v0 offset:2048
v_add_f32 v16, v16, v18
v_mfma_f32_16x16x32_bf16 v[44:47], v[48:51], v[8:11], 0
v_bfe_u32 v48, v0, 5, 1
v_add_f32 v17, v17, v19
v_mfma_f32_16x16x32_bf16 v[44:47], v[52:55], v[12:15], v[44:47]
s_nop 0
v_lshl_add_u32 v48, v48, 3, v5
v_add_f32 v20, v20, v22
v_smfmac_f32_16x16x64_bf16 v[28:31], v[36:39], a[224:231], v1
s_waitcnt lgkmcnt(3)
ds_read_b128 v[36:39], v0 offset:6144
v_cvt_pk_bf16_f32 v16, v16, v17
v_add_f32 v21, v21, v23
v_cndmask_b32_dpp v44, v46, v44, vcc quad_perm:[0,1,0,1] row_mask:0xf bank_mask:0xf
v_cvt_pk_bf16_f32 v20, v20, v21
v_smfmac_f32_16x16x64_bf16 v[24:27], v[40:43], a[232:239], v1
s_waitcnt lgkmcnt(1)
ds_write2_b32 v3, v16, v20 offset0:1 offset1:129
v_cndmask_b32_dpp v45, v47, v45, vcc quad_perm:[0,1,0,1] row_mask:0xf bank_mask:0xf
v_xor_b32 v48, 128, v48
v_smfmac_f32_16x16x64_bf16 v[28:31], v[40:43], v[80:87], v1
s_add_u32 s17, s17, 1
ds_write_b64 v48, v[44:45] offset:7680
v_smfmac_f32_16x16x64_bf16 v[24:27], v[32:35], a[240:247], v1
s_add_u32 s21, s21, 10240
ds_read_b128 v[40:43], v0 offset:1024
v_smfmac_f32_16x16x64_bf16 v[28:31], v[32:35], a[248:255], v1
s_waitcnt vmcnt(7)
ds_read_b128 v[32:35], v0 offset:5120
s_waitcnt lgkmcnt(4)
v_smfmac_f32_16x16x64_bf16 v[24:27], v[36:39], v[64:71], v1
ds_read_b128 v[80:83], v2 offset:22528
global_load_dwordx4 v[64:67], v0, s[76:77] offset:-4096 sc1
v_smfmac_f32_16x16x64_bf16 v[28:31], v[36:39], v[88:95], v1
s_waitcnt lgkmcnt(3)
ds_read_b128 v[36:39], v0 offset:0
s_barrier
ds_read_b128 v[52:55], v6 offset:7168
s_waitcnt lgkmcnt(4)
v_smfmac_f32_16x16x64_bf16 v[28:31], v[40:43], v[104:111], v1
s_waitcnt lgkmcnt(3)
ds_read_b128 v[48:51], v6 offset:6144
v_smfmac_f32_16x16x64_bf16 v[24:27], v[40:43], v[96:103], v1
ds_read_b128 v[40:43], v0 offset:4096
ds_read_b64_tr_b16 v[16:17], v4 offset:2048
v_smfmac_f32_16x16x64_bf16 v[24:27], v[32:35], v[112:119], v1
ds_read_b64_tr_b16 v[18:19], v4 offset:2560
s_waitcnt lgkmcnt(5)
ds_read_b64_tr_b16 v[14:15], v4 offset:1536
v_smfmac_f32_16x16x64_bf16 v[28:31], v[32:35], v[120:127], v1
s_waitcnt vmcnt(4)
ds_read_b64_tr_b16 v[8:9], v4 offset:0
ds_read_b64_tr_b16 v[12:13], v4 offset:1024
v_smfmac_f32_16x16x64_bf16 v[28:31], v[36:39], v[136:143], v1
s_waitcnt lgkmcnt(6)
ds_read_b64_tr_b16 v[10:11], v4 offset:512
v_add_f32 v49, v49, v53
v_smfmac_f32_16x16x64_bf16 v[24:27], v[36:39], v[128:135], v1
s_waitcnt lgkmcnt(6)
ds_read_b64_tr_b16 v[20:21], v4 offset:3072
v_add_f32 v50, v50, v54
v_smfmac_f32_16x16x64_bf16 v[28:31], v[40:43], v[144:151], v1
ds_read_b64_tr_b16 v[22:23], v4 offset:3584
v_add_f32 v51, v51, v55
v_exp_f32 v51, v51
v_exp_f32 v49, v49
v_smfmac_f32_16x16x64_bf16 v[24:27], v[40:43], v[72:79], v1
s_waitcnt lgkmcnt(2)
ds_read_b128 v[84:87], v2 offset:23552
v_add_f32 v48, v48, v52
v_exp_f32 v48, v48
v_exp_f32 v50, v50
v_mfma_f32_16x16x32_bf16 v[44:47], v[8:11], v[8:11], 0
s_waitcnt lgkmcnt(1)
v_cvt_pk_bf16_f32 v55, v50, v51
v_cvt_pk_bf16_f32 v54, v48, v49
v_mfma_f32_16x16x32_bf16 v[44:47], v[12:15], v[12:15], v[44:47]
v_mov_b32_dpp v51, v55 quad_perm:[2,3,2,3] row_mask:0xf bank_mask:0xf
v_mov_b32_dpp v50, v54 quad_perm:[2,3,2,3] row_mask:0xf bank_mask:0xf
v_mfma_f32_16x16x32_bf16 v[44:47], v[16:19], v[16:19], v[44:47]
v_mov_b32_dpp v49, v55 quad_perm:[0,1,0,1] row_mask:0xf bank_mask:0xf
v_mov_b32_dpp v48, v54 quad_perm:[0,1,0,1] row_mask:0xf bank_mask:0xf
v_mfma_f32_16x16x32_bf16 v[44:47], v[20:23], v[20:23], v[44:47]
v_mov_b64 v[20:21], s[44:45]
v_cvt_pk_bf16_f32 v24, v24, v25
v_mfma_f32_16x16x32_bf16 v[8:11], v[56:59], v[48:51], 0
s_add_u32 s34, s17, 2
v_mov_b64 v[22:23], s[44:45]
v_cvt_pk_bf16_f32 v25, v26, v27
v_mfma_f32_16x16x32_bf16 v[12:15], v[60:63], v[48:51], 0
s_nop 0
v_exp_f32_dpp v44, v46 quad_perm:[0,1,0,1] row_mask:0xf bank_mask:0xf
v_exp_f32_dpp v45, v47 quad_perm:[0,1,0,1] row_mask:0xf bank_mask:0xf
v_mfma_f32_16x16x32_bf16 v[16:19], v[20:23], v[48:51], 0
s_waitcnt lgkmcnt(0)
v_cvt_pk_bf16_f32 v52, v44, v45
v_cvt_pk_bf16_f32 v53, v44, v45
v_mov_b64 v[54:55], s[46:47]
v_cvt_pk_bf16_f32 v27, v30, v31
v_mfma_f32_16x16x16_bf16 v[8:11], v[24:25], v[52:53], v[8:11]
s_mov_b32 s19, 1
global_load_dwordx4 v[68:71], v0, s[76:77] offset:-3072 sc1
v_cvt_pk_bf16_f32 v26, v28, v29
v_mfma_f32_16x16x16_bf16 v[16:19], v[54:55], v[52:53], v[16:19]
s_min_u32 s34, s34, s32
v_mov_b64 v[38:39], 0
v_mov_b64 v[36:37], 0
v_mfma_f32_16x16x16_bf16 v[12:15], v[26:27], v[52:53], v[12:15]
s_nop 0
ds_read_b128 v[28:31], v0 offset:56320
v_bfe_u32 v32, v0, 5, 1
v_mov_b64 v[34:35], 0
v_rcp_f32 v18, v16
v_subrev_u32 v17, s37, v16
v_cmp_lt_u32 vcc, s38, v17
v_lshl_add_u32 v32, v32, 3, v5
v_cndmask_b32 v9, v13, v9, s[42:43]
v_cndmask_b32 v8, v12, v8, s[42:43]
v_cndmask_b32 v10, v14, v10, s[42:43]
v_mul_f32 v10, v10, v18
v_mul_f32 v9, v9, v18
v_mul_f32 v8, v8, v18
v_cndmask_b32 v11, v15, v11, s[42:43]
v_mul_f32 v11, v11, v18
v_cvt_pk_bf16_f32 v13, v10, v11
v_cvt_pk_bf16_f32 v12, v8, v9
s_cbranch_vccnz rare_10115
back_10116:
ds_read_b128 v[16:19], v0 offset:53248
ds_write_b64 v32, v[12:13] offset:1536
v_mov_b64 v[42:43], 0
v_mov_b64 v[32:33], 0
v_mov_b32_dpp v10, v12 quad_perm:[2,3,2,3] row_mask:0xf bank_mask:0xf
v_mov_b64 v[54:55], 0
v_mov_b32_dpp v8, v12 quad_perm:[0,1,0,1] row_mask:0xf bank_mask:0xf
v_mov_b32_dpp v11, v13 quad_perm:[2,3,2,3] row_mask:0xf bank_mask:0xf
v_mov_b32_dpp v9, v13 quad_perm:[0,1,0,1] row_mask:0xf bank_mask:0xf
v_mov_b64 v[52:53], 0
v_mov_b64 v[40:41], 0
v_smfmac_f32_16x16x64_bf16 v[36:39], v[8:11], v[80:87], v1
ds_read_b128 v[24:27], v0 offset:55296
global_load_dwordx4 v[72:75], v0, s[76:77] offset:-2048 sc1
ds_read_b128 v[20:23], v0 offset:54272
v_smfmac_f32_16x16x64_bf16 v[40:43], v[8:11], v[152:159], v1
s_waitcnt lgkmcnt(2)
ds_read_b128 v[80:83], v0 offset:57344
s_barrier
ds_read_b128 v[56:59], v5 offset:1024
v_smfmac_f32_16x16x64_bf16 v[32:35], v[8:11], v[176:183], v1
s_add_u32 s27, s20, 524288
ds_read_b128 v[60:63], v5 offset:512
v_mov_b64 v[48:49], 0
v_mov_b64 v[50:51], 0
v_smfmac_f32_16x16x64_bf16 v[52:55], v[8:11], v[168:175], v1
s_add_u32 s58, s4, s20
ds_read_b128 v[12:15], v5 offset:0
v_lshrrev_b32 v44, 8, v0
v_smfmac_f32_16x16x64_bf16 v[48:51], v[8:11], v[160:167], v1
s_waitcnt lgkmcnt(4)
ds_read_b128 v[84:87], v0 offset:58368
global_load_dwordx4 v[76:79], v0, s[76:77] offset:-1024 sc1
v_bfe_u32 v45, v0, 1, 7
s_waitcnt lgkmcnt(3)
v_smfmac_f32_16x16x64_bf16 v[36:39], v[56:59], v[16:23], v1
s_addc_u32 s59, s5, 0
ds_read_b128 v[16:19], v0 offset:59392
s_waitcnt lgkmcnt(3)
v_smfmac_f32_16x16x64_bf16 v[36:39], v[60:63], v[24:31], v1
ds_read_b128 v[28:31], v0 offset:62464
s_waitcnt lgkmcnt(3)
v_smfmac_f32_16x16x64_bf16 v[36:39], v[12:15], v[184:191], v1
ds_read_b128 v[20:23], v0 offset:60416
s_waitcnt lgkmcnt(3)
v_smfmac_f32_16x16x64_bf16 v[40:43], v[56:59], v[80:87], v1
ds_read_b128 v[24:27], v0 offset:61440
v_lshl_or_b32 v44, v44, 12, v45
v_smfmac_f32_16x16x64_bf16 v[40:43], v[60:63], v[192:199], v1
s_nop 0
ds_read_b128 v[84:87], v0 offset:64512
v_cvt_pk_bf16_f32 v36, v36, v37
v_and_or_b32 v36, v36, -2, s18
v_cvt_pk_bf16_f32 v37, v38, v39
v_smfmac_f32_16x16x64_bf16 v[40:43], v[12:15], v[200:207], v1
s_and_b32 s33, s17, 3
global_store_dwordx2 v44, v[36:37], s[48:49]
s_waitcnt lgkmcnt(2)
v_smfmac_f32_16x16x64_bf16 v[48:51], v[56:59], v[16:23], v1
ds_read_b128 v[80:83], v0 offset:63488
s_waitcnt lgkmcnt(2)
v_smfmac_f32_16x16x64_bf16 v[48:51], v[60:63], v[24:31], v1
s_mov_b32 s30, 0
v_cvt_pk_bf16_f32 v40, v40, v41
v_cvt_pk_bf16_f32 v41, v42, v43
v_and_or_b32 v40, v40, -2, s18
v_smfmac_f32_16x16x64_bf16 v[48:51], v[12:15], v[208:215], v1
global_store_dwordx2 v44, v[40:41], s[50:51]
s_waitcnt lgkmcnt(1)
v_smfmac_f32_16x16x64_bf16 v[32:35], v[56:59], v[232:239], v1
s_nop 0
s_waitcnt lgkmcnt(0)
v_smfmac_f32_16x16x64_bf16 v[52:55], v[56:59], v[80:87], v1
s_nop 1
v_cvt_pk_bf16_f32 v48, v48, v49
v_smfmac_f32_16x16x64_bf16 v[52:55], v[60:63], v[216:223], v1
s_cselect_b32 s33, s6, s23
v_and_or_b32 v48, v48, -2, s18
v_cvt_pk_bf16_f32 v49, v50, v51
v_smfmac_f32_16x16x64_bf16 v[52:55], v[12:15], v[224:231], v1
global_store_dwordx2 v44, v[48:49], s[52:53]
v_smfmac_f32_16x16x64_bf16 v[32:35], v[60:63], v[240:247], v1
s_nop 2
v_smfmac_f32_16x16x64_bf16 v[32:35], v[12:15], v[248:255], v1
s_nop 1
v_cvt_pk_bf16_f32 v52, v52, v53
v_and_or_b32 v52, v52, -2, s18
v_cvt_pk_bf16_f32 v53, v54, v55
s_nop 0
global_store_dwordx2 v44, v[52:53], s[54:55]
s_nop 0
v_cvt_pk_bf16_f32 v32, v32, v33
v_cvt_pk_bf16_f32 v33, v34, v35
v_and_or_b32 v32, v32, -2, s18
global_store_dwordx2 v44, v[32:33], s[56:57]
nored_10122:
s_waitcnt vmcnt(9)
v_cmp_gt_u32 vcc, s34, v7
s_cmp_eq_u32 vcc_hi, 0
s_cbranch_scc1 kv_10126
s_mov_b32 s30, 0
kv_10125:
v_and_b32 v7, 128, v0
buffer_load_dword v7, v7, s[4:7], s22 offen sc1
s_add_u32 s30, s30, 1
s_cmp_gt_u32 s30, 262144
s_cbranch_scc1 L_fail
s_waitcnt vmcnt(0)
v_cmp_gt_u32 vcc, s34, v7
s_cbranch_vccnz kv_10125
kv_10126:
v_and_b32 v7, 128, v0
v_add_u32 v7, s22, v7
s_mov_b32 exec_hi, 0
v_and_b32 v7, 511, v0
v_lshl_add_u32 v7, v7, 3, s27
s_mov_b32 exec_hi, -1
s_nop 15
s_nop 15
s_nop 15
s_nop 15
s_nop 15
s_nop 1
global_load_dwordx4 v[56:59], v0, s[76:77] offset:0 sc1
global_load_dwordx4 v[60:63], v0, s[76:77] offset:1024 sc1
global_load_dwordx4 v[48:51], v0, s[76:77] offset:2048 sc1
global_load_dwordx4 v[52:55], v0, s[76:77] offset:3072 sc1
join_10123:
s_barrier
s_nop 15
s_nop 15
s_nop 7
s_barrier
global_load_dwordx4 v[32:35], v0, s[68:69] offset:-4096 sc1
s_nop 10
global_load_dwordx4 v[36:39], v0, s[68:69] offset:0 sc1
s_barrier
global_load_dwordx4 v[80:83], v0, s[78:79] offset:-4096 sc1
global_load_dwordx4 v[84:87], v0, s[78:79] offset:-3072 sc1
v_mov_b64 v[8:9], 0
v_mov_b64 v[10:11], 0
v_mov_b64 v[12:13], 0
v_mov_b64 v[14:15], 0
v_mov_b64 v[16:17], 0
v_mov_b64 v[18:19], 0
v_mov_b64 v[20:21], 0
v_mov_b64 v[22:23], 0
v_mov_b64 v[24:25], 0
v_mov_b64 v[26:27], 0
v_mov_b64 v[28:29], 0
v_mov_b64 v[30:31], 0
s_mov_b32 s30, 0
s_cmp_eq_u32 s17, s31
s_cbranch_scc0 gather_10114
s_branch exit_10117
rt_10119:
global_load_dwordx4 v[32:35], v0, s[68:69] offset:-4096 sc1
global_load_dwordx4 v[36:39], v0, s[68:69] offset:0 sc1
s_add_u32 s30, s30, 1
s_cmp_gt_u32 s30, 262144
s_cbranch_scc1 L_fail
s_mov_b64 exec, 1
global_store_dword v0, v0, s[62:63]
global_store_dword v0, v0, s[62:63]
s_mov_b64 exec, -1
v_mov_b64 v[8:9], 0
v_mov_b64 v[10:11], 0
v_mov_b64 v[12:13], 0
v_mov_b64 v[14:15], 0
v_mov_b64 v[16:17], 0
v_mov_b64 v[18:19], 0
v_mov_b64 v[20:21], 0
v_mov_b64 v[22:23], 0
v_mov_b64 v[24:25], 0
v_mov_b64 v[26:27], 0
v_mov_b64 v[28:29], 0
v_mov_b64 v[30:31], 0
s_branch gather_10114
rare_10115:
ds_read_b128 v[48:51], v6 offset:6144
ds_read_b128 v[52:55], v6 offset:7168
s_waitcnt lgkmcnt(0)
v_add_f32 v48, v48, v52
v_add_f32 v49, v49, v53
v_add_f32 v50, v50, v54
v_add_f32 v51, v51, v55
v_mov_b32_dpp v46, v46 quad_perm:[0,1,0,1] row_mask:0xf bank_mask:0xf
v_mov_b32_dpp v47, v47 quad_perm:[0,1,0,1] row_mask:0xf bank_mask:0xf
v_max3_f32 v19, v48, v49, v50
v_max3_f32 v19, v19, v51, v46
v_max_f32 v19, v19, v47
s_nop 1
v_max_f32_dpp v19, v19, v19 quad_perm:[2,3,0,1] row_mask:0xf bank_mask:0xf
v_mov_b32 v44, v19
s_nop 1
v_permlane32_swap_b32 v19, v44
v_max_f32 v19, v19, v44
v_mov_b32 v44, v19
s_nop 1
v_permlane16_swap_b32 v19, v44
v_max_f32 v19, v19, v44
v_sub_f32 v48, v48, v19
v_sub_f32 v49, v49, v19
v_sub_f32 v50, v50, v19
v_sub_f32 v51, v51, v19
v_sub_f32 v46, v46, v19
v_sub_f32 v47, v47, v19
v_exp_f32 v48, v48
v_exp_f32 v49, v49
v_exp_f32 v50, v50
v_exp_f32 v51, v51
v_cvt_pk_bf16_f32 v54, v48, v49
v_cvt_pk_bf16_f32 v55, v50, v51
s_nop 0
v_mov_b32_dpp v48, v54 quad_perm:[0,1,0,1] row_mask:0xf bank_mask:0xf
v_mov_b32_dpp v49, v55 quad_perm:[0,1,0,1] row_mask:0xf bank_mask:0xf
v_mov_b32_dpp v50, v54 quad_perm:[2,3,2,3] row_mask:0xf bank_mask:0xf
v_mov_b32_dpp v51, v55 quad_perm:[2,3,2,3] row_mask:0xf bank_mask:0xf
v_mov_b64 v[20:21], s[44:45]
v_mov_b64 v[22:23], s[44:45]
v_mfma_f32_16x16x32_bf16 v[8:11], v[56:59], v[48:51], 0
v_mfma_f32_16x16x32_bf16 v[12:15], v[60:63], v[48:51], 0
v_mfma_f32_16x16x32_bf16 v[16:19], v[20:23], v[48:51], 0
v_mov_b64 v[54:55], s[46:47]
v_exp_f32_dpp v44, v46 quad_perm:[0,1,0,1] row_mask:0xf bank_mask:0xf
v_exp_f32_dpp v45, v47 quad_perm:[0,1,0,1] row_mask:0xf bank_mask:0xf
s_nop 0
v_cvt_pk_bf16_f32 v52, v44, v45
v_cvt_pk_bf16_f32 v53, v44, v45
s_nop 1
v_mfma_f32_16x16x16_bf16 v[16:19], v[54:55], v[52:53], v[16:19]
v_mfma_f32_16x16x16_bf16 v[8:11], v[24:25], v[52:53], v[8:11]
v_mfma_f32_16x16x16_bf16 v[12:15], v[26:27], v[52:53], v[12:15]
s_nop 5
v_rcp_f32 v18, v16
s_nop 0
v_cndmask_b32 v8, v12, v8, s[42:43]
v_mul_f32 v8, v8, v18
v_cndmask_b32 v9, v13, v9, s[42:43]
v_mul_f32 v9, v9, v18
v_cndmask_b32 v10, v14, v10, s[42:43]
v_mul_f32 v10, v10, v18
v_cndmask_b32 v11, v15, v11, s[42:43]
v_mul_f32 v11, v11, v18
v_cvt_pk_bf16_f32 v12, v8, v9
v_cvt_pk_bf16_f32 v13, v10, v11
s_branch back_10116
exit_10117:
global_load_dwordx4 v[32:35], v0, s[68:69] offset:-4096 sc1
global_load_dwordx4 v[36:39], v0, s[68:69] offset:0 sc1
s_add_u32 s30, s30, 1
s_cmp_gt_u32 s30, 262144
s_cbranch_scc1 L_fail
s_waitcnt vmcnt(1)
v_bitop3_b32 v44, v32, v34, s18 bitop3:0x7e
s_waitcnt vmcnt(0)
v_bitop3_b32 v45, v36, v38, s18 bitop3:0x7e
v_bitop3_b32 v44, v44, v45, s19 bitop3:0xa8
v_cmp_ne_u32 vcc, 0, v44
s_cbranch_vccnz exit_10117
ds_write_b128 v0, v[32:35] offset:3072
ds_write_b128 v0, v[36:39] offset:7168
s_waitcnt lgkmcnt(0)
s_barrier
v_add_u32 v44, s24, v0
ds_read_b128 v[44:47], v44
s_waitcnt lgkmcnt(0)
v_swap_b32 v45, v46
buffer_store_dwordx4 v[44:47], v0, s[4:7], s21 offen sc1
s_add_u32 s26, s17, 1
s_waitcnt vmcnt(0)
v_mov_b32 v44, s26
s_mov_b64 exec, 1
buffer_store_dword v44, off, s[4:7], s23 sc1
s_mov_b64 exec, -1
s_barrier
s_add_u32 s36, s36, 1
s_cmp_lt_u32 s36, 2
s_cbranch_scc1 layer_10113
s_endpgm
grp_10064:
L_last:
s_endpgm

.section .rodata,"a"
.p2align 6
.amdhsa_kernel interleave_layers__spectral_gfnet__memory_aug_recurrent_mem_tr__prompt_kernel
  .amdhsa_next_free_vgpr 512
  .amdhsa_next_free_sgpr 102
  .amdhsa_accum_offset 256
  .amdhsa_group_segment_fixed_size 0
  .amdhsa_kernarg_size 104
  .amdhsa_user_sgpr_count 2
  .amdhsa_user_sgpr_kernarg_segment_ptr 1
  .amdhsa_system_sgpr_workgroup_id_x 1
  .amdhsa_float_denorm_mode_32 3
  .amdhsa_ieee_mode 0
.end_amdhsa_kernel
```

```asm
; @launch grid=(256,1,1) block=(256,1,1) lds=163840
.amdgcn_target "amdgcn-amd-amdhsa--gfx950"
.text
.globl interleave_layers__spectral_gfnet__memory_aug_recurrent_mem_tr__prompt_kernel
.p2align 8
.type interleave_layers__spectral_gfnet__memory_aug_recurrent_mem_tr__prompt_kernel,@function
interleave_layers__spectral_gfnet__memory_aug_recurrent_mem_tr__prompt_kernel:
s_cmp_ge_u32 s2, 256
s_cbranch_scc1 L_end
s_load_dwordx2 s[4:5], s[0:1], 96
s_load_dwordx2 s[8:9], s[0:1], 88
s_mov_b32 s6, 268435456
s_mov_b32 s7, 0x20000
s_mov_b32 s10, 256
s_mov_b32 s11, 0x20000
s_getreg_b32 s12, hwreg(HW_REG_XCC_ID, 0, 3)
v_lshrrev_b32 v1, 6, v0
s_nop 0
v_readfirstlane_b32 s13, v1
s_waitcnt lgkmcnt(0)
s_cmp_lg_u32 s13, 0
s_cbranch_scc1 reg_3
v_mov_b32 v1, 0
v_mov_b32 v2, -1
ds_write_b32 v1, v2
s_sub_u32 s15, s12, 8
s_and_b32 s15, s15, 7
s_lshl_b32 s15, s15, 4
v_mov_b32 v2, 1
s_mov_b64 exec, 1
buffer_atomic_add v2, off, s[8:11], s15 offset:16 sc0
s_mov_b64 exec, -1
s_cmp_lg_u32 s12, 7
s_cbranch_scc1 reg_6
s_waitcnt vmcnt(0)
v_readfirstlane_b32 s16, v2
s_nop 0
s_cmp_ge_u32 s16, 32
s_cbranch_scc1 reg_6
s_mov_b32 s18, 0
reg_5:
buffer_load_dword v3, off, s[8:11], 0 offset:128 sc1
s_waitcnt vmcnt(0)
v_cmp_gt_u32 vcc, 32, v3
s_cbranch_vccz reg_7
s_add_u32 s18, s18, 1
s_cmp_lt_u32 s18, 16
s_cbranch_scc1 reg_5
reg_6:
v_and_b32 v1, 15, v0
v_cmp_ne_u32 vcc, 9, v1
s_nop 1
v_cndmask_b32 v1, 10, v1, vcc
v_lshlrev_b32 v1, 4, v1
s_mov_b32 s16, 0
all_8:
buffer_load_dword v3, v1, s[8:11], 0 offen sc1
s_add_u32 s16, s16, 1
s_cmp_gt_u32 s16, 262144
s_cbranch_scc1 L_fail
all_9:
s_waitcnt vmcnt(0)
v_add_u32_dpp v4, v3, v3 quad_perm:[1,0,3,2] row_mask:0xf bank_mask:0xf
s_nop 1
v_add_u32_dpp v4, v4, v4 quad_perm:[2,3,0,1] row_mask:0xf bank_mask:0xf
s_nop 1
v_add_u32_dpp v4, v4, v4 row_ror:4 row_mask:0xf bank_mask:0xf
s_nop 1
v_add_u32_dpp v4, v4, v4 row_ror:8 row_mask:0xf bank_mask:0xf
v_cmp_ne_u32 vcc, 274, v4
s_cbranch_vccnz all_8
v_readfirstlane_b32 s17, v2
v_readlane_b32 s20, v3, 1
v_readlane_b32 s21, v3, 2
v_readlane_b32 s22, v3, 3
v_readlane_b32 s23, v3, 4
v_readlane_b32 s24, v3, 5
v_readlane_b32 s25, v3, 6
v_readlane_b32 s26, v3, 7
v_readlane_b32 s27, v3, 8
s_mov_b32 s15, 6
s_cmp_ge_u32 s25, 32
s_cselect_b32 s15, 5, s15
s_cmp_ge_u32 s24, 32
s_cselect_b32 s15, 4, s15
s_cmp_ge_u32 s23, 32
s_cselect_b32 s15, 3, s15
s_cmp_ge_u32 s22, 32
s_cselect_b32 s15, 2, s15
s_cmp_ge_u32 s21, 32
s_cselect_b32 s15, 1, s15
s_cmp_ge_u32 s20, 32
s_cselect_b32 s15, 0, s15
s_cmp_ge_u32 s27, 32
s_cselect_b32 s15, 7, s15
s_mov_b32 s16, s17
s_cmp_gt_u32 s12, 0
s_cselect_b32 s18, s20, 0
s_add_u32 s16, s16, s18
s_cmp_gt_u32 s12, 1
s_cselect_b32 s18, s21, 0
s_add_u32 s16, s16, s18
s_cmp_gt_u32 s12, 2
s_cselect_b32 s18, s22, 0
s_add_u32 s16, s16, s18
s_cmp_gt_u32 s12, 3
s_cselect_b32 s18, s23, 0
s_add_u32 s16, s16, s18
s_cmp_gt_u32 s12, 4
s_cselect_b32 s18, s24, 0
s_add_u32 s16, s16, s18
s_cmp_gt_u32 s12, 5
s_cselect_b32 s18, s25, 0
s_add_u32 s16, s16, s18
s_cmp_gt_u32 s12, 6
s_cselect_b32 s18, s26, 0
s_add_u32 s16, s16, s18
s_add_u32 s18, s16, 32
s_cmp_lt_u32 s12, s15
s_cselect_b32 s16, s18, s16
s_cmp_eq_u32 s12, s15
s_cselect_b32 s18, s17, 32
s_cmp_lt_u32 s18, 32
s_cselect_b32 s16, s18, s16
reg_7:
v_mov_b32 v1, 0
v_mov_b32 v2, s16
ds_write_b32 v1, v2
s_waitcnt lgkmcnt(0)
s_branch reg_2
reg_3:
s_cmp_lg_u32 s13, 3
s_cbranch_scc1 reg_10
s_getpc_b64 s[20:21]
L_here:
s_bfe_u32 s15, s2, 0x50003
v_and_b32 v1, 63, v0
v_lshl_add_u32 v1, v1, 5, s15
v_lshlrev_b32 v1, 7, v1
v_min_u32 v1, L_last-L_here, v1
v_mov_b32 v7, s21
v_add_co_u32 v6, vcc, s20, v1
s_nop 1
v_addc_co_u32 v7, vcc, 0, v7, vcc
global_load_dword v6, v[6:7], off
reg_10:
s_cmp_lg_u32 s13, 1
s_cbranch_scc1 reg_4
s_cmp_ge_u32 s2, 18
s_cbranch_scc1 reg_4
v_lshlrev_b32 v1, 7, v0
s_lshl_b32 s15, s2, 13
s_add_u32 s15, s15, 11526144
v_mov_b32 v4, 0
buffer_store_dword v4, v1, s[4:7], s15 offen sc1
v_mov_b32 v2, 1
s_waitcnt vmcnt(0)
s_mov_b64 exec, 1
buffer_atomic_add v2, off, s[8:11], 0
s_mov_b64 exec, -1
reg_4:
s_cmp_eq_u32 s12, 7
s_cbranch_scc1 reg_2
s_load_dwordx2 s[24:25], s[0:1], 48
s_mov_b32 s26, 5242880
s_mov_b32 s27, 0x20000
s_lshl_b32 s15, s13, 3
s_sub_u32 s15, s15, 8
s_load_dwordx2 s[20:21], s[0:1], s15
s_mov_b32 s16, 1314816
s_cmp_eq_u32 s13, 1
s_cselect_b32 s22, 2621440, s16
s_cselect_b32 s16, 80, 41
s_mov_b32 s23, 0x20000
s_mul_i32 s17, s16, s2
s_lshl_b32 s17, s17, 7
s_sub_u32 s16, s16, 1
v_and_b32 v1, 63, v0
v_add_u32 v2, 64, v1
v_min_u32 v1, s16, v1
v_min_u32 v2, s16, v2
v_lshlrev_b32 v1, 7, v1
v_lshlrev_b32 v2, 7, v2
s_waitcnt lgkmcnt(0)
buffer_load_dword v3, v1, s[20:23], s17 offen
buffer_load_dword v4, v2, s[20:23], s17 offen
v_subrev_u32 v1, 64, v0
v_min_u32 v1, 159, v1
v_lshlrev_b32 v1, 7, v1
s_mul_i32 s17, s2, 20480
buffer_load_dword v5, v1, s[24:27], s17 offen
reg_2:
s_barrier
v_mov_b32 v1, 0
ds_read_b32 v2, v1
s_waitcnt lgkmcnt(0)
v_readfirstlane_b32 s14, v2
s_barrier
s_cmp_ge_u32 s14, 256
s_cbranch_scc1 L_end
s_cmp_lt_u32 s14, 32
s_cbranch_scc1 L_chain
s_sub_u32 s15, s14, 32
v_and_b32 v0, 63, v0
v_lshlrev_b32 v0, 4, v0
s_mov_b32 s24, 0x3f803f80
s_mul_i32 s31, s13, 10240
s_lshl_b32 s37, s13, 10
s_mov_b32 s22, s6
s_mov_b32 s23, 0
s_mov_b32 s16, 0
s_lshr_b32 s18, s15, 5
s_lshl_b32 s18, s18, 2
s_lshr_b32 s18, 106180896, s18
s_and_b32 s18, s18, 7
s_lshl_b32 s18, s18, 5
s_and_b32 s15, s15, 31
s_or_b32 s15, s15, s18
s_cmp_ge_u32 s15, 64
s_cbranch_scc1 roleA_12
s_and_b32 s32, s15, 31
s_cmp_ge_u32 s15, 32
s_cbranch_scc1 roleV_11
s_load_dwordx2 s[40:41], s[0:1], 8
s_mov_b32 s42, 1314816
s_mov_b32 s43, 0x20000
s_waitcnt lgkmcnt(0)
s_waitcnt vmcnt(0)
v_bfe_u32 v5, v0, 4, 2
v_lshrrev_b32 v6, 6, v0
v_mul_u32_u24 v7, 642, v5
v_lshl_add_u32 v7, v6, 2, v7
v_lshlrev_b32 v5, 4, v5
v_lshl_add_u32 v5, v6, 14, v5
s_and_b32 s18, s32, 3
s_bfe_u32 s19, s32, 0x20002
s_lshr_b32 s20, s32, 4
s_lshl_b32 s26, s20, 2
s_add_u32 s26, s26, s18
s_lshl_b32 s27, s26, 8
s_lshl_b32 s26, s26, 4
s_add_u32 s26, s26, s19
s_lshl_b32 s26, s26, 2
s_add_u32 s26, s26, s13
s_mul_i32 s26, s26, 2568
s_lshl_b32 s19, s19, 12
s_add_u32 s27, s27, s19
s_lshl_b32 s19, s13, 6
s_add_u32 s27, s27, s19
s_add_u32 s27, s27, 167772160
s_add_u32 s18, s26, 2
buffer_load_dword v32, v7, s[40:43], s18 offen offset:0
buffer_load_dword v36, v7, s[40:43], s18 offen offset:64
buffer_load_dword v40, v7, s[40:43], s18 offen offset:128
buffer_load_dword v44, v7, s[40:43], s18 offen offset:192
buffer_load_dword v48, v7, s[40:43], s18 offen offset:256
buffer_load_dword v52, v7, s[40:43], s18 offen offset:320
buffer_load_dword v56, v7, s[40:43], s18 offen offset:384
buffer_load_dword v60, v7, s[40:43], s18 offen offset:448
buffer_load_dword v64, v7, s[40:43], s18 offen offset:512
buffer_load_dword v68, v7, s[40:43], s18 offen offset:576
s_add_u32 s18, s26, 41090
buffer_load_dword v33, v7, s[40:43], s18 offen offset:0
buffer_load_dword v37, v7, s[40:43], s18 offen offset:64
buffer_load_dword v41, v7, s[40:43], s18 offen offset:128
buffer_load_dword v45, v7, s[40:43], s18 offen offset:192
buffer_load_dword v49, v7, s[40:43], s18 offen offset:256
buffer_load_dword v53, v7, s[40:43], s18 offen offset:320
buffer_load_dword v57, v7, s[40:43], s18 offen offset:384
buffer_load_dword v61, v7, s[40:43], s18 offen offset:448
buffer_load_dword v65, v7, s[40:43], s18 offen offset:512
buffer_load_dword v69, v7, s[40:43], s18 offen offset:576
s_add_u32 s18, s26, 82178
buffer_load_dword v34, v7, s[40:43], s18 offen offset:0
buffer_load_dword v38, v7, s[40:43], s18 offen offset:64
buffer_load_dword v42, v7, s[40:43], s18 offen offset:128
buffer_load_dword v46, v7, s[40:43], s18 offen offset:192
buffer_load_dword v50, v7, s[40:43], s18 offen offset:256
buffer_load_dword v54, v7, s[40:43], s18 offen offset:320
buffer_load_dword v58, v7, s[40:43], s18 offen offset:384
buffer_load_dword v62, v7, s[40:43], s18 offen offset:448
buffer_load_dword v66, v7, s[40:43], s18 offen offset:512
buffer_load_dword v70, v7, s[40:43], s18 offen offset:576
s_add_u32 s18, s26, 123266
buffer_load_dword v35, v7, s[40:43], s18 offen offset:0
buffer_load_dword v39, v7, s[40:43], s18 offen offset:64
buffer_load_dword v43, v7, s[40:43], s18 offen offset:128
buffer_load_dword v47, v7, s[40:43], s18 offen offset:192
buffer_load_dword v51, v7, s[40:43], s18 offen offset:256
buffer_load_dword v55, v7, s[40:43], s18 offen offset:320
buffer_load_dword v59, v7, s[40:43], s18 offen offset:384
buffer_load_dword v63, v7, s[40:43], s18 offen offset:448
buffer_load_dword v67, v7, s[40:43], s18 offen offset:512
buffer_load_dword v71, v7, s[40:43], s18 offen offset:576
s_waitcnt vmcnt(9)
buffer_store_dwordx4 v[32:35], v5, s[4:7], s27 offen sc1
s_add_u32 s27, s27, 262144
s_waitcnt vmcnt(9)
buffer_store_dwordx4 v[36:39], v5, s[4:7], s27 offen sc1
s_add_u32 s27, s27, 262144
s_waitcnt vmcnt(9)
buffer_store_dwordx4 v[40:43], v5, s[4:7], s27 offen sc1
s_add_u32 s27, s27, 262144
s_waitcnt vmcnt(9)
buffer_store_dwordx4 v[44:47], v5, s[4:7], s27 offen sc1
s_add_u32 s27, s27, 262144
s_waitcnt vmcnt(9)
buffer_store_dwordx4 v[48:51], v5, s[4:7], s27 offen sc1
s_add_u32 s27, s27, 262144
s_waitcnt vmcnt(9)
buffer_store_dwordx4 v[52:55], v5, s[4:7], s27 offen sc1
s_add_u32 s27, s27, 262144
s_waitcnt vmcnt(9)
buffer_store_dwordx4 v[56:59], v5, s[4:7], s27 offen sc1
s_add_u32 s27, s27, 262144
s_waitcnt vmcnt(9)
buffer_store_dwordx4 v[60:63], v5, s[4:7], s27 offen sc1
s_add_u32 s27, s27, 262144
s_waitcnt vmcnt(9)
buffer_store_dwordx4 v[64:67], v5, s[4:7], s27 offen sc1
s_add_u32 s27, s27, 262144
s_waitcnt vmcnt(9)
buffer_store_dwordx4 v[68:71], v5, s[4:7], s27 offen sc1
s_add_u32 s27, s27, 262144
s_lshl_b32 s18, s15, 7
s_add_u32 s18, s18, 11563008
s_cmp_eq_u32 s13, 0
s_cselect_b32 s22, s18, s6
s_mov_b32 s23, 1
s_waitcnt vmcnt(0)
s_barrier
v_mov_b32 v3, s23
s_mov_b64 exec, 1
buffer_store_dword v3, off, s[4:7], s22 sc1
s_mov_b64 exec, -1
s_mov_b32 s22, s6
s_lshl_b32 s26, s32, 8
s_lshl_b32 s18, s13, 6
s_add_u32 s26, s26, s18
s_load_dwordx2 s[40:41], s[0:1], 48
s_mov_b32 s42, 5242880
s_mov_b32 s43, 0x20000
s_waitcnt lgkmcnt(0)
v_lshrrev_b32 v32, 6, v0
v_mul_u32_u24 v32, 8192, v32
v_and_b32 v33, 48, v0
v_add_u32 v30, v32, v33
v_bfe_u32 v32, v0, 6, 2
v_lshrrev_b32 v33, 9, v0
v_lshl_add_u32 v32, v33, 3, v32
v_lshlrev_b32 v31, 6, v32
v_and_b32 v32, 16, v0
v_add_u32 v31, v31, v32
v_bfe_u32 v32, v0, 5, 1
v_lshl_add_u32 v31, v32, 3, v31
v_bfe_u32 v32, v0, 8, 1
v_lshl_add_u32 v31, v32, 5, v31
s_mul_i32 s18, s13, 36864
v_add_u32 v31, s18, v31
s_barrier
s_add_u32 m0, s18, 0
s_add_u32 s19, s26, 0
buffer_load_dwordx4 v30, s[40:43], s19 offen lds
s_add_u32 m0, s18, 1024
s_add_u32 s19, s26, 131072
buffer_load_dwordx4 v30, s[40:43], s19 offen lds
s_add_u32 m0, s18, 2048
s_add_u32 s19, s26, 262144
buffer_load_dwordx4 v30, s[40:43], s19 offen lds
s_add_u32 m0, s18, 3072
s_add_u32 s19, s26, 393216
buffer_load_dwordx4 v30, s[40:43], s19 offen lds
s_add_u32 m0, s18, 4096
s_add_u32 s19, s26, 524288
buffer_load_dwordx4 v30, s[40:43], s19 offen lds
s_add_u32 m0, s18, 5120
s_add_u32 s19, s26, 655360
buffer_load_dwordx4 v30, s[40:43], s19 offen lds
s_add_u32 m0, s18, 6144
s_add_u32 s19, s26, 786432
buffer_load_dwordx4 v30, s[40:43], s19 offen lds
s_add_u32 m0, s18, 7168
s_add_u32 s19, s26, 917504
buffer_load_dwordx4 v30, s[40:43], s19 offen lds
s_add_u32 m0, s18, 8192
s_add_u32 s19, s26, 1048576
buffer_load_dwordx4 v30, s[40:43], s19 offen lds
s_add_u32 m0, s18, 9216
s_add_u32 s19, s26, 1179648
buffer_load_dwordx4 v30, s[40:43], s19 offen lds
s_add_u32 m0, s18, 10240
s_add_u32 s19, s26, 1310720
buffer_load_dwordx4 v30, s[40:43], s19 offen lds
s_add_u32 m0, s18, 11264
s_add_u32 s19, s26, 1441792
buffer_load_dwordx4 v30, s[40:43], s19 offen lds
s_add_u32 m0, s18, 12288
s_add_u32 s19, s26, 1572864
buffer_load_dwordx4 v30, s[40:43], s19 offen lds
s_add_u32 m0, s18, 13312
s_add_u32 s19, s26, 1703936
buffer_load_dwordx4 v30, s[40:43], s19 offen lds
s_add_u32 m0, s18, 14336
s_add_u32 s19, s26, 1835008
buffer_load_dwordx4 v30, s[40:43], s19 offen lds
s_add_u32 m0, s18, 15360
s_add_u32 s19, s26, 1966080
buffer_load_dwordx4 v30, s[40:43], s19 offen lds
s_add_u32 m0, s18, 16384
s_add_u32 s19, s26, 2097152
buffer_load_dwordx4 v30, s[40:43], s19 offen lds
s_add_u32 m0, s18, 17408
s_add_u32 s19, s26, 2228224
buffer_load_dwordx4 v30, s[40:43], s19 offen lds
s_add_u32 m0, s18, 18432
s_add_u32 s19, s26, 2359296
buffer_load_dwordx4 v30, s[40:43], s19 offen lds
s_add_u32 m0, s18, 19456
s_add_u32 s19, s26, 2490368
buffer_load_dwordx4 v30, s[40:43], s19 offen lds
s_add_u32 m0, s18, 20480
s_add_u32 s19, s26, 2621440
buffer_load_dwordx4 v30, s[40:43], s19 offen lds
s_add_u32 m0, s18, 21504
s_add_u32 s19, s26, 2752512
buffer_load_dwordx4 v30, s[40:43], s19 offen lds
s_add_u32 m0, s18, 22528
s_add_u32 s19, s26, 2883584
buffer_load_dwordx4 v30, s[40:43], s19 offen lds
s_add_u32 m0, s18, 23552
s_add_u32 s19, s26, 3014656
buffer_load_dwordx4 v30, s[40:43], s19 offen lds
s_add_u32 m0, s18, 24576
s_add_u32 s19, s26, 3145728
buffer_load_dwordx4 v30, s[40:43], s19 offen lds
s_add_u32 m0, s18, 25600
s_add_u32 s19, s26, 3276800
buffer_load_dwordx4 v30, s[40:43], s19 offen lds
s_add_u32 m0, s18, 26624
s_add_u32 s19, s26, 3407872
buffer_load_dwordx4 v30, s[40:43], s19 offen lds
s_add_u32 m0, s18, 27648
s_add_u32 s19, s26, 3538944
buffer_load_dwordx4 v30, s[40:43], s19 offen lds
s_add_u32 m0, s18, 28672
s_add_u32 s19, s26, 3670016
buffer_load_dwordx4 v30, s[40:43], s19 offen lds
s_add_u32 m0, s18, 29696
s_add_u32 s19, s26, 3801088
buffer_load_dwordx4 v30, s[40:43], s19 offen lds
s_add_u32 m0, s18, 30720
s_add_u32 s19, s26, 3932160
buffer_load_dwordx4 v30, s[40:43], s19 offen lds
s_add_u32 m0, s18, 31744
s_add_u32 s19, s26, 4063232
buffer_load_dwordx4 v30, s[40:43], s19 offen lds
s_add_u32 m0, s18, 32768
s_add_u32 s19, s26, 4194304
buffer_load_dwordx4 v30, s[40:43], s19 offen lds
s_add_u32 m0, s18, 33792
s_add_u32 s19, s26, 4325376
buffer_load_dwordx4 v30, s[40:43], s19 offen lds
s_add_u32 m0, s18, 34816
s_add_u32 s19, s26, 4456448
buffer_load_dwordx4 v30, s[40:43], s19 offen lds
s_add_u32 m0, s18, 35840
s_add_u32 s19, s26, 4587520
buffer_load_dwordx4 v30, s[40:43], s19 offen lds
s_waitcnt vmcnt(32)
ds_read_b64_tr_b16 a[0:1], v31 offset:0
ds_read_b64_tr_b16 a[2:3], v31 offset:256
ds_read_b64_tr_b16 a[4:5], v31 offset:1024
ds_read_b64_tr_b16 a[6:7], v31 offset:1280
ds_read_b64_tr_b16 a[8:9], v31 offset:2048
ds_read_b64_tr_b16 a[10:11], v31 offset:2304
ds_read_b64_tr_b16 a[12:13], v31 offset:3072
ds_read_b64_tr_b16 a[14:15], v31 offset:3328
s_waitcnt lgkmcnt(0)
s_add_u32 m0, s18, 0
s_add_u32 s19, s26, 4718592
buffer_load_dwordx4 v30, s[40:43], s19 offen lds
s_add_u32 m0, s18, 1024
s_add_u32 s19, s26, 4849664
buffer_load_dwordx4 v30, s[40:43], s19 offen lds
s_add_u32 m0, s18, 2048
s_add_u32 s19, s26, 4980736
buffer_load_dwordx4 v30, s[40:43], s19 offen lds
s_add_u32 m0, s18, 3072
s_add_u32 s19, s26, 5111808
buffer_load_dwordx4 v30, s[40:43], s19 offen lds
s_waitcnt vmcnt(32)
ds_read_b64_tr_b16 a[16:17], v31 offset:4096
ds_read_b64_tr_b16 a[18:19], v31 offset:4352
ds_read_b64_tr_b16 a[20:21], v31 offset:5120
ds_read_b64_tr_b16 a[22:23], v31 offset:5376
ds_read_b64_tr_b16 a[24:25], v31 offset:6144
ds_read_b64_tr_b16 a[26:27], v31 offset:6400
ds_read_b64_tr_b16 a[28:29], v31 offset:7168
ds_read_b64_tr_b16 a[30:31], v31 offset:7424
s_waitcnt vmcnt(28)
ds_read_b64_tr_b16 a[32:33], v31 offset:8192
ds_read_b64_tr_b16 a[34:35], v31 offset:8448
ds_read_b64_tr_b16 a[36:37], v31 offset:9216
ds_read_b64_tr_b16 a[38:39], v31 offset:9472
ds_read_b64_tr_b16 a[40:41], v31 offset:10240
ds_read_b64_tr_b16 a[42:43], v31 offset:10496
ds_read_b64_tr_b16 a[44:45], v31 offset:11264
ds_read_b64_tr_b16 a[46:47], v31 offset:11520
s_waitcnt vmcnt(24)
ds_read_b64_tr_b16 a[48:49], v31 offset:12288
ds_read_b64_tr_b16 a[50:51], v31 offset:12544
ds_read_b64_tr_b16 a[52:53], v31 offset:13312
ds_read_b64_tr_b16 a[54:55], v31 offset:13568
ds_read_b64_tr_b16 a[56:57], v31 offset:14336
ds_read_b64_tr_b16 a[58:59], v31 offset:14592
ds_read_b64_tr_b16 a[60:61], v31 offset:15360
ds_read_b64_tr_b16 a[62:63], v31 offset:15616
s_waitcnt vmcnt(20)
ds_read_b64_tr_b16 a[64:65], v31 offset:16384
ds_read_b64_tr_b16 a[66:67], v31 offset:16640
ds_read_b64_tr_b16 a[68:69], v31 offset:17408
ds_read_b64_tr_b16 a[70:71], v31 offset:17664
ds_read_b64_tr_b16 a[72:73], v31 offset:18432
ds_read_b64_tr_b16 a[74:75], v31 offset:18688
ds_read_b64_tr_b16 a[76:77], v31 offset:19456
ds_read_b64_tr_b16 a[78:79], v31 offset:19712
s_waitcnt vmcnt(16)
ds_read_b64_tr_b16 a[80:81], v31 offset:20480
ds_read_b64_tr_b16 a[82:83], v31 offset:20736
ds_read_b64_tr_b16 a[84:85], v31 offset:21504
ds_read_b64_tr_b16 a[86:87], v31 offset:21760
ds_read_b64_tr_b16 a[88:89], v31 offset:22528
ds_read_b64_tr_b16 a[90:91], v31 offset:22784
ds_read_b64_tr_b16 a[92:93], v31 offset:23552
ds_read_b64_tr_b16 a[94:95], v31 offset:23808
s_waitcnt vmcnt(12)
ds_read_b64_tr_b16 a[96:97], v31 offset:24576
ds_read_b64_tr_b16 a[98:99], v31 offset:24832
ds_read_b64_tr_b16 a[100:101], v31 offset:25600
ds_read_b64_tr_b16 a[102:103], v31 offset:25856
ds_read_b64_tr_b16 a[104:105], v31 offset:26624
ds_read_b64_tr_b16 a[106:107], v31 offset:26880
ds_read_b64_tr_b16 a[108:109], v31 offset:27648
ds_read_b64_tr_b16 a[110:111], v31 offset:27904
s_waitcnt vmcnt(8)
ds_read_b64_tr_b16 a[112:113], v31 offset:28672
ds_read_b64_tr_b16 a[114:115], v31 offset:28928
ds_read_b64_tr_b16 a[116:117], v31 offset:29696
ds_read_b64_tr_b16 a[118:119], v31 offset:29952
ds_read_b64_tr_b16 a[120:121], v31 offset:30720
ds_read_b64_tr_b16 a[122:123], v31 offset:30976
ds_read_b64_tr_b16 a[124:125], v31 offset:31744
ds_read_b64_tr_b16 a[126:127], v31 offset:32000
s_waitcnt vmcnt(4)
ds_read_b64_tr_b16 a[128:129], v31 offset:32768
ds_read_b64_tr_b16 a[130:131], v31 offset:33024
ds_read_b64_tr_b16 a[132:133], v31 offset:33792
ds_read_b64_tr_b16 a[134:135], v31 offset:34048
ds_read_b64_tr_b16 a[136:137], v31 offset:34816
ds_read_b64_tr_b16 a[138:139], v31 offset:35072
ds_read_b64_tr_b16 a[140:141], v31 offset:35840
ds_read_b64_tr_b16 a[142:143], v31 offset:36096
s_waitcnt vmcnt(0)
ds_read_b64_tr_b16 a[144:145], v31 offset:0
ds_read_b64_tr_b16 a[146:147], v31 offset:256
ds_read_b64_tr_b16 a[148:149], v31 offset:1024
ds_read_b64_tr_b16 a[150:151], v31 offset:1280
ds_read_b64_tr_b16 a[152:153], v31 offset:2048
ds_read_b64_tr_b16 a[154:155], v31 offset:2304
ds_read_b64_tr_b16 a[156:157], v31 offset:3072
ds_read_b64_tr_b16 a[158:159], v31 offset:3328
s_waitcnt lgkmcnt(0)
s_barrier
s_load_dwordx2 s[40:41], s[0:1], 40
s_mov_b32 s42, 5242880
s_mov_b32 s43, 0x20000
s_waitcnt lgkmcnt(0)
v_lshrrev_b32 v5, 5, v0
v_lshlrev_b32 v5, 13, v5
v_bfe_u32 v6, v0, 4, 1
v_lshl_add_u32 v5, v6, 7, v5
s_lshl_b32 s18, s32, 8
s_mul_i32 s19, s13, 1310720
s_add_u32 s18, s18, s19
buffer_load_dword v24, v5, s[40:43], s18 offen
s_add_u32 s18, s18, 262144
buffer_load_dword v25, v5, s[40:43], s18 offen
s_add_u32 s18, s18, 262144
buffer_load_dword v26, v5, s[40:43], s18 offen
s_add_u32 s18, s18, 262144
buffer_load_dword v27, v5, s[40:43], s18 offen
s_add_u32 s18, s18, 262144
buffer_load_dword v28, v5, s[40:43], s18 offen
s_add_u32 s18, s18, 262144
v_mov_b32 v32, s24
v_mov_b32 v33, s24
v_mov_b32 v34, s24
v_mov_b32 v35, s24
s_nop 1
v_mfma_f32_32x32x16_bf16 v[36:51], a[0:3], v[32:35], 0
v_mfma_f32_32x32x16_bf16 v[36:51], a[4:7], v[32:35], v[36:51]
v_mfma_f32_32x32x16_bf16 v[36:51], a[8:11], v[32:35], v[36:51]
v_mfma_f32_32x32x16_bf16 v[36:51], a[12:15], v[32:35], v[36:51]
v_mfma_f32_32x32x16_bf16 v[36:51], a[16:19], v[32:35], v[36:51]
v_mfma_f32_32x32x16_bf16 v[36:51], a[20:23], v[32:35], v[36:51]
v_mfma_f32_32x32x16_bf16 v[36:51], a[24:27], v[32:35], v[36:51]
v_mfma_f32_32x32x16_bf16 v[36:51], a[28:31], v[32:35], v[36:51]
v_mfma_f32_32x32x16_bf16 v[36:51], a[32:35], v[32:35], v[36:51]
v_mfma_f32_32x32x16_bf16 v[36:51], a[36:39], v[32:35], v[36:51]
v_mfma_f32_32x32x16_bf16 v[36:51], a[40:43], v[32:35], v[36:51]
v_mfma_f32_32x32x16_bf16 v[36:51], a[44:47], v[32:35], v[36:51]
v_mfma_f32_32x32x16_bf16 v[36:51], a[48:51], v[32:35], v[36:51]
v_mfma_f32_32x32x16_bf16 v[36:51], a[52:55], v[32:35], v[36:51]
v_mfma_f32_32x32x16_bf16 v[36:51], a[56:59], v[32:35], v[36:51]
v_mfma_f32_32x32x16_bf16 v[36:51], a[60:63], v[32:35], v[36:51]
v_mfma_f32_32x32x16_bf16 v[36:51], a[64:67], v[32:35], v[36:51]
v_mfma_f32_32x32x16_bf16 v[36:51], a[68:71], v[32:35], v[36:51]
v_mfma_f32_32x32x16_bf16 v[36:51], a[72:75], v[32:35], v[36:51]
v_mfma_f32_32x32x16_bf16 v[36:51], a[76:79], v[32:35], v[36:51]
v_mfma_f32_32x32x16_bf16 v[36:51], a[80:83], v[32:35], v[36:51]
v_mfma_f32_32x32x16_bf16 v[36:51], a[84:87], v[32:35], v[36:51]
v_mfma_f32_32x32x16_bf16 v[36:51], a[88:91], v[32:35], v[36:51]
v_mfma_f32_32x32x16_bf16 v[36:51], a[92:95], v[32:35], v[36:51]
v_mfma_f32_32x32x16_bf16 v[36:51], a[96:99], v[32:35], v[36:51]
v_mfma_f32_32x32x16_bf16 v[36:51], a[100:103], v[32:35], v[36:51]
v_mfma_f32_32x32x16_bf16 v[36:51], a[104:107], v[32:35], v[36:51]
v_mfma_f32_32x32x16_bf16 v[36:51], a[108:111], v[32:35], v[36:51]
v_mfma_f32_32x32x16_bf16 v[36:51], a[112:115], v[32:35], v[36:51]
v_mfma_f32_32x32x16_bf16 v[36:51], a[116:119], v[32:35], v[36:51]
v_mfma_f32_32x32x16_bf16 v[36:51], a[120:123], v[32:35], v[36:51]
v_mfma_f32_32x32x16_bf16 v[36:51], a[124:127], v[32:35], v[36:51]
v_mfma_f32_32x32x16_bf16 v[36:51], a[128:131], v[32:35], v[36:51]
v_mfma_f32_32x32x16_bf16 v[36:51], a[132:135], v[32:35], v[36:51]
v_mfma_f32_32x32x16_bf16 v[36:51], a[136:139], v[32:35], v[36:51]
v_mfma_f32_32x32x16_bf16 v[36:51], a[140:143], v[32:35], v[36:51]
v_mfma_f32_32x32x16_bf16 v[36:51], a[144:147], v[32:35], v[36:51]
v_mfma_f32_32x32x16_bf16 v[36:51], a[148:151], v[32:35], v[36:51]
v_mfma_f32_32x32x16_bf16 v[36:51], a[152:155], v[32:35], v[36:51]
v_mfma_f32_32x32x16_bf16 v[36:51], a[156:159], v[32:35], v[36:51]
s_nop 11
v_mov_b32 v8, v36
v_mov_b32 v9, v37
v_mov_b32 v10, v38
v_mov_b32 v11, v39
v_mov_b32 v12, v40
v_mov_b32 v13, v41
v_mov_b32 v14, v42
v_mov_b32 v15, v43
v_mov_b32 v16, v44
v_mov_b32 v17, v45
v_mov_b32 v18, v46
v_mov_b32 v19, v47
v_mov_b32 v20, v48
v_mov_b32 v21, v49
v_mov_b32 v22, v50
v_mov_b32 v23, v51
v_and_b32 v5, 0x70, v0
s_waitcnt vmcnt(4)
v_lshrrev_b32 v24, 8, v0
v_lshl_add_u32 v5, v24, 7, v5
v_bfe_u32 v24, v0, 7, 1
v_lshl_add_u32 v5, v24, 12, v5
s_lshr_b32 s34, s13, 1
s_lshl_b32 s34, s34, 13
s_and_b32 s18, s13, 1
s_lshl_b32 s18, s18, 10
s_add_u32 s34, s34, s18
s_lshl_b32 s18, s32, 14
s_add_u32 s34, s34, s18
v_bfe_u32 v6, v0, 7, 2
v_mul_u32_u24 v6, 10240, v6
v_bfe_u32 v24, v0, 5, 2
v_lshl_add_u32 v6, v24, 6, v6
v_lshrrev_b32 v24, 9, v0
v_lshl_add_u32 v6, v24, 5, v6
v_and_b32 v24, 16, v0
v_add_u32 v6, v24, v6
s_lshl_b32 s51, s32, 8
s_add_u32 s51, s51, 11534336
s_mul_i32 s52, s13, 2560
s_add_u32 s52, s52, 12582912
s_add_u32 s50, s34, 110100480
s_mov_b32 s39, 0
kvlay_13:
s_mul_i32 s26, s16, 6291456
s_add_u32 s26, s26, 88080384
s_add_u32 s26, s26, s31
s_mul_i32 s54, s16, 327680
s_add_u32 s54, s54, 163577856
s_mul_i32 s27, s16, 35651584
s_add_u32 s27, s27, 16777216
s_mul_i32 s18, s32, 0
s_add_u32 s27, s27, s18
s_add_u32 s27, s27, s34
s_lshl_b32 s29, s16, 1
s_add_u32 s29, s29, 1
s_mov_b32 s28, 0
s_mov_b32 s30, 0
s_cmp_lt_u32 s30, 64
s_cselect_b32 s53, s26, s6
s_cselect_b32 s36, s54, s6
s_mov_b32 s38, 1024
v_mov_b32 v7, v0
s_add_u32 s26, s26, 40960
s_add_u32 s54, s54, 5120
s_add_u32 s30, s30, 1
v_xor_b32 v1, 40960, v0
s_mov_b32 s25, s31
s_mov_b32 s35, 131072
s_cmp_lg_u32 s13, 0
s_cbranch_scc1 polld_22
v_lshlrev_b32 v3, 3, v0
s_waitcnt vmcnt(0)
v_min_u32 v28, 1152, v3
s_mov_b32 s21, 11612160
s_mov_b32 s17, 0
poll_21:
buffer_load_dword v24, v28, s[4:7], s21 offen sc1
s_add_u32 s17, s17, 1
s_cmp_gt_u32 s17, 262144
s_cbranch_scc1 L_fail
s_waitcnt vmcnt(0)
v_cmp_gt_u32 vcc, s29, v24
s_cbranch_vccz polld_22
s_sleep 2
s_branch poll_21
polld_22:
s_barrier
s_add_u32 m0, s25, 2048
s_mov_b32 s20, s53
buffer_load_dwordx4 v7, s[4:7], s20 offen sc1 lds
s_add_u32 m0, s25, 3072
s_add_u32 s20, s20, s38
buffer_load_dwordx4 v7, s[4:7], s20 offen sc1 lds
s_add_u32 m0, s25, 4096
s_add_u32 s20, s20, s38
buffer_load_dwordx4 v7, s[4:7], s20 offen sc1 lds
s_add_u32 m0, s25, 5120
s_add_u32 s20, s20, s38
buffer_load_dwordx4 v7, s[4:7], s20 offen sc1 lds
s_add_u32 m0, s25, 6144
s_add_u32 s20, s20, s38
buffer_load_dwordx4 v7, s[4:7], s20 offen sc1 lds
s_add_u32 m0, s25, 7168
s_add_u32 s20, s20, s38
buffer_load_dwordx4 v7, s[4:7], s20 offen sc1 lds
s_add_u32 m0, s25, 8192
s_add_u32 s20, s20, s38
buffer_load_dwordx4 v7, s[4:7], s20 offen sc1 lds
s_add_u32 m0, s25, 9216
s_add_u32 s20, s20, s38
buffer_load_dwordx4 v7, s[4:7], s20 offen sc1 lds
s_add_u32 m0, s25, 10240
s_add_u32 s20, s20, s38
buffer_load_dwordx4 v7, s[4:7], s20 offen sc1 lds
s_add_u32 m0, s25, 11264
s_add_u32 s20, s20, s38
buffer_load_dwordx4 v7, s[4:7], s20 offen sc1 lds
s_add_u32 m0, s35, s37
s_add_u32 s20, s36, s37
buffer_load_dwordx4 v0, s[4:7], s20 offen sc1 lds
s_add_u32 m0, s35, 4096
s_add_u32 s20, s36, 4096
buffer_load_dwordx4 v0, s[4:7], s20 offen sc1 lds
s_waitcnt vmcnt(0)
kvx_14:
v_xor_b32 v1, 40960, v1
s_sub_u32 s25, s25, s31
s_xor_b32 s25, s25, 40960
s_add_u32 s25, s25, s31
s_xor_b32 s35, s35, 8192
s_cmp_eq_u32 s28, 1
s_cbranch_scc1 kv_16
s_cmp_eq_u32 s28, 30
s_cbranch_scc0 kv_17
s_add_u32 s29, s29, 1
kv_16:
s_waitcnt vmcnt(0)
s_barrier
v_mov_b32 v3, s23
s_mov_b64 exec, 1
buffer_store_dword v3, off, s[4:7], s22 sc1
s_mov_b64 exec, -1
s_mov_b32 s22, s6
s_cmp_lg_u32 s13, 0
s_cbranch_scc1 polld_24
v_lshlrev_b32 v3, 3, v0
v_min_u32 v28, 3968, v3
s_mov_b32 s21, 11612160
s_mov_b32 s17, 0
poll_23:
buffer_load_dword v24, v3, s[4:7], s21 offen sc1
s_add_u32 s20, s21, 8192
buffer_load_dword v25, v3, s[4:7], s20 offen sc1
s_add_u32 s20, s21, 16384
buffer_load_dword v26, v28, s[4:7], s20 offen sc1
s_add_u32 s17, s17, 1
s_cmp_gt_u32 s17, 262144
s_cbranch_scc1 L_fail
s_waitcnt vmcnt(1)
v_min_u32 v24, v24, v25
s_waitcnt vmcnt(0)
v_min_u32 v24, v24, v26
v_cmp_gt_u32 vcc, s29, v24
s_cbranch_vccz polld_24
s_sleep 2
s_branch poll_23
polld_24:
s_barrier
kv_17:
s_add_u32 s28, s28, 1
s_and_b32 s33, s28, 3
s_cmp_lt_u32 s28, 12
s_cselect_b32 s33, 1, s33
s_cmp_eq_u32 s33, 0
s_cbranch_scc1 kv_18
s_cmp_lt_u32 s30, 64
s_cselect_b32 s53, s26, s6
s_cselect_b32 s36, s54, s6
s_mov_b32 s38, 1024
v_mov_b32 v7, v0
s_add_u32 s26, s26, 40960
s_add_u32 s54, s54, 5120
s_add_u32 s30, s30, 1
kvn_15:
s_waitcnt vmcnt(3)
s_barrier
s_add_u32 m0, s25, 2048
s_mov_b32 s20, s53
buffer_load_dwordx4 v7, s[4:7], s20 offen sc1 lds
ds_read_b128 v[48:51], v1 offset:2048
ds_read_b128 v[52:55], v1 offset:3072
s_add_u32 m0, s25, 3072
s_add_u32 s20, s20, s38
buffer_load_dwordx4 v7, s[4:7], s20 offen sc1 lds
s_add_u32 m0, s25, 4096
s_add_u32 s20, s20, s38
buffer_load_dwordx4 v7, s[4:7], s20 offen sc1 lds
ds_read_b128 v[56:59], v1 offset:4096
ds_read_b128 v[60:63], v1 offset:5120
s_waitcnt lgkmcnt(3)
v_mfma_f32_32x32x16_bf16 v[32:47], a[0:3], v[48:51], 0
s_xor_b32 s18, s35, 8192
ds_read_b128 v[48:51], v1 offset:6144
v_lshrrev_b32 v2, 2, v0
s_waitcnt lgkmcnt(3)
v_mfma_f32_32x32x16_bf16 v[32:47], a[4:7], v[52:55], v[32:47]
ds_read_b128 v[52:55], v1 offset:7168
v_add_u32 v2, s18, v2
s_waitcnt lgkmcnt(3)
v_mfma_f32_32x32x16_bf16 v[32:47], a[8:11], v[56:59], v[32:47]
ds_read2st64_b32 v[64:65], v2 offset0:0 offset1:1
s_waitcnt lgkmcnt(2)
ds_read2st64_b32 v[66:67], v2 offset0:2 offset1:3
ds_read_b128 v[56:59], v1 offset:8192
v_mfma_f32_32x32x16_bf16 v[32:47], a[12:15], v[60:63], v[32:47]
ds_read_b128 v[60:63], v1 offset:9216
ds_read2st64_b32 v[74:75], v2 offset0:6 offset1:7
s_waitcnt lgkmcnt(5)
v_mfma_f32_32x32x16_bf16 v[32:47], a[16:19], v[48:51], v[32:47]
s_add_u32 m0, s25, 5120
s_add_u32 s20, s20, s38
buffer_load_dwordx4 v7, s[4:7], s20 offen sc1 lds
ds_read2st64_b32 v[72:73], v2 offset0:4 offset1:5
ds_read_b128 v[48:51], v1 offset:10240
ds_read2st64_b32 v[84:85], v2 offset0:16 offset1:17
s_waitcnt lgkmcnt(5)
v_mfma_f32_32x32x16_bf16 v[32:47], a[20:23], v[52:55], v[32:47]
s_waitcnt lgkmcnt(4)
s_add_u32 m0, s25, 6144
s_add_u32 s20, s20, s38
buffer_load_dwordx4 v7, s[4:7], s20 offen sc1 lds
v_mfma_f32_32x32x16_bf16 v[32:47], a[24:27], v[56:59], v[32:47]
ds_read_b128 v[52:55], v1 offset:11264
s_add_u32 m0, s25, 7168
s_add_u32 s20, s20, s38
buffer_load_dwordx4 v7, s[4:7], s20 offen sc1 lds
v_mfma_f32_32x32x16_bf16 v[32:47], a[28:31], v[60:63], v[32:47]
ds_read_b128 v[60:63], v1 offset:13312
s_waitcnt lgkmcnt(2)
ds_read_b128 v[56:59], v1 offset:12288
ds_read2st64_b32 v[80:81], v2 offset0:12 offset1:13
v_add_f32 v65, v65, v67
v_mfma_f32_32x32x16_bf16 v[32:47], a[32:35], v[48:51], v[32:47]
s_waitcnt lgkmcnt(3)
ds_read_b128 v[48:51], v1 offset:14336
ds_read2st64_b32 v[76:77], v2 offset0:8 offset1:9
s_add_u32 m0, s25, 8192
s_add_u32 s20, s20, s38
buffer_load_dwordx4 v7, s[4:7], s20 offen sc1 lds
v_mfma_f32_32x32x16_bf16 v[32:47], a[36:39], v[52:55], v[32:47]
s_add_u32 m0, s25, 9216
s_add_u32 s20, s20, s38
buffer_load_dwordx4 v7, s[4:7], s20 offen sc1 lds
ds_read_b128 v[52:55], v1 offset:15360
s_waitcnt lgkmcnt(4)
v_mfma_f32_32x32x16_bf16 v[32:47], a[40:43], v[56:59], v[32:47]
s_waitcnt lgkmcnt(2)
v_add_f32 v64, v64, v66
v_mov_b32 v3, s23
s_waitcnt lgkmcnt(1)
v_mfma_f32_32x32x16_bf16 v[32:47], a[44:47], v[60:63], v[32:47]
ds_read_b128 v[60:63], v1 offset:17408
ds_read_b128 v[56:59], v1 offset:16384
v_mfma_f32_32x32x16_bf16 v[32:47], a[48:51], v[48:51], v[32:47]
s_waitcnt lgkmcnt(2)
ds_read_b128 v[48:51], v1 offset:18432
ds_read2st64_b32 v[86:87], v2 offset0:18 offset1:19
v_mfma_f32_32x32x16_bf16 v[32:47], a[52:55], v[52:55], v[32:47]
ds_read2st64_b32 v[78:79], v2 offset0:10 offset1:11
s_waitcnt lgkmcnt(3)
v_mfma_f32_32x32x16_bf16 v[32:47], a[56:59], v[56:59], v[32:47]
s_waitcnt lgkmcnt(2)
ds_read_b128 v[52:55], v1 offset:19456
ds_read2st64_b32 v[82:83], v2 offset0:14 offset1:15
s_add_u32 m0, s25, 10240
s_add_u32 s20, s20, s38
buffer_load_dwordx4 v7, s[4:7], s20 offen sc1 lds
v_mfma_f32_32x32x16_bf16 v[32:47], a[60:63], v[60:63], v[32:47]
ds_read_b128 v[56:59], v1 offset:20480
s_waitcnt lgkmcnt(3)
ds_read_b128 v[60:63], v1 offset:21504
v_add_f32 v65, v65, v73
v_mfma_f32_32x32x16_bf16 v[32:47], a[64:67], v[48:51], v[32:47]
v_add_f32 v64, v64, v72
s_waitcnt lgkmcnt(3)
v_add_f32 v64, v64, v74
v_add_f32 v65, v65, v75
s_waitcnt lgkmcnt(2)
v_mfma_f32_32x32x16_bf16 v[32:47], a[68:71], v[52:55], v[32:47]
ds_read_b128 v[52:55], v1 offset:23552
ds_read_b128 v[48:51], v1 offset:22528
s_waitcnt lgkmcnt(3)
v_add_f32 v65, v65, v77
v_add_f32 v64, v64, v76
v_mfma_f32_32x32x16_bf16 v[32:47], a[72:75], v[56:59], v[32:47]
v_add_f32 v64, v64, v78
ds_read_b128 v[56:59], v1 offset:24576
s_waitcnt lgkmcnt(3)
v_mfma_f32_32x32x16_bf16 v[32:47], a[76:79], v[60:63], v[32:47]
ds_read_b128 v[60:63], v1 offset:25600
s_waitcnt lgkmcnt(3)
v_add_f32 v64, v64, v80
s_waitcnt lgkmcnt(2)
v_mfma_f32_32x32x16_bf16 v[32:47], a[80:83], v[48:51], v[32:47]
ds_read_b128 v[48:51], v1 offset:26624
s_add_u32 m0, s25, 11264
s_add_u32 s20, s20, s38
buffer_load_dwordx4 v7, s[4:7], s20 offen sc1 lds
v_mfma_f32_32x32x16_bf16 v[32:47], a[84:87], v[52:55], v[32:47]
s_waitcnt lgkmcnt(2)
ds_read_b128 v[52:55], v1 offset:27648
v_add_f32 v65, v65, v79
s_waitcnt lgkmcnt(2)
v_mfma_f32_32x32x16_bf16 v[32:47], a[88:91], v[56:59], v[32:47]
s_waitcnt lgkmcnt(1)
s_add_u32 m0, s35, s37
s_add_u32 s20, s36, s37
buffer_load_dwordx4 v0, s[4:7], s20 offen sc1 lds
v_mfma_f32_32x32x16_bf16 v[32:47], a[92:95], v[60:63], v[32:47]
ds_read_b128 v[56:59], v1 offset:28672
ds_read_b128 v[60:63], v1 offset:29696
s_waitcnt lgkmcnt(2)
v_add_f32 v64, v64, v82
v_add_f32 v65, v65, v81
v_mfma_f32_32x32x16_bf16 v[32:47], a[96:99], v[48:51], v[32:47]
s_add_u32 m0, s35, 4096
s_add_u32 s20, s36, 4096
buffer_load_dwordx4 v0, s[4:7], s20 offen sc1 lds
v_mfma_f32_32x32x16_bf16 v[32:47], a[100:103], v[52:55], v[32:47]
ds_read_b128 v[48:51], v1 offset:30720
s_waitcnt lgkmcnt(2)
ds_read_b128 v[52:55], v1 offset:31744
v_mfma_f32_32x32x16_bf16 v[32:47], a[104:107], v[56:59], v[32:47]
ds_read_b128 v[56:59], v1 offset:32768
v_add_f32 v65, v65, v83
s_waitcnt lgkmcnt(3)
v_add_f32 v64, v64, v84
v_add_f32 v65, v65, v85
v_mfma_f32_32x32x16_bf16 v[32:47], a[108:111], v[60:63], v[32:47]
s_waitcnt lgkmcnt(2)
v_add_f32 v65, v65, v87
s_waitcnt lgkmcnt(1)
v_add_f32 v64, v64, v86
v_mfma_f32_32x32x16_bf16 v[32:47], a[112:115], v[48:51], v[32:47]
s_waitcnt lgkmcnt(0)
ds_read_b128 v[48:51], v1 offset:34816
ds_read_b128 v[60:63], v1 offset:33792
v_add_f32 v64, v64, v65
v_mov_b32 v68, v64
v_mfma_f32_32x32x16_bf16 v[32:47], a[116:119], v[52:55], v[32:47]
s_waitcnt vmcnt(12)
s_barrier
s_mov_b64 exec, 1
buffer_store_dword v3, off, s[4:7], s22 sc1
s_mov_b64 exec, -1
v_mfma_f32_32x32x16_bf16 v[32:47], a[120:123], v[56:59], v[32:47]
ds_read_b128 v[52:55], v1 offset:35840
ds_read_b128 v[56:59], v1 offset:36864
s_waitcnt lgkmcnt(2)
v_mfma_f32_32x32x16_bf16 v[32:47], a[124:127], v[60:63], v[32:47]
ds_read_b128 v[60:63], v1 offset:37888
v_permlane32_swap_b32 v64, v68
v_mul_f32 v68, 0x3acccccd, v68
v_mul_f32 v64, 0x3acccccd, v64
v_mfma_f32_32x32x16_bf16 v[32:47], a[128:131], v[48:51], v[32:47]
s_waitcnt lgkmcnt(2)
v_mfma_f32_32x32x16_bf16 v[32:47], a[132:135], v[52:55], v[32:47]
s_waitcnt lgkmcnt(0)
ds_read_b128 v[48:51], v1 offset:38912
v_fma_f32 v68, -v64, v64, v68
v_max_f32 v68, 0, v68
v_add_f32 v68, 0x3727c5ac, v68
v_mfma_f32_32x32x16_bf16 v[32:47], a[136:139], v[56:59], v[32:47]
ds_read_b128 v[52:55], v1 offset:39936
v_rsq_f32 v68, v68
s_nop 0
v_mul_f32 v64, v68, v64
v_mfma_f32_32x32x16_bf16 v[32:47], a[140:143], v[60:63], v[32:47]
ds_read_b128 v[56:59], v1 offset:40960
s_waitcnt lgkmcnt(2)
v_mfma_f32_32x32x16_bf16 v[32:47], a[144:147], v[48:51], v[32:47]
ds_read_b128 v[60:63], v1 offset:41984
v_mul_f32 v78, v64, v14
v_mul_f32 v85, v64, v21
s_waitcnt lgkmcnt(2)
v_mul_f32 v75, v64, v11
v_mul_f32 v79, v64, v15
v_mfma_f32_32x32x16_bf16 v[32:47], a[148:151], v[52:55], v[32:47]
v_mul_f32 v84, v64, v20
s_waitcnt lgkmcnt(1)
v_mul_f32 v73, v64, v9
v_mul_f32 v72, v64, v8
v_mul_f32 v82, v64, v18
v_mul_f32 v87, v64, v23
v_mfma_f32_32x32x16_bf16 v[32:47], a[152:155], v[56:59], v[32:47]
s_waitcnt lgkmcnt(0)
v_mul_f32 v83, v64, v19
v_mul_f32 v74, v64, v10
v_mul_f32 v81, v64, v17
v_mul_f32 v86, v64, v22
v_mfma_f32_32x32x16_bf16 v[32:47], a[156:159], v[60:63], v[32:47]
s_nop 0
v_mul_f32 v80, v64, v16
v_mul_f32 v76, v64, v12
v_mul_f32 v77, v64, v13
s_nop 7
v_pk_fma_f32 v[40:41], v[40:41], v[68:69], v[80:81] op_sel_hi:[1,0,1] neg_lo:[0,0,1] neg_hi:[0,0,1]
v_pk_fma_f32 v[32:33], v[32:33], v[68:69], v[72:73] op_sel_hi:[1,0,1] neg_lo:[0,0,1] neg_hi:[0,0,1]
v_pk_fma_f32 v[34:35], v[34:35], v[68:69], v[74:75] op_sel_hi:[1,0,1] neg_lo:[0,0,1] neg_hi:[0,0,1]
v_pk_fma_f32 v[42:43], v[42:43], v[68:69], v[82:83] op_sel_hi:[1,0,1] neg_lo:[0,0,1] neg_hi:[0,0,1]
v_cvt_pk_bf16_f32 v48, v32, v33
v_cvt_pk_bf16_f32 v49, v34, v35
v_pk_fma_f32 v[44:45], v[44:45], v[68:69], v[84:85] op_sel_hi:[1,0,1] neg_lo:[0,0,1] neg_hi:[0,0,1]
v_pk_fma_f32 v[46:47], v[46:47], v[68:69], v[86:87] op_sel_hi:[1,0,1] neg_lo:[0,0,1] neg_hi:[0,0,1]
v_pk_fma_f32 v[36:37], v[36:37], v[68:69], v[76:77] op_sel_hi:[1,0,1] neg_lo:[0,0,1] neg_hi:[0,0,1]
v_cvt_pk_bf16_f32 v50, v36, v37
v_cvt_pk_bf16_f32 v52, v40, v41
v_cvt_pk_bf16_f32 v54, v44, v45
v_pk_fma_f32 v[38:39], v[38:39], v[68:69], v[78:79] op_sel_hi:[1,0,1] neg_lo:[0,0,1] neg_hi:[0,0,1]
v_cvt_pk_bf16_f32 v51, v38, v39
v_cvt_pk_bf16_f32 v53, v42, v43
v_cvt_pk_bf16_f32 v55, v46, v47
buffer_store_dwordx4 v[48:51], v5, s[4:7], s27 offen offset:0 sc1
buffer_store_dwordx4 v[52:55], v5, s[4:7], s27 offen offset:512 sc1
s_lshl_b32 s18, s16, 6
s_add_u32 s18, s18, s28
s_add_u32 s27, s27, 524288
s_cmp_eq_u32 s13, 0
s_cselect_b32 s22, s51, s6
s_mov_b32 s23, s18
s_cmp_lg_u32 s33, 0
s_cbranch_scc1 kvx_14
kvm_19:
v_xor_b32 v1, 40960, v1
s_sub_u32 s25, s25, s31
s_xor_b32 s25, s25, 40960
s_add_u32 s25, s25, s31
s_xor_b32 s35, s35, 8192
s_cmp_lt_u32 s30, 64
s_cselect_b32 s53, s26, s6
s_cselect_b32 s36, s54, s6
s_mov_b32 s38, 1024
v_mov_b32 v7, v0
s_add_u32 s26, s26, 40960
s_add_u32 s54, s54, 5120
s_add_u32 s30, s30, 1
s_waitcnt vmcnt(3)
s_barrier
ds_read_b128 v[48:51], v1 offset:2048
s_add_u32 m0, s25, 2048
s_mov_b32 s20, s53
buffer_load_dwordx4 v7, s[4:7], s20 offen sc1 lds
ds_read_b128 v[52:55], v1 offset:3072
ds_read_b128 v[56:59], v1 offset:4096
s_add_u32 m0, s25, 3072
s_add_u32 s20, s20, s38
buffer_load_dwordx4 v7, s[4:7], s20 offen sc1 lds
s_waitcnt lgkmcnt(2)
v_mfma_f32_32x32x16_bf16 v[32:47], a[0:3], v[48:51], 0
ds_read_b128 v[60:63], v1 offset:5120
s_waitcnt lgkmcnt(2)
s_add_u32 m0, s25, 4096
s_add_u32 s20, s20, s38
buffer_load_dwordx4 v7, s[4:7], s20 offen sc1 lds
s_waitcnt lgkmcnt(1)
v_mfma_f32_32x32x16_bf16 v[32:47], a[4:7], v[52:55], v[32:47]
s_add_u32 m0, s25, 5120
s_add_u32 s20, s20, s38
buffer_load_dwordx4 v7, s[4:7], s20 offen sc1 lds
ds_read_b128 v[48:51], v1 offset:6144
ds_read_b128 v[52:55], v1 offset:7168
v_mfma_f32_32x32x16_bf16 v[32:47], a[8:11], v[56:59], v[32:47]
ds_read_b128 v[56:59], v1 offset:8192
s_waitcnt lgkmcnt(3)
v_mfma_f32_32x32x16_bf16 v[32:47], a[12:15], v[60:63], v[32:47]
s_waitcnt lgkmcnt(2)
v_mfma_f32_32x32x16_bf16 v[32:47], a[16:19], v[48:51], v[32:47]
ds_read_b128 v[60:63], v1 offset:9216
ds_read_b128 v[48:51], v1 offset:10240
s_waitcnt lgkmcnt(2)
v_mfma_f32_32x32x16_bf16 v[32:47], a[20:23], v[52:55], v[32:47]
v_mfma_f32_32x32x16_bf16 v[32:47], a[24:27], v[56:59], v[32:47]
ds_read_b128 v[56:59], v1 offset:12288
s_waitcnt lgkmcnt(2)
ds_read_b128 v[52:55], v1 offset:11264
v_mfma_f32_32x32x16_bf16 v[32:47], a[28:31], v[60:63], v[32:47]
s_waitcnt lgkmcnt(2)
s_add_u32 m0, s25, 6144
s_add_u32 s20, s20, s38
buffer_load_dwordx4 v7, s[4:7], s20 offen sc1 lds
ds_read_b128 v[60:63], v1 offset:13312
v_mfma_f32_32x32x16_bf16 v[32:47], a[32:35], v[48:51], v[32:47]
s_waitcnt lgkmcnt(2)
s_add_u32 m0, s25, 7168
s_add_u32 s20, s20, s38
buffer_load_dwordx4 v7, s[4:7], s20 offen sc1 lds
s_waitcnt lgkmcnt(1)
v_mfma_f32_32x32x16_bf16 v[32:47], a[36:39], v[52:55], v[32:47]
ds_read_b128 v[48:51], v1 offset:14336
s_add_u32 m0, s25, 8192
s_add_u32 s20, s20, s38
buffer_load_dwordx4 v7, s[4:7], s20 offen sc1 lds
s_waitcnt lgkmcnt(1)
ds_read_b128 v[52:55], v1 offset:15360
v_mfma_f32_32x32x16_bf16 v[32:47], a[40:43], v[56:59], v[32:47]
ds_read_b128 v[56:59], v1 offset:16384
v_mfma_f32_32x32x16_bf16 v[32:47], a[44:47], v[60:63], v[32:47]
s_waitcnt lgkmcnt(2)
ds_read_b128 v[60:63], v1 offset:17408
v_mfma_f32_32x32x16_bf16 v[32:47], a[48:51], v[48:51], v[32:47]
ds_read_b128 v[48:51], v1 offset:18432
s_waitcnt lgkmcnt(2)
v_mfma_f32_32x32x16_bf16 v[32:47], a[52:55], v[52:55], v[32:47]
ds_read_b128 v[52:55], v1 offset:19456
s_add_u32 m0, s25, 9216
s_add_u32 s20, s20, s38
buffer_load_dwordx4 v7, s[4:7], s20 offen sc1 lds
s_waitcnt lgkmcnt(2)
v_mfma_f32_32x32x16_bf16 v[32:47], a[56:59], v[56:59], v[32:47]
v_mfma_f32_32x32x16_bf16 v[32:47], a[60:63], v[60:63], v[32:47]
ds_read_b128 v[60:63], v1 offset:21504
ds_read_b128 v[56:59], v1 offset:20480
s_waitcnt lgkmcnt(3)
v_mov_b32 v3, s23
v_mfma_f32_32x32x16_bf16 v[32:47], a[64:67], v[48:51], v[32:47]
s_waitcnt lgkmcnt(2)
s_add_u32 m0, s25, 10240
s_add_u32 s20, s20, s38
buffer_load_dwordx4 v7, s[4:7], s20 offen sc1 lds
ds_read_b128 v[48:51], v1 offset:22528
v_mfma_f32_32x32x16_bf16 v[32:47], a[68:71], v[52:55], v[32:47]
ds_read_b128 v[52:55], v1 offset:23552
s_waitcnt lgkmcnt(2)
v_mfma_f32_32x32x16_bf16 v[32:47], a[72:75], v[56:59], v[32:47]
v_mfma_f32_32x32x16_bf16 v[32:47], a[76:79], v[60:63], v[32:47]
s_waitcnt lgkmcnt(0)
ds_read_b128 v[56:59], v1 offset:24576
v_mfma_f32_32x32x16_bf16 v[32:47], a[80:83], v[48:51], v[32:47]
ds_read_b128 v[60:63], v1 offset:25600
s_add_u32 m0, s25, 11264
s_add_u32 s20, s20, s38
buffer_load_dwordx4 v7, s[4:7], s20 offen sc1 lds
v_mfma_f32_32x32x16_bf16 v[32:47], a[84:87], v[52:55], v[32:47]
ds_read_b128 v[48:51], v1 offset:26624
s_waitcnt lgkmcnt(2)
ds_read_b128 v[52:55], v1 offset:27648
v_mfma_f32_32x32x16_bf16 v[32:47], a[88:91], v[56:59], v[32:47]
s_waitcnt lgkmcnt(2)
ds_read_b128 v[56:59], v1 offset:28672
s_add_u32 m0, s35, s37
s_add_u32 s20, s36, s37
buffer_load_dwordx4 v0, s[4:7], s20 offen sc1 lds
v_mfma_f32_32x32x16_bf16 v[32:47], a[92:95], v[60:63], v[32:47]
ds_read_b128 v[60:63], v1 offset:29696
s_waitcnt lgkmcnt(3)
v_mfma_f32_32x32x16_bf16 v[32:47], a[96:99], v[48:51], v[32:47]
s_waitcnt lgkmcnt(1)
ds_read_b128 v[48:51], v1 offset:30720
s_add_u32 m0, s35, 4096
s_add_u32 s20, s36, 4096
buffer_load_dwordx4 v0, s[4:7], s20 offen sc1 lds
v_mfma_f32_32x32x16_bf16 v[32:47], a[100:103], v[52:55], v[32:47]
ds_read_b128 v[52:55], v1 offset:31744
v_mfma_f32_32x32x16_bf16 v[32:47], a[104:107], v[56:59], v[32:47]
s_waitcnt lgkmcnt(2)
s_waitcnt lgkmcnt(1)
v_mfma_f32_32x32x16_bf16 v[32:47], a[108:111], v[60:63], v[32:47]
ds_read_b128 v[56:59], v1 offset:32768
ds_read_b128 v[60:63], v1 offset:33792
v_mfma_f32_32x32x16_bf16 v[32:47], a[112:115], v[48:51], v[32:47]
ds_read_b128 v[48:51], v1 offset:34816
s_waitcnt lgkmcnt(3)
v_mfma_f32_32x32x16_bf16 v[32:47], a[116:119], v[52:55], v[32:47]
s_waitcnt vmcnt(12)
s_barrier
ds_read_b128 v[52:55], v1 offset:35840
s_waitcnt lgkmcnt(3)
v_mfma_f32_32x32x16_bf16 v[32:47], a[120:123], v[56:59], v[32:47]
s_mov_b64 exec, 1
buffer_store_dword v3, off, s[4:7], s22 sc1
s_mov_b64 exec, -1
s_waitcnt lgkmcnt(1)
v_mfma_f32_32x32x16_bf16 v[32:47], a[124:127], v[60:63], v[32:47]
ds_read_b128 v[56:59], v1 offset:36864
s_waitcnt lgkmcnt(1)
ds_read_b128 v[60:63], v1 offset:37888
v_mfma_f32_32x32x16_bf16 v[32:47], a[128:131], v[48:51], v[32:47]
v_mfma_f32_32x32x16_bf16 v[32:47], a[132:135], v[52:55], v[32:47]
s_waitcnt lgkmcnt(1)
ds_read_b128 v[52:55], v1 offset:39936
ds_read_b128 v[48:51], v1 offset:38912
v_mfma_f32_32x32x16_bf16 v[32:47], a[136:139], v[56:59], v[32:47]
s_waitcnt lgkmcnt(2)
v_mfma_f32_32x32x16_bf16 v[32:47], a[140:143], v[60:63], v[32:47]
ds_read_b128 v[56:59], v1 offset:40960
ds_read_b128 v[60:63], v1 offset:41984
s_waitcnt lgkmcnt(2)
v_mfma_f32_32x32x16_bf16 v[32:47], a[144:147], v[48:51], v[32:47]
v_mfma_f32_32x32x16_bf16 v[32:47], a[148:151], v[52:55], v[32:47]
s_waitcnt lgkmcnt(1)
v_mfma_f32_32x32x16_bf16 v[32:47], a[152:155], v[56:59], v[32:47]
s_waitcnt lgkmcnt(0)
v_mfma_f32_32x32x16_bf16 v[32:47], a[156:159], v[60:63], v[32:47]
s_nop 11
v_cvt_pk_bf16_f32 v49, v34, v35
v_cvt_pk_bf16_f32 v48, v32, v33
v_cvt_pk_bf16_f32 v53, v42, v43
v_cvt_pk_bf16_f32 v51, v38, v39
v_cvt_pk_bf16_f32 v54, v44, v45
v_cvt_pk_bf16_f32 v50, v36, v37
v_cvt_pk_bf16_f32 v52, v40, v41
v_cvt_pk_bf16_f32 v55, v46, v47
buffer_store_dwordx4 v[48:51], v5, s[4:7], s50 offen offset:0 sc1
buffer_store_dwordx4 v[52:55], v5, s[4:7], s50 offen offset:512 sc1
s_add_u32 s39, s39, 1
s_add_u32 s50, s50, 524288
s_add_u32 s18, s51, 8192
s_cmp_eq_u32 s13, 0
s_cselect_b32 s22, s18, s6
s_mov_b32 s23, s39
s_cmp_lt_u32 s28, 64
s_cbranch_scc1 kvx_14
s_and_b32 s18, s39, 15
s_cbranch_scc0 kvt_20
s_waitcnt vmcnt(0)
s_barrier
v_mov_b32 v3, s23
s_mov_b64 exec, 1
buffer_store_dword v3, off, s[4:7], s22 sc1
s_mov_b64 exec, -1
s_mov_b32 s22, s6
s_lshl_b32 s18, s39, 2
s_add_u32 s18, s18, 4
s_cmp_lg_u32 s13, 0
s_cbranch_scc1 polld_26
v_lshlrev_b32 v3, 3, v0
v_min_u32 v28, 1152, v3
s_mov_b32 s21, 11550720
s_mov_b32 s17, 0
poll_25:
buffer_load_dword v24, v28, s[4:7], s21 offen sc1
s_add_u32 s17, s17, 1
s_cmp_gt_u32 s17, 262144
s_cbranch_scc1 L_fail
s_waitcnt vmcnt(0)
v_cmp_gt_u32 vcc, s18, v24
s_cbranch_vccz polld_26
s_sleep 2
s_branch poll_25
polld_26:
s_barrier
s_mov_b32 s53, s52
s_mov_b32 s36, s6
s_mov_b32 s38, 256
v_mov_b32 v7, v6
s_add_u32 s52, s52, 40960
s_add_u32 m0, s25, 2048
s_mov_b32 s20, s53
buffer_load_dwordx4 v7, s[4:7], s20 offen sc1 lds
s_add_u32 m0, s25, 3072
s_add_u32 s20, s20, s38
buffer_load_dwordx4 v7, s[4:7], s20 offen sc1 lds
s_add_u32 m0, s25, 4096
s_add_u32 s20, s20, s38
buffer_load_dwordx4 v7, s[4:7], s20 offen sc1 lds
s_add_u32 m0, s25, 5120
s_add_u32 s20, s20, s38
buffer_load_dwordx4 v7, s[4:7], s20 offen sc1 lds
s_add_u32 m0, s25, 6144
s_add_u32 s20, s20, s38
buffer_load_dwordx4 v7, s[4:7], s20 offen sc1 lds
s_add_u32 m0, s25, 7168
s_add_u32 s20, s20, s38
buffer_load_dwordx4 v7, s[4:7], s20 offen sc1 lds
s_add_u32 m0, s25, 8192
s_add_u32 s20, s20, s38
buffer_load_dwordx4 v7, s[4:7], s20 offen sc1 lds
s_add_u32 m0, s25, 9216
s_add_u32 s20, s20, s38
buffer_load_dwordx4 v7, s[4:7], s20 offen sc1 lds
s_add_u32 m0, s25, 10240
s_add_u32 s20, s20, s38
buffer_load_dwordx4 v7, s[4:7], s20 offen sc1 lds
s_add_u32 m0, s25, 11264
s_add_u32 s20, s20, s38
buffer_load_dwordx4 v7, s[4:7], s20 offen sc1 lds
s_waitcnt vmcnt(0)
s_branch kvm_19
kv_18:
s_lshl_b32 s18, s39, 2
s_add_u32 s18, s18, 4
s_cmp_lg_u32 s13, 0
s_cbranch_scc1 polld_28
v_lshlrev_b32 v3, 3, v0
v_min_u32 v28, 1152, v3
s_mov_b32 s21, 11550720
s_mov_b32 s17, 0
poll_27:
buffer_load_dword v24, v28, s[4:7], s21 offen sc1
s_add_u32 s17, s17, 1
s_cmp_gt_u32 s17, 262144
s_cbranch_scc1 L_fail
s_waitcnt vmcnt(0)
v_cmp_gt_u32 vcc, s18, v24
s_cbranch_vccz polld_28
s_sleep 2
s_branch poll_27
polld_28:
s_barrier
s_mov_b32 s53, s52
s_mov_b32 s36, s6
s_mov_b32 s38, 256
v_mov_b32 v7, v6
s_add_u32 s52, s52, 40960
s_branch kvn_15
kvt_20:
s_waitcnt vmcnt(0)
s_barrier
v_mov_b32 v3, s23
s_mov_b64 exec, 1
buffer_store_dword v3, off, s[4:7], s22 sc1
s_mov_b64 exec, -1
s_mov_b32 s22, s6
s_add_u32 s16, s16, 1
s_cmp_lt_u32 s16, 2
s_cbranch_scc1 kvlay_13
s_endpgm
roleV_11:
s_load_dwordx2 s[40:41], s[0:1], 16
s_mov_b32 s42, 1314816
s_mov_b32 s43, 0x20000
s_waitcnt lgkmcnt(0)
s_waitcnt vmcnt(0)
v_bfe_u32 v6, v0, 4, 2
v_lshrrev_b32 v7, 6, v0
v_mul_u32_u24 v8, 642, v6
v_lshl_add_u32 v8, v7, 2, v8
v_lshlrev_b32 v6, 4, v6
v_lshl_add_u32 v6, v7, 14, v6
s_and_b32 s18, s32, 3
s_bfe_u32 s19, s32, 0x20002
s_lshr_b32 s20, s32, 4
s_lshl_b32 s26, s20, 2
s_add_u32 s26, s26, s18
s_lshl_b32 s27, s26, 8
s_lshl_b32 s26, s26, 4
s_add_u32 s26, s26, s19
s_lshl_b32 s26, s26, 2
s_add_u32 s26, s26, s13
s_mul_i32 s26, s26, 2568
s_lshl_b32 s19, s19, 12
s_add_u32 s27, s27, s19
s_lshl_b32 s19, s13, 6
s_add_u32 s27, s27, s19
s_add_u32 s27, s27, 167774208
s_add_u32 s18, s26, 2
buffer_load_dword v20, v8, s[40:43], s18 offen offset:0
buffer_load_dword v24, v8, s[40:43], s18 offen offset:64
buffer_load_dword v28, v8, s[40:43], s18 offen offset:128
buffer_load_dword v32, v8, s[40:43], s18 offen offset:192
buffer_load_dword v36, v8, s[40:43], s18 offen offset:256
buffer_load_dword v40, v8, s[40:43], s18 offen offset:320
buffer_load_dword v44, v8, s[40:43], s18 offen offset:384
buffer_load_dword v48, v8, s[40:43], s18 offen offset:448
buffer_load_dword v52, v8, s[40:43], s18 offen offset:512
buffer_load_dword v56, v8, s[40:43], s18 offen offset:576
s_add_u32 s18, s26, 41090
buffer_load_dword v21, v8, s[40:43], s18 offen offset:0
buffer_load_dword v25, v8, s[40:43], s18 offen offset:64
buffer_load_dword v29, v8, s[40:43], s18 offen offset:128
buffer_load_dword v33, v8, s[40:43], s18 offen offset:192
buffer_load_dword v37, v8, s[40:43], s18 offen offset:256
buffer_load_dword v41, v8, s[40:43], s18 offen offset:320
buffer_load_dword v45, v8, s[40:43], s18 offen offset:384
buffer_load_dword v49, v8, s[40:43], s18 offen offset:448
buffer_load_dword v53, v8, s[40:43], s18 offen offset:512
buffer_load_dword v57, v8, s[40:43], s18 offen offset:576
s_add_u32 s18, s26, 82178
buffer_load_dword v22, v8, s[40:43], s18 offen offset:0
buffer_load_dword v26, v8, s[40:43], s18 offen offset:64
buffer_load_dword v30, v8, s[40:43], s18 offen offset:128
buffer_load_dword v34, v8, s[40:43], s18 offen offset:192
buffer_load_dword v38, v8, s[40:43], s18 offen offset:256
buffer_load_dword v42, v8, s[40:43], s18 offen offset:320
buffer_load_dword v46, v8, s[40:43], s18 offen offset:384
buffer_load_dword v50, v8, s[40:43], s18 offen offset:448
buffer_load_dword v54, v8, s[40:43], s18 offen offset:512
buffer_load_dword v58, v8, s[40:43], s18 offen offset:576
s_add_u32 s18, s26, 123266
buffer_load_dword v23, v8, s[40:43], s18 offen offset:0
buffer_load_dword v27, v8, s[40:43], s18 offen offset:64
buffer_load_dword v31, v8, s[40:43], s18 offen offset:128
buffer_load_dword v35, v8, s[40:43], s18 offen offset:192
buffer_load_dword v39, v8, s[40:43], s18 offen offset:256
buffer_load_dword v43, v8, s[40:43], s18 offen offset:320
buffer_load_dword v47, v8, s[40:43], s18 offen offset:384
buffer_load_dword v51, v8, s[40:43], s18 offen offset:448
buffer_load_dword v55, v8, s[40:43], s18 offen offset:512
buffer_load_dword v59, v8, s[40:43], s18 offen offset:576
s_waitcnt vmcnt(9)
buffer_store_dwordx4 v[20:23], v6, s[4:7], s27 offen sc1
s_add_u32 s27, s27, 262144
s_waitcnt vmcnt(9)
buffer_store_dwordx4 v[24:27], v6, s[4:7], s27 offen sc1
s_add_u32 s27, s27, 262144
s_waitcnt vmcnt(9)
buffer_store_dwordx4 v[28:31], v6, s[4:7], s27 offen sc1
s_add_u32 s27, s27, 262144
s_waitcnt vmcnt(9)
buffer_store_dwordx4 v[32:35], v6, s[4:7], s27 offen sc1
s_add_u32 s27, s27, 262144
s_waitcnt vmcnt(9)
buffer_store_dwordx4 v[36:39], v6, s[4:7], s27 offen sc1
s_add_u32 s27, s27, 262144
s_waitcnt vmcnt(9)
buffer_store_dwordx4 v[40:43], v6, s[4:7], s27 offen sc1
s_add_u32 s27, s27, 262144
s_waitcnt vmcnt(9)
buffer_store_dwordx4 v[44:47], v6, s[4:7], s27 offen sc1
s_add_u32 s27, s27, 262144
s_waitcnt vmcnt(9)
buffer_store_dwordx4 v[48:51], v6, s[4:7], s27 offen sc1
s_add_u32 s27, s27, 262144
s_waitcnt vmcnt(9)
buffer_store_dwordx4 v[52:55], v6, s[4:7], s27 offen sc1
s_add_u32 s27, s27, 262144
s_waitcnt vmcnt(9)
buffer_store_dwordx4 v[56:59], v6, s[4:7], s27 offen sc1
s_add_u32 s27, s27, 262144
s_lshl_b32 s18, s15, 7
s_add_u32 s18, s18, 11563008
s_cmp_eq_u32 s13, 0
s_cselect_b32 s22, s18, s6
s_mov_b32 s23, 1
s_waitcnt vmcnt(0)
s_barrier
v_mov_b32 v3, s23
s_mov_b64 exec, 1
buffer_store_dword v3, off, s[4:7], s22 sc1
s_mov_b64 exec, -1
s_mov_b32 s22, s6
s_lshl_b32 s26, s32, 8
s_lshl_b32 s18, s13, 6
s_add_u32 s26, s26, s18
s_load_dwordx2 s[40:41], s[0:1], 56
s_mov_b32 s42, 5242880
s_mov_b32 s43, 0x20000
s_waitcnt lgkmcnt(0)
v_lshrrev_b32 v20, 6, v0
v_mul_u32_u24 v20, 8192, v20
v_and_b32 v21, 48, v0
v_add_u32 v18, v20, v21
v_bfe_u32 v20, v0, 6, 2
v_lshrrev_b32 v21, 9, v0
v_lshl_add_u32 v20, v21, 3, v20
v_lshlrev_b32 v19, 6, v20
v_and_b32 v20, 48, v0
v_add_u32 v19, v19, v20
v_bfe_u32 v20, v0, 8, 1
v_lshl_add_u32 v19, v20, 3, v19
s_mul_i32 s18, s13, 36864
v_add_u32 v19, s18, v19
s_barrier
s_add_u32 m0, s18, 0
s_add_u32 s19, s26, 0
buffer_load_dwordx4 v18, s[40:43], s19 offen lds
s_add_u32 m0, s18, 1024
s_add_u32 s19, s26, 131072
buffer_load_dwordx4 v18, s[40:43], s19 offen lds
s_add_u32 m0, s18, 2048
s_add_u32 s19, s26, 262144
buffer_load_dwordx4 v18, s[40:43], s19 offen lds
s_add_u32 m0, s18, 3072
s_add_u32 s19, s26, 393216
buffer_load_dwordx4 v18, s[40:43], s19 offen lds
s_add_u32 m0, s18, 4096
s_add_u32 s19, s26, 524288
buffer_load_dwordx4 v18, s[40:43], s19 offen lds
s_add_u32 m0, s18, 5120
s_add_u32 s19, s26, 655360
buffer_load_dwordx4 v18, s[40:43], s19 offen lds
s_add_u32 m0, s18, 6144
s_add_u32 s19, s26, 786432
buffer_load_dwordx4 v18, s[40:43], s19 offen lds
s_add_u32 m0, s18, 7168
s_add_u32 s19, s26, 917504
buffer_load_dwordx4 v18, s[40:43], s19 offen lds
s_add_u32 m0, s18, 8192
s_add_u32 s19, s26, 1048576
buffer_load_dwordx4 v18, s[40:43], s19 offen lds
s_add_u32 m0, s18, 9216
s_add_u32 s19, s26, 1179648
buffer_load_dwordx4 v18, s[40:43], s19 offen lds
s_add_u32 m0, s18, 10240
s_add_u32 s19, s26, 1310720
buffer_load_dwordx4 v18, s[40:43], s19 offen lds
s_add_u32 m0, s18, 11264
s_add_u32 s19, s26, 1441792
buffer_load_dwordx4 v18, s[40:43], s19 offen lds
s_add_u32 m0, s18, 12288
s_add_u32 s19, s26, 1572864
buffer_load_dwordx4 v18, s[40:43], s19 offen lds
s_add_u32 m0, s18, 13312
s_add_u32 s19, s26, 1703936
buffer_load_dwordx4 v18, s[40:43], s19 offen lds
s_add_u32 m0, s18, 14336
s_add_u32 s19, s26, 1835008
buffer_load_dwordx4 v18, s[40:43], s19 offen lds
s_add_u32 m0, s18, 15360
s_add_u32 s19, s26, 1966080
buffer_load_dwordx4 v18, s[40:43], s19 offen lds
s_add_u32 m0, s18, 16384
s_add_u32 s19, s26, 2097152
buffer_load_dwordx4 v18, s[40:43], s19 offen lds
s_add_u32 m0, s18, 17408
s_add_u32 s19, s26, 2228224
buffer_load_dwordx4 v18, s[40:43], s19 offen lds
s_add_u32 m0, s18, 18432
s_add_u32 s19, s26, 2359296
buffer_load_dwordx4 v18, s[40:43], s19 offen lds
s_add_u32 m0, s18, 19456
s_add_u32 s19, s26, 2490368
buffer_load_dwordx4 v18, s[40:43], s19 offen lds
s_add_u32 m0, s18, 20480
s_add_u32 s19, s26, 2621440
buffer_load_dwordx4 v18, s[40:43], s19 offen lds
s_add_u32 m0, s18, 21504
s_add_u32 s19, s26, 2752512
buffer_load_dwordx4 v18, s[40:43], s19 offen lds
s_add_u32 m0, s18, 22528
s_add_u32 s19, s26, 2883584
buffer_load_dwordx4 v18, s[40:43], s19 offen lds
s_add_u32 m0, s18, 23552
s_add_u32 s19, s26, 3014656
buffer_load_dwordx4 v18, s[40:43], s19 offen lds
s_add_u32 m0, s18, 24576
s_add_u32 s19, s26, 3145728
buffer_load_dwordx4 v18, s[40:43], s19 offen lds
s_add_u32 m0, s18, 25600
s_add_u32 s19, s26, 3276800
buffer_load_dwordx4 v18, s[40:43], s19 offen lds
s_add_u32 m0, s18, 26624
s_add_u32 s19, s26, 3407872
buffer_load_dwordx4 v18, s[40:43], s19 offen lds
s_add_u32 m0, s18, 27648
s_add_u32 s19, s26, 3538944
buffer_load_dwordx4 v18, s[40:43], s19 offen lds
s_add_u32 m0, s18, 28672
s_add_u32 s19, s26, 3670016
buffer_load_dwordx4 v18, s[40:43], s19 offen lds
s_add_u32 m0, s18, 29696
s_add_u32 s19, s26, 3801088
buffer_load_dwordx4 v18, s[40:43], s19 offen lds
s_add_u32 m0, s18, 30720
s_add_u32 s19, s26, 3932160
buffer_load_dwordx4 v18, s[40:43], s19 offen lds
s_add_u32 m0, s18, 31744
s_add_u32 s19, s26, 4063232
buffer_load_dwordx4 v18, s[40:43], s19 offen lds
s_add_u32 m0, s18, 32768
s_add_u32 s19, s26, 4194304
buffer_load_dwordx4 v18, s[40:43], s19 offen lds
s_add_u32 m0, s18, 33792
s_add_u32 s19, s26, 4325376
buffer_load_dwordx4 v18, s[40:43], s19 offen lds
s_add_u32 m0, s18, 34816
s_add_u32 s19, s26, 4456448
buffer_load_dwordx4 v18, s[40:43], s19 offen lds
s_add_u32 m0, s18, 35840
s_add_u32 s19, s26, 4587520
buffer_load_dwordx4 v18, s[40:43], s19 offen lds
s_waitcnt vmcnt(32)
ds_read_b64_tr_b16 a[0:1], v19 offset:0
ds_read_b64_tr_b16 a[2:3], v19 offset:256
ds_read_b64_tr_b16 a[4:5], v19 offset:1024
ds_read_b64_tr_b16 a[6:7], v19 offset:1280
ds_read_b64_tr_b16 a[8:9], v19 offset:2048
ds_read_b64_tr_b16 a[10:11], v19 offset:2304
ds_read_b64_tr_b16 a[12:13], v19 offset:3072
ds_read_b64_tr_b16 a[14:15], v19 offset:3328
s_waitcnt lgkmcnt(0)
s_add_u32 m0, s18, 0
s_add_u32 s19, s26, 4718592
buffer_load_dwordx4 v18, s[40:43], s19 offen lds
s_add_u32 m0, s18, 1024
s_add_u32 s19, s26, 4849664
buffer_load_dwordx4 v18, s[40:43], s19 offen lds
s_add_u32 m0, s18, 2048
s_add_u32 s19, s26, 4980736
buffer_load_dwordx4 v18, s[40:43], s19 offen lds
s_add_u32 m0, s18, 3072
s_add_u32 s19, s26, 5111808
buffer_load_dwordx4 v18, s[40:43], s19 offen lds
s_waitcnt vmcnt(32)
ds_read_b64_tr_b16 a[16:17], v19 offset:4096
ds_read_b64_tr_b16 a[18:19], v19 offset:4352
ds_read_b64_tr_b16 a[20:21], v19 offset:5120
ds_read_b64_tr_b16 a[22:23], v19 offset:5376
ds_read_b64_tr_b16 a[24:25], v19 offset:6144
ds_read_b64_tr_b16 a[26:27], v19 offset:6400
ds_read_b64_tr_b16 a[28:29], v19 offset:7168
ds_read_b64_tr_b16 a[30:31], v19 offset:7424
s_waitcnt vmcnt(28)
ds_read_b64_tr_b16 a[32:33], v19 offset:8192
ds_read_b64_tr_b16 a[34:35], v19 offset:8448
ds_read_b64_tr_b16 a[36:37], v19 offset:9216
ds_read_b64_tr_b16 a[38:39], v19 offset:9472
ds_read_b64_tr_b16 a[40:41], v19 offset:10240
ds_read_b64_tr_b16 a[42:43], v19 offset:10496
ds_read_b64_tr_b16 a[44:45], v19 offset:11264
ds_read_b64_tr_b16 a[46:47], v19 offset:11520
s_waitcnt vmcnt(24)
ds_read_b64_tr_b16 a[48:49], v19 offset:12288
ds_read_b64_tr_b16 a[50:51], v19 offset:12544
ds_read_b64_tr_b16 a[52:53], v19 offset:13312
ds_read_b64_tr_b16 a[54:55], v19 offset:13568
ds_read_b64_tr_b16 a[56:57], v19 offset:14336
ds_read_b64_tr_b16 a[58:59], v19 offset:14592
ds_read_b64_tr_b16 a[60:61], v19 offset:15360
ds_read_b64_tr_b16 a[62:63], v19 offset:15616
s_waitcnt vmcnt(20)
ds_read_b64_tr_b16 a[64:65], v19 offset:16384
ds_read_b64_tr_b16 a[66:67], v19 offset:16640
ds_read_b64_tr_b16 a[68:69], v19 offset:17408
ds_read_b64_tr_b16 a[70:71], v19 offset:17664
ds_read_b64_tr_b16 a[72:73], v19 offset:18432
ds_read_b64_tr_b16 a[74:75], v19 offset:18688
ds_read_b64_tr_b16 a[76:77], v19 offset:19456
ds_read_b64_tr_b16 a[78:79], v19 offset:19712
s_waitcnt vmcnt(16)
ds_read_b64_tr_b16 a[80:81], v19 offset:20480
ds_read_b64_tr_b16 a[82:83], v19 offset:20736
ds_read_b64_tr_b16 a[84:85], v19 offset:21504
ds_read_b64_tr_b16 a[86:87], v19 offset:21760
ds_read_b64_tr_b16 a[88:89], v19 offset:22528
ds_read_b64_tr_b16 a[90:91], v19 offset:22784
ds_read_b64_tr_b16 a[92:93], v19 offset:23552
ds_read_b64_tr_b16 a[94:95], v19 offset:23808
s_waitcnt vmcnt(12)
ds_read_b64_tr_b16 a[96:97], v19 offset:24576
ds_read_b64_tr_b16 a[98:99], v19 offset:24832
ds_read_b64_tr_b16 a[100:101], v19 offset:25600
ds_read_b64_tr_b16 a[102:103], v19 offset:25856
ds_read_b64_tr_b16 a[104:105], v19 offset:26624
ds_read_b64_tr_b16 a[106:107], v19 offset:26880
ds_read_b64_tr_b16 a[108:109], v19 offset:27648
ds_read_b64_tr_b16 a[110:111], v19 offset:27904
s_waitcnt vmcnt(8)
ds_read_b64_tr_b16 a[112:113], v19 offset:28672
ds_read_b64_tr_b16 a[114:115], v19 offset:28928
ds_read_b64_tr_b16 a[116:117], v19 offset:29696
ds_read_b64_tr_b16 a[118:119], v19 offset:29952
ds_read_b64_tr_b16 a[120:121], v19 offset:30720
ds_read_b64_tr_b16 a[122:123], v19 offset:30976
ds_read_b64_tr_b16 a[124:125], v19 offset:31744
ds_read_b64_tr_b16 a[126:127], v19 offset:32000
s_waitcnt vmcnt(4)
ds_read_b64_tr_b16 a[128:129], v19 offset:32768
ds_read_b64_tr_b16 a[130:131], v19 offset:33024
ds_read_b64_tr_b16 a[132:133], v19 offset:33792
ds_read_b64_tr_b16 a[134:135], v19 offset:34048
ds_read_b64_tr_b16 a[136:137], v19 offset:34816
ds_read_b64_tr_b16 a[138:139], v19 offset:35072
ds_read_b64_tr_b16 a[140:141], v19 offset:35840
ds_read_b64_tr_b16 a[142:143], v19 offset:36096
s_waitcnt vmcnt(0)
ds_read_b64_tr_b16 a[144:145], v19 offset:0
ds_read_b64_tr_b16 a[146:147], v19 offset:256
ds_read_b64_tr_b16 a[148:149], v19 offset:1024
ds_read_b64_tr_b16 a[150:151], v19 offset:1280
ds_read_b64_tr_b16 a[152:153], v19 offset:2048
ds_read_b64_tr_b16 a[154:155], v19 offset:2304
ds_read_b64_tr_b16 a[156:157], v19 offset:3072
ds_read_b64_tr_b16 a[158:159], v19 offset:3328
s_waitcnt lgkmcnt(0)
s_barrier
s_load_dwordx2 s[40:41], s[0:1], 64
s_mov_b32 s42, 5242880
s_mov_b32 s43, 0x20000
s_waitcnt lgkmcnt(0)
v_lshlrev_b32 v6, 3, v0
s_mul_i32 s18, s32, 163840
s_mul_i32 s19, s13, 40960
s_add_u32 s18, s18, s19
buffer_load_dword v12, v6, s[40:43], s18 offen
s_add_u32 s18, s18, 8192
buffer_load_dword v13, v6, s[40:43], s18 offen
s_add_u32 s18, s18, 8192
buffer_load_dword v14, v6, s[40:43], s18 offen
s_add_u32 s18, s18, 8192
buffer_load_dword v15, v6, s[40:43], s18 offen
s_add_u32 s18, s18, 8192
buffer_load_dword v16, v6, s[40:43], s18 offen
s_add_u32 s18, s18, 8192
v_mov_b32 v20, s24
v_mov_b32 v21, s24
v_mov_b32 v22, s24
v_mov_b32 v23, s24
s_nop 1
v_mfma_f32_32x32x16_bf16 v[24:39], v[20:23], a[0:3], 0
v_mfma_f32_32x32x16_bf16 v[24:39], v[20:23], a[4:7], v[24:39]
v_mfma_f32_32x32x16_bf16 v[24:39], v[20:23], a[8:11], v[24:39]
v_mfma_f32_32x32x16_bf16 v[24:39], v[20:23], a[12:15], v[24:39]
v_mfma_f32_32x32x16_bf16 v[24:39], v[20:23], a[16:19], v[24:39]
v_mfma_f32_32x32x16_bf16 v[24:39], v[20:23], a[20:23], v[24:39]
v_mfma_f32_32x32x16_bf16 v[24:39], v[20:23], a[24:27], v[24:39]
v_mfma_f32_32x32x16_bf16 v[24:39], v[20:23], a[28:31], v[24:39]
v_mfma_f32_32x32x16_bf16 v[24:39], v[20:23], a[32:35], v[24:39]
v_mfma_f32_32x32x16_bf16 v[24:39], v[20:23], a[36:39], v[24:39]
v_mfma_f32_32x32x16_bf16 v[24:39], v[20:23], a[40:43], v[24:39]
v_mfma_f32_32x32x16_bf16 v[24:39], v[20:23], a[44:47], v[24:39]
v_mfma_f32_32x32x16_bf16 v[24:39], v[20:23], a[48:51], v[24:39]
v_mfma_f32_32x32x16_bf16 v[24:39], v[20:23], a[52:55], v[24:39]
v_mfma_f32_32x32x16_bf16 v[24:39], v[20:23], a[56:59], v[24:39]
v_mfma_f32_32x32x16_bf16 v[24:39], v[20:23], a[60:63], v[24:39]
v_mfma_f32_32x32x16_bf16 v[24:39], v[20:23], a[64:67], v[24:39]
v_mfma_f32_32x32x16_bf16 v[24:39], v[20:23], a[68:71], v[24:39]
v_mfma_f32_32x32x16_bf16 v[24:39], v[20:23], a[72:75], v[24:39]
v_mfma_f32_32x32x16_bf16 v[24:39], v[20:23], a[76:79], v[24:39]
v_mfma_f32_32x32x16_bf16 v[24:39], v[20:23], a[80:83], v[24:39]
v_mfma_f32_32x32x16_bf16 v[24:39], v[20:23], a[84:87], v[24:39]
v_mfma_f32_32x32x16_bf16 v[24:39], v[20:23], a[88:91], v[24:39]
v_mfma_f32_32x32x16_bf16 v[24:39], v[20:23], a[92:95], v[24:39]
v_mfma_f32_32x32x16_bf16 v[24:39], v[20:23], a[96:99], v[24:39]
v_mfma_f32_32x32x16_bf16 v[24:39], v[20:23], a[100:103], v[24:39]
v_mfma_f32_32x32x16_bf16 v[24:39], v[20:23], a[104:107], v[24:39]
v_mfma_f32_32x32x16_bf16 v[24:39], v[20:23], a[108:111], v[24:39]
v_mfma_f32_32x32x16_bf16 v[24:39], v[20:23], a[112:115], v[24:39]
v_mfma_f32_32x32x16_bf16 v[24:39], v[20:23], a[116:119], v[24:39]
v_mfma_f32_32x32x16_bf16 v[24:39], v[20:23], a[120:123], v[24:39]
v_mfma_f32_32x32x16_bf16 v[24:39], v[20:23], a[124:127], v[24:39]
v_mfma_f32_32x32x16_bf16 v[24:39], v[20:23], a[128:131], v[24:39]
v_mfma_f32_32x32x16_bf16 v[24:39], v[20:23], a[132:135], v[24:39]
v_mfma_f32_32x32x16_bf16 v[24:39], v[20:23], a[136:139], v[24:39]
v_mfma_f32_32x32x16_bf16 v[24:39], v[20:23], a[140:143], v[24:39]
v_mfma_f32_32x32x16_bf16 v[24:39], v[20:23], a[144:147], v[24:39]
v_mfma_f32_32x32x16_bf16 v[24:39], v[20:23], a[148:151], v[24:39]
v_mfma_f32_32x32x16_bf16 v[24:39], v[20:23], a[152:155], v[24:39]
v_mfma_f32_32x32x16_bf16 v[24:39], v[20:23], a[156:159], v[24:39]
s_nop 11
v_mov_b32 v5, v24
v_and_b32 v6, 0xf0, v0
s_waitcnt vmcnt(4)
v_bfe_u32 v12, v0, 8, 1
v_lshl_add_u32 v6, v12, 10, v6
v_lshrrev_b32 v12, 9, v0
v_lshl_add_u32 v6, v12, 8, v6
s_lshl_b32 s34, s13, 12
s_add_u32 s34, s34, 2048
s_lshl_b32 s18, s32, 14
s_add_u32 s34, s34, s18
v_bfe_u32 v7, v0, 7, 2
v_mul_u32_u24 v7, 10240, v7
v_bfe_u32 v12, v0, 5, 2
v_lshl_add_u32 v7, v12, 6, v7
v_lshrrev_b32 v12, 9, v0
v_lshl_add_u32 v7, v12, 5, v7
v_and_b32 v12, 16, v0
v_add_u32 v7, v12, v7
s_lshl_b32 s51, s32, 8
s_add_u32 s51, s51, 11534464
s_mul_i32 s52, s13, 2560
s_add_u32 s52, s52, 12582912
s_add_u32 s50, s34, 110100480
s_mov_b32 s39, 0
kvlay_29:
s_mul_i32 s26, s16, 6291456
s_add_u32 s26, s26, 88080384
s_add_u32 s26, s26, s31
s_mul_i32 s54, s16, 327680
s_add_u32 s54, s54, 163577856
s_mul_i32 s27, s16, 35651584
s_add_u32 s27, s27, 16777216
s_mul_i32 s18, s32, 0
s_add_u32 s27, s27, s18
s_add_u32 s27, s27, s34
s_lshl_b32 s29, s16, 1
s_add_u32 s29, s29, 1
s_mov_b32 s28, 0
s_mov_b32 s30, 0
s_cmp_lt_u32 s30, 64
s_cselect_b32 s53, s26, s6
s_cselect_b32 s36, s54, s6
s_mov_b32 s38, 1024
v_mov_b32 v8, v0
s_add_u32 s26, s26, 40960
s_add_u32 s54, s54, 5120
s_add_u32 s30, s30, 1
v_xor_b32 v1, 40960, v0
s_mov_b32 s25, s31
s_mov_b32 s35, 131072
s_cmp_lg_u32 s13, 0
s_cbranch_scc1 polld_38
v_lshlrev_b32 v3, 3, v0
s_waitcnt vmcnt(0)
v_min_u32 v16, 1152, v3
s_mov_b32 s21, 11612160
s_mov_b32 s17, 0
poll_37:
buffer_load_dword v12, v16, s[4:7], s21 offen sc1
s_add_u32 s17, s17, 1
s_cmp_gt_u32 s17, 262144
s_cbranch_scc1 L_fail
s_waitcnt vmcnt(0)
v_cmp_gt_u32 vcc, s29, v12
s_cbranch_vccz polld_38
s_sleep 2
s_branch poll_37
polld_38:
s_barrier
s_add_u32 m0, s25, 2048
s_mov_b32 s20, s53
buffer_load_dwordx4 v8, s[4:7], s20 offen sc1 lds
s_add_u32 m0, s25, 3072
s_add_u32 s20, s20, s38
buffer_load_dwordx4 v8, s[4:7], s20 offen sc1 lds
s_add_u32 m0, s25, 4096
s_add_u32 s20, s20, s38
buffer_load_dwordx4 v8, s[4:7], s20 offen sc1 lds
s_add_u32 m0, s25, 5120
s_add_u32 s20, s20, s38
buffer_load_dwordx4 v8, s[4:7], s20 offen sc1 lds
s_add_u32 m0, s25, 6144
s_add_u32 s20, s20, s38
buffer_load_dwordx4 v8, s[4:7], s20 offen sc1 lds
s_add_u32 m0, s25, 7168
s_add_u32 s20, s20, s38
buffer_load_dwordx4 v8, s[4:7], s20 offen sc1 lds
s_add_u32 m0, s25, 8192
s_add_u32 s20, s20, s38
buffer_load_dwordx4 v8, s[4:7], s20 offen sc1 lds
s_add_u32 m0, s25, 9216
s_add_u32 s20, s20, s38
buffer_load_dwordx4 v8, s[4:7], s20 offen sc1 lds
s_add_u32 m0, s25, 10240
s_add_u32 s20, s20, s38
buffer_load_dwordx4 v8, s[4:7], s20 offen sc1 lds
s_add_u32 m0, s25, 11264
s_add_u32 s20, s20, s38
buffer_load_dwordx4 v8, s[4:7], s20 offen sc1 lds
s_add_u32 m0, s35, s37
s_add_u32 s20, s36, s37
buffer_load_dwordx4 v0, s[4:7], s20 offen sc1 lds
s_add_u32 m0, s35, 4096
s_add_u32 s20, s36, 4096
buffer_load_dwordx4 v0, s[4:7], s20 offen sc1 lds
s_waitcnt vmcnt(0)
kvx_30:
v_xor_b32 v1, 40960, v1
s_sub_u32 s25, s25, s31
s_xor_b32 s25, s25, 40960
s_add_u32 s25, s25, s31
s_xor_b32 s35, s35, 8192
s_cmp_eq_u32 s28, 1
s_cbranch_scc1 kv_32
s_cmp_eq_u32 s28, 30
s_cbranch_scc0 kv_33
s_add_u32 s29, s29, 1
kv_32:
s_waitcnt vmcnt(0)
s_barrier
v_mov_b32 v3, s23
s_mov_b64 exec, 1
buffer_store_dword v3, off, s[4:7], s22 sc1
s_mov_b64 exec, -1
s_mov_b32 s22, s6
s_cmp_lg_u32 s13, 0
s_cbranch_scc1 polld_40
v_lshlrev_b32 v3, 3, v0
v_min_u32 v16, 3968, v3
s_mov_b32 s21, 11612160
s_mov_b32 s17, 0
poll_39:
buffer_load_dword v12, v3, s[4:7], s21 offen sc1
s_add_u32 s20, s21, 8192
buffer_load_dword v13, v3, s[4:7], s20 offen sc1
s_add_u32 s20, s21, 16384
buffer_load_dword v14, v16, s[4:7], s20 offen sc1
s_add_u32 s17, s17, 1
s_cmp_gt_u32 s17, 262144
s_cbranch_scc1 L_fail
s_waitcnt vmcnt(1)
v_min_u32 v12, v12, v13
s_waitcnt vmcnt(0)
v_min_u32 v12, v12, v14
v_cmp_gt_u32 vcc, s29, v12
s_cbranch_vccz polld_40
s_sleep 2
s_branch poll_39
polld_40:
s_barrier
kv_33:
s_add_u32 s28, s28, 1
s_and_b32 s33, s28, 3
s_cmp_lt_u32 s28, 12
s_cselect_b32 s33, 1, s33
s_cmp_eq_u32 s33, 0
s_cbranch_scc1 kv_34
s_cmp_lt_u32 s30, 64
s_cselect_b32 s53, s26, s6
s_cselect_b32 s36, s54, s6
s_mov_b32 s38, 1024
v_mov_b32 v8, v0
s_add_u32 s26, s26, 40960
s_add_u32 s54, s54, 5120
s_add_u32 s30, s30, 1
kvn_31:
s_waitcnt vmcnt(3)
s_barrier
ds_read_b128 v[36:39], v1 offset:2048
s_add_u32 m0, s25, 2048
s_mov_b32 s20, s53
buffer_load_dwordx4 v8, s[4:7], s20 offen sc1 lds
ds_read_b128 v[40:43], v1 offset:3072
s_xor_b32 s18, s35, 8192
v_lshrrev_b32 v2, 2, v0
v_add_u32 v2, s18, v2
ds_read_b128 v[48:51], v1 offset:5120
s_add_u32 m0, s25, 3072
s_add_u32 s20, s20, s38
buffer_load_dwordx4 v8, s[4:7], s20 offen sc1 lds
ds_read_b128 v[44:47], v1 offset:4096
s_waitcnt lgkmcnt(3)
v_mfma_f32_32x32x16_bf16 v[20:35], v[36:39], a[0:3], 0
ds_read2st64_b32 v[62:63], v2 offset0:6 offset1:7
s_waitcnt lgkmcnt(3)
ds_read2st64_b32 v[72:73], v2 offset0:16 offset1:17
ds_read2st64_b32 v[74:75], v2 offset0:18 offset1:19
ds_read_b128 v[36:39], v1 offset:6144
v_mfma_f32_32x32x16_bf16 v[20:35], v[40:43], a[4:7], v[20:35]
s_add_u32 m0, s25, 4096
s_add_u32 s20, s20, s38
buffer_load_dwordx4 v8, s[4:7], s20 offen sc1 lds
ds_read2st64_b32 v[54:55], v2 offset0:2 offset1:3
s_waitcnt lgkmcnt(5)
ds_read2st64_b32 v[52:53], v2 offset0:0 offset1:1
v_mfma_f32_32x32x16_bf16 v[20:35], v[44:47], a[8:11], v[20:35]
ds_read_b128 v[40:43], v1 offset:7168
ds_read2st64_b32 v[60:61], v2 offset0:4 offset1:5
ds_read2st64_b32 v[66:67], v2 offset0:10 offset1:11
s_add_u32 m0, s25, 5120
s_add_u32 s20, s20, s38
buffer_load_dwordx4 v8, s[4:7], s20 offen sc1 lds
v_mfma_f32_32x32x16_bf16 v[20:35], v[48:51], a[12:15], v[20:35]
ds_read_b128 v[48:51], v1 offset:9216
s_waitcnt lgkmcnt(6)
ds_read_b128 v[44:47], v1 offset:8192
s_waitcnt lgkmcnt(5)
ds_read2st64_b32 v[70:71], v2 offset0:14 offset1:15
v_mfma_f32_32x32x16_bf16 v[20:35], v[36:39], a[16:19], v[20:35]
s_add_u32 m0, s25, 6144
s_add_u32 s20, s20, s38
buffer_load_dwordx4 v8, s[4:7], s20 offen sc1 lds
s_waitcnt lgkmcnt(3)
ds_read2st64_b32 v[68:69], v2 offset0:12 offset1:13
v_mfma_f32_32x32x16_bf16 v[20:35], v[40:43], a[20:23], v[20:35]
s_waitcnt lgkmcnt(3)
ds_read_b128 v[36:39], v1 offset:10240
s_waitcnt lgkmcnt(3)
ds_read_b128 v[40:43], v1 offset:11264
v_mfma_f32_32x32x16_bf16 v[20:35], v[44:47], a[24:27], v[20:35]
ds_read_b128 v[44:47], v1 offset:12288
v_add_f32 v52, v52, v54
ds_read2st64_b32 v[64:65], v2 offset0:8 offset1:9
v_mfma_f32_32x32x16_bf16 v[20:35], v[48:51], a[28:31], v[20:35]
s_add_u32 m0, s25, 7168
s_add_u32 s20, s20, s38
buffer_load_dwordx4 v8, s[4:7], s20 offen sc1 lds
v_add_f32 v53, v53, v55
v_add_f32 v52, v52, v60
s_waitcnt lgkmcnt(3)
v_mfma_f32_32x32x16_bf16 v[20:35], v[36:39], a[32:35], v[20:35]
ds_read_b128 v[48:51], v1 offset:13312
s_waitcnt lgkmcnt(3)
s_waitcnt lgkmcnt(2)
ds_read_b128 v[36:39], v1 offset:14336
v_mfma_f32_32x32x16_bf16 v[20:35], v[40:43], a[36:39], v[20:35]
ds_read_b128 v[40:43], v1 offset:15360
s_add_u32 m0, s25, 8192
s_add_u32 s20, s20, s38
buffer_load_dwordx4 v8, s[4:7], s20 offen sc1 lds
v_mfma_f32_32x32x16_bf16 v[20:35], v[44:47], a[40:43], v[20:35]
s_add_u32 m0, s25, 9216
s_add_u32 s20, s20, s38
buffer_load_dwordx4 v8, s[4:7], s20 offen sc1 lds
v_mov_b32 v3, s23
v_add_f32 v53, v53, v61
s_waitcnt lgkmcnt(1)
v_add_f32 v53, v53, v63
v_mfma_f32_32x32x16_bf16 v[20:35], v[48:51], a[44:47], v[20:35]
v_add_f32 v52, v52, v62
v_add_f32 v52, v52, v64
ds_read_b128 v[44:47], v1 offset:16384
v_add_f32 v53, v53, v65
v_mfma_f32_32x32x16_bf16 v[20:35], v[36:39], a[48:51], v[20:35]
s_waitcnt lgkmcnt(1)
ds_read_b128 v[48:51], v1 offset:17408
ds_read_b128 v[36:39], v1 offset:18432
v_bfe_u32 v54, v0, 5, 5
v_add_f32 v53, v53, v67
v_and_b32 v54, 16, v54
v_add_f32 v53, v53, v69
v_mfma_f32_32x32x16_bf16 v[20:35], v[40:43], a[52:55], v[20:35]
v_add_f32 v52, v52, v66
ds_read_b128 v[40:43], v1 offset:19456
s_waitcnt lgkmcnt(3)
v_mfma_f32_32x32x16_bf16 v[20:35], v[44:47], a[56:59], v[20:35]
s_waitcnt lgkmcnt(2)
v_add_f32 v52, v52, v68
s_add_u32 m0, s25, 10240
s_add_u32 s20, s20, s38
buffer_load_dwordx4 v8, s[4:7], s20 offen sc1 lds
v_mfma_f32_32x32x16_bf16 v[20:35], v[48:51], a[60:63], v[20:35]
ds_read_b128 v[44:47], v1 offset:20480
v_add_f32 v53, v53, v71
s_waitcnt lgkmcnt(2)
v_add_f32 v52, v52, v70
v_add_f32 v52, v52, v72
v_add_f32 v53, v53, v73
v_mfma_f32_32x32x16_bf16 v[20:35], v[36:39], a[64:67], v[20:35]
ds_read_b128 v[48:51], v1 offset:21504
v_add_f32 v52, v52, v74
s_waitcnt lgkmcnt(2)
v_mfma_f32_32x32x16_bf16 v[20:35], v[40:43], a[68:71], v[20:35]
ds_read_b128 v[40:43], v1 offset:23552
ds_read_b128 v[36:39], v1 offset:22528
v_add_f32 v53, v53, v75
s_waitcnt lgkmcnt(3)
v_add_f32 v52, v52, v53
v_mfma_f32_32x32x16_bf16 v[20:35], v[44:47], a[72:75], v[20:35]
v_mov_b32 v56, v52
s_nop 1
v_permlane32_swap_b32 v52, v56
s_waitcnt lgkmcnt(2)
v_mfma_f32_32x32x16_bf16 v[20:35], v[48:51], a[76:79], v[20:35]
ds_read_b128 v[44:47], v1 offset:24576
s_waitcnt lgkmcnt(1)
ds_read_b128 v[48:51], v1 offset:25600
v_mfma_f32_32x32x16_bf16 v[20:35], v[36:39], a[80:83], v[20:35]
ds_read_b128 v[36:39], v1 offset:26624
v_mul_f32 v52, 0x3acccccd, v52
v_lshrrev_b32 v53, 2, v0
v_mul_f32 v56, 0x3acccccd, v56
s_add_u32 m0, s25, 11264
s_add_u32 s20, s20, s38
buffer_load_dwordx4 v8, s[4:7], s20 offen sc1 lds
v_mfma_f32_32x32x16_bf16 v[20:35], v[40:43], a[84:87], v[20:35]
s_waitcnt lgkmcnt(2)
ds_read_b128 v[40:43], v1 offset:27648
v_fma_f32 v56, -v52, v52, v56
v_max_f32 v56, 0, v56
s_waitcnt lgkmcnt(2)
v_lshl_add_u32 v53, s13, 8, v53
v_add_f32 v56, 0x3727c5ac, v56
v_mfma_f32_32x32x16_bf16 v[20:35], v[44:47], a[88:91], v[20:35]
ds_read_b128 v[44:47], v1 offset:28672
s_add_u32 m0, s35, s37
s_add_u32 s20, s36, s37
buffer_load_dwordx4 v0, s[4:7], s20 offen sc1 lds
v_mfma_f32_32x32x16_bf16 v[20:35], v[48:51], a[92:95], v[20:35]
s_waitcnt lgkmcnt(2)
v_rsq_f32 v56, v56
ds_read_b128 v[48:51], v1 offset:29696
v_mul_f32 v52, v56, v52
v_mfma_f32_32x32x16_bf16 v[20:35], v[36:39], a[96:99], v[20:35]
ds_read_b128 v[36:39], v1 offset:30720
s_waitcnt lgkmcnt(3)
s_add_u32 m0, s35, 4096
s_add_u32 s20, s36, 4096
buffer_load_dwordx4 v0, s[4:7], s20 offen sc1 lds
v_mfma_f32_32x32x16_bf16 v[20:35], v[40:43], a[100:103], v[20:35]
ds_read_b128 v[40:43], v1 offset:31744
s_waitcnt lgkmcnt(3)
v_permlane32_swap_b32 v56, v52
v_lshl_add_u32 v54, s13, 8, v54
v_mfma_f32_32x32x16_bf16 v[20:35], v[44:47], a[104:107], v[20:35]
s_waitcnt lgkmcnt(1)
ds_read_b128 v[44:47], v1 offset:32768
ds_write_b32 v53, v56 offset:1024
ds_read_b128 v[80:83], v54 offset:1184
ds_read_b128 v[76:79], v54 offset:1152
v_mfma_f32_32x32x16_bf16 v[20:35], v[48:51], a[108:111], v[20:35]
v_mfma_f32_32x32x16_bf16 v[20:35], v[36:39], a[112:115], v[20:35]
s_waitcnt lgkmcnt(4)
ds_read_b128 v[48:51], v1 offset:33792
ds_read_b128 v[88:91], v54 offset:1248
ds_read_b128 v[36:39], v1 offset:34816
s_waitcnt lgkmcnt(6)
ds_read_b128 v[84:87], v54 offset:1216
v_mfma_f32_32x32x16_bf16 v[20:35], v[40:43], a[116:119], v[20:35]
s_waitcnt vmcnt(12)
s_barrier
s_mov_b64 exec, 1
buffer_store_dword v3, off, s[4:7], s22 sc1
s_mov_b64 exec, -1
v_mfma_f32_32x32x16_bf16 v[20:35], v[44:47], a[120:123], v[20:35]
ds_read_b128 v[40:43], v1 offset:35840
s_waitcnt lgkmcnt(4)
ds_read_b128 v[44:47], v1 offset:36864
v_mfma_f32_32x32x16_bf16 v[20:35], v[48:51], a[124:127], v[20:35]
ds_read_b128 v[48:51], v1 offset:37888
ds_read_b128 v[72:75], v54 offset:1120
s_waitcnt lgkmcnt(4)
v_mul_f32 v79, v79, v5
v_mul_f32 v86, v86, v5
v_mfma_f32_32x32x16_bf16 v[20:35], v[36:39], a[128:131], v[20:35]
s_waitcnt lgkmcnt(3)
v_mfma_f32_32x32x16_bf16 v[20:35], v[40:43], a[132:135], v[20:35]
v_mul_f32 v89, v89, v5
v_mul_f32 v90, v90, v5
s_waitcnt lgkmcnt(2)
s_waitcnt lgkmcnt(1)
ds_read_b128 v[36:39], v1 offset:38912
ds_read_b128 v[60:63], v54 offset:1024
v_mfma_f32_32x32x16_bf16 v[20:35], v[44:47], a[136:139], v[20:35]
ds_read_b128 v[40:43], v1 offset:39936
ds_read_b128 v[44:47], v1 offset:40960
ds_read_b128 v[64:67], v54 offset:1056
v_mul_f32 v87, v87, v5
v_mfma_f32_32x32x16_bf16 v[20:35], v[48:51], a[140:143], v[20:35]
ds_read_b128 v[48:51], v1 offset:41984
ds_read_b128 v[68:71], v54 offset:1088
s_waitcnt lgkmcnt(6)
v_mfma_f32_32x32x16_bf16 v[20:35], v[36:39], a[144:147], v[20:35]
s_waitcnt lgkmcnt(4)
v_mul_f32 v78, v78, v5
v_mfma_f32_32x32x16_bf16 v[20:35], v[40:43], a[148:151], v[20:35]
v_mul_f32 v76, v76, v5
v_mul_f32 v85, v85, v5
v_mul_f32 v91, v91, v5
v_mul_f32 v77, v77, v5
s_waitcnt lgkmcnt(3)
v_mul_f32 v84, v84, v5
v_mfma_f32_32x32x16_bf16 v[20:35], v[44:47], a[152:155], v[20:35]
s_waitcnt lgkmcnt(1)
v_mul_f32 v88, v88, v5
v_mul_f32 v80, v80, v5
v_mfma_f32_32x32x16_bf16 v[20:35], v[48:51], a[156:159], v[20:35]
s_waitcnt lgkmcnt(0)
v_mul_f32 v83, v83, v5
v_mul_f32 v82, v82, v5
v_mul_f32 v81, v81, v5
s_nop 7
v_pk_fma_f32 v[26:27], v[26:27], v[66:67], v[82:83] neg_lo:[0,0,1] neg_hi:[0,0,1]
v_pk_fma_f32 v[24:25], v[24:25], v[64:65], v[80:81] neg_lo:[0,0,1] neg_hi:[0,0,1]
v_pk_fma_f32 v[34:35], v[34:35], v[74:75], v[90:91] neg_lo:[0,0,1] neg_hi:[0,0,1]
v_pk_fma_f32 v[22:23], v[22:23], v[62:63], v[78:79] neg_lo:[0,0,1] neg_hi:[0,0,1]
v_cvt_pk_bf16_f32 v37, v22, v23
v_pk_fma_f32 v[30:31], v[30:31], v[70:71], v[86:87] neg_lo:[0,0,1] neg_hi:[0,0,1]
v_cvt_pk_bf16_f32 v39, v26, v27
v_pk_fma_f32 v[32:33], v[32:33], v[72:73], v[88:89] neg_lo:[0,0,1] neg_hi:[0,0,1]
v_pk_fma_f32 v[20:21], v[20:21], v[60:61], v[76:77] neg_lo:[0,0,1] neg_hi:[0,0,1]
v_pk_fma_f32 v[28:29], v[28:29], v[68:69], v[84:85] neg_lo:[0,0,1] neg_hi:[0,0,1]
v_cvt_pk_bf16_f32 v38, v24, v25
v_cvt_pk_bf16_f32 v42, v32, v33
v_cvt_pk_bf16_f32 v40, v28, v29
v_cvt_pk_bf16_f32 v41, v30, v31
v_cvt_pk_bf16_f32 v43, v34, v35
v_cvt_pk_bf16_f32 v36, v20, v21
buffer_store_dwordx4 v[36:39], v6, s[4:7], s27 offen offset:0 sc1
buffer_store_dwordx4 v[40:43], v6, s[4:7], s27 offen offset:512 sc1
s_lshl_b32 s18, s16, 6
s_add_u32 s18, s18, s28
s_add_u32 s27, s27, 524288
s_cmp_eq_u32 s13, 0
s_cselect_b32 s22, s51, s6
s_mov_b32 s23, s18
s_cmp_lg_u32 s33, 0
s_cbranch_scc1 kvx_30
kvm_35:
v_xor_b32 v1, 40960, v1
s_sub_u32 s25, s25, s31
s_xor_b32 s25, s25, 40960
s_add_u32 s25, s25, s31
s_xor_b32 s35, s35, 8192
s_cmp_lt_u32 s30, 64
s_cselect_b32 s53, s26, s6
s_cselect_b32 s36, s54, s6
s_mov_b32 s38, 1024
v_mov_b32 v8, v0
s_add_u32 s26, s26, 40960
s_add_u32 s54, s54, 5120
s_add_u32 s30, s30, 1
s_waitcnt vmcnt(3)
s_barrier
ds_read_b128 v[36:39], v1 offset:2048
s_add_u32 m0, s25, 2048
s_mov_b32 s20, s53
buffer_load_dwordx4 v8, s[4:7], s20 offen sc1 lds
ds_read_b128 v[40:43], v1 offset:3072
ds_read_b128 v[44:47], v1 offset:4096
s_add_u32 m0, s25, 3072
s_add_u32 s20, s20, s38
buffer_load_dwordx4 v8, s[4:7], s20 offen sc1 lds
s_waitcnt lgkmcnt(2)
v_mfma_f32_32x32x16_bf16 v[20:35], v[36:39], a[0:3], 0
ds_read_b128 v[48:51], v1 offset:5120
s_waitcnt lgkmcnt(2)
s_add_u32 m0, s25, 4096
s_add_u32 s20, s20, s38
buffer_load_dwordx4 v8, s[4:7], s20 offen sc1 lds
s_waitcnt lgkmcnt(1)
v_mfma_f32_32x32x16_bf16 v[20:35], v[40:43], a[4:7], v[20:35]
s_add_u32 m0, s25, 5120
s_add_u32 s20, s20, s38
buffer_load_dwordx4 v8, s[4:7], s20 offen sc1 lds
ds_read_b128 v[36:39], v1 offset:6144
ds_read_b128 v[40:43], v1 offset:7168
v_mfma_f32_32x32x16_bf16 v[20:35], v[44:47], a[8:11], v[20:35]
ds_read_b128 v[44:47], v1 offset:8192
s_waitcnt lgkmcnt(3)
v_mfma_f32_32x32x16_bf16 v[20:35], v[48:51], a[12:15], v[20:35]
s_waitcnt lgkmcnt(2)
v_mfma_f32_32x32x16_bf16 v[20:35], v[36:39], a[16:19], v[20:35]
ds_read_b128 v[48:51], v1 offset:9216
ds_read_b128 v[36:39], v1 offset:10240
s_waitcnt lgkmcnt(2)
v_mfma_f32_32x32x16_bf16 v[20:35], v[40:43], a[20:23], v[20:35]
v_mfma_f32_32x32x16_bf16 v[20:35], v[44:47], a[24:27], v[20:35]
ds_read_b128 v[44:47], v1 offset:12288
s_waitcnt lgkmcnt(2)
ds_read_b128 v[40:43], v1 offset:11264
v_mfma_f32_32x32x16_bf16 v[20:35], v[48:51], a[28:31], v[20:35]
s_waitcnt lgkmcnt(2)
s_add_u32 m0, s25, 6144
s_add_u32 s20, s20, s38
buffer_load_dwordx4 v8, s[4:7], s20 offen sc1 lds
ds_read_b128 v[48:51], v1 offset:13312
v_mfma_f32_32x32x16_bf16 v[20:35], v[36:39], a[32:35], v[20:35]
s_waitcnt lgkmcnt(2)
s_add_u32 m0, s25, 7168
s_add_u32 s20, s20, s38
buffer_load_dwordx4 v8, s[4:7], s20 offen sc1 lds
s_waitcnt lgkmcnt(1)
v_mfma_f32_32x32x16_bf16 v[20:35], v[40:43], a[36:39], v[20:35]
ds_read_b128 v[36:39], v1 offset:14336
s_add_u32 m0, s25, 8192
s_add_u32 s20, s20, s38
buffer_load_dwordx4 v8, s[4:7], s20 offen sc1 lds
s_waitcnt lgkmcnt(1)
ds_read_b128 v[40:43], v1 offset:15360
v_mfma_f32_32x32x16_bf16 v[20:35], v[44:47], a[40:43], v[20:35]
ds_read_b128 v[44:47], v1 offset:16384
v_mfma_f32_32x32x16_bf16 v[20:35], v[48:51], a[44:47], v[20:35]
s_waitcnt lgkmcnt(2)
ds_read_b128 v[48:51], v1 offset:17408
v_mfma_f32_32x32x16_bf16 v[20:35], v[36:39], a[48:51], v[20:35]
ds_read_b128 v[36:39], v1 offset:18432
s_waitcnt lgkmcnt(2)
v_mfma_f32_32x32x16_bf16 v[20:35], v[40:43], a[52:55], v[20:35]
ds_read_b128 v[40:43], v1 offset:19456
s_add_u32 m0, s25, 9216
s_add_u32 s20, s20, s38
buffer_load_dwordx4 v8, s[4:7], s20 offen sc1 lds
s_waitcnt lgkmcnt(2)
v_mfma_f32_32x32x16_bf16 v[20:35], v[44:47], a[56:59], v[20:35]
v_mfma_f32_32x32x16_bf16 v[20:35], v[48:51], a[60:63], v[20:35]
ds_read_b128 v[48:51], v1 offset:21504
ds_read_b128 v[44:47], v1 offset:20480
s_waitcnt lgkmcnt(3)
v_mov_b32 v3, s23
v_mfma_f32_32x32x16_bf16 v[20:35], v[36:39], a[64:67], v[20:35]
s_waitcnt lgkmcnt(2)
s_add_u32 m0, s25, 10240
s_add_u32 s20, s20, s38
buffer_load_dwordx4 v8, s[4:7], s20 offen sc1 lds
ds_read_b128 v[36:39], v1 offset:22528
v_mfma_f32_32x32x16_bf16 v[20:35], v[40:43], a[68:71], v[20:35]
ds_read_b128 v[40:43], v1 offset:23552
s_waitcnt lgkmcnt(2)
v_mfma_f32_32x32x16_bf16 v[20:35], v[44:47], a[72:75], v[20:35]
v_mfma_f32_32x32x16_bf16 v[20:35], v[48:51], a[76:79], v[20:35]
s_waitcnt lgkmcnt(0)
ds_read_b128 v[44:47], v1 offset:24576
v_mfma_f32_32x32x16_bf16 v[20:35], v[36:39], a[80:83], v[20:35]
ds_read_b128 v[48:51], v1 offset:25600
s_add_u32 m0, s25, 11264
s_add_u32 s20, s20, s38
buffer_load_dwordx4 v8, s[4:7], s20 offen sc1 lds
v_mfma_f32_32x32x16_bf16 v[20:35], v[40:43], a[84:87], v[20:35]
ds_read_b128 v[36:39], v1 offset:26624
s_waitcnt lgkmcnt(2)
ds_read_b128 v[40:43], v1 offset:27648
v_mfma_f32_32x32x16_bf16 v[20:35], v[44:47], a[88:91], v[20:35]
s_waitcnt lgkmcnt(2)
ds_read_b128 v[44:47], v1 offset:28672
s_add_u32 m0, s35, s37
s_add_u32 s20, s36, s37
buffer_load_dwordx4 v0, s[4:7], s20 offen sc1 lds
v_mfma_f32_32x32x16_bf16 v[20:35], v[48:51], a[92:95], v[20:35]
ds_read_b128 v[48:51], v1 offset:29696
s_waitcnt lgkmcnt(3)
v_mfma_f32_32x32x16_bf16 v[20:35], v[36:39], a[96:99], v[20:35]
s_waitcnt lgkmcnt(1)
ds_read_b128 v[36:39], v1 offset:30720
s_add_u32 m0, s35, 4096
s_add_u32 s20, s36, 4096
buffer_load_dwordx4 v0, s[4:7], s20 offen sc1 lds
v_mfma_f32_32x32x16_bf16 v[20:35], v[40:43], a[100:103], v[20:35]
ds_read_b128 v[40:43], v1 offset:31744
v_mfma_f32_32x32x16_bf16 v[20:35], v[44:47], a[104:107], v[20:35]
s_waitcnt lgkmcnt(2)
s_waitcnt lgkmcnt(1)
v_mfma_f32_32x32x16_bf16 v[20:35], v[48:51], a[108:111], v[20:35]
ds_read_b128 v[44:47], v1 offset:32768
ds_read_b128 v[48:51], v1 offset:33792
v_mfma_f32_32x32x16_bf16 v[20:35], v[36:39], a[112:115], v[20:35]
ds_read_b128 v[36:39], v1 offset:34816
s_waitcnt lgkmcnt(3)
v_mfma_f32_32x32x16_bf16 v[20:35], v[40:43], a[116:119], v[20:35]
s_waitcnt vmcnt(12)
s_barrier
ds_read_b128 v[40:43], v1 offset:35840
s_waitcnt lgkmcnt(3)
v_mfma_f32_32x32x16_bf16 v[20:35], v[44:47], a[120:123], v[20:35]
s_mov_b64 exec, 1
buffer_store_dword v3, off, s[4:7], s22 sc1
s_mov_b64 exec, -1
s_waitcnt lgkmcnt(1)
v_mfma_f32_32x32x16_bf16 v[20:35], v[48:51], a[124:127], v[20:35]
ds_read_b128 v[44:47], v1 offset:36864
s_waitcnt lgkmcnt(1)
ds_read_b128 v[48:51], v1 offset:37888
v_mfma_f32_32x32x16_bf16 v[20:35], v[36:39], a[128:131], v[20:35]
v_mfma_f32_32x32x16_bf16 v[20:35], v[40:43], a[132:135], v[20:35]
s_waitcnt lgkmcnt(1)
ds_read_b128 v[40:43], v1 offset:39936
ds_read_b128 v[36:39], v1 offset:38912
v_mfma_f32_32x32x16_bf16 v[20:35], v[44:47], a[136:139], v[20:35]
s_waitcnt lgkmcnt(2)
v_mfma_f32_32x32x16_bf16 v[20:35], v[48:51], a[140:143], v[20:35]
ds_read_b128 v[44:47], v1 offset:40960
ds_read_b128 v[48:51], v1 offset:41984
s_waitcnt lgkmcnt(2)
v_mfma_f32_32x32x16_bf16 v[20:35], v[36:39], a[144:147], v[20:35]
v_mfma_f32_32x32x16_bf16 v[20:35], v[40:43], a[148:151], v[20:35]
s_waitcnt lgkmcnt(1)
v_mfma_f32_32x32x16_bf16 v[20:35], v[44:47], a[152:155], v[20:35]
s_waitcnt lgkmcnt(0)
v_mfma_f32_32x32x16_bf16 v[20:35], v[48:51], a[156:159], v[20:35]
s_nop 11
v_cvt_pk_bf16_f32 v37, v22, v23
v_cvt_pk_bf16_f32 v36, v20, v21
v_cvt_pk_bf16_f32 v41, v30, v31
v_cvt_pk_bf16_f32 v39, v26, v27
v_cvt_pk_bf16_f32 v42, v32, v33
v_cvt_pk_bf16_f32 v38, v24, v25
v_cvt_pk_bf16_f32 v40, v28, v29
v_cvt_pk_bf16_f32 v43, v34, v35
buffer_store_dwordx4 v[36:39], v6, s[4:7], s50 offen offset:0 sc1
buffer_store_dwordx4 v[40:43], v6, s[4:7], s50 offen offset:512 sc1
s_add_u32 s39, s39, 1
s_add_u32 s50, s50, 524288
s_add_u32 s18, s51, 8192
s_cmp_eq_u32 s13, 0
s_cselect_b32 s22, s18, s6
s_mov_b32 s23, s39
s_cmp_lt_u32 s28, 64
s_cbranch_scc1 kvx_30
s_and_b32 s18, s39, 15
s_cbranch_scc0 kvt_36
s_waitcnt vmcnt(0)
s_barrier
v_mov_b32 v3, s23
s_mov_b64 exec, 1
buffer_store_dword v3, off, s[4:7], s22 sc1
s_mov_b64 exec, -1
s_mov_b32 s22, s6
s_lshl_b32 s18, s39, 2
s_add_u32 s18, s18, 4
s_cmp_lg_u32 s13, 0
s_cbranch_scc1 polld_42
v_lshlrev_b32 v3, 3, v0
v_min_u32 v16, 1152, v3
s_mov_b32 s21, 11550720
s_mov_b32 s17, 0
poll_41:
buffer_load_dword v12, v16, s[4:7], s21 offen sc1
s_add_u32 s17, s17, 1
s_cmp_gt_u32 s17, 262144
s_cbranch_scc1 L_fail
s_waitcnt vmcnt(0)
v_cmp_gt_u32 vcc, s18, v12
s_cbranch_vccz polld_42
s_sleep 2
s_branch poll_41
polld_42:
s_barrier
s_mov_b32 s53, s52
s_mov_b32 s36, s6
s_mov_b32 s38, 256
v_mov_b32 v8, v7
s_add_u32 s52, s52, 40960
s_add_u32 m0, s25, 2048
s_mov_b32 s20, s53
buffer_load_dwordx4 v8, s[4:7], s20 offen sc1 lds
s_add_u32 m0, s25, 3072
s_add_u32 s20, s20, s38
buffer_load_dwordx4 v8, s[4:7], s20 offen sc1 lds
s_add_u32 m0, s25, 4096
s_add_u32 s20, s20, s38
buffer_load_dwordx4 v8, s[4:7], s20 offen sc1 lds
s_add_u32 m0, s25, 5120
s_add_u32 s20, s20, s38
buffer_load_dwordx4 v8, s[4:7], s20 offen sc1 lds
s_add_u32 m0, s25, 6144
s_add_u32 s20, s20, s38
buffer_load_dwordx4 v8, s[4:7], s20 offen sc1 lds
s_add_u32 m0, s25, 7168
s_add_u32 s20, s20, s38
buffer_load_dwordx4 v8, s[4:7], s20 offen sc1 lds
s_add_u32 m0, s25, 8192
s_add_u32 s20, s20, s38
buffer_load_dwordx4 v8, s[4:7], s20 offen sc1 lds
s_add_u32 m0, s25, 9216
s_add_u32 s20, s20, s38
buffer_load_dwordx4 v8, s[4:7], s20 offen sc1 lds
s_add_u32 m0, s25, 10240
s_add_u32 s20, s20, s38
buffer_load_dwordx4 v8, s[4:7], s20 offen sc1 lds
s_add_u32 m0, s25, 11264
s_add_u32 s20, s20, s38
buffer_load_dwordx4 v8, s[4:7], s20 offen sc1 lds
s_waitcnt vmcnt(0)
s_branch kvm_35
kv_34:
s_lshl_b32 s18, s39, 2
s_add_u32 s18, s18, 4
s_cmp_lg_u32 s13, 0
s_cbranch_scc1 polld_44
v_lshlrev_b32 v3, 3, v0
v_min_u32 v16, 1152, v3
s_mov_b32 s21, 11550720
s_mov_b32 s17, 0
poll_43:
buffer_load_dword v12, v16, s[4:7], s21 offen sc1
s_add_u32 s17, s17, 1
s_cmp_gt_u32 s17, 262144
s_cbranch_scc1 L_fail
s_waitcnt vmcnt(0)
v_cmp_gt_u32 vcc, s18, v12
s_cbranch_vccz polld_44
s_sleep 2
s_branch poll_43
polld_44:
s_barrier
s_mov_b32 s53, s52
s_mov_b32 s36, s6
s_mov_b32 s38, 256
v_mov_b32 v8, v7
s_add_u32 s52, s52, 40960
s_branch kvn_31
kvt_36:
s_waitcnt vmcnt(0)
s_barrier
v_mov_b32 v3, s23
s_mov_b64 exec, 1
buffer_store_dword v3, off, s[4:7], s22 sc1
s_mov_b64 exec, -1
s_mov_b32 s22, s6
s_cmp_lg_u32 s16, 0
s_cbranch_scc1 kvz_45
s_cmp_ge_u32 s32, 20
s_cbranch_scc1 kvz_45
s_mov_b32 s55, s34
s_mul_i32 s30, s32, 13108
s_lshr_b32 s30, s30, 16
s_mul_i32 s18, s30, 5
s_sub_u32 s34, s32, s18
s_add_u32 s30, s30, 60
s_add_u32 s54, s32, 15
s_lshl_b32 s18, s34, 2
s_add_u32 s18, s18, s13
s_lshl_b32 s33, s18, 11
v_lshrrev_b32 v12, 9, v0
v_and_b32 v10, 0x1ff, v0
v_lshlrev_b32 v10, 1, v10
v_lshl_add_u32 v10, v12, 4, v10
s_lshl_b32 s18, s34, 7
s_lshl_b32 s19, s13, 5
s_add_u32 s18, s18, s19
s_mov_b32 s19, 0x3acccccd
v_bfe_u32 v202, v0, 4, 5
v_lshrrev_b32 v197, 9, v0
v_add_u32 v202, s18, v202
v_and_b32 v201, 1, v202
v_mul_u32_u24 v201, 160, v201
v_lshrrev_b32 v200, 1, v202
v_add_u32 v200, 1, v200
v_lshlrev_b32 v197, 3, v197
v_mad_u32_u24 v201, v197, v200, v201
v_mad_u32_u24 v196, v200, 16, 0
v_cvt_f32_u32 v196, v196
v_mul_f32 v202, s19, v196
v_rndne_f32 v202, v202
v_fmac_f32 v196, 0xc4200000, v202
v_mul_f32 v196, s19, v196
v_cos_f32 v196, v196
s_nop 0
v_add_f32 v196, v196, v196
v_mad_u32_u24 v198, v200, 1, 0
v_cvt_f32_u32 v198, v198
v_mul_f32 v202, s19, v198
v_rndne_f32 v202, v202
v_fmac_f32 v198, 0xc4200000, v202
v_mul_f32 v198, s19, v198
v_cos_f32 v198, v198
s_nop 0
v_add_f32 v198, v198, v198
v_mad_u32_u24 v183, v200, 3, v201
v_cvt_f32_u32 v183, v183
v_mul_f32 v202, s19, v183
v_rndne_f32 v202, v202
v_fmac_f32 v183, 0xc4200000, v202
v_mul_f32 v183, s19, v183
v_cos_f32 v183, v183
v_mad_u32_u24 v184, v200, 4, v201
v_cvt_f32_u32 v184, v184
v_mul_f32 v202, s19, v184
v_rndne_f32 v202, v202
v_fmac_f32 v184, 0xc4200000, v202
v_mul_f32 v184, s19, v184
v_cos_f32 v184, v184
s_nop 0
v_fma_f32 v185, v198, v184, -v183
v_fma_f32 v182, v198, v183, -v184
v_fma_f32 v186, v198, v185, -v184
v_fma_f32 v181, v198, v182, -v183
v_fma_f32 v187, v198, v186, -v185
v_fma_f32 v180, v198, v181, -v182
v_cvt_pk_bf16_f32 v20, v180, v181
v_cvt_pk_bf16_f32 v21, v182, v183
v_cvt_pk_bf16_f32 v22, v184, v185
v_cvt_pk_bf16_f32 v23, v186, v187
v_mad_u32_u24 v191, v200, 19, v201
v_cvt_f32_u32 v191, v191
v_mul_f32 v202, s19, v191
v_rndne_f32 v202, v202
v_fmac_f32 v191, 0xc4200000, v202
v_mul_f32 v191, s19, v191
v_cos_f32 v191, v191
v_mad_u32_u24 v192, v200, 20, v201
v_cvt_f32_u32 v192, v192
v_mul_f32 v202, s19, v192
v_rndne_f32 v202, v202
v_fmac_f32 v192, 0xc4200000, v202
v_mul_f32 v192, s19, v192
v_cos_f32 v192, v192
s_nop 0
v_fma_f32 v193, v198, v192, -v191
v_fma_f32 v190, v198, v191, -v192
v_fma_f32 v194, v198, v193, -v192
v_fma_f32 v189, v198, v190, -v191
v_fma_f32 v195, v198, v194, -v193
v_fma_f32 v188, v198, v189, -v190
v_cvt_pk_bf16_f32 v24, v188, v189
v_cvt_pk_bf16_f32 v25, v190, v191
v_cvt_pk_bf16_f32 v26, v192, v193
v_cvt_pk_bf16_f32 v27, v194, v195
v_pk_fma_f32 v[180:181], v[196:197], v[188:189], v[180:181] op_sel_hi:[0,1,1] neg_lo:[0,0,1] neg_hi:[0,0,1]
v_pk_fma_f32 v[182:183], v[196:197], v[190:191], v[182:183] op_sel_hi:[0,1,1] neg_lo:[0,0,1] neg_hi:[0,0,1]
v_pk_fma_f32 v[184:185], v[196:197], v[192:193], v[184:185] op_sel_hi:[0,1,1] neg_lo:[0,0,1] neg_hi:[0,0,1]
v_pk_fma_f32 v[186:187], v[196:197], v[194:195], v[186:187] op_sel_hi:[0,1,1] neg_lo:[0,0,1] neg_hi:[0,0,1]
v_cvt_pk_bf16_f32 v28, v180, v181
v_cvt_pk_bf16_f32 v29, v182, v183
v_cvt_pk_bf16_f32 v30, v184, v185
v_cvt_pk_bf16_f32 v31, v186, v187
v_pk_fma_f32 v[188:189], v[196:197], v[180:181], v[188:189] op_sel_hi:[0,1,1] neg_lo:[0,0,1] neg_hi:[0,0,1]
v_pk_fma_f32 v[190:191], v[196:197], v[182:183], v[190:191] op_sel_hi:[0,1,1] neg_lo:[0,0,1] neg_hi:[0,0,1]
v_pk_fma_f32 v[192:193], v[196:197], v[184:185], v[192:193] op_sel_hi:[0,1,1] neg_lo:[0,0,1] neg_hi:[0,0,1]
v_pk_fma_f32 v[194:195], v[196:197], v[186:187], v[194:195] op_sel_hi:[0,1,1] neg_lo:[0,0,1] neg_hi:[0,0,1]
v_cvt_pk_bf16_f32 v32, v188, v189
v_cvt_pk_bf16_f32 v33, v190, v191
v_cvt_pk_bf16_f32 v34, v192, v193
v_cvt_pk_bf16_f32 v35, v194, v195
v_pk_fma_f32 v[180:181], v[196:197], v[188:189], v[180:181] op_sel_hi:[0,1,1] neg_lo:[0,0,1] neg_hi:[0,0,1]
v_pk_fma_f32 v[182:183], v[196:197], v[190:191], v[182:183] op_sel_hi:[0,1,1] neg_lo:[0,0,1] neg_hi:[0,0,1]
v_pk_fma_f32 v[184:185], v[196:197], v[192:193], v[184:185] op_sel_hi:[0,1,1] neg_lo:[0,0,1] neg_hi:[0,0,1]
v_pk_fma_f32 v[186:187], v[196:197], v[194:195], v[186:187] op_sel_hi:[0,1,1] neg_lo:[0,0,1] neg_hi:[0,0,1]
v_cvt_pk_bf16_f32 v36, v180, v181
v_cvt_pk_bf16_f32 v37, v182, v183
v_cvt_pk_bf16_f32 v38, v184, v185
v_cvt_pk_bf16_f32 v39, v186, v187
v_pk_fma_f32 v[188:189], v[196:197], v[180:181], v[188:189] op_sel_hi:[0,1,1] neg_lo:[0,0,1] neg_hi:[0,0,1]
v_pk_fma_f32 v[190:191], v[196:197], v[182:183], v[190:191] op_sel_hi:[0,1,1] neg_lo:[0,0,1] neg_hi:[0,0,1]
v_pk_fma_f32 v[192:193], v[196:197], v[184:185], v[192:193] op_sel_hi:[0,1,1] neg_lo:[0,0,1] neg_hi:[0,0,1]
v_pk_fma_f32 v[194:195], v[196:197], v[186:187], v[194:195] op_sel_hi:[0,1,1] neg_lo:[0,0,1] neg_hi:[0,0,1]
v_cvt_pk_bf16_f32 v40, v188, v189
v_cvt_pk_bf16_f32 v41, v190, v191
v_cvt_pk_bf16_f32 v42, v192, v193
v_cvt_pk_bf16_f32 v43, v194, v195
v_pk_fma_f32 v[180:181], v[196:197], v[188:189], v[180:181] op_sel_hi:[0,1,1] neg_lo:[0,0,1] neg_hi:[0,0,1]
v_pk_fma_f32 v[182:183], v[196:197], v[190:191], v[182:183] op_sel_hi:[0,1,1] neg_lo:[0,0,1] neg_hi:[0,0,1]
v_pk_fma_f32 v[184:185], v[196:197], v[192:193], v[184:185] op_sel_hi:[0,1,1] neg_lo:[0,0,1] neg_hi:[0,0,1]
v_pk_fma_f32 v[186:187], v[196:197], v[194:195], v[186:187] op_sel_hi:[0,1,1] neg_lo:[0,0,1] neg_hi:[0,0,1]
v_cvt_pk_bf16_f32 v44, v180, v181
v_cvt_pk_bf16_f32 v45, v182, v183
v_cvt_pk_bf16_f32 v46, v184, v185
v_cvt_pk_bf16_f32 v47, v186, v187
v_pk_fma_f32 v[188:189], v[196:197], v[180:181], v[188:189] op_sel_hi:[0,1,1] neg_lo:[0,0,1] neg_hi:[0,0,1]
v_pk_fma_f32 v[190:191], v[196:197], v[182:183], v[190:191] op_sel_hi:[0,1,1] neg_lo:[0,0,1] neg_hi:[0,0,1]
v_pk_fma_f32 v[192:193], v[196:197], v[184:185], v[192:193] op_sel_hi:[0,1,1] neg_lo:[0,0,1] neg_hi:[0,0,1]
v_pk_fma_f32 v[194:195], v[196:197], v[186:187], v[194:195] op_sel_hi:[0,1,1] neg_lo:[0,0,1] neg_hi:[0,0,1]
v_cvt_pk_bf16_f32 v48, v188, v189
v_cvt_pk_bf16_f32 v49, v190, v191
v_cvt_pk_bf16_f32 v50, v192, v193
v_cvt_pk_bf16_f32 v51, v194, v195
v_pk_fma_f32 v[180:181], v[196:197], v[188:189], v[180:181] op_sel_hi:[0,1,1] neg_lo:[0,0,1] neg_hi:[0,0,1]
v_pk_fma_f32 v[182:183], v[196:197], v[190:191], v[182:183] op_sel_hi:[0,1,1] neg_lo:[0,0,1] neg_hi:[0,0,1]
v_pk_fma_f32 v[184:185], v[196:197], v[192:193], v[184:185] op_sel_hi:[0,1,1] neg_lo:[0,0,1] neg_hi:[0,0,1]
v_pk_fma_f32 v[186:187], v[196:197], v[194:195], v[186:187] op_sel_hi:[0,1,1] neg_lo:[0,0,1] neg_hi:[0,0,1]
v_cvt_pk_bf16_f32 v52, v180, v181
v_cvt_pk_bf16_f32 v53, v182, v183
v_cvt_pk_bf16_f32 v54, v184, v185
v_cvt_pk_bf16_f32 v55, v186, v187
v_pk_fma_f32 v[188:189], v[196:197], v[180:181], v[188:189] op_sel_hi:[0,1,1] neg_lo:[0,0,1] neg_hi:[0,0,1]
v_pk_fma_f32 v[190:191], v[196:197], v[182:183], v[190:191] op_sel_hi:[0,1,1] neg_lo:[0,0,1] neg_hi:[0,0,1]
v_pk_fma_f32 v[192:193], v[196:197], v[184:185], v[192:193] op_sel_hi:[0,1,1] neg_lo:[0,0,1] neg_hi:[0,0,1]
v_pk_fma_f32 v[194:195], v[196:197], v[186:187], v[194:195] op_sel_hi:[0,1,1] neg_lo:[0,0,1] neg_hi:[0,0,1]
v_cvt_pk_bf16_f32 v56, v188, v189
v_cvt_pk_bf16_f32 v57, v190, v191
v_cvt_pk_bf16_f32 v58, v192, v193
v_cvt_pk_bf16_f32 v59, v194, v195
v_pk_fma_f32 v[180:181], v[196:197], v[188:189], v[180:181] op_sel_hi:[0,1,1] neg_lo:[0,0,1] neg_hi:[0,0,1]
v_pk_fma_f32 v[182:183], v[196:197], v[190:191], v[182:183] op_sel_hi:[0,1,1] neg_lo:[0,0,1] neg_hi:[0,0,1]
v_pk_fma_f32 v[184:185], v[196:197], v[192:193], v[184:185] op_sel_hi:[0,1,1] neg_lo:[0,0,1] neg_hi:[0,0,1]
v_pk_fma_f32 v[186:187], v[196:197], v[194:195], v[186:187] op_sel_hi:[0,1,1] neg_lo:[0,0,1] neg_hi:[0,0,1]
v_cvt_pk_bf16_f32 v60, v180, v181
v_cvt_pk_bf16_f32 v61, v182, v183
v_cvt_pk_bf16_f32 v62, v184, v185
v_cvt_pk_bf16_f32 v63, v186, v187
v_pk_fma_f32 v[188:189], v[196:197], v[180:181], v[188:189] op_sel_hi:[0,1,1] neg_lo:[0,0,1] neg_hi:[0,0,1]
v_pk_fma_f32 v[190:191], v[196:197], v[182:183], v[190:191] op_sel_hi:[0,1,1] neg_lo:[0,0,1] neg_hi:[0,0,1]
v_pk_fma_f32 v[192:193], v[196:197], v[184:185], v[192:193] op_sel_hi:[0,1,1] neg_lo:[0,0,1] neg_hi:[0,0,1]
v_pk_fma_f32 v[194:195], v[196:197], v[186:187], v[194:195] op_sel_hi:[0,1,1] neg_lo:[0,0,1] neg_hi:[0,0,1]
v_cvt_pk_bf16_f32 v64, v188, v189
v_cvt_pk_bf16_f32 v65, v190, v191
v_cvt_pk_bf16_f32 v66, v192, v193
v_cvt_pk_bf16_f32 v67, v194, v195
v_pk_fma_f32 v[180:181], v[196:197], v[188:189], v[180:181] op_sel_hi:[0,1,1] neg_lo:[0,0,1] neg_hi:[0,0,1]
v_pk_fma_f32 v[182:183], v[196:197], v[190:191], v[182:183] op_sel_hi:[0,1,1] neg_lo:[0,0,1] neg_hi:[0,0,1]
v_pk_fma_f32 v[184:185], v[196:197], v[192:193], v[184:185] op_sel_hi:[0,1,1] neg_lo:[0,0,1] neg_hi:[0,0,1]
v_pk_fma_f32 v[186:187], v[196:197], v[194:195], v[186:187] op_sel_hi:[0,1,1] neg_lo:[0,0,1] neg_hi:[0,0,1]
v_cvt_pk_bf16_f32 v68, v180, v181
v_cvt_pk_bf16_f32 v69, v182, v183
v_cvt_pk_bf16_f32 v70, v184, v185
v_cvt_pk_bf16_f32 v71, v186, v187
v_pk_fma_f32 v[188:189], v[196:197], v[180:181], v[188:189] op_sel_hi:[0,1,1] neg_lo:[0,0,1] neg_hi:[0,0,1]
v_pk_fma_f32 v[190:191], v[196:197], v[182:183], v[190:191] op_sel_hi:[0,1,1] neg_lo:[0,0,1] neg_hi:[0,0,1]
v_pk_fma_f32 v[192:193], v[196:197], v[184:185], v[192:193] op_sel_hi:[0,1,1] neg_lo:[0,0,1] neg_hi:[0,0,1]
v_pk_fma_f32 v[194:195], v[196:197], v[186:187], v[194:195] op_sel_hi:[0,1,1] neg_lo:[0,0,1] neg_hi:[0,0,1]
v_cvt_pk_bf16_f32 v72, v188, v189
v_cvt_pk_bf16_f32 v73, v190, v191
v_cvt_pk_bf16_f32 v74, v192, v193
v_cvt_pk_bf16_f32 v75, v194, v195
v_pk_fma_f32 v[180:181], v[196:197], v[188:189], v[180:181] op_sel_hi:[0,1,1] neg_lo:[0,0,1] neg_hi:[0,0,1]
v_pk_fma_f32 v[182:183], v[196:197], v[190:191], v[182:183] op_sel_hi:[0,1,1] neg_lo:[0,0,1] neg_hi:[0,0,1]
v_pk_fma_f32 v[184:185], v[196:197], v[192:193], v[184:185] op_sel_hi:[0,1,1] neg_lo:[0,0,1] neg_hi:[0,0,1]
v_pk_fma_f32 v[186:187], v[196:197], v[194:195], v[186:187] op_sel_hi:[0,1,1] neg_lo:[0,0,1] neg_hi:[0,0,1]
v_cvt_pk_bf16_f32 v76, v180, v181
v_cvt_pk_bf16_f32 v77, v182, v183
v_cvt_pk_bf16_f32 v78, v184, v185
v_cvt_pk_bf16_f32 v79, v186, v187
v_pk_fma_f32 v[188:189], v[196:197], v[180:181], v[188:189] op_sel_hi:[0,1,1] neg_lo:[0,0,1] neg_hi:[0,0,1]
v_pk_fma_f32 v[190:191], v[196:197], v[182:183], v[190:191] op_sel_hi:[0,1,1] neg_lo:[0,0,1] neg_hi:[0,0,1]
v_pk_fma_f32 v[192:193], v[196:197], v[184:185], v[192:193] op_sel_hi:[0,1,1] neg_lo:[0,0,1] neg_hi:[0,0,1]
v_pk_fma_f32 v[194:195], v[196:197], v[186:187], v[194:195] op_sel_hi:[0,1,1] neg_lo:[0,0,1] neg_hi:[0,0,1]
v_cvt_pk_bf16_f32 v80, v188, v189
v_cvt_pk_bf16_f32 v81, v190, v191
v_cvt_pk_bf16_f32 v82, v192, v193
v_cvt_pk_bf16_f32 v83, v194, v195
v_pk_fma_f32 v[180:181], v[196:197], v[188:189], v[180:181] op_sel_hi:[0,1,1] neg_lo:[0,0,1] neg_hi:[0,0,1]
v_pk_fma_f32 v[182:183], v[196:197], v[190:191], v[182:183] op_sel_hi:[0,1,1] neg_lo:[0,0,1] neg_hi:[0,0,1]
v_pk_fma_f32 v[184:185], v[196:197], v[192:193], v[184:185] op_sel_hi:[0,1,1] neg_lo:[0,0,1] neg_hi:[0,0,1]
v_pk_fma_f32 v[186:187], v[196:197], v[194:195], v[186:187] op_sel_hi:[0,1,1] neg_lo:[0,0,1] neg_hi:[0,0,1]
v_cvt_pk_bf16_f32 v84, v180, v181
v_cvt_pk_bf16_f32 v85, v182, v183
v_cvt_pk_bf16_f32 v86, v184, v185
v_cvt_pk_bf16_f32 v87, v186, v187
v_pk_fma_f32 v[188:189], v[196:197], v[180:181], v[188:189] op_sel_hi:[0,1,1] neg_lo:[0,0,1] neg_hi:[0,0,1]
v_pk_fma_f32 v[190:191], v[196:197], v[182:183], v[190:191] op_sel_hi:[0,1,1] neg_lo:[0,0,1] neg_hi:[0,0,1]
v_pk_fma_f32 v[192:193], v[196:197], v[184:185], v[192:193] op_sel_hi:[0,1,1] neg_lo:[0,0,1] neg_hi:[0,0,1]
v_pk_fma_f32 v[194:195], v[196:197], v[186:187], v[194:195] op_sel_hi:[0,1,1] neg_lo:[0,0,1] neg_hi:[0,0,1]
v_cvt_pk_bf16_f32 v88, v188, v189
v_cvt_pk_bf16_f32 v89, v190, v191
v_cvt_pk_bf16_f32 v90, v192, v193
v_cvt_pk_bf16_f32 v91, v194, v195
v_pk_fma_f32 v[180:181], v[196:197], v[188:189], v[180:181] op_sel_hi:[0,1,1] neg_lo:[0,0,1] neg_hi:[0,0,1]
v_pk_fma_f32 v[182:183], v[196:197], v[190:191], v[182:183] op_sel_hi:[0,1,1] neg_lo:[0,0,1] neg_hi:[0,0,1]
v_pk_fma_f32 v[184:185], v[196:197], v[192:193], v[184:185] op_sel_hi:[0,1,1] neg_lo:[0,0,1] neg_hi:[0,0,1]
v_pk_fma_f32 v[186:187], v[196:197], v[194:195], v[186:187] op_sel_hi:[0,1,1] neg_lo:[0,0,1] neg_hi:[0,0,1]
v_cvt_pk_bf16_f32 v92, v180, v181
v_cvt_pk_bf16_f32 v93, v182, v183
v_cvt_pk_bf16_f32 v94, v184, v185
v_cvt_pk_bf16_f32 v95, v186, v187
v_pk_fma_f32 v[188:189], v[196:197], v[180:181], v[188:189] op_sel_hi:[0,1,1] neg_lo:[0,0,1] neg_hi:[0,0,1]
v_pk_fma_f32 v[190:191], v[196:197], v[182:183], v[190:191] op_sel_hi:[0,1,1] neg_lo:[0,0,1] neg_hi:[0,0,1]
v_pk_fma_f32 v[192:193], v[196:197], v[184:185], v[192:193] op_sel_hi:[0,1,1] neg_lo:[0,0,1] neg_hi:[0,0,1]
v_pk_fma_f32 v[194:195], v[196:197], v[186:187], v[194:195] op_sel_hi:[0,1,1] neg_lo:[0,0,1] neg_hi:[0,0,1]
v_cvt_pk_bf16_f32 v96, v188, v189
v_cvt_pk_bf16_f32 v97, v190, v191
v_cvt_pk_bf16_f32 v98, v192, v193
v_cvt_pk_bf16_f32 v99, v194, v195
s_mov_b32 s20, 323
v_mad_u32_u24 v183, v200, s20, v201
v_cvt_f32_u32 v183, v183
v_mul_f32 v202, s19, v183
v_rndne_f32 v202, v202
v_fmac_f32 v183, 0xc4200000, v202
v_mul_f32 v183, s19, v183
v_cos_f32 v183, v183
s_mov_b32 s20, 324
v_mad_u32_u24 v184, v200, s20, v201
v_cvt_f32_u32 v184, v184
v_mul_f32 v202, s19, v184
v_rndne_f32 v202, v202
v_fmac_f32 v184, 0xc4200000, v202
v_mul_f32 v184, s19, v184
v_cos_f32 v184, v184
s_nop 0
v_fma_f32 v185, v198, v184, -v183
v_fma_f32 v182, v198, v183, -v184
v_fma_f32 v186, v198, v185, -v184
v_fma_f32 v181, v198, v182, -v183
v_fma_f32 v187, v198, v186, -v185
v_fma_f32 v180, v198, v181, -v182
v_cvt_pk_bf16_f32 v100, v180, v181
v_cvt_pk_bf16_f32 v101, v182, v183
v_cvt_pk_bf16_f32 v102, v184, v185
v_cvt_pk_bf16_f32 v103, v186, v187
s_mov_b32 s20, 339
v_mad_u32_u24 v191, v200, s20, v201
v_cvt_f32_u32 v191, v191
v_mul_f32 v202, s19, v191
v_rndne_f32 v202, v202
v_fmac_f32 v191, 0xc4200000, v202
v_mul_f32 v191, s19, v191
v_cos_f32 v191, v191
s_mov_b32 s20, 340
v_mad_u32_u24 v192, v200, s20, v201
v_cvt_f32_u32 v192, v192
v_mul_f32 v202, s19, v192
v_rndne_f32 v202, v202
v_fmac_f32 v192, 0xc4200000, v202
v_mul_f32 v192, s19, v192
v_cos_f32 v192, v192
s_nop 0
v_fma_f32 v193, v198, v192, -v191
v_fma_f32 v190, v198, v191, -v192
v_fma_f32 v194, v198, v193, -v192
v_fma_f32 v189, v198, v190, -v191
v_fma_f32 v195, v198, v194, -v193
v_fma_f32 v188, v198, v189, -v190
v_cvt_pk_bf16_f32 v104, v188, v189
v_cvt_pk_bf16_f32 v105, v190, v191
v_cvt_pk_bf16_f32 v106, v192, v193
v_cvt_pk_bf16_f32 v107, v194, v195
v_pk_fma_f32 v[180:181], v[196:197], v[188:189], v[180:181] op_sel_hi:[0,1,1] neg_lo:[0,0,1] neg_hi:[0,0,1]
v_pk_fma_f32 v[182:183], v[196:197], v[190:191], v[182:183] op_sel_hi:[0,1,1] neg_lo:[0,0,1] neg_hi:[0,0,1]
v_pk_fma_f32 v[184:185], v[196:197], v[192:193], v[184:185] op_sel_hi:[0,1,1] neg_lo:[0,0,1] neg_hi:[0,0,1]
v_pk_fma_f32 v[186:187], v[196:197], v[194:195], v[186:187] op_sel_hi:[0,1,1] neg_lo:[0,0,1] neg_hi:[0,0,1]
v_cvt_pk_bf16_f32 v108, v180, v181
v_cvt_pk_bf16_f32 v109, v182, v183
v_cvt_pk_bf16_f32 v110, v184, v185
v_cvt_pk_bf16_f32 v111, v186, v187
v_pk_fma_f32 v[188:189], v[196:197], v[180:181], v[188:189] op_sel_hi:[0,1,1] neg_lo:[0,0,1] neg_hi:[0,0,1]
v_pk_fma_f32 v[190:191], v[196:197], v[182:183], v[190:191] op_sel_hi:[0,1,1] neg_lo:[0,0,1] neg_hi:[0,0,1]
v_pk_fma_f32 v[192:193], v[196:197], v[184:185], v[192:193] op_sel_hi:[0,1,1] neg_lo:[0,0,1] neg_hi:[0,0,1]
v_pk_fma_f32 v[194:195], v[196:197], v[186:187], v[194:195] op_sel_hi:[0,1,1] neg_lo:[0,0,1] neg_hi:[0,0,1]
v_cvt_pk_bf16_f32 v112, v188, v189
v_cvt_pk_bf16_f32 v113, v190, v191
v_cvt_pk_bf16_f32 v114, v192, v193
v_cvt_pk_bf16_f32 v115, v194, v195
v_pk_fma_f32 v[180:181], v[196:197], v[188:189], v[180:181] op_sel_hi:[0,1,1] neg_lo:[0,0,1] neg_hi:[0,0,1]
v_pk_fma_f32 v[182:183], v[196:197], v[190:191], v[182:183] op_sel_hi:[0,1,1] neg_lo:[0,0,1] neg_hi:[0,0,1]
v_pk_fma_f32 v[184:185], v[196:197], v[192:193], v[184:185] op_sel_hi:[0,1,1] neg_lo:[0,0,1] neg_hi:[0,0,1]
v_pk_fma_f32 v[186:187], v[196:197], v[194:195], v[186:187] op_sel_hi:[0,1,1] neg_lo:[0,0,1] neg_hi:[0,0,1]
v_cvt_pk_bf16_f32 v116, v180, v181
v_cvt_pk_bf16_f32 v117, v182, v183
v_cvt_pk_bf16_f32 v118, v184, v185
v_cvt_pk_bf16_f32 v119, v186, v187
v_pk_fma_f32 v[188:189], v[196:197], v[180:181], v[188:189] op_sel_hi:[0,1,1] neg_lo:[0,0,1] neg_hi:[0,0,1]
v_pk_fma_f32 v[190:191], v[196:197], v[182:183], v[190:191] op_sel_hi:[0,1,1] neg_lo:[0,0,1] neg_hi:[0,0,1]
v_pk_fma_f32 v[192:193], v[196:197], v[184:185], v[192:193] op_sel_hi:[0,1,1] neg_lo:[0,0,1] neg_hi:[0,0,1]
v_pk_fma_f32 v[194:195], v[196:197], v[186:187], v[194:195] op_sel_hi:[0,1,1] neg_lo:[0,0,1] neg_hi:[0,0,1]
v_cvt_pk_bf16_f32 v120, v188, v189
v_cvt_pk_bf16_f32 v121, v190, v191
v_cvt_pk_bf16_f32 v122, v192, v193
v_cvt_pk_bf16_f32 v123, v194, v195
v_pk_fma_f32 v[180:181], v[196:197], v[188:189], v[180:181] op_sel_hi:[0,1,1] neg_lo:[0,0,1] neg_hi:[0,0,1]
v_pk_fma_f32 v[182:183], v[196:197], v[190:191], v[182:183] op_sel_hi:[0,1,1] neg_lo:[0,0,1] neg_hi:[0,0,1]
v_pk_fma_f32 v[184:185], v[196:197], v[192:193], v[184:185] op_sel_hi:[0,1,1] neg_lo:[0,0,1] neg_hi:[0,0,1]
v_pk_fma_f32 v[186:187], v[196:197], v[194:195], v[186:187] op_sel_hi:[0,1,1] neg_lo:[0,0,1] neg_hi:[0,0,1]
v_cvt_pk_bf16_f32 v124, v180, v181
v_cvt_pk_bf16_f32 v125, v182, v183
v_cvt_pk_bf16_f32 v126, v184, v185
v_cvt_pk_bf16_f32 v127, v186, v187
v_pk_fma_f32 v[188:189], v[196:197], v[180:181], v[188:189] op_sel_hi:[0,1,1] neg_lo:[0,0,1] neg_hi:[0,0,1]
v_pk_fma_f32 v[190:191], v[196:197], v[182:183], v[190:191] op_sel_hi:[0,1,1] neg_lo:[0,0,1] neg_hi:[0,0,1]
v_pk_fma_f32 v[192:193], v[196:197], v[184:185], v[192:193] op_sel_hi:[0,1,1] neg_lo:[0,0,1] neg_hi:[0,0,1]
v_pk_fma_f32 v[194:195], v[196:197], v[186:187], v[194:195] op_sel_hi:[0,1,1] neg_lo:[0,0,1] neg_hi:[0,0,1]
v_cvt_pk_bf16_f32 v128, v188, v189
v_cvt_pk_bf16_f32 v129, v190, v191
v_cvt_pk_bf16_f32 v130, v192, v193
v_cvt_pk_bf16_f32 v131, v194, v195
v_pk_fma_f32 v[180:181], v[196:197], v[188:189], v[180:181] op_sel_hi:[0,1,1] neg_lo:[0,0,1] neg_hi:[0,0,1]
v_pk_fma_f32 v[182:183], v[196:197], v[190:191], v[182:183] op_sel_hi:[0,1,1] neg_lo:[0,0,1] neg_hi:[0,0,1]
v_pk_fma_f32 v[184:185], v[196:197], v[192:193], v[184:185] op_sel_hi:[0,1,1] neg_lo:[0,0,1] neg_hi:[0,0,1]
v_pk_fma_f32 v[186:187], v[196:197], v[194:195], v[186:187] op_sel_hi:[0,1,1] neg_lo:[0,0,1] neg_hi:[0,0,1]
v_cvt_pk_bf16_f32 v132, v180, v181
v_cvt_pk_bf16_f32 v133, v182, v183
v_cvt_pk_bf16_f32 v134, v184, v185
v_cvt_pk_bf16_f32 v135, v186, v187
v_pk_fma_f32 v[188:189], v[196:197], v[180:181], v[188:189] op_sel_hi:[0,1,1] neg_lo:[0,0,1] neg_hi:[0,0,1]
v_pk_fma_f32 v[190:191], v[196:197], v[182:183], v[190:191] op_sel_hi:[0,1,1] neg_lo:[0,0,1] neg_hi:[0,0,1]
v_pk_fma_f32 v[192:193], v[196:197], v[184:185], v[192:193] op_sel_hi:[0,1,1] neg_lo:[0,0,1] neg_hi:[0,0,1]
v_pk_fma_f32 v[194:195], v[196:197], v[186:187], v[194:195] op_sel_hi:[0,1,1] neg_lo:[0,0,1] neg_hi:[0,0,1]
v_cvt_pk_bf16_f32 v136, v188, v189
v_cvt_pk_bf16_f32 v137, v190, v191
v_cvt_pk_bf16_f32 v138, v192, v193
v_cvt_pk_bf16_f32 v139, v194, v195
v_pk_fma_f32 v[180:181], v[196:197], v[188:189], v[180:181] op_sel_hi:[0,1,1] neg_lo:[0,0,1] neg_hi:[0,0,1]
v_pk_fma_f32 v[182:183], v[196:197], v[190:191], v[182:183] op_sel_hi:[0,1,1] neg_lo:[0,0,1] neg_hi:[0,0,1]
v_pk_fma_f32 v[184:185], v[196:197], v[192:193], v[184:185] op_sel_hi:[0,1,1] neg_lo:[0,0,1] neg_hi:[0,0,1]
v_pk_fma_f32 v[186:187], v[196:197], v[194:195], v[186:187] op_sel_hi:[0,1,1] neg_lo:[0,0,1] neg_hi:[0,0,1]
v_cvt_pk_bf16_f32 v140, v180, v181
v_cvt_pk_bf16_f32 v141, v182, v183
v_cvt_pk_bf16_f32 v142, v184, v185
v_cvt_pk_bf16_f32 v143, v186, v187
v_pk_fma_f32 v[188:189], v[196:197], v[180:181], v[188:189] op_sel_hi:[0,1,1] neg_lo:[0,0,1] neg_hi:[0,0,1]
v_pk_fma_f32 v[190:191], v[196:197], v[182:183], v[190:191] op_sel_hi:[0,1,1] neg_lo:[0,0,1] neg_hi:[0,0,1]
v_pk_fma_f32 v[192:193], v[196:197], v[184:185], v[192:193] op_sel_hi:[0,1,1] neg_lo:[0,0,1] neg_hi:[0,0,1]
v_pk_fma_f32 v[194:195], v[196:197], v[186:187], v[194:195] op_sel_hi:[0,1,1] neg_lo:[0,0,1] neg_hi:[0,0,1]
v_cvt_pk_bf16_f32 v144, v188, v189
v_cvt_pk_bf16_f32 v145, v190, v191
v_cvt_pk_bf16_f32 v146, v192, v193
v_cvt_pk_bf16_f32 v147, v194, v195
v_pk_fma_f32 v[180:181], v[196:197], v[188:189], v[180:181] op_sel_hi:[0,1,1] neg_lo:[0,0,1] neg_hi:[0,0,1]
v_pk_fma_f32 v[182:183], v[196:197], v[190:191], v[182:183] op_sel_hi:[0,1,1] neg_lo:[0,0,1] neg_hi:[0,0,1]
v_pk_fma_f32 v[184:185], v[196:197], v[192:193], v[184:185] op_sel_hi:[0,1,1] neg_lo:[0,0,1] neg_hi:[0,0,1]
v_pk_fma_f32 v[186:187], v[196:197], v[194:195], v[186:187] op_sel_hi:[0,1,1] neg_lo:[0,0,1] neg_hi:[0,0,1]
v_cvt_pk_bf16_f32 v148, v180, v181
v_cvt_pk_bf16_f32 v149, v182, v183
v_cvt_pk_bf16_f32 v150, v184, v185
v_cvt_pk_bf16_f32 v151, v186, v187
v_pk_fma_f32 v[188:189], v[196:197], v[180:181], v[188:189] op_sel_hi:[0,1,1] neg_lo:[0,0,1] neg_hi:[0,0,1]
v_pk_fma_f32 v[190:191], v[196:197], v[182:183], v[190:191] op_sel_hi:[0,1,1] neg_lo:[0,0,1] neg_hi:[0,0,1]
v_pk_fma_f32 v[192:193], v[196:197], v[184:185], v[192:193] op_sel_hi:[0,1,1] neg_lo:[0,0,1] neg_hi:[0,0,1]
v_pk_fma_f32 v[194:195], v[196:197], v[186:187], v[194:195] op_sel_hi:[0,1,1] neg_lo:[0,0,1] neg_hi:[0,0,1]
v_cvt_pk_bf16_f32 v152, v188, v189
v_cvt_pk_bf16_f32 v153, v190, v191
v_cvt_pk_bf16_f32 v154, v192, v193
v_cvt_pk_bf16_f32 v155, v194, v195
v_pk_fma_f32 v[180:181], v[196:197], v[188:189], v[180:181] op_sel_hi:[0,1,1] neg_lo:[0,0,1] neg_hi:[0,0,1]
v_pk_fma_f32 v[182:183], v[196:197], v[190:191], v[182:183] op_sel_hi:[0,1,1] neg_lo:[0,0,1] neg_hi:[0,0,1]
v_pk_fma_f32 v[184:185], v[196:197], v[192:193], v[184:185] op_sel_hi:[0,1,1] neg_lo:[0,0,1] neg_hi:[0,0,1]
v_pk_fma_f32 v[186:187], v[196:197], v[194:195], v[186:187] op_sel_hi:[0,1,1] neg_lo:[0,0,1] neg_hi:[0,0,1]
v_cvt_pk_bf16_f32 v156, v180, v181
v_cvt_pk_bf16_f32 v157, v182, v183
v_cvt_pk_bf16_f32 v158, v184, v185
v_cvt_pk_bf16_f32 v159, v186, v187
v_pk_fma_f32 v[188:189], v[196:197], v[180:181], v[188:189] op_sel_hi:[0,1,1] neg_lo:[0,0,1] neg_hi:[0,0,1]
v_pk_fma_f32 v[190:191], v[196:197], v[182:183], v[190:191] op_sel_hi:[0,1,1] neg_lo:[0,0,1] neg_hi:[0,0,1]
v_pk_fma_f32 v[192:193], v[196:197], v[184:185], v[192:193] op_sel_hi:[0,1,1] neg_lo:[0,0,1] neg_hi:[0,0,1]
v_pk_fma_f32 v[194:195], v[196:197], v[186:187], v[194:195] op_sel_hi:[0,1,1] neg_lo:[0,0,1] neg_hi:[0,0,1]
v_cvt_pk_bf16_f32 v160, v188, v189
v_cvt_pk_bf16_f32 v161, v190, v191
v_cvt_pk_bf16_f32 v162, v192, v193
v_cvt_pk_bf16_f32 v163, v194, v195
v_pk_fma_f32 v[180:181], v[196:197], v[188:189], v[180:181] op_sel_hi:[0,1,1] neg_lo:[0,0,1] neg_hi:[0,0,1]
v_pk_fma_f32 v[182:183], v[196:197], v[190:191], v[182:183] op_sel_hi:[0,1,1] neg_lo:[0,0,1] neg_hi:[0,0,1]
v_pk_fma_f32 v[184:185], v[196:197], v[192:193], v[184:185] op_sel_hi:[0,1,1] neg_lo:[0,0,1] neg_hi:[0,0,1]
v_pk_fma_f32 v[186:187], v[196:197], v[194:195], v[186:187] op_sel_hi:[0,1,1] neg_lo:[0,0,1] neg_hi:[0,0,1]
v_cvt_pk_bf16_f32 v164, v180, v181
v_cvt_pk_bf16_f32 v165, v182, v183
v_cvt_pk_bf16_f32 v166, v184, v185
v_cvt_pk_bf16_f32 v167, v186, v187
v_pk_fma_f32 v[188:189], v[196:197], v[180:181], v[188:189] op_sel_hi:[0,1,1] neg_lo:[0,0,1] neg_hi:[0,0,1]
v_pk_fma_f32 v[190:191], v[196:197], v[182:183], v[190:191] op_sel_hi:[0,1,1] neg_lo:[0,0,1] neg_hi:[0,0,1]
v_pk_fma_f32 v[192:193], v[196:197], v[184:185], v[192:193] op_sel_hi:[0,1,1] neg_lo:[0,0,1] neg_hi:[0,0,1]
v_pk_fma_f32 v[194:195], v[196:197], v[186:187], v[194:195] op_sel_hi:[0,1,1] neg_lo:[0,0,1] neg_hi:[0,0,1]
v_cvt_pk_bf16_f32 v168, v188, v189
v_cvt_pk_bf16_f32 v169, v190, v191
v_cvt_pk_bf16_f32 v170, v192, v193
v_cvt_pk_bf16_f32 v171, v194, v195
v_pk_fma_f32 v[180:181], v[196:197], v[188:189], v[180:181] op_sel_hi:[0,1,1] neg_lo:[0,0,1] neg_hi:[0,0,1]
v_pk_fma_f32 v[182:183], v[196:197], v[190:191], v[182:183] op_sel_hi:[0,1,1] neg_lo:[0,0,1] neg_hi:[0,0,1]
v_pk_fma_f32 v[184:185], v[196:197], v[192:193], v[184:185] op_sel_hi:[0,1,1] neg_lo:[0,0,1] neg_hi:[0,0,1]
v_pk_fma_f32 v[186:187], v[196:197], v[194:195], v[186:187] op_sel_hi:[0,1,1] neg_lo:[0,0,1] neg_hi:[0,0,1]
v_cvt_pk_bf16_f32 v172, v180, v181
v_cvt_pk_bf16_f32 v173, v182, v183
v_cvt_pk_bf16_f32 v174, v184, v185
v_cvt_pk_bf16_f32 v175, v186, v187
v_pk_fma_f32 v[188:189], v[196:197], v[180:181], v[188:189] op_sel_hi:[0,1,1] neg_lo:[0,0,1] neg_hi:[0,0,1]
v_pk_fma_f32 v[190:191], v[196:197], v[182:183], v[190:191] op_sel_hi:[0,1,1] neg_lo:[0,0,1] neg_hi:[0,0,1]
v_pk_fma_f32 v[192:193], v[196:197], v[184:185], v[192:193] op_sel_hi:[0,1,1] neg_lo:[0,0,1] neg_hi:[0,0,1]
v_pk_fma_f32 v[194:195], v[196:197], v[186:187], v[194:195] op_sel_hi:[0,1,1] neg_lo:[0,0,1] neg_hi:[0,0,1]
v_cvt_pk_bf16_f32 v176, v188, v189
v_cvt_pk_bf16_f32 v177, v190, v191
v_cvt_pk_bf16_f32 v178, v192, v193
v_cvt_pk_bf16_f32 v179, v194, v195
v_mov_b32 v180, s24
v_mov_b32 v181, s24
v_mov_b32 v182, s24
v_mov_b32 v183, s24
s_nop 1
v_mfma_f32_32x32x16_bf16 v[184:199], v[180:183], v[20:23], 0
v_mfma_f32_32x32x16_bf16 v[184:199], v[180:183], v[24:27], v[184:199]
v_mfma_f32_32x32x16_bf16 v[184:199], v[180:183], v[28:31], v[184:199]
v_mfma_f32_32x32x16_bf16 v[184:199], v[180:183], v[32:35], v[184:199]
v_mfma_f32_32x32x16_bf16 v[184:199], v[180:183], v[36:39], v[184:199]
v_mfma_f32_32x32x16_bf16 v[184:199], v[180:183], v[40:43], v[184:199]
v_mfma_f32_32x32x16_bf16 v[184:199], v[180:183], v[44:47], v[184:199]
v_mfma_f32_32x32x16_bf16 v[184:199], v[180:183], v[48:51], v[184:199]
v_mfma_f32_32x32x16_bf16 v[184:199], v[180:183], v[52:55], v[184:199]
v_mfma_f32_32x32x16_bf16 v[184:199], v[180:183], v[56:59], v[184:199]
v_mfma_f32_32x32x16_bf16 v[184:199], v[180:183], v[60:63], v[184:199]
v_mfma_f32_32x32x16_bf16 v[184:199], v[180:183], v[64:67], v[184:199]
v_mfma_f32_32x32x16_bf16 v[184:199], v[180:183], v[68:71], v[184:199]
v_mfma_f32_32x32x16_bf16 v[184:199], v[180:183], v[72:75], v[184:199]
v_mfma_f32_32x32x16_bf16 v[184:199], v[180:183], v[76:79], v[184:199]
v_mfma_f32_32x32x16_bf16 v[184:199], v[180:183], v[80:83], v[184:199]
v_mfma_f32_32x32x16_bf16 v[184:199], v[180:183], v[84:87], v[184:199]
v_mfma_f32_32x32x16_bf16 v[184:199], v[180:183], v[88:91], v[184:199]
v_mfma_f32_32x32x16_bf16 v[184:199], v[180:183], v[92:95], v[184:199]
v_mfma_f32_32x32x16_bf16 v[184:199], v[180:183], v[96:99], v[184:199]
v_mfma_f32_32x32x16_bf16 v[184:199], v[180:183], v[100:103], v[184:199]
v_mfma_f32_32x32x16_bf16 v[184:199], v[180:183], v[104:107], v[184:199]
v_mfma_f32_32x32x16_bf16 v[184:199], v[180:183], v[108:111], v[184:199]
v_mfma_f32_32x32x16_bf16 v[184:199], v[180:183], v[112:115], v[184:199]
v_mfma_f32_32x32x16_bf16 v[184:199], v[180:183], v[116:119], v[184:199]
v_mfma_f32_32x32x16_bf16 v[184:199], v[180:183], v[120:123], v[184:199]
v_mfma_f32_32x32x16_bf16 v[184:199], v[180:183], v[124:127], v[184:199]
v_mfma_f32_32x32x16_bf16 v[184:199], v[180:183], v[128:131], v[184:199]
v_mfma_f32_32x32x16_bf16 v[184:199], v[180:183], v[132:135], v[184:199]
v_mfma_f32_32x32x16_bf16 v[184:199], v[180:183], v[136:139], v[184:199]
v_mfma_f32_32x32x16_bf16 v[184:199], v[180:183], v[140:143], v[184:199]
v_mfma_f32_32x32x16_bf16 v[184:199], v[180:183], v[144:147], v[184:199]
v_mfma_f32_32x32x16_bf16 v[184:199], v[180:183], v[148:151], v[184:199]
v_mfma_f32_32x32x16_bf16 v[184:199], v[180:183], v[152:155], v[184:199]
v_mfma_f32_32x32x16_bf16 v[184:199], v[180:183], v[156:159], v[184:199]
v_mfma_f32_32x32x16_bf16 v[184:199], v[180:183], v[160:163], v[184:199]
v_mfma_f32_32x32x16_bf16 v[184:199], v[180:183], v[164:167], v[184:199]
v_mfma_f32_32x32x16_bf16 v[184:199], v[180:183], v[168:171], v[184:199]
v_mfma_f32_32x32x16_bf16 v[184:199], v[180:183], v[172:175], v[184:199]
v_mfma_f32_32x32x16_bf16 v[184:199], v[180:183], v[176:179], v[184:199]
s_nop 11
v_mov_b32 v9, v184
p1q_46:
s_mul_i32 s18, s30, 21846
s_lshr_b32 s18, s18, 16
s_mul_i32 s18, s18, 3
s_sub_u32 s18, s30, s18
s_and_b32 s19, s30, 3
s_cmp_lt_u32 s30, 56
s_cselect_b32 s18, s18, s19
s_mul_i32 s18, s18, 2560
s_add_u32 s18, s18, 11665408
s_add_u32 s29, s30, 1
s_cmp_lg_u32 s13, 0
s_cbranch_scc1 polld_48
v_lshlrev_b32 v3, 3, v0
v_min_u32 v16, 2432, v3
s_mov_b32 s17, 0
poll_47:
buffer_load_dword v12, v16, s[4:7], s18 offen sc1
s_add_u32 s17, s17, 1
s_cmp_gt_u32 s17, 262144
s_cbranch_scc1 L_fail
s_waitcnt vmcnt(0)
v_cmp_gt_u32 vcc, s29, v12
s_cbranch_vccz polld_48
s_sleep 2
s_branch poll_47
polld_48:
s_barrier
s_mul_i32 s18, s30, 40960
s_add_u32 s26, s18, 91226112
s_add_u32 s26, s26, s31
s_add_u32 s27, s18, 100663296
s_add_u32 s27, s27, s33
s_add_u32 m0, s31, 2048
s_add_u32 s20, s26, 0
buffer_load_dwordx4 v0, s[4:7], s20 offen sc1 lds
s_add_u32 m0, s31, 3072
s_add_u32 s20, s26, 1024
buffer_load_dwordx4 v0, s[4:7], s20 offen sc1 lds
s_add_u32 m0, s31, 4096
s_add_u32 s20, s26, 2048
buffer_load_dwordx4 v0, s[4:7], s20 offen sc1 lds
s_add_u32 m0, s31, 5120
s_add_u32 s20, s26, 3072
buffer_load_dwordx4 v0, s[4:7], s20 offen sc1 lds
s_add_u32 m0, s31, 6144
s_add_u32 s20, s26, 4096
buffer_load_dwordx4 v0, s[4:7], s20 offen sc1 lds
s_add_u32 m0, s31, 7168
s_add_u32 s20, s26, 5120
buffer_load_dwordx4 v0, s[4:7], s20 offen sc1 lds
s_add_u32 m0, s31, 8192
s_add_u32 s20, s26, 6144
buffer_load_dwordx4 v0, s[4:7], s20 offen sc1 lds
s_add_u32 m0, s31, 9216
s_add_u32 s20, s26, 7168
buffer_load_dwordx4 v0, s[4:7], s20 offen sc1 lds
s_add_u32 m0, s31, 10240
s_add_u32 s20, s26, 8192
buffer_load_dwordx4 v0, s[4:7], s20 offen sc1 lds
s_add_u32 m0, s31, 11264
s_add_u32 s20, s26, 9216
buffer_load_dwordx4 v0, s[4:7], s20 offen sc1 lds
s_waitcnt vmcnt(0)
s_barrier
v_add_u32 v2, s31, v0
ds_read_b128 v[220:223], v2 offset:2048
ds_read_b128 v[224:227], v2 offset:3072
ds_read_b128 v[228:231], v2 offset:4096
ds_read_b128 v[200:203], v0 offset:3072
ds_read_b128 v[232:235], v2 offset:5120
ds_read_b128 v[196:199], v0 offset:2048
v_mov_b64 v[212:213], 0
ds_read_b128 v[204:207], v0 offset:4096
ds_read_b128 v[208:211], v0 offset:5120
s_waitcnt lgkmcnt(7)
v_dot2c_f32_bf16 v212, s24, v220
v_dot2c_f32_bf16 v213, v220, v220
v_dot2c_f32_bf16 v212, s24, v221
v_dot2c_f32_bf16 v213, v221, v221
v_dot2c_f32_bf16 v212, s24, v222
v_dot2c_f32_bf16 v213, v222, v222
v_dot2c_f32_bf16 v212, s24, v223
s_waitcnt lgkmcnt(5)
v_dot2c_f32_bf16 v213, v223, v223
v_dot2c_f32_bf16 v212, s24, v224
v_dot2c_f32_bf16 v213, v224, v224
v_dot2c_f32_bf16 v212, s24, v225
v_dot2c_f32_bf16 v213, v225, v225
v_dot2c_f32_bf16 v212, s24, v226
v_dot2c_f32_bf16 v213, v226, v226
v_dot2c_f32_bf16 v212, s24, v227
v_dot2c_f32_bf16 v213, v227, v227
v_dot2c_f32_bf16 v212, s24, v228
v_dot2c_f32_bf16 v213, v228, v228
s_waitcnt lgkmcnt(3)
ds_read_b128 v[220:223], v2 offset:6144
ds_read_b128 v[224:227], v2 offset:7168
v_dot2c_f32_bf16 v212, s24, v229
v_dot2c_f32_bf16 v213, v229, v229
v_dot2c_f32_bf16 v212, s24, v230
v_dot2c_f32_bf16 v213, v230, v230
v_dot2c_f32_bf16 v212, s24, v231
v_dot2c_f32_bf16 v213, v231, v231
v_dot2c_f32_bf16 v212, s24, v232
v_dot2c_f32_bf16 v213, v232, v232
v_dot2c_f32_bf16 v212, s24, v233
v_dot2c_f32_bf16 v213, v233, v233
v_dot2c_f32_bf16 v212, s24, v234
v_dot2c_f32_bf16 v213, v234, v234
v_dot2c_f32_bf16 v212, s24, v235
v_dot2c_f32_bf16 v213, v235, v235
s_waitcnt lgkmcnt(1)
ds_read_b128 v[232:235], v2 offset:9216
ds_read_b128 v[228:231], v2 offset:8192
v_dot2c_f32_bf16 v212, s24, v220
v_dot2c_f32_bf16 v213, v220, v220
v_dot2c_f32_bf16 v212, s24, v221
s_waitcnt lgkmcnt(2)
v_dot2c_f32_bf16 v213, v221, v221
v_dot2c_f32_bf16 v212, s24, v222
v_dot2c_f32_bf16 v213, v222, v222
v_dot2c_f32_bf16 v212, s24, v223
v_dot2c_f32_bf16 v213, v223, v223
v_dot2c_f32_bf16 v212, s24, v224
v_dot2c_f32_bf16 v213, v224, v224
v_dot2c_f32_bf16 v212, s24, v225
v_dot2c_f32_bf16 v213, v225, v225
v_dot2c_f32_bf16 v212, s24, v226
v_dot2c_f32_bf16 v213, v226, v226
v_dot2c_f32_bf16 v212, s24, v227
v_dot2c_f32_bf16 v213, v227, v227
s_waitcnt lgkmcnt(0)
ds_read_b128 v[220:223], v2 offset:10240
ds_read_b128 v[224:227], v2 offset:11264
v_dot2c_f32_bf16 v212, s24, v228
v_dot2c_f32_bf16 v213, v228, v228
v_dot2c_f32_bf16 v212, s24, v229
v_dot2c_f32_bf16 v213, v229, v229
v_dot2c_f32_bf16 v212, s24, v230
v_dot2c_f32_bf16 v213, v230, v230
v_dot2c_f32_bf16 v212, s24, v231
v_dot2c_f32_bf16 v213, v231, v231
v_dot2c_f32_bf16 v212, s24, v232
v_dot2c_f32_bf16 v213, v232, v232
v_dot2c_f32_bf16 v212, s24, v233
v_dot2c_f32_bf16 v213, v233, v233
v_dot2c_f32_bf16 v212, s24, v234
v_dot2c_f32_bf16 v213, v234, v234
s_waitcnt lgkmcnt(1)
v_dot2c_f32_bf16 v212, s24, v235
v_dot2c_f32_bf16 v213, v235, v235
v_dot2c_f32_bf16 v212, s24, v220
s_waitcnt lgkmcnt(0)
v_dot2c_f32_bf16 v213, v220, v220
v_dot2c_f32_bf16 v212, s24, v221
v_dot2c_f32_bf16 v213, v221, v221
v_dot2c_f32_bf16 v212, s24, v222
v_dot2c_f32_bf16 v213, v222, v222
v_dot2c_f32_bf16 v212, s24, v223
v_dot2c_f32_bf16 v213, v223, v223
v_dot2c_f32_bf16 v212, s24, v224
v_dot2c_f32_bf16 v213, v224, v224
v_dot2c_f32_bf16 v212, s24, v225
v_dot2c_f32_bf16 v213, v225, v225
v_dot2c_f32_bf16 v212, s24, v226
v_dot2c_f32_bf16 v213, v226, v226
v_dot2c_f32_bf16 v212, s24, v227
v_dot2c_f32_bf16 v213, v227, v227
v_mfma_f32_32x32x16_bf16 v[180:195], v[196:199], v[20:23], 0
s_nop 1
v_permlane32_swap_b32 v212, v213
ds_read_b128 v[196:199], v0 offset:6144
v_mfma_f32_32x32x16_bf16 v[180:195], v[200:203], v[24:27], v[180:195]
v_and_b32 v2, 0x1ff, v0
v_add_f32 v212, v212, v213
v_mfma_f32_32x32x16_bf16 v[180:195], v[204:207], v[28:31], v[180:195]
v_lshl_add_u32 v213, s13, 2, v0
ds_read_b128 v[200:203], v0 offset:7168
ds_write_b32 v213, v212 offset:0
v_mfma_f32_32x32x16_bf16 v[180:195], v[208:211], v[32:35], v[180:195]
s_waitcnt lgkmcnt(2)
ds_read_b128 v[204:207], v0 offset:8192
ds_read_b128 v[208:211], v0 offset:9216
v_mfma_f32_32x32x16_bf16 v[180:195], v[196:199], v[36:39], v[180:195]
s_waitcnt lgkmcnt(3)
v_mfma_f32_32x32x16_bf16 v[180:195], v[200:203], v[40:43], v[180:195]
s_waitcnt lgkmcnt(2)
ds_read_b128 v[196:199], v0 offset:10240
s_waitcnt lgkmcnt(2)
s_waitcnt lgkmcnt(1)
v_mfma_f32_32x32x16_bf16 v[180:195], v[204:207], v[44:47], v[180:195]
ds_read_b128 v[200:203], v0 offset:11264
s_barrier
ds_read_b128 v[212:215], v2 offset:0
v_mfma_f32_32x32x16_bf16 v[180:195], v[208:211], v[48:51], v[180:195]
ds_read_b128 v[208:211], v0 offset:13312
ds_read_b128 v[204:207], v0 offset:12288
s_waitcnt lgkmcnt(4)
v_mfma_f32_32x32x16_bf16 v[180:195], v[196:199], v[52:55], v[180:195]
s_waitcnt lgkmcnt(3)
ds_read_b128 v[216:219], v2 offset:512
ds_read_b128 v[196:199], v0 offset:14336
v_mfma_f32_32x32x16_bf16 v[180:195], v[200:203], v[56:59], v[180:195]
s_waitcnt lgkmcnt(2)
v_mfma_f32_32x32x16_bf16 v[180:195], v[204:207], v[60:63], v[180:195]
ds_read_b128 v[200:203], v0 offset:15360
ds_read_b128 v[204:207], v0 offset:16384
v_add_f32 v212, v212, v213
v_add_f32 v214, v214, v215
s_waitcnt lgkmcnt(3)
v_mfma_f32_32x32x16_bf16 v[180:195], v[208:211], v[64:67], v[180:195]
s_waitcnt lgkmcnt(2)
ds_read_b128 v[208:211], v0 offset:17408
v_add_f32 v216, v216, v217
v_add_f32 v212, v212, v214
v_mfma_f32_32x32x16_bf16 v[180:195], v[196:199], v[68:71], v[180:195]
s_waitcnt lgkmcnt(2)
v_mfma_f32_32x32x16_bf16 v[180:195], v[200:203], v[72:75], v[180:195]
v_mul_f32 v212, 0x3acccccd, v212
s_waitcnt lgkmcnt(1)
ds_read_b128 v[196:199], v0 offset:18432
v_add_f32 v218, v218, v219
s_waitcnt lgkmcnt(1)
v_mfma_f32_32x32x16_bf16 v[180:195], v[204:207], v[76:79], v[180:195]
v_lshrrev_b32 v213, 2, v0
ds_read_b128 v[200:203], v0 offset:19456
v_mfma_f32_32x32x16_bf16 v[180:195], v[208:211], v[80:83], v[180:195]
ds_read_b128 v[204:207], v0 offset:20480
ds_read_b128 v[208:211], v0 offset:21504
v_add_f32 v216, v216, v218
v_mul_f32 v216, 0x3acccccd, v216
s_waitcnt lgkmcnt(3)
v_mfma_f32_32x32x16_bf16 v[180:195], v[196:199], v[84:87], v[180:195]
v_fma_f32 v216, -v212, v212, v216
s_waitcnt lgkmcnt(2)
v_max_f32 v216, 0, v216
v_add_f32 v216, 0x3727c5ac, v216
v_mfma_f32_32x32x16_bf16 v[180:195], v[200:203], v[88:91], v[180:195]
ds_read_b128 v[196:199], v0 offset:22528
s_waitcnt lgkmcnt(2)
v_bfe_u32 v214, v0, 5, 5
v_lshl_add_u32 v213, s13, 8, v213
v_mfma_f32_32x32x16_bf16 v[180:195], v[204:207], v[92:95], v[180:195]
ds_read_b128 v[200:203], v0 offset:23552
ds_read_b128 v[204:207], v0 offset:24576
v_rsq_f32 v216, v216
s_waitcnt lgkmcnt(3)
v_and_b32 v214, 16, v214
v_mfma_f32_32x32x16_bf16 v[180:195], v[208:211], v[96:99], v[180:195]
ds_read_b128 v[208:211], v0 offset:25600
s_waitcnt lgkmcnt(3)
v_mul_f32 v212, v216, v212
v_mfma_f32_32x32x16_bf16 v[180:195], v[196:199], v[100:103], v[180:195]
v_lshl_add_u32 v214, s13, 8, v214
v_permlane32_swap_b32 v216, v212
s_waitcnt lgkmcnt(2)
ds_read_b128 v[196:199], v0 offset:26624
v_mfma_f32_32x32x16_bf16 v[180:195], v[200:203], v[104:107], v[180:195]
ds_write_b32 v213, v216 offset:1024
s_waitcnt lgkmcnt(3)
s_waitcnt lgkmcnt(2)
v_mfma_f32_32x32x16_bf16 v[180:195], v[204:207], v[108:111], v[180:195]
ds_read_b128 v[244:247], v214 offset:1216
ds_read_b128 v[200:203], v0 offset:27648
v_mfma_f32_32x32x16_bf16 v[180:195], v[208:211], v[112:115], v[180:195]
ds_read_b128 v[204:207], v0 offset:28672
s_waitcnt lgkmcnt(4)
ds_read_b128 v[236:239], v214 offset:1152
v_mfma_f32_32x32x16_bf16 v[180:195], v[196:199], v[116:119], v[180:195]
ds_read_b128 v[208:211], v0 offset:29696
ds_read_b128 v[196:199], v0 offset:30720
s_waitcnt lgkmcnt(4)
v_mfma_f32_32x32x16_bf16 v[180:195], v[200:203], v[120:123], v[180:195]
ds_read_b128 v[232:235], v214 offset:1120
s_waitcnt lgkmcnt(4)
ds_read_b128 v[220:223], v214 offset:1024
ds_read_b128 v[200:203], v0 offset:31744
v_mfma_f32_32x32x16_bf16 v[180:195], v[204:207], v[124:127], v[180:195]
v_mul_f32 v245, v245, v9
s_waitcnt lgkmcnt(3)
ds_read_b128 v[204:207], v0 offset:32768
v_mfma_f32_32x32x16_bf16 v[180:195], v[208:211], v[128:131], v[180:195]
ds_read_b128 v[224:227], v214 offset:1056
v_mfma_f32_32x32x16_bf16 v[180:195], v[196:199], v[132:135], v[180:195]
ds_read_b128 v[208:211], v0 offset:33792
s_waitcnt lgkmcnt(3)
v_mfma_f32_32x32x16_bf16 v[180:195], v[200:203], v[136:139], v[180:195]
s_waitcnt lgkmcnt(2)
ds_read_b128 v[196:199], v0 offset:34816
ds_read_b128 v[228:231], v214 offset:1088
ds_read_b128 v[200:203], v0 offset:35840
ds_read_b128 v[248:251], v214 offset:1248
v_mfma_f32_32x32x16_bf16 v[180:195], v[204:207], v[140:143], v[180:195]
s_waitcnt lgkmcnt(4)
ds_read_b128 v[204:207], v0 offset:36864
v_mfma_f32_32x32x16_bf16 v[180:195], v[208:211], v[144:147], v[180:195]
v_mul_f32 v246, v246, v9
ds_read_b128 v[240:243], v214 offset:1184
s_waitcnt lgkmcnt(5)
v_mfma_f32_32x32x16_bf16 v[180:195], v[196:199], v[148:151], v[180:195]
ds_read_b128 v[208:211], v0 offset:37888
s_waitcnt lgkmcnt(3)
ds_read_b128 v[196:199], v0 offset:38912
v_mfma_f32_32x32x16_bf16 v[180:195], v[200:203], v[152:155], v[180:195]
ds_read_b128 v[200:203], v0 offset:39936
s_waitcnt lgkmcnt(4)
s_waitcnt lgkmcnt(3)
v_mul_f32 v244, v244, v9
v_mfma_f32_32x32x16_bf16 v[180:195], v[204:207], v[156:159], v[180:195]
v_mul_f32 v251, v251, v9
v_mul_f32 v249, v249, v9
v_mul_f32 v237, v237, v9
s_waitcnt lgkmcnt(2)
v_mfma_f32_32x32x16_bf16 v[180:195], v[208:211], v[160:163], v[180:195]
ds_read_b128 v[204:207], v0 offset:40960
s_waitcnt lgkmcnt(1)
ds_read_b128 v[208:211], v0 offset:41984
v_mul_f32 v236, v236, v9
v_mfma_f32_32x32x16_bf16 v[180:195], v[196:199], v[164:167], v[180:195]
v_mul_f32 v250, v250, v9
v_mul_f32 v248, v248, v9
v_mul_f32 v240, v240, v9
v_mfma_f32_32x32x16_bf16 v[180:195], v[200:203], v[168:171], v[180:195]
s_waitcnt lgkmcnt(0)
v_mul_f32 v243, v243, v9
v_mfma_f32_32x32x16_bf16 v[180:195], v[204:207], v[172:175], v[180:195]
v_mul_f32 v242, v242, v9
v_mfma_f32_32x32x16_bf16 v[180:195], v[208:211], v[176:179], v[180:195]
s_nop 0
v_mul_f32 v241, v241, v9
v_mul_f32 v239, v239, v9
v_mul_f32 v238, v238, v9
v_mul_f32 v247, v247, v9
s_nop 6
v_pk_fma_f32 v[188:189], v[188:189], v[228:229], v[244:245] neg_lo:[0,0,1] neg_hi:[0,0,1]
v_pk_fma_f32 v[186:187], v[186:187], v[226:227], v[242:243] neg_lo:[0,0,1] neg_hi:[0,0,1]
v_pk_fma_f32 v[184:185], v[184:185], v[224:225], v[240:241] neg_lo:[0,0,1] neg_hi:[0,0,1]
v_pk_fma_f32 v[192:193], v[192:193], v[232:233], v[248:249] neg_lo:[0,0,1] neg_hi:[0,0,1]
v_pk_fma_f32 v[180:181], v[180:181], v[220:221], v[236:237] neg_lo:[0,0,1] neg_hi:[0,0,1]
v_cvt_pk_bf16_f32 v198, v184, v185
v_pk_fma_f32 v[182:183], v[182:183], v[222:223], v[238:239] neg_lo:[0,0,1] neg_hi:[0,0,1]
v_cvt_pk_bf16_f32 v202, v192, v193
v_pk_fma_f32 v[194:195], v[194:195], v[234:235], v[250:251] neg_lo:[0,0,1] neg_hi:[0,0,1]
v_cvt_pk_bf16_f32 v203, v194, v195
v_cvt_pk_bf16_f32 v199, v186, v187
v_pk_fma_f32 v[190:191], v[190:191], v[230:231], v[246:247] neg_lo:[0,0,1] neg_hi:[0,0,1]
v_cvt_pk_bf16_f32 v197, v182, v183
v_cvt_pk_bf16_f32 v200, v188, v189
v_cvt_pk_bf16_f32 v201, v190, v191
v_cvt_pk_bf16_f32 v196, v180, v181
buffer_store_dwordx4 v[196:199], v10, s[4:7], s27 offen offset:0 sc1
buffer_store_dwordx4 v[200:203], v10, s[4:7], s27 offen offset:1024 sc1
s_add_u32 s30, s30, 3
s_cmp_lt_u32 s30, 60
s_cbranch_scc1 p1q_46
s_lshl_b32 s18, s54, 7
s_add_u32 s18, s18, 11552768
s_cmp_eq_u32 s13, 0
s_cselect_b32 s22, s18, s6
s_mov_b32 s23, 1
s_waitcnt vmcnt(0)
s_barrier
v_mov_b32 v3, s23
s_mov_b64 exec, 1
buffer_store_dword v3, off, s[4:7], s22 sc1
s_mov_b64 exec, -1
s_mov_b32 s22, s6
s_mov_b32 s34, s55
kvz_45:
s_add_u32 s16, s16, 1
s_cmp_lt_u32 s16, 2
s_cbranch_scc1 kvlay_29
s_endpgm
roleA_12:
s_sub_u32 s39, s15, 64
s_mul_i32 s50, s39, 13108
s_lshr_b32 s50, s50, 16
s_mul_i32 s18, s50, 5
s_sub_u32 s34, s39, s18
s_waitcnt vmcnt(0)
v_bfe_u32 v5, v0, 4, 5
v_mul_u32_u24 v5, 1280, v5
v_lshrrev_b32 v8, 9, v0
v_lshl_add_u32 v5, v8, 4, v5
v_and_b32 v6, 0x1ff, v0
v_lshlrev_b32 v6, 1, v6
v_lshl_add_u32 v6, v8, 4, v6
s_load_dwordx2 s[44:45], s[0:1], 0
s_mov_b32 s46, 2621440
s_mov_b32 s47, 0x20000
s_waitcnt lgkmcnt(0)
v_lshrrev_b32 v8, 7, v0
v_lshl_add_u32 v8, s13, 3, v8
v_bfe_u32 v9, v8, 1, 3
v_lshlrev_b32 v9, 4, v9
v_xor_b32 v9, v9, v0
v_and_b32 v9, 0x70, v9
v_mul_u32_u24 v8, 1280, v8
v_add_u32 v8, v8, v9
s_mul_i32 s26, s50, 40960
s_lshl_b32 s25, s13, 10
s_add_u32 m0, s25, 2048
s_add_u32 s20, s26, 0
buffer_load_dwordx4 v8, s[44:47], s20 offen sc1 lds
s_add_u32 m0, s25, 6144
s_add_u32 s20, s26, 128
buffer_load_dwordx4 v8, s[44:47], s20 offen sc1 lds
s_add_u32 m0, s25, 10240
s_add_u32 s20, s26, 256
buffer_load_dwordx4 v8, s[44:47], s20 offen sc1 lds
s_add_u32 m0, s25, 14336
s_add_u32 s20, s26, 384
buffer_load_dwordx4 v8, s[44:47], s20 offen sc1 lds
s_add_u32 m0, s25, 18432
s_add_u32 s20, s26, 512
buffer_load_dwordx4 v8, s[44:47], s20 offen sc1 lds
s_add_u32 m0, s25, 22528
s_add_u32 s20, s26, 640
buffer_load_dwordx4 v8, s[44:47], s20 offen sc1 lds
s_add_u32 m0, s25, 26624
s_add_u32 s20, s26, 768
buffer_load_dwordx4 v8, s[44:47], s20 offen sc1 lds
s_add_u32 m0, s25, 30720
s_add_u32 s20, s26, 896
buffer_load_dwordx4 v8, s[44:47], s20 offen sc1 lds
s_add_u32 m0, s25, 34816
s_add_u32 s20, s26, 1024
buffer_load_dwordx4 v8, s[44:47], s20 offen sc1 lds
s_add_u32 m0, s25, 38912
s_add_u32 s20, s26, 1152
buffer_load_dwordx4 v8, s[44:47], s20 offen sc1 lds
s_add_u32 s26, s26, 1310720
s_add_u32 s25, s25, 40960
v_bfe_u32 v176, v0, 5, 3
v_lshrrev_b32 v9, 9, v0
v_xor_b32 v176, v176, v9
v_lshlrev_b32 v176, 4, v176
v_and_b32 v9, 0x1f0, v0
v_lshl_add_u32 v176, v9, 3, v176
v_xor_b32 v177, 32, v176
v_xor_b32 v178, 64, v176
v_xor_b32 v179, 96, v176
s_lshl_b32 s18, s34, 7
s_lshl_b32 s19, s13, 5
s_add_u32 s18, s18, s19
s_mov_b32 s19, 0x3acccccd
v_bfe_u32 v202, v0, 4, 5
v_lshrrev_b32 v197, 9, v0
v_add_u32 v202, s18, v202
v_and_b32 v201, 1, v202
v_mul_u32_u24 v201, 160, v201
v_lshrrev_b32 v200, 1, v202
v_add_u32 v200, 1, v200
v_lshlrev_b32 v197, 3, v197
v_mad_u32_u24 v201, v197, v200, v201
v_mad_u32_u24 v196, v200, 16, 0
v_cvt_f32_u32 v196, v196
v_mul_f32 v202, s19, v196
v_rndne_f32 v202, v202
v_fmac_f32 v196, 0xc4200000, v202
v_mul_f32 v196, s19, v196
v_cos_f32 v196, v196
s_nop 0
v_add_f32 v196, v196, v196
v_mad_u32_u24 v198, v200, 1, 0
v_cvt_f32_u32 v198, v198
v_mul_f32 v202, s19, v198
v_rndne_f32 v202, v202
v_fmac_f32 v198, 0xc4200000, v202
v_mul_f32 v198, s19, v198
v_cos_f32 v198, v198
s_nop 0
v_add_f32 v198, v198, v198
v_mad_u32_u24 v183, v200, 3, v201
v_cvt_f32_u32 v183, v183
v_mul_f32 v202, s19, v183
v_rndne_f32 v202, v202
v_fmac_f32 v183, 0xc4200000, v202
v_mul_f32 v183, s19, v183
v_cos_f32 v183, v183
v_mad_u32_u24 v184, v200, 4, v201
v_cvt_f32_u32 v184, v184
v_mul_f32 v202, s19, v184
v_rndne_f32 v202, v202
v_fmac_f32 v184, 0xc4200000, v202
v_mul_f32 v184, s19, v184
v_cos_f32 v184, v184
s_nop 0
v_fma_f32 v185, v198, v184, -v183
v_fma_f32 v182, v198, v183, -v184
v_fma_f32 v186, v198, v185, -v184
v_fma_f32 v181, v198, v182, -v183
v_fma_f32 v187, v198, v186, -v185
v_fma_f32 v180, v198, v181, -v182
v_cvt_pk_bf16_f32 v16, v180, v181
v_cvt_pk_bf16_f32 v17, v182, v183
v_cvt_pk_bf16_f32 v18, v184, v185
v_cvt_pk_bf16_f32 v19, v186, v187
v_mad_u32_u24 v191, v200, 19, v201
v_cvt_f32_u32 v191, v191
v_mul_f32 v202, s19, v191
v_rndne_f32 v202, v202
v_fmac_f32 v191, 0xc4200000, v202
v_mul_f32 v191, s19, v191
v_cos_f32 v191, v191
v_mad_u32_u24 v192, v200, 20, v201
v_cvt_f32_u32 v192, v192
v_mul_f32 v202, s19, v192
v_rndne_f32 v202, v202
v_fmac_f32 v192, 0xc4200000, v202
v_mul_f32 v192, s19, v192
v_cos_f32 v192, v192
s_nop 0
v_fma_f32 v193, v198, v192, -v191
v_fma_f32 v190, v198, v191, -v192
v_fma_f32 v194, v198, v193, -v192
v_fma_f32 v189, v198, v190, -v191
v_fma_f32 v195, v198, v194, -v193
v_fma_f32 v188, v198, v189, -v190
v_cvt_pk_bf16_f32 v20, v188, v189
v_cvt_pk_bf16_f32 v21, v190, v191
v_cvt_pk_bf16_f32 v22, v192, v193
v_cvt_pk_bf16_f32 v23, v194, v195
v_pk_fma_f32 v[180:181], v[196:197], v[188:189], v[180:181] op_sel_hi:[0,1,1] neg_lo:[0,0,1] neg_hi:[0,0,1]
v_pk_fma_f32 v[182:183], v[196:197], v[190:191], v[182:183] op_sel_hi:[0,1,1] neg_lo:[0,0,1] neg_hi:[0,0,1]
v_pk_fma_f32 v[184:185], v[196:197], v[192:193], v[184:185] op_sel_hi:[0,1,1] neg_lo:[0,0,1] neg_hi:[0,0,1]
v_pk_fma_f32 v[186:187], v[196:197], v[194:195], v[186:187] op_sel_hi:[0,1,1] neg_lo:[0,0,1] neg_hi:[0,0,1]
v_cvt_pk_bf16_f32 v24, v180, v181
v_cvt_pk_bf16_f32 v25, v182, v183
v_cvt_pk_bf16_f32 v26, v184, v185
v_cvt_pk_bf16_f32 v27, v186, v187
s_add_u32 m0, s25, 2048
s_add_u32 s21, s26, 0
buffer_load_dwordx4 v8, s[44:47], s21 offen lds
v_pk_fma_f32 v[188:189], v[196:197], v[180:181], v[188:189] op_sel_hi:[0,1,1] neg_lo:[0,0,1] neg_hi:[0,0,1]
v_pk_fma_f32 v[190:191], v[196:197], v[182:183], v[190:191] op_sel_hi:[0,1,1] neg_lo:[0,0,1] neg_hi:[0,0,1]
v_pk_fma_f32 v[192:193], v[196:197], v[184:185], v[192:193] op_sel_hi:[0,1,1] neg_lo:[0,0,1] neg_hi:[0,0,1]
v_pk_fma_f32 v[194:195], v[196:197], v[186:187], v[194:195] op_sel_hi:[0,1,1] neg_lo:[0,0,1] neg_hi:[0,0,1]
v_cvt_pk_bf16_f32 v28, v188, v189
v_cvt_pk_bf16_f32 v29, v190, v191
v_cvt_pk_bf16_f32 v30, v192, v193
v_cvt_pk_bf16_f32 v31, v194, v195
s_add_u32 m0, s25, 6144
s_add_u32 s21, s26, 128
buffer_load_dwordx4 v8, s[44:47], s21 offen lds
v_pk_fma_f32 v[180:181], v[196:197], v[188:189], v[180:181] op_sel_hi:[0,1,1] neg_lo:[0,0,1] neg_hi:[0,0,1]
v_pk_fma_f32 v[182:183], v[196:197], v[190:191], v[182:183] op_sel_hi:[0,1,1] neg_lo:[0,0,1] neg_hi:[0,0,1]
v_pk_fma_f32 v[184:185], v[196:197], v[192:193], v[184:185] op_sel_hi:[0,1,1] neg_lo:[0,0,1] neg_hi:[0,0,1]
v_pk_fma_f32 v[186:187], v[196:197], v[194:195], v[186:187] op_sel_hi:[0,1,1] neg_lo:[0,0,1] neg_hi:[0,0,1]
v_cvt_pk_bf16_f32 v32, v180, v181
v_cvt_pk_bf16_f32 v33, v182, v183
v_cvt_pk_bf16_f32 v34, v184, v185
v_cvt_pk_bf16_f32 v35, v186, v187
s_add_u32 m0, s25, 10240
s_add_u32 s21, s26, 256
buffer_load_dwordx4 v8, s[44:47], s21 offen lds
v_pk_fma_f32 v[188:189], v[196:197], v[180:181], v[188:189] op_sel_hi:[0,1,1] neg_lo:[0,0,1] neg_hi:[0,0,1]
v_pk_fma_f32 v[190:191], v[196:197], v[182:183], v[190:191] op_sel_hi:[0,1,1] neg_lo:[0,0,1] neg_hi:[0,0,1]
v_pk_fma_f32 v[192:193], v[196:197], v[184:185], v[192:193] op_sel_hi:[0,1,1] neg_lo:[0,0,1] neg_hi:[0,0,1]
v_pk_fma_f32 v[194:195], v[196:197], v[186:187], v[194:195] op_sel_hi:[0,1,1] neg_lo:[0,0,1] neg_hi:[0,0,1]
v_cvt_pk_bf16_f32 v36, v188, v189
v_cvt_pk_bf16_f32 v37, v190, v191
v_cvt_pk_bf16_f32 v38, v192, v193
v_cvt_pk_bf16_f32 v39, v194, v195
s_add_u32 m0, s25, 14336
s_add_u32 s21, s26, 384
buffer_load_dwordx4 v8, s[44:47], s21 offen lds
v_pk_fma_f32 v[180:181], v[196:197], v[188:189], v[180:181] op_sel_hi:[0,1,1] neg_lo:[0,0,1] neg_hi:[0,0,1]
v_pk_fma_f32 v[182:183], v[196:197], v[190:191], v[182:183] op_sel_hi:[0,1,1] neg_lo:[0,0,1] neg_hi:[0,0,1]
v_pk_fma_f32 v[184:185], v[196:197], v[192:193], v[184:185] op_sel_hi:[0,1,1] neg_lo:[0,0,1] neg_hi:[0,0,1]
v_pk_fma_f32 v[186:187], v[196:197], v[194:195], v[186:187] op_sel_hi:[0,1,1] neg_lo:[0,0,1] neg_hi:[0,0,1]
v_cvt_pk_bf16_f32 v40, v180, v181
v_cvt_pk_bf16_f32 v41, v182, v183
v_cvt_pk_bf16_f32 v42, v184, v185
v_cvt_pk_bf16_f32 v43, v186, v187
s_add_u32 m0, s25, 18432
s_add_u32 s21, s26, 512
buffer_load_dwordx4 v8, s[44:47], s21 offen lds
v_pk_fma_f32 v[188:189], v[196:197], v[180:181], v[188:189] op_sel_hi:[0,1,1] neg_lo:[0,0,1] neg_hi:[0,0,1]
v_pk_fma_f32 v[190:191], v[196:197], v[182:183], v[190:191] op_sel_hi:[0,1,1] neg_lo:[0,0,1] neg_hi:[0,0,1]
v_pk_fma_f32 v[192:193], v[196:197], v[184:185], v[192:193] op_sel_hi:[0,1,1] neg_lo:[0,0,1] neg_hi:[0,0,1]
v_pk_fma_f32 v[194:195], v[196:197], v[186:187], v[194:195] op_sel_hi:[0,1,1] neg_lo:[0,0,1] neg_hi:[0,0,1]
v_cvt_pk_bf16_f32 v44, v188, v189
v_cvt_pk_bf16_f32 v45, v190, v191
v_cvt_pk_bf16_f32 v46, v192, v193
v_cvt_pk_bf16_f32 v47, v194, v195
s_add_u32 m0, s25, 22528
s_add_u32 s21, s26, 640
buffer_load_dwordx4 v8, s[44:47], s21 offen lds
v_pk_fma_f32 v[180:181], v[196:197], v[188:189], v[180:181] op_sel_hi:[0,1,1] neg_lo:[0,0,1] neg_hi:[0,0,1]
v_pk_fma_f32 v[182:183], v[196:197], v[190:191], v[182:183] op_sel_hi:[0,1,1] neg_lo:[0,0,1] neg_hi:[0,0,1]
v_pk_fma_f32 v[184:185], v[196:197], v[192:193], v[184:185] op_sel_hi:[0,1,1] neg_lo:[0,0,1] neg_hi:[0,0,1]
v_pk_fma_f32 v[186:187], v[196:197], v[194:195], v[186:187] op_sel_hi:[0,1,1] neg_lo:[0,0,1] neg_hi:[0,0,1]
v_cvt_pk_bf16_f32 v48, v180, v181
v_cvt_pk_bf16_f32 v49, v182, v183
v_cvt_pk_bf16_f32 v50, v184, v185
v_cvt_pk_bf16_f32 v51, v186, v187
s_add_u32 m0, s25, 26624
s_add_u32 s21, s26, 768
buffer_load_dwordx4 v8, s[44:47], s21 offen lds
v_pk_fma_f32 v[188:189], v[196:197], v[180:181], v[188:189] op_sel_hi:[0,1,1] neg_lo:[0,0,1] neg_hi:[0,0,1]
v_pk_fma_f32 v[190:191], v[196:197], v[182:183], v[190:191] op_sel_hi:[0,1,1] neg_lo:[0,0,1] neg_hi:[0,0,1]
v_pk_fma_f32 v[192:193], v[196:197], v[184:185], v[192:193] op_sel_hi:[0,1,1] neg_lo:[0,0,1] neg_hi:[0,0,1]
v_pk_fma_f32 v[194:195], v[196:197], v[186:187], v[194:195] op_sel_hi:[0,1,1] neg_lo:[0,0,1] neg_hi:[0,0,1]
v_cvt_pk_bf16_f32 v52, v188, v189
v_cvt_pk_bf16_f32 v53, v190, v191
v_cvt_pk_bf16_f32 v54, v192, v193
v_cvt_pk_bf16_f32 v55, v194, v195
s_add_u32 m0, s25, 30720
s_add_u32 s21, s26, 896
buffer_load_dwordx4 v8, s[44:47], s21 offen lds
v_pk_fma_f32 v[180:181], v[196:197], v[188:189], v[180:181] op_sel_hi:[0,1,1] neg_lo:[0,0,1] neg_hi:[0,0,1]
v_pk_fma_f32 v[182:183], v[196:197], v[190:191], v[182:183] op_sel_hi:[0,1,1] neg_lo:[0,0,1] neg_hi:[0,0,1]
v_pk_fma_f32 v[184:185], v[196:197], v[192:193], v[184:185] op_sel_hi:[0,1,1] neg_lo:[0,0,1] neg_hi:[0,0,1]
v_pk_fma_f32 v[186:187], v[196:197], v[194:195], v[186:187] op_sel_hi:[0,1,1] neg_lo:[0,0,1] neg_hi:[0,0,1]
v_cvt_pk_bf16_f32 v56, v180, v181
v_cvt_pk_bf16_f32 v57, v182, v183
v_cvt_pk_bf16_f32 v58, v184, v185
v_cvt_pk_bf16_f32 v59, v186, v187
s_add_u32 m0, s25, 34816
s_add_u32 s21, s26, 1024
buffer_load_dwordx4 v8, s[44:47], s21 offen lds
v_pk_fma_f32 v[188:189], v[196:197], v[180:181], v[188:189] op_sel_hi:[0,1,1] neg_lo:[0,0,1] neg_hi:[0,0,1]
v_pk_fma_f32 v[190:191], v[196:197], v[182:183], v[190:191] op_sel_hi:[0,1,1] neg_lo:[0,0,1] neg_hi:[0,0,1]
v_pk_fma_f32 v[192:193], v[196:197], v[184:185], v[192:193] op_sel_hi:[0,1,1] neg_lo:[0,0,1] neg_hi:[0,0,1]
v_pk_fma_f32 v[194:195], v[196:197], v[186:187], v[194:195] op_sel_hi:[0,1,1] neg_lo:[0,0,1] neg_hi:[0,0,1]
v_cvt_pk_bf16_f32 v60, v188, v189
v_cvt_pk_bf16_f32 v61, v190, v191
v_cvt_pk_bf16_f32 v62, v192, v193
v_cvt_pk_bf16_f32 v63, v194, v195
s_add_u32 m0, s25, 38912
s_add_u32 s21, s26, 1152
buffer_load_dwordx4 v8, s[44:47], s21 offen lds
v_pk_fma_f32 v[180:181], v[196:197], v[188:189], v[180:181] op_sel_hi:[0,1,1] neg_lo:[0,0,1] neg_hi:[0,0,1]
v_pk_fma_f32 v[182:183], v[196:197], v[190:191], v[182:183] op_sel_hi:[0,1,1] neg_lo:[0,0,1] neg_hi:[0,0,1]
v_pk_fma_f32 v[184:185], v[196:197], v[192:193], v[184:185] op_sel_hi:[0,1,1] neg_lo:[0,0,1] neg_hi:[0,0,1]
v_pk_fma_f32 v[186:187], v[196:197], v[194:195], v[186:187] op_sel_hi:[0,1,1] neg_lo:[0,0,1] neg_hi:[0,0,1]
v_cvt_pk_bf16_f32 v64, v180, v181
v_cvt_pk_bf16_f32 v65, v182, v183
v_cvt_pk_bf16_f32 v66, v184, v185
v_cvt_pk_bf16_f32 v67, v186, v187
v_pk_fma_f32 v[188:189], v[196:197], v[180:181], v[188:189] op_sel_hi:[0,1,1] neg_lo:[0,0,1] neg_hi:[0,0,1]
v_pk_fma_f32 v[190:191], v[196:197], v[182:183], v[190:191] op_sel_hi:[0,1,1] neg_lo:[0,0,1] neg_hi:[0,0,1]
v_pk_fma_f32 v[192:193], v[196:197], v[184:185], v[192:193] op_sel_hi:[0,1,1] neg_lo:[0,0,1] neg_hi:[0,0,1]
v_pk_fma_f32 v[194:195], v[196:197], v[186:187], v[194:195] op_sel_hi:[0,1,1] neg_lo:[0,0,1] neg_hi:[0,0,1]
v_cvt_pk_bf16_f32 v68, v188, v189
v_cvt_pk_bf16_f32 v69, v190, v191
v_cvt_pk_bf16_f32 v70, v192, v193
v_cvt_pk_bf16_f32 v71, v194, v195
v_pk_fma_f32 v[180:181], v[196:197], v[188:189], v[180:181] op_sel_hi:[0,1,1] neg_lo:[0,0,1] neg_hi:[0,0,1]
v_pk_fma_f32 v[182:183], v[196:197], v[190:191], v[182:183] op_sel_hi:[0,1,1] neg_lo:[0,0,1] neg_hi:[0,0,1]
v_pk_fma_f32 v[184:185], v[196:197], v[192:193], v[184:185] op_sel_hi:[0,1,1] neg_lo:[0,0,1] neg_hi:[0,0,1]
v_pk_fma_f32 v[186:187], v[196:197], v[194:195], v[186:187] op_sel_hi:[0,1,1] neg_lo:[0,0,1] neg_hi:[0,0,1]
v_cvt_pk_bf16_f32 v72, v180, v181
v_cvt_pk_bf16_f32 v73, v182, v183
v_cvt_pk_bf16_f32 v74, v184, v185
v_cvt_pk_bf16_f32 v75, v186, v187
v_pk_fma_f32 v[188:189], v[196:197], v[180:181], v[188:189] op_sel_hi:[0,1,1] neg_lo:[0,0,1] neg_hi:[0,0,1]
v_pk_fma_f32 v[190:191], v[196:197], v[182:183], v[190:191] op_sel_hi:[0,1,1] neg_lo:[0,0,1] neg_hi:[0,0,1]
v_pk_fma_f32 v[192:193], v[196:197], v[184:185], v[192:193] op_sel_hi:[0,1,1] neg_lo:[0,0,1] neg_hi:[0,0,1]
v_pk_fma_f32 v[194:195], v[196:197], v[186:187], v[194:195] op_sel_hi:[0,1,1] neg_lo:[0,0,1] neg_hi:[0,0,1]
v_cvt_pk_bf16_f32 v76, v188, v189
v_cvt_pk_bf16_f32 v77, v190, v191
v_cvt_pk_bf16_f32 v78, v192, v193
v_cvt_pk_bf16_f32 v79, v194, v195
v_pk_fma_f32 v[180:181], v[196:197], v[188:189], v[180:181] op_sel_hi:[0,1,1] neg_lo:[0,0,1] neg_hi:[0,0,1]
v_pk_fma_f32 v[182:183], v[196:197], v[190:191], v[182:183] op_sel_hi:[0,1,1] neg_lo:[0,0,1] neg_hi:[0,0,1]
v_pk_fma_f32 v[184:185], v[196:197], v[192:193], v[184:185] op_sel_hi:[0,1,1] neg_lo:[0,0,1] neg_hi:[0,0,1]
v_pk_fma_f32 v[186:187], v[196:197], v[194:195], v[186:187] op_sel_hi:[0,1,1] neg_lo:[0,0,1] neg_hi:[0,0,1]
v_cvt_pk_bf16_f32 v80, v180, v181
v_cvt_pk_bf16_f32 v81, v182, v183
v_cvt_pk_bf16_f32 v82, v184, v185
v_cvt_pk_bf16_f32 v83, v186, v187
v_pk_fma_f32 v[188:189], v[196:197], v[180:181], v[188:189] op_sel_hi:[0,1,1] neg_lo:[0,0,1] neg_hi:[0,0,1]
v_pk_fma_f32 v[190:191], v[196:197], v[182:183], v[190:191] op_sel_hi:[0,1,1] neg_lo:[0,0,1] neg_hi:[0,0,1]
v_pk_fma_f32 v[192:193], v[196:197], v[184:185], v[192:193] op_sel_hi:[0,1,1] neg_lo:[0,0,1] neg_hi:[0,0,1]
v_pk_fma_f32 v[194:195], v[196:197], v[186:187], v[194:195] op_sel_hi:[0,1,1] neg_lo:[0,0,1] neg_hi:[0,0,1]
v_cvt_pk_bf16_f32 v84, v188, v189
v_cvt_pk_bf16_f32 v85, v190, v191
v_cvt_pk_bf16_f32 v86, v192, v193
v_cvt_pk_bf16_f32 v87, v194, v195
v_pk_fma_f32 v[180:181], v[196:197], v[188:189], v[180:181] op_sel_hi:[0,1,1] neg_lo:[0,0,1] neg_hi:[0,0,1]
v_pk_fma_f32 v[182:183], v[196:197], v[190:191], v[182:183] op_sel_hi:[0,1,1] neg_lo:[0,0,1] neg_hi:[0,0,1]
v_pk_fma_f32 v[184:185], v[196:197], v[192:193], v[184:185] op_sel_hi:[0,1,1] neg_lo:[0,0,1] neg_hi:[0,0,1]
v_pk_fma_f32 v[186:187], v[196:197], v[194:195], v[186:187] op_sel_hi:[0,1,1] neg_lo:[0,0,1] neg_hi:[0,0,1]
v_cvt_pk_bf16_f32 v88, v180, v181
v_cvt_pk_bf16_f32 v89, v182, v183
v_cvt_pk_bf16_f32 v90, v184, v185
v_cvt_pk_bf16_f32 v91, v186, v187
v_pk_fma_f32 v[188:189], v[196:197], v[180:181], v[188:189] op_sel_hi:[0,1,1] neg_lo:[0,0,1] neg_hi:[0,0,1]
v_pk_fma_f32 v[190:191], v[196:197], v[182:183], v[190:191] op_sel_hi:[0,1,1] neg_lo:[0,0,1] neg_hi:[0,0,1]
v_pk_fma_f32 v[192:193], v[196:197], v[184:185], v[192:193] op_sel_hi:[0,1,1] neg_lo:[0,0,1] neg_hi:[0,0,1]
v_pk_fma_f32 v[194:195], v[196:197], v[186:187], v[194:195] op_sel_hi:[0,1,1] neg_lo:[0,0,1] neg_hi:[0,0,1]
v_cvt_pk_bf16_f32 v92, v188, v189
v_cvt_pk_bf16_f32 v93, v190, v191
v_cvt_pk_bf16_f32 v94, v192, v193
v_cvt_pk_bf16_f32 v95, v194, v195
s_mov_b32 s20, 323
v_mad_u32_u24 v183, v200, s20, v201
v_cvt_f32_u32 v183, v183
v_mul_f32 v202, s19, v183
v_rndne_f32 v202, v202
v_fmac_f32 v183, 0xc4200000, v202
v_mul_f32 v183, s19, v183
v_cos_f32 v183, v183
s_mov_b32 s20, 324
v_mad_u32_u24 v184, v200, s20, v201
v_cvt_f32_u32 v184, v184
v_mul_f32 v202, s19, v184
v_rndne_f32 v202, v202
v_fmac_f32 v184, 0xc4200000, v202
v_mul_f32 v184, s19, v184
v_cos_f32 v184, v184
s_nop 0
v_fma_f32 v185, v198, v184, -v183
v_fma_f32 v182, v198, v183, -v184
v_fma_f32 v186, v198, v185, -v184
v_fma_f32 v181, v198, v182, -v183
v_fma_f32 v187, v198, v186, -v185
v_fma_f32 v180, v198, v181, -v182
v_cvt_pk_bf16_f32 v96, v180, v181
v_cvt_pk_bf16_f32 v97, v182, v183
v_cvt_pk_bf16_f32 v98, v184, v185
v_cvt_pk_bf16_f32 v99, v186, v187
s_mov_b32 s20, 339
v_mad_u32_u24 v191, v200, s20, v201
v_cvt_f32_u32 v191, v191
v_mul_f32 v202, s19, v191
v_rndne_f32 v202, v202
v_fmac_f32 v191, 0xc4200000, v202
v_mul_f32 v191, s19, v191
v_cos_f32 v191, v191
s_mov_b32 s20, 340
v_mad_u32_u24 v192, v200, s20, v201
v_cvt_f32_u32 v192, v192
v_mul_f32 v202, s19, v192
v_rndne_f32 v202, v202
v_fmac_f32 v192, 0xc4200000, v202
v_mul_f32 v192, s19, v192
v_cos_f32 v192, v192
s_nop 0
v_fma_f32 v193, v198, v192, -v191
v_fma_f32 v190, v198, v191, -v192
v_fma_f32 v194, v198, v193, -v192
v_fma_f32 v189, v198, v190, -v191
v_fma_f32 v195, v198, v194, -v193
v_fma_f32 v188, v198, v189, -v190
v_cvt_pk_bf16_f32 v100, v188, v189
v_cvt_pk_bf16_f32 v101, v190, v191
v_cvt_pk_bf16_f32 v102, v192, v193
v_cvt_pk_bf16_f32 v103, v194, v195
v_pk_fma_f32 v[180:181], v[196:197], v[188:189], v[180:181] op_sel_hi:[0,1,1] neg_lo:[0,0,1] neg_hi:[0,0,1]
v_pk_fma_f32 v[182:183], v[196:197], v[190:191], v[182:183] op_sel_hi:[0,1,1] neg_lo:[0,0,1] neg_hi:[0,0,1]
v_pk_fma_f32 v[184:185], v[196:197], v[192:193], v[184:185] op_sel_hi:[0,1,1] neg_lo:[0,0,1] neg_hi:[0,0,1]
v_pk_fma_f32 v[186:187], v[196:197], v[194:195], v[186:187] op_sel_hi:[0,1,1] neg_lo:[0,0,1] neg_hi:[0,0,1]
v_cvt_pk_bf16_f32 v104, v180, v181
v_cvt_pk_bf16_f32 v105, v182, v183
v_cvt_pk_bf16_f32 v106, v184, v185
v_cvt_pk_bf16_f32 v107, v186, v187
v_pk_fma_f32 v[188:189], v[196:197], v[180:181], v[188:189] op_sel_hi:[0,1,1] neg_lo:[0,0,1] neg_hi:[0,0,1]
v_pk_fma_f32 v[190:191], v[196:197], v[182:183], v[190:191] op_sel_hi:[0,1,1] neg_lo:[0,0,1] neg_hi:[0,0,1]
v_pk_fma_f32 v[192:193], v[196:197], v[184:185], v[192:193] op_sel_hi:[0,1,1] neg_lo:[0,0,1] neg_hi:[0,0,1]
v_pk_fma_f32 v[194:195], v[196:197], v[186:187], v[194:195] op_sel_hi:[0,1,1] neg_lo:[0,0,1] neg_hi:[0,0,1]
v_cvt_pk_bf16_f32 v108, v188, v189
v_cvt_pk_bf16_f32 v109, v190, v191
v_cvt_pk_bf16_f32 v110, v192, v193
v_cvt_pk_bf16_f32 v111, v194, v195
v_pk_fma_f32 v[180:181], v[196:197], v[188:189], v[180:181] op_sel_hi:[0,1,1] neg_lo:[0,0,1] neg_hi:[0,0,1]
v_pk_fma_f32 v[182:183], v[196:197], v[190:191], v[182:183] op_sel_hi:[0,1,1] neg_lo:[0,0,1] neg_hi:[0,0,1]
v_pk_fma_f32 v[184:185], v[196:197], v[192:193], v[184:185] op_sel_hi:[0,1,1] neg_lo:[0,0,1] neg_hi:[0,0,1]
v_pk_fma_f32 v[186:187], v[196:197], v[194:195], v[186:187] op_sel_hi:[0,1,1] neg_lo:[0,0,1] neg_hi:[0,0,1]
v_cvt_pk_bf16_f32 v112, v180, v181
v_cvt_pk_bf16_f32 v113, v182, v183
v_cvt_pk_bf16_f32 v114, v184, v185
v_cvt_pk_bf16_f32 v115, v186, v187
v_pk_fma_f32 v[188:189], v[196:197], v[180:181], v[188:189] op_sel_hi:[0,1,1] neg_lo:[0,0,1] neg_hi:[0,0,1]
v_pk_fma_f32 v[190:191], v[196:197], v[182:183], v[190:191] op_sel_hi:[0,1,1] neg_lo:[0,0,1] neg_hi:[0,0,1]
v_pk_fma_f32 v[192:193], v[196:197], v[184:185], v[192:193] op_sel_hi:[0,1,1] neg_lo:[0,0,1] neg_hi:[0,0,1]
v_pk_fma_f32 v[194:195], v[196:197], v[186:187], v[194:195] op_sel_hi:[0,1,1] neg_lo:[0,0,1] neg_hi:[0,0,1]
v_cvt_pk_bf16_f32 v116, v188, v189
v_cvt_pk_bf16_f32 v117, v190, v191
v_cvt_pk_bf16_f32 v118, v192, v193
v_cvt_pk_bf16_f32 v119, v194, v195
v_pk_fma_f32 v[180:181], v[196:197], v[188:189], v[180:181] op_sel_hi:[0,1,1] neg_lo:[0,0,1] neg_hi:[0,0,1]
v_pk_fma_f32 v[182:183], v[196:197], v[190:191], v[182:183] op_sel_hi:[0,1,1] neg_lo:[0,0,1] neg_hi:[0,0,1]
v_pk_fma_f32 v[184:185], v[196:197], v[192:193], v[184:185] op_sel_hi:[0,1,1] neg_lo:[0,0,1] neg_hi:[0,0,1]
v_pk_fma_f32 v[186:187], v[196:197], v[194:195], v[186:187] op_sel_hi:[0,1,1] neg_lo:[0,0,1] neg_hi:[0,0,1]
v_cvt_pk_bf16_f32 v120, v180, v181
v_cvt_pk_bf16_f32 v121, v182, v183
v_cvt_pk_bf16_f32 v122, v184, v185
v_cvt_pk_bf16_f32 v123, v186, v187
v_pk_fma_f32 v[188:189], v[196:197], v[180:181], v[188:189] op_sel_hi:[0,1,1] neg_lo:[0,0,1] neg_hi:[0,0,1]
v_pk_fma_f32 v[190:191], v[196:197], v[182:183], v[190:191] op_sel_hi:[0,1,1] neg_lo:[0,0,1] neg_hi:[0,0,1]
v_pk_fma_f32 v[192:193], v[196:197], v[184:185], v[192:193] op_sel_hi:[0,1,1] neg_lo:[0,0,1] neg_hi:[0,0,1]
v_pk_fma_f32 v[194:195], v[196:197], v[186:187], v[194:195] op_sel_hi:[0,1,1] neg_lo:[0,0,1] neg_hi:[0,0,1]
v_cvt_pk_bf16_f32 v124, v188, v189
v_cvt_pk_bf16_f32 v125, v190, v191
v_cvt_pk_bf16_f32 v126, v192, v193
v_cvt_pk_bf16_f32 v127, v194, v195
v_pk_fma_f32 v[180:181], v[196:197], v[188:189], v[180:181] op_sel_hi:[0,1,1] neg_lo:[0,0,1] neg_hi:[0,0,1]
v_pk_fma_f32 v[182:183], v[196:197], v[190:191], v[182:183] op_sel_hi:[0,1,1] neg_lo:[0,0,1] neg_hi:[0,0,1]
v_pk_fma_f32 v[184:185], v[196:197], v[192:193], v[184:185] op_sel_hi:[0,1,1] neg_lo:[0,0,1] neg_hi:[0,0,1]
v_pk_fma_f32 v[186:187], v[196:197], v[194:195], v[186:187] op_sel_hi:[0,1,1] neg_lo:[0,0,1] neg_hi:[0,0,1]
v_cvt_pk_bf16_f32 v128, v180, v181
v_cvt_pk_bf16_f32 v129, v182, v183
v_cvt_pk_bf16_f32 v130, v184, v185
v_cvt_pk_bf16_f32 v131, v186, v187
v_pk_fma_f32 v[188:189], v[196:197], v[180:181], v[188:189] op_sel_hi:[0,1,1] neg_lo:[0,0,1] neg_hi:[0,0,1]
v_pk_fma_f32 v[190:191], v[196:197], v[182:183], v[190:191] op_sel_hi:[0,1,1] neg_lo:[0,0,1] neg_hi:[0,0,1]
v_pk_fma_f32 v[192:193], v[196:197], v[184:185], v[192:193] op_sel_hi:[0,1,1] neg_lo:[0,0,1] neg_hi:[0,0,1]
v_pk_fma_f32 v[194:195], v[196:197], v[186:187], v[194:195] op_sel_hi:[0,1,1] neg_lo:[0,0,1] neg_hi:[0,0,1]
v_cvt_pk_bf16_f32 v132, v188, v189
v_cvt_pk_bf16_f32 v133, v190, v191
v_cvt_pk_bf16_f32 v134, v192, v193
v_cvt_pk_bf16_f32 v135, v194, v195
v_pk_fma_f32 v[180:181], v[196:197], v[188:189], v[180:181] op_sel_hi:[0,1,1] neg_lo:[0,0,1] neg_hi:[0,0,1]
v_pk_fma_f32 v[182:183], v[196:197], v[190:191], v[182:183] op_sel_hi:[0,1,1] neg_lo:[0,0,1] neg_hi:[0,0,1]
v_pk_fma_f32 v[184:185], v[196:197], v[192:193], v[184:185] op_sel_hi:[0,1,1] neg_lo:[0,0,1] neg_hi:[0,0,1]
v_pk_fma_f32 v[186:187], v[196:197], v[194:195], v[186:187] op_sel_hi:[0,1,1] neg_lo:[0,0,1] neg_hi:[0,0,1]
v_cvt_pk_bf16_f32 v136, v180, v181
v_cvt_pk_bf16_f32 v137, v182, v183
v_cvt_pk_bf16_f32 v138, v184, v185
v_cvt_pk_bf16_f32 v139, v186, v187
v_pk_fma_f32 v[188:189], v[196:197], v[180:181], v[188:189] op_sel_hi:[0,1,1] neg_lo:[0,0,1] neg_hi:[0,0,1]
v_pk_fma_f32 v[190:191], v[196:197], v[182:183], v[190:191] op_sel_hi:[0,1,1] neg_lo:[0,0,1] neg_hi:[0,0,1]
v_pk_fma_f32 v[192:193], v[196:197], v[184:185], v[192:193] op_sel_hi:[0,1,1] neg_lo:[0,0,1] neg_hi:[0,0,1]
v_pk_fma_f32 v[194:195], v[196:197], v[186:187], v[194:195] op_sel_hi:[0,1,1] neg_lo:[0,0,1] neg_hi:[0,0,1]
v_cvt_pk_bf16_f32 v140, v188, v189
v_cvt_pk_bf16_f32 v141, v190, v191
v_cvt_pk_bf16_f32 v142, v192, v193
v_cvt_pk_bf16_f32 v143, v194, v195
v_pk_fma_f32 v[180:181], v[196:197], v[188:189], v[180:181] op_sel_hi:[0,1,1] neg_lo:[0,0,1] neg_hi:[0,0,1]
v_pk_fma_f32 v[182:183], v[196:197], v[190:191], v[182:183] op_sel_hi:[0,1,1] neg_lo:[0,0,1] neg_hi:[0,0,1]
v_pk_fma_f32 v[184:185], v[196:197], v[192:193], v[184:185] op_sel_hi:[0,1,1] neg_lo:[0,0,1] neg_hi:[0,0,1]
v_pk_fma_f32 v[186:187], v[196:197], v[194:195], v[186:187] op_sel_hi:[0,1,1] neg_lo:[0,0,1] neg_hi:[0,0,1]
v_cvt_pk_bf16_f32 v144, v180, v181
v_cvt_pk_bf16_f32 v145, v182, v183
v_cvt_pk_bf16_f32 v146, v184, v185
v_cvt_pk_bf16_f32 v147, v186, v187
v_pk_fma_f32 v[188:189], v[196:197], v[180:181], v[188:189] op_sel_hi:[0,1,1] neg_lo:[0,0,1] neg_hi:[0,0,1]
v_pk_fma_f32 v[190:191], v[196:197], v[182:183], v[190:191] op_sel_hi:[0,1,1] neg_lo:[0,0,1] neg_hi:[0,0,1]
v_pk_fma_f32 v[192:193], v[196:197], v[184:185], v[192:193] op_sel_hi:[0,1,1] neg_lo:[0,0,1] neg_hi:[0,0,1]
v_pk_fma_f32 v[194:195], v[196:197], v[186:187], v[194:195] op_sel_hi:[0,1,1] neg_lo:[0,0,1] neg_hi:[0,0,1]
v_cvt_pk_bf16_f32 v148, v188, v189
v_cvt_pk_bf16_f32 v149, v190, v191
v_cvt_pk_bf16_f32 v150, v192, v193
v_cvt_pk_bf16_f32 v151, v194, v195
v_pk_fma_f32 v[180:181], v[196:197], v[188:189], v[180:181] op_sel_hi:[0,1,1] neg_lo:[0,0,1] neg_hi:[0,0,1]
v_pk_fma_f32 v[182:183], v[196:197], v[190:191], v[182:183] op_sel_hi:[0,1,1] neg_lo:[0,0,1] neg_hi:[0,0,1]
v_pk_fma_f32 v[184:185], v[196:197], v[192:193], v[184:185] op_sel_hi:[0,1,1] neg_lo:[0,0,1] neg_hi:[0,0,1]
v_pk_fma_f32 v[186:187], v[196:197], v[194:195], v[186:187] op_sel_hi:[0,1,1] neg_lo:[0,0,1] neg_hi:[0,0,1]
v_cvt_pk_bf16_f32 v152, v180, v181
v_cvt_pk_bf16_f32 v153, v182, v183
v_cvt_pk_bf16_f32 v154, v184, v185
v_cvt_pk_bf16_f32 v155, v186, v187
v_pk_fma_f32 v[188:189], v[196:197], v[180:181], v[188:189] op_sel_hi:[0,1,1] neg_lo:[0,0,1] neg_hi:[0,0,1]
v_pk_fma_f32 v[190:191], v[196:197], v[182:183], v[190:191] op_sel_hi:[0,1,1] neg_lo:[0,0,1] neg_hi:[0,0,1]
v_pk_fma_f32 v[192:193], v[196:197], v[184:185], v[192:193] op_sel_hi:[0,1,1] neg_lo:[0,0,1] neg_hi:[0,0,1]
v_pk_fma_f32 v[194:195], v[196:197], v[186:187], v[194:195] op_sel_hi:[0,1,1] neg_lo:[0,0,1] neg_hi:[0,0,1]
v_cvt_pk_bf16_f32 v156, v188, v189
v_cvt_pk_bf16_f32 v157, v190, v191
v_cvt_pk_bf16_f32 v158, v192, v193
v_cvt_pk_bf16_f32 v159, v194, v195
v_pk_fma_f32 v[180:181], v[196:197], v[188:189], v[180:181] op_sel_hi:[0,1,1] neg_lo:[0,0,1] neg_hi:[0,0,1]
v_pk_fma_f32 v[182:183], v[196:197], v[190:191], v[182:183] op_sel_hi:[0,1,1] neg_lo:[0,0,1] neg_hi:[0,0,1]
v_pk_fma_f32 v[184:185], v[196:197], v[192:193], v[184:185] op_sel_hi:[0,1,1] neg_lo:[0,0,1] neg_hi:[0,0,1]
v_pk_fma_f32 v[186:187], v[196:197], v[194:195], v[186:187] op_sel_hi:[0,1,1] neg_lo:[0,0,1] neg_hi:[0,0,1]
v_cvt_pk_bf16_f32 v160, v180, v181
v_cvt_pk_bf16_f32 v161, v182, v183
v_cvt_pk_bf16_f32 v162, v184, v185
v_cvt_pk_bf16_f32 v163, v186, v187
v_pk_fma_f32 v[188:189], v[196:197], v[180:181], v[188:189] op_sel_hi:[0,1,1] neg_lo:[0,0,1] neg_hi:[0,0,1]
v_pk_fma_f32 v[190:191], v[196:197], v[182:183], v[190:191] op_sel_hi:[0,1,1] neg_lo:[0,0,1] neg_hi:[0,0,1]
v_pk_fma_f32 v[192:193], v[196:197], v[184:185], v[192:193] op_sel_hi:[0,1,1] neg_lo:[0,0,1] neg_hi:[0,0,1]
v_pk_fma_f32 v[194:195], v[196:197], v[186:187], v[194:195] op_sel_hi:[0,1,1] neg_lo:[0,0,1] neg_hi:[0,0,1]
v_cvt_pk_bf16_f32 v164, v188, v189
v_cvt_pk_bf16_f32 v165, v190, v191
v_cvt_pk_bf16_f32 v166, v192, v193
v_cvt_pk_bf16_f32 v167, v194, v195
v_pk_fma_f32 v[180:181], v[196:197], v[188:189], v[180:181] op_sel_hi:[0,1,1] neg_lo:[0,0,1] neg_hi:[0,0,1]
v_pk_fma_f32 v[182:183], v[196:197], v[190:191], v[182:183] op_sel_hi:[0,1,1] neg_lo:[0,0,1] neg_hi:[0,0,1]
v_pk_fma_f32 v[184:185], v[196:197], v[192:193], v[184:185] op_sel_hi:[0,1,1] neg_lo:[0,0,1] neg_hi:[0,0,1]
v_pk_fma_f32 v[186:187], v[196:197], v[194:195], v[186:187] op_sel_hi:[0,1,1] neg_lo:[0,0,1] neg_hi:[0,0,1]
v_cvt_pk_bf16_f32 v168, v180, v181
v_cvt_pk_bf16_f32 v169, v182, v183
v_cvt_pk_bf16_f32 v170, v184, v185
v_cvt_pk_bf16_f32 v171, v186, v187
v_pk_fma_f32 v[188:189], v[196:197], v[180:181], v[188:189] op_sel_hi:[0,1,1] neg_lo:[0,0,1] neg_hi:[0,0,1]
v_pk_fma_f32 v[190:191], v[196:197], v[182:183], v[190:191] op_sel_hi:[0,1,1] neg_lo:[0,0,1] neg_hi:[0,0,1]
v_pk_fma_f32 v[192:193], v[196:197], v[184:185], v[192:193] op_sel_hi:[0,1,1] neg_lo:[0,0,1] neg_hi:[0,0,1]
v_pk_fma_f32 v[194:195], v[196:197], v[186:187], v[194:195] op_sel_hi:[0,1,1] neg_lo:[0,0,1] neg_hi:[0,0,1]
v_cvt_pk_bf16_f32 v172, v188, v189
v_cvt_pk_bf16_f32 v173, v190, v191
v_cvt_pk_bf16_f32 v174, v192, v193
v_cvt_pk_bf16_f32 v175, v194, v195
v_mov_b32 v180, s24
v_mov_b32 v181, s24
v_mov_b32 v182, s24
v_mov_b32 v183, s24
s_nop 1
v_mfma_f32_32x32x16_bf16 v[184:199], v[180:183], v[16:19], 0
v_mfma_f32_32x32x16_bf16 v[184:199], v[180:183], v[20:23], v[184:199]
v_mfma_f32_32x32x16_bf16 v[184:199], v[180:183], v[24:27], v[184:199]
v_mfma_f32_32x32x16_bf16 v[184:199], v[180:183], v[28:31], v[184:199]
v_mfma_f32_32x32x16_bf16 v[184:199], v[180:183], v[32:35], v[184:199]
v_mfma_f32_32x32x16_bf16 v[184:199], v[180:183], v[36:39], v[184:199]
v_mfma_f32_32x32x16_bf16 v[184:199], v[180:183], v[40:43], v[184:199]
v_mfma_f32_32x32x16_bf16 v[184:199], v[180:183], v[44:47], v[184:199]
v_mfma_f32_32x32x16_bf16 v[184:199], v[180:183], v[48:51], v[184:199]
v_mfma_f32_32x32x16_bf16 v[184:199], v[180:183], v[52:55], v[184:199]
v_mfma_f32_32x32x16_bf16 v[184:199], v[180:183], v[56:59], v[184:199]
v_mfma_f32_32x32x16_bf16 v[184:199], v[180:183], v[60:63], v[184:199]
v_mfma_f32_32x32x16_bf16 v[184:199], v[180:183], v[64:67], v[184:199]
v_mfma_f32_32x32x16_bf16 v[184:199], v[180:183], v[68:71], v[184:199]
v_mfma_f32_32x32x16_bf16 v[184:199], v[180:183], v[72:75], v[184:199]
v_mfma_f32_32x32x16_bf16 v[184:199], v[180:183], v[76:79], v[184:199]
v_mfma_f32_32x32x16_bf16 v[184:199], v[180:183], v[80:83], v[184:199]
v_mfma_f32_32x32x16_bf16 v[184:199], v[180:183], v[84:87], v[184:199]
v_mfma_f32_32x32x16_bf16 v[184:199], v[180:183], v[88:91], v[184:199]
v_mfma_f32_32x32x16_bf16 v[184:199], v[180:183], v[92:95], v[184:199]
v_mfma_f32_32x32x16_bf16 v[184:199], v[180:183], v[96:99], v[184:199]
v_mfma_f32_32x32x16_bf16 v[184:199], v[180:183], v[100:103], v[184:199]
v_mfma_f32_32x32x16_bf16 v[184:199], v[180:183], v[104:107], v[184:199]
v_mfma_f32_32x32x16_bf16 v[184:199], v[180:183], v[108:111], v[184:199]
v_mfma_f32_32x32x16_bf16 v[184:199], v[180:183], v[112:115], v[184:199]
v_mfma_f32_32x32x16_bf16 v[184:199], v[180:183], v[116:119], v[184:199]
v_mfma_f32_32x32x16_bf16 v[184:199], v[180:183], v[120:123], v[184:199]
v_mfma_f32_32x32x16_bf16 v[184:199], v[180:183], v[124:127], v[184:199]
v_mfma_f32_32x32x16_bf16 v[184:199], v[180:183], v[128:131], v[184:199]
v_mfma_f32_32x32x16_bf16 v[184:199], v[180:183], v[132:135], v[184:199]
v_mfma_f32_32x32x16_bf16 v[184:199], v[180:183], v[136:139], v[184:199]
v_mfma_f32_32x32x16_bf16 v[184:199], v[180:183], v[140:143], v[184:199]
v_mfma_f32_32x32x16_bf16 v[184:199], v[180:183], v[144:147], v[184:199]
v_mfma_f32_32x32x16_bf16 v[184:199], v[180:183], v[148:151], v[184:199]
v_mfma_f32_32x32x16_bf16 v[184:199], v[180:183], v[152:155], v[184:199]
v_mfma_f32_32x32x16_bf16 v[184:199], v[180:183], v[156:159], v[184:199]
v_mfma_f32_32x32x16_bf16 v[184:199], v[180:183], v[160:163], v[184:199]
v_mfma_f32_32x32x16_bf16 v[184:199], v[180:183], v[164:167], v[184:199]
v_mfma_f32_32x32x16_bf16 v[184:199], v[180:183], v[168:171], v[184:199]
v_mfma_f32_32x32x16_bf16 v[184:199], v[180:183], v[172:175], v[184:199]
s_nop 11
v_mov_b32 v7, v184
s_lshl_b32 s18, s34, 2
s_add_u32 s18, s18, s13
s_lshl_b32 s33, s18, 11
s_mul_i32 s27, s50, 40960
s_add_u32 s27, s27, s33
s_add_u32 s27, s27, 97517568
s_mov_b32 s28, 0
s_waitcnt vmcnt(0)
p1_49:
s_barrier
s_lshl_b32 s18, s13, 5
v_xor_b32 v2, s18, v176
ds_read_b128 v[220:223], v2 offset:2048
ds_read_b128 v[224:227], v2 offset:6144
ds_read_b128 v[228:231], v2 offset:10240
ds_read_b128 v[200:203], v177 offset:2048
v_mov_b64 v[212:213], 0
ds_read_b128 v[232:235], v2 offset:14336
ds_read_b128 v[204:207], v178 offset:2048
ds_read_b128 v[196:199], v176 offset:2048
ds_read_b128 v[208:211], v179 offset:2048
s_waitcnt lgkmcnt(7)
v_dot2c_f32_bf16 v212, s24, v220
v_dot2c_f32_bf16 v213, v220, v220
v_dot2c_f32_bf16 v212, s24, v221
v_dot2c_f32_bf16 v213, v221, v221
s_waitcnt lgkmcnt(6)
v_dot2c_f32_bf16 v212, s24, v222
v_dot2c_f32_bf16 v213, v222, v222
v_dot2c_f32_bf16 v212, s24, v223
v_dot2c_f32_bf16 v213, v223, v223
v_dot2c_f32_bf16 v212, s24, v224
v_dot2c_f32_bf16 v213, v224, v224
v_dot2c_f32_bf16 v212, s24, v225
v_dot2c_f32_bf16 v213, v225, v225
v_dot2c_f32_bf16 v212, s24, v226
v_dot2c_f32_bf16 v213, v226, v226
v_dot2c_f32_bf16 v212, s24, v227
v_dot2c_f32_bf16 v213, v227, v227
s_waitcnt lgkmcnt(5)
s_waitcnt lgkmcnt(3)
ds_read_b128 v[220:223], v2 offset:18432
ds_read_b128 v[224:227], v2 offset:22528
v_dot2c_f32_bf16 v212, s24, v228
v_dot2c_f32_bf16 v213, v228, v228
v_dot2c_f32_bf16 v212, s24, v229
v_dot2c_f32_bf16 v213, v229, v229
v_dot2c_f32_bf16 v212, s24, v230
v_dot2c_f32_bf16 v213, v230, v230
v_dot2c_f32_bf16 v212, s24, v231
v_dot2c_f32_bf16 v213, v231, v231
v_dot2c_f32_bf16 v212, s24, v232
v_dot2c_f32_bf16 v213, v232, v232
v_dot2c_f32_bf16 v212, s24, v233
v_dot2c_f32_bf16 v213, v233, v233
v_dot2c_f32_bf16 v212, s24, v234
v_dot2c_f32_bf16 v213, v234, v234
v_dot2c_f32_bf16 v212, s24, v235
v_dot2c_f32_bf16 v213, v235, v235
s_waitcnt lgkmcnt(1)
ds_read_b128 v[232:235], v2 offset:30720
ds_read_b128 v[228:231], v2 offset:26624
v_dot2c_f32_bf16 v212, s24, v220
v_dot2c_f32_bf16 v213, v220, v220
v_dot2c_f32_bf16 v212, s24, v221
v_dot2c_f32_bf16 v213, v221, v221
v_dot2c_f32_bf16 v212, s24, v222
v_dot2c_f32_bf16 v213, v222, v222
s_waitcnt lgkmcnt(2)
v_dot2c_f32_bf16 v212, s24, v223
v_dot2c_f32_bf16 v213, v223, v223
v_dot2c_f32_bf16 v212, s24, v224
v_dot2c_f32_bf16 v213, v224, v224
v_dot2c_f32_bf16 v212, s24, v225
v_dot2c_f32_bf16 v213, v225, v225
v_dot2c_f32_bf16 v212, s24, v226
v_dot2c_f32_bf16 v213, v226, v226
v_dot2c_f32_bf16 v212, s24, v227
v_dot2c_f32_bf16 v213, v227, v227
s_waitcnt lgkmcnt(1)
s_waitcnt lgkmcnt(0)
ds_read_b128 v[220:223], v2 offset:34816
ds_read_b128 v[224:227], v2 offset:38912
v_dot2c_f32_bf16 v212, s24, v228
v_dot2c_f32_bf16 v213, v228, v228
v_dot2c_f32_bf16 v212, s24, v229
v_dot2c_f32_bf16 v213, v229, v229
v_dot2c_f32_bf16 v212, s24, v230
v_dot2c_f32_bf16 v213, v230, v230
v_dot2c_f32_bf16 v212, s24, v231
v_dot2c_f32_bf16 v213, v231, v231
v_dot2c_f32_bf16 v212, s24, v232
v_dot2c_f32_bf16 v213, v232, v232
v_dot2c_f32_bf16 v212, s24, v233
v_dot2c_f32_bf16 v213, v233, v233
v_dot2c_f32_bf16 v212, s24, v234
v_dot2c_f32_bf16 v213, v234, v234
v_dot2c_f32_bf16 v212, s24, v235
s_waitcnt lgkmcnt(1)
v_dot2c_f32_bf16 v213, v235, v235
v_dot2c_f32_bf16 v212, s24, v220
v_dot2c_f32_bf16 v213, v220, v220
v_dot2c_f32_bf16 v212, s24, v221
v_dot2c_f32_bf16 v213, v221, v221
s_waitcnt lgkmcnt(0)
v_dot2c_f32_bf16 v212, s24, v222
v_dot2c_f32_bf16 v213, v222, v222
v_dot2c_f32_bf16 v212, s24, v223
v_dot2c_f32_bf16 v213, v223, v223
v_dot2c_f32_bf16 v212, s24, v224
v_dot2c_f32_bf16 v213, v224, v224
v_dot2c_f32_bf16 v212, s24, v225
v_dot2c_f32_bf16 v213, v225, v225
v_dot2c_f32_bf16 v212, s24, v226
v_dot2c_f32_bf16 v213, v226, v226
v_dot2c_f32_bf16 v212, s24, v227
v_dot2c_f32_bf16 v213, v227, v227
v_mfma_f32_32x32x16_bf16 v[180:195], v[196:199], v[16:19], 0
v_and_b32 v2, 0x1ff, v0
ds_read_b128 v[196:199], v176 offset:6144
v_permlane32_swap_b32 v212, v213
v_mfma_f32_32x32x16_bf16 v[180:195], v[200:203], v[20:23], v[180:195]
v_add_f32 v212, v212, v213
v_lshl_add_u32 v213, s13, 2, v0
ds_write_b32 v213, v212 offset:0
v_mfma_f32_32x32x16_bf16 v[180:195], v[204:207], v[24:27], v[180:195]
ds_read_b128 v[200:203], v177 offset:6144
s_waitcnt lgkmcnt(2)
ds_read_b128 v[204:207], v178 offset:6144
v_mfma_f32_32x32x16_bf16 v[180:195], v[208:211], v[28:31], v[180:195]
ds_read_b128 v[208:211], v179 offset:6144
v_mfma_f32_32x32x16_bf16 v[180:195], v[196:199], v[32:35], v[180:195]
s_waitcnt lgkmcnt(3)
s_barrier
ds_read_b128 v[196:199], v176 offset:10240
s_waitcnt lgkmcnt(3)
v_mfma_f32_32x32x16_bf16 v[180:195], v[200:203], v[36:39], v[180:195]
ds_read_b128 v[212:215], v2 offset:0
s_waitcnt lgkmcnt(3)
s_waitcnt lgkmcnt(2)
ds_read_b128 v[200:203], v177 offset:10240
v_mfma_f32_32x32x16_bf16 v[180:195], v[204:207], v[40:43], v[180:195]
s_waitcnt lgkmcnt(2)
ds_read_b128 v[204:207], v178 offset:10240
v_mfma_f32_32x32x16_bf16 v[180:195], v[208:211], v[44:47], v[180:195]
ds_read_b128 v[216:219], v2 offset:512
s_waitcnt lgkmcnt(3)
s_waitcnt lgkmcnt(2)
v_mfma_f32_32x32x16_bf16 v[180:195], v[196:199], v[48:51], v[180:195]
ds_read_b128 v[208:211], v179 offset:10240
v_mfma_f32_32x32x16_bf16 v[180:195], v[200:203], v[52:55], v[180:195]
s_waitcnt lgkmcnt(2)
ds_read_b128 v[196:199], v176 offset:14336
v_add_f32 v212, v212, v213
v_add_f32 v214, v214, v215
v_lshrrev_b32 v213, 2, v0
v_mfma_f32_32x32x16_bf16 v[180:195], v[204:207], v[56:59], v[180:195]
s_waitcnt lgkmcnt(1)
ds_read_b128 v[200:203], v177 offset:14336
ds_read_b128 v[204:207], v178 offset:14336
v_add_f32 v212, v212, v214
v_mfma_f32_32x32x16_bf16 v[180:195], v[208:211], v[60:63], v[180:195]
ds_read_b128 v[208:211], v179 offset:14336
v_bfe_u32 v214, v0, 5, 5
s_waitcnt lgkmcnt(3)
v_and_b32 v214, 16, v214
v_mfma_f32_32x32x16_bf16 v[180:195], v[196:199], v[64:67], v[180:195]
ds_read_b128 v[196:199], v176 offset:18432
v_add_f32 v218, v218, v219
s_waitcnt lgkmcnt(3)
v_mul_f32 v212, 0x3acccccd, v212
v_add_f32 v216, v216, v217
v_mfma_f32_32x32x16_bf16 v[180:195], v[200:203], v[68:71], v[180:195]
ds_read_b128 v[200:203], v177 offset:18432
s_waitcnt lgkmcnt(2)
v_add_f32 v216, v216, v218
v_mul_f32 v216, 0x3acccccd, v216
v_fma_f32 v216, -v212, v212, v216
v_mfma_f32_32x32x16_bf16 v[180:195], v[204:207], v[72:75], v[180:195]
v_max_f32 v216, 0, v216
v_add_f32 v216, 0x3727c5ac, v216
v_mfma_f32_32x32x16_bf16 v[180:195], v[208:211], v[76:79], v[180:195]
s_waitcnt lgkmcnt(1)
ds_read_b128 v[208:211], v179 offset:18432
ds_read_b128 v[204:207], v178 offset:18432
v_lshl_add_u32 v214, s13, 8, v214
s_waitcnt lgkmcnt(2)
v_rsq_f32 v216, v216
v_mfma_f32_32x32x16_bf16 v[180:195], v[196:199], v[80:83], v[180:195]
v_mul_f32 v212, v216, v212
v_lshl_add_u32 v213, s13, 8, v213
s_nop 0
v_permlane32_swap_b32 v216, v212
v_mfma_f32_32x32x16_bf16 v[180:195], v[200:203], v[84:87], v[180:195]
ds_read_b128 v[196:199], v176 offset:22528
ds_read_b128 v[200:203], v177 offset:22528
s_waitcnt lgkmcnt(2)
v_mfma_f32_32x32x16_bf16 v[180:195], v[204:207], v[88:91], v[180:195]
ds_write_b32 v213, v216 offset:1024
ds_read_b128 v[240:243], v214 offset:1184
ds_read_b128 v[204:207], v178 offset:22528
ds_read_b128 v[232:235], v214 offset:1120
v_mfma_f32_32x32x16_bf16 v[180:195], v[208:211], v[92:95], v[180:195]
ds_read_b128 v[208:211], v179 offset:22528
s_waitcnt lgkmcnt(6)
v_mfma_f32_32x32x16_bf16 v[180:195], v[196:199], v[96:99], v[180:195]
s_waitcnt lgkmcnt(5)
ds_read_b128 v[196:199], v176 offset:26624
v_mfma_f32_32x32x16_bf16 v[180:195], v[200:203], v[100:103], v[180:195]
s_waitcnt lgkmcnt(3)
ds_read_b128 v[220:223], v214 offset:1024
v_mfma_f32_32x32x16_bf16 v[180:195], v[204:207], v[104:107], v[180:195]
s_waitcnt lgkmcnt(2)
ds_read_b128 v[204:207], v178 offset:26624
ds_read_b128 v[200:203], v177 offset:26624
ds_read_b128 v[228:231], v214 offset:1088
s_waitcnt lgkmcnt(4)
v_mfma_f32_32x32x16_bf16 v[180:195], v[208:211], v[108:111], v[180:195]
v_mfma_f32_32x32x16_bf16 v[180:195], v[196:199], v[112:115], v[180:195]
ds_read_b128 v[196:199], v176 offset:30720
ds_read_b128 v[208:211], v179 offset:26624
s_waitcnt lgkmcnt(4)
ds_read_b128 v[244:247], v214 offset:1216
s_waitcnt lgkmcnt(4)
ds_read_b128 v[236:239], v214 offset:1152
v_mfma_f32_32x32x16_bf16 v[180:195], v[200:203], v[116:119], v[180:195]
v_mul_f32 v243, v243, v7
ds_read_b128 v[248:251], v214 offset:1248
v_mfma_f32_32x32x16_bf16 v[180:195], v[204:207], v[120:123], v[180:195]
ds_read_b128 v[200:203], v177 offset:30720
s_waitcnt lgkmcnt(4)
v_mfma_f32_32x32x16_bf16 v[180:195], v[208:211], v[124:127], v[180:195]
ds_read_b128 v[208:211], v179 offset:30720
ds_read_b128 v[204:207], v178 offset:30720
v_mul_f32 v240, v240, v7
v_mfma_f32_32x32x16_bf16 v[180:195], v[196:199], v[128:131], v[180:195]
s_waitcnt lgkmcnt(2)
v_mfma_f32_32x32x16_bf16 v[180:195], v[200:203], v[132:135], v[180:195]
ds_read_b128 v[200:203], v177 offset:34816
ds_read_b128 v[196:199], v176 offset:34816
s_waitcnt lgkmcnt(3)
s_waitcnt lgkmcnt(2)
ds_read_b128 v[224:227], v214 offset:1056
v_mfma_f32_32x32x16_bf16 v[180:195], v[204:207], v[136:139], v[180:195]
v_mul_f32 v248, v248, v7
v_mfma_f32_32x32x16_bf16 v[180:195], v[208:211], v[140:143], v[180:195]
ds_read_b128 v[208:211], v179 offset:34816
ds_read_b128 v[204:207], v178 offset:34816
s_waitcnt lgkmcnt(3)
v_mfma_f32_32x32x16_bf16 v[180:195], v[196:199], v[144:147], v[180:195]
v_mfma_f32_32x32x16_bf16 v[180:195], v[200:203], v[148:151], v[180:195]
s_waitcnt lgkmcnt(0)
ds_read_b128 v[196:199], v176 offset:38912
v_mfma_f32_32x32x16_bf16 v[180:195], v[204:207], v[152:155], v[180:195]
ds_read_b128 v[204:207], v178 offset:38912
v_mul_f32 v238, v238, v7
v_mul_f32 v239, v239, v7
ds_read_b128 v[200:203], v177 offset:38912
v_mfma_f32_32x32x16_bf16 v[180:195], v[208:211], v[156:159], v[180:195]
v_mul_f32 v250, v250, v7
v_mul_f32 v247, v247, v7
s_waitcnt lgkmcnt(2)
v_mfma_f32_32x32x16_bf16 v[180:195], v[196:199], v[160:163], v[180:195]
ds_read_b128 v[208:211], v179 offset:38912
v_mul_f32 v249, v249, v7
v_mul_f32 v241, v241, v7
s_waitcnt lgkmcnt(1)
v_mfma_f32_32x32x16_bf16 v[180:195], v[200:203], v[164:167], v[180:195]
v_mul_f32 v237, v237, v7
v_mul_f32 v242, v242, v7
v_mul_f32 v244, v244, v7
v_mul_f32 v246, v246, v7
v_mul_f32 v251, v251, v7
v_mul_f32 v245, v245, v7
v_mfma_f32_32x32x16_bf16 v[180:195], v[204:207], v[168:171], v[180:195]
s_waitcnt lgkmcnt(0)
v_mul_f32 v236, v236, v7
v_mfma_f32_32x32x16_bf16 v[180:195], v[208:211], v[172:175], v[180:195]
s_nop 11
v_pk_fma_f32 v[184:185], v[184:185], v[224:225], v[240:241] neg_lo:[0,0,1] neg_hi:[0,0,1]
v_cvt_pk_bf16_f32 v198, v184, v185
v_pk_fma_f32 v[192:193], v[192:193], v[232:233], v[248:249] neg_lo:[0,0,1] neg_hi:[0,0,1]
v_pk_fma_f32 v[182:183], v[182:183], v[222:223], v[238:239] neg_lo:[0,0,1] neg_hi:[0,0,1]
v_pk_fma_f32 v[194:195], v[194:195], v[234:235], v[250:251] neg_lo:[0,0,1] neg_hi:[0,0,1]
v_pk_fma_f32 v[188:189], v[188:189], v[228:229], v[244:245] neg_lo:[0,0,1] neg_hi:[0,0,1]
v_pk_fma_f32 v[190:191], v[190:191], v[230:231], v[246:247] neg_lo:[0,0,1] neg_hi:[0,0,1]
v_pk_fma_f32 v[186:187], v[186:187], v[226:227], v[242:243] neg_lo:[0,0,1] neg_hi:[0,0,1]
v_cvt_pk_bf16_f32 v203, v194, v195
v_cvt_pk_bf16_f32 v199, v186, v187
v_pk_fma_f32 v[180:181], v[180:181], v[220:221], v[236:237] neg_lo:[0,0,1] neg_hi:[0,0,1]
v_cvt_pk_bf16_f32 v200, v188, v189
v_cvt_pk_bf16_f32 v202, v192, v193
v_cvt_pk_bf16_f32 v197, v182, v183
v_cvt_pk_bf16_f32 v196, v180, v181
v_cvt_pk_bf16_f32 v201, v190, v191
buffer_store_dwordx4 v[196:199], v6, s[4:7], s27 offen offset:0 sc1
buffer_store_dwordx4 v[200:203], v6, s[4:7], s27 offen offset:1024 sc1
v_add_u32 v176, 40960, v176
v_add_u32 v177, 40960, v177
v_add_u32 v178, 40960, v178
v_add_u32 v179, 40960, v179
s_add_u32 s27, s27, 1310720
s_add_u32 s28, s28, 1
s_cmp_lt_u32 s28, 2
s_cbranch_scc1 p1_49
s_lshl_b32 s18, s39, 7
s_add_u32 s18, s18, 11571200
s_cmp_eq_u32 s13, 0
s_cselect_b32 s22, s18, s6
s_mov_b32 s23, 1
alay_50:
v_bfe_u32 v96, v0, 4, 4
v_lshrrev_b32 v97, 8, v0
v_lshlrev_b32 v97, 2, v97
v_lshl_add_u32 v98, s13, 4, v96
v_add_u32 v99, 0, v97
v_mul_u32_u24 v99, v99, v98
v_and_b32 v99, 63, v99
v_cvt_f32_u32 v99, v99
v_mul_f32 v99, 0x3c800000, v99
v_cos_f32 v104, v99
v_sin_f32 v112, v99
v_add_u32 v99, 1, v97
v_mul_u32_u24 v99, v99, v98
v_and_b32 v99, 63, v99
v_cvt_f32_u32 v99, v99
v_mul_f32 v99, 0x3c800000, v99
v_cos_f32 v105, v99
v_sin_f32 v113, v99
v_add_u32 v99, 2, v97
v_mul_u32_u24 v99, v99, v98
v_and_b32 v99, 63, v99
v_cvt_f32_u32 v99, v99
v_mul_f32 v99, 0x3c800000, v99
v_cos_f32 v106, v99
v_sin_f32 v114, v99
v_add_u32 v99, 3, v97
v_mul_u32_u24 v99, v99, v98
v_and_b32 v99, 63, v99
v_cvt_f32_u32 v99, v99
v_mul_f32 v99, 0x3c800000, v99
v_cos_f32 v107, v99
v_sin_f32 v115, v99
v_add_u32 v99, 16, v97
v_mul_u32_u24 v99, v99, v98
v_and_b32 v99, 63, v99
v_cvt_f32_u32 v99, v99
v_mul_f32 v99, 0x3c800000, v99
v_cos_f32 v108, v99
v_sin_f32 v116, v99
v_add_u32 v99, 17, v97
v_mul_u32_u24 v99, v99, v98
v_and_b32 v99, 63, v99
v_cvt_f32_u32 v99, v99
v_mul_f32 v99, 0x3c800000, v99
v_cos_f32 v109, v99
v_sin_f32 v117, v99
v_add_u32 v99, 18, v97
v_mul_u32_u24 v99, v99, v98
v_and_b32 v99, 63, v99
v_cvt_f32_u32 v99, v99
v_mul_f32 v99, 0x3c800000, v99
v_cos_f32 v110, v99
v_sin_f32 v118, v99
v_add_u32 v99, 19, v97
v_mul_u32_u24 v99, v99, v98
v_and_b32 v99, 63, v99
v_cvt_f32_u32 v99, v99
v_mul_f32 v99, 0x3c800000, v99
v_cos_f32 v111, v99
v_sin_f32 v119, v99
v_cvt_pk_bf16_f32 v16, v104, v105
v_cvt_pk_bf16_f32 v24, v112, v113
v_xor_b32 v32, 0x80008000, v24
v_cvt_pk_bf16_f32 v17, v106, v107
v_cvt_pk_bf16_f32 v25, v114, v115
v_xor_b32 v33, 0x80008000, v25
v_cvt_pk_bf16_f32 v18, v108, v109
v_cvt_pk_bf16_f32 v26, v116, v117
v_xor_b32 v34, 0x80008000, v26
v_cvt_pk_bf16_f32 v19, v110, v111
v_cvt_pk_bf16_f32 v27, v118, v119
v_xor_b32 v35, 0x80008000, v27
v_add_u32 v99, 32, v97
v_mul_u32_u24 v99, v99, v98
v_and_b32 v99, 63, v99
v_cvt_f32_u32 v99, v99
v_mul_f32 v99, 0x3c800000, v99
v_cos_f32 v104, v99
v_sin_f32 v112, v99
v_add_u32 v99, 33, v97
v_mul_u32_u24 v99, v99, v98
v_and_b32 v99, 63, v99
v_cvt_f32_u32 v99, v99
v_mul_f32 v99, 0x3c800000, v99
v_cos_f32 v105, v99
v_sin_f32 v113, v99
v_add_u32 v99, 34, v97
v_mul_u32_u24 v99, v99, v98
v_and_b32 v99, 63, v99
v_cvt_f32_u32 v99, v99
v_mul_f32 v99, 0x3c800000, v99
v_cos_f32 v106, v99
v_sin_f32 v114, v99
v_add_u32 v99, 35, v97
v_mul_u32_u24 v99, v99, v98
v_and_b32 v99, 63, v99
v_cvt_f32_u32 v99, v99
v_mul_f32 v99, 0x3c800000, v99
v_cos_f32 v107, v99
v_sin_f32 v115, v99
v_add_u32 v99, 48, v97
v_mul_u32_u24 v99, v99, v98
v_and_b32 v99, 63, v99
v_cvt_f32_u32 v99, v99
v_mul_f32 v99, 0x3c800000, v99
v_cos_f32 v108, v99
v_sin_f32 v116, v99
v_add_u32 v99, 49, v97
v_mul_u32_u24 v99, v99, v98
v_and_b32 v99, 63, v99
v_cvt_f32_u32 v99, v99
v_mul_f32 v99, 0x3c800000, v99
v_cos_f32 v109, v99
v_sin_f32 v117, v99
v_add_u32 v99, 50, v97
v_mul_u32_u24 v99, v99, v98
v_and_b32 v99, 63, v99
v_cvt_f32_u32 v99, v99
v_mul_f32 v99, 0x3c800000, v99
v_cos_f32 v110, v99
v_sin_f32 v118, v99
v_add_u32 v99, 51, v97
v_mul_u32_u24 v99, v99, v98
v_and_b32 v99, 63, v99
v_cvt_f32_u32 v99, v99
v_mul_f32 v99, 0x3c800000, v99
v_cos_f32 v111, v99
v_sin_f32 v119, v99
v_cvt_pk_bf16_f32 v20, v104, v105
v_cvt_pk_bf16_f32 v28, v112, v113
v_xor_b32 v36, 0x80008000, v28
v_cvt_pk_bf16_f32 v21, v106, v107
v_cvt_pk_bf16_f32 v29, v114, v115
v_xor_b32 v37, 0x80008000, v29
v_cvt_pk_bf16_f32 v22, v108, v109
v_cvt_pk_bf16_f32 v30, v116, v117
v_xor_b32 v38, 0x80008000, v30
v_cvt_pk_bf16_f32 v23, v110, v111
v_cvt_pk_bf16_f32 v31, v118, v119
v_xor_b32 v39, 0x80008000, v31
s_waitcnt vmcnt(0)
s_barrier
v_mov_b32 v3, s23
s_mov_b64 exec, 1
buffer_store_dword v3, off, s[4:7], s22 sc1
s_mov_b64 exec, -1
s_mov_b32 s22, s6
v_add_u32 v99, 0, v97
v_mul_u32_u24 v99, v99, v98
v_and_b32 v99, 2047, v99
v_cvt_f32_u32 v99, v99
v_mul_f32 v99, 0x3a000000, v99
v_cos_f32 v64, v99
v_sin_f32 v72, v99
v_add_u32 v99, 1, v97
v_mul_u32_u24 v99, v99, v98
v_and_b32 v99, 2047, v99
v_cvt_f32_u32 v99, v99
v_mul_f32 v99, 0x3a000000, v99
v_cos_f32 v65, v99
v_sin_f32 v73, v99
v_add_u32 v99, 2, v97
v_mul_u32_u24 v99, v99, v98
v_and_b32 v99, 2047, v99
v_cvt_f32_u32 v99, v99
v_mul_f32 v99, 0x3a000000, v99
v_cos_f32 v66, v99
v_sin_f32 v74, v99
v_add_u32 v99, 3, v97
v_mul_u32_u24 v99, v99, v98
v_and_b32 v99, 2047, v99
v_cvt_f32_u32 v99, v99
v_mul_f32 v99, 0x3a000000, v99
v_cos_f32 v67, v99
v_sin_f32 v75, v99
v_add_u32 v99, 16, v97
v_mul_u32_u24 v99, v99, v98
v_and_b32 v99, 2047, v99
v_cvt_f32_u32 v99, v99
v_mul_f32 v99, 0x3a000000, v99
v_cos_f32 v68, v99
v_sin_f32 v76, v99
v_add_u32 v99, 17, v97
v_mul_u32_u24 v99, v99, v98
v_and_b32 v99, 2047, v99
v_cvt_f32_u32 v99, v99
v_mul_f32 v99, 0x3a000000, v99
v_cos_f32 v69, v99
v_sin_f32 v77, v99
v_add_u32 v99, 18, v97
v_mul_u32_u24 v99, v99, v98
v_and_b32 v99, 2047, v99
v_cvt_f32_u32 v99, v99
v_mul_f32 v99, 0x3a000000, v99
v_cos_f32 v70, v99
v_sin_f32 v78, v99
v_add_u32 v99, 19, v97
v_mul_u32_u24 v99, v99, v98
v_and_b32 v99, 2047, v99
v_cvt_f32_u32 v99, v99
v_mul_f32 v99, 0x3a000000, v99
v_cos_f32 v71, v99
v_sin_f32 v79, v99
v_lshl_add_u32 v100, s13, 4, v97
v_add_u32 v98, 0, v96
v_add_u32 v99, 0, v97
v_mul_u32_u24 v99, v99, v98
v_and_b32 v99, 31, v99
v_cvt_f32_u32 v99, v99
v_mul_f32 v99, 0x3d000000, v99
v_cos_f32 v104, v99
v_sin_f32 v112, v99
v_add_u32 v99, 1, v97
v_mul_u32_u24 v99, v99, v98
v_and_b32 v99, 31, v99
v_cvt_f32_u32 v99, v99
v_mul_f32 v99, 0x3d000000, v99
v_cos_f32 v105, v99
v_sin_f32 v113, v99
v_add_u32 v99, 2, v97
v_mul_u32_u24 v99, v99, v98
v_and_b32 v99, 31, v99
v_cvt_f32_u32 v99, v99
v_mul_f32 v99, 0x3d000000, v99
v_cos_f32 v106, v99
v_sin_f32 v114, v99
v_add_u32 v99, 3, v97
v_mul_u32_u24 v99, v99, v98
v_and_b32 v99, 31, v99
v_cvt_f32_u32 v99, v99
v_mul_f32 v99, 0x3d000000, v99
v_cos_f32 v107, v99
v_sin_f32 v115, v99
v_add_u32 v99, 16, v97
v_mul_u32_u24 v99, v99, v98
v_and_b32 v99, 31, v99
v_cvt_f32_u32 v99, v99
v_mul_f32 v99, 0x3d000000, v99
v_cos_f32 v108, v99
v_sin_f32 v116, v99
v_add_u32 v99, 17, v97
v_mul_u32_u24 v99, v99, v98
v_and_b32 v99, 31, v99
v_cvt_f32_u32 v99, v99
v_mul_f32 v99, 0x3d000000, v99
v_cos_f32 v109, v99
v_sin_f32 v117, v99
v_add_u32 v99, 18, v97
v_mul_u32_u24 v99, v99, v98
v_and_b32 v99, 31, v99
v_cvt_f32_u32 v99, v99
v_mul_f32 v99, 0x3d000000, v99
v_cos_f32 v110, v99
v_sin_f32 v118, v99
v_add_u32 v99, 19, v97
v_mul_u32_u24 v99, v99, v98
v_and_b32 v99, 31, v99
v_cvt_f32_u32 v99, v99
v_mul_f32 v99, 0x3d000000, v99
v_cos_f32 v111, v99
v_sin_f32 v119, v99
v_cvt_pk_bf16_f32 v40, v104, v105
v_cvt_pk_bf16_f32 v48, v112, v113
v_xor_b32 v56, 0x80008000, v48
v_cvt_pk_bf16_f32 v41, v106, v107
v_cvt_pk_bf16_f32 v49, v114, v115
v_xor_b32 v57, 0x80008000, v49
v_cvt_pk_bf16_f32 v42, v108, v109
v_cvt_pk_bf16_f32 v50, v116, v117
v_xor_b32 v58, 0x80008000, v50
v_cvt_pk_bf16_f32 v43, v110, v111
v_cvt_pk_bf16_f32 v51, v118, v119
v_xor_b32 v59, 0x80008000, v51
v_add_u32 v99, 0, v100
v_mul_u32_u24 v99, v99, v98
v_and_b32 v99, 2047, v99
v_cvt_f32_u32 v99, v99
v_mul_f32 v99, 0x3a000000, v99
v_cos_f32 v80, v99
v_sin_f32 v88, v99
v_mul_f32 v80, 0x3a000000, v80
v_mul_f32 v88, 0x3a000000, v88
v_add_u32 v99, 1, v100
v_mul_u32_u24 v99, v99, v98
v_and_b32 v99, 2047, v99
v_cvt_f32_u32 v99, v99
v_mul_f32 v99, 0x3a000000, v99
v_cos_f32 v81, v99
v_sin_f32 v89, v99
v_mul_f32 v81, 0x3a000000, v81
v_mul_f32 v89, 0x3a000000, v89
v_add_u32 v99, 2, v100
v_mul_u32_u24 v99, v99, v98
v_and_b32 v99, 2047, v99
v_cvt_f32_u32 v99, v99
v_mul_f32 v99, 0x3a000000, v99
v_cos_f32 v82, v99
v_sin_f32 v90, v99
v_mul_f32 v82, 0x3a000000, v82
v_mul_f32 v90, 0x3a000000, v90
v_add_u32 v99, 3, v100
v_mul_u32_u24 v99, v99, v98
v_and_b32 v99, 2047, v99
v_cvt_f32_u32 v99, v99
v_mul_f32 v99, 0x3a000000, v99
v_cos_f32 v83, v99
v_sin_f32 v91, v99
v_mul_f32 v83, 0x3a000000, v83
v_mul_f32 v91, 0x3a000000, v91
v_add_u32 v98, 16, v96
v_add_u32 v99, 0, v97
v_mul_u32_u24 v99, v99, v98
v_and_b32 v99, 31, v99
v_cvt_f32_u32 v99, v99
v_mul_f32 v99, 0x3d000000, v99
v_cos_f32 v104, v99
v_sin_f32 v112, v99
v_add_u32 v99, 1, v97
v_mul_u32_u24 v99, v99, v98
v_and_b32 v99, 31, v99
v_cvt_f32_u32 v99, v99
v_mul_f32 v99, 0x3d000000, v99
v_cos_f32 v105, v99
v_sin_f32 v113, v99
v_add_u32 v99, 2, v97
v_mul_u32_u24 v99, v99, v98
v_and_b32 v99, 31, v99
v_cvt_f32_u32 v99, v99
v_mul_f32 v99, 0x3d000000, v99
v_cos_f32 v106, v99
v_sin_f32 v114, v99
v_add_u32 v99, 3, v97
v_mul_u32_u24 v99, v99, v98
v_and_b32 v99, 31, v99
v_cvt_f32_u32 v99, v99
v_mul_f32 v99, 0x3d000000, v99
v_cos_f32 v107, v99
v_sin_f32 v115, v99
v_add_u32 v99, 16, v97
v_mul_u32_u24 v99, v99, v98
v_and_b32 v99, 31, v99
v_cvt_f32_u32 v99, v99
v_mul_f32 v99, 0x3d000000, v99
v_cos_f32 v108, v99
v_sin_f32 v116, v99
v_add_u32 v99, 17, v97
v_mul_u32_u24 v99, v99, v98
v_and_b32 v99, 31, v99
v_cvt_f32_u32 v99, v99
v_mul_f32 v99, 0x3d000000, v99
v_cos_f32 v109, v99
v_sin_f32 v117, v99
v_add_u32 v99, 18, v97
v_mul_u32_u24 v99, v99, v98
v_and_b32 v99, 31, v99
v_cvt_f32_u32 v99, v99
v_mul_f32 v99, 0x3d000000, v99
v_cos_f32 v110, v99
v_sin_f32 v118, v99
v_add_u32 v99, 19, v97
v_mul_u32_u24 v99, v99, v98
v_and_b32 v99, 31, v99
v_cvt_f32_u32 v99, v99
v_mul_f32 v99, 0x3d000000, v99
v_cos_f32 v111, v99
v_sin_f32 v119, v99
v_cvt_pk_bf16_f32 v44, v104, v105
v_cvt_pk_bf16_f32 v52, v112, v113
v_xor_b32 v60, 0x80008000, v52
v_cvt_pk_bf16_f32 v45, v106, v107
v_cvt_pk_bf16_f32 v53, v114, v115
v_xor_b32 v61, 0x80008000, v53
v_cvt_pk_bf16_f32 v46, v108, v109
v_cvt_pk_bf16_f32 v54, v116, v117
v_xor_b32 v62, 0x80008000, v54
v_cvt_pk_bf16_f32 v47, v110, v111
v_cvt_pk_bf16_f32 v55, v118, v119
v_xor_b32 v63, 0x80008000, v55
v_add_u32 v99, 0, v100
v_mul_u32_u24 v99, v99, v98
v_and_b32 v99, 2047, v99
v_cvt_f32_u32 v99, v99
v_mul_f32 v99, 0x3a000000, v99
v_cos_f32 v84, v99
v_sin_f32 v92, v99
v_mul_f32 v84, 0x3a000000, v84
v_mul_f32 v92, 0x3a000000, v92
v_add_u32 v99, 1, v100
v_mul_u32_u24 v99, v99, v98
v_and_b32 v99, 2047, v99
v_cvt_f32_u32 v99, v99
v_mul_f32 v99, 0x3a000000, v99
v_cos_f32 v85, v99
v_sin_f32 v93, v99
v_mul_f32 v85, 0x3a000000, v85
v_mul_f32 v93, 0x3a000000, v93
v_add_u32 v99, 2, v100
v_mul_u32_u24 v99, v99, v98
v_and_b32 v99, 2047, v99
v_cvt_f32_u32 v99, v99
v_mul_f32 v99, 0x3a000000, v99
v_cos_f32 v86, v99
v_sin_f32 v94, v99
v_mul_f32 v86, 0x3a000000, v86
v_mul_f32 v94, 0x3a000000, v94
v_add_u32 v99, 3, v100
v_mul_u32_u24 v99, v99, v98
v_and_b32 v99, 2047, v99
v_cvt_f32_u32 v99, v99
v_mul_f32 v99, 0x3a000000, v99
v_cos_f32 v87, v99
v_sin_f32 v95, v99
v_mul_f32 v87, 0x3a000000, v87
v_mul_f32 v95, 0x3a000000, v95
v_lshrrev_b32 v98, 6, v0
v_and_b32 v99, 7, v98
v_lshlrev_b32 v99, 5, v99
v_lshl_add_u32 v98, v98, 8, v99
v_and_b32 v99, 16, v0
v_add_u32 v98, v98, v99
v_bfe_u32 v99, v0, 5, 1
v_lshl_add_u32 v224, v99, 3, v98
v_xor_b32 v225, 32, v224
v_xor_b32 v226, 64, v224
v_xor_b32 v227, 96, v224
v_xor_b32 v228, 128, v224
v_xor_b32 v229, 160, v224
v_xor_b32 v230, 192, v224
v_xor_b32 v231, 224, v224
v_lshrrev_b32 v98, 8, v0
v_bfe_u32 v99, v0, 5, 3
v_xor_b32 v99, v99, v98
v_mul_u32_u24 v98, 40960, v98
v_and_b32 v96, 16, v0
v_add_u32 v98, v98, v96
v_and_b32 v96, 3, v99
v_lshl_add_u32 v98, v96, 5, v98
v_lshrrev_b32 v99, 2, v99
v_lshl_add_u32 v232, v99, 10, v98
v_xor_b32 v99, 1, v99
v_lshl_add_u32 v233, v99, 10, v98
s_lshl_b32 s18, s13, 12
s_add_u32 s19, s18, 147456
v_add_u32 v220, s19, v0
s_mov_b32 s25, s18
s_mul_i32 s26, s16, 3145728
s_mul_i32 s19, s13, 655360
s_add_u32 s26, s26, s19
s_lshl_b32 s19, s39, 8
s_add_u32 s27, s26, s19
s_add_u32 s27, s27, 103809024
s_lshr_b32 s19, s39, 3
s_lshl_b32 s19, s19, 11
s_add_u32 s26, s26, s19
s_and_b32 s19, s39, 7
s_lshl_b32 s19, s19, 7
s_add_u32 s26, s26, s19
s_add_u32 s26, s26, 97517568
s_cmp_lg_u32 s16, 0
s_cbranch_scc1 cw_51
s_cmp_lg_u32 s13, 0
s_cbranch_scc1 polld_54
v_lshlrev_b32 v3, 3, v0
v_min_u32 v12, 3968, v3
s_mov_b32 s21, 11563008
s_mov_b32 s17, 0
poll_53:
buffer_load_dword v8, v3, s[4:7], s21 offen sc1
s_add_u32 s20, s21, 8192
buffer_load_dword v9, v3, s[4:7], s20 offen sc1
s_add_u32 s20, s21, 16384
buffer_load_dword v10, v3, s[4:7], s20 offen sc1
s_add_u32 s20, s21, 24576
buffer_load_dword v11, v12, s[4:7], s20 offen sc1
s_add_u32 s17, s17, 1
s_cmp_gt_u32 s17, 262144
s_cbranch_scc1 L_fail
s_waitcnt vmcnt(2)
v_min_u32 v8, v8, v9
s_waitcnt vmcnt(1)
v_min_u32 v8, v8, v10
s_waitcnt vmcnt(0)
v_min_u32 v8, v8, v11
v_cmp_gt_u32 vcc, 1, v8
s_cbranch_vccz polld_54
s_sleep 2
s_branch poll_53
polld_54:
s_barrier
s_add_u32 s18, s25, 145408
s_lshl_b32 s19, s39, 14
s_add_u32 s19, s19, s25
s_add_u32 s19, s19, 167772160
s_add_u32 m0, s18, 2048
s_add_u32 s20, s19, 0
buffer_load_dwordx4 v0, s[4:7], s20 offen sc1 lds
s_add_u32 m0, s18, 3072
s_add_u32 s20, s19, 1024
buffer_load_dwordx4 v0, s[4:7], s20 offen sc1 lds
s_add_u32 m0, s18, 4096
s_add_u32 s20, s19, 2048
buffer_load_dwordx4 v0, s[4:7], s20 offen sc1 lds
s_add_u32 m0, s18, 5120
s_add_u32 s20, s19, 3072
buffer_load_dwordx4 v0, s[4:7], s20 offen sc1 lds
s_branch cw_52
cw_51:
s_cmp_lg_u32 s13, 0
s_cbranch_scc1 polld_56
v_lshlrev_b32 v3, 3, v0
v_min_u32 v12, 4352, v3
s_mov_b32 s21, 11552768
s_mov_b32 s17, 0
poll_55:
buffer_load_dword v8, v12, s[4:7], s21 offen sc1
s_add_u32 s17, s17, 1
s_cmp_gt_u32 s17, 262144
s_cbranch_scc1 L_fail
s_waitcnt vmcnt(0)
v_cmp_gt_u32 vcc, 1, v8
s_cbranch_vccz polld_56
s_sleep 2
s_branch poll_55
polld_56:
s_barrier
cw_52:
s_add_u32 m0, s25, 0
s_add_u32 s20, s26, 0
buffer_load_dwordx4 v232, s[4:7], s20 offen sc1 lds
s_add_u32 m0, s25, 1024
s_add_u32 s20, s26, 163840
buffer_load_dwordx4 v233, s[4:7], s20 offen sc1 lds
s_add_u32 m0, s25, 2048
s_add_u32 s20, s26, 327680
buffer_load_dwordx4 v232, s[4:7], s20 offen sc1 lds
s_add_u32 m0, s25, 3072
s_add_u32 s20, s26, 491520
buffer_load_dwordx4 v233, s[4:7], s20 offen sc1 lds
s_lshr_b32 s18, s13, 1
s_lshl_b32 s18, s18, 10
s_and_b32 s19, s13, 1
s_lshl_b32 s19, s19, 3
s_add_u32 s18, s18, s19
v_add_u32 v234, s18, v0
v_bfe_u32 v235, v0, 4, 4
v_mul_u32_u24 v235, 40960, v235
v_lshrrev_b32 v99, 8, v0
v_lshl_add_u32 v235, v99, 4, v235
s_waitcnt vmcnt(0)
s_barrier
ds_read_b64_tr_b16 v[112:113], v225 offset:0
ds_read_b64_tr_b16 v[114:115], v225 offset:4096
ds_read_b64_tr_b16 v[98:99], v224 offset:4096
ds_read_b64_tr_b16 v[96:97], v224 offset:0
ds_read_b64_tr_b16 v[102:103], v224 offset:12288
ds_read_b64_tr_b16 v[144:145], v227 offset:0
ds_read_b64_tr_b16 v[130:131], v226 offset:4096
ds_read_b64_tr_b16 v[104:105], v228 offset:0
ds_read_b64_tr_b16 v[118:119], v225 offset:12288
ds_read_b64_tr_b16 v[100:101], v224 offset:8192
ds_read_b64_tr_b16 v[120:121], v229 offset:0
ds_read_b64_tr_b16 v[116:117], v225 offset:8192
ds_read_b64_tr_b16 v[110:111], v228 offset:12288
ds_read_b64_tr_b16 v[122:123], v229 offset:4096
ds_read_b64_tr_b16 v[108:109], v228 offset:8192
ds_read_b64_tr_b16 v[152:153], v231 offset:0
s_waitcnt lgkmcnt(14)
ds_read_b64_tr_b16 v[126:127], v229 offset:12288
v_mfma_f32_16x16x32_bf16 v[168:171], v[112:115], v[16:19], 0
s_waitcnt lgkmcnt(13)
ds_read_b64_tr_b16 v[106:107], v228 offset:4096
ds_read_b64_tr_b16 v[146:147], v227 offset:4096
v_mfma_f32_16x16x32_bf16 v[160:163], v[96:99], v[16:19], 0
ds_read_b64_tr_b16 v[128:129], v226 offset:0
ds_read_b64_tr_b16 v[134:135], v226 offset:12288
v_mfma_f32_16x16x32_bf16 v[168:171], v[96:99], v[32:35], v[168:171]
s_waitcnt lgkmcnt(13)
ds_read_b128 v[208:211], v220 offset:0
ds_read_b64_tr_b16 v[138:139], v230 offset:4096
v_mfma_f32_16x16x32_bf16 v[160:163], v[112:115], v[24:27], v[160:163]
s_waitcnt lgkmcnt(13)
ds_read_b64_tr_b16 v[136:137], v230 offset:0
ds_read_b64_tr_b16 v[140:141], v230 offset:8192
v_mfma_f32_16x16x32_bf16 v[160:163], v[100:103], v[20:23], v[160:163]
s_waitcnt lgkmcnt(13)
ds_read_b64_tr_b16 v[148:149], v227 offset:8192
ds_read_b64_tr_b16 v[124:125], v229 offset:8192
v_mfma_f32_16x16x32_bf16 v[160:163], v[116:119], v[28:31], v[160:163]
s_waitcnt lgkmcnt(13)
ds_read_b64_tr_b16 v[154:155], v231 offset:4096
ds_read_b64_tr_b16 v[142:143], v230 offset:12288
v_mfma_f32_16x16x32_bf16 v[168:171], v[116:119], v[20:23], v[168:171]
ds_read_b128 v[212:215], v220 offset:1024
ds_read_b128 v[216:219], v220 offset:2048
v_mfma_f32_16x16x32_bf16 v[168:171], v[100:103], v[36:39], v[168:171]
s_waitcnt lgkmcnt(13)
ds_read_b128 v[220:223], v220 offset:3072
v_mul_f32 v233, v161, v73
v_mfma_f32_16x16x32_bf16 v[172:175], v[120:123], v[16:19], 0
s_waitcnt lgkmcnt(13)
v_mul_f32 v232, v160, v72
v_mul_f32 v160, v160, v64
v_mfma_f32_16x16x32_bf16 v[164:167], v[104:107], v[16:19], 0
ds_read_b64_tr_b16 v[158:159], v231 offset:12288
ds_read_b64_tr_b16 v[150:151], v227 offset:12288
v_mfma_f32_16x16x32_bf16 v[172:175], v[104:107], v[32:35], v[172:175]
ds_read_b64_tr_b16 v[156:157], v231 offset:8192
v_fma_f32 v160, v168, v72, v160
v_mfma_f32_16x16x32_bf16 v[164:167], v[120:123], v[24:27], v[164:167]
s_waitcnt lgkmcnt(11)
ds_read_b64_tr_b16 v[132:133], v226 offset:8192
v_mul_f32 v161, v161, v65
v_mfma_f32_16x16x32_bf16 v[184:187], v[144:147], v[16:19], 0
s_waitcnt lgkmcnt(9)
v_fma_f32 v161, v169, v73, v161
v_fma_f32 v168, v168, v64, -v232
v_mfma_f32_16x16x32_bf16 v[164:167], v[108:111], v[20:23], v[164:167]
v_fma_f32 v169, v169, v65, -v233
v_mul_f32 v233, v163, v75
v_mfma_f32_16x16x32_bf16 v[172:175], v[124:127], v[20:23], v[172:175]
v_mul_f32 v232, v162, v74
v_mul_f32 v162, v162, v66
v_mfma_f32_16x16x32_bf16 v[164:167], v[124:127], v[28:31], v[164:167]
s_waitcnt lgkmcnt(7)
v_mul_f32 v163, v163, v67
v_cvt_pk_bf16_f32 v192, v160, v161
v_mfma_f32_16x16x32_bf16 v[172:175], v[108:111], v[36:39], v[172:175]
v_fma_f32 v162, v170, v74, v162
v_fma_f32 v170, v170, v66, -v232
v_mfma_f32_16x16x32_bf16 v[188:191], v[152:155], v[16:19], 0
s_waitcnt lgkmcnt(2)
v_fma_f32 v163, v171, v75, v163
v_mul_f32 v232, v164, v76
v_mfma_f32_16x16x32_bf16 v[180:183], v[136:139], v[16:19], 0
v_mul_f32 v164, v164, v68
v_fma_f32 v164, v172, v76, v164
v_mfma_f32_16x16x32_bf16 v[184:187], v[128:131], v[32:35], v[184:187]
v_fma_f32 v172, v172, v68, -v232
v_fma_f32 v171, v171, v67, -v233
v_mfma_f32_16x16x32_bf16 v[188:191], v[136:139], v[32:35], v[188:191]
s_waitcnt lgkmcnt(0)
v_mul_f32 v233, v165, v77
v_mul_f32 v165, v165, v69
v_mfma_f32_16x16x32_bf16 v[184:187], v[148:151], v[20:23], v[184:187]
v_fma_f32 v165, v173, v77, v165
v_mul_f32 v232, v166, v78
v_mfma_f32_16x16x32_bf16 v[176:179], v[128:131], v[16:19], 0
v_fma_f32 v173, v173, v69, -v233
v_mul_f32 v166, v166, v70
v_mfma_f32_16x16x32_bf16 v[180:183], v[152:155], v[24:27], v[180:183]
v_mul_f32 v233, v167, v79
v_fma_f32 v166, v174, v78, v166
v_mfma_f32_16x16x32_bf16 v[176:179], v[144:147], v[24:27], v[176:179]
v_cvt_pk_bf16_f32 v196, v168, v169
v_cvt_pk_bf16_f32 v198, v172, v173
v_mfma_f32_16x16x32_bf16 v[188:191], v[156:159], v[20:23], v[188:191]
v_mul_f32 v167, v167, v71
v_cvt_pk_bf16_f32 v193, v162, v163
v_mfma_f32_16x16x32_bf16 v[176:179], v[132:135], v[20:23], v[176:179]
v_cvt_pk_bf16_f32 v194, v164, v165
v_fma_f32 v167, v175, v79, v167
v_mfma_f32_16x16x32_bf16 v[176:179], v[148:151], v[28:31], v[176:179]
v_fma_f32 v175, v175, v71, -v233
v_fma_f32 v174, v174, v70, -v232
v_mfma_f32_16x16x32_bf16 v[188:191], v[140:143], v[36:39], v[188:191]
s_nop 0
v_cvt_pk_bf16_f32 v197, v170, v171
v_cvt_pk_bf16_f32 v195, v166, v167
v_mfma_f32_16x16x32_bf16 v[184:187], v[132:135], v[36:39], v[184:187]
s_nop 0
v_mul_f32 v232, v176, v72
v_mul_f32 v233, v177, v73
v_mfma_f32_16x16x32_bf16 v[164:167], v[44:47], v[192:195], 0
v_cvt_pk_bf16_f32 v199, v174, v175
v_mul_f32 v176, v176, v64
v_mfma_f32_16x16x32_bf16 v[180:183], v[140:143], v[20:23], v[180:183]
s_nop 0
v_fma_f32 v176, v184, v72, v176
v_fma_f32 v184, v184, v64, -v232
v_mfma_f32_16x16x32_bf16 v[164:167], v[52:55], v[196:199], v[164:167]
v_mul_f32 v232, v178, v74
v_mul_f32 v177, v177, v65
v_mfma_f32_16x16x32_bf16 v[168:171], v[40:43], v[196:199], 0
v_mul_f32 v178, v178, v66
v_fma_f32 v177, v185, v73, v177
v_mfma_f32_16x16x32_bf16 v[180:183], v[156:159], v[28:31], v[180:183]
v_fma_f32 v185, v185, v65, -v233
v_lshlrev_b32 v111, 16, v223
v_fma_f32 v178, v186, v74, v178
v_mfma_f32_16x16x32_bf16 v[172:175], v[44:47], v[196:199], 0
v_mul_f32 v233, v179, v75
v_mul_f32 v179, v179, v67
v_mfma_f32_16x16x32_bf16 v[168:171], v[56:59], v[192:195], v[168:171]
v_fma_f32 v179, v187, v75, v179
v_fma_f32 v186, v186, v66, -v232
v_mfma_f32_16x16x32_bf16 v[160:163], v[40:43], v[192:195], 0
v_fma_f32 v187, v187, v67, -v233
v_mul_f32 v233, v181, v77
v_mfma_f32_16x16x32_bf16 v[160:163], v[48:51], v[196:199], v[160:163]
v_cvt_pk_bf16_f32 v200, v176, v177
v_mul_f32 v232, v180, v76
v_mul_f32 v181, v181, v69
v_fma_f32 v181, v189, v77, v181
v_mul_f32 v180, v180, v68
v_fma_f32 v180, v188, v76, v180
v_mfma_f32_16x16x32_bf16 v[172:175], v[60:63], v[192:195], v[172:175]
v_fma_f32 v189, v189, v69, -v233
v_mul_f32 v233, v183, v79
v_lshlrev_b32 v97, 16, v216
v_fma_f32 v188, v188, v68, -v232
v_mul_f32 v183, v183, v71
v_fma_f32 v183, v191, v79, v183
v_cvt_pk_bf16_f32 v205, v186, v187
v_mul_f32 v232, v182, v78
v_mul_f32 v182, v182, v70
v_cvt_pk_bf16_f32 v201, v178, v179
v_fma_f32 v182, v190, v78, v182
v_cvt_pk_bf16_f32 v203, v182, v183
v_cvt_pk_bf16_f32 v202, v180, v181
v_cvt_pk_bf16_f32 v204, v184, v185
v_fma_f32 v190, v190, v70, -v232
v_mfma_f32_16x16x32_bf16 v[176:179], v[40:43], v[200:203], 0
v_lshlrev_b32 v98, 16, v209
v_lshlrev_b32 v99, 16, v217
v_mfma_f32_16x16x32_bf16 v[180:183], v[44:47], v[200:203], 0
v_mul_f32 v232, v160, v97
v_cvt_pk_bf16_f32 v206, v188, v189
v_fma_f32 v191, v191, v71, -v233
v_cvt_pk_bf16_f32 v207, v190, v191
v_lshlrev_b32 v106, 16, v213
v_and_b32 v118, 0xffff0000, v211
v_mfma_f32_16x16x32_bf16 v[188:191], v[44:47], v[204:207], 0
v_mul_f32 v233, v161, v99
v_mul_f32 v161, v161, v98
v_mfma_f32_16x16x32_bf16 v[176:179], v[48:51], v[204:207], v[176:179]
v_lshlrev_b32 v104, 16, v212
v_and_b32 v117, 0xffff0000, v218
v_lshlrev_b32 v96, 16, v208
v_mfma_f32_16x16x32_bf16 v[184:187], v[40:43], v[204:207], 0
v_mul_f32 v160, v160, v96
v_fma_f32 v161, v169, -v99, v161
v_mfma_f32_16x16x32_bf16 v[184:187], v[56:59], v[200:203], v[184:187]
v_fma_f32 v160, v168, -v97, v160
v_fma_f32 v169, v169, v98, v233
v_mfma_f32_16x16x32_bf16 v[188:191], v[60:63], v[200:203], v[188:191]
v_lshlrev_b32 v101, 16, v218
v_lshlrev_b32 v103, 16, v219
v_mfma_f32_16x16x32_bf16 v[180:183], v[52:55], v[204:207], v[180:183]
v_lshlrev_b32 v105, 16, v220
v_lshlrev_b32 v109, 16, v222
v_lshlrev_b32 v100, 16, v210
v_fma_f32 v168, v168, v96, v232
v_mul_f32 v233, v163, v103
v_lshlrev_b32 v102, 16, v211
v_mul_f32 v232, v162, v101
v_mul_f32 v163, v163, v102
v_mul_f32 v162, v162, v100
v_cvt_pk_bf16_f32 v196, v168, v169
v_fma_f32 v162, v170, -v101, v162
v_fma_f32 v163, v171, -v103, v163
v_fma_f32 v171, v171, v102, v233
v_fma_f32 v170, v170, v100, v232
v_and_b32 v126, 0xffff0000, v215
v_cvt_pk_bf16_f32 v193, v162, v163
v_and_b32 v112, 0xffff0000, v208
v_mul_f32 v232, v164, v105
v_mul_f32 v164, v164, v104
v_lshlrev_b32 v107, 16, v221
v_lshlrev_b32 v108, 16, v214
v_mul_f32 v233, v165, v107
v_mul_f32 v165, v165, v106
v_and_b32 v123, 0xffff0000, v221
v_cvt_pk_bf16_f32 v197, v170, v171
v_fma_f32 v164, v172, -v105, v164
v_fma_f32 v172, v172, v104, v232
v_fma_f32 v165, v173, -v107, v165
v_lshlrev_b32 v110, 16, v215
v_mul_f32 v232, v166, v109
v_mul_f32 v166, v166, v108
v_fma_f32 v166, v174, -v109, v166
v_fma_f32 v173, v173, v106, v233
v_mul_f32 v233, v167, v111
v_mul_f32 v167, v167, v110
v_and_b32 v113, 0xffff0000, v216
v_fma_f32 v167, v175, -v111, v167
v_and_b32 v115, 0xffff0000, v217
v_fma_f32 v174, v174, v108, v232
v_fma_f32 v175, v175, v110, v233
v_cvt_pk_bf16_f32 v192, v160, v161
v_cvt_pk_bf16_f32 v199, v174, v175
v_cvt_pk_bf16_f32 v198, v172, v173
v_mul_f32 v232, v176, v113
v_cvt_pk_bf16_f32 v194, v164, v165
v_mfma_f32_16x16x32_bf16 v[172:175], v[196:199], v[44:47], 0
v_mul_f32 v233, v177, v115
v_and_b32 v114, 0xffff0000, v209
v_mfma_f32_16x16x32_bf16 v[168:171], v[196:199], v[40:43], 0
v_cvt_pk_bf16_f32 v195, v166, v167
v_and_b32 v116, 0xffff0000, v210
v_mul_f32 v177, v177, v114
v_mfma_f32_16x16x32_bf16 v[160:163], v[192:195], v[40:43], 0
v_and_b32 v127, 0xffff0000, v223
v_mul_f32 v176, v176, v112
v_fma_f32 v176, v184, -v113, v176
v_mfma_f32_16x16x32_bf16 v[168:171], v[192:195], v[48:51], v[168:171]
v_fma_f32 v177, v185, -v115, v177
v_fma_f32 v184, v184, v112, v232
v_mfma_f32_16x16x32_bf16 v[160:163], v[196:199], v[56:59], v[160:163]
v_fma_f32 v185, v185, v114, v233
v_mul_f32 v232, v178, v117
v_and_b32 v119, 0xffff0000, v219
v_mul_f32 v178, v178, v116
v_and_b32 v125, 0xffff0000, v222
v_mfma_f32_16x16x32_bf16 v[172:175], v[192:195], v[52:55], v[172:175]
v_cvt_pk_bf16_f32 v204, v184, v185
v_mul_f32 v233, v179, v119
v_fma_f32 v178, v186, -v117, v178
v_mul_f32 v179, v179, v118
v_mfma_f32_16x16x32_bf16 v[164:167], v[192:195], v[44:47], 0
v_fma_f32 v179, v187, -v119, v179
v_fma_f32 v186, v186, v116, v232
v_and_b32 v122, 0xffff0000, v213
v_mfma_f32_16x16x32_bf16 v[164:167], v[196:199], v[60:63], v[164:167]
v_and_b32 v120, 0xffff0000, v212
v_and_b32 v121, 0xffff0000, v220
v_mul_f32 v232, v180, v121
v_and_b32 v124, 0xffff0000, v214
v_fma_f32 v187, v187, v118, v233
v_mul_f32 v233, v181, v123
v_cvt_pk_bf16_f32 v205, v186, v187
v_mul_f32 v180, v180, v120
v_mul_f32 v181, v181, v122
v_cvt_pk_bf16_f32 v201, v178, v179
v_fma_f32 v180, v188, -v121, v180
v_fma_f32 v188, v188, v120, v232
v_fma_f32 v181, v189, -v123, v181
v_fma_f32 v189, v189, v122, v233
v_mul_f32 v233, v183, v127
v_mul_f32 v232, v182, v125
v_mul_f32 v182, v182, v124
v_fma_f32 v182, v190, -v125, v182
v_mul_f32 v183, v183, v126
v_fma_f32 v183, v191, -v127, v183
v_cvt_pk_bf16_f32 v206, v188, v189
v_fma_f32 v190, v190, v124, v232
v_fma_f32 v191, v191, v126, v233
v_cvt_pk_bf16_f32 v207, v190, v191
v_cvt_pk_bf16_f32 v203, v182, v183
v_cvt_pk_bf16_f32 v200, v176, v177
v_cvt_pk_bf16_f32 v202, v180, v181
v_mul_f32 v233, v161, v89
v_mfma_f32_16x16x32_bf16 v[184:187], v[204:207], v[40:43], 0
v_mul_f32 v161, v161, v81
v_mul_f32 v232, v160, v88
v_mfma_f32_16x16x32_bf16 v[176:179], v[200:203], v[40:43], 0
v_fma_f32 v161, v169, -v89, v161
v_fma_f32 v169, v169, v81, v233
v_mfma_f32_16x16x32_bf16 v[188:191], v[204:207], v[44:47], 0
v_mul_f32 v160, v160, v80
v_fma_f32 v160, v168, -v88, v160
v_mfma_f32_16x16x32_bf16 v[176:179], v[204:207], v[56:59], v[176:179]
v_fma_f32 v168, v168, v80, v232
v_mul_f32 v233, v163, v91
v_mfma_f32_16x16x32_bf16 v[180:183], v[200:203], v[44:47], 0
v_mul_f32 v163, v163, v83
v_mul_f32 v232, v162, v90
v_fma_f32 v163, v171, -v91, v163
v_mfma_f32_16x16x32_bf16 v[180:183], v[204:207], v[60:63], v[180:183]
v_mul_f32 v162, v162, v82
v_fma_f32 v162, v170, -v90, v162
v_fma_f32 v171, v171, v83, v233
v_mfma_f32_16x16x32_bf16 v[184:187], v[200:203], v[48:51], v[184:187]
v_cvt_pk_bf16_f32 v196, v168, v169
v_mul_f32 v233, v165, v93
v_fma_f32 v170, v170, v82, v232
v_mul_f32 v232, v164, v92
v_mul_f32 v164, v164, v84
v_mul_f32 v165, v165, v85
v_fma_f32 v164, v172, -v92, v164
v_fma_f32 v165, v173, -v93, v165
v_fma_f32 v173, v173, v85, v233
v_fma_f32 v172, v172, v84, v232
v_mul_f32 v233, v167, v95
v_mul_f32 v232, v166, v94
v_mul_f32 v167, v167, v87
v_mul_f32 v166, v166, v86
v_fma_f32 v167, v175, -v95, v167
v_fma_f32 v166, v174, -v94, v166
v_fma_f32 v174, v174, v86, v232
v_mul_f32 v232, v176, v88
v_fma_f32 v175, v175, v87, v233
v_cvt_pk_bf16_f32 v194, v164, v165
v_mul_f32 v233, v177, v89
v_mul_f32 v176, v176, v80
v_mul_f32 v177, v177, v81
v_fma_f32 v176, v184, -v88, v176
v_cvt_pk_bf16_f32 v195, v166, v167
v_fma_f32 v184, v184, v80, v232
v_cvt_pk_bf16_f32 v197, v170, v171
v_mfma_f32_16x16x32_bf16 v[188:191], v[200:203], v[52:55], v[188:191]
ds_write_b64 v234, v[196:197] offset:20480
ds_write_b64 v234, v[194:195] offset:18432
v_cvt_pk_bf16_f32 v199, v174, v175
v_mul_f32 v232, v178, v90
v_mul_f32 v178, v178, v82
v_fma_f32 v177, v185, -v89, v177
v_fma_f32 v185, v185, v81, v233
v_cvt_pk_bf16_f32 v200, v176, v177
v_cvt_pk_bf16_f32 v193, v162, v163
v_fma_f32 v178, v186, -v90, v178
v_fma_f32 v186, v186, v82, v232
v_mul_f32 v233, v179, v91
v_mul_f32 v179, v179, v83
v_cvt_pk_bf16_f32 v204, v184, v185
v_mul_f32 v232, v180, v92
v_cvt_pk_bf16_f32 v192, v160, v161
v_cvt_pk_bf16_f32 v198, v172, v173
v_fma_f32 v179, v187, -v91, v179
v_fma_f32 v187, v187, v83, v233
v_mul_f32 v180, v180, v84
v_cvt_pk_bf16_f32 v205, v186, v187
v_fma_f32 v180, v188, -v92, v180
v_mul_f32 v233, v181, v93
ds_write_b64 v234, v[204:205] offset:28672
ds_write_b64 v234, v[198:199] offset:22528
ds_write_b64 v234, v[192:193] offset:16384
v_mul_f32 v181, v181, v85
v_fma_f32 v181, v189, -v93, v181
v_fma_f32 v189, v189, v85, v233
v_fma_f32 v188, v188, v84, v232
v_cvt_pk_bf16_f32 v202, v180, v181
v_mul_f32 v232, v182, v94
v_mul_f32 v233, v183, v95
v_mul_f32 v182, v182, v86
v_fma_f32 v182, v190, -v94, v182
v_mul_f32 v183, v183, v87
v_fma_f32 v183, v191, -v95, v183
v_cvt_pk_bf16_f32 v201, v178, v179
v_cvt_pk_bf16_f32 v203, v182, v183
s_waitcnt lgkmcnt(0)
ds_write_b64 v234, v[200:201] offset:24576
ds_write_b64 v234, v[202:203] offset:26624
v_fma_f32 v191, v191, v87, v233
v_fma_f32 v190, v190, v86, v232
v_cvt_pk_bf16_f32 v207, v190, v191
v_cvt_pk_bf16_f32 v206, v188, v189
s_waitcnt lgkmcnt(0)
ds_write_b64 v234, v[206:207] offset:30720
s_waitcnt lgkmcnt(0)
s_barrier
ds_read_b128 v[112:115], v0 offset:20480
ds_read_b128 v[96:99], v0 offset:16384
ds_read_b128 v[128:131], v0 offset:24576
ds_read_b128 v[104:107], v0 offset:18432
ds_read_b128 v[100:103], v0 offset:17408
ds_read_b128 v[144:147], v0 offset:28672
ds_read_b128 v[116:119], v0 offset:21504
ds_read_b128 v[120:123], v0 offset:22528
ds_read_b128 v[156:159], v0 offset:31744
s_waitcnt lgkmcnt(8)
v_mfma_f32_16x16x32_bf16 v[168:171], v[112:115], v[16:19], 0
s_waitcnt lgkmcnt(7)
v_mfma_f32_16x16x32_bf16 v[160:163], v[96:99], v[16:19], 0
ds_read_b128 v[124:127], v0 offset:23552
v_mfma_f32_16x16x32_bf16 v[168:171], v[96:99], v[24:27], v[168:171]
s_waitcnt lgkmcnt(7)
ds_read_b128 v[148:151], v0 offset:29696
v_mfma_f32_16x16x32_bf16 v[160:163], v[112:115], v[32:35], v[160:163]
v_mfma_f32_16x16x32_bf16 v[176:179], v[128:131], v[16:19], 0
s_waitcnt lgkmcnt(7)
ds_read_b128 v[152:155], v0 offset:30720
v_mfma_f32_16x16x32_bf16 v[164:167], v[104:107], v[16:19], 0
s_waitcnt lgkmcnt(6)
s_waitcnt lgkmcnt(5)
v_mfma_f32_16x16x32_bf16 v[184:187], v[144:147], v[16:19], 0
ds_read_b128 v[108:111], v0 offset:19456
v_mfma_f32_16x16x32_bf16 v[168:171], v[116:119], v[20:23], v[168:171]
v_mfma_f32_16x16x32_bf16 v[160:163], v[100:103], v[20:23], v[160:163]
ds_read_b128 v[140:143], v0 offset:27648
s_waitcnt lgkmcnt(4)
v_mfma_f32_16x16x32_bf16 v[168:171], v[100:103], v[28:31], v[168:171]
ds_read_b128 v[132:135], v0 offset:25600
v_mfma_f32_16x16x32_bf16 v[164:167], v[120:123], v[32:35], v[164:167]
v_mfma_f32_16x16x32_bf16 v[160:163], v[116:119], v[36:39], v[160:163]
s_nop 0
s_waitcnt lgkmcnt(2)
v_mfma_f32_16x16x32_bf16 v[172:175], v[120:123], v[16:19], 0
s_nop 0
ds_read_b128 v[136:139], v0 offset:26624
s_nop 0
v_mfma_f32_16x16x32_bf16 v[172:175], v[104:107], v[24:27], v[172:175]
s_nop 0
v_cvt_pk_bf16_f32 v192, v160, v161
v_mfma_f32_16x16x32_bf16 v[172:175], v[124:127], v[20:23], v[172:175]
v_mfma_f32_16x16x32_bf16 v[172:175], v[108:111], v[28:31], v[172:175]
v_mfma_f32_16x16x32_bf16 v[164:167], v[108:111], v[20:23], v[164:167]
s_waitcnt lgkmcnt(1)
v_cvt_pk_bf16_f32 v193, v162, v163
v_cvt_pk_bf16_f32 v197, v170, v171
v_mfma_f32_16x16x32_bf16 v[164:167], v[124:127], v[36:39], v[164:167]
v_mfma_f32_16x16x32_bf16 v[176:179], v[144:147], v[32:35], v[176:179]
v_cvt_pk_bf16_f32 v196, v168, v169
v_mfma_f32_16x16x32_bf16 v[176:179], v[132:135], v[20:23], v[176:179]
s_waitcnt lgkmcnt(0)
v_mfma_f32_16x16x32_bf16 v[176:179], v[148:151], v[36:39], v[176:179]
s_nop 1
v_mfma_f32_16x16x32_bf16 v[184:187], v[128:131], v[24:27], v[184:187]
s_nop 0
v_cvt_pk_bf16_f32 v195, v166, v167
s_nop 0
v_mfma_f32_16x16x32_bf16 v[180:183], v[136:139], v[16:19], 0
s_nop 0
v_cvt_pk_bf16_f32 v201, v178, v179
v_mfma_f32_16x16x32_bf16 v[180:183], v[152:155], v[32:35], v[180:183]
v_cvt_pk_bf16_f32 v199, v174, v175
v_mfma_f32_16x16x32_bf16 v[180:183], v[140:143], v[20:23], v[180:183]
v_cvt_pk_bf16_f32 v200, v176, v177
v_mfma_f32_16x16x32_bf16 v[180:183], v[156:159], v[36:39], v[180:183]
v_cvt_pk_bf16_f32 v198, v172, v173
v_mfma_f32_16x16x32_bf16 v[184:187], v[148:151], v[20:23], v[184:187]
s_nop 2
v_mfma_f32_16x16x32_bf16 v[184:187], v[132:135], v[28:31], v[184:187]
s_nop 0
v_cvt_pk_bf16_f32 v194, v164, v165
v_cvt_pk_bf16_f32 v203, v182, v183
v_mfma_f32_16x16x32_bf16 v[188:191], v[152:155], v[16:19], 0
v_cvt_pk_bf16_f32 v202, v180, v181
v_mfma_f32_16x16x32_bf16 v[188:191], v[136:139], v[24:27], v[188:191]
buffer_store_dwordx4 v[192:195], v235, s[4:7], s27 offen offset:0 sc1
v_mfma_f32_16x16x32_bf16 v[188:191], v[156:159], v[20:23], v[188:191]
v_cvt_pk_bf16_f32 v205, v186, v187
v_cvt_pk_bf16_f32 v204, v184, v185
v_mfma_f32_16x16x32_bf16 v[188:191], v[140:143], v[28:31], v[188:191]
buffer_store_dwordx4 v[196:199], v235, s[4:7], s27 offen offset:64 sc1
s_nop 2
buffer_store_dwordx4 v[200:203], v235, s[4:7], s27 offen offset:128 sc1
s_nop 2
v_cvt_pk_bf16_f32 v207, v190, v191
v_cvt_pk_bf16_f32 v206, v188, v189
buffer_store_dwordx4 v[204:207], v235, s[4:7], s27 offen offset:192 sc1
s_lshl_b32 s18, s39, 7
s_add_u32 s18, s18, 11591680
s_add_u32 s29, s16, 1
s_cmp_eq_u32 s13, 0
s_cselect_b32 s22, s18, s6
s_mov_b32 s23, s29
s_lshl_b32 s18, s34, 7
s_lshl_b32 s19, s13, 5
s_add_u32 s18, s18, s19
s_mov_b32 s19, 0x3acccccd
v_bfe_u32 v222, v0, 4, 5
v_lshrrev_b32 v217, 9, v0
v_and_b32 v220, 19, v222
v_bfe_u32 v223, v222, 2, 1
v_lshl_add_u32 v220, v223, 3, v220
v_bfe_u32 v223, v222, 3, 1
v_lshl_add_u32 v220, v223, 2, v220
v_add_u32 v220, s18, v220
v_lshlrev_b32 v217, 2, v217
v_mov_b32 v221, 0
v_mad_u32_u24 v221, v217, v220, v221
v_mad_u32_u24 v216, v220, 8, 0
v_cvt_f32_u32 v216, v216
v_mul_f32 v222, s19, v216
v_rndne_f32 v222, v222
v_fmac_f32 v216, 0xc4200000, v222
v_mul_f32 v216, s19, v216
v_cos_f32 v216, v216
s_nop 0
v_add_f32 v216, v216, v216
v_mad_u32_u24 v218, v220, 1, 0
v_cvt_f32_u32 v218, v218
v_mul_f32 v222, s19, v218
v_rndne_f32 v222, v222
v_fmac_f32 v218, 0xc4200000, v222
v_mul_f32 v218, s19, v218
v_cos_f32 v218, v218
s_nop 0
v_add_f32 v218, v218, v218
v_mad_u32_u24 v200, v220, 1, v221
v_cvt_f32_u32 v200, v200
v_mul_f32 v222, s19, v200
v_rndne_f32 v222, v222
v_fmac_f32 v200, 0xc4200000, v222
v_mul_f32 v200, s19, v200
v_sin_f32 v201, -v200
v_cos_f32 v200, v200
v_mad_u32_u24 v202, v220, 2, v221
v_cvt_f32_u32 v202, v202
v_mul_f32 v222, s19, v202
v_rndne_f32 v222, v222
v_fmac_f32 v202, 0xc4200000, v222
v_mul_f32 v202, s19, v202
v_sin_f32 v203, -v202
v_cos_f32 v202, v202
s_nop 0
v_pk_fma_f32 v[204:205], v[218:219], v[202:203], v[200:201] op_sel_hi:[0,1,1] neg_lo:[0,0,1] neg_hi:[0,0,1]
v_pk_fma_f32 v[206:207], v[218:219], v[204:205], v[202:203] op_sel_hi:[0,1,1] neg_lo:[0,0,1] neg_hi:[0,0,1]
v_cvt_pk_bf16_f32 v16, v200, v201
v_cvt_pk_bf16_f32 v17, v202, v203
v_cvt_pk_bf16_f32 v18, v204, v205
v_cvt_pk_bf16_f32 v19, v206, v207
v_mad_u32_u24 v208, v220, 9, v221
v_cvt_f32_u32 v208, v208
v_mul_f32 v222, s19, v208
v_rndne_f32 v222, v222
v_fmac_f32 v208, 0xc4200000, v222
v_mul_f32 v208, s19, v208
v_sin_f32 v209, -v208
v_cos_f32 v208, v208
v_mad_u32_u24 v210, v220, 10, v221
v_cvt_f32_u32 v210, v210
v_mul_f32 v222, s19, v210
v_rndne_f32 v222, v222
v_fmac_f32 v210, 0xc4200000, v222
v_mul_f32 v210, s19, v210
v_sin_f32 v211, -v210
v_cos_f32 v210, v210
s_nop 0
v_pk_fma_f32 v[212:213], v[218:219], v[210:211], v[208:209] op_sel_hi:[0,1,1] neg_lo:[0,0,1] neg_hi:[0,0,1]
v_pk_fma_f32 v[214:215], v[218:219], v[212:213], v[210:211] op_sel_hi:[0,1,1] neg_lo:[0,0,1] neg_hi:[0,0,1]
v_cvt_pk_bf16_f32 v20, v208, v209
v_cvt_pk_bf16_f32 v21, v210, v211
v_cvt_pk_bf16_f32 v22, v212, v213
v_cvt_pk_bf16_f32 v23, v214, v215
v_pk_fma_f32 v[200:201], v[216:217], v[208:209], v[200:201] op_sel_hi:[0,1,1] neg_lo:[0,0,1] neg_hi:[0,0,1]
v_pk_fma_f32 v[202:203], v[216:217], v[210:211], v[202:203] op_sel_hi:[0,1,1] neg_lo:[0,0,1] neg_hi:[0,0,1]
v_pk_fma_f32 v[204:205], v[216:217], v[212:213], v[204:205] op_sel_hi:[0,1,1] neg_lo:[0,0,1] neg_hi:[0,0,1]
v_pk_fma_f32 v[206:207], v[216:217], v[214:215], v[206:207] op_sel_hi:[0,1,1] neg_lo:[0,0,1] neg_hi:[0,0,1]
v_cvt_pk_bf16_f32 v24, v200, v201
v_cvt_pk_bf16_f32 v25, v202, v203
v_cvt_pk_bf16_f32 v26, v204, v205
v_cvt_pk_bf16_f32 v27, v206, v207
v_pk_fma_f32 v[208:209], v[216:217], v[200:201], v[208:209] op_sel_hi:[0,1,1] neg_lo:[0,0,1] neg_hi:[0,0,1]
v_pk_fma_f32 v[210:211], v[216:217], v[202:203], v[210:211] op_sel_hi:[0,1,1] neg_lo:[0,0,1] neg_hi:[0,0,1]
v_pk_fma_f32 v[212:213], v[216:217], v[204:205], v[212:213] op_sel_hi:[0,1,1] neg_lo:[0,0,1] neg_hi:[0,0,1]
v_pk_fma_f32 v[214:215], v[216:217], v[206:207], v[214:215] op_sel_hi:[0,1,1] neg_lo:[0,0,1] neg_hi:[0,0,1]
v_cvt_pk_bf16_f32 v28, v208, v209
v_cvt_pk_bf16_f32 v29, v210, v211
v_cvt_pk_bf16_f32 v30, v212, v213
v_cvt_pk_bf16_f32 v31, v214, v215
v_pk_fma_f32 v[200:201], v[216:217], v[208:209], v[200:201] op_sel_hi:[0,1,1] neg_lo:[0,0,1] neg_hi:[0,0,1]
v_pk_fma_f32 v[202:203], v[216:217], v[210:211], v[202:203] op_sel_hi:[0,1,1] neg_lo:[0,0,1] neg_hi:[0,0,1]
v_pk_fma_f32 v[204:205], v[216:217], v[212:213], v[204:205] op_sel_hi:[0,1,1] neg_lo:[0,0,1] neg_hi:[0,0,1]
v_pk_fma_f32 v[206:207], v[216:217], v[214:215], v[206:207] op_sel_hi:[0,1,1] neg_lo:[0,0,1] neg_hi:[0,0,1]
v_cvt_pk_bf16_f32 v32, v200, v201
v_cvt_pk_bf16_f32 v33, v202, v203
v_cvt_pk_bf16_f32 v34, v204, v205
v_cvt_pk_bf16_f32 v35, v206, v207
v_pk_fma_f32 v[208:209], v[216:217], v[200:201], v[208:209] op_sel_hi:[0,1,1] neg_lo:[0,0,1] neg_hi:[0,0,1]
v_pk_fma_f32 v[210:211], v[216:217], v[202:203], v[210:211] op_sel_hi:[0,1,1] neg_lo:[0,0,1] neg_hi:[0,0,1]
v_pk_fma_f32 v[212:213], v[216:217], v[204:205], v[212:213] op_sel_hi:[0,1,1] neg_lo:[0,0,1] neg_hi:[0,0,1]
v_pk_fma_f32 v[214:215], v[216:217], v[206:207], v[214:215] op_sel_hi:[0,1,1] neg_lo:[0,0,1] neg_hi:[0,0,1]
v_cvt_pk_bf16_f32 v36, v208, v209
v_cvt_pk_bf16_f32 v37, v210, v211
v_cvt_pk_bf16_f32 v38, v212, v213
v_cvt_pk_bf16_f32 v39, v214, v215
v_pk_fma_f32 v[200:201], v[216:217], v[208:209], v[200:201] op_sel_hi:[0,1,1] neg_lo:[0,0,1] neg_hi:[0,0,1]
v_pk_fma_f32 v[202:203], v[216:217], v[210:211], v[202:203] op_sel_hi:[0,1,1] neg_lo:[0,0,1] neg_hi:[0,0,1]
v_pk_fma_f32 v[204:205], v[216:217], v[212:213], v[204:205] op_sel_hi:[0,1,1] neg_lo:[0,0,1] neg_hi:[0,0,1]
v_pk_fma_f32 v[206:207], v[216:217], v[214:215], v[206:207] op_sel_hi:[0,1,1] neg_lo:[0,0,1] neg_hi:[0,0,1]
v_cvt_pk_bf16_f32 v40, v200, v201
v_cvt_pk_bf16_f32 v41, v202, v203
v_cvt_pk_bf16_f32 v42, v204, v205
v_cvt_pk_bf16_f32 v43, v206, v207
v_pk_fma_f32 v[208:209], v[216:217], v[200:201], v[208:209] op_sel_hi:[0,1,1] neg_lo:[0,0,1] neg_hi:[0,0,1]
v_pk_fma_f32 v[210:211], v[216:217], v[202:203], v[210:211] op_sel_hi:[0,1,1] neg_lo:[0,0,1] neg_hi:[0,0,1]
v_pk_fma_f32 v[212:213], v[216:217], v[204:205], v[212:213] op_sel_hi:[0,1,1] neg_lo:[0,0,1] neg_hi:[0,0,1]
v_pk_fma_f32 v[214:215], v[216:217], v[206:207], v[214:215] op_sel_hi:[0,1,1] neg_lo:[0,0,1] neg_hi:[0,0,1]
v_cvt_pk_bf16_f32 v44, v208, v209
v_cvt_pk_bf16_f32 v45, v210, v211
v_cvt_pk_bf16_f32 v46, v212, v213
v_cvt_pk_bf16_f32 v47, v214, v215
v_pk_fma_f32 v[200:201], v[216:217], v[208:209], v[200:201] op_sel_hi:[0,1,1] neg_lo:[0,0,1] neg_hi:[0,0,1]
v_pk_fma_f32 v[202:203], v[216:217], v[210:211], v[202:203] op_sel_hi:[0,1,1] neg_lo:[0,0,1] neg_hi:[0,0,1]
v_pk_fma_f32 v[204:205], v[216:217], v[212:213], v[204:205] op_sel_hi:[0,1,1] neg_lo:[0,0,1] neg_hi:[0,0,1]
v_pk_fma_f32 v[206:207], v[216:217], v[214:215], v[206:207] op_sel_hi:[0,1,1] neg_lo:[0,0,1] neg_hi:[0,0,1]
v_cvt_pk_bf16_f32 v48, v200, v201
v_cvt_pk_bf16_f32 v49, v202, v203
v_cvt_pk_bf16_f32 v50, v204, v205
v_cvt_pk_bf16_f32 v51, v206, v207
v_pk_fma_f32 v[208:209], v[216:217], v[200:201], v[208:209] op_sel_hi:[0,1,1] neg_lo:[0,0,1] neg_hi:[0,0,1]
v_pk_fma_f32 v[210:211], v[216:217], v[202:203], v[210:211] op_sel_hi:[0,1,1] neg_lo:[0,0,1] neg_hi:[0,0,1]
v_pk_fma_f32 v[212:213], v[216:217], v[204:205], v[212:213] op_sel_hi:[0,1,1] neg_lo:[0,0,1] neg_hi:[0,0,1]
v_pk_fma_f32 v[214:215], v[216:217], v[206:207], v[214:215] op_sel_hi:[0,1,1] neg_lo:[0,0,1] neg_hi:[0,0,1]
v_cvt_pk_bf16_f32 v52, v208, v209
v_cvt_pk_bf16_f32 v53, v210, v211
v_cvt_pk_bf16_f32 v54, v212, v213
v_cvt_pk_bf16_f32 v55, v214, v215
v_pk_fma_f32 v[200:201], v[216:217], v[208:209], v[200:201] op_sel_hi:[0,1,1] neg_lo:[0,0,1] neg_hi:[0,0,1]
v_pk_fma_f32 v[202:203], v[216:217], v[210:211], v[202:203] op_sel_hi:[0,1,1] neg_lo:[0,0,1] neg_hi:[0,0,1]
v_pk_fma_f32 v[204:205], v[216:217], v[212:213], v[204:205] op_sel_hi:[0,1,1] neg_lo:[0,0,1] neg_hi:[0,0,1]
v_pk_fma_f32 v[206:207], v[216:217], v[214:215], v[206:207] op_sel_hi:[0,1,1] neg_lo:[0,0,1] neg_hi:[0,0,1]
v_cvt_pk_bf16_f32 v56, v200, v201
v_cvt_pk_bf16_f32 v57, v202, v203
v_cvt_pk_bf16_f32 v58, v204, v205
v_cvt_pk_bf16_f32 v59, v206, v207
v_pk_fma_f32 v[208:209], v[216:217], v[200:201], v[208:209] op_sel_hi:[0,1,1] neg_lo:[0,0,1] neg_hi:[0,0,1]
v_pk_fma_f32 v[210:211], v[216:217], v[202:203], v[210:211] op_sel_hi:[0,1,1] neg_lo:[0,0,1] neg_hi:[0,0,1]
v_pk_fma_f32 v[212:213], v[216:217], v[204:205], v[212:213] op_sel_hi:[0,1,1] neg_lo:[0,0,1] neg_hi:[0,0,1]
v_pk_fma_f32 v[214:215], v[216:217], v[206:207], v[214:215] op_sel_hi:[0,1,1] neg_lo:[0,0,1] neg_hi:[0,0,1]
v_cvt_pk_bf16_f32 v60, v208, v209
v_cvt_pk_bf16_f32 v61, v210, v211
v_cvt_pk_bf16_f32 v62, v212, v213
v_cvt_pk_bf16_f32 v63, v214, v215
v_pk_fma_f32 v[200:201], v[216:217], v[208:209], v[200:201] op_sel_hi:[0,1,1] neg_lo:[0,0,1] neg_hi:[0,0,1]
v_pk_fma_f32 v[202:203], v[216:217], v[210:211], v[202:203] op_sel_hi:[0,1,1] neg_lo:[0,0,1] neg_hi:[0,0,1]
v_pk_fma_f32 v[204:205], v[216:217], v[212:213], v[204:205] op_sel_hi:[0,1,1] neg_lo:[0,0,1] neg_hi:[0,0,1]
v_pk_fma_f32 v[206:207], v[216:217], v[214:215], v[206:207] op_sel_hi:[0,1,1] neg_lo:[0,0,1] neg_hi:[0,0,1]
v_cvt_pk_bf16_f32 v64, v200, v201
v_cvt_pk_bf16_f32 v65, v202, v203
v_cvt_pk_bf16_f32 v66, v204, v205
v_cvt_pk_bf16_f32 v67, v206, v207
s_waitcnt vmcnt(0)
s_barrier
v_mov_b32 v3, s23
s_mov_b64 exec, 1
buffer_store_dword v3, off, s[4:7], s22 sc1
s_mov_b64 exec, -1
s_mov_b32 s22, s6
v_pk_fma_f32 v[208:209], v[216:217], v[200:201], v[208:209] op_sel_hi:[0,1,1] neg_lo:[0,0,1] neg_hi:[0,0,1]
v_pk_fma_f32 v[210:211], v[216:217], v[202:203], v[210:211] op_sel_hi:[0,1,1] neg_lo:[0,0,1] neg_hi:[0,0,1]
v_pk_fma_f32 v[212:213], v[216:217], v[204:205], v[212:213] op_sel_hi:[0,1,1] neg_lo:[0,0,1] neg_hi:[0,0,1]
v_pk_fma_f32 v[214:215], v[216:217], v[206:207], v[214:215] op_sel_hi:[0,1,1] neg_lo:[0,0,1] neg_hi:[0,0,1]
v_cvt_pk_bf16_f32 v68, v208, v209
v_cvt_pk_bf16_f32 v69, v210, v211
v_cvt_pk_bf16_f32 v70, v212, v213
v_cvt_pk_bf16_f32 v71, v214, v215
v_pk_fma_f32 v[200:201], v[216:217], v[208:209], v[200:201] op_sel_hi:[0,1,1] neg_lo:[0,0,1] neg_hi:[0,0,1]
v_pk_fma_f32 v[202:203], v[216:217], v[210:211], v[202:203] op_sel_hi:[0,1,1] neg_lo:[0,0,1] neg_hi:[0,0,1]
v_pk_fma_f32 v[204:205], v[216:217], v[212:213], v[204:205] op_sel_hi:[0,1,1] neg_lo:[0,0,1] neg_hi:[0,0,1]
v_pk_fma_f32 v[206:207], v[216:217], v[214:215], v[206:207] op_sel_hi:[0,1,1] neg_lo:[0,0,1] neg_hi:[0,0,1]
v_cvt_pk_bf16_f32 v72, v200, v201
v_cvt_pk_bf16_f32 v73, v202, v203
v_cvt_pk_bf16_f32 v74, v204, v205
v_cvt_pk_bf16_f32 v75, v206, v207
v_pk_fma_f32 v[208:209], v[216:217], v[200:201], v[208:209] op_sel_hi:[0,1,1] neg_lo:[0,0,1] neg_hi:[0,0,1]
v_pk_fma_f32 v[210:211], v[216:217], v[202:203], v[210:211] op_sel_hi:[0,1,1] neg_lo:[0,0,1] neg_hi:[0,0,1]
v_pk_fma_f32 v[212:213], v[216:217], v[204:205], v[212:213] op_sel_hi:[0,1,1] neg_lo:[0,0,1] neg_hi:[0,0,1]
v_pk_fma_f32 v[214:215], v[216:217], v[206:207], v[214:215] op_sel_hi:[0,1,1] neg_lo:[0,0,1] neg_hi:[0,0,1]
v_cvt_pk_bf16_f32 v76, v208, v209
v_cvt_pk_bf16_f32 v77, v210, v211
v_cvt_pk_bf16_f32 v78, v212, v213
v_cvt_pk_bf16_f32 v79, v214, v215
v_pk_fma_f32 v[200:201], v[216:217], v[208:209], v[200:201] op_sel_hi:[0,1,1] neg_lo:[0,0,1] neg_hi:[0,0,1]
v_pk_fma_f32 v[202:203], v[216:217], v[210:211], v[202:203] op_sel_hi:[0,1,1] neg_lo:[0,0,1] neg_hi:[0,0,1]
v_pk_fma_f32 v[204:205], v[216:217], v[212:213], v[204:205] op_sel_hi:[0,1,1] neg_lo:[0,0,1] neg_hi:[0,0,1]
v_pk_fma_f32 v[206:207], v[216:217], v[214:215], v[206:207] op_sel_hi:[0,1,1] neg_lo:[0,0,1] neg_hi:[0,0,1]
v_cvt_pk_bf16_f32 v80, v200, v201
v_cvt_pk_bf16_f32 v81, v202, v203
v_cvt_pk_bf16_f32 v82, v204, v205
v_cvt_pk_bf16_f32 v83, v206, v207
v_pk_fma_f32 v[208:209], v[216:217], v[200:201], v[208:209] op_sel_hi:[0,1,1] neg_lo:[0,0,1] neg_hi:[0,0,1]
v_pk_fma_f32 v[210:211], v[216:217], v[202:203], v[210:211] op_sel_hi:[0,1,1] neg_lo:[0,0,1] neg_hi:[0,0,1]
v_pk_fma_f32 v[212:213], v[216:217], v[204:205], v[212:213] op_sel_hi:[0,1,1] neg_lo:[0,0,1] neg_hi:[0,0,1]
v_pk_fma_f32 v[214:215], v[216:217], v[206:207], v[214:215] op_sel_hi:[0,1,1] neg_lo:[0,0,1] neg_hi:[0,0,1]
v_cvt_pk_bf16_f32 v84, v208, v209
v_cvt_pk_bf16_f32 v85, v210, v211
v_cvt_pk_bf16_f32 v86, v212, v213
v_cvt_pk_bf16_f32 v87, v214, v215
v_pk_fma_f32 v[200:201], v[216:217], v[208:209], v[200:201] op_sel_hi:[0,1,1] neg_lo:[0,0,1] neg_hi:[0,0,1]
v_pk_fma_f32 v[202:203], v[216:217], v[210:211], v[202:203] op_sel_hi:[0,1,1] neg_lo:[0,0,1] neg_hi:[0,0,1]
v_pk_fma_f32 v[204:205], v[216:217], v[212:213], v[204:205] op_sel_hi:[0,1,1] neg_lo:[0,0,1] neg_hi:[0,0,1]
v_pk_fma_f32 v[206:207], v[216:217], v[214:215], v[206:207] op_sel_hi:[0,1,1] neg_lo:[0,0,1] neg_hi:[0,0,1]
v_cvt_pk_bf16_f32 v88, v200, v201
v_cvt_pk_bf16_f32 v89, v202, v203
v_cvt_pk_bf16_f32 v90, v204, v205
v_cvt_pk_bf16_f32 v91, v206, v207
v_pk_fma_f32 v[208:209], v[216:217], v[200:201], v[208:209] op_sel_hi:[0,1,1] neg_lo:[0,0,1] neg_hi:[0,0,1]
v_pk_fma_f32 v[210:211], v[216:217], v[202:203], v[210:211] op_sel_hi:[0,1,1] neg_lo:[0,0,1] neg_hi:[0,0,1]
v_pk_fma_f32 v[212:213], v[216:217], v[204:205], v[212:213] op_sel_hi:[0,1,1] neg_lo:[0,0,1] neg_hi:[0,0,1]
v_pk_fma_f32 v[214:215], v[216:217], v[206:207], v[214:215] op_sel_hi:[0,1,1] neg_lo:[0,0,1] neg_hi:[0,0,1]
v_cvt_pk_bf16_f32 v92, v208, v209
v_cvt_pk_bf16_f32 v93, v210, v211
v_cvt_pk_bf16_f32 v94, v212, v213
v_cvt_pk_bf16_f32 v95, v214, v215
s_mov_b32 s20, 161
v_mad_u32_u24 v200, v220, s20, v221
v_cvt_f32_u32 v200, v200
v_mul_f32 v222, s19, v200
v_rndne_f32 v222, v222
v_fmac_f32 v200, 0xc4200000, v222
v_mul_f32 v200, s19, v200
v_sin_f32 v201, -v200
v_cos_f32 v200, v200
s_mov_b32 s20, 162
v_mad_u32_u24 v202, v220, s20, v221
v_cvt_f32_u32 v202, v202
v_mul_f32 v222, s19, v202
v_rndne_f32 v222, v222
v_fmac_f32 v202, 0xc4200000, v222
v_mul_f32 v202, s19, v202
v_sin_f32 v203, -v202
v_cos_f32 v202, v202
s_nop 0
v_pk_fma_f32 v[204:205], v[218:219], v[202:203], v[200:201] op_sel_hi:[0,1,1] neg_lo:[0,0,1] neg_hi:[0,0,1]
v_pk_fma_f32 v[206:207], v[218:219], v[204:205], v[202:203] op_sel_hi:[0,1,1] neg_lo:[0,0,1] neg_hi:[0,0,1]
v_cvt_pk_bf16_f32 v96, v200, v201
v_cvt_pk_bf16_f32 v97, v202, v203
v_cvt_pk_bf16_f32 v98, v204, v205
v_cvt_pk_bf16_f32 v99, v206, v207
s_mov_b32 s20, 169
v_mad_u32_u24 v208, v220, s20, v221
v_cvt_f32_u32 v208, v208
v_mul_f32 v222, s19, v208
v_rndne_f32 v222, v222
v_fmac_f32 v208, 0xc4200000, v222
v_mul_f32 v208, s19, v208
v_sin_f32 v209, -v208
v_cos_f32 v208, v208
s_mov_b32 s20, 170
v_mad_u32_u24 v210, v220, s20, v221
v_cvt_f32_u32 v210, v210
v_mul_f32 v222, s19, v210
v_rndne_f32 v222, v222
v_fmac_f32 v210, 0xc4200000, v222
v_mul_f32 v210, s19, v210
v_sin_f32 v211, -v210
v_cos_f32 v210, v210
s_nop 0
v_pk_fma_f32 v[212:213], v[218:219], v[210:211], v[208:209] op_sel_hi:[0,1,1] neg_lo:[0,0,1] neg_hi:[0,0,1]
v_pk_fma_f32 v[214:215], v[218:219], v[212:213], v[210:211] op_sel_hi:[0,1,1] neg_lo:[0,0,1] neg_hi:[0,0,1]
v_cvt_pk_bf16_f32 v100, v208, v209
v_cvt_pk_bf16_f32 v101, v210, v211
v_cvt_pk_bf16_f32 v102, v212, v213
v_cvt_pk_bf16_f32 v103, v214, v215
v_pk_fma_f32 v[200:201], v[216:217], v[208:209], v[200:201] op_sel_hi:[0,1,1] neg_lo:[0,0,1] neg_hi:[0,0,1]
v_pk_fma_f32 v[202:203], v[216:217], v[210:211], v[202:203] op_sel_hi:[0,1,1] neg_lo:[0,0,1] neg_hi:[0,0,1]
v_pk_fma_f32 v[204:205], v[216:217], v[212:213], v[204:205] op_sel_hi:[0,1,1] neg_lo:[0,0,1] neg_hi:[0,0,1]
v_pk_fma_f32 v[206:207], v[216:217], v[214:215], v[206:207] op_sel_hi:[0,1,1] neg_lo:[0,0,1] neg_hi:[0,0,1]
v_cvt_pk_bf16_f32 v104, v200, v201
v_cvt_pk_bf16_f32 v105, v202, v203
v_cvt_pk_bf16_f32 v106, v204, v205
v_cvt_pk_bf16_f32 v107, v206, v207
v_pk_fma_f32 v[208:209], v[216:217], v[200:201], v[208:209] op_sel_hi:[0,1,1] neg_lo:[0,0,1] neg_hi:[0,0,1]
v_pk_fma_f32 v[210:211], v[216:217], v[202:203], v[210:211] op_sel_hi:[0,1,1] neg_lo:[0,0,1] neg_hi:[0,0,1]
v_pk_fma_f32 v[212:213], v[216:217], v[204:205], v[212:213] op_sel_hi:[0,1,1] neg_lo:[0,0,1] neg_hi:[0,0,1]
v_pk_fma_f32 v[214:215], v[216:217], v[206:207], v[214:215] op_sel_hi:[0,1,1] neg_lo:[0,0,1] neg_hi:[0,0,1]
v_cvt_pk_bf16_f32 v108, v208, v209
v_cvt_pk_bf16_f32 v109, v210, v211
v_cvt_pk_bf16_f32 v110, v212, v213
v_cvt_pk_bf16_f32 v111, v214, v215
v_pk_fma_f32 v[200:201], v[216:217], v[208:209], v[200:201] op_sel_hi:[0,1,1] neg_lo:[0,0,1] neg_hi:[0,0,1]
v_pk_fma_f32 v[202:203], v[216:217], v[210:211], v[202:203] op_sel_hi:[0,1,1] neg_lo:[0,0,1] neg_hi:[0,0,1]
v_pk_fma_f32 v[204:205], v[216:217], v[212:213], v[204:205] op_sel_hi:[0,1,1] neg_lo:[0,0,1] neg_hi:[0,0,1]
v_pk_fma_f32 v[206:207], v[216:217], v[214:215], v[206:207] op_sel_hi:[0,1,1] neg_lo:[0,0,1] neg_hi:[0,0,1]
v_cvt_pk_bf16_f32 v112, v200, v201
v_cvt_pk_bf16_f32 v113, v202, v203
v_cvt_pk_bf16_f32 v114, v204, v205
v_cvt_pk_bf16_f32 v115, v206, v207
v_pk_fma_f32 v[208:209], v[216:217], v[200:201], v[208:209] op_sel_hi:[0,1,1] neg_lo:[0,0,1] neg_hi:[0,0,1]
v_pk_fma_f32 v[210:211], v[216:217], v[202:203], v[210:211] op_sel_hi:[0,1,1] neg_lo:[0,0,1] neg_hi:[0,0,1]
v_pk_fma_f32 v[212:213], v[216:217], v[204:205], v[212:213] op_sel_hi:[0,1,1] neg_lo:[0,0,1] neg_hi:[0,0,1]
v_pk_fma_f32 v[214:215], v[216:217], v[206:207], v[214:215] op_sel_hi:[0,1,1] neg_lo:[0,0,1] neg_hi:[0,0,1]
v_cvt_pk_bf16_f32 v116, v208, v209
v_cvt_pk_bf16_f32 v117, v210, v211
v_cvt_pk_bf16_f32 v118, v212, v213
v_cvt_pk_bf16_f32 v119, v214, v215
v_pk_fma_f32 v[200:201], v[216:217], v[208:209], v[200:201] op_sel_hi:[0,1,1] neg_lo:[0,0,1] neg_hi:[0,0,1]
v_pk_fma_f32 v[202:203], v[216:217], v[210:211], v[202:203] op_sel_hi:[0,1,1] neg_lo:[0,0,1] neg_hi:[0,0,1]
v_pk_fma_f32 v[204:205], v[216:217], v[212:213], v[204:205] op_sel_hi:[0,1,1] neg_lo:[0,0,1] neg_hi:[0,0,1]
v_pk_fma_f32 v[206:207], v[216:217], v[214:215], v[206:207] op_sel_hi:[0,1,1] neg_lo:[0,0,1] neg_hi:[0,0,1]
v_cvt_pk_bf16_f32 v120, v200, v201
v_cvt_pk_bf16_f32 v121, v202, v203
v_cvt_pk_bf16_f32 v122, v204, v205
v_cvt_pk_bf16_f32 v123, v206, v207
v_pk_fma_f32 v[208:209], v[216:217], v[200:201], v[208:209] op_sel_hi:[0,1,1] neg_lo:[0,0,1] neg_hi:[0,0,1]
v_pk_fma_f32 v[210:211], v[216:217], v[202:203], v[210:211] op_sel_hi:[0,1,1] neg_lo:[0,0,1] neg_hi:[0,0,1]
v_pk_fma_f32 v[212:213], v[216:217], v[204:205], v[212:213] op_sel_hi:[0,1,1] neg_lo:[0,0,1] neg_hi:[0,0,1]
v_pk_fma_f32 v[214:215], v[216:217], v[206:207], v[214:215] op_sel_hi:[0,1,1] neg_lo:[0,0,1] neg_hi:[0,0,1]
v_cvt_pk_bf16_f32 v124, v208, v209
v_cvt_pk_bf16_f32 v125, v210, v211
v_cvt_pk_bf16_f32 v126, v212, v213
v_cvt_pk_bf16_f32 v127, v214, v215
v_pk_fma_f32 v[200:201], v[216:217], v[208:209], v[200:201] op_sel_hi:[0,1,1] neg_lo:[0,0,1] neg_hi:[0,0,1]
v_pk_fma_f32 v[202:203], v[216:217], v[210:211], v[202:203] op_sel_hi:[0,1,1] neg_lo:[0,0,1] neg_hi:[0,0,1]
v_pk_fma_f32 v[204:205], v[216:217], v[212:213], v[204:205] op_sel_hi:[0,1,1] neg_lo:[0,0,1] neg_hi:[0,0,1]
v_pk_fma_f32 v[206:207], v[216:217], v[214:215], v[206:207] op_sel_hi:[0,1,1] neg_lo:[0,0,1] neg_hi:[0,0,1]
v_cvt_pk_bf16_f32 v128, v200, v201
v_cvt_pk_bf16_f32 v129, v202, v203
v_cvt_pk_bf16_f32 v130, v204, v205
v_cvt_pk_bf16_f32 v131, v206, v207
v_pk_fma_f32 v[208:209], v[216:217], v[200:201], v[208:209] op_sel_hi:[0,1,1] neg_lo:[0,0,1] neg_hi:[0,0,1]
v_pk_fma_f32 v[210:211], v[216:217], v[202:203], v[210:211] op_sel_hi:[0,1,1] neg_lo:[0,0,1] neg_hi:[0,0,1]
v_pk_fma_f32 v[212:213], v[216:217], v[204:205], v[212:213] op_sel_hi:[0,1,1] neg_lo:[0,0,1] neg_hi:[0,0,1]
v_pk_fma_f32 v[214:215], v[216:217], v[206:207], v[214:215] op_sel_hi:[0,1,1] neg_lo:[0,0,1] neg_hi:[0,0,1]
v_cvt_pk_bf16_f32 v132, v208, v209
v_cvt_pk_bf16_f32 v133, v210, v211
v_cvt_pk_bf16_f32 v134, v212, v213
v_cvt_pk_bf16_f32 v135, v214, v215
v_pk_fma_f32 v[200:201], v[216:217], v[208:209], v[200:201] op_sel_hi:[0,1,1] neg_lo:[0,0,1] neg_hi:[0,0,1]
v_pk_fma_f32 v[202:203], v[216:217], v[210:211], v[202:203] op_sel_hi:[0,1,1] neg_lo:[0,0,1] neg_hi:[0,0,1]
v_pk_fma_f32 v[204:205], v[216:217], v[212:213], v[204:205] op_sel_hi:[0,1,1] neg_lo:[0,0,1] neg_hi:[0,0,1]
v_pk_fma_f32 v[206:207], v[216:217], v[214:215], v[206:207] op_sel_hi:[0,1,1] neg_lo:[0,0,1] neg_hi:[0,0,1]
v_cvt_pk_bf16_f32 v136, v200, v201
v_cvt_pk_bf16_f32 v137, v202, v203
v_cvt_pk_bf16_f32 v138, v204, v205
v_cvt_pk_bf16_f32 v139, v206, v207
v_pk_fma_f32 v[208:209], v[216:217], v[200:201], v[208:209] op_sel_hi:[0,1,1] neg_lo:[0,0,1] neg_hi:[0,0,1]
v_pk_fma_f32 v[210:211], v[216:217], v[202:203], v[210:211] op_sel_hi:[0,1,1] neg_lo:[0,0,1] neg_hi:[0,0,1]
v_pk_fma_f32 v[212:213], v[216:217], v[204:205], v[212:213] op_sel_hi:[0,1,1] neg_lo:[0,0,1] neg_hi:[0,0,1]
v_pk_fma_f32 v[214:215], v[216:217], v[206:207], v[214:215] op_sel_hi:[0,1,1] neg_lo:[0,0,1] neg_hi:[0,0,1]
v_cvt_pk_bf16_f32 v140, v208, v209
v_cvt_pk_bf16_f32 v141, v210, v211
v_cvt_pk_bf16_f32 v142, v212, v213
v_cvt_pk_bf16_f32 v143, v214, v215
v_pk_fma_f32 v[200:201], v[216:217], v[208:209], v[200:201] op_sel_hi:[0,1,1] neg_lo:[0,0,1] neg_hi:[0,0,1]
v_pk_fma_f32 v[202:203], v[216:217], v[210:211], v[202:203] op_sel_hi:[0,1,1] neg_lo:[0,0,1] neg_hi:[0,0,1]
v_pk_fma_f32 v[204:205], v[216:217], v[212:213], v[204:205] op_sel_hi:[0,1,1] neg_lo:[0,0,1] neg_hi:[0,0,1]
v_pk_fma_f32 v[206:207], v[216:217], v[214:215], v[206:207] op_sel_hi:[0,1,1] neg_lo:[0,0,1] neg_hi:[0,0,1]
v_cvt_pk_bf16_f32 v144, v200, v201
v_cvt_pk_bf16_f32 v145, v202, v203
v_cvt_pk_bf16_f32 v146, v204, v205
v_cvt_pk_bf16_f32 v147, v206, v207
v_pk_fma_f32 v[208:209], v[216:217], v[200:201], v[208:209] op_sel_hi:[0,1,1] neg_lo:[0,0,1] neg_hi:[0,0,1]
v_pk_fma_f32 v[210:211], v[216:217], v[202:203], v[210:211] op_sel_hi:[0,1,1] neg_lo:[0,0,1] neg_hi:[0,0,1]
v_pk_fma_f32 v[212:213], v[216:217], v[204:205], v[212:213] op_sel_hi:[0,1,1] neg_lo:[0,0,1] neg_hi:[0,0,1]
v_pk_fma_f32 v[214:215], v[216:217], v[206:207], v[214:215] op_sel_hi:[0,1,1] neg_lo:[0,0,1] neg_hi:[0,0,1]
v_cvt_pk_bf16_f32 v148, v208, v209
v_cvt_pk_bf16_f32 v149, v210, v211
v_cvt_pk_bf16_f32 v150, v212, v213
v_cvt_pk_bf16_f32 v151, v214, v215
v_pk_fma_f32 v[200:201], v[216:217], v[208:209], v[200:201] op_sel_hi:[0,1,1] neg_lo:[0,0,1] neg_hi:[0,0,1]
v_pk_fma_f32 v[202:203], v[216:217], v[210:211], v[202:203] op_sel_hi:[0,1,1] neg_lo:[0,0,1] neg_hi:[0,0,1]
v_pk_fma_f32 v[204:205], v[216:217], v[212:213], v[204:205] op_sel_hi:[0,1,1] neg_lo:[0,0,1] neg_hi:[0,0,1]
v_pk_fma_f32 v[206:207], v[216:217], v[214:215], v[206:207] op_sel_hi:[0,1,1] neg_lo:[0,0,1] neg_hi:[0,0,1]
v_cvt_pk_bf16_f32 v152, v200, v201
v_cvt_pk_bf16_f32 v153, v202, v203
v_cvt_pk_bf16_f32 v154, v204, v205
v_cvt_pk_bf16_f32 v155, v206, v207
v_pk_fma_f32 v[208:209], v[216:217], v[200:201], v[208:209] op_sel_hi:[0,1,1] neg_lo:[0,0,1] neg_hi:[0,0,1]
v_pk_fma_f32 v[210:211], v[216:217], v[202:203], v[210:211] op_sel_hi:[0,1,1] neg_lo:[0,0,1] neg_hi:[0,0,1]
v_pk_fma_f32 v[212:213], v[216:217], v[204:205], v[212:213] op_sel_hi:[0,1,1] neg_lo:[0,0,1] neg_hi:[0,0,1]
v_pk_fma_f32 v[214:215], v[216:217], v[206:207], v[214:215] op_sel_hi:[0,1,1] neg_lo:[0,0,1] neg_hi:[0,0,1]
v_cvt_pk_bf16_f32 v156, v208, v209
v_cvt_pk_bf16_f32 v157, v210, v211
v_cvt_pk_bf16_f32 v158, v212, v213
v_cvt_pk_bf16_f32 v159, v214, v215
v_pk_fma_f32 v[200:201], v[216:217], v[208:209], v[200:201] op_sel_hi:[0,1,1] neg_lo:[0,0,1] neg_hi:[0,0,1]
v_pk_fma_f32 v[202:203], v[216:217], v[210:211], v[202:203] op_sel_hi:[0,1,1] neg_lo:[0,0,1] neg_hi:[0,0,1]
v_pk_fma_f32 v[204:205], v[216:217], v[212:213], v[204:205] op_sel_hi:[0,1,1] neg_lo:[0,0,1] neg_hi:[0,0,1]
v_pk_fma_f32 v[206:207], v[216:217], v[214:215], v[206:207] op_sel_hi:[0,1,1] neg_lo:[0,0,1] neg_hi:[0,0,1]
v_cvt_pk_bf16_f32 v160, v200, v201
v_cvt_pk_bf16_f32 v161, v202, v203
v_cvt_pk_bf16_f32 v162, v204, v205
v_cvt_pk_bf16_f32 v163, v206, v207
v_pk_fma_f32 v[208:209], v[216:217], v[200:201], v[208:209] op_sel_hi:[0,1,1] neg_lo:[0,0,1] neg_hi:[0,0,1]
v_pk_fma_f32 v[210:211], v[216:217], v[202:203], v[210:211] op_sel_hi:[0,1,1] neg_lo:[0,0,1] neg_hi:[0,0,1]
v_pk_fma_f32 v[212:213], v[216:217], v[204:205], v[212:213] op_sel_hi:[0,1,1] neg_lo:[0,0,1] neg_hi:[0,0,1]
v_pk_fma_f32 v[214:215], v[216:217], v[206:207], v[214:215] op_sel_hi:[0,1,1] neg_lo:[0,0,1] neg_hi:[0,0,1]
v_cvt_pk_bf16_f32 v164, v208, v209
v_cvt_pk_bf16_f32 v165, v210, v211
v_cvt_pk_bf16_f32 v166, v212, v213
v_cvt_pk_bf16_f32 v167, v214, v215
v_pk_fma_f32 v[200:201], v[216:217], v[208:209], v[200:201] op_sel_hi:[0,1,1] neg_lo:[0,0,1] neg_hi:[0,0,1]
v_pk_fma_f32 v[202:203], v[216:217], v[210:211], v[202:203] op_sel_hi:[0,1,1] neg_lo:[0,0,1] neg_hi:[0,0,1]
v_pk_fma_f32 v[204:205], v[216:217], v[212:213], v[204:205] op_sel_hi:[0,1,1] neg_lo:[0,0,1] neg_hi:[0,0,1]
v_pk_fma_f32 v[206:207], v[216:217], v[214:215], v[206:207] op_sel_hi:[0,1,1] neg_lo:[0,0,1] neg_hi:[0,0,1]
v_cvt_pk_bf16_f32 v168, v200, v201
v_cvt_pk_bf16_f32 v169, v202, v203
v_cvt_pk_bf16_f32 v170, v204, v205
v_cvt_pk_bf16_f32 v171, v206, v207
v_pk_fma_f32 v[208:209], v[216:217], v[200:201], v[208:209] op_sel_hi:[0,1,1] neg_lo:[0,0,1] neg_hi:[0,0,1]
v_pk_fma_f32 v[210:211], v[216:217], v[202:203], v[210:211] op_sel_hi:[0,1,1] neg_lo:[0,0,1] neg_hi:[0,0,1]
v_pk_fma_f32 v[212:213], v[216:217], v[204:205], v[212:213] op_sel_hi:[0,1,1] neg_lo:[0,0,1] neg_hi:[0,0,1]
v_pk_fma_f32 v[214:215], v[216:217], v[206:207], v[214:215] op_sel_hi:[0,1,1] neg_lo:[0,0,1] neg_hi:[0,0,1]
s_mov_b32 exec_lo, 0
v_mul_f32 v214, 0.5, v214
s_mov_b32 exec_lo, -1
v_cvt_pk_bf16_f32 v172, v208, v209
v_cvt_pk_bf16_f32 v173, v210, v211
v_cvt_pk_bf16_f32 v174, v212, v213
v_cvt_pk_bf16_f32 v175, v214, v215
v_and_b32 v1, 0x2f0, v0
v_bfe_u32 v3, v0, 8, 1
v_lshl_add_u32 v1, v3, 3, v1
s_mul_i32 s18, s50, 40960
s_mul_i32 s19, s16, 3145728
s_add_u32 s26, s18, s19
s_add_u32 s27, s26, s19
s_add_u32 s27, s27, s33
s_add_u32 s27, s27, 88080384
s_add_u32 s26, s26, s31
s_add_u32 s26, s26, 103809024
s_lshl_b32 s19, s16, 6
s_add_u32 s19, s19, s50
s_mul_i32 s19, s19, 5120
s_lshr_b32 s36, s33, 3
s_add_u32 s36, s36, s19
s_add_u32 s36, s36, 163577856
s_mov_b32 s43, 0x20000
s_cmp_lg_u32 s16, 0
s_cbranch_scc1 rs_57
s_mov_b64 s[40:41], s[44:45]
s_mov_b32 s42, s46
s_lshr_b32 s51, s33, 5
s_add_u32 s51, s51, s18
s_add_u32 s52, s51, 32
v_mov_b32 v13, v5
s_branch rs_58
rs_57:
s_mov_b64 s[40:41], s[4:5]
s_mov_b32 s42, s6
s_sub_u32 s51, s27, 3145728
s_add_u32 s52, s51, 1024
v_mov_b32 v13, v0
rs_58:
s_cmp_lg_u32 s13, 0
s_cbranch_scc1 polld_60
v_lshlrev_b32 v3, 3, v0
v_min_u32 v12, 3968, v3
s_mov_b32 s21, 11591680
s_mov_b32 s17, 0
poll_59:
buffer_load_dword v8, v3, s[4:7], s21 offen sc1
s_add_u32 s20, s21, 8192
buffer_load_dword v9, v3, s[4:7], s20 offen sc1
s_add_u32 s20, s21, 16384
buffer_load_dword v10, v12, s[4:7], s20 offen sc1
s_add_u32 s17, s17, 1
s_cmp_gt_u32 s17, 262144
s_cbranch_scc1 L_fail
s_waitcnt vmcnt(1)
v_min_u32 v8, v8, v9
s_waitcnt vmcnt(0)
v_min_u32 v8, v8, v10
v_cmp_gt_u32 vcc, s29, v8
s_cbranch_vccz polld_60
s_sleep 2
s_branch poll_59
polld_60:
s_barrier
s_add_u32 m0, s31, 2048
s_add_u32 s20, s26, 0
buffer_load_dwordx4 v0, s[4:7], s20 offen sc1 lds
s_add_u32 m0, s31, 3072
s_add_u32 s20, s26, 1024
buffer_load_dwordx4 v0, s[4:7], s20 offen sc1 lds
s_add_u32 m0, s31, 4096
s_add_u32 s20, s26, 2048
buffer_load_dwordx4 v0, s[4:7], s20 offen sc1 lds
s_add_u32 m0, s31, 5120
s_add_u32 s20, s26, 3072
buffer_load_dwordx4 v0, s[4:7], s20 offen sc1 lds
s_add_u32 m0, s31, 6144
s_add_u32 s20, s26, 4096
buffer_load_dwordx4 v0, s[4:7], s20 offen sc1 lds
s_add_u32 m0, s31, 7168
s_add_u32 s20, s26, 5120
buffer_load_dwordx4 v0, s[4:7], s20 offen sc1 lds
s_add_u32 m0, s31, 8192
s_add_u32 s20, s26, 6144
buffer_load_dwordx4 v0, s[4:7], s20 offen sc1 lds
s_add_u32 m0, s31, 9216
s_add_u32 s20, s26, 7168
buffer_load_dwordx4 v0, s[4:7], s20 offen sc1 lds
s_add_u32 m0, s31, 10240
s_add_u32 s20, s26, 8192
buffer_load_dwordx4 v0, s[4:7], s20 offen sc1 lds
s_add_u32 m0, s31, 11264
s_add_u32 s20, s26, 9216
buffer_load_dwordx4 v0, s[4:7], s20 offen sc1 lds
s_add_u32 s26, s26, 1310720
s_add_u32 s25, s31, 40960
s_mov_b32 s28, 0
s_waitcnt vmcnt(0)
p3_61:
s_barrier
ds_read_b64_tr_b16 v[216:217], v1 offset:2048
ds_read_b64_tr_b16 v[218:219], v1 offset:2304
ds_read_b64_tr_b16 v[222:223], v1 offset:3328
ds_read_b64_tr_b16 v[220:221], v1 offset:3072
buffer_load_dwordx4 v[176:179], v13, s[40:43], s51 offen sc1
ds_read_b64_tr_b16 v[224:225], v1 offset:4096
buffer_load_dwordx4 v[180:183], v13, s[40:43], s52 offen sc1
ds_read_b64_tr_b16 v[230:231], v1 offset:5376
ds_read_b64_tr_b16 v[226:227], v1 offset:4352
s_add_u32 m0, s25, 2048
s_add_u32 s20, s26, 0
buffer_load_dwordx4 v0, s[4:7], s20 offen sc1 lds
s_waitcnt lgkmcnt(5)
v_mfma_f32_32x32x16_bf16 v[200:215], v[16:19], v[216:219], 0
s_waitcnt lgkmcnt(4)
ds_read_b64_tr_b16 v[228:229], v1 offset:5120
ds_read_b64_tr_b16 v[218:219], v1 offset:6400
s_add_u32 m0, s25, 3072
s_add_u32 s20, s26, 1024
buffer_load_dwordx4 v0, s[4:7], s20 offen sc1 lds
s_waitcnt lgkmcnt(4)
v_mfma_f32_32x32x16_bf16 v[200:215], v[20:23], v[220:223], v[200:215]
s_add_u32 m0, s25, 4096
s_add_u32 s20, s26, 2048
buffer_load_dwordx4 v0, s[4:7], s20 offen sc1 lds
ds_read_b64_tr_b16 v[216:217], v1 offset:6144
s_waitcnt lgkmcnt(3)
ds_read_b64_tr_b16 v[222:223], v1 offset:7424
v_mfma_f32_32x32x16_bf16 v[200:215], v[24:27], v[224:227], v[200:215]
s_waitcnt lgkmcnt(3)
ds_read_b64_tr_b16 v[220:221], v1 offset:7168
ds_read_b64_tr_b16 v[224:225], v1 offset:8192
s_waitcnt lgkmcnt(4)
v_mfma_f32_32x32x16_bf16 v[200:215], v[28:31], v[228:231], v[200:215]
s_add_u32 m0, s25, 5120
s_add_u32 s20, s26, 3072
buffer_load_dwordx4 v0, s[4:7], s20 offen sc1 lds
s_waitcnt lgkmcnt(3)
ds_read_b64_tr_b16 v[226:227], v1 offset:8448
ds_read_b64_tr_b16 v[230:231], v1 offset:9472
ds_read_b64_tr_b16 v[228:229], v1 offset:9216
v_mfma_f32_32x32x16_bf16 v[200:215], v[32:35], v[216:219], v[200:215]
ds_read_b64_tr_b16 v[216:217], v1 offset:10240
s_waitcnt lgkmcnt(5)
v_mfma_f32_32x32x16_bf16 v[200:215], v[36:39], v[220:223], v[200:215]
ds_read_b64_tr_b16 v[220:221], v1 offset:11264
s_waitcnt lgkmcnt(4)
ds_read_b64_tr_b16 v[218:219], v1 offset:10496
v_mfma_f32_32x32x16_bf16 v[200:215], v[40:43], v[224:227], v[200:215]
ds_read_b64_tr_b16 v[222:223], v1 offset:11520
ds_read_b64_tr_b16 v[224:225], v1 offset:12288
s_waitcnt lgkmcnt(5)
v_mfma_f32_32x32x16_bf16 v[200:215], v[44:47], v[228:231], v[200:215]
ds_read_b64_tr_b16 v[228:229], v1 offset:13312
ds_read_b64_tr_b16 v[226:227], v1 offset:12544
s_waitcnt lgkmcnt(6)
s_waitcnt lgkmcnt(4)
ds_read_b64_tr_b16 v[230:231], v1 offset:13568
v_mfma_f32_32x32x16_bf16 v[200:215], v[48:51], v[216:219], v[200:215]
ds_read_b64_tr_b16 v[218:219], v1 offset:14592
s_add_u32 m0, s25, 6144
s_add_u32 s20, s26, 4096
buffer_load_dwordx4 v0, s[4:7], s20 offen sc1 lds
s_waitcnt lgkmcnt(5)
ds_read_b64_tr_b16 v[216:217], v1 offset:14336
v_mfma_f32_32x32x16_bf16 v[200:215], v[52:55], v[220:223], v[200:215]
ds_read_b64_tr_b16 v[222:223], v1 offset:15616
s_waitcnt lgkmcnt(4)
s_add_u32 m0, s25, 7168
s_add_u32 s20, s26, 5120
buffer_load_dwordx4 v0, s[4:7], s20 offen sc1 lds
ds_read_b64_tr_b16 v[220:221], v1 offset:15360
v_mfma_f32_32x32x16_bf16 v[200:215], v[56:59], v[224:227], v[200:215]
s_waitcnt lgkmcnt(4)
ds_read_b64_tr_b16 v[226:227], v1 offset:16640
ds_read_b64_tr_b16 v[224:225], v1 offset:16384
s_waitcnt lgkmcnt(5)
s_waitcnt lgkmcnt(4)
v_mfma_f32_32x32x16_bf16 v[200:215], v[60:63], v[228:231], v[200:215]
v_mfma_f32_32x32x16_bf16 v[200:215], v[64:67], v[216:219], v[200:215]
s_waitcnt lgkmcnt(2)
ds_read_b64_tr_b16 v[218:219], v1 offset:18688
s_waitcnt lgkmcnt(1)
ds_read_b64_tr_b16 v[230:231], v1 offset:17664
ds_read_b64_tr_b16 v[228:229], v1 offset:17408
ds_read_b64_tr_b16 v[216:217], v1 offset:18432
v_mfma_f32_32x32x16_bf16 v[200:215], v[68:71], v[220:223], v[200:215]
v_mfma_f32_32x32x16_bf16 v[200:215], v[72:75], v[224:227], v[200:215]
s_waitcnt lgkmcnt(3)
ds_read_b64_tr_b16 v[224:225], v1 offset:20480
ds_read_b64_tr_b16 v[226:227], v1 offset:20736
ds_read_b64_tr_b16 v[222:223], v1 offset:19712
s_waitcnt lgkmcnt(4)
ds_read_b64_tr_b16 v[220:221], v1 offset:19456
v_mfma_f32_32x32x16_bf16 v[200:215], v[76:79], v[228:231], v[200:215]
ds_read_b64_tr_b16 v[230:231], v1 offset:21760
s_waitcnt lgkmcnt(5)
ds_read_b64_tr_b16 v[228:229], v1 offset:21504
v_mfma_f32_32x32x16_bf16 v[200:215], v[80:83], v[216:219], v[200:215]
ds_read_b64_tr_b16 v[218:219], v1 offset:22784
s_waitcnt lgkmcnt(3)
ds_read_b64_tr_b16 v[216:217], v1 offset:22528
v_mfma_f32_32x32x16_bf16 v[200:215], v[84:87], v[220:223], v[200:215]
ds_read_b64_tr_b16 v[220:221], v1 offset:23552
s_waitcnt lgkmcnt(4)
ds_read_b64_tr_b16 v[222:223], v1 offset:23808
v_mfma_f32_32x32x16_bf16 v[200:215], v[88:91], v[224:227], v[200:215]
s_add_u32 m0, s25, 8192
s_add_u32 s20, s26, 6144
buffer_load_dwordx4 v0, s[4:7], s20 offen sc1 lds
s_waitcnt lgkmcnt(2)
ds_read_b64_tr_b16 v[224:225], v1 offset:24576
ds_read_b64_tr_b16 v[226:227], v1 offset:24832
v_mfma_f32_32x32x16_bf16 v[200:215], v[92:95], v[228:231], v[200:215]
s_waitcnt lgkmcnt(3)
ds_read_b64_tr_b16 v[230:231], v1 offset:25856
s_waitcnt lgkmcnt(3)
v_mfma_f32_32x32x16_bf16 v[200:215], v[96:99], v[216:219], v[200:215]
s_waitcnt lgkmcnt(2)
ds_read_b64_tr_b16 v[228:229], v1 offset:25600
ds_read_b64_tr_b16 v[218:219], v1 offset:26880
v_mfma_f32_32x32x16_bf16 v[200:215], v[100:103], v[220:223], v[200:215]
ds_read_b64_tr_b16 v[216:217], v1 offset:26624
ds_read_b64_tr_b16 v[222:223], v1 offset:27904
ds_read_b64_tr_b16 v[220:221], v1 offset:27648
s_waitcnt lgkmcnt(6)
v_mfma_f32_32x32x16_bf16 v[200:215], v[104:107], v[224:227], v[200:215]
s_waitcnt lgkmcnt(4)
ds_read_b64_tr_b16 v[224:225], v1 offset:28672
ds_read_b64_tr_b16 v[226:227], v1 offset:28928
s_waitcnt lgkmcnt(5)
v_mfma_f32_32x32x16_bf16 v[200:215], v[108:111], v[228:231], v[200:215]
ds_read_b64_tr_b16 v[228:229], v1 offset:29696
s_waitcnt lgkmcnt(5)
v_mfma_f32_32x32x16_bf16 v[200:215], v[112:115], v[216:219], v[200:215]
s_waitcnt lgkmcnt(4)
s_waitcnt lgkmcnt(1)
ds_read_b64_tr_b16 v[218:219], v1 offset:30976
ds_read_b64_tr_b16 v[230:231], v1 offset:29952
v_mfma_f32_32x32x16_bf16 v[200:215], v[116:119], v[220:223], v[200:215]
s_add_u32 m0, s25, 9216
s_add_u32 s20, s26, 7168
buffer_load_dwordx4 v0, s[4:7], s20 offen sc1 lds
ds_read_b64_tr_b16 v[216:217], v1 offset:30720
ds_read_b64_tr_b16 v[220:221], v1 offset:31744
s_waitcnt lgkmcnt(4)
v_mfma_f32_32x32x16_bf16 v[200:215], v[120:123], v[224:227], v[200:215]
ds_read_b64_tr_b16 v[226:227], v1 offset:33024
ds_read_b64_tr_b16 v[222:223], v1 offset:32000
ds_read_b64_tr_b16 v[224:225], v1 offset:32768
s_waitcnt lgkmcnt(5)
v_lshrrev_b32 v2, 2, v0
v_mfma_f32_32x32x16_bf16 v[200:215], v[124:127], v[228:231], v[200:215]
s_add_u32 m0, s25, 10240
s_add_u32 s20, s26, 8192
buffer_load_dwordx4 v0, s[4:7], s20 offen sc1 lds
s_waitcnt lgkmcnt(4)
ds_read_b64_tr_b16 v[228:229], v1 offset:33792
s_waitcnt lgkmcnt(4)
v_mfma_f32_32x32x16_bf16 v[200:215], v[128:131], v[216:219], v[200:215]
s_waitcnt lgkmcnt(3)
s_waitcnt lgkmcnt(2)
ds_read_b64_tr_b16 v[230:231], v1 offset:34048
ds_read_b64_tr_b16 v[216:217], v1 offset:34816
ds_read_b64_tr_b16 v[218:219], v1 offset:35072
v_mfma_f32_32x32x16_bf16 v[200:215], v[132:135], v[220:223], v[200:215]
s_waitcnt vmcnt(10)
s_waitcnt lgkmcnt(4)
ds_read_b64_tr_b16 v[220:221], v1 offset:35840
s_add_u32 m0, s25, 11264
s_add_u32 s20, s26, 9216
buffer_load_dwordx4 v0, s[4:7], s20 offen sc1 lds
v_mfma_f32_32x32x16_bf16 v[200:215], v[136:139], v[224:227], v[200:215]
ds_read_b64_tr_b16 v[222:223], v1 offset:36096
ds_read_b64_tr_b16 v[226:227], v1 offset:37120
v_and_b32 v187, 0xffff0000, v177
s_waitcnt lgkmcnt(5)
v_lshlrev_b32 v184, 16, v176
s_waitcnt vmcnt(10)
v_mfma_f32_32x32x16_bf16 v[200:215], v[140:143], v[228:231], v[200:215]
s_waitcnt lgkmcnt(3)
ds_read_b64_tr_b16 v[230:231], v1 offset:38144
ds_read_b64_tr_b16 v[224:225], v1 offset:36864
s_waitcnt lgkmcnt(4)
ds_read_b64_tr_b16 v[228:229], v1 offset:37888
v_mfma_f32_32x32x16_bf16 v[200:215], v[144:147], v[216:219], v[200:215]
s_waitcnt lgkmcnt(3)
ds_read_b64_tr_b16 v[218:219], v1 offset:39168
ds_read_b64_tr_b16 v[216:217], v1 offset:38912
v_and_b32 v199, 0xffff0000, v183
v_mfma_f32_32x32x16_bf16 v[200:215], v[148:151], v[220:223], v[200:215]
s_waitcnt lgkmcnt(4)
s_waitcnt lgkmcnt(3)
s_waitcnt lgkmcnt(2)
v_lshlrev_b32 v198, 16, v183
v_and_b32 v189, 0xffff0000, v178
v_and_b32 v197, 0xffff0000, v182
v_mfma_f32_32x32x16_bf16 v[200:215], v[152:155], v[224:227], v[200:215]
ds_read_b64_tr_b16 v[220:221], v1 offset:39936
s_waitcnt lgkmcnt(2)
ds_read_b64_tr_b16 v[224:225], v1 offset:40960
ds_read_b64_tr_b16 v[222:223], v1 offset:40192
v_mfma_f32_32x32x16_bf16 v[200:215], v[156:159], v[228:231], v[200:215]
s_waitcnt lgkmcnt(3)
ds_read_b64_tr_b16 v[230:231], v1 offset:42240
ds_read_b64_tr_b16 v[226:227], v1 offset:41216
v_mfma_f32_32x32x16_bf16 v[200:215], v[160:163], v[216:219], v[200:215]
ds_read_b64_tr_b16 v[228:229], v1 offset:41984
s_waitcnt lgkmcnt(3)
v_and_b32 v193, 0xffff0000, v180
v_lshlrev_b32 v186, 16, v177
v_and_b32 v191, 0xffff0000, v179
v_mfma_f32_32x32x16_bf16 v[200:215], v[164:167], v[220:223], v[200:215]
s_waitcnt lgkmcnt(1)
v_lshlrev_b32 v196, 16, v182
v_mfma_f32_32x32x16_bf16 v[200:215], v[168:171], v[224:227], v[200:215]
v_lshlrev_b32 v188, 16, v178
s_waitcnt lgkmcnt(0)
v_lshlrev_b32 v194, 16, v181
v_mfma_f32_32x32x16_bf16 v[200:215], v[172:175], v[228:231], v[200:215]
s_nop 0
v_lshlrev_b32 v190, 16, v179
v_lshlrev_b32 v192, 16, v180
v_and_b32 v185, 0xffff0000, v176
v_and_b32 v195, 0xffff0000, v181
v_mov_b32 v176, 0x3b4ccccd
s_nop 5
v_pk_fma_f32 v[200:201], v[200:201], v[176:177], v[184:185] op_sel_hi:[1,0,1]
v_pk_fma_f32 v[202:203], v[202:203], v[176:177], v[186:187] op_sel_hi:[1,0,1]
v_pk_fma_f32 v[204:205], v[204:205], v[176:177], v[188:189] op_sel_hi:[1,0,1]
v_pk_mul_f32 v[180:181], v[200:201], v[200:201]
v_pk_fma_f32 v[206:207], v[206:207], v[176:177], v[190:191] op_sel_hi:[1,0,1]
v_pk_add_f32 v[178:179], v[200:201], v[202:203]
v_pk_fma_f32 v[208:209], v[208:209], v[176:177], v[192:193] op_sel_hi:[1,0,1]
v_pk_add_f32 v[178:179], v[178:179], v[204:205]
v_pk_add_f32 v[178:179], v[178:179], v[206:207]
v_pk_fma_f32 v[180:181], v[202:203], v[202:203], v[180:181]
v_pk_fma_f32 v[180:181], v[204:205], v[204:205], v[180:181]
v_pk_fma_f32 v[210:211], v[210:211], v[176:177], v[194:195] op_sel_hi:[1,0,1]
v_pk_fma_f32 v[180:181], v[206:207], v[206:207], v[180:181]
v_pk_add_f32 v[178:179], v[178:179], v[208:209]
v_pk_fma_f32 v[180:181], v[208:209], v[208:209], v[180:181]
v_pk_add_f32 v[178:179], v[178:179], v[210:211]
v_pk_fma_f32 v[180:181], v[210:211], v[210:211], v[180:181]
v_pk_fma_f32 v[214:215], v[214:215], v[176:177], v[198:199] op_sel_hi:[1,0,1]
v_pk_fma_f32 v[212:213], v[212:213], v[176:177], v[196:197] op_sel_hi:[1,0,1]
v_pk_add_f32 v[178:179], v[178:179], v[212:213]
v_pk_add_f32 v[178:179], v[178:179], v[214:215]
v_pk_fma_f32 v[180:181], v[212:213], v[212:213], v[180:181]
v_add_f32 v178, v178, v179
v_pk_fma_f32 v[180:181], v[214:215], v[214:215], v[180:181]
v_add_f32 v180, v180, v181
v_cvt_pk_bf16_f32 v220, v208, v209
v_cvt_pk_bf16_f32 v221, v210, v211
v_permlane32_swap_b32 v178, v180
v_cvt_pk_bf16_f32 v223, v214, v215
v_cvt_pk_bf16_f32 v222, v212, v213
v_cvt_pk_bf16_f32 v219, v206, v207
v_cvt_pk_bf16_f32 v216, v200, v201
v_cvt_pk_bf16_f32 v218, v204, v205
v_add_f32 v178, v178, v180
v_cvt_pk_bf16_f32 v217, v202, v203
buffer_store_dwordx4 v[216:219], v0, s[4:7], s27 offen offset:0 sc1
buffer_store_dwordx4 v[220:223], v0, s[4:7], s27 offen offset:1024 sc1
buffer_store_dword v178, v2, s[4:7], s36 offen sc1
v_xor_b32 v1, 40960, v1
s_mov_b32 s26, s6
s_mov_b32 s25, s31
s_add_u32 s27, s27, 1310720
s_add_u32 s36, s36, 163840
s_add_u32 s51, s51, 1310720
s_add_u32 s52, s52, 1310720
s_add_u32 s28, s28, 1
s_lshl_b32 s18, s39, 7
s_add_u32 s18, s18, 11612160
s_lshl_b32 s19, s16, 1
s_add_u32 s19, s19, s28
s_cmp_eq_u32 s13, 0
s_cselect_b32 s22, s18, s6
s_mov_b32 s23, s19
s_waitcnt vmcnt(0)
s_barrier
v_mov_b32 v3, s23
s_mov_b64 exec, 1
buffer_store_dword v3, off, s[4:7], s22 sc1
s_mov_b64 exec, -1
s_mov_b32 s22, s6
s_cmp_lt_u32 s28, 2
s_cbranch_scc1 p3_61
s_cmp_ge_u32 s39, 144
s_cbranch_scc1 p1b_63
s_cmp_ge_u32 s39, 64
s_cbranch_scc1 wo_62
s_and_b32 s32, s39, 31
s_cmp_lg_u32 s16, 0
s_cbranch_scc1 qw_65
s_lshl_b32 s26, s32, 8
s_lshl_b32 s18, s13, 6
s_add_u32 s26, s26, s18
s_load_dwordx2 s[40:41], s[0:1], 40
s_mov_b32 s42, 5242880
s_mov_b32 s43, 0x20000
s_waitcnt lgkmcnt(0)
v_lshrrev_b32 v34, 6, v0
v_mul_u32_u24 v34, 8192, v34
v_and_b32 v35, 48, v0
v_add_u32 v32, v34, v35
v_bfe_u32 v34, v0, 6, 2
v_lshrrev_b32 v35, 9, v0
v_lshl_add_u32 v34, v35, 3, v34
v_lshlrev_b32 v33, 6, v34
v_and_b32 v34, 16, v0
v_add_u32 v33, v33, v34
v_bfe_u32 v34, v0, 5, 1
v_lshl_add_u32 v33, v34, 3, v33
v_bfe_u32 v34, v0, 8, 1
v_lshl_add_u32 v33, v34, 5, v33
s_mul_i32 s18, s13, 36864
v_add_u32 v33, s18, v33
s_barrier
s_add_u32 m0, s18, 0
s_add_u32 s19, s26, 0
buffer_load_dwordx4 v32, s[40:43], s19 offen lds
s_add_u32 m0, s18, 1024
s_add_u32 s19, s26, 131072
buffer_load_dwordx4 v32, s[40:43], s19 offen lds
s_add_u32 m0, s18, 2048
s_add_u32 s19, s26, 262144
buffer_load_dwordx4 v32, s[40:43], s19 offen lds
s_add_u32 m0, s18, 3072
s_add_u32 s19, s26, 393216
buffer_load_dwordx4 v32, s[40:43], s19 offen lds
s_add_u32 m0, s18, 4096
s_add_u32 s19, s26, 524288
buffer_load_dwordx4 v32, s[40:43], s19 offen lds
s_add_u32 m0, s18, 5120
s_add_u32 s19, s26, 655360
buffer_load_dwordx4 v32, s[40:43], s19 offen lds
s_add_u32 m0, s18, 6144
s_add_u32 s19, s26, 786432
buffer_load_dwordx4 v32, s[40:43], s19 offen lds
s_add_u32 m0, s18, 7168
s_add_u32 s19, s26, 917504
buffer_load_dwordx4 v32, s[40:43], s19 offen lds
s_add_u32 m0, s18, 8192
s_add_u32 s19, s26, 1048576
buffer_load_dwordx4 v32, s[40:43], s19 offen lds
s_add_u32 m0, s18, 9216
s_add_u32 s19, s26, 1179648
buffer_load_dwordx4 v32, s[40:43], s19 offen lds
s_add_u32 m0, s18, 10240
s_add_u32 s19, s26, 1310720
buffer_load_dwordx4 v32, s[40:43], s19 offen lds
s_add_u32 m0, s18, 11264
s_add_u32 s19, s26, 1441792
buffer_load_dwordx4 v32, s[40:43], s19 offen lds
s_add_u32 m0, s18, 12288
s_add_u32 s19, s26, 1572864
buffer_load_dwordx4 v32, s[40:43], s19 offen lds
s_add_u32 m0, s18, 13312
s_add_u32 s19, s26, 1703936
buffer_load_dwordx4 v32, s[40:43], s19 offen lds
s_add_u32 m0, s18, 14336
s_add_u32 s19, s26, 1835008
buffer_load_dwordx4 v32, s[40:43], s19 offen lds
s_add_u32 m0, s18, 15360
s_add_u32 s19, s26, 1966080
buffer_load_dwordx4 v32, s[40:43], s19 offen lds
s_add_u32 m0, s18, 16384
s_add_u32 s19, s26, 2097152
buffer_load_dwordx4 v32, s[40:43], s19 offen lds
s_add_u32 m0, s18, 17408
s_add_u32 s19, s26, 2228224
buffer_load_dwordx4 v32, s[40:43], s19 offen lds
s_add_u32 m0, s18, 18432
s_add_u32 s19, s26, 2359296
buffer_load_dwordx4 v32, s[40:43], s19 offen lds
s_add_u32 m0, s18, 19456
s_add_u32 s19, s26, 2490368
buffer_load_dwordx4 v32, s[40:43], s19 offen lds
s_add_u32 m0, s18, 20480
s_add_u32 s19, s26, 2621440
buffer_load_dwordx4 v32, s[40:43], s19 offen lds
s_add_u32 m0, s18, 21504
s_add_u32 s19, s26, 2752512
buffer_load_dwordx4 v32, s[40:43], s19 offen lds
s_add_u32 m0, s18, 22528
s_add_u32 s19, s26, 2883584
buffer_load_dwordx4 v32, s[40:43], s19 offen lds
s_add_u32 m0, s18, 23552
s_add_u32 s19, s26, 3014656
buffer_load_dwordx4 v32, s[40:43], s19 offen lds
s_add_u32 m0, s18, 24576
s_add_u32 s19, s26, 3145728
buffer_load_dwordx4 v32, s[40:43], s19 offen lds
s_add_u32 m0, s18, 25600
s_add_u32 s19, s26, 3276800
buffer_load_dwordx4 v32, s[40:43], s19 offen lds
s_add_u32 m0, s18, 26624
s_add_u32 s19, s26, 3407872
buffer_load_dwordx4 v32, s[40:43], s19 offen lds
s_add_u32 m0, s18, 27648
s_add_u32 s19, s26, 3538944
buffer_load_dwordx4 v32, s[40:43], s19 offen lds
s_add_u32 m0, s18, 28672
s_add_u32 s19, s26, 3670016
buffer_load_dwordx4 v32, s[40:43], s19 offen lds
s_add_u32 m0, s18, 29696
s_add_u32 s19, s26, 3801088
buffer_load_dwordx4 v32, s[40:43], s19 offen lds
s_add_u32 m0, s18, 30720
s_add_u32 s19, s26, 3932160
buffer_load_dwordx4 v32, s[40:43], s19 offen lds
s_add_u32 m0, s18, 31744
s_add_u32 s19, s26, 4063232
buffer_load_dwordx4 v32, s[40:43], s19 offen lds
s_add_u32 m0, s18, 32768
s_add_u32 s19, s26, 4194304
buffer_load_dwordx4 v32, s[40:43], s19 offen lds
s_add_u32 m0, s18, 33792
s_add_u32 s19, s26, 4325376
buffer_load_dwordx4 v32, s[40:43], s19 offen lds
s_add_u32 m0, s18, 34816
s_add_u32 s19, s26, 4456448
buffer_load_dwordx4 v32, s[40:43], s19 offen lds
s_add_u32 m0, s18, 35840
s_add_u32 s19, s26, 4587520
buffer_load_dwordx4 v32, s[40:43], s19 offen lds
s_waitcnt vmcnt(32)
ds_read_b64_tr_b16 a[0:1], v33 offset:0
ds_read_b64_tr_b16 a[2:3], v33 offset:256
ds_read_b64_tr_b16 a[4:5], v33 offset:1024
ds_read_b64_tr_b16 a[6:7], v33 offset:1280
ds_read_b64_tr_b16 a[8:9], v33 offset:2048
ds_read_b64_tr_b16 a[10:11], v33 offset:2304
ds_read_b64_tr_b16 a[12:13], v33 offset:3072
ds_read_b64_tr_b16 a[14:15], v33 offset:3328
s_waitcnt lgkmcnt(0)
s_add_u32 m0, s18, 0
s_add_u32 s19, s26, 4718592
buffer_load_dwordx4 v32, s[40:43], s19 offen lds
s_add_u32 m0, s18, 1024
s_add_u32 s19, s26, 4849664
buffer_load_dwordx4 v32, s[40:43], s19 offen lds
s_add_u32 m0, s18, 2048
s_add_u32 s19, s26, 4980736
buffer_load_dwordx4 v32, s[40:43], s19 offen lds
s_add_u32 m0, s18, 3072
s_add_u32 s19, s26, 5111808
buffer_load_dwordx4 v32, s[40:43], s19 offen lds
s_waitcnt vmcnt(32)
ds_read_b64_tr_b16 a[16:17], v33 offset:4096
ds_read_b64_tr_b16 a[18:19], v33 offset:4352
ds_read_b64_tr_b16 a[20:21], v33 offset:5120
ds_read_b64_tr_b16 a[22:23], v33 offset:5376
ds_read_b64_tr_b16 a[24:25], v33 offset:6144
ds_read_b64_tr_b16 a[26:27], v33 offset:6400
ds_read_b64_tr_b16 a[28:29], v33 offset:7168
ds_read_b64_tr_b16 a[30:31], v33 offset:7424
s_waitcnt vmcnt(28)
ds_read_b64_tr_b16 a[32:33], v33 offset:8192
ds_read_b64_tr_b16 a[34:35], v33 offset:8448
ds_read_b64_tr_b16 a[36:37], v33 offset:9216
ds_read_b64_tr_b16 a[38:39], v33 offset:9472
ds_read_b64_tr_b16 a[40:41], v33 offset:10240
ds_read_b64_tr_b16 a[42:43], v33 offset:10496
ds_read_b64_tr_b16 a[44:45], v33 offset:11264
ds_read_b64_tr_b16 a[46:47], v33 offset:11520
s_waitcnt vmcnt(24)
ds_read_b64_tr_b16 a[48:49], v33 offset:12288
ds_read_b64_tr_b16 a[50:51], v33 offset:12544
ds_read_b64_tr_b16 a[52:53], v33 offset:13312
ds_read_b64_tr_b16 a[54:55], v33 offset:13568
ds_read_b64_tr_b16 a[56:57], v33 offset:14336
ds_read_b64_tr_b16 a[58:59], v33 offset:14592
ds_read_b64_tr_b16 a[60:61], v33 offset:15360
ds_read_b64_tr_b16 a[62:63], v33 offset:15616
s_waitcnt vmcnt(20)
ds_read_b64_tr_b16 a[64:65], v33 offset:16384
ds_read_b64_tr_b16 a[66:67], v33 offset:16640
ds_read_b64_tr_b16 a[68:69], v33 offset:17408
ds_read_b64_tr_b16 a[70:71], v33 offset:17664
ds_read_b64_tr_b16 a[72:73], v33 offset:18432
ds_read_b64_tr_b16 a[74:75], v33 offset:18688
ds_read_b64_tr_b16 a[76:77], v33 offset:19456
ds_read_b64_tr_b16 a[78:79], v33 offset:19712
s_waitcnt vmcnt(16)
ds_read_b64_tr_b16 a[80:81], v33 offset:20480
ds_read_b64_tr_b16 a[82:83], v33 offset:20736
ds_read_b64_tr_b16 a[84:85], v33 offset:21504
ds_read_b64_tr_b16 a[86:87], v33 offset:21760
ds_read_b64_tr_b16 a[88:89], v33 offset:22528
ds_read_b64_tr_b16 a[90:91], v33 offset:22784
ds_read_b64_tr_b16 a[92:93], v33 offset:23552
ds_read_b64_tr_b16 a[94:95], v33 offset:23808
s_waitcnt vmcnt(12)
ds_read_b64_tr_b16 a[96:97], v33 offset:24576
ds_read_b64_tr_b16 a[98:99], v33 offset:24832
ds_read_b64_tr_b16 a[100:101], v33 offset:25600
ds_read_b64_tr_b16 a[102:103], v33 offset:25856
ds_read_b64_tr_b16 a[104:105], v33 offset:26624
ds_read_b64_tr_b16 a[106:107], v33 offset:26880
ds_read_b64_tr_b16 a[108:109], v33 offset:27648
ds_read_b64_tr_b16 a[110:111], v33 offset:27904
s_waitcnt vmcnt(8)
ds_read_b64_tr_b16 a[112:113], v33 offset:28672
ds_read_b64_tr_b16 a[114:115], v33 offset:28928
ds_read_b64_tr_b16 a[116:117], v33 offset:29696
ds_read_b64_tr_b16 a[118:119], v33 offset:29952
ds_read_b64_tr_b16 a[120:121], v33 offset:30720
ds_read_b64_tr_b16 a[122:123], v33 offset:30976
ds_read_b64_tr_b16 a[124:125], v33 offset:31744
ds_read_b64_tr_b16 a[126:127], v33 offset:32000
s_waitcnt vmcnt(4)
ds_read_b64_tr_b16 a[128:129], v33 offset:32768
ds_read_b64_tr_b16 a[130:131], v33 offset:33024
ds_read_b64_tr_b16 a[132:133], v33 offset:33792
ds_read_b64_tr_b16 a[134:135], v33 offset:34048
ds_read_b64_tr_b16 a[136:137], v33 offset:34816
ds_read_b64_tr_b16 a[138:139], v33 offset:35072
ds_read_b64_tr_b16 a[140:141], v33 offset:35840
ds_read_b64_tr_b16 a[142:143], v33 offset:36096
s_waitcnt vmcnt(0)
ds_read_b64_tr_b16 a[144:145], v33 offset:0
ds_read_b64_tr_b16 a[146:147], v33 offset:256
ds_read_b64_tr_b16 a[148:149], v33 offset:1024
ds_read_b64_tr_b16 a[150:151], v33 offset:1280
ds_read_b64_tr_b16 a[152:153], v33 offset:2048
ds_read_b64_tr_b16 a[154:155], v33 offset:2304
ds_read_b64_tr_b16 a[156:157], v33 offset:3072
ds_read_b64_tr_b16 a[158:159], v33 offset:3328
s_waitcnt lgkmcnt(0)
s_barrier
v_mov_b32 v32, s24
v_mov_b32 v33, s24
v_mov_b32 v34, s24
v_mov_b32 v35, s24
s_nop 1
v_mfma_f32_32x32x16_bf16 v[36:51], a[0:3], v[32:35], 0
v_mfma_f32_32x32x16_bf16 v[36:51], a[4:7], v[32:35], v[36:51]
v_mfma_f32_32x32x16_bf16 v[36:51], a[8:11], v[32:35], v[36:51]
v_mfma_f32_32x32x16_bf16 v[36:51], a[12:15], v[32:35], v[36:51]
v_mfma_f32_32x32x16_bf16 v[36:51], a[16:19], v[32:35], v[36:51]
v_mfma_f32_32x32x16_bf16 v[36:51], a[20:23], v[32:35], v[36:51]
v_mfma_f32_32x32x16_bf16 v[36:51], a[24:27], v[32:35], v[36:51]
v_mfma_f32_32x32x16_bf16 v[36:51], a[28:31], v[32:35], v[36:51]
v_mfma_f32_32x32x16_bf16 v[36:51], a[32:35], v[32:35], v[36:51]
v_mfma_f32_32x32x16_bf16 v[36:51], a[36:39], v[32:35], v[36:51]
v_mfma_f32_32x32x16_bf16 v[36:51], a[40:43], v[32:35], v[36:51]
v_mfma_f32_32x32x16_bf16 v[36:51], a[44:47], v[32:35], v[36:51]
v_mfma_f32_32x32x16_bf16 v[36:51], a[48:51], v[32:35], v[36:51]
v_mfma_f32_32x32x16_bf16 v[36:51], a[52:55], v[32:35], v[36:51]
v_mfma_f32_32x32x16_bf16 v[36:51], a[56:59], v[32:35], v[36:51]
v_mfma_f32_32x32x16_bf16 v[36:51], a[60:63], v[32:35], v[36:51]
v_mfma_f32_32x32x16_bf16 v[36:51], a[64:67], v[32:35], v[36:51]
v_mfma_f32_32x32x16_bf16 v[36:51], a[68:71], v[32:35], v[36:51]
v_mfma_f32_32x32x16_bf16 v[36:51], a[72:75], v[32:35], v[36:51]
v_mfma_f32_32x32x16_bf16 v[36:51], a[76:79], v[32:35], v[36:51]
v_mfma_f32_32x32x16_bf16 v[36:51], a[80:83], v[32:35], v[36:51]
v_mfma_f32_32x32x16_bf16 v[36:51], a[84:87], v[32:35], v[36:51]
v_mfma_f32_32x32x16_bf16 v[36:51], a[88:91], v[32:35], v[36:51]
v_mfma_f32_32x32x16_bf16 v[36:51], a[92:95], v[32:35], v[36:51]
v_mfma_f32_32x32x16_bf16 v[36:51], a[96:99], v[32:35], v[36:51]
v_mfma_f32_32x32x16_bf16 v[36:51], a[100:103], v[32:35], v[36:51]
v_mfma_f32_32x32x16_bf16 v[36:51], a[104:107], v[32:35], v[36:51]
v_mfma_f32_32x32x16_bf16 v[36:51], a[108:111], v[32:35], v[36:51]
v_mfma_f32_32x32x16_bf16 v[36:51], a[112:115], v[32:35], v[36:51]
v_mfma_f32_32x32x16_bf16 v[36:51], a[116:119], v[32:35], v[36:51]
v_mfma_f32_32x32x16_bf16 v[36:51], a[120:123], v[32:35], v[36:51]
v_mfma_f32_32x32x16_bf16 v[36:51], a[124:127], v[32:35], v[36:51]
v_mfma_f32_32x32x16_bf16 v[36:51], a[128:131], v[32:35], v[36:51]
v_mfma_f32_32x32x16_bf16 v[36:51], a[132:135], v[32:35], v[36:51]
v_mfma_f32_32x32x16_bf16 v[36:51], a[136:139], v[32:35], v[36:51]
v_mfma_f32_32x32x16_bf16 v[36:51], a[140:143], v[32:35], v[36:51]
v_mfma_f32_32x32x16_bf16 v[36:51], a[144:147], v[32:35], v[36:51]
v_mfma_f32_32x32x16_bf16 v[36:51], a[148:151], v[32:35], v[36:51]
v_mfma_f32_32x32x16_bf16 v[36:51], a[152:155], v[32:35], v[36:51]
v_mfma_f32_32x32x16_bf16 v[36:51], a[156:159], v[32:35], v[36:51]
s_nop 11
v_mov_b32 v16, v36
v_mov_b32 v17, v37
v_mov_b32 v18, v38
v_mov_b32 v19, v39
v_mov_b32 v20, v40
v_mov_b32 v21, v41
v_mov_b32 v22, v42
v_mov_b32 v23, v43
v_mov_b32 v24, v44
v_mov_b32 v25, v45
v_mov_b32 v26, v46
v_mov_b32 v27, v47
v_mov_b32 v28, v48
v_mov_b32 v29, v49
v_mov_b32 v30, v50
v_mov_b32 v31, v51
v_accvgpr_write_b32 a160, v16
v_accvgpr_write_b32 a161, v17
v_accvgpr_write_b32 a162, v18
v_accvgpr_write_b32 a163, v19
v_accvgpr_write_b32 a164, v20
v_accvgpr_write_b32 a165, v21
v_accvgpr_write_b32 a166, v22
v_accvgpr_write_b32 a167, v23
v_accvgpr_write_b32 a168, v24
v_accvgpr_write_b32 a169, v25
v_accvgpr_write_b32 a170, v26
v_accvgpr_write_b32 a171, v27
v_accvgpr_write_b32 a172, v28
v_accvgpr_write_b32 a173, v29
v_accvgpr_write_b32 a174, v30
v_accvgpr_write_b32 a175, v31
qw_65:
v_accvgpr_read_b32 v16, a160
v_accvgpr_read_b32 v17, a161
v_accvgpr_read_b32 v18, a162
v_accvgpr_read_b32 v19, a163
v_accvgpr_read_b32 v20, a164
v_accvgpr_read_b32 v21, a165
v_accvgpr_read_b32 v22, a166
v_accvgpr_read_b32 v23, a167
v_accvgpr_read_b32 v24, a168
v_accvgpr_read_b32 v25, a169
v_accvgpr_read_b32 v26, a170
v_accvgpr_read_b32 v27, a171
v_accvgpr_read_b32 v28, a172
v_accvgpr_read_b32 v29, a173
v_accvgpr_read_b32 v30, a174
v_accvgpr_read_b32 v31, a175
s_lshl_b32 s29, s16, 1
s_add_u32 s29, s29, 2
s_lshr_b32 s52, s39, 5
s_lshl_b32 s53, s32, 8
s_add_u32 s53, s53, 11534336
s_cmp_lg_u32 s13, 0
s_cbranch_scc1 polld_67
v_lshlrev_b32 v3, 3, v0
v_min_u32 v12, 3968, v3
s_mov_b32 s21, 11612160
s_mov_b32 s17, 0
poll_66:
buffer_load_dword v8, v3, s[4:7], s21 offen sc1
s_add_u32 s20, s21, 8192
buffer_load_dword v9, v3, s[4:7], s20 offen sc1
s_add_u32 s20, s21, 16384
buffer_load_dword v10, v12, s[4:7], s20 offen sc1
s_add_u32 s17, s17, 1
s_cmp_gt_u32 s17, 262144
s_cbranch_scc1 L_fail
s_waitcnt vmcnt(1)
v_min_u32 v8, v8, v9
s_waitcnt vmcnt(0)
v_min_u32 v8, v8, v10
v_cmp_gt_u32 vcc, s29, v8
s_cbranch_vccz polld_67
s_sleep 2
s_branch poll_66
polld_67:
s_barrier
qr_68:
s_mul_i32 s26, s16, 6291456
s_mul_i32 s18, s52, 163840
s_add_u32 s26, s26, s18
s_add_u32 s26, s26, s31
s_add_u32 s26, s26, 88080384
s_lshl_b32 s18, s16, 4
s_add_u32 s18, s18, s52
s_mul_i32 s18, s18, 20480
s_add_u32 s36, s18, 163577856
s_lshl_b32 s18, s13, 11
s_add_u32 s18, s18, 83968
v_add_u32 v13, s18, v0
s_mov_b32 s28, 0
v_xor_b32 v1, 40960, v0
s_mov_b32 s25, s31
s_mov_b32 s35, 131072
s_add_u32 m0, s25, 2048
s_add_u32 s20, s26, 0
buffer_load_dwordx4 v0, s[4:7], s20 offen sc1 lds
s_add_u32 m0, s25, 3072
s_add_u32 s20, s26, 1024
buffer_load_dwordx4 v0, s[4:7], s20 offen sc1 lds
s_add_u32 m0, s25, 4096
s_add_u32 s20, s26, 2048
buffer_load_dwordx4 v0, s[4:7], s20 offen sc1 lds
s_add_u32 m0, s25, 5120
s_add_u32 s20, s26, 3072
buffer_load_dwordx4 v0, s[4:7], s20 offen sc1 lds
s_add_u32 m0, s25, 6144
s_add_u32 s20, s26, 4096
buffer_load_dwordx4 v0, s[4:7], s20 offen sc1 lds
s_add_u32 m0, s25, 7168
s_add_u32 s20, s26, 5120
buffer_load_dwordx4 v0, s[4:7], s20 offen sc1 lds
s_add_u32 m0, s25, 8192
s_add_u32 s20, s26, 6144
buffer_load_dwordx4 v0, s[4:7], s20 offen sc1 lds
s_add_u32 m0, s25, 9216
s_add_u32 s20, s26, 7168
buffer_load_dwordx4 v0, s[4:7], s20 offen sc1 lds
s_add_u32 m0, s25, 10240
s_add_u32 s20, s26, 8192
buffer_load_dwordx4 v0, s[4:7], s20 offen sc1 lds
s_add_u32 m0, s25, 11264
s_add_u32 s20, s26, 9216
buffer_load_dwordx4 v0, s[4:7], s20 offen sc1 lds
s_add_u32 m0, s35, s37
s_add_u32 s20, s36, s37
buffer_load_dwordx4 v0, s[4:7], s20 offen sc1 lds
s_add_u32 m0, s35, 4096
s_add_u32 s20, s36, 4096
buffer_load_dwordx4 v0, s[4:7], s20 offen sc1 lds
s_waitcnt vmcnt(0)
qu_69:
v_xor_b32 v1, 40960, v1
s_sub_u32 s25, s25, s31
s_xor_b32 s25, s25, 40960
s_add_u32 s25, s25, s31
s_xor_b32 s35, s35, 8192
s_add_u32 s26, s26, 40960
s_add_u32 s36, s36, 5120
s_cmp_eq_u32 s28, 3
s_cselect_b32 s26, s6, s26
s_cselect_b32 s36, s6, s36
s_waitcnt vmcnt(0)
s_barrier
ds_read_b128 v[48:51], v1 offset:2048
ds_read_b128 v[52:55], v1 offset:3072
s_add_u32 m0, s25, 2048
s_add_u32 s20, s26, 0
buffer_load_dwordx4 v0, s[4:7], s20 offen sc1 lds
v_lshrrev_b32 v2, 2, v0
ds_read_b128 v[56:59], v1 offset:4096
ds_read_b128 v[60:63], v1 offset:5120
s_xor_b32 s18, s35, 8192
v_add_u32 v2, s18, v2
ds_read2st64_b32 v[72:73], v2 offset0:4 offset1:5
s_waitcnt lgkmcnt(4)
v_mfma_f32_32x32x16_bf16 v[32:47], a[0:3], v[48:51], 0
s_add_u32 m0, s25, 3072
s_add_u32 s20, s26, 1024
buffer_load_dwordx4 v0, s[4:7], s20 offen sc1 lds
ds_read_b128 v[48:51], v1 offset:6144
ds_read2st64_b32 v[66:67], v2 offset0:2 offset1:3
s_waitcnt lgkmcnt(4)
v_mfma_f32_32x32x16_bf16 v[32:47], a[4:7], v[52:55], v[32:47]
ds_read_b128 v[52:55], v1 offset:7168
ds_read2st64_b32 v[78:79], v2 offset0:10 offset1:11
s_add_u32 m0, s25, 4096
s_add_u32 s20, s26, 2048
buffer_load_dwordx4 v0, s[4:7], s20 offen sc1 lds
v_mfma_f32_32x32x16_bf16 v[32:47], a[8:11], v[56:59], v[32:47]
s_waitcnt lgkmcnt(3)
ds_read_b128 v[56:59], v1 offset:8192
ds_read2st64_b32 v[86:87], v2 offset0:18 offset1:19
v_mfma_f32_32x32x16_bf16 v[32:47], a[12:15], v[60:63], v[32:47]
ds_read_b128 v[60:63], v1 offset:9216
ds_read2st64_b32 v[64:65], v2 offset0:0 offset1:1
s_waitcnt lgkmcnt(5)
ds_read2st64_b32 v[74:75], v2 offset0:6 offset1:7
v_mfma_f32_32x32x16_bf16 v[32:47], a[16:19], v[48:51], v[32:47]
ds_read2st64_b32 v[80:81], v2 offset0:12 offset1:13
ds_read_b128 v[48:51], v1 offset:10240
ds_read2st64_b32 v[82:83], v2 offset0:14 offset1:15
ds_read2st64_b32 v[76:77], v2 offset0:8 offset1:9
v_mfma_f32_32x32x16_bf16 v[32:47], a[20:23], v[52:55], v[32:47]
ds_read_b128 v[52:55], v1 offset:11264
s_waitcnt lgkmcnt(9)
s_add_u32 m0, s25, 5120
s_add_u32 s20, s26, 3072
buffer_load_dwordx4 v0, s[4:7], s20 offen sc1 lds
v_mfma_f32_32x32x16_bf16 v[32:47], a[24:27], v[56:59], v[32:47]
s_waitcnt lgkmcnt(7)
s_add_u32 m0, s25, 6144
s_add_u32 s20, s26, 4096
buffer_load_dwordx4 v0, s[4:7], s20 offen sc1 lds
s_waitcnt lgkmcnt(6)
v_add_f32 v64, v64, v66
v_mfma_f32_32x32x16_bf16 v[32:47], a[28:31], v[60:63], v[32:47]
ds_read_b128 v[56:59], v1 offset:12288
ds_read_b128 v[60:63], v1 offset:13312
v_add_f32 v65, v65, v67
s_waitcnt lgkmcnt(5)
v_mfma_f32_32x32x16_bf16 v[32:47], a[32:35], v[48:51], v[32:47]
ds_read_b128 v[48:51], v1 offset:14336
v_add_f32 v65, v65, v73
s_waitcnt lgkmcnt(3)
v_add_f32 v65, v65, v75
v_mfma_f32_32x32x16_bf16 v[32:47], a[36:39], v[52:55], v[32:47]
s_add_u32 m0, s25, 7168
s_add_u32 s20, s26, 5120
buffer_load_dwordx4 v0, s[4:7], s20 offen sc1 lds
ds_read2st64_b32 v[84:85], v2 offset0:16 offset1:17
v_add_f32 v64, v64, v72
s_waitcnt lgkmcnt(3)
v_add_f32 v65, v65, v77
v_mfma_f32_32x32x16_bf16 v[32:47], a[40:43], v[56:59], v[32:47]
s_waitcnt lgkmcnt(2)
ds_read_b128 v[56:59], v1 offset:16384
ds_read_b128 v[52:55], v1 offset:15360
v_add_f32 v64, v64, v74
v_add_f32 v64, v64, v76
v_mfma_f32_32x32x16_bf16 v[32:47], a[44:47], v[60:63], v[32:47]
s_waitcnt lgkmcnt(3)
ds_read_b128 v[60:63], v1 offset:17408
v_add_f32 v65, v65, v79
v_mfma_f32_32x32x16_bf16 v[32:47], a[48:51], v[48:51], v[32:47]
v_add_f32 v64, v64, v78
s_add_u32 m0, s25, 8192
s_add_u32 s20, s26, 6144
buffer_load_dwordx4 v0, s[4:7], s20 offen sc1 lds
s_waitcnt lgkmcnt(1)
v_mfma_f32_32x32x16_bf16 v[32:47], a[52:55], v[52:55], v[32:47]
ds_read_b128 v[48:51], v1 offset:18432
v_add_f32 v65, v65, v81
s_waitcnt lgkmcnt(1)
ds_read_b128 v[52:55], v1 offset:19456
v_mfma_f32_32x32x16_bf16 v[32:47], a[56:59], v[56:59], v[32:47]
s_add_u32 m0, s25, 9216
s_add_u32 s20, s26, 7168
buffer_load_dwordx4 v0, s[4:7], s20 offen sc1 lds
v_mfma_f32_32x32x16_bf16 v[32:47], a[60:63], v[60:63], v[32:47]
ds_read_b128 v[60:63], v1 offset:21504
s_waitcnt lgkmcnt(2)
ds_read_b128 v[56:59], v1 offset:20480
v_mfma_f32_32x32x16_bf16 v[32:47], a[64:67], v[48:51], v[32:47]
v_add_f32 v65, v65, v83
s_waitcnt lgkmcnt(2)
ds_read_b128 v[48:51], v1 offset:22528
v_mfma_f32_32x32x16_bf16 v[32:47], a[68:71], v[52:55], v[32:47]
v_add_f32 v65, v65, v85
v_add_f32 v64, v64, v80
v_add_f32 v64, v64, v82
s_waitcnt lgkmcnt(2)
s_waitcnt lgkmcnt(1)
v_mfma_f32_32x32x16_bf16 v[32:47], a[72:75], v[56:59], v[32:47]
s_add_u32 m0, s25, 10240
s_add_u32 s20, s26, 8192
buffer_load_dwordx4 v0, s[4:7], s20 offen sc1 lds
ds_read_b128 v[52:55], v1 offset:23552
v_add_f32 v64, v64, v84
v_add_f32 v65, v65, v87
s_waitcnt lgkmcnt(1)
v_mfma_f32_32x32x16_bf16 v[32:47], a[76:79], v[60:63], v[32:47]
v_add_f32 v64, v64, v86
ds_read_b128 v[56:59], v1 offset:24576
v_mfma_f32_32x32x16_bf16 v[32:47], a[80:83], v[48:51], v[32:47]
ds_read_b128 v[60:63], v1 offset:25600
ds_read_b128 v[48:51], v1 offset:26624
v_add_f32 v64, v64, v65
v_mov_b32 v68, v64
s_waitcnt lgkmcnt(3)
v_mfma_f32_32x32x16_bf16 v[32:47], a[84:87], v[52:55], v[32:47]
s_add_u32 m0, s25, 11264
s_add_u32 s20, s26, 9216
buffer_load_dwordx4 v0, s[4:7], s20 offen sc1 lds
s_waitcnt lgkmcnt(2)
v_permlane32_swap_b32 v64, v68
v_mfma_f32_32x32x16_bf16 v[32:47], a[88:91], v[56:59], v[32:47]
ds_read_b128 v[56:59], v1 offset:28672
ds_read_b128 v[52:55], v1 offset:27648
v_mul_f32 v68, 0x3acccccd, v68
s_waitcnt lgkmcnt(3)
v_mul_f32 v64, 0x3acccccd, v64
v_fma_f32 v68, -v64, v64, v68
v_mfma_f32_32x32x16_bf16 v[32:47], a[92:95], v[60:63], v[32:47]
s_add_u32 m0, s35, s37
s_add_u32 s20, s36, s37
buffer_load_dwordx4 v0, s[4:7], s20 offen sc1 lds
ds_read_b128 v[60:63], v1 offset:29696
s_waitcnt lgkmcnt(3)
v_max_f32 v68, 0, v68
v_add_f32 v68, 0x3727c5ac, v68
v_mfma_f32_32x32x16_bf16 v[32:47], a[96:99], v[48:51], v[32:47]
ds_read_b128 v[48:51], v1 offset:30720
v_rsq_f32 v68, v68
s_waitcnt lgkmcnt(2)
v_mul_f32 v68, 0x3e0293ee, v68
v_mfma_f32_32x32x16_bf16 v[32:47], a[100:103], v[52:55], v[32:47]
s_add_u32 m0, s35, 4096
s_add_u32 s20, s36, 4096
buffer_load_dwordx4 v0, s[4:7], s20 offen sc1 lds
v_mul_f32 v64, v68, v64
s_waitcnt lgkmcnt(1)
v_mfma_f32_32x32x16_bf16 v[32:47], a[104:107], v[56:59], v[32:47]
v_mul_f32 v82, v64, v26
s_waitcnt lgkmcnt(0)
ds_read_b128 v[52:55], v1 offset:31744
ds_read_b128 v[56:59], v1 offset:32768
v_mfma_f32_32x32x16_bf16 v[32:47], a[108:111], v[60:63], v[32:47]
ds_read_b128 v[60:63], v1 offset:33792
v_mfma_f32_32x32x16_bf16 v[32:47], a[112:115], v[48:51], v[32:47]
s_waitcnt lgkmcnt(2)
v_mul_f32 v84, v64, v28
v_mul_f32 v73, v64, v17
v_mfma_f32_32x32x16_bf16 v[32:47], a[116:119], v[52:55], v[32:47]
ds_read_b128 v[52:55], v1 offset:35840
s_waitcnt lgkmcnt(2)
ds_read_b128 v[48:51], v1 offset:34816
v_mfma_f32_32x32x16_bf16 v[32:47], a[120:123], v[56:59], v[32:47]
v_mul_f32 v87, v64, v31
v_mul_f32 v77, v64, v21
v_mul_f32 v81, v64, v25
s_waitcnt lgkmcnt(2)
v_mfma_f32_32x32x16_bf16 v[32:47], a[124:127], v[60:63], v[32:47]
ds_read_b128 v[60:63], v1 offset:37888
s_waitcnt lgkmcnt(2)
s_waitcnt lgkmcnt(1)
ds_read_b128 v[56:59], v1 offset:36864
v_mfma_f32_32x32x16_bf16 v[32:47], a[128:131], v[48:51], v[32:47]
ds_read_b128 v[48:51], v1 offset:38912
v_mul_f32 v75, v64, v19
v_mfma_f32_32x32x16_bf16 v[32:47], a[132:135], v[52:55], v[32:47]
s_waitcnt lgkmcnt(1)
v_mfma_f32_32x32x16_bf16 v[32:47], a[136:139], v[56:59], v[32:47]
ds_read_b128 v[56:59], v1 offset:40960
ds_read_b128 v[52:55], v1 offset:39936
v_mul_f32 v79, v64, v23
v_mul_f32 v85, v64, v29
v_mul_f32 v76, v64, v20
v_mfma_f32_32x32x16_bf16 v[32:47], a[140:143], v[60:63], v[32:47]
s_waitcnt lgkmcnt(2)
ds_read_b128 v[60:63], v1 offset:41984
v_mul_f32 v74, v64, v18
v_mul_f32 v86, v64, v30
v_mfma_f32_32x32x16_bf16 v[32:47], a[144:147], v[48:51], v[32:47]
s_waitcnt lgkmcnt(1)
v_mfma_f32_32x32x16_bf16 v[32:47], a[148:151], v[52:55], v[32:47]
s_waitcnt lgkmcnt(0)
v_mfma_f32_32x32x16_bf16 v[32:47], a[152:155], v[56:59], v[32:47]
v_mfma_f32_32x32x16_bf16 v[32:47], a[156:159], v[60:63], v[32:47]
s_nop 0
v_mul_f32 v72, v64, v16
v_mul_f32 v78, v64, v22
v_mul_f32 v83, v64, v27
v_mul_f32 v80, v64, v24
s_nop 6
v_pk_fma_f32 v[44:45], v[44:45], v[68:69], v[84:85] op_sel_hi:[1,0,1] neg_lo:[0,0,1] neg_hi:[0,0,1]
v_pk_fma_f32 v[38:39], v[38:39], v[68:69], v[78:79] op_sel_hi:[1,0,1] neg_lo:[0,0,1] neg_hi:[0,0,1]
v_pk_fma_f32 v[42:43], v[42:43], v[68:69], v[82:83] op_sel_hi:[1,0,1] neg_lo:[0,0,1] neg_hi:[0,0,1]
v_pk_fma_f32 v[46:47], v[46:47], v[68:69], v[86:87] op_sel_hi:[1,0,1] neg_lo:[0,0,1] neg_hi:[0,0,1]
v_pk_fma_f32 v[34:35], v[34:35], v[68:69], v[74:75] op_sel_hi:[1,0,1] neg_lo:[0,0,1] neg_hi:[0,0,1]
v_pk_fma_f32 v[32:33], v[32:33], v[68:69], v[72:73] op_sel_hi:[1,0,1] neg_lo:[0,0,1] neg_hi:[0,0,1]
v_cvt_pk_bf16_f32 v51, v38, v39
v_cvt_pk_bf16_f32 v49, v34, v35
v_pk_fma_f32 v[36:37], v[36:37], v[68:69], v[76:77] op_sel_hi:[1,0,1] neg_lo:[0,0,1] neg_hi:[0,0,1]
v_cvt_pk_bf16_f32 v54, v44, v45
v_cvt_pk_bf16_f32 v50, v36, v37
v_cvt_pk_bf16_f32 v48, v32, v33
v_pk_fma_f32 v[40:41], v[40:41], v[68:69], v[80:81] op_sel_hi:[1,0,1] neg_lo:[0,0,1] neg_hi:[0,0,1]
v_cvt_pk_bf16_f32 v55, v46, v47
v_cvt_pk_bf16_f32 v53, v42, v43
v_cvt_pk_bf16_f32 v52, v40, v41
ds_write_b128 v13, v[48:51] offset:0
ds_write_b128 v13, v[52:55] offset:1024
v_add_u32 v13, 8192, v13
s_add_u32 s28, s28, 1
s_cmp_lt_u32 s28, 4
s_cbranch_scc1 qu_69
s_waitcnt lgkmcnt(0)
s_barrier
s_lshl_b32 s30, s52, 2
s_add_u32 s30, s30, s13
s_lshl_b32 s18, s16, 6
s_add_u32 s29, s18, s30
s_lshl_b32 s27, s29, 18
s_lshl_b32 s19, s32, 13
s_add_u32 s27, s27, s19
s_add_u32 s27, s27, 127926272
s_mul_i32 s18, s16, 35651584
s_mul_i32 s19, s30, 524288
s_add_u32 s18, s18, s19
s_mul_i32 s19, s32, 16384
s_add_u32 s18, s18, s19
s_add_u32 s29, s29, 1
s_mov_b32 s28, s29
s_lshl_b32 s19, s13, 13
s_add_u32 s19, s19, 83968
v_add_u32 v200, s19, v0
s_add_u32 s54, s18, 16777216
s_add_u32 s55, s18, 16781312
s_add_u32 s56, s18, 16785408
s_add_u32 s57, s18, 16789504
ds_read_b128 v[32:35], v200 offset:0
ds_read_b128 v[36:39], v200 offset:1024
ds_read_b128 v[40:43], v200 offset:2048
ds_read_b128 v[44:47], v200 offset:3072
ds_read_b128 v[48:51], v200 offset:4096
ds_read_b128 v[52:55], v200 offset:5120
ds_read_b128 v[56:59], v200 offset:6144
ds_read_b128 v[60:63], v200 offset:7168
v_and_b32 v14, 0x70, v0
v_lshrrev_b32 v200, 8, v0
v_lshl_add_u32 v14, v200, 7, v14
v_bfe_u32 v200, v0, 7, 1
v_lshl_add_u32 v14, v200, 12, v14
v_and_b32 v15, 0x70, v0
v_lshrrev_b32 v200, 8, v0
v_lshl_add_u32 v15, v200, 7, v15
v_bfe_u32 v200, v0, 7, 1
v_lshl_add_u32 v15, v200, 10, v15
v_bfe_u32 v200, v0, 4, 5
v_lshrrev_b32 v144, 9, v0
v_lshlrev_b32 v144, 2, v144
v_sub_u32 v200, v200, v144
v_mov_b32 v145, 0xf149f2ca
v_cmp_gt_i32 vcc, 0, v200
s_nop 1
v_cndmask_b32 v128, 0, v145, vcc
v_cmp_gt_i32 vcc, 1, v200
s_nop 1
v_cndmask_b32 v129, 0, v145, vcc
v_cmp_gt_i32 vcc, 2, v200
s_nop 1
v_cndmask_b32 v130, 0, v145, vcc
v_cmp_gt_i32 vcc, 3, v200
s_nop 1
v_cndmask_b32 v131, 0, v145, vcc
v_cmp_gt_i32 vcc, 8, v200
s_nop 1
v_cndmask_b32 v132, 0, v145, vcc
v_cmp_gt_i32 vcc, 9, v200
s_nop 1
v_cndmask_b32 v133, 0, v145, vcc
v_cmp_gt_i32 vcc, 10, v200
s_nop 1
v_cndmask_b32 v134, 0, v145, vcc
v_cmp_gt_i32 vcc, 11, v200
s_nop 1
v_cndmask_b32 v135, 0, v145, vcc
v_cmp_gt_i32 vcc, 16, v200
s_nop 1
v_cndmask_b32 v136, 0, v145, vcc
v_cmp_gt_i32 vcc, 17, v200
s_nop 1
v_cndmask_b32 v137, 0, v145, vcc
v_cmp_gt_i32 vcc, 18, v200
s_nop 1
v_cndmask_b32 v138, 0, v145, vcc
v_cmp_gt_i32 vcc, 19, v200
s_nop 1
v_cndmask_b32 v139, 0, v145, vcc
v_cmp_gt_i32 vcc, 24, v200
s_nop 1
v_cndmask_b32 v140, 0, v145, vcc
v_cmp_gt_i32 vcc, 25, v200
s_nop 1
v_cndmask_b32 v141, 0, v145, vcc
v_cmp_gt_i32 vcc, 26, v200
s_nop 1
v_cndmask_b32 v142, 0, v145, vcc
v_cmp_gt_i32 vcc, 27, v200
s_nop 1
v_cndmask_b32 v143, 0, v145, vcc
v_lshlrev_b32 v3, 3, v0
v_min_u32 v12, 128, v3
s_mov_b32 s17, 0
poll_70:
buffer_load_dword v8, v12, s[4:7], s53 offen sc1
s_add_u32 s17, s17, 1
s_cmp_gt_u32 s17, 262144
s_cbranch_scc1 L_fail
s_waitcnt vmcnt(0)
v_cmp_gt_u32 vcc, s29, v8
s_cbranch_vccz polld_71
s_sleep 2
s_branch poll_70
polld_71:
buffer_load_dwordx4 v[64:67], v14, s[4:7], s54 offen offset:0 sc1
buffer_load_dwordx4 v[68:71], v14, s[4:7], s54 offen offset:512 sc1
buffer_load_dwordx4 v[72:75], v14, s[4:7], s54 offen offset:1024 sc1
buffer_load_dwordx4 v[76:79], v14, s[4:7], s54 offen offset:1536 sc1
buffer_load_dwordx4 v[80:83], v14, s[4:7], s56 offen offset:0 sc1
buffer_load_dwordx4 v[84:87], v14, s[4:7], s56 offen offset:512 sc1
buffer_load_dwordx4 v[88:91], v14, s[4:7], s56 offen offset:1024 sc1
buffer_load_dwordx4 v[92:95], v14, s[4:7], s56 offen offset:1536 sc1
buffer_load_dwordx4 v[96:99], v15, s[4:7], s54 offen offset:2048 sc1
buffer_load_dwordx4 v[100:103], v15, s[4:7], s54 offen offset:2560 sc1
buffer_load_dwordx4 v[104:107], v15, s[4:7], s55 offen offset:2048 sc1
buffer_load_dwordx4 v[108:111], v15, s[4:7], s55 offen offset:2560 sc1
buffer_load_dwordx4 v[112:115], v15, s[4:7], s56 offen offset:2048 sc1
buffer_load_dwordx4 v[116:119], v15, s[4:7], s56 offen offset:2560 sc1
buffer_load_dwordx4 v[120:123], v15, s[4:7], s57 offen offset:2048 sc1
buffer_load_dwordx4 v[124:127], v15, s[4:7], s57 offen offset:2560 sc1
s_waitcnt vmcnt(15) lgkmcnt(7)
v_mfma_f32_32x32x16_bf16 v[128:143], v[64:67], v[32:35], v[128:143]
s_waitcnt vmcnt(14) lgkmcnt(6)
v_mfma_f32_32x32x16_bf16 v[128:143], v[68:71], v[36:39], v[128:143]
s_waitcnt vmcnt(13) lgkmcnt(5)
v_mfma_f32_32x32x16_bf16 v[128:143], v[72:75], v[40:43], v[128:143]
s_waitcnt vmcnt(12) lgkmcnt(4)
v_mfma_f32_32x32x16_bf16 v[128:143], v[76:79], v[44:47], v[128:143]
s_waitcnt vmcnt(11) lgkmcnt(3)
v_mfma_f32_32x32x16_bf16 v[128:143], v[80:83], v[48:51], v[128:143]
s_waitcnt vmcnt(10) lgkmcnt(2)
v_mfma_f32_32x32x16_bf16 v[128:143], v[84:87], v[52:55], v[128:143]
s_waitcnt vmcnt(9) lgkmcnt(1)
v_mfma_f32_32x32x16_bf16 v[128:143], v[88:91], v[56:59], v[128:143]
s_waitcnt vmcnt(8) lgkmcnt(0)
v_mfma_f32_32x32x16_bf16 v[128:143], v[92:95], v[60:63], v[128:143]
s_lshl_b32 s18, s16, 4
s_add_u32 s29, s18, s52
s_lshl_b32 s18, s29, 19
s_lshl_b32 s19, s32, 14
s_add_u32 s18, s18, s19
s_add_u32 s29, s29, 1
s_and_b32 s19, s13, 1
s_lshr_b32 s20, s13, 1
v_and_b32 v14, 0x170, v14
v_lshl_add_u32 v14, s19, 12, v14
v_lshl_add_u32 v14, s20, 7, v14
v_lshl_add_u32 v15, s19, 3, v15
v_lshl_add_u32 v15, s20, 9, v15
s_add_u32 s54, s18, 110100480
s_add_u32 s55, s18, 110104576
s_add_u32 s56, s18, 110108672
s_add_u32 s57, s18, 110112768
v_max3_f32 v200, v128, v129, v130
v_max3_f32 v200, v200, v131, v132
v_max3_f32 v200, v200, v133, v134
v_max3_f32 v200, v200, v135, v136
v_max3_f32 v200, v200, v137, v138
v_max3_f32 v200, v200, v139, v140
v_max3_f32 v200, v200, v141, v142
v_max_f32 v200, v200, v143
s_add_u32 s18, s53, 8192
v_lshlrev_b32 v3, 3, v0
v_min_u32 v12, 128, v3
s_mov_b32 s17, 0
poll_72:
buffer_load_dword v8, v12, s[4:7], s18 offen sc1
s_add_u32 s17, s17, 1
s_cmp_gt_u32 s17, 262144
s_cbranch_scc1 L_fail
s_waitcnt vmcnt(0)
v_cmp_gt_u32 vcc, s29, v8
s_cbranch_vccz polld_73
s_sleep 2
s_branch poll_72
polld_73:
buffer_load_dwordx4 v[64:67], v14, s[4:7], s54 offen offset:0 sc1
buffer_load_dwordx4 v[68:71], v14, s[4:7], s54 offen offset:512 sc1
buffer_load_dwordx4 v[72:75], v14, s[4:7], s54 offen offset:1024 sc1
buffer_load_dwordx4 v[76:79], v14, s[4:7], s54 offen offset:1536 sc1
buffer_load_dwordx4 v[80:83], v14, s[4:7], s56 offen offset:0 sc1
buffer_load_dwordx4 v[84:87], v14, s[4:7], s56 offen offset:512 sc1
buffer_load_dwordx4 v[88:91], v14, s[4:7], s56 offen offset:1024 sc1
buffer_load_dwordx4 v[92:95], v14, s[4:7], s56 offen offset:1536 sc1
buffer_load_dwordx2 v[192:193], v15, s[4:7], s54 offen offset:2048 sc1
buffer_load_dwordx2 v[194:195], v15, s[4:7], s55 offen offset:2048 sc1
buffer_load_dwordx2 v[196:197], v15, s[4:7], s56 offen offset:2048 sc1
buffer_load_dwordx2 v[198:199], v15, s[4:7], s57 offen offset:2048 sc1
s_waitcnt vmcnt(11)
v_mfma_f32_32x32x16_bf16 v[144:159], v[64:67], v[32:35], 0
s_waitcnt vmcnt(10)
v_mfma_f32_32x32x16_bf16 v[144:159], v[68:71], v[36:39], v[144:159]
s_waitcnt vmcnt(9)
v_mfma_f32_32x32x16_bf16 v[144:159], v[72:75], v[40:43], v[144:159]
s_waitcnt vmcnt(8)
v_mfma_f32_32x32x16_bf16 v[144:159], v[76:79], v[44:47], v[144:159]
s_waitcnt vmcnt(7)
v_mfma_f32_32x32x16_bf16 v[144:159], v[80:83], v[48:51], v[144:159]
s_waitcnt vmcnt(6)
v_mfma_f32_32x32x16_bf16 v[144:159], v[84:87], v[52:55], v[144:159]
s_waitcnt vmcnt(5)
v_mfma_f32_32x32x16_bf16 v[144:159], v[88:91], v[56:59], v[144:159]
s_waitcnt vmcnt(4)
v_mfma_f32_32x32x16_bf16 v[144:159], v[92:95], v[60:63], v[144:159]
s_nop 11
v_max3_f32 v148, v200, v144, v145
v_max3_f32 v148, v148, v146, v147
v_mov_b32 v150, v148
s_nop 1
v_permlane32_swap_b32 v148, v150
v_max_f32 v148, v148, v150
v_sub_f32 v145, v145, v148
v_sub_f32 v146, v146, v148
v_sub_f32 v144, v144, v148
v_exp_f32 v145, v145
v_sub_f32 v147, v147, v148
v_exp_f32 v146, v146
v_exp_f32 v144, v144
v_exp_f32 v147, v147
v_cvt_pk_bf16_f32 v40, v144, v145
v_cvt_pk_bf16_f32 v41, v146, v147
v_sub_f32 v132, v132, v148
v_sub_f32 v128, v128, v148
s_waitcnt vmcnt(3)
v_mfma_f32_32x32x8_bf16 v[160:175], v[192:193], v[40:41], 0
v_sub_f32 v133, v133, v148
v_sub_f32 v130, v130, v148
v_sub_f32 v134, v134, v148
v_sub_f32 v131, v131, v148
v_exp_f32 v132, v132
s_waitcnt vmcnt(0)
v_mfma_f32_32x32x8_bf16 v[80:95], v[198:199], v[40:41], 0
v_sub_f32 v129, v129, v148
v_sub_f32 v135, v135, v148
v_exp_f32 v128, v128
v_exp_f32 v133, v133
v_mfma_f32_32x32x8_bf16 v[176:191], v[194:195], v[40:41], 0
v_exp_f32 v130, v130
v_exp_f32 v135, v135
v_exp_f32 v131, v131
v_mfma_f32_32x32x8_bf16 v[64:79], v[196:197], v[40:41], 0
v_exp_f32 v129, v129
v_cvt_pk_bf16_f32 v33, v130, v131
v_cvt_pk_bf16_f32 v34, v132, v133
v_exp_f32 v134, v134
v_cvt_pk_bf16_f32 v32, v128, v129
v_cvt_pk_bf16_f32 v35, v134, v135
v_sub_f32 v136, v136, v148
v_sub_f32 v140, v140, v148
v_mfma_f32_32x32x16_bf16 v[176:191], v[104:107], v[32:35], v[176:191]
v_sub_f32 v141, v141, v148
v_sub_f32 v142, v142, v148
v_sub_f32 v139, v139, v148
v_sub_f32 v138, v138, v148
v_sub_f32 v137, v137, v148
v_sub_f32 v143, v143, v148
v_mfma_f32_32x32x16_bf16 v[64:79], v[112:115], v[32:35], v[64:79]
v_exp_f32 v139, v139
v_exp_f32 v136, v136
v_exp_f32 v141, v141
v_mfma_f32_32x32x16_bf16 v[160:175], v[96:99], v[32:35], v[160:175]
s_add_u32 s19, s27, 4096
v_exp_f32 v142, v142
v_exp_f32 v143, v143
v_exp_f32 v138, v138
v_mfma_f32_32x32x16_bf16 v[80:95], v[120:123], v[32:35], v[80:95]
v_exp_f32 v137, v137
v_cvt_pk_bf16_f32 v37, v138, v139
v_cvt_pk_bf16_f32 v36, v136, v137
v_exp_f32 v140, v140
v_cvt_pk_bf16_f32 v39, v142, v143
v_cvt_pk_bf16_f32 v38, v140, v141
v_add_f32 v149, v128, v129
v_add_f32 v149, v149, v130
v_mfma_f32_32x32x16_bf16 v[160:175], v[100:103], v[36:39], v[160:175]
v_add_f32 v149, v149, v131
v_add_f32 v149, v149, v132
v_add_f32 v149, v149, v133
v_add_f32 v149, v149, v134
v_add_f32 v149, v149, v135
v_add_f32 v149, v149, v136
v_mfma_f32_32x32x16_bf16 v[176:191], v[108:111], v[36:39], v[176:191]
v_add_f32 v149, v149, v137
v_add_f32 v149, v149, v138
v_add_f32 v149, v149, v139
v_add_f32 v149, v149, v140
v_add_f32 v149, v149, v141
v_add_f32 v149, v149, v142
v_mfma_f32_32x32x16_bf16 v[80:95], v[124:127], v[36:39], v[80:95]
v_add_f32 v149, v149, v143
v_add_f32 v149, v149, v144
v_add_f32 v149, v149, v145
v_add_f32 v149, v149, v146
v_add_f32 v149, v149, v147
v_mov_b32 v150, v149
v_mfma_f32_32x32x16_bf16 v[64:79], v[116:119], v[36:39], v[64:79]
s_nop 0
v_permlane32_swap_b32 v149, v150
v_add_f32 v149, v149, v150
v_rcp_f32 v149, v149
s_nop 0
v_mul_f32 v171, v171, v149
v_mul_f32 v167, v167, v149
v_mul_f32 v160, v160, v149
v_mul_f32 v178, v178, v149
v_mul_f32 v191, v191, v149
v_mul_f32 v172, v172, v149
v_mul_f32 v162, v162, v149
v_mul_f32 v76, v76, v149
v_mul_f32 v161, v161, v149
v_mul_f32 v78, v78, v149
v_mul_f32 v163, v163, v149
v_mul_f32 v90, v90, v149
v_mul_f32 v177, v177, v149
v_mul_f32 v71, v71, v149
v_mul_f32 v174, v174, v149
v_mul_f32 v79, v79, v149
v_cvt_pk_bf16_f32 v160, v160, v161
v_mul_f32 v190, v190, v149
v_mul_f32 v181, v181, v149
v_mul_f32 v85, v85, v149
v_mul_f32 v176, v176, v149
v_mul_f32 v179, v179, v149
v_mul_f32 v80, v80, v149
v_mul_f32 v64, v64, v149
v_mul_f32 v73, v73, v149
v_mul_f32 v168, v168, v149
v_mul_f32 v87, v87, v149
v_mul_f32 v175, v175, v149
v_mul_f32 v188, v188, v149
v_mul_f32 v86, v86, v149
v_mul_f32 v182, v182, v149
v_mul_f32 v165, v165, v149
v_mul_f32 v65, v65, v149
v_mul_f32 v180, v180, v149
v_mul_f32 v164, v164, v149
v_mul_f32 v84, v84, v149
v_mul_f32 v170, v170, v149
v_cvt_pk_bf16_f32 v176, v176, v177
v_cvt_pk_bf16_f32 v177, v178, v179
v_mul_f32 v166, v166, v149
v_mul_f32 v169, v169, v149
v_mul_f32 v184, v184, v149
v_cvt_pk_bf16_f32 v161, v162, v163
v_cvt_pk_bf16_f32 v163, v166, v167
v_mul_f32 v173, v173, v149
v_mul_f32 v88, v88, v149
v_cvt_pk_bf16_f32 v162, v164, v165
v_mul_f32 v189, v189, v149
v_mul_f32 v74, v74, v149
v_mul_f32 v82, v82, v149
v_mul_f32 v81, v81, v149
v_mul_f32 v77, v77, v149
v_cvt_pk_bf16_f32 v64, v64, v65
v_mul_f32 v183, v183, v149
v_mul_f32 v185, v185, v149
v_cvt_pk_bf16_f32 v164, v168, v169
v_mul_f32 v68, v68, v149
v_cvt_pk_bf16_f32 v179, v182, v183
v_cvt_pk_bf16_f32 v167, v174, v175
v_cvt_pk_bf16_f32 v178, v180, v181
v_mul_f32 v93, v93, v149
v_mul_f32 v187, v187, v149
v_cvt_pk_bf16_f32 v166, v172, v173
v_mul_f32 v66, v66, v149
v_cvt_pk_bf16_f32 v165, v170, v171
v_mul_f32 v67, v67, v149
v_mul_f32 v69, v69, v149
v_mul_f32 v83, v83, v149
buffer_store_dwordx4 v[160:163], v0, s[4:7], s27 offen offset:0 sc1
buffer_store_dwordx4 v[164:167], v0, s[4:7], s27 offen offset:1024 sc1
buffer_store_dwordx4 v[176:179], v0, s[4:7], s27 offen offset:2048 sc1
v_mul_f32 v94, v94, v149
v_cvt_pk_bf16_f32 v180, v184, v185
v_mul_f32 v89, v89, v149
v_cvt_pk_bf16_f32 v65, v66, v67
v_cvt_pk_bf16_f32 v182, v188, v189
v_mul_f32 v72, v72, v149
v_mul_f32 v95, v95, v149
v_mul_f32 v186, v186, v149
v_mul_f32 v92, v92, v149
v_mul_f32 v70, v70, v149
v_mul_f32 v75, v75, v149
v_cvt_pk_bf16_f32 v80, v80, v81
v_cvt_pk_bf16_f32 v81, v82, v83
v_cvt_pk_bf16_f32 v67, v70, v71
v_cvt_pk_bf16_f32 v66, v68, v69
v_cvt_pk_bf16_f32 v83, v86, v87
v_cvt_pk_bf16_f32 v183, v190, v191
v_cvt_pk_bf16_f32 v70, v76, v77
v_cvt_pk_bf16_f32 v82, v84, v85
v_cvt_pk_bf16_f32 v71, v78, v79
v_cvt_pk_bf16_f32 v87, v94, v95
v_cvt_pk_bf16_f32 v69, v74, v75
v_cvt_pk_bf16_f32 v84, v88, v89
v_mul_f32 v91, v91, v149
v_cvt_pk_bf16_f32 v86, v92, v93
v_cvt_pk_bf16_f32 v85, v90, v91
v_cvt_pk_bf16_f32 v68, v72, v73
v_cvt_pk_bf16_f32 v181, v186, v187
buffer_store_dwordx4 v[180:183], v0, s[4:7], s27 offen offset:3072 sc1
buffer_store_dwordx4 v[64:67], v0, s[4:7], s19 offen offset:0 sc1
buffer_store_dwordx4 v[68:71], v0, s[4:7], s19 offen offset:1024 sc1
buffer_store_dwordx4 v[80:83], v0, s[4:7], s19 offen offset:2048 sc1
buffer_store_dwordx4 v[84:87], v0, s[4:7], s19 offen offset:3072 sc1
s_and_b32 s18, s30, 7
s_lshl_b32 s18, s18, 5
s_add_u32 s18, s18, s32
s_lshl_b32 s18, s18, 7
s_add_u32 s18, s18, 11632640
s_waitcnt vmcnt(0)
v_mov_b32 v3, s28
s_mov_b64 exec, 1
buffer_store_dword v3, off, s[4:7], s18 sc1
s_mov_b64 exec, -1
s_add_u32 s52, s52, 2
s_cmp_lt_u32 s52, 16
s_cbranch_scc1 qr_68
s_barrier
s_branch aend_64
wo_62:
s_sub_u32 s18, s39, 64
s_mul_i32 s30, s18, 3277
s_lshr_b32 s30, s30, 16
s_mul_i32 s19, s30, 20
s_sub_u32 s52, s18, s19
s_cmp_lg_u32 s16, 0
s_cbranch_scc1 ww_74
s_mul_i32 s26, s13, 1310720
s_lshl_b32 s18, s52, 6
s_add_u32 s26, s26, s18
s_load_dwordx2 s[40:41], s[0:1], 64
s_mov_b32 s42, 5242880
s_mov_b32 s43, 0x20000
s_waitcnt lgkmcnt(0)
v_lshrrev_b32 v214, 6, v0
v_mul_u32_u24 v214, 1280, v214
v_and_b32 v215, 48, v0
v_add_u32 v212, v214, v215
v_bfe_u32 v214, v0, 6, 2
v_lshrrev_b32 v215, 9, v0
v_lshl_add_u32 v214, v215, 3, v214
v_lshlrev_b32 v213, 6, v214
v_and_b32 v214, 16, v0
v_add_u32 v213, v213, v214
v_bfe_u32 v214, v0, 5, 1
v_lshl_add_u32 v213, v214, 3, v213
v_bfe_u32 v214, v0, 8, 1
v_lshl_add_u32 v213, v214, 5, v213
s_mul_i32 s18, s13, 36864
v_add_u32 v213, s18, v213
s_barrier
s_add_u32 m0, s18, 0
s_add_u32 s19, s26, 0
buffer_load_dwordx4 v212, s[40:43], s19 offen lds
s_add_u32 m0, s18, 1024
s_add_u32 s19, s26, 20480
buffer_load_dwordx4 v212, s[40:43], s19 offen lds
s_add_u32 m0, s18, 2048
s_add_u32 s19, s26, 40960
buffer_load_dwordx4 v212, s[40:43], s19 offen lds
s_add_u32 m0, s18, 3072
s_add_u32 s19, s26, 61440
buffer_load_dwordx4 v212, s[40:43], s19 offen lds
s_add_u32 m0, s18, 4096
s_add_u32 s19, s26, 81920
buffer_load_dwordx4 v212, s[40:43], s19 offen lds
s_add_u32 m0, s18, 5120
s_add_u32 s19, s26, 102400
buffer_load_dwordx4 v212, s[40:43], s19 offen lds
s_add_u32 m0, s18, 6144
s_add_u32 s19, s26, 122880
buffer_load_dwordx4 v212, s[40:43], s19 offen lds
s_add_u32 m0, s18, 7168
s_add_u32 s19, s26, 143360
buffer_load_dwordx4 v212, s[40:43], s19 offen lds
s_add_u32 m0, s18, 8192
s_add_u32 s19, s26, 163840
buffer_load_dwordx4 v212, s[40:43], s19 offen lds
s_add_u32 m0, s18, 9216
s_add_u32 s19, s26, 184320
buffer_load_dwordx4 v212, s[40:43], s19 offen lds
s_add_u32 m0, s18, 10240
s_add_u32 s19, s26, 204800
buffer_load_dwordx4 v212, s[40:43], s19 offen lds
s_add_u32 m0, s18, 11264
s_add_u32 s19, s26, 225280
buffer_load_dwordx4 v212, s[40:43], s19 offen lds
s_add_u32 m0, s18, 12288
s_add_u32 s19, s26, 245760
buffer_load_dwordx4 v212, s[40:43], s19 offen lds
s_add_u32 m0, s18, 13312
s_add_u32 s19, s26, 266240
buffer_load_dwordx4 v212, s[40:43], s19 offen lds
s_add_u32 m0, s18, 14336
s_add_u32 s19, s26, 286720
buffer_load_dwordx4 v212, s[40:43], s19 offen lds
s_add_u32 m0, s18, 15360
s_add_u32 s19, s26, 307200
buffer_load_dwordx4 v212, s[40:43], s19 offen lds
s_add_u32 m0, s18, 16384
s_add_u32 s19, s26, 327680
buffer_load_dwordx4 v212, s[40:43], s19 offen lds
s_add_u32 m0, s18, 17408
s_add_u32 s19, s26, 348160
buffer_load_dwordx4 v212, s[40:43], s19 offen lds
s_add_u32 m0, s18, 18432
s_add_u32 s19, s26, 368640
buffer_load_dwordx4 v212, s[40:43], s19 offen lds
s_add_u32 m0, s18, 19456
s_add_u32 s19, s26, 389120
buffer_load_dwordx4 v212, s[40:43], s19 offen lds
s_add_u32 m0, s18, 20480
s_add_u32 s19, s26, 409600
buffer_load_dwordx4 v212, s[40:43], s19 offen lds
s_add_u32 m0, s18, 21504
s_add_u32 s19, s26, 430080
buffer_load_dwordx4 v212, s[40:43], s19 offen lds
s_add_u32 m0, s18, 22528
s_add_u32 s19, s26, 450560
buffer_load_dwordx4 v212, s[40:43], s19 offen lds
s_add_u32 m0, s18, 23552
s_add_u32 s19, s26, 471040
buffer_load_dwordx4 v212, s[40:43], s19 offen lds
s_add_u32 m0, s18, 24576
s_add_u32 s19, s26, 491520
buffer_load_dwordx4 v212, s[40:43], s19 offen lds
s_add_u32 m0, s18, 25600
s_add_u32 s19, s26, 512000
buffer_load_dwordx4 v212, s[40:43], s19 offen lds
s_add_u32 m0, s18, 26624
s_add_u32 s19, s26, 532480
buffer_load_dwordx4 v212, s[40:43], s19 offen lds
s_add_u32 m0, s18, 27648
s_add_u32 s19, s26, 552960
buffer_load_dwordx4 v212, s[40:43], s19 offen lds
s_add_u32 m0, s18, 28672
s_add_u32 s19, s26, 573440
buffer_load_dwordx4 v212, s[40:43], s19 offen lds
s_add_u32 m0, s18, 29696
s_add_u32 s19, s26, 593920
buffer_load_dwordx4 v212, s[40:43], s19 offen lds
s_add_u32 m0, s18, 30720
s_add_u32 s19, s26, 614400
buffer_load_dwordx4 v212, s[40:43], s19 offen lds
s_add_u32 m0, s18, 31744
s_add_u32 s19, s26, 634880
buffer_load_dwordx4 v212, s[40:43], s19 offen lds
s_add_u32 m0, s18, 32768
s_add_u32 s19, s26, 655360
buffer_load_dwordx4 v212, s[40:43], s19 offen lds
s_add_u32 m0, s18, 33792
s_add_u32 s19, s26, 675840
buffer_load_dwordx4 v212, s[40:43], s19 offen lds
s_add_u32 m0, s18, 34816
s_add_u32 s19, s26, 696320
buffer_load_dwordx4 v212, s[40:43], s19 offen lds
s_add_u32 m0, s18, 35840
s_add_u32 s19, s26, 716800
buffer_load_dwordx4 v212, s[40:43], s19 offen lds
s_waitcnt vmcnt(32)
ds_read_b64_tr_b16 a[0:1], v213 offset:0
ds_read_b64_tr_b16 a[2:3], v213 offset:256
ds_read_b64_tr_b16 a[4:5], v213 offset:1024
ds_read_b64_tr_b16 a[6:7], v213 offset:1280
ds_read_b64_tr_b16 a[8:9], v213 offset:2048
ds_read_b64_tr_b16 a[10:11], v213 offset:2304
ds_read_b64_tr_b16 a[12:13], v213 offset:3072
ds_read_b64_tr_b16 a[14:15], v213 offset:3328
s_waitcnt lgkmcnt(0)
s_add_u32 m0, s18, 0
s_add_u32 s19, s26, 737280
buffer_load_dwordx4 v212, s[40:43], s19 offen lds
s_add_u32 m0, s18, 1024
s_add_u32 s19, s26, 757760
buffer_load_dwordx4 v212, s[40:43], s19 offen lds
s_add_u32 m0, s18, 2048
s_add_u32 s19, s26, 778240
buffer_load_dwordx4 v212, s[40:43], s19 offen lds
s_add_u32 m0, s18, 3072
s_add_u32 s19, s26, 798720
buffer_load_dwordx4 v212, s[40:43], s19 offen lds
s_waitcnt vmcnt(32)
ds_read_b64_tr_b16 a[16:17], v213 offset:4096
ds_read_b64_tr_b16 a[18:19], v213 offset:4352
ds_read_b64_tr_b16 a[20:21], v213 offset:5120
ds_read_b64_tr_b16 a[22:23], v213 offset:5376
ds_read_b64_tr_b16 a[24:25], v213 offset:6144
ds_read_b64_tr_b16 a[26:27], v213 offset:6400
ds_read_b64_tr_b16 a[28:29], v213 offset:7168
ds_read_b64_tr_b16 a[30:31], v213 offset:7424
s_waitcnt lgkmcnt(0)
s_add_u32 m0, s18, 4096
s_add_u32 s19, s26, 819200
buffer_load_dwordx4 v212, s[40:43], s19 offen lds
s_add_u32 m0, s18, 5120
s_add_u32 s19, s26, 839680
buffer_load_dwordx4 v212, s[40:43], s19 offen lds
s_add_u32 m0, s18, 6144
s_add_u32 s19, s26, 860160
buffer_load_dwordx4 v212, s[40:43], s19 offen lds
s_add_u32 m0, s18, 7168
s_add_u32 s19, s26, 880640
buffer_load_dwordx4 v212, s[40:43], s19 offen lds
s_waitcnt vmcnt(32)
ds_read_b64_tr_b16 a[32:33], v213 offset:8192
ds_read_b64_tr_b16 a[34:35], v213 offset:8448
ds_read_b64_tr_b16 a[36:37], v213 offset:9216
ds_read_b64_tr_b16 a[38:39], v213 offset:9472
ds_read_b64_tr_b16 a[40:41], v213 offset:10240
ds_read_b64_tr_b16 a[42:43], v213 offset:10496
ds_read_b64_tr_b16 a[44:45], v213 offset:11264
ds_read_b64_tr_b16 a[46:47], v213 offset:11520
s_waitcnt lgkmcnt(0)
s_add_u32 m0, s18, 8192
s_add_u32 s19, s26, 901120
buffer_load_dwordx4 v212, s[40:43], s19 offen lds
s_add_u32 m0, s18, 9216
s_add_u32 s19, s26, 921600
buffer_load_dwordx4 v212, s[40:43], s19 offen lds
s_add_u32 m0, s18, 10240
s_add_u32 s19, s26, 942080
buffer_load_dwordx4 v212, s[40:43], s19 offen lds
s_add_u32 m0, s18, 11264
s_add_u32 s19, s26, 962560
buffer_load_dwordx4 v212, s[40:43], s19 offen lds
s_waitcnt vmcnt(32)
ds_read_b64_tr_b16 a[48:49], v213 offset:12288
ds_read_b64_tr_b16 a[50:51], v213 offset:12544
ds_read_b64_tr_b16 a[52:53], v213 offset:13312
ds_read_b64_tr_b16 a[54:55], v213 offset:13568
ds_read_b64_tr_b16 a[56:57], v213 offset:14336
ds_read_b64_tr_b16 a[58:59], v213 offset:14592
ds_read_b64_tr_b16 a[60:61], v213 offset:15360
ds_read_b64_tr_b16 a[62:63], v213 offset:15616
s_waitcnt lgkmcnt(0)
s_add_u32 m0, s18, 12288
s_add_u32 s19, s26, 983040
buffer_load_dwordx4 v212, s[40:43], s19 offen lds
s_add_u32 m0, s18, 13312
s_add_u32 s19, s26, 1003520
buffer_load_dwordx4 v212, s[40:43], s19 offen lds
s_add_u32 m0, s18, 14336
s_add_u32 s19, s26, 1024000
buffer_load_dwordx4 v212, s[40:43], s19 offen lds
s_add_u32 m0, s18, 15360
s_add_u32 s19, s26, 1044480
buffer_load_dwordx4 v212, s[40:43], s19 offen lds
s_waitcnt vmcnt(32)
ds_read_b64_tr_b16 a[64:65], v213 offset:16384
ds_read_b64_tr_b16 a[66:67], v213 offset:16640
ds_read_b64_tr_b16 a[68:69], v213 offset:17408
ds_read_b64_tr_b16 a[70:71], v213 offset:17664
ds_read_b64_tr_b16 a[72:73], v213 offset:18432
ds_read_b64_tr_b16 a[74:75], v213 offset:18688
ds_read_b64_tr_b16 a[76:77], v213 offset:19456
ds_read_b64_tr_b16 a[78:79], v213 offset:19712
s_waitcnt lgkmcnt(0)
s_add_u32 m0, s18, 16384
s_add_u32 s19, s26, 1064960
buffer_load_dwordx4 v212, s[40:43], s19 offen lds
s_add_u32 m0, s18, 17408
s_add_u32 s19, s26, 1085440
buffer_load_dwordx4 v212, s[40:43], s19 offen lds
s_add_u32 m0, s18, 18432
s_add_u32 s19, s26, 1105920
buffer_load_dwordx4 v212, s[40:43], s19 offen lds
s_add_u32 m0, s18, 19456
s_add_u32 s19, s26, 1126400
buffer_load_dwordx4 v212, s[40:43], s19 offen lds
s_waitcnt vmcnt(32)
ds_read_b64_tr_b16 a[80:81], v213 offset:20480
ds_read_b64_tr_b16 a[82:83], v213 offset:20736
ds_read_b64_tr_b16 a[84:85], v213 offset:21504
ds_read_b64_tr_b16 a[86:87], v213 offset:21760
ds_read_b64_tr_b16 a[88:89], v213 offset:22528
ds_read_b64_tr_b16 a[90:91], v213 offset:22784
ds_read_b64_tr_b16 a[92:93], v213 offset:23552
ds_read_b64_tr_b16 a[94:95], v213 offset:23808
s_waitcnt lgkmcnt(0)
s_add_u32 m0, s18, 20480
s_add_u32 s19, s26, 1146880
buffer_load_dwordx4 v212, s[40:43], s19 offen lds
s_add_u32 m0, s18, 21504
s_add_u32 s19, s26, 1167360
buffer_load_dwordx4 v212, s[40:43], s19 offen lds
s_add_u32 m0, s18, 22528
s_add_u32 s19, s26, 1187840
buffer_load_dwordx4 v212, s[40:43], s19 offen lds
s_add_u32 m0, s18, 23552
s_add_u32 s19, s26, 1208320
buffer_load_dwordx4 v212, s[40:43], s19 offen lds
s_waitcnt vmcnt(32)
ds_read_b64_tr_b16 a[96:97], v213 offset:24576
ds_read_b64_tr_b16 a[98:99], v213 offset:24832
ds_read_b64_tr_b16 a[100:101], v213 offset:25600
ds_read_b64_tr_b16 a[102:103], v213 offset:25856
ds_read_b64_tr_b16 a[104:105], v213 offset:26624
ds_read_b64_tr_b16 a[106:107], v213 offset:26880
ds_read_b64_tr_b16 a[108:109], v213 offset:27648
ds_read_b64_tr_b16 a[110:111], v213 offset:27904
s_waitcnt lgkmcnt(0)
s_add_u32 m0, s18, 24576
s_add_u32 s19, s26, 1228800
buffer_load_dwordx4 v212, s[40:43], s19 offen lds
s_add_u32 m0, s18, 25600
s_add_u32 s19, s26, 1249280
buffer_load_dwordx4 v212, s[40:43], s19 offen lds
s_add_u32 m0, s18, 26624
s_add_u32 s19, s26, 1269760
buffer_load_dwordx4 v212, s[40:43], s19 offen lds
s_add_u32 m0, s18, 27648
s_add_u32 s19, s26, 1290240
buffer_load_dwordx4 v212, s[40:43], s19 offen lds
s_waitcnt vmcnt(32)
ds_read_b64_tr_b16 a[112:113], v213 offset:28672
ds_read_b64_tr_b16 a[114:115], v213 offset:28928
ds_read_b64_tr_b16 a[116:117], v213 offset:29696
ds_read_b64_tr_b16 a[118:119], v213 offset:29952
ds_read_b64_tr_b16 a[120:121], v213 offset:30720
ds_read_b64_tr_b16 a[122:123], v213 offset:30976
ds_read_b64_tr_b16 a[124:125], v213 offset:31744
ds_read_b64_tr_b16 a[126:127], v213 offset:32000
s_waitcnt vmcnt(28)
ds_read_b64_tr_b16 a[128:129], v213 offset:32768
ds_read_b64_tr_b16 a[130:131], v213 offset:33024
ds_read_b64_tr_b16 a[132:133], v213 offset:33792
ds_read_b64_tr_b16 a[134:135], v213 offset:34048
ds_read_b64_tr_b16 a[136:137], v213 offset:34816
ds_read_b64_tr_b16 a[138:139], v213 offset:35072
ds_read_b64_tr_b16 a[140:141], v213 offset:35840
ds_read_b64_tr_b16 a[142:143], v213 offset:36096
s_waitcnt vmcnt(24)
ds_read_b64_tr_b16 a[144:145], v213 offset:0
ds_read_b64_tr_b16 a[146:147], v213 offset:256
ds_read_b64_tr_b16 a[148:149], v213 offset:1024
ds_read_b64_tr_b16 a[150:151], v213 offset:1280
ds_read_b64_tr_b16 a[152:153], v213 offset:2048
ds_read_b64_tr_b16 a[154:155], v213 offset:2304
ds_read_b64_tr_b16 a[156:157], v213 offset:3072
ds_read_b64_tr_b16 a[158:159], v213 offset:3328
s_waitcnt vmcnt(20)
ds_read_b64_tr_b16 a[160:161], v213 offset:4096
ds_read_b64_tr_b16 a[162:163], v213 offset:4352
ds_read_b64_tr_b16 a[164:165], v213 offset:5120
ds_read_b64_tr_b16 a[166:167], v213 offset:5376
ds_read_b64_tr_b16 a[168:169], v213 offset:6144
ds_read_b64_tr_b16 a[170:171], v213 offset:6400
ds_read_b64_tr_b16 a[172:173], v213 offset:7168
ds_read_b64_tr_b16 a[174:175], v213 offset:7424
s_waitcnt vmcnt(16)
ds_read_b64_tr_b16 a[176:177], v213 offset:8192
ds_read_b64_tr_b16 a[178:179], v213 offset:8448
ds_read_b64_tr_b16 a[180:181], v213 offset:9216
ds_read_b64_tr_b16 a[182:183], v213 offset:9472
ds_read_b64_tr_b16 a[184:185], v213 offset:10240
ds_read_b64_tr_b16 a[186:187], v213 offset:10496
ds_read_b64_tr_b16 a[188:189], v213 offset:11264
ds_read_b64_tr_b16 a[190:191], v213 offset:11520
s_waitcnt vmcnt(12)
ds_read_b64_tr_b16 a[192:193], v213 offset:12288
ds_read_b64_tr_b16 a[194:195], v213 offset:12544
ds_read_b64_tr_b16 a[196:197], v213 offset:13312
ds_read_b64_tr_b16 a[198:199], v213 offset:13568
ds_read_b64_tr_b16 a[200:201], v213 offset:14336
ds_read_b64_tr_b16 a[202:203], v213 offset:14592
ds_read_b64_tr_b16 a[204:205], v213 offset:15360
ds_read_b64_tr_b16 a[206:207], v213 offset:15616
s_waitcnt vmcnt(8)
ds_read_b64_tr_b16 a[208:209], v213 offset:16384
ds_read_b64_tr_b16 a[210:211], v213 offset:16640
ds_read_b64_tr_b16 a[212:213], v213 offset:17408
ds_read_b64_tr_b16 a[214:215], v213 offset:17664
ds_read_b64_tr_b16 a[216:217], v213 offset:18432
ds_read_b64_tr_b16 a[218:219], v213 offset:18688
ds_read_b64_tr_b16 a[220:221], v213 offset:19456
ds_read_b64_tr_b16 a[222:223], v213 offset:19712
s_waitcnt vmcnt(4)
ds_read_b64_tr_b16 a[224:225], v213 offset:20480
ds_read_b64_tr_b16 a[226:227], v213 offset:20736
ds_read_b64_tr_b16 a[228:229], v213 offset:21504
ds_read_b64_tr_b16 a[230:231], v213 offset:21760
ds_read_b64_tr_b16 a[232:233], v213 offset:22528
ds_read_b64_tr_b16 a[234:235], v213 offset:22784
ds_read_b64_tr_b16 a[236:237], v213 offset:23552
ds_read_b64_tr_b16 a[238:239], v213 offset:23808
s_waitcnt vmcnt(0)
ds_read_b64_tr_b16 a[240:241], v213 offset:24576
ds_read_b64_tr_b16 a[242:243], v213 offset:24832
ds_read_b64_tr_b16 a[244:245], v213 offset:25600
ds_read_b64_tr_b16 a[246:247], v213 offset:25856
ds_read_b64_tr_b16 a[248:249], v213 offset:26624
ds_read_b64_tr_b16 a[250:251], v213 offset:26880
ds_read_b64_tr_b16 a[252:253], v213 offset:27648
ds_read_b64_tr_b16 a[254:255], v213 offset:27904
s_waitcnt lgkmcnt(0)
s_barrier
ww_74:
s_load_dwordx2 s[56:57], s[0:1], 80
s_mov_b32 s58, 2621440
s_mov_b32 s59, 0x20000
s_waitcnt lgkmcnt(0)
s_lshl_b32 s18, s13, 12
v_add_u32 v13, s18, v0
s_lshl_b32 s18, s13, 11
v_add_u32 v14, s18, v0
s_add_u32 s53, s30, 56
s_cmp_eq_u32 s30, 3
s_cselect_b32 s30, s53, s30
ws_75:
s_lshl_b32 s18, s16, 6
s_add_u32 s18, s18, s30
s_lshl_b32 s26, s18, 18
s_lshl_b32 s19, s13, 16
s_add_u32 s26, s26, s19
s_add_u32 s26, s26, 127926272
s_add_u32 s38, s18, 1
s_and_b32 s18, s18, 7
s_lshl_b32 s18, s18, 12
s_add_u32 s18, s18, s37
s_add_u32 s28, s18, 11632640
s_mul_i32 s27, s30, 40960
s_and_b32 s18, s13, 1
s_lshl_b32 s19, s52, 1
s_add_u32 s29, s18, s19
v_lshlrev_b32 v3, 3, v0
v_min_u32 v12, 896, v3
s_mov_b32 s17, 0
poll_79:
buffer_load_dword v8, v12, s[4:7], s28 offen sc1
s_add_u32 s17, s17, 1
s_cmp_gt_u32 s17, 262144
s_cbranch_scc1 L_fail
s_waitcnt vmcnt(0)
v_cmp_gt_u32 vcc, s38, v8
s_cbranch_vccz polld_80
s_sleep 2
s_branch poll_79
polld_80:
s_lshl_b32 s18, s29, 10
s_add_u32 s18, s18, s27
s_mul_i32 s19, s16, 6291456
s_add_u32 s18, s18, s19
s_add_u32 s18, s18, 88080384
s_add_u32 s19, s26, 0
buffer_load_dwordx4 v[16:19], v0, s[4:7], s19 offen offset:0 sc1
buffer_load_dwordx4 v[20:23], v0, s[4:7], s19 offen offset:1024 sc1
buffer_load_dwordx4 v[24:27], v0, s[4:7], s19 offen offset:2048 sc1
buffer_load_dwordx4 v[28:31], v0, s[4:7], s19 offen offset:3072 sc1
s_add_u32 s19, s26, 4096
buffer_load_dwordx4 v[32:35], v0, s[4:7], s19 offen offset:0 sc1
buffer_load_dwordx4 v[36:39], v0, s[4:7], s19 offen offset:1024 sc1
buffer_load_dwordx4 v[40:43], v0, s[4:7], s19 offen offset:2048 sc1
buffer_load_dwordx4 v[44:47], v0, s[4:7], s19 offen offset:3072 sc1
s_add_u32 s19, s26, 8192
buffer_load_dwordx4 v[48:51], v0, s[4:7], s19 offen offset:0 sc1
buffer_load_dwordx4 v[52:55], v0, s[4:7], s19 offen offset:1024 sc1
buffer_load_dwordx4 v[56:59], v0, s[4:7], s19 offen offset:2048 sc1
buffer_load_dwordx4 v[60:63], v0, s[4:7], s19 offen offset:3072 sc1
s_add_u32 s19, s26, 12288
buffer_load_dwordx4 v[64:67], v0, s[4:7], s19 offen offset:0 sc1
buffer_load_dwordx4 v[68:71], v0, s[4:7], s19 offen offset:1024 sc1
buffer_load_dwordx4 v[72:75], v0, s[4:7], s19 offen offset:2048 sc1
buffer_load_dwordx4 v[76:79], v0, s[4:7], s19 offen offset:3072 sc1
s_add_u32 s19, s26, 16384
buffer_load_dwordx4 v[80:83], v0, s[4:7], s19 offen offset:0 sc1
buffer_load_dwordx4 v[84:87], v0, s[4:7], s19 offen offset:1024 sc1
buffer_load_dwordx4 v[88:91], v0, s[4:7], s19 offen offset:2048 sc1
buffer_load_dwordx4 v[92:95], v0, s[4:7], s19 offen offset:3072 sc1
s_add_u32 s19, s26, 20480
buffer_load_dwordx4 v[96:99], v0, s[4:7], s19 offen offset:0 sc1
buffer_load_dwordx4 v[100:103], v0, s[4:7], s19 offen offset:1024 sc1
buffer_load_dwordx4 v[104:107], v0, s[4:7], s19 offen offset:2048 sc1
buffer_load_dwordx4 v[108:111], v0, s[4:7], s19 offen offset:3072 sc1
s_add_u32 s19, s26, 24576
buffer_load_dwordx4 v[112:115], v0, s[4:7], s19 offen offset:0 sc1
buffer_load_dwordx4 v[116:119], v0, s[4:7], s19 offen offset:1024 sc1
buffer_load_dwordx4 v[120:123], v0, s[4:7], s19 offen offset:2048 sc1
buffer_load_dwordx4 v[124:127], v0, s[4:7], s19 offen offset:3072 sc1
s_add_u32 s19, s26, 28672
buffer_load_dwordx4 v[128:131], v0, s[4:7], s19 offen offset:0 sc1
buffer_load_dwordx4 v[132:135], v0, s[4:7], s19 offen offset:1024 sc1
buffer_load_dwordx4 v[136:139], v0, s[4:7], s19 offen offset:2048 sc1
buffer_load_dwordx4 v[140:143], v0, s[4:7], s19 offen offset:3072 sc1
s_add_u32 s19, s26, 32768
buffer_load_dwordx4 v[144:147], v0, s[4:7], s19 offen offset:0 sc1
buffer_load_dwordx4 v[148:151], v0, s[4:7], s19 offen offset:1024 sc1
buffer_load_dwordx4 v[152:155], v0, s[4:7], s19 offen offset:2048 sc1
buffer_load_dwordx4 v[156:159], v0, s[4:7], s19 offen offset:3072 sc1
s_add_u32 s19, s26, 36864
buffer_load_dwordx4 v[160:163], v0, s[4:7], s19 offen offset:0 sc1
buffer_load_dwordx4 v[164:167], v0, s[4:7], s19 offen offset:1024 sc1
buffer_load_dwordx4 v[168:171], v0, s[4:7], s19 offen offset:2048 sc1
buffer_load_dwordx4 v[172:175], v0, s[4:7], s19 offen offset:3072 sc1
s_add_u32 s19, s26, 40960
buffer_load_dwordx4 v[176:179], v0, s[4:7], s19 offen offset:0 sc1
buffer_load_dwordx4 v[180:183], v0, s[4:7], s19 offen offset:1024 sc1
buffer_load_dwordx4 v[184:187], v0, s[4:7], s19 offen offset:2048 sc1
buffer_load_dwordx4 v[188:191], v0, s[4:7], s19 offen offset:3072 sc1
s_waitcnt vmcnt(43)
v_mfma_f32_32x32x16_bf16 v[192:207], a[0:3], v[16:19], 0
s_add_u32 s19, s26, 45056
buffer_load_dwordx4 v[16:19], v0, s[4:7], s19 offen offset:0 sc1
s_waitcnt vmcnt(43)
v_mfma_f32_32x32x16_bf16 v[192:207], a[4:7], v[20:23], v[192:207]
buffer_load_dwordx4 v[20:23], v0, s[4:7], s19 offen offset:1024 sc1
s_waitcnt vmcnt(43)
v_mfma_f32_32x32x16_bf16 v[192:207], a[8:11], v[24:27], v[192:207]
buffer_load_dwordx4 v[24:27], v0, s[4:7], s19 offen offset:2048 sc1
s_waitcnt vmcnt(43)
v_mfma_f32_32x32x16_bf16 v[192:207], a[12:15], v[28:31], v[192:207]
buffer_load_dwordx4 v[28:31], v0, s[4:7], s19 offen offset:3072 sc1
s_waitcnt vmcnt(43)
v_mfma_f32_32x32x16_bf16 v[192:207], a[16:19], v[32:35], v[192:207]
s_add_u32 s19, s26, 49152
buffer_load_dwordx4 v[32:35], v0, s[4:7], s19 offen offset:0 sc1
s_waitcnt vmcnt(43)
v_mfma_f32_32x32x16_bf16 v[192:207], a[20:23], v[36:39], v[192:207]
buffer_load_dwordx4 v[36:39], v0, s[4:7], s19 offen offset:1024 sc1
s_waitcnt vmcnt(43)
v_mfma_f32_32x32x16_bf16 v[192:207], a[24:27], v[40:43], v[192:207]
buffer_load_dwordx4 v[40:43], v0, s[4:7], s19 offen offset:2048 sc1
s_waitcnt vmcnt(43)
v_mfma_f32_32x32x16_bf16 v[192:207], a[28:31], v[44:47], v[192:207]
buffer_load_dwordx4 v[44:47], v0, s[4:7], s19 offen offset:3072 sc1
s_waitcnt vmcnt(43)
v_mfma_f32_32x32x16_bf16 v[192:207], a[32:35], v[48:51], v[192:207]
s_add_u32 s19, s26, 53248
buffer_load_dwordx4 v[48:51], v0, s[4:7], s19 offen offset:0 sc1
s_waitcnt vmcnt(43)
v_mfma_f32_32x32x16_bf16 v[192:207], a[36:39], v[52:55], v[192:207]
buffer_load_dwordx4 v[52:55], v0, s[4:7], s19 offen offset:1024 sc1
s_waitcnt vmcnt(43)
v_mfma_f32_32x32x16_bf16 v[192:207], a[40:43], v[56:59], v[192:207]
buffer_load_dwordx4 v[56:59], v0, s[4:7], s19 offen offset:2048 sc1
s_waitcnt vmcnt(43)
v_mfma_f32_32x32x16_bf16 v[192:207], a[44:47], v[60:63], v[192:207]
buffer_load_dwordx4 v[60:63], v0, s[4:7], s19 offen offset:3072 sc1
s_waitcnt vmcnt(43)
v_mfma_f32_32x32x16_bf16 v[192:207], a[48:51], v[64:67], v[192:207]
s_add_u32 s19, s26, 57344
buffer_load_dwordx4 v[64:67], v0, s[4:7], s19 offen offset:0 sc1
s_waitcnt vmcnt(43)
v_mfma_f32_32x32x16_bf16 v[192:207], a[52:55], v[68:71], v[192:207]
buffer_load_dwordx4 v[68:71], v0, s[4:7], s19 offen offset:1024 sc1
s_waitcnt vmcnt(43)
v_mfma_f32_32x32x16_bf16 v[192:207], a[56:59], v[72:75], v[192:207]
buffer_load_dwordx4 v[72:75], v0, s[4:7], s19 offen offset:2048 sc1
s_waitcnt vmcnt(43)
v_mfma_f32_32x32x16_bf16 v[192:207], a[60:63], v[76:79], v[192:207]
buffer_load_dwordx4 v[76:79], v0, s[4:7], s19 offen offset:3072 sc1
s_waitcnt vmcnt(43)
v_mfma_f32_32x32x16_bf16 v[192:207], a[64:67], v[80:83], v[192:207]
s_add_u32 s19, s26, 61440
buffer_load_dwordx4 v[80:83], v0, s[4:7], s19 offen offset:0 sc1
s_waitcnt vmcnt(43)
v_mfma_f32_32x32x16_bf16 v[192:207], a[68:71], v[84:87], v[192:207]
buffer_load_dwordx4 v[84:87], v0, s[4:7], s19 offen offset:1024 sc1
s_waitcnt vmcnt(43)
v_mfma_f32_32x32x16_bf16 v[192:207], a[72:75], v[88:91], v[192:207]
buffer_load_dwordx4 v[88:91], v0, s[4:7], s19 offen offset:2048 sc1
s_waitcnt vmcnt(43)
v_mfma_f32_32x32x16_bf16 v[192:207], a[76:79], v[92:95], v[192:207]
buffer_load_dwordx4 v[92:95], v0, s[4:7], s19 offen offset:3072 sc1
s_waitcnt vmcnt(43)
v_mfma_f32_32x32x16_bf16 v[192:207], a[80:83], v[96:99], v[192:207]
buffer_load_dwordx4 v[208:211], v0, s[4:7], s18 offen sc1
s_waitcnt vmcnt(43)
v_mfma_f32_32x32x16_bf16 v[192:207], a[84:87], v[100:103], v[192:207]
s_waitcnt vmcnt(42)
v_mfma_f32_32x32x16_bf16 v[192:207], a[88:91], v[104:107], v[192:207]
s_waitcnt vmcnt(41)
v_mfma_f32_32x32x16_bf16 v[192:207], a[92:95], v[108:111], v[192:207]
s_waitcnt vmcnt(40)
v_mfma_f32_32x32x16_bf16 v[192:207], a[96:99], v[112:115], v[192:207]
s_waitcnt vmcnt(39)
v_mfma_f32_32x32x16_bf16 v[192:207], a[100:103], v[116:119], v[192:207]
s_waitcnt vmcnt(38)
v_mfma_f32_32x32x16_bf16 v[192:207], a[104:107], v[120:123], v[192:207]
s_waitcnt vmcnt(37)
v_mfma_f32_32x32x16_bf16 v[192:207], a[108:111], v[124:127], v[192:207]
s_waitcnt vmcnt(36)
v_mfma_f32_32x32x16_bf16 v[192:207], a[112:115], v[128:131], v[192:207]
s_waitcnt vmcnt(35)
v_mfma_f32_32x32x16_bf16 v[192:207], a[116:119], v[132:135], v[192:207]
s_waitcnt vmcnt(34)
v_mfma_f32_32x32x16_bf16 v[192:207], a[120:123], v[136:139], v[192:207]
s_waitcnt vmcnt(33)
v_mfma_f32_32x32x16_bf16 v[192:207], a[124:127], v[140:143], v[192:207]
s_waitcnt vmcnt(32)
v_mfma_f32_32x32x16_bf16 v[192:207], a[128:131], v[144:147], v[192:207]
s_waitcnt vmcnt(31)
v_mfma_f32_32x32x16_bf16 v[192:207], a[132:135], v[148:151], v[192:207]
s_waitcnt vmcnt(30)
v_mfma_f32_32x32x16_bf16 v[192:207], a[136:139], v[152:155], v[192:207]
s_waitcnt vmcnt(29)
v_mfma_f32_32x32x16_bf16 v[192:207], a[140:143], v[156:159], v[192:207]
s_waitcnt vmcnt(28)
v_mfma_f32_32x32x16_bf16 v[192:207], a[144:147], v[160:163], v[192:207]
s_waitcnt vmcnt(27)
v_mfma_f32_32x32x16_bf16 v[192:207], a[148:151], v[164:167], v[192:207]
s_waitcnt vmcnt(26)
v_mfma_f32_32x32x16_bf16 v[192:207], a[152:155], v[168:171], v[192:207]
s_waitcnt vmcnt(25)
v_mfma_f32_32x32x16_bf16 v[192:207], a[156:159], v[172:175], v[192:207]
s_waitcnt vmcnt(24)
v_mfma_f32_32x32x16_bf16 v[192:207], a[160:163], v[176:179], v[192:207]
s_waitcnt vmcnt(23)
v_mfma_f32_32x32x16_bf16 v[192:207], a[164:167], v[180:183], v[192:207]
s_waitcnt vmcnt(22)
v_mfma_f32_32x32x16_bf16 v[192:207], a[168:171], v[184:187], v[192:207]
s_waitcnt vmcnt(21)
v_mfma_f32_32x32x16_bf16 v[192:207], a[172:175], v[188:191], v[192:207]
s_waitcnt vmcnt(20)
v_mfma_f32_32x32x16_bf16 v[192:207], a[176:179], v[16:19], v[192:207]
s_waitcnt vmcnt(19)
v_mfma_f32_32x32x16_bf16 v[192:207], a[180:183], v[20:23], v[192:207]
s_waitcnt vmcnt(18)
v_mfma_f32_32x32x16_bf16 v[192:207], a[184:187], v[24:27], v[192:207]
s_waitcnt vmcnt(17)
v_mfma_f32_32x32x16_bf16 v[192:207], a[188:191], v[28:31], v[192:207]
s_waitcnt vmcnt(16)
v_mfma_f32_32x32x16_bf16 v[192:207], a[192:195], v[32:35], v[192:207]
s_waitcnt vmcnt(15)
v_mfma_f32_32x32x16_bf16 v[192:207], a[196:199], v[36:39], v[192:207]
s_waitcnt vmcnt(14)
v_mfma_f32_32x32x16_bf16 v[192:207], a[200:203], v[40:43], v[192:207]
s_waitcnt vmcnt(13)
v_mfma_f32_32x32x16_bf16 v[192:207], a[204:207], v[44:47], v[192:207]
s_waitcnt vmcnt(12)
v_mfma_f32_32x32x16_bf16 v[192:207], a[208:211], v[48:51], v[192:207]
s_waitcnt vmcnt(11)
v_mfma_f32_32x32x16_bf16 v[192:207], a[212:215], v[52:55], v[192:207]
s_waitcnt vmcnt(10)
v_mfma_f32_32x32x16_bf16 v[192:207], a[216:219], v[56:59], v[192:207]
s_waitcnt vmcnt(9)
v_mfma_f32_32x32x16_bf16 v[192:207], a[220:223], v[60:63], v[192:207]
s_waitcnt vmcnt(8)
v_mfma_f32_32x32x16_bf16 v[192:207], a[224:227], v[64:67], v[192:207]
s_waitcnt vmcnt(7)
v_mfma_f32_32x32x16_bf16 v[192:207], a[228:231], v[68:71], v[192:207]
s_waitcnt vmcnt(6)
v_mfma_f32_32x32x16_bf16 v[192:207], a[232:235], v[72:75], v[192:207]
s_waitcnt vmcnt(5)
v_mfma_f32_32x32x16_bf16 v[192:207], a[236:239], v[76:79], v[192:207]
s_waitcnt vmcnt(4)
v_mfma_f32_32x32x16_bf16 v[192:207], a[240:243], v[80:83], v[192:207]
s_waitcnt vmcnt(3)
v_mfma_f32_32x32x16_bf16 v[192:207], a[244:247], v[84:87], v[192:207]
s_waitcnt vmcnt(2)
v_mfma_f32_32x32x16_bf16 v[192:207], a[248:251], v[88:91], v[192:207]
s_waitcnt vmcnt(1)
v_mfma_f32_32x32x16_bf16 v[192:207], a[252:255], v[92:95], v[192:207]
s_nop 11
ds_write_b128 v13, v[192:195] offset:0
ds_write_b128 v13, v[196:199] offset:1024
ds_write_b128 v13, v[200:203] offset:2048
ds_write_b128 v13, v[204:207] offset:3072
s_waitcnt lgkmcnt(0)
s_barrier
s_cmp_ge_u32 s13, 2
s_cbranch_scc1 wn_76
ds_read_b128 v[16:19], v14 offset:0
ds_read_b128 v[20:23], v14 offset:1024
ds_read_b128 v[24:27], v14 offset:4096
ds_read_b128 v[28:31], v14 offset:5120
ds_read_b128 v[32:35], v14 offset:8192
ds_read_b128 v[36:39], v14 offset:9216
ds_read_b128 v[40:43], v14 offset:12288
ds_read_b128 v[44:47], v14 offset:13312
s_waitcnt vmcnt(0)
v_lshlrev_b32 v192, 16, v208
v_and_b32 v193, 0xffff0000, v208
v_lshlrev_b32 v194, 16, v209
v_and_b32 v195, 0xffff0000, v209
v_lshlrev_b32 v196, 16, v210
v_and_b32 v197, 0xffff0000, v210
v_lshlrev_b32 v198, 16, v211
v_and_b32 v199, 0xffff0000, v211
s_waitcnt lgkmcnt(5)
v_add_f32 v16, v16, v24
s_waitcnt lgkmcnt(1)
v_add_f32 v32, v32, v40
v_add_f32 v17, v17, v25
v_add_f32 v33, v33, v41
v_add_f32 v18, v18, v26
v_add_f32 v34, v34, v42
v_add_f32 v19, v19, v27
v_add_f32 v35, v35, v43
v_add_f32 v20, v20, v28
s_waitcnt lgkmcnt(0)
v_add_f32 v36, v36, v44
v_add_f32 v21, v21, v29
v_add_f32 v37, v37, v45
v_add_f32 v22, v22, v30
v_add_f32 v38, v38, v46
v_add_f32 v23, v23, v31
v_add_f32 v39, v39, v47
v_add_f32 v16, v16, v32
v_add_f32 v17, v17, v33
v_add_f32 v18, v18, v34
v_add_f32 v19, v19, v35
v_add_f32 v20, v20, v36
v_add_f32 v21, v21, v37
v_add_f32 v22, v22, v38
v_add_f32 v23, v23, v39
v_add_f32 v16, v16, v192
v_add_f32 v17, v17, v193
v_add_f32 v18, v18, v194
v_add_f32 v19, v19, v195
v_add_f32 v20, v20, v196
v_add_f32 v21, v21, v197
v_add_f32 v22, v22, v198
v_add_f32 v23, v23, v199
v_cvt_pk_bf16_f32 v208, v16, v17
v_cvt_pk_bf16_f32 v209, v18, v19
v_cvt_pk_bf16_f32 v210, v20, v21
v_cvt_pk_bf16_f32 v211, v22, v23
s_cmp_lg_u32 s16, 0
s_cbranch_scc1 wo_77
s_add_u32 s18, s18, 3145728
buffer_store_dwordx4 v[208:211], v0, s[4:7], s18 offen sc1
s_branch wn_76
wo_77:
s_lshl_b32 s18, s29, 5
s_add_u32 s18, s18, s27
buffer_store_dwordx4 v[208:211], v5, s[56:59], s18 offen
wn_76:
s_lshl_b32 s18, s39, 7
s_add_u32 s18, s18, 11657216
s_cmp_eq_u32 s13, 0
s_cselect_b32 s22, s18, s6
s_mov_b32 s23, s38
s_waitcnt vmcnt(0)
s_barrier
v_mov_b32 v3, s23
s_mov_b64 exec, 1
buffer_store_dword v3, off, s[4:7], s22 sc1
s_mov_b64 exec, -1
s_mov_b32 s22, s6
s_add_u32 s18, s30, 3
s_cmp_lt_u32 s18, 56
s_cselect_b32 s18, s18, s53
s_add_u32 s19, s30, 4
s_cmp_lt_u32 s30, 56
s_cselect_b32 s30, s18, s19
s_cmp_lt_u32 s30, 64
s_cbranch_scc1 ws_75
s_branch aend_64
p1b_63:
s_cmp_eq_u32 s39, 144
s_cbranch_scc1 aend_64
s_cmp_lg_u32 s16, 0
s_cbranch_scc1 aend_64
s_sub_u32 s30, s50, 29
s_sub_u32 s51, s39, 145
s_lshl_b32 s18, s34, 7
s_lshl_b32 s19, s13, 5
s_add_u32 s18, s18, s19
s_mov_b32 s19, 0x3acccccd
v_bfe_u32 v198, v0, 4, 5
v_lshrrev_b32 v193, 9, v0
v_add_u32 v198, s18, v198
v_and_b32 v197, 1, v198
v_mul_u32_u24 v197, 160, v197
v_lshrrev_b32 v196, 1, v198
v_add_u32 v196, 1, v196
v_lshlrev_b32 v193, 3, v193
v_mad_u32_u24 v197, v193, v196, v197
v_mad_u32_u24 v192, v196, 16, 0
v_cvt_f32_u32 v192, v192
v_mul_f32 v198, s19, v192
v_rndne_f32 v198, v198
v_fmac_f32 v192, 0xc4200000, v198
v_mul_f32 v192, s19, v192
v_cos_f32 v192, v192
s_nop 0
v_add_f32 v192, v192, v192
v_mad_u32_u24 v194, v196, 1, 0
v_cvt_f32_u32 v194, v194
v_mul_f32 v198, s19, v194
v_rndne_f32 v198, v198
v_fmac_f32 v194, 0xc4200000, v198
v_mul_f32 v194, s19, v194
v_cos_f32 v194, v194
s_nop 0
v_add_f32 v194, v194, v194
v_mad_u32_u24 v179, v196, 3, v197
v_cvt_f32_u32 v179, v179
v_mul_f32 v198, s19, v179
v_rndne_f32 v198, v198
v_fmac_f32 v179, 0xc4200000, v198
v_mul_f32 v179, s19, v179
v_cos_f32 v179, v179
v_mad_u32_u24 v180, v196, 4, v197
v_cvt_f32_u32 v180, v180
v_mul_f32 v198, s19, v180
v_rndne_f32 v198, v198
v_fmac_f32 v180, 0xc4200000, v198
v_mul_f32 v180, s19, v180
v_cos_f32 v180, v180
s_nop 0
v_fma_f32 v181, v194, v180, -v179
v_fma_f32 v178, v194, v179, -v180
v_fma_f32 v182, v194, v181, -v180
v_fma_f32 v177, v194, v178, -v179
v_fma_f32 v183, v194, v182, -v181
v_fma_f32 v176, v194, v177, -v178
v_cvt_pk_bf16_f32 v16, v176, v177
v_cvt_pk_bf16_f32 v17, v178, v179
v_cvt_pk_bf16_f32 v18, v180, v181
v_cvt_pk_bf16_f32 v19, v182, v183
v_mad_u32_u24 v187, v196, 19, v197
v_cvt_f32_u32 v187, v187
v_mul_f32 v198, s19, v187
v_rndne_f32 v198, v198
v_fmac_f32 v187, 0xc4200000, v198
v_mul_f32 v187, s19, v187
v_cos_f32 v187, v187
v_mad_u32_u24 v188, v196, 20, v197
v_cvt_f32_u32 v188, v188
v_mul_f32 v198, s19, v188
v_rndne_f32 v198, v198
v_fmac_f32 v188, 0xc4200000, v198
v_mul_f32 v188, s19, v188
v_cos_f32 v188, v188
s_nop 0
v_fma_f32 v189, v194, v188, -v187
v_fma_f32 v186, v194, v187, -v188
v_fma_f32 v190, v194, v189, -v188
v_fma_f32 v185, v194, v186, -v187
v_fma_f32 v191, v194, v190, -v189
v_fma_f32 v184, v194, v185, -v186
v_cvt_pk_bf16_f32 v20, v184, v185
v_cvt_pk_bf16_f32 v21, v186, v187
v_cvt_pk_bf16_f32 v22, v188, v189
v_cvt_pk_bf16_f32 v23, v190, v191
v_pk_fma_f32 v[176:177], v[192:193], v[184:185], v[176:177] op_sel_hi:[0,1,1] neg_lo:[0,0,1] neg_hi:[0,0,1]
v_pk_fma_f32 v[178:179], v[192:193], v[186:187], v[178:179] op_sel_hi:[0,1,1] neg_lo:[0,0,1] neg_hi:[0,0,1]
v_pk_fma_f32 v[180:181], v[192:193], v[188:189], v[180:181] op_sel_hi:[0,1,1] neg_lo:[0,0,1] neg_hi:[0,0,1]
v_pk_fma_f32 v[182:183], v[192:193], v[190:191], v[182:183] op_sel_hi:[0,1,1] neg_lo:[0,0,1] neg_hi:[0,0,1]
v_cvt_pk_bf16_f32 v24, v176, v177
v_cvt_pk_bf16_f32 v25, v178, v179
v_cvt_pk_bf16_f32 v26, v180, v181
v_cvt_pk_bf16_f32 v27, v182, v183
v_pk_fma_f32 v[184:185], v[192:193], v[176:177], v[184:185] op_sel_hi:[0,1,1] neg_lo:[0,0,1] neg_hi:[0,0,1]
v_pk_fma_f32 v[186:187], v[192:193], v[178:179], v[186:187] op_sel_hi:[0,1,1] neg_lo:[0,0,1] neg_hi:[0,0,1]
v_pk_fma_f32 v[188:189], v[192:193], v[180:181], v[188:189] op_sel_hi:[0,1,1] neg_lo:[0,0,1] neg_hi:[0,0,1]
v_pk_fma_f32 v[190:191], v[192:193], v[182:183], v[190:191] op_sel_hi:[0,1,1] neg_lo:[0,0,1] neg_hi:[0,0,1]
v_cvt_pk_bf16_f32 v28, v184, v185
v_cvt_pk_bf16_f32 v29, v186, v187
v_cvt_pk_bf16_f32 v30, v188, v189
v_cvt_pk_bf16_f32 v31, v190, v191
v_pk_fma_f32 v[176:177], v[192:193], v[184:185], v[176:177] op_sel_hi:[0,1,1] neg_lo:[0,0,1] neg_hi:[0,0,1]
v_pk_fma_f32 v[178:179], v[192:193], v[186:187], v[178:179] op_sel_hi:[0,1,1] neg_lo:[0,0,1] neg_hi:[0,0,1]
v_pk_fma_f32 v[180:181], v[192:193], v[188:189], v[180:181] op_sel_hi:[0,1,1] neg_lo:[0,0,1] neg_hi:[0,0,1]
v_pk_fma_f32 v[182:183], v[192:193], v[190:191], v[182:183] op_sel_hi:[0,1,1] neg_lo:[0,0,1] neg_hi:[0,0,1]
v_cvt_pk_bf16_f32 v32, v176, v177
v_cvt_pk_bf16_f32 v33, v178, v179
v_cvt_pk_bf16_f32 v34, v180, v181
v_cvt_pk_bf16_f32 v35, v182, v183
v_pk_fma_f32 v[184:185], v[192:193], v[176:177], v[184:185] op_sel_hi:[0,1,1] neg_lo:[0,0,1] neg_hi:[0,0,1]
v_pk_fma_f32 v[186:187], v[192:193], v[178:179], v[186:187] op_sel_hi:[0,1,1] neg_lo:[0,0,1] neg_hi:[0,0,1]
v_pk_fma_f32 v[188:189], v[192:193], v[180:181], v[188:189] op_sel_hi:[0,1,1] neg_lo:[0,0,1] neg_hi:[0,0,1]
v_pk_fma_f32 v[190:191], v[192:193], v[182:183], v[190:191] op_sel_hi:[0,1,1] neg_lo:[0,0,1] neg_hi:[0,0,1]
v_cvt_pk_bf16_f32 v36, v184, v185
v_cvt_pk_bf16_f32 v37, v186, v187
v_cvt_pk_bf16_f32 v38, v188, v189
v_cvt_pk_bf16_f32 v39, v190, v191
v_pk_fma_f32 v[176:177], v[192:193], v[184:185], v[176:177] op_sel_hi:[0,1,1] neg_lo:[0,0,1] neg_hi:[0,0,1]
v_pk_fma_f32 v[178:179], v[192:193], v[186:187], v[178:179] op_sel_hi:[0,1,1] neg_lo:[0,0,1] neg_hi:[0,0,1]
v_pk_fma_f32 v[180:181], v[192:193], v[188:189], v[180:181] op_sel_hi:[0,1,1] neg_lo:[0,0,1] neg_hi:[0,0,1]
v_pk_fma_f32 v[182:183], v[192:193], v[190:191], v[182:183] op_sel_hi:[0,1,1] neg_lo:[0,0,1] neg_hi:[0,0,1]
v_cvt_pk_bf16_f32 v40, v176, v177
v_cvt_pk_bf16_f32 v41, v178, v179
v_cvt_pk_bf16_f32 v42, v180, v181
v_cvt_pk_bf16_f32 v43, v182, v183
v_pk_fma_f32 v[184:185], v[192:193], v[176:177], v[184:185] op_sel_hi:[0,1,1] neg_lo:[0,0,1] neg_hi:[0,0,1]
v_pk_fma_f32 v[186:187], v[192:193], v[178:179], v[186:187] op_sel_hi:[0,1,1] neg_lo:[0,0,1] neg_hi:[0,0,1]
v_pk_fma_f32 v[188:189], v[192:193], v[180:181], v[188:189] op_sel_hi:[0,1,1] neg_lo:[0,0,1] neg_hi:[0,0,1]
v_pk_fma_f32 v[190:191], v[192:193], v[182:183], v[190:191] op_sel_hi:[0,1,1] neg_lo:[0,0,1] neg_hi:[0,0,1]
v_cvt_pk_bf16_f32 v44, v184, v185
v_cvt_pk_bf16_f32 v45, v186, v187
v_cvt_pk_bf16_f32 v46, v188, v189
v_cvt_pk_bf16_f32 v47, v190, v191
v_pk_fma_f32 v[176:177], v[192:193], v[184:185], v[176:177] op_sel_hi:[0,1,1] neg_lo:[0,0,1] neg_hi:[0,0,1]
v_pk_fma_f32 v[178:179], v[192:193], v[186:187], v[178:179] op_sel_hi:[0,1,1] neg_lo:[0,0,1] neg_hi:[0,0,1]
v_pk_fma_f32 v[180:181], v[192:193], v[188:189], v[180:181] op_sel_hi:[0,1,1] neg_lo:[0,0,1] neg_hi:[0,0,1]
v_pk_fma_f32 v[182:183], v[192:193], v[190:191], v[182:183] op_sel_hi:[0,1,1] neg_lo:[0,0,1] neg_hi:[0,0,1]
v_cvt_pk_bf16_f32 v48, v176, v177
v_cvt_pk_bf16_f32 v49, v178, v179
v_cvt_pk_bf16_f32 v50, v180, v181
v_cvt_pk_bf16_f32 v51, v182, v183
v_pk_fma_f32 v[184:185], v[192:193], v[176:177], v[184:185] op_sel_hi:[0,1,1] neg_lo:[0,0,1] neg_hi:[0,0,1]
v_pk_fma_f32 v[186:187], v[192:193], v[178:179], v[186:187] op_sel_hi:[0,1,1] neg_lo:[0,0,1] neg_hi:[0,0,1]
v_pk_fma_f32 v[188:189], v[192:193], v[180:181], v[188:189] op_sel_hi:[0,1,1] neg_lo:[0,0,1] neg_hi:[0,0,1]
v_pk_fma_f32 v[190:191], v[192:193], v[182:183], v[190:191] op_sel_hi:[0,1,1] neg_lo:[0,0,1] neg_hi:[0,0,1]
v_cvt_pk_bf16_f32 v52, v184, v185
v_cvt_pk_bf16_f32 v53, v186, v187
v_cvt_pk_bf16_f32 v54, v188, v189
v_cvt_pk_bf16_f32 v55, v190, v191
v_pk_fma_f32 v[176:177], v[192:193], v[184:185], v[176:177] op_sel_hi:[0,1,1] neg_lo:[0,0,1] neg_hi:[0,0,1]
v_pk_fma_f32 v[178:179], v[192:193], v[186:187], v[178:179] op_sel_hi:[0,1,1] neg_lo:[0,0,1] neg_hi:[0,0,1]
v_pk_fma_f32 v[180:181], v[192:193], v[188:189], v[180:181] op_sel_hi:[0,1,1] neg_lo:[0,0,1] neg_hi:[0,0,1]
v_pk_fma_f32 v[182:183], v[192:193], v[190:191], v[182:183] op_sel_hi:[0,1,1] neg_lo:[0,0,1] neg_hi:[0,0,1]
v_cvt_pk_bf16_f32 v56, v176, v177
v_cvt_pk_bf16_f32 v57, v178, v179
v_cvt_pk_bf16_f32 v58, v180, v181
v_cvt_pk_bf16_f32 v59, v182, v183
v_pk_fma_f32 v[184:185], v[192:193], v[176:177], v[184:185] op_sel_hi:[0,1,1] neg_lo:[0,0,1] neg_hi:[0,0,1]
v_pk_fma_f32 v[186:187], v[192:193], v[178:179], v[186:187] op_sel_hi:[0,1,1] neg_lo:[0,0,1] neg_hi:[0,0,1]
v_pk_fma_f32 v[188:189], v[192:193], v[180:181], v[188:189] op_sel_hi:[0,1,1] neg_lo:[0,0,1] neg_hi:[0,0,1]
v_pk_fma_f32 v[190:191], v[192:193], v[182:183], v[190:191] op_sel_hi:[0,1,1] neg_lo:[0,0,1] neg_hi:[0,0,1]
v_cvt_pk_bf16_f32 v60, v184, v185
v_cvt_pk_bf16_f32 v61, v186, v187
v_cvt_pk_bf16_f32 v62, v188, v189
v_cvt_pk_bf16_f32 v63, v190, v191
v_pk_fma_f32 v[176:177], v[192:193], v[184:185], v[176:177] op_sel_hi:[0,1,1] neg_lo:[0,0,1] neg_hi:[0,0,1]
v_pk_fma_f32 v[178:179], v[192:193], v[186:187], v[178:179] op_sel_hi:[0,1,1] neg_lo:[0,0,1] neg_hi:[0,0,1]
v_pk_fma_f32 v[180:181], v[192:193], v[188:189], v[180:181] op_sel_hi:[0,1,1] neg_lo:[0,0,1] neg_hi:[0,0,1]
v_pk_fma_f32 v[182:183], v[192:193], v[190:191], v[182:183] op_sel_hi:[0,1,1] neg_lo:[0,0,1] neg_hi:[0,0,1]
v_cvt_pk_bf16_f32 v64, v176, v177
v_cvt_pk_bf16_f32 v65, v178, v179
v_cvt_pk_bf16_f32 v66, v180, v181
v_cvt_pk_bf16_f32 v67, v182, v183
v_pk_fma_f32 v[184:185], v[192:193], v[176:177], v[184:185] op_sel_hi:[0,1,1] neg_lo:[0,0,1] neg_hi:[0,0,1]
v_pk_fma_f32 v[186:187], v[192:193], v[178:179], v[186:187] op_sel_hi:[0,1,1] neg_lo:[0,0,1] neg_hi:[0,0,1]
v_pk_fma_f32 v[188:189], v[192:193], v[180:181], v[188:189] op_sel_hi:[0,1,1] neg_lo:[0,0,1] neg_hi:[0,0,1]
v_pk_fma_f32 v[190:191], v[192:193], v[182:183], v[190:191] op_sel_hi:[0,1,1] neg_lo:[0,0,1] neg_hi:[0,0,1]
v_cvt_pk_bf16_f32 v68, v184, v185
v_cvt_pk_bf16_f32 v69, v186, v187
v_cvt_pk_bf16_f32 v70, v188, v189
v_cvt_pk_bf16_f32 v71, v190, v191
v_pk_fma_f32 v[176:177], v[192:193], v[184:185], v[176:177] op_sel_hi:[0,1,1] neg_lo:[0,0,1] neg_hi:[0,0,1]
v_pk_fma_f32 v[178:179], v[192:193], v[186:187], v[178:179] op_sel_hi:[0,1,1] neg_lo:[0,0,1] neg_hi:[0,0,1]
v_pk_fma_f32 v[180:181], v[192:193], v[188:189], v[180:181] op_sel_hi:[0,1,1] neg_lo:[0,0,1] neg_hi:[0,0,1]
v_pk_fma_f32 v[182:183], v[192:193], v[190:191], v[182:183] op_sel_hi:[0,1,1] neg_lo:[0,0,1] neg_hi:[0,0,1]
v_cvt_pk_bf16_f32 v72, v176, v177
v_cvt_pk_bf16_f32 v73, v178, v179
v_cvt_pk_bf16_f32 v74, v180, v181
v_cvt_pk_bf16_f32 v75, v182, v183
v_pk_fma_f32 v[184:185], v[192:193], v[176:177], v[184:185] op_sel_hi:[0,1,1] neg_lo:[0,0,1] neg_hi:[0,0,1]
v_pk_fma_f32 v[186:187], v[192:193], v[178:179], v[186:187] op_sel_hi:[0,1,1] neg_lo:[0,0,1] neg_hi:[0,0,1]
v_pk_fma_f32 v[188:189], v[192:193], v[180:181], v[188:189] op_sel_hi:[0,1,1] neg_lo:[0,0,1] neg_hi:[0,0,1]
v_pk_fma_f32 v[190:191], v[192:193], v[182:183], v[190:191] op_sel_hi:[0,1,1] neg_lo:[0,0,1] neg_hi:[0,0,1]
v_cvt_pk_bf16_f32 v76, v184, v185
v_cvt_pk_bf16_f32 v77, v186, v187
v_cvt_pk_bf16_f32 v78, v188, v189
v_cvt_pk_bf16_f32 v79, v190, v191
v_pk_fma_f32 v[176:177], v[192:193], v[184:185], v[176:177] op_sel_hi:[0,1,1] neg_lo:[0,0,1] neg_hi:[0,0,1]
v_pk_fma_f32 v[178:179], v[192:193], v[186:187], v[178:179] op_sel_hi:[0,1,1] neg_lo:[0,0,1] neg_hi:[0,0,1]
v_pk_fma_f32 v[180:181], v[192:193], v[188:189], v[180:181] op_sel_hi:[0,1,1] neg_lo:[0,0,1] neg_hi:[0,0,1]
v_pk_fma_f32 v[182:183], v[192:193], v[190:191], v[182:183] op_sel_hi:[0,1,1] neg_lo:[0,0,1] neg_hi:[0,0,1]
v_cvt_pk_bf16_f32 v80, v176, v177
v_cvt_pk_bf16_f32 v81, v178, v179
v_cvt_pk_bf16_f32 v82, v180, v181
v_cvt_pk_bf16_f32 v83, v182, v183
v_pk_fma_f32 v[184:185], v[192:193], v[176:177], v[184:185] op_sel_hi:[0,1,1] neg_lo:[0,0,1] neg_hi:[0,0,1]
v_pk_fma_f32 v[186:187], v[192:193], v[178:179], v[186:187] op_sel_hi:[0,1,1] neg_lo:[0,0,1] neg_hi:[0,0,1]
v_pk_fma_f32 v[188:189], v[192:193], v[180:181], v[188:189] op_sel_hi:[0,1,1] neg_lo:[0,0,1] neg_hi:[0,0,1]
v_pk_fma_f32 v[190:191], v[192:193], v[182:183], v[190:191] op_sel_hi:[0,1,1] neg_lo:[0,0,1] neg_hi:[0,0,1]
v_cvt_pk_bf16_f32 v84, v184, v185
v_cvt_pk_bf16_f32 v85, v186, v187
v_cvt_pk_bf16_f32 v86, v188, v189
v_cvt_pk_bf16_f32 v87, v190, v191
v_pk_fma_f32 v[176:177], v[192:193], v[184:185], v[176:177] op_sel_hi:[0,1,1] neg_lo:[0,0,1] neg_hi:[0,0,1]
v_pk_fma_f32 v[178:179], v[192:193], v[186:187], v[178:179] op_sel_hi:[0,1,1] neg_lo:[0,0,1] neg_hi:[0,0,1]
v_pk_fma_f32 v[180:181], v[192:193], v[188:189], v[180:181] op_sel_hi:[0,1,1] neg_lo:[0,0,1] neg_hi:[0,0,1]
v_pk_fma_f32 v[182:183], v[192:193], v[190:191], v[182:183] op_sel_hi:[0,1,1] neg_lo:[0,0,1] neg_hi:[0,0,1]
v_cvt_pk_bf16_f32 v88, v176, v177
v_cvt_pk_bf16_f32 v89, v178, v179
v_cvt_pk_bf16_f32 v90, v180, v181
v_cvt_pk_bf16_f32 v91, v182, v183
v_pk_fma_f32 v[184:185], v[192:193], v[176:177], v[184:185] op_sel_hi:[0,1,1] neg_lo:[0,0,1] neg_hi:[0,0,1]
v_pk_fma_f32 v[186:187], v[192:193], v[178:179], v[186:187] op_sel_hi:[0,1,1] neg_lo:[0,0,1] neg_hi:[0,0,1]
v_pk_fma_f32 v[188:189], v[192:193], v[180:181], v[188:189] op_sel_hi:[0,1,1] neg_lo:[0,0,1] neg_hi:[0,0,1]
v_pk_fma_f32 v[190:191], v[192:193], v[182:183], v[190:191] op_sel_hi:[0,1,1] neg_lo:[0,0,1] neg_hi:[0,0,1]
v_cvt_pk_bf16_f32 v92, v184, v185
v_cvt_pk_bf16_f32 v93, v186, v187
v_cvt_pk_bf16_f32 v94, v188, v189
v_cvt_pk_bf16_f32 v95, v190, v191
s_mov_b32 s20, 323
v_mad_u32_u24 v179, v196, s20, v197
v_cvt_f32_u32 v179, v179
v_mul_f32 v198, s19, v179
v_rndne_f32 v198, v198
v_fmac_f32 v179, 0xc4200000, v198
v_mul_f32 v179, s19, v179
v_cos_f32 v179, v179
s_mov_b32 s20, 324
v_mad_u32_u24 v180, v196, s20, v197
v_cvt_f32_u32 v180, v180
v_mul_f32 v198, s19, v180
v_rndne_f32 v198, v198
v_fmac_f32 v180, 0xc4200000, v198
v_mul_f32 v180, s19, v180
v_cos_f32 v180, v180
s_nop 0
v_fma_f32 v181, v194, v180, -v179
v_fma_f32 v178, v194, v179, -v180
v_fma_f32 v182, v194, v181, -v180
v_fma_f32 v177, v194, v178, -v179
v_fma_f32 v183, v194, v182, -v181
v_fma_f32 v176, v194, v177, -v178
v_cvt_pk_bf16_f32 v96, v176, v177
v_cvt_pk_bf16_f32 v97, v178, v179
v_cvt_pk_bf16_f32 v98, v180, v181
v_cvt_pk_bf16_f32 v99, v182, v183
s_mov_b32 s20, 339
v_mad_u32_u24 v187, v196, s20, v197
v_cvt_f32_u32 v187, v187
v_mul_f32 v198, s19, v187
v_rndne_f32 v198, v198
v_fmac_f32 v187, 0xc4200000, v198
v_mul_f32 v187, s19, v187
v_cos_f32 v187, v187
s_mov_b32 s20, 340
v_mad_u32_u24 v188, v196, s20, v197
v_cvt_f32_u32 v188, v188
v_mul_f32 v198, s19, v188
v_rndne_f32 v198, v198
v_fmac_f32 v188, 0xc4200000, v198
v_mul_f32 v188, s19, v188
v_cos_f32 v188, v188
s_nop 0
v_fma_f32 v189, v194, v188, -v187
v_fma_f32 v186, v194, v187, -v188
v_fma_f32 v190, v194, v189, -v188
v_fma_f32 v185, v194, v186, -v187
v_fma_f32 v191, v194, v190, -v189
v_fma_f32 v184, v194, v185, -v186
v_cvt_pk_bf16_f32 v100, v184, v185
v_cvt_pk_bf16_f32 v101, v186, v187
v_cvt_pk_bf16_f32 v102, v188, v189
v_cvt_pk_bf16_f32 v103, v190, v191
v_pk_fma_f32 v[176:177], v[192:193], v[184:185], v[176:177] op_sel_hi:[0,1,1] neg_lo:[0,0,1] neg_hi:[0,0,1]
v_pk_fma_f32 v[178:179], v[192:193], v[186:187], v[178:179] op_sel_hi:[0,1,1] neg_lo:[0,0,1] neg_hi:[0,0,1]
v_pk_fma_f32 v[180:181], v[192:193], v[188:189], v[180:181] op_sel_hi:[0,1,1] neg_lo:[0,0,1] neg_hi:[0,0,1]
v_pk_fma_f32 v[182:183], v[192:193], v[190:191], v[182:183] op_sel_hi:[0,1,1] neg_lo:[0,0,1] neg_hi:[0,0,1]
v_cvt_pk_bf16_f32 v104, v176, v177
v_cvt_pk_bf16_f32 v105, v178, v179
v_cvt_pk_bf16_f32 v106, v180, v181
v_cvt_pk_bf16_f32 v107, v182, v183
v_pk_fma_f32 v[184:185], v[192:193], v[176:177], v[184:185] op_sel_hi:[0,1,1] neg_lo:[0,0,1] neg_hi:[0,0,1]
v_pk_fma_f32 v[186:187], v[192:193], v[178:179], v[186:187] op_sel_hi:[0,1,1] neg_lo:[0,0,1] neg_hi:[0,0,1]
v_pk_fma_f32 v[188:189], v[192:193], v[180:181], v[188:189] op_sel_hi:[0,1,1] neg_lo:[0,0,1] neg_hi:[0,0,1]
v_pk_fma_f32 v[190:191], v[192:193], v[182:183], v[190:191] op_sel_hi:[0,1,1] neg_lo:[0,0,1] neg_hi:[0,0,1]
v_cvt_pk_bf16_f32 v108, v184, v185
v_cvt_pk_bf16_f32 v109, v186, v187
v_cvt_pk_bf16_f32 v110, v188, v189
v_cvt_pk_bf16_f32 v111, v190, v191
v_pk_fma_f32 v[176:177], v[192:193], v[184:185], v[176:177] op_sel_hi:[0,1,1] neg_lo:[0,0,1] neg_hi:[0,0,1]
v_pk_fma_f32 v[178:179], v[192:193], v[186:187], v[178:179] op_sel_hi:[0,1,1] neg_lo:[0,0,1] neg_hi:[0,0,1]
v_pk_fma_f32 v[180:181], v[192:193], v[188:189], v[180:181] op_sel_hi:[0,1,1] neg_lo:[0,0,1] neg_hi:[0,0,1]
v_pk_fma_f32 v[182:183], v[192:193], v[190:191], v[182:183] op_sel_hi:[0,1,1] neg_lo:[0,0,1] neg_hi:[0,0,1]
v_cvt_pk_bf16_f32 v112, v176, v177
v_cvt_pk_bf16_f32 v113, v178, v179
v_cvt_pk_bf16_f32 v114, v180, v181
v_cvt_pk_bf16_f32 v115, v182, v183
v_pk_fma_f32 v[184:185], v[192:193], v[176:177], v[184:185] op_sel_hi:[0,1,1] neg_lo:[0,0,1] neg_hi:[0,0,1]
v_pk_fma_f32 v[186:187], v[192:193], v[178:179], v[186:187] op_sel_hi:[0,1,1] neg_lo:[0,0,1] neg_hi:[0,0,1]
v_pk_fma_f32 v[188:189], v[192:193], v[180:181], v[188:189] op_sel_hi:[0,1,1] neg_lo:[0,0,1] neg_hi:[0,0,1]
v_pk_fma_f32 v[190:191], v[192:193], v[182:183], v[190:191] op_sel_hi:[0,1,1] neg_lo:[0,0,1] neg_hi:[0,0,1]
v_cvt_pk_bf16_f32 v116, v184, v185
v_cvt_pk_bf16_f32 v117, v186, v187
v_cvt_pk_bf16_f32 v118, v188, v189
v_cvt_pk_bf16_f32 v119, v190, v191
v_pk_fma_f32 v[176:177], v[192:193], v[184:185], v[176:177] op_sel_hi:[0,1,1] neg_lo:[0,0,1] neg_hi:[0,0,1]
v_pk_fma_f32 v[178:179], v[192:193], v[186:187], v[178:179] op_sel_hi:[0,1,1] neg_lo:[0,0,1] neg_hi:[0,0,1]
v_pk_fma_f32 v[180:181], v[192:193], v[188:189], v[180:181] op_sel_hi:[0,1,1] neg_lo:[0,0,1] neg_hi:[0,0,1]
v_pk_fma_f32 v[182:183], v[192:193], v[190:191], v[182:183] op_sel_hi:[0,1,1] neg_lo:[0,0,1] neg_hi:[0,0,1]
v_cvt_pk_bf16_f32 v120, v176, v177
v_cvt_pk_bf16_f32 v121, v178, v179
v_cvt_pk_bf16_f32 v122, v180, v181
v_cvt_pk_bf16_f32 v123, v182, v183
v_pk_fma_f32 v[184:185], v[192:193], v[176:177], v[184:185] op_sel_hi:[0,1,1] neg_lo:[0,0,1] neg_hi:[0,0,1]
v_pk_fma_f32 v[186:187], v[192:193], v[178:179], v[186:187] op_sel_hi:[0,1,1] neg_lo:[0,0,1] neg_hi:[0,0,1]
v_pk_fma_f32 v[188:189], v[192:193], v[180:181], v[188:189] op_sel_hi:[0,1,1] neg_lo:[0,0,1] neg_hi:[0,0,1]
v_pk_fma_f32 v[190:191], v[192:193], v[182:183], v[190:191] op_sel_hi:[0,1,1] neg_lo:[0,0,1] neg_hi:[0,0,1]
v_cvt_pk_bf16_f32 v124, v184, v185
v_cvt_pk_bf16_f32 v125, v186, v187
v_cvt_pk_bf16_f32 v126, v188, v189
v_cvt_pk_bf16_f32 v127, v190, v191
v_pk_fma_f32 v[176:177], v[192:193], v[184:185], v[176:177] op_sel_hi:[0,1,1] neg_lo:[0,0,1] neg_hi:[0,0,1]
v_pk_fma_f32 v[178:179], v[192:193], v[186:187], v[178:179] op_sel_hi:[0,1,1] neg_lo:[0,0,1] neg_hi:[0,0,1]
v_pk_fma_f32 v[180:181], v[192:193], v[188:189], v[180:181] op_sel_hi:[0,1,1] neg_lo:[0,0,1] neg_hi:[0,0,1]
v_pk_fma_f32 v[182:183], v[192:193], v[190:191], v[182:183] op_sel_hi:[0,1,1] neg_lo:[0,0,1] neg_hi:[0,0,1]
v_cvt_pk_bf16_f32 v128, v176, v177
v_cvt_pk_bf16_f32 v129, v178, v179
v_cvt_pk_bf16_f32 v130, v180, v181
v_cvt_pk_bf16_f32 v131, v182, v183
v_pk_fma_f32 v[184:185], v[192:193], v[176:177], v[184:185] op_sel_hi:[0,1,1] neg_lo:[0,0,1] neg_hi:[0,0,1]
v_pk_fma_f32 v[186:187], v[192:193], v[178:179], v[186:187] op_sel_hi:[0,1,1] neg_lo:[0,0,1] neg_hi:[0,0,1]
v_pk_fma_f32 v[188:189], v[192:193], v[180:181], v[188:189] op_sel_hi:[0,1,1] neg_lo:[0,0,1] neg_hi:[0,0,1]
v_pk_fma_f32 v[190:191], v[192:193], v[182:183], v[190:191] op_sel_hi:[0,1,1] neg_lo:[0,0,1] neg_hi:[0,0,1]
v_cvt_pk_bf16_f32 v132, v184, v185
v_cvt_pk_bf16_f32 v133, v186, v187
v_cvt_pk_bf16_f32 v134, v188, v189
v_cvt_pk_bf16_f32 v135, v190, v191
v_pk_fma_f32 v[176:177], v[192:193], v[184:185], v[176:177] op_sel_hi:[0,1,1] neg_lo:[0,0,1] neg_hi:[0,0,1]
v_pk_fma_f32 v[178:179], v[192:193], v[186:187], v[178:179] op_sel_hi:[0,1,1] neg_lo:[0,0,1] neg_hi:[0,0,1]
v_pk_fma_f32 v[180:181], v[192:193], v[188:189], v[180:181] op_sel_hi:[0,1,1] neg_lo:[0,0,1] neg_hi:[0,0,1]
v_pk_fma_f32 v[182:183], v[192:193], v[190:191], v[182:183] op_sel_hi:[0,1,1] neg_lo:[0,0,1] neg_hi:[0,0,1]
v_cvt_pk_bf16_f32 v136, v176, v177
v_cvt_pk_bf16_f32 v137, v178, v179
v_cvt_pk_bf16_f32 v138, v180, v181
v_cvt_pk_bf16_f32 v139, v182, v183
v_pk_fma_f32 v[184:185], v[192:193], v[176:177], v[184:185] op_sel_hi:[0,1,1] neg_lo:[0,0,1] neg_hi:[0,0,1]
v_pk_fma_f32 v[186:187], v[192:193], v[178:179], v[186:187] op_sel_hi:[0,1,1] neg_lo:[0,0,1] neg_hi:[0,0,1]
v_pk_fma_f32 v[188:189], v[192:193], v[180:181], v[188:189] op_sel_hi:[0,1,1] neg_lo:[0,0,1] neg_hi:[0,0,1]
v_pk_fma_f32 v[190:191], v[192:193], v[182:183], v[190:191] op_sel_hi:[0,1,1] neg_lo:[0,0,1] neg_hi:[0,0,1]
v_cvt_pk_bf16_f32 v140, v184, v185
v_cvt_pk_bf16_f32 v141, v186, v187
v_cvt_pk_bf16_f32 v142, v188, v189
v_cvt_pk_bf16_f32 v143, v190, v191
v_pk_fma_f32 v[176:177], v[192:193], v[184:185], v[176:177] op_sel_hi:[0,1,1] neg_lo:[0,0,1] neg_hi:[0,0,1]
v_pk_fma_f32 v[178:179], v[192:193], v[186:187], v[178:179] op_sel_hi:[0,1,1] neg_lo:[0,0,1] neg_hi:[0,0,1]
v_pk_fma_f32 v[180:181], v[192:193], v[188:189], v[180:181] op_sel_hi:[0,1,1] neg_lo:[0,0,1] neg_hi:[0,0,1]
v_pk_fma_f32 v[182:183], v[192:193], v[190:191], v[182:183] op_sel_hi:[0,1,1] neg_lo:[0,0,1] neg_hi:[0,0,1]
v_cvt_pk_bf16_f32 v144, v176, v177
v_cvt_pk_bf16_f32 v145, v178, v179
v_cvt_pk_bf16_f32 v146, v180, v181
v_cvt_pk_bf16_f32 v147, v182, v183
v_pk_fma_f32 v[184:185], v[192:193], v[176:177], v[184:185] op_sel_hi:[0,1,1] neg_lo:[0,0,1] neg_hi:[0,0,1]
v_pk_fma_f32 v[186:187], v[192:193], v[178:179], v[186:187] op_sel_hi:[0,1,1] neg_lo:[0,0,1] neg_hi:[0,0,1]
v_pk_fma_f32 v[188:189], v[192:193], v[180:181], v[188:189] op_sel_hi:[0,1,1] neg_lo:[0,0,1] neg_hi:[0,0,1]
v_pk_fma_f32 v[190:191], v[192:193], v[182:183], v[190:191] op_sel_hi:[0,1,1] neg_lo:[0,0,1] neg_hi:[0,0,1]
v_cvt_pk_bf16_f32 v148, v184, v185
v_cvt_pk_bf16_f32 v149, v186, v187
v_cvt_pk_bf16_f32 v150, v188, v189
v_cvt_pk_bf16_f32 v151, v190, v191
v_pk_fma_f32 v[176:177], v[192:193], v[184:185], v[176:177] op_sel_hi:[0,1,1] neg_lo:[0,0,1] neg_hi:[0,0,1]
v_pk_fma_f32 v[178:179], v[192:193], v[186:187], v[178:179] op_sel_hi:[0,1,1] neg_lo:[0,0,1] neg_hi:[0,0,1]
v_pk_fma_f32 v[180:181], v[192:193], v[188:189], v[180:181] op_sel_hi:[0,1,1] neg_lo:[0,0,1] neg_hi:[0,0,1]
v_pk_fma_f32 v[182:183], v[192:193], v[190:191], v[182:183] op_sel_hi:[0,1,1] neg_lo:[0,0,1] neg_hi:[0,0,1]
v_cvt_pk_bf16_f32 v152, v176, v177
v_cvt_pk_bf16_f32 v153, v178, v179
v_cvt_pk_bf16_f32 v154, v180, v181
v_cvt_pk_bf16_f32 v155, v182, v183
v_pk_fma_f32 v[184:185], v[192:193], v[176:177], v[184:185] op_sel_hi:[0,1,1] neg_lo:[0,0,1] neg_hi:[0,0,1]
v_pk_fma_f32 v[186:187], v[192:193], v[178:179], v[186:187] op_sel_hi:[0,1,1] neg_lo:[0,0,1] neg_hi:[0,0,1]
v_pk_fma_f32 v[188:189], v[192:193], v[180:181], v[188:189] op_sel_hi:[0,1,1] neg_lo:[0,0,1] neg_hi:[0,0,1]
v_pk_fma_f32 v[190:191], v[192:193], v[182:183], v[190:191] op_sel_hi:[0,1,1] neg_lo:[0,0,1] neg_hi:[0,0,1]
v_cvt_pk_bf16_f32 v156, v184, v185
v_cvt_pk_bf16_f32 v157, v186, v187
v_cvt_pk_bf16_f32 v158, v188, v189
v_cvt_pk_bf16_f32 v159, v190, v191
v_pk_fma_f32 v[176:177], v[192:193], v[184:185], v[176:177] op_sel_hi:[0,1,1] neg_lo:[0,0,1] neg_hi:[0,0,1]
v_pk_fma_f32 v[178:179], v[192:193], v[186:187], v[178:179] op_sel_hi:[0,1,1] neg_lo:[0,0,1] neg_hi:[0,0,1]
v_pk_fma_f32 v[180:181], v[192:193], v[188:189], v[180:181] op_sel_hi:[0,1,1] neg_lo:[0,0,1] neg_hi:[0,0,1]
v_pk_fma_f32 v[182:183], v[192:193], v[190:191], v[182:183] op_sel_hi:[0,1,1] neg_lo:[0,0,1] neg_hi:[0,0,1]
v_cvt_pk_bf16_f32 v160, v176, v177
v_cvt_pk_bf16_f32 v161, v178, v179
v_cvt_pk_bf16_f32 v162, v180, v181
v_cvt_pk_bf16_f32 v163, v182, v183
v_pk_fma_f32 v[184:185], v[192:193], v[176:177], v[184:185] op_sel_hi:[0,1,1] neg_lo:[0,0,1] neg_hi:[0,0,1]
v_pk_fma_f32 v[186:187], v[192:193], v[178:179], v[186:187] op_sel_hi:[0,1,1] neg_lo:[0,0,1] neg_hi:[0,0,1]
v_pk_fma_f32 v[188:189], v[192:193], v[180:181], v[188:189] op_sel_hi:[0,1,1] neg_lo:[0,0,1] neg_hi:[0,0,1]
v_pk_fma_f32 v[190:191], v[192:193], v[182:183], v[190:191] op_sel_hi:[0,1,1] neg_lo:[0,0,1] neg_hi:[0,0,1]
v_cvt_pk_bf16_f32 v164, v184, v185
v_cvt_pk_bf16_f32 v165, v186, v187
v_cvt_pk_bf16_f32 v166, v188, v189
v_cvt_pk_bf16_f32 v167, v190, v191
v_pk_fma_f32 v[176:177], v[192:193], v[184:185], v[176:177] op_sel_hi:[0,1,1] neg_lo:[0,0,1] neg_hi:[0,0,1]
v_pk_fma_f32 v[178:179], v[192:193], v[186:187], v[178:179] op_sel_hi:[0,1,1] neg_lo:[0,0,1] neg_hi:[0,0,1]
v_pk_fma_f32 v[180:181], v[192:193], v[188:189], v[180:181] op_sel_hi:[0,1,1] neg_lo:[0,0,1] neg_hi:[0,0,1]
v_pk_fma_f32 v[182:183], v[192:193], v[190:191], v[182:183] op_sel_hi:[0,1,1] neg_lo:[0,0,1] neg_hi:[0,0,1]
v_cvt_pk_bf16_f32 v168, v176, v177
v_cvt_pk_bf16_f32 v169, v178, v179
v_cvt_pk_bf16_f32 v170, v180, v181
v_cvt_pk_bf16_f32 v171, v182, v183
v_pk_fma_f32 v[184:185], v[192:193], v[176:177], v[184:185] op_sel_hi:[0,1,1] neg_lo:[0,0,1] neg_hi:[0,0,1]
v_pk_fma_f32 v[186:187], v[192:193], v[178:179], v[186:187] op_sel_hi:[0,1,1] neg_lo:[0,0,1] neg_hi:[0,0,1]
v_pk_fma_f32 v[188:189], v[192:193], v[180:181], v[188:189] op_sel_hi:[0,1,1] neg_lo:[0,0,1] neg_hi:[0,0,1]
v_pk_fma_f32 v[190:191], v[192:193], v[182:183], v[190:191] op_sel_hi:[0,1,1] neg_lo:[0,0,1] neg_hi:[0,0,1]
v_cvt_pk_bf16_f32 v172, v184, v185
v_cvt_pk_bf16_f32 v173, v186, v187
v_cvt_pk_bf16_f32 v174, v188, v189
v_cvt_pk_bf16_f32 v175, v190, v191
p1q_81:
s_mul_i32 s18, s30, 21846
s_lshr_b32 s18, s18, 16
s_mul_i32 s18, s18, 3
s_sub_u32 s18, s30, s18
s_and_b32 s19, s30, 3
s_cmp_lt_u32 s30, 56
s_cselect_b32 s18, s18, s19
s_mul_i32 s18, s18, 2560
s_add_u32 s18, s18, 11665408
s_add_u32 s29, s30, 1
s_cmp_lg_u32 s13, 0
s_cbranch_scc1 polld_83
v_lshlrev_b32 v3, 3, v0
v_min_u32 v12, 2432, v3
s_mov_b32 s17, 0
poll_82:
buffer_load_dword v8, v12, s[4:7], s18 offen sc1
s_add_u32 s17, s17, 1
s_cmp_gt_u32 s17, 262144
s_cbranch_scc1 L_fail
s_waitcnt vmcnt(0)
v_cmp_gt_u32 vcc, s29, v8
s_cbranch_vccz polld_83
s_sleep 2
s_branch poll_82
polld_83:
s_barrier
s_mul_i32 s18, s30, 40960
s_add_u32 s26, s18, 91226112
s_add_u32 s26, s26, s31
s_add_u32 s27, s18, 100663296
s_add_u32 s27, s27, s33
s_add_u32 m0, s31, 2048
s_add_u32 s20, s26, 0
buffer_load_dwordx4 v0, s[4:7], s20 offen sc1 lds
s_add_u32 m0, s31, 3072
s_add_u32 s20, s26, 1024
buffer_load_dwordx4 v0, s[4:7], s20 offen sc1 lds
s_add_u32 m0, s31, 4096
s_add_u32 s20, s26, 2048
buffer_load_dwordx4 v0, s[4:7], s20 offen sc1 lds
s_add_u32 m0, s31, 5120
s_add_u32 s20, s26, 3072
buffer_load_dwordx4 v0, s[4:7], s20 offen sc1 lds
s_add_u32 m0, s31, 6144
s_add_u32 s20, s26, 4096
buffer_load_dwordx4 v0, s[4:7], s20 offen sc1 lds
s_add_u32 m0, s31, 7168
s_add_u32 s20, s26, 5120
buffer_load_dwordx4 v0, s[4:7], s20 offen sc1 lds
s_add_u32 m0, s31, 8192
s_add_u32 s20, s26, 6144
buffer_load_dwordx4 v0, s[4:7], s20 offen sc1 lds
s_add_u32 m0, s31, 9216
s_add_u32 s20, s26, 7168
buffer_load_dwordx4 v0, s[4:7], s20 offen sc1 lds
s_add_u32 m0, s31, 10240
s_add_u32 s20, s26, 8192
buffer_load_dwordx4 v0, s[4:7], s20 offen sc1 lds
s_add_u32 m0, s31, 11264
s_add_u32 s20, s26, 9216
buffer_load_dwordx4 v0, s[4:7], s20 offen sc1 lds
s_waitcnt vmcnt(0)
s_barrier
v_add_u32 v2, s31, v0
ds_read_b128 v[216:219], v2 offset:2048
ds_read_b128 v[220:223], v2 offset:3072
ds_read_b128 v[224:227], v2 offset:4096
ds_read_b128 v[196:199], v0 offset:3072
ds_read_b128 v[228:231], v2 offset:5120
ds_read_b128 v[192:195], v0 offset:2048
v_mov_b64 v[208:209], 0
ds_read_b128 v[200:203], v0 offset:4096
ds_read_b128 v[204:207], v0 offset:5120
s_waitcnt lgkmcnt(7)
v_dot2c_f32_bf16 v208, s24, v216
v_dot2c_f32_bf16 v209, v216, v216
v_dot2c_f32_bf16 v208, s24, v217
v_dot2c_f32_bf16 v209, v217, v217
v_dot2c_f32_bf16 v208, s24, v218
v_dot2c_f32_bf16 v209, v218, v218
v_dot2c_f32_bf16 v208, s24, v219
s_waitcnt lgkmcnt(5)
v_dot2c_f32_bf16 v209, v219, v219
v_dot2c_f32_bf16 v208, s24, v220
v_dot2c_f32_bf16 v209, v220, v220
v_dot2c_f32_bf16 v208, s24, v221
v_dot2c_f32_bf16 v209, v221, v221
v_dot2c_f32_bf16 v208, s24, v222
v_dot2c_f32_bf16 v209, v222, v222
v_dot2c_f32_bf16 v208, s24, v223
v_dot2c_f32_bf16 v209, v223, v223
v_dot2c_f32_bf16 v208, s24, v224
v_dot2c_f32_bf16 v209, v224, v224
s_waitcnt lgkmcnt(3)
ds_read_b128 v[216:219], v2 offset:6144
ds_read_b128 v[220:223], v2 offset:7168
v_dot2c_f32_bf16 v208, s24, v225
v_dot2c_f32_bf16 v209, v225, v225
v_dot2c_f32_bf16 v208, s24, v226
v_dot2c_f32_bf16 v209, v226, v226
v_dot2c_f32_bf16 v208, s24, v227
v_dot2c_f32_bf16 v209, v227, v227
v_dot2c_f32_bf16 v208, s24, v228
v_dot2c_f32_bf16 v209, v228, v228
v_dot2c_f32_bf16 v208, s24, v229
v_dot2c_f32_bf16 v209, v229, v229
v_dot2c_f32_bf16 v208, s24, v230
v_dot2c_f32_bf16 v209, v230, v230
v_dot2c_f32_bf16 v208, s24, v231
v_dot2c_f32_bf16 v209, v231, v231
s_waitcnt lgkmcnt(1)
ds_read_b128 v[228:231], v2 offset:9216
ds_read_b128 v[224:227], v2 offset:8192
v_dot2c_f32_bf16 v208, s24, v216
v_dot2c_f32_bf16 v209, v216, v216
v_dot2c_f32_bf16 v208, s24, v217
s_waitcnt lgkmcnt(2)
v_dot2c_f32_bf16 v209, v217, v217
v_dot2c_f32_bf16 v208, s24, v218
v_dot2c_f32_bf16 v209, v218, v218
v_dot2c_f32_bf16 v208, s24, v219
v_dot2c_f32_bf16 v209, v219, v219
v_dot2c_f32_bf16 v208, s24, v220
v_dot2c_f32_bf16 v209, v220, v220
v_dot2c_f32_bf16 v208, s24, v221
v_dot2c_f32_bf16 v209, v221, v221
v_dot2c_f32_bf16 v208, s24, v222
v_dot2c_f32_bf16 v209, v222, v222
v_dot2c_f32_bf16 v208, s24, v223
v_dot2c_f32_bf16 v209, v223, v223
s_waitcnt lgkmcnt(0)
ds_read_b128 v[216:219], v2 offset:10240
ds_read_b128 v[220:223], v2 offset:11264
v_dot2c_f32_bf16 v208, s24, v224
v_dot2c_f32_bf16 v209, v224, v224
v_dot2c_f32_bf16 v208, s24, v225
v_dot2c_f32_bf16 v209, v225, v225
v_dot2c_f32_bf16 v208, s24, v226
v_dot2c_f32_bf16 v209, v226, v226
v_dot2c_f32_bf16 v208, s24, v227
v_dot2c_f32_bf16 v209, v227, v227
v_dot2c_f32_bf16 v208, s24, v228
v_dot2c_f32_bf16 v209, v228, v228
v_dot2c_f32_bf16 v208, s24, v229
v_dot2c_f32_bf16 v209, v229, v229
v_dot2c_f32_bf16 v208, s24, v230
v_dot2c_f32_bf16 v209, v230, v230
s_waitcnt lgkmcnt(1)
v_dot2c_f32_bf16 v208, s24, v231
v_dot2c_f32_bf16 v209, v231, v231
v_dot2c_f32_bf16 v208, s24, v216
s_waitcnt lgkmcnt(0)
v_dot2c_f32_bf16 v209, v216, v216
v_dot2c_f32_bf16 v208, s24, v217
v_dot2c_f32_bf16 v209, v217, v217
v_dot2c_f32_bf16 v208, s24, v218
v_dot2c_f32_bf16 v209, v218, v218
v_dot2c_f32_bf16 v208, s24, v219
v_dot2c_f32_bf16 v209, v219, v219
v_dot2c_f32_bf16 v208, s24, v220
v_dot2c_f32_bf16 v209, v220, v220
v_dot2c_f32_bf16 v208, s24, v221
v_dot2c_f32_bf16 v209, v221, v221
v_dot2c_f32_bf16 v208, s24, v222
v_dot2c_f32_bf16 v209, v222, v222
v_dot2c_f32_bf16 v208, s24, v223
v_dot2c_f32_bf16 v209, v223, v223
v_mfma_f32_32x32x16_bf16 v[176:191], v[192:195], v[16:19], 0
s_nop 1
v_permlane32_swap_b32 v208, v209
ds_read_b128 v[192:195], v0 offset:6144
v_mfma_f32_32x32x16_bf16 v[176:191], v[196:199], v[20:23], v[176:191]
v_and_b32 v2, 0x1ff, v0
v_add_f32 v208, v208, v209
v_mfma_f32_32x32x16_bf16 v[176:191], v[200:203], v[24:27], v[176:191]
v_lshl_add_u32 v209, s13, 2, v0
ds_read_b128 v[196:199], v0 offset:7168
ds_write_b32 v209, v208 offset:0
v_mfma_f32_32x32x16_bf16 v[176:191], v[204:207], v[28:31], v[176:191]
s_waitcnt lgkmcnt(2)
ds_read_b128 v[200:203], v0 offset:8192
ds_read_b128 v[204:207], v0 offset:9216
v_mfma_f32_32x32x16_bf16 v[176:191], v[192:195], v[32:35], v[176:191]
s_waitcnt lgkmcnt(3)
v_mfma_f32_32x32x16_bf16 v[176:191], v[196:199], v[36:39], v[176:191]
s_waitcnt lgkmcnt(2)
ds_read_b128 v[192:195], v0 offset:10240
s_waitcnt lgkmcnt(2)
s_waitcnt lgkmcnt(1)
v_mfma_f32_32x32x16_bf16 v[176:191], v[200:203], v[40:43], v[176:191]
ds_read_b128 v[196:199], v0 offset:11264
s_barrier
ds_read_b128 v[208:211], v2 offset:0
v_mfma_f32_32x32x16_bf16 v[176:191], v[204:207], v[44:47], v[176:191]
ds_read_b128 v[204:207], v0 offset:13312
ds_read_b128 v[200:203], v0 offset:12288
s_waitcnt lgkmcnt(4)
v_mfma_f32_32x32x16_bf16 v[176:191], v[192:195], v[48:51], v[176:191]
s_waitcnt lgkmcnt(3)
ds_read_b128 v[212:215], v2 offset:512
ds_read_b128 v[192:195], v0 offset:14336
v_mfma_f32_32x32x16_bf16 v[176:191], v[196:199], v[52:55], v[176:191]
s_waitcnt lgkmcnt(2)
v_mfma_f32_32x32x16_bf16 v[176:191], v[200:203], v[56:59], v[176:191]
ds_read_b128 v[196:199], v0 offset:15360
ds_read_b128 v[200:203], v0 offset:16384
v_add_f32 v208, v208, v209
v_add_f32 v210, v210, v211
s_waitcnt lgkmcnt(3)
v_mfma_f32_32x32x16_bf16 v[176:191], v[204:207], v[60:63], v[176:191]
s_waitcnt lgkmcnt(2)
ds_read_b128 v[204:207], v0 offset:17408
v_add_f32 v212, v212, v213
v_add_f32 v208, v208, v210
v_mfma_f32_32x32x16_bf16 v[176:191], v[192:195], v[64:67], v[176:191]
s_waitcnt lgkmcnt(2)
v_mfma_f32_32x32x16_bf16 v[176:191], v[196:199], v[68:71], v[176:191]
v_mul_f32 v208, 0x3acccccd, v208
s_waitcnt lgkmcnt(1)
ds_read_b128 v[192:195], v0 offset:18432
v_add_f32 v214, v214, v215
s_waitcnt lgkmcnt(1)
v_mfma_f32_32x32x16_bf16 v[176:191], v[200:203], v[72:75], v[176:191]
v_lshrrev_b32 v209, 2, v0
ds_read_b128 v[196:199], v0 offset:19456
v_mfma_f32_32x32x16_bf16 v[176:191], v[204:207], v[76:79], v[176:191]
ds_read_b128 v[200:203], v0 offset:20480
ds_read_b128 v[204:207], v0 offset:21504
v_add_f32 v212, v212, v214
v_mul_f32 v212, 0x3acccccd, v212
s_waitcnt lgkmcnt(3)
v_mfma_f32_32x32x16_bf16 v[176:191], v[192:195], v[80:83], v[176:191]
v_fma_f32 v212, -v208, v208, v212
s_waitcnt lgkmcnt(2)
v_max_f32 v212, 0, v212
v_add_f32 v212, 0x3727c5ac, v212
v_mfma_f32_32x32x16_bf16 v[176:191], v[196:199], v[84:87], v[176:191]
ds_read_b128 v[192:195], v0 offset:22528
s_waitcnt lgkmcnt(2)
v_bfe_u32 v210, v0, 5, 5
v_lshl_add_u32 v209, s13, 8, v209
v_mfma_f32_32x32x16_bf16 v[176:191], v[200:203], v[88:91], v[176:191]
ds_read_b128 v[196:199], v0 offset:23552
ds_read_b128 v[200:203], v0 offset:24576
v_rsq_f32 v212, v212
s_waitcnt lgkmcnt(3)
v_and_b32 v210, 16, v210
v_mfma_f32_32x32x16_bf16 v[176:191], v[204:207], v[92:95], v[176:191]
ds_read_b128 v[204:207], v0 offset:25600
s_waitcnt lgkmcnt(3)
v_mul_f32 v208, v212, v208
v_mfma_f32_32x32x16_bf16 v[176:191], v[192:195], v[96:99], v[176:191]
v_lshl_add_u32 v210, s13, 8, v210
v_permlane32_swap_b32 v212, v208
s_waitcnt lgkmcnt(2)
ds_read_b128 v[192:195], v0 offset:26624
v_mfma_f32_32x32x16_bf16 v[176:191], v[196:199], v[100:103], v[176:191]
ds_write_b32 v209, v212 offset:1024
s_waitcnt lgkmcnt(3)
s_waitcnt lgkmcnt(2)
v_mfma_f32_32x32x16_bf16 v[176:191], v[200:203], v[104:107], v[176:191]
ds_read_b128 v[240:243], v210 offset:1216
ds_read_b128 v[196:199], v0 offset:27648
v_mfma_f32_32x32x16_bf16 v[176:191], v[204:207], v[108:111], v[176:191]
ds_read_b128 v[200:203], v0 offset:28672
s_waitcnt lgkmcnt(4)
ds_read_b128 v[232:235], v210 offset:1152
v_mfma_f32_32x32x16_bf16 v[176:191], v[192:195], v[112:115], v[176:191]
ds_read_b128 v[204:207], v0 offset:29696
ds_read_b128 v[192:195], v0 offset:30720
s_waitcnt lgkmcnt(4)
v_mfma_f32_32x32x16_bf16 v[176:191], v[196:199], v[116:119], v[176:191]
ds_read_b128 v[228:231], v210 offset:1120
s_waitcnt lgkmcnt(4)
ds_read_b128 v[216:219], v210 offset:1024
ds_read_b128 v[196:199], v0 offset:31744
v_mfma_f32_32x32x16_bf16 v[176:191], v[200:203], v[120:123], v[176:191]
v_mul_f32 v241, v241, v7
s_waitcnt lgkmcnt(3)
ds_read_b128 v[200:203], v0 offset:32768
v_mfma_f32_32x32x16_bf16 v[176:191], v[204:207], v[124:127], v[176:191]
ds_read_b128 v[220:223], v210 offset:1056
v_mfma_f32_32x32x16_bf16 v[176:191], v[192:195], v[128:131], v[176:191]
ds_read_b128 v[204:207], v0 offset:33792
s_waitcnt lgkmcnt(3)
v_mfma_f32_32x32x16_bf16 v[176:191], v[196:199], v[132:135], v[176:191]
s_waitcnt lgkmcnt(2)
ds_read_b128 v[192:195], v0 offset:34816
ds_read_b128 v[224:227], v210 offset:1088
ds_read_b128 v[196:199], v0 offset:35840
ds_read_b128 v[244:247], v210 offset:1248
v_mfma_f32_32x32x16_bf16 v[176:191], v[200:203], v[136:139], v[176:191]
s_waitcnt lgkmcnt(4)
ds_read_b128 v[200:203], v0 offset:36864
v_mfma_f32_32x32x16_bf16 v[176:191], v[204:207], v[140:143], v[176:191]
v_mul_f32 v242, v242, v7
ds_read_b128 v[236:239], v210 offset:1184
s_waitcnt lgkmcnt(5)
v_mfma_f32_32x32x16_bf16 v[176:191], v[192:195], v[144:147], v[176:191]
ds_read_b128 v[204:207], v0 offset:37888
s_waitcnt lgkmcnt(3)
ds_read_b128 v[192:195], v0 offset:38912
v_mfma_f32_32x32x16_bf16 v[176:191], v[196:199], v[148:151], v[176:191]
ds_read_b128 v[196:199], v0 offset:39936
s_waitcnt lgkmcnt(4)
s_waitcnt lgkmcnt(3)
v_mul_f32 v240, v240, v7
v_mfma_f32_32x32x16_bf16 v[176:191], v[200:203], v[152:155], v[176:191]
v_mul_f32 v247, v247, v7
v_mul_f32 v245, v245, v7
v_mul_f32 v233, v233, v7
s_waitcnt lgkmcnt(2)
v_mfma_f32_32x32x16_bf16 v[176:191], v[204:207], v[156:159], v[176:191]
ds_read_b128 v[200:203], v0 offset:40960
s_waitcnt lgkmcnt(1)
ds_read_b128 v[204:207], v0 offset:41984
v_mul_f32 v232, v232, v7
v_mfma_f32_32x32x16_bf16 v[176:191], v[192:195], v[160:163], v[176:191]
v_mul_f32 v246, v246, v7
v_mul_f32 v244, v244, v7
v_mul_f32 v236, v236, v7
v_mfma_f32_32x32x16_bf16 v[176:191], v[196:199], v[164:167], v[176:191]
s_waitcnt lgkmcnt(0)
v_mul_f32 v239, v239, v7
v_mfma_f32_32x32x16_bf16 v[176:191], v[200:203], v[168:171], v[176:191]
v_mul_f32 v238, v238, v7
v_mfma_f32_32x32x16_bf16 v[176:191], v[204:207], v[172:175], v[176:191]
s_nop 0
v_mul_f32 v237, v237, v7
v_mul_f32 v235, v235, v7
v_mul_f32 v234, v234, v7
v_mul_f32 v243, v243, v7
s_nop 6
v_pk_fma_f32 v[184:185], v[184:185], v[224:225], v[240:241] neg_lo:[0,0,1] neg_hi:[0,0,1]
v_pk_fma_f32 v[182:183], v[182:183], v[222:223], v[238:239] neg_lo:[0,0,1] neg_hi:[0,0,1]
v_pk_fma_f32 v[180:181], v[180:181], v[220:221], v[236:237] neg_lo:[0,0,1] neg_hi:[0,0,1]
v_pk_fma_f32 v[188:189], v[188:189], v[228:229], v[244:245] neg_lo:[0,0,1] neg_hi:[0,0,1]
v_pk_fma_f32 v[176:177], v[176:177], v[216:217], v[232:233] neg_lo:[0,0,1] neg_hi:[0,0,1]
v_cvt_pk_bf16_f32 v194, v180, v181
v_pk_fma_f32 v[178:179], v[178:179], v[218:219], v[234:235] neg_lo:[0,0,1] neg_hi:[0,0,1]
v_cvt_pk_bf16_f32 v198, v188, v189
v_pk_fma_f32 v[190:191], v[190:191], v[230:231], v[246:247] neg_lo:[0,0,1] neg_hi:[0,0,1]
v_cvt_pk_bf16_f32 v199, v190, v191
v_cvt_pk_bf16_f32 v195, v182, v183
v_pk_fma_f32 v[186:187], v[186:187], v[226:227], v[242:243] neg_lo:[0,0,1] neg_hi:[0,0,1]
v_cvt_pk_bf16_f32 v193, v178, v179
v_cvt_pk_bf16_f32 v196, v184, v185
v_cvt_pk_bf16_f32 v197, v186, v187
v_cvt_pk_bf16_f32 v192, v176, v177
buffer_store_dwordx4 v[192:195], v6, s[4:7], s27 offen offset:0 sc1
buffer_store_dwordx4 v[196:199], v6, s[4:7], s27 offen offset:1024 sc1
s_add_u32 s30, s30, 3
s_cmp_lt_u32 s30, 60
s_cbranch_scc1 p1q_81
s_lshl_b32 s18, s51, 7
s_add_u32 s18, s18, 11552768
s_cmp_eq_u32 s13, 0
s_cselect_b32 s22, s18, s6
s_mov_b32 s23, 1
s_waitcnt vmcnt(0)
s_barrier
v_mov_b32 v3, s23
s_mov_b64 exec, 1
buffer_store_dword v3, off, s[4:7], s22 sc1
s_mov_b64 exec, -1
s_mov_b32 s22, s6
aend_64:
s_add_u32 s16, s16, 1
s_cmp_lt_u32 s16, 2
s_cbranch_scc1 alay_50
s_endpgm
L_fail:
s_mov_b64 exec, 1
v_mov_b32 v1, 0xdead
buffer_store_dword v1, off, s[8:11], 0 offset:4 sc1
L_end:
s_endpgm
L_chain:
s_waitcnt vmcnt(0)
s_nop 4
s_bitcmp1_b32 0xb5b5b5b5, s14
s_cbranch_scc0 grp_10001
s_bfm_b32 s24, s14, 0
s_and_b32 s24, s24, 0xb5b5b5b5
s_bcnt1_i32_b32 s24, s24
v_and_b32 v64, 63, v0
v_and_b32 v65, 15, v64
v_lshrrev_b32 v66, 4, v64
v_lshlrev_b32 v0, 4, v64
v_and_b32 v67, 2, v64
v_mov_b32 v68, 0x4444
v_mov_b32 v69, 0xeeee
v_cmp_eq_u32 vcc, 0, v67
s_nop 1
v_cndmask_b32 v1, v69, v68, vcc
s_mul_i32 s26, s13, 24576
s_add_u32 s26, s26, 65536
v_add_u32 v2, s26, v0
v_lshrrev_b32 v67, 2, v65
v_xor_b32 v68, v66, v67
v_lshlrev_b32 v68, 3, v68
v_lshl_add_u32 v68, v65, 5, v68
s_lshl_b32 s26, s13, 10
s_add_u32 s26, s26, 10240
v_add_u32 v3, s26, v68
v_lshl_add_u32 v68, v66, 2, v67
v_and_b32 v69, 3, v65
v_xor_b32 v69, v69, v66
v_lshlrev_b32 v69, 3, v69
v_lshl_add_u32 v68, v68, 5, v69
v_add_u32 v4, 10240, v68
v_and_b32 v69, 1, v65
v_lshl_add_u32 v68, v67, 1, v69
v_lshlrev_b32 v68, 4, v68
v_lshl_add_u32 v68, v66, 7, v68
v_add_u32 v5, 8192, v68
v_bfe_u32 v69, v65, 1, 1
v_mul_u32_u24 v69, 640, v69
v_xor_b32 v6, v69, v5
s_mov_b32 s42, 0x33333333
s_mov_b32 s43, 0x33333333
s_mov_b32 s44, 0x3f803f80
s_mov_b32 s45, 0x3f803f80
s_mov_b32 s46, 0x3f803f80
s_mov_b32 s47, 0
s_mov_b32 s37, 729808896
s_mov_b32 s38, 671088640
v_lshlrev_b32 v68, 3, v65
v_lshl_add_u32 v7, v66, 12, v68
s_lshl_b32 s26, s13, 14
s_lshl_b32 s27, s14, 7
s_add_u32 s26, s26, s27
s_add_u32 s90, s26, 65536
s_lshl_b32 s26, s13, 5
s_add_u32 s93, s26, s14
s_lshl_b32 s26, s93, 12
s_add_u32 s91, s26, 65536
s_lshr_b32 s26, s93, 2
s_lshl_b32 s26, s26, 9
s_and_b32 s27, s93, 3
s_lshl_b32 s27, s27, 6
s_add_u32 s26, s26, s27
s_add_u32 s92, s26, 393216
s_lshl_b32 s26, s14, 8
s_add_u32 s22, s26, 11534336
s_lshl_b32 s26, s24, 7
s_add_u32 s26, s26, 11550720
s_cmp_lt_u32 s24, 10
s_cselect_b32 s23, s26, 268435456
s_cselect_b32 s24, s24, 0
s_cselect_b32 s25, 12582912, s23
s_lshl_b32 s24, s24, 10
s_and_b32 s26, s14, 0
s_lshl_b32 s26, s26, 12
s_add_u32 s94, s26, 425984
s_lshl_b32 s26, s14, 7
s_add_u32 s95, s26, 425984
s_mov_b32 s35, 0x3e0293ee
s_lshl_b32 s26, s14, 2
s_add_u32 s26, s26, s13
s_mul_i32 s27, s26, 18432
s_add_u32 s89, s27, 1048576
s_add_u32 s48, s4, s90
s_addc_u32 s49, s5, 0
s_add_u32 s50, s90, 65536
s_add_u32 s50, s4, s50
s_addc_u32 s51, s5, 0
s_add_u32 s52, s90, 131072
s_add_u32 s52, s4, s52
s_addc_u32 s53, s5, 0
s_add_u32 s54, s90, 196608
s_add_u32 s54, s4, s54
s_addc_u32 s55, s5, 0
s_add_u32 s56, s90, 262144
s_add_u32 s56, s4, s56
s_addc_u32 s57, s5, 0
s_add_u32 s76, s89, 4096
s_add_u32 s76, s4, s76
s_addc_u32 s77, s5, 0
s_add_u32 s78, s89, 12288
s_add_u32 s78, s4, s78
s_addc_u32 s79, s5, 0
s_add_u32 s80, s89, 20480
s_add_u32 s80, s4, s80
s_addc_u32 s81, s5, 0
s_add_u32 s60, s4, s94
s_addc_u32 s61, s5, 0
s_add_u32 s62, s4, s95
s_addc_u32 s63, s5, 0
s_add_u32 s64, s4, s91
s_addc_u32 s65, s5, 0
s_add_u32 s66, s4, s92
s_addc_u32 s67, s5, 0
v_mov_b32 v72, 0
v_mov_b32 v73, 0
s_mov_b32 s26, s90
buffer_store_dwordx2 v[72:73], v7, s[4:7], s26 offen
s_add_u32 s26, s26, 65536
buffer_store_dwordx2 v[72:73], v7, s[4:7], s26 offen
s_add_u32 s26, s26, 65536
buffer_store_dwordx2 v[72:73], v7, s[4:7], s26 offen
s_add_u32 s26, s26, 65536
buffer_store_dwordx2 v[72:73], v7, s[4:7], s26 offen
s_add_u32 s26, s26, 65536
buffer_store_dwordx2 v[72:73], v7, s[4:7], s26 offen
s_add_u32 s26, s26, 65536
buffer_store_dword v72, off, s[4:7], s95 offset:0
s_load_dwordx2 s[96:97], s[0:1], 32
s_mov_b32 s98, 10240
s_mov_b32 s99, 0x20000
s_cmp_ge_u32 s93, 80
s_cbranch_scc1 nm0_10002
s_and_b32 s26, s93, 3
s_mul_i32 s26, s26, 2560
s_lshr_b32 s27, s93, 2
s_lshl_b32 s27, s27, 6
s_add_u32 s26, s26, s27
v_bfe_u32 v68, v65, 1, 2
v_lshlrev_b32 v68, 4, v68
v_and_b32 v69, 1, v65
v_lshl_add_u32 v68, v69, 2, v68
v_and_b32 v69, 1, v66
v_mul_u32_u24 v69, 1280, v69
v_add_u32 v68, v68, v69
s_waitcnt lgkmcnt(0)
buffer_load_dword v74, v68, s[96:99], s26 offen
buffer_load_dword v75, v68, s[96:99], s26 offen offset:8
v_and_b32 v68, 32, v0
v_bfe_u32 v69, v0, 6, 1
v_lshl_add_u32 v68, v69, 8, v68
v_bfe_u32 v69, v0, 8, 1
v_lshl_add_u32 v68, v69, 4, v68
v_bfe_u32 v69, v0, 4, 1
v_lshl_add_u32 v68, v69, 3, v68
s_add_u32 s27, s92, 16384
buffer_store_dwordx2 v[72:73], v68, s[4:7], s92 offen
s_waitcnt vmcnt(1)
buffer_store_dwordx2 v[74:75], v68, s[4:7], s27 offen
nm0_10002:
s_waitcnt vmcnt(0) lgkmcnt(0)
s_barrier
s_cmp_eq_u32 s13, 0
s_cselect_b32 s26, 144, s10
v_mov_b32 v74, 1
s_mov_b64 exec, 1
buffer_atomic_add v74, off, s[8:11], s26
s_mov_b64 exec, -1
v_lshrrev_b32 v67, 3, v64
v_and_b32 v68, 7, v64
v_lshlrev_b32 v68, 4, v68
v_lshl_add_u32 v32, v67, 13, v68
v_mul_u32_u24 v67, 1280, v67
v_add_u32 v36, v67, v68
v_lshrrev_b32 v67, 1, v66
v_lshlrev_b32 v67, 4, v67
v_and_b32 v68, 1, v66
v_lshl_add_u32 v67, v68, 1, v67
v_lshrrev_b32 v68, 3, v65
v_lshl_add_u32 v67, v68, 3, v67
v_bfe_u32 v68, v65, 2, 1
v_add_u32 v67, v67, v68
v_and_b32 v69, 3, v65
v_lshlrev_b32 v40, 4, v69
v_lshl_add_u32 v40, v67, 7, v40
v_lshl_add_u32 v67, v66, 2, v68
v_lshlrev_b32 v42, 4, v69
v_lshl_add_u32 v42, v67, 7, v42
v_lshrrev_b32 v68, 3, v65
v_lshl_add_u32 v42, v68, 3, v42
s_lshl_b32 s29, s13, 12
s_and_b32 s26, s13, 1
s_lshl_b32 s26, s26, 6
s_add_u32 s26, s26, s29
v_add_u32 v40, s26, v40
v_add_u32 v42, s26, v42
v_xor_b32 v41, 4096, v40
v_xor_b32 v43, 4096, v42
v_add_u32 v33, 64512, v32
v_add_u32 v37, 9216, v36
v_add_u32 v34, 129024, v32
v_add_u32 v38, 18432, v36
v_add_u32 v35, 193536, v32
v_add_u32 v39, 27648, v36
s_lshr_b32 s28, s13, 1
s_lshl_b32 s28, s28, 7
s_lshl_b32 s27, s14, 8
s_add_u32 s27, s27, s28
s_xor_b32 s26, s13, 0
s_lshl_b32 s82, s26, 19
s_add_u32 s82, s82, s27
s_lshl_b32 s85, s14, 2
s_add_u32 s85, s85, s26
s_mul_i32 s85, s85, 40960
s_add_u32 s85, s85, s28
s_xor_b32 s26, s13, 2
s_lshl_b32 s83, s26, 19
s_add_u32 s83, s83, s27
s_lshl_b32 s86, s14, 2
s_add_u32 s86, s86, s26
s_mul_i32 s86, s86, 40960
s_add_u32 s86, s86, s28
s_and_b32 s26, s13, 1
s_add_u32 s26, s26, 8
s_lshl_b32 s84, s26, 19
s_add_u32 s84, s84, s27
s_load_dwordx2 s[68:69], s[0:1], 40
s_load_dwordx2 s[70:71], s[0:1], 48
s_load_dwordx2 s[72:73], s[0:1], 56
s_load_dwordx2 s[74:75], s[0:1], 64
s_mov_b32 s98, 5242880
s_waitcnt lgkmcnt(0)
s_mov_b64 s[96:97], s[70:71]
s_add_u32 m0, s29, 0
s_add_u32 s26, s82, 0
buffer_load_dwordx4 v32, s[96:99], s26 offen offset:0 lds
buffer_load_dwordx4 v33, s[96:99], s26 offen offset:1024 lds
buffer_load_dwordx4 v34, s[96:99], s26 offen offset:2048 lds
buffer_load_dwordx4 v35, s[96:99], s26 offen offset:3072 lds
s_add_u32 m0, s29, 16384
s_add_u32 s26, s82, 262144
buffer_load_dwordx4 v32, s[96:99], s26 offen offset:0 lds
buffer_load_dwordx4 v33, s[96:99], s26 offen offset:1024 lds
buffer_load_dwordx4 v34, s[96:99], s26 offen offset:2048 lds
buffer_load_dwordx4 v35, s[96:99], s26 offen offset:3072 lds
s_add_u32 m0, s29, 32768
s_add_u32 s26, s82, 2097152
buffer_load_dwordx4 v32, s[96:99], s26 offen offset:0 lds
buffer_load_dwordx4 v33, s[96:99], s26 offen offset:1024 lds
buffer_load_dwordx4 v34, s[96:99], s26 offen offset:2048 lds
buffer_load_dwordx4 v35, s[96:99], s26 offen offset:3072 lds
s_waitcnt vmcnt(8)
s_barrier
s_add_u32 m0, s29, 49152
s_add_u32 s26, s82, 2359296
buffer_load_dwordx4 v32, s[96:99], s26 offen offset:0 lds
buffer_load_dwordx4 v33, s[96:99], s26 offen offset:1024 lds
buffer_load_dwordx4 v34, s[96:99], s26 offen offset:2048 lds
buffer_load_dwordx4 v35, s[96:99], s26 offen offset:3072 lds
ds_read_b64_tr_b16 a[0:1], v40 offset:0
ds_read_b64_tr_b16 a[2:3], v40 offset:512
ds_read_b64_tr_b16 v[72:73], v40 offset:8
ds_read_b64_tr_b16 v[74:75], v40 offset:520
ds_read_b64_tr_b16 a[104:105], v41 offset:0
ds_read_b64_tr_b16 a[106:107], v41 offset:512
ds_read_b64_tr_b16 a[112:113], v41 offset:8
ds_read_b64_tr_b16 a[114:115], v41 offset:520
s_waitcnt lgkmcnt(4)
global_store_dwordx4 v0, v[72:75], s[76:77] offset:0
s_waitcnt vmcnt(9) lgkmcnt(0)
s_barrier
s_add_u32 m0, s29, 0
s_add_u32 s26, s83, 0
buffer_load_dwordx4 v32, s[96:99], s26 offen offset:0 lds
buffer_load_dwordx4 v33, s[96:99], s26 offen offset:1024 lds
buffer_load_dwordx4 v34, s[96:99], s26 offen offset:2048 lds
buffer_load_dwordx4 v35, s[96:99], s26 offen offset:3072 lds
ds_read_b64_tr_b16 a[4:5], v40 offset:16384
ds_read_b64_tr_b16 a[6:7], v40 offset:16896
ds_read_b64_tr_b16 v[72:73], v40 offset:16392
ds_read_b64_tr_b16 v[74:75], v40 offset:16904
ds_read_b64_tr_b16 a[108:109], v41 offset:16384
ds_read_b64_tr_b16 a[110:111], v41 offset:16896
ds_read_b64_tr_b16 a[116:117], v41 offset:16392
ds_read_b64_tr_b16 a[118:119], v41 offset:16904
s_waitcnt lgkmcnt(4)
global_store_dwordx4 v0, v[72:75], s[76:77] offset:1024
s_waitcnt vmcnt(10) lgkmcnt(0)
s_barrier
s_add_u32 m0, s29, 16384
s_add_u32 s26, s83, 262144
buffer_load_dwordx4 v32, s[96:99], s26 offen offset:0 lds
buffer_load_dwordx4 v33, s[96:99], s26 offen offset:1024 lds
buffer_load_dwordx4 v34, s[96:99], s26 offen offset:2048 lds
buffer_load_dwordx4 v35, s[96:99], s26 offen offset:3072 lds
ds_read_b64_tr_b16 a[16:17], v40 offset:32768
ds_read_b64_tr_b16 a[18:19], v40 offset:33280
ds_read_b64_tr_b16 a[24:25], v40 offset:32776
ds_read_b64_tr_b16 a[26:27], v40 offset:33288
ds_read_b64_tr_b16 v[72:73], v41 offset:32768
ds_read_b64_tr_b16 v[74:75], v41 offset:33280
ds_read_b64_tr_b16 v[76:77], v41 offset:32776
ds_read_b64_tr_b16 v[78:79], v41 offset:33288
s_waitcnt lgkmcnt(2)
ds_write_b128 v2, v[72:75] offset:12288
s_waitcnt lgkmcnt(1)
global_store_dwordx4 v0, v[76:79], s[78:79] offset:-2048
s_waitcnt vmcnt(11)
s_barrier
s_add_u32 m0, s29, 32768
s_add_u32 s26, s83, 2097152
buffer_load_dwordx4 v32, s[96:99], s26 offen offset:0 lds
buffer_load_dwordx4 v33, s[96:99], s26 offen offset:1024 lds
buffer_load_dwordx4 v34, s[96:99], s26 offen offset:2048 lds
buffer_load_dwordx4 v35, s[96:99], s26 offen offset:3072 lds
ds_read_b64_tr_b16 a[20:21], v40 offset:49152
ds_read_b64_tr_b16 a[22:23], v40 offset:49664
ds_read_b64_tr_b16 a[28:29], v40 offset:49160
ds_read_b64_tr_b16 a[30:31], v40 offset:49672
ds_read_b64_tr_b16 v[72:73], v41 offset:49152
ds_read_b64_tr_b16 v[74:75], v41 offset:49664
ds_read_b64_tr_b16 v[76:77], v41 offset:49160
ds_read_b64_tr_b16 v[78:79], v41 offset:49672
s_waitcnt lgkmcnt(2)
ds_write_b128 v2, v[72:75] offset:13312
s_waitcnt lgkmcnt(1)
global_store_dwordx4 v0, v[76:79], s[78:79] offset:-1024
s_waitcnt vmcnt(11)
s_barrier
s_add_u32 m0, s29, 49152
s_add_u32 s26, s83, 2359296
buffer_load_dwordx4 v32, s[96:99], s26 offen offset:0 lds
buffer_load_dwordx4 v33, s[96:99], s26 offen offset:1024 lds
buffer_load_dwordx4 v34, s[96:99], s26 offen offset:2048 lds
buffer_load_dwordx4 v35, s[96:99], s26 offen offset:3072 lds
ds_read_b64_tr_b16 a[120:121], v40 offset:0
ds_read_b64_tr_b16 a[122:123], v40 offset:512
ds_read_b64_tr_b16 a[128:129], v40 offset:8
ds_read_b64_tr_b16 a[130:131], v40 offset:520
ds_read_b64_tr_b16 a[152:153], v41 offset:0
ds_read_b64_tr_b16 a[154:155], v41 offset:512
ds_read_b64_tr_b16 a[160:161], v41 offset:8
ds_read_b64_tr_b16 a[162:163], v41 offset:520
s_waitcnt vmcnt(10) lgkmcnt(0)
s_barrier
s_add_u32 m0, s29, 0
s_add_u32 s26, s84, 0
buffer_load_dwordx4 v32, s[96:99], s26 offen offset:0 lds
buffer_load_dwordx4 v33, s[96:99], s26 offen offset:1024 lds
buffer_load_dwordx4 v34, s[96:99], s26 offen offset:2048 lds
buffer_load_dwordx4 v35, s[96:99], s26 offen offset:3072 lds
ds_read_b64_tr_b16 a[124:125], v40 offset:16384
ds_read_b64_tr_b16 a[126:127], v40 offset:16896
ds_read_b64_tr_b16 a[132:133], v40 offset:16392
ds_read_b64_tr_b16 a[134:135], v40 offset:16904
ds_read_b64_tr_b16 a[156:157], v41 offset:16384
ds_read_b64_tr_b16 a[158:159], v41 offset:16896
ds_read_b64_tr_b16 a[164:165], v41 offset:16392
ds_read_b64_tr_b16 a[166:167], v41 offset:16904
s_waitcnt vmcnt(9) lgkmcnt(0)
s_barrier
s_add_u32 m0, s29, 16384
s_add_u32 s26, s84, 262144
buffer_load_dwordx4 v32, s[96:99], s26 offen offset:0 lds
buffer_load_dwordx4 v33, s[96:99], s26 offen offset:1024 lds
buffer_load_dwordx4 v34, s[96:99], s26 offen offset:2048 lds
buffer_load_dwordx4 v35, s[96:99], s26 offen offset:3072 lds
ds_read_b64_tr_b16 a[136:137], v40 offset:32768
ds_read_b64_tr_b16 a[138:139], v40 offset:33280
ds_read_b64_tr_b16 a[144:145], v40 offset:32776
ds_read_b64_tr_b16 a[146:147], v40 offset:33288
ds_read_b64_tr_b16 a[168:169], v41 offset:32768
ds_read_b64_tr_b16 a[170:171], v41 offset:33280
ds_read_b64_tr_b16 v[72:73], v41 offset:32776
ds_read_b64_tr_b16 v[74:75], v41 offset:33288
s_waitcnt lgkmcnt(0)
ds_write_b128 v2, v[72:75] offset:14336
s_waitcnt vmcnt(8)
s_barrier
s_mov_b64 s[96:97], s[72:73]
s_add_u32 m0, s29, 32768
s_add_u32 s26, s82, 0
buffer_load_dwordx4 v32, s[96:99], s26 offen offset:0 lds
buffer_load_dwordx4 v33, s[96:99], s26 offen offset:1024 lds
buffer_load_dwordx4 v34, s[96:99], s26 offen offset:2048 lds
buffer_load_dwordx4 v35, s[96:99], s26 offen offset:3072 lds
ds_read_b64_tr_b16 a[140:141], v40 offset:49152
ds_read_b64_tr_b16 a[142:143], v40 offset:49664
ds_read_b64_tr_b16 a[148:149], v40 offset:49160
ds_read_b64_tr_b16 a[150:151], v40 offset:49672
ds_read_b64_tr_b16 a[172:173], v41 offset:49152
ds_read_b64_tr_b16 a[174:175], v41 offset:49664
ds_read_b64_tr_b16 v[72:73], v41 offset:49160
ds_read_b64_tr_b16 v[74:75], v41 offset:49672
s_waitcnt lgkmcnt(0)
ds_write_b128 v2, v[72:75] offset:15360
s_waitcnt vmcnt(8)
s_barrier
s_add_u32 m0, s29, 49152
s_add_u32 s26, s82, 262144
buffer_load_dwordx4 v32, s[96:99], s26 offen offset:0 lds
buffer_load_dwordx4 v33, s[96:99], s26 offen offset:1024 lds
buffer_load_dwordx4 v34, s[96:99], s26 offen offset:2048 lds
buffer_load_dwordx4 v35, s[96:99], s26 offen offset:3072 lds
ds_read_b64_tr_b16 a[176:177], v40 offset:0
ds_read_b64_tr_b16 a[178:179], v40 offset:512
ds_read_b64_tr_b16 v[72:73], v40 offset:8
ds_read_b64_tr_b16 v[74:75], v40 offset:520
ds_read_b64_tr_b16 a[184:185], v41 offset:0
ds_read_b64_tr_b16 a[186:187], v41 offset:512
ds_read_b64_tr_b16 a[192:193], v41 offset:8
ds_read_b64_tr_b16 a[194:195], v41 offset:520
s_waitcnt lgkmcnt(4)
ds_write_b128 v2, v[72:75] offset:16384
s_waitcnt vmcnt(8) lgkmcnt(1)
s_barrier
s_add_u32 m0, s29, 0
s_add_u32 s26, s82, 2097152
buffer_load_dwordx4 v32, s[96:99], s26 offen offset:0 lds
buffer_load_dwordx4 v33, s[96:99], s26 offen offset:1024 lds
buffer_load_dwordx4 v34, s[96:99], s26 offen offset:2048 lds
buffer_load_dwordx4 v35, s[96:99], s26 offen offset:3072 lds
ds_read_b64_tr_b16 a[180:181], v40 offset:16384
ds_read_b64_tr_b16 a[182:183], v40 offset:16896
ds_read_b64_tr_b16 v[72:73], v40 offset:16392
ds_read_b64_tr_b16 v[74:75], v40 offset:16904
ds_read_b64_tr_b16 a[188:189], v41 offset:16384
ds_read_b64_tr_b16 a[190:191], v41 offset:16896
ds_read_b64_tr_b16 a[196:197], v41 offset:16392
ds_read_b64_tr_b16 a[198:199], v41 offset:16904
s_waitcnt lgkmcnt(4)
ds_write_b128 v2, v[72:75] offset:17408
s_waitcnt vmcnt(8) lgkmcnt(1)
s_barrier
s_add_u32 m0, s29, 16384
s_add_u32 s26, s82, 2359296
buffer_load_dwordx4 v32, s[96:99], s26 offen offset:0 lds
buffer_load_dwordx4 v33, s[96:99], s26 offen offset:1024 lds
buffer_load_dwordx4 v34, s[96:99], s26 offen offset:2048 lds
buffer_load_dwordx4 v35, s[96:99], s26 offen offset:3072 lds
ds_read_b64_tr_b16 v[72:73], v40 offset:32768
ds_read_b64_tr_b16 v[74:75], v40 offset:33280
ds_read_b64_tr_b16 a[224:225], v40 offset:32776
ds_read_b64_tr_b16 a[226:227], v40 offset:33288
ds_read_b64_tr_b16 v[76:77], v41 offset:32768
ds_read_b64_tr_b16 v[78:79], v41 offset:33280
ds_read_b64_tr_b16 v[8:9], v41 offset:32776
ds_read_b64_tr_b16 v[10:11], v41 offset:33288
s_waitcnt lgkmcnt(6)
ds_write_b128 v2, v[72:75] offset:20480
s_waitcnt lgkmcnt(3)
ds_write_b128 v2, v[76:79] offset:22528
s_waitcnt vmcnt(8) lgkmcnt(2)
s_barrier
s_add_u32 m0, s29, 32768
s_add_u32 s26, s83, 0
buffer_load_dwordx4 v32, s[96:99], s26 offen offset:0 lds
buffer_load_dwordx4 v33, s[96:99], s26 offen offset:1024 lds
buffer_load_dwordx4 v34, s[96:99], s26 offen offset:2048 lds
buffer_load_dwordx4 v35, s[96:99], s26 offen offset:3072 lds
ds_read_b64_tr_b16 v[72:73], v40 offset:49152
ds_read_b64_tr_b16 v[74:75], v40 offset:49664
ds_read_b64_tr_b16 a[228:229], v40 offset:49160
ds_read_b64_tr_b16 a[230:231], v40 offset:49672
ds_read_b64_tr_b16 v[76:77], v41 offset:49152
ds_read_b64_tr_b16 v[78:79], v41 offset:49664
ds_read_b64_tr_b16 v[12:13], v41 offset:49160
ds_read_b64_tr_b16 v[14:15], v41 offset:49672
s_waitcnt lgkmcnt(6)
ds_write_b128 v2, v[72:75] offset:21504
s_waitcnt lgkmcnt(3)
ds_write_b128 v2, v[76:79] offset:23552
s_waitcnt vmcnt(8) lgkmcnt(2)
s_barrier
s_add_u32 m0, s29, 49152
s_add_u32 s26, s83, 262144
buffer_load_dwordx4 v32, s[96:99], s26 offen offset:0 lds
buffer_load_dwordx4 v33, s[96:99], s26 offen offset:1024 lds
buffer_load_dwordx4 v34, s[96:99], s26 offen offset:2048 lds
buffer_load_dwordx4 v35, s[96:99], s26 offen offset:3072 lds
ds_read_b64_tr_b16 a[232:233], v40 offset:0
ds_read_b64_tr_b16 a[234:235], v40 offset:512
ds_read_b64_tr_b16 a[240:241], v40 offset:8
ds_read_b64_tr_b16 a[242:243], v40 offset:520
ds_read_b64_tr_b16 a[248:249], v41 offset:0
ds_read_b64_tr_b16 a[250:251], v41 offset:512
ds_read_b64_tr_b16 v[88:89], v41 offset:8
ds_read_b64_tr_b16 v[90:91], v41 offset:520
s_waitcnt vmcnt(8) lgkmcnt(0)
s_barrier
s_add_u32 m0, s29, 0
s_add_u32 s26, s83, 2097152
buffer_load_dwordx4 v32, s[96:99], s26 offen offset:0 lds
buffer_load_dwordx4 v33, s[96:99], s26 offen offset:1024 lds
buffer_load_dwordx4 v34, s[96:99], s26 offen offset:2048 lds
buffer_load_dwordx4 v35, s[96:99], s26 offen offset:3072 lds
ds_read_b64_tr_b16 a[236:237], v40 offset:16384
ds_read_b64_tr_b16 a[238:239], v40 offset:16896
ds_read_b64_tr_b16 a[244:245], v40 offset:16392
ds_read_b64_tr_b16 a[246:247], v40 offset:16904
ds_read_b64_tr_b16 a[252:253], v41 offset:16384
ds_read_b64_tr_b16 a[254:255], v41 offset:16896
ds_read_b64_tr_b16 v[92:93], v41 offset:16392
ds_read_b64_tr_b16 v[94:95], v41 offset:16904
s_waitcnt vmcnt(8) lgkmcnt(0)
s_barrier
s_add_u32 m0, s29, 16384
s_add_u32 s26, s83, 2359296
buffer_load_dwordx4 v32, s[96:99], s26 offen offset:0 lds
buffer_load_dwordx4 v33, s[96:99], s26 offen offset:1024 lds
buffer_load_dwordx4 v34, s[96:99], s26 offen offset:2048 lds
buffer_load_dwordx4 v35, s[96:99], s26 offen offset:3072 lds
ds_read_b64_tr_b16 v[96:97], v40 offset:32768
ds_read_b64_tr_b16 v[98:99], v40 offset:33280
ds_read_b64_tr_b16 v[104:105], v40 offset:32776
ds_read_b64_tr_b16 v[106:107], v40 offset:33288
ds_read_b64_tr_b16 v[128:129], v41 offset:32768
ds_read_b64_tr_b16 v[130:131], v41 offset:33280
ds_read_b64_tr_b16 v[136:137], v41 offset:32776
ds_read_b64_tr_b16 v[138:139], v41 offset:33288
s_waitcnt vmcnt(8) lgkmcnt(0)
s_barrier
s_add_u32 m0, s29, 32768
s_add_u32 s26, s84, 0
buffer_load_dwordx4 v32, s[96:99], s26 offen offset:0 lds
buffer_load_dwordx4 v33, s[96:99], s26 offen offset:1024 lds
buffer_load_dwordx4 v34, s[96:99], s26 offen offset:2048 lds
buffer_load_dwordx4 v35, s[96:99], s26 offen offset:3072 lds
ds_read_b64_tr_b16 v[100:101], v40 offset:49152
ds_read_b64_tr_b16 v[102:103], v40 offset:49664
ds_read_b64_tr_b16 v[108:109], v40 offset:49160
ds_read_b64_tr_b16 v[110:111], v40 offset:49672
ds_read_b64_tr_b16 v[132:133], v41 offset:49152
ds_read_b64_tr_b16 v[134:135], v41 offset:49664
ds_read_b64_tr_b16 v[140:141], v41 offset:49160
ds_read_b64_tr_b16 v[142:143], v41 offset:49672
s_waitcnt vmcnt(8) lgkmcnt(0)
s_barrier
s_add_u32 m0, s29, 49152
s_add_u32 s26, s84, 262144
buffer_load_dwordx4 v32, s[96:99], s26 offen offset:0 lds
buffer_load_dwordx4 v33, s[96:99], s26 offen offset:1024 lds
buffer_load_dwordx4 v34, s[96:99], s26 offen offset:2048 lds
buffer_load_dwordx4 v35, s[96:99], s26 offen offset:3072 lds
ds_read_b64_tr_b16 v[112:113], v40 offset:0
ds_read_b64_tr_b16 v[114:115], v40 offset:512
ds_read_b64_tr_b16 v[120:121], v40 offset:8
ds_read_b64_tr_b16 v[122:123], v40 offset:520
ds_read_b64_tr_b16 v[144:145], v41 offset:0
ds_read_b64_tr_b16 v[146:147], v41 offset:512
ds_read_b64_tr_b16 v[152:153], v41 offset:8
ds_read_b64_tr_b16 v[154:155], v41 offset:520
s_waitcnt vmcnt(8) lgkmcnt(0)
s_barrier
s_mov_b64 s[96:97], s[68:69]
s_add_u32 m0, s29, 0
s_add_u32 s26, s82, 0
buffer_load_dwordx4 v32, s[96:99], s26 offen offset:0 lds
buffer_load_dwordx4 v33, s[96:99], s26 offen offset:1024 lds
buffer_load_dwordx4 v34, s[96:99], s26 offen offset:2048 lds
buffer_load_dwordx4 v35, s[96:99], s26 offen offset:3072 lds
ds_read_b64_tr_b16 v[116:117], v40 offset:16384
ds_read_b64_tr_b16 v[118:119], v40 offset:16896
ds_read_b64_tr_b16 v[124:125], v40 offset:16392
ds_read_b64_tr_b16 v[126:127], v40 offset:16904
ds_read_b64_tr_b16 v[148:149], v41 offset:16384
ds_read_b64_tr_b16 v[150:151], v41 offset:16896
ds_read_b64_tr_b16 v[156:157], v41 offset:16392
ds_read_b64_tr_b16 v[158:159], v41 offset:16904
s_waitcnt vmcnt(8) lgkmcnt(0)
s_barrier
s_add_u32 m0, s29, 16384
s_add_u32 s26, s82, 262144
buffer_load_dwordx4 v32, s[96:99], s26 offen offset:0 lds
buffer_load_dwordx4 v33, s[96:99], s26 offen offset:1024 lds
buffer_load_dwordx4 v34, s[96:99], s26 offen offset:2048 lds
buffer_load_dwordx4 v35, s[96:99], s26 offen offset:3072 lds
ds_read_b64_tr_b16 a[200:201], v40 offset:32768
ds_read_b64_tr_b16 a[202:203], v40 offset:33280
ds_read_b64_tr_b16 a[208:209], v40 offset:32776
ds_read_b64_tr_b16 a[210:211], v40 offset:33288
ds_read_b64_tr_b16 v[72:73], v41 offset:32768
ds_read_b64_tr_b16 v[74:75], v41 offset:33280
ds_read_b64_tr_b16 a[216:217], v41 offset:32776
ds_read_b64_tr_b16 a[218:219], v41 offset:33288
s_waitcnt lgkmcnt(2)
ds_write_b128 v2, v[72:75] offset:18432
s_waitcnt vmcnt(8) lgkmcnt(1)
s_barrier
s_add_u32 m0, s29, 32768
s_add_u32 s26, s82, 2097152
buffer_load_dwordx4 v32, s[96:99], s26 offen offset:0 lds
buffer_load_dwordx4 v33, s[96:99], s26 offen offset:1024 lds
buffer_load_dwordx4 v34, s[96:99], s26 offen offset:2048 lds
buffer_load_dwordx4 v35, s[96:99], s26 offen offset:3072 lds
ds_read_b64_tr_b16 a[204:205], v40 offset:49152
ds_read_b64_tr_b16 a[206:207], v40 offset:49664
ds_read_b64_tr_b16 a[212:213], v40 offset:49160
ds_read_b64_tr_b16 a[214:215], v40 offset:49672
ds_read_b64_tr_b16 v[72:73], v41 offset:49152
ds_read_b64_tr_b16 v[74:75], v41 offset:49664
ds_read_b64_tr_b16 a[220:221], v41 offset:49160
ds_read_b64_tr_b16 a[222:223], v41 offset:49672
s_waitcnt lgkmcnt(2)
ds_write_b128 v2, v[72:75] offset:19456
s_waitcnt vmcnt(8) lgkmcnt(1)
s_barrier
s_add_u32 m0, s29, 49152
s_add_u32 s26, s82, 2359296
buffer_load_dwordx4 v32, s[96:99], s26 offen offset:0 lds
buffer_load_dwordx4 v33, s[96:99], s26 offen offset:1024 lds
buffer_load_dwordx4 v34, s[96:99], s26 offen offset:2048 lds
buffer_load_dwordx4 v35, s[96:99], s26 offen offset:3072 lds
ds_read_b64_tr_b16 v[72:73], v40 offset:0
ds_read_b64_tr_b16 v[74:75], v40 offset:512
ds_read_b64_tr_b16 v[76:77], v40 offset:8
ds_read_b64_tr_b16 v[78:79], v40 offset:520
ds_read_b64_tr_b16 v[80:81], v41 offset:0
ds_read_b64_tr_b16 v[82:83], v41 offset:512
ds_read_b64_tr_b16 a[32:33], v41 offset:8
ds_read_b64_tr_b16 a[34:35], v41 offset:520
s_waitcnt lgkmcnt(6)
global_store_dwordx4 v0, v[72:75], s[76:77] offset:-4096
s_waitcnt lgkmcnt(4)
global_store_dwordx4 v0, v[76:79], s[76:77] offset:-2048
s_waitcnt lgkmcnt(2)
ds_write_b128 v2, v[80:83] offset:0
s_waitcnt vmcnt(10) lgkmcnt(1)
s_barrier
s_add_u32 m0, s29, 0
s_add_u32 s26, s83, 0
buffer_load_dwordx4 v32, s[96:99], s26 offen offset:0 lds
buffer_load_dwordx4 v33, s[96:99], s26 offen offset:1024 lds
buffer_load_dwordx4 v34, s[96:99], s26 offen offset:2048 lds
buffer_load_dwordx4 v35, s[96:99], s26 offen offset:3072 lds
ds_read_b64_tr_b16 v[72:73], v40 offset:16384
ds_read_b64_tr_b16 v[74:75], v40 offset:16896
ds_read_b64_tr_b16 v[76:77], v40 offset:16392
ds_read_b64_tr_b16 v[78:79], v40 offset:16904
ds_read_b64_tr_b16 v[80:81], v41 offset:16384
ds_read_b64_tr_b16 v[82:83], v41 offset:16896
ds_read_b64_tr_b16 a[36:37], v41 offset:16392
ds_read_b64_tr_b16 a[38:39], v41 offset:16904
s_waitcnt lgkmcnt(6)
global_store_dwordx4 v0, v[72:75], s[76:77] offset:-3072
s_waitcnt lgkmcnt(4)
global_store_dwordx4 v0, v[76:79], s[76:77] offset:-1024
s_waitcnt lgkmcnt(2)
ds_write_b128 v2, v[80:83] offset:1024
s_waitcnt vmcnt(12) lgkmcnt(1)
s_barrier
s_add_u32 m0, s29, 16384
s_add_u32 s26, s83, 262144
buffer_load_dwordx4 v32, s[96:99], s26 offen offset:0 lds
buffer_load_dwordx4 v33, s[96:99], s26 offen offset:1024 lds
buffer_load_dwordx4 v34, s[96:99], s26 offen offset:2048 lds
buffer_load_dwordx4 v35, s[96:99], s26 offen offset:3072 lds
ds_read_b64_tr_b16 v[72:73], v40 offset:32768
ds_read_b64_tr_b16 v[74:75], v40 offset:33280
ds_read_b64_tr_b16 a[8:9], v40 offset:32776
ds_read_b64_tr_b16 a[10:11], v40 offset:33288
ds_read_b64_tr_b16 a[40:41], v41 offset:32768
ds_read_b64_tr_b16 a[42:43], v41 offset:33280
ds_read_b64_tr_b16 v[76:77], v41 offset:32776
ds_read_b64_tr_b16 v[78:79], v41 offset:33288
s_waitcnt lgkmcnt(6)
global_store_dwordx4 v0, v[72:75], s[76:77] offset:2048
s_waitcnt lgkmcnt(0)
global_store_dwordx4 v0, v[76:79], s[78:79] offset:-4096
s_waitcnt vmcnt(14)
s_barrier
s_add_u32 m0, s29, 32768
s_add_u32 s26, s83, 2097152
buffer_load_dwordx4 v32, s[96:99], s26 offen offset:0 lds
buffer_load_dwordx4 v33, s[96:99], s26 offen offset:1024 lds
buffer_load_dwordx4 v34, s[96:99], s26 offen offset:2048 lds
buffer_load_dwordx4 v35, s[96:99], s26 offen offset:3072 lds
ds_read_b64_tr_b16 v[72:73], v40 offset:49152
ds_read_b64_tr_b16 v[74:75], v40 offset:49664
ds_read_b64_tr_b16 a[12:13], v40 offset:49160
ds_read_b64_tr_b16 a[14:15], v40 offset:49672
ds_read_b64_tr_b16 a[44:45], v41 offset:49152
ds_read_b64_tr_b16 a[46:47], v41 offset:49664
ds_read_b64_tr_b16 v[76:77], v41 offset:49160
ds_read_b64_tr_b16 v[78:79], v41 offset:49672
s_waitcnt lgkmcnt(6)
global_store_dwordx4 v0, v[72:75], s[76:77] offset:3072
s_waitcnt lgkmcnt(0)
global_store_dwordx4 v0, v[76:79], s[78:79] offset:-3072
s_waitcnt vmcnt(14)
s_barrier
s_add_u32 m0, s29, 49152
s_add_u32 s26, s83, 2359296
buffer_load_dwordx4 v32, s[96:99], s26 offen offset:0 lds
buffer_load_dwordx4 v33, s[96:99], s26 offen offset:1024 lds
buffer_load_dwordx4 v34, s[96:99], s26 offen offset:2048 lds
buffer_load_dwordx4 v35, s[96:99], s26 offen offset:3072 lds
ds_read_b64_tr_b16 a[48:49], v40 offset:0
ds_read_b64_tr_b16 a[50:51], v40 offset:512
ds_read_b64_tr_b16 a[56:57], v40 offset:8
ds_read_b64_tr_b16 a[58:59], v40 offset:520
ds_read_b64_tr_b16 v[72:73], v41 offset:0
ds_read_b64_tr_b16 v[74:75], v41 offset:512
ds_read_b64_tr_b16 v[76:77], v41 offset:8
ds_read_b64_tr_b16 v[78:79], v41 offset:520
s_waitcnt lgkmcnt(2)
ds_write_b128 v2, v[72:75] offset:4096
s_waitcnt lgkmcnt(1)
ds_write_b128 v2, v[76:79] offset:6144
s_waitcnt vmcnt(12)
s_barrier
s_add_u32 m0, s29, 0
s_add_u32 s26, s84, 0
buffer_load_dwordx4 v32, s[96:99], s26 offen offset:0 lds
buffer_load_dwordx4 v33, s[96:99], s26 offen offset:1024 lds
buffer_load_dwordx4 v34, s[96:99], s26 offen offset:2048 lds
buffer_load_dwordx4 v35, s[96:99], s26 offen offset:3072 lds
ds_read_b64_tr_b16 a[52:53], v40 offset:16384
ds_read_b64_tr_b16 a[54:55], v40 offset:16896
ds_read_b64_tr_b16 a[60:61], v40 offset:16392
ds_read_b64_tr_b16 a[62:63], v40 offset:16904
ds_read_b64_tr_b16 v[72:73], v41 offset:16384
ds_read_b64_tr_b16 v[74:75], v41 offset:16896
ds_read_b64_tr_b16 v[76:77], v41 offset:16392
ds_read_b64_tr_b16 v[78:79], v41 offset:16904
s_waitcnt lgkmcnt(2)
ds_write_b128 v2, v[72:75] offset:5120
s_waitcnt lgkmcnt(1)
ds_write_b128 v2, v[76:79] offset:7168
s_waitcnt vmcnt(10)
s_barrier
s_add_u32 m0, s29, 16384
s_add_u32 s26, s84, 262144
buffer_load_dwordx4 v32, s[96:99], s26 offen offset:0 lds
buffer_load_dwordx4 v33, s[96:99], s26 offen offset:1024 lds
buffer_load_dwordx4 v34, s[96:99], s26 offen offset:2048 lds
buffer_load_dwordx4 v35, s[96:99], s26 offen offset:3072 lds
ds_read_b64_tr_b16 v[72:73], v40 offset:32768
ds_read_b64_tr_b16 v[74:75], v40 offset:33280
ds_read_b64_tr_b16 a[64:65], v40 offset:32776
ds_read_b64_tr_b16 a[66:67], v40 offset:33288
ds_read_b64_tr_b16 a[72:73], v41 offset:32768
ds_read_b64_tr_b16 a[74:75], v41 offset:33280
ds_read_b64_tr_b16 a[80:81], v41 offset:32776
ds_read_b64_tr_b16 a[82:83], v41 offset:33288
s_waitcnt lgkmcnt(6)
ds_write_b128 v2, v[72:75] offset:2048
s_waitcnt vmcnt(8) lgkmcnt(1)
s_barrier
s_mov_b64 s[96:97], s[74:75]
s_add_u32 m0, s29, 32768
s_add_u32 s26, s85, 0
buffer_load_dwordx4 v36, s[96:99], s26 offen offset:0 lds
buffer_load_dwordx4 v37, s[96:99], s26 offen offset:1024 lds
buffer_load_dwordx4 v38, s[96:99], s26 offen offset:2048 lds
buffer_load_dwordx4 v39, s[96:99], s26 offen offset:3072 lds
ds_read_b64_tr_b16 v[72:73], v40 offset:49152
ds_read_b64_tr_b16 v[74:75], v40 offset:49664
ds_read_b64_tr_b16 a[68:69], v40 offset:49160
ds_read_b64_tr_b16 a[70:71], v40 offset:49672
ds_read_b64_tr_b16 a[76:77], v41 offset:49152
ds_read_b64_tr_b16 a[78:79], v41 offset:49664
ds_read_b64_tr_b16 a[84:85], v41 offset:49160
ds_read_b64_tr_b16 a[86:87], v41 offset:49672
s_waitcnt lgkmcnt(6)
ds_write_b128 v2, v[72:75] offset:3072
s_waitcnt vmcnt(8) lgkmcnt(1)
s_barrier
s_add_u32 m0, s29, 49152
s_add_u32 s26, s86, 0
buffer_load_dwordx4 v36, s[96:99], s26 offen offset:0 lds
buffer_load_dwordx4 v37, s[96:99], s26 offen offset:1024 lds
buffer_load_dwordx4 v38, s[96:99], s26 offen offset:2048 lds
buffer_load_dwordx4 v39, s[96:99], s26 offen offset:3072 lds
ds_read_b64_tr_b16 v[72:73], v40 offset:0
ds_read_b64_tr_b16 v[74:75], v40 offset:512
ds_read_b64_tr_b16 a[88:89], v40 offset:8
ds_read_b64_tr_b16 a[90:91], v40 offset:520
ds_read_b64_tr_b16 a[96:97], v41 offset:0
ds_read_b64_tr_b16 a[98:99], v41 offset:512
ds_read_b64_tr_b16 v[76:77], v41 offset:8
ds_read_b64_tr_b16 v[78:79], v41 offset:520
s_waitcnt lgkmcnt(6)
ds_write_b128 v2, v[72:75] offset:8192
s_waitcnt lgkmcnt(1)
ds_write_b128 v2, v[76:79] offset:10240
s_waitcnt vmcnt(8)
s_barrier
s_add_u32 m0, s29, 0
s_add_u32 s26, s85, 256
buffer_load_dwordx4 v36, s[96:99], s26 offen offset:0 lds
buffer_load_dwordx4 v37, s[96:99], s26 offen offset:1024 lds
buffer_load_dwordx4 v38, s[96:99], s26 offen offset:2048 lds
buffer_load_dwordx4 v39, s[96:99], s26 offen offset:3072 lds
ds_read_b64_tr_b16 v[72:73], v40 offset:16384
ds_read_b64_tr_b16 v[74:75], v40 offset:16896
ds_read_b64_tr_b16 a[92:93], v40 offset:16392
ds_read_b64_tr_b16 a[94:95], v40 offset:16904
ds_read_b64_tr_b16 a[100:101], v41 offset:16384
ds_read_b64_tr_b16 a[102:103], v41 offset:16896
ds_read_b64_tr_b16 v[76:77], v41 offset:16392
ds_read_b64_tr_b16 v[78:79], v41 offset:16904
s_waitcnt lgkmcnt(6)
ds_write_b128 v2, v[72:75] offset:9216
s_waitcnt lgkmcnt(1)
ds_write_b128 v2, v[76:79] offset:11264
s_waitcnt vmcnt(8)
s_barrier
s_add_u32 m0, s29, 16384
s_add_u32 s26, s86, 256
buffer_load_dwordx4 v36, s[96:99], s26 offen offset:0 lds
buffer_load_dwordx4 v37, s[96:99], s26 offen offset:1024 lds
buffer_load_dwordx4 v38, s[96:99], s26 offen offset:2048 lds
buffer_load_dwordx4 v39, s[96:99], s26 offen offset:3072 lds
ds_read_b64_tr_b16 v[160:161], v42 offset:32768
ds_read_b64_tr_b16 v[162:163], v42 offset:33024
ds_read_b64_tr_b16 v[164:165], v42 offset:34816
ds_read_b64_tr_b16 v[166:167], v42 offset:35072
ds_read_b64_tr_b16 v[184:185], v43 offset:32768
ds_read_b64_tr_b16 v[186:187], v43 offset:33024
ds_read_b64_tr_b16 v[188:189], v43 offset:34816
ds_read_b64_tr_b16 v[190:191], v43 offset:35072
s_waitcnt vmcnt(8) lgkmcnt(0)
s_barrier
s_add_u32 m0, s29, 32768
s_add_u32 s26, s85, 512
buffer_load_dwordx4 v36, s[96:99], s26 offen offset:0 lds
buffer_load_dwordx4 v37, s[96:99], s26 offen offset:1024 lds
buffer_load_dwordx4 v38, s[96:99], s26 offen offset:2048 lds
buffer_load_dwordx4 v39, s[96:99], s26 offen offset:3072 lds
ds_read_b64_tr_b16 v[16:17], v42 offset:49152
ds_read_b64_tr_b16 v[18:19], v42 offset:49408
ds_read_b64_tr_b16 v[20:21], v42 offset:51200
ds_read_b64_tr_b16 v[22:23], v42 offset:51456
ds_read_b64_tr_b16 v[24:25], v43 offset:49152
ds_read_b64_tr_b16 v[26:27], v43 offset:49408
ds_read_b64_tr_b16 v[28:29], v43 offset:51200
ds_read_b64_tr_b16 v[30:31], v43 offset:51456
s_waitcnt vmcnt(8) lgkmcnt(0)
s_barrier
s_add_u32 m0, s29, 49152
s_add_u32 s26, s86, 512
buffer_load_dwordx4 v36, s[96:99], s26 offen offset:0 lds
buffer_load_dwordx4 v37, s[96:99], s26 offen offset:1024 lds
buffer_load_dwordx4 v38, s[96:99], s26 offen offset:2048 lds
buffer_load_dwordx4 v39, s[96:99], s26 offen offset:3072 lds
ds_read_b64_tr_b16 v[72:73], v42 offset:0
ds_read_b64_tr_b16 v[74:75], v42 offset:256
ds_read_b64_tr_b16 v[76:77], v42 offset:2048
ds_read_b64_tr_b16 v[78:79], v42 offset:2304
ds_read_b64_tr_b16 v[192:193], v43 offset:0
ds_read_b64_tr_b16 v[194:195], v43 offset:256
ds_read_b64_tr_b16 v[196:197], v43 offset:2048
ds_read_b64_tr_b16 v[198:199], v43 offset:2304
s_waitcnt lgkmcnt(6)
global_store_dwordx4 v0, v[72:75], s[78:79] offset:0
s_waitcnt lgkmcnt(4)
global_store_dwordx4 v0, v[76:79], s[78:79] offset:1024
s_waitcnt vmcnt(10) lgkmcnt(0)
s_barrier
s_add_u32 m0, s29, 0
s_add_u32 s26, s85, 768
buffer_load_dwordx4 v36, s[96:99], s26 offen offset:0 lds
buffer_load_dwordx4 v37, s[96:99], s26 offen offset:1024 lds
buffer_load_dwordx4 v38, s[96:99], s26 offen offset:2048 lds
buffer_load_dwordx4 v39, s[96:99], s26 offen offset:3072 lds
ds_read_b64_tr_b16 v[72:73], v42 offset:16384
ds_read_b64_tr_b16 v[74:75], v42 offset:16640
ds_read_b64_tr_b16 v[76:77], v42 offset:18432
ds_read_b64_tr_b16 v[78:79], v42 offset:18688
ds_read_b64_tr_b16 v[48:49], v43 offset:16384
ds_read_b64_tr_b16 v[50:51], v43 offset:16640
ds_read_b64_tr_b16 v[52:53], v43 offset:18432
ds_read_b64_tr_b16 v[54:55], v43 offset:18688
s_waitcnt lgkmcnt(6)
global_store_dwordx4 v0, v[72:75], s[80:81] offset:-4096
s_waitcnt lgkmcnt(4)
global_store_dwordx4 v0, v[76:79], s[80:81] offset:-3072
s_waitcnt vmcnt(12) lgkmcnt(0)
s_barrier
s_add_u32 m0, s29, 16384
s_add_u32 s26, s86, 768
buffer_load_dwordx4 v36, s[96:99], s26 offen offset:0 lds
buffer_load_dwordx4 v37, s[96:99], s26 offen offset:1024 lds
buffer_load_dwordx4 v38, s[96:99], s26 offen offset:2048 lds
buffer_load_dwordx4 v39, s[96:99], s26 offen offset:3072 lds
ds_read_b64_tr_b16 v[168:169], v42 offset:32768
ds_read_b64_tr_b16 v[170:171], v42 offset:33024
ds_read_b64_tr_b16 v[172:173], v42 offset:34816
ds_read_b64_tr_b16 v[174:175], v42 offset:35072
ds_read_b64_tr_b16 v[200:201], v43 offset:32768
ds_read_b64_tr_b16 v[202:203], v43 offset:33024
ds_read_b64_tr_b16 v[204:205], v43 offset:34816
ds_read_b64_tr_b16 v[206:207], v43 offset:35072
s_waitcnt vmcnt(12) lgkmcnt(0)
s_barrier
s_add_u32 m0, s29, 32768
s_add_u32 s26, s85, 1024
buffer_load_dwordx4 v36, s[96:99], s26 offen offset:0 lds
buffer_load_dwordx4 v37, s[96:99], s26 offen offset:1024 lds
buffer_load_dwordx4 v38, s[96:99], s26 offen offset:2048 lds
buffer_load_dwordx4 v39, s[96:99], s26 offen offset:3072 lds
ds_read_b64_tr_b16 v[208:209], v42 offset:49152
ds_read_b64_tr_b16 v[210:211], v42 offset:49408
ds_read_b64_tr_b16 v[212:213], v42 offset:51200
ds_read_b64_tr_b16 v[214:215], v42 offset:51456
ds_read_b64_tr_b16 v[56:57], v43 offset:49152
ds_read_b64_tr_b16 v[58:59], v43 offset:49408
ds_read_b64_tr_b16 v[60:61], v43 offset:51200
ds_read_b64_tr_b16 v[62:63], v43 offset:51456
v_lshrrev_b32 v44, 4, v0
v_and_b32 v44, 15, v44
v_lshlrev_b32 v44, 4, v44
buffer_load_dword v45, v44, s[8:11], 0 offen sc1
s_waitcnt vmcnt(11) lgkmcnt(0)
s_barrier
s_add_u32 m0, s29, 49152
s_add_u32 s26, s86, 1024
buffer_load_dwordx4 v36, s[96:99], s26 offen offset:0 lds
buffer_load_dwordx4 v37, s[96:99], s26 offen offset:1024 lds
buffer_load_dwordx4 v38, s[96:99], s26 offen offset:2048 lds
buffer_load_dwordx4 v39, s[96:99], s26 offen offset:3072 lds
ds_read_b64_tr_b16 v[176:177], v42 offset:0
ds_read_b64_tr_b16 v[178:179], v42 offset:256
ds_read_b64_tr_b16 v[180:181], v42 offset:2048
ds_read_b64_tr_b16 v[182:183], v42 offset:2304
ds_read_b64_tr_b16 v[216:217], v43 offset:0
ds_read_b64_tr_b16 v[218:219], v43 offset:256
ds_read_b64_tr_b16 v[220:221], v43 offset:2048
ds_read_b64_tr_b16 v[222:223], v43 offset:2304
s_waitcnt vmcnt(9) lgkmcnt(0)
s_barrier
ds_read_b64_tr_b16 v[224:225], v42 offset:16384
ds_read_b64_tr_b16 v[226:227], v42 offset:16640
ds_read_b64_tr_b16 v[228:229], v42 offset:18432
ds_read_b64_tr_b16 v[230:231], v42 offset:18688
ds_read_b64_tr_b16 v[232:233], v43 offset:16384
ds_read_b64_tr_b16 v[234:235], v43 offset:16640
ds_read_b64_tr_b16 v[236:237], v43 offset:18432
ds_read_b64_tr_b16 v[238:239], v43 offset:18688
s_waitcnt vmcnt(5) lgkmcnt(0)
s_barrier
ds_read_b64_tr_b16 v[72:73], v42 offset:32768
ds_read_b64_tr_b16 v[74:75], v42 offset:33024
ds_read_b64_tr_b16 v[76:77], v42 offset:34816
ds_read_b64_tr_b16 v[78:79], v42 offset:35072
ds_read_b64_tr_b16 v[240:241], v43 offset:32768
ds_read_b64_tr_b16 v[242:243], v43 offset:33024
ds_read_b64_tr_b16 v[244:245], v43 offset:34816
ds_read_b64_tr_b16 v[246:247], v43 offset:35072
s_waitcnt lgkmcnt(6)
global_store_dwordx4 v0, v[72:75], s[78:79] offset:2048
s_waitcnt lgkmcnt(4)
global_store_dwordx4 v0, v[76:79], s[78:79] offset:3072
s_waitcnt vmcnt(2) lgkmcnt(0)
s_barrier
ds_read_b64_tr_b16 v[248:249], v42 offset:49152
ds_read_b64_tr_b16 v[250:251], v42 offset:49408
ds_read_b64_tr_b16 v[252:253], v42 offset:51200
ds_read_b64_tr_b16 v[254:255], v42 offset:51456
ds_read_b64_tr_b16 v[64:65], v43 offset:49152
ds_read_b64_tr_b16 v[66:67], v43 offset:49408
ds_read_b64_tr_b16 v[68:69], v43 offset:51200
ds_read_b64_tr_b16 v[70:71], v43 offset:51456
s_waitcnt lgkmcnt(0)
s_barrier
s_mul_i32 s26, s13, 12288
v_add_u32 v47, s26, v0
ds_write_b128 v47, v[8:11] offset:16384
ds_write_b128 v47, v[12:15] offset:17408
ds_write_b128 v47, v[16:19] offset:18432
ds_write_b128 v47, v[20:23] offset:19456
ds_write_b128 v47, v[24:27] offset:20480
ds_write_b128 v47, v[28:31] offset:21504
ds_write_b128 v47, v[48:51] offset:22528
ds_write_b128 v47, v[52:55] offset:23552
ds_write_b128 v47, v[56:59] offset:24576
ds_write_b128 v47, v[60:63] offset:25600
ds_write_b128 v47, v[64:67] offset:26624
ds_write_b128 v47, v[68:71] offset:27648
s_mov_b32 s30, 0
s_branch all_10004
all_10003:
buffer_load_dword v45, v44, s[8:11], 0 offen sc1
s_add_u32 s30, s30, 1
s_cmp_gt_u32 s30, 262144
s_cbranch_scc1 L_fail
all_10004:
s_waitcnt vmcnt(0)
v_add_u32_dpp v46, v45, v45 quad_perm:[1,0,3,2] row_mask:0xf bank_mask:0xf
s_nop 1
v_add_u32_dpp v46, v46, v46 quad_perm:[2,3,0,1] row_mask:0xf bank_mask:0xf
s_nop 1
v_add_u32_dpp v46, v46, v46 row_ror:4 row_mask:0xf bank_mask:0xf
s_nop 1
v_add_u32_dpp v46, v46, v46 row_ror:8 row_mask:0xf bank_mask:0xf
v_cmp_ne_u32 vcc, 306, v46
s_cbranch_vccnz all_10003
s_waitcnt vmcnt(0) lgkmcnt(0)
s_barrier
s_mov_b32 s18, 0
s_mov_b32 s36, 0
s_cmp_eq_u32 s13, 1
s_cbranch_scc1 wave_10006
s_cmp_eq_u32 s13, 2
s_cbranch_scc1 wave_10007
s_cmp_eq_u32 s13, 3
s_cbranch_scc1 wave_10008
wave_10005:
layer_10009:
s_lshl_b32 s17, s36, 6
s_mul_i32 s27, s36, 35651584
s_mul_i32 s28, s14, 16384
s_add_u32 s27, s27, s28
s_add_u32 s20, s27, 16777216
s_mul_i32 s27, s17, 10240
s_add_u32 s27, s27, s24
s_add_u32 s21, s27, s25
s_mov_b32 s19, 0
s_mov_b32 s33, s6
s_add_u32 s34, s17, 1
s_add_u32 s31, s17, 63
s_add_u32 s32, s17, 64
s_mov_b32 s27, s20
v_mov_b32 v7, 0
s_add_u32 s68, s4, 413696
s_addc_u32 s69, s5, 0
s_add_u32 s72, s4, 397312
s_addc_u32 s73, s5, 0
s_add_u32 s70, s4, 417792
s_addc_u32 s71, s5, 0
s_add_u32 s74, s4, 401408
s_addc_u32 s75, s5, 0
s_add_u32 s58, s4, s20
s_addc_u32 s59, s5, 0
global_load_dwordx4 v[64:67], v0, s[76:77] offset:-4096 sc1
global_load_dwordx4 v[68:71], v0, s[76:77] offset:-3072 sc1
global_load_dwordx4 v[72:75], v0, s[76:77] offset:0 sc1
global_load_dwordx4 v[76:79], v0, s[76:77] offset:1024 sc1
global_load_dwordx4 v[80:83], v0, s[76:77] offset:2048 sc1
global_load_dwordx4 v[84:87], v0, s[76:77] offset:3072 sc1
global_load_dwordx4 v[56:59], v0, s[76:77] offset:-2048 sc1
global_load_dwordx4 v[60:63], v0, s[76:77] offset:-1024 sc1
global_load_dwordx4 v[24:27], v0, s[78:79] offset:-4096 sc1
global_load_dwordx4 v[28:31], v0, s[78:79] offset:-3072 sc1
v_mov_b64 v[8:9], 0
v_mov_b64 v[10:11], 0
v_mov_b64 v[12:13], 0
v_mov_b64 v[14:15], 0
v_mov_b64 v[16:17], 0
v_mov_b64 v[18:19], 0
v_mov_b64 v[20:21], 0
v_mov_b64 v[22:23], 0
v_cmp_gt_u32 vcc, s34, v7
s_cmp_eq_u32 vcc_hi, 0
s_cbranch_scc1 kv_10020
s_mov_b32 s30, 0
kv_10019:
v_and_b32 v7, 128, v0
buffer_load_dword v7, v7, s[4:7], s22 offen sc1
s_add_u32 s30, s30, 1
s_cmp_gt_u32 s30, 262144
s_cbranch_scc1 L_fail
s_waitcnt vmcnt(0)
v_cmp_gt_u32 vcc, s34, v7
s_cbranch_vccnz kv_10019
kv_10020:
s_barrier
global_load_dwordx4 v[48:51], v0, s[58:59] offset:0 nt sc1
global_load_dwordx4 v[52:55], v0, s[58:59] offset:1024 nt sc1
v_and_b32 v7, 255, v0
v_lshl_add_u32 v7, v7, 3, s27
global_load_dwordx4 v[32:35], v0, s[68:69] offset:-4096 sc1
global_load_dwordx4 v[36:39], v0, s[68:69] offset:0 sc1
global_load_dwordx4 v[40:43], v0, s[70:71] offset:0 sc1
s_mov_b32 s30, 0
s_waitcnt vmcnt(0)
.p2align 6
gather_10010:
s_waitcnt vmcnt(6)
rt_10015_b:
v_smfmac_f32_16x16x64_bf16 v[12:15], v[32:35], v[56:63], v1
ds_write_b128 v0, v[32:35] offset:0
v_smfmac_f32_16x16x64_bf16 v[20:23], v[32:35], v[72:79], v1
v_bitop3_b32 v44, v32, v34, s18 bitop3:0x7e
v_smfmac_f32_16x16x64_bf16 v[8:11], v[32:35], v[64:71], v1
s_waitcnt vmcnt(5)
ds_write_b128 v0, v[36:39] offset:4096
v_bitop3_b32 v45, v36, v38, s18 bitop3:0x7e
v_or_b32 v44, v44, v45
s_waitcnt vmcnt(4)
v_bitop3_b32 v45, v40, v42, s18 bitop3:0x7e
v_smfmac_f32_16x16x64_bf16 v[8:11], v[36:39], v[80:87], v1
ds_write_b128 v0, v[40:43] offset:8192
v_bitop3_b32 v44, v44, v45, s19 bitop3:0xa8
v_cmp_ne_u32 vcc, 0, v44
v_smfmac_f32_16x16x64_bf16 v[20:23], v[36:39], a[24:31], v1
s_cbranch_vccnz rt_10015
ds_read_b128 v[76:79], v2 offset:1024
global_load_dwordx4 v[64:67], v0, s[78:79] offset:-2048 sc1
ds_read_b128 v[72:75], v2 offset:0
global_load_dwordx4 v[68:71], v0, s[78:79] offset:-1024 sc1
ds_read_b128 v[84:87], v2 offset:5120
s_waitcnt lgkmcnt(3)
s_barrier
ds_read_b128 v[40:43], v0 offset:1024
v_smfmac_f32_16x16x64_bf16 v[16:19], v[32:35], a[0:7], v1
ds_read_b128 v[44:47], v0 offset:5120
global_load_dwordx4 v[56:59], v0, s[58:59] offset:2048 nt sc1
ds_read_b128 v[32:35], v0 offset:2048
v_smfmac_f32_16x16x64_bf16 v[12:15], v[36:39], a[8:15], v1
s_mov_b32 s30, 0
ds_read_b128 v[80:83], v2 offset:4096
v_smfmac_f32_16x16x64_bf16 v[16:19], v[36:39], a[16:23], v1
s_waitcnt lgkmcnt(5)
ds_read_b128 v[36:39], v0 offset:6144
global_load_dwordx4 v[60:63], v0, s[58:59] offset:3072 nt sc1
s_waitcnt lgkmcnt(4)
v_smfmac_f32_16x16x64_bf16 v[8:11], v[40:43], v[72:79], v1
ds_read_b128 v[72:75], v2 offset:2048
v_smfmac_f32_16x16x64_bf16 v[12:15], v[40:43], a[32:39], v1
s_waitcnt lgkmcnt(4)
ds_read_b128 v[40:43], v0 offset:3072
v_smfmac_f32_16x16x64_bf16 v[8:11], v[44:47], a[40:47], v1
s_waitcnt lgkmcnt(4)
ds_read_b128 v[76:79], v2 offset:3072
s_waitcnt vmcnt(6)
v_smfmac_f32_16x16x64_bf16 v[12:15], v[44:47], v[24:31], v1
ds_read_b128 v[28:31], v2 offset:7168
v_smfmac_f32_16x16x64_bf16 v[12:15], v[32:35], a[56:63], v1
s_mov_b32 s19, 1
ds_read_b128 v[24:27], v2 offset:6144
v_smfmac_f32_16x16x64_bf16 v[8:11], v[32:35], a[48:55], v1
s_waitcnt lgkmcnt(4)
ds_read_b128 v[44:47], v0 offset:7168
v_smfmac_f32_16x16x64_bf16 v[12:15], v[36:39], a[64:71], v1
ds_read_b128 v[32:35], v0 offset:8192
s_waitcnt lgkmcnt(4)
v_smfmac_f32_16x16x64_bf16 v[8:11], v[36:39], v[72:79], v1
ds_read_b128 v[36:39], v0 offset:9216
s_waitcnt lgkmcnt(4)
v_smfmac_f32_16x16x64_bf16 v[8:11], v[40:43], v[80:87], v1
ds_read_b128 v[84:87], v2 offset:9216
s_waitcnt lgkmcnt(4)
v_smfmac_f32_16x16x64_bf16 v[12:15], v[40:43], v[24:31], v1
ds_read_b128 v[80:83], v2 offset:8192
s_waitcnt lgkmcnt(4)
v_smfmac_f32_16x16x64_bf16 v[12:15], v[44:47], a[80:87], v1
ds_read_b128 v[76:79], v2 offset:11264
s_waitcnt lgkmcnt(4)
v_smfmac_f32_16x16x64_bf16 v[12:15], v[32:35], a[88:95], v1
ds_read_b128 v[72:75], v2 offset:10240
s_waitcnt lgkmcnt(4)
v_smfmac_f32_16x16x64_bf16 v[8:11], v[44:47], a[72:79], v1
ds_read_b128 v[40:43], v0 offset:1024
global_load_dword v7, v7, s[4:5] sc1
ds_read_b128 v[28:31], v2 offset:13312
s_waitcnt lgkmcnt(4)
v_smfmac_f32_16x16x64_bf16 v[8:11], v[32:35], v[80:87], v1
s_waitcnt vmcnt(3)
ds_read_b128 v[24:27], v2 offset:12288
v_smfmac_f32_16x16x64_bf16 v[8:11], v[36:39], a[96:103], v1
s_nop 0
ds_read_b128 v[32:35], v0 offset:5120
s_waitcnt lgkmcnt(4)
v_smfmac_f32_16x16x64_bf16 v[12:15], v[36:39], v[72:79], v1
s_nop 0
ds_read_b128 v[36:39], v0 offset:2048
s_waitcnt lgkmcnt(4)
ds_read_b128 v[72:75], v2 offset:16384
v_add_f32 v9, v9, v11
v_smfmac_f32_16x16x64_bf16 v[16:19], v[40:43], a[104:111], v1
s_xor_b32 s18, s18, 1
ds_read_b128 v[76:79], v2 offset:17408
v_add_f32 v8, v8, v10
v_smfmac_f32_16x16x64_bf16 v[20:23], v[40:43], a[112:119], v1
s_waitcnt lgkmcnt(5)
ds_read_b128 v[40:43], v0 offset:6144
v_add_f32 v12, v12, v14
v_mul_f32 v9, s35, v9
s_waitcnt lgkmcnt(4)
v_smfmac_f32_16x16x64_bf16 v[16:19], v[32:35], v[24:31], v1
ds_read_b128 v[84:87], v2 offset:15360
v_mul_f32 v8, s35, v8
v_cvt_pk_bf16_f32 v8, v8, v9
v_smfmac_f32_16x16x64_bf16 v[20:23], v[32:35], v[64:71], v1
s_waitcnt lgkmcnt(4)
ds_read_b128 v[80:83], v2 offset:14336
v_add_f32 v13, v13, v15
v_smfmac_f32_16x16x64_bf16 v[20:23], v[36:39], a[128:135], v1
ds_read_b128 v[32:35], v0 offset:3072
v_mul_f32 v12, s35, v12
v_mul_f32 v13, s35, v13
v_smfmac_f32_16x16x64_bf16 v[16:19], v[36:39], a[120:127], v1
s_waitcnt lgkmcnt(3)
ds_read_b128 v[36:39], v0 offset:7168
v_cvt_pk_bf16_f32 v12, v12, v13
v_smfmac_f32_16x16x64_bf16 v[20:23], v[40:43], a[144:151], v1
ds_write2_b32 v3, v8, v12 offset0:0 offset1:128
v_mov_b64 v[26:27], 0
v_smfmac_f32_16x16x64_bf16 v[16:19], v[40:43], a[136:143], v1
s_waitcnt lgkmcnt(2)
ds_read_b128 v[40:43], v0 offset:8192
v_smfmac_f32_16x16x64_bf16 v[16:19], v[32:35], a[152:159], v1
s_mov_b64 vcc, s[42:43]
ds_read_b128 v[68:71], v2 offset:19456
v_mov_b64 v[30:31], 0
v_smfmac_f32_16x16x64_bf16 v[20:23], v[32:35], a[160:167], v1
s_waitcnt lgkmcnt(3)
ds_read_b128 v[32:35], v0 offset:9216
v_mov_b64 v[24:25], 0
v_smfmac_f32_16x16x64_bf16 v[20:23], v[36:39], v[80:87], v1
s_add_u32 s20, s20, 524288
ds_read_b128 v[64:67], v2 offset:18432
v_mov_b64 v[28:29], 0
v_smfmac_f32_16x16x64_bf16 v[16:19], v[36:39], a[168:175], v1
ds_read_b128 v[36:39], v0 offset:8192
s_waitcnt lgkmcnt(4)
v_smfmac_f32_16x16x64_bf16 v[20:23], v[40:43], v[72:79], v1
s_barrier
ds_read_b64_tr_b16 v[8:9], v4 offset:0
v_smfmac_f32_16x16x64_bf16 v[16:19], v[40:43], a[176:183], v1
s_waitcnt lgkmcnt(3)
ds_read_b64_tr_b16 v[14:15], v4 offset:1536
ds_read_b64_tr_b16 v[10:11], v4 offset:512
v_smfmac_f32_16x16x64_bf16 v[16:19], v[32:35], a[184:191], v1
s_nop 0
ds_read_b64_tr_b16 v[12:13], v4 offset:1024
ds_read_b128 v[40:43], v0 offset:9216
v_smfmac_f32_16x16x64_bf16 v[20:23], v[32:35], a[192:199], v1
s_add_u32 s17, s17, 1
ds_read_b128 v[72:75], v2 offset:20480
s_waitcnt lgkmcnt(6)
ds_read_b128 v[80:83], v0 offset:16384
v_add_f32 v17, v17, v19
v_add_f32 v16, v16, v18
v_cvt_pk_bf16_f32 v16, v16, v17
v_smfmac_f32_16x16x64_bf16 v[24:27], v[36:39], a[200:207], v1
s_waitcnt lgkmcnt(6)
ds_read_b128 v[76:79], v2 offset:21504
s_waitcnt lgkmcnt(5)
v_mfma_f32_16x16x32_bf16 v[44:47], v[48:51], v[8:11], 0
s_waitcnt lgkmcnt(4)
ds_read_b128 v[84:87], v0 offset:17408
v_add_f32 v21, v21, v23
v_mfma_f32_16x16x32_bf16 v[44:47], v[52:55], v[12:15], v[44:47]
ds_read_b128 v[32:35], v0 offset:0
v_bfe_u32 v48, v0, 5, 1
v_add_f32 v20, v20, v22
v_cvt_pk_bf16_f32 v20, v20, v21
v_smfmac_f32_16x16x64_bf16 v[28:31], v[36:39], a[208:215], v1
s_waitcnt lgkmcnt(5)
ds_write2_b32 v3, v16, v20 offset0:1 offset1:129
v_lshl_add_u32 v48, v48, 3, v5
v_cndmask_b32_dpp v45, v47, v45, vcc quad_perm:[0,1,0,1] row_mask:0xf bank_mask:0xf
v_smfmac_f32_16x16x64_bf16 v[24:27], v[40:43], v[64:71], v1
s_add_u32 s21, s21, 10240
ds_read_b128 v[36:39], v0 offset:4096
v_cndmask_b32_dpp v44, v46, v44, vcc quad_perm:[0,1,0,1] row_mask:0xf bank_mask:0xf
v_smfmac_f32_16x16x64_bf16 v[28:31], v[40:43], a[216:223], v1
s_waitcnt lgkmcnt(2)
ds_write_b64 v48, v[44:45] offset:6144
v_smfmac_f32_16x16x64_bf16 v[24:27], v[32:35], v[72:79], v1
global_load_dwordx4 v[64:67], v0, s[78:79] offset:0 sc1
ds_read_b128 v[72:75], v2 offset:22528
v_smfmac_f32_16x16x64_bf16 v[28:31], v[32:35], a[224:231], v1
ds_read_b128 v[40:43], v0 offset:1024
s_waitcnt lgkmcnt(3)
v_smfmac_f32_16x16x64_bf16 v[28:31], v[36:39], a[240:247], v1
ds_read_b128 v[76:79], v2 offset:23552
global_load_dwordx4 v[68:71], v0, s[78:79] offset:1024 sc1
ds_read_b128 v[32:35], v0 offset:5120
v_smfmac_f32_16x16x64_bf16 v[24:27], v[36:39], a[232:239], v1
s_waitcnt lgkmcnt(4)
ds_read_b128 v[36:39], v0 offset:2048
s_barrier
ds_read_b128 v[48:51], v6 offset:6144
s_waitcnt lgkmcnt(4)
v_smfmac_f32_16x16x64_bf16 v[28:31], v[40:43], v[80:87], v1
s_add_u32 s34, s17, 2
ds_read_b64_tr_b16 v[22:23], v4 offset:3584
s_waitcnt lgkmcnt(4)
ds_read_b128 v[52:55], v6 offset:7168
v_smfmac_f32_16x16x64_bf16 v[24:27], v[40:43], v[72:79], v1
ds_read_b128 v[40:43], v0 offset:6144
s_waitcnt lgkmcnt(5)
ds_read_b64_tr_b16 v[8:9], v4 offset:0
v_smfmac_f32_16x16x64_bf16 v[24:27], v[32:35], a[248:255], v1
s_waitcnt lgkmcnt(5)
ds_read_b64_tr_b16 v[16:17], v4 offset:2048
global_load_dwordx4 v[72:75], v0, s[78:79] offset:2048 sc1
ds_read_b64_tr_b16 v[18:19], v4 offset:2560
v_smfmac_f32_16x16x64_bf16 v[28:31], v[32:35], v[88:95], v1
global_load_dwordx4 v[76:79], v0, s[78:79] offset:3072 sc1
ds_read_b128 v[32:35], v0 offset:3072
v_smfmac_f32_16x16x64_bf16 v[24:27], v[36:39], v[96:103], v1
s_waitcnt lgkmcnt(5)
ds_read_b64_tr_b16 v[10:11], v4 offset:512
v_add_f32 v49, v49, v53
v_smfmac_f32_16x16x64_bf16 v[28:31], v[36:39], v[104:111], v1
s_waitcnt lgkmcnt(5)
ds_read_b64_tr_b16 v[12:13], v4 offset:1024
v_add_f32 v48, v48, v52
v_add_f32 v50, v50, v54
v_smfmac_f32_16x16x64_bf16 v[24:27], v[40:43], v[112:119], v1
ds_read_b128 v[36:39], v0 offset:7168
v_exp_f32 v49, v49
v_smfmac_f32_16x16x64_bf16 v[28:31], v[40:43], v[120:127], v1
s_waitcnt lgkmcnt(3)
ds_read_b64_tr_b16 v[14:15], v4 offset:1536
v_add_f32 v51, v51, v55
v_smfmac_f32_16x16x64_bf16 v[28:31], v[32:35], v[136:143], v1
s_waitcnt lgkmcnt(3)
ds_read_b64_tr_b16 v[20:21], v4 offset:3072
v_exp_f32 v51, v51
v_mfma_f32_16x16x32_bf16 v[44:47], v[8:11], v[8:11], 0
v_exp_f32 v48, v48
v_exp_f32 v50, v50
v_smfmac_f32_16x16x64_bf16 v[24:27], v[32:35], v[128:135], v1
s_waitcnt lgkmcnt(1)
s_min_u32 s34, s34, s32
v_cvt_pk_bf16_f32 v55, v50, v51
v_mfma_f32_16x16x32_bf16 v[44:47], v[12:15], v[12:15], v[44:47]
s_nop 0
v_mov_b32_dpp v51, v55 quad_perm:[2,3,2,3] row_mask:0xf bank_mask:0xf
v_cvt_pk_bf16_f32 v54, v48, v49
v_mfma_f32_16x16x32_bf16 v[44:47], v[16:19], v[16:19], v[44:47]
s_waitcnt lgkmcnt(0)
v_mov_b32_dpp v48, v54 quad_perm:[0,1,0,1] row_mask:0xf bank_mask:0xf
v_mov_b32_dpp v49, v55 quad_perm:[0,1,0,1] row_mask:0xf bank_mask:0xf
v_mov_b32_dpp v50, v54 quad_perm:[2,3,2,3] row_mask:0xf bank_mask:0xf
v_mfma_f32_16x16x32_bf16 v[44:47], v[20:23], v[20:23], v[44:47]
s_add_u32 s27, s20, 524288
v_mov_b64 v[20:21], s[44:45]
v_mov_b64 v[22:23], s[44:45]
v_smfmac_f32_16x16x64_bf16 v[24:27], v[36:39], v[144:151], v1
s_waitcnt vmcnt(5)
global_load_dwordx4 v[80:83], v0, s[80:81] offset:-4096 sc1
v_mfma_f32_16x16x32_bf16 v[16:19], v[20:23], v[48:51], 0
s_nop 0
v_exp_f32_dpp v44, v46 quad_perm:[0,1,0,1] row_mask:0xf bank_mask:0xf
v_mfma_f32_16x16x32_bf16 v[8:11], v[56:59], v[48:51], 0
v_exp_f32_dpp v45, v47 quad_perm:[0,1,0,1] row_mask:0xf bank_mask:0xf
v_mov_b64 v[54:55], s[46:47]
v_smfmac_f32_16x16x64_bf16 v[28:31], v[36:39], v[152:159], v1
global_load_dwordx4 v[84:87], v0, s[80:81] offset:-3072 sc1
v_cvt_pk_bf16_f32 v52, v44, v45
v_mfma_f32_16x16x32_bf16 v[12:15], v[60:63], v[48:51], 0
v_cvt_pk_bf16_f32 v53, v44, v45
v_cvt_pk_bf16_f32 v24, v24, v25
v_cvt_pk_bf16_f32 v25, v26, v27
v_mfma_f32_16x16x16_bf16 v[16:19], v[54:55], v[52:53], v[16:19]
s_nop 0
v_cvt_pk_bf16_f32 v27, v30, v31
v_cvt_pk_bf16_f32 v26, v28, v29
v_mfma_f32_16x16x16_bf16 v[8:11], v[24:25], v[52:53], v[8:11]
v_bfe_u32 v32, v0, 5, 1
v_mov_b64 v[38:39], 0
v_mfma_f32_16x16x16_bf16 v[12:15], v[26:27], v[52:53], v[12:15]
s_nop 0
v_mov_b64 v[42:43], 0
v_rcp_f32 v18, v16
v_mov_b64 v[36:37], 0
v_lshl_add_u32 v32, v32, 3, v5
v_subrev_u32 v17, s37, v16
v_mov_b64 v[40:41], 0
v_cmp_lt_u32 vcc, s38, v17
v_cndmask_b32 v9, v13, v9, s[42:43]
v_cndmask_b32 v11, v15, v11, s[42:43]
v_mul_f32 v11, v11, v18
v_cndmask_b32 v10, v14, v10, s[42:43]
v_mul_f32 v10, v10, v18
v_cndmask_b32 v8, v12, v8, s[42:43]
v_mul_f32 v9, v9, v18
v_mul_f32 v8, v8, v18
v_cvt_pk_bf16_f32 v12, v8, v9
v_cvt_pk_bf16_f32 v13, v10, v11
s_cbranch_vccnz rare_10011
back_10012:
ds_write_b64 v32, v[12:13] offset:0
v_mov_b32_dpp v10, v12 quad_perm:[2,3,2,3] row_mask:0xf bank_mask:0xf
v_mov_b32_dpp v8, v12 quad_perm:[0,1,0,1] row_mask:0xf bank_mask:0xf
v_mov_b32_dpp v9, v13 quad_perm:[0,1,0,1] row_mask:0xf bank_mask:0xf
v_mov_b32_dpp v11, v13 quad_perm:[2,3,2,3] row_mask:0xf bank_mask:0xf
v_mov_b64 v[52:53], 0
s_waitcnt vmcnt(4)
v_smfmac_f32_16x16x64_bf16 v[40:43], v[8:11], v[64:71], v1
s_mov_b64 s[70:71], s[74:75]
ds_read_b128 v[16:19], v0 offset:18432
global_load_dwordx4 v[64:67], v0, s[76:77] offset:-4096 sc1
ds_read_b128 v[28:31], v0 offset:21504
v_mov_b64 v[54:55], 0
v_mov_b64 v[48:49], 0
v_mov_b64 v[32:33], 0
v_smfmac_f32_16x16x64_bf16 v[52:55], v[8:11], v[176:183], v1
s_waitcnt lgkmcnt(2)
ds_read_b128 v[24:27], v0 offset:20480
global_load_dwordx4 v[68:71], v0, s[76:77] offset:-3072 sc1
ds_read_b128 v[20:23], v0 offset:19456
s_barrier
ds_read_b128 v[56:59], v5 offset:512
v_mov_b64 v[50:51], 0
v_smfmac_f32_16x16x64_bf16 v[36:39], v[8:11], v[160:167], v1
s_waitcnt vmcnt(5)
ds_read_b128 v[60:63], v5 offset:1024
v_mov_b64 v[34:35], 0
v_smfmac_f32_16x16x64_bf16 v[48:51], v[8:11], v[168:175], v1
ds_read_b128 v[12:15], v5 offset:1536
v_bfe_u32 v45, v0, 1, 7
v_lshrrev_b32 v44, 8, v0
s_waitcnt vmcnt(4)
v_smfmac_f32_16x16x64_bf16 v[32:35], v[8:11], v[72:79], v1
global_load_dwordx4 v[72:75], v0, s[76:77] offset:0 sc1
s_waitcnt lgkmcnt(2)
v_smfmac_f32_16x16x64_bf16 v[36:39], v[56:59], v[184:191], v1
global_load_dwordx4 v[76:79], v0, s[76:77] offset:1024 sc1
s_waitcnt lgkmcnt(1)
v_smfmac_f32_16x16x64_bf16 v[36:39], v[60:63], v[16:23], v1
s_waitcnt lgkmcnt(0)
v_lshl_or_b32 v44, v44, 12, v45
v_smfmac_f32_16x16x64_bf16 v[36:39], v[12:15], v[24:31], v1
s_mov_b64 s[68:69], s[72:73]
ds_read_b128 v[24:27], v0 offset:22528
v_smfmac_f32_16x16x64_bf16 v[40:43], v[56:59], v[192:199], v1
ds_read_b128 v[28:31], v0 offset:23552
s_nop 0
v_smfmac_f32_16x16x64_bf16 v[32:35], v[56:59], v[240:247], v1
s_waitcnt vmcnt(5)
ds_read_b128 v[20:23], v0 offset:25600
v_cvt_pk_bf16_f32 v36, v36, v37
v_smfmac_f32_16x16x64_bf16 v[48:51], v[56:59], v[200:207], v1
ds_read_b128 v[16:19], v0 offset:24576
v_and_or_b32 v36, v36, -2, s18
v_cvt_pk_bf16_f32 v37, v38, v39
s_waitcnt vmcnt(4)
v_smfmac_f32_16x16x64_bf16 v[40:43], v[60:63], v[80:87], v1
global_store_dwordx2 v44, v[36:37], s[48:49]
s_waitcnt lgkmcnt(2)
v_smfmac_f32_16x16x64_bf16 v[40:43], v[12:15], v[24:31], v1
s_add_u32 s58, s4, s20
ds_read_b128 v[28:31], v0 offset:27648
v_smfmac_f32_16x16x64_bf16 v[48:51], v[60:63], v[208:215], v1
s_waitcnt lgkmcnt(2)
s_waitcnt lgkmcnt(1)
v_smfmac_f32_16x16x64_bf16 v[48:51], v[12:15], v[16:23], v1
s_nop 1
v_cvt_pk_bf16_f32 v40, v40, v41
v_cvt_pk_bf16_f32 v41, v42, v43
v_and_or_b32 v40, v40, -2, s18
v_smfmac_f32_16x16x64_bf16 v[52:55], v[56:59], v[216:223], v1
global_store_dwordx2 v44, v[40:41], s[50:51]
v_smfmac_f32_16x16x64_bf16 v[52:55], v[60:63], v[224:231], v1
s_addc_u32 s59, s5, 0
ds_read_b128 v[24:27], v0 offset:26624
v_cvt_pk_bf16_f32 v48, v48, v49
v_cvt_pk_bf16_f32 v49, v50, v51
v_and_or_b32 v48, v48, -2, s18
v_smfmac_f32_16x16x64_bf16 v[52:55], v[12:15], v[232:239], v1
global_store_dwordx2 v44, v[48:49], s[52:53]
v_smfmac_f32_16x16x64_bf16 v[32:35], v[60:63], v[248:255], v1
s_nop 1
s_waitcnt lgkmcnt(0)
v_smfmac_f32_16x16x64_bf16 v[32:35], v[12:15], v[24:31], v1
s_nop 1
v_cvt_pk_bf16_f32 v52, v52, v53
v_and_or_b32 v52, v52, -2, s18
v_cvt_pk_bf16_f32 v53, v54, v55
s_nop 0
global_store_dwordx2 v44, v[52:53], s[54:55]
s_nop 0
v_cvt_pk_bf16_f32 v32, v32, v33
v_cvt_pk_bf16_f32 v33, v34, v35
v_and_or_b32 v32, v32, -2, s18
global_store_dwordx2 v44, v[32:33], s[56:57]
v_bfe_u32 v32, v0, 6, 1
v_lshlrev_b32 v32, 4, v32
v_mov_b32 v33, 0x3f80
v_lshlrev_b32 v32, v32, v33
v_bfe_i32 v33, v0, 4, 1
v_and_b32 v45, v32, v33
v_and_b32 v47, v32, v33
v_xor_b32 v44, v32, v45
v_xor_b32 v46, v32, v45
v_and_b32 v36, 32, v0
v_bfe_u32 v37, v0, 6, 1
v_lshl_add_u32 v36, v37, 8, v36
v_bfe_u32 v37, v0, 8, 1
v_lshl_add_u32 v36, v37, 4, v36
v_bfe_u32 v37, v0, 4, 1
v_lshl_add_u32 v36, v37, 3, v36
v_and_b32 v7, 255, v0
v_lshl_add_u32 v7, v7, 3, s27
s_nop 15
s_nop 15
s_nop 15
s_nop 8
global_load_dwordx4 v[8:11], v0, s[64:65] offset:0 sc1
global_load_dwordx4 v[12:15], v0, s[64:65] offset:1024 sc1
global_load_dwordx4 v[16:19], v0, s[64:65] offset:2048 sc1
global_load_dwordx4 v[20:23], v0, s[64:65] offset:3072 sc1
chk_10023:
v_mov_b64 v[40:41], 0
v_mov_b64 v[42:43], 0
s_waitcnt vmcnt(2)
s_nop 0
v_smfmac_f32_16x16x64_bf16 v[40:43], v[44:47], v[8:15], v1
v_bitop3_b32 v32, v8, v10, s18 bitop3:0x7e
v_bitop3_b32 v33, v12, v14, s18 bitop3:0x7e
s_waitcnt vmcnt(0)
v_smfmac_f32_16x16x64_bf16 v[40:43], v[44:47], v[16:23], v1
v_bitop3_b32 v34, v16, v18, s18 bitop3:0x7e
v_bitop3_b32 v35, v20, v22, s18 bitop3:0x7e
v_or3_b32 v37, v32, v33, v34
v_bitop3_b32 v37, v37, v35, 1 bitop3:0xa8
v_cmp_ne_u32 vcc, 0, v37
s_cbranch_vccnz chk_10023_f
s_nop 1
v_add_f32_dpp v40, v40, v40 row_ror:8 row_mask:0xf bank_mask:0xf
v_add_f32_dpp v41, v41, v41 row_ror:8 row_mask:0xf bank_mask:0xf
v_add_f32_dpp v42, v42, v42 row_ror:8 row_mask:0xf bank_mask:0xf
v_add_f32_dpp v43, v43, v43 row_ror:8 row_mask:0xf bank_mask:0xf
v_cvt_pk_bf16_f32 v40, v40, v41
v_cvt_pk_bf16_f32 v41, v42, v43
v_and_or_b32 v40, v40, -2, s18
s_mov_b64 exec, 0x00ff00ff
global_store_dwordx2 v36, v[40:41], s[66:67]
s_mov_b64 exec, -1
s_branch join_10022
chk_10023_f:
global_load_dwordx4 v[8:11], v0, s[64:65] offset:0 sc1
global_load_dwordx4 v[12:15], v0, s[64:65] offset:1024 sc1
global_load_dwordx4 v[16:19], v0, s[64:65] offset:2048 sc1
global_load_dwordx4 v[20:23], v0, s[64:65] offset:3072 sc1
s_add_u32 s30, s30, 1
s_cmp_le_u32 s30, 262144
s_cbranch_scc1 chk_10023
s_branch L_fail
nored_10021:
join_10022:
s_nop 11
s_barrier
global_load_dwordx4 v[56:59], v0, s[76:77] offset:-2048 sc1
global_load_dwordx4 v[60:63], v0, s[76:77] offset:-1024 sc1
global_load_dwordx4 v[80:83], v0, s[76:77] offset:2048 sc1
global_load_dwordx4 v[84:87], v0, s[76:77] offset:3072 sc1
s_nop 15
s_nop 15
s_nop 3
s_barrier
global_load_dwordx4 v[32:35], v0, s[68:69] offset:-4096 sc1
s_nop 10
global_load_dwordx4 v[36:39], v0, s[68:69] offset:0 sc1
s_nop 10
global_load_dwordx4 v[40:43], v0, s[70:71] offset:0 sc1
s_barrier
global_load_dwordx4 v[24:27], v0, s[78:79] offset:-4096 sc1
global_load_dwordx4 v[28:31], v0, s[78:79] offset:-3072 sc1
global_load_dwordx4 v[48:51], v0, s[58:59] offset:0 nt sc1
global_load_dwordx4 v[52:55], v0, s[58:59] offset:1024 nt sc1
v_mov_b64 v[8:9], 0
v_mov_b64 v[10:11], 0
v_mov_b64 v[12:13], 0
v_mov_b64 v[14:15], 0
v_mov_b64 v[16:17], 0
v_mov_b64 v[18:19], 0
v_mov_b64 v[20:21], 0
v_mov_b64 v[22:23], 0
s_mov_b32 s30, 0
s_cmp_eq_u32 s17, s31
s_cbranch_scc0 gather_10010
s_branch exit_10013
rt_10015:
global_load_dwordx4 v[32:35], v0, s[68:69] offset:-4096 sc1
global_load_dwordx4 v[36:39], v0, s[68:69] offset:0 sc1
global_load_dwordx4 v[40:43], v0, s[70:71] offset:0 sc1
s_add_u32 s30, s30, 1
s_cmp_gt_u32 s30, 262144
s_cbranch_scc1 L_fail
s_mov_b64 exec, 1
global_store_dword v0, v0, s[62:63]
global_store_dword v0, v0, s[62:63]
global_store_dword v0, v0, s[62:63]
global_store_dword v0, v0, s[62:63]
s_mov_b64 exec, -1
v_mov_b64 v[8:9], 0
v_mov_b64 v[10:11], 0
v_mov_b64 v[12:13], 0
v_mov_b64 v[14:15], 0
v_mov_b64 v[16:17], 0
v_mov_b64 v[18:19], 0
v_mov_b64 v[20:21], 0
v_mov_b64 v[22:23], 0
s_branch gather_10010
rare_10011:
ds_read_b128 v[48:51], v6 offset:6144
ds_read_b128 v[52:55], v6 offset:7168
s_waitcnt lgkmcnt(0)
v_add_f32 v48, v48, v52
v_add_f32 v49, v49, v53
v_add_f32 v50, v50, v54
v_add_f32 v51, v51, v55
v_mov_b32_dpp v46, v46 quad_perm:[0,1,0,1] row_mask:0xf bank_mask:0xf
v_mov_b32_dpp v47, v47 quad_perm:[0,1,0,1] row_mask:0xf bank_mask:0xf
v_max3_f32 v19, v48, v49, v50
v_max3_f32 v19, v19, v51, v46
v_max_f32 v19, v19, v47
s_nop 1
v_max_f32_dpp v19, v19, v19 quad_perm:[2,3,0,1] row_mask:0xf bank_mask:0xf
v_mov_b32 v44, v19
s_nop 1
v_permlane32_swap_b32 v19, v44
v_max_f32 v19, v19, v44
v_mov_b32 v44, v19
s_nop 1
v_permlane16_swap_b32 v19, v44
v_max_f32 v19, v19, v44
v_sub_f32 v48, v48, v19
v_sub_f32 v49, v49, v19
v_sub_f32 v50, v50, v19
v_sub_f32 v51, v51, v19
v_sub_f32 v46, v46, v19
v_sub_f32 v47, v47, v19
v_exp_f32 v48, v48
v_exp_f32 v49, v49
v_exp_f32 v50, v50
v_exp_f32 v51, v51
v_cvt_pk_bf16_f32 v54, v48, v49
v_cvt_pk_bf16_f32 v55, v50, v51
s_nop 0
v_mov_b32_dpp v48, v54 quad_perm:[0,1,0,1] row_mask:0xf bank_mask:0xf
v_mov_b32_dpp v49, v55 quad_perm:[0,1,0,1] row_mask:0xf bank_mask:0xf
v_mov_b32_dpp v50, v54 quad_perm:[2,3,2,3] row_mask:0xf bank_mask:0xf
v_mov_b32_dpp v51, v55 quad_perm:[2,3,2,3] row_mask:0xf bank_mask:0xf
v_mov_b64 v[20:21], s[44:45]
v_mov_b64 v[22:23], s[44:45]
v_mfma_f32_16x16x32_bf16 v[8:11], v[56:59], v[48:51], 0
v_mfma_f32_16x16x32_bf16 v[12:15], v[60:63], v[48:51], 0
v_mfma_f32_16x16x32_bf16 v[16:19], v[20:23], v[48:51], 0
v_mov_b64 v[54:55], s[46:47]
v_exp_f32_dpp v44, v46 quad_perm:[0,1,0,1] row_mask:0xf bank_mask:0xf
v_exp_f32_dpp v45, v47 quad_perm:[0,1,0,1] row_mask:0xf bank_mask:0xf
s_nop 0
v_cvt_pk_bf16_f32 v52, v44, v45
v_cvt_pk_bf16_f32 v53, v44, v45
s_nop 1
v_mfma_f32_16x16x16_bf16 v[16:19], v[54:55], v[52:53], v[16:19]
v_mfma_f32_16x16x16_bf16 v[8:11], v[24:25], v[52:53], v[8:11]
v_mfma_f32_16x16x16_bf16 v[12:15], v[26:27], v[52:53], v[12:15]
s_nop 5
v_rcp_f32 v18, v16
s_nop 0
v_cndmask_b32 v8, v12, v8, s[42:43]
v_mul_f32 v8, v8, v18
v_cndmask_b32 v9, v13, v9, s[42:43]
v_mul_f32 v9, v9, v18
v_cndmask_b32 v10, v14, v10, s[42:43]
v_mul_f32 v10, v10, v18
v_cndmask_b32 v11, v15, v11, s[42:43]
v_mul_f32 v11, v11, v18
v_cvt_pk_bf16_f32 v12, v8, v9
v_cvt_pk_bf16_f32 v13, v10, v11
s_branch back_10012
exit_10013:
global_load_dwordx4 v[32:35], v0, s[68:69] offset:-4096 sc1
global_load_dwordx4 v[36:39], v0, s[68:69] offset:0 sc1
global_load_dwordx4 v[40:43], v0, s[70:71] offset:0 sc1
s_add_u32 s30, s30, 1
s_cmp_gt_u32 s30, 262144
s_cbranch_scc1 L_fail
s_waitcnt vmcnt(2)
v_bitop3_b32 v44, v32, v34, s18 bitop3:0x7e
s_waitcnt vmcnt(1)
v_bitop3_b32 v45, v36, v38, s18 bitop3:0x7e
v_or_b32 v44, v44, v45
s_waitcnt vmcnt(0)
v_bitop3_b32 v46, v40, v42, s18 bitop3:0x7e
v_bitop3_b32 v44, v44, v46, s19 bitop3:0xa8
v_cmp_ne_u32 vcc, 0, v44
s_cbranch_vccnz exit_10013
s_add_u32 s36, s36, 1
s_cmp_lt_u32 s36, 2
s_cbranch_scc1 layer_10009
s_endpgm
wave_10006:
layer_10024:
s_lshl_b32 s17, s36, 6
s_mul_i32 s27, s36, 35651584
s_mul_i32 s28, s14, 16384
s_add_u32 s27, s27, s28
s_add_u32 s20, s27, 16781312
s_mul_i32 s27, s17, 10240
s_add_u32 s27, s27, s24
s_add_u32 s21, s27, s25
s_mov_b32 s19, 0
s_mov_b32 s33, s6
s_add_u32 s34, s17, 1
s_add_u32 s31, s17, 63
s_add_u32 s32, s17, 64
s_mov_b32 s27, s20
v_mov_b32 v7, 0
s_add_u32 s68, s4, 414720
s_addc_u32 s69, s5, 0
s_add_u32 s72, s4, 398336
s_addc_u32 s73, s5, 0
s_add_u32 s70, s4, 418816
s_addc_u32 s71, s5, 0
s_add_u32 s74, s4, 402432
s_addc_u32 s75, s5, 0
s_add_u32 s58, s4, s20
s_addc_u32 s59, s5, 0
global_load_dwordx4 v[64:67], v0, s[76:77] offset:-4096 sc1
global_load_dwordx4 v[68:71], v0, s[76:77] offset:-3072 sc1
global_load_dwordx4 v[72:75], v0, s[76:77] offset:0 sc1
global_load_dwordx4 v[76:79], v0, s[76:77] offset:1024 sc1
global_load_dwordx4 v[80:83], v0, s[76:77] offset:2048 sc1
global_load_dwordx4 v[84:87], v0, s[76:77] offset:3072 sc1
global_load_dwordx4 v[56:59], v0, s[76:77] offset:-2048 sc1
global_load_dwordx4 v[60:63], v0, s[76:77] offset:-1024 sc1
global_load_dwordx4 v[24:27], v0, s[78:79] offset:-4096 sc1
global_load_dwordx4 v[28:31], v0, s[78:79] offset:-3072 sc1
v_mov_b64 v[8:9], 0
v_mov_b64 v[10:11], 0
v_mov_b64 v[12:13], 0
v_mov_b64 v[14:15], 0
v_mov_b64 v[16:17], 0
v_mov_b64 v[18:19], 0
v_mov_b64 v[20:21], 0
v_mov_b64 v[22:23], 0
s_barrier
global_load_dwordx4 v[48:51], v0, s[58:59] offset:0 nt sc1
global_load_dwordx4 v[52:55], v0, s[58:59] offset:1024 nt sc1
v_and_b32 v7, 255, v0
v_lshl_add_u32 v7, v7, 3, s27
global_load_dwordx4 v[32:35], v0, s[68:69] offset:-4096 sc1
global_load_dwordx4 v[36:39], v0, s[68:69] offset:0 sc1
global_load_dwordx4 v[40:43], v0, s[70:71] offset:0 sc1
s_mov_b32 s30, 0
s_waitcnt vmcnt(0)
.p2align 6
gather_10025:
s_waitcnt vmcnt(6)
rt_10030_b:
v_smfmac_f32_16x16x64_bf16 v[12:15], v[32:35], v[56:63], v1
ds_write_b128 v0, v[32:35] offset:1024
v_smfmac_f32_16x16x64_bf16 v[20:23], v[32:35], v[72:79], v1
v_bitop3_b32 v44, v32, v34, s18 bitop3:0x7e
v_smfmac_f32_16x16x64_bf16 v[8:11], v[32:35], v[64:71], v1
s_waitcnt vmcnt(5)
ds_write_b128 v0, v[36:39] offset:5120
v_bitop3_b32 v45, v36, v38, s18 bitop3:0x7e
v_or_b32 v44, v44, v45
s_waitcnt vmcnt(4)
v_bitop3_b32 v45, v40, v42, s18 bitop3:0x7e
v_smfmac_f32_16x16x64_bf16 v[8:11], v[36:39], v[80:87], v1
ds_write_b128 v0, v[40:43] offset:9216
v_bitop3_b32 v44, v44, v45, s19 bitop3:0xa8
v_cmp_ne_u32 vcc, 0, v44
v_smfmac_f32_16x16x64_bf16 v[20:23], v[36:39], a[24:31], v1
s_cbranch_vccnz rt_10030
ds_read_b128 v[76:79], v2 offset:1024
global_load_dwordx4 v[64:67], v0, s[78:79] offset:-2048 sc1
ds_read_b128 v[72:75], v2 offset:0
global_load_dwordx4 v[68:71], v0, s[78:79] offset:-1024 sc1
ds_read_b128 v[84:87], v2 offset:5120
s_waitcnt lgkmcnt(3)
s_barrier
ds_read_b128 v[40:43], v0 offset:0
v_smfmac_f32_16x16x64_bf16 v[16:19], v[32:35], a[0:7], v1
ds_read_b128 v[44:47], v0 offset:4096
global_load_dwordx4 v[56:59], v0, s[58:59] offset:2048 nt sc1
ds_read_b128 v[32:35], v0 offset:3072
v_smfmac_f32_16x16x64_bf16 v[12:15], v[36:39], a[8:15], v1
s_mov_b32 s30, 0
ds_read_b128 v[80:83], v2 offset:4096
v_smfmac_f32_16x16x64_bf16 v[16:19], v[36:39], a[16:23], v1
s_waitcnt lgkmcnt(5)
ds_read_b128 v[36:39], v0 offset:7168
global_load_dwordx4 v[60:63], v0, s[58:59] offset:3072 nt sc1
s_waitcnt lgkmcnt(4)
v_smfmac_f32_16x16x64_bf16 v[8:11], v[40:43], v[72:79], v1
ds_read_b128 v[72:75], v2 offset:2048
v_smfmac_f32_16x16x64_bf16 v[12:15], v[40:43], a[32:39], v1
s_waitcnt lgkmcnt(4)
ds_read_b128 v[40:43], v0 offset:2048
v_smfmac_f32_16x16x64_bf16 v[8:11], v[44:47], a[40:47], v1
s_waitcnt lgkmcnt(4)
ds_read_b128 v[76:79], v2 offset:3072
s_waitcnt vmcnt(6)
v_smfmac_f32_16x16x64_bf16 v[12:15], v[44:47], v[24:31], v1
ds_read_b128 v[28:31], v2 offset:7168
v_smfmac_f32_16x16x64_bf16 v[12:15], v[32:35], a[56:63], v1
s_mov_b32 s19, 1
ds_read_b128 v[24:27], v2 offset:6144
v_smfmac_f32_16x16x64_bf16 v[8:11], v[32:35], a[48:55], v1
s_waitcnt lgkmcnt(4)
ds_read_b128 v[44:47], v0 offset:6144
v_smfmac_f32_16x16x64_bf16 v[12:15], v[36:39], a[64:71], v1
ds_read_b128 v[32:35], v0 offset:9216
s_waitcnt lgkmcnt(4)
v_smfmac_f32_16x16x64_bf16 v[8:11], v[36:39], v[72:79], v1
ds_read_b128 v[36:39], v0 offset:8192
s_waitcnt lgkmcnt(4)
v_smfmac_f32_16x16x64_bf16 v[8:11], v[40:43], v[80:87], v1
ds_read_b128 v[84:87], v2 offset:9216
s_waitcnt lgkmcnt(4)
v_smfmac_f32_16x16x64_bf16 v[12:15], v[40:43], v[24:31], v1
ds_read_b128 v[80:83], v2 offset:8192
s_waitcnt lgkmcnt(4)
v_smfmac_f32_16x16x64_bf16 v[12:15], v[44:47], a[80:87], v1
ds_read_b128 v[76:79], v2 offset:11264
s_waitcnt lgkmcnt(4)
v_smfmac_f32_16x16x64_bf16 v[12:15], v[32:35], a[88:95], v1
ds_read_b128 v[72:75], v2 offset:10240
s_waitcnt lgkmcnt(4)
v_smfmac_f32_16x16x64_bf16 v[8:11], v[44:47], a[72:79], v1
ds_read_b128 v[40:43], v0 offset:0
global_load_dword v7, v7, s[4:5] sc1
ds_read_b128 v[28:31], v2 offset:13312
s_waitcnt lgkmcnt(4)
v_smfmac_f32_16x16x64_bf16 v[8:11], v[32:35], v[80:87], v1
s_waitcnt vmcnt(3)
ds_read_b128 v[24:27], v2 offset:12288
v_smfmac_f32_16x16x64_bf16 v[8:11], v[36:39], a[96:103], v1
s_nop 0
ds_read_b128 v[32:35], v0 offset:4096
s_waitcnt lgkmcnt(4)
v_smfmac_f32_16x16x64_bf16 v[12:15], v[36:39], v[72:79], v1
s_nop 0
ds_read_b128 v[36:39], v0 offset:3072
s_waitcnt lgkmcnt(4)
ds_read_b128 v[72:75], v2 offset:16384
v_add_f32 v9, v9, v11
v_smfmac_f32_16x16x64_bf16 v[16:19], v[40:43], a[104:111], v1
s_xor_b32 s18, s18, 1
ds_read_b128 v[76:79], v2 offset:17408
v_add_f32 v8, v8, v10
v_smfmac_f32_16x16x64_bf16 v[20:23], v[40:43], a[112:119], v1
s_waitcnt lgkmcnt(5)
ds_read_b128 v[40:43], v0 offset:7168
v_add_f32 v12, v12, v14
v_mul_f32 v9, s35, v9
s_waitcnt lgkmcnt(4)
v_smfmac_f32_16x16x64_bf16 v[16:19], v[32:35], v[24:31], v1
ds_read_b128 v[84:87], v2 offset:15360
v_mul_f32 v8, s35, v8
v_cvt_pk_bf16_f32 v8, v8, v9
v_smfmac_f32_16x16x64_bf16 v[20:23], v[32:35], v[64:71], v1
s_waitcnt lgkmcnt(4)
ds_read_b128 v[80:83], v2 offset:14336
v_add_f32 v13, v13, v15
v_smfmac_f32_16x16x64_bf16 v[20:23], v[36:39], a[128:135], v1
ds_read_b128 v[32:35], v0 offset:2048
v_mul_f32 v12, s35, v12
v_mul_f32 v13, s35, v13
v_smfmac_f32_16x16x64_bf16 v[16:19], v[36:39], a[120:127], v1
s_waitcnt lgkmcnt(3)
ds_read_b128 v[36:39], v0 offset:6144
v_cvt_pk_bf16_f32 v12, v12, v13
v_smfmac_f32_16x16x64_bf16 v[20:23], v[40:43], a[144:151], v1
ds_write2_b32 v3, v8, v12 offset0:0 offset1:128
v_mov_b64 v[26:27], 0
v_smfmac_f32_16x16x64_bf16 v[16:19], v[40:43], a[136:143], v1
s_waitcnt lgkmcnt(2)
ds_read_b128 v[40:43], v0 offset:9216
v_smfmac_f32_16x16x64_bf16 v[16:19], v[32:35], a[152:159], v1
s_mov_b64 vcc, s[42:43]
ds_read_b128 v[68:71], v2 offset:19456
v_mov_b64 v[30:31], 0
v_smfmac_f32_16x16x64_bf16 v[20:23], v[32:35], a[160:167], v1
s_waitcnt lgkmcnt(3)
ds_read_b128 v[32:35], v0 offset:8192
v_mov_b64 v[24:25], 0
v_smfmac_f32_16x16x64_bf16 v[20:23], v[36:39], v[80:87], v1
s_add_u32 s20, s20, 524288
ds_read_b128 v[64:67], v2 offset:18432
v_mov_b64 v[28:29], 0
v_smfmac_f32_16x16x64_bf16 v[16:19], v[36:39], a[168:175], v1
ds_read_b128 v[36:39], v0 offset:9216
s_waitcnt lgkmcnt(4)
v_smfmac_f32_16x16x64_bf16 v[20:23], v[40:43], v[72:79], v1
s_barrier
ds_read_b64_tr_b16 v[8:9], v4 offset:0
v_smfmac_f32_16x16x64_bf16 v[16:19], v[40:43], a[176:183], v1
s_waitcnt lgkmcnt(3)
ds_read_b64_tr_b16 v[14:15], v4 offset:1536
ds_read_b64_tr_b16 v[10:11], v4 offset:512
v_smfmac_f32_16x16x64_bf16 v[16:19], v[32:35], a[184:191], v1
s_nop 0
ds_read_b64_tr_b16 v[12:13], v4 offset:1024
ds_read_b128 v[40:43], v0 offset:8192
v_smfmac_f32_16x16x64_bf16 v[20:23], v[32:35], a[192:199], v1
s_add_u32 s17, s17, 1
ds_read_b128 v[72:75], v2 offset:20480
s_waitcnt lgkmcnt(6)
ds_read_b128 v[80:83], v0 offset:28672
v_add_f32 v17, v17, v19
v_add_f32 v16, v16, v18
v_cvt_pk_bf16_f32 v16, v16, v17
v_smfmac_f32_16x16x64_bf16 v[24:27], v[36:39], a[200:207], v1
s_waitcnt lgkmcnt(6)
ds_read_b128 v[76:79], v2 offset:21504
s_waitcnt lgkmcnt(5)
v_mfma_f32_16x16x32_bf16 v[44:47], v[48:51], v[8:11], 0
s_waitcnt lgkmcnt(4)
ds_read_b128 v[84:87], v0 offset:29696
v_add_f32 v21, v21, v23
v_mfma_f32_16x16x32_bf16 v[44:47], v[52:55], v[12:15], v[44:47]
ds_read_b128 v[32:35], v0 offset:1024
v_bfe_u32 v48, v0, 5, 1
v_add_f32 v20, v20, v22
v_cvt_pk_bf16_f32 v20, v20, v21
v_smfmac_f32_16x16x64_bf16 v[28:31], v[36:39], a[208:215], v1
s_waitcnt lgkmcnt(5)
ds_write2_b32 v3, v16, v20 offset0:1 offset1:129
v_lshl_add_u32 v48, v48, 3, v5
v_cndmask_b32_dpp v45, v47, v45, vcc quad_perm:[0,1,0,1] row_mask:0xf bank_mask:0xf
v_smfmac_f32_16x16x64_bf16 v[24:27], v[40:43], v[64:71], v1
s_add_u32 s21, s21, 10240
ds_read_b128 v[36:39], v0 offset:5120
v_cndmask_b32_dpp v44, v46, v44, vcc quad_perm:[0,1,0,1] row_mask:0xf bank_mask:0xf
v_xor_b32 v48, 128, v48
v_smfmac_f32_16x16x64_bf16 v[28:31], v[40:43], a[216:223], v1
s_waitcnt lgkmcnt(2)
ds_write_b64 v48, v[44:45] offset:6656
v_smfmac_f32_16x16x64_bf16 v[24:27], v[32:35], v[72:79], v1
global_load_dwordx4 v[64:67], v0, s[78:79] offset:0 sc1
ds_read_b128 v[72:75], v2 offset:22528
v_smfmac_f32_16x16x64_bf16 v[28:31], v[32:35], a[224:231], v1
ds_read_b128 v[40:43], v0 offset:0
s_waitcnt lgkmcnt(3)
v_smfmac_f32_16x16x64_bf16 v[28:31], v[36:39], a[240:247], v1
ds_read_b128 v[76:79], v2 offset:23552
global_load_dwordx4 v[68:71], v0, s[78:79] offset:1024 sc1
ds_read_b128 v[32:35], v0 offset:4096
v_smfmac_f32_16x16x64_bf16 v[24:27], v[36:39], a[232:239], v1
s_waitcnt lgkmcnt(4)
ds_read_b128 v[36:39], v0 offset:3072
s_barrier
ds_read_b128 v[48:51], v6 offset:6144
s_waitcnt lgkmcnt(4)
v_smfmac_f32_16x16x64_bf16 v[28:31], v[40:43], v[80:87], v1
s_add_u32 s34, s17, 2
ds_read_b64_tr_b16 v[22:23], v4 offset:3584
s_waitcnt lgkmcnt(4)
ds_read_b128 v[52:55], v6 offset:7168
v_smfmac_f32_16x16x64_bf16 v[24:27], v[40:43], v[72:79], v1
ds_read_b128 v[40:43], v0 offset:7168
s_waitcnt lgkmcnt(5)
ds_read_b64_tr_b16 v[8:9], v4 offset:0
v_smfmac_f32_16x16x64_bf16 v[24:27], v[32:35], a[248:255], v1
s_waitcnt lgkmcnt(5)
ds_read_b64_tr_b16 v[16:17], v4 offset:2048
global_load_dwordx4 v[72:75], v0, s[78:79] offset:2048 sc1
ds_read_b64_tr_b16 v[18:19], v4 offset:2560
v_smfmac_f32_16x16x64_bf16 v[28:31], v[32:35], v[88:95], v1
global_load_dwordx4 v[76:79], v0, s[78:79] offset:3072 sc1
ds_read_b128 v[32:35], v0 offset:2048
v_smfmac_f32_16x16x64_bf16 v[24:27], v[36:39], v[96:103], v1
s_waitcnt lgkmcnt(5)
ds_read_b64_tr_b16 v[10:11], v4 offset:512
v_add_f32 v49, v49, v53
v_smfmac_f32_16x16x64_bf16 v[28:31], v[36:39], v[104:111], v1
s_waitcnt lgkmcnt(5)
ds_read_b64_tr_b16 v[12:13], v4 offset:1024
v_add_f32 v48, v48, v52
v_add_f32 v50, v50, v54
v_smfmac_f32_16x16x64_bf16 v[24:27], v[40:43], v[112:119], v1
ds_read_b128 v[36:39], v0 offset:6144
v_exp_f32 v49, v49
v_smfmac_f32_16x16x64_bf16 v[28:31], v[40:43], v[120:127], v1
s_waitcnt lgkmcnt(3)
ds_read_b64_tr_b16 v[14:15], v4 offset:1536
v_add_f32 v51, v51, v55
v_smfmac_f32_16x16x64_bf16 v[28:31], v[32:35], v[136:143], v1
s_waitcnt lgkmcnt(3)
ds_read_b64_tr_b16 v[20:21], v4 offset:3072
v_exp_f32 v51, v51
v_mfma_f32_16x16x32_bf16 v[44:47], v[8:11], v[8:11], 0
v_exp_f32 v48, v48
v_exp_f32 v50, v50
v_smfmac_f32_16x16x64_bf16 v[24:27], v[32:35], v[128:135], v1
s_waitcnt lgkmcnt(1)
s_min_u32 s34, s34, s32
v_cvt_pk_bf16_f32 v55, v50, v51
v_mfma_f32_16x16x32_bf16 v[44:47], v[12:15], v[12:15], v[44:47]
s_nop 0
v_mov_b32_dpp v51, v55 quad_perm:[2,3,2,3] row_mask:0xf bank_mask:0xf
v_cvt_pk_bf16_f32 v54, v48, v49
v_mfma_f32_16x16x32_bf16 v[44:47], v[16:19], v[16:19], v[44:47]
s_waitcnt lgkmcnt(0)
v_mov_b32_dpp v48, v54 quad_perm:[0,1,0,1] row_mask:0xf bank_mask:0xf
v_mov_b32_dpp v49, v55 quad_perm:[0,1,0,1] row_mask:0xf bank_mask:0xf
v_mov_b32_dpp v50, v54 quad_perm:[2,3,2,3] row_mask:0xf bank_mask:0xf
v_mfma_f32_16x16x32_bf16 v[44:47], v[20:23], v[20:23], v[44:47]
s_add_u32 s27, s20, 524288
v_mov_b64 v[20:21], s[44:45]
v_mov_b64 v[22:23], s[44:45]
v_smfmac_f32_16x16x64_bf16 v[24:27], v[36:39], v[144:151], v1
s_waitcnt vmcnt(5)
global_load_dwordx4 v[80:83], v0, s[80:81] offset:-4096 sc1
v_mfma_f32_16x16x32_bf16 v[16:19], v[20:23], v[48:51], 0
s_nop 0
v_exp_f32_dpp v44, v46 quad_perm:[0,1,0,1] row_mask:0xf bank_mask:0xf
v_mfma_f32_16x16x32_bf16 v[8:11], v[56:59], v[48:51], 0
v_exp_f32_dpp v45, v47 quad_perm:[0,1,0,1] row_mask:0xf bank_mask:0xf
v_mov_b64 v[54:55], s[46:47]
v_smfmac_f32_16x16x64_bf16 v[28:31], v[36:39], v[152:159], v1
global_load_dwordx4 v[84:87], v0, s[80:81] offset:-3072 sc1
v_cvt_pk_bf16_f32 v52, v44, v45
v_mfma_f32_16x16x32_bf16 v[12:15], v[60:63], v[48:51], 0
v_cvt_pk_bf16_f32 v53, v44, v45
v_cvt_pk_bf16_f32 v24, v24, v25
v_cvt_pk_bf16_f32 v25, v26, v27
v_mfma_f32_16x16x16_bf16 v[16:19], v[54:55], v[52:53], v[16:19]
s_nop 0
v_cvt_pk_bf16_f32 v27, v30, v31
v_cvt_pk_bf16_f32 v26, v28, v29
v_mfma_f32_16x16x16_bf16 v[8:11], v[24:25], v[52:53], v[8:11]
v_bfe_u32 v32, v0, 5, 1
v_mov_b64 v[38:39], 0
v_mfma_f32_16x16x16_bf16 v[12:15], v[26:27], v[52:53], v[12:15]
s_nop 0
v_mov_b64 v[42:43], 0
v_rcp_f32 v18, v16
v_mov_b64 v[36:37], 0
v_lshl_add_u32 v32, v32, 3, v5
v_subrev_u32 v17, s37, v16
v_mov_b64 v[40:41], 0
v_cmp_lt_u32 vcc, s38, v17
v_cndmask_b32 v9, v13, v9, s[42:43]
v_cndmask_b32 v11, v15, v11, s[42:43]
v_mul_f32 v11, v11, v18
v_cndmask_b32 v10, v14, v10, s[42:43]
v_mul_f32 v10, v10, v18
v_cndmask_b32 v8, v12, v8, s[42:43]
v_mul_f32 v9, v9, v18
v_mul_f32 v8, v8, v18
v_cvt_pk_bf16_f32 v12, v8, v9
v_cvt_pk_bf16_f32 v13, v10, v11
s_cbranch_vccnz rare_10026
back_10027:
ds_write_b64 v32, v[12:13] offset:512
v_mov_b32_dpp v10, v12 quad_perm:[2,3,2,3] row_mask:0xf bank_mask:0xf
v_mov_b32_dpp v8, v12 quad_perm:[0,1,0,1] row_mask:0xf bank_mask:0xf
v_mov_b32_dpp v9, v13 quad_perm:[0,1,0,1] row_mask:0xf bank_mask:0xf
v_mov_b32_dpp v11, v13 quad_perm:[2,3,2,3] row_mask:0xf bank_mask:0xf
v_mov_b64 v[52:53], 0
s_waitcnt vmcnt(4)
v_smfmac_f32_16x16x64_bf16 v[40:43], v[8:11], v[64:71], v1
s_mov_b64 s[70:71], s[74:75]
ds_read_b128 v[16:19], v0 offset:30720
global_load_dwordx4 v[64:67], v0, s[76:77] offset:-4096 sc1
ds_read_b128 v[28:31], v0 offset:33792
v_mov_b64 v[54:55], 0
v_mov_b64 v[48:49], 0
v_mov_b64 v[32:33], 0
v_smfmac_f32_16x16x64_bf16 v[52:55], v[8:11], v[176:183], v1
s_waitcnt lgkmcnt(2)
ds_read_b128 v[24:27], v0 offset:32768
global_load_dwordx4 v[68:71], v0, s[76:77] offset:-3072 sc1
ds_read_b128 v[20:23], v0 offset:31744
s_barrier
ds_read_b128 v[56:59], v5 offset:0
v_mov_b64 v[50:51], 0
v_smfmac_f32_16x16x64_bf16 v[36:39], v[8:11], v[160:167], v1
s_waitcnt vmcnt(5)
ds_read_b128 v[60:63], v5 offset:1536
v_mov_b64 v[34:35], 0
v_smfmac_f32_16x16x64_bf16 v[48:51], v[8:11], v[168:175], v1
ds_read_b128 v[12:15], v5 offset:1024
v_bfe_u32 v45, v0, 1, 7
v_lshrrev_b32 v44, 8, v0
s_waitcnt vmcnt(4)
v_smfmac_f32_16x16x64_bf16 v[32:35], v[8:11], v[72:79], v1
global_load_dwordx4 v[72:75], v0, s[76:77] offset:0 sc1
s_waitcnt lgkmcnt(2)
v_smfmac_f32_16x16x64_bf16 v[36:39], v[56:59], v[184:191], v1
global_load_dwordx4 v[76:79], v0, s[76:77] offset:1024 sc1
s_waitcnt lgkmcnt(1)
v_smfmac_f32_16x16x64_bf16 v[36:39], v[60:63], v[16:23], v1
s_waitcnt lgkmcnt(0)
v_lshl_or_b32 v44, v44, 12, v45
v_smfmac_f32_16x16x64_bf16 v[36:39], v[12:15], v[24:31], v1
s_mov_b64 s[68:69], s[72:73]
ds_read_b128 v[24:27], v0 offset:34816
v_smfmac_f32_16x16x64_bf16 v[40:43], v[56:59], v[192:199], v1
ds_read_b128 v[28:31], v0 offset:35840
s_nop 0
v_smfmac_f32_16x16x64_bf16 v[32:35], v[56:59], v[240:247], v1
s_waitcnt vmcnt(5)
ds_read_b128 v[20:23], v0 offset:37888
v_cvt_pk_bf16_f32 v36, v36, v37
v_smfmac_f32_16x16x64_bf16 v[48:51], v[56:59], v[200:207], v1
ds_read_b128 v[16:19], v0 offset:36864
v_and_or_b32 v36, v36, -2, s18
v_cvt_pk_bf16_f32 v37, v38, v39
s_waitcnt vmcnt(4)
v_smfmac_f32_16x16x64_bf16 v[40:43], v[60:63], v[80:87], v1
global_store_dwordx2 v44, v[36:37], s[48:49]
s_waitcnt lgkmcnt(2)
v_smfmac_f32_16x16x64_bf16 v[40:43], v[12:15], v[24:31], v1
s_add_u32 s58, s4, s20
ds_read_b128 v[28:31], v0 offset:39936
v_smfmac_f32_16x16x64_bf16 v[48:51], v[60:63], v[208:215], v1
s_waitcnt lgkmcnt(2)
s_waitcnt lgkmcnt(1)
v_smfmac_f32_16x16x64_bf16 v[48:51], v[12:15], v[16:23], v1
s_nop 1
v_cvt_pk_bf16_f32 v40, v40, v41
v_cvt_pk_bf16_f32 v41, v42, v43
v_and_or_b32 v40, v40, -2, s18
v_smfmac_f32_16x16x64_bf16 v[52:55], v[56:59], v[216:223], v1
global_store_dwordx2 v44, v[40:41], s[50:51]
v_smfmac_f32_16x16x64_bf16 v[52:55], v[60:63], v[224:231], v1
s_addc_u32 s59, s5, 0
ds_read_b128 v[24:27], v0 offset:38912
v_cvt_pk_bf16_f32 v48, v48, v49
v_cvt_pk_bf16_f32 v49, v50, v51
v_and_or_b32 v48, v48, -2, s18
v_smfmac_f32_16x16x64_bf16 v[52:55], v[12:15], v[232:239], v1
global_store_dwordx2 v44, v[48:49], s[52:53]
v_smfmac_f32_16x16x64_bf16 v[32:35], v[60:63], v[248:255], v1
s_nop 1
s_waitcnt lgkmcnt(0)
v_smfmac_f32_16x16x64_bf16 v[32:35], v[12:15], v[24:31], v1
s_nop 1
v_cvt_pk_bf16_f32 v52, v52, v53
v_and_or_b32 v52, v52, -2, s18
v_cvt_pk_bf16_f32 v53, v54, v55
s_nop 0
global_store_dwordx2 v44, v[52:53], s[54:55]
s_nop 0
v_cvt_pk_bf16_f32 v32, v32, v33
v_cvt_pk_bf16_f32 v33, v34, v35
v_and_or_b32 v32, v32, -2, s18
global_store_dwordx2 v44, v[32:33], s[56:57]
v_bfe_u32 v32, v0, 6, 1
v_lshlrev_b32 v32, 4, v32
v_mov_b32 v33, 0x3f80
v_lshlrev_b32 v32, v32, v33
v_bfe_i32 v33, v0, 4, 1
v_and_b32 v45, v32, v33
v_and_b32 v47, v32, v33
v_xor_b32 v44, v32, v45
v_xor_b32 v46, v32, v45
v_and_b32 v36, 32, v0
v_bfe_u32 v37, v0, 6, 1
v_lshl_add_u32 v36, v37, 8, v36
v_bfe_u32 v37, v0, 8, 1
v_lshl_add_u32 v36, v37, 4, v36
v_bfe_u32 v37, v0, 4, 1
v_lshl_add_u32 v36, v37, 3, v36
v_and_b32 v7, 255, v0
v_lshl_add_u32 v7, v7, 3, s27
s_nop 15
s_nop 15
s_nop 15
s_nop 15
global_load_dwordx4 v[8:11], v0, s[64:65] offset:0 sc1
global_load_dwordx4 v[12:15], v0, s[64:65] offset:1024 sc1
global_load_dwordx4 v[16:19], v0, s[64:65] offset:2048 sc1
global_load_dwordx4 v[20:23], v0, s[64:65] offset:3072 sc1
s_nop 15
s_nop 15
s_nop 5
global_load_dwordx4 v[24:27], v0, s[64:65] offset:0 sc1
global_load_dwordx4 v[28:31], v0, s[64:65] offset:1024 sc1
global_load_dwordx4 v[48:51], v0, s[64:65] offset:2048 sc1
global_load_dwordx4 v[52:55], v0, s[64:65] offset:3072 sc1
chk_10035:
v_mov_b64 v[40:41], 0
v_mov_b64 v[42:43], 0
s_waitcnt vmcnt(6)
s_nop 0
v_smfmac_f32_16x16x64_bf16 v[40:43], v[44:47], v[8:15], v1
v_bitop3_b32 v32, v8, v10, s18 bitop3:0x7e
v_bitop3_b32 v33, v12, v14, s18 bitop3:0x7e
s_waitcnt vmcnt(4)
v_smfmac_f32_16x16x64_bf16 v[40:43], v[44:47], v[16:23], v1
v_bitop3_b32 v34, v16, v18, s18 bitop3:0x7e
v_bitop3_b32 v35, v20, v22, s18 bitop3:0x7e
v_or3_b32 v37, v32, v33, v34
v_bitop3_b32 v37, v37, v35, 1 bitop3:0xa8
v_cmp_ne_u32 vcc, 0, v37
s_cbranch_vccnz chk_10035_f
s_nop 1
v_add_f32_dpp v40, v40, v40 row_ror:8 row_mask:0xf bank_mask:0xf
v_add_f32_dpp v41, v41, v41 row_ror:8 row_mask:0xf bank_mask:0xf
v_add_f32_dpp v42, v42, v42 row_ror:8 row_mask:0xf bank_mask:0xf
v_add_f32_dpp v43, v43, v43 row_ror:8 row_mask:0xf bank_mask:0xf
v_cvt_pk_bf16_f32 v40, v40, v41
v_cvt_pk_bf16_f32 v41, v42, v43
v_and_or_b32 v40, v40, -2, s18
s_mov_b64 exec, 0x00ff00ff
global_store_dwordx2 v36, v[40:41], s[66:67]
s_mov_b64 exec, -1
s_branch join_10034
chk_10035_f:
global_load_dwordx4 v[8:11], v0, s[64:65] offset:0 sc1
global_load_dwordx4 v[12:15], v0, s[64:65] offset:1024 sc1
global_load_dwordx4 v[16:19], v0, s[64:65] offset:2048 sc1
global_load_dwordx4 v[20:23], v0, s[64:65] offset:3072 sc1
chk_10036:
v_mov_b64 v[40:41], 0
v_mov_b64 v[42:43], 0
s_waitcnt vmcnt(6)
s_nop 0
v_smfmac_f32_16x16x64_bf16 v[40:43], v[44:47], v[24:31], v1
v_bitop3_b32 v32, v24, v26, s18 bitop3:0x7e
v_bitop3_b32 v33, v28, v30, s18 bitop3:0x7e
s_waitcnt vmcnt(4)
v_smfmac_f32_16x16x64_bf16 v[40:43], v[44:47], v[48:55], v1
v_bitop3_b32 v34, v48, v50, s18 bitop3:0x7e
v_bitop3_b32 v35, v52, v54, s18 bitop3:0x7e
v_or3_b32 v37, v32, v33, v34
v_bitop3_b32 v37, v37, v35, 1 bitop3:0xa8
v_cmp_ne_u32 vcc, 0, v37
s_cbranch_vccnz chk_10036_f
s_nop 1
v_add_f32_dpp v40, v40, v40 row_ror:8 row_mask:0xf bank_mask:0xf
v_add_f32_dpp v41, v41, v41 row_ror:8 row_mask:0xf bank_mask:0xf
v_add_f32_dpp v42, v42, v42 row_ror:8 row_mask:0xf bank_mask:0xf
v_add_f32_dpp v43, v43, v43 row_ror:8 row_mask:0xf bank_mask:0xf
v_cvt_pk_bf16_f32 v40, v40, v41
v_cvt_pk_bf16_f32 v41, v42, v43
v_and_or_b32 v40, v40, -2, s18
s_mov_b64 exec, 0x00ff00ff
global_store_dwordx2 v36, v[40:41], s[66:67]
s_mov_b64 exec, -1
s_branch join_10034
chk_10036_f:
global_load_dwordx4 v[24:27], v0, s[64:65] offset:0 sc1
global_load_dwordx4 v[28:31], v0, s[64:65] offset:1024 sc1
global_load_dwordx4 v[48:51], v0, s[64:65] offset:2048 sc1
global_load_dwordx4 v[52:55], v0, s[64:65] offset:3072 sc1
s_add_u32 s30, s30, 1
s_cmp_le_u32 s30, 262144
s_cbranch_scc1 chk_10035
s_branch L_fail
nored_10033:
join_10034:
s_barrier
global_load_dwordx4 v[56:59], v0, s[76:77] offset:-2048 sc1
global_load_dwordx4 v[60:63], v0, s[76:77] offset:-1024 sc1
global_load_dwordx4 v[80:83], v0, s[76:77] offset:2048 sc1
global_load_dwordx4 v[84:87], v0, s[76:77] offset:3072 sc1
s_nop 15
s_nop 15
s_nop 3
s_barrier
global_load_dwordx4 v[32:35], v0, s[68:69] offset:-4096 sc1
s_nop 10
global_load_dwordx4 v[36:39], v0, s[68:69] offset:0 sc1
s_nop 10
global_load_dwordx4 v[40:43], v0, s[70:71] offset:0 sc1
s_barrier
global_load_dwordx4 v[24:27], v0, s[78:79] offset:-4096 sc1
global_load_dwordx4 v[28:31], v0, s[78:79] offset:-3072 sc1
global_load_dwordx4 v[48:51], v0, s[58:59] offset:0 nt sc1
global_load_dwordx4 v[52:55], v0, s[58:59] offset:1024 nt sc1
s_waitcnt vmcnt(15)
v_mov_b64 v[8:9], 0
v_mov_b64 v[10:11], 0
s_waitcnt vmcnt(14)
v_mov_b64 v[12:13], 0
v_mov_b64 v[14:15], 0
s_waitcnt vmcnt(13)
v_mov_b64 v[16:17], 0
v_mov_b64 v[18:19], 0
s_waitcnt vmcnt(12)
v_mov_b64 v[20:21], 0
v_mov_b64 v[22:23], 0
s_mov_b32 s30, 0
s_cmp_eq_u32 s17, s31
s_cbranch_scc0 gather_10025
s_branch exit_10028
rt_10030:
global_load_dwordx4 v[32:35], v0, s[68:69] offset:-4096 sc1
global_load_dwordx4 v[36:39], v0, s[68:69] offset:0 sc1
global_load_dwordx4 v[40:43], v0, s[70:71] offset:0 sc1
s_add_u32 s30, s30, 1
s_cmp_gt_u32 s30, 262144
s_cbranch_scc1 L_fail
s_mov_b64 exec, 1
global_store_dword v0, v0, s[62:63]
global_store_dword v0, v0, s[62:63]
global_store_dword v0, v0, s[62:63]
global_store_dword v0, v0, s[62:63]
s_mov_b64 exec, -1
v_mov_b64 v[8:9], 0
v_mov_b64 v[10:11], 0
v_mov_b64 v[12:13], 0
v_mov_b64 v[14:15], 0
v_mov_b64 v[16:17], 0
v_mov_b64 v[18:19], 0
v_mov_b64 v[20:21], 0
v_mov_b64 v[22:23], 0
s_branch gather_10025
rare_10026:
ds_read_b128 v[48:51], v6 offset:6144
ds_read_b128 v[52:55], v6 offset:7168
s_waitcnt lgkmcnt(0)
v_add_f32 v48, v48, v52
v_add_f32 v49, v49, v53
v_add_f32 v50, v50, v54
v_add_f32 v51, v51, v55
v_mov_b32_dpp v46, v46 quad_perm:[0,1,0,1] row_mask:0xf bank_mask:0xf
v_mov_b32_dpp v47, v47 quad_perm:[0,1,0,1] row_mask:0xf bank_mask:0xf
v_max3_f32 v19, v48, v49, v50
v_max3_f32 v19, v19, v51, v46
v_max_f32 v19, v19, v47
s_nop 1
v_max_f32_dpp v19, v19, v19 quad_perm:[2,3,0,1] row_mask:0xf bank_mask:0xf
v_mov_b32 v44, v19
s_nop 1
v_permlane32_swap_b32 v19, v44
v_max_f32 v19, v19, v44
v_mov_b32 v44, v19
s_nop 1
v_permlane16_swap_b32 v19, v44
v_max_f32 v19, v19, v44
v_sub_f32 v48, v48, v19
v_sub_f32 v49, v49, v19
v_sub_f32 v50, v50, v19
v_sub_f32 v51, v51, v19
v_sub_f32 v46, v46, v19
v_sub_f32 v47, v47, v19
v_exp_f32 v48, v48
v_exp_f32 v49, v49
v_exp_f32 v50, v50
v_exp_f32 v51, v51
v_cvt_pk_bf16_f32 v54, v48, v49
v_cvt_pk_bf16_f32 v55, v50, v51
s_nop 0
v_mov_b32_dpp v48, v54 quad_perm:[0,1,0,1] row_mask:0xf bank_mask:0xf
v_mov_b32_dpp v49, v55 quad_perm:[0,1,0,1] row_mask:0xf bank_mask:0xf
v_mov_b32_dpp v50, v54 quad_perm:[2,3,2,3] row_mask:0xf bank_mask:0xf
v_mov_b32_dpp v51, v55 quad_perm:[2,3,2,3] row_mask:0xf bank_mask:0xf
v_mov_b64 v[20:21], s[44:45]
v_mov_b64 v[22:23], s[44:45]
v_mfma_f32_16x16x32_bf16 v[8:11], v[56:59], v[48:51], 0
v_mfma_f32_16x16x32_bf16 v[12:15], v[60:63], v[48:51], 0
v_mfma_f32_16x16x32_bf16 v[16:19], v[20:23], v[48:51], 0
v_mov_b64 v[54:55], s[46:47]
v_exp_f32_dpp v44, v46 quad_perm:[0,1,0,1] row_mask:0xf bank_mask:0xf
v_exp_f32_dpp v45, v47 quad_perm:[0,1,0,1] row_mask:0xf bank_mask:0xf
s_nop 0
v_cvt_pk_bf16_f32 v52, v44, v45
v_cvt_pk_bf16_f32 v53, v44, v45
s_nop 1
v_mfma_f32_16x16x16_bf16 v[16:19], v[54:55], v[52:53], v[16:19]
v_mfma_f32_16x16x16_bf16 v[8:11], v[24:25], v[52:53], v[8:11]
v_mfma_f32_16x16x16_bf16 v[12:15], v[26:27], v[52:53], v[12:15]
s_nop 5
v_rcp_f32 v18, v16
s_nop 0
v_cndmask_b32 v8, v12, v8, s[42:43]
v_mul_f32 v8, v8, v18
v_cndmask_b32 v9, v13, v9, s[42:43]
v_mul_f32 v9, v9, v18
v_cndmask_b32 v10, v14, v10, s[42:43]
v_mul_f32 v10, v10, v18
v_cndmask_b32 v11, v15, v11, s[42:43]
v_mul_f32 v11, v11, v18
v_cvt_pk_bf16_f32 v12, v8, v9
v_cvt_pk_bf16_f32 v13, v10, v11
s_branch back_10027
exit_10028:
global_load_dwordx4 v[32:35], v0, s[68:69] offset:-4096 sc1
global_load_dwordx4 v[36:39], v0, s[68:69] offset:0 sc1
global_load_dwordx4 v[40:43], v0, s[70:71] offset:0 sc1
s_add_u32 s30, s30, 1
s_cmp_gt_u32 s30, 262144
s_cbranch_scc1 L_fail
s_waitcnt vmcnt(2)
v_bitop3_b32 v44, v32, v34, s18 bitop3:0x7e
s_waitcnt vmcnt(1)
v_bitop3_b32 v45, v36, v38, s18 bitop3:0x7e
v_or_b32 v44, v44, v45
s_waitcnt vmcnt(0)
v_bitop3_b32 v46, v40, v42, s18 bitop3:0x7e
v_bitop3_b32 v44, v44, v46, s19 bitop3:0xa8
v_cmp_ne_u32 vcc, 0, v44
s_cbranch_vccnz exit_10028
s_add_u32 s36, s36, 1
s_cmp_lt_u32 s36, 2
s_cbranch_scc1 layer_10024
s_endpgm
wave_10007:
layer_10037:
s_lshl_b32 s17, s36, 6
s_mul_i32 s27, s36, 35651584
s_mul_i32 s28, s14, 16384
s_add_u32 s27, s27, s28
s_add_u32 s20, s27, 16785408
s_mul_i32 s27, s17, 10240
s_add_u32 s27, s27, s24
s_add_u32 s21, s27, s25
s_mov_b32 s19, 0
s_mov_b32 s33, s6
s_add_u32 s34, s17, 1
s_add_u32 s31, s17, 63
s_add_u32 s32, s17, 64
s_mov_b32 s27, s20
v_mov_b32 v7, 0
s_add_u32 s68, s4, 415744
s_addc_u32 s69, s5, 0
s_add_u32 s72, s4, 399360
s_addc_u32 s73, s5, 0
s_add_u32 s70, s4, 419840
s_addc_u32 s71, s5, 0
s_add_u32 s74, s4, 403456
s_addc_u32 s75, s5, 0
s_add_u32 s58, s4, s20
s_addc_u32 s59, s5, 0
global_load_dwordx4 v[64:67], v0, s[76:77] offset:-4096 sc1
global_load_dwordx4 v[68:71], v0, s[76:77] offset:-3072 sc1
global_load_dwordx4 v[72:75], v0, s[76:77] offset:0 sc1
global_load_dwordx4 v[76:79], v0, s[76:77] offset:1024 sc1
global_load_dwordx4 v[80:83], v0, s[76:77] offset:2048 sc1
global_load_dwordx4 v[84:87], v0, s[76:77] offset:3072 sc1
global_load_dwordx4 v[56:59], v0, s[76:77] offset:-2048 sc1
global_load_dwordx4 v[60:63], v0, s[76:77] offset:-1024 sc1
global_load_dwordx4 v[24:27], v0, s[78:79] offset:-4096 sc1
global_load_dwordx4 v[28:31], v0, s[78:79] offset:-3072 sc1
v_mov_b64 v[8:9], 0
v_mov_b64 v[10:11], 0
v_mov_b64 v[12:13], 0
v_mov_b64 v[14:15], 0
v_mov_b64 v[16:17], 0
v_mov_b64 v[18:19], 0
v_mov_b64 v[20:21], 0
v_mov_b64 v[22:23], 0
s_barrier
global_load_dwordx4 v[48:51], v0, s[58:59] offset:0 nt sc1
global_load_dwordx4 v[52:55], v0, s[58:59] offset:1024 nt sc1
v_and_b32 v7, 255, v0
v_lshl_add_u32 v7, v7, 3, s27
global_load_dwordx4 v[32:35], v0, s[68:69] offset:-4096 sc1
global_load_dwordx4 v[36:39], v0, s[68:69] offset:0 sc1
v_mov_b32 v45, -1
s_mov_b32 s30, 0
s_waitcnt vmcnt(0)
.p2align 6
gather_10038:
s_waitcnt vmcnt(5)
rt_10043_b:
v_smfmac_f32_16x16x64_bf16 v[12:15], v[32:35], v[56:63], v1
ds_write_b128 v0, v[32:35] offset:2048
v_smfmac_f32_16x16x64_bf16 v[20:23], v[32:35], v[72:79], v1
v_bitop3_b32 v44, v32, v34, s18 bitop3:0x7e
v_smfmac_f32_16x16x64_bf16 v[8:11], v[32:35], v[64:71], v1
s_waitcnt vmcnt(4)
ds_write_b128 v0, v[36:39] offset:6144
v_bitop3_b32 v45, v36, v38, s18 bitop3:0x7e
v_smfmac_f32_16x16x64_bf16 v[8:11], v[36:39], v[80:87], v1
v_bitop3_b32 v44, v44, v45, s19 bitop3:0xa8
v_cmp_ne_u32 vcc, 0, v44
v_smfmac_f32_16x16x64_bf16 v[20:23], v[36:39], a[24:31], v1
s_cbranch_vccnz rt_10043
ds_read_b128 v[76:79], v2 offset:1024
global_load_dwordx4 v[64:67], v0, s[78:79] offset:-2048 sc1
ds_read_b128 v[72:75], v2 offset:0
global_load_dwordx4 v[68:71], v0, s[78:79] offset:-1024 sc1
ds_read_b128 v[84:87], v2 offset:5120
s_waitcnt lgkmcnt(3)
s_barrier
ds_read_b128 v[40:43], v0 offset:3072
v_smfmac_f32_16x16x64_bf16 v[16:19], v[32:35], a[0:7], v1
ds_read_b128 v[44:47], v0 offset:7168
global_load_dwordx4 v[56:59], v0, s[58:59] offset:2048 nt sc1
ds_read_b128 v[32:35], v0 offset:0
v_smfmac_f32_16x16x64_bf16 v[12:15], v[36:39], a[8:15], v1
s_mov_b32 s30, 0
ds_read_b128 v[80:83], v2 offset:4096
v_smfmac_f32_16x16x64_bf16 v[16:19], v[36:39], a[16:23], v1
s_waitcnt lgkmcnt(5)
ds_read_b128 v[36:39], v0 offset:4096
global_load_dwordx4 v[60:63], v0, s[58:59] offset:3072 nt sc1
s_waitcnt lgkmcnt(4)
v_smfmac_f32_16x16x64_bf16 v[8:11], v[40:43], v[72:79], v1
ds_read_b128 v[72:75], v2 offset:2048
v_smfmac_f32_16x16x64_bf16 v[12:15], v[40:43], a[32:39], v1
s_waitcnt lgkmcnt(4)
ds_read_b128 v[40:43], v0 offset:1024
v_smfmac_f32_16x16x64_bf16 v[8:11], v[44:47], a[40:47], v1
s_waitcnt lgkmcnt(4)
ds_read_b128 v[76:79], v2 offset:3072
s_waitcnt vmcnt(6)
v_smfmac_f32_16x16x64_bf16 v[12:15], v[44:47], v[24:31], v1
ds_read_b128 v[28:31], v2 offset:7168
v_smfmac_f32_16x16x64_bf16 v[12:15], v[32:35], a[56:63], v1
s_mov_b32 s19, 1
ds_read_b128 v[24:27], v2 offset:6144
v_smfmac_f32_16x16x64_bf16 v[8:11], v[32:35], a[48:55], v1
s_waitcnt lgkmcnt(4)
ds_read_b128 v[44:47], v0 offset:5120
v_smfmac_f32_16x16x64_bf16 v[12:15], v[36:39], a[64:71], v1
ds_read_b128 v[32:35], v0 offset:8192
s_waitcnt lgkmcnt(4)
v_smfmac_f32_16x16x64_bf16 v[8:11], v[36:39], v[72:79], v1
ds_read_b128 v[36:39], v0 offset:9216
s_waitcnt lgkmcnt(4)
v_smfmac_f32_16x16x64_bf16 v[8:11], v[40:43], v[80:87], v1
ds_read_b128 v[84:87], v2 offset:9216
s_waitcnt lgkmcnt(4)
v_smfmac_f32_16x16x64_bf16 v[12:15], v[40:43], v[24:31], v1
ds_read_b128 v[80:83], v2 offset:8192
s_waitcnt lgkmcnt(4)
v_smfmac_f32_16x16x64_bf16 v[12:15], v[44:47], a[80:87], v1
ds_read_b128 v[76:79], v2 offset:11264
s_waitcnt lgkmcnt(4)
v_smfmac_f32_16x16x64_bf16 v[12:15], v[32:35], a[88:95], v1
ds_read_b128 v[72:75], v2 offset:10240
s_waitcnt lgkmcnt(4)
v_smfmac_f32_16x16x64_bf16 v[8:11], v[44:47], a[72:79], v1
ds_read_b128 v[40:43], v0 offset:3072
global_load_dword v7, v7, s[4:5] sc1
ds_read_b128 v[28:31], v2 offset:13312
s_waitcnt lgkmcnt(4)
v_smfmac_f32_16x16x64_bf16 v[8:11], v[32:35], v[80:87], v1
s_waitcnt vmcnt(3)
ds_read_b128 v[24:27], v2 offset:12288
v_smfmac_f32_16x16x64_bf16 v[8:11], v[36:39], a[96:103], v1
s_nop 0
ds_read_b128 v[32:35], v0 offset:7168
s_waitcnt lgkmcnt(4)
v_smfmac_f32_16x16x64_bf16 v[12:15], v[36:39], v[72:79], v1
s_nop 0
ds_read_b128 v[36:39], v0 offset:0
s_waitcnt lgkmcnt(4)
ds_read_b128 v[72:75], v2 offset:16384
v_add_f32 v9, v9, v11
v_smfmac_f32_16x16x64_bf16 v[16:19], v[40:43], a[104:111], v1
s_xor_b32 s18, s18, 1
ds_read_b128 v[76:79], v2 offset:17408
v_add_f32 v8, v8, v10
v_smfmac_f32_16x16x64_bf16 v[20:23], v[40:43], a[112:119], v1
s_waitcnt lgkmcnt(5)
ds_read_b128 v[40:43], v0 offset:4096
v_add_f32 v12, v12, v14
v_mul_f32 v9, s35, v9
s_waitcnt lgkmcnt(4)
v_smfmac_f32_16x16x64_bf16 v[16:19], v[32:35], v[24:31], v1
ds_read_b128 v[84:87], v2 offset:15360
v_mul_f32 v8, s35, v8
v_cvt_pk_bf16_f32 v8, v8, v9
v_smfmac_f32_16x16x64_bf16 v[20:23], v[32:35], v[64:71], v1
s_waitcnt lgkmcnt(4)
ds_read_b128 v[80:83], v2 offset:14336
v_add_f32 v13, v13, v15
v_smfmac_f32_16x16x64_bf16 v[20:23], v[36:39], a[128:135], v1
ds_read_b128 v[32:35], v0 offset:1024
v_mul_f32 v12, s35, v12
v_mul_f32 v13, s35, v13
v_smfmac_f32_16x16x64_bf16 v[16:19], v[36:39], a[120:127], v1
s_waitcnt lgkmcnt(3)
ds_read_b128 v[36:39], v0 offset:5120
v_cvt_pk_bf16_f32 v12, v12, v13
v_smfmac_f32_16x16x64_bf16 v[20:23], v[40:43], a[144:151], v1
ds_write2_b32 v3, v8, v12 offset0:0 offset1:128
v_mov_b64 v[26:27], 0
v_smfmac_f32_16x16x64_bf16 v[16:19], v[40:43], a[136:143], v1
s_waitcnt lgkmcnt(2)
ds_read_b128 v[40:43], v0 offset:8192
v_smfmac_f32_16x16x64_bf16 v[16:19], v[32:35], a[152:159], v1
s_mov_b64 vcc, s[42:43]
ds_read_b128 v[68:71], v2 offset:19456
v_mov_b64 v[30:31], 0
v_smfmac_f32_16x16x64_bf16 v[20:23], v[32:35], a[160:167], v1
s_waitcnt lgkmcnt(3)
ds_read_b128 v[32:35], v0 offset:9216
v_mov_b64 v[24:25], 0
v_smfmac_f32_16x16x64_bf16 v[20:23], v[36:39], v[80:87], v1
s_add_u32 s20, s20, 524288
ds_read_b128 v[64:67], v2 offset:18432
v_mov_b64 v[28:29], 0
v_smfmac_f32_16x16x64_bf16 v[16:19], v[36:39], a[168:175], v1
ds_read_b128 v[36:39], v0 offset:8192
s_waitcnt lgkmcnt(4)
v_smfmac_f32_16x16x64_bf16 v[20:23], v[40:43], v[72:79], v1
s_barrier
ds_read_b64_tr_b16 v[8:9], v4 offset:2048
v_smfmac_f32_16x16x64_bf16 v[16:19], v[40:43], a[176:183], v1
s_waitcnt lgkmcnt(3)
ds_read_b64_tr_b16 v[14:15], v4 offset:3584
ds_read_b64_tr_b16 v[10:11], v4 offset:2560
v_smfmac_f32_16x16x64_bf16 v[16:19], v[32:35], a[184:191], v1
s_nop 0
ds_read_b64_tr_b16 v[12:13], v4 offset:3072
ds_read_b128 v[40:43], v0 offset:9216
v_smfmac_f32_16x16x64_bf16 v[20:23], v[32:35], a[192:199], v1
s_add_u32 s17, s17, 1
ds_read_b128 v[72:75], v2 offset:20480
s_waitcnt lgkmcnt(6)
ds_read_b128 v[80:83], v0 offset:40960
v_add_f32 v17, v17, v19
v_add_f32 v16, v16, v18
v_cvt_pk_bf16_f32 v16, v16, v17
v_smfmac_f32_16x16x64_bf16 v[24:27], v[36:39], a[200:207], v1
s_waitcnt lgkmcnt(6)
ds_read_b128 v[76:79], v2 offset:21504
s_waitcnt lgkmcnt(5)
v_mfma_f32_16x16x32_bf16 v[44:47], v[48:51], v[8:11], 0
s_waitcnt lgkmcnt(4)
ds_read_b128 v[84:87], v0 offset:41984
v_add_f32 v21, v21, v23
v_mfma_f32_16x16x32_bf16 v[44:47], v[52:55], v[12:15], v[44:47]
ds_read_b128 v[32:35], v0 offset:2048
v_bfe_u32 v48, v0, 5, 1
v_add_f32 v20, v20, v22
v_cvt_pk_bf16_f32 v20, v20, v21
v_smfmac_f32_16x16x64_bf16 v[28:31], v[36:39], a[208:215], v1
s_waitcnt lgkmcnt(5)
ds_write2_b32 v3, v16, v20 offset0:1 offset1:129
v_lshl_add_u32 v48, v48, 3, v5
v_cndmask_b32_dpp v45, v47, v45, vcc quad_perm:[0,1,0,1] row_mask:0xf bank_mask:0xf
v_smfmac_f32_16x16x64_bf16 v[24:27], v[40:43], v[64:71], v1
s_add_u32 s21, s21, 10240
ds_read_b128 v[36:39], v0 offset:6144
v_cndmask_b32_dpp v44, v46, v44, vcc quad_perm:[0,1,0,1] row_mask:0xf bank_mask:0xf
v_smfmac_f32_16x16x64_bf16 v[28:31], v[40:43], a[216:223], v1
s_waitcnt lgkmcnt(2)
ds_write_b64 v48, v[44:45] offset:7168
v_smfmac_f32_16x16x64_bf16 v[24:27], v[32:35], v[72:79], v1
global_load_dwordx4 v[64:67], v0, s[78:79] offset:0 sc1
ds_read_b128 v[72:75], v2 offset:22528
v_smfmac_f32_16x16x64_bf16 v[28:31], v[32:35], a[224:231], v1
ds_read_b128 v[40:43], v0 offset:3072
s_waitcnt lgkmcnt(3)
v_smfmac_f32_16x16x64_bf16 v[28:31], v[36:39], a[240:247], v1
ds_read_b128 v[76:79], v2 offset:23552
global_load_dwordx4 v[68:71], v0, s[78:79] offset:1024 sc1
ds_read_b128 v[32:35], v0 offset:7168
v_smfmac_f32_16x16x64_bf16 v[24:27], v[36:39], a[232:239], v1
s_waitcnt lgkmcnt(4)
ds_read_b128 v[36:39], v0 offset:0
s_barrier
ds_read_b128 v[48:51], v6 offset:6144
s_waitcnt lgkmcnt(4)
v_smfmac_f32_16x16x64_bf16 v[28:31], v[40:43], v[80:87], v1
s_add_u32 s34, s17, 2
ds_read_b64_tr_b16 v[22:23], v4 offset:3584
s_waitcnt lgkmcnt(4)
ds_read_b128 v[52:55], v6 offset:7168
v_smfmac_f32_16x16x64_bf16 v[24:27], v[40:43], v[72:79], v1
ds_read_b128 v[40:43], v0 offset:4096
s_waitcnt lgkmcnt(5)
ds_read_b64_tr_b16 v[8:9], v4 offset:0
v_smfmac_f32_16x16x64_bf16 v[24:27], v[32:35], a[248:255], v1
s_waitcnt lgkmcnt(5)
ds_read_b64_tr_b16 v[16:17], v4 offset:2048
global_load_dwordx4 v[72:75], v0, s[78:79] offset:2048 sc1
ds_read_b64_tr_b16 v[18:19], v4 offset:2560
v_smfmac_f32_16x16x64_bf16 v[28:31], v[32:35], v[88:95], v1
global_load_dwordx4 v[76:79], v0, s[78:79] offset:3072 sc1
ds_read_b128 v[32:35], v0 offset:1024
v_smfmac_f32_16x16x64_bf16 v[24:27], v[36:39], v[96:103], v1
s_waitcnt lgkmcnt(5)
ds_read_b64_tr_b16 v[10:11], v4 offset:512
v_add_f32 v49, v49, v53
v_smfmac_f32_16x16x64_bf16 v[28:31], v[36:39], v[104:111], v1
s_waitcnt lgkmcnt(5)
ds_read_b64_tr_b16 v[12:13], v4 offset:1024
v_add_f32 v48, v48, v52
v_add_f32 v50, v50, v54
v_smfmac_f32_16x16x64_bf16 v[24:27], v[40:43], v[112:119], v1
ds_read_b128 v[36:39], v0 offset:5120
v_exp_f32 v49, v49
v_smfmac_f32_16x16x64_bf16 v[28:31], v[40:43], v[120:127], v1
s_waitcnt lgkmcnt(3)
ds_read_b64_tr_b16 v[14:15], v4 offset:1536
v_add_f32 v51, v51, v55
v_smfmac_f32_16x16x64_bf16 v[28:31], v[32:35], v[136:143], v1
s_waitcnt lgkmcnt(3)
ds_read_b64_tr_b16 v[20:21], v4 offset:3072
v_exp_f32 v51, v51
v_mfma_f32_16x16x32_bf16 v[44:47], v[8:11], v[8:11], 0
v_exp_f32 v48, v48
v_exp_f32 v50, v50
v_smfmac_f32_16x16x64_bf16 v[24:27], v[32:35], v[128:135], v1
s_waitcnt lgkmcnt(1)
s_min_u32 s34, s34, s32
v_cvt_pk_bf16_f32 v55, v50, v51
v_mfma_f32_16x16x32_bf16 v[44:47], v[12:15], v[12:15], v[44:47]
s_nop 0
v_mov_b32_dpp v51, v55 quad_perm:[2,3,2,3] row_mask:0xf bank_mask:0xf
v_cvt_pk_bf16_f32 v54, v48, v49
v_mfma_f32_16x16x32_bf16 v[44:47], v[16:19], v[16:19], v[44:47]
s_waitcnt lgkmcnt(0)
v_mov_b32_dpp v48, v54 quad_perm:[0,1,0,1] row_mask:0xf bank_mask:0xf
v_mov_b32_dpp v49, v55 quad_perm:[0,1,0,1] row_mask:0xf bank_mask:0xf
v_mov_b32_dpp v50, v54 quad_perm:[2,3,2,3] row_mask:0xf bank_mask:0xf
v_mfma_f32_16x16x32_bf16 v[44:47], v[20:23], v[20:23], v[44:47]
s_add_u32 s27, s20, 524288
v_mov_b64 v[20:21], s[44:45]
v_mov_b64 v[22:23], s[44:45]
v_smfmac_f32_16x16x64_bf16 v[24:27], v[36:39], v[144:151], v1
s_waitcnt vmcnt(5)
global_load_dwordx4 v[80:83], v0, s[80:81] offset:-4096 sc1
v_mfma_f32_16x16x32_bf16 v[16:19], v[20:23], v[48:51], 0
s_nop 0
v_exp_f32_dpp v44, v46 quad_perm:[0,1,0,1] row_mask:0xf bank_mask:0xf
v_mfma_f32_16x16x32_bf16 v[8:11], v[56:59], v[48:51], 0
v_exp_f32_dpp v45, v47 quad_perm:[0,1,0,1] row_mask:0xf bank_mask:0xf
v_mov_b64 v[54:55], s[46:47]
v_smfmac_f32_16x16x64_bf16 v[28:31], v[36:39], v[152:159], v1
global_load_dwordx4 v[84:87], v0, s[80:81] offset:-3072 sc1
v_cvt_pk_bf16_f32 v52, v44, v45
v_mfma_f32_16x16x32_bf16 v[12:15], v[60:63], v[48:51], 0
v_cvt_pk_bf16_f32 v53, v44, v45
v_cvt_pk_bf16_f32 v24, v24, v25
v_cvt_pk_bf16_f32 v25, v26, v27
v_mfma_f32_16x16x16_bf16 v[16:19], v[54:55], v[52:53], v[16:19]
s_nop 0
v_cvt_pk_bf16_f32 v27, v30, v31
v_cvt_pk_bf16_f32 v26, v28, v29
v_mfma_f32_16x16x16_bf16 v[8:11], v[24:25], v[52:53], v[8:11]
v_bfe_u32 v32, v0, 5, 1
v_mov_b64 v[38:39], 0
v_mfma_f32_16x16x16_bf16 v[12:15], v[26:27], v[52:53], v[12:15]
s_nop 0
v_mov_b64 v[42:43], 0
v_rcp_f32 v18, v16
v_mov_b64 v[36:37], 0
v_lshl_add_u32 v32, v32, 3, v5
v_subrev_u32 v17, s37, v16
v_mov_b64 v[40:41], 0
v_cmp_lt_u32 vcc, s38, v17
v_cndmask_b32 v9, v13, v9, s[42:43]
v_cndmask_b32 v11, v15, v11, s[42:43]
v_mul_f32 v11, v11, v18
v_cndmask_b32 v10, v14, v10, s[42:43]
v_mul_f32 v10, v10, v18
v_cndmask_b32 v8, v12, v8, s[42:43]
v_mul_f32 v9, v9, v18
v_mul_f32 v8, v8, v18
v_cvt_pk_bf16_f32 v12, v8, v9
v_cvt_pk_bf16_f32 v13, v10, v11
s_cbranch_vccnz rare_10039
back_10040:
ds_write_b64 v32, v[12:13] offset:1024
v_mov_b32_dpp v10, v12 quad_perm:[2,3,2,3] row_mask:0xf bank_mask:0xf
v_mov_b32_dpp v8, v12 quad_perm:[0,1,0,1] row_mask:0xf bank_mask:0xf
v_mov_b32_dpp v9, v13 quad_perm:[0,1,0,1] row_mask:0xf bank_mask:0xf
v_mov_b32_dpp v11, v13 quad_perm:[2,3,2,3] row_mask:0xf bank_mask:0xf
v_mov_b64 v[52:53], 0
s_waitcnt vmcnt(4)
v_smfmac_f32_16x16x64_bf16 v[40:43], v[8:11], v[64:71], v1
ds_read_b128 v[16:19], v0 offset:43008
global_load_dwordx4 v[64:67], v0, s[76:77] offset:-4096 sc1
ds_read_b128 v[28:31], v0 offset:46080
v_mov_b64 v[54:55], 0
v_mov_b64 v[48:49], 0
v_mov_b64 v[32:33], 0
v_smfmac_f32_16x16x64_bf16 v[52:55], v[8:11], v[176:183], v1
s_waitcnt lgkmcnt(2)
ds_read_b128 v[24:27], v0 offset:45056
global_load_dwordx4 v[68:71], v0, s[76:77] offset:-3072 sc1
ds_read_b128 v[20:23], v0 offset:44032
s_barrier
ds_read_b128 v[56:59], v5 offset:1536
v_mov_b64 v[50:51], 0
v_smfmac_f32_16x16x64_bf16 v[36:39], v[8:11], v[160:167], v1
s_waitcnt vmcnt(5)
ds_read_b128 v[60:63], v5 offset:0
v_mov_b64 v[34:35], 0
v_smfmac_f32_16x16x64_bf16 v[48:51], v[8:11], v[168:175], v1
ds_read_b128 v[12:15], v5 offset:512
v_bfe_u32 v45, v0, 1, 7
v_lshrrev_b32 v44, 8, v0
s_waitcnt vmcnt(4)
v_smfmac_f32_16x16x64_bf16 v[32:35], v[8:11], v[72:79], v1
global_load_dwordx4 v[72:75], v0, s[76:77] offset:0 sc1
s_waitcnt lgkmcnt(2)
v_smfmac_f32_16x16x64_bf16 v[36:39], v[56:59], v[184:191], v1
global_load_dwordx4 v[76:79], v0, s[76:77] offset:1024 sc1
s_waitcnt lgkmcnt(1)
v_smfmac_f32_16x16x64_bf16 v[36:39], v[60:63], v[16:23], v1
s_waitcnt lgkmcnt(0)
v_lshl_or_b32 v44, v44, 12, v45
v_smfmac_f32_16x16x64_bf16 v[36:39], v[12:15], v[24:31], v1
s_mov_b64 s[68:69], s[72:73]
ds_read_b128 v[24:27], v0 offset:47104
v_smfmac_f32_16x16x64_bf16 v[40:43], v[56:59], v[192:199], v1
ds_read_b128 v[28:31], v0 offset:48128
s_nop 0
v_smfmac_f32_16x16x64_bf16 v[32:35], v[56:59], v[240:247], v1
s_waitcnt vmcnt(5)
ds_read_b128 v[20:23], v0 offset:50176
v_cvt_pk_bf16_f32 v36, v36, v37
v_smfmac_f32_16x16x64_bf16 v[48:51], v[56:59], v[200:207], v1
ds_read_b128 v[16:19], v0 offset:49152
v_and_or_b32 v36, v36, -2, s18
v_cvt_pk_bf16_f32 v37, v38, v39
s_waitcnt vmcnt(4)
v_smfmac_f32_16x16x64_bf16 v[40:43], v[60:63], v[80:87], v1
global_store_dwordx2 v44, v[36:37], s[48:49]
s_waitcnt lgkmcnt(2)
v_smfmac_f32_16x16x64_bf16 v[40:43], v[12:15], v[24:31], v1
s_add_u32 s58, s4, s20
ds_read_b128 v[28:31], v0 offset:52224
v_smfmac_f32_16x16x64_bf16 v[48:51], v[60:63], v[208:215], v1
s_waitcnt lgkmcnt(2)
s_waitcnt lgkmcnt(1)
v_smfmac_f32_16x16x64_bf16 v[48:51], v[12:15], v[16:23], v1
s_nop 1
v_cvt_pk_bf16_f32 v40, v40, v41
v_cvt_pk_bf16_f32 v41, v42, v43
v_and_or_b32 v40, v40, -2, s18
v_smfmac_f32_16x16x64_bf16 v[52:55], v[56:59], v[216:223], v1
global_store_dwordx2 v44, v[40:41], s[50:51]
v_smfmac_f32_16x16x64_bf16 v[52:55], v[60:63], v[224:231], v1
s_addc_u32 s59, s5, 0
ds_read_b128 v[24:27], v0 offset:51200
v_cvt_pk_bf16_f32 v48, v48, v49
v_cvt_pk_bf16_f32 v49, v50, v51
v_and_or_b32 v48, v48, -2, s18
v_smfmac_f32_16x16x64_bf16 v[52:55], v[12:15], v[232:239], v1
global_store_dwordx2 v44, v[48:49], s[52:53]
v_smfmac_f32_16x16x64_bf16 v[32:35], v[60:63], v[248:255], v1
s_nop 1
s_waitcnt lgkmcnt(0)
v_smfmac_f32_16x16x64_bf16 v[32:35], v[12:15], v[24:31], v1
s_nop 1
v_cvt_pk_bf16_f32 v52, v52, v53
v_and_or_b32 v52, v52, -2, s18
v_cvt_pk_bf16_f32 v53, v54, v55
s_nop 0
global_store_dwordx2 v44, v[52:53], s[54:55]
s_nop 0
v_cvt_pk_bf16_f32 v32, v32, v33
v_cvt_pk_bf16_f32 v33, v34, v35
v_and_or_b32 v32, v32, -2, s18
global_store_dwordx2 v44, v[32:33], s[56:57]
s_cmp_ge_u32 s14, 16
s_cbranch_scc1 nored_10046
v_bfe_u32 v32, v0, 6, 1
v_lshlrev_b32 v32, 4, v32
v_mov_b32 v33, 0x3f80
v_lshlrev_b32 v32, v32, v33
v_bfe_i32 v33, v0, 4, 1
v_and_b32 v45, v32, v33
v_and_b32 v47, v32, v33
v_xor_b32 v44, v32, v45
v_xor_b32 v46, v32, v45
v_and_b32 v36, 32, v0
v_bfe_u32 v37, v0, 6, 1
v_lshl_add_u32 v36, v37, 8, v36
v_bfe_u32 v37, v0, 8, 1
v_lshl_add_u32 v36, v37, 4, v36
v_bfe_u32 v37, v0, 4, 1
v_lshl_add_u32 v36, v37, 3, v36
v_and_b32 v7, 255, v0
v_lshl_add_u32 v7, v7, 3, s27
s_nop 15
s_nop 15
s_nop 15
s_nop 15
s_nop 12
global_load_dwordx4 v[8:11], v0, s[64:65] offset:0 sc1
global_load_dwordx4 v[12:15], v0, s[64:65] offset:1024 sc1
global_load_dwordx4 v[16:19], v0, s[64:65] offset:2048 sc1
global_load_dwordx4 v[20:23], v0, s[64:65] offset:3072 sc1
s_nop 15
s_nop 15
s_nop 5
global_load_dwordx4 v[24:27], v0, s[64:65] offset:0 sc1
global_load_dwordx4 v[28:31], v0, s[64:65] offset:1024 sc1
global_load_dwordx4 v[48:51], v0, s[64:65] offset:2048 sc1
global_load_dwordx4 v[52:55], v0, s[64:65] offset:3072 sc1
chk_10048:
v_mov_b64 v[40:41], 0
v_mov_b64 v[42:43], 0
s_waitcnt vmcnt(6)
s_nop 0
v_smfmac_f32_16x16x64_bf16 v[40:43], v[44:47], v[8:15], v1
v_bitop3_b32 v32, v8, v10, s18 bitop3:0x7e
v_bitop3_b32 v33, v12, v14, s18 bitop3:0x7e
s_waitcnt vmcnt(4)
v_smfmac_f32_16x16x64_bf16 v[40:43], v[44:47], v[16:23], v1
v_bitop3_b32 v34, v16, v18, s18 bitop3:0x7e
v_bitop3_b32 v35, v20, v22, s18 bitop3:0x7e
v_or3_b32 v37, v32, v33, v34
v_bitop3_b32 v37, v37, v35, 1 bitop3:0xa8
v_cmp_ne_u32 vcc, 0, v37
s_cbranch_vccnz chk_10048_f
s_nop 1
v_add_f32_dpp v40, v40, v40 row_ror:8 row_mask:0xf bank_mask:0xf
v_add_f32_dpp v41, v41, v41 row_ror:8 row_mask:0xf bank_mask:0xf
v_add_f32_dpp v42, v42, v42 row_ror:8 row_mask:0xf bank_mask:0xf
v_add_f32_dpp v43, v43, v43 row_ror:8 row_mask:0xf bank_mask:0xf
v_cvt_pk_bf16_f32 v40, v40, v41
v_cvt_pk_bf16_f32 v41, v42, v43
v_and_or_b32 v40, v40, -2, s18
s_mov_b64 exec, 0x00ff00ff
global_store_dwordx2 v36, v[40:41], s[66:67]
s_mov_b64 exec, -1
s_branch join_10047
chk_10048_f:
global_load_dwordx4 v[8:11], v0, s[64:65] offset:0 sc1
global_load_dwordx4 v[12:15], v0, s[64:65] offset:1024 sc1
global_load_dwordx4 v[16:19], v0, s[64:65] offset:2048 sc1
global_load_dwordx4 v[20:23], v0, s[64:65] offset:3072 sc1
chk_10049:
v_mov_b64 v[40:41], 0
v_mov_b64 v[42:43], 0
s_waitcnt vmcnt(6)
s_nop 0
v_smfmac_f32_16x16x64_bf16 v[40:43], v[44:47], v[24:31], v1
v_bitop3_b32 v32, v24, v26, s18 bitop3:0x7e
v_bitop3_b32 v33, v28, v30, s18 bitop3:0x7e
s_waitcnt vmcnt(4)
v_smfmac_f32_16x16x64_bf16 v[40:43], v[44:47], v[48:55], v1
v_bitop3_b32 v34, v48, v50, s18 bitop3:0x7e
v_bitop3_b32 v35, v52, v54, s18 bitop3:0x7e
v_or3_b32 v37, v32, v33, v34
v_bitop3_b32 v37, v37, v35, 1 bitop3:0xa8
v_cmp_ne_u32 vcc, 0, v37
s_cbranch_vccnz chk_10049_f
s_nop 1
v_add_f32_dpp v40, v40, v40 row_ror:8 row_mask:0xf bank_mask:0xf
v_add_f32_dpp v41, v41, v41 row_ror:8 row_mask:0xf bank_mask:0xf
v_add_f32_dpp v42, v42, v42 row_ror:8 row_mask:0xf bank_mask:0xf
v_add_f32_dpp v43, v43, v43 row_ror:8 row_mask:0xf bank_mask:0xf
v_cvt_pk_bf16_f32 v40, v40, v41
v_cvt_pk_bf16_f32 v41, v42, v43
v_and_or_b32 v40, v40, -2, s18
s_mov_b64 exec, 0x00ff00ff
global_store_dwordx2 v36, v[40:41], s[66:67]
s_mov_b64 exec, -1
s_branch join_10047
chk_10049_f:
global_load_dwordx4 v[24:27], v0, s[64:65] offset:0 sc1
global_load_dwordx4 v[28:31], v0, s[64:65] offset:1024 sc1
global_load_dwordx4 v[48:51], v0, s[64:65] offset:2048 sc1
global_load_dwordx4 v[52:55], v0, s[64:65] offset:3072 sc1
s_add_u32 s30, s30, 1
s_cmp_le_u32 s30, 262144
s_cbranch_scc1 chk_10048
s_branch L_fail
nored_10046:
v_and_b32 v7, 255, v0
v_lshl_add_u32 v7, v7, 3, s27
join_10047:
s_barrier
global_load_dwordx4 v[56:59], v0, s[76:77] offset:-2048 sc1
global_load_dwordx4 v[60:63], v0, s[76:77] offset:-1024 sc1
global_load_dwordx4 v[80:83], v0, s[76:77] offset:2048 sc1
global_load_dwordx4 v[84:87], v0, s[76:77] offset:3072 sc1
s_nop 15
s_nop 15
s_nop 3
s_barrier
global_load_dwordx4 v[32:35], v0, s[68:69] offset:-4096 sc1
s_nop 10
global_load_dwordx4 v[36:39], v0, s[68:69] offset:0 sc1
s_barrier
global_load_dwordx4 v[24:27], v0, s[78:79] offset:-4096 sc1
global_load_dwordx4 v[28:31], v0, s[78:79] offset:-3072 sc1
global_load_dwordx4 v[48:51], v0, s[58:59] offset:0 nt sc1
global_load_dwordx4 v[52:55], v0, s[58:59] offset:1024 nt sc1
s_waitcnt vmcnt(14)
v_mov_b64 v[8:9], 0
v_mov_b64 v[10:11], 0
s_waitcnt vmcnt(13)
v_mov_b64 v[12:13], 0
v_mov_b64 v[14:15], 0
s_waitcnt vmcnt(12)
v_mov_b64 v[16:17], 0
v_mov_b64 v[18:19], 0
s_waitcnt vmcnt(11)
v_mov_b64 v[20:21], 0
v_mov_b64 v[22:23], 0
s_mov_b32 s30, 0
s_cmp_eq_u32 s17, s31
s_cbranch_scc0 gather_10038
s_branch exit_10041
rt_10043:
global_load_dwordx4 v[32:35], v0, s[68:69] offset:-4096 sc1
global_load_dwordx4 v[36:39], v0, s[68:69] offset:0 sc1
s_add_u32 s30, s30, 1
s_cmp_gt_u32 s30, 262144
s_cbranch_scc1 L_fail
s_mov_b64 exec, 1
global_store_dword v0, v0, s[62:63]
global_store_dword v0, v0, s[62:63]
global_store_dword v0, v0, s[62:63]
global_store_dword v0, v0, s[62:63]
s_mov_b64 exec, -1
v_mov_b64 v[8:9], 0
v_mov_b64 v[10:11], 0
v_mov_b64 v[12:13], 0
v_mov_b64 v[14:15], 0
v_mov_b64 v[16:17], 0
v_mov_b64 v[18:19], 0
v_mov_b64 v[20:21], 0
v_mov_b64 v[22:23], 0
s_branch gather_10038
rare_10039:
ds_read_b128 v[48:51], v6 offset:6144
ds_read_b128 v[52:55], v6 offset:7168
s_waitcnt lgkmcnt(0)
v_add_f32 v48, v48, v52
v_add_f32 v49, v49, v53
v_add_f32 v50, v50, v54
v_add_f32 v51, v51, v55
v_mov_b32_dpp v46, v46 quad_perm:[0,1,0,1] row_mask:0xf bank_mask:0xf
v_mov_b32_dpp v47, v47 quad_perm:[0,1,0,1] row_mask:0xf bank_mask:0xf
v_max3_f32 v19, v48, v49, v50
v_max3_f32 v19, v19, v51, v46
v_max_f32 v19, v19, v47
s_nop 1
v_max_f32_dpp v19, v19, v19 quad_perm:[2,3,0,1] row_mask:0xf bank_mask:0xf
v_mov_b32 v44, v19
s_nop 1
v_permlane32_swap_b32 v19, v44
v_max_f32 v19, v19, v44
v_mov_b32 v44, v19
s_nop 1
v_permlane16_swap_b32 v19, v44
v_max_f32 v19, v19, v44
v_sub_f32 v48, v48, v19
v_sub_f32 v49, v49, v19
v_sub_f32 v50, v50, v19
v_sub_f32 v51, v51, v19
v_sub_f32 v46, v46, v19
v_sub_f32 v47, v47, v19
v_exp_f32 v48, v48
v_exp_f32 v49, v49
v_exp_f32 v50, v50
v_exp_f32 v51, v51
v_cvt_pk_bf16_f32 v54, v48, v49
v_cvt_pk_bf16_f32 v55, v50, v51
s_nop 0
v_mov_b32_dpp v48, v54 quad_perm:[0,1,0,1] row_mask:0xf bank_mask:0xf
v_mov_b32_dpp v49, v55 quad_perm:[0,1,0,1] row_mask:0xf bank_mask:0xf
v_mov_b32_dpp v50, v54 quad_perm:[2,3,2,3] row_mask:0xf bank_mask:0xf
v_mov_b32_dpp v51, v55 quad_perm:[2,3,2,3] row_mask:0xf bank_mask:0xf
v_mov_b64 v[20:21], s[44:45]
v_mov_b64 v[22:23], s[44:45]
v_mfma_f32_16x16x32_bf16 v[8:11], v[56:59], v[48:51], 0
v_mfma_f32_16x16x32_bf16 v[12:15], v[60:63], v[48:51], 0
v_mfma_f32_16x16x32_bf16 v[16:19], v[20:23], v[48:51], 0
v_mov_b64 v[54:55], s[46:47]
v_exp_f32_dpp v44, v46 quad_perm:[0,1,0,1] row_mask:0xf bank_mask:0xf
v_exp_f32_dpp v45, v47 quad_perm:[0,1,0,1] row_mask:0xf bank_mask:0xf
s_nop 0
v_cvt_pk_bf16_f32 v52, v44, v45
v_cvt_pk_bf16_f32 v53, v44, v45
s_nop 1
v_mfma_f32_16x16x16_bf16 v[16:19], v[54:55], v[52:53], v[16:19]
v_mfma_f32_16x16x16_bf16 v[8:11], v[24:25], v[52:53], v[8:11]
v_mfma_f32_16x16x16_bf16 v[12:15], v[26:27], v[52:53], v[12:15]
s_nop 5
v_rcp_f32 v18, v16
s_nop 0
v_cndmask_b32 v8, v12, v8, s[42:43]
v_mul_f32 v8, v8, v18
v_cndmask_b32 v9, v13, v9, s[42:43]
v_mul_f32 v9, v9, v18
v_cndmask_b32 v10, v14, v10, s[42:43]
v_mul_f32 v10, v10, v18
v_cndmask_b32 v11, v15, v11, s[42:43]
v_mul_f32 v11, v11, v18
v_cvt_pk_bf16_f32 v12, v8, v9
v_cvt_pk_bf16_f32 v13, v10, v11
s_branch back_10040
exit_10041:
global_load_dwordx4 v[32:35], v0, s[68:69] offset:-4096 sc1
global_load_dwordx4 v[36:39], v0, s[68:69] offset:0 sc1
s_add_u32 s30, s30, 1
s_cmp_gt_u32 s30, 262144
s_cbranch_scc1 L_fail
s_waitcnt vmcnt(1)
v_bitop3_b32 v44, v32, v34, s18 bitop3:0x7e
s_waitcnt vmcnt(0)
v_bitop3_b32 v45, v36, v38, s18 bitop3:0x7e
v_bitop3_b32 v44, v44, v45, s19 bitop3:0xa8
v_cmp_ne_u32 vcc, 0, v44
s_cbranch_vccnz exit_10041
s_add_u32 s36, s36, 1
s_cmp_lt_u32 s36, 2
s_cbranch_scc1 layer_10037
s_endpgm
wave_10008:
layer_10050:
s_lshl_b32 s17, s36, 6
s_mul_i32 s27, s36, 35651584
s_mul_i32 s28, s14, 16384
s_add_u32 s27, s27, s28
s_add_u32 s20, s27, 16789504
s_mul_i32 s27, s17, 10240
s_add_u32 s27, s27, s24
s_add_u32 s21, s27, s25
s_mov_b32 s19, 0
s_mov_b32 s33, s6
s_add_u32 s34, s17, 1
s_add_u32 s31, s17, 63
s_add_u32 s32, s17, 64
s_mov_b32 s27, s20
v_mov_b32 v7, 0
s_add_u32 s68, s4, 416768
s_addc_u32 s69, s5, 0
s_add_u32 s72, s4, 400384
s_addc_u32 s73, s5, 0
s_add_u32 s70, s4, 420864
s_addc_u32 s71, s5, 0
s_add_u32 s74, s4, 404480
s_addc_u32 s75, s5, 0
s_add_u32 s58, s4, s20
s_addc_u32 s59, s5, 0
global_load_dwordx4 v[64:67], v0, s[76:77] offset:-4096 sc1
global_load_dwordx4 v[68:71], v0, s[76:77] offset:-3072 sc1
global_load_dwordx4 v[72:75], v0, s[76:77] offset:0 sc1
global_load_dwordx4 v[76:79], v0, s[76:77] offset:1024 sc1
global_load_dwordx4 v[80:83], v0, s[76:77] offset:2048 sc1
global_load_dwordx4 v[84:87], v0, s[76:77] offset:3072 sc1
global_load_dwordx4 v[56:59], v0, s[76:77] offset:-2048 sc1
global_load_dwordx4 v[60:63], v0, s[76:77] offset:-1024 sc1
global_load_dwordx4 v[24:27], v0, s[78:79] offset:-4096 sc1
global_load_dwordx4 v[28:31], v0, s[78:79] offset:-3072 sc1
v_mov_b64 v[8:9], 0
v_mov_b64 v[10:11], 0
v_mov_b64 v[12:13], 0
v_mov_b64 v[14:15], 0
v_mov_b64 v[16:17], 0
v_mov_b64 v[18:19], 0
v_mov_b64 v[20:21], 0
v_mov_b64 v[22:23], 0
s_barrier
global_load_dwordx4 v[48:51], v0, s[58:59] offset:0 nt sc1
global_load_dwordx4 v[52:55], v0, s[58:59] offset:1024 nt sc1
v_and_b32 v7, 128, v0
v_add_u32 v7, s22, v7
s_mov_b32 exec_hi, 0
v_and_b32 v7, 255, v0
v_lshl_add_u32 v7, v7, 3, s27
s_mov_b32 exec_hi, -1
global_load_dwordx4 v[32:35], v0, s[68:69] offset:-4096 sc1
global_load_dwordx4 v[36:39], v0, s[68:69] offset:0 sc1
s_mov_b32 s30, 0
s_waitcnt vmcnt(0)
.p2align 6
gather_10051:
s_waitcnt vmcnt(5)
rt_10056_b:
v_smfmac_f32_16x16x64_bf16 v[12:15], v[32:35], v[56:63], v1
ds_write_b128 v0, v[32:35] offset:3072
v_smfmac_f32_16x16x64_bf16 v[20:23], v[32:35], v[72:79], v1
v_bitop3_b32 v44, v32, v34, s18 bitop3:0x7e
v_smfmac_f32_16x16x64_bf16 v[8:11], v[32:35], v[64:71], v1
s_waitcnt vmcnt(4)
ds_write_b128 v0, v[36:39] offset:7168
v_bitop3_b32 v45, v36, v38, s18 bitop3:0x7e
v_smfmac_f32_16x16x64_bf16 v[8:11], v[36:39], v[80:87], v1
v_bitop3_b32 v44, v44, v45, s19 bitop3:0xa8
v_cmp_ne_u32 vcc, 0, v44
v_smfmac_f32_16x16x64_bf16 v[20:23], v[36:39], a[24:31], v1
s_cbranch_vccnz rt_10056
ds_read_b128 v[76:79], v2 offset:1024
global_load_dwordx4 v[64:67], v0, s[78:79] offset:-2048 sc1
ds_read_b128 v[72:75], v2 offset:0
global_load_dwordx4 v[68:71], v0, s[78:79] offset:-1024 sc1
ds_read_b128 v[84:87], v2 offset:5120
s_waitcnt lgkmcnt(3)
s_barrier
ds_read_b128 v[40:43], v0 offset:2048
v_smfmac_f32_16x16x64_bf16 v[16:19], v[32:35], a[0:7], v1
ds_read_b128 v[44:47], v0 offset:6144
global_load_dwordx4 v[56:59], v0, s[58:59] offset:2048 nt sc1
ds_read_b128 v[32:35], v0 offset:1024
v_smfmac_f32_16x16x64_bf16 v[12:15], v[36:39], a[8:15], v1
s_mov_b32 s30, 0
ds_read_b128 v[80:83], v2 offset:4096
v_smfmac_f32_16x16x64_bf16 v[16:19], v[36:39], a[16:23], v1
s_waitcnt lgkmcnt(5)
ds_read_b128 v[36:39], v0 offset:5120
global_load_dwordx4 v[60:63], v0, s[58:59] offset:3072 nt sc1
s_waitcnt lgkmcnt(4)
v_smfmac_f32_16x16x64_bf16 v[8:11], v[40:43], v[72:79], v1
ds_read_b128 v[72:75], v2 offset:2048
v_smfmac_f32_16x16x64_bf16 v[12:15], v[40:43], a[32:39], v1
s_waitcnt lgkmcnt(4)
ds_read_b128 v[40:43], v0 offset:0
v_smfmac_f32_16x16x64_bf16 v[8:11], v[44:47], a[40:47], v1
s_waitcnt lgkmcnt(4)
ds_read_b128 v[76:79], v2 offset:3072
s_waitcnt vmcnt(6)
v_smfmac_f32_16x16x64_bf16 v[12:15], v[44:47], v[24:31], v1
ds_read_b128 v[28:31], v2 offset:7168
v_smfmac_f32_16x16x64_bf16 v[12:15], v[32:35], a[56:63], v1
s_mov_b32 s19, 1
ds_read_b128 v[24:27], v2 offset:6144
v_smfmac_f32_16x16x64_bf16 v[8:11], v[32:35], a[48:55], v1
s_waitcnt lgkmcnt(4)
ds_read_b128 v[44:47], v0 offset:4096
v_smfmac_f32_16x16x64_bf16 v[12:15], v[36:39], a[64:71], v1
ds_read_b128 v[32:35], v0 offset:9216
s_waitcnt lgkmcnt(4)
v_smfmac_f32_16x16x64_bf16 v[8:11], v[36:39], v[72:79], v1
ds_read_b128 v[36:39], v0 offset:8192
s_waitcnt lgkmcnt(4)
v_smfmac_f32_16x16x64_bf16 v[8:11], v[40:43], v[80:87], v1
ds_read_b128 v[84:87], v2 offset:9216
s_waitcnt lgkmcnt(4)
v_smfmac_f32_16x16x64_bf16 v[12:15], v[40:43], v[24:31], v1
ds_read_b128 v[80:83], v2 offset:8192
s_waitcnt lgkmcnt(4)
v_smfmac_f32_16x16x64_bf16 v[12:15], v[44:47], a[80:87], v1
ds_read_b128 v[76:79], v2 offset:11264
s_waitcnt lgkmcnt(4)
v_smfmac_f32_16x16x64_bf16 v[12:15], v[32:35], a[88:95], v1
ds_read_b128 v[72:75], v2 offset:10240
s_waitcnt lgkmcnt(4)
v_smfmac_f32_16x16x64_bf16 v[8:11], v[44:47], a[72:79], v1
ds_read_b128 v[40:43], v0 offset:2048
global_load_dword v7, v7, s[4:5] sc1
ds_read_b128 v[28:31], v2 offset:13312
s_waitcnt lgkmcnt(4)
v_smfmac_f32_16x16x64_bf16 v[8:11], v[32:35], v[80:87], v1
s_waitcnt vmcnt(3)
ds_read_b128 v[24:27], v2 offset:12288
v_smfmac_f32_16x16x64_bf16 v[8:11], v[36:39], a[96:103], v1
s_nop 0
ds_read_b128 v[32:35], v0 offset:6144
s_waitcnt lgkmcnt(4)
v_smfmac_f32_16x16x64_bf16 v[12:15], v[36:39], v[72:79], v1
s_nop 0
ds_read_b128 v[36:39], v0 offset:1024
s_waitcnt lgkmcnt(4)
ds_read_b128 v[72:75], v2 offset:16384
v_add_f32 v9, v9, v11
v_smfmac_f32_16x16x64_bf16 v[16:19], v[40:43], a[104:111], v1
s_xor_b32 s18, s18, 1
ds_read_b128 v[76:79], v2 offset:17408
v_add_f32 v8, v8, v10
v_smfmac_f32_16x16x64_bf16 v[20:23], v[40:43], a[112:119], v1
s_waitcnt lgkmcnt(5)
ds_read_b128 v[40:43], v0 offset:5120
v_add_f32 v12, v12, v14
v_mul_f32 v9, s35, v9
s_waitcnt lgkmcnt(4)
v_smfmac_f32_16x16x64_bf16 v[16:19], v[32:35], v[24:31], v1
ds_read_b128 v[84:87], v2 offset:15360
v_mul_f32 v8, s35, v8
v_cvt_pk_bf16_f32 v8, v8, v9
v_smfmac_f32_16x16x64_bf16 v[20:23], v[32:35], v[64:71], v1
s_waitcnt lgkmcnt(4)
ds_read_b128 v[80:83], v2 offset:14336
v_add_f32 v13, v13, v15
v_smfmac_f32_16x16x64_bf16 v[20:23], v[36:39], a[128:135], v1
ds_read_b128 v[32:35], v0 offset:0
v_mul_f32 v12, s35, v12
v_mul_f32 v13, s35, v13
v_smfmac_f32_16x16x64_bf16 v[16:19], v[36:39], a[120:127], v1
s_waitcnt lgkmcnt(3)
ds_read_b128 v[36:39], v0 offset:4096
v_cvt_pk_bf16_f32 v12, v12, v13
v_smfmac_f32_16x16x64_bf16 v[20:23], v[40:43], a[144:151], v1
ds_write2_b32 v3, v8, v12 offset0:0 offset1:128
v_mov_b64 v[26:27], 0
v_smfmac_f32_16x16x64_bf16 v[16:19], v[40:43], a[136:143], v1
s_waitcnt lgkmcnt(2)
ds_read_b128 v[40:43], v0 offset:9216
v_smfmac_f32_16x16x64_bf16 v[16:19], v[32:35], a[152:159], v1
s_mov_b64 vcc, s[42:43]
ds_read_b128 v[68:71], v2 offset:19456
v_mov_b64 v[30:31], 0
v_smfmac_f32_16x16x64_bf16 v[20:23], v[32:35], a[160:167], v1
s_waitcnt lgkmcnt(3)
ds_read_b128 v[32:35], v0 offset:8192
v_mov_b64 v[24:25], 0
v_smfmac_f32_16x16x64_bf16 v[20:23], v[36:39], v[80:87], v1
s_add_u32 s20, s20, 524288
ds_read_b128 v[64:67], v2 offset:18432
v_mov_b64 v[28:29], 0
v_smfmac_f32_16x16x64_bf16 v[16:19], v[36:39], a[168:175], v1
ds_read_b128 v[36:39], v0 offset:9216
s_waitcnt lgkmcnt(4)
v_smfmac_f32_16x16x64_bf16 v[20:23], v[40:43], v[72:79], v1
s_barrier
ds_read_b64_tr_b16 v[8:9], v4 offset:2048
v_smfmac_f32_16x16x64_bf16 v[16:19], v[40:43], a[176:183], v1
s_waitcnt lgkmcnt(3)
ds_read_b64_tr_b16 v[14:15], v4 offset:3584
ds_read_b64_tr_b16 v[10:11], v4 offset:2560
v_smfmac_f32_16x16x64_bf16 v[16:19], v[32:35], a[184:191], v1
s_nop 0
ds_read_b64_tr_b16 v[12:13], v4 offset:3072
ds_read_b128 v[40:43], v0 offset:8192
v_smfmac_f32_16x16x64_bf16 v[20:23], v[32:35], a[192:199], v1
s_add_u32 s17, s17, 1
ds_read_b128 v[72:75], v2 offset:20480
s_waitcnt lgkmcnt(6)
ds_read_b128 v[80:83], v0 offset:53248
v_add_f32 v17, v17, v19
v_add_f32 v16, v16, v18
v_cvt_pk_bf16_f32 v16, v16, v17
v_smfmac_f32_16x16x64_bf16 v[24:27], v[36:39], a[200:207], v1
s_waitcnt lgkmcnt(6)
ds_read_b128 v[76:79], v2 offset:21504
s_waitcnt lgkmcnt(5)
v_mfma_f32_16x16x32_bf16 v[44:47], v[48:51], v[8:11], 0
s_waitcnt lgkmcnt(4)
ds_read_b128 v[84:87], v0 offset:54272
v_add_f32 v21, v21, v23
v_mfma_f32_16x16x32_bf16 v[44:47], v[52:55], v[12:15], v[44:47]
ds_read_b128 v[32:35], v0 offset:3072
v_bfe_u32 v48, v0, 5, 1
v_add_f32 v20, v20, v22
v_cvt_pk_bf16_f32 v20, v20, v21
v_smfmac_f32_16x16x64_bf16 v[28:31], v[36:39], a[208:215], v1
s_waitcnt lgkmcnt(5)
ds_write2_b32 v3, v16, v20 offset0:1 offset1:129
v_lshl_add_u32 v48, v48, 3, v5
v_cndmask_b32_dpp v45, v47, v45, vcc quad_perm:[0,1,0,1] row_mask:0xf bank_mask:0xf
v_smfmac_f32_16x16x64_bf16 v[24:27], v[40:43], v[64:71], v1
s_add_u32 s21, s21, 10240
ds_read_b128 v[36:39], v0 offset:7168
v_cndmask_b32_dpp v44, v46, v44, vcc quad_perm:[0,1,0,1] row_mask:0xf bank_mask:0xf
v_xor_b32 v48, 128, v48
v_smfmac_f32_16x16x64_bf16 v[28:31], v[40:43], a[216:223], v1
s_waitcnt lgkmcnt(2)
ds_write_b64 v48, v[44:45] offset:7680
v_smfmac_f32_16x16x64_bf16 v[24:27], v[32:35], v[72:79], v1
global_load_dwordx4 v[64:67], v0, s[78:79] offset:0 sc1
ds_read_b128 v[72:75], v2 offset:22528
v_smfmac_f32_16x16x64_bf16 v[28:31], v[32:35], a[224:231], v1
ds_read_b128 v[40:43], v0 offset:2048
s_waitcnt lgkmcnt(3)
v_smfmac_f32_16x16x64_bf16 v[28:31], v[36:39], a[240:247], v1
ds_read_b128 v[76:79], v2 offset:23552
global_load_dwordx4 v[68:71], v0, s[78:79] offset:1024 sc1
ds_read_b128 v[32:35], v0 offset:6144
v_smfmac_f32_16x16x64_bf16 v[24:27], v[36:39], a[232:239], v1
s_waitcnt lgkmcnt(4)
ds_read_b128 v[36:39], v0 offset:1024
s_barrier
ds_read_b128 v[48:51], v6 offset:6144
s_waitcnt lgkmcnt(4)
v_smfmac_f32_16x16x64_bf16 v[28:31], v[40:43], v[80:87], v1
s_add_u32 s34, s17, 2
ds_read_b64_tr_b16 v[22:23], v4 offset:3584
s_waitcnt lgkmcnt(4)
ds_read_b128 v[52:55], v6 offset:7168
v_smfmac_f32_16x16x64_bf16 v[24:27], v[40:43], v[72:79], v1
ds_read_b128 v[40:43], v0 offset:5120
s_waitcnt lgkmcnt(5)
ds_read_b64_tr_b16 v[8:9], v4 offset:0
v_smfmac_f32_16x16x64_bf16 v[24:27], v[32:35], a[248:255], v1
s_waitcnt lgkmcnt(5)
ds_read_b64_tr_b16 v[16:17], v4 offset:2048
global_load_dwordx4 v[72:75], v0, s[78:79] offset:2048 sc1
ds_read_b64_tr_b16 v[18:19], v4 offset:2560
v_smfmac_f32_16x16x64_bf16 v[28:31], v[32:35], v[88:95], v1
global_load_dwordx4 v[76:79], v0, s[78:79] offset:3072 sc1
ds_read_b128 v[32:35], v0 offset:0
v_smfmac_f32_16x16x64_bf16 v[24:27], v[36:39], v[96:103], v1
s_waitcnt lgkmcnt(5)
ds_read_b64_tr_b16 v[10:11], v4 offset:512
v_add_f32 v49, v49, v53
v_smfmac_f32_16x16x64_bf16 v[28:31], v[36:39], v[104:111], v1
s_waitcnt lgkmcnt(5)
ds_read_b64_tr_b16 v[12:13], v4 offset:1024
v_add_f32 v48, v48, v52
v_add_f32 v50, v50, v54
v_smfmac_f32_16x16x64_bf16 v[24:27], v[40:43], v[112:119], v1
ds_read_b128 v[36:39], v0 offset:4096
v_exp_f32 v49, v49
v_smfmac_f32_16x16x64_bf16 v[28:31], v[40:43], v[120:127], v1
s_waitcnt lgkmcnt(3)
ds_read_b64_tr_b16 v[14:15], v4 offset:1536
v_add_f32 v51, v51, v55
v_smfmac_f32_16x16x64_bf16 v[28:31], v[32:35], v[136:143], v1
s_waitcnt lgkmcnt(3)
ds_read_b64_tr_b16 v[20:21], v4 offset:3072
v_exp_f32 v51, v51
v_mfma_f32_16x16x32_bf16 v[44:47], v[8:11], v[8:11], 0
v_exp_f32 v48, v48
v_exp_f32 v50, v50
v_smfmac_f32_16x16x64_bf16 v[24:27], v[32:35], v[128:135], v1
s_waitcnt lgkmcnt(1)
s_min_u32 s34, s34, s32
v_cvt_pk_bf16_f32 v55, v50, v51
v_mfma_f32_16x16x32_bf16 v[44:47], v[12:15], v[12:15], v[44:47]
s_nop 0
v_mov_b32_dpp v51, v55 quad_perm:[2,3,2,3] row_mask:0xf bank_mask:0xf
v_cvt_pk_bf16_f32 v54, v48, v49
v_mfma_f32_16x16x32_bf16 v[44:47], v[16:19], v[16:19], v[44:47]
s_waitcnt lgkmcnt(0)
v_mov_b32_dpp v48, v54 quad_perm:[0,1,0,1] row_mask:0xf bank_mask:0xf
v_mov_b32_dpp v49, v55 quad_perm:[0,1,0,1] row_mask:0xf bank_mask:0xf
v_mov_b32_dpp v50, v54 quad_perm:[2,3,2,3] row_mask:0xf bank_mask:0xf
v_mfma_f32_16x16x32_bf16 v[44:47], v[20:23], v[20:23], v[44:47]
s_add_u32 s27, s20, 524288
v_mov_b64 v[20:21], s[44:45]
v_mov_b64 v[22:23], s[44:45]
v_smfmac_f32_16x16x64_bf16 v[24:27], v[36:39], v[144:151], v1
s_waitcnt vmcnt(5)
global_load_dwordx4 v[80:83], v0, s[80:81] offset:-4096 sc1
v_mfma_f32_16x16x32_bf16 v[16:19], v[20:23], v[48:51], 0
s_nop 0
v_exp_f32_dpp v44, v46 quad_perm:[0,1,0,1] row_mask:0xf bank_mask:0xf
v_mfma_f32_16x16x32_bf16 v[8:11], v[56:59], v[48:51], 0
v_exp_f32_dpp v45, v47 quad_perm:[0,1,0,1] row_mask:0xf bank_mask:0xf
v_mov_b64 v[54:55], s[46:47]
v_smfmac_f32_16x16x64_bf16 v[28:31], v[36:39], v[152:159], v1
global_load_dwordx4 v[84:87], v0, s[80:81] offset:-3072 sc1
v_cvt_pk_bf16_f32 v52, v44, v45
v_mfma_f32_16x16x32_bf16 v[12:15], v[60:63], v[48:51], 0
v_cvt_pk_bf16_f32 v53, v44, v45
v_cvt_pk_bf16_f32 v24, v24, v25
v_cvt_pk_bf16_f32 v25, v26, v27
v_mfma_f32_16x16x16_bf16 v[16:19], v[54:55], v[52:53], v[16:19]
s_nop 0
v_cvt_pk_bf16_f32 v27, v30, v31
v_cvt_pk_bf16_f32 v26, v28, v29
v_mfma_f32_16x16x16_bf16 v[8:11], v[24:25], v[52:53], v[8:11]
v_bfe_u32 v32, v0, 5, 1
v_mov_b64 v[38:39], 0
v_mfma_f32_16x16x16_bf16 v[12:15], v[26:27], v[52:53], v[12:15]
s_nop 0
v_mov_b64 v[42:43], 0
v_rcp_f32 v18, v16
v_mov_b64 v[36:37], 0
v_lshl_add_u32 v32, v32, 3, v5
v_subrev_u32 v17, s37, v16
v_mov_b64 v[40:41], 0
v_cmp_lt_u32 vcc, s38, v17
v_cndmask_b32 v9, v13, v9, s[42:43]
v_cndmask_b32 v11, v15, v11, s[42:43]
v_mul_f32 v11, v11, v18
v_cndmask_b32 v10, v14, v10, s[42:43]
v_mul_f32 v10, v10, v18
v_cndmask_b32 v8, v12, v8, s[42:43]
v_mul_f32 v9, v9, v18
v_mul_f32 v8, v8, v18
v_cvt_pk_bf16_f32 v12, v8, v9
v_cvt_pk_bf16_f32 v13, v10, v11
s_cbranch_vccnz rare_10052
back_10053:
ds_write_b64 v32, v[12:13] offset:1536
v_mov_b32_dpp v10, v12 quad_perm:[2,3,2,3] row_mask:0xf bank_mask:0xf
v_mov_b32_dpp v8, v12 quad_perm:[0,1,0,1] row_mask:0xf bank_mask:0xf
v_mov_b32_dpp v9, v13 quad_perm:[0,1,0,1] row_mask:0xf bank_mask:0xf
v_mov_b32_dpp v11, v13 quad_perm:[2,3,2,3] row_mask:0xf bank_mask:0xf
v_mov_b64 v[52:53], 0
s_waitcnt vmcnt(4)
v_smfmac_f32_16x16x64_bf16 v[40:43], v[8:11], v[64:71], v1
ds_read_b128 v[16:19], v0 offset:55296
global_load_dwordx4 v[64:67], v0, s[76:77] offset:-4096 sc1
ds_read_b128 v[28:31], v0 offset:58368
v_mov_b64 v[54:55], 0
v_mov_b64 v[48:49], 0
v_mov_b64 v[32:33], 0
v_smfmac_f32_16x16x64_bf16 v[52:55], v[8:11], v[176:183], v1
s_waitcnt lgkmcnt(2)
ds_read_b128 v[24:27], v0 offset:57344
global_load_dwordx4 v[68:71], v0, s[76:77] offset:-3072 sc1
ds_read_b128 v[20:23], v0 offset:56320
s_barrier
ds_read_b128 v[56:59], v5 offset:1024
v_mov_b64 v[50:51], 0
v_smfmac_f32_16x16x64_bf16 v[36:39], v[8:11], v[160:167], v1
s_waitcnt vmcnt(5)
ds_read_b128 v[60:63], v5 offset:512
v_mov_b64 v[34:35], 0
v_smfmac_f32_16x16x64_bf16 v[48:51], v[8:11], v[168:175], v1
ds_read_b128 v[12:15], v5 offset:0
v_bfe_u32 v45, v0, 1, 7
v_lshrrev_b32 v44, 8, v0
s_waitcnt vmcnt(4)
v_smfmac_f32_16x16x64_bf16 v[32:35], v[8:11], v[72:79], v1
global_load_dwordx4 v[72:75], v0, s[76:77] offset:0 sc1
s_waitcnt lgkmcnt(2)
v_smfmac_f32_16x16x64_bf16 v[36:39], v[56:59], v[184:191], v1
global_load_dwordx4 v[76:79], v0, s[76:77] offset:1024 sc1
s_waitcnt lgkmcnt(1)
v_smfmac_f32_16x16x64_bf16 v[36:39], v[60:63], v[16:23], v1
s_waitcnt lgkmcnt(0)
v_lshl_or_b32 v44, v44, 12, v45
v_smfmac_f32_16x16x64_bf16 v[36:39], v[12:15], v[24:31], v1
s_mov_b64 s[68:69], s[72:73]
ds_read_b128 v[24:27], v0 offset:59392
v_smfmac_f32_16x16x64_bf16 v[40:43], v[56:59], v[192:199], v1
ds_read_b128 v[28:31], v0 offset:60416
s_nop 0
v_smfmac_f32_16x16x64_bf16 v[32:35], v[56:59], v[240:247], v1
s_waitcnt vmcnt(5)
ds_read_b128 v[20:23], v0 offset:62464
v_cvt_pk_bf16_f32 v36, v36, v37
v_smfmac_f32_16x16x64_bf16 v[48:51], v[56:59], v[200:207], v1
ds_read_b128 v[16:19], v0 offset:61440
v_and_or_b32 v36, v36, -2, s18
v_cvt_pk_bf16_f32 v37, v38, v39
s_waitcnt vmcnt(4)
v_smfmac_f32_16x16x64_bf16 v[40:43], v[60:63], v[80:87], v1
global_store_dwordx2 v44, v[36:37], s[48:49]
s_waitcnt lgkmcnt(2)
v_smfmac_f32_16x16x64_bf16 v[40:43], v[12:15], v[24:31], v1
s_add_u32 s58, s4, s20
ds_read_b128 v[28:31], v0 offset:64512
v_smfmac_f32_16x16x64_bf16 v[48:51], v[60:63], v[208:215], v1
s_waitcnt lgkmcnt(2)
s_waitcnt lgkmcnt(1)
v_smfmac_f32_16x16x64_bf16 v[48:51], v[12:15], v[16:23], v1
s_nop 1
v_cvt_pk_bf16_f32 v40, v40, v41
v_cvt_pk_bf16_f32 v41, v42, v43
v_and_or_b32 v40, v40, -2, s18
v_smfmac_f32_16x16x64_bf16 v[52:55], v[56:59], v[216:223], v1
global_store_dwordx2 v44, v[40:41], s[50:51]
v_smfmac_f32_16x16x64_bf16 v[52:55], v[60:63], v[224:231], v1
s_addc_u32 s59, s5, 0
ds_read_b128 v[24:27], v0 offset:63488
v_cvt_pk_bf16_f32 v48, v48, v49
v_cvt_pk_bf16_f32 v49, v50, v51
v_and_or_b32 v48, v48, -2, s18
v_smfmac_f32_16x16x64_bf16 v[52:55], v[12:15], v[232:239], v1
global_store_dwordx2 v44, v[48:49], s[52:53]
v_smfmac_f32_16x16x64_bf16 v[32:35], v[60:63], v[248:255], v1
s_nop 1
s_waitcnt lgkmcnt(0)
v_smfmac_f32_16x16x64_bf16 v[32:35], v[12:15], v[24:31], v1
s_nop 1
v_cvt_pk_bf16_f32 v52, v52, v53
v_and_or_b32 v52, v52, -2, s18
v_cvt_pk_bf16_f32 v53, v54, v55
s_nop 0
global_store_dwordx2 v44, v[52:53], s[54:55]
s_nop 0
v_cvt_pk_bf16_f32 v32, v32, v33
v_cvt_pk_bf16_f32 v33, v34, v35
v_and_or_b32 v32, v32, -2, s18
global_store_dwordx2 v44, v[32:33], s[56:57]
nored_10059:
v_cmp_gt_u32 vcc, s34, v7
s_cmp_eq_u32 vcc_hi, 0
s_cbranch_scc1 kv_10063
s_mov_b32 s30, 0
kv_10062:
v_and_b32 v7, 128, v0
buffer_load_dword v7, v7, s[4:7], s22 offen sc1
s_add_u32 s30, s30, 1
s_cmp_gt_u32 s30, 262144
s_cbranch_scc1 L_fail
s_waitcnt vmcnt(0)
v_cmp_gt_u32 vcc, s34, v7
s_cbranch_vccnz kv_10062
kv_10063:
v_and_b32 v7, 128, v0
v_add_u32 v7, s22, v7
s_mov_b32 exec_hi, 0
v_and_b32 v7, 255, v0
v_lshl_add_u32 v7, v7, 3, s27
s_mov_b32 exec_hi, -1
join_10060:
s_barrier
global_load_dwordx4 v[56:59], v0, s[76:77] offset:-2048 sc1
global_load_dwordx4 v[60:63], v0, s[76:77] offset:-1024 sc1
global_load_dwordx4 v[80:83], v0, s[76:77] offset:2048 sc1
global_load_dwordx4 v[84:87], v0, s[76:77] offset:3072 sc1
s_nop 15
s_nop 15
s_nop 3
s_barrier
global_load_dwordx4 v[32:35], v0, s[68:69] offset:-4096 sc1
s_nop 10
global_load_dwordx4 v[36:39], v0, s[68:69] offset:0 sc1
s_barrier
global_load_dwordx4 v[24:27], v0, s[78:79] offset:-4096 sc1
global_load_dwordx4 v[28:31], v0, s[78:79] offset:-3072 sc1
global_load_dwordx4 v[48:51], v0, s[58:59] offset:0 nt sc1
global_load_dwordx4 v[52:55], v0, s[58:59] offset:1024 nt sc1
v_mov_b64 v[8:9], 0
v_mov_b64 v[10:11], 0
v_mov_b64 v[12:13], 0
v_mov_b64 v[14:15], 0
v_mov_b64 v[16:17], 0
v_mov_b64 v[18:19], 0
v_mov_b64 v[20:21], 0
v_mov_b64 v[22:23], 0
s_mov_b32 s30, 0
s_cmp_eq_u32 s17, s31
s_cbranch_scc0 gather_10051
s_branch exit_10054
rt_10056:
global_load_dwordx4 v[32:35], v0, s[68:69] offset:-4096 sc1
global_load_dwordx4 v[36:39], v0, s[68:69] offset:0 sc1
s_add_u32 s30, s30, 1
s_cmp_gt_u32 s30, 262144
s_cbranch_scc1 L_fail
s_mov_b64 exec, 1
global_store_dword v0, v0, s[62:63]
global_store_dword v0, v0, s[62:63]
global_store_dword v0, v0, s[62:63]
global_store_dword v0, v0, s[62:63]
s_mov_b64 exec, -1
v_mov_b64 v[8:9], 0
v_mov_b64 v[10:11], 0
v_mov_b64 v[12:13], 0
v_mov_b64 v[14:15], 0
v_mov_b64 v[16:17], 0
v_mov_b64 v[18:19], 0
v_mov_b64 v[20:21], 0
v_mov_b64 v[22:23], 0
s_branch gather_10051
rare_10052:
ds_read_b128 v[48:51], v6 offset:6144
ds_read_b128 v[52:55], v6 offset:7168
s_waitcnt lgkmcnt(0)
v_add_f32 v48, v48, v52
v_add_f32 v49, v49, v53
v_add_f32 v50, v50, v54
v_add_f32 v51, v51, v55
v_mov_b32_dpp v46, v46 quad_perm:[0,1,0,1] row_mask:0xf bank_mask:0xf
v_mov_b32_dpp v47, v47 quad_perm:[0,1,0,1] row_mask:0xf bank_mask:0xf
v_max3_f32 v19, v48, v49, v50
v_max3_f32 v19, v19, v51, v46
v_max_f32 v19, v19, v47
s_nop 1
v_max_f32_dpp v19, v19, v19 quad_perm:[2,3,0,1] row_mask:0xf bank_mask:0xf
v_mov_b32 v44, v19
s_nop 1
v_permlane32_swap_b32 v19, v44
v_max_f32 v19, v19, v44
v_mov_b32 v44, v19
s_nop 1
v_permlane16_swap_b32 v19, v44
v_max_f32 v19, v19, v44
v_sub_f32 v48, v48, v19
v_sub_f32 v49, v49, v19
v_sub_f32 v50, v50, v19
v_sub_f32 v51, v51, v19
v_sub_f32 v46, v46, v19
v_sub_f32 v47, v47, v19
v_exp_f32 v48, v48
v_exp_f32 v49, v49
v_exp_f32 v50, v50
v_exp_f32 v51, v51
v_cvt_pk_bf16_f32 v54, v48, v49
v_cvt_pk_bf16_f32 v55, v50, v51
s_nop 0
v_mov_b32_dpp v48, v54 quad_perm:[0,1,0,1] row_mask:0xf bank_mask:0xf
v_mov_b32_dpp v49, v55 quad_perm:[0,1,0,1] row_mask:0xf bank_mask:0xf
v_mov_b32_dpp v50, v54 quad_perm:[2,3,2,3] row_mask:0xf bank_mask:0xf
v_mov_b32_dpp v51, v55 quad_perm:[2,3,2,3] row_mask:0xf bank_mask:0xf
v_mov_b64 v[20:21], s[44:45]
v_mov_b64 v[22:23], s[44:45]
v_mfma_f32_16x16x32_bf16 v[8:11], v[56:59], v[48:51], 0
v_mfma_f32_16x16x32_bf16 v[12:15], v[60:63], v[48:51], 0
v_mfma_f32_16x16x32_bf16 v[16:19], v[20:23], v[48:51], 0
v_mov_b64 v[54:55], s[46:47]
v_exp_f32_dpp v44, v46 quad_perm:[0,1,0,1] row_mask:0xf bank_mask:0xf
v_exp_f32_dpp v45, v47 quad_perm:[0,1,0,1] row_mask:0xf bank_mask:0xf
s_nop 0
v_cvt_pk_bf16_f32 v52, v44, v45
v_cvt_pk_bf16_f32 v53, v44, v45
s_nop 1
v_mfma_f32_16x16x16_bf16 v[16:19], v[54:55], v[52:53], v[16:19]
v_mfma_f32_16x16x16_bf16 v[8:11], v[24:25], v[52:53], v[8:11]
v_mfma_f32_16x16x16_bf16 v[12:15], v[26:27], v[52:53], v[12:15]
s_nop 5
v_rcp_f32 v18, v16
s_nop 0
v_cndmask_b32 v8, v12, v8, s[42:43]
v_mul_f32 v8, v8, v18
v_cndmask_b32 v9, v13, v9, s[42:43]
v_mul_f32 v9, v9, v18
v_cndmask_b32 v10, v14, v10, s[42:43]
v_mul_f32 v10, v10, v18
v_cndmask_b32 v11, v15, v11, s[42:43]
v_mul_f32 v11, v11, v18
v_cvt_pk_bf16_f32 v12, v8, v9
v_cvt_pk_bf16_f32 v13, v10, v11
s_branch back_10053
exit_10054:
global_load_dwordx4 v[32:35], v0, s[68:69] offset:-4096 sc1
global_load_dwordx4 v[36:39], v0, s[68:69] offset:0 sc1
s_add_u32 s30, s30, 1
s_cmp_gt_u32 s30, 262144
s_cbranch_scc1 L_fail
s_waitcnt vmcnt(1)
v_bitop3_b32 v44, v32, v34, s18 bitop3:0x7e
s_waitcnt vmcnt(0)
v_bitop3_b32 v45, v36, v38, s18 bitop3:0x7e
v_bitop3_b32 v44, v44, v45, s19 bitop3:0xa8
v_cmp_ne_u32 vcc, 0, v44
s_cbranch_vccnz exit_10054
s_add_u32 s36, s36, 1
s_cmp_lt_u32 s36, 2
s_cbranch_scc1 layer_10050
s_endpgm
grp_10001:
s_bfm_b32 s24, s14, 0
s_and_b32 s24, s24, 0x4a4a4a4a
s_bcnt1_i32_b32 s24, s24
v_and_b32 v64, 63, v0
v_and_b32 v65, 15, v64
v_lshrrev_b32 v66, 4, v64
v_lshlrev_b32 v0, 4, v64
v_and_b32 v67, 2, v64
v_mov_b32 v68, 0x4444
v_mov_b32 v69, 0xeeee
v_cmp_eq_u32 vcc, 0, v67
s_nop 1
v_cndmask_b32 v1, v69, v68, vcc
s_mul_i32 s26, s13, 24576
s_add_u32 s26, s26, 65536
v_add_u32 v2, s26, v0
v_lshrrev_b32 v67, 2, v65
v_xor_b32 v68, v66, v67
v_lshlrev_b32 v68, 3, v68
v_lshl_add_u32 v68, v65, 5, v68
s_lshl_b32 s26, s13, 10
s_add_u32 s26, s26, 10240
v_add_u32 v3, s26, v68
v_lshl_add_u32 v68, v66, 2, v67
v_and_b32 v69, 3, v65
v_xor_b32 v69, v69, v66
v_lshlrev_b32 v69, 3, v69
v_lshl_add_u32 v68, v68, 5, v69
v_add_u32 v4, 10240, v68
v_and_b32 v69, 1, v65
v_lshl_add_u32 v68, v67, 1, v69
v_lshlrev_b32 v68, 4, v68
v_lshl_add_u32 v68, v66, 7, v68
v_add_u32 v5, 8192, v68
v_bfe_u32 v69, v65, 1, 1
v_mul_u32_u24 v69, 640, v69
v_xor_b32 v6, v69, v5
s_mov_b32 s42, 0x33333333
s_mov_b32 s43, 0x33333333
s_mov_b32 s44, 0x3f803f80
s_mov_b32 s45, 0x3f803f80
s_mov_b32 s46, 0x3f803f80
s_mov_b32 s47, 0
s_mov_b32 s37, 729808896
s_mov_b32 s38, 671088640
v_lshlrev_b32 v68, 3, v65
v_lshl_add_u32 v7, v66, 12, v68
s_lshl_b32 s26, s13, 14
s_lshl_b32 s27, s14, 7
s_add_u32 s26, s26, s27
s_add_u32 s90, s26, 65536
s_lshl_b32 s26, s13, 5
s_add_u32 s93, s26, s14
s_lshl_b32 s26, s93, 12
s_add_u32 s91, s26, 65536
s_lshr_b32 s26, s93, 2
s_lshl_b32 s26, s26, 9
s_and_b32 s27, s93, 3
s_lshl_b32 s27, s27, 6
s_add_u32 s26, s26, s27
s_add_u32 s92, s26, 393216
s_lshl_b32 s26, s14, 8
s_add_u32 s22, s26, 11534336
s_lshl_b32 s26, s24, 7
s_add_u32 s26, s26, 11550720
s_cmp_lt_u32 s24, 10
s_cselect_b32 s23, s26, 268435456
s_cselect_b32 s24, s24, 0
s_cselect_b32 s25, 12582912, s23
s_lshl_b32 s24, s24, 10
s_and_b32 s26, s14, 0
s_lshl_b32 s26, s26, 12
s_add_u32 s94, s26, 425984
s_lshl_b32 s26, s14, 7
s_add_u32 s95, s26, 425984
s_mov_b32 s35, 0x3e0293ee
s_lshl_b32 s26, s14, 2
s_add_u32 s26, s26, s13
s_mul_i32 s27, s26, 18432
s_add_u32 s89, s27, 1048576
s_add_u32 s48, s4, s90
s_addc_u32 s49, s5, 0
s_add_u32 s50, s90, 65536
s_add_u32 s50, s4, s50
s_addc_u32 s51, s5, 0
s_add_u32 s52, s90, 131072
s_add_u32 s52, s4, s52
s_addc_u32 s53, s5, 0
s_add_u32 s54, s90, 196608
s_add_u32 s54, s4, s54
s_addc_u32 s55, s5, 0
s_add_u32 s56, s90, 262144
s_add_u32 s56, s4, s56
s_addc_u32 s57, s5, 0
s_add_u32 s76, s89, 4096
s_add_u32 s76, s4, s76
s_addc_u32 s77, s5, 0
s_add_u32 s78, s89, 12288
s_add_u32 s78, s4, s78
s_addc_u32 s79, s5, 0
s_add_u32 s60, s4, s94
s_addc_u32 s61, s5, 0
s_add_u32 s62, s4, s95
s_addc_u32 s63, s5, 0
s_add_u32 s64, s4, s91
s_addc_u32 s65, s5, 0
s_add_u32 s66, s4, s92
s_addc_u32 s67, s5, 0
v_mov_b32 v72, 0
v_mov_b32 v73, 0
s_mov_b32 s26, s90
buffer_store_dwordx2 v[72:73], v7, s[4:7], s26 offen
s_add_u32 s26, s26, 65536
buffer_store_dwordx2 v[72:73], v7, s[4:7], s26 offen
s_add_u32 s26, s26, 65536
buffer_store_dwordx2 v[72:73], v7, s[4:7], s26 offen
s_add_u32 s26, s26, 65536
buffer_store_dwordx2 v[72:73], v7, s[4:7], s26 offen
s_add_u32 s26, s26, 65536
buffer_store_dwordx2 v[72:73], v7, s[4:7], s26 offen
s_add_u32 s26, s26, 65536
buffer_store_dword v72, off, s[4:7], s95 offset:0
s_load_dwordx2 s[96:97], s[0:1], 32
s_mov_b32 s98, 10240
s_mov_b32 s99, 0x20000
s_cmp_ge_u32 s93, 80
s_cbranch_scc1 nm0_10065
s_and_b32 s26, s93, 3
s_mul_i32 s26, s26, 2560
s_lshr_b32 s27, s93, 2
s_lshl_b32 s27, s27, 6
s_add_u32 s26, s26, s27
v_bfe_u32 v68, v65, 1, 2
v_lshlrev_b32 v68, 4, v68
v_and_b32 v69, 1, v65
v_lshl_add_u32 v68, v69, 2, v68
v_and_b32 v69, 1, v66
v_mul_u32_u24 v69, 1280, v69
v_add_u32 v68, v68, v69
s_waitcnt lgkmcnt(0)
buffer_load_dword v74, v68, s[96:99], s26 offen
buffer_load_dword v75, v68, s[96:99], s26 offen offset:8
v_and_b32 v68, 32, v0
v_bfe_u32 v69, v0, 6, 1
v_lshl_add_u32 v68, v69, 8, v68
v_bfe_u32 v69, v0, 8, 1
v_lshl_add_u32 v68, v69, 4, v68
v_bfe_u32 v69, v0, 4, 1
v_lshl_add_u32 v68, v69, 3, v68
s_add_u32 s27, s92, 16384
buffer_store_dwordx2 v[72:73], v68, s[4:7], s92 offen
s_waitcnt vmcnt(1)
buffer_store_dwordx2 v[74:75], v68, s[4:7], s27 offen
nm0_10065:
s_waitcnt vmcnt(0) lgkmcnt(0)
s_barrier
s_cmp_eq_u32 s13, 0
s_cselect_b32 s26, 144, s10
v_mov_b32 v74, 1
s_mov_b64 exec, 1
buffer_atomic_add v74, off, s[8:11], s26
s_mov_b64 exec, -1
v_lshrrev_b32 v67, 3, v64
v_and_b32 v68, 7, v64
v_lshlrev_b32 v68, 4, v68
v_lshl_add_u32 v32, v67, 13, v68
v_mul_u32_u24 v67, 1280, v67
v_add_u32 v36, v67, v68
v_lshrrev_b32 v67, 1, v66
v_lshlrev_b32 v67, 4, v67
v_and_b32 v68, 1, v66
v_lshl_add_u32 v67, v68, 1, v67
v_lshrrev_b32 v68, 3, v65
v_lshl_add_u32 v67, v68, 3, v67
v_bfe_u32 v68, v65, 2, 1
v_add_u32 v67, v67, v68
v_and_b32 v69, 3, v65
v_lshlrev_b32 v40, 4, v69
v_lshl_add_u32 v40, v67, 7, v40
v_lshl_add_u32 v67, v66, 2, v68
v_lshlrev_b32 v42, 4, v69
v_lshl_add_u32 v42, v67, 7, v42
v_lshrrev_b32 v68, 3, v65
v_lshl_add_u32 v42, v68, 3, v42
s_lshl_b32 s29, s13, 12
s_and_b32 s26, s13, 1
s_lshl_b32 s26, s26, 6
s_add_u32 s26, s26, s29
v_add_u32 v40, s26, v40
v_add_u32 v42, s26, v42
v_xor_b32 v41, 4096, v40
v_xor_b32 v43, 4096, v42
v_add_u32 v33, 64512, v32
v_add_u32 v37, 9216, v36
v_add_u32 v34, 129024, v32
v_add_u32 v38, 18432, v36
v_add_u32 v35, 193536, v32
v_add_u32 v39, 27648, v36
s_lshr_b32 s28, s13, 1
s_lshl_b32 s28, s28, 7
s_lshl_b32 s27, s14, 8
s_add_u32 s27, s27, s28
s_xor_b32 s26, s13, 0
s_lshl_b32 s80, s26, 19
s_add_u32 s80, s80, s27
s_lshl_b32 s83, s14, 2
s_add_u32 s83, s83, s26
s_mul_i32 s83, s83, 40960
s_add_u32 s83, s83, s28
s_xor_b32 s26, s13, 2
s_lshl_b32 s81, s26, 19
s_add_u32 s81, s81, s27
s_lshl_b32 s84, s14, 2
s_add_u32 s84, s84, s26
s_mul_i32 s84, s84, 40960
s_add_u32 s84, s84, s28
s_and_b32 s26, s13, 1
s_add_u32 s26, s26, 8
s_lshl_b32 s82, s26, 19
s_add_u32 s82, s82, s27
s_load_dwordx2 s[68:69], s[0:1], 40
s_load_dwordx2 s[70:71], s[0:1], 48
s_load_dwordx2 s[72:73], s[0:1], 56
s_load_dwordx2 s[74:75], s[0:1], 64
s_mov_b32 s98, 5242880
s_waitcnt lgkmcnt(0)
s_mov_b64 s[96:97], s[70:71]
s_add_u32 m0, s29, 0
s_add_u32 s26, s80, 0
buffer_load_dwordx4 v32, s[96:99], s26 offen offset:0 lds
buffer_load_dwordx4 v33, s[96:99], s26 offen offset:1024 lds
buffer_load_dwordx4 v34, s[96:99], s26 offen offset:2048 lds
buffer_load_dwordx4 v35, s[96:99], s26 offen offset:3072 lds
s_add_u32 m0, s29, 16384
s_add_u32 s26, s80, 262144
buffer_load_dwordx4 v32, s[96:99], s26 offen offset:0 lds
buffer_load_dwordx4 v33, s[96:99], s26 offen offset:1024 lds
buffer_load_dwordx4 v34, s[96:99], s26 offen offset:2048 lds
buffer_load_dwordx4 v35, s[96:99], s26 offen offset:3072 lds
s_add_u32 m0, s29, 32768
s_add_u32 s26, s80, 2097152
buffer_load_dwordx4 v32, s[96:99], s26 offen offset:0 lds
buffer_load_dwordx4 v33, s[96:99], s26 offen offset:1024 lds
buffer_load_dwordx4 v34, s[96:99], s26 offen offset:2048 lds
buffer_load_dwordx4 v35, s[96:99], s26 offen offset:3072 lds
s_waitcnt vmcnt(8)
s_barrier
s_add_u32 m0, s29, 49152
s_add_u32 s26, s80, 2359296
buffer_load_dwordx4 v32, s[96:99], s26 offen offset:0 lds
buffer_load_dwordx4 v33, s[96:99], s26 offen offset:1024 lds
buffer_load_dwordx4 v34, s[96:99], s26 offen offset:2048 lds
buffer_load_dwordx4 v35, s[96:99], s26 offen offset:3072 lds
ds_read_b64_tr_b16 v[72:73], v40 offset:0
ds_read_b64_tr_b16 v[74:75], v40 offset:512
ds_read_b64_tr_b16 a[8:9], v40 offset:8
ds_read_b64_tr_b16 a[10:11], v40 offset:520
ds_read_b64_tr_b16 a[144:145], v41 offset:0
ds_read_b64_tr_b16 a[146:147], v41 offset:512
ds_read_b64_tr_b16 a[152:153], v41 offset:8
ds_read_b64_tr_b16 a[154:155], v41 offset:520
s_waitcnt lgkmcnt(6)
global_store_dwordx4 v0, v[72:75], s[76:77] offset:-2048
s_waitcnt vmcnt(9) lgkmcnt(0)
s_barrier
s_add_u32 m0, s29, 0
s_add_u32 s26, s81, 0
buffer_load_dwordx4 v32, s[96:99], s26 offen offset:0 lds
buffer_load_dwordx4 v33, s[96:99], s26 offen offset:1024 lds
buffer_load_dwordx4 v34, s[96:99], s26 offen offset:2048 lds
buffer_load_dwordx4 v35, s[96:99], s26 offen offset:3072 lds
ds_read_b64_tr_b16 v[72:73], v40 offset:16384
ds_read_b64_tr_b16 v[74:75], v40 offset:16896
ds_read_b64_tr_b16 a[12:13], v40 offset:16392
ds_read_b64_tr_b16 a[14:15], v40 offset:16904
ds_read_b64_tr_b16 a[148:149], v41 offset:16384
ds_read_b64_tr_b16 a[150:151], v41 offset:16896
ds_read_b64_tr_b16 a[156:157], v41 offset:16392
ds_read_b64_tr_b16 a[158:159], v41 offset:16904
s_waitcnt lgkmcnt(6)
global_store_dwordx4 v0, v[72:75], s[76:77] offset:-1024
s_waitcnt vmcnt(10) lgkmcnt(0)
s_barrier
s_add_u32 m0, s29, 16384
s_add_u32 s26, s81, 262144
buffer_load_dwordx4 v32, s[96:99], s26 offen offset:0 lds
buffer_load_dwordx4 v33, s[96:99], s26 offen offset:1024 lds
buffer_load_dwordx4 v34, s[96:99], s26 offen offset:2048 lds
buffer_load_dwordx4 v35, s[96:99], s26 offen offset:3072 lds
ds_read_b64_tr_b16 a[40:41], v40 offset:32768
ds_read_b64_tr_b16 a[42:43], v40 offset:33280
ds_read_b64_tr_b16 a[48:49], v40 offset:32776
ds_read_b64_tr_b16 a[50:51], v40 offset:33288
ds_read_b64_tr_b16 a[160:161], v41 offset:32768
ds_read_b64_tr_b16 a[162:163], v41 offset:33280
ds_read_b64_tr_b16 v[72:73], v41 offset:32776
ds_read_b64_tr_b16 v[74:75], v41 offset:33288
s_waitcnt lgkmcnt(0)
ds_write_b128 v2, v[72:75] offset:10240
s_waitcnt vmcnt(10)
s_barrier
s_add_u32 m0, s29, 32768
s_add_u32 s26, s81, 2097152
buffer_load_dwordx4 v32, s[96:99], s26 offen offset:0 lds
buffer_load_dwordx4 v33, s[96:99], s26 offen offset:1024 lds
buffer_load_dwordx4 v34, s[96:99], s26 offen offset:2048 lds
buffer_load_dwordx4 v35, s[96:99], s26 offen offset:3072 lds
ds_read_b64_tr_b16 a[44:45], v40 offset:49152
ds_read_b64_tr_b16 a[46:47], v40 offset:49664
ds_read_b64_tr_b16 a[52:53], v40 offset:49160
ds_read_b64_tr_b16 a[54:55], v40 offset:49672
ds_read_b64_tr_b16 a[164:165], v41 offset:49152
ds_read_b64_tr_b16 a[166:167], v41 offset:49664
ds_read_b64_tr_b16 v[72:73], v41 offset:49160
ds_read_b64_tr_b16 v[74:75], v41 offset:49672
s_waitcnt lgkmcnt(0)
ds_write_b128 v2, v[72:75] offset:11264
s_waitcnt vmcnt(9)
s_barrier
s_add_u32 m0, s29, 49152
s_add_u32 s26, s81, 2359296
buffer_load_dwordx4 v32, s[96:99], s26 offen offset:0 lds
buffer_load_dwordx4 v33, s[96:99], s26 offen offset:1024 lds
buffer_load_dwordx4 v34, s[96:99], s26 offen offset:2048 lds
buffer_load_dwordx4 v35, s[96:99], s26 offen offset:3072 lds
ds_read_b64_tr_b16 a[168:169], v40 offset:0
ds_read_b64_tr_b16 a[170:171], v40 offset:512
ds_read_b64_tr_b16 a[176:177], v40 offset:8
ds_read_b64_tr_b16 a[178:179], v40 offset:520
ds_read_b64_tr_b16 a[184:185], v41 offset:0
ds_read_b64_tr_b16 a[186:187], v41 offset:512
ds_read_b64_tr_b16 a[192:193], v41 offset:8
ds_read_b64_tr_b16 a[194:195], v41 offset:520
s_waitcnt vmcnt(8) lgkmcnt(0)
s_barrier
s_add_u32 m0, s29, 0
s_add_u32 s26, s82, 0
buffer_load_dwordx4 v32, s[96:99], s26 offen offset:0 lds
buffer_load_dwordx4 v33, s[96:99], s26 offen offset:1024 lds
buffer_load_dwordx4 v34, s[96:99], s26 offen offset:2048 lds
buffer_load_dwordx4 v35, s[96:99], s26 offen offset:3072 lds
ds_read_b64_tr_b16 a[172:173], v40 offset:16384
ds_read_b64_tr_b16 a[174:175], v40 offset:16896
ds_read_b64_tr_b16 a[180:181], v40 offset:16392
ds_read_b64_tr_b16 a[182:183], v40 offset:16904
ds_read_b64_tr_b16 a[188:189], v41 offset:16384
ds_read_b64_tr_b16 a[190:191], v41 offset:16896
ds_read_b64_tr_b16 a[196:197], v41 offset:16392
ds_read_b64_tr_b16 a[198:199], v41 offset:16904
s_waitcnt vmcnt(8) lgkmcnt(0)
s_barrier
s_add_u32 m0, s29, 16384
s_add_u32 s26, s82, 262144
buffer_load_dwordx4 v32, s[96:99], s26 offen offset:0 lds
buffer_load_dwordx4 v33, s[96:99], s26 offen offset:1024 lds
buffer_load_dwordx4 v34, s[96:99], s26 offen offset:2048 lds
buffer_load_dwordx4 v35, s[96:99], s26 offen offset:3072 lds
ds_read_b64_tr_b16 v[72:73], v40 offset:32768
ds_read_b64_tr_b16 v[74:75], v40 offset:33280
ds_read_b64_tr_b16 v[76:77], v40 offset:32776
ds_read_b64_tr_b16 v[78:79], v40 offset:33288
s_waitcnt lgkmcnt(2)
ds_write_b128 v2, v[72:75] offset:12288
s_waitcnt lgkmcnt(1)
global_store_dwordx4 v0, v[76:79], s[78:79] offset:-2048
ds_read_b64_tr_b16 a[200:201], v41 offset:32768
ds_read_b64_tr_b16 a[202:203], v41 offset:33280
ds_read_b64_tr_b16 a[208:209], v41 offset:32776
ds_read_b64_tr_b16 a[210:211], v41 offset:33288
s_waitcnt vmcnt(9) lgkmcnt(0)
s_barrier
s_mov_b64 s[96:97], s[72:73]
s_add_u32 m0, s29, 32768
s_add_u32 s26, s80, 0
buffer_load_dwordx4 v32, s[96:99], s26 offen offset:0 lds
buffer_load_dwordx4 v33, s[96:99], s26 offen offset:1024 lds
buffer_load_dwordx4 v34, s[96:99], s26 offen offset:2048 lds
buffer_load_dwordx4 v35, s[96:99], s26 offen offset:3072 lds
ds_read_b64_tr_b16 v[72:73], v40 offset:49152
ds_read_b64_tr_b16 v[74:75], v40 offset:49664
ds_read_b64_tr_b16 v[76:77], v40 offset:49160
ds_read_b64_tr_b16 v[78:79], v40 offset:49672
s_waitcnt lgkmcnt(2)
ds_write_b128 v2, v[72:75] offset:13312
s_waitcnt lgkmcnt(1)
global_store_dwordx4 v0, v[76:79], s[78:79] offset:-1024
ds_read_b64_tr_b16 a[204:205], v41 offset:49152
ds_read_b64_tr_b16 a[206:207], v41 offset:49664
ds_read_b64_tr_b16 a[212:213], v41 offset:49160
ds_read_b64_tr_b16 a[214:215], v41 offset:49672
s_waitcnt vmcnt(10) lgkmcnt(0)
s_barrier
s_add_u32 m0, s29, 49152
s_add_u32 s26, s80, 262144
buffer_load_dwordx4 v32, s[96:99], s26 offen offset:0 lds
buffer_load_dwordx4 v33, s[96:99], s26 offen offset:1024 lds
buffer_load_dwordx4 v34, s[96:99], s26 offen offset:2048 lds
buffer_load_dwordx4 v35, s[96:99], s26 offen offset:3072 lds
ds_read_b64_tr_b16 a[216:217], v40 offset:0
ds_read_b64_tr_b16 a[218:219], v40 offset:512
ds_read_b64_tr_b16 a[224:225], v40 offset:8
ds_read_b64_tr_b16 a[226:227], v40 offset:520
ds_read_b64_tr_b16 a[232:233], v41 offset:0
ds_read_b64_tr_b16 a[234:235], v41 offset:512
ds_read_b64_tr_b16 a[240:241], v41 offset:8
ds_read_b64_tr_b16 a[242:243], v41 offset:520
s_waitcnt vmcnt(10) lgkmcnt(0)
s_barrier
s_add_u32 m0, s29, 0
s_add_u32 s26, s80, 2097152
buffer_load_dwordx4 v32, s[96:99], s26 offen offset:0 lds
buffer_load_dwordx4 v33, s[96:99], s26 offen offset:1024 lds
buffer_load_dwordx4 v34, s[96:99], s26 offen offset:2048 lds
buffer_load_dwordx4 v35, s[96:99], s26 offen offset:3072 lds
ds_read_b64_tr_b16 a[220:221], v40 offset:16384
ds_read_b64_tr_b16 a[222:223], v40 offset:16896
ds_read_b64_tr_b16 a[228:229], v40 offset:16392
ds_read_b64_tr_b16 a[230:231], v40 offset:16904
ds_read_b64_tr_b16 a[236:237], v41 offset:16384
ds_read_b64_tr_b16 a[238:239], v41 offset:16896
ds_read_b64_tr_b16 a[244:245], v41 offset:16392
ds_read_b64_tr_b16 a[246:247], v41 offset:16904
s_waitcnt vmcnt(9) lgkmcnt(0)
s_barrier
s_add_u32 m0, s29, 16384
s_add_u32 s26, s80, 2359296
buffer_load_dwordx4 v32, s[96:99], s26 offen offset:0 lds
buffer_load_dwordx4 v33, s[96:99], s26 offen offset:1024 lds
buffer_load_dwordx4 v34, s[96:99], s26 offen offset:2048 lds
buffer_load_dwordx4 v35, s[96:99], s26 offen offset:3072 lds
ds_read_b64_tr_b16 a[16:17], v40 offset:32768
ds_read_b64_tr_b16 a[18:19], v40 offset:33280
ds_read_b64_tr_b16 v[72:73], v40 offset:32776
ds_read_b64_tr_b16 v[74:75], v40 offset:33288
ds_read_b64_tr_b16 v[88:89], v41 offset:32768
ds_read_b64_tr_b16 v[90:91], v41 offset:33280
ds_read_b64_tr_b16 v[96:97], v41 offset:32776
ds_read_b64_tr_b16 v[98:99], v41 offset:33288
s_waitcnt lgkmcnt(4)
global_store_dwordx4 v0, v[72:75], s[76:77] offset:0
s_waitcnt vmcnt(9) lgkmcnt(0)
s_barrier
s_add_u32 m0, s29, 32768
s_add_u32 s26, s81, 0
buffer_load_dwordx4 v32, s[96:99], s26 offen offset:0 lds
buffer_load_dwordx4 v33, s[96:99], s26 offen offset:1024 lds
buffer_load_dwordx4 v34, s[96:99], s26 offen offset:2048 lds
buffer_load_dwordx4 v35, s[96:99], s26 offen offset:3072 lds
ds_read_b64_tr_b16 a[20:21], v40 offset:49152
ds_read_b64_tr_b16 a[22:23], v40 offset:49664
ds_read_b64_tr_b16 v[72:73], v40 offset:49160
ds_read_b64_tr_b16 v[74:75], v40 offset:49672
ds_read_b64_tr_b16 v[92:93], v41 offset:49152
ds_read_b64_tr_b16 v[94:95], v41 offset:49664
ds_read_b64_tr_b16 v[100:101], v41 offset:49160
ds_read_b64_tr_b16 v[102:103], v41 offset:49672
s_waitcnt lgkmcnt(4)
global_store_dwordx4 v0, v[72:75], s[76:77] offset:1024
s_waitcnt vmcnt(10) lgkmcnt(0)
s_barrier
s_add_u32 m0, s29, 49152
s_add_u32 s26, s81, 262144
buffer_load_dwordx4 v32, s[96:99], s26 offen offset:0 lds
buffer_load_dwordx4 v33, s[96:99], s26 offen offset:1024 lds
buffer_load_dwordx4 v34, s[96:99], s26 offen offset:2048 lds
buffer_load_dwordx4 v35, s[96:99], s26 offen offset:3072 lds
ds_read_b64_tr_b16 a[56:57], v40 offset:0
ds_read_b64_tr_b16 a[58:59], v40 offset:512
ds_read_b64_tr_b16 v[72:73], v40 offset:8
ds_read_b64_tr_b16 v[74:75], v40 offset:520
ds_read_b64_tr_b16 v[76:77], v41 offset:0
ds_read_b64_tr_b16 v[78:79], v41 offset:512
s_waitcnt lgkmcnt(2)
ds_write_b128 v2, v[72:75] offset:0
s_waitcnt lgkmcnt(1)
global_store_dwordx4 v0, v[76:79], s[78:79] offset:0
ds_read_b64_tr_b16 v[104:105], v41 offset:8
ds_read_b64_tr_b16 v[106:107], v41 offset:520
s_waitcnt vmcnt(11) lgkmcnt(0)
s_barrier
s_add_u32 m0, s29, 0
s_add_u32 s26, s81, 2097152
buffer_load_dwordx4 v32, s[96:99], s26 offen offset:0 lds
buffer_load_dwordx4 v33, s[96:99], s26 offen offset:1024 lds
buffer_load_dwordx4 v34, s[96:99], s26 offen offset:2048 lds
buffer_load_dwordx4 v35, s[96:99], s26 offen offset:3072 lds
ds_read_b64_tr_b16 a[60:61], v40 offset:16384
ds_read_b64_tr_b16 a[62:63], v40 offset:16896
ds_read_b64_tr_b16 v[72:73], v40 offset:16392
ds_read_b64_tr_b16 v[74:75], v40 offset:16904
ds_read_b64_tr_b16 v[76:77], v41 offset:16384
ds_read_b64_tr_b16 v[78:79], v41 offset:16896
s_waitcnt lgkmcnt(2)
ds_write_b128 v2, v[72:75] offset:1024
s_waitcnt lgkmcnt(1)
global_store_dwordx4 v0, v[76:79], s[78:79] offset:1024
ds_read_b64_tr_b16 v[108:109], v41 offset:16392
ds_read_b64_tr_b16 v[110:111], v41 offset:16904
s_waitcnt vmcnt(11) lgkmcnt(0)
s_barrier
s_add_u32 m0, s29, 16384
s_add_u32 s26, s81, 2359296
buffer_load_dwordx4 v32, s[96:99], s26 offen offset:0 lds
buffer_load_dwordx4 v33, s[96:99], s26 offen offset:1024 lds
buffer_load_dwordx4 v34, s[96:99], s26 offen offset:2048 lds
buffer_load_dwordx4 v35, s[96:99], s26 offen offset:3072 lds
ds_read_b64_tr_b16 v[112:113], v40 offset:32768
ds_read_b64_tr_b16 v[114:115], v40 offset:33280
ds_read_b64_tr_b16 v[120:121], v40 offset:32776
ds_read_b64_tr_b16 v[122:123], v40 offset:33288
ds_read_b64_tr_b16 v[72:73], v41 offset:32768
ds_read_b64_tr_b16 v[74:75], v41 offset:33280
ds_read_b64_tr_b16 v[144:145], v41 offset:32776
ds_read_b64_tr_b16 v[146:147], v41 offset:33288
s_waitcnt lgkmcnt(2)
ds_write_b128 v2, v[72:75] offset:18432
s_waitcnt vmcnt(10) lgkmcnt(1)
s_barrier
s_add_u32 m0, s29, 32768
s_add_u32 s26, s82, 0
buffer_load_dwordx4 v32, s[96:99], s26 offen offset:0 lds
buffer_load_dwordx4 v33, s[96:99], s26 offen offset:1024 lds
buffer_load_dwordx4 v34, s[96:99], s26 offen offset:2048 lds
buffer_load_dwordx4 v35, s[96:99], s26 offen offset:3072 lds
ds_read_b64_tr_b16 v[116:117], v40 offset:49152
ds_read_b64_tr_b16 v[118:119], v40 offset:49664
ds_read_b64_tr_b16 v[124:125], v40 offset:49160
ds_read_b64_tr_b16 v[126:127], v40 offset:49672
ds_read_b64_tr_b16 v[72:73], v41 offset:49152
ds_read_b64_tr_b16 v[74:75], v41 offset:49664
ds_read_b64_tr_b16 v[148:149], v41 offset:49160
ds_read_b64_tr_b16 v[150:151], v41 offset:49672
s_waitcnt lgkmcnt(2)
ds_write_b128 v2, v[72:75] offset:19456
s_waitcnt vmcnt(9) lgkmcnt(1)
s_barrier
s_add_u32 m0, s29, 49152
s_add_u32 s26, s82, 262144
buffer_load_dwordx4 v32, s[96:99], s26 offen offset:0 lds
buffer_load_dwordx4 v33, s[96:99], s26 offen offset:1024 lds
buffer_load_dwordx4 v34, s[96:99], s26 offen offset:2048 lds
buffer_load_dwordx4 v35, s[96:99], s26 offen offset:3072 lds
ds_read_b64_tr_b16 v[128:129], v40 offset:0
ds_read_b64_tr_b16 v[130:131], v40 offset:512
ds_read_b64_tr_b16 v[136:137], v40 offset:8
ds_read_b64_tr_b16 v[138:139], v40 offset:520
ds_read_b64_tr_b16 v[72:73], v41 offset:0
ds_read_b64_tr_b16 v[74:75], v41 offset:512
ds_read_b64_tr_b16 v[152:153], v41 offset:8
ds_read_b64_tr_b16 v[154:155], v41 offset:520
s_waitcnt lgkmcnt(2)
global_store_dwordx4 v0, v[72:75], s[78:79] offset:2048
s_waitcnt vmcnt(9) lgkmcnt(0)
s_barrier
s_mov_b64 s[96:97], s[68:69]
s_add_u32 m0, s29, 0
s_add_u32 s26, s80, 0
buffer_load_dwordx4 v32, s[96:99], s26 offen offset:0 lds
buffer_load_dwordx4 v33, s[96:99], s26 offen offset:1024 lds
buffer_load_dwordx4 v34, s[96:99], s26 offen offset:2048 lds
buffer_load_dwordx4 v35, s[96:99], s26 offen offset:3072 lds
ds_read_b64_tr_b16 v[132:133], v40 offset:16384
ds_read_b64_tr_b16 v[134:135], v40 offset:16896
ds_read_b64_tr_b16 v[140:141], v40 offset:16392
ds_read_b64_tr_b16 v[142:143], v40 offset:16904
ds_read_b64_tr_b16 v[72:73], v41 offset:16384
ds_read_b64_tr_b16 v[74:75], v41 offset:16896
ds_read_b64_tr_b16 v[156:157], v41 offset:16392
ds_read_b64_tr_b16 v[158:159], v41 offset:16904
s_waitcnt lgkmcnt(2)
global_store_dwordx4 v0, v[72:75], s[78:79] offset:3072
s_waitcnt vmcnt(10) lgkmcnt(0)
s_barrier
s_add_u32 m0, s29, 16384
s_add_u32 s26, s80, 262144
buffer_load_dwordx4 v32, s[96:99], s26 offen offset:0 lds
buffer_load_dwordx4 v33, s[96:99], s26 offen offset:1024 lds
buffer_load_dwordx4 v34, s[96:99], s26 offen offset:2048 lds
buffer_load_dwordx4 v35, s[96:99], s26 offen offset:3072 lds
ds_read_b64_tr_b16 a[248:249], v40 offset:32768
ds_read_b64_tr_b16 a[250:251], v40 offset:33280
ds_read_b64_tr_b16 v[80:81], v40 offset:32776
ds_read_b64_tr_b16 v[82:83], v40 offset:33288
ds_read_b64_tr_b16 v[72:73], v41 offset:32768
ds_read_b64_tr_b16 v[74:75], v41 offset:33280
ds_read_b64_tr_b16 v[76:77], v41 offset:32776
ds_read_b64_tr_b16 v[78:79], v41 offset:33288
s_waitcnt lgkmcnt(2)
ds_write_b128 v2, v[72:75] offset:14336
s_waitcnt lgkmcnt(1)
ds_write_b128 v2, v[76:79] offset:16384
s_waitcnt vmcnt(10)
s_barrier
s_add_u32 m0, s29, 32768
s_add_u32 s26, s80, 2097152
buffer_load_dwordx4 v32, s[96:99], s26 offen offset:0 lds
buffer_load_dwordx4 v33, s[96:99], s26 offen offset:1024 lds
buffer_load_dwordx4 v34, s[96:99], s26 offen offset:2048 lds
buffer_load_dwordx4 v35, s[96:99], s26 offen offset:3072 lds
ds_read_b64_tr_b16 a[252:253], v40 offset:49152
ds_read_b64_tr_b16 a[254:255], v40 offset:49664
ds_read_b64_tr_b16 v[84:85], v40 offset:49160
ds_read_b64_tr_b16 v[86:87], v40 offset:49672
ds_read_b64_tr_b16 v[72:73], v41 offset:49152
ds_read_b64_tr_b16 v[74:75], v41 offset:49664
ds_read_b64_tr_b16 v[76:77], v41 offset:49160
ds_read_b64_tr_b16 v[78:79], v41 offset:49672
s_waitcnt lgkmcnt(2)
ds_write_b128 v2, v[72:75] offset:15360
s_waitcnt lgkmcnt(1)
ds_write_b128 v2, v[76:79] offset:17408
s_waitcnt vmcnt(9)
s_barrier
s_add_u32 m0, s29, 49152
s_add_u32 s26, s80, 2359296
buffer_load_dwordx4 v32, s[96:99], s26 offen offset:0 lds
buffer_load_dwordx4 v33, s[96:99], s26 offen offset:1024 lds
buffer_load_dwordx4 v34, s[96:99], s26 offen offset:2048 lds
buffer_load_dwordx4 v35, s[96:99], s26 offen offset:3072 lds
ds_read_b64_tr_b16 v[72:73], v40 offset:0
ds_read_b64_tr_b16 v[74:75], v40 offset:512
ds_read_b64_tr_b16 a[0:1], v40 offset:8
ds_read_b64_tr_b16 a[2:3], v40 offset:520
ds_read_b64_tr_b16 a[64:65], v41 offset:0
ds_read_b64_tr_b16 a[66:67], v41 offset:512
ds_read_b64_tr_b16 v[76:77], v41 offset:8
ds_read_b64_tr_b16 v[78:79], v41 offset:520
s_waitcnt lgkmcnt(6)
global_store_dwordx4 v0, v[72:75], s[76:77] offset:-4096
s_waitcnt lgkmcnt(0)
global_store_dwordx4 v0, v[76:79], s[76:77] offset:2048
s_waitcnt vmcnt(10)
s_barrier
s_add_u32 m0, s29, 0
s_add_u32 s26, s81, 0
buffer_load_dwordx4 v32, s[96:99], s26 offen offset:0 lds
buffer_load_dwordx4 v33, s[96:99], s26 offen offset:1024 lds
buffer_load_dwordx4 v34, s[96:99], s26 offen offset:2048 lds
buffer_load_dwordx4 v35, s[96:99], s26 offen offset:3072 lds
ds_read_b64_tr_b16 v[72:73], v40 offset:16384
ds_read_b64_tr_b16 v[74:75], v40 offset:16896
ds_read_b64_tr_b16 a[4:5], v40 offset:16392
ds_read_b64_tr_b16 a[6:7], v40 offset:16904
ds_read_b64_tr_b16 a[68:69], v41 offset:16384
ds_read_b64_tr_b16 a[70:71], v41 offset:16896
ds_read_b64_tr_b16 v[76:77], v41 offset:16392
ds_read_b64_tr_b16 v[78:79], v41 offset:16904
s_waitcnt lgkmcnt(6)
global_store_dwordx4 v0, v[72:75], s[76:77] offset:-3072
s_waitcnt lgkmcnt(0)
global_store_dwordx4 v0, v[76:79], s[76:77] offset:3072
s_waitcnt vmcnt(12)
s_barrier
s_add_u32 m0, s29, 16384
s_add_u32 s26, s81, 262144
buffer_load_dwordx4 v32, s[96:99], s26 offen offset:0 lds
buffer_load_dwordx4 v33, s[96:99], s26 offen offset:1024 lds
buffer_load_dwordx4 v34, s[96:99], s26 offen offset:2048 lds
buffer_load_dwordx4 v35, s[96:99], s26 offen offset:3072 lds
ds_read_b64_tr_b16 a[24:25], v40 offset:32768
ds_read_b64_tr_b16 a[26:27], v40 offset:33280
ds_read_b64_tr_b16 a[32:33], v40 offset:32776
ds_read_b64_tr_b16 a[34:35], v40 offset:33288
ds_read_b64_tr_b16 a[72:73], v41 offset:32768
ds_read_b64_tr_b16 a[74:75], v41 offset:33280
ds_read_b64_tr_b16 a[80:81], v41 offset:32776
ds_read_b64_tr_b16 a[82:83], v41 offset:33288
s_waitcnt vmcnt(12) lgkmcnt(0)
s_barrier
s_add_u32 m0, s29, 32768
s_add_u32 s26, s81, 2097152
buffer_load_dwordx4 v32, s[96:99], s26 offen offset:0 lds
buffer_load_dwordx4 v33, s[96:99], s26 offen offset:1024 lds
buffer_load_dwordx4 v34, s[96:99], s26 offen offset:2048 lds
buffer_load_dwordx4 v35, s[96:99], s26 offen offset:3072 lds
ds_read_b64_tr_b16 a[28:29], v40 offset:49152
ds_read_b64_tr_b16 a[30:31], v40 offset:49664
ds_read_b64_tr_b16 a[36:37], v40 offset:49160
ds_read_b64_tr_b16 a[38:39], v40 offset:49672
ds_read_b64_tr_b16 a[76:77], v41 offset:49152
ds_read_b64_tr_b16 a[78:79], v41 offset:49664
ds_read_b64_tr_b16 a[84:85], v41 offset:49160
ds_read_b64_tr_b16 a[86:87], v41 offset:49672
s_waitcnt vmcnt(10) lgkmcnt(0)
s_barrier
s_add_u32 m0, s29, 49152
s_add_u32 s26, s81, 2359296
buffer_load_dwordx4 v32, s[96:99], s26 offen offset:0 lds
buffer_load_dwordx4 v33, s[96:99], s26 offen offset:1024 lds
buffer_load_dwordx4 v34, s[96:99], s26 offen offset:2048 lds
buffer_load_dwordx4 v35, s[96:99], s26 offen offset:3072 lds
ds_read_b64_tr_b16 v[72:73], v40 offset:0
ds_read_b64_tr_b16 v[74:75], v40 offset:512
ds_read_b64_tr_b16 a[88:89], v40 offset:8
ds_read_b64_tr_b16 a[90:91], v40 offset:520
ds_read_b64_tr_b16 a[104:105], v41 offset:0
ds_read_b64_tr_b16 a[106:107], v41 offset:512
ds_read_b64_tr_b16 a[112:113], v41 offset:8
ds_read_b64_tr_b16 a[114:115], v41 offset:520
s_waitcnt lgkmcnt(6)
ds_write_b128 v2, v[72:75] offset:2048
s_waitcnt vmcnt(8) lgkmcnt(1)
s_barrier
s_add_u32 m0, s29, 0
s_add_u32 s26, s82, 0
buffer_load_dwordx4 v32, s[96:99], s26 offen offset:0 lds
buffer_load_dwordx4 v33, s[96:99], s26 offen offset:1024 lds
buffer_load_dwordx4 v34, s[96:99], s26 offen offset:2048 lds
buffer_load_dwordx4 v35, s[96:99], s26 offen offset:3072 lds
ds_read_b64_tr_b16 v[72:73], v40 offset:16384
ds_read_b64_tr_b16 v[74:75], v40 offset:16896
ds_read_b64_tr_b16 a[92:93], v40 offset:16392
ds_read_b64_tr_b16 a[94:95], v40 offset:16904
ds_read_b64_tr_b16 a[108:109], v41 offset:16384
ds_read_b64_tr_b16 a[110:111], v41 offset:16896
ds_read_b64_tr_b16 a[116:117], v41 offset:16392
ds_read_b64_tr_b16 a[118:119], v41 offset:16904
s_waitcnt lgkmcnt(6)
ds_write_b128 v2, v[72:75] offset:3072
s_waitcnt vmcnt(8) lgkmcnt(1)
s_barrier
s_add_u32 m0, s29, 16384
s_add_u32 s26, s82, 262144
buffer_load_dwordx4 v32, s[96:99], s26 offen offset:0 lds
buffer_load_dwordx4 v33, s[96:99], s26 offen offset:1024 lds
buffer_load_dwordx4 v34, s[96:99], s26 offen offset:2048 lds
buffer_load_dwordx4 v35, s[96:99], s26 offen offset:3072 lds
ds_read_b64_tr_b16 a[96:97], v40 offset:32768
ds_read_b64_tr_b16 a[98:99], v40 offset:33280
ds_read_b64_tr_b16 v[72:73], v40 offset:32776
ds_read_b64_tr_b16 v[74:75], v40 offset:33288
ds_read_b64_tr_b16 v[76:77], v41 offset:32768
ds_read_b64_tr_b16 v[78:79], v41 offset:33280
s_waitcnt lgkmcnt(2)
ds_write_b128 v2, v[72:75] offset:4096
s_waitcnt lgkmcnt(1)
global_store_dwordx4 v0, v[76:79], s[78:79] offset:-4096
ds_read_b64_tr_b16 v[72:73], v41 offset:32776
ds_read_b64_tr_b16 v[74:75], v41 offset:33288
s_waitcnt lgkmcnt(0)
ds_write_b128 v2, v[72:75] offset:6144
s_waitcnt vmcnt(9)
s_barrier
s_mov_b64 s[96:97], s[74:75]
s_add_u32 m0, s29, 32768
s_add_u32 s26, s83, 0
buffer_load_dwordx4 v36, s[96:99], s26 offen offset:0 lds
buffer_load_dwordx4 v37, s[96:99], s26 offen offset:1024 lds
buffer_load_dwordx4 v38, s[96:99], s26 offen offset:2048 lds
buffer_load_dwordx4 v39, s[96:99], s26 offen offset:3072 lds
ds_read_b64_tr_b16 a[100:101], v40 offset:49152
ds_read_b64_tr_b16 a[102:103], v40 offset:49664
ds_read_b64_tr_b16 v[72:73], v40 offset:49160
ds_read_b64_tr_b16 v[74:75], v40 offset:49672
ds_read_b64_tr_b16 v[76:77], v41 offset:49152
ds_read_b64_tr_b16 v[78:79], v41 offset:49664
s_waitcnt lgkmcnt(2)
ds_write_b128 v2, v[72:75] offset:5120
s_waitcnt lgkmcnt(1)
global_store_dwordx4 v0, v[76:79], s[78:79] offset:-3072
ds_read_b64_tr_b16 v[72:73], v41 offset:49160
ds_read_b64_tr_b16 v[74:75], v41 offset:49672
s_waitcnt lgkmcnt(0)
ds_write_b128 v2, v[72:75] offset:7168
s_waitcnt vmcnt(10)
s_barrier
s_add_u32 m0, s29, 49152
s_add_u32 s26, s84, 0
buffer_load_dwordx4 v36, s[96:99], s26 offen offset:0 lds
buffer_load_dwordx4 v37, s[96:99], s26 offen offset:1024 lds
buffer_load_dwordx4 v38, s[96:99], s26 offen offset:2048 lds
buffer_load_dwordx4 v39, s[96:99], s26 offen offset:3072 lds
ds_read_b64_tr_b16 a[120:121], v40 offset:0
ds_read_b64_tr_b16 a[122:123], v40 offset:512
ds_read_b64_tr_b16 v[72:73], v40 offset:8
ds_read_b64_tr_b16 v[74:75], v40 offset:520
ds_read_b64_tr_b16 a[128:129], v41 offset:0
ds_read_b64_tr_b16 a[130:131], v41 offset:512
ds_read_b64_tr_b16 a[136:137], v41 offset:8
ds_read_b64_tr_b16 a[138:139], v41 offset:520
s_waitcnt lgkmcnt(4)
ds_write_b128 v2, v[72:75] offset:8192
s_waitcnt vmcnt(10) lgkmcnt(1)
s_barrier
s_add_u32 m0, s29, 0
s_add_u32 s26, s83, 256
buffer_load_dwordx4 v36, s[96:99], s26 offen offset:0 lds
buffer_load_dwordx4 v37, s[96:99], s26 offen offset:1024 lds
buffer_load_dwordx4 v38, s[96:99], s26 offen offset:2048 lds
buffer_load_dwordx4 v39, s[96:99], s26 offen offset:3072 lds
ds_read_b64_tr_b16 a[124:125], v40 offset:16384
ds_read_b64_tr_b16 a[126:127], v40 offset:16896
ds_read_b64_tr_b16 v[72:73], v40 offset:16392
ds_read_b64_tr_b16 v[74:75], v40 offset:16904
ds_read_b64_tr_b16 a[132:133], v41 offset:16384
ds_read_b64_tr_b16 a[134:135], v41 offset:16896
ds_read_b64_tr_b16 a[140:141], v41 offset:16392
ds_read_b64_tr_b16 a[142:143], v41 offset:16904
s_waitcnt lgkmcnt(4)
ds_write_b128 v2, v[72:75] offset:9216
s_waitcnt vmcnt(9) lgkmcnt(1)
s_barrier
s_add_u32 m0, s29, 16384
s_add_u32 s26, s84, 256
buffer_load_dwordx4 v36, s[96:99], s26 offen offset:0 lds
buffer_load_dwordx4 v37, s[96:99], s26 offen offset:1024 lds
buffer_load_dwordx4 v38, s[96:99], s26 offen offset:2048 lds
buffer_load_dwordx4 v39, s[96:99], s26 offen offset:3072 lds
ds_read_b64_tr_b16 v[72:73], v42 offset:32768
ds_read_b64_tr_b16 v[74:75], v42 offset:33024
ds_read_b64_tr_b16 v[76:77], v42 offset:34816
ds_read_b64_tr_b16 v[78:79], v42 offset:35072
s_waitcnt lgkmcnt(2)
ds_write_b128 v2, v[72:75] offset:20480
s_waitcnt lgkmcnt(1)
ds_write_b128 v2, v[76:79] offset:21504
ds_read_b64_tr_b16 v[8:9], v43 offset:32768
ds_read_b64_tr_b16 v[10:11], v43 offset:33024
ds_read_b64_tr_b16 v[12:13], v43 offset:34816
ds_read_b64_tr_b16 v[14:15], v43 offset:35072
s_waitcnt vmcnt(8) lgkmcnt(0)
s_barrier
s_add_u32 m0, s29, 32768
s_add_u32 s26, s83, 512
buffer_load_dwordx4 v36, s[96:99], s26 offen offset:0 lds
buffer_load_dwordx4 v37, s[96:99], s26 offen offset:1024 lds
buffer_load_dwordx4 v38, s[96:99], s26 offen offset:2048 lds
buffer_load_dwordx4 v39, s[96:99], s26 offen offset:3072 lds
ds_read_b64_tr_b16 v[16:17], v42 offset:49152
ds_read_b64_tr_b16 v[18:19], v42 offset:49408
ds_read_b64_tr_b16 v[20:21], v42 offset:51200
ds_read_b64_tr_b16 v[22:23], v42 offset:51456
ds_read_b64_tr_b16 v[184:185], v43 offset:49152
ds_read_b64_tr_b16 v[186:187], v43 offset:49408
ds_read_b64_tr_b16 v[188:189], v43 offset:51200
ds_read_b64_tr_b16 v[190:191], v43 offset:51456
s_waitcnt vmcnt(8) lgkmcnt(0)
s_barrier
s_add_u32 m0, s29, 49152
s_add_u32 s26, s84, 512
buffer_load_dwordx4 v36, s[96:99], s26 offen offset:0 lds
buffer_load_dwordx4 v37, s[96:99], s26 offen offset:1024 lds
buffer_load_dwordx4 v38, s[96:99], s26 offen offset:2048 lds
buffer_load_dwordx4 v39, s[96:99], s26 offen offset:3072 lds
ds_read_b64_tr_b16 v[72:73], v42 offset:0
ds_read_b64_tr_b16 v[74:75], v42 offset:256
ds_read_b64_tr_b16 v[76:77], v42 offset:2048
ds_read_b64_tr_b16 v[78:79], v42 offset:2304
s_waitcnt lgkmcnt(2)
ds_write_b128 v2, v[72:75] offset:22528
s_waitcnt lgkmcnt(1)
ds_write_b128 v2, v[76:79] offset:23552
ds_read_b64_tr_b16 v[192:193], v43 offset:0
ds_read_b64_tr_b16 v[194:195], v43 offset:256
ds_read_b64_tr_b16 v[196:197], v43 offset:2048
ds_read_b64_tr_b16 v[198:199], v43 offset:2304
s_waitcnt vmcnt(8) lgkmcnt(0)
s_barrier
s_add_u32 m0, s29, 0
s_add_u32 s26, s83, 768
buffer_load_dwordx4 v36, s[96:99], s26 offen offset:0 lds
buffer_load_dwordx4 v37, s[96:99], s26 offen offset:1024 lds
buffer_load_dwordx4 v38, s[96:99], s26 offen offset:2048 lds
buffer_load_dwordx4 v39, s[96:99], s26 offen offset:3072 lds
ds_read_b64_tr_b16 v[200:201], v42 offset:16384
ds_read_b64_tr_b16 v[202:203], v42 offset:16640
ds_read_b64_tr_b16 v[204:205], v42 offset:18432
ds_read_b64_tr_b16 v[206:207], v42 offset:18688
ds_read_b64_tr_b16 v[24:25], v43 offset:16384
ds_read_b64_tr_b16 v[26:27], v43 offset:16640
ds_read_b64_tr_b16 v[28:29], v43 offset:18432
ds_read_b64_tr_b16 v[30:31], v43 offset:18688
s_waitcnt vmcnt(8) lgkmcnt(0)
s_barrier
s_add_u32 m0, s29, 16384
s_add_u32 s26, s84, 768
buffer_load_dwordx4 v36, s[96:99], s26 offen offset:0 lds
buffer_load_dwordx4 v37, s[96:99], s26 offen offset:1024 lds
buffer_load_dwordx4 v38, s[96:99], s26 offen offset:2048 lds
buffer_load_dwordx4 v39, s[96:99], s26 offen offset:3072 lds
ds_read_b64_tr_b16 v[160:161], v42 offset:32768
ds_read_b64_tr_b16 v[162:163], v42 offset:33024
ds_read_b64_tr_b16 v[164:165], v42 offset:34816
ds_read_b64_tr_b16 v[166:167], v42 offset:35072
ds_read_b64_tr_b16 v[208:209], v43 offset:32768
ds_read_b64_tr_b16 v[210:211], v43 offset:33024
ds_read_b64_tr_b16 v[212:213], v43 offset:34816
ds_read_b64_tr_b16 v[214:215], v43 offset:35072
s_waitcnt vmcnt(8) lgkmcnt(0)
s_barrier
s_add_u32 m0, s29, 32768
s_add_u32 s26, s83, 1024
buffer_load_dwordx4 v36, s[96:99], s26 offen offset:0 lds
buffer_load_dwordx4 v37, s[96:99], s26 offen offset:1024 lds
buffer_load_dwordx4 v38, s[96:99], s26 offen offset:2048 lds
buffer_load_dwordx4 v39, s[96:99], s26 offen offset:3072 lds
ds_read_b64_tr_b16 v[216:217], v42 offset:49152
ds_read_b64_tr_b16 v[218:219], v42 offset:49408
ds_read_b64_tr_b16 v[220:221], v42 offset:51200
ds_read_b64_tr_b16 v[222:223], v42 offset:51456
ds_read_b64_tr_b16 v[48:49], v43 offset:49152
ds_read_b64_tr_b16 v[50:51], v43 offset:49408
ds_read_b64_tr_b16 v[52:53], v43 offset:51200
ds_read_b64_tr_b16 v[54:55], v43 offset:51456
v_lshrrev_b32 v44, 4, v0
v_and_b32 v44, 15, v44
v_lshlrev_b32 v44, 4, v44
buffer_load_dword v45, v44, s[8:11], 0 offen sc1
s_waitcnt vmcnt(9) lgkmcnt(0)
s_barrier
s_add_u32 m0, s29, 49152
s_add_u32 s26, s84, 1024
buffer_load_dwordx4 v36, s[96:99], s26 offen offset:0 lds
buffer_load_dwordx4 v37, s[96:99], s26 offen offset:1024 lds
buffer_load_dwordx4 v38, s[96:99], s26 offen offset:2048 lds
buffer_load_dwordx4 v39, s[96:99], s26 offen offset:3072 lds
ds_read_b64_tr_b16 v[168:169], v42 offset:0
ds_read_b64_tr_b16 v[170:171], v42 offset:256
ds_read_b64_tr_b16 v[172:173], v42 offset:2048
ds_read_b64_tr_b16 v[174:175], v42 offset:2304
ds_read_b64_tr_b16 v[224:225], v43 offset:0
ds_read_b64_tr_b16 v[226:227], v43 offset:256
ds_read_b64_tr_b16 v[228:229], v43 offset:2048
ds_read_b64_tr_b16 v[230:231], v43 offset:2304
s_waitcnt vmcnt(9) lgkmcnt(0)
s_barrier
ds_read_b64_tr_b16 v[56:57], v42 offset:16384
ds_read_b64_tr_b16 v[58:59], v42 offset:16640
ds_read_b64_tr_b16 v[60:61], v42 offset:18432
ds_read_b64_tr_b16 v[62:63], v42 offset:18688
ds_read_b64_tr_b16 v[64:65], v43 offset:16384
ds_read_b64_tr_b16 v[66:67], v43 offset:16640
ds_read_b64_tr_b16 v[68:69], v43 offset:18432
ds_read_b64_tr_b16 v[70:71], v43 offset:18688
s_waitcnt vmcnt(5) lgkmcnt(0)
s_barrier
ds_read_b64_tr_b16 v[176:177], v42 offset:32768
ds_read_b64_tr_b16 v[178:179], v42 offset:33024
ds_read_b64_tr_b16 v[180:181], v42 offset:34816
ds_read_b64_tr_b16 v[182:183], v42 offset:35072
ds_read_b64_tr_b16 v[232:233], v43 offset:32768
ds_read_b64_tr_b16 v[234:235], v43 offset:33024
ds_read_b64_tr_b16 v[236:237], v43 offset:34816
ds_read_b64_tr_b16 v[238:239], v43 offset:35072
s_waitcnt vmcnt(0) lgkmcnt(0)
s_barrier
ds_read_b64_tr_b16 v[240:241], v42 offset:49152
ds_read_b64_tr_b16 v[242:243], v42 offset:49408
ds_read_b64_tr_b16 v[244:245], v42 offset:51200
ds_read_b64_tr_b16 v[246:247], v42 offset:51456
ds_read_b64_tr_b16 v[248:249], v43 offset:49152
ds_read_b64_tr_b16 v[250:251], v43 offset:49408
ds_read_b64_tr_b16 v[252:253], v43 offset:51200
ds_read_b64_tr_b16 v[254:255], v43 offset:51456
s_waitcnt lgkmcnt(0)
s_barrier
s_mul_i32 s26, s13, 12288
v_add_u32 v47, s26, v0
ds_write_b128 v47, v[8:11] offset:16384
ds_write_b128 v47, v[12:15] offset:17408
ds_write_b128 v47, v[16:19] offset:18432
ds_write_b128 v47, v[20:23] offset:19456
ds_write_b128 v47, v[24:27] offset:20480
ds_write_b128 v47, v[28:31] offset:21504
ds_write_b128 v47, v[48:51] offset:22528
ds_write_b128 v47, v[52:55] offset:23552
ds_write_b128 v47, v[56:59] offset:24576
ds_write_b128 v47, v[60:63] offset:25600
ds_write_b128 v47, v[64:67] offset:26624
ds_write_b128 v47, v[68:71] offset:27648
s_mov_b32 s30, 0
s_branch all_10067
all_10066:
buffer_load_dword v45, v44, s[8:11], 0 offen sc1
s_add_u32 s30, s30, 1
s_cmp_gt_u32 s30, 262144
s_cbranch_scc1 L_fail
all_10067:
s_waitcnt vmcnt(0)
v_add_u32_dpp v46, v45, v45 quad_perm:[1,0,3,2] row_mask:0xf bank_mask:0xf
s_nop 1
v_add_u32_dpp v46, v46, v46 quad_perm:[2,3,0,1] row_mask:0xf bank_mask:0xf
s_nop 1
v_add_u32_dpp v46, v46, v46 row_ror:4 row_mask:0xf bank_mask:0xf
s_nop 1
v_add_u32_dpp v46, v46, v46 row_ror:8 row_mask:0xf bank_mask:0xf
v_cmp_ne_u32 vcc, 306, v46
s_cbranch_vccnz all_10066
s_waitcnt vmcnt(0) lgkmcnt(0)
s_barrier
s_mov_b32 s18, 0
s_mov_b32 s36, 0
s_cmp_eq_u32 s13, 1
s_cbranch_scc1 wave_10069
s_cmp_eq_u32 s13, 2
s_cbranch_scc1 wave_10070
s_cmp_eq_u32 s13, 3
s_cbranch_scc1 wave_10071
wave_10068:
layer_10072:
s_lshl_b32 s17, s36, 6
s_mul_i32 s27, s36, 35651584
s_mul_i32 s28, s14, 16384
s_add_u32 s27, s27, s28
s_add_u32 s20, s27, 16777216
s_mul_i32 s27, s17, 10240
s_add_u32 s27, s27, s24
s_add_u32 s21, s27, s25
s_mov_b32 s19, 0
s_mov_b32 s33, s6
s_add_u32 s34, s17, 1
s_add_u32 s31, s17, 63
s_add_u32 s32, s17, 64
s_mov_b32 s27, s20
v_mov_b32 v7, 0
s_add_u32 s68, s4, 413696
s_addc_u32 s69, s5, 0
s_add_u32 s72, s4, 397312
s_addc_u32 s73, s5, 0
s_add_u32 s70, s4, 417792
s_addc_u32 s71, s5, 0
s_add_u32 s74, s4, 401408
s_addc_u32 s75, s5, 0
s_add_u32 s58, s4, s20
s_addc_u32 s59, s5, 0
global_load_dwordx4 v[64:67], v0, s[76:77] offset:-4096 sc1
global_load_dwordx4 v[68:71], v0, s[76:77] offset:-3072 sc1
global_load_dwordx4 v[72:75], v0, s[76:77] offset:0 sc1
global_load_dwordx4 v[76:79], v0, s[76:77] offset:1024 sc1
global_load_dwordx4 v[48:51], v0, s[76:77] offset:2048 sc1
global_load_dwordx4 v[52:55], v0, s[76:77] offset:3072 sc1
global_load_dwordx4 v[56:59], v0, s[76:77] offset:-2048 sc1
global_load_dwordx4 v[60:63], v0, s[76:77] offset:-1024 sc1
v_mov_b64 v[8:9], 0
v_mov_b64 v[10:11], 0
v_mov_b64 v[12:13], 0
v_mov_b64 v[14:15], 0
v_mov_b64 v[16:17], 0
v_mov_b64 v[18:19], 0
v_mov_b64 v[20:21], 0
v_mov_b64 v[22:23], 0
v_mov_b64 v[24:25], 0
v_mov_b64 v[26:27], 0
v_mov_b64 v[28:29], 0
v_mov_b64 v[30:31], 0
v_cmp_gt_u32 vcc, s34, v7
s_cmp_eq_u32 vcc_hi, 0
s_cbranch_scc1 kv_10083
s_mov_b32 s30, 0
kv_10082:
v_and_b32 v7, 128, v0
buffer_load_dword v7, v7, s[4:7], s22 offen sc1
s_add_u32 s30, s30, 1
s_cmp_gt_u32 s30, 262144
s_cbranch_scc1 L_fail
s_waitcnt vmcnt(0)
v_cmp_gt_u32 vcc, s34, v7
s_cbranch_vccnz kv_10082
kv_10083:
s_barrier
v_and_b32 v7, 511, v0
v_lshl_add_u32 v7, v7, 3, s27
global_load_dwordx4 v[32:35], v0, s[68:69] offset:-4096 sc1
global_load_dwordx4 v[36:39], v0, s[68:69] offset:0 sc1
global_load_dwordx4 v[40:43], v0, s[70:71] offset:0 sc1
s_mov_b32 s30, 0
s_waitcnt vmcnt(0)
.p2align 6
gather_10073:
s_waitcnt vmcnt(4)
rt_10078_b:
v_smfmac_f32_16x16x64_bf16 v[12:15], v[32:35], a[0:7], v1
ds_write_b128 v0, v[32:35] offset:0
v_smfmac_f32_16x16x64_bf16 v[20:23], v[32:35], a[8:15], v1
v_bitop3_b32 v44, v32, v34, s18 bitop3:0x7e
v_smfmac_f32_16x16x64_bf16 v[28:31], v[32:35], v[72:79], v1
s_waitcnt vmcnt(3)
ds_write_b128 v0, v[36:39] offset:4096
v_bitop3_b32 v45, v36, v38, s18 bitop3:0x7e
v_or_b32 v44, v44, v45
s_waitcnt vmcnt(2)
v_bitop3_b32 v45, v40, v42, s18 bitop3:0x7e
v_bitop3_b32 v44, v44, v45, s19 bitop3:0xa8
v_cmp_ne_u32 vcc, 0, v44
v_smfmac_f32_16x16x64_bf16 v[8:11], v[32:35], v[64:71], v1
s_cbranch_vccnz rt_10078
global_load_dwordx4 v[64:67], v0, s[78:79] offset:-4096 sc1
ds_write_b128 v0, v[40:43] offset:8192
v_smfmac_f32_16x16x64_bf16 v[16:19], v[32:35], v[56:63], v1
global_load_dwordx4 v[68:71], v0, s[78:79] offset:-3072 sc1
v_smfmac_f32_16x16x64_bf16 v[20:23], v[36:39], a[48:55], v1
s_waitcnt lgkmcnt(1)
ds_read_b128 v[60:63], v2 offset:1024
global_load_dwordx4 v[72:75], v0, s[78:79] offset:-2048 sc1
v_smfmac_f32_16x16x64_bf16 v[16:19], v[36:39], a[40:47], v1
ds_read_b128 v[56:59], v2 offset:0
s_waitcnt lgkmcnt(2)
v_smfmac_f32_16x16x64_bf16 v[24:27], v[32:35], a[16:23], v1
s_barrier
ds_read_b128 v[40:43], v0 offset:1024
v_smfmac_f32_16x16x64_bf16 v[12:15], v[36:39], a[32:39], v1
ds_read_b128 v[44:47], v0 offset:5120
s_waitcnt lgkmcnt(3)
v_smfmac_f32_16x16x64_bf16 v[8:11], v[36:39], a[24:31], v1
ds_read_b128 v[32:35], v0 offset:2048
s_waitcnt lgkmcnt(3)
v_smfmac_f32_16x16x64_bf16 v[28:31], v[36:39], v[56:63], v1
ds_read_b128 v[56:59], v2 offset:2048
v_smfmac_f32_16x16x64_bf16 v[24:27], v[36:39], a[56:63], v1
ds_read_b128 v[60:63], v2 offset:3072
s_waitcnt lgkmcnt(4)
v_smfmac_f32_16x16x64_bf16 v[8:11], v[40:43], a[64:71], v1
ds_read_b128 v[36:39], v0 offset:6144
s_waitcnt vmcnt(3)
v_smfmac_f32_16x16x64_bf16 v[12:15], v[40:43], v[48:55], v1
s_waitcnt lgkmcnt(4)
ds_read_b128 v[48:51], v2 offset:4096
v_smfmac_f32_16x16x64_bf16 v[8:11], v[44:47], a[72:79], v1
ds_read_b128 v[52:55], v2 offset:5120
s_waitcnt lgkmcnt(5)
v_smfmac_f32_16x16x64_bf16 v[12:15], v[44:47], a[80:87], v1
s_waitcnt lgkmcnt(4)
ds_read_b128 v[44:47], v0 offset:7168
s_waitcnt lgkmcnt(4)
v_smfmac_f32_16x16x64_bf16 v[12:15], v[32:35], a[88:95], v1
ds_read_b128 v[40:43], v0 offset:3072
s_waitcnt lgkmcnt(4)
v_smfmac_f32_16x16x64_bf16 v[8:11], v[32:35], v[56:63], v1
s_mov_b64 s[68:69], s[72:73]
ds_read_b128 v[56:59], v2 offset:6144
s_waitcnt lgkmcnt(4)
v_smfmac_f32_16x16x64_bf16 v[8:11], v[36:39], a[96:103], v1
ds_read_b128 v[32:35], v0 offset:8192
s_waitcnt vmcnt(2)
global_load_dwordx4 v[76:79], v0, s[78:79] offset:-1024 sc1
ds_read_b128 v[60:63], v2 offset:7168
s_waitcnt lgkmcnt(5)
v_smfmac_f32_16x16x64_bf16 v[12:15], v[36:39], v[48:55], v1
s_xor_b32 s18, s18, 1
s_waitcnt lgkmcnt(4)
ds_read_b128 v[52:55], v2 offset:9216
s_waitcnt lgkmcnt(4)
ds_read_b128 v[48:51], v2 offset:8192
v_smfmac_f32_16x16x64_bf16 v[8:11], v[40:43], a[104:111], v1
ds_read_b128 v[36:39], v0 offset:9216
s_waitcnt vmcnt(2)
v_smfmac_f32_16x16x64_bf16 v[8:11], v[44:47], v[64:71], v1
global_load_dwordx4 v[64:67], v0, s[78:79] offset:0 sc1
v_smfmac_f32_16x16x64_bf16 v[12:15], v[40:43], a[112:119], v1
s_waitcnt lgkmcnt(3)
ds_read_b128 v[40:43], v0 offset:1024
s_mov_b64 vcc, s[42:43]
v_smfmac_f32_16x16x64_bf16 v[12:15], v[44:47], v[56:63], v1
s_waitcnt lgkmcnt(3)
ds_read_b128 v[60:63], v2 offset:11264
global_load_dwordx4 v[68:71], v0, s[78:79] offset:1024 sc1
v_smfmac_f32_16x16x64_bf16 v[8:11], v[32:35], a[120:127], v1
s_waitcnt lgkmcnt(3)
ds_read_b128 v[56:59], v2 offset:10240
v_smfmac_f32_16x16x64_bf16 v[12:15], v[32:35], v[48:55], v1
s_waitcnt lgkmcnt(3)
ds_read_b128 v[32:35], v0 offset:5120
v_smfmac_f32_16x16x64_bf16 v[12:15], v[36:39], a[136:143], v1
s_nop 0
global_load_dwordx4 v[48:51], v0, s[58:59] offset:0 nt sc1
v_smfmac_f32_16x16x64_bf16 v[8:11], v[36:39], a[128:135], v1
s_waitcnt lgkmcnt(3)
ds_read_b128 v[36:39], v0 offset:2048
global_load_dwordx4 v[52:55], v0, s[58:59] offset:1024 nt sc1
v_smfmac_f32_16x16x64_bf16 v[20:23], v[40:43], a[152:159], v1
s_nop 0
v_add_f32 v13, v13, v15
v_smfmac_f32_16x16x64_bf16 v[16:19], v[40:43], a[144:151], v1
s_waitcnt lgkmcnt(1)
ds_read_b128 v[40:43], v0 offset:6144
v_add_f32 v9, v9, v11
v_smfmac_f32_16x16x64_bf16 v[20:23], v[32:35], v[56:63], v1
ds_read_b128 v[56:59], v2 offset:12288
ds_read_b128 v[60:63], v2 offset:13312
v_smfmac_f32_16x16x64_bf16 v[16:19], v[32:35], a[160:167], v1
s_waitcnt lgkmcnt(3)
v_add_f32 v8, v8, v10
v_smfmac_f32_16x16x64_bf16 v[20:23], v[36:39], a[176:183], v1
s_waitcnt vmcnt(5)
ds_read_b128 v[32:35], v0 offset:3072
v_mul_f32 v9, s35, v9
v_add_f32 v12, v12, v14
v_mul_f32 v13, s35, v13
v_mul_f32 v8, s35, v8
v_mul_f32 v12, s35, v12
v_cvt_pk_bf16_f32 v12, v12, v13
v_cvt_pk_bf16_f32 v8, v8, v9
v_smfmac_f32_16x16x64_bf16 v[16:19], v[36:39], a[168:175], v1
s_waitcnt lgkmcnt(2)
ds_read_b128 v[36:39], v0 offset:7168
ds_write2_b32 v3, v8, v12 offset0:0 offset1:128
s_waitcnt lgkmcnt(3)
v_smfmac_f32_16x16x64_bf16 v[16:19], v[40:43], v[56:63], v1
s_waitcnt vmcnt(4)
global_load_dwordx4 v[56:59], v0, s[58:59] offset:2048 nt sc1
v_smfmac_f32_16x16x64_bf16 v[20:23], v[40:43], v[72:79], v1
s_waitcnt lgkmcnt(2)
global_load_dwordx4 v[60:63], v0, s[58:59] offset:3072 nt sc1
ds_read_b128 v[40:43], v0 offset:8192
v_smfmac_f32_16x16x64_bf16 v[16:19], v[32:35], a[184:191], v1
global_load_dwordx4 v[72:75], v0, s[78:79] offset:2048 sc1
v_smfmac_f32_16x16x64_bf16 v[20:23], v[32:35], a[192:199], v1
s_waitcnt lgkmcnt(1)
ds_read_b128 v[32:35], v0 offset:9216
global_load_dwordx4 v[76:79], v0, s[78:79] offset:3072 sc1
v_smfmac_f32_16x16x64_bf16 v[16:19], v[36:39], a[200:207], v1
s_barrier
v_smfmac_f32_16x16x64_bf16 v[20:23], v[36:39], a[208:215], v1
s_waitcnt lgkmcnt(1)
ds_read_b64_tr_b16 v[10:11], v4 offset:512
ds_read_b64_tr_b16 v[8:9], v4 offset:0
v_smfmac_f32_16x16x64_bf16 v[16:19], v[40:43], a[216:223], v1
s_add_u32 s20, s20, 524288
ds_read_b64_tr_b16 v[14:15], v4 offset:1536
s_waitcnt lgkmcnt(3)
ds_read_b64_tr_b16 v[12:13], v4 offset:1024
v_smfmac_f32_16x16x64_bf16 v[16:19], v[32:35], a[232:239], v1
ds_read_b128 v[36:39], v0 offset:8192
v_smfmac_f32_16x16x64_bf16 v[20:23], v[40:43], a[224:231], v1
v_smfmac_f32_16x16x64_bf16 v[20:23], v[32:35], a[240:247], v1
s_waitcnt lgkmcnt(2)
ds_read_b128 v[32:35], v0 offset:1024
s_waitcnt vmcnt(5)
ds_read_b128 v[40:43], v0 offset:9216
v_mfma_f32_16x16x32_bf16 v[44:47], v[48:51], v[8:11], 0
s_waitcnt lgkmcnt(3)
ds_read_b128 v[8:11], v2 offset:14336
v_bfe_u32 v48, v0, 5, 1
v_add_f32 v17, v17, v19
v_add_f32 v16, v16, v18
s_waitcnt vmcnt(4)
v_mfma_f32_16x16x32_bf16 v[44:47], v[52:55], v[12:15], v[44:47]
s_waitcnt lgkmcnt(3)
ds_read_b128 v[52:55], v2 offset:17408
ds_read_b128 v[12:15], v2 offset:15360
v_lshl_add_u32 v48, v48, 3, v5
v_add_f32 v20, v20, v22
v_add_f32 v21, v21, v23
v_cvt_pk_bf16_f32 v16, v16, v17
s_nop 0
v_cndmask_b32_dpp v45, v47, v45, vcc quad_perm:[0,1,0,1] row_mask:0xf bank_mask:0xf
v_cndmask_b32_dpp v44, v46, v44, vcc quad_perm:[0,1,0,1] row_mask:0xf bank_mask:0xf
v_smfmac_f32_16x16x64_bf16 v[28:31], v[36:39], v[80:87], v1
ds_write_b64 v48, v[44:45] offset:6144
v_cvt_pk_bf16_f32 v20, v20, v21
v_smfmac_f32_16x16x64_bf16 v[24:27], v[36:39], a[248:255], v1
s_waitcnt lgkmcnt(2)
ds_read_b128 v[48:51], v2 offset:16384
global_load_dword v7, v7, s[4:5] sc1
ds_write2_b32 v3, v16, v20 offset0:1 offset1:129
s_waitcnt lgkmcnt(3)
v_smfmac_f32_16x16x64_bf16 v[24:27], v[40:43], v[8:15], v1
ds_read_b128 v[36:39], v0 offset:5120
s_mov_b64 s[70:71], s[74:75]
v_smfmac_f32_16x16x64_bf16 v[24:27], v[32:35], v[88:95], v1
s_waitcnt lgkmcnt(2)
v_smfmac_f32_16x16x64_bf16 v[28:31], v[40:43], v[48:55], v1
ds_read_b128 v[40:43], v0 offset:2048
v_smfmac_f32_16x16x64_bf16 v[28:31], v[32:35], v[96:103], v1
s_waitcnt lgkmcnt(2)
ds_read_b128 v[32:35], v0 offset:6144
s_barrier
ds_read_b64_tr_b16 v[12:13], v4 offset:1024
s_waitcnt lgkmcnt(3)
ds_read_b128 v[48:51], v6 offset:6144
v_smfmac_f32_16x16x64_bf16 v[28:31], v[36:39], v[104:111], v1
ds_read_b128 v[52:55], v6 offset:7168
s_waitcnt lgkmcnt(4)
ds_read_b64_tr_b16 v[10:11], v4 offset:512
v_smfmac_f32_16x16x64_bf16 v[24:27], v[36:39], v[64:71], v1
ds_read_b64_tr_b16 v[18:19], v4 offset:2560
s_add_u32 s17, s17, 1
ds_read_b64_tr_b16 v[8:9], v4 offset:0
v_smfmac_f32_16x16x64_bf16 v[28:31], v[40:43], v[120:127], v1
s_waitcnt lgkmcnt(6)
ds_read_b64_tr_b16 v[22:23], v4 offset:3584
s_mov_b32 s30, 0
ds_read_b64_tr_b16 v[16:17], v4 offset:2048
v_smfmac_f32_16x16x64_bf16 v[24:27], v[40:43], v[112:119], v1
s_waitcnt vmcnt(1)
ds_read_b64_tr_b16 v[14:15], v4 offset:1536
s_waitcnt lgkmcnt(8)
ds_read_b128 v[40:43], v0 offset:7168
v_smfmac_f32_16x16x64_bf16 v[24:27], v[32:35], v[128:135], v1
ds_read_b128 v[68:71], v2 offset:19456
s_waitcnt lgkmcnt(6)
ds_read_b128 v[36:39], v0 offset:3072
v_smfmac_f32_16x16x64_bf16 v[28:31], v[32:35], v[136:143], v1
s_waitcnt lgkmcnt(6)
ds_read_b64_tr_b16 v[20:21], v4 offset:3072
v_add_f32 v50, v50, v54
v_add_f32 v48, v48, v52
v_mfma_f32_16x16x32_bf16 v[44:47], v[8:11], v[8:11], 0
s_waitcnt lgkmcnt(4)
ds_read_b128 v[64:67], v2 offset:18432
v_add_f32 v51, v51, v55
v_mfma_f32_16x16x32_bf16 v[44:47], v[12:15], v[12:15], v[44:47]
v_add_f32 v49, v49, v53
v_exp_f32 v50, v50
v_exp_f32 v51, v51
v_exp_f32 v48, v48
v_exp_f32 v49, v49
v_mfma_f32_16x16x32_bf16 v[44:47], v[16:19], v[16:19], v[44:47]
s_waitcnt lgkmcnt(1)
v_cvt_pk_bf16_f32 v55, v50, v51
v_cvt_pk_bf16_f32 v54, v48, v49
v_mfma_f32_16x16x32_bf16 v[44:47], v[20:23], v[20:23], v[44:47]
s_waitcnt lgkmcnt(0)
v_mov_b32_dpp v50, v54 quad_perm:[2,3,2,3] row_mask:0xf bank_mask:0xf
v_mov_b64 v[20:21], s[44:45]
v_smfmac_f32_16x16x64_bf16 v[24:27], v[36:39], v[64:71], v1
ds_read_b128 v[64:67], v2 offset:20480
v_mov_b32_dpp v51, v55 quad_perm:[2,3,2,3] row_mask:0xf bank_mask:0xf
v_smfmac_f32_16x16x64_bf16 v[28:31], v[36:39], v[144:151], v1
ds_read_b128 v[68:71], v2 offset:21504
v_mov_b64 v[22:23], s[44:45]
v_mov_b32_dpp v49, v55 quad_perm:[0,1,0,1] row_mask:0xf bank_mask:0xf
v_smfmac_f32_16x16x64_bf16 v[24:27], v[40:43], v[72:79], v1
ds_read_b128 v[76:79], v2 offset:23552
v_mov_b32_dpp v48, v54 quad_perm:[0,1,0,1] row_mask:0xf bank_mask:0xf
v_smfmac_f32_16x16x64_bf16 v[28:31], v[40:43], v[152:159], v1
ds_read_b128 v[72:75], v2 offset:22528
v_exp_f32_dpp v45, v47 quad_perm:[0,1,0,1] row_mask:0xf bank_mask:0xf
v_mfma_f32_16x16x32_bf16 v[12:15], v[60:63], v[48:51], 0
v_exp_f32_dpp v44, v46 quad_perm:[0,1,0,1] row_mask:0xf bank_mask:0xf
v_mfma_f32_16x16x32_bf16 v[16:19], v[20:23], v[48:51], 0
v_mov_b64 v[54:55], s[46:47]
v_cvt_pk_bf16_f32 v52, v44, v45
v_cvt_pk_bf16_f32 v53, v44, v45
v_mfma_f32_16x16x32_bf16 v[8:11], v[56:59], v[48:51], 0
v_cvt_pk_bf16_f32 v24, v24, v25
v_cvt_pk_bf16_f32 v25, v26, v27
v_mfma_f32_16x16x16_bf16 v[16:19], v[54:55], v[52:53], v[16:19]
s_waitcnt lgkmcnt(0)
v_cvt_pk_bf16_f32 v27, v30, v31
v_cvt_pk_bf16_f32 v26, v28, v29
v_mfma_f32_16x16x16_bf16 v[8:11], v[24:25], v[52:53], v[8:11]
ds_read_b128 v[28:31], v0 offset:19456
v_bfe_u32 v32, v0, 5, 1
v_mfma_f32_16x16x16_bf16 v[12:15], v[26:27], v[52:53], v[12:15]
s_add_u32 s21, s21, 10240
v_subrev_u32 v17, s37, v16
v_mov_b64 v[42:43], 0
v_rcp_f32 v18, v16
v_cmp_lt_u32 vcc, s38, v17
v_lshl_add_u32 v32, v32, 3, v5
v_mov_b64 v[40:41], 0
v_mov_b64 v[36:37], 0
v_cndmask_b32 v10, v14, v10, s[42:43]
v_mul_f32 v10, v10, v18
v_cndmask_b32 v9, v13, v9, s[42:43]
v_cndmask_b32 v11, v15, v11, s[42:43]
v_cndmask_b32 v8, v12, v8, s[42:43]
v_mul_f32 v8, v8, v18
v_mul_f32 v9, v9, v18
v_cvt_pk_bf16_f32 v12, v8, v9
v_mul_f32 v11, v11, v18
v_cvt_pk_bf16_f32 v13, v10, v11
s_cbranch_vccnz rare_10074
back_10075:
ds_write_b64 v32, v[12:13] offset:0
v_mov_b64 v[50:51], 0
v_mov_b32_dpp v10, v12 quad_perm:[2,3,2,3] row_mask:0xf bank_mask:0xf
v_mov_b32_dpp v9, v13 quad_perm:[0,1,0,1] row_mask:0xf bank_mask:0xf
v_mov_b32_dpp v11, v13 quad_perm:[2,3,2,3] row_mask:0xf bank_mask:0xf
v_mov_b32_dpp v8, v12 quad_perm:[0,1,0,1] row_mask:0xf bank_mask:0xf
v_mov_b64 v[38:39], 0
v_mov_b64 v[32:33], 0
v_mov_b64 v[48:49], 0
v_smfmac_f32_16x16x64_bf16 v[36:39], v[8:11], v[64:71], v1
s_add_u32 s34, s17, 2
ds_read_b128 v[24:27], v0 offset:18432
global_load_dwordx4 v[64:67], v0, s[76:77] offset:-4096 sc1
ds_read_b128 v[16:19], v0 offset:16384
v_mov_b64 v[34:35], 0
v_smfmac_f32_16x16x64_bf16 v[40:43], v[8:11], v[72:79], v1
s_waitcnt lgkmcnt(2)
ds_read_b128 v[20:23], v0 offset:17408
s_barrier
ds_read_b128 v[56:59], v5 offset:512
v_smfmac_f32_16x16x64_bf16 v[32:35], v[8:11], v[176:183], v1
global_load_dwordx4 v[68:71], v0, s[76:77] offset:-3072 sc1
s_waitcnt lgkmcnt(3)
ds_read_b128 v[60:63], v5 offset:1024
v_lshrrev_b32 v44, 8, v0
v_smfmac_f32_16x16x64_bf16 v[48:51], v[8:11], v[160:167], v1
ds_read_b128 v[12:15], v5 offset:1536
global_load_dwordx4 v[72:75], v0, s[76:77] offset:0 sc1
v_bfe_u32 v45, v0, 1, 7
v_mov_b64 v[54:55], 0
s_waitcnt lgkmcnt(2)
v_smfmac_f32_16x16x64_bf16 v[48:51], v[56:59], v[208:215], v1
s_min_u32 s34, s34, s32
global_load_dwordx4 v[76:79], v0, s[76:77] offset:1024 sc1
v_smfmac_f32_16x16x64_bf16 v[36:39], v[56:59], v[16:23], v1
s_mov_b32 s19, 1
ds_read_b128 v[16:19], v0 offset:20480
s_waitcnt lgkmcnt(2)
v_smfmac_f32_16x16x64_bf16 v[36:39], v[60:63], v[24:31], v1
s_add_u32 s27, s20, 524288
ds_read_b128 v[20:23], v0 offset:21504
v_smfmac_f32_16x16x64_bf16 v[32:35], v[56:59], v[232:239], v1
s_waitcnt lgkmcnt(2)
ds_read_b128 v[28:31], v0 offset:23552
v_mov_b64 v[52:53], 0
v_smfmac_f32_16x16x64_bf16 v[36:39], v[12:15], v[184:191], v1
v_lshl_or_b32 v44, v44, 12, v45
v_smfmac_f32_16x16x64_bf16 v[40:43], v[56:59], v[192:199], v1
s_nop 0
ds_read_b128 v[24:27], v0 offset:22528
s_nop 0
v_smfmac_f32_16x16x64_bf16 v[40:43], v[60:63], v[200:207], v1
s_add_u32 s58, s4, s20
s_waitcnt lgkmcnt(2)
v_cvt_pk_bf16_f32 v36, v36, v37
v_smfmac_f32_16x16x64_bf16 v[40:43], v[12:15], v[16:23], v1
ds_read_b128 v[20:23], v0 offset:25600
v_and_or_b32 v36, v36, -2, s18
v_cvt_pk_bf16_f32 v37, v38, v39
v_smfmac_f32_16x16x64_bf16 v[32:35], v[60:63], v[240:247], v1
global_store_dwordx2 v44, v[36:37], s[48:49]
v_smfmac_f32_16x16x64_bf16 v[48:51], v[60:63], v[216:223], v1
s_waitcnt lgkmcnt(1)
ds_read_b128 v[16:19], v0 offset:24576
v_cvt_pk_bf16_f32 v40, v40, v41
v_smfmac_f32_16x16x64_bf16 v[48:51], v[12:15], v[24:31], v1
s_addc_u32 s59, s5, 0
ds_read_b128 v[24:27], v0 offset:26624
v_and_or_b32 v40, v40, -2, s18
v_cvt_pk_bf16_f32 v41, v42, v43
v_smfmac_f32_16x16x64_bf16 v[32:35], v[12:15], v[248:255], v1
global_store_dwordx2 v44, v[40:41], s[50:51]
ds_read_b128 v[28:31], v0 offset:27648
v_smfmac_f32_16x16x64_bf16 v[52:55], v[8:11], v[168:175], v1
v_cvt_pk_bf16_f32 v48, v48, v49
v_smfmac_f32_16x16x64_bf16 v[52:55], v[56:59], v[224:231], v1
s_waitcnt lgkmcnt(2)
v_and_or_b32 v48, v48, -2, s18
v_cvt_pk_bf16_f32 v49, v50, v51
v_smfmac_f32_16x16x64_bf16 v[52:55], v[60:63], v[16:23], v1
s_waitcnt lgkmcnt(1)
global_store_dwordx2 v44, v[48:49], s[52:53]
s_waitcnt lgkmcnt(0)
v_smfmac_f32_16x16x64_bf16 v[52:55], v[12:15], v[24:31], v1
s_nop 1
v_cvt_pk_bf16_f32 v32, v32, v33
v_and_or_b32 v32, v32, -2, s18
v_cvt_pk_bf16_f32 v33, v34, v35
s_nop 2
v_cvt_pk_bf16_f32 v52, v52, v53
v_and_or_b32 v52, v52, -2, s18
v_cvt_pk_bf16_f32 v53, v54, v55
global_store_dwordx2 v44, v[52:53], s[54:55]
global_store_dwordx2 v44, v[32:33], s[56:57]
v_bfe_u32 v32, v0, 6, 1
v_lshlrev_b32 v32, 4, v32
v_mov_b32 v33, 0x3f80
v_lshlrev_b32 v32, v32, v33
v_bfe_i32 v33, v0, 4, 1
v_and_b32 v45, v32, v33
v_and_b32 v47, v32, v33
v_xor_b32 v44, v32, v45
v_xor_b32 v46, v32, v45
v_and_b32 v36, 32, v0
v_bfe_u32 v37, v0, 6, 1
v_lshl_add_u32 v36, v37, 8, v36
v_bfe_u32 v37, v0, 8, 1
v_lshl_add_u32 v36, v37, 4, v36
v_bfe_u32 v37, v0, 4, 1
v_lshl_add_u32 v36, v37, 3, v36
s_waitcnt vmcnt(9)
v_and_b32 v7, 511, v0
v_lshl_add_u32 v7, v7, 3, s27
s_nop 15
s_nop 15
s_nop 15
s_nop 8
global_load_dwordx4 v[8:11], v0, s[64:65] offset:0 sc1
global_load_dwordx4 v[12:15], v0, s[64:65] offset:1024 sc1
global_load_dwordx4 v[16:19], v0, s[64:65] offset:2048 sc1
global_load_dwordx4 v[20:23], v0, s[64:65] offset:3072 sc1
chk_10086:
v_mov_b64 v[40:41], 0
v_mov_b64 v[42:43], 0
s_waitcnt vmcnt(2)
s_nop 0
v_smfmac_f32_16x16x64_bf16 v[40:43], v[44:47], v[8:15], v1
v_bitop3_b32 v32, v8, v10, s18 bitop3:0x7e
v_bitop3_b32 v33, v12, v14, s18 bitop3:0x7e
s_waitcnt vmcnt(0)
v_smfmac_f32_16x16x64_bf16 v[40:43], v[44:47], v[16:23], v1
v_bitop3_b32 v34, v16, v18, s18 bitop3:0x7e
v_bitop3_b32 v35, v20, v22, s18 bitop3:0x7e
v_or3_b32 v37, v32, v33, v34
v_bitop3_b32 v37, v37, v35, 1 bitop3:0xa8
v_cmp_ne_u32 vcc, 0, v37
s_cbranch_vccnz chk_10086_f
s_nop 1
v_add_f32_dpp v40, v40, v40 row_ror:8 row_mask:0xf bank_mask:0xf
v_add_f32_dpp v41, v41, v41 row_ror:8 row_mask:0xf bank_mask:0xf
v_add_f32_dpp v42, v42, v42 row_ror:8 row_mask:0xf bank_mask:0xf
v_add_f32_dpp v43, v43, v43 row_ror:8 row_mask:0xf bank_mask:0xf
v_cvt_pk_bf16_f32 v40, v40, v41
v_cvt_pk_bf16_f32 v41, v42, v43
v_and_or_b32 v40, v40, -2, s18
s_mov_b64 exec, 0x00ff00ff
global_store_dwordx2 v36, v[40:41], s[66:67]
s_mov_b64 exec, -1
s_branch join_10085
chk_10086_f:
global_load_dwordx4 v[8:11], v0, s[64:65] offset:0 sc1
global_load_dwordx4 v[12:15], v0, s[64:65] offset:1024 sc1
global_load_dwordx4 v[16:19], v0, s[64:65] offset:2048 sc1
global_load_dwordx4 v[20:23], v0, s[64:65] offset:3072 sc1
s_add_u32 s30, s30, 1
s_cmp_le_u32 s30, 262144
s_cbranch_scc1 chk_10086
s_branch L_fail
nored_10084:
join_10085:
s_nop 11
s_barrier
global_load_dwordx4 v[56:59], v0, s[76:77] offset:-2048 sc1
global_load_dwordx4 v[60:63], v0, s[76:77] offset:-1024 sc1
s_nop 15
s_nop 15
s_nop 5
s_barrier
global_load_dwordx4 v[32:35], v0, s[68:69] offset:-4096 sc1
s_nop 10
global_load_dwordx4 v[36:39], v0, s[68:69] offset:0 sc1
s_nop 10
global_load_dwordx4 v[40:43], v0, s[70:71] offset:0 sc1
s_barrier
global_load_dwordx4 v[48:51], v0, s[76:77] offset:2048 sc1
global_load_dwordx4 v[52:55], v0, s[76:77] offset:3072 sc1
v_mov_b64 v[8:9], 0
v_mov_b64 v[10:11], 0
v_mov_b64 v[12:13], 0
v_mov_b64 v[14:15], 0
v_mov_b64 v[16:17], 0
v_mov_b64 v[18:19], 0
v_mov_b64 v[20:21], 0
v_mov_b64 v[22:23], 0
v_mov_b64 v[24:25], 0
v_mov_b64 v[26:27], 0
v_mov_b64 v[28:29], 0
v_mov_b64 v[30:31], 0
s_mov_b32 s30, 0
s_cmp_eq_u32 s17, s31
s_cbranch_scc0 gather_10073
s_branch exit_10076
rt_10078:
global_load_dwordx4 v[32:35], v0, s[68:69] offset:-4096 sc1
global_load_dwordx4 v[36:39], v0, s[68:69] offset:0 sc1
global_load_dwordx4 v[40:43], v0, s[70:71] offset:0 sc1
s_add_u32 s30, s30, 1
s_cmp_gt_u32 s30, 262144
s_cbranch_scc1 L_fail
s_mov_b64 exec, 1
global_store_dword v0, v0, s[62:63]
global_store_dword v0, v0, s[62:63]
s_mov_b64 exec, -1
v_mov_b64 v[8:9], 0
v_mov_b64 v[10:11], 0
v_mov_b64 v[12:13], 0
v_mov_b64 v[14:15], 0
v_mov_b64 v[16:17], 0
v_mov_b64 v[18:19], 0
v_mov_b64 v[20:21], 0
v_mov_b64 v[22:23], 0
v_mov_b64 v[24:25], 0
v_mov_b64 v[26:27], 0
v_mov_b64 v[28:29], 0
v_mov_b64 v[30:31], 0
s_branch gather_10073
rare_10074:
ds_read_b128 v[48:51], v6 offset:6144
ds_read_b128 v[52:55], v6 offset:7168
s_waitcnt lgkmcnt(0)
v_add_f32 v48, v48, v52
v_add_f32 v49, v49, v53
v_add_f32 v50, v50, v54
v_add_f32 v51, v51, v55
v_mov_b32_dpp v46, v46 quad_perm:[0,1,0,1] row_mask:0xf bank_mask:0xf
v_mov_b32_dpp v47, v47 quad_perm:[0,1,0,1] row_mask:0xf bank_mask:0xf
v_max3_f32 v19, v48, v49, v50
v_max3_f32 v19, v19, v51, v46
v_max_f32 v19, v19, v47
s_nop 1
v_max_f32_dpp v19, v19, v19 quad_perm:[2,3,0,1] row_mask:0xf bank_mask:0xf
v_mov_b32 v44, v19
s_nop 1
v_permlane32_swap_b32 v19, v44
v_max_f32 v19, v19, v44
v_mov_b32 v44, v19
s_nop 1
v_permlane16_swap_b32 v19, v44
v_max_f32 v19, v19, v44
v_sub_f32 v48, v48, v19
v_sub_f32 v49, v49, v19
v_sub_f32 v50, v50, v19
v_sub_f32 v51, v51, v19
v_sub_f32 v46, v46, v19
v_sub_f32 v47, v47, v19
v_exp_f32 v48, v48
v_exp_f32 v49, v49
v_exp_f32 v50, v50
v_exp_f32 v51, v51
v_cvt_pk_bf16_f32 v54, v48, v49
v_cvt_pk_bf16_f32 v55, v50, v51
s_nop 0
v_mov_b32_dpp v48, v54 quad_perm:[0,1,0,1] row_mask:0xf bank_mask:0xf
v_mov_b32_dpp v49, v55 quad_perm:[0,1,0,1] row_mask:0xf bank_mask:0xf
v_mov_b32_dpp v50, v54 quad_perm:[2,3,2,3] row_mask:0xf bank_mask:0xf
v_mov_b32_dpp v51, v55 quad_perm:[2,3,2,3] row_mask:0xf bank_mask:0xf
v_mov_b64 v[20:21], s[44:45]
v_mov_b64 v[22:23], s[44:45]
v_mfma_f32_16x16x32_bf16 v[8:11], v[56:59], v[48:51], 0
v_mfma_f32_16x16x32_bf16 v[12:15], v[60:63], v[48:51], 0
v_mfma_f32_16x16x32_bf16 v[16:19], v[20:23], v[48:51], 0
v_mov_b64 v[54:55], s[46:47]
v_exp_f32_dpp v44, v46 quad_perm:[0,1,0,1] row_mask:0xf bank_mask:0xf
v_exp_f32_dpp v45, v47 quad_perm:[0,1,0,1] row_mask:0xf bank_mask:0xf
s_nop 0
v_cvt_pk_bf16_f32 v52, v44, v45
v_cvt_pk_bf16_f32 v53, v44, v45
s_nop 1
v_mfma_f32_16x16x16_bf16 v[16:19], v[54:55], v[52:53], v[16:19]
v_mfma_f32_16x16x16_bf16 v[8:11], v[24:25], v[52:53], v[8:11]
v_mfma_f32_16x16x16_bf16 v[12:15], v[26:27], v[52:53], v[12:15]
s_nop 5
v_rcp_f32 v18, v16
s_nop 0
v_cndmask_b32 v8, v12, v8, s[42:43]
v_mul_f32 v8, v8, v18
v_cndmask_b32 v9, v13, v9, s[42:43]
v_mul_f32 v9, v9, v18
v_cndmask_b32 v10, v14, v10, s[42:43]
v_mul_f32 v10, v10, v18
v_cndmask_b32 v11, v15, v11, s[42:43]
v_mul_f32 v11, v11, v18
v_cvt_pk_bf16_f32 v12, v8, v9
v_cvt_pk_bf16_f32 v13, v10, v11
s_branch back_10075
exit_10076:
global_load_dwordx4 v[32:35], v0, s[68:69] offset:-4096 sc1
global_load_dwordx4 v[36:39], v0, s[68:69] offset:0 sc1
global_load_dwordx4 v[40:43], v0, s[70:71] offset:0 sc1
s_add_u32 s30, s30, 1
s_cmp_gt_u32 s30, 262144
s_cbranch_scc1 L_fail
s_waitcnt vmcnt(2)
v_bitop3_b32 v44, v32, v34, s18 bitop3:0x7e
s_waitcnt vmcnt(1)
v_bitop3_b32 v45, v36, v38, s18 bitop3:0x7e
v_or_b32 v44, v44, v45
s_waitcnt vmcnt(0)
v_bitop3_b32 v46, v40, v42, s18 bitop3:0x7e
v_bitop3_b32 v44, v44, v46, s19 bitop3:0xa8
v_cmp_ne_u32 vcc, 0, v44
s_cbranch_vccnz exit_10076
ds_write_b128 v0, v[32:35] offset:0
ds_write_b128 v0, v[36:39] offset:4096
ds_write_b128 v0, v[40:43] offset:8192
s_waitcnt lgkmcnt(0)
s_barrier
s_barrier
s_add_u32 s36, s36, 1
s_cmp_lt_u32 s36, 2
s_cbranch_scc1 layer_10072
s_endpgm
wave_10069:
layer_10087:
s_lshl_b32 s17, s36, 6
s_mul_i32 s27, s36, 35651584
s_mul_i32 s28, s14, 16384
s_add_u32 s27, s27, s28
s_add_u32 s20, s27, 16781312
s_mul_i32 s27, s17, 10240
s_add_u32 s27, s27, s24
s_add_u32 s21, s27, s25
s_mov_b32 s19, 0
s_mov_b32 s33, s6
s_add_u32 s34, s17, 1
s_add_u32 s31, s17, 63
s_add_u32 s32, s17, 64
s_mov_b32 s27, s20
v_mov_b32 v7, 0
s_add_u32 s68, s4, 414720
s_addc_u32 s69, s5, 0
s_add_u32 s72, s4, 398336
s_addc_u32 s73, s5, 0
s_add_u32 s70, s4, 418816
s_addc_u32 s71, s5, 0
s_add_u32 s74, s4, 402432
s_addc_u32 s75, s5, 0
s_add_u32 s58, s4, s20
s_addc_u32 s59, s5, 0
global_load_dwordx4 v[64:67], v0, s[76:77] offset:-4096 sc1
global_load_dwordx4 v[68:71], v0, s[76:77] offset:-3072 sc1
global_load_dwordx4 v[72:75], v0, s[76:77] offset:0 sc1
global_load_dwordx4 v[76:79], v0, s[76:77] offset:1024 sc1
global_load_dwordx4 v[48:51], v0, s[76:77] offset:2048 sc1
global_load_dwordx4 v[52:55], v0, s[76:77] offset:3072 sc1
global_load_dwordx4 v[56:59], v0, s[76:77] offset:-2048 sc1
global_load_dwordx4 v[60:63], v0, s[76:77] offset:-1024 sc1
v_mov_b64 v[8:9], 0
v_mov_b64 v[10:11], 0
v_mov_b64 v[12:13], 0
v_mov_b64 v[14:15], 0
v_mov_b64 v[16:17], 0
v_mov_b64 v[18:19], 0
v_mov_b64 v[20:21], 0
v_mov_b64 v[22:23], 0
v_mov_b64 v[24:25], 0
v_mov_b64 v[26:27], 0
v_mov_b64 v[28:29], 0
v_mov_b64 v[30:31], 0
s_barrier
v_and_b32 v7, 511, v0
v_lshl_add_u32 v7, v7, 3, s27
global_load_dwordx4 v[32:35], v0, s[68:69] offset:-4096 sc1
global_load_dwordx4 v[36:39], v0, s[68:69] offset:0 sc1
global_load_dwordx4 v[40:43], v0, s[70:71] offset:0 sc1
s_mov_b32 s30, 0
s_waitcnt vmcnt(0)
.p2align 6
gather_10088:
s_waitcnt vmcnt(4)
rt_10093_b:
v_smfmac_f32_16x16x64_bf16 v[12:15], v[32:35], a[0:7], v1
ds_write_b128 v0, v[32:35] offset:1024
v_smfmac_f32_16x16x64_bf16 v[20:23], v[32:35], a[8:15], v1
v_bitop3_b32 v44, v32, v34, s18 bitop3:0x7e
v_smfmac_f32_16x16x64_bf16 v[28:31], v[32:35], v[72:79], v1
s_waitcnt vmcnt(3)
ds_write_b128 v0, v[36:39] offset:5120
v_bitop3_b32 v45, v36, v38, s18 bitop3:0x7e
v_or_b32 v44, v44, v45
s_waitcnt vmcnt(2)
v_bitop3_b32 v45, v40, v42, s18 bitop3:0x7e
v_bitop3_b32 v44, v44, v45, s19 bitop3:0xa8
v_cmp_ne_u32 vcc, 0, v44
v_smfmac_f32_16x16x64_bf16 v[8:11], v[32:35], v[64:71], v1
s_cbranch_vccnz rt_10093
global_load_dwordx4 v[64:67], v0, s[78:79] offset:-4096 sc1
ds_write_b128 v0, v[40:43] offset:9216
v_smfmac_f32_16x16x64_bf16 v[16:19], v[32:35], v[56:63], v1
global_load_dwordx4 v[68:71], v0, s[78:79] offset:-3072 sc1
v_smfmac_f32_16x16x64_bf16 v[20:23], v[36:39], a[48:55], v1
s_waitcnt lgkmcnt(1)
ds_read_b128 v[60:63], v2 offset:1024
global_load_dwordx4 v[72:75], v0, s[78:79] offset:-2048 sc1
v_smfmac_f32_16x16x64_bf16 v[16:19], v[36:39], a[40:47], v1
ds_read_b128 v[56:59], v2 offset:0
s_waitcnt lgkmcnt(2)
v_smfmac_f32_16x16x64_bf16 v[24:27], v[32:35], a[16:23], v1
s_barrier
ds_read_b128 v[40:43], v0 offset:0
v_smfmac_f32_16x16x64_bf16 v[12:15], v[36:39], a[32:39], v1
ds_read_b128 v[44:47], v0 offset:4096
s_waitcnt lgkmcnt(3)
v_smfmac_f32_16x16x64_bf16 v[8:11], v[36:39], a[24:31], v1
ds_read_b128 v[32:35], v0 offset:3072
s_waitcnt lgkmcnt(3)
v_smfmac_f32_16x16x64_bf16 v[28:31], v[36:39], v[56:63], v1
ds_read_b128 v[56:59], v2 offset:2048
v_smfmac_f32_16x16x64_bf16 v[24:27], v[36:39], a[56:63], v1
ds_read_b128 v[60:63], v2 offset:3072
s_waitcnt lgkmcnt(4)
v_smfmac_f32_16x16x64_bf16 v[8:11], v[40:43], a[64:71], v1
ds_read_b128 v[36:39], v0 offset:7168
s_waitcnt vmcnt(3)
v_smfmac_f32_16x16x64_bf16 v[12:15], v[40:43], v[48:55], v1
s_waitcnt lgkmcnt(4)
ds_read_b128 v[48:51], v2 offset:4096
v_smfmac_f32_16x16x64_bf16 v[8:11], v[44:47], a[72:79], v1
ds_read_b128 v[52:55], v2 offset:5120
s_waitcnt lgkmcnt(5)
v_smfmac_f32_16x16x64_bf16 v[12:15], v[44:47], a[80:87], v1
s_waitcnt lgkmcnt(4)
ds_read_b128 v[44:47], v0 offset:6144
s_waitcnt lgkmcnt(4)
v_smfmac_f32_16x16x64_bf16 v[12:15], v[32:35], a[88:95], v1
ds_read_b128 v[40:43], v0 offset:2048
s_waitcnt lgkmcnt(4)
v_smfmac_f32_16x16x64_bf16 v[8:11], v[32:35], v[56:63], v1
s_mov_b64 s[68:69], s[72:73]
ds_read_b128 v[56:59], v2 offset:6144
s_waitcnt lgkmcnt(4)
v_smfmac_f32_16x16x64_bf16 v[8:11], v[36:39], a[96:103], v1
ds_read_b128 v[32:35], v0 offset:9216
s_waitcnt vmcnt(2)
global_load_dwordx4 v[76:79], v0, s[78:79] offset:-1024 sc1
ds_read_b128 v[60:63], v2 offset:7168
s_waitcnt lgkmcnt(5)
v_smfmac_f32_16x16x64_bf16 v[12:15], v[36:39], v[48:55], v1
s_xor_b32 s18, s18, 1
s_waitcnt lgkmcnt(4)
ds_read_b128 v[52:55], v2 offset:9216
s_waitcnt lgkmcnt(4)
ds_read_b128 v[48:51], v2 offset:8192
v_smfmac_f32_16x16x64_bf16 v[8:11], v[40:43], a[104:111], v1
ds_read_b128 v[36:39], v0 offset:8192
s_waitcnt vmcnt(2)
v_smfmac_f32_16x16x64_bf16 v[8:11], v[44:47], v[64:71], v1
global_load_dwordx4 v[64:67], v0, s[78:79] offset:0 sc1
v_smfmac_f32_16x16x64_bf16 v[12:15], v[40:43], a[112:119], v1
s_waitcnt lgkmcnt(3)
ds_read_b128 v[40:43], v0 offset:0
s_mov_b64 vcc, s[42:43]
v_smfmac_f32_16x16x64_bf16 v[12:15], v[44:47], v[56:63], v1
s_waitcnt lgkmcnt(3)
ds_read_b128 v[60:63], v2 offset:11264
global_load_dwordx4 v[68:71], v0, s[78:79] offset:1024 sc1
v_smfmac_f32_16x16x64_bf16 v[8:11], v[32:35], a[120:127], v1
s_waitcnt lgkmcnt(3)
ds_read_b128 v[56:59], v2 offset:10240
v_smfmac_f32_16x16x64_bf16 v[12:15], v[32:35], v[48:55], v1
s_waitcnt lgkmcnt(3)
ds_read_b128 v[32:35], v0 offset:4096
v_smfmac_f32_16x16x64_bf16 v[12:15], v[36:39], a[136:143], v1
s_nop 0
global_load_dwordx4 v[48:51], v0, s[58:59] offset:0 nt sc1
v_smfmac_f32_16x16x64_bf16 v[8:11], v[36:39], a[128:135], v1
s_waitcnt lgkmcnt(3)
ds_read_b128 v[36:39], v0 offset:3072
global_load_dwordx4 v[52:55], v0, s[58:59] offset:1024 nt sc1
v_smfmac_f32_16x16x64_bf16 v[20:23], v[40:43], a[152:159], v1
s_nop 0
v_add_f32 v13, v13, v15
v_smfmac_f32_16x16x64_bf16 v[16:19], v[40:43], a[144:151], v1
s_waitcnt lgkmcnt(1)
ds_read_b128 v[40:43], v0 offset:7168
v_add_f32 v9, v9, v11
v_smfmac_f32_16x16x64_bf16 v[20:23], v[32:35], v[56:63], v1
ds_read_b128 v[56:59], v2 offset:12288
ds_read_b128 v[60:63], v2 offset:13312
v_smfmac_f32_16x16x64_bf16 v[16:19], v[32:35], a[160:167], v1
s_waitcnt lgkmcnt(3)
v_add_f32 v8, v8, v10
v_smfmac_f32_16x16x64_bf16 v[20:23], v[36:39], a[176:183], v1
s_waitcnt vmcnt(5)
ds_read_b128 v[32:35], v0 offset:2048
v_mul_f32 v9, s35, v9
v_add_f32 v12, v12, v14
v_mul_f32 v13, s35, v13
v_mul_f32 v8, s35, v8
v_mul_f32 v12, s35, v12
v_cvt_pk_bf16_f32 v12, v12, v13
v_cvt_pk_bf16_f32 v8, v8, v9
v_smfmac_f32_16x16x64_bf16 v[16:19], v[36:39], a[168:175], v1
s_waitcnt lgkmcnt(2)
ds_read_b128 v[36:39], v0 offset:6144
ds_write2_b32 v3, v8, v12 offset0:0 offset1:128
s_waitcnt lgkmcnt(3)
v_smfmac_f32_16x16x64_bf16 v[16:19], v[40:43], v[56:63], v1
s_waitcnt vmcnt(4)
global_load_dwordx4 v[56:59], v0, s[58:59] offset:2048 nt sc1
v_smfmac_f32_16x16x64_bf16 v[20:23], v[40:43], v[72:79], v1
s_waitcnt lgkmcnt(2)
global_load_dwordx4 v[60:63], v0, s[58:59] offset:3072 nt sc1
ds_read_b128 v[40:43], v0 offset:9216
v_smfmac_f32_16x16x64_bf16 v[16:19], v[32:35], a[184:191], v1
global_load_dwordx4 v[72:75], v0, s[78:79] offset:2048 sc1
v_smfmac_f32_16x16x64_bf16 v[20:23], v[32:35], a[192:199], v1
s_waitcnt lgkmcnt(1)
ds_read_b128 v[32:35], v0 offset:8192
global_load_dwordx4 v[76:79], v0, s[78:79] offset:3072 sc1
v_smfmac_f32_16x16x64_bf16 v[16:19], v[36:39], a[200:207], v1
s_barrier
v_smfmac_f32_16x16x64_bf16 v[20:23], v[36:39], a[208:215], v1
s_waitcnt lgkmcnt(1)
ds_read_b64_tr_b16 v[10:11], v4 offset:512
ds_read_b64_tr_b16 v[8:9], v4 offset:0
v_smfmac_f32_16x16x64_bf16 v[16:19], v[40:43], a[216:223], v1
s_add_u32 s20, s20, 524288
ds_read_b64_tr_b16 v[14:15], v4 offset:1536
s_waitcnt lgkmcnt(3)
ds_read_b64_tr_b16 v[12:13], v4 offset:1024
v_smfmac_f32_16x16x64_bf16 v[16:19], v[32:35], a[232:239], v1
ds_read_b128 v[36:39], v0 offset:9216
v_smfmac_f32_16x16x64_bf16 v[20:23], v[40:43], a[224:231], v1
v_smfmac_f32_16x16x64_bf16 v[20:23], v[32:35], a[240:247], v1
s_waitcnt lgkmcnt(2)
ds_read_b128 v[32:35], v0 offset:0
s_waitcnt vmcnt(5)
ds_read_b128 v[40:43], v0 offset:8192
v_mfma_f32_16x16x32_bf16 v[44:47], v[48:51], v[8:11], 0
s_waitcnt lgkmcnt(3)
ds_read_b128 v[8:11], v2 offset:14336
v_bfe_u32 v48, v0, 5, 1
v_add_f32 v17, v17, v19
v_add_f32 v16, v16, v18
s_waitcnt vmcnt(4)
v_mfma_f32_16x16x32_bf16 v[44:47], v[52:55], v[12:15], v[44:47]
s_waitcnt lgkmcnt(3)
ds_read_b128 v[52:55], v2 offset:17408
ds_read_b128 v[12:15], v2 offset:15360
v_lshl_add_u32 v48, v48, 3, v5
v_add_f32 v20, v20, v22
v_add_f32 v21, v21, v23
v_xor_b32 v48, 128, v48
v_cvt_pk_bf16_f32 v16, v16, v17
v_cndmask_b32_dpp v45, v47, v45, vcc quad_perm:[0,1,0,1] row_mask:0xf bank_mask:0xf
v_cndmask_b32_dpp v44, v46, v44, vcc quad_perm:[0,1,0,1] row_mask:0xf bank_mask:0xf
v_smfmac_f32_16x16x64_bf16 v[28:31], v[36:39], v[80:87], v1
ds_write_b64 v48, v[44:45] offset:6656
v_cvt_pk_bf16_f32 v20, v20, v21
v_smfmac_f32_16x16x64_bf16 v[24:27], v[36:39], a[248:255], v1
s_waitcnt lgkmcnt(2)
ds_read_b128 v[48:51], v2 offset:16384
global_load_dword v7, v7, s[4:5] sc1
ds_write2_b32 v3, v16, v20 offset0:1 offset1:129
s_waitcnt lgkmcnt(3)
v_smfmac_f32_16x16x64_bf16 v[24:27], v[40:43], v[8:15], v1
ds_read_b128 v[36:39], v0 offset:4096
s_mov_b64 s[70:71], s[74:75]
v_smfmac_f32_16x16x64_bf16 v[24:27], v[32:35], v[88:95], v1
s_waitcnt lgkmcnt(2)
v_smfmac_f32_16x16x64_bf16 v[28:31], v[40:43], v[48:55], v1
ds_read_b128 v[40:43], v0 offset:3072
v_smfmac_f32_16x16x64_bf16 v[28:31], v[32:35], v[96:103], v1
s_waitcnt lgkmcnt(2)
ds_read_b128 v[32:35], v0 offset:7168
s_barrier
ds_read_b64_tr_b16 v[12:13], v4 offset:1024
s_waitcnt lgkmcnt(3)
ds_read_b128 v[48:51], v6 offset:6144
v_smfmac_f32_16x16x64_bf16 v[28:31], v[36:39], v[104:111], v1
ds_read_b128 v[52:55], v6 offset:7168
s_waitcnt lgkmcnt(4)
ds_read_b64_tr_b16 v[10:11], v4 offset:512
v_smfmac_f32_16x16x64_bf16 v[24:27], v[36:39], v[64:71], v1
ds_read_b64_tr_b16 v[18:19], v4 offset:2560
s_add_u32 s17, s17, 1
ds_read_b64_tr_b16 v[8:9], v4 offset:0
v_smfmac_f32_16x16x64_bf16 v[28:31], v[40:43], v[120:127], v1
s_waitcnt lgkmcnt(6)
ds_read_b64_tr_b16 v[22:23], v4 offset:3584
s_mov_b32 s30, 0
ds_read_b64_tr_b16 v[16:17], v4 offset:2048
v_smfmac_f32_16x16x64_bf16 v[24:27], v[40:43], v[112:119], v1
s_waitcnt vmcnt(1)
ds_read_b64_tr_b16 v[14:15], v4 offset:1536
s_waitcnt lgkmcnt(8)
ds_read_b128 v[40:43], v0 offset:6144
v_smfmac_f32_16x16x64_bf16 v[24:27], v[32:35], v[128:135], v1
ds_read_b128 v[68:71], v2 offset:19456
s_waitcnt lgkmcnt(6)
ds_read_b128 v[36:39], v0 offset:2048
v_smfmac_f32_16x16x64_bf16 v[28:31], v[32:35], v[136:143], v1
s_waitcnt lgkmcnt(6)
ds_read_b64_tr_b16 v[20:21], v4 offset:3072
v_add_f32 v50, v50, v54
v_add_f32 v48, v48, v52
v_mfma_f32_16x16x32_bf16 v[44:47], v[8:11], v[8:11], 0
s_waitcnt lgkmcnt(4)
ds_read_b128 v[64:67], v2 offset:18432
v_add_f32 v51, v51, v55
v_mfma_f32_16x16x32_bf16 v[44:47], v[12:15], v[12:15], v[44:47]
v_add_f32 v49, v49, v53
v_exp_f32 v50, v50
v_exp_f32 v51, v51
v_exp_f32 v48, v48
v_exp_f32 v49, v49
v_mfma_f32_16x16x32_bf16 v[44:47], v[16:19], v[16:19], v[44:47]
s_waitcnt lgkmcnt(1)
v_cvt_pk_bf16_f32 v55, v50, v51
v_cvt_pk_bf16_f32 v54, v48, v49
v_mfma_f32_16x16x32_bf16 v[44:47], v[20:23], v[20:23], v[44:47]
s_waitcnt lgkmcnt(0)
v_mov_b32_dpp v50, v54 quad_perm:[2,3,2,3] row_mask:0xf bank_mask:0xf
v_mov_b64 v[20:21], s[44:45]
v_smfmac_f32_16x16x64_bf16 v[24:27], v[36:39], v[64:71], v1
ds_read_b128 v[64:67], v2 offset:20480
v_mov_b32_dpp v51, v55 quad_perm:[2,3,2,3] row_mask:0xf bank_mask:0xf
v_smfmac_f32_16x16x64_bf16 v[28:31], v[36:39], v[144:151], v1
ds_read_b128 v[68:71], v2 offset:21504
v_mov_b64 v[22:23], s[44:45]
v_mov_b32_dpp v49, v55 quad_perm:[0,1,0,1] row_mask:0xf bank_mask:0xf
v_smfmac_f32_16x16x64_bf16 v[24:27], v[40:43], v[72:79], v1
ds_read_b128 v[76:79], v2 offset:23552
v_mov_b32_dpp v48, v54 quad_perm:[0,1,0,1] row_mask:0xf bank_mask:0xf
v_smfmac_f32_16x16x64_bf16 v[28:31], v[40:43], v[152:159], v1
ds_read_b128 v[72:75], v2 offset:22528
v_exp_f32_dpp v45, v47 quad_perm:[0,1,0,1] row_mask:0xf bank_mask:0xf
v_mfma_f32_16x16x32_bf16 v[12:15], v[60:63], v[48:51], 0
v_exp_f32_dpp v44, v46 quad_perm:[0,1,0,1] row_mask:0xf bank_mask:0xf
v_mfma_f32_16x16x32_bf16 v[16:19], v[20:23], v[48:51], 0
v_mov_b64 v[54:55], s[46:47]
v_cvt_pk_bf16_f32 v52, v44, v45
v_cvt_pk_bf16_f32 v53, v44, v45
v_mfma_f32_16x16x32_bf16 v[8:11], v[56:59], v[48:51], 0
v_cvt_pk_bf16_f32 v24, v24, v25
v_cvt_pk_bf16_f32 v25, v26, v27
v_mfma_f32_16x16x16_bf16 v[16:19], v[54:55], v[52:53], v[16:19]
s_waitcnt lgkmcnt(0)
v_cvt_pk_bf16_f32 v27, v30, v31
v_cvt_pk_bf16_f32 v26, v28, v29
v_mfma_f32_16x16x16_bf16 v[8:11], v[24:25], v[52:53], v[8:11]
ds_read_b128 v[28:31], v0 offset:31744
v_bfe_u32 v32, v0, 5, 1
v_mfma_f32_16x16x16_bf16 v[12:15], v[26:27], v[52:53], v[12:15]
s_add_u32 s21, s21, 10240
v_subrev_u32 v17, s37, v16
v_mov_b64 v[42:43], 0
v_rcp_f32 v18, v16
v_cmp_lt_u32 vcc, s38, v17
v_lshl_add_u32 v32, v32, 3, v5
v_mov_b64 v[40:41], 0
v_mov_b64 v[36:37], 0
v_cndmask_b32 v10, v14, v10, s[42:43]
v_mul_f32 v10, v10, v18
v_cndmask_b32 v9, v13, v9, s[42:43]
v_cndmask_b32 v11, v15, v11, s[42:43]
v_cndmask_b32 v8, v12, v8, s[42:43]
v_mul_f32 v8, v8, v18
v_mul_f32 v9, v9, v18
v_cvt_pk_bf16_f32 v12, v8, v9
v_mul_f32 v11, v11, v18
v_cvt_pk_bf16_f32 v13, v10, v11
s_cbranch_vccnz rare_10089
back_10090:
ds_write_b64 v32, v[12:13] offset:512
v_mov_b64 v[50:51], 0
v_mov_b32_dpp v10, v12 quad_perm:[2,3,2,3] row_mask:0xf bank_mask:0xf
v_mov_b32_dpp v9, v13 quad_perm:[0,1,0,1] row_mask:0xf bank_mask:0xf
v_mov_b32_dpp v11, v13 quad_perm:[2,3,2,3] row_mask:0xf bank_mask:0xf
v_mov_b32_dpp v8, v12 quad_perm:[0,1,0,1] row_mask:0xf bank_mask:0xf
v_mov_b64 v[38:39], 0
v_mov_b64 v[32:33], 0
v_mov_b64 v[48:49], 0
v_smfmac_f32_16x16x64_bf16 v[36:39], v[8:11], v[64:71], v1
s_add_u32 s34, s17, 2
ds_read_b128 v[24:27], v0 offset:30720
global_load_dwordx4 v[64:67], v0, s[76:77] offset:-4096 sc1
ds_read_b128 v[16:19], v0 offset:28672
v_mov_b64 v[34:35], 0
v_smfmac_f32_16x16x64_bf16 v[40:43], v[8:11], v[72:79], v1
s_waitcnt lgkmcnt(2)
ds_read_b128 v[20:23], v0 offset:29696
s_barrier
ds_read_b128 v[56:59], v5 offset:0
v_smfmac_f32_16x16x64_bf16 v[32:35], v[8:11], v[176:183], v1
global_load_dwordx4 v[68:71], v0, s[76:77] offset:-3072 sc1
s_waitcnt lgkmcnt(3)
ds_read_b128 v[60:63], v5 offset:1536
v_lshrrev_b32 v44, 8, v0
v_smfmac_f32_16x16x64_bf16 v[48:51], v[8:11], v[160:167], v1
ds_read_b128 v[12:15], v5 offset:1024
global_load_dwordx4 v[72:75], v0, s[76:77] offset:0 sc1
v_bfe_u32 v45, v0, 1, 7
v_mov_b64 v[54:55], 0
s_waitcnt lgkmcnt(2)
v_smfmac_f32_16x16x64_bf16 v[48:51], v[56:59], v[208:215], v1
s_min_u32 s34, s34, s32
global_load_dwordx4 v[76:79], v0, s[76:77] offset:1024 sc1
v_smfmac_f32_16x16x64_bf16 v[36:39], v[56:59], v[16:23], v1
s_mov_b32 s19, 1
ds_read_b128 v[16:19], v0 offset:32768
s_waitcnt lgkmcnt(2)
v_smfmac_f32_16x16x64_bf16 v[36:39], v[60:63], v[24:31], v1
s_add_u32 s27, s20, 524288
ds_read_b128 v[20:23], v0 offset:33792
v_smfmac_f32_16x16x64_bf16 v[32:35], v[56:59], v[232:239], v1
s_waitcnt lgkmcnt(2)
ds_read_b128 v[28:31], v0 offset:35840
v_mov_b64 v[52:53], 0
v_smfmac_f32_16x16x64_bf16 v[36:39], v[12:15], v[184:191], v1
v_lshl_or_b32 v44, v44, 12, v45
v_smfmac_f32_16x16x64_bf16 v[40:43], v[56:59], v[192:199], v1
s_nop 0
ds_read_b128 v[24:27], v0 offset:34816
s_nop 0
v_smfmac_f32_16x16x64_bf16 v[40:43], v[60:63], v[200:207], v1
s_add_u32 s58, s4, s20
s_waitcnt lgkmcnt(2)
v_cvt_pk_bf16_f32 v36, v36, v37
v_smfmac_f32_16x16x64_bf16 v[40:43], v[12:15], v[16:23], v1
ds_read_b128 v[20:23], v0 offset:37888
v_and_or_b32 v36, v36, -2, s18
v_cvt_pk_bf16_f32 v37, v38, v39
v_smfmac_f32_16x16x64_bf16 v[32:35], v[60:63], v[240:247], v1
global_store_dwordx2 v44, v[36:37], s[48:49]
v_smfmac_f32_16x16x64_bf16 v[48:51], v[60:63], v[216:223], v1
s_waitcnt lgkmcnt(1)
ds_read_b128 v[16:19], v0 offset:36864
v_cvt_pk_bf16_f32 v40, v40, v41
v_smfmac_f32_16x16x64_bf16 v[48:51], v[12:15], v[24:31], v1
s_addc_u32 s59, s5, 0
ds_read_b128 v[24:27], v0 offset:38912
v_and_or_b32 v40, v40, -2, s18
v_cvt_pk_bf16_f32 v41, v42, v43
v_smfmac_f32_16x16x64_bf16 v[32:35], v[12:15], v[248:255], v1
global_store_dwordx2 v44, v[40:41], s[50:51]
ds_read_b128 v[28:31], v0 offset:39936
v_smfmac_f32_16x16x64_bf16 v[52:55], v[8:11], v[168:175], v1
v_cvt_pk_bf16_f32 v48, v48, v49
v_smfmac_f32_16x16x64_bf16 v[52:55], v[56:59], v[224:231], v1
s_waitcnt lgkmcnt(2)
v_and_or_b32 v48, v48, -2, s18
v_cvt_pk_bf16_f32 v49, v50, v51
v_smfmac_f32_16x16x64_bf16 v[52:55], v[60:63], v[16:23], v1
s_waitcnt lgkmcnt(1)
global_store_dwordx2 v44, v[48:49], s[52:53]
s_waitcnt lgkmcnt(0)
v_smfmac_f32_16x16x64_bf16 v[52:55], v[12:15], v[24:31], v1
s_nop 1
v_cvt_pk_bf16_f32 v32, v32, v33
v_and_or_b32 v32, v32, -2, s18
v_cvt_pk_bf16_f32 v33, v34, v35
s_nop 2
v_cvt_pk_bf16_f32 v52, v52, v53
v_and_or_b32 v52, v52, -2, s18
v_cvt_pk_bf16_f32 v53, v54, v55
global_store_dwordx2 v44, v[52:53], s[54:55]
global_store_dwordx2 v44, v[32:33], s[56:57]
v_bfe_u32 v32, v0, 6, 1
v_lshlrev_b32 v32, 4, v32
v_mov_b32 v33, 0x3f80
v_lshlrev_b32 v32, v32, v33
v_bfe_i32 v33, v0, 4, 1
v_and_b32 v45, v32, v33
v_and_b32 v47, v32, v33
v_xor_b32 v44, v32, v45
v_xor_b32 v46, v32, v45
v_and_b32 v36, 32, v0
v_bfe_u32 v37, v0, 6, 1
v_lshl_add_u32 v36, v37, 8, v36
v_bfe_u32 v37, v0, 8, 1
v_lshl_add_u32 v36, v37, 4, v36
v_bfe_u32 v37, v0, 4, 1
v_lshl_add_u32 v36, v37, 3, v36
s_waitcnt vmcnt(9)
v_and_b32 v7, 511, v0
v_lshl_add_u32 v7, v7, 3, s27
s_nop 15
s_nop 15
s_nop 15
s_nop 15
global_load_dwordx4 v[8:11], v0, s[64:65] offset:0 sc1
global_load_dwordx4 v[12:15], v0, s[64:65] offset:1024 sc1
global_load_dwordx4 v[16:19], v0, s[64:65] offset:2048 sc1
global_load_dwordx4 v[20:23], v0, s[64:65] offset:3072 sc1
s_nop 15
s_nop 15
s_nop 5
global_load_dwordx4 v[24:27], v0, s[64:65] offset:0 sc1
global_load_dwordx4 v[28:31], v0, s[64:65] offset:1024 sc1
global_load_dwordx4 v[48:51], v0, s[64:65] offset:2048 sc1
global_load_dwordx4 v[52:55], v0, s[64:65] offset:3072 sc1
chk_10098:
v_mov_b64 v[40:41], 0
v_mov_b64 v[42:43], 0
s_waitcnt vmcnt(6)
s_nop 0
v_smfmac_f32_16x16x64_bf16 v[40:43], v[44:47], v[8:15], v1
v_bitop3_b32 v32, v8, v10, s18 bitop3:0x7e
v_bitop3_b32 v33, v12, v14, s18 bitop3:0x7e
s_waitcnt vmcnt(4)
v_smfmac_f32_16x16x64_bf16 v[40:43], v[44:47], v[16:23], v1
v_bitop3_b32 v34, v16, v18, s18 bitop3:0x7e
v_bitop3_b32 v35, v20, v22, s18 bitop3:0x7e
v_or3_b32 v37, v32, v33, v34
v_bitop3_b32 v37, v37, v35, 1 bitop3:0xa8
v_cmp_ne_u32 vcc, 0, v37
s_cbranch_vccnz chk_10098_f
s_nop 1
v_add_f32_dpp v40, v40, v40 row_ror:8 row_mask:0xf bank_mask:0xf
v_add_f32_dpp v41, v41, v41 row_ror:8 row_mask:0xf bank_mask:0xf
v_add_f32_dpp v42, v42, v42 row_ror:8 row_mask:0xf bank_mask:0xf
v_add_f32_dpp v43, v43, v43 row_ror:8 row_mask:0xf bank_mask:0xf
v_cvt_pk_bf16_f32 v40, v40, v41
v_cvt_pk_bf16_f32 v41, v42, v43
v_and_or_b32 v40, v40, -2, s18
s_mov_b64 exec, 0x00ff00ff
global_store_dwordx2 v36, v[40:41], s[66:67]
s_mov_b64 exec, -1
s_branch join_10097
chk_10098_f:
global_load_dwordx4 v[8:11], v0, s[64:65] offset:0 sc1
global_load_dwordx4 v[12:15], v0, s[64:65] offset:1024 sc1
global_load_dwordx4 v[16:19], v0, s[64:65] offset:2048 sc1
global_load_dwordx4 v[20:23], v0, s[64:65] offset:3072 sc1
chk_10099:
v_mov_b64 v[40:41], 0
v_mov_b64 v[42:43], 0
s_waitcnt vmcnt(6)
s_nop 0
v_smfmac_f32_16x16x64_bf16 v[40:43], v[44:47], v[24:31], v1
v_bitop3_b32 v32, v24, v26, s18 bitop3:0x7e
v_bitop3_b32 v33, v28, v30, s18 bitop3:0x7e
s_waitcnt vmcnt(4)
v_smfmac_f32_16x16x64_bf16 v[40:43], v[44:47], v[48:55], v1
v_bitop3_b32 v34, v48, v50, s18 bitop3:0x7e
v_bitop3_b32 v35, v52, v54, s18 bitop3:0x7e
v_or3_b32 v37, v32, v33, v34
v_bitop3_b32 v37, v37, v35, 1 bitop3:0xa8
v_cmp_ne_u32 vcc, 0, v37
s_cbranch_vccnz chk_10099_f
s_nop 1
v_add_f32_dpp v40, v40, v40 row_ror:8 row_mask:0xf bank_mask:0xf
v_add_f32_dpp v41, v41, v41 row_ror:8 row_mask:0xf bank_mask:0xf
v_add_f32_dpp v42, v42, v42 row_ror:8 row_mask:0xf bank_mask:0xf
v_add_f32_dpp v43, v43, v43 row_ror:8 row_mask:0xf bank_mask:0xf
v_cvt_pk_bf16_f32 v40, v40, v41
v_cvt_pk_bf16_f32 v41, v42, v43
v_and_or_b32 v40, v40, -2, s18
s_mov_b64 exec, 0x00ff00ff
global_store_dwordx2 v36, v[40:41], s[66:67]
s_mov_b64 exec, -1
s_branch join_10097
chk_10099_f:
global_load_dwordx4 v[24:27], v0, s[64:65] offset:0 sc1
global_load_dwordx4 v[28:31], v0, s[64:65] offset:1024 sc1
global_load_dwordx4 v[48:51], v0, s[64:65] offset:2048 sc1
global_load_dwordx4 v[52:55], v0, s[64:65] offset:3072 sc1
s_add_u32 s30, s30, 1
s_cmp_le_u32 s30, 262144
s_cbranch_scc1 chk_10098
s_branch L_fail
nored_10096:
join_10097:
s_barrier
global_load_dwordx4 v[56:59], v0, s[76:77] offset:-2048 sc1
global_load_dwordx4 v[60:63], v0, s[76:77] offset:-1024 sc1
s_nop 15
s_nop 15
s_nop 5
s_barrier
global_load_dwordx4 v[32:35], v0, s[68:69] offset:-4096 sc1
s_nop 10
global_load_dwordx4 v[36:39], v0, s[68:69] offset:0 sc1
s_nop 10
global_load_dwordx4 v[40:43], v0, s[70:71] offset:0 sc1
s_barrier
global_load_dwordx4 v[48:51], v0, s[76:77] offset:2048 sc1
global_load_dwordx4 v[52:55], v0, s[76:77] offset:3072 sc1
s_waitcnt vmcnt(11)
v_mov_b64 v[8:9], 0
v_mov_b64 v[10:11], 0
s_waitcnt vmcnt(10)
v_mov_b64 v[12:13], 0
v_mov_b64 v[14:15], 0
s_waitcnt vmcnt(9)
v_mov_b64 v[16:17], 0
v_mov_b64 v[18:19], 0
s_waitcnt vmcnt(8)
v_mov_b64 v[20:21], 0
v_mov_b64 v[22:23], 0
v_mov_b64 v[24:25], 0
v_mov_b64 v[26:27], 0
v_mov_b64 v[28:29], 0
v_mov_b64 v[30:31], 0
s_mov_b32 s30, 0
s_cmp_eq_u32 s17, s31
s_cbranch_scc0 gather_10088
s_branch exit_10091
rt_10093:
global_load_dwordx4 v[32:35], v0, s[68:69] offset:-4096 sc1
global_load_dwordx4 v[36:39], v0, s[68:69] offset:0 sc1
global_load_dwordx4 v[40:43], v0, s[70:71] offset:0 sc1
s_add_u32 s30, s30, 1
s_cmp_gt_u32 s30, 262144
s_cbranch_scc1 L_fail
s_mov_b64 exec, 1
global_store_dword v0, v0, s[62:63]
global_store_dword v0, v0, s[62:63]
s_mov_b64 exec, -1
v_mov_b64 v[8:9], 0
v_mov_b64 v[10:11], 0
v_mov_b64 v[12:13], 0
v_mov_b64 v[14:15], 0
v_mov_b64 v[16:17], 0
v_mov_b64 v[18:19], 0
v_mov_b64 v[20:21], 0
v_mov_b64 v[22:23], 0
v_mov_b64 v[24:25], 0
v_mov_b64 v[26:27], 0
v_mov_b64 v[28:29], 0
v_mov_b64 v[30:31], 0
s_branch gather_10088
rare_10089:
ds_read_b128 v[48:51], v6 offset:6144
ds_read_b128 v[52:55], v6 offset:7168
s_waitcnt lgkmcnt(0)
v_add_f32 v48, v48, v52
v_add_f32 v49, v49, v53
v_add_f32 v50, v50, v54
v_add_f32 v51, v51, v55
v_mov_b32_dpp v46, v46 quad_perm:[0,1,0,1] row_mask:0xf bank_mask:0xf
v_mov_b32_dpp v47, v47 quad_perm:[0,1,0,1] row_mask:0xf bank_mask:0xf
v_max3_f32 v19, v48, v49, v50
v_max3_f32 v19, v19, v51, v46
v_max_f32 v19, v19, v47
s_nop 1
v_max_f32_dpp v19, v19, v19 quad_perm:[2,3,0,1] row_mask:0xf bank_mask:0xf
v_mov_b32 v44, v19
s_nop 1
v_permlane32_swap_b32 v19, v44
v_max_f32 v19, v19, v44
v_mov_b32 v44, v19
s_nop 1
v_permlane16_swap_b32 v19, v44
v_max_f32 v19, v19, v44
v_sub_f32 v48, v48, v19
v_sub_f32 v49, v49, v19
v_sub_f32 v50, v50, v19
v_sub_f32 v51, v51, v19
v_sub_f32 v46, v46, v19
v_sub_f32 v47, v47, v19
v_exp_f32 v48, v48
v_exp_f32 v49, v49
v_exp_f32 v50, v50
v_exp_f32 v51, v51
v_cvt_pk_bf16_f32 v54, v48, v49
v_cvt_pk_bf16_f32 v55, v50, v51
s_nop 0
v_mov_b32_dpp v48, v54 quad_perm:[0,1,0,1] row_mask:0xf bank_mask:0xf
v_mov_b32_dpp v49, v55 quad_perm:[0,1,0,1] row_mask:0xf bank_mask:0xf
v_mov_b32_dpp v50, v54 quad_perm:[2,3,2,3] row_mask:0xf bank_mask:0xf
v_mov_b32_dpp v51, v55 quad_perm:[2,3,2,3] row_mask:0xf bank_mask:0xf
v_mov_b64 v[20:21], s[44:45]
v_mov_b64 v[22:23], s[44:45]
v_mfma_f32_16x16x32_bf16 v[8:11], v[56:59], v[48:51], 0
v_mfma_f32_16x16x32_bf16 v[12:15], v[60:63], v[48:51], 0
v_mfma_f32_16x16x32_bf16 v[16:19], v[20:23], v[48:51], 0
v_mov_b64 v[54:55], s[46:47]
v_exp_f32_dpp v44, v46 quad_perm:[0,1,0,1] row_mask:0xf bank_mask:0xf
v_exp_f32_dpp v45, v47 quad_perm:[0,1,0,1] row_mask:0xf bank_mask:0xf
s_nop 0
v_cvt_pk_bf16_f32 v52, v44, v45
v_cvt_pk_bf16_f32 v53, v44, v45
s_nop 1
v_mfma_f32_16x16x16_bf16 v[16:19], v[54:55], v[52:53], v[16:19]
v_mfma_f32_16x16x16_bf16 v[8:11], v[24:25], v[52:53], v[8:11]
v_mfma_f32_16x16x16_bf16 v[12:15], v[26:27], v[52:53], v[12:15]
s_nop 5
v_rcp_f32 v18, v16
s_nop 0
v_cndmask_b32 v8, v12, v8, s[42:43]
v_mul_f32 v8, v8, v18
v_cndmask_b32 v9, v13, v9, s[42:43]
v_mul_f32 v9, v9, v18
v_cndmask_b32 v10, v14, v10, s[42:43]
v_mul_f32 v10, v10, v18
v_cndmask_b32 v11, v15, v11, s[42:43]
v_mul_f32 v11, v11, v18
v_cvt_pk_bf16_f32 v12, v8, v9
v_cvt_pk_bf16_f32 v13, v10, v11
s_branch back_10090
exit_10091:
global_load_dwordx4 v[32:35], v0, s[68:69] offset:-4096 sc1
global_load_dwordx4 v[36:39], v0, s[68:69] offset:0 sc1
global_load_dwordx4 v[40:43], v0, s[70:71] offset:0 sc1
s_add_u32 s30, s30, 1
s_cmp_gt_u32 s30, 262144
s_cbranch_scc1 L_fail
s_waitcnt vmcnt(2)
v_bitop3_b32 v44, v32, v34, s18 bitop3:0x7e
s_waitcnt vmcnt(1)
v_bitop3_b32 v45, v36, v38, s18 bitop3:0x7e
v_or_b32 v44, v44, v45
s_waitcnt vmcnt(0)
v_bitop3_b32 v46, v40, v42, s18 bitop3:0x7e
v_bitop3_b32 v44, v44, v46, s19 bitop3:0xa8
v_cmp_ne_u32 vcc, 0, v44
s_cbranch_vccnz exit_10091
ds_write_b128 v0, v[32:35] offset:1024
ds_write_b128 v0, v[36:39] offset:5120
ds_write_b128 v0, v[40:43] offset:9216
s_waitcnt lgkmcnt(0)
s_barrier
s_barrier
s_add_u32 s36, s36, 1
s_cmp_lt_u32 s36, 2
s_cbranch_scc1 layer_10087
s_endpgm
wave_10070:
layer_10100:
s_lshl_b32 s17, s36, 6
s_mul_i32 s27, s36, 35651584
s_mul_i32 s28, s14, 16384
s_add_u32 s27, s27, s28
s_add_u32 s20, s27, 16785408
s_mul_i32 s27, s17, 10240
s_add_u32 s27, s27, s24
s_add_u32 s21, s27, s25
s_mov_b32 s19, 0
s_mov_b32 s33, s6
s_add_u32 s34, s17, 1
s_add_u32 s31, s17, 63
s_add_u32 s32, s17, 64
s_mov_b32 s27, s20
v_mov_b32 v7, 0
s_add_u32 s68, s4, 415744
s_addc_u32 s69, s5, 0
s_add_u32 s72, s4, 399360
s_addc_u32 s73, s5, 0
s_add_u32 s70, s4, 419840
s_addc_u32 s71, s5, 0
s_add_u32 s74, s4, 403456
s_addc_u32 s75, s5, 0
s_add_u32 s58, s4, s20
s_addc_u32 s59, s5, 0
global_load_dwordx4 v[64:67], v0, s[76:77] offset:-4096 sc1
global_load_dwordx4 v[68:71], v0, s[76:77] offset:-3072 sc1
global_load_dwordx4 v[72:75], v0, s[76:77] offset:0 sc1
global_load_dwordx4 v[76:79], v0, s[76:77] offset:1024 sc1
global_load_dwordx4 v[48:51], v0, s[76:77] offset:2048 sc1
global_load_dwordx4 v[52:55], v0, s[76:77] offset:3072 sc1
global_load_dwordx4 v[56:59], v0, s[76:77] offset:-2048 sc1
global_load_dwordx4 v[60:63], v0, s[76:77] offset:-1024 sc1
v_mov_b64 v[8:9], 0
v_mov_b64 v[10:11], 0
v_mov_b64 v[12:13], 0
v_mov_b64 v[14:15], 0
v_mov_b64 v[16:17], 0
v_mov_b64 v[18:19], 0
v_mov_b64 v[20:21], 0
v_mov_b64 v[22:23], 0
v_mov_b64 v[24:25], 0
v_mov_b64 v[26:27], 0
v_mov_b64 v[28:29], 0
v_mov_b64 v[30:31], 0
s_barrier
v_and_b32 v7, 511, v0
v_lshl_add_u32 v7, v7, 3, s27
global_load_dwordx4 v[32:35], v0, s[68:69] offset:-4096 sc1
global_load_dwordx4 v[36:39], v0, s[68:69] offset:0 sc1
v_mov_b32 v45, -1
s_mov_b32 s30, 0
s_waitcnt vmcnt(0)
.p2align 6
gather_10101:
s_waitcnt vmcnt(3)
rt_10106_b:
v_smfmac_f32_16x16x64_bf16 v[12:15], v[32:35], a[0:7], v1
ds_write_b128 v0, v[32:35] offset:2048
v_smfmac_f32_16x16x64_bf16 v[20:23], v[32:35], a[8:15], v1
v_bitop3_b32 v44, v32, v34, s18 bitop3:0x7e
v_smfmac_f32_16x16x64_bf16 v[28:31], v[32:35], v[72:79], v1
s_waitcnt vmcnt(2)
ds_write_b128 v0, v[36:39] offset:6144
v_bitop3_b32 v45, v36, v38, s18 bitop3:0x7e
v_bitop3_b32 v44, v44, v45, s19 bitop3:0xa8
v_cmp_ne_u32 vcc, 0, v44
v_smfmac_f32_16x16x64_bf16 v[8:11], v[32:35], v[64:71], v1
s_cbranch_vccnz rt_10106
global_load_dwordx4 v[64:67], v0, s[78:79] offset:-4096 sc1
v_smfmac_f32_16x16x64_bf16 v[16:19], v[32:35], v[56:63], v1
global_load_dwordx4 v[68:71], v0, s[78:79] offset:-3072 sc1
v_smfmac_f32_16x16x64_bf16 v[20:23], v[36:39], a[48:55], v1
s_waitcnt lgkmcnt(0)
ds_read_b128 v[60:63], v2 offset:1024
global_load_dwordx4 v[72:75], v0, s[78:79] offset:-2048 sc1
v_smfmac_f32_16x16x64_bf16 v[16:19], v[36:39], a[40:47], v1
ds_read_b128 v[56:59], v2 offset:0
v_smfmac_f32_16x16x64_bf16 v[24:27], v[32:35], a[16:23], v1
s_barrier
ds_read_b128 v[40:43], v0 offset:3072
v_smfmac_f32_16x16x64_bf16 v[12:15], v[36:39], a[32:39], v1
ds_read_b128 v[44:47], v0 offset:7168
s_waitcnt lgkmcnt(3)
v_smfmac_f32_16x16x64_bf16 v[8:11], v[36:39], a[24:31], v1
ds_read_b128 v[32:35], v0 offset:0
s_waitcnt lgkmcnt(3)
v_smfmac_f32_16x16x64_bf16 v[28:31], v[36:39], v[56:63], v1
ds_read_b128 v[56:59], v2 offset:2048
v_smfmac_f32_16x16x64_bf16 v[24:27], v[36:39], a[56:63], v1
ds_read_b128 v[60:63], v2 offset:3072
s_waitcnt lgkmcnt(4)
v_smfmac_f32_16x16x64_bf16 v[8:11], v[40:43], a[64:71], v1
ds_read_b128 v[36:39], v0 offset:4096
s_waitcnt vmcnt(3)
v_smfmac_f32_16x16x64_bf16 v[12:15], v[40:43], v[48:55], v1
s_waitcnt lgkmcnt(4)
ds_read_b128 v[48:51], v2 offset:4096
v_smfmac_f32_16x16x64_bf16 v[8:11], v[44:47], a[72:79], v1
ds_read_b128 v[52:55], v2 offset:5120
s_waitcnt lgkmcnt(5)
v_smfmac_f32_16x16x64_bf16 v[12:15], v[44:47], a[80:87], v1
s_waitcnt lgkmcnt(4)
ds_read_b128 v[44:47], v0 offset:5120
s_waitcnt lgkmcnt(4)
v_smfmac_f32_16x16x64_bf16 v[12:15], v[32:35], a[88:95], v1
ds_read_b128 v[40:43], v0 offset:1024
s_waitcnt lgkmcnt(4)
v_smfmac_f32_16x16x64_bf16 v[8:11], v[32:35], v[56:63], v1
s_mov_b64 s[68:69], s[72:73]
ds_read_b128 v[56:59], v2 offset:6144
s_waitcnt lgkmcnt(4)
v_smfmac_f32_16x16x64_bf16 v[8:11], v[36:39], a[96:103], v1
ds_read_b128 v[32:35], v0 offset:8192
s_waitcnt vmcnt(2)
global_load_dwordx4 v[76:79], v0, s[78:79] offset:-1024 sc1
ds_read_b128 v[60:63], v2 offset:7168
s_waitcnt lgkmcnt(5)
v_smfmac_f32_16x16x64_bf16 v[12:15], v[36:39], v[48:55], v1
s_xor_b32 s18, s18, 1
s_waitcnt lgkmcnt(4)
ds_read_b128 v[52:55], v2 offset:9216
s_waitcnt lgkmcnt(4)
ds_read_b128 v[48:51], v2 offset:8192
v_smfmac_f32_16x16x64_bf16 v[8:11], v[40:43], a[104:111], v1
ds_read_b128 v[36:39], v0 offset:9216
s_waitcnt vmcnt(2)
v_smfmac_f32_16x16x64_bf16 v[8:11], v[44:47], v[64:71], v1
global_load_dwordx4 v[64:67], v0, s[78:79] offset:0 sc1
v_smfmac_f32_16x16x64_bf16 v[12:15], v[40:43], a[112:119], v1
s_waitcnt lgkmcnt(3)
ds_read_b128 v[40:43], v0 offset:3072
s_mov_b64 vcc, s[42:43]
v_smfmac_f32_16x16x64_bf16 v[12:15], v[44:47], v[56:63], v1
s_waitcnt lgkmcnt(3)
ds_read_b128 v[60:63], v2 offset:11264
global_load_dwordx4 v[68:71], v0, s[78:79] offset:1024 sc1
v_smfmac_f32_16x16x64_bf16 v[8:11], v[32:35], a[120:127], v1
s_waitcnt lgkmcnt(3)
ds_read_b128 v[56:59], v2 offset:10240
v_smfmac_f32_16x16x64_bf16 v[12:15], v[32:35], v[48:55], v1
s_waitcnt lgkmcnt(3)
ds_read_b128 v[32:35], v0 offset:7168
v_smfmac_f32_16x16x64_bf16 v[12:15], v[36:39], a[136:143], v1
s_nop 0
global_load_dwordx4 v[48:51], v0, s[58:59] offset:0 nt sc1
v_smfmac_f32_16x16x64_bf16 v[8:11], v[36:39], a[128:135], v1
s_waitcnt lgkmcnt(3)
ds_read_b128 v[36:39], v0 offset:0
global_load_dwordx4 v[52:55], v0, s[58:59] offset:1024 nt sc1
v_smfmac_f32_16x16x64_bf16 v[20:23], v[40:43], a[152:159], v1
s_nop 0
v_add_f32 v13, v13, v15
v_smfmac_f32_16x16x64_bf16 v[16:19], v[40:43], a[144:151], v1
s_waitcnt lgkmcnt(1)
ds_read_b128 v[40:43], v0 offset:4096
v_add_f32 v9, v9, v11
v_smfmac_f32_16x16x64_bf16 v[20:23], v[32:35], v[56:63], v1
ds_read_b128 v[56:59], v2 offset:12288
ds_read_b128 v[60:63], v2 offset:13312
v_smfmac_f32_16x16x64_bf16 v[16:19], v[32:35], a[160:167], v1
s_waitcnt lgkmcnt(3)
v_add_f32 v8, v8, v10
v_smfmac_f32_16x16x64_bf16 v[20:23], v[36:39], a[176:183], v1
s_waitcnt vmcnt(5)
ds_read_b128 v[32:35], v0 offset:1024
v_mul_f32 v9, s35, v9
v_add_f32 v12, v12, v14
v_mul_f32 v13, s35, v13
v_mul_f32 v8, s35, v8
v_mul_f32 v12, s35, v12
v_cvt_pk_bf16_f32 v12, v12, v13
v_cvt_pk_bf16_f32 v8, v8, v9
v_smfmac_f32_16x16x64_bf16 v[16:19], v[36:39], a[168:175], v1
s_waitcnt lgkmcnt(2)
ds_read_b128 v[36:39], v0 offset:5120
ds_write2_b32 v3, v8, v12 offset0:0 offset1:128
s_waitcnt lgkmcnt(3)
v_smfmac_f32_16x16x64_bf16 v[16:19], v[40:43], v[56:63], v1
s_waitcnt vmcnt(4)
global_load_dwordx4 v[56:59], v0, s[58:59] offset:2048 nt sc1
v_smfmac_f32_16x16x64_bf16 v[20:23], v[40:43], v[72:79], v1
s_waitcnt lgkmcnt(2)
global_load_dwordx4 v[60:63], v0, s[58:59] offset:3072 nt sc1
ds_read_b128 v[40:43], v0 offset:8192
v_smfmac_f32_16x16x64_bf16 v[16:19], v[32:35], a[184:191], v1
global_load_dwordx4 v[72:75], v0, s[78:79] offset:2048 sc1
v_smfmac_f32_16x16x64_bf16 v[20:23], v[32:35], a[192:199], v1
s_waitcnt lgkmcnt(1)
ds_read_b128 v[32:35], v0 offset:9216
global_load_dwordx4 v[76:79], v0, s[78:79] offset:3072 sc1
v_smfmac_f32_16x16x64_bf16 v[16:19], v[36:39], a[200:207], v1
s_barrier
v_smfmac_f32_16x16x64_bf16 v[20:23], v[36:39], a[208:215], v1
s_waitcnt lgkmcnt(1)
ds_read_b64_tr_b16 v[10:11], v4 offset:2560
ds_read_b64_tr_b16 v[8:9], v4 offset:2048
v_smfmac_f32_16x16x64_bf16 v[16:19], v[40:43], a[216:223], v1
s_add_u32 s20, s20, 524288
ds_read_b64_tr_b16 v[14:15], v4 offset:3584
s_waitcnt lgkmcnt(3)
ds_read_b64_tr_b16 v[12:13], v4 offset:3072
v_smfmac_f32_16x16x64_bf16 v[16:19], v[32:35], a[232:239], v1
ds_read_b128 v[36:39], v0 offset:8192
v_smfmac_f32_16x16x64_bf16 v[20:23], v[40:43], a[224:231], v1
v_smfmac_f32_16x16x64_bf16 v[20:23], v[32:35], a[240:247], v1
s_waitcnt lgkmcnt(2)
ds_read_b128 v[32:35], v0 offset:3072
s_waitcnt vmcnt(5)
ds_read_b128 v[40:43], v0 offset:9216
v_mfma_f32_16x16x32_bf16 v[44:47], v[48:51], v[8:11], 0
s_waitcnt lgkmcnt(3)
ds_read_b128 v[8:11], v2 offset:14336
v_bfe_u32 v48, v0, 5, 1
v_add_f32 v17, v17, v19
v_add_f32 v16, v16, v18
s_waitcnt vmcnt(4)
v_mfma_f32_16x16x32_bf16 v[44:47], v[52:55], v[12:15], v[44:47]
s_waitcnt lgkmcnt(3)
ds_read_b128 v[52:55], v2 offset:17408
ds_read_b128 v[12:15], v2 offset:15360
v_lshl_add_u32 v48, v48, 3, v5
v_add_f32 v20, v20, v22
v_add_f32 v21, v21, v23
v_cvt_pk_bf16_f32 v16, v16, v17
s_nop 0
v_cndmask_b32_dpp v45, v47, v45, vcc quad_perm:[0,1,0,1] row_mask:0xf bank_mask:0xf
v_cndmask_b32_dpp v44, v46, v44, vcc quad_perm:[0,1,0,1] row_mask:0xf bank_mask:0xf
v_smfmac_f32_16x16x64_bf16 v[28:31], v[36:39], v[80:87], v1
ds_write_b64 v48, v[44:45] offset:7168
v_cvt_pk_bf16_f32 v20, v20, v21
v_smfmac_f32_16x16x64_bf16 v[24:27], v[36:39], a[248:255], v1
s_waitcnt lgkmcnt(2)
ds_read_b128 v[48:51], v2 offset:16384
global_load_dword v7, v7, s[4:5] sc1
ds_write2_b32 v3, v16, v20 offset0:1 offset1:129
s_waitcnt lgkmcnt(3)
v_smfmac_f32_16x16x64_bf16 v[24:27], v[40:43], v[8:15], v1
ds_read_b128 v[36:39], v0 offset:7168
v_smfmac_f32_16x16x64_bf16 v[24:27], v[32:35], v[88:95], v1
s_waitcnt lgkmcnt(2)
v_smfmac_f32_16x16x64_bf16 v[28:31], v[40:43], v[48:55], v1
ds_read_b128 v[40:43], v0 offset:0
v_smfmac_f32_16x16x64_bf16 v[28:31], v[32:35], v[96:103], v1
s_waitcnt lgkmcnt(2)
ds_read_b128 v[32:35], v0 offset:4096
s_barrier
ds_read_b64_tr_b16 v[12:13], v4 offset:1024
s_waitcnt lgkmcnt(3)
ds_read_b128 v[48:51], v6 offset:6144
v_smfmac_f32_16x16x64_bf16 v[28:31], v[36:39], v[104:111], v1
ds_read_b128 v[52:55], v6 offset:7168
s_waitcnt lgkmcnt(4)
ds_read_b64_tr_b16 v[10:11], v4 offset:512
v_smfmac_f32_16x16x64_bf16 v[24:27], v[36:39], v[64:71], v1
ds_read_b64_tr_b16 v[18:19], v4 offset:2560
s_add_u32 s17, s17, 1
ds_read_b64_tr_b16 v[8:9], v4 offset:0
v_smfmac_f32_16x16x64_bf16 v[28:31], v[40:43], v[120:127], v1
s_waitcnt lgkmcnt(6)
ds_read_b64_tr_b16 v[22:23], v4 offset:3584
s_mov_b32 s30, 0
ds_read_b64_tr_b16 v[16:17], v4 offset:2048
v_smfmac_f32_16x16x64_bf16 v[24:27], v[40:43], v[112:119], v1
s_waitcnt vmcnt(1)
ds_read_b64_tr_b16 v[14:15], v4 offset:1536
s_waitcnt lgkmcnt(8)
ds_read_b128 v[40:43], v0 offset:5120
v_smfmac_f32_16x16x64_bf16 v[24:27], v[32:35], v[128:135], v1
ds_read_b128 v[68:71], v2 offset:19456
s_waitcnt lgkmcnt(6)
ds_read_b128 v[36:39], v0 offset:1024
v_smfmac_f32_16x16x64_bf16 v[28:31], v[32:35], v[136:143], v1
s_waitcnt lgkmcnt(6)
ds_read_b64_tr_b16 v[20:21], v4 offset:3072
v_add_f32 v50, v50, v54
v_add_f32 v48, v48, v52
v_mfma_f32_16x16x32_bf16 v[44:47], v[8:11], v[8:11], 0
s_waitcnt lgkmcnt(4)
ds_read_b128 v[64:67], v2 offset:18432
v_add_f32 v51, v51, v55
v_mfma_f32_16x16x32_bf16 v[44:47], v[12:15], v[12:15], v[44:47]
v_add_f32 v49, v49, v53
v_exp_f32 v50, v50
v_exp_f32 v51, v51
v_exp_f32 v48, v48
v_exp_f32 v49, v49
v_mfma_f32_16x16x32_bf16 v[44:47], v[16:19], v[16:19], v[44:47]
s_waitcnt lgkmcnt(1)
v_cvt_pk_bf16_f32 v55, v50, v51
v_cvt_pk_bf16_f32 v54, v48, v49
v_mfma_f32_16x16x32_bf16 v[44:47], v[20:23], v[20:23], v[44:47]
s_waitcnt lgkmcnt(0)
v_mov_b32_dpp v50, v54 quad_perm:[2,3,2,3] row_mask:0xf bank_mask:0xf
v_mov_b64 v[20:21], s[44:45]
v_smfmac_f32_16x16x64_bf16 v[24:27], v[36:39], v[64:71], v1
ds_read_b128 v[64:67], v2 offset:20480
v_mov_b32_dpp v51, v55 quad_perm:[2,3,2,3] row_mask:0xf bank_mask:0xf
v_smfmac_f32_16x16x64_bf16 v[28:31], v[36:39], v[144:151], v1
ds_read_b128 v[68:71], v2 offset:21504
v_mov_b64 v[22:23], s[44:45]
v_mov_b32_dpp v49, v55 quad_perm:[0,1,0,1] row_mask:0xf bank_mask:0xf
v_smfmac_f32_16x16x64_bf16 v[24:27], v[40:43], v[72:79], v1
ds_read_b128 v[76:79], v2 offset:23552
v_mov_b32_dpp v48, v54 quad_perm:[0,1,0,1] row_mask:0xf bank_mask:0xf
v_smfmac_f32_16x16x64_bf16 v[28:31], v[40:43], v[152:159], v1
ds_read_b128 v[72:75], v2 offset:22528
v_exp_f32_dpp v45, v47 quad_perm:[0,1,0,1] row_mask:0xf bank_mask:0xf
v_mfma_f32_16x16x32_bf16 v[12:15], v[60:63], v[48:51], 0
v_exp_f32_dpp v44, v46 quad_perm:[0,1,0,1] row_mask:0xf bank_mask:0xf
v_mfma_f32_16x16x32_bf16 v[16:19], v[20:23], v[48:51], 0
v_mov_b64 v[54:55], s[46:47]
v_cvt_pk_bf16_f32 v52, v44, v45
v_cvt_pk_bf16_f32 v53, v44, v45
v_mfma_f32_16x16x32_bf16 v[8:11], v[56:59], v[48:51], 0
v_cvt_pk_bf16_f32 v24, v24, v25
v_cvt_pk_bf16_f32 v25, v26, v27
v_mfma_f32_16x16x16_bf16 v[16:19], v[54:55], v[52:53], v[16:19]
s_waitcnt lgkmcnt(0)
v_cvt_pk_bf16_f32 v27, v30, v31
v_cvt_pk_bf16_f32 v26, v28, v29
v_mfma_f32_16x16x16_bf16 v[8:11], v[24:25], v[52:53], v[8:11]
ds_read_b128 v[28:31], v0 offset:44032
v_bfe_u32 v32, v0, 5, 1
v_mfma_f32_16x16x16_bf16 v[12:15], v[26:27], v[52:53], v[12:15]
s_add_u32 s21, s21, 10240
v_subrev_u32 v17, s37, v16
v_mov_b64 v[42:43], 0
v_rcp_f32 v18, v16
v_cmp_lt_u32 vcc, s38, v17
v_lshl_add_u32 v32, v32, 3, v5
v_mov_b64 v[40:41], 0
v_mov_b64 v[36:37], 0
v_cndmask_b32 v10, v14, v10, s[42:43]
v_mul_f32 v10, v10, v18
v_cndmask_b32 v9, v13, v9, s[42:43]
v_cndmask_b32 v11, v15, v11, s[42:43]
v_cndmask_b32 v8, v12, v8, s[42:43]
v_mul_f32 v8, v8, v18
v_mul_f32 v9, v9, v18
v_cvt_pk_bf16_f32 v12, v8, v9
v_mul_f32 v11, v11, v18
v_cvt_pk_bf16_f32 v13, v10, v11
s_cbranch_vccnz rare_10102
back_10103:
ds_write_b64 v32, v[12:13] offset:1024
v_mov_b64 v[50:51], 0
v_mov_b32_dpp v10, v12 quad_perm:[2,3,2,3] row_mask:0xf bank_mask:0xf
v_mov_b32_dpp v9, v13 quad_perm:[0,1,0,1] row_mask:0xf bank_mask:0xf
v_mov_b32_dpp v11, v13 quad_perm:[2,3,2,3] row_mask:0xf bank_mask:0xf
v_mov_b32_dpp v8, v12 quad_perm:[0,1,0,1] row_mask:0xf bank_mask:0xf
v_mov_b64 v[38:39], 0
v_mov_b64 v[32:33], 0
v_mov_b64 v[48:49], 0
v_smfmac_f32_16x16x64_bf16 v[36:39], v[8:11], v[64:71], v1
s_add_u32 s34, s17, 2
ds_read_b128 v[24:27], v0 offset:43008
global_load_dwordx4 v[64:67], v0, s[76:77] offset:-4096 sc1
ds_read_b128 v[16:19], v0 offset:40960
v_mov_b64 v[34:35], 0
v_smfmac_f32_16x16x64_bf16 v[40:43], v[8:11], v[72:79], v1
s_waitcnt lgkmcnt(2)
ds_read_b128 v[20:23], v0 offset:41984
s_barrier
ds_read_b128 v[56:59], v5 offset:1536
v_smfmac_f32_16x16x64_bf16 v[32:35], v[8:11], v[176:183], v1
global_load_dwordx4 v[68:71], v0, s[76:77] offset:-3072 sc1
s_waitcnt lgkmcnt(3)
ds_read_b128 v[60:63], v5 offset:0
v_lshrrev_b32 v44, 8, v0
v_smfmac_f32_16x16x64_bf16 v[48:51], v[8:11], v[160:167], v1
ds_read_b128 v[12:15], v5 offset:512
global_load_dwordx4 v[72:75], v0, s[76:77] offset:0 sc1
v_bfe_u32 v45, v0, 1, 7
v_mov_b64 v[54:55], 0
s_waitcnt lgkmcnt(2)
v_smfmac_f32_16x16x64_bf16 v[48:51], v[56:59], v[208:215], v1
s_min_u32 s34, s34, s32
global_load_dwordx4 v[76:79], v0, s[76:77] offset:1024 sc1
v_smfmac_f32_16x16x64_bf16 v[36:39], v[56:59], v[16:23], v1
s_mov_b32 s19, 1
ds_read_b128 v[16:19], v0 offset:45056
s_waitcnt lgkmcnt(2)
v_smfmac_f32_16x16x64_bf16 v[36:39], v[60:63], v[24:31], v1
s_add_u32 s27, s20, 524288
ds_read_b128 v[20:23], v0 offset:46080
v_smfmac_f32_16x16x64_bf16 v[32:35], v[56:59], v[232:239], v1
s_waitcnt lgkmcnt(2)
ds_read_b128 v[28:31], v0 offset:48128
v_mov_b64 v[52:53], 0
v_smfmac_f32_16x16x64_bf16 v[36:39], v[12:15], v[184:191], v1
v_lshl_or_b32 v44, v44, 12, v45
v_smfmac_f32_16x16x64_bf16 v[40:43], v[56:59], v[192:199], v1
s_nop 0
ds_read_b128 v[24:27], v0 offset:47104
s_nop 0
v_smfmac_f32_16x16x64_bf16 v[40:43], v[60:63], v[200:207], v1
s_add_u32 s58, s4, s20
s_waitcnt lgkmcnt(2)
v_cvt_pk_bf16_f32 v36, v36, v37
v_smfmac_f32_16x16x64_bf16 v[40:43], v[12:15], v[16:23], v1
ds_read_b128 v[20:23], v0 offset:50176
v_and_or_b32 v36, v36, -2, s18
v_cvt_pk_bf16_f32 v37, v38, v39
v_smfmac_f32_16x16x64_bf16 v[32:35], v[60:63], v[240:247], v1
global_store_dwordx2 v44, v[36:37], s[48:49]
v_smfmac_f32_16x16x64_bf16 v[48:51], v[60:63], v[216:223], v1
s_waitcnt lgkmcnt(1)
ds_read_b128 v[16:19], v0 offset:49152
v_cvt_pk_bf16_f32 v40, v40, v41
v_smfmac_f32_16x16x64_bf16 v[48:51], v[12:15], v[24:31], v1
s_addc_u32 s59, s5, 0
ds_read_b128 v[24:27], v0 offset:51200
v_and_or_b32 v40, v40, -2, s18
v_cvt_pk_bf16_f32 v41, v42, v43
v_smfmac_f32_16x16x64_bf16 v[32:35], v[12:15], v[248:255], v1
global_store_dwordx2 v44, v[40:41], s[50:51]
ds_read_b128 v[28:31], v0 offset:52224
v_smfmac_f32_16x16x64_bf16 v[52:55], v[8:11], v[168:175], v1
v_cvt_pk_bf16_f32 v48, v48, v49
v_smfmac_f32_16x16x64_bf16 v[52:55], v[56:59], v[224:231], v1
s_waitcnt lgkmcnt(2)
v_and_or_b32 v48, v48, -2, s18
v_cvt_pk_bf16_f32 v49, v50, v51
v_smfmac_f32_16x16x64_bf16 v[52:55], v[60:63], v[16:23], v1
s_waitcnt lgkmcnt(1)
global_store_dwordx2 v44, v[48:49], s[52:53]
s_waitcnt lgkmcnt(0)
v_smfmac_f32_16x16x64_bf16 v[52:55], v[12:15], v[24:31], v1
s_nop 1
v_cvt_pk_bf16_f32 v32, v32, v33
v_and_or_b32 v32, v32, -2, s18
v_cvt_pk_bf16_f32 v33, v34, v35
s_nop 2
v_cvt_pk_bf16_f32 v52, v52, v53
v_and_or_b32 v52, v52, -2, s18
v_cvt_pk_bf16_f32 v53, v54, v55
global_store_dwordx2 v44, v[52:53], s[54:55]
global_store_dwordx2 v44, v[32:33], s[56:57]
s_cmp_ge_u32 s14, 16
s_cbranch_scc1 nored_10109
v_bfe_u32 v32, v0, 6, 1
v_lshlrev_b32 v32, 4, v32
v_mov_b32 v33, 0x3f80
v_lshlrev_b32 v32, v32, v33
v_bfe_i32 v33, v0, 4, 1
v_and_b32 v45, v32, v33
v_and_b32 v47, v32, v33
v_xor_b32 v44, v32, v45
v_xor_b32 v46, v32, v45
v_and_b32 v36, 32, v0
v_bfe_u32 v37, v0, 6, 1
v_lshl_add_u32 v36, v37, 8, v36
v_bfe_u32 v37, v0, 8, 1
v_lshl_add_u32 v36, v37, 4, v36
v_bfe_u32 v37, v0, 4, 1
v_lshl_add_u32 v36, v37, 3, v36
s_waitcnt vmcnt(9)
v_and_b32 v7, 511, v0
v_lshl_add_u32 v7, v7, 3, s27
s_nop 15
s_nop 15
s_nop 15
s_nop 15
s_nop 12
global_load_dwordx4 v[8:11], v0, s[64:65] offset:0 sc1
global_load_dwordx4 v[12:15], v0, s[64:65] offset:1024 sc1
global_load_dwordx4 v[16:19], v0, s[64:65] offset:2048 sc1
global_load_dwordx4 v[20:23], v0, s[64:65] offset:3072 sc1
s_nop 15
s_nop 15
s_nop 5
global_load_dwordx4 v[24:27], v0, s[64:65] offset:0 sc1
global_load_dwordx4 v[28:31], v0, s[64:65] offset:1024 sc1
global_load_dwordx4 v[48:51], v0, s[64:65] offset:2048 sc1
global_load_dwordx4 v[52:55], v0, s[64:65] offset:3072 sc1
chk_10111:
v_mov_b64 v[40:41], 0
v_mov_b64 v[42:43], 0
s_waitcnt vmcnt(6)
s_nop 0
v_smfmac_f32_16x16x64_bf16 v[40:43], v[44:47], v[8:15], v1
v_bitop3_b32 v32, v8, v10, s18 bitop3:0x7e
v_bitop3_b32 v33, v12, v14, s18 bitop3:0x7e
s_waitcnt vmcnt(4)
v_smfmac_f32_16x16x64_bf16 v[40:43], v[44:47], v[16:23], v1
v_bitop3_b32 v34, v16, v18, s18 bitop3:0x7e
v_bitop3_b32 v35, v20, v22, s18 bitop3:0x7e
v_or3_b32 v37, v32, v33, v34
v_bitop3_b32 v37, v37, v35, 1 bitop3:0xa8
v_cmp_ne_u32 vcc, 0, v37
s_cbranch_vccnz chk_10111_f
s_nop 1
v_add_f32_dpp v40, v40, v40 row_ror:8 row_mask:0xf bank_mask:0xf
v_add_f32_dpp v41, v41, v41 row_ror:8 row_mask:0xf bank_mask:0xf
v_add_f32_dpp v42, v42, v42 row_ror:8 row_mask:0xf bank_mask:0xf
v_add_f32_dpp v43, v43, v43 row_ror:8 row_mask:0xf bank_mask:0xf
v_cvt_pk_bf16_f32 v40, v40, v41
v_cvt_pk_bf16_f32 v41, v42, v43
v_and_or_b32 v40, v40, -2, s18
s_mov_b64 exec, 0x00ff00ff
global_store_dwordx2 v36, v[40:41], s[66:67]
s_mov_b64 exec, -1
s_branch join_10110
chk_10111_f:
global_load_dwordx4 v[8:11], v0, s[64:65] offset:0 sc1
global_load_dwordx4 v[12:15], v0, s[64:65] offset:1024 sc1
global_load_dwordx4 v[16:19], v0, s[64:65] offset:2048 sc1
global_load_dwordx4 v[20:23], v0, s[64:65] offset:3072 sc1
chk_10112:
v_mov_b64 v[40:41], 0
v_mov_b64 v[42:43], 0
s_waitcnt vmcnt(6)
s_nop 0
v_smfmac_f32_16x16x64_bf16 v[40:43], v[44:47], v[24:31], v1
v_bitop3_b32 v32, v24, v26, s18 bitop3:0x7e
v_bitop3_b32 v33, v28, v30, s18 bitop3:0x7e
s_waitcnt vmcnt(4)
v_smfmac_f32_16x16x64_bf16 v[40:43], v[44:47], v[48:55], v1
v_bitop3_b32 v34, v48, v50, s18 bitop3:0x7e
v_bitop3_b32 v35, v52, v54, s18 bitop3:0x7e
v_or3_b32 v37, v32, v33, v34
v_bitop3_b32 v37, v37, v35, 1 bitop3:0xa8
v_cmp_ne_u32 vcc, 0, v37
s_cbranch_vccnz chk_10112_f
s_nop 1
v_add_f32_dpp v40, v40, v40 row_ror:8 row_mask:0xf bank_mask:0xf
v_add_f32_dpp v41, v41, v41 row_ror:8 row_mask:0xf bank_mask:0xf
v_add_f32_dpp v42, v42, v42 row_ror:8 row_mask:0xf bank_mask:0xf
v_add_f32_dpp v43, v43, v43 row_ror:8 row_mask:0xf bank_mask:0xf
v_cvt_pk_bf16_f32 v40, v40, v41
v_cvt_pk_bf16_f32 v41, v42, v43
v_and_or_b32 v40, v40, -2, s18
s_mov_b64 exec, 0x00ff00ff
global_store_dwordx2 v36, v[40:41], s[66:67]
s_mov_b64 exec, -1
s_branch join_10110
chk_10112_f:
global_load_dwordx4 v[24:27], v0, s[64:65] offset:0 sc1
global_load_dwordx4 v[28:31], v0, s[64:65] offset:1024 sc1
global_load_dwordx4 v[48:51], v0, s[64:65] offset:2048 sc1
global_load_dwordx4 v[52:55], v0, s[64:65] offset:3072 sc1
s_add_u32 s30, s30, 1
s_cmp_le_u32 s30, 262144
s_cbranch_scc1 chk_10111
s_branch L_fail
nored_10109:
s_waitcnt vmcnt(9)
v_and_b32 v7, 511, v0
v_lshl_add_u32 v7, v7, 3, s27
join_10110:
s_barrier
global_load_dwordx4 v[56:59], v0, s[76:77] offset:-2048 sc1
global_load_dwordx4 v[60:63], v0, s[76:77] offset:-1024 sc1
s_nop 15
s_nop 15
s_nop 5
s_barrier
global_load_dwordx4 v[32:35], v0, s[68:69] offset:-4096 sc1
s_nop 10
global_load_dwordx4 v[36:39], v0, s[68:69] offset:0 sc1
s_barrier
global_load_dwordx4 v[48:51], v0, s[76:77] offset:2048 sc1
global_load_dwordx4 v[52:55], v0, s[76:77] offset:3072 sc1
s_waitcnt vmcnt(10)
v_mov_b64 v[8:9], 0
v_mov_b64 v[10:11], 0
s_waitcnt vmcnt(9)
v_mov_b64 v[12:13], 0
v_mov_b64 v[14:15], 0
s_waitcnt vmcnt(8)
v_mov_b64 v[16:17], 0
v_mov_b64 v[18:19], 0
s_waitcnt vmcnt(7)
v_mov_b64 v[20:21], 0
v_mov_b64 v[22:23], 0
v_mov_b64 v[24:25], 0
v_mov_b64 v[26:27], 0
v_mov_b64 v[28:29], 0
v_mov_b64 v[30:31], 0
s_mov_b32 s30, 0
s_cmp_eq_u32 s17, s31
s_cbranch_scc0 gather_10101
s_branch exit_10104
rt_10106:
global_load_dwordx4 v[32:35], v0, s[68:69] offset:-4096 sc1
global_load_dwordx4 v[36:39], v0, s[68:69] offset:0 sc1
s_add_u32 s30, s30, 1
s_cmp_gt_u32 s30, 262144
s_cbranch_scc1 L_fail
s_mov_b64 exec, 1
global_store_dword v0, v0, s[62:63]
global_store_dword v0, v0, s[62:63]
s_mov_b64 exec, -1
v_mov_b64 v[8:9], 0
v_mov_b64 v[10:11], 0
v_mov_b64 v[12:13], 0
v_mov_b64 v[14:15], 0
v_mov_b64 v[16:17], 0
v_mov_b64 v[18:19], 0
v_mov_b64 v[20:21], 0
v_mov_b64 v[22:23], 0
v_mov_b64 v[24:25], 0
v_mov_b64 v[26:27], 0
v_mov_b64 v[28:29], 0
v_mov_b64 v[30:31], 0
s_branch gather_10101
rare_10102:
ds_read_b128 v[48:51], v6 offset:6144
ds_read_b128 v[52:55], v6 offset:7168
s_waitcnt lgkmcnt(0)
v_add_f32 v48, v48, v52
v_add_f32 v49, v49, v53
v_add_f32 v50, v50, v54
v_add_f32 v51, v51, v55
v_mov_b32_dpp v46, v46 quad_perm:[0,1,0,1] row_mask:0xf bank_mask:0xf
v_mov_b32_dpp v47, v47 quad_perm:[0,1,0,1] row_mask:0xf bank_mask:0xf
v_max3_f32 v19, v48, v49, v50
v_max3_f32 v19, v19, v51, v46
v_max_f32 v19, v19, v47
s_nop 1
v_max_f32_dpp v19, v19, v19 quad_perm:[2,3,0,1] row_mask:0xf bank_mask:0xf
v_mov_b32 v44, v19
s_nop 1
v_permlane32_swap_b32 v19, v44
v_max_f32 v19, v19, v44
v_mov_b32 v44, v19
s_nop 1
v_permlane16_swap_b32 v19, v44
v_max_f32 v19, v19, v44
v_sub_f32 v48, v48, v19
v_sub_f32 v49, v49, v19
v_sub_f32 v50, v50, v19
v_sub_f32 v51, v51, v19
v_sub_f32 v46, v46, v19
v_sub_f32 v47, v47, v19
v_exp_f32 v48, v48
v_exp_f32 v49, v49
v_exp_f32 v50, v50
v_exp_f32 v51, v51
v_cvt_pk_bf16_f32 v54, v48, v49
v_cvt_pk_bf16_f32 v55, v50, v51
s_nop 0
v_mov_b32_dpp v48, v54 quad_perm:[0,1,0,1] row_mask:0xf bank_mask:0xf
v_mov_b32_dpp v49, v55 quad_perm:[0,1,0,1] row_mask:0xf bank_mask:0xf
v_mov_b32_dpp v50, v54 quad_perm:[2,3,2,3] row_mask:0xf bank_mask:0xf
v_mov_b32_dpp v51, v55 quad_perm:[2,3,2,3] row_mask:0xf bank_mask:0xf
v_mov_b64 v[20:21], s[44:45]
v_mov_b64 v[22:23], s[44:45]
v_mfma_f32_16x16x32_bf16 v[8:11], v[56:59], v[48:51], 0
v_mfma_f32_16x16x32_bf16 v[12:15], v[60:63], v[48:51], 0
v_mfma_f32_16x16x32_bf16 v[16:19], v[20:23], v[48:51], 0
v_mov_b64 v[54:55], s[46:47]
v_exp_f32_dpp v44, v46 quad_perm:[0,1,0,1] row_mask:0xf bank_mask:0xf
v_exp_f32_dpp v45, v47 quad_perm:[0,1,0,1] row_mask:0xf bank_mask:0xf
s_nop 0
v_cvt_pk_bf16_f32 v52, v44, v45
v_cvt_pk_bf16_f32 v53, v44, v45
s_nop 1
v_mfma_f32_16x16x16_bf16 v[16:19], v[54:55], v[52:53], v[16:19]
v_mfma_f32_16x16x16_bf16 v[8:11], v[24:25], v[52:53], v[8:11]
v_mfma_f32_16x16x16_bf16 v[12:15], v[26:27], v[52:53], v[12:15]
s_nop 5
v_rcp_f32 v18, v16
s_nop 0
v_cndmask_b32 v8, v12, v8, s[42:43]
v_mul_f32 v8, v8, v18
v_cndmask_b32 v9, v13, v9, s[42:43]
v_mul_f32 v9, v9, v18
v_cndmask_b32 v10, v14, v10, s[42:43]
v_mul_f32 v10, v10, v18
v_cndmask_b32 v11, v15, v11, s[42:43]
v_mul_f32 v11, v11, v18
v_cvt_pk_bf16_f32 v12, v8, v9
v_cvt_pk_bf16_f32 v13, v10, v11
s_branch back_10103
exit_10104:
global_load_dwordx4 v[32:35], v0, s[68:69] offset:-4096 sc1
global_load_dwordx4 v[36:39], v0, s[68:69] offset:0 sc1
s_add_u32 s30, s30, 1
s_cmp_gt_u32 s30, 262144
s_cbranch_scc1 L_fail
s_waitcnt vmcnt(1)
v_bitop3_b32 v44, v32, v34, s18 bitop3:0x7e
s_waitcnt vmcnt(0)
v_bitop3_b32 v45, v36, v38, s18 bitop3:0x7e
v_bitop3_b32 v44, v44, v45, s19 bitop3:0xa8
v_cmp_ne_u32 vcc, 0, v44
s_cbranch_vccnz exit_10104
ds_write_b128 v0, v[32:35] offset:2048
ds_write_b128 v0, v[36:39] offset:6144
s_waitcnt lgkmcnt(0)
s_barrier
s_barrier
s_add_u32 s36, s36, 1
s_cmp_lt_u32 s36, 2
s_cbranch_scc1 layer_10100
s_endpgm
wave_10071:
layer_10113:
s_lshl_b32 s17, s36, 6
s_mul_i32 s27, s36, 35651584
s_mul_i32 s28, s14, 16384
s_add_u32 s27, s27, s28
s_add_u32 s20, s27, 16789504
s_mul_i32 s27, s17, 10240
s_add_u32 s27, s27, s24
s_add_u32 s21, s27, s25
s_mov_b32 s19, 0
s_mov_b32 s33, s6
s_add_u32 s34, s17, 1
s_add_u32 s31, s17, 63
s_add_u32 s32, s17, 64
s_mov_b32 s27, s20
v_mov_b32 v7, 0
s_add_u32 s68, s4, 416768
s_addc_u32 s69, s5, 0
s_add_u32 s72, s4, 400384
s_addc_u32 s73, s5, 0
s_add_u32 s70, s4, 420864
s_addc_u32 s71, s5, 0
s_add_u32 s74, s4, 404480
s_addc_u32 s75, s5, 0
s_add_u32 s58, s4, s20
s_addc_u32 s59, s5, 0
global_load_dwordx4 v[64:67], v0, s[76:77] offset:-4096 sc1
global_load_dwordx4 v[68:71], v0, s[76:77] offset:-3072 sc1
global_load_dwordx4 v[72:75], v0, s[76:77] offset:0 sc1
global_load_dwordx4 v[76:79], v0, s[76:77] offset:1024 sc1
global_load_dwordx4 v[48:51], v0, s[76:77] offset:2048 sc1
global_load_dwordx4 v[52:55], v0, s[76:77] offset:3072 sc1
global_load_dwordx4 v[56:59], v0, s[76:77] offset:-2048 sc1
global_load_dwordx4 v[60:63], v0, s[76:77] offset:-1024 sc1
v_mov_b64 v[8:9], 0
v_mov_b64 v[10:11], 0
v_mov_b64 v[12:13], 0
v_mov_b64 v[14:15], 0
v_mov_b64 v[16:17], 0
v_mov_b64 v[18:19], 0
v_mov_b64 v[20:21], 0
v_mov_b64 v[22:23], 0
v_mov_b64 v[24:25], 0
v_mov_b64 v[26:27], 0
v_mov_b64 v[28:29], 0
v_mov_b64 v[30:31], 0
s_barrier
v_and_b32 v7, 128, v0
v_add_u32 v7, s22, v7
s_mov_b32 exec_hi, 0
v_and_b32 v7, 511, v0
v_lshl_add_u32 v7, v7, 3, s27
s_mov_b32 exec_hi, -1
global_load_dwordx4 v[32:35], v0, s[68:69] offset:-4096 sc1
global_load_dwordx4 v[36:39], v0, s[68:69] offset:0 sc1
s_mov_b32 s30, 0
s_waitcnt vmcnt(0)
.p2align 6
gather_10114:
s_waitcnt vmcnt(3)
rt_10119_b:
v_smfmac_f32_16x16x64_bf16 v[12:15], v[32:35], a[0:7], v1
ds_write_b128 v0, v[32:35] offset:3072
v_smfmac_f32_16x16x64_bf16 v[20:23], v[32:35], a[8:15], v1
v_bitop3_b32 v44, v32, v34, s18 bitop3:0x7e
v_smfmac_f32_16x16x64_bf16 v[28:31], v[32:35], v[72:79], v1
s_waitcnt vmcnt(2)
ds_write_b128 v0, v[36:39] offset:7168
v_bitop3_b32 v45, v36, v38, s18 bitop3:0x7e
v_bitop3_b32 v44, v44, v45, s19 bitop3:0xa8
v_cmp_ne_u32 vcc, 0, v44
v_smfmac_f32_16x16x64_bf16 v[8:11], v[32:35], v[64:71], v1
s_cbranch_vccnz rt_10119
global_load_dwordx4 v[64:67], v0, s[78:79] offset:-4096 sc1
v_smfmac_f32_16x16x64_bf16 v[16:19], v[32:35], v[56:63], v1
global_load_dwordx4 v[68:71], v0, s[78:79] offset:-3072 sc1
v_smfmac_f32_16x16x64_bf16 v[20:23], v[36:39], a[48:55], v1
s_waitcnt lgkmcnt(0)
ds_read_b128 v[60:63], v2 offset:1024
global_load_dwordx4 v[72:75], v0, s[78:79] offset:-2048 sc1
v_smfmac_f32_16x16x64_bf16 v[16:19], v[36:39], a[40:47], v1
ds_read_b128 v[56:59], v2 offset:0
v_smfmac_f32_16x16x64_bf16 v[24:27], v[32:35], a[16:23], v1
s_barrier
ds_read_b128 v[40:43], v0 offset:2048
v_smfmac_f32_16x16x64_bf16 v[12:15], v[36:39], a[32:39], v1
ds_read_b128 v[44:47], v0 offset:6144
s_waitcnt lgkmcnt(3)
v_smfmac_f32_16x16x64_bf16 v[8:11], v[36:39], a[24:31], v1
ds_read_b128 v[32:35], v0 offset:1024
s_waitcnt lgkmcnt(3)
v_smfmac_f32_16x16x64_bf16 v[28:31], v[36:39], v[56:63], v1
ds_read_b128 v[56:59], v2 offset:2048
v_smfmac_f32_16x16x64_bf16 v[24:27], v[36:39], a[56:63], v1
ds_read_b128 v[60:63], v2 offset:3072
s_waitcnt lgkmcnt(4)
v_smfmac_f32_16x16x64_bf16 v[8:11], v[40:43], a[64:71], v1
ds_read_b128 v[36:39], v0 offset:5120
s_waitcnt vmcnt(3)
v_smfmac_f32_16x16x64_bf16 v[12:15], v[40:43], v[48:55], v1
s_waitcnt lgkmcnt(4)
ds_read_b128 v[48:51], v2 offset:4096
v_smfmac_f32_16x16x64_bf16 v[8:11], v[44:47], a[72:79], v1
ds_read_b128 v[52:55], v2 offset:5120
s_waitcnt lgkmcnt(5)
v_smfmac_f32_16x16x64_bf16 v[12:15], v[44:47], a[80:87], v1
s_waitcnt lgkmcnt(4)
ds_read_b128 v[44:47], v0 offset:4096
s_waitcnt lgkmcnt(4)
v_smfmac_f32_16x16x64_bf16 v[12:15], v[32:35], a[88:95], v1
ds_read_b128 v[40:43], v0 offset:0
s_waitcnt lgkmcnt(4)
v_smfmac_f32_16x16x64_bf16 v[8:11], v[32:35], v[56:63], v1
s_mov_b64 s[68:69], s[72:73]
ds_read_b128 v[56:59], v2 offset:6144
s_waitcnt lgkmcnt(4)
v_smfmac_f32_16x16x64_bf16 v[8:11], v[36:39], a[96:103], v1
ds_read_b128 v[32:35], v0 offset:9216
s_waitcnt vmcnt(2)
global_load_dwordx4 v[76:79], v0, s[78:79] offset:-1024 sc1
ds_read_b128 v[60:63], v2 offset:7168
s_waitcnt lgkmcnt(5)
v_smfmac_f32_16x16x64_bf16 v[12:15], v[36:39], v[48:55], v1
s_xor_b32 s18, s18, 1
s_waitcnt lgkmcnt(4)
ds_read_b128 v[52:55], v2 offset:9216
s_waitcnt lgkmcnt(4)
ds_read_b128 v[48:51], v2 offset:8192
v_smfmac_f32_16x16x64_bf16 v[8:11], v[40:43], a[104:111], v1
ds_read_b128 v[36:39], v0 offset:8192
s_waitcnt vmcnt(2)
v_smfmac_f32_16x16x64_bf16 v[8:11], v[44:47], v[64:71], v1
global_load_dwordx4 v[64:67], v0, s[78:79] offset:0 sc1
v_smfmac_f32_16x16x64_bf16 v[12:15], v[40:43], a[112:119], v1
s_waitcnt lgkmcnt(3)
ds_read_b128 v[40:43], v0 offset:2048
s_mov_b64 vcc, s[42:43]
v_smfmac_f32_16x16x64_bf16 v[12:15], v[44:47], v[56:63], v1
s_waitcnt lgkmcnt(3)
ds_read_b128 v[60:63], v2 offset:11264
global_load_dwordx4 v[68:71], v0, s[78:79] offset:1024 sc1
v_smfmac_f32_16x16x64_bf16 v[8:11], v[32:35], a[120:127], v1
s_waitcnt lgkmcnt(3)
ds_read_b128 v[56:59], v2 offset:10240
v_smfmac_f32_16x16x64_bf16 v[12:15], v[32:35], v[48:55], v1
s_waitcnt lgkmcnt(3)
ds_read_b128 v[32:35], v0 offset:6144
v_add_u32 v44, s24, v0
v_smfmac_f32_16x16x64_bf16 v[12:15], v[36:39], a[136:143], v1
global_load_dwordx4 v[48:51], v0, s[58:59] offset:0 nt sc1
v_smfmac_f32_16x16x64_bf16 v[8:11], v[36:39], a[128:135], v1
s_waitcnt lgkmcnt(3)
ds_read_b128 v[36:39], v0 offset:1024
global_load_dwordx4 v[52:55], v0, s[58:59] offset:1024 nt sc1
v_smfmac_f32_16x16x64_bf16 v[20:23], v[40:43], a[152:159], v1
s_nop 0
ds_read_b128 v[44:47], v44
v_add_f32 v13, v13, v15
v_smfmac_f32_16x16x64_bf16 v[16:19], v[40:43], a[144:151], v1
s_waitcnt lgkmcnt(2)
ds_read_b128 v[40:43], v0 offset:5120
v_add_f32 v9, v9, v11
v_smfmac_f32_16x16x64_bf16 v[20:23], v[32:35], v[56:63], v1
ds_read_b128 v[56:59], v2 offset:12288
ds_read_b128 v[60:63], v2 offset:13312
v_smfmac_f32_16x16x64_bf16 v[16:19], v[32:35], a[160:167], v1
s_waitcnt lgkmcnt(4)
v_add_f32 v8, v8, v10
v_smfmac_f32_16x16x64_bf16 v[20:23], v[36:39], a[176:183], v1
s_waitcnt vmcnt(5)
ds_read_b128 v[32:35], v0 offset:0
v_mul_f32 v9, s35, v9
v_add_f32 v12, v12, v14
v_mul_f32 v13, s35, v13
v_mul_f32 v8, s35, v8
v_mul_f32 v12, s35, v12
v_cvt_pk_bf16_f32 v12, v12, v13
v_cvt_pk_bf16_f32 v8, v8, v9
v_smfmac_f32_16x16x64_bf16 v[16:19], v[36:39], a[168:175], v1
s_waitcnt lgkmcnt(2)
ds_read_b128 v[36:39], v0 offset:4096
ds_write2_b32 v3, v8, v12 offset0:0 offset1:128
s_waitcnt lgkmcnt(3)
v_smfmac_f32_16x16x64_bf16 v[16:19], v[40:43], v[56:63], v1
s_waitcnt vmcnt(4)
global_load_dwordx4 v[56:59], v0, s[58:59] offset:2048 nt sc1
v_smfmac_f32_16x16x64_bf16 v[20:23], v[40:43], v[72:79], v1
s_waitcnt lgkmcnt(2)
global_load_dwordx4 v[60:63], v0, s[58:59] offset:3072 nt sc1
ds_read_b128 v[40:43], v0 offset:9216
v_smfmac_f32_16x16x64_bf16 v[16:19], v[32:35], a[184:191], v1
global_load_dwordx4 v[72:75], v0, s[78:79] offset:2048 sc1
v_swap_b32 v45, v46
v_smfmac_f32_16x16x64_bf16 v[20:23], v[32:35], a[192:199], v1
s_waitcnt lgkmcnt(1)
ds_read_b128 v[32:35], v0 offset:8192
global_load_dwordx4 v[76:79], v0, s[78:79] offset:3072 sc1
v_smfmac_f32_16x16x64_bf16 v[16:19], v[36:39], a[200:207], v1
s_barrier
v_smfmac_f32_16x16x64_bf16 v[20:23], v[36:39], a[208:215], v1
s_waitcnt lgkmcnt(1)
ds_read_b64_tr_b16 v[10:11], v4 offset:2560
ds_read_b64_tr_b16 v[8:9], v4 offset:2048
v_smfmac_f32_16x16x64_bf16 v[16:19], v[40:43], a[216:223], v1
s_add_u32 s20, s20, 524288
ds_read_b64_tr_b16 v[14:15], v4 offset:3584
buffer_store_dwordx4 v[44:47], v0, s[4:7], s21 offen sc1
s_waitcnt lgkmcnt(3)
ds_read_b64_tr_b16 v[12:13], v4 offset:3072
v_smfmac_f32_16x16x64_bf16 v[16:19], v[32:35], a[232:239], v1
ds_read_b128 v[36:39], v0 offset:9216
v_mov_b32 v47, s17
v_smfmac_f32_16x16x64_bf16 v[20:23], v[40:43], a[224:231], v1
s_mov_b64 exec, 1
buffer_store_dword v47, off, s[4:7], s33 sc1
s_mov_b64 exec, -1
v_smfmac_f32_16x16x64_bf16 v[20:23], v[32:35], a[240:247], v1
s_waitcnt lgkmcnt(2)
ds_read_b128 v[32:35], v0 offset:2048
s_waitcnt vmcnt(7)
ds_read_b128 v[40:43], v0 offset:8192
v_mfma_f32_16x16x32_bf16 v[44:47], v[48:51], v[8:11], 0
s_waitcnt lgkmcnt(3)
ds_read_b128 v[8:11], v2 offset:14336
v_bfe_u32 v48, v0, 5, 1
v_add_f32 v17, v17, v19
v_add_f32 v16, v16, v18
s_waitcnt vmcnt(6)
v_mfma_f32_16x16x32_bf16 v[44:47], v[52:55], v[12:15], v[44:47]
s_waitcnt lgkmcnt(3)
ds_read_b128 v[52:55], v2 offset:17408
ds_read_b128 v[12:15], v2 offset:15360
v_lshl_add_u32 v48, v48, 3, v5
v_add_f32 v20, v20, v22
v_add_f32 v21, v21, v23
v_xor_b32 v48, 128, v48
v_cvt_pk_bf16_f32 v16, v16, v17
v_cndmask_b32_dpp v45, v47, v45, vcc quad_perm:[0,1,0,1] row_mask:0xf bank_mask:0xf
v_cndmask_b32_dpp v44, v46, v44, vcc quad_perm:[0,1,0,1] row_mask:0xf bank_mask:0xf
v_smfmac_f32_16x16x64_bf16 v[28:31], v[36:39], v[80:87], v1
ds_write_b64 v48, v[44:45] offset:7680
v_cvt_pk_bf16_f32 v20, v20, v21
v_smfmac_f32_16x16x64_bf16 v[24:27], v[36:39], a[248:255], v1
s_waitcnt lgkmcnt(2)
ds_read_b128 v[48:51], v2 offset:16384
global_load_dword v7, v7, s[4:5] sc1
ds_write2_b32 v3, v16, v20 offset0:1 offset1:129
s_waitcnt lgkmcnt(3)
v_smfmac_f32_16x16x64_bf16 v[24:27], v[40:43], v[8:15], v1
ds_read_b128 v[36:39], v0 offset:6144
v_smfmac_f32_16x16x64_bf16 v[24:27], v[32:35], v[88:95], v1
s_waitcnt lgkmcnt(2)
v_smfmac_f32_16x16x64_bf16 v[28:31], v[40:43], v[48:55], v1
ds_read_b128 v[40:43], v0 offset:1024
v_smfmac_f32_16x16x64_bf16 v[28:31], v[32:35], v[96:103], v1
s_waitcnt lgkmcnt(2)
ds_read_b128 v[32:35], v0 offset:5120
s_barrier
ds_read_b64_tr_b16 v[12:13], v4 offset:1024
s_waitcnt lgkmcnt(3)
ds_read_b128 v[48:51], v6 offset:6144
v_smfmac_f32_16x16x64_bf16 v[28:31], v[36:39], v[104:111], v1
ds_read_b128 v[52:55], v6 offset:7168
s_waitcnt lgkmcnt(4)
ds_read_b64_tr_b16 v[10:11], v4 offset:512
v_smfmac_f32_16x16x64_bf16 v[24:27], v[36:39], v[64:71], v1
ds_read_b64_tr_b16 v[18:19], v4 offset:2560
s_add_u32 s17, s17, 1
ds_read_b64_tr_b16 v[8:9], v4 offset:0
v_smfmac_f32_16x16x64_bf16 v[28:31], v[40:43], v[120:127], v1
s_waitcnt lgkmcnt(6)
ds_read_b64_tr_b16 v[22:23], v4 offset:3584
s_mov_b32 s30, 0
ds_read_b64_tr_b16 v[16:17], v4 offset:2048
v_smfmac_f32_16x16x64_bf16 v[24:27], v[40:43], v[112:119], v1
s_waitcnt vmcnt(3)
ds_read_b64_tr_b16 v[14:15], v4 offset:1536
s_waitcnt lgkmcnt(8)
ds_read_b128 v[40:43], v0 offset:4096
v_smfmac_f32_16x16x64_bf16 v[24:27], v[32:35], v[128:135], v1
ds_read_b128 v[68:71], v2 offset:19456
s_waitcnt lgkmcnt(6)
ds_read_b128 v[36:39], v0 offset:0
v_smfmac_f32_16x16x64_bf16 v[28:31], v[32:35], v[136:143], v1
s_waitcnt lgkmcnt(6)
ds_read_b64_tr_b16 v[20:21], v4 offset:3072
v_add_f32 v50, v50, v54
v_add_f32 v48, v48, v52
v_mfma_f32_16x16x32_bf16 v[44:47], v[8:11], v[8:11], 0
s_waitcnt lgkmcnt(4)
ds_read_b128 v[64:67], v2 offset:18432
v_add_f32 v51, v51, v55
v_mfma_f32_16x16x32_bf16 v[44:47], v[12:15], v[12:15], v[44:47]
v_add_f32 v49, v49, v53
v_exp_f32 v50, v50
v_exp_f32 v51, v51
v_exp_f32 v48, v48
v_exp_f32 v49, v49
v_mfma_f32_16x16x32_bf16 v[44:47], v[16:19], v[16:19], v[44:47]
s_waitcnt lgkmcnt(1)
v_cvt_pk_bf16_f32 v55, v50, v51
v_cvt_pk_bf16_f32 v54, v48, v49
v_mfma_f32_16x16x32_bf16 v[44:47], v[20:23], v[20:23], v[44:47]
s_waitcnt lgkmcnt(0)
v_mov_b32_dpp v50, v54 quad_perm:[2,3,2,3] row_mask:0xf bank_mask:0xf
v_mov_b64 v[20:21], s[44:45]
v_smfmac_f32_16x16x64_bf16 v[24:27], v[36:39], v[64:71], v1
ds_read_b128 v[64:67], v2 offset:20480
v_mov_b32_dpp v51, v55 quad_perm:[2,3,2,3] row_mask:0xf bank_mask:0xf
v_smfmac_f32_16x16x64_bf16 v[28:31], v[36:39], v[144:151], v1
ds_read_b128 v[68:71], v2 offset:21504
v_mov_b64 v[22:23], s[44:45]
v_mov_b32_dpp v49, v55 quad_perm:[0,1,0,1] row_mask:0xf bank_mask:0xf
v_smfmac_f32_16x16x64_bf16 v[24:27], v[40:43], v[72:79], v1
ds_read_b128 v[76:79], v2 offset:23552
v_mov_b32_dpp v48, v54 quad_perm:[0,1,0,1] row_mask:0xf bank_mask:0xf
v_smfmac_f32_16x16x64_bf16 v[28:31], v[40:43], v[152:159], v1
ds_read_b128 v[72:75], v2 offset:22528
v_exp_f32_dpp v45, v47 quad_perm:[0,1,0,1] row_mask:0xf bank_mask:0xf
v_mfma_f32_16x16x32_bf16 v[12:15], v[60:63], v[48:51], 0
v_exp_f32_dpp v44, v46 quad_perm:[0,1,0,1] row_mask:0xf bank_mask:0xf
v_mfma_f32_16x16x32_bf16 v[16:19], v[20:23], v[48:51], 0
v_mov_b64 v[54:55], s[46:47]
v_cvt_pk_bf16_f32 v52, v44, v45
v_cvt_pk_bf16_f32 v53, v44, v45
v_mfma_f32_16x16x32_bf16 v[8:11], v[56:59], v[48:51], 0
v_cvt_pk_bf16_f32 v24, v24, v25
v_cvt_pk_bf16_f32 v25, v26, v27
v_mfma_f32_16x16x16_bf16 v[16:19], v[54:55], v[52:53], v[16:19]
s_waitcnt lgkmcnt(0)
v_cvt_pk_bf16_f32 v27, v30, v31
v_cvt_pk_bf16_f32 v26, v28, v29
v_mfma_f32_16x16x16_bf16 v[8:11], v[24:25], v[52:53], v[8:11]
ds_read_b128 v[28:31], v0 offset:56320
v_bfe_u32 v32, v0, 5, 1
v_mfma_f32_16x16x16_bf16 v[12:15], v[26:27], v[52:53], v[12:15]
s_add_u32 s21, s21, 10240
v_subrev_u32 v17, s37, v16
v_mov_b64 v[42:43], 0
v_rcp_f32 v18, v16
v_cmp_lt_u32 vcc, s38, v17
v_lshl_add_u32 v32, v32, 3, v5
v_mov_b64 v[40:41], 0
v_mov_b64 v[36:37], 0
v_cndmask_b32 v10, v14, v10, s[42:43]
v_mul_f32 v10, v10, v18
v_cndmask_b32 v9, v13, v9, s[42:43]
v_cndmask_b32 v11, v15, v11, s[42:43]
v_cndmask_b32 v8, v12, v8, s[42:43]
v_mul_f32 v8, v8, v18
v_mul_f32 v9, v9, v18
v_cvt_pk_bf16_f32 v12, v8, v9
v_mul_f32 v11, v11, v18
v_cvt_pk_bf16_f32 v13, v10, v11
s_cbranch_vccnz rare_10115
back_10116:
ds_write_b64 v32, v[12:13] offset:1536
v_mov_b64 v[50:51], 0
v_mov_b32_dpp v10, v12 quad_perm:[2,3,2,3] row_mask:0xf bank_mask:0xf
v_mov_b32_dpp v9, v13 quad_perm:[0,1,0,1] row_mask:0xf bank_mask:0xf
v_mov_b32_dpp v11, v13 quad_perm:[2,3,2,3] row_mask:0xf bank_mask:0xf
v_mov_b32_dpp v8, v12 quad_perm:[0,1,0,1] row_mask:0xf bank_mask:0xf
v_mov_b64 v[38:39], 0
v_mov_b64 v[32:33], 0
v_mov_b64 v[48:49], 0
v_smfmac_f32_16x16x64_bf16 v[36:39], v[8:11], v[64:71], v1
s_add_u32 s34, s17, 2
ds_read_b128 v[24:27], v0 offset:55296
global_load_dwordx4 v[64:67], v0, s[76:77] offset:-4096 sc1
ds_read_b128 v[16:19], v0 offset:53248
v_mov_b64 v[34:35], 0
v_smfmac_f32_16x16x64_bf16 v[40:43], v[8:11], v[72:79], v1
s_waitcnt lgkmcnt(2)
ds_read_b128 v[20:23], v0 offset:54272
s_barrier
ds_read_b128 v[56:59], v5 offset:1024
v_smfmac_f32_16x16x64_bf16 v[32:35], v[8:11], v[176:183], v1
global_load_dwordx4 v[68:71], v0, s[76:77] offset:-3072 sc1
s_waitcnt lgkmcnt(3)
ds_read_b128 v[60:63], v5 offset:512
v_lshrrev_b32 v44, 8, v0
v_smfmac_f32_16x16x64_bf16 v[48:51], v[8:11], v[160:167], v1
ds_read_b128 v[12:15], v5 offset:0
global_load_dwordx4 v[72:75], v0, s[76:77] offset:0 sc1
v_bfe_u32 v45, v0, 1, 7
v_mov_b64 v[54:55], 0
s_waitcnt lgkmcnt(2)
v_smfmac_f32_16x16x64_bf16 v[48:51], v[56:59], v[208:215], v1
s_min_u32 s34, s34, s32
global_load_dwordx4 v[76:79], v0, s[76:77] offset:1024 sc1
v_smfmac_f32_16x16x64_bf16 v[36:39], v[56:59], v[16:23], v1
s_mov_b32 s19, 1
ds_read_b128 v[16:19], v0 offset:57344
s_waitcnt lgkmcnt(2)
v_smfmac_f32_16x16x64_bf16 v[36:39], v[60:63], v[24:31], v1
s_add_u32 s27, s20, 524288
ds_read_b128 v[20:23], v0 offset:58368
v_smfmac_f32_16x16x64_bf16 v[32:35], v[56:59], v[232:239], v1
s_waitcnt lgkmcnt(2)
ds_read_b128 v[28:31], v0 offset:60416
v_mov_b64 v[52:53], 0
v_smfmac_f32_16x16x64_bf16 v[36:39], v[12:15], v[184:191], v1
v_lshl_or_b32 v44, v44, 12, v45
v_smfmac_f32_16x16x64_bf16 v[40:43], v[56:59], v[192:199], v1
s_nop 0
ds_read_b128 v[24:27], v0 offset:59392
s_nop 0
v_smfmac_f32_16x16x64_bf16 v[40:43], v[60:63], v[200:207], v1
s_add_u32 s58, s4, s20
s_waitcnt lgkmcnt(2)
v_cvt_pk_bf16_f32 v36, v36, v37
v_smfmac_f32_16x16x64_bf16 v[40:43], v[12:15], v[16:23], v1
ds_read_b128 v[20:23], v0 offset:62464
v_and_or_b32 v36, v36, -2, s18
v_cvt_pk_bf16_f32 v37, v38, v39
v_smfmac_f32_16x16x64_bf16 v[32:35], v[60:63], v[240:247], v1
global_store_dwordx2 v44, v[36:37], s[48:49]
v_smfmac_f32_16x16x64_bf16 v[48:51], v[60:63], v[216:223], v1
s_waitcnt lgkmcnt(1)
ds_read_b128 v[16:19], v0 offset:61440
v_cvt_pk_bf16_f32 v40, v40, v41
v_smfmac_f32_16x16x64_bf16 v[48:51], v[12:15], v[24:31], v1
s_addc_u32 s59, s5, 0
ds_read_b128 v[24:27], v0 offset:63488
v_and_or_b32 v40, v40, -2, s18
v_cvt_pk_bf16_f32 v41, v42, v43
v_smfmac_f32_16x16x64_bf16 v[32:35], v[12:15], v[248:255], v1
global_store_dwordx2 v44, v[40:41], s[50:51]
ds_read_b128 v[28:31], v0 offset:64512
v_smfmac_f32_16x16x64_bf16 v[52:55], v[8:11], v[168:175], v1
v_cvt_pk_bf16_f32 v48, v48, v49
v_smfmac_f32_16x16x64_bf16 v[52:55], v[56:59], v[224:231], v1
s_waitcnt lgkmcnt(2)
v_and_or_b32 v48, v48, -2, s18
v_cvt_pk_bf16_f32 v49, v50, v51
v_smfmac_f32_16x16x64_bf16 v[52:55], v[60:63], v[16:23], v1
s_and_b32 s33, s17, 3
s_waitcnt lgkmcnt(1)
global_store_dwordx2 v44, v[48:49], s[52:53]
s_waitcnt lgkmcnt(0)
v_smfmac_f32_16x16x64_bf16 v[52:55], v[12:15], v[24:31], v1
s_nop 1
v_cvt_pk_bf16_f32 v32, v32, v33
v_and_or_b32 v32, v32, -2, s18
v_cvt_pk_bf16_f32 v33, v34, v35
s_nop 2
v_cvt_pk_bf16_f32 v52, v52, v53
v_and_or_b32 v52, v52, -2, s18
v_cvt_pk_bf16_f32 v53, v54, v55
s_cselect_b32 s33, s6, s23
global_store_dwordx2 v44, v[52:53], s[54:55]
global_store_dwordx2 v44, v[32:33], s[56:57]
nored_10122:
s_waitcnt vmcnt(9)
v_cmp_gt_u32 vcc, s34, v7
s_cmp_eq_u32 vcc_hi, 0
s_cbranch_scc1 kv_10126
s_mov_b32 s30, 0
kv_10125:
v_and_b32 v7, 128, v0
buffer_load_dword v7, v7, s[4:7], s22 offen sc1
s_add_u32 s30, s30, 1
s_cmp_gt_u32 s30, 262144
s_cbranch_scc1 L_fail
s_waitcnt vmcnt(0)
v_cmp_gt_u32 vcc, s34, v7
s_cbranch_vccnz kv_10125
kv_10126:
v_and_b32 v7, 128, v0
v_add_u32 v7, s22, v7
s_mov_b32 exec_hi, 0
v_and_b32 v7, 511, v0
v_lshl_add_u32 v7, v7, 3, s27
s_mov_b32 exec_hi, -1
join_10123:
s_barrier
global_load_dwordx4 v[56:59], v0, s[76:77] offset:-2048 sc1
global_load_dwordx4 v[60:63], v0, s[76:77] offset:-1024 sc1
s_nop 15
s_nop 15
s_nop 5
s_barrier
global_load_dwordx4 v[32:35], v0, s[68:69] offset:-4096 sc1
s_nop 10
global_load_dwordx4 v[36:39], v0, s[68:69] offset:0 sc1
s_barrier
global_load_dwordx4 v[48:51], v0, s[76:77] offset:2048 sc1
global_load_dwordx4 v[52:55], v0, s[76:77] offset:3072 sc1
v_mov_b64 v[8:9], 0
v_mov_b64 v[10:11], 0
v_mov_b64 v[12:13], 0
v_mov_b64 v[14:15], 0
v_mov_b64 v[16:17], 0
v_mov_b64 v[18:19], 0
v_mov_b64 v[20:21], 0
v_mov_b64 v[22:23], 0
v_mov_b64 v[24:25], 0
v_mov_b64 v[26:27], 0
v_mov_b64 v[28:29], 0
v_mov_b64 v[30:31], 0
s_mov_b32 s30, 0
s_cmp_eq_u32 s17, s31
s_cbranch_scc0 gather_10114
s_branch exit_10117
rt_10119:
global_load_dwordx4 v[32:35], v0, s[68:69] offset:-4096 sc1
global_load_dwordx4 v[36:39], v0, s[68:69] offset:0 sc1
s_add_u32 s30, s30, 1
s_cmp_gt_u32 s30, 262144
s_cbranch_scc1 L_fail
s_mov_b64 exec, 1
global_store_dword v0, v0, s[62:63]
global_store_dword v0, v0, s[62:63]
s_mov_b64 exec, -1
v_mov_b64 v[8:9], 0
v_mov_b64 v[10:11], 0
v_mov_b64 v[12:13], 0
v_mov_b64 v[14:15], 0
v_mov_b64 v[16:17], 0
v_mov_b64 v[18:19], 0
v_mov_b64 v[20:21], 0
v_mov_b64 v[22:23], 0
v_mov_b64 v[24:25], 0
v_mov_b64 v[26:27], 0
v_mov_b64 v[28:29], 0
v_mov_b64 v[30:31], 0
s_branch gather_10114
rare_10115:
ds_read_b128 v[48:51], v6 offset:6144
ds_read_b128 v[52:55], v6 offset:7168
s_waitcnt lgkmcnt(0)
v_add_f32 v48, v48, v52
v_add_f32 v49, v49, v53
v_add_f32 v50, v50, v54
v_add_f32 v51, v51, v55
v_mov_b32_dpp v46, v46 quad_perm:[0,1,0,1] row_mask:0xf bank_mask:0xf
v_mov_b32_dpp v47, v47 quad_perm:[0,1,0,1] row_mask:0xf bank_mask:0xf
v_max3_f32 v19, v48, v49, v50
v_max3_f32 v19, v19, v51, v46
v_max_f32 v19, v19, v47
s_nop 1
v_max_f32_dpp v19, v19, v19 quad_perm:[2,3,0,1] row_mask:0xf bank_mask:0xf
v_mov_b32 v44, v19
s_nop 1
v_permlane32_swap_b32 v19, v44
v_max_f32 v19, v19, v44
v_mov_b32 v44, v19
s_nop 1
v_permlane16_swap_b32 v19, v44
v_max_f32 v19, v19, v44
v_sub_f32 v48, v48, v19
v_sub_f32 v49, v49, v19
v_sub_f32 v50, v50, v19
v_sub_f32 v51, v51, v19
v_sub_f32 v46, v46, v19
v_sub_f32 v47, v47, v19
v_exp_f32 v48, v48
v_exp_f32 v49, v49
v_exp_f32 v50, v50
v_exp_f32 v51, v51
v_cvt_pk_bf16_f32 v54, v48, v49
v_cvt_pk_bf16_f32 v55, v50, v51
s_nop 0
v_mov_b32_dpp v48, v54 quad_perm:[0,1,0,1] row_mask:0xf bank_mask:0xf
v_mov_b32_dpp v49, v55 quad_perm:[0,1,0,1] row_mask:0xf bank_mask:0xf
v_mov_b32_dpp v50, v54 quad_perm:[2,3,2,3] row_mask:0xf bank_mask:0xf
v_mov_b32_dpp v51, v55 quad_perm:[2,3,2,3] row_mask:0xf bank_mask:0xf
v_mov_b64 v[20:21], s[44:45]
v_mov_b64 v[22:23], s[44:45]
v_mfma_f32_16x16x32_bf16 v[8:11], v[56:59], v[48:51], 0
v_mfma_f32_16x16x32_bf16 v[12:15], v[60:63], v[48:51], 0
v_mfma_f32_16x16x32_bf16 v[16:19], v[20:23], v[48:51], 0
v_mov_b64 v[54:55], s[46:47]
v_exp_f32_dpp v44, v46 quad_perm:[0,1,0,1] row_mask:0xf bank_mask:0xf
v_exp_f32_dpp v45, v47 quad_perm:[0,1,0,1] row_mask:0xf bank_mask:0xf
s_nop 0
v_cvt_pk_bf16_f32 v52, v44, v45
v_cvt_pk_bf16_f32 v53, v44, v45
s_nop 1
v_mfma_f32_16x16x16_bf16 v[16:19], v[54:55], v[52:53], v[16:19]
v_mfma_f32_16x16x16_bf16 v[8:11], v[24:25], v[52:53], v[8:11]
v_mfma_f32_16x16x16_bf16 v[12:15], v[26:27], v[52:53], v[12:15]
s_nop 5
v_rcp_f32 v18, v16
s_nop 0
v_cndmask_b32 v8, v12, v8, s[42:43]
v_mul_f32 v8, v8, v18
v_cndmask_b32 v9, v13, v9, s[42:43]
v_mul_f32 v9, v9, v18
v_cndmask_b32 v10, v14, v10, s[42:43]
v_mul_f32 v10, v10, v18
v_cndmask_b32 v11, v15, v11, s[42:43]
v_mul_f32 v11, v11, v18
v_cvt_pk_bf16_f32 v12, v8, v9
v_cvt_pk_bf16_f32 v13, v10, v11
s_branch back_10116
exit_10117:
global_load_dwordx4 v[32:35], v0, s[68:69] offset:-4096 sc1
global_load_dwordx4 v[36:39], v0, s[68:69] offset:0 sc1
s_add_u32 s30, s30, 1
s_cmp_gt_u32 s30, 262144
s_cbranch_scc1 L_fail
s_waitcnt vmcnt(1)
v_bitop3_b32 v44, v32, v34, s18 bitop3:0x7e
s_waitcnt vmcnt(0)
v_bitop3_b32 v45, v36, v38, s18 bitop3:0x7e
v_bitop3_b32 v44, v44, v45, s19 bitop3:0xa8
v_cmp_ne_u32 vcc, 0, v44
s_cbranch_vccnz exit_10117
ds_write_b128 v0, v[32:35] offset:3072
ds_write_b128 v0, v[36:39] offset:7168
s_waitcnt lgkmcnt(0)
s_barrier
v_add_u32 v44, s24, v0
ds_read_b128 v[44:47], v44
s_waitcnt lgkmcnt(0)
v_swap_b32 v45, v46
buffer_store_dwordx4 v[44:47], v0, s[4:7], s21 offen sc1
s_add_u32 s26, s17, 1
s_waitcnt vmcnt(0)
v_mov_b32 v44, s26
s_mov_b64 exec, 1
buffer_store_dword v44, off, s[4:7], s23 sc1
s_mov_b64 exec, -1
s_barrier
s_add_u32 s36, s36, 1
s_cmp_lt_u32 s36, 2
s_cbranch_scc1 layer_10113
s_endpgm
grp_10064:
L_last:
s_endpgm

.section .rodata,"a"
.p2align 6
.amdhsa_kernel interleave_layers__spectral_gfnet__memory_aug_recurrent_mem_tr__prompt_kernel
  .amdhsa_next_free_vgpr 512
  .amdhsa_next_free_sgpr 102
  .amdhsa_accum_offset 256
  .amdhsa_group_segment_fixed_size 0
  .amdhsa_kernarg_size 104
  .amdhsa_user_sgpr_count 2
  .amdhsa_user_sgpr_kernarg_segment_ptr 1
  .amdhsa_system_sgpr_workgroup_id_x 1
  .amdhsa_float_denorm_mode_32 3
  .amdhsa_ieee_mode 0
.end_amdhsa_kernel
```

```asm
; @launch grid=(256,1,1) block=(256,1,1) lds=163840
.amdgcn_target "amdgcn-amd-amdhsa--gfx950"
.text
.globl interleave_layers__spectral_gfnet__memory_aug_recurrent_mem_tr__prompt_kernel
.p2align 8
.type interleave_layers__spectral_gfnet__memory_aug_recurrent_mem_tr__prompt_kernel,@function
interleave_layers__spectral_gfnet__memory_aug_recurrent_mem_tr__prompt_kernel:
s_cmp_ge_u32 s2, 256
s_cbranch_scc1 L_end
s_load_dwordx2 s[4:5], s[0:1], 96
s_load_dwordx2 s[8:9], s[0:1], 88
s_mov_b32 s6, 268435456
s_mov_b32 s7, 0x20000
s_mov_b32 s10, 256
s_mov_b32 s11, 0x20000
s_getreg_b32 s12, hwreg(HW_REG_XCC_ID, 0, 3)
v_lshrrev_b32 v1, 6, v0
s_nop 0
v_readfirstlane_b32 s13, v1
s_waitcnt lgkmcnt(0)
s_cmp_lg_u32 s13, 0
s_cbranch_scc1 reg_3
v_mov_b32 v1, 0
v_mov_b32 v2, -1
ds_write_b32 v1, v2
s_sub_u32 s15, s12, 8
s_and_b32 s15, s15, 7
s_lshl_b32 s15, s15, 4
v_mov_b32 v2, 1
s_mov_b64 exec, 1
buffer_atomic_add v2, off, s[8:11], s15 offset:16 sc0
s_mov_b64 exec, -1
s_cmp_lg_u32 s12, 7
s_cbranch_scc1 reg_6
s_waitcnt vmcnt(0)
v_readfirstlane_b32 s16, v2
s_nop 0
s_cmp_ge_u32 s16, 32
s_cbranch_scc1 reg_6
s_mov_b32 s18, 0
reg_5:
buffer_load_dword v3, off, s[8:11], 0 offset:128 sc1
s_waitcnt vmcnt(0)
v_cmp_gt_u32 vcc, 32, v3
s_cbranch_vccz reg_7
s_add_u32 s18, s18, 1
s_cmp_lt_u32 s18, 16
s_cbranch_scc1 reg_5
reg_6:
v_and_b32 v1, 15, v0
v_cmp_ne_u32 vcc, 9, v1
s_nop 1
v_cndmask_b32 v1, 10, v1, vcc
v_lshlrev_b32 v1, 4, v1
s_mov_b32 s16, 0
all_8:
buffer_load_dword v3, v1, s[8:11], 0 offen sc1
s_add_u32 s16, s16, 1
s_cmp_gt_u32 s16, 262144
s_cbranch_scc1 L_fail
all_9:
s_waitcnt vmcnt(0)
v_add_u32_dpp v4, v3, v3 quad_perm:[1,0,3,2] row_mask:0xf bank_mask:0xf
s_nop 1
v_add_u32_dpp v4, v4, v4 quad_perm:[2,3,0,1] row_mask:0xf bank_mask:0xf
s_nop 1
v_add_u32_dpp v4, v4, v4 row_ror:4 row_mask:0xf bank_mask:0xf
s_nop 1
v_add_u32_dpp v4, v4, v4 row_ror:8 row_mask:0xf bank_mask:0xf
v_cmp_ne_u32 vcc, 274, v4
s_cbranch_vccnz all_8
v_readfirstlane_b32 s17, v2
v_readlane_b32 s20, v3, 1
v_readlane_b32 s21, v3, 2
v_readlane_b32 s22, v3, 3
v_readlane_b32 s23, v3, 4
v_readlane_b32 s24, v3, 5
v_readlane_b32 s25, v3, 6
v_readlane_b32 s26, v3, 7
v_readlane_b32 s27, v3, 8
s_mov_b32 s15, 6
s_cmp_ge_u32 s25, 32
s_cselect_b32 s15, 5, s15
s_cmp_ge_u32 s24, 32
s_cselect_b32 s15, 4, s15
s_cmp_ge_u32 s23, 32
s_cselect_b32 s15, 3, s15
s_cmp_ge_u32 s22, 32
s_cselect_b32 s15, 2, s15
s_cmp_ge_u32 s21, 32
s_cselect_b32 s15, 1, s15
s_cmp_ge_u32 s20, 32
s_cselect_b32 s15, 0, s15
s_cmp_ge_u32 s27, 32
s_cselect_b32 s15, 7, s15
s_mov_b32 s16, s17
s_cmp_gt_u32 s12, 0
s_cselect_b32 s18, s20, 0
s_add_u32 s16, s16, s18
s_cmp_gt_u32 s12, 1
s_cselect_b32 s18, s21, 0
s_add_u32 s16, s16, s18
s_cmp_gt_u32 s12, 2
s_cselect_b32 s18, s22, 0
s_add_u32 s16, s16, s18
s_cmp_gt_u32 s12, 3
s_cselect_b32 s18, s23, 0
s_add_u32 s16, s16, s18
s_cmp_gt_u32 s12, 4
s_cselect_b32 s18, s24, 0
s_add_u32 s16, s16, s18
s_cmp_gt_u32 s12, 5
s_cselect_b32 s18, s25, 0
s_add_u32 s16, s16, s18
s_cmp_gt_u32 s12, 6
s_cselect_b32 s18, s26, 0
s_add_u32 s16, s16, s18
s_add_u32 s18, s16, 32
s_cmp_lt_u32 s12, s15
s_cselect_b32 s16, s18, s16
s_cmp_eq_u32 s12, s15
s_cselect_b32 s18, s17, 32
s_cmp_lt_u32 s18, 32
s_cselect_b32 s16, s18, s16
reg_7:
v_mov_b32 v1, 0
v_mov_b32 v2, s16
ds_write_b32 v1, v2
s_waitcnt lgkmcnt(0)
s_branch reg_2
reg_3:
s_cmp_lg_u32 s13, 3
s_cbranch_scc1 reg_10
s_getpc_b64 s[20:21]
L_here:
s_bfe_u32 s15, s2, 0x50003
v_and_b32 v1, 63, v0
v_lshl_add_u32 v1, v1, 5, s15
v_lshlrev_b32 v1, 7, v1
v_min_u32 v1, L_last-L_here, v1
v_mov_b32 v7, s21
v_add_co_u32 v6, vcc, s20, v1
s_nop 1
v_addc_co_u32 v7, vcc, 0, v7, vcc
global_load_dword v6, v[6:7], off
reg_10:
s_cmp_lg_u32 s13, 1
s_cbranch_scc1 reg_4
s_cmp_ge_u32 s2, 18
s_cbranch_scc1 reg_4
v_lshlrev_b32 v1, 7, v0
s_lshl_b32 s15, s2, 13
s_add_u32 s15, s15, 11526144
v_mov_b32 v4, 0
buffer_store_dword v4, v1, s[4:7], s15 offen sc1
v_mov_b32 v2, 1
s_waitcnt vmcnt(0)
s_mov_b64 exec, 1
buffer_atomic_add v2, off, s[8:11], 0
s_mov_b64 exec, -1
reg_4:
s_cmp_eq_u32 s12, 7
s_cbranch_scc1 reg_2
s_load_dwordx2 s[24:25], s[0:1], 48
s_mov_b32 s26, 5242880
s_mov_b32 s27, 0x20000
s_lshl_b32 s15, s13, 3
s_sub_u32 s15, s15, 8
s_load_dwordx2 s[20:21], s[0:1], s15
s_mov_b32 s16, 1314816
s_cmp_eq_u32 s13, 1
s_cselect_b32 s22, 2621440, s16
s_cselect_b32 s16, 80, 41
s_mov_b32 s23, 0x20000
s_mul_i32 s17, s16, s2
s_lshl_b32 s17, s17, 7
s_sub_u32 s16, s16, 1
v_and_b32 v1, 63, v0
v_add_u32 v2, 64, v1
v_min_u32 v1, s16, v1
v_min_u32 v2, s16, v2
v_lshlrev_b32 v1, 7, v1
v_lshlrev_b32 v2, 7, v2
s_waitcnt lgkmcnt(0)
buffer_load_dword v3, v1, s[20:23], s17 offen
buffer_load_dword v4, v2, s[20:23], s17 offen
v_subrev_u32 v1, 64, v0
v_min_u32 v1, 159, v1
v_lshlrev_b32 v1, 7, v1
s_mul_i32 s17, s2, 20480
buffer_load_dword v5, v1, s[24:27], s17 offen
reg_2:
s_barrier
v_mov_b32 v1, 0
ds_read_b32 v2, v1
s_waitcnt lgkmcnt(0)
v_readfirstlane_b32 s14, v2
s_barrier
s_cmp_ge_u32 s14, 256
s_cbranch_scc1 L_end
s_cmp_lt_u32 s14, 32
s_cbranch_scc1 L_chain
s_sub_u32 s15, s14, 32
v_and_b32 v0, 63, v0
v_lshlrev_b32 v0, 4, v0
s_mov_b32 s24, 0x3f803f80
s_mul_i32 s31, s13, 10240
s_lshl_b32 s37, s13, 10
s_mov_b32 s22, s6
s_mov_b32 s23, 0
s_mov_b32 s16, 0
s_lshr_b32 s18, s15, 5
s_lshl_b32 s18, s18, 2
s_lshr_b32 s18, 106180896, s18
s_and_b32 s18, s18, 7
s_lshl_b32 s18, s18, 5
s_and_b32 s15, s15, 31
s_or_b32 s15, s15, s18
s_cmp_ge_u32 s15, 64
s_cbranch_scc1 roleA_12
s_and_b32 s32, s15, 31
s_cmp_ge_u32 s15, 32
s_cbranch_scc1 roleV_11
s_load_dwordx2 s[40:41], s[0:1], 8
s_mov_b32 s42, 1314816
s_mov_b32 s43, 0x20000
s_waitcnt lgkmcnt(0)
s_waitcnt vmcnt(0)
v_bfe_u32 v5, v0, 4, 2
v_lshrrev_b32 v6, 6, v0
v_mul_u32_u24 v7, 642, v5
v_lshl_add_u32 v7, v6, 2, v7
v_lshlrev_b32 v5, 4, v5
v_lshl_add_u32 v5, v6, 14, v5
s_and_b32 s18, s32, 3
s_bfe_u32 s19, s32, 0x20002
s_lshr_b32 s20, s32, 4
s_lshl_b32 s26, s20, 2
s_add_u32 s26, s26, s18
s_lshl_b32 s27, s26, 8
s_lshl_b32 s26, s26, 4
s_add_u32 s26, s26, s19
s_lshl_b32 s26, s26, 2
s_add_u32 s26, s26, s13
s_mul_i32 s26, s26, 2568
s_lshl_b32 s19, s19, 12
s_add_u32 s27, s27, s19
s_lshl_b32 s19, s13, 6
s_add_u32 s27, s27, s19
s_add_u32 s27, s27, 167772160
s_add_u32 s18, s26, 2
buffer_load_dword v32, v7, s[40:43], s18 offen offset:0
buffer_load_dword v36, v7, s[40:43], s18 offen offset:64
buffer_load_dword v40, v7, s[40:43], s18 offen offset:128
buffer_load_dword v44, v7, s[40:43], s18 offen offset:192
buffer_load_dword v48, v7, s[40:43], s18 offen offset:256
buffer_load_dword v52, v7, s[40:43], s18 offen offset:320
buffer_load_dword v56, v7, s[40:43], s18 offen offset:384
buffer_load_dword v60, v7, s[40:43], s18 offen offset:448
buffer_load_dword v64, v7, s[40:43], s18 offen offset:512
buffer_load_dword v68, v7, s[40:43], s18 offen offset:576
s_add_u32 s18, s26, 41090
buffer_load_dword v33, v7, s[40:43], s18 offen offset:0
buffer_load_dword v37, v7, s[40:43], s18 offen offset:64
buffer_load_dword v41, v7, s[40:43], s18 offen offset:128
buffer_load_dword v45, v7, s[40:43], s18 offen offset:192
buffer_load_dword v49, v7, s[40:43], s18 offen offset:256
buffer_load_dword v53, v7, s[40:43], s18 offen offset:320
buffer_load_dword v57, v7, s[40:43], s18 offen offset:384
buffer_load_dword v61, v7, s[40:43], s18 offen offset:448
buffer_load_dword v65, v7, s[40:43], s18 offen offset:512
buffer_load_dword v69, v7, s[40:43], s18 offen offset:576
s_add_u32 s18, s26, 82178
buffer_load_dword v34, v7, s[40:43], s18 offen offset:0
buffer_load_dword v38, v7, s[40:43], s18 offen offset:64
buffer_load_dword v42, v7, s[40:43], s18 offen offset:128
buffer_load_dword v46, v7, s[40:43], s18 offen offset:192
buffer_load_dword v50, v7, s[40:43], s18 offen offset:256
buffer_load_dword v54, v7, s[40:43], s18 offen offset:320
buffer_load_dword v58, v7, s[40:43], s18 offen offset:384
buffer_load_dword v62, v7, s[40:43], s18 offen offset:448
buffer_load_dword v66, v7, s[40:43], s18 offen offset:512
buffer_load_dword v70, v7, s[40:43], s18 offen offset:576
s_add_u32 s18, s26, 123266
buffer_load_dword v35, v7, s[40:43], s18 offen offset:0
buffer_load_dword v39, v7, s[40:43], s18 offen offset:64
buffer_load_dword v43, v7, s[40:43], s18 offen offset:128
buffer_load_dword v47, v7, s[40:43], s18 offen offset:192
buffer_load_dword v51, v7, s[40:43], s18 offen offset:256
buffer_load_dword v55, v7, s[40:43], s18 offen offset:320
buffer_load_dword v59, v7, s[40:43], s18 offen offset:384
buffer_load_dword v63, v7, s[40:43], s18 offen offset:448
buffer_load_dword v67, v7, s[40:43], s18 offen offset:512
buffer_load_dword v71, v7, s[40:43], s18 offen offset:576
s_waitcnt vmcnt(9)
buffer_store_dwordx4 v[32:35], v5, s[4:7], s27 offen sc1
s_add_u32 s27, s27, 262144
s_waitcnt vmcnt(9)
buffer_store_dwordx4 v[36:39], v5, s[4:7], s27 offen sc1
s_add_u32 s27, s27, 262144
s_waitcnt vmcnt(9)
buffer_store_dwordx4 v[40:43], v5, s[4:7], s27 offen sc1
s_add_u32 s27, s27, 262144
s_waitcnt vmcnt(9)
buffer_store_dwordx4 v[44:47], v5, s[4:7], s27 offen sc1
s_add_u32 s27, s27, 262144
s_waitcnt vmcnt(9)
buffer_store_dwordx4 v[48:51], v5, s[4:7], s27 offen sc1
s_add_u32 s27, s27, 262144
s_waitcnt vmcnt(9)
buffer_store_dwordx4 v[52:55], v5, s[4:7], s27 offen sc1
s_add_u32 s27, s27, 262144
s_waitcnt vmcnt(9)
buffer_store_dwordx4 v[56:59], v5, s[4:7], s27 offen sc1
s_add_u32 s27, s27, 262144
s_waitcnt vmcnt(9)
buffer_store_dwordx4 v[60:63], v5, s[4:7], s27 offen sc1
s_add_u32 s27, s27, 262144
s_waitcnt vmcnt(9)
buffer_store_dwordx4 v[64:67], v5, s[4:7], s27 offen sc1
s_add_u32 s27, s27, 262144
s_waitcnt vmcnt(9)
buffer_store_dwordx4 v[68:71], v5, s[4:7], s27 offen sc1
s_add_u32 s27, s27, 262144
s_lshl_b32 s18, s15, 7
s_add_u32 s18, s18, 11563008
s_cmp_eq_u32 s13, 0
s_cselect_b32 s22, s18, s6
s_mov_b32 s23, 1
s_waitcnt vmcnt(0)
s_barrier
v_mov_b32 v3, s23
s_mov_b64 exec, 1
buffer_store_dword v3, off, s[4:7], s22 sc1
s_mov_b64 exec, -1
s_mov_b32 s22, s6
s_lshl_b32 s26, s32, 8
s_lshl_b32 s18, s13, 6
s_add_u32 s26, s26, s18
s_load_dwordx2 s[40:41], s[0:1], 48
s_mov_b32 s42, 5242880
s_mov_b32 s43, 0x20000
s_waitcnt lgkmcnt(0)
v_lshrrev_b32 v32, 6, v0
v_mul_u32_u24 v32, 8192, v32
v_and_b32 v33, 48, v0
v_add_u32 v30, v32, v33
v_bfe_u32 v32, v0, 6, 2
v_lshrrev_b32 v33, 9, v0
v_lshl_add_u32 v32, v33, 3, v32
v_lshlrev_b32 v31, 6, v32
v_and_b32 v32, 16, v0
v_add_u32 v31, v31, v32
v_bfe_u32 v32, v0, 5, 1
v_lshl_add_u32 v31, v32, 3, v31
v_bfe_u32 v32, v0, 8, 1
v_lshl_add_u32 v31, v32, 5, v31
s_mul_i32 s18, s13, 36864
v_add_u32 v31, s18, v31
s_barrier
s_add_u32 m0, s18, 0
s_add_u32 s19, s26, 0
buffer_load_dwordx4 v30, s[40:43], s19 offen lds
s_add_u32 m0, s18, 1024
s_add_u32 s19, s26, 131072
buffer_load_dwordx4 v30, s[40:43], s19 offen lds
s_add_u32 m0, s18, 2048
s_add_u32 s19, s26, 262144
buffer_load_dwordx4 v30, s[40:43], s19 offen lds
s_add_u32 m0, s18, 3072
s_add_u32 s19, s26, 393216
buffer_load_dwordx4 v30, s[40:43], s19 offen lds
s_add_u32 m0, s18, 4096
s_add_u32 s19, s26, 524288
buffer_load_dwordx4 v30, s[40:43], s19 offen lds
s_add_u32 m0, s18, 5120
s_add_u32 s19, s26, 655360
buffer_load_dwordx4 v30, s[40:43], s19 offen lds
s_add_u32 m0, s18, 6144
s_add_u32 s19, s26, 786432
buffer_load_dwordx4 v30, s[40:43], s19 offen lds
s_add_u32 m0, s18, 7168
s_add_u32 s19, s26, 917504
buffer_load_dwordx4 v30, s[40:43], s19 offen lds
s_add_u32 m0, s18, 8192
s_add_u32 s19, s26, 1048576
buffer_load_dwordx4 v30, s[40:43], s19 offen lds
s_add_u32 m0, s18, 9216
s_add_u32 s19, s26, 1179648
buffer_load_dwordx4 v30, s[40:43], s19 offen lds
s_add_u32 m0, s18, 10240
s_add_u32 s19, s26, 1310720
buffer_load_dwordx4 v30, s[40:43], s19 offen lds
s_add_u32 m0, s18, 11264
s_add_u32 s19, s26, 1441792
buffer_load_dwordx4 v30, s[40:43], s19 offen lds
s_add_u32 m0, s18, 12288
s_add_u32 s19, s26, 1572864
buffer_load_dwordx4 v30, s[40:43], s19 offen lds
s_add_u32 m0, s18, 13312
s_add_u32 s19, s26, 1703936
buffer_load_dwordx4 v30, s[40:43], s19 offen lds
s_add_u32 m0, s18, 14336
s_add_u32 s19, s26, 1835008
buffer_load_dwordx4 v30, s[40:43], s19 offen lds
s_add_u32 m0, s18, 15360
s_add_u32 s19, s26, 1966080
buffer_load_dwordx4 v30, s[40:43], s19 offen lds
s_add_u32 m0, s18, 16384
s_add_u32 s19, s26, 2097152
buffer_load_dwordx4 v30, s[40:43], s19 offen lds
s_add_u32 m0, s18, 17408
s_add_u32 s19, s26, 2228224
buffer_load_dwordx4 v30, s[40:43], s19 offen lds
s_add_u32 m0, s18, 18432
s_add_u32 s19, s26, 2359296
buffer_load_dwordx4 v30, s[40:43], s19 offen lds
s_add_u32 m0, s18, 19456
s_add_u32 s19, s26, 2490368
buffer_load_dwordx4 v30, s[40:43], s19 offen lds
s_add_u32 m0, s18, 20480
s_add_u32 s19, s26, 2621440
buffer_load_dwordx4 v30, s[40:43], s19 offen lds
s_add_u32 m0, s18, 21504
s_add_u32 s19, s26, 2752512
buffer_load_dwordx4 v30, s[40:43], s19 offen lds
s_add_u32 m0, s18, 22528
s_add_u32 s19, s26, 2883584
buffer_load_dwordx4 v30, s[40:43], s19 offen lds
s_add_u32 m0, s18, 23552
s_add_u32 s19, s26, 3014656
buffer_load_dwordx4 v30, s[40:43], s19 offen lds
s_add_u32 m0, s18, 24576
s_add_u32 s19, s26, 3145728
buffer_load_dwordx4 v30, s[40:43], s19 offen lds
s_add_u32 m0, s18, 25600
s_add_u32 s19, s26, 3276800
buffer_load_dwordx4 v30, s[40:43], s19 offen lds
s_add_u32 m0, s18, 26624
s_add_u32 s19, s26, 3407872
buffer_load_dwordx4 v30, s[40:43], s19 offen lds
s_add_u32 m0, s18, 27648
s_add_u32 s19, s26, 3538944
buffer_load_dwordx4 v30, s[40:43], s19 offen lds
s_add_u32 m0, s18, 28672
s_add_u32 s19, s26, 3670016
buffer_load_dwordx4 v30, s[40:43], s19 offen lds
s_add_u32 m0, s18, 29696
s_add_u32 s19, s26, 3801088
buffer_load_dwordx4 v30, s[40:43], s19 offen lds
s_add_u32 m0, s18, 30720
s_add_u32 s19, s26, 3932160
buffer_load_dwordx4 v30, s[40:43], s19 offen lds
s_add_u32 m0, s18, 31744
s_add_u32 s19, s26, 4063232
buffer_load_dwordx4 v30, s[40:43], s19 offen lds
s_add_u32 m0, s18, 32768
s_add_u32 s19, s26, 4194304
buffer_load_dwordx4 v30, s[40:43], s19 offen lds
s_add_u32 m0, s18, 33792
s_add_u32 s19, s26, 4325376
buffer_load_dwordx4 v30, s[40:43], s19 offen lds
s_add_u32 m0, s18, 34816
s_add_u32 s19, s26, 4456448
buffer_load_dwordx4 v30, s[40:43], s19 offen lds
s_add_u32 m0, s18, 35840
s_add_u32 s19, s26, 4587520
buffer_load_dwordx4 v30, s[40:43], s19 offen lds
s_waitcnt vmcnt(32)
ds_read_b64_tr_b16 a[0:1], v31 offset:0
ds_read_b64_tr_b16 a[2:3], v31 offset:256
ds_read_b64_tr_b16 a[4:5], v31 offset:1024
ds_read_b64_tr_b16 a[6:7], v31 offset:1280
ds_read_b64_tr_b16 a[8:9], v31 offset:2048
ds_read_b64_tr_b16 a[10:11], v31 offset:2304
ds_read_b64_tr_b16 a[12:13], v31 offset:3072
ds_read_b64_tr_b16 a[14:15], v31 offset:3328
s_waitcnt lgkmcnt(0)
s_add_u32 m0, s18, 0
s_add_u32 s19, s26, 4718592
buffer_load_dwordx4 v30, s[40:43], s19 offen lds
s_add_u32 m0, s18, 1024
s_add_u32 s19, s26, 4849664
buffer_load_dwordx4 v30, s[40:43], s19 offen lds
s_add_u32 m0, s18, 2048
s_add_u32 s19, s26, 4980736
buffer_load_dwordx4 v30, s[40:43], s19 offen lds
s_add_u32 m0, s18, 3072
s_add_u32 s19, s26, 5111808
buffer_load_dwordx4 v30, s[40:43], s19 offen lds
s_waitcnt vmcnt(32)
ds_read_b64_tr_b16 a[16:17], v31 offset:4096
ds_read_b64_tr_b16 a[18:19], v31 offset:4352
ds_read_b64_tr_b16 a[20:21], v31 offset:5120
ds_read_b64_tr_b16 a[22:23], v31 offset:5376
ds_read_b64_tr_b16 a[24:25], v31 offset:6144
ds_read_b64_tr_b16 a[26:27], v31 offset:6400
ds_read_b64_tr_b16 a[28:29], v31 offset:7168
ds_read_b64_tr_b16 a[30:31], v31 offset:7424
s_waitcnt vmcnt(28)
ds_read_b64_tr_b16 a[32:33], v31 offset:8192
ds_read_b64_tr_b16 a[34:35], v31 offset:8448
ds_read_b64_tr_b16 a[36:37], v31 offset:9216
ds_read_b64_tr_b16 a[38:39], v31 offset:9472
ds_read_b64_tr_b16 a[40:41], v31 offset:10240
ds_read_b64_tr_b16 a[42:43], v31 offset:10496
ds_read_b64_tr_b16 a[44:45], v31 offset:11264
ds_read_b64_tr_b16 a[46:47], v31 offset:11520
s_waitcnt vmcnt(24)
ds_read_b64_tr_b16 a[48:49], v31 offset:12288
ds_read_b64_tr_b16 a[50:51], v31 offset:12544
ds_read_b64_tr_b16 a[52:53], v31 offset:13312
ds_read_b64_tr_b16 a[54:55], v31 offset:13568
ds_read_b64_tr_b16 a[56:57], v31 offset:14336
ds_read_b64_tr_b16 a[58:59], v31 offset:14592
ds_read_b64_tr_b16 a[60:61], v31 offset:15360
ds_read_b64_tr_b16 a[62:63], v31 offset:15616
s_waitcnt vmcnt(20)
ds_read_b64_tr_b16 a[64:65], v31 offset:16384
ds_read_b64_tr_b16 a[66:67], v31 offset:16640
ds_read_b64_tr_b16 a[68:69], v31 offset:17408
ds_read_b64_tr_b16 a[70:71], v31 offset:17664
ds_read_b64_tr_b16 a[72:73], v31 offset:18432
ds_read_b64_tr_b16 a[74:75], v31 offset:18688
ds_read_b64_tr_b16 a[76:77], v31 offset:19456
ds_read_b64_tr_b16 a[78:79], v31 offset:19712
s_waitcnt vmcnt(16)
ds_read_b64_tr_b16 a[80:81], v31 offset:20480
ds_read_b64_tr_b16 a[82:83], v31 offset:20736
ds_read_b64_tr_b16 a[84:85], v31 offset:21504
ds_read_b64_tr_b16 a[86:87], v31 offset:21760
ds_read_b64_tr_b16 a[88:89], v31 offset:22528
ds_read_b64_tr_b16 a[90:91], v31 offset:22784
ds_read_b64_tr_b16 a[92:93], v31 offset:23552
ds_read_b64_tr_b16 a[94:95], v31 offset:23808
s_waitcnt vmcnt(12)
ds_read_b64_tr_b16 a[96:97], v31 offset:24576
ds_read_b64_tr_b16 a[98:99], v31 offset:24832
ds_read_b64_tr_b16 a[100:101], v31 offset:25600
ds_read_b64_tr_b16 a[102:103], v31 offset:25856
ds_read_b64_tr_b16 a[104:105], v31 offset:26624
ds_read_b64_tr_b16 a[106:107], v31 offset:26880
ds_read_b64_tr_b16 a[108:109], v31 offset:27648
ds_read_b64_tr_b16 a[110:111], v31 offset:27904
s_waitcnt vmcnt(8)
ds_read_b64_tr_b16 a[112:113], v31 offset:28672
ds_read_b64_tr_b16 a[114:115], v31 offset:28928
ds_read_b64_tr_b16 a[116:117], v31 offset:29696
ds_read_b64_tr_b16 a[118:119], v31 offset:29952
ds_read_b64_tr_b16 a[120:121], v31 offset:30720
ds_read_b64_tr_b16 a[122:123], v31 offset:30976
ds_read_b64_tr_b16 a[124:125], v31 offset:31744
ds_read_b64_tr_b16 a[126:127], v31 offset:32000
s_waitcnt vmcnt(4)
ds_read_b64_tr_b16 a[128:129], v31 offset:32768
ds_read_b64_tr_b16 a[130:131], v31 offset:33024
ds_read_b64_tr_b16 a[132:133], v31 offset:33792
ds_read_b64_tr_b16 a[134:135], v31 offset:34048
ds_read_b64_tr_b16 a[136:137], v31 offset:34816
ds_read_b64_tr_b16 a[138:139], v31 offset:35072
ds_read_b64_tr_b16 a[140:141], v31 offset:35840
ds_read_b64_tr_b16 a[142:143], v31 offset:36096
s_waitcnt vmcnt(0)
ds_read_b64_tr_b16 a[144:145], v31 offset:0
ds_read_b64_tr_b16 a[146:147], v31 offset:256
ds_read_b64_tr_b16 a[148:149], v31 offset:1024
ds_read_b64_tr_b16 a[150:151], v31 offset:1280
ds_read_b64_tr_b16 a[152:153], v31 offset:2048
ds_read_b64_tr_b16 a[154:155], v31 offset:2304
ds_read_b64_tr_b16 a[156:157], v31 offset:3072
ds_read_b64_tr_b16 a[158:159], v31 offset:3328
s_waitcnt lgkmcnt(0)
s_barrier
s_load_dwordx2 s[40:41], s[0:1], 40
s_mov_b32 s42, 5242880
s_mov_b32 s43, 0x20000
s_waitcnt lgkmcnt(0)
v_lshrrev_b32 v5, 5, v0
v_lshlrev_b32 v5, 13, v5
v_bfe_u32 v6, v0, 4, 1
v_lshl_add_u32 v5, v6, 7, v5
s_lshl_b32 s18, s32, 8
s_mul_i32 s19, s13, 1310720
s_add_u32 s18, s18, s19
buffer_load_dword v24, v5, s[40:43], s18 offen
s_add_u32 s18, s18, 262144
buffer_load_dword v25, v5, s[40:43], s18 offen
s_add_u32 s18, s18, 262144
buffer_load_dword v26, v5, s[40:43], s18 offen
s_add_u32 s18, s18, 262144
buffer_load_dword v27, v5, s[40:43], s18 offen
s_add_u32 s18, s18, 262144
buffer_load_dword v28, v5, s[40:43], s18 offen
s_add_u32 s18, s18, 262144
v_mov_b32 v32, s24
v_mov_b32 v33, s24
v_mov_b32 v34, s24
v_mov_b32 v35, s24
s_nop 1
v_mfma_f32_32x32x16_bf16 v[36:51], a[0:3], v[32:35], 0
v_mfma_f32_32x32x16_bf16 v[36:51], a[4:7], v[32:35], v[36:51]
v_mfma_f32_32x32x16_bf16 v[36:51], a[8:11], v[32:35], v[36:51]
v_mfma_f32_32x32x16_bf16 v[36:51], a[12:15], v[32:35], v[36:51]
v_mfma_f32_32x32x16_bf16 v[36:51], a[16:19], v[32:35], v[36:51]
v_mfma_f32_32x32x16_bf16 v[36:51], a[20:23], v[32:35], v[36:51]
v_mfma_f32_32x32x16_bf16 v[36:51], a[24:27], v[32:35], v[36:51]
v_mfma_f32_32x32x16_bf16 v[36:51], a[28:31], v[32:35], v[36:51]
v_mfma_f32_32x32x16_bf16 v[36:51], a[32:35], v[32:35], v[36:51]
v_mfma_f32_32x32x16_bf16 v[36:51], a[36:39], v[32:35], v[36:51]
v_mfma_f32_32x32x16_bf16 v[36:51], a[40:43], v[32:35], v[36:51]
v_mfma_f32_32x32x16_bf16 v[36:51], a[44:47], v[32:35], v[36:51]
v_mfma_f32_32x32x16_bf16 v[36:51], a[48:51], v[32:35], v[36:51]
v_mfma_f32_32x32x16_bf16 v[36:51], a[52:55], v[32:35], v[36:51]
v_mfma_f32_32x32x16_bf16 v[36:51], a[56:59], v[32:35], v[36:51]
v_mfma_f32_32x32x16_bf16 v[36:51], a[60:63], v[32:35], v[36:51]
v_mfma_f32_32x32x16_bf16 v[36:51], a[64:67], v[32:35], v[36:51]
v_mfma_f32_32x32x16_bf16 v[36:51], a[68:71], v[32:35], v[36:51]
v_mfma_f32_32x32x16_bf16 v[36:51], a[72:75], v[32:35], v[36:51]
v_mfma_f32_32x32x16_bf16 v[36:51], a[76:79], v[32:35], v[36:51]
v_mfma_f32_32x32x16_bf16 v[36:51], a[80:83], v[32:35], v[36:51]
v_mfma_f32_32x32x16_bf16 v[36:51], a[84:87], v[32:35], v[36:51]
v_mfma_f32_32x32x16_bf16 v[36:51], a[88:91], v[32:35], v[36:51]
v_mfma_f32_32x32x16_bf16 v[36:51], a[92:95], v[32:35], v[36:51]
v_mfma_f32_32x32x16_bf16 v[36:51], a[96:99], v[32:35], v[36:51]
v_mfma_f32_32x32x16_bf16 v[36:51], a[100:103], v[32:35], v[36:51]
v_mfma_f32_32x32x16_bf16 v[36:51], a[104:107], v[32:35], v[36:51]
v_mfma_f32_32x32x16_bf16 v[36:51], a[108:111], v[32:35], v[36:51]
v_mfma_f32_32x32x16_bf16 v[36:51], a[112:115], v[32:35], v[36:51]
v_mfma_f32_32x32x16_bf16 v[36:51], a[116:119], v[32:35], v[36:51]
v_mfma_f32_32x32x16_bf16 v[36:51], a[120:123], v[32:35], v[36:51]
v_mfma_f32_32x32x16_bf16 v[36:51], a[124:127], v[32:35], v[36:51]
v_mfma_f32_32x32x16_bf16 v[36:51], a[128:131], v[32:35], v[36:51]
v_mfma_f32_32x32x16_bf16 v[36:51], a[132:135], v[32:35], v[36:51]
v_mfma_f32_32x32x16_bf16 v[36:51], a[136:139], v[32:35], v[36:51]
v_mfma_f32_32x32x16_bf16 v[36:51], a[140:143], v[32:35], v[36:51]
v_mfma_f32_32x32x16_bf16 v[36:51], a[144:147], v[32:35], v[36:51]
v_mfma_f32_32x32x16_bf16 v[36:51], a[148:151], v[32:35], v[36:51]
v_mfma_f32_32x32x16_bf16 v[36:51], a[152:155], v[32:35], v[36:51]
v_mfma_f32_32x32x16_bf16 v[36:51], a[156:159], v[32:35], v[36:51]
s_nop 11
v_mov_b32 v8, v36
v_mov_b32 v9, v37
v_mov_b32 v10, v38
v_mov_b32 v11, v39
v_mov_b32 v12, v40
v_mov_b32 v13, v41
v_mov_b32 v14, v42
v_mov_b32 v15, v43
v_mov_b32 v16, v44
v_mov_b32 v17, v45
v_mov_b32 v18, v46
v_mov_b32 v19, v47
v_mov_b32 v20, v48
v_mov_b32 v21, v49
v_mov_b32 v22, v50
v_mov_b32 v23, v51
v_and_b32 v5, 0x70, v0
s_waitcnt vmcnt(4)
v_lshrrev_b32 v24, 8, v0
v_lshl_add_u32 v5, v24, 7, v5
v_bfe_u32 v24, v0, 7, 1
v_lshl_add_u32 v5, v24, 12, v5
s_lshr_b32 s34, s13, 1
s_lshl_b32 s34, s34, 13
s_and_b32 s18, s13, 1
s_lshl_b32 s18, s18, 10
s_add_u32 s34, s34, s18
s_lshl_b32 s18, s32, 14
s_add_u32 s34, s34, s18
v_bfe_u32 v6, v0, 7, 2
v_mul_u32_u24 v6, 10240, v6
v_bfe_u32 v24, v0, 5, 2
v_lshl_add_u32 v6, v24, 6, v6
v_lshrrev_b32 v24, 9, v0
v_lshl_add_u32 v6, v24, 5, v6
v_and_b32 v24, 16, v0
v_add_u32 v6, v24, v6
s_lshl_b32 s51, s32, 8
s_add_u32 s51, s51, 11534336
s_mul_i32 s52, s13, 2560
s_add_u32 s52, s52, 12582912
s_add_u32 s50, s34, 110100480
s_mov_b32 s39, 0
kvlay_13:
s_mul_i32 s26, s16, 6291456
s_add_u32 s26, s26, 88080384
s_add_u32 s26, s26, s31
s_mul_i32 s54, s16, 327680
s_add_u32 s54, s54, 163577856
s_mul_i32 s27, s16, 35651584
s_add_u32 s27, s27, 16777216
s_mul_i32 s18, s32, 0
s_add_u32 s27, s27, s18
s_add_u32 s27, s27, s34
s_lshl_b32 s29, s16, 1
s_add_u32 s29, s29, 1
s_mov_b32 s28, 0
s_mov_b32 s30, 0
s_cmp_lt_u32 s30, 64
s_cselect_b32 s53, s26, s6
s_cselect_b32 s36, s54, s6
s_mov_b32 s38, 1024
v_mov_b32 v7, v0
s_add_u32 s26, s26, 40960
s_add_u32 s54, s54, 5120
s_add_u32 s30, s30, 1
v_xor_b32 v1, 40960, v0
s_mov_b32 s25, s31
s_mov_b32 s35, 131072
s_cmp_lg_u32 s13, 0
s_cbranch_scc1 polld_22
v_lshlrev_b32 v3, 3, v0
s_waitcnt vmcnt(0)
v_min_u32 v28, 1152, v3
s_mov_b32 s21, 11612160
s_mov_b32 s17, 0
poll_21:
buffer_load_dword v24, v28, s[4:7], s21 offen sc1
s_add_u32 s17, s17, 1
s_cmp_gt_u32 s17, 262144
s_cbranch_scc1 L_fail
s_waitcnt vmcnt(0)
v_cmp_gt_u32 vcc, s29, v24
s_cbranch_vccz polld_22
s_sleep 2
s_branch poll_21
polld_22:
s_barrier
s_add_u32 m0, s25, 2048
s_mov_b32 s20, s53
buffer_load_dwordx4 v7, s[4:7], s20 offen sc1 lds
s_add_u32 m0, s25, 3072
s_add_u32 s20, s20, s38
buffer_load_dwordx4 v7, s[4:7], s20 offen sc1 lds
s_add_u32 m0, s25, 4096
s_add_u32 s20, s20, s38
buffer_load_dwordx4 v7, s[4:7], s20 offen sc1 lds
s_add_u32 m0, s25, 5120
s_add_u32 s20, s20, s38
buffer_load_dwordx4 v7, s[4:7], s20 offen sc1 lds
s_add_u32 m0, s25, 6144
s_add_u32 s20, s20, s38
buffer_load_dwordx4 v7, s[4:7], s20 offen sc1 lds
s_add_u32 m0, s25, 7168
s_add_u32 s20, s20, s38
buffer_load_dwordx4 v7, s[4:7], s20 offen sc1 lds
s_add_u32 m0, s25, 8192
s_add_u32 s20, s20, s38
buffer_load_dwordx4 v7, s[4:7], s20 offen sc1 lds
s_add_u32 m0, s25, 9216
s_add_u32 s20, s20, s38
buffer_load_dwordx4 v7, s[4:7], s20 offen sc1 lds
s_add_u32 m0, s25, 10240
s_add_u32 s20, s20, s38
buffer_load_dwordx4 v7, s[4:7], s20 offen sc1 lds
s_add_u32 m0, s25, 11264
s_add_u32 s20, s20, s38
buffer_load_dwordx4 v7, s[4:7], s20 offen sc1 lds
s_add_u32 m0, s35, s37
s_add_u32 s20, s36, s37
buffer_load_dwordx4 v0, s[4:7], s20 offen sc1 lds
s_add_u32 m0, s35, 4096
s_add_u32 s20, s36, 4096
buffer_load_dwordx4 v0, s[4:7], s20 offen sc1 lds
s_waitcnt vmcnt(0)
kvx_14:
v_xor_b32 v1, 40960, v1
s_sub_u32 s25, s25, s31
s_xor_b32 s25, s25, 40960
s_add_u32 s25, s25, s31
s_xor_b32 s35, s35, 8192
s_cmp_eq_u32 s28, 1
s_cbranch_scc1 kv_16
s_cmp_eq_u32 s28, 30
s_cbranch_scc0 kv_17
s_add_u32 s29, s29, 1
kv_16:
s_waitcnt vmcnt(0)
s_barrier
v_mov_b32 v3, s23
s_mov_b64 exec, 1
buffer_store_dword v3, off, s[4:7], s22 sc1
s_mov_b64 exec, -1
s_mov_b32 s22, s6
s_cmp_lg_u32 s13, 0
s_cbranch_scc1 polld_24
v_lshlrev_b32 v3, 3, v0
v_min_u32 v28, 3968, v3
s_mov_b32 s21, 11612160
s_mov_b32 s17, 0
poll_23:
buffer_load_dword v24, v3, s[4:7], s21 offen sc1
s_add_u32 s20, s21, 8192
buffer_load_dword v25, v3, s[4:7], s20 offen sc1
s_add_u32 s20, s21, 16384
buffer_load_dword v26, v28, s[4:7], s20 offen sc1
s_add_u32 s17, s17, 1
s_cmp_gt_u32 s17, 262144
s_cbranch_scc1 L_fail
s_waitcnt vmcnt(1)
v_min_u32 v24, v24, v25
s_waitcnt vmcnt(0)
v_min_u32 v24, v24, v26
v_cmp_gt_u32 vcc, s29, v24
s_cbranch_vccz polld_24
s_sleep 2
s_branch poll_23
polld_24:
s_barrier
kv_17:
s_add_u32 s28, s28, 1
s_and_b32 s33, s28, 3
s_cmp_lt_u32 s28, 12
s_cselect_b32 s33, 1, s33
s_cmp_eq_u32 s33, 0
s_cbranch_scc1 kv_18
s_cmp_lt_u32 s30, 64
s_cselect_b32 s53, s26, s6
s_cselect_b32 s36, s54, s6
s_mov_b32 s38, 1024
v_mov_b32 v7, v0
s_add_u32 s26, s26, 40960
s_add_u32 s54, s54, 5120
s_add_u32 s30, s30, 1
kvn_15:
s_waitcnt vmcnt(3)
s_barrier
s_add_u32 m0, s25, 2048
s_mov_b32 s20, s53
buffer_load_dwordx4 v7, s[4:7], s20 offen sc1 lds
ds_read_b128 v[48:51], v1 offset:2048
ds_read_b128 v[52:55], v1 offset:3072
s_add_u32 m0, s25, 3072
s_add_u32 s20, s20, s38
buffer_load_dwordx4 v7, s[4:7], s20 offen sc1 lds
s_add_u32 m0, s25, 4096
s_add_u32 s20, s20, s38
buffer_load_dwordx4 v7, s[4:7], s20 offen sc1 lds
ds_read_b128 v[56:59], v1 offset:4096
ds_read_b128 v[60:63], v1 offset:5120
s_waitcnt lgkmcnt(3)
v_mfma_f32_32x32x16_bf16 v[32:47], a[0:3], v[48:51], 0
s_xor_b32 s18, s35, 8192
ds_read_b128 v[48:51], v1 offset:6144
v_lshrrev_b32 v2, 2, v0
s_waitcnt lgkmcnt(3)
v_mfma_f32_32x32x16_bf16 v[32:47], a[4:7], v[52:55], v[32:47]
ds_read_b128 v[52:55], v1 offset:7168
v_add_u32 v2, s18, v2
s_waitcnt lgkmcnt(3)
v_mfma_f32_32x32x16_bf16 v[32:47], a[8:11], v[56:59], v[32:47]
ds_read2st64_b32 v[64:65], v2 offset0:0 offset1:1
s_waitcnt lgkmcnt(2)
ds_read2st64_b32 v[66:67], v2 offset0:2 offset1:3
ds_read_b128 v[56:59], v1 offset:8192
v_mfma_f32_32x32x16_bf16 v[32:47], a[12:15], v[60:63], v[32:47]
ds_read_b128 v[60:63], v1 offset:9216
ds_read2st64_b32 v[74:75], v2 offset0:6 offset1:7
s_waitcnt lgkmcnt(5)
v_mfma_f32_32x32x16_bf16 v[32:47], a[16:19], v[48:51], v[32:47]
s_add_u32 m0, s25, 5120
s_add_u32 s20, s20, s38
buffer_load_dwordx4 v7, s[4:7], s20 offen sc1 lds
ds_read2st64_b32 v[72:73], v2 offset0:4 offset1:5
ds_read_b128 v[48:51], v1 offset:10240
ds_read2st64_b32 v[84:85], v2 offset0:16 offset1:17
s_waitcnt lgkmcnt(5)
v_mfma_f32_32x32x16_bf16 v[32:47], a[20:23], v[52:55], v[32:47]
s_waitcnt lgkmcnt(4)
s_add_u32 m0, s25, 6144
s_add_u32 s20, s20, s38
buffer_load_dwordx4 v7, s[4:7], s20 offen sc1 lds
v_mfma_f32_32x32x16_bf16 v[32:47], a[24:27], v[56:59], v[32:47]
ds_read_b128 v[52:55], v1 offset:11264
s_add_u32 m0, s25, 7168
s_add_u32 s20, s20, s38
buffer_load_dwordx4 v7, s[4:7], s20 offen sc1 lds
v_mfma_f32_32x32x16_bf16 v[32:47], a[28:31], v[60:63], v[32:47]
ds_read_b128 v[60:63], v1 offset:13312
s_waitcnt lgkmcnt(2)
ds_read_b128 v[56:59], v1 offset:12288
ds_read2st64_b32 v[80:81], v2 offset0:12 offset1:13
v_add_f32 v65, v65, v67
v_mfma_f32_32x32x16_bf16 v[32:47], a[32:35], v[48:51], v[32:47]
s_waitcnt lgkmcnt(3)
ds_read_b128 v[48:51], v1 offset:14336
ds_read2st64_b32 v[76:77], v2 offset0:8 offset1:9
s_add_u32 m0, s25, 8192
s_add_u32 s20, s20, s38
buffer_load_dwordx4 v7, s[4:7], s20 offen sc1 lds
v_mfma_f32_32x32x16_bf16 v[32:47], a[36:39], v[52:55], v[32:47]
s_add_u32 m0, s25, 9216
s_add_u32 s20, s20, s38
buffer_load_dwordx4 v7, s[4:7], s20 offen sc1 lds
ds_read_b128 v[52:55], v1 offset:15360
s_waitcnt lgkmcnt(4)
v_mfma_f32_32x32x16_bf16 v[32:47], a[40:43], v[56:59], v[32:47]
s_waitcnt lgkmcnt(2)
v_add_f32 v64, v64, v66
v_mov_b32 v3, s23
s_waitcnt lgkmcnt(1)
v_mfma_f32_32x32x16_bf16 v[32:47], a[44:47], v[60:63], v[32:47]
ds_read_b128 v[60:63], v1 offset:17408
ds_read_b128 v[56:59], v1 offset:16384
v_mfma_f32_32x32x16_bf16 v[32:47], a[48:51], v[48:51], v[32:47]
s_waitcnt lgkmcnt(2)
ds_read_b128 v[48:51], v1 offset:18432
ds_read2st64_b32 v[86:87], v2 offset0:18 offset1:19
v_mfma_f32_32x32x16_bf16 v[32:47], a[52:55], v[52:55], v[32:47]
ds_read2st64_b32 v[78:79], v2 offset0:10 offset1:11
s_waitcnt lgkmcnt(3)
v_mfma_f32_32x32x16_bf16 v[32:47], a[56:59], v[56:59], v[32:47]
s_waitcnt lgkmcnt(2)
ds_read_b128 v[52:55], v1 offset:19456
ds_read2st64_b32 v[82:83], v2 offset0:14 offset1:15
s_add_u32 m0, s25, 10240
s_add_u32 s20, s20, s38
buffer_load_dwordx4 v7, s[4:7], s20 offen sc1 lds
v_mfma_f32_32x32x16_bf16 v[32:47], a[60:63], v[60:63], v[32:47]
ds_read_b128 v[56:59], v1 offset:20480
s_waitcnt lgkmcnt(3)
ds_read_b128 v[60:63], v1 offset:21504
v_add_f32 v65, v65, v73
v_mfma_f32_32x32x16_bf16 v[32:47], a[64:67], v[48:51], v[32:47]
v_add_f32 v64, v64, v72
s_waitcnt lgkmcnt(3)
v_add_f32 v64, v64, v74
v_add_f32 v65, v65, v75
s_waitcnt lgkmcnt(2)
v_mfma_f32_32x32x16_bf16 v[32:47], a[68:71], v[52:55], v[32:47]
ds_read_b128 v[52:55], v1 offset:23552
ds_read_b128 v[48:51], v1 offset:22528
s_waitcnt lgkmcnt(3)
v_add_f32 v65, v65, v77
v_add_f32 v64, v64, v76
v_mfma_f32_32x32x16_bf16 v[32:47], a[72:75], v[56:59], v[32:47]
v_add_f32 v64, v64, v78
ds_read_b128 v[56:59], v1 offset:24576
s_waitcnt lgkmcnt(3)
v_mfma_f32_32x32x16_bf16 v[32:47], a[76:79], v[60:63], v[32:47]
ds_read_b128 v[60:63], v1 offset:25600
s_waitcnt lgkmcnt(3)
v_add_f32 v64, v64, v80
s_waitcnt lgkmcnt(2)
v_mfma_f32_32x32x16_bf16 v[32:47], a[80:83], v[48:51], v[32:47]
ds_read_b128 v[48:51], v1 offset:26624
s_add_u32 m0, s25, 11264
s_add_u32 s20, s20, s38
buffer_load_dwordx4 v7, s[4:7], s20 offen sc1 lds
v_mfma_f32_32x32x16_bf16 v[32:47], a[84:87], v[52:55], v[32:47]
s_waitcnt lgkmcnt(2)
ds_read_b128 v[52:55], v1 offset:27648
v_add_f32 v65, v65, v79
s_waitcnt lgkmcnt(2)
v_mfma_f32_32x32x16_bf16 v[32:47], a[88:91], v[56:59], v[32:47]
s_waitcnt lgkmcnt(1)
s_add_u32 m0, s35, s37
s_add_u32 s20, s36, s37
buffer_load_dwordx4 v0, s[4:7], s20 offen sc1 lds
v_mfma_f32_32x32x16_bf16 v[32:47], a[92:95], v[60:63], v[32:47]
ds_read_b128 v[56:59], v1 offset:28672
ds_read_b128 v[60:63], v1 offset:29696
s_waitcnt lgkmcnt(2)
v_add_f32 v64, v64, v82
v_add_f32 v65, v65, v81
v_mfma_f32_32x32x16_bf16 v[32:47], a[96:99], v[48:51], v[32:47]
s_add_u32 m0, s35, 4096
s_add_u32 s20, s36, 4096
buffer_load_dwordx4 v0, s[4:7], s20 offen sc1 lds
v_mfma_f32_32x32x16_bf16 v[32:47], a[100:103], v[52:55], v[32:47]
ds_read_b128 v[48:51], v1 offset:30720
s_waitcnt lgkmcnt(2)
ds_read_b128 v[52:55], v1 offset:31744
v_mfma_f32_32x32x16_bf16 v[32:47], a[104:107], v[56:59], v[32:47]
ds_read_b128 v[56:59], v1 offset:32768
v_add_f32 v65, v65, v83
s_waitcnt lgkmcnt(3)
v_add_f32 v64, v64, v84
v_add_f32 v65, v65, v85
v_mfma_f32_32x32x16_bf16 v[32:47], a[108:111], v[60:63], v[32:47]
s_waitcnt lgkmcnt(2)
v_add_f32 v65, v65, v87
s_waitcnt lgkmcnt(1)
v_add_f32 v64, v64, v86
v_mfma_f32_32x32x16_bf16 v[32:47], a[112:115], v[48:51], v[32:47]
s_waitcnt lgkmcnt(0)
ds_read_b128 v[48:51], v1 offset:34816
ds_read_b128 v[60:63], v1 offset:33792
v_add_f32 v64, v64, v65
v_mov_b32 v68, v64
v_mfma_f32_32x32x16_bf16 v[32:47], a[116:119], v[52:55], v[32:47]
s_waitcnt vmcnt(12)
s_barrier
s_mov_b64 exec, 1
buffer_store_dword v3, off, s[4:7], s22 sc1
s_mov_b64 exec, -1
v_mfma_f32_32x32x16_bf16 v[32:47], a[120:123], v[56:59], v[32:47]
ds_read_b128 v[52:55], v1 offset:35840
ds_read_b128 v[56:59], v1 offset:36864
s_waitcnt lgkmcnt(2)
v_mfma_f32_32x32x16_bf16 v[32:47], a[124:127], v[60:63], v[32:47]
ds_read_b128 v[60:63], v1 offset:37888
v_permlane32_swap_b32 v64, v68
v_mul_f32 v68, 0x3acccccd, v68
v_mul_f32 v64, 0x3acccccd, v64
v_mfma_f32_32x32x16_bf16 v[32:47], a[128:131], v[48:51], v[32:47]
s_waitcnt lgkmcnt(2)
v_mfma_f32_32x32x16_bf16 v[32:47], a[132:135], v[52:55], v[32:47]
s_waitcnt lgkmcnt(0)
ds_read_b128 v[48:51], v1 offset:38912
v_fma_f32 v68, -v64, v64, v68
v_max_f32 v68, 0, v68
v_add_f32 v68, 0x3727c5ac, v68
v_mfma_f32_32x32x16_bf16 v[32:47], a[136:139], v[56:59], v[32:47]
ds_read_b128 v[52:55], v1 offset:39936
v_rsq_f32 v68, v68
s_nop 0
v_mul_f32 v64, v68, v64
v_mfma_f32_32x32x16_bf16 v[32:47], a[140:143], v[60:63], v[32:47]
ds_read_b128 v[56:59], v1 offset:40960
s_waitcnt lgkmcnt(2)
v_mfma_f32_32x32x16_bf16 v[32:47], a[144:147], v[48:51], v[32:47]
ds_read_b128 v[60:63], v1 offset:41984
v_mul_f32 v78, v64, v14
v_mul_f32 v85, v64, v21
s_waitcnt lgkmcnt(2)
v_mul_f32 v75, v64, v11
v_mul_f32 v79, v64, v15
v_mfma_f32_32x32x16_bf16 v[32:47], a[148:151], v[52:55], v[32:47]
v_mul_f32 v84, v64, v20
s_waitcnt lgkmcnt(1)
v_mul_f32 v73, v64, v9
v_mul_f32 v72, v64, v8
v_mul_f32 v82, v64, v18
v_mul_f32 v87, v64, v23
v_mfma_f32_32x32x16_bf16 v[32:47], a[152:155], v[56:59], v[32:47]
s_waitcnt lgkmcnt(0)
v_mul_f32 v83, v64, v19
v_mul_f32 v74, v64, v10
v_mul_f32 v81, v64, v17
v_mul_f32 v86, v64, v22
v_mfma_f32_32x32x16_bf16 v[32:47], a[156:159], v[60:63], v[32:47]
s_nop 0
v_mul_f32 v80, v64, v16
v_mul_f32 v76, v64, v12
v_mul_f32 v77, v64, v13
s_nop 7
v_pk_fma_f32 v[40:41], v[40:41], v[68:69], v[80:81] op_sel_hi:[1,0,1] neg_lo:[0,0,1] neg_hi:[0,0,1]
v_pk_fma_f32 v[32:33], v[32:33], v[68:69], v[72:73] op_sel_hi:[1,0,1] neg_lo:[0,0,1] neg_hi:[0,0,1]
v_pk_fma_f32 v[34:35], v[34:35], v[68:69], v[74:75] op_sel_hi:[1,0,1] neg_lo:[0,0,1] neg_hi:[0,0,1]
v_pk_fma_f32 v[42:43], v[42:43], v[68:69], v[82:83] op_sel_hi:[1,0,1] neg_lo:[0,0,1] neg_hi:[0,0,1]
v_cvt_pk_bf16_f32 v48, v32, v33
v_cvt_pk_bf16_f32 v49, v34, v35
v_pk_fma_f32 v[44:45], v[44:45], v[68:69], v[84:85] op_sel_hi:[1,0,1] neg_lo:[0,0,1] neg_hi:[0,0,1]
v_pk_fma_f32 v[46:47], v[46:47], v[68:69], v[86:87] op_sel_hi:[1,0,1] neg_lo:[0,0,1] neg_hi:[0,0,1]
v_pk_fma_f32 v[36:37], v[36:37], v[68:69], v[76:77] op_sel_hi:[1,0,1] neg_lo:[0,0,1] neg_hi:[0,0,1]
v_cvt_pk_bf16_f32 v50, v36, v37
v_cvt_pk_bf16_f32 v52, v40, v41
v_cvt_pk_bf16_f32 v54, v44, v45
v_pk_fma_f32 v[38:39], v[38:39], v[68:69], v[78:79] op_sel_hi:[1,0,1] neg_lo:[0,0,1] neg_hi:[0,0,1]
v_cvt_pk_bf16_f32 v51, v38, v39
v_cvt_pk_bf16_f32 v53, v42, v43
v_cvt_pk_bf16_f32 v55, v46, v47
buffer_store_dwordx4 v[48:51], v5, s[4:7], s27 offen offset:0 sc1
buffer_store_dwordx4 v[52:55], v5, s[4:7], s27 offen offset:512 sc1
s_lshl_b32 s18, s16, 6
s_add_u32 s18, s18, s28
s_add_u32 s27, s27, 524288
s_cmp_eq_u32 s13, 0
s_cselect_b32 s22, s51, s6
s_mov_b32 s23, s18
s_cmp_lg_u32 s33, 0
s_cbranch_scc1 kvx_14
kvm_19:
v_xor_b32 v1, 40960, v1
s_sub_u32 s25, s25, s31
s_xor_b32 s25, s25, 40960
s_add_u32 s25, s25, s31
s_xor_b32 s35, s35, 8192
s_cmp_lt_u32 s30, 64
s_cselect_b32 s53, s26, s6
s_cselect_b32 s36, s54, s6
s_mov_b32 s38, 1024
v_mov_b32 v7, v0
s_add_u32 s26, s26, 40960
s_add_u32 s54, s54, 5120
s_add_u32 s30, s30, 1
s_waitcnt vmcnt(3)
s_barrier
ds_read_b128 v[48:51], v1 offset:2048
s_add_u32 m0, s25, 2048
s_mov_b32 s20, s53
buffer_load_dwordx4 v7, s[4:7], s20 offen sc1 lds
ds_read_b128 v[52:55], v1 offset:3072
ds_read_b128 v[56:59], v1 offset:4096
s_add_u32 m0, s25, 3072
s_add_u32 s20, s20, s38
buffer_load_dwordx4 v7, s[4:7], s20 offen sc1 lds
s_waitcnt lgkmcnt(2)
v_mfma_f32_32x32x16_bf16 v[32:47], a[0:3], v[48:51], 0
ds_read_b128 v[60:63], v1 offset:5120
s_waitcnt lgkmcnt(2)
s_add_u32 m0, s25, 4096
s_add_u32 s20, s20, s38
buffer_load_dwordx4 v7, s[4:7], s20 offen sc1 lds
s_waitcnt lgkmcnt(1)
v_mfma_f32_32x32x16_bf16 v[32:47], a[4:7], v[52:55], v[32:47]
s_add_u32 m0, s25, 5120
s_add_u32 s20, s20, s38
buffer_load_dwordx4 v7, s[4:7], s20 offen sc1 lds
ds_read_b128 v[48:51], v1 offset:6144
ds_read_b128 v[52:55], v1 offset:7168
v_mfma_f32_32x32x16_bf16 v[32:47], a[8:11], v[56:59], v[32:47]
ds_read_b128 v[56:59], v1 offset:8192
s_waitcnt lgkmcnt(3)
v_mfma_f32_32x32x16_bf16 v[32:47], a[12:15], v[60:63], v[32:47]
s_waitcnt lgkmcnt(2)
v_mfma_f32_32x32x16_bf16 v[32:47], a[16:19], v[48:51], v[32:47]
ds_read_b128 v[60:63], v1 offset:9216
ds_read_b128 v[48:51], v1 offset:10240
s_waitcnt lgkmcnt(2)
v_mfma_f32_32x32x16_bf16 v[32:47], a[20:23], v[52:55], v[32:47]
v_mfma_f32_32x32x16_bf16 v[32:47], a[24:27], v[56:59], v[32:47]
ds_read_b128 v[56:59], v1 offset:12288
s_waitcnt lgkmcnt(2)
ds_read_b128 v[52:55], v1 offset:11264
v_mfma_f32_32x32x16_bf16 v[32:47], a[28:31], v[60:63], v[32:47]
s_waitcnt lgkmcnt(2)
s_add_u32 m0, s25, 6144
s_add_u32 s20, s20, s38
buffer_load_dwordx4 v7, s[4:7], s20 offen sc1 lds
ds_read_b128 v[60:63], v1 offset:13312
v_mfma_f32_32x32x16_bf16 v[32:47], a[32:35], v[48:51], v[32:47]
s_waitcnt lgkmcnt(2)
s_add_u32 m0, s25, 7168
s_add_u32 s20, s20, s38
buffer_load_dwordx4 v7, s[4:7], s20 offen sc1 lds
s_waitcnt lgkmcnt(1)
v_mfma_f32_32x32x16_bf16 v[32:47], a[36:39], v[52:55], v[32:47]
ds_read_b128 v[48:51], v1 offset:14336
s_add_u32 m0, s25, 8192
s_add_u32 s20, s20, s38
buffer_load_dwordx4 v7, s[4:7], s20 offen sc1 lds
s_waitcnt lgkmcnt(1)
ds_read_b128 v[52:55], v1 offset:15360
v_mfma_f32_32x32x16_bf16 v[32:47], a[40:43], v[56:59], v[32:47]
ds_read_b128 v[56:59], v1 offset:16384
v_mfma_f32_32x32x16_bf16 v[32:47], a[44:47], v[60:63], v[32:47]
s_waitcnt lgkmcnt(2)
ds_read_b128 v[60:63], v1 offset:17408
v_mfma_f32_32x32x16_bf16 v[32:47], a[48:51], v[48:51], v[32:47]
ds_read_b128 v[48:51], v1 offset:18432
s_waitcnt lgkmcnt(2)
v_mfma_f32_32x32x16_bf16 v[32:47], a[52:55], v[52:55], v[32:47]
ds_read_b128 v[52:55], v1 offset:19456
s_add_u32 m0, s25, 9216
s_add_u32 s20, s20, s38
buffer_load_dwordx4 v7, s[4:7], s20 offen sc1 lds
s_waitcnt lgkmcnt(2)
v_mfma_f32_32x32x16_bf16 v[32:47], a[56:59], v[56:59], v[32:47]
v_mfma_f32_32x32x16_bf16 v[32:47], a[60:63], v[60:63], v[32:47]
ds_read_b128 v[60:63], v1 offset:21504
ds_read_b128 v[56:59], v1 offset:20480
s_waitcnt lgkmcnt(3)
v_mov_b32 v3, s23
v_mfma_f32_32x32x16_bf16 v[32:47], a[64:67], v[48:51], v[32:47]
s_waitcnt lgkmcnt(2)
s_add_u32 m0, s25, 10240
s_add_u32 s20, s20, s38
buffer_load_dwordx4 v7, s[4:7], s20 offen sc1 lds
ds_read_b128 v[48:51], v1 offset:22528
v_mfma_f32_32x32x16_bf16 v[32:47], a[68:71], v[52:55], v[32:47]
ds_read_b128 v[52:55], v1 offset:23552
s_waitcnt lgkmcnt(2)
v_mfma_f32_32x32x16_bf16 v[32:47], a[72:75], v[56:59], v[32:47]
v_mfma_f32_32x32x16_bf16 v[32:47], a[76:79], v[60:63], v[32:47]
s_waitcnt lgkmcnt(0)
ds_read_b128 v[56:59], v1 offset:24576
v_mfma_f32_32x32x16_bf16 v[32:47], a[80:83], v[48:51], v[32:47]
ds_read_b128 v[60:63], v1 offset:25600
s_add_u32 m0, s25, 11264
s_add_u32 s20, s20, s38
buffer_load_dwordx4 v7, s[4:7], s20 offen sc1 lds
v_mfma_f32_32x32x16_bf16 v[32:47], a[84:87], v[52:55], v[32:47]
ds_read_b128 v[48:51], v1 offset:26624
s_waitcnt lgkmcnt(2)
ds_read_b128 v[52:55], v1 offset:27648
v_mfma_f32_32x32x16_bf16 v[32:47], a[88:91], v[56:59], v[32:47]
s_waitcnt lgkmcnt(2)
ds_read_b128 v[56:59], v1 offset:28672
s_add_u32 m0, s35, s37
s_add_u32 s20, s36, s37
buffer_load_dwordx4 v0, s[4:7], s20 offen sc1 lds
v_mfma_f32_32x32x16_bf16 v[32:47], a[92:95], v[60:63], v[32:47]
ds_read_b128 v[60:63], v1 offset:29696
s_waitcnt lgkmcnt(3)
v_mfma_f32_32x32x16_bf16 v[32:47], a[96:99], v[48:51], v[32:47]
s_waitcnt lgkmcnt(1)
ds_read_b128 v[48:51], v1 offset:30720
s_add_u32 m0, s35, 4096
s_add_u32 s20, s36, 4096
buffer_load_dwordx4 v0, s[4:7], s20 offen sc1 lds
v_mfma_f32_32x32x16_bf16 v[32:47], a[100:103], v[52:55], v[32:47]
ds_read_b128 v[52:55], v1 offset:31744
v_mfma_f32_32x32x16_bf16 v[32:47], a[104:107], v[56:59], v[32:47]
s_waitcnt lgkmcnt(2)
s_waitcnt lgkmcnt(1)
v_mfma_f32_32x32x16_bf16 v[32:47], a[108:111], v[60:63], v[32:47]
ds_read_b128 v[56:59], v1 offset:32768
ds_read_b128 v[60:63], v1 offset:33792
v_mfma_f32_32x32x16_bf16 v[32:47], a[112:115], v[48:51], v[32:47]
ds_read_b128 v[48:51], v1 offset:34816
s_waitcnt lgkmcnt(3)
v_mfma_f32_32x32x16_bf16 v[32:47], a[116:119], v[52:55], v[32:47]
s_waitcnt vmcnt(12)
s_barrier
ds_read_b128 v[52:55], v1 offset:35840
s_waitcnt lgkmcnt(3)
v_mfma_f32_32x32x16_bf16 v[32:47], a[120:123], v[56:59], v[32:47]
s_mov_b64 exec, 1
buffer_store_dword v3, off, s[4:7], s22 sc1
s_mov_b64 exec, -1
s_waitcnt lgkmcnt(1)
v_mfma_f32_32x32x16_bf16 v[32:47], a[124:127], v[60:63], v[32:47]
ds_read_b128 v[56:59], v1 offset:36864
s_waitcnt lgkmcnt(1)
ds_read_b128 v[60:63], v1 offset:37888
v_mfma_f32_32x32x16_bf16 v[32:47], a[128:131], v[48:51], v[32:47]
v_mfma_f32_32x32x16_bf16 v[32:47], a[132:135], v[52:55], v[32:47]
s_waitcnt lgkmcnt(1)
ds_read_b128 v[52:55], v1 offset:39936
ds_read_b128 v[48:51], v1 offset:38912
v_mfma_f32_32x32x16_bf16 v[32:47], a[136:139], v[56:59], v[32:47]
s_waitcnt lgkmcnt(2)
v_mfma_f32_32x32x16_bf16 v[32:47], a[140:143], v[60:63], v[32:47]
ds_read_b128 v[56:59], v1 offset:40960
ds_read_b128 v[60:63], v1 offset:41984
s_waitcnt lgkmcnt(2)
v_mfma_f32_32x32x16_bf16 v[32:47], a[144:147], v[48:51], v[32:47]
v_mfma_f32_32x32x16_bf16 v[32:47], a[148:151], v[52:55], v[32:47]
s_waitcnt lgkmcnt(1)
v_mfma_f32_32x32x16_bf16 v[32:47], a[152:155], v[56:59], v[32:47]
s_waitcnt lgkmcnt(0)
v_mfma_f32_32x32x16_bf16 v[32:47], a[156:159], v[60:63], v[32:47]
s_nop 11
v_cvt_pk_bf16_f32 v49, v34, v35
v_cvt_pk_bf16_f32 v48, v32, v33
v_cvt_pk_bf16_f32 v53, v42, v43
v_cvt_pk_bf16_f32 v51, v38, v39
v_cvt_pk_bf16_f32 v54, v44, v45
v_cvt_pk_bf16_f32 v50, v36, v37
v_cvt_pk_bf16_f32 v52, v40, v41
v_cvt_pk_bf16_f32 v55, v46, v47
buffer_store_dwordx4 v[48:51], v5, s[4:7], s50 offen offset:0 sc1
buffer_store_dwordx4 v[52:55], v5, s[4:7], s50 offen offset:512 sc1
s_add_u32 s39, s39, 1
s_add_u32 s50, s50, 524288
s_add_u32 s18, s51, 8192
s_cmp_eq_u32 s13, 0
s_cselect_b32 s22, s18, s6
s_mov_b32 s23, s39
s_cmp_lt_u32 s28, 64
s_cbranch_scc1 kvx_14
s_and_b32 s18, s39, 15
s_cbranch_scc0 kvt_20
s_waitcnt vmcnt(0)
s_barrier
v_mov_b32 v3, s23
s_mov_b64 exec, 1
buffer_store_dword v3, off, s[4:7], s22 sc1
s_mov_b64 exec, -1
s_mov_b32 s22, s6
s_lshl_b32 s18, s39, 2
s_add_u32 s18, s18, 4
s_cmp_lg_u32 s13, 0
s_cbranch_scc1 polld_26
v_lshlrev_b32 v3, 3, v0
v_min_u32 v28, 1152, v3
s_mov_b32 s21, 11550720
s_mov_b32 s17, 0
poll_25:
buffer_load_dword v24, v28, s[4:7], s21 offen sc1
s_add_u32 s17, s17, 1
s_cmp_gt_u32 s17, 262144
s_cbranch_scc1 L_fail
s_waitcnt vmcnt(0)
v_cmp_gt_u32 vcc, s18, v24
s_cbranch_vccz polld_26
s_sleep 2
s_branch poll_25
polld_26:
s_barrier
s_mov_b32 s53, s52
s_mov_b32 s36, s6
s_mov_b32 s38, 256
v_mov_b32 v7, v6
s_add_u32 s52, s52, 40960
s_add_u32 m0, s25, 2048
s_mov_b32 s20, s53
buffer_load_dwordx4 v7, s[4:7], s20 offen sc1 lds
s_add_u32 m0, s25, 3072
s_add_u32 s20, s20, s38
buffer_load_dwordx4 v7, s[4:7], s20 offen sc1 lds
s_add_u32 m0, s25, 4096
s_add_u32 s20, s20, s38
buffer_load_dwordx4 v7, s[4:7], s20 offen sc1 lds
s_add_u32 m0, s25, 5120
s_add_u32 s20, s20, s38
buffer_load_dwordx4 v7, s[4:7], s20 offen sc1 lds
s_add_u32 m0, s25, 6144
s_add_u32 s20, s20, s38
buffer_load_dwordx4 v7, s[4:7], s20 offen sc1 lds
s_add_u32 m0, s25, 7168
s_add_u32 s20, s20, s38
buffer_load_dwordx4 v7, s[4:7], s20 offen sc1 lds
s_add_u32 m0, s25, 8192
s_add_u32 s20, s20, s38
buffer_load_dwordx4 v7, s[4:7], s20 offen sc1 lds
s_add_u32 m0, s25, 9216
s_add_u32 s20, s20, s38
buffer_load_dwordx4 v7, s[4:7], s20 offen sc1 lds
s_add_u32 m0, s25, 10240
s_add_u32 s20, s20, s38
buffer_load_dwordx4 v7, s[4:7], s20 offen sc1 lds
s_add_u32 m0, s25, 11264
s_add_u32 s20, s20, s38
buffer_load_dwordx4 v7, s[4:7], s20 offen sc1 lds
s_waitcnt vmcnt(0)
s_branch kvm_19
kv_18:
s_lshl_b32 s18, s39, 2
s_add_u32 s18, s18, 4
s_cmp_lg_u32 s13, 0
s_cbranch_scc1 polld_28
v_lshlrev_b32 v3, 3, v0
v_min_u32 v28, 1152, v3
s_mov_b32 s21, 11550720
s_mov_b32 s17, 0
poll_27:
buffer_load_dword v24, v28, s[4:7], s21 offen sc1
s_add_u32 s17, s17, 1
s_cmp_gt_u32 s17, 262144
s_cbranch_scc1 L_fail
s_waitcnt vmcnt(0)
v_cmp_gt_u32 vcc, s18, v24
s_cbranch_vccz polld_28
s_sleep 2
s_branch poll_27
polld_28:
s_barrier
s_mov_b32 s53, s52
s_mov_b32 s36, s6
s_mov_b32 s38, 256
v_mov_b32 v7, v6
s_add_u32 s52, s52, 40960
s_branch kvn_15
kvt_20:
s_waitcnt vmcnt(0)
s_barrier
v_mov_b32 v3, s23
s_mov_b64 exec, 1
buffer_store_dword v3, off, s[4:7], s22 sc1
s_mov_b64 exec, -1
s_mov_b32 s22, s6
s_add_u32 s16, s16, 1
s_cmp_lt_u32 s16, 2
s_cbranch_scc1 kvlay_13
s_endpgm
roleV_11:
s_load_dwordx2 s[40:41], s[0:1], 16
s_mov_b32 s42, 1314816
s_mov_b32 s43, 0x20000
s_waitcnt lgkmcnt(0)
s_waitcnt vmcnt(0)
v_bfe_u32 v6, v0, 4, 2
v_lshrrev_b32 v7, 6, v0
v_mul_u32_u24 v8, 642, v6
v_lshl_add_u32 v8, v7, 2, v8
v_lshlrev_b32 v6, 4, v6
v_lshl_add_u32 v6, v7, 14, v6
s_and_b32 s18, s32, 3
s_bfe_u32 s19, s32, 0x20002
s_lshr_b32 s20, s32, 4
s_lshl_b32 s26, s20, 2
s_add_u32 s26, s26, s18
s_lshl_b32 s27, s26, 8
s_lshl_b32 s26, s26, 4
s_add_u32 s26, s26, s19
s_lshl_b32 s26, s26, 2
s_add_u32 s26, s26, s13
s_mul_i32 s26, s26, 2568
s_lshl_b32 s19, s19, 12
s_add_u32 s27, s27, s19
s_lshl_b32 s19, s13, 6
s_add_u32 s27, s27, s19
s_add_u32 s27, s27, 167774208
s_add_u32 s18, s26, 2
buffer_load_dword v20, v8, s[40:43], s18 offen offset:0
buffer_load_dword v24, v8, s[40:43], s18 offen offset:64
buffer_load_dword v28, v8, s[40:43], s18 offen offset:128
buffer_load_dword v32, v8, s[40:43], s18 offen offset:192
buffer_load_dword v36, v8, s[40:43], s18 offen offset:256
buffer_load_dword v40, v8, s[40:43], s18 offen offset:320
buffer_load_dword v44, v8, s[40:43], s18 offen offset:384
buffer_load_dword v48, v8, s[40:43], s18 offen offset:448
buffer_load_dword v52, v8, s[40:43], s18 offen offset:512
buffer_load_dword v56, v8, s[40:43], s18 offen offset:576
s_add_u32 s18, s26, 41090
buffer_load_dword v21, v8, s[40:43], s18 offen offset:0
buffer_load_dword v25, v8, s[40:43], s18 offen offset:64
buffer_load_dword v29, v8, s[40:43], s18 offen offset:128
buffer_load_dword v33, v8, s[40:43], s18 offen offset:192
buffer_load_dword v37, v8, s[40:43], s18 offen offset:256
buffer_load_dword v41, v8, s[40:43], s18 offen offset:320
buffer_load_dword v45, v8, s[40:43], s18 offen offset:384
buffer_load_dword v49, v8, s[40:43], s18 offen offset:448
buffer_load_dword v53, v8, s[40:43], s18 offen offset:512
buffer_load_dword v57, v8, s[40:43], s18 offen offset:576
s_add_u32 s18, s26, 82178
buffer_load_dword v22, v8, s[40:43], s18 offen offset:0
buffer_load_dword v26, v8, s[40:43], s18 offen offset:64
buffer_load_dword v30, v8, s[40:43], s18 offen offset:128
buffer_load_dword v34, v8, s[40:43], s18 offen offset:192
buffer_load_dword v38, v8, s[40:43], s18 offen offset:256
buffer_load_dword v42, v8, s[40:43], s18 offen offset:320
buffer_load_dword v46, v8, s[40:43], s18 offen offset:384
buffer_load_dword v50, v8, s[40:43], s18 offen offset:448
buffer_load_dword v54, v8, s[40:43], s18 offen offset:512
buffer_load_dword v58, v8, s[40:43], s18 offen offset:576
s_add_u32 s18, s26, 123266
buffer_load_dword v23, v8, s[40:43], s18 offen offset:0
buffer_load_dword v27, v8, s[40:43], s18 offen offset:64
buffer_load_dword v31, v8, s[40:43], s18 offen offset:128
buffer_load_dword v35, v8, s[40:43], s18 offen offset:192
buffer_load_dword v39, v8, s[40:43], s18 offen offset:256
buffer_load_dword v43, v8, s[40:43], s18 offen offset:320
buffer_load_dword v47, v8, s[40:43], s18 offen offset:384
buffer_load_dword v51, v8, s[40:43], s18 offen offset:448
buffer_load_dword v55, v8, s[40:43], s18 offen offset:512
buffer_load_dword v59, v8, s[40:43], s18 offen offset:576
s_waitcnt vmcnt(9)
buffer_store_dwordx4 v[20:23], v6, s[4:7], s27 offen sc1
s_add_u32 s27, s27, 262144
s_waitcnt vmcnt(9)
buffer_store_dwordx4 v[24:27], v6, s[4:7], s27 offen sc1
s_add_u32 s27, s27, 262144
s_waitcnt vmcnt(9)
buffer_store_dwordx4 v[28:31], v6, s[4:7], s27 offen sc1
s_add_u32 s27, s27, 262144
s_waitcnt vmcnt(9)
buffer_store_dwordx4 v[32:35], v6, s[4:7], s27 offen sc1
s_add_u32 s27, s27, 262144
s_waitcnt vmcnt(9)
buffer_store_dwordx4 v[36:39], v6, s[4:7], s27 offen sc1
s_add_u32 s27, s27, 262144
s_waitcnt vmcnt(9)
buffer_store_dwordx4 v[40:43], v6, s[4:7], s27 offen sc1
s_add_u32 s27, s27, 262144
s_waitcnt vmcnt(9)
buffer_store_dwordx4 v[44:47], v6, s[4:7], s27 offen sc1
s_add_u32 s27, s27, 262144
s_waitcnt vmcnt(9)
buffer_store_dwordx4 v[48:51], v6, s[4:7], s27 offen sc1
s_add_u32 s27, s27, 262144
s_waitcnt vmcnt(9)
buffer_store_dwordx4 v[52:55], v6, s[4:7], s27 offen sc1
s_add_u32 s27, s27, 262144
s_waitcnt vmcnt(9)
buffer_store_dwordx4 v[56:59], v6, s[4:7], s27 offen sc1
s_add_u32 s27, s27, 262144
s_lshl_b32 s18, s15, 7
s_add_u32 s18, s18, 11563008
s_cmp_eq_u32 s13, 0
s_cselect_b32 s22, s18, s6
s_mov_b32 s23, 1
s_waitcnt vmcnt(0)
s_barrier
v_mov_b32 v3, s23
s_mov_b64 exec, 1
buffer_store_dword v3, off, s[4:7], s22 sc1
s_mov_b64 exec, -1
s_mov_b32 s22, s6
s_lshl_b32 s26, s32, 8
s_lshl_b32 s18, s13, 6
s_add_u32 s26, s26, s18
s_load_dwordx2 s[40:41], s[0:1], 56
s_mov_b32 s42, 5242880
s_mov_b32 s43, 0x20000
s_waitcnt lgkmcnt(0)
v_lshrrev_b32 v20, 6, v0
v_mul_u32_u24 v20, 8192, v20
v_and_b32 v21, 48, v0
v_add_u32 v18, v20, v21
v_bfe_u32 v20, v0, 6, 2
v_lshrrev_b32 v21, 9, v0
v_lshl_add_u32 v20, v21, 3, v20
v_lshlrev_b32 v19, 6, v20
v_and_b32 v20, 48, v0
v_add_u32 v19, v19, v20
v_bfe_u32 v20, v0, 8, 1
v_lshl_add_u32 v19, v20, 3, v19
s_mul_i32 s18, s13, 36864
v_add_u32 v19, s18, v19
s_barrier
s_add_u32 m0, s18, 0
s_add_u32 s19, s26, 0
buffer_load_dwordx4 v18, s[40:43], s19 offen lds
s_add_u32 m0, s18, 1024
s_add_u32 s19, s26, 131072
buffer_load_dwordx4 v18, s[40:43], s19 offen lds
s_add_u32 m0, s18, 2048
s_add_u32 s19, s26, 262144
buffer_load_dwordx4 v18, s[40:43], s19 offen lds
s_add_u32 m0, s18, 3072
s_add_u32 s19, s26, 393216
buffer_load_dwordx4 v18, s[40:43], s19 offen lds
s_add_u32 m0, s18, 4096
s_add_u32 s19, s26, 524288
buffer_load_dwordx4 v18, s[40:43], s19 offen lds
s_add_u32 m0, s18, 5120
s_add_u32 s19, s26, 655360
buffer_load_dwordx4 v18, s[40:43], s19 offen lds
s_add_u32 m0, s18, 6144
s_add_u32 s19, s26, 786432
buffer_load_dwordx4 v18, s[40:43], s19 offen lds
s_add_u32 m0, s18, 7168
s_add_u32 s19, s26, 917504
buffer_load_dwordx4 v18, s[40:43], s19 offen lds
s_add_u32 m0, s18, 8192
s_add_u32 s19, s26, 1048576
buffer_load_dwordx4 v18, s[40:43], s19 offen lds
s_add_u32 m0, s18, 9216
s_add_u32 s19, s26, 1179648
buffer_load_dwordx4 v18, s[40:43], s19 offen lds
s_add_u32 m0, s18, 10240
s_add_u32 s19, s26, 1310720
buffer_load_dwordx4 v18, s[40:43], s19 offen lds
s_add_u32 m0, s18, 11264
s_add_u32 s19, s26, 1441792
buffer_load_dwordx4 v18, s[40:43], s19 offen lds
s_add_u32 m0, s18, 12288
s_add_u32 s19, s26, 1572864
buffer_load_dwordx4 v18, s[40:43], s19 offen lds
s_add_u32 m0, s18, 13312
s_add_u32 s19, s26, 1703936
buffer_load_dwordx4 v18, s[40:43], s19 offen lds
s_add_u32 m0, s18, 14336
s_add_u32 s19, s26, 1835008
buffer_load_dwordx4 v18, s[40:43], s19 offen lds
s_add_u32 m0, s18, 15360
s_add_u32 s19, s26, 1966080
buffer_load_dwordx4 v18, s[40:43], s19 offen lds
s_add_u32 m0, s18, 16384
s_add_u32 s19, s26, 2097152
buffer_load_dwordx4 v18, s[40:43], s19 offen lds
s_add_u32 m0, s18, 17408
s_add_u32 s19, s26, 2228224
buffer_load_dwordx4 v18, s[40:43], s19 offen lds
s_add_u32 m0, s18, 18432
s_add_u32 s19, s26, 2359296
buffer_load_dwordx4 v18, s[40:43], s19 offen lds
s_add_u32 m0, s18, 19456
s_add_u32 s19, s26, 2490368
buffer_load_dwordx4 v18, s[40:43], s19 offen lds
s_add_u32 m0, s18, 20480
s_add_u32 s19, s26, 2621440
buffer_load_dwordx4 v18, s[40:43], s19 offen lds
s_add_u32 m0, s18, 21504
s_add_u32 s19, s26, 2752512
buffer_load_dwordx4 v18, s[40:43], s19 offen lds
s_add_u32 m0, s18, 22528
s_add_u32 s19, s26, 2883584
buffer_load_dwordx4 v18, s[40:43], s19 offen lds
s_add_u32 m0, s18, 23552
s_add_u32 s19, s26, 3014656
buffer_load_dwordx4 v18, s[40:43], s19 offen lds
s_add_u32 m0, s18, 24576
s_add_u32 s19, s26, 3145728
buffer_load_dwordx4 v18, s[40:43], s19 offen lds
s_add_u32 m0, s18, 25600
s_add_u32 s19, s26, 3276800
buffer_load_dwordx4 v18, s[40:43], s19 offen lds
s_add_u32 m0, s18, 26624
s_add_u32 s19, s26, 3407872
buffer_load_dwordx4 v18, s[40:43], s19 offen lds
s_add_u32 m0, s18, 27648
s_add_u32 s19, s26, 3538944
buffer_load_dwordx4 v18, s[40:43], s19 offen lds
s_add_u32 m0, s18, 28672
s_add_u32 s19, s26, 3670016
buffer_load_dwordx4 v18, s[40:43], s19 offen lds
s_add_u32 m0, s18, 29696
s_add_u32 s19, s26, 3801088
buffer_load_dwordx4 v18, s[40:43], s19 offen lds
s_add_u32 m0, s18, 30720
s_add_u32 s19, s26, 3932160
buffer_load_dwordx4 v18, s[40:43], s19 offen lds
s_add_u32 m0, s18, 31744
s_add_u32 s19, s26, 4063232
buffer_load_dwordx4 v18, s[40:43], s19 offen lds
s_add_u32 m0, s18, 32768
s_add_u32 s19, s26, 4194304
buffer_load_dwordx4 v18, s[40:43], s19 offen lds
s_add_u32 m0, s18, 33792
s_add_u32 s19, s26, 4325376
buffer_load_dwordx4 v18, s[40:43], s19 offen lds
s_add_u32 m0, s18, 34816
s_add_u32 s19, s26, 4456448
buffer_load_dwordx4 v18, s[40:43], s19 offen lds
s_add_u32 m0, s18, 35840
s_add_u32 s19, s26, 4587520
buffer_load_dwordx4 v18, s[40:43], s19 offen lds
s_waitcnt vmcnt(32)
ds_read_b64_tr_b16 a[0:1], v19 offset:0
ds_read_b64_tr_b16 a[2:3], v19 offset:256
ds_read_b64_tr_b16 a[4:5], v19 offset:1024
ds_read_b64_tr_b16 a[6:7], v19 offset:1280
ds_read_b64_tr_b16 a[8:9], v19 offset:2048
ds_read_b64_tr_b16 a[10:11], v19 offset:2304
ds_read_b64_tr_b16 a[12:13], v19 offset:3072
ds_read_b64_tr_b16 a[14:15], v19 offset:3328
s_waitcnt lgkmcnt(0)
s_add_u32 m0, s18, 0
s_add_u32 s19, s26, 4718592
buffer_load_dwordx4 v18, s[40:43], s19 offen lds
s_add_u32 m0, s18, 1024
s_add_u32 s19, s26, 4849664
buffer_load_dwordx4 v18, s[40:43], s19 offen lds
s_add_u32 m0, s18, 2048
s_add_u32 s19, s26, 4980736
buffer_load_dwordx4 v18, s[40:43], s19 offen lds
s_add_u32 m0, s18, 3072
s_add_u32 s19, s26, 5111808
buffer_load_dwordx4 v18, s[40:43], s19 offen lds
s_waitcnt vmcnt(32)
ds_read_b64_tr_b16 a[16:17], v19 offset:4096
ds_read_b64_tr_b16 a[18:19], v19 offset:4352
ds_read_b64_tr_b16 a[20:21], v19 offset:5120
ds_read_b64_tr_b16 a[22:23], v19 offset:5376
ds_read_b64_tr_b16 a[24:25], v19 offset:6144
ds_read_b64_tr_b16 a[26:27], v19 offset:6400
ds_read_b64_tr_b16 a[28:29], v19 offset:7168
ds_read_b64_tr_b16 a[30:31], v19 offset:7424
s_waitcnt vmcnt(28)
ds_read_b64_tr_b16 a[32:33], v19 offset:8192
ds_read_b64_tr_b16 a[34:35], v19 offset:8448
ds_read_b64_tr_b16 a[36:37], v19 offset:9216
ds_read_b64_tr_b16 a[38:39], v19 offset:9472
ds_read_b64_tr_b16 a[40:41], v19 offset:10240
ds_read_b64_tr_b16 a[42:43], v19 offset:10496
ds_read_b64_tr_b16 a[44:45], v19 offset:11264
ds_read_b64_tr_b16 a[46:47], v19 offset:11520
s_waitcnt vmcnt(24)
ds_read_b64_tr_b16 a[48:49], v19 offset:12288
ds_read_b64_tr_b16 a[50:51], v19 offset:12544
ds_read_b64_tr_b16 a[52:53], v19 offset:13312
ds_read_b64_tr_b16 a[54:55], v19 offset:13568
ds_read_b64_tr_b16 a[56:57], v19 offset:14336
ds_read_b64_tr_b16 a[58:59], v19 offset:14592
ds_read_b64_tr_b16 a[60:61], v19 offset:15360
ds_read_b64_tr_b16 a[62:63], v19 offset:15616
s_waitcnt vmcnt(20)
ds_read_b64_tr_b16 a[64:65], v19 offset:16384
ds_read_b64_tr_b16 a[66:67], v19 offset:16640
ds_read_b64_tr_b16 a[68:69], v19 offset:17408
ds_read_b64_tr_b16 a[70:71], v19 offset:17664
ds_read_b64_tr_b16 a[72:73], v19 offset:18432
ds_read_b64_tr_b16 a[74:75], v19 offset:18688
ds_read_b64_tr_b16 a[76:77], v19 offset:19456
ds_read_b64_tr_b16 a[78:79], v19 offset:19712
s_waitcnt vmcnt(16)
ds_read_b64_tr_b16 a[80:81], v19 offset:20480
ds_read_b64_tr_b16 a[82:83], v19 offset:20736
ds_read_b64_tr_b16 a[84:85], v19 offset:21504
ds_read_b64_tr_b16 a[86:87], v19 offset:21760
ds_read_b64_tr_b16 a[88:89], v19 offset:22528
ds_read_b64_tr_b16 a[90:91], v19 offset:22784
ds_read_b64_tr_b16 a[92:93], v19 offset:23552
ds_read_b64_tr_b16 a[94:95], v19 offset:23808
s_waitcnt vmcnt(12)
ds_read_b64_tr_b16 a[96:97], v19 offset:24576
ds_read_b64_tr_b16 a[98:99], v19 offset:24832
ds_read_b64_tr_b16 a[100:101], v19 offset:25600
ds_read_b64_tr_b16 a[102:103], v19 offset:25856
ds_read_b64_tr_b16 a[104:105], v19 offset:26624
ds_read_b64_tr_b16 a[106:107], v19 offset:26880
ds_read_b64_tr_b16 a[108:109], v19 offset:27648
ds_read_b64_tr_b16 a[110:111], v19 offset:27904
s_waitcnt vmcnt(8)
ds_read_b64_tr_b16 a[112:113], v19 offset:28672
ds_read_b64_tr_b16 a[114:115], v19 offset:28928
ds_read_b64_tr_b16 a[116:117], v19 offset:29696
ds_read_b64_tr_b16 a[118:119], v19 offset:29952
ds_read_b64_tr_b16 a[120:121], v19 offset:30720
ds_read_b64_tr_b16 a[122:123], v19 offset:30976
ds_read_b64_tr_b16 a[124:125], v19 offset:31744
ds_read_b64_tr_b16 a[126:127], v19 offset:32000
s_waitcnt vmcnt(4)
ds_read_b64_tr_b16 a[128:129], v19 offset:32768
ds_read_b64_tr_b16 a[130:131], v19 offset:33024
ds_read_b64_tr_b16 a[132:133], v19 offset:33792
ds_read_b64_tr_b16 a[134:135], v19 offset:34048
ds_read_b64_tr_b16 a[136:137], v19 offset:34816
ds_read_b64_tr_b16 a[138:139], v19 offset:35072
ds_read_b64_tr_b16 a[140:141], v19 offset:35840
ds_read_b64_tr_b16 a[142:143], v19 offset:36096
s_waitcnt vmcnt(0)
ds_read_b64_tr_b16 a[144:145], v19 offset:0
ds_read_b64_tr_b16 a[146:147], v19 offset:256
ds_read_b64_tr_b16 a[148:149], v19 offset:1024
ds_read_b64_tr_b16 a[150:151], v19 offset:1280
ds_read_b64_tr_b16 a[152:153], v19 offset:2048
ds_read_b64_tr_b16 a[154:155], v19 offset:2304
ds_read_b64_tr_b16 a[156:157], v19 offset:3072
ds_read_b64_tr_b16 a[158:159], v19 offset:3328
s_waitcnt lgkmcnt(0)
s_barrier
s_load_dwordx2 s[40:41], s[0:1], 64
s_mov_b32 s42, 5242880
s_mov_b32 s43, 0x20000
s_waitcnt lgkmcnt(0)
v_lshlrev_b32 v6, 3, v0
s_mul_i32 s18, s32, 163840
s_mul_i32 s19, s13, 40960
s_add_u32 s18, s18, s19
buffer_load_dword v12, v6, s[40:43], s18 offen
s_add_u32 s18, s18, 8192
buffer_load_dword v13, v6, s[40:43], s18 offen
s_add_u32 s18, s18, 8192
buffer_load_dword v14, v6, s[40:43], s18 offen
s_add_u32 s18, s18, 8192
buffer_load_dword v15, v6, s[40:43], s18 offen
s_add_u32 s18, s18, 8192
buffer_load_dword v16, v6, s[40:43], s18 offen
s_add_u32 s18, s18, 8192
v_mov_b32 v20, s24
v_mov_b32 v21, s24
v_mov_b32 v22, s24
v_mov_b32 v23, s24
s_nop 1
v_mfma_f32_32x32x16_bf16 v[24:39], v[20:23], a[0:3], 0
v_mfma_f32_32x32x16_bf16 v[24:39], v[20:23], a[4:7], v[24:39]
v_mfma_f32_32x32x16_bf16 v[24:39], v[20:23], a[8:11], v[24:39]
v_mfma_f32_32x32x16_bf16 v[24:39], v[20:23], a[12:15], v[24:39]
v_mfma_f32_32x32x16_bf16 v[24:39], v[20:23], a[16:19], v[24:39]
v_mfma_f32_32x32x16_bf16 v[24:39], v[20:23], a[20:23], v[24:39]
v_mfma_f32_32x32x16_bf16 v[24:39], v[20:23], a[24:27], v[24:39]
v_mfma_f32_32x32x16_bf16 v[24:39], v[20:23], a[28:31], v[24:39]
v_mfma_f32_32x32x16_bf16 v[24:39], v[20:23], a[32:35], v[24:39]
v_mfma_f32_32x32x16_bf16 v[24:39], v[20:23], a[36:39], v[24:39]
v_mfma_f32_32x32x16_bf16 v[24:39], v[20:23], a[40:43], v[24:39]
v_mfma_f32_32x32x16_bf16 v[24:39], v[20:23], a[44:47], v[24:39]
v_mfma_f32_32x32x16_bf16 v[24:39], v[20:23], a[48:51], v[24:39]
v_mfma_f32_32x32x16_bf16 v[24:39], v[20:23], a[52:55], v[24:39]
v_mfma_f32_32x32x16_bf16 v[24:39], v[20:23], a[56:59], v[24:39]
v_mfma_f32_32x32x16_bf16 v[24:39], v[20:23], a[60:63], v[24:39]
v_mfma_f32_32x32x16_bf16 v[24:39], v[20:23], a[64:67], v[24:39]
v_mfma_f32_32x32x16_bf16 v[24:39], v[20:23], a[68:71], v[24:39]
v_mfma_f32_32x32x16_bf16 v[24:39], v[20:23], a[72:75], v[24:39]
v_mfma_f32_32x32x16_bf16 v[24:39], v[20:23], a[76:79], v[24:39]
v_mfma_f32_32x32x16_bf16 v[24:39], v[20:23], a[80:83], v[24:39]
v_mfma_f32_32x32x16_bf16 v[24:39], v[20:23], a[84:87], v[24:39]
v_mfma_f32_32x32x16_bf16 v[24:39], v[20:23], a[88:91], v[24:39]
v_mfma_f32_32x32x16_bf16 v[24:39], v[20:23], a[92:95], v[24:39]
v_mfma_f32_32x32x16_bf16 v[24:39], v[20:23], a[96:99], v[24:39]
v_mfma_f32_32x32x16_bf16 v[24:39], v[20:23], a[100:103], v[24:39]
v_mfma_f32_32x32x16_bf16 v[24:39], v[20:23], a[104:107], v[24:39]
v_mfma_f32_32x32x16_bf16 v[24:39], v[20:23], a[108:111], v[24:39]
v_mfma_f32_32x32x16_bf16 v[24:39], v[20:23], a[112:115], v[24:39]
v_mfma_f32_32x32x16_bf16 v[24:39], v[20:23], a[116:119], v[24:39]
v_mfma_f32_32x32x16_bf16 v[24:39], v[20:23], a[120:123], v[24:39]
v_mfma_f32_32x32x16_bf16 v[24:39], v[20:23], a[124:127], v[24:39]
v_mfma_f32_32x32x16_bf16 v[24:39], v[20:23], a[128:131], v[24:39]
v_mfma_f32_32x32x16_bf16 v[24:39], v[20:23], a[132:135], v[24:39]
v_mfma_f32_32x32x16_bf16 v[24:39], v[20:23], a[136:139], v[24:39]
v_mfma_f32_32x32x16_bf16 v[24:39], v[20:23], a[140:143], v[24:39]
v_mfma_f32_32x32x16_bf16 v[24:39], v[20:23], a[144:147], v[24:39]
v_mfma_f32_32x32x16_bf16 v[24:39], v[20:23], a[148:151], v[24:39]
v_mfma_f32_32x32x16_bf16 v[24:39], v[20:23], a[152:155], v[24:39]
v_mfma_f32_32x32x16_bf16 v[24:39], v[20:23], a[156:159], v[24:39]
s_nop 11
v_mov_b32 v5, v24
v_and_b32 v6, 0xf0, v0
s_waitcnt vmcnt(4)
v_bfe_u32 v12, v0, 8, 1
v_lshl_add_u32 v6, v12, 10, v6
v_lshrrev_b32 v12, 9, v0
v_lshl_add_u32 v6, v12, 8, v6
s_lshl_b32 s34, s13, 12
s_add_u32 s34, s34, 2048
s_lshl_b32 s18, s32, 14
s_add_u32 s34, s34, s18
v_bfe_u32 v7, v0, 7, 2
v_mul_u32_u24 v7, 10240, v7
v_bfe_u32 v12, v0, 5, 2
v_lshl_add_u32 v7, v12, 6, v7
v_lshrrev_b32 v12, 9, v0
v_lshl_add_u32 v7, v12, 5, v7
v_and_b32 v12, 16, v0
v_add_u32 v7, v12, v7
s_lshl_b32 s51, s32, 8
s_add_u32 s51, s51, 11534464
s_mul_i32 s52, s13, 2560
s_add_u32 s52, s52, 12582912
s_add_u32 s50, s34, 110100480
s_mov_b32 s39, 0
kvlay_29:
s_mul_i32 s26, s16, 6291456
s_add_u32 s26, s26, 88080384
s_add_u32 s26, s26, s31
s_mul_i32 s54, s16, 327680
s_add_u32 s54, s54, 163577856
s_mul_i32 s27, s16, 35651584
s_add_u32 s27, s27, 16777216
s_mul_i32 s18, s32, 0
s_add_u32 s27, s27, s18
s_add_u32 s27, s27, s34
s_lshl_b32 s29, s16, 1
s_add_u32 s29, s29, 1
s_mov_b32 s28, 0
s_mov_b32 s30, 0
s_cmp_lt_u32 s30, 64
s_cselect_b32 s53, s26, s6
s_cselect_b32 s36, s54, s6
s_mov_b32 s38, 1024
v_mov_b32 v8, v0
s_add_u32 s26, s26, 40960
s_add_u32 s54, s54, 5120
s_add_u32 s30, s30, 1
v_xor_b32 v1, 40960, v0
s_mov_b32 s25, s31
s_mov_b32 s35, 131072
s_cmp_lg_u32 s13, 0
s_cbranch_scc1 polld_38
v_lshlrev_b32 v3, 3, v0
s_waitcnt vmcnt(0)
v_min_u32 v16, 1152, v3
s_mov_b32 s21, 11612160
s_mov_b32 s17, 0
poll_37:
buffer_load_dword v12, v16, s[4:7], s21 offen sc1
s_add_u32 s17, s17, 1
s_cmp_gt_u32 s17, 262144
s_cbranch_scc1 L_fail
s_waitcnt vmcnt(0)
v_cmp_gt_u32 vcc, s29, v12
s_cbranch_vccz polld_38
s_sleep 2
s_branch poll_37
polld_38:
s_barrier
s_add_u32 m0, s25, 2048
s_mov_b32 s20, s53
buffer_load_dwordx4 v8, s[4:7], s20 offen sc1 lds
s_add_u32 m0, s25, 3072
s_add_u32 s20, s20, s38
buffer_load_dwordx4 v8, s[4:7], s20 offen sc1 lds
s_add_u32 m0, s25, 4096
s_add_u32 s20, s20, s38
buffer_load_dwordx4 v8, s[4:7], s20 offen sc1 lds
s_add_u32 m0, s25, 5120
s_add_u32 s20, s20, s38
buffer_load_dwordx4 v8, s[4:7], s20 offen sc1 lds
s_add_u32 m0, s25, 6144
s_add_u32 s20, s20, s38
buffer_load_dwordx4 v8, s[4:7], s20 offen sc1 lds
s_add_u32 m0, s25, 7168
s_add_u32 s20, s20, s38
buffer_load_dwordx4 v8, s[4:7], s20 offen sc1 lds
s_add_u32 m0, s25, 8192
s_add_u32 s20, s20, s38
buffer_load_dwordx4 v8, s[4:7], s20 offen sc1 lds
s_add_u32 m0, s25, 9216
s_add_u32 s20, s20, s38
buffer_load_dwordx4 v8, s[4:7], s20 offen sc1 lds
s_add_u32 m0, s25, 10240
s_add_u32 s20, s20, s38
buffer_load_dwordx4 v8, s[4:7], s20 offen sc1 lds
s_add_u32 m0, s25, 11264
s_add_u32 s20, s20, s38
buffer_load_dwordx4 v8, s[4:7], s20 offen sc1 lds
s_add_u32 m0, s35, s37
s_add_u32 s20, s36, s37
buffer_load_dwordx4 v0, s[4:7], s20 offen sc1 lds
s_add_u32 m0, s35, 4096
s_add_u32 s20, s36, 4096
buffer_load_dwordx4 v0, s[4:7], s20 offen sc1 lds
s_waitcnt vmcnt(0)
kvx_30:
v_xor_b32 v1, 40960, v1
s_sub_u32 s25, s25, s31
s_xor_b32 s25, s25, 40960
s_add_u32 s25, s25, s31
s_xor_b32 s35, s35, 8192
s_cmp_eq_u32 s28, 1
s_cbranch_scc1 kv_32
s_cmp_eq_u32 s28, 30
s_cbranch_scc0 kv_33
s_add_u32 s29, s29, 1
kv_32:
s_waitcnt vmcnt(0)
s_barrier
v_mov_b32 v3, s23
s_mov_b64 exec, 1
buffer_store_dword v3, off, s[4:7], s22 sc1
s_mov_b64 exec, -1
s_mov_b32 s22, s6
s_cmp_lg_u32 s13, 0
s_cbranch_scc1 polld_40
v_lshlrev_b32 v3, 3, v0
v_min_u32 v16, 3968, v3
s_mov_b32 s21, 11612160
s_mov_b32 s17, 0
poll_39:
buffer_load_dword v12, v3, s[4:7], s21 offen sc1
s_add_u32 s20, s21, 8192
buffer_load_dword v13, v3, s[4:7], s20 offen sc1
s_add_u32 s20, s21, 16384
buffer_load_dword v14, v16, s[4:7], s20 offen sc1
s_add_u32 s17, s17, 1
s_cmp_gt_u32 s17, 262144
s_cbranch_scc1 L_fail
s_waitcnt vmcnt(1)
v_min_u32 v12, v12, v13
s_waitcnt vmcnt(0)
v_min_u32 v12, v12, v14
v_cmp_gt_u32 vcc, s29, v12
s_cbranch_vccz polld_40
s_sleep 2
s_branch poll_39
polld_40:
s_barrier
kv_33:
s_add_u32 s28, s28, 1
s_and_b32 s33, s28, 3
s_cmp_lt_u32 s28, 12
s_cselect_b32 s33, 1, s33
s_cmp_eq_u32 s33, 0
s_cbranch_scc1 kv_34
s_cmp_lt_u32 s30, 64
s_cselect_b32 s53, s26, s6
s_cselect_b32 s36, s54, s6
s_mov_b32 s38, 1024
v_mov_b32 v8, v0
s_add_u32 s26, s26, 40960
s_add_u32 s54, s54, 5120
s_add_u32 s30, s30, 1
kvn_31:
s_waitcnt vmcnt(3)
s_barrier
ds_read_b128 v[36:39], v1 offset:2048
s_add_u32 m0, s25, 2048
s_mov_b32 s20, s53
buffer_load_dwordx4 v8, s[4:7], s20 offen sc1 lds
ds_read_b128 v[40:43], v1 offset:3072
s_xor_b32 s18, s35, 8192
v_lshrrev_b32 v2, 2, v0
v_add_u32 v2, s18, v2
ds_read_b128 v[48:51], v1 offset:5120
s_add_u32 m0, s25, 3072
s_add_u32 s20, s20, s38
buffer_load_dwordx4 v8, s[4:7], s20 offen sc1 lds
ds_read_b128 v[44:47], v1 offset:4096
s_waitcnt lgkmcnt(3)
v_mfma_f32_32x32x16_bf16 v[20:35], v[36:39], a[0:3], 0
ds_read2st64_b32 v[62:63], v2 offset0:6 offset1:7
s_waitcnt lgkmcnt(3)
ds_read2st64_b32 v[72:73], v2 offset0:16 offset1:17
ds_read2st64_b32 v[74:75], v2 offset0:18 offset1:19
ds_read_b128 v[36:39], v1 offset:6144
v_mfma_f32_32x32x16_bf16 v[20:35], v[40:43], a[4:7], v[20:35]
s_add_u32 m0, s25, 4096
s_add_u32 s20, s20, s38
buffer_load_dwordx4 v8, s[4:7], s20 offen sc1 lds
ds_read2st64_b32 v[54:55], v2 offset0:2 offset1:3
s_waitcnt lgkmcnt(5)
ds_read2st64_b32 v[52:53], v2 offset0:0 offset1:1
v_mfma_f32_32x32x16_bf16 v[20:35], v[44:47], a[8:11], v[20:35]
ds_read_b128 v[40:43], v1 offset:7168
ds_read2st64_b32 v[60:61], v2 offset0:4 offset1:5
ds_read2st64_b32 v[66:67], v2 offset0:10 offset1:11
s_add_u32 m0, s25, 5120
s_add_u32 s20, s20, s38
buffer_load_dwordx4 v8, s[4:7], s20 offen sc1 lds
v_mfma_f32_32x32x16_bf16 v[20:35], v[48:51], a[12:15], v[20:35]
ds_read_b128 v[48:51], v1 offset:9216
s_waitcnt lgkmcnt(6)
ds_read_b128 v[44:47], v1 offset:8192
s_waitcnt lgkmcnt(5)
ds_read2st64_b32 v[70:71], v2 offset0:14 offset1:15
v_mfma_f32_32x32x16_bf16 v[20:35], v[36:39], a[16:19], v[20:35]
s_add_u32 m0, s25, 6144
s_add_u32 s20, s20, s38
buffer_load_dwordx4 v8, s[4:7], s20 offen sc1 lds
s_waitcnt lgkmcnt(3)
ds_read2st64_b32 v[68:69], v2 offset0:12 offset1:13
v_mfma_f32_32x32x16_bf16 v[20:35], v[40:43], a[20:23], v[20:35]
s_waitcnt lgkmcnt(3)
ds_read_b128 v[36:39], v1 offset:10240
s_waitcnt lgkmcnt(3)
ds_read_b128 v[40:43], v1 offset:11264
v_mfma_f32_32x32x16_bf16 v[20:35], v[44:47], a[24:27], v[20:35]
ds_read_b128 v[44:47], v1 offset:12288
v_add_f32 v52, v52, v54
ds_read2st64_b32 v[64:65], v2 offset0:8 offset1:9
v_mfma_f32_32x32x16_bf16 v[20:35], v[48:51], a[28:31], v[20:35]
s_add_u32 m0, s25, 7168
s_add_u32 s20, s20, s38
buffer_load_dwordx4 v8, s[4:7], s20 offen sc1 lds
v_add_f32 v53, v53, v55
v_add_f32 v52, v52, v60
s_waitcnt lgkmcnt(3)
v_mfma_f32_32x32x16_bf16 v[20:35], v[36:39], a[32:35], v[20:35]
ds_read_b128 v[48:51], v1 offset:13312
s_waitcnt lgkmcnt(3)
s_waitcnt lgkmcnt(2)
ds_read_b128 v[36:39], v1 offset:14336
v_mfma_f32_32x32x16_bf16 v[20:35], v[40:43], a[36:39], v[20:35]
ds_read_b128 v[40:43], v1 offset:15360
s_add_u32 m0, s25, 8192
s_add_u32 s20, s20, s38
buffer_load_dwordx4 v8, s[4:7], s20 offen sc1 lds
v_mfma_f32_32x32x16_bf16 v[20:35], v[44:47], a[40:43], v[20:35]
s_add_u32 m0, s25, 9216
s_add_u32 s20, s20, s38
buffer_load_dwordx4 v8, s[4:7], s20 offen sc1 lds
v_mov_b32 v3, s23
v_add_f32 v53, v53, v61
s_waitcnt lgkmcnt(1)
v_add_f32 v53, v53, v63
v_mfma_f32_32x32x16_bf16 v[20:35], v[48:51], a[44:47], v[20:35]
v_add_f32 v52, v52, v62
v_add_f32 v52, v52, v64
ds_read_b128 v[44:47], v1 offset:16384
v_add_f32 v53, v53, v65
v_mfma_f32_32x32x16_bf16 v[20:35], v[36:39], a[48:51], v[20:35]
s_waitcnt lgkmcnt(1)
ds_read_b128 v[48:51], v1 offset:17408
ds_read_b128 v[36:39], v1 offset:18432
v_bfe_u32 v54, v0, 5, 5
v_add_f32 v53, v53, v67
v_and_b32 v54, 16, v54
v_add_f32 v53, v53, v69
v_mfma_f32_32x32x16_bf16 v[20:35], v[40:43], a[52:55], v[20:35]
v_add_f32 v52, v52, v66
ds_read_b128 v[40:43], v1 offset:19456
s_waitcnt lgkmcnt(3)
v_mfma_f32_32x32x16_bf16 v[20:35], v[44:47], a[56:59], v[20:35]
s_waitcnt lgkmcnt(2)
v_add_f32 v52, v52, v68
s_add_u32 m0, s25, 10240
s_add_u32 s20, s20, s38
buffer_load_dwordx4 v8, s[4:7], s20 offen sc1 lds
v_mfma_f32_32x32x16_bf16 v[20:35], v[48:51], a[60:63], v[20:35]
ds_read_b128 v[44:47], v1 offset:20480
v_add_f32 v53, v53, v71
s_waitcnt lgkmcnt(2)
v_add_f32 v52, v52, v70
v_add_f32 v52, v52, v72
v_add_f32 v53, v53, v73
v_mfma_f32_32x32x16_bf16 v[20:35], v[36:39], a[64:67], v[20:35]
ds_read_b128 v[48:51], v1 offset:21504
v_add_f32 v52, v52, v74
s_waitcnt lgkmcnt(2)
v_mfma_f32_32x32x16_bf16 v[20:35], v[40:43], a[68:71], v[20:35]
ds_read_b128 v[40:43], v1 offset:23552
ds_read_b128 v[36:39], v1 offset:22528
v_add_f32 v53, v53, v75
s_waitcnt lgkmcnt(3)
v_add_f32 v52, v52, v53
v_mfma_f32_32x32x16_bf16 v[20:35], v[44:47], a[72:75], v[20:35]
v_mov_b32 v56, v52
s_nop 1
v_permlane32_swap_b32 v52, v56
s_waitcnt lgkmcnt(2)
v_mfma_f32_32x32x16_bf16 v[20:35], v[48:51], a[76:79], v[20:35]
ds_read_b128 v[44:47], v1 offset:24576
s_waitcnt lgkmcnt(1)
ds_read_b128 v[48:51], v1 offset:25600
v_mfma_f32_32x32x16_bf16 v[20:35], v[36:39], a[80:83], v[20:35]
ds_read_b128 v[36:39], v1 offset:26624
v_mul_f32 v52, 0x3acccccd, v52
v_lshrrev_b32 v53, 2, v0
v_mul_f32 v56, 0x3acccccd, v56
s_add_u32 m0, s25, 11264
s_add_u32 s20, s20, s38
buffer_load_dwordx4 v8, s[4:7], s20 offen sc1 lds
v_mfma_f32_32x32x16_bf16 v[20:35], v[40:43], a[84:87], v[20:35]
s_waitcnt lgkmcnt(2)
ds_read_b128 v[40:43], v1 offset:27648
v_fma_f32 v56, -v52, v52, v56
v_max_f32 v56, 0, v56
s_waitcnt lgkmcnt(2)
v_lshl_add_u32 v53, s13, 8, v53
v_add_f32 v56, 0x3727c5ac, v56
v_mfma_f32_32x32x16_bf16 v[20:35], v[44:47], a[88:91], v[20:35]
ds_read_b128 v[44:47], v1 offset:28672
s_add_u32 m0, s35, s37
s_add_u32 s20, s36, s37
buffer_load_dwordx4 v0, s[4:7], s20 offen sc1 lds
v_mfma_f32_32x32x16_bf16 v[20:35], v[48:51], a[92:95], v[20:35]
s_waitcnt lgkmcnt(2)
v_rsq_f32 v56, v56
ds_read_b128 v[48:51], v1 offset:29696
v_mul_f32 v52, v56, v52
v_mfma_f32_32x32x16_bf16 v[20:35], v[36:39], a[96:99], v[20:35]
ds_read_b128 v[36:39], v1 offset:30720
s_waitcnt lgkmcnt(3)
s_add_u32 m0, s35, 4096
s_add_u32 s20, s36, 4096
buffer_load_dwordx4 v0, s[4:7], s20 offen sc1 lds
v_mfma_f32_32x32x16_bf16 v[20:35], v[40:43], a[100:103], v[20:35]
ds_read_b128 v[40:43], v1 offset:31744
s_waitcnt lgkmcnt(3)
v_permlane32_swap_b32 v56, v52
v_lshl_add_u32 v54, s13, 8, v54
v_mfma_f32_32x32x16_bf16 v[20:35], v[44:47], a[104:107], v[20:35]
s_waitcnt lgkmcnt(1)
ds_read_b128 v[44:47], v1 offset:32768
ds_write_b32 v53, v56 offset:1024
ds_read_b128 v[80:83], v54 offset:1184
ds_read_b128 v[76:79], v54 offset:1152
v_mfma_f32_32x32x16_bf16 v[20:35], v[48:51], a[108:111], v[20:35]
v_mfma_f32_32x32x16_bf16 v[20:35], v[36:39], a[112:115], v[20:35]
s_waitcnt lgkmcnt(4)
ds_read_b128 v[48:51], v1 offset:33792
ds_read_b128 v[88:91], v54 offset:1248
ds_read_b128 v[36:39], v1 offset:34816
s_waitcnt lgkmcnt(6)
ds_read_b128 v[84:87], v54 offset:1216
v_mfma_f32_32x32x16_bf16 v[20:35], v[40:43], a[116:119], v[20:35]
s_waitcnt vmcnt(12)
s_barrier
s_mov_b64 exec, 1
buffer_store_dword v3, off, s[4:7], s22 sc1
s_mov_b64 exec, -1
v_mfma_f32_32x32x16_bf16 v[20:35], v[44:47], a[120:123], v[20:35]
ds_read_b128 v[40:43], v1 offset:35840
s_waitcnt lgkmcnt(4)
ds_read_b128 v[44:47], v1 offset:36864
v_mfma_f32_32x32x16_bf16 v[20:35], v[48:51], a[124:127], v[20:35]
ds_read_b128 v[48:51], v1 offset:37888
ds_read_b128 v[72:75], v54 offset:1120
s_waitcnt lgkmcnt(4)
v_mul_f32 v79, v79, v5
v_mul_f32 v86, v86, v5
v_mfma_f32_32x32x16_bf16 v[20:35], v[36:39], a[128:131], v[20:35]
s_waitcnt lgkmcnt(3)
v_mfma_f32_32x32x16_bf16 v[20:35], v[40:43], a[132:135], v[20:35]
v_mul_f32 v89, v89, v5
v_mul_f32 v90, v90, v5
s_waitcnt lgkmcnt(2)
s_waitcnt lgkmcnt(1)
ds_read_b128 v[36:39], v1 offset:38912
ds_read_b128 v[60:63], v54 offset:1024
v_mfma_f32_32x32x16_bf16 v[20:35], v[44:47], a[136:139], v[20:35]
ds_read_b128 v[40:43], v1 offset:39936
ds_read_b128 v[44:47], v1 offset:40960
ds_read_b128 v[64:67], v54 offset:1056
v_mul_f32 v87, v87, v5
v_mfma_f32_32x32x16_bf16 v[20:35], v[48:51], a[140:143], v[20:35]
ds_read_b128 v[48:51], v1 offset:41984
ds_read_b128 v[68:71], v54 offset:1088
s_waitcnt lgkmcnt(6)
v_mfma_f32_32x32x16_bf16 v[20:35], v[36:39], a[144:147], v[20:35]
s_waitcnt lgkmcnt(4)
v_mul_f32 v78, v78, v5
v_mfma_f32_32x32x16_bf16 v[20:35], v[40:43], a[148:151], v[20:35]
v_mul_f32 v76, v76, v5
v_mul_f32 v85, v85, v5
v_mul_f32 v91, v91, v5
v_mul_f32 v77, v77, v5
s_waitcnt lgkmcnt(3)
v_mul_f32 v84, v84, v5
v_mfma_f32_32x32x16_bf16 v[20:35], v[44:47], a[152:155], v[20:35]
s_waitcnt lgkmcnt(1)
v_mul_f32 v88, v88, v5
v_mul_f32 v80, v80, v5
v_mfma_f32_32x32x16_bf16 v[20:35], v[48:51], a[156:159], v[20:35]
s_waitcnt lgkmcnt(0)
v_mul_f32 v83, v83, v5
v_mul_f32 v82, v82, v5
v_mul_f32 v81, v81, v5
s_nop 7
v_pk_fma_f32 v[26:27], v[26:27], v[66:67], v[82:83] neg_lo:[0,0,1] neg_hi:[0,0,1]
v_pk_fma_f32 v[24:25], v[24:25], v[64:65], v[80:81] neg_lo:[0,0,1] neg_hi:[0,0,1]
v_pk_fma_f32 v[34:35], v[34:35], v[74:75], v[90:91] neg_lo:[0,0,1] neg_hi:[0,0,1]
v_pk_fma_f32 v[22:23], v[22:23], v[62:63], v[78:79] neg_lo:[0,0,1] neg_hi:[0,0,1]
v_cvt_pk_bf16_f32 v37, v22, v23
v_pk_fma_f32 v[30:31], v[30:31], v[70:71], v[86:87] neg_lo:[0,0,1] neg_hi:[0,0,1]
v_cvt_pk_bf16_f32 v39, v26, v27
v_pk_fma_f32 v[32:33], v[32:33], v[72:73], v[88:89] neg_lo:[0,0,1] neg_hi:[0,0,1]
v_pk_fma_f32 v[20:21], v[20:21], v[60:61], v[76:77] neg_lo:[0,0,1] neg_hi:[0,0,1]
v_pk_fma_f32 v[28:29], v[28:29], v[68:69], v[84:85] neg_lo:[0,0,1] neg_hi:[0,0,1]
v_cvt_pk_bf16_f32 v38, v24, v25
v_cvt_pk_bf16_f32 v42, v32, v33
v_cvt_pk_bf16_f32 v40, v28, v29
v_cvt_pk_bf16_f32 v41, v30, v31
v_cvt_pk_bf16_f32 v43, v34, v35
v_cvt_pk_bf16_f32 v36, v20, v21
buffer_store_dwordx4 v[36:39], v6, s[4:7], s27 offen offset:0 sc1
buffer_store_dwordx4 v[40:43], v6, s[4:7], s27 offen offset:512 sc1
s_lshl_b32 s18, s16, 6
s_add_u32 s18, s18, s28
s_add_u32 s27, s27, 524288
s_cmp_eq_u32 s13, 0
s_cselect_b32 s22, s51, s6
s_mov_b32 s23, s18
s_cmp_lg_u32 s33, 0
s_cbranch_scc1 kvx_30
kvm_35:
v_xor_b32 v1, 40960, v1
s_sub_u32 s25, s25, s31
s_xor_b32 s25, s25, 40960
s_add_u32 s25, s25, s31
s_xor_b32 s35, s35, 8192
s_cmp_lt_u32 s30, 64
s_cselect_b32 s53, s26, s6
s_cselect_b32 s36, s54, s6
s_mov_b32 s38, 1024
v_mov_b32 v8, v0
s_add_u32 s26, s26, 40960
s_add_u32 s54, s54, 5120
s_add_u32 s30, s30, 1
s_waitcnt vmcnt(3)
s_barrier
ds_read_b128 v[36:39], v1 offset:2048
s_add_u32 m0, s25, 2048
s_mov_b32 s20, s53
buffer_load_dwordx4 v8, s[4:7], s20 offen sc1 lds
ds_read_b128 v[40:43], v1 offset:3072
ds_read_b128 v[44:47], v1 offset:4096
s_add_u32 m0, s25, 3072
s_add_u32 s20, s20, s38
buffer_load_dwordx4 v8, s[4:7], s20 offen sc1 lds
s_waitcnt lgkmcnt(2)
v_mfma_f32_32x32x16_bf16 v[20:35], v[36:39], a[0:3], 0
ds_read_b128 v[48:51], v1 offset:5120
s_waitcnt lgkmcnt(2)
s_add_u32 m0, s25, 4096
s_add_u32 s20, s20, s38
buffer_load_dwordx4 v8, s[4:7], s20 offen sc1 lds
s_waitcnt lgkmcnt(1)
v_mfma_f32_32x32x16_bf16 v[20:35], v[40:43], a[4:7], v[20:35]
s_add_u32 m0, s25, 5120
s_add_u32 s20, s20, s38
buffer_load_dwordx4 v8, s[4:7], s20 offen sc1 lds
ds_read_b128 v[36:39], v1 offset:6144
ds_read_b128 v[40:43], v1 offset:7168
v_mfma_f32_32x32x16_bf16 v[20:35], v[44:47], a[8:11], v[20:35]
ds_read_b128 v[44:47], v1 offset:8192
s_waitcnt lgkmcnt(3)
v_mfma_f32_32x32x16_bf16 v[20:35], v[48:51], a[12:15], v[20:35]
s_waitcnt lgkmcnt(2)
v_mfma_f32_32x32x16_bf16 v[20:35], v[36:39], a[16:19], v[20:35]
ds_read_b128 v[48:51], v1 offset:9216
ds_read_b128 v[36:39], v1 offset:10240
s_waitcnt lgkmcnt(2)
v_mfma_f32_32x32x16_bf16 v[20:35], v[40:43], a[20:23], v[20:35]
v_mfma_f32_32x32x16_bf16 v[20:35], v[44:47], a[24:27], v[20:35]
ds_read_b128 v[44:47], v1 offset:12288
s_waitcnt lgkmcnt(2)
ds_read_b128 v[40:43], v1 offset:11264
v_mfma_f32_32x32x16_bf16 v[20:35], v[48:51], a[28:31], v[20:35]
s_waitcnt lgkmcnt(2)
s_add_u32 m0, s25, 6144
s_add_u32 s20, s20, s38
buffer_load_dwordx4 v8, s[4:7], s20 offen sc1 lds
ds_read_b128 v[48:51], v1 offset:13312
v_mfma_f32_32x32x16_bf16 v[20:35], v[36:39], a[32:35], v[20:35]
s_waitcnt lgkmcnt(2)
s_add_u32 m0, s25, 7168
s_add_u32 s20, s20, s38
buffer_load_dwordx4 v8, s[4:7], s20 offen sc1 lds
s_waitcnt lgkmcnt(1)
v_mfma_f32_32x32x16_bf16 v[20:35], v[40:43], a[36:39], v[20:35]
ds_read_b128 v[36:39], v1 offset:14336
s_add_u32 m0, s25, 8192
s_add_u32 s20, s20, s38
buffer_load_dwordx4 v8, s[4:7], s20 offen sc1 lds
s_waitcnt lgkmcnt(1)
ds_read_b128 v[40:43], v1 offset:15360
v_mfma_f32_32x32x16_bf16 v[20:35], v[44:47], a[40:43], v[20:35]
ds_read_b128 v[44:47], v1 offset:16384
v_mfma_f32_32x32x16_bf16 v[20:35], v[48:51], a[44:47], v[20:35]
s_waitcnt lgkmcnt(2)
ds_read_b128 v[48:51], v1 offset:17408
v_mfma_f32_32x32x16_bf16 v[20:35], v[36:39], a[48:51], v[20:35]
ds_read_b128 v[36:39], v1 offset:18432
s_waitcnt lgkmcnt(2)
v_mfma_f32_32x32x16_bf16 v[20:35], v[40:43], a[52:55], v[20:35]
ds_read_b128 v[40:43], v1 offset:19456
s_add_u32 m0, s25, 9216
s_add_u32 s20, s20, s38
buffer_load_dwordx4 v8, s[4:7], s20 offen sc1 lds
s_waitcnt lgkmcnt(2)
v_mfma_f32_32x32x16_bf16 v[20:35], v[44:47], a[56:59], v[20:35]
v_mfma_f32_32x32x16_bf16 v[20:35], v[48:51], a[60:63], v[20:35]
ds_read_b128 v[48:51], v1 offset:21504
ds_read_b128 v[44:47], v1 offset:20480
s_waitcnt lgkmcnt(3)
v_mov_b32 v3, s23
v_mfma_f32_32x32x16_bf16 v[20:35], v[36:39], a[64:67], v[20:35]
s_waitcnt lgkmcnt(2)
s_add_u32 m0, s25, 10240
s_add_u32 s20, s20, s38
buffer_load_dwordx4 v8, s[4:7], s20 offen sc1 lds
ds_read_b128 v[36:39], v1 offset:22528
v_mfma_f32_32x32x16_bf16 v[20:35], v[40:43], a[68:71], v[20:35]
ds_read_b128 v[40:43], v1 offset:23552
s_waitcnt lgkmcnt(2)
v_mfma_f32_32x32x16_bf16 v[20:35], v[44:47], a[72:75], v[20:35]
v_mfma_f32_32x32x16_bf16 v[20:35], v[48:51], a[76:79], v[20:35]
s_waitcnt lgkmcnt(0)
ds_read_b128 v[44:47], v1 offset:24576
v_mfma_f32_32x32x16_bf16 v[20:35], v[36:39], a[80:83], v[20:35]
ds_read_b128 v[48:51], v1 offset:25600
s_add_u32 m0, s25, 11264
s_add_u32 s20, s20, s38
buffer_load_dwordx4 v8, s[4:7], s20 offen sc1 lds
v_mfma_f32_32x32x16_bf16 v[20:35], v[40:43], a[84:87], v[20:35]
ds_read_b128 v[36:39], v1 offset:26624
s_waitcnt lgkmcnt(2)
ds_read_b128 v[40:43], v1 offset:27648
v_mfma_f32_32x32x16_bf16 v[20:35], v[44:47], a[88:91], v[20:35]
s_waitcnt lgkmcnt(2)
ds_read_b128 v[44:47], v1 offset:28672
s_add_u32 m0, s35, s37
s_add_u32 s20, s36, s37
buffer_load_dwordx4 v0, s[4:7], s20 offen sc1 lds
v_mfma_f32_32x32x16_bf16 v[20:35], v[48:51], a[92:95], v[20:35]
ds_read_b128 v[48:51], v1 offset:29696
s_waitcnt lgkmcnt(3)
v_mfma_f32_32x32x16_bf16 v[20:35], v[36:39], a[96:99], v[20:35]
s_waitcnt lgkmcnt(1)
ds_read_b128 v[36:39], v1 offset:30720
s_add_u32 m0, s35, 4096
s_add_u32 s20, s36, 4096
buffer_load_dwordx4 v0, s[4:7], s20 offen sc1 lds
v_mfma_f32_32x32x16_bf16 v[20:35], v[40:43], a[100:103], v[20:35]
ds_read_b128 v[40:43], v1 offset:31744
v_mfma_f32_32x32x16_bf16 v[20:35], v[44:47], a[104:107], v[20:35]
s_waitcnt lgkmcnt(2)
s_waitcnt lgkmcnt(1)
v_mfma_f32_32x32x16_bf16 v[20:35], v[48:51], a[108:111], v[20:35]
ds_read_b128 v[44:47], v1 offset:32768
ds_read_b128 v[48:51], v1 offset:33792
v_mfma_f32_32x32x16_bf16 v[20:35], v[36:39], a[112:115], v[20:35]
ds_read_b128 v[36:39], v1 offset:34816
s_waitcnt lgkmcnt(3)
v_mfma_f32_32x32x16_bf16 v[20:35], v[40:43], a[116:119], v[20:35]
s_waitcnt vmcnt(12)
s_barrier
ds_read_b128 v[40:43], v1 offset:35840
s_waitcnt lgkmcnt(3)
v_mfma_f32_32x32x16_bf16 v[20:35], v[44:47], a[120:123], v[20:35]
s_mov_b64 exec, 1
buffer_store_dword v3, off, s[4:7], s22 sc1
s_mov_b64 exec, -1
s_waitcnt lgkmcnt(1)
v_mfma_f32_32x32x16_bf16 v[20:35], v[48:51], a[124:127], v[20:35]
ds_read_b128 v[44:47], v1 offset:36864
s_waitcnt lgkmcnt(1)
ds_read_b128 v[48:51], v1 offset:37888
v_mfma_f32_32x32x16_bf16 v[20:35], v[36:39], a[128:131], v[20:35]
v_mfma_f32_32x32x16_bf16 v[20:35], v[40:43], a[132:135], v[20:35]
s_waitcnt lgkmcnt(1)
ds_read_b128 v[40:43], v1 offset:39936
ds_read_b128 v[36:39], v1 offset:38912
v_mfma_f32_32x32x16_bf16 v[20:35], v[44:47], a[136:139], v[20:35]
s_waitcnt lgkmcnt(2)
v_mfma_f32_32x32x16_bf16 v[20:35], v[48:51], a[140:143], v[20:35]
ds_read_b128 v[44:47], v1 offset:40960
ds_read_b128 v[48:51], v1 offset:41984
s_waitcnt lgkmcnt(2)
v_mfma_f32_32x32x16_bf16 v[20:35], v[36:39], a[144:147], v[20:35]
v_mfma_f32_32x32x16_bf16 v[20:35], v[40:43], a[148:151], v[20:35]
s_waitcnt lgkmcnt(1)
v_mfma_f32_32x32x16_bf16 v[20:35], v[44:47], a[152:155], v[20:35]
s_waitcnt lgkmcnt(0)
v_mfma_f32_32x32x16_bf16 v[20:35], v[48:51], a[156:159], v[20:35]
s_nop 11
v_cvt_pk_bf16_f32 v37, v22, v23
v_cvt_pk_bf16_f32 v36, v20, v21
v_cvt_pk_bf16_f32 v41, v30, v31
v_cvt_pk_bf16_f32 v39, v26, v27
v_cvt_pk_bf16_f32 v42, v32, v33
v_cvt_pk_bf16_f32 v38, v24, v25
v_cvt_pk_bf16_f32 v40, v28, v29
v_cvt_pk_bf16_f32 v43, v34, v35
buffer_store_dwordx4 v[36:39], v6, s[4:7], s50 offen offset:0 sc1
buffer_store_dwordx4 v[40:43], v6, s[4:7], s50 offen offset:512 sc1
s_add_u32 s39, s39, 1
s_add_u32 s50, s50, 524288
s_add_u32 s18, s51, 8192
s_cmp_eq_u32 s13, 0
s_cselect_b32 s22, s18, s6
s_mov_b32 s23, s39
s_cmp_lt_u32 s28, 64
s_cbranch_scc1 kvx_30
s_and_b32 s18, s39, 15
s_cbranch_scc0 kvt_36
s_waitcnt vmcnt(0)
s_barrier
v_mov_b32 v3, s23
s_mov_b64 exec, 1
buffer_store_dword v3, off, s[4:7], s22 sc1
s_mov_b64 exec, -1
s_mov_b32 s22, s6
s_lshl_b32 s18, s39, 2
s_add_u32 s18, s18, 4
s_cmp_lg_u32 s13, 0
s_cbranch_scc1 polld_42
v_lshlrev_b32 v3, 3, v0
v_min_u32 v16, 1152, v3
s_mov_b32 s21, 11550720
s_mov_b32 s17, 0
poll_41:
buffer_load_dword v12, v16, s[4:7], s21 offen sc1
s_add_u32 s17, s17, 1
s_cmp_gt_u32 s17, 262144
s_cbranch_scc1 L_fail
s_waitcnt vmcnt(0)
v_cmp_gt_u32 vcc, s18, v12
s_cbranch_vccz polld_42
s_sleep 2
s_branch poll_41
polld_42:
s_barrier
s_mov_b32 s53, s52
s_mov_b32 s36, s6
s_mov_b32 s38, 256
v_mov_b32 v8, v7
s_add_u32 s52, s52, 40960
s_add_u32 m0, s25, 2048
s_mov_b32 s20, s53
buffer_load_dwordx4 v8, s[4:7], s20 offen sc1 lds
s_add_u32 m0, s25, 3072
s_add_u32 s20, s20, s38
buffer_load_dwordx4 v8, s[4:7], s20 offen sc1 lds
s_add_u32 m0, s25, 4096
s_add_u32 s20, s20, s38
buffer_load_dwordx4 v8, s[4:7], s20 offen sc1 lds
s_add_u32 m0, s25, 5120
s_add_u32 s20, s20, s38
buffer_load_dwordx4 v8, s[4:7], s20 offen sc1 lds
s_add_u32 m0, s25, 6144
s_add_u32 s20, s20, s38
buffer_load_dwordx4 v8, s[4:7], s20 offen sc1 lds
s_add_u32 m0, s25, 7168
s_add_u32 s20, s20, s38
buffer_load_dwordx4 v8, s[4:7], s20 offen sc1 lds
s_add_u32 m0, s25, 8192
s_add_u32 s20, s20, s38
buffer_load_dwordx4 v8, s[4:7], s20 offen sc1 lds
s_add_u32 m0, s25, 9216
s_add_u32 s20, s20, s38
buffer_load_dwordx4 v8, s[4:7], s20 offen sc1 lds
s_add_u32 m0, s25, 10240
s_add_u32 s20, s20, s38
buffer_load_dwordx4 v8, s[4:7], s20 offen sc1 lds
s_add_u32 m0, s25, 11264
s_add_u32 s20, s20, s38
buffer_load_dwordx4 v8, s[4:7], s20 offen sc1 lds
s_waitcnt vmcnt(0)
s_branch kvm_35
kv_34:
s_lshl_b32 s18, s39, 2
s_add_u32 s18, s18, 4
s_cmp_lg_u32 s13, 0
s_cbranch_scc1 polld_44
v_lshlrev_b32 v3, 3, v0
v_min_u32 v16, 1152, v3
s_mov_b32 s21, 11550720
s_mov_b32 s17, 0
poll_43:
buffer_load_dword v12, v16, s[4:7], s21 offen sc1
s_add_u32 s17, s17, 1
s_cmp_gt_u32 s17, 262144
s_cbranch_scc1 L_fail
s_waitcnt vmcnt(0)
v_cmp_gt_u32 vcc, s18, v12
s_cbranch_vccz polld_44
s_sleep 2
s_branch poll_43
polld_44:
s_barrier
s_mov_b32 s53, s52
s_mov_b32 s36, s6
s_mov_b32 s38, 256
v_mov_b32 v8, v7
s_add_u32 s52, s52, 40960
s_branch kvn_31
kvt_36:
s_waitcnt vmcnt(0)
s_barrier
v_mov_b32 v3, s23
s_mov_b64 exec, 1
buffer_store_dword v3, off, s[4:7], s22 sc1
s_mov_b64 exec, -1
s_mov_b32 s22, s6
s_cmp_lg_u32 s16, 0
s_cbranch_scc1 kvz_45
s_cmp_ge_u32 s32, 20
s_cbranch_scc1 kvz_45
s_mov_b32 s55, s34
s_mul_i32 s30, s32, 13108
s_lshr_b32 s30, s30, 16
s_mul_i32 s18, s30, 5
s_sub_u32 s34, s32, s18
s_add_u32 s30, s30, 60
s_add_u32 s54, s32, 15
s_lshl_b32 s18, s34, 2
s_add_u32 s18, s18, s13
s_lshl_b32 s33, s18, 11
v_lshrrev_b32 v12, 9, v0
v_and_b32 v10, 0x1ff, v0
v_lshlrev_b32 v10, 1, v10
v_lshl_add_u32 v10, v12, 4, v10
s_lshl_b32 s18, s34, 7
s_lshl_b32 s19, s13, 5
s_add_u32 s18, s18, s19
s_mov_b32 s19, 0x3acccccd
v_bfe_u32 v202, v0, 4, 5
v_lshrrev_b32 v197, 9, v0
v_add_u32 v202, s18, v202
v_and_b32 v201, 1, v202
v_mul_u32_u24 v201, 160, v201
v_lshrrev_b32 v200, 1, v202
v_add_u32 v200, 1, v200
v_lshlrev_b32 v197, 3, v197
v_mad_u32_u24 v201, v197, v200, v201
v_mad_u32_u24 v196, v200, 16, 0
v_cvt_f32_u32 v196, v196
v_mul_f32 v202, s19, v196
v_rndne_f32 v202, v202
v_fmac_f32 v196, 0xc4200000, v202
v_mul_f32 v196, s19, v196
v_cos_f32 v196, v196
s_nop 0
v_add_f32 v196, v196, v196
v_mad_u32_u24 v198, v200, 1, 0
v_cvt_f32_u32 v198, v198
v_mul_f32 v202, s19, v198
v_rndne_f32 v202, v202
v_fmac_f32 v198, 0xc4200000, v202
v_mul_f32 v198, s19, v198
v_cos_f32 v198, v198
s_nop 0
v_add_f32 v198, v198, v198
v_mad_u32_u24 v183, v200, 3, v201
v_cvt_f32_u32 v183, v183
v_mul_f32 v202, s19, v183
v_rndne_f32 v202, v202
v_fmac_f32 v183, 0xc4200000, v202
v_mul_f32 v183, s19, v183
v_cos_f32 v183, v183
v_mad_u32_u24 v184, v200, 4, v201
v_cvt_f32_u32 v184, v184
v_mul_f32 v202, s19, v184
v_rndne_f32 v202, v202
v_fmac_f32 v184, 0xc4200000, v202
v_mul_f32 v184, s19, v184
v_cos_f32 v184, v184
s_nop 0
v_fma_f32 v185, v198, v184, -v183
v_fma_f32 v182, v198, v183, -v184
v_fma_f32 v186, v198, v185, -v184
v_fma_f32 v181, v198, v182, -v183
v_fma_f32 v187, v198, v186, -v185
v_fma_f32 v180, v198, v181, -v182
v_cvt_pk_bf16_f32 v20, v180, v181
v_cvt_pk_bf16_f32 v21, v182, v183
v_cvt_pk_bf16_f32 v22, v184, v185
v_cvt_pk_bf16_f32 v23, v186, v187
v_mad_u32_u24 v191, v200, 19, v201
v_cvt_f32_u32 v191, v191
v_mul_f32 v202, s19, v191
v_rndne_f32 v202, v202
v_fmac_f32 v191, 0xc4200000, v202
v_mul_f32 v191, s19, v191
v_cos_f32 v191, v191
v_mad_u32_u24 v192, v200, 20, v201
v_cvt_f32_u32 v192, v192
v_mul_f32 v202, s19, v192
v_rndne_f32 v202, v202
v_fmac_f32 v192, 0xc4200000, v202
v_mul_f32 v192, s19, v192
v_cos_f32 v192, v192
s_nop 0
v_fma_f32 v193, v198, v192, -v191
v_fma_f32 v190, v198, v191, -v192
v_fma_f32 v194, v198, v193, -v192
v_fma_f32 v189, v198, v190, -v191
v_fma_f32 v195, v198, v194, -v193
v_fma_f32 v188, v198, v189, -v190
v_cvt_pk_bf16_f32 v24, v188, v189
v_cvt_pk_bf16_f32 v25, v190, v191
v_cvt_pk_bf16_f32 v26, v192, v193
v_cvt_pk_bf16_f32 v27, v194, v195
v_pk_fma_f32 v[180:181], v[196:197], v[188:189], v[180:181] op_sel_hi:[0,1,1] neg_lo:[0,0,1] neg_hi:[0,0,1]
v_pk_fma_f32 v[182:183], v[196:197], v[190:191], v[182:183] op_sel_hi:[0,1,1] neg_lo:[0,0,1] neg_hi:[0,0,1]
v_pk_fma_f32 v[184:185], v[196:197], v[192:193], v[184:185] op_sel_hi:[0,1,1] neg_lo:[0,0,1] neg_hi:[0,0,1]
v_pk_fma_f32 v[186:187], v[196:197], v[194:195], v[186:187] op_sel_hi:[0,1,1] neg_lo:[0,0,1] neg_hi:[0,0,1]
v_cvt_pk_bf16_f32 v28, v180, v181
v_cvt_pk_bf16_f32 v29, v182, v183
v_cvt_pk_bf16_f32 v30, v184, v185
v_cvt_pk_bf16_f32 v31, v186, v187
v_pk_fma_f32 v[188:189], v[196:197], v[180:181], v[188:189] op_sel_hi:[0,1,1] neg_lo:[0,0,1] neg_hi:[0,0,1]
v_pk_fma_f32 v[190:191], v[196:197], v[182:183], v[190:191] op_sel_hi:[0,1,1] neg_lo:[0,0,1] neg_hi:[0,0,1]
v_pk_fma_f32 v[192:193], v[196:197], v[184:185], v[192:193] op_sel_hi:[0,1,1] neg_lo:[0,0,1] neg_hi:[0,0,1]
v_pk_fma_f32 v[194:195], v[196:197], v[186:187], v[194:195] op_sel_hi:[0,1,1] neg_lo:[0,0,1] neg_hi:[0,0,1]
v_cvt_pk_bf16_f32 v32, v188, v189
v_cvt_pk_bf16_f32 v33, v190, v191
v_cvt_pk_bf16_f32 v34, v192, v193
v_cvt_pk_bf16_f32 v35, v194, v195
v_pk_fma_f32 v[180:181], v[196:197], v[188:189], v[180:181] op_sel_hi:[0,1,1] neg_lo:[0,0,1] neg_hi:[0,0,1]
v_pk_fma_f32 v[182:183], v[196:197], v[190:191], v[182:183] op_sel_hi:[0,1,1] neg_lo:[0,0,1] neg_hi:[0,0,1]
v_pk_fma_f32 v[184:185], v[196:197], v[192:193], v[184:185] op_sel_hi:[0,1,1] neg_lo:[0,0,1] neg_hi:[0,0,1]
v_pk_fma_f32 v[186:187], v[196:197], v[194:195], v[186:187] op_sel_hi:[0,1,1] neg_lo:[0,0,1] neg_hi:[0,0,1]
v_cvt_pk_bf16_f32 v36, v180, v181
v_cvt_pk_bf16_f32 v37, v182, v183
v_cvt_pk_bf16_f32 v38, v184, v185
v_cvt_pk_bf16_f32 v39, v186, v187
v_pk_fma_f32 v[188:189], v[196:197], v[180:181], v[188:189] op_sel_hi:[0,1,1] neg_lo:[0,0,1] neg_hi:[0,0,1]
v_pk_fma_f32 v[190:191], v[196:197], v[182:183], v[190:191] op_sel_hi:[0,1,1] neg_lo:[0,0,1] neg_hi:[0,0,1]
v_pk_fma_f32 v[192:193], v[196:197], v[184:185], v[192:193] op_sel_hi:[0,1,1] neg_lo:[0,0,1] neg_hi:[0,0,1]
v_pk_fma_f32 v[194:195], v[196:197], v[186:187], v[194:195] op_sel_hi:[0,1,1] neg_lo:[0,0,1] neg_hi:[0,0,1]
v_cvt_pk_bf16_f32 v40, v188, v189
v_cvt_pk_bf16_f32 v41, v190, v191
v_cvt_pk_bf16_f32 v42, v192, v193
v_cvt_pk_bf16_f32 v43, v194, v195
v_pk_fma_f32 v[180:181], v[196:197], v[188:189], v[180:181] op_sel_hi:[0,1,1] neg_lo:[0,0,1] neg_hi:[0,0,1]
v_pk_fma_f32 v[182:183], v[196:197], v[190:191], v[182:183] op_sel_hi:[0,1,1] neg_lo:[0,0,1] neg_hi:[0,0,1]
v_pk_fma_f32 v[184:185], v[196:197], v[192:193], v[184:185] op_sel_hi:[0,1,1] neg_lo:[0,0,1] neg_hi:[0,0,1]
v_pk_fma_f32 v[186:187], v[196:197], v[194:195], v[186:187] op_sel_hi:[0,1,1] neg_lo:[0,0,1] neg_hi:[0,0,1]
v_cvt_pk_bf16_f32 v44, v180, v181
v_cvt_pk_bf16_f32 v45, v182, v183
v_cvt_pk_bf16_f32 v46, v184, v185
v_cvt_pk_bf16_f32 v47, v186, v187
v_pk_fma_f32 v[188:189], v[196:197], v[180:181], v[188:189] op_sel_hi:[0,1,1] neg_lo:[0,0,1] neg_hi:[0,0,1]
v_pk_fma_f32 v[190:191], v[196:197], v[182:183], v[190:191] op_sel_hi:[0,1,1] neg_lo:[0,0,1] neg_hi:[0,0,1]
v_pk_fma_f32 v[192:193], v[196:197], v[184:185], v[192:193] op_sel_hi:[0,1,1] neg_lo:[0,0,1] neg_hi:[0,0,1]
v_pk_fma_f32 v[194:195], v[196:197], v[186:187], v[194:195] op_sel_hi:[0,1,1] neg_lo:[0,0,1] neg_hi:[0,0,1]
v_cvt_pk_bf16_f32 v48, v188, v189
v_cvt_pk_bf16_f32 v49, v190, v191
v_cvt_pk_bf16_f32 v50, v192, v193
v_cvt_pk_bf16_f32 v51, v194, v195
v_pk_fma_f32 v[180:181], v[196:197], v[188:189], v[180:181] op_sel_hi:[0,1,1] neg_lo:[0,0,1] neg_hi:[0,0,1]
v_pk_fma_f32 v[182:183], v[196:197], v[190:191], v[182:183] op_sel_hi:[0,1,1] neg_lo:[0,0,1] neg_hi:[0,0,1]
v_pk_fma_f32 v[184:185], v[196:197], v[192:193], v[184:185] op_sel_hi:[0,1,1] neg_lo:[0,0,1] neg_hi:[0,0,1]
v_pk_fma_f32 v[186:187], v[196:197], v[194:195], v[186:187] op_sel_hi:[0,1,1] neg_lo:[0,0,1] neg_hi:[0,0,1]
v_cvt_pk_bf16_f32 v52, v180, v181
v_cvt_pk_bf16_f32 v53, v182, v183
v_cvt_pk_bf16_f32 v54, v184, v185
v_cvt_pk_bf16_f32 v55, v186, v187
v_pk_fma_f32 v[188:189], v[196:197], v[180:181], v[188:189] op_sel_hi:[0,1,1] neg_lo:[0,0,1] neg_hi:[0,0,1]
v_pk_fma_f32 v[190:191], v[196:197], v[182:183], v[190:191] op_sel_hi:[0,1,1] neg_lo:[0,0,1] neg_hi:[0,0,1]
v_pk_fma_f32 v[192:193], v[196:197], v[184:185], v[192:193] op_sel_hi:[0,1,1] neg_lo:[0,0,1] neg_hi:[0,0,1]
v_pk_fma_f32 v[194:195], v[196:197], v[186:187], v[194:195] op_sel_hi:[0,1,1] neg_lo:[0,0,1] neg_hi:[0,0,1]
v_cvt_pk_bf16_f32 v56, v188, v189
v_cvt_pk_bf16_f32 v57, v190, v191
v_cvt_pk_bf16_f32 v58, v192, v193
v_cvt_pk_bf16_f32 v59, v194, v195
v_pk_fma_f32 v[180:181], v[196:197], v[188:189], v[180:181] op_sel_hi:[0,1,1] neg_lo:[0,0,1] neg_hi:[0,0,1]
v_pk_fma_f32 v[182:183], v[196:197], v[190:191], v[182:183] op_sel_hi:[0,1,1] neg_lo:[0,0,1] neg_hi:[0,0,1]
v_pk_fma_f32 v[184:185], v[196:197], v[192:193], v[184:185] op_sel_hi:[0,1,1] neg_lo:[0,0,1] neg_hi:[0,0,1]
v_pk_fma_f32 v[186:187], v[196:197], v[194:195], v[186:187] op_sel_hi:[0,1,1] neg_lo:[0,0,1] neg_hi:[0,0,1]
v_cvt_pk_bf16_f32 v60, v180, v181
v_cvt_pk_bf16_f32 v61, v182, v183
v_cvt_pk_bf16_f32 v62, v184, v185
v_cvt_pk_bf16_f32 v63, v186, v187
v_pk_fma_f32 v[188:189], v[196:197], v[180:181], v[188:189] op_sel_hi:[0,1,1] neg_lo:[0,0,1] neg_hi:[0,0,1]
v_pk_fma_f32 v[190:191], v[196:197], v[182:183], v[190:191] op_sel_hi:[0,1,1] neg_lo:[0,0,1] neg_hi:[0,0,1]
v_pk_fma_f32 v[192:193], v[196:197], v[184:185], v[192:193] op_sel_hi:[0,1,1] neg_lo:[0,0,1] neg_hi:[0,0,1]
v_pk_fma_f32 v[194:195], v[196:197], v[186:187], v[194:195] op_sel_hi:[0,1,1] neg_lo:[0,0,1] neg_hi:[0,0,1]
v_cvt_pk_bf16_f32 v64, v188, v189
v_cvt_pk_bf16_f32 v65, v190, v191
v_cvt_pk_bf16_f32 v66, v192, v193
v_cvt_pk_bf16_f32 v67, v194, v195
v_pk_fma_f32 v[180:181], v[196:197], v[188:189], v[180:181] op_sel_hi:[0,1,1] neg_lo:[0,0,1] neg_hi:[0,0,1]
v_pk_fma_f32 v[182:183], v[196:197], v[190:191], v[182:183] op_sel_hi:[0,1,1] neg_lo:[0,0,1] neg_hi:[0,0,1]
v_pk_fma_f32 v[184:185], v[196:197], v[192:193], v[184:185] op_sel_hi:[0,1,1] neg_lo:[0,0,1] neg_hi:[0,0,1]
v_pk_fma_f32 v[186:187], v[196:197], v[194:195], v[186:187] op_sel_hi:[0,1,1] neg_lo:[0,0,1] neg_hi:[0,0,1]
v_cvt_pk_bf16_f32 v68, v180, v181
v_cvt_pk_bf16_f32 v69, v182, v183
v_cvt_pk_bf16_f32 v70, v184, v185
v_cvt_pk_bf16_f32 v71, v186, v187
v_pk_fma_f32 v[188:189], v[196:197], v[180:181], v[188:189] op_sel_hi:[0,1,1] neg_lo:[0,0,1] neg_hi:[0,0,1]
v_pk_fma_f32 v[190:191], v[196:197], v[182:183], v[190:191] op_sel_hi:[0,1,1] neg_lo:[0,0,1] neg_hi:[0,0,1]
v_pk_fma_f32 v[192:193], v[196:197], v[184:185], v[192:193] op_sel_hi:[0,1,1] neg_lo:[0,0,1] neg_hi:[0,0,1]
v_pk_fma_f32 v[194:195], v[196:197], v[186:187], v[194:195] op_sel_hi:[0,1,1] neg_lo:[0,0,1] neg_hi:[0,0,1]
v_cvt_pk_bf16_f32 v72, v188, v189
v_cvt_pk_bf16_f32 v73, v190, v191
v_cvt_pk_bf16_f32 v74, v192, v193
v_cvt_pk_bf16_f32 v75, v194, v195
v_pk_fma_f32 v[180:181], v[196:197], v[188:189], v[180:181] op_sel_hi:[0,1,1] neg_lo:[0,0,1] neg_hi:[0,0,1]
v_pk_fma_f32 v[182:183], v[196:197], v[190:191], v[182:183] op_sel_hi:[0,1,1] neg_lo:[0,0,1] neg_hi:[0,0,1]
v_pk_fma_f32 v[184:185], v[196:197], v[192:193], v[184:185] op_sel_hi:[0,1,1] neg_lo:[0,0,1] neg_hi:[0,0,1]
v_pk_fma_f32 v[186:187], v[196:197], v[194:195], v[186:187] op_sel_hi:[0,1,1] neg_lo:[0,0,1] neg_hi:[0,0,1]
v_cvt_pk_bf16_f32 v76, v180, v181
v_cvt_pk_bf16_f32 v77, v182, v183
v_cvt_pk_bf16_f32 v78, v184, v185
v_cvt_pk_bf16_f32 v79, v186, v187
v_pk_fma_f32 v[188:189], v[196:197], v[180:181], v[188:189] op_sel_hi:[0,1,1] neg_lo:[0,0,1] neg_hi:[0,0,1]
v_pk_fma_f32 v[190:191], v[196:197], v[182:183], v[190:191] op_sel_hi:[0,1,1] neg_lo:[0,0,1] neg_hi:[0,0,1]
v_pk_fma_f32 v[192:193], v[196:197], v[184:185], v[192:193] op_sel_hi:[0,1,1] neg_lo:[0,0,1] neg_hi:[0,0,1]
v_pk_fma_f32 v[194:195], v[196:197], v[186:187], v[194:195] op_sel_hi:[0,1,1] neg_lo:[0,0,1] neg_hi:[0,0,1]
v_cvt_pk_bf16_f32 v80, v188, v189
v_cvt_pk_bf16_f32 v81, v190, v191
v_cvt_pk_bf16_f32 v82, v192, v193
v_cvt_pk_bf16_f32 v83, v194, v195
v_pk_fma_f32 v[180:181], v[196:197], v[188:189], v[180:181] op_sel_hi:[0,1,1] neg_lo:[0,0,1] neg_hi:[0,0,1]
v_pk_fma_f32 v[182:183], v[196:197], v[190:191], v[182:183] op_sel_hi:[0,1,1] neg_lo:[0,0,1] neg_hi:[0,0,1]
v_pk_fma_f32 v[184:185], v[196:197], v[192:193], v[184:185] op_sel_hi:[0,1,1] neg_lo:[0,0,1] neg_hi:[0,0,1]
v_pk_fma_f32 v[186:187], v[196:197], v[194:195], v[186:187] op_sel_hi:[0,1,1] neg_lo:[0,0,1] neg_hi:[0,0,1]
v_cvt_pk_bf16_f32 v84, v180, v181
v_cvt_pk_bf16_f32 v85, v182, v183
v_cvt_pk_bf16_f32 v86, v184, v185
v_cvt_pk_bf16_f32 v87, v186, v187
v_pk_fma_f32 v[188:189], v[196:197], v[180:181], v[188:189] op_sel_hi:[0,1,1] neg_lo:[0,0,1] neg_hi:[0,0,1]
v_pk_fma_f32 v[190:191], v[196:197], v[182:183], v[190:191] op_sel_hi:[0,1,1] neg_lo:[0,0,1] neg_hi:[0,0,1]
v_pk_fma_f32 v[192:193], v[196:197], v[184:185], v[192:193] op_sel_hi:[0,1,1] neg_lo:[0,0,1] neg_hi:[0,0,1]
v_pk_fma_f32 v[194:195], v[196:197], v[186:187], v[194:195] op_sel_hi:[0,1,1] neg_lo:[0,0,1] neg_hi:[0,0,1]
v_cvt_pk_bf16_f32 v88, v188, v189
v_cvt_pk_bf16_f32 v89, v190, v191
v_cvt_pk_bf16_f32 v90, v192, v193
v_cvt_pk_bf16_f32 v91, v194, v195
v_pk_fma_f32 v[180:181], v[196:197], v[188:189], v[180:181] op_sel_hi:[0,1,1] neg_lo:[0,0,1] neg_hi:[0,0,1]
v_pk_fma_f32 v[182:183], v[196:197], v[190:191], v[182:183] op_sel_hi:[0,1,1] neg_lo:[0,0,1] neg_hi:[0,0,1]
v_pk_fma_f32 v[184:185], v[196:197], v[192:193], v[184:185] op_sel_hi:[0,1,1] neg_lo:[0,0,1] neg_hi:[0,0,1]
v_pk_fma_f32 v[186:187], v[196:197], v[194:195], v[186:187] op_sel_hi:[0,1,1] neg_lo:[0,0,1] neg_hi:[0,0,1]
v_cvt_pk_bf16_f32 v92, v180, v181
v_cvt_pk_bf16_f32 v93, v182, v183
v_cvt_pk_bf16_f32 v94, v184, v185
v_cvt_pk_bf16_f32 v95, v186, v187
v_pk_fma_f32 v[188:189], v[196:197], v[180:181], v[188:189] op_sel_hi:[0,1,1] neg_lo:[0,0,1] neg_hi:[0,0,1]
v_pk_fma_f32 v[190:191], v[196:197], v[182:183], v[190:191] op_sel_hi:[0,1,1] neg_lo:[0,0,1] neg_hi:[0,0,1]
v_pk_fma_f32 v[192:193], v[196:197], v[184:185], v[192:193] op_sel_hi:[0,1,1] neg_lo:[0,0,1] neg_hi:[0,0,1]
v_pk_fma_f32 v[194:195], v[196:197], v[186:187], v[194:195] op_sel_hi:[0,1,1] neg_lo:[0,0,1] neg_hi:[0,0,1]
v_cvt_pk_bf16_f32 v96, v188, v189
v_cvt_pk_bf16_f32 v97, v190, v191
v_cvt_pk_bf16_f32 v98, v192, v193
v_cvt_pk_bf16_f32 v99, v194, v195
s_mov_b32 s20, 323
v_mad_u32_u24 v183, v200, s20, v201
v_cvt_f32_u32 v183, v183
v_mul_f32 v202, s19, v183
v_rndne_f32 v202, v202
v_fmac_f32 v183, 0xc4200000, v202
v_mul_f32 v183, s19, v183
v_cos_f32 v183, v183
s_mov_b32 s20, 324
v_mad_u32_u24 v184, v200, s20, v201
v_cvt_f32_u32 v184, v184
v_mul_f32 v202, s19, v184
v_rndne_f32 v202, v202
v_fmac_f32 v184, 0xc4200000, v202
v_mul_f32 v184, s19, v184
v_cos_f32 v184, v184
s_nop 0
v_fma_f32 v185, v198, v184, -v183
v_fma_f32 v182, v198, v183, -v184
v_fma_f32 v186, v198, v185, -v184
v_fma_f32 v181, v198, v182, -v183
v_fma_f32 v187, v198, v186, -v185
v_fma_f32 v180, v198, v181, -v182
v_cvt_pk_bf16_f32 v100, v180, v181
v_cvt_pk_bf16_f32 v101, v182, v183
v_cvt_pk_bf16_f32 v102, v184, v185
v_cvt_pk_bf16_f32 v103, v186, v187
s_mov_b32 s20, 339
v_mad_u32_u24 v191, v200, s20, v201
v_cvt_f32_u32 v191, v191
v_mul_f32 v202, s19, v191
v_rndne_f32 v202, v202
v_fmac_f32 v191, 0xc4200000, v202
v_mul_f32 v191, s19, v191
v_cos_f32 v191, v191
s_mov_b32 s20, 340
v_mad_u32_u24 v192, v200, s20, v201
v_cvt_f32_u32 v192, v192
v_mul_f32 v202, s19, v192
v_rndne_f32 v202, v202
v_fmac_f32 v192, 0xc4200000, v202
v_mul_f32 v192, s19, v192
v_cos_f32 v192, v192
s_nop 0
v_fma_f32 v193, v198, v192, -v191
v_fma_f32 v190, v198, v191, -v192
v_fma_f32 v194, v198, v193, -v192
v_fma_f32 v189, v198, v190, -v191
v_fma_f32 v195, v198, v194, -v193
v_fma_f32 v188, v198, v189, -v190
v_cvt_pk_bf16_f32 v104, v188, v189
v_cvt_pk_bf16_f32 v105, v190, v191
v_cvt_pk_bf16_f32 v106, v192, v193
v_cvt_pk_bf16_f32 v107, v194, v195
v_pk_fma_f32 v[180:181], v[196:197], v[188:189], v[180:181] op_sel_hi:[0,1,1] neg_lo:[0,0,1] neg_hi:[0,0,1]
v_pk_fma_f32 v[182:183], v[196:197], v[190:191], v[182:183] op_sel_hi:[0,1,1] neg_lo:[0,0,1] neg_hi:[0,0,1]
v_pk_fma_f32 v[184:185], v[196:197], v[192:193], v[184:185] op_sel_hi:[0,1,1] neg_lo:[0,0,1] neg_hi:[0,0,1]
v_pk_fma_f32 v[186:187], v[196:197], v[194:195], v[186:187] op_sel_hi:[0,1,1] neg_lo:[0,0,1] neg_hi:[0,0,1]
v_cvt_pk_bf16_f32 v108, v180, v181
v_cvt_pk_bf16_f32 v109, v182, v183
v_cvt_pk_bf16_f32 v110, v184, v185
v_cvt_pk_bf16_f32 v111, v186, v187
v_pk_fma_f32 v[188:189], v[196:197], v[180:181], v[188:189] op_sel_hi:[0,1,1] neg_lo:[0,0,1] neg_hi:[0,0,1]
v_pk_fma_f32 v[190:191], v[196:197], v[182:183], v[190:191] op_sel_hi:[0,1,1] neg_lo:[0,0,1] neg_hi:[0,0,1]
v_pk_fma_f32 v[192:193], v[196:197], v[184:185], v[192:193] op_sel_hi:[0,1,1] neg_lo:[0,0,1] neg_hi:[0,0,1]
v_pk_fma_f32 v[194:195], v[196:197], v[186:187], v[194:195] op_sel_hi:[0,1,1] neg_lo:[0,0,1] neg_hi:[0,0,1]
v_cvt_pk_bf16_f32 v112, v188, v189
v_cvt_pk_bf16_f32 v113, v190, v191
v_cvt_pk_bf16_f32 v114, v192, v193
v_cvt_pk_bf16_f32 v115, v194, v195
v_pk_fma_f32 v[180:181], v[196:197], v[188:189], v[180:181] op_sel_hi:[0,1,1] neg_lo:[0,0,1] neg_hi:[0,0,1]
v_pk_fma_f32 v[182:183], v[196:197], v[190:191], v[182:183] op_sel_hi:[0,1,1] neg_lo:[0,0,1] neg_hi:[0,0,1]
v_pk_fma_f32 v[184:185], v[196:197], v[192:193], v[184:185] op_sel_hi:[0,1,1] neg_lo:[0,0,1] neg_hi:[0,0,1]
v_pk_fma_f32 v[186:187], v[196:197], v[194:195], v[186:187] op_sel_hi:[0,1,1] neg_lo:[0,0,1] neg_hi:[0,0,1]
v_cvt_pk_bf16_f32 v116, v180, v181
v_cvt_pk_bf16_f32 v117, v182, v183
v_cvt_pk_bf16_f32 v118, v184, v185
v_cvt_pk_bf16_f32 v119, v186, v187
v_pk_fma_f32 v[188:189], v[196:197], v[180:181], v[188:189] op_sel_hi:[0,1,1] neg_lo:[0,0,1] neg_hi:[0,0,1]
v_pk_fma_f32 v[190:191], v[196:197], v[182:183], v[190:191] op_sel_hi:[0,1,1] neg_lo:[0,0,1] neg_hi:[0,0,1]
v_pk_fma_f32 v[192:193], v[196:197], v[184:185], v[192:193] op_sel_hi:[0,1,1] neg_lo:[0,0,1] neg_hi:[0,0,1]
v_pk_fma_f32 v[194:195], v[196:197], v[186:187], v[194:195] op_sel_hi:[0,1,1] neg_lo:[0,0,1] neg_hi:[0,0,1]
v_cvt_pk_bf16_f32 v120, v188, v189
v_cvt_pk_bf16_f32 v121, v190, v191
v_cvt_pk_bf16_f32 v122, v192, v193
v_cvt_pk_bf16_f32 v123, v194, v195
v_pk_fma_f32 v[180:181], v[196:197], v[188:189], v[180:181] op_sel_hi:[0,1,1] neg_lo:[0,0,1] neg_hi:[0,0,1]
v_pk_fma_f32 v[182:183], v[196:197], v[190:191], v[182:183] op_sel_hi:[0,1,1] neg_lo:[0,0,1] neg_hi:[0,0,1]
v_pk_fma_f32 v[184:185], v[196:197], v[192:193], v[184:185] op_sel_hi:[0,1,1] neg_lo:[0,0,1] neg_hi:[0,0,1]
v_pk_fma_f32 v[186:187], v[196:197], v[194:195], v[186:187] op_sel_hi:[0,1,1] neg_lo:[0,0,1] neg_hi:[0,0,1]
v_cvt_pk_bf16_f32 v124, v180, v181
v_cvt_pk_bf16_f32 v125, v182, v183
v_cvt_pk_bf16_f32 v126, v184, v185
v_cvt_pk_bf16_f32 v127, v186, v187
v_pk_fma_f32 v[188:189], v[196:197], v[180:181], v[188:189] op_sel_hi:[0,1,1] neg_lo:[0,0,1] neg_hi:[0,0,1]
v_pk_fma_f32 v[190:191], v[196:197], v[182:183], v[190:191] op_sel_hi:[0,1,1] neg_lo:[0,0,1] neg_hi:[0,0,1]
v_pk_fma_f32 v[192:193], v[196:197], v[184:185], v[192:193] op_sel_hi:[0,1,1] neg_lo:[0,0,1] neg_hi:[0,0,1]
v_pk_fma_f32 v[194:195], v[196:197], v[186:187], v[194:195] op_sel_hi:[0,1,1] neg_lo:[0,0,1] neg_hi:[0,0,1]
v_cvt_pk_bf16_f32 v128, v188, v189
v_cvt_pk_bf16_f32 v129, v190, v191
v_cvt_pk_bf16_f32 v130, v192, v193
v_cvt_pk_bf16_f32 v131, v194, v195
v_pk_fma_f32 v[180:181], v[196:197], v[188:189], v[180:181] op_sel_hi:[0,1,1] neg_lo:[0,0,1] neg_hi:[0,0,1]
v_pk_fma_f32 v[182:183], v[196:197], v[190:191], v[182:183] op_sel_hi:[0,1,1] neg_lo:[0,0,1] neg_hi:[0,0,1]
v_pk_fma_f32 v[184:185], v[196:197], v[192:193], v[184:185] op_sel_hi:[0,1,1] neg_lo:[0,0,1] neg_hi:[0,0,1]
v_pk_fma_f32 v[186:187], v[196:197], v[194:195], v[186:187] op_sel_hi:[0,1,1] neg_lo:[0,0,1] neg_hi:[0,0,1]
v_cvt_pk_bf16_f32 v132, v180, v181
v_cvt_pk_bf16_f32 v133, v182, v183
v_cvt_pk_bf16_f32 v134, v184, v185
v_cvt_pk_bf16_f32 v135, v186, v187
v_pk_fma_f32 v[188:189], v[196:197], v[180:181], v[188:189] op_sel_hi:[0,1,1] neg_lo:[0,0,1] neg_hi:[0,0,1]
v_pk_fma_f32 v[190:191], v[196:197], v[182:183], v[190:191] op_sel_hi:[0,1,1] neg_lo:[0,0,1] neg_hi:[0,0,1]
v_pk_fma_f32 v[192:193], v[196:197], v[184:185], v[192:193] op_sel_hi:[0,1,1] neg_lo:[0,0,1] neg_hi:[0,0,1]
v_pk_fma_f32 v[194:195], v[196:197], v[186:187], v[194:195] op_sel_hi:[0,1,1] neg_lo:[0,0,1] neg_hi:[0,0,1]
v_cvt_pk_bf16_f32 v136, v188, v189
v_cvt_pk_bf16_f32 v137, v190, v191
v_cvt_pk_bf16_f32 v138, v192, v193
v_cvt_pk_bf16_f32 v139, v194, v195
v_pk_fma_f32 v[180:181], v[196:197], v[188:189], v[180:181] op_sel_hi:[0,1,1] neg_lo:[0,0,1] neg_hi:[0,0,1]
v_pk_fma_f32 v[182:183], v[196:197], v[190:191], v[182:183] op_sel_hi:[0,1,1] neg_lo:[0,0,1] neg_hi:[0,0,1]
v_pk_fma_f32 v[184:185], v[196:197], v[192:193], v[184:185] op_sel_hi:[0,1,1] neg_lo:[0,0,1] neg_hi:[0,0,1]
v_pk_fma_f32 v[186:187], v[196:197], v[194:195], v[186:187] op_sel_hi:[0,1,1] neg_lo:[0,0,1] neg_hi:[0,0,1]
v_cvt_pk_bf16_f32 v140, v180, v181
v_cvt_pk_bf16_f32 v141, v182, v183
v_cvt_pk_bf16_f32 v142, v184, v185
v_cvt_pk_bf16_f32 v143, v186, v187
v_pk_fma_f32 v[188:189], v[196:197], v[180:181], v[188:189] op_sel_hi:[0,1,1] neg_lo:[0,0,1] neg_hi:[0,0,1]
v_pk_fma_f32 v[190:191], v[196:197], v[182:183], v[190:191] op_sel_hi:[0,1,1] neg_lo:[0,0,1] neg_hi:[0,0,1]
v_pk_fma_f32 v[192:193], v[196:197], v[184:185], v[192:193] op_sel_hi:[0,1,1] neg_lo:[0,0,1] neg_hi:[0,0,1]
v_pk_fma_f32 v[194:195], v[196:197], v[186:187], v[194:195] op_sel_hi:[0,1,1] neg_lo:[0,0,1] neg_hi:[0,0,1]
v_cvt_pk_bf16_f32 v144, v188, v189
v_cvt_pk_bf16_f32 v145, v190, v191
v_cvt_pk_bf16_f32 v146, v192, v193
v_cvt_pk_bf16_f32 v147, v194, v195
v_pk_fma_f32 v[180:181], v[196:197], v[188:189], v[180:181] op_sel_hi:[0,1,1] neg_lo:[0,0,1] neg_hi:[0,0,1]
v_pk_fma_f32 v[182:183], v[196:197], v[190:191], v[182:183] op_sel_hi:[0,1,1] neg_lo:[0,0,1] neg_hi:[0,0,1]
v_pk_fma_f32 v[184:185], v[196:197], v[192:193], v[184:185] op_sel_hi:[0,1,1] neg_lo:[0,0,1] neg_hi:[0,0,1]
v_pk_fma_f32 v[186:187], v[196:197], v[194:195], v[186:187] op_sel_hi:[0,1,1] neg_lo:[0,0,1] neg_hi:[0,0,1]
v_cvt_pk_bf16_f32 v148, v180, v181
v_cvt_pk_bf16_f32 v149, v182, v183
v_cvt_pk_bf16_f32 v150, v184, v185
v_cvt_pk_bf16_f32 v151, v186, v187
v_pk_fma_f32 v[188:189], v[196:197], v[180:181], v[188:189] op_sel_hi:[0,1,1] neg_lo:[0,0,1] neg_hi:[0,0,1]
v_pk_fma_f32 v[190:191], v[196:197], v[182:183], v[190:191] op_sel_hi:[0,1,1] neg_lo:[0,0,1] neg_hi:[0,0,1]
v_pk_fma_f32 v[192:193], v[196:197], v[184:185], v[192:193] op_sel_hi:[0,1,1] neg_lo:[0,0,1] neg_hi:[0,0,1]
v_pk_fma_f32 v[194:195], v[196:197], v[186:187], v[194:195] op_sel_hi:[0,1,1] neg_lo:[0,0,1] neg_hi:[0,0,1]
v_cvt_pk_bf16_f32 v152, v188, v189
v_cvt_pk_bf16_f32 v153, v190, v191
v_cvt_pk_bf16_f32 v154, v192, v193
v_cvt_pk_bf16_f32 v155, v194, v195
v_pk_fma_f32 v[180:181], v[196:197], v[188:189], v[180:181] op_sel_hi:[0,1,1] neg_lo:[0,0,1] neg_hi:[0,0,1]
v_pk_fma_f32 v[182:183], v[196:197], v[190:191], v[182:183] op_sel_hi:[0,1,1] neg_lo:[0,0,1] neg_hi:[0,0,1]
v_pk_fma_f32 v[184:185], v[196:197], v[192:193], v[184:185] op_sel_hi:[0,1,1] neg_lo:[0,0,1] neg_hi:[0,0,1]
v_pk_fma_f32 v[186:187], v[196:197], v[194:195], v[186:187] op_sel_hi:[0,1,1] neg_lo:[0,0,1] neg_hi:[0,0,1]
v_cvt_pk_bf16_f32 v156, v180, v181
v_cvt_pk_bf16_f32 v157, v182, v183
v_cvt_pk_bf16_f32 v158, v184, v185
v_cvt_pk_bf16_f32 v159, v186, v187
v_pk_fma_f32 v[188:189], v[196:197], v[180:181], v[188:189] op_sel_hi:[0,1,1] neg_lo:[0,0,1] neg_hi:[0,0,1]
v_pk_fma_f32 v[190:191], v[196:197], v[182:183], v[190:191] op_sel_hi:[0,1,1] neg_lo:[0,0,1] neg_hi:[0,0,1]
v_pk_fma_f32 v[192:193], v[196:197], v[184:185], v[192:193] op_sel_hi:[0,1,1] neg_lo:[0,0,1] neg_hi:[0,0,1]
v_pk_fma_f32 v[194:195], v[196:197], v[186:187], v[194:195] op_sel_hi:[0,1,1] neg_lo:[0,0,1] neg_hi:[0,0,1]
v_cvt_pk_bf16_f32 v160, v188, v189
v_cvt_pk_bf16_f32 v161, v190, v191
v_cvt_pk_bf16_f32 v162, v192, v193
v_cvt_pk_bf16_f32 v163, v194, v195
v_pk_fma_f32 v[180:181], v[196:197], v[188:189], v[180:181] op_sel_hi:[0,1,1] neg_lo:[0,0,1] neg_hi:[0,0,1]
v_pk_fma_f32 v[182:183], v[196:197], v[190:191], v[182:183] op_sel_hi:[0,1,1] neg_lo:[0,0,1] neg_hi:[0,0,1]
v_pk_fma_f32 v[184:185], v[196:197], v[192:193], v[184:185] op_sel_hi:[0,1,1] neg_lo:[0,0,1] neg_hi:[0,0,1]
v_pk_fma_f32 v[186:187], v[196:197], v[194:195], v[186:187] op_sel_hi:[0,1,1] neg_lo:[0,0,1] neg_hi:[0,0,1]
v_cvt_pk_bf16_f32 v164, v180, v181
v_cvt_pk_bf16_f32 v165, v182, v183
v_cvt_pk_bf16_f32 v166, v184, v185
v_cvt_pk_bf16_f32 v167, v186, v187
v_pk_fma_f32 v[188:189], v[196:197], v[180:181], v[188:189] op_sel_hi:[0,1,1] neg_lo:[0,0,1] neg_hi:[0,0,1]
v_pk_fma_f32 v[190:191], v[196:197], v[182:183], v[190:191] op_sel_hi:[0,1,1] neg_lo:[0,0,1] neg_hi:[0,0,1]
v_pk_fma_f32 v[192:193], v[196:197], v[184:185], v[192:193] op_sel_hi:[0,1,1] neg_lo:[0,0,1] neg_hi:[0,0,1]
v_pk_fma_f32 v[194:195], v[196:197], v[186:187], v[194:195] op_sel_hi:[0,1,1] neg_lo:[0,0,1] neg_hi:[0,0,1]
v_cvt_pk_bf16_f32 v168, v188, v189
v_cvt_pk_bf16_f32 v169, v190, v191
v_cvt_pk_bf16_f32 v170, v192, v193
v_cvt_pk_bf16_f32 v171, v194, v195
v_pk_fma_f32 v[180:181], v[196:197], v[188:189], v[180:181] op_sel_hi:[0,1,1] neg_lo:[0,0,1] neg_hi:[0,0,1]
v_pk_fma_f32 v[182:183], v[196:197], v[190:191], v[182:183] op_sel_hi:[0,1,1] neg_lo:[0,0,1] neg_hi:[0,0,1]
v_pk_fma_f32 v[184:185], v[196:197], v[192:193], v[184:185] op_sel_hi:[0,1,1] neg_lo:[0,0,1] neg_hi:[0,0,1]
v_pk_fma_f32 v[186:187], v[196:197], v[194:195], v[186:187] op_sel_hi:[0,1,1] neg_lo:[0,0,1] neg_hi:[0,0,1]
v_cvt_pk_bf16_f32 v172, v180, v181
v_cvt_pk_bf16_f32 v173, v182, v183
v_cvt_pk_bf16_f32 v174, v184, v185
v_cvt_pk_bf16_f32 v175, v186, v187
v_pk_fma_f32 v[188:189], v[196:197], v[180:181], v[188:189] op_sel_hi:[0,1,1] neg_lo:[0,0,1] neg_hi:[0,0,1]
v_pk_fma_f32 v[190:191], v[196:197], v[182:183], v[190:191] op_sel_hi:[0,1,1] neg_lo:[0,0,1] neg_hi:[0,0,1]
v_pk_fma_f32 v[192:193], v[196:197], v[184:185], v[192:193] op_sel_hi:[0,1,1] neg_lo:[0,0,1] neg_hi:[0,0,1]
v_pk_fma_f32 v[194:195], v[196:197], v[186:187], v[194:195] op_sel_hi:[0,1,1] neg_lo:[0,0,1] neg_hi:[0,0,1]
v_cvt_pk_bf16_f32 v176, v188, v189
v_cvt_pk_bf16_f32 v177, v190, v191
v_cvt_pk_bf16_f32 v178, v192, v193
v_cvt_pk_bf16_f32 v179, v194, v195
v_mov_b32 v180, s24
v_mov_b32 v181, s24
v_mov_b32 v182, s24
v_mov_b32 v183, s24
s_nop 1
v_mfma_f32_32x32x16_bf16 v[184:199], v[180:183], v[20:23], 0
v_mfma_f32_32x32x16_bf16 v[184:199], v[180:183], v[24:27], v[184:199]
v_mfma_f32_32x32x16_bf16 v[184:199], v[180:183], v[28:31], v[184:199]
v_mfma_f32_32x32x16_bf16 v[184:199], v[180:183], v[32:35], v[184:199]
v_mfma_f32_32x32x16_bf16 v[184:199], v[180:183], v[36:39], v[184:199]
v_mfma_f32_32x32x16_bf16 v[184:199], v[180:183], v[40:43], v[184:199]
v_mfma_f32_32x32x16_bf16 v[184:199], v[180:183], v[44:47], v[184:199]
v_mfma_f32_32x32x16_bf16 v[184:199], v[180:183], v[48:51], v[184:199]
v_mfma_f32_32x32x16_bf16 v[184:199], v[180:183], v[52:55], v[184:199]
v_mfma_f32_32x32x16_bf16 v[184:199], v[180:183], v[56:59], v[184:199]
v_mfma_f32_32x32x16_bf16 v[184:199], v[180:183], v[60:63], v[184:199]
v_mfma_f32_32x32x16_bf16 v[184:199], v[180:183], v[64:67], v[184:199]
v_mfma_f32_32x32x16_bf16 v[184:199], v[180:183], v[68:71], v[184:199]
v_mfma_f32_32x32x16_bf16 v[184:199], v[180:183], v[72:75], v[184:199]
v_mfma_f32_32x32x16_bf16 v[184:199], v[180:183], v[76:79], v[184:199]
v_mfma_f32_32x32x16_bf16 v[184:199], v[180:183], v[80:83], v[184:199]
v_mfma_f32_32x32x16_bf16 v[184:199], v[180:183], v[84:87], v[184:199]
v_mfma_f32_32x32x16_bf16 v[184:199], v[180:183], v[88:91], v[184:199]
v_mfma_f32_32x32x16_bf16 v[184:199], v[180:183], v[92:95], v[184:199]
v_mfma_f32_32x32x16_bf16 v[184:199], v[180:183], v[96:99], v[184:199]
v_mfma_f32_32x32x16_bf16 v[184:199], v[180:183], v[100:103], v[184:199]
v_mfma_f32_32x32x16_bf16 v[184:199], v[180:183], v[104:107], v[184:199]
v_mfma_f32_32x32x16_bf16 v[184:199], v[180:183], v[108:111], v[184:199]
v_mfma_f32_32x32x16_bf16 v[184:199], v[180:183], v[112:115], v[184:199]
v_mfma_f32_32x32x16_bf16 v[184:199], v[180:183], v[116:119], v[184:199]
v_mfma_f32_32x32x16_bf16 v[184:199], v[180:183], v[120:123], v[184:199]
v_mfma_f32_32x32x16_bf16 v[184:199], v[180:183], v[124:127], v[184:199]
v_mfma_f32_32x32x16_bf16 v[184:199], v[180:183], v[128:131], v[184:199]
v_mfma_f32_32x32x16_bf16 v[184:199], v[180:183], v[132:135], v[184:199]
v_mfma_f32_32x32x16_bf16 v[184:199], v[180:183], v[136:139], v[184:199]
v_mfma_f32_32x32x16_bf16 v[184:199], v[180:183], v[140:143], v[184:199]
v_mfma_f32_32x32x16_bf16 v[184:199], v[180:183], v[144:147], v[184:199]
v_mfma_f32_32x32x16_bf16 v[184:199], v[180:183], v[148:151], v[184:199]
v_mfma_f32_32x32x16_bf16 v[184:199], v[180:183], v[152:155], v[184:199]
v_mfma_f32_32x32x16_bf16 v[184:199], v[180:183], v[156:159], v[184:199]
v_mfma_f32_32x32x16_bf16 v[184:199], v[180:183], v[160:163], v[184:199]
v_mfma_f32_32x32x16_bf16 v[184:199], v[180:183], v[164:167], v[184:199]
v_mfma_f32_32x32x16_bf16 v[184:199], v[180:183], v[168:171], v[184:199]
v_mfma_f32_32x32x16_bf16 v[184:199], v[180:183], v[172:175], v[184:199]
v_mfma_f32_32x32x16_bf16 v[184:199], v[180:183], v[176:179], v[184:199]
s_nop 11
v_mov_b32 v9, v184
p1q_46:
s_mul_i32 s18, s30, 21846
s_lshr_b32 s18, s18, 16
s_mul_i32 s18, s18, 3
s_sub_u32 s18, s30, s18
s_and_b32 s19, s30, 3
s_cmp_lt_u32 s30, 56
s_cselect_b32 s18, s18, s19
s_mul_i32 s18, s18, 2560
s_add_u32 s18, s18, 11665408
s_add_u32 s29, s30, 1
s_cmp_lg_u32 s13, 0
s_cbranch_scc1 polld_48
v_lshlrev_b32 v3, 3, v0
v_min_u32 v16, 2432, v3
s_mov_b32 s17, 0
poll_47:
buffer_load_dword v12, v16, s[4:7], s18 offen sc1
s_add_u32 s17, s17, 1
s_cmp_gt_u32 s17, 262144
s_cbranch_scc1 L_fail
s_waitcnt vmcnt(0)
v_cmp_gt_u32 vcc, s29, v12
s_cbranch_vccz polld_48
s_sleep 2
s_branch poll_47
polld_48:
s_barrier
s_mul_i32 s18, s30, 40960
s_add_u32 s26, s18, 91226112
s_add_u32 s26, s26, s31
s_add_u32 s27, s18, 100663296
s_add_u32 s27, s27, s33
s_add_u32 m0, s31, 2048
s_add_u32 s20, s26, 0
buffer_load_dwordx4 v0, s[4:7], s20 offen sc1 lds
s_add_u32 m0, s31, 3072
s_add_u32 s20, s26, 1024
buffer_load_dwordx4 v0, s[4:7], s20 offen sc1 lds
s_add_u32 m0, s31, 4096
s_add_u32 s20, s26, 2048
buffer_load_dwordx4 v0, s[4:7], s20 offen sc1 lds
s_add_u32 m0, s31, 5120
s_add_u32 s20, s26, 3072
buffer_load_dwordx4 v0, s[4:7], s20 offen sc1 lds
s_add_u32 m0, s31, 6144
s_add_u32 s20, s26, 4096
buffer_load_dwordx4 v0, s[4:7], s20 offen sc1 lds
s_add_u32 m0, s31, 7168
s_add_u32 s20, s26, 5120
buffer_load_dwordx4 v0, s[4:7], s20 offen sc1 lds
s_add_u32 m0, s31, 8192
s_add_u32 s20, s26, 6144
buffer_load_dwordx4 v0, s[4:7], s20 offen sc1 lds
s_add_u32 m0, s31, 9216
s_add_u32 s20, s26, 7168
buffer_load_dwordx4 v0, s[4:7], s20 offen sc1 lds
s_add_u32 m0, s31, 10240
s_add_u32 s20, s26, 8192
buffer_load_dwordx4 v0, s[4:7], s20 offen sc1 lds
s_add_u32 m0, s31, 11264
s_add_u32 s20, s26, 9216
buffer_load_dwordx4 v0, s[4:7], s20 offen sc1 lds
s_waitcnt vmcnt(0)
s_barrier
v_add_u32 v2, s31, v0
ds_read_b128 v[220:223], v2 offset:2048
ds_read_b128 v[224:227], v2 offset:3072
ds_read_b128 v[228:231], v2 offset:4096
ds_read_b128 v[200:203], v0 offset:3072
ds_read_b128 v[232:235], v2 offset:5120
ds_read_b128 v[196:199], v0 offset:2048
v_mov_b64 v[212:213], 0
ds_read_b128 v[204:207], v0 offset:4096
ds_read_b128 v[208:211], v0 offset:5120
s_waitcnt lgkmcnt(7)
v_dot2c_f32_bf16 v212, s24, v220
v_dot2c_f32_bf16 v213, v220, v220
v_dot2c_f32_bf16 v212, s24, v221
v_dot2c_f32_bf16 v213, v221, v221
v_dot2c_f32_bf16 v212, s24, v222
v_dot2c_f32_bf16 v213, v222, v222
v_dot2c_f32_bf16 v212, s24, v223
s_waitcnt lgkmcnt(5)
v_dot2c_f32_bf16 v213, v223, v223
v_dot2c_f32_bf16 v212, s24, v224
v_dot2c_f32_bf16 v213, v224, v224
v_dot2c_f32_bf16 v212, s24, v225
v_dot2c_f32_bf16 v213, v225, v225
v_dot2c_f32_bf16 v212, s24, v226
v_dot2c_f32_bf16 v213, v226, v226
v_dot2c_f32_bf16 v212, s24, v227
v_dot2c_f32_bf16 v213, v227, v227
v_dot2c_f32_bf16 v212, s24, v228
v_dot2c_f32_bf16 v213, v228, v228
s_waitcnt lgkmcnt(3)
ds_read_b128 v[220:223], v2 offset:6144
ds_read_b128 v[224:227], v2 offset:7168
v_dot2c_f32_bf16 v212, s24, v229
v_dot2c_f32_bf16 v213, v229, v229
v_dot2c_f32_bf16 v212, s24, v230
v_dot2c_f32_bf16 v213, v230, v230
v_dot2c_f32_bf16 v212, s24, v231
v_dot2c_f32_bf16 v213, v231, v231
v_dot2c_f32_bf16 v212, s24, v232
v_dot2c_f32_bf16 v213, v232, v232
v_dot2c_f32_bf16 v212, s24, v233
v_dot2c_f32_bf16 v213, v233, v233
v_dot2c_f32_bf16 v212, s24, v234
v_dot2c_f32_bf16 v213, v234, v234
v_dot2c_f32_bf16 v212, s24, v235
v_dot2c_f32_bf16 v213, v235, v235
s_waitcnt lgkmcnt(1)
ds_read_b128 v[232:235], v2 offset:9216
ds_read_b128 v[228:231], v2 offset:8192
v_dot2c_f32_bf16 v212, s24, v220
v_dot2c_f32_bf16 v213, v220, v220
v_dot2c_f32_bf16 v212, s24, v221
s_waitcnt lgkmcnt(2)
v_dot2c_f32_bf16 v213, v221, v221
v_dot2c_f32_bf16 v212, s24, v222
v_dot2c_f32_bf16 v213, v222, v222
v_dot2c_f32_bf16 v212, s24, v223
v_dot2c_f32_bf16 v213, v223, v223
v_dot2c_f32_bf16 v212, s24, v224
v_dot2c_f32_bf16 v213, v224, v224
v_dot2c_f32_bf16 v212, s24, v225
v_dot2c_f32_bf16 v213, v225, v225
v_dot2c_f32_bf16 v212, s24, v226
v_dot2c_f32_bf16 v213, v226, v226
v_dot2c_f32_bf16 v212, s24, v227
v_dot2c_f32_bf16 v213, v227, v227
s_waitcnt lgkmcnt(0)
ds_read_b128 v[220:223], v2 offset:10240
ds_read_b128 v[224:227], v2 offset:11264
v_dot2c_f32_bf16 v212, s24, v228
v_dot2c_f32_bf16 v213, v228, v228
v_dot2c_f32_bf16 v212, s24, v229
v_dot2c_f32_bf16 v213, v229, v229
v_dot2c_f32_bf16 v212, s24, v230
v_dot2c_f32_bf16 v213, v230, v230
v_dot2c_f32_bf16 v212, s24, v231
v_dot2c_f32_bf16 v213, v231, v231
v_dot2c_f32_bf16 v212, s24, v232
v_dot2c_f32_bf16 v213, v232, v232
v_dot2c_f32_bf16 v212, s24, v233
v_dot2c_f32_bf16 v213, v233, v233
v_dot2c_f32_bf16 v212, s24, v234
v_dot2c_f32_bf16 v213, v234, v234
s_waitcnt lgkmcnt(1)
v_dot2c_f32_bf16 v212, s24, v235
v_dot2c_f32_bf16 v213, v235, v235
v_dot2c_f32_bf16 v212, s24, v220
s_waitcnt lgkmcnt(0)
v_dot2c_f32_bf16 v213, v220, v220
v_dot2c_f32_bf16 v212, s24, v221
v_dot2c_f32_bf16 v213, v221, v221
v_dot2c_f32_bf16 v212, s24, v222
v_dot2c_f32_bf16 v213, v222, v222
v_dot2c_f32_bf16 v212, s24, v223
v_dot2c_f32_bf16 v213, v223, v223
v_dot2c_f32_bf16 v212, s24, v224
v_dot2c_f32_bf16 v213, v224, v224
v_dot2c_f32_bf16 v212, s24, v225
v_dot2c_f32_bf16 v213, v225, v225
v_dot2c_f32_bf16 v212, s24, v226
v_dot2c_f32_bf16 v213, v226, v226
v_dot2c_f32_bf16 v212, s24, v227
v_dot2c_f32_bf16 v213, v227, v227
v_mfma_f32_32x32x16_bf16 v[180:195], v[196:199], v[20:23], 0
s_nop 1
v_permlane32_swap_b32 v212, v213
ds_read_b128 v[196:199], v0 offset:6144
v_mfma_f32_32x32x16_bf16 v[180:195], v[200:203], v[24:27], v[180:195]
v_and_b32 v2, 0x1ff, v0
v_add_f32 v212, v212, v213
v_mfma_f32_32x32x16_bf16 v[180:195], v[204:207], v[28:31], v[180:195]
v_lshl_add_u32 v213, s13, 2, v0
ds_read_b128 v[200:203], v0 offset:7168
ds_write_b32 v213, v212 offset:0
v_mfma_f32_32x32x16_bf16 v[180:195], v[208:211], v[32:35], v[180:195]
s_waitcnt lgkmcnt(2)
ds_read_b128 v[204:207], v0 offset:8192
ds_read_b128 v[208:211], v0 offset:9216
v_mfma_f32_32x32x16_bf16 v[180:195], v[196:199], v[36:39], v[180:195]
s_waitcnt lgkmcnt(3)
v_mfma_f32_32x32x16_bf16 v[180:195], v[200:203], v[40:43], v[180:195]
s_waitcnt lgkmcnt(2)
ds_read_b128 v[196:199], v0 offset:10240
s_waitcnt lgkmcnt(2)
s_waitcnt lgkmcnt(1)
v_mfma_f32_32x32x16_bf16 v[180:195], v[204:207], v[44:47], v[180:195]
ds_read_b128 v[200:203], v0 offset:11264
s_barrier
ds_read_b128 v[212:215], v2 offset:0
v_mfma_f32_32x32x16_bf16 v[180:195], v[208:211], v[48:51], v[180:195]
ds_read_b128 v[208:211], v0 offset:13312
ds_read_b128 v[204:207], v0 offset:12288
s_waitcnt lgkmcnt(4)
v_mfma_f32_32x32x16_bf16 v[180:195], v[196:199], v[52:55], v[180:195]
s_waitcnt lgkmcnt(3)
ds_read_b128 v[216:219], v2 offset:512
ds_read_b128 v[196:199], v0 offset:14336
v_mfma_f32_32x32x16_bf16 v[180:195], v[200:203], v[56:59], v[180:195]
s_waitcnt lgkmcnt(2)
v_mfma_f32_32x32x16_bf16 v[180:195], v[204:207], v[60:63], v[180:195]
ds_read_b128 v[200:203], v0 offset:15360
ds_read_b128 v[204:207], v0 offset:16384
v_add_f32 v212, v212, v213
v_add_f32 v214, v214, v215
s_waitcnt lgkmcnt(3)
v_mfma_f32_32x32x16_bf16 v[180:195], v[208:211], v[64:67], v[180:195]
s_waitcnt lgkmcnt(2)
ds_read_b128 v[208:211], v0 offset:17408
v_add_f32 v216, v216, v217
v_add_f32 v212, v212, v214
v_mfma_f32_32x32x16_bf16 v[180:195], v[196:199], v[68:71], v[180:195]
s_waitcnt lgkmcnt(2)
v_mfma_f32_32x32x16_bf16 v[180:195], v[200:203], v[72:75], v[180:195]
v_mul_f32 v212, 0x3acccccd, v212
s_waitcnt lgkmcnt(1)
ds_read_b128 v[196:199], v0 offset:18432
v_add_f32 v218, v218, v219
s_waitcnt lgkmcnt(1)
v_mfma_f32_32x32x16_bf16 v[180:195], v[204:207], v[76:79], v[180:195]
v_lshrrev_b32 v213, 2, v0
ds_read_b128 v[200:203], v0 offset:19456
v_mfma_f32_32x32x16_bf16 v[180:195], v[208:211], v[80:83], v[180:195]
ds_read_b128 v[204:207], v0 offset:20480
ds_read_b128 v[208:211], v0 offset:21504
v_add_f32 v216, v216, v218
v_mul_f32 v216, 0x3acccccd, v216
s_waitcnt lgkmcnt(3)
v_mfma_f32_32x32x16_bf16 v[180:195], v[196:199], v[84:87], v[180:195]
v_fma_f32 v216, -v212, v212, v216
s_waitcnt lgkmcnt(2)
v_max_f32 v216, 0, v216
v_add_f32 v216, 0x3727c5ac, v216
v_mfma_f32_32x32x16_bf16 v[180:195], v[200:203], v[88:91], v[180:195]
ds_read_b128 v[196:199], v0 offset:22528
s_waitcnt lgkmcnt(2)
v_bfe_u32 v214, v0, 5, 5
v_lshl_add_u32 v213, s13, 8, v213
v_mfma_f32_32x32x16_bf16 v[180:195], v[204:207], v[92:95], v[180:195]
ds_read_b128 v[200:203], v0 offset:23552
ds_read_b128 v[204:207], v0 offset:24576
v_rsq_f32 v216, v216
s_waitcnt lgkmcnt(3)
v_and_b32 v214, 16, v214
v_mfma_f32_32x32x16_bf16 v[180:195], v[208:211], v[96:99], v[180:195]
ds_read_b128 v[208:211], v0 offset:25600
s_waitcnt lgkmcnt(3)
v_mul_f32 v212, v216, v212
v_mfma_f32_32x32x16_bf16 v[180:195], v[196:199], v[100:103], v[180:195]
v_lshl_add_u32 v214, s13, 8, v214
v_permlane32_swap_b32 v216, v212
s_waitcnt lgkmcnt(2)
ds_read_b128 v[196:199], v0 offset:26624
v_mfma_f32_32x32x16_bf16 v[180:195], v[200:203], v[104:107], v[180:195]
ds_write_b32 v213, v216 offset:1024
s_waitcnt lgkmcnt(3)
s_waitcnt lgkmcnt(2)
v_mfma_f32_32x32x16_bf16 v[180:195], v[204:207], v[108:111], v[180:195]
ds_read_b128 v[244:247], v214 offset:1216
ds_read_b128 v[200:203], v0 offset:27648
v_mfma_f32_32x32x16_bf16 v[180:195], v[208:211], v[112:115], v[180:195]
ds_read_b128 v[204:207], v0 offset:28672
s_waitcnt lgkmcnt(4)
ds_read_b128 v[236:239], v214 offset:1152
v_mfma_f32_32x32x16_bf16 v[180:195], v[196:199], v[116:119], v[180:195]
ds_read_b128 v[208:211], v0 offset:29696
ds_read_b128 v[196:199], v0 offset:30720
s_waitcnt lgkmcnt(4)
v_mfma_f32_32x32x16_bf16 v[180:195], v[200:203], v[120:123], v[180:195]
ds_read_b128 v[232:235], v214 offset:1120
s_waitcnt lgkmcnt(4)
ds_read_b128 v[220:223], v214 offset:1024
ds_read_b128 v[200:203], v0 offset:31744
v_mfma_f32_32x32x16_bf16 v[180:195], v[204:207], v[124:127], v[180:195]
v_mul_f32 v245, v245, v9
s_waitcnt lgkmcnt(3)
ds_read_b128 v[204:207], v0 offset:32768
v_mfma_f32_32x32x16_bf16 v[180:195], v[208:211], v[128:131], v[180:195]
ds_read_b128 v[224:227], v214 offset:1056
v_mfma_f32_32x32x16_bf16 v[180:195], v[196:199], v[132:135], v[180:195]
ds_read_b128 v[208:211], v0 offset:33792
s_waitcnt lgkmcnt(3)
v_mfma_f32_32x32x16_bf16 v[180:195], v[200:203], v[136:139], v[180:195]
s_waitcnt lgkmcnt(2)
ds_read_b128 v[196:199], v0 offset:34816
ds_read_b128 v[228:231], v214 offset:1088
ds_read_b128 v[200:203], v0 offset:35840
ds_read_b128 v[248:251], v214 offset:1248
v_mfma_f32_32x32x16_bf16 v[180:195], v[204:207], v[140:143], v[180:195]
s_waitcnt lgkmcnt(4)
ds_read_b128 v[204:207], v0 offset:36864
v_mfma_f32_32x32x16_bf16 v[180:195], v[208:211], v[144:147], v[180:195]
v_mul_f32 v246, v246, v9
ds_read_b128 v[240:243], v214 offset:1184
s_waitcnt lgkmcnt(5)
v_mfma_f32_32x32x16_bf16 v[180:195], v[196:199], v[148:151], v[180:195]
ds_read_b128 v[208:211], v0 offset:37888
s_waitcnt lgkmcnt(3)
ds_read_b128 v[196:199], v0 offset:38912
v_mfma_f32_32x32x16_bf16 v[180:195], v[200:203], v[152:155], v[180:195]
ds_read_b128 v[200:203], v0 offset:39936
s_waitcnt lgkmcnt(4)
s_waitcnt lgkmcnt(3)
v_mul_f32 v244, v244, v9
v_mfma_f32_32x32x16_bf16 v[180:195], v[204:207], v[156:159], v[180:195]
v_mul_f32 v251, v251, v9
v_mul_f32 v249, v249, v9
v_mul_f32 v237, v237, v9
s_waitcnt lgkmcnt(2)
v_mfma_f32_32x32x16_bf16 v[180:195], v[208:211], v[160:163], v[180:195]
ds_read_b128 v[204:207], v0 offset:40960
s_waitcnt lgkmcnt(1)
ds_read_b128 v[208:211], v0 offset:41984
v_mul_f32 v236, v236, v9
v_mfma_f32_32x32x16_bf16 v[180:195], v[196:199], v[164:167], v[180:195]
v_mul_f32 v250, v250, v9
v_mul_f32 v248, v248, v9
v_mul_f32 v240, v240, v9
v_mfma_f32_32x32x16_bf16 v[180:195], v[200:203], v[168:171], v[180:195]
s_waitcnt lgkmcnt(0)
v_mul_f32 v243, v243, v9
v_mfma_f32_32x32x16_bf16 v[180:195], v[204:207], v[172:175], v[180:195]
v_mul_f32 v242, v242, v9
v_mfma_f32_32x32x16_bf16 v[180:195], v[208:211], v[176:179], v[180:195]
s_nop 0
v_mul_f32 v241, v241, v9
v_mul_f32 v239, v239, v9
v_mul_f32 v238, v238, v9
v_mul_f32 v247, v247, v9
s_nop 6
v_pk_fma_f32 v[188:189], v[188:189], v[228:229], v[244:245] neg_lo:[0,0,1] neg_hi:[0,0,1]
v_pk_fma_f32 v[186:187], v[186:187], v[226:227], v[242:243] neg_lo:[0,0,1] neg_hi:[0,0,1]
v_pk_fma_f32 v[184:185], v[184:185], v[224:225], v[240:241] neg_lo:[0,0,1] neg_hi:[0,0,1]
v_pk_fma_f32 v[192:193], v[192:193], v[232:233], v[248:249] neg_lo:[0,0,1] neg_hi:[0,0,1]
v_pk_fma_f32 v[180:181], v[180:181], v[220:221], v[236:237] neg_lo:[0,0,1] neg_hi:[0,0,1]
v_cvt_pk_bf16_f32 v198, v184, v185
v_pk_fma_f32 v[182:183], v[182:183], v[222:223], v[238:239] neg_lo:[0,0,1] neg_hi:[0,0,1]
v_cvt_pk_bf16_f32 v202, v192, v193
v_pk_fma_f32 v[194:195], v[194:195], v[234:235], v[250:251] neg_lo:[0,0,1] neg_hi:[0,0,1]
v_cvt_pk_bf16_f32 v203, v194, v195
v_cvt_pk_bf16_f32 v199, v186, v187
v_pk_fma_f32 v[190:191], v[190:191], v[230:231], v[246:247] neg_lo:[0,0,1] neg_hi:[0,0,1]
v_cvt_pk_bf16_f32 v197, v182, v183
v_cvt_pk_bf16_f32 v200, v188, v189
v_cvt_pk_bf16_f32 v201, v190, v191
v_cvt_pk_bf16_f32 v196, v180, v181
buffer_store_dwordx4 v[196:199], v10, s[4:7], s27 offen offset:0 sc1
buffer_store_dwordx4 v[200:203], v10, s[4:7], s27 offen offset:1024 sc1
s_add_u32 s30, s30, 3
s_cmp_lt_u32 s30, 60
s_cbranch_scc1 p1q_46
s_lshl_b32 s18, s54, 7
s_add_u32 s18, s18, 11552768
s_cmp_eq_u32 s13, 0
s_cselect_b32 s22, s18, s6
s_mov_b32 s23, 1
s_waitcnt vmcnt(0)
s_barrier
v_mov_b32 v3, s23
s_mov_b64 exec, 1
buffer_store_dword v3, off, s[4:7], s22 sc1
s_mov_b64 exec, -1
s_mov_b32 s22, s6
s_mov_b32 s34, s55
kvz_45:
s_add_u32 s16, s16, 1
s_cmp_lt_u32 s16, 2
s_cbranch_scc1 kvlay_29
s_endpgm
roleA_12:
s_sub_u32 s39, s15, 64
s_mul_i32 s50, s39, 13108
s_lshr_b32 s50, s50, 16
s_mul_i32 s18, s50, 5
s_sub_u32 s34, s39, s18
s_waitcnt vmcnt(0)
v_bfe_u32 v5, v0, 4, 5
v_mul_u32_u24 v5, 1280, v5
v_lshrrev_b32 v8, 9, v0
v_lshl_add_u32 v5, v8, 4, v5
v_and_b32 v6, 0x1ff, v0
v_lshlrev_b32 v6, 1, v6
v_lshl_add_u32 v6, v8, 4, v6
s_load_dwordx2 s[44:45], s[0:1], 0
s_mov_b32 s46, 2621440
s_mov_b32 s47, 0x20000
s_waitcnt lgkmcnt(0)
v_lshrrev_b32 v8, 7, v0
v_lshl_add_u32 v8, s13, 3, v8
v_bfe_u32 v9, v8, 1, 3
v_lshlrev_b32 v9, 4, v9
v_xor_b32 v9, v9, v0
v_and_b32 v9, 0x70, v9
v_mul_u32_u24 v8, 1280, v8
v_add_u32 v8, v8, v9
s_mul_i32 s26, s50, 40960
s_lshl_b32 s25, s13, 10
s_add_u32 m0, s25, 2048
s_add_u32 s20, s26, 0
buffer_load_dwordx4 v8, s[44:47], s20 offen sc1 lds
s_add_u32 m0, s25, 6144
s_add_u32 s20, s26, 128
buffer_load_dwordx4 v8, s[44:47], s20 offen sc1 lds
s_add_u32 m0, s25, 10240
s_add_u32 s20, s26, 256
buffer_load_dwordx4 v8, s[44:47], s20 offen sc1 lds
s_add_u32 m0, s25, 14336
s_add_u32 s20, s26, 384
buffer_load_dwordx4 v8, s[44:47], s20 offen sc1 lds
s_add_u32 m0, s25, 18432
s_add_u32 s20, s26, 512
buffer_load_dwordx4 v8, s[44:47], s20 offen sc1 lds
s_add_u32 m0, s25, 22528
s_add_u32 s20, s26, 640
buffer_load_dwordx4 v8, s[44:47], s20 offen sc1 lds
s_add_u32 m0, s25, 26624
s_add_u32 s20, s26, 768
buffer_load_dwordx4 v8, s[44:47], s20 offen sc1 lds
s_add_u32 m0, s25, 30720
s_add_u32 s20, s26, 896
buffer_load_dwordx4 v8, s[44:47], s20 offen sc1 lds
s_add_u32 m0, s25, 34816
s_add_u32 s20, s26, 1024
buffer_load_dwordx4 v8, s[44:47], s20 offen sc1 lds
s_add_u32 m0, s25, 38912
s_add_u32 s20, s26, 1152
buffer_load_dwordx4 v8, s[44:47], s20 offen sc1 lds
s_add_u32 s26, s26, 1310720
s_add_u32 s25, s25, 40960
v_bfe_u32 v176, v0, 5, 3
v_lshrrev_b32 v9, 9, v0
v_xor_b32 v176, v176, v9
v_lshlrev_b32 v176, 4, v176
v_and_b32 v9, 0x1f0, v0
v_lshl_add_u32 v176, v9, 3, v176
v_xor_b32 v177, 32, v176
v_xor_b32 v178, 64, v176
v_xor_b32 v179, 96, v176
s_lshl_b32 s18, s34, 7
s_lshl_b32 s19, s13, 5
s_add_u32 s18, s18, s19
s_mov_b32 s19, 0x3acccccd
v_bfe_u32 v202, v0, 4, 5
v_lshrrev_b32 v197, 9, v0
v_add_u32 v202, s18, v202
v_and_b32 v201, 1, v202
v_mul_u32_u24 v201, 160, v201
v_lshrrev_b32 v200, 1, v202
v_add_u32 v200, 1, v200
v_lshlrev_b32 v197, 3, v197
v_mad_u32_u24 v201, v197, v200, v201
v_mad_u32_u24 v196, v200, 16, 0
v_cvt_f32_u32 v196, v196
v_mul_f32 v202, s19, v196
v_rndne_f32 v202, v202
v_fmac_f32 v196, 0xc4200000, v202
v_mul_f32 v196, s19, v196
v_cos_f32 v196, v196
s_nop 0
v_add_f32 v196, v196, v196
v_mad_u32_u24 v198, v200, 1, 0
v_cvt_f32_u32 v198, v198
v_mul_f32 v202, s19, v198
v_rndne_f32 v202, v202
v_fmac_f32 v198, 0xc4200000, v202
v_mul_f32 v198, s19, v198
v_cos_f32 v198, v198
s_nop 0
v_add_f32 v198, v198, v198
v_mad_u32_u24 v183, v200, 3, v201
v_cvt_f32_u32 v183, v183
v_mul_f32 v202, s19, v183
v_rndne_f32 v202, v202
v_fmac_f32 v183, 0xc4200000, v202
v_mul_f32 v183, s19, v183
v_cos_f32 v183, v183
v_mad_u32_u24 v184, v200, 4, v201
v_cvt_f32_u32 v184, v184
v_mul_f32 v202, s19, v184
v_rndne_f32 v202, v202
v_fmac_f32 v184, 0xc4200000, v202
v_mul_f32 v184, s19, v184
v_cos_f32 v184, v184
s_nop 0
v_fma_f32 v185, v198, v184, -v183
v_fma_f32 v182, v198, v183, -v184
v_fma_f32 v186, v198, v185, -v184
v_fma_f32 v181, v198, v182, -v183
v_fma_f32 v187, v198, v186, -v185
v_fma_f32 v180, v198, v181, -v182
v_cvt_pk_bf16_f32 v16, v180, v181
v_cvt_pk_bf16_f32 v17, v182, v183
v_cvt_pk_bf16_f32 v18, v184, v185
v_cvt_pk_bf16_f32 v19, v186, v187
v_mad_u32_u24 v191, v200, 19, v201
v_cvt_f32_u32 v191, v191
v_mul_f32 v202, s19, v191
v_rndne_f32 v202, v202
v_fmac_f32 v191, 0xc4200000, v202
v_mul_f32 v191, s19, v191
v_cos_f32 v191, v191
v_mad_u32_u24 v192, v200, 20, v201
v_cvt_f32_u32 v192, v192
v_mul_f32 v202, s19, v192
v_rndne_f32 v202, v202
v_fmac_f32 v192, 0xc4200000, v202
v_mul_f32 v192, s19, v192
v_cos_f32 v192, v192
s_nop 0
v_fma_f32 v193, v198, v192, -v191
v_fma_f32 v190, v198, v191, -v192
v_fma_f32 v194, v198, v193, -v192
v_fma_f32 v189, v198, v190, -v191
v_fma_f32 v195, v198, v194, -v193
v_fma_f32 v188, v198, v189, -v190
v_cvt_pk_bf16_f32 v20, v188, v189
v_cvt_pk_bf16_f32 v21, v190, v191
v_cvt_pk_bf16_f32 v22, v192, v193
v_cvt_pk_bf16_f32 v23, v194, v195
v_pk_fma_f32 v[180:181], v[196:197], v[188:189], v[180:181] op_sel_hi:[0,1,1] neg_lo:[0,0,1] neg_hi:[0,0,1]
v_pk_fma_f32 v[182:183], v[196:197], v[190:191], v[182:183] op_sel_hi:[0,1,1] neg_lo:[0,0,1] neg_hi:[0,0,1]
v_pk_fma_f32 v[184:185], v[196:197], v[192:193], v[184:185] op_sel_hi:[0,1,1] neg_lo:[0,0,1] neg_hi:[0,0,1]
v_pk_fma_f32 v[186:187], v[196:197], v[194:195], v[186:187] op_sel_hi:[0,1,1] neg_lo:[0,0,1] neg_hi:[0,0,1]
v_cvt_pk_bf16_f32 v24, v180, v181
v_cvt_pk_bf16_f32 v25, v182, v183
v_cvt_pk_bf16_f32 v26, v184, v185
v_cvt_pk_bf16_f32 v27, v186, v187
s_add_u32 m0, s25, 2048
s_add_u32 s21, s26, 0
buffer_load_dwordx4 v8, s[44:47], s21 offen lds
v_pk_fma_f32 v[188:189], v[196:197], v[180:181], v[188:189] op_sel_hi:[0,1,1] neg_lo:[0,0,1] neg_hi:[0,0,1]
v_pk_fma_f32 v[190:191], v[196:197], v[182:183], v[190:191] op_sel_hi:[0,1,1] neg_lo:[0,0,1] neg_hi:[0,0,1]
v_pk_fma_f32 v[192:193], v[196:197], v[184:185], v[192:193] op_sel_hi:[0,1,1] neg_lo:[0,0,1] neg_hi:[0,0,1]
v_pk_fma_f32 v[194:195], v[196:197], v[186:187], v[194:195] op_sel_hi:[0,1,1] neg_lo:[0,0,1] neg_hi:[0,0,1]
v_cvt_pk_bf16_f32 v28, v188, v189
v_cvt_pk_bf16_f32 v29, v190, v191
v_cvt_pk_bf16_f32 v30, v192, v193
v_cvt_pk_bf16_f32 v31, v194, v195
s_add_u32 m0, s25, 6144
s_add_u32 s21, s26, 128
buffer_load_dwordx4 v8, s[44:47], s21 offen lds
v_pk_fma_f32 v[180:181], v[196:197], v[188:189], v[180:181] op_sel_hi:[0,1,1] neg_lo:[0,0,1] neg_hi:[0,0,1]
v_pk_fma_f32 v[182:183], v[196:197], v[190:191], v[182:183] op_sel_hi:[0,1,1] neg_lo:[0,0,1] neg_hi:[0,0,1]
v_pk_fma_f32 v[184:185], v[196:197], v[192:193], v[184:185] op_sel_hi:[0,1,1] neg_lo:[0,0,1] neg_hi:[0,0,1]
v_pk_fma_f32 v[186:187], v[196:197], v[194:195], v[186:187] op_sel_hi:[0,1,1] neg_lo:[0,0,1] neg_hi:[0,0,1]
v_cvt_pk_bf16_f32 v32, v180, v181
v_cvt_pk_bf16_f32 v33, v182, v183
v_cvt_pk_bf16_f32 v34, v184, v185
v_cvt_pk_bf16_f32 v35, v186, v187
s_add_u32 m0, s25, 10240
s_add_u32 s21, s26, 256
buffer_load_dwordx4 v8, s[44:47], s21 offen lds
v_pk_fma_f32 v[188:189], v[196:197], v[180:181], v[188:189] op_sel_hi:[0,1,1] neg_lo:[0,0,1] neg_hi:[0,0,1]
v_pk_fma_f32 v[190:191], v[196:197], v[182:183], v[190:191] op_sel_hi:[0,1,1] neg_lo:[0,0,1] neg_hi:[0,0,1]
v_pk_fma_f32 v[192:193], v[196:197], v[184:185], v[192:193] op_sel_hi:[0,1,1] neg_lo:[0,0,1] neg_hi:[0,0,1]
v_pk_fma_f32 v[194:195], v[196:197], v[186:187], v[194:195] op_sel_hi:[0,1,1] neg_lo:[0,0,1] neg_hi:[0,0,1]
v_cvt_pk_bf16_f32 v36, v188, v189
v_cvt_pk_bf16_f32 v37, v190, v191
v_cvt_pk_bf16_f32 v38, v192, v193
v_cvt_pk_bf16_f32 v39, v194, v195
s_add_u32 m0, s25, 14336
s_add_u32 s21, s26, 384
buffer_load_dwordx4 v8, s[44:47], s21 offen lds
v_pk_fma_f32 v[180:181], v[196:197], v[188:189], v[180:181] op_sel_hi:[0,1,1] neg_lo:[0,0,1] neg_hi:[0,0,1]
v_pk_fma_f32 v[182:183], v[196:197], v[190:191], v[182:183] op_sel_hi:[0,1,1] neg_lo:[0,0,1] neg_hi:[0,0,1]
v_pk_fma_f32 v[184:185], v[196:197], v[192:193], v[184:185] op_sel_hi:[0,1,1] neg_lo:[0,0,1] neg_hi:[0,0,1]
v_pk_fma_f32 v[186:187], v[196:197], v[194:195], v[186:187] op_sel_hi:[0,1,1] neg_lo:[0,0,1] neg_hi:[0,0,1]
v_cvt_pk_bf16_f32 v40, v180, v181
v_cvt_pk_bf16_f32 v41, v182, v183
v_cvt_pk_bf16_f32 v42, v184, v185
v_cvt_pk_bf16_f32 v43, v186, v187
s_add_u32 m0, s25, 18432
s_add_u32 s21, s26, 512
buffer_load_dwordx4 v8, s[44:47], s21 offen lds
v_pk_fma_f32 v[188:189], v[196:197], v[180:181], v[188:189] op_sel_hi:[0,1,1] neg_lo:[0,0,1] neg_hi:[0,0,1]
v_pk_fma_f32 v[190:191], v[196:197], v[182:183], v[190:191] op_sel_hi:[0,1,1] neg_lo:[0,0,1] neg_hi:[0,0,1]
v_pk_fma_f32 v[192:193], v[196:197], v[184:185], v[192:193] op_sel_hi:[0,1,1] neg_lo:[0,0,1] neg_hi:[0,0,1]
v_pk_fma_f32 v[194:195], v[196:197], v[186:187], v[194:195] op_sel_hi:[0,1,1] neg_lo:[0,0,1] neg_hi:[0,0,1]
v_cvt_pk_bf16_f32 v44, v188, v189
v_cvt_pk_bf16_f32 v45, v190, v191
v_cvt_pk_bf16_f32 v46, v192, v193
v_cvt_pk_bf16_f32 v47, v194, v195
s_add_u32 m0, s25, 22528
s_add_u32 s21, s26, 640
buffer_load_dwordx4 v8, s[44:47], s21 offen lds
v_pk_fma_f32 v[180:181], v[196:197], v[188:189], v[180:181] op_sel_hi:[0,1,1] neg_lo:[0,0,1] neg_hi:[0,0,1]
v_pk_fma_f32 v[182:183], v[196:197], v[190:191], v[182:183] op_sel_hi:[0,1,1] neg_lo:[0,0,1] neg_hi:[0,0,1]
v_pk_fma_f32 v[184:185], v[196:197], v[192:193], v[184:185] op_sel_hi:[0,1,1] neg_lo:[0,0,1] neg_hi:[0,0,1]
v_pk_fma_f32 v[186:187], v[196:197], v[194:195], v[186:187] op_sel_hi:[0,1,1] neg_lo:[0,0,1] neg_hi:[0,0,1]
v_cvt_pk_bf16_f32 v48, v180, v181
v_cvt_pk_bf16_f32 v49, v182, v183
v_cvt_pk_bf16_f32 v50, v184, v185
v_cvt_pk_bf16_f32 v51, v186, v187
s_add_u32 m0, s25, 26624
s_add_u32 s21, s26, 768
buffer_load_dwordx4 v8, s[44:47], s21 offen lds
v_pk_fma_f32 v[188:189], v[196:197], v[180:181], v[188:189] op_sel_hi:[0,1,1] neg_lo:[0,0,1] neg_hi:[0,0,1]
v_pk_fma_f32 v[190:191], v[196:197], v[182:183], v[190:191] op_sel_hi:[0,1,1] neg_lo:[0,0,1] neg_hi:[0,0,1]
v_pk_fma_f32 v[192:193], v[196:197], v[184:185], v[192:193] op_sel_hi:[0,1,1] neg_lo:[0,0,1] neg_hi:[0,0,1]
v_pk_fma_f32 v[194:195], v[196:197], v[186:187], v[194:195] op_sel_hi:[0,1,1] neg_lo:[0,0,1] neg_hi:[0,0,1]
v_cvt_pk_bf16_f32 v52, v188, v189
v_cvt_pk_bf16_f32 v53, v190, v191
v_cvt_pk_bf16_f32 v54, v192, v193
v_cvt_pk_bf16_f32 v55, v194, v195
s_add_u32 m0, s25, 30720
s_add_u32 s21, s26, 896
buffer_load_dwordx4 v8, s[44:47], s21 offen lds
v_pk_fma_f32 v[180:181], v[196:197], v[188:189], v[180:181] op_sel_hi:[0,1,1] neg_lo:[0,0,1] neg_hi:[0,0,1]
v_pk_fma_f32 v[182:183], v[196:197], v[190:191], v[182:183] op_sel_hi:[0,1,1] neg_lo:[0,0,1] neg_hi:[0,0,1]
v_pk_fma_f32 v[184:185], v[196:197], v[192:193], v[184:185] op_sel_hi:[0,1,1] neg_lo:[0,0,1] neg_hi:[0,0,1]
v_pk_fma_f32 v[186:187], v[196:197], v[194:195], v[186:187] op_sel_hi:[0,1,1] neg_lo:[0,0,1] neg_hi:[0,0,1]
v_cvt_pk_bf16_f32 v56, v180, v181
v_cvt_pk_bf16_f32 v57, v182, v183
v_cvt_pk_bf16_f32 v58, v184, v185
v_cvt_pk_bf16_f32 v59, v186, v187
s_add_u32 m0, s25, 34816
s_add_u32 s21, s26, 1024
buffer_load_dwordx4 v8, s[44:47], s21 offen lds
v_pk_fma_f32 v[188:189], v[196:197], v[180:181], v[188:189] op_sel_hi:[0,1,1] neg_lo:[0,0,1] neg_hi:[0,0,1]
v_pk_fma_f32 v[190:191], v[196:197], v[182:183], v[190:191] op_sel_hi:[0,1,1] neg_lo:[0,0,1] neg_hi:[0,0,1]
v_pk_fma_f32 v[192:193], v[196:197], v[184:185], v[192:193] op_sel_hi:[0,1,1] neg_lo:[0,0,1] neg_hi:[0,0,1]
v_pk_fma_f32 v[194:195], v[196:197], v[186:187], v[194:195] op_sel_hi:[0,1,1] neg_lo:[0,0,1] neg_hi:[0,0,1]
v_cvt_pk_bf16_f32 v60, v188, v189
v_cvt_pk_bf16_f32 v61, v190, v191
v_cvt_pk_bf16_f32 v62, v192, v193
v_cvt_pk_bf16_f32 v63, v194, v195
s_add_u32 m0, s25, 38912
s_add_u32 s21, s26, 1152
buffer_load_dwordx4 v8, s[44:47], s21 offen lds
v_pk_fma_f32 v[180:181], v[196:197], v[188:189], v[180:181] op_sel_hi:[0,1,1] neg_lo:[0,0,1] neg_hi:[0,0,1]
v_pk_fma_f32 v[182:183], v[196:197], v[190:191], v[182:183] op_sel_hi:[0,1,1] neg_lo:[0,0,1] neg_hi:[0,0,1]
v_pk_fma_f32 v[184:185], v[196:197], v[192:193], v[184:185] op_sel_hi:[0,1,1] neg_lo:[0,0,1] neg_hi:[0,0,1]
v_pk_fma_f32 v[186:187], v[196:197], v[194:195], v[186:187] op_sel_hi:[0,1,1] neg_lo:[0,0,1] neg_hi:[0,0,1]
v_cvt_pk_bf16_f32 v64, v180, v181
v_cvt_pk_bf16_f32 v65, v182, v183
v_cvt_pk_bf16_f32 v66, v184, v185
v_cvt_pk_bf16_f32 v67, v186, v187
v_pk_fma_f32 v[188:189], v[196:197], v[180:181], v[188:189] op_sel_hi:[0,1,1] neg_lo:[0,0,1] neg_hi:[0,0,1]
v_pk_fma_f32 v[190:191], v[196:197], v[182:183], v[190:191] op_sel_hi:[0,1,1] neg_lo:[0,0,1] neg_hi:[0,0,1]
v_pk_fma_f32 v[192:193], v[196:197], v[184:185], v[192:193] op_sel_hi:[0,1,1] neg_lo:[0,0,1] neg_hi:[0,0,1]
v_pk_fma_f32 v[194:195], v[196:197], v[186:187], v[194:195] op_sel_hi:[0,1,1] neg_lo:[0,0,1] neg_hi:[0,0,1]
v_cvt_pk_bf16_f32 v68, v188, v189
v_cvt_pk_bf16_f32 v69, v190, v191
v_cvt_pk_bf16_f32 v70, v192, v193
v_cvt_pk_bf16_f32 v71, v194, v195
v_pk_fma_f32 v[180:181], v[196:197], v[188:189], v[180:181] op_sel_hi:[0,1,1] neg_lo:[0,0,1] neg_hi:[0,0,1]
v_pk_fma_f32 v[182:183], v[196:197], v[190:191], v[182:183] op_sel_hi:[0,1,1] neg_lo:[0,0,1] neg_hi:[0,0,1]
v_pk_fma_f32 v[184:185], v[196:197], v[192:193], v[184:185] op_sel_hi:[0,1,1] neg_lo:[0,0,1] neg_hi:[0,0,1]
v_pk_fma_f32 v[186:187], v[196:197], v[194:195], v[186:187] op_sel_hi:[0,1,1] neg_lo:[0,0,1] neg_hi:[0,0,1]
v_cvt_pk_bf16_f32 v72, v180, v181
v_cvt_pk_bf16_f32 v73, v182, v183
v_cvt_pk_bf16_f32 v74, v184, v185
v_cvt_pk_bf16_f32 v75, v186, v187
v_pk_fma_f32 v[188:189], v[196:197], v[180:181], v[188:189] op_sel_hi:[0,1,1] neg_lo:[0,0,1] neg_hi:[0,0,1]
v_pk_fma_f32 v[190:191], v[196:197], v[182:183], v[190:191] op_sel_hi:[0,1,1] neg_lo:[0,0,1] neg_hi:[0,0,1]
v_pk_fma_f32 v[192:193], v[196:197], v[184:185], v[192:193] op_sel_hi:[0,1,1] neg_lo:[0,0,1] neg_hi:[0,0,1]
v_pk_fma_f32 v[194:195], v[196:197], v[186:187], v[194:195] op_sel_hi:[0,1,1] neg_lo:[0,0,1] neg_hi:[0,0,1]
v_cvt_pk_bf16_f32 v76, v188, v189
v_cvt_pk_bf16_f32 v77, v190, v191
v_cvt_pk_bf16_f32 v78, v192, v193
v_cvt_pk_bf16_f32 v79, v194, v195
v_pk_fma_f32 v[180:181], v[196:197], v[188:189], v[180:181] op_sel_hi:[0,1,1] neg_lo:[0,0,1] neg_hi:[0,0,1]
v_pk_fma_f32 v[182:183], v[196:197], v[190:191], v[182:183] op_sel_hi:[0,1,1] neg_lo:[0,0,1] neg_hi:[0,0,1]
v_pk_fma_f32 v[184:185], v[196:197], v[192:193], v[184:185] op_sel_hi:[0,1,1] neg_lo:[0,0,1] neg_hi:[0,0,1]
v_pk_fma_f32 v[186:187], v[196:197], v[194:195], v[186:187] op_sel_hi:[0,1,1] neg_lo:[0,0,1] neg_hi:[0,0,1]
v_cvt_pk_bf16_f32 v80, v180, v181
v_cvt_pk_bf16_f32 v81, v182, v183
v_cvt_pk_bf16_f32 v82, v184, v185
v_cvt_pk_bf16_f32 v83, v186, v187
v_pk_fma_f32 v[188:189], v[196:197], v[180:181], v[188:189] op_sel_hi:[0,1,1] neg_lo:[0,0,1] neg_hi:[0,0,1]
v_pk_fma_f32 v[190:191], v[196:197], v[182:183], v[190:191] op_sel_hi:[0,1,1] neg_lo:[0,0,1] neg_hi:[0,0,1]
v_pk_fma_f32 v[192:193], v[196:197], v[184:185], v[192:193] op_sel_hi:[0,1,1] neg_lo:[0,0,1] neg_hi:[0,0,1]
v_pk_fma_f32 v[194:195], v[196:197], v[186:187], v[194:195] op_sel_hi:[0,1,1] neg_lo:[0,0,1] neg_hi:[0,0,1]
v_cvt_pk_bf16_f32 v84, v188, v189
v_cvt_pk_bf16_f32 v85, v190, v191
v_cvt_pk_bf16_f32 v86, v192, v193
v_cvt_pk_bf16_f32 v87, v194, v195
v_pk_fma_f32 v[180:181], v[196:197], v[188:189], v[180:181] op_sel_hi:[0,1,1] neg_lo:[0,0,1] neg_hi:[0,0,1]
v_pk_fma_f32 v[182:183], v[196:197], v[190:191], v[182:183] op_sel_hi:[0,1,1] neg_lo:[0,0,1] neg_hi:[0,0,1]
v_pk_fma_f32 v[184:185], v[196:197], v[192:193], v[184:185] op_sel_hi:[0,1,1] neg_lo:[0,0,1] neg_hi:[0,0,1]
v_pk_fma_f32 v[186:187], v[196:197], v[194:195], v[186:187] op_sel_hi:[0,1,1] neg_lo:[0,0,1] neg_hi:[0,0,1]
v_cvt_pk_bf16_f32 v88, v180, v181
v_cvt_pk_bf16_f32 v89, v182, v183
v_cvt_pk_bf16_f32 v90, v184, v185
v_cvt_pk_bf16_f32 v91, v186, v187
v_pk_fma_f32 v[188:189], v[196:197], v[180:181], v[188:189] op_sel_hi:[0,1,1] neg_lo:[0,0,1] neg_hi:[0,0,1]
v_pk_fma_f32 v[190:191], v[196:197], v[182:183], v[190:191] op_sel_hi:[0,1,1] neg_lo:[0,0,1] neg_hi:[0,0,1]
v_pk_fma_f32 v[192:193], v[196:197], v[184:185], v[192:193] op_sel_hi:[0,1,1] neg_lo:[0,0,1] neg_hi:[0,0,1]
v_pk_fma_f32 v[194:195], v[196:197], v[186:187], v[194:195] op_sel_hi:[0,1,1] neg_lo:[0,0,1] neg_hi:[0,0,1]
v_cvt_pk_bf16_f32 v92, v188, v189
v_cvt_pk_bf16_f32 v93, v190, v191
v_cvt_pk_bf16_f32 v94, v192, v193
v_cvt_pk_bf16_f32 v95, v194, v195
s_mov_b32 s20, 323
v_mad_u32_u24 v183, v200, s20, v201
v_cvt_f32_u32 v183, v183
v_mul_f32 v202, s19, v183
v_rndne_f32 v202, v202
v_fmac_f32 v183, 0xc4200000, v202
v_mul_f32 v183, s19, v183
v_cos_f32 v183, v183
s_mov_b32 s20, 324
v_mad_u32_u24 v184, v200, s20, v201
v_cvt_f32_u32 v184, v184
v_mul_f32 v202, s19, v184
v_rndne_f32 v202, v202
v_fmac_f32 v184, 0xc4200000, v202
v_mul_f32 v184, s19, v184
v_cos_f32 v184, v184
s_nop 0
v_fma_f32 v185, v198, v184, -v183
v_fma_f32 v182, v198, v183, -v184
v_fma_f32 v186, v198, v185, -v184
v_fma_f32 v181, v198, v182, -v183
v_fma_f32 v187, v198, v186, -v185
v_fma_f32 v180, v198, v181, -v182
v_cvt_pk_bf16_f32 v96, v180, v181
v_cvt_pk_bf16_f32 v97, v182, v183
v_cvt_pk_bf16_f32 v98, v184, v185
v_cvt_pk_bf16_f32 v99, v186, v187
s_mov_b32 s20, 339
v_mad_u32_u24 v191, v200, s20, v201
v_cvt_f32_u32 v191, v191
v_mul_f32 v202, s19, v191
v_rndne_f32 v202, v202
v_fmac_f32 v191, 0xc4200000, v202
v_mul_f32 v191, s19, v191
v_cos_f32 v191, v191
s_mov_b32 s20, 340
v_mad_u32_u24 v192, v200, s20, v201
v_cvt_f32_u32 v192, v192
v_mul_f32 v202, s19, v192
v_rndne_f32 v202, v202
v_fmac_f32 v192, 0xc4200000, v202
v_mul_f32 v192, s19, v192
v_cos_f32 v192, v192
s_nop 0
v_fma_f32 v193, v198, v192, -v191
v_fma_f32 v190, v198, v191, -v192
v_fma_f32 v194, v198, v193, -v192
v_fma_f32 v189, v198, v190, -v191
v_fma_f32 v195, v198, v194, -v193
v_fma_f32 v188, v198, v189, -v190
v_cvt_pk_bf16_f32 v100, v188, v189
v_cvt_pk_bf16_f32 v101, v190, v191
v_cvt_pk_bf16_f32 v102, v192, v193
v_cvt_pk_bf16_f32 v103, v194, v195
v_pk_fma_f32 v[180:181], v[196:197], v[188:189], v[180:181] op_sel_hi:[0,1,1] neg_lo:[0,0,1] neg_hi:[0,0,1]
v_pk_fma_f32 v[182:183], v[196:197], v[190:191], v[182:183] op_sel_hi:[0,1,1] neg_lo:[0,0,1] neg_hi:[0,0,1]
v_pk_fma_f32 v[184:185], v[196:197], v[192:193], v[184:185] op_sel_hi:[0,1,1] neg_lo:[0,0,1] neg_hi:[0,0,1]
v_pk_fma_f32 v[186:187], v[196:197], v[194:195], v[186:187] op_sel_hi:[0,1,1] neg_lo:[0,0,1] neg_hi:[0,0,1]
v_cvt_pk_bf16_f32 v104, v180, v181
v_cvt_pk_bf16_f32 v105, v182, v183
v_cvt_pk_bf16_f32 v106, v184, v185
v_cvt_pk_bf16_f32 v107, v186, v187
v_pk_fma_f32 v[188:189], v[196:197], v[180:181], v[188:189] op_sel_hi:[0,1,1] neg_lo:[0,0,1] neg_hi:[0,0,1]
v_pk_fma_f32 v[190:191], v[196:197], v[182:183], v[190:191] op_sel_hi:[0,1,1] neg_lo:[0,0,1] neg_hi:[0,0,1]
v_pk_fma_f32 v[192:193], v[196:197], v[184:185], v[192:193] op_sel_hi:[0,1,1] neg_lo:[0,0,1] neg_hi:[0,0,1]
v_pk_fma_f32 v[194:195], v[196:197], v[186:187], v[194:195] op_sel_hi:[0,1,1] neg_lo:[0,0,1] neg_hi:[0,0,1]
v_cvt_pk_bf16_f32 v108, v188, v189
v_cvt_pk_bf16_f32 v109, v190, v191
v_cvt_pk_bf16_f32 v110, v192, v193
v_cvt_pk_bf16_f32 v111, v194, v195
v_pk_fma_f32 v[180:181], v[196:197], v[188:189], v[180:181] op_sel_hi:[0,1,1] neg_lo:[0,0,1] neg_hi:[0,0,1]
v_pk_fma_f32 v[182:183], v[196:197], v[190:191], v[182:183] op_sel_hi:[0,1,1] neg_lo:[0,0,1] neg_hi:[0,0,1]
v_pk_fma_f32 v[184:185], v[196:197], v[192:193], v[184:185] op_sel_hi:[0,1,1] neg_lo:[0,0,1] neg_hi:[0,0,1]
v_pk_fma_f32 v[186:187], v[196:197], v[194:195], v[186:187] op_sel_hi:[0,1,1] neg_lo:[0,0,1] neg_hi:[0,0,1]
v_cvt_pk_bf16_f32 v112, v180, v181
v_cvt_pk_bf16_f32 v113, v182, v183
v_cvt_pk_bf16_f32 v114, v184, v185
v_cvt_pk_bf16_f32 v115, v186, v187
v_pk_fma_f32 v[188:189], v[196:197], v[180:181], v[188:189] op_sel_hi:[0,1,1] neg_lo:[0,0,1] neg_hi:[0,0,1]
v_pk_fma_f32 v[190:191], v[196:197], v[182:183], v[190:191] op_sel_hi:[0,1,1] neg_lo:[0,0,1] neg_hi:[0,0,1]
v_pk_fma_f32 v[192:193], v[196:197], v[184:185], v[192:193] op_sel_hi:[0,1,1] neg_lo:[0,0,1] neg_hi:[0,0,1]
v_pk_fma_f32 v[194:195], v[196:197], v[186:187], v[194:195] op_sel_hi:[0,1,1] neg_lo:[0,0,1] neg_hi:[0,0,1]
v_cvt_pk_bf16_f32 v116, v188, v189
v_cvt_pk_bf16_f32 v117, v190, v191
v_cvt_pk_bf16_f32 v118, v192, v193
v_cvt_pk_bf16_f32 v119, v194, v195
v_pk_fma_f32 v[180:181], v[196:197], v[188:189], v[180:181] op_sel_hi:[0,1,1] neg_lo:[0,0,1] neg_hi:[0,0,1]
v_pk_fma_f32 v[182:183], v[196:197], v[190:191], v[182:183] op_sel_hi:[0,1,1] neg_lo:[0,0,1] neg_hi:[0,0,1]
v_pk_fma_f32 v[184:185], v[196:197], v[192:193], v[184:185] op_sel_hi:[0,1,1] neg_lo:[0,0,1] neg_hi:[0,0,1]
v_pk_fma_f32 v[186:187], v[196:197], v[194:195], v[186:187] op_sel_hi:[0,1,1] neg_lo:[0,0,1] neg_hi:[0,0,1]
v_cvt_pk_bf16_f32 v120, v180, v181
v_cvt_pk_bf16_f32 v121, v182, v183
v_cvt_pk_bf16_f32 v122, v184, v185
v_cvt_pk_bf16_f32 v123, v186, v187
v_pk_fma_f32 v[188:189], v[196:197], v[180:181], v[188:189] op_sel_hi:[0,1,1] neg_lo:[0,0,1] neg_hi:[0,0,1]
v_pk_fma_f32 v[190:191], v[196:197], v[182:183], v[190:191] op_sel_hi:[0,1,1] neg_lo:[0,0,1] neg_hi:[0,0,1]
v_pk_fma_f32 v[192:193], v[196:197], v[184:185], v[192:193] op_sel_hi:[0,1,1] neg_lo:[0,0,1] neg_hi:[0,0,1]
v_pk_fma_f32 v[194:195], v[196:197], v[186:187], v[194:195] op_sel_hi:[0,1,1] neg_lo:[0,0,1] neg_hi:[0,0,1]
v_cvt_pk_bf16_f32 v124, v188, v189
v_cvt_pk_bf16_f32 v125, v190, v191
v_cvt_pk_bf16_f32 v126, v192, v193
v_cvt_pk_bf16_f32 v127, v194, v195
v_pk_fma_f32 v[180:181], v[196:197], v[188:189], v[180:181] op_sel_hi:[0,1,1] neg_lo:[0,0,1] neg_hi:[0,0,1]
v_pk_fma_f32 v[182:183], v[196:197], v[190:191], v[182:183] op_sel_hi:[0,1,1] neg_lo:[0,0,1] neg_hi:[0,0,1]
v_pk_fma_f32 v[184:185], v[196:197], v[192:193], v[184:185] op_sel_hi:[0,1,1] neg_lo:[0,0,1] neg_hi:[0,0,1]
v_pk_fma_f32 v[186:187], v[196:197], v[194:195], v[186:187] op_sel_hi:[0,1,1] neg_lo:[0,0,1] neg_hi:[0,0,1]
v_cvt_pk_bf16_f32 v128, v180, v181
v_cvt_pk_bf16_f32 v129, v182, v183
v_cvt_pk_bf16_f32 v130, v184, v185
v_cvt_pk_bf16_f32 v131, v186, v187
v_pk_fma_f32 v[188:189], v[196:197], v[180:181], v[188:189] op_sel_hi:[0,1,1] neg_lo:[0,0,1] neg_hi:[0,0,1]
v_pk_fma_f32 v[190:191], v[196:197], v[182:183], v[190:191] op_sel_hi:[0,1,1] neg_lo:[0,0,1] neg_hi:[0,0,1]
v_pk_fma_f32 v[192:193], v[196:197], v[184:185], v[192:193] op_sel_hi:[0,1,1] neg_lo:[0,0,1] neg_hi:[0,0,1]
v_pk_fma_f32 v[194:195], v[196:197], v[186:187], v[194:195] op_sel_hi:[0,1,1] neg_lo:[0,0,1] neg_hi:[0,0,1]
v_cvt_pk_bf16_f32 v132, v188, v189
v_cvt_pk_bf16_f32 v133, v190, v191
v_cvt_pk_bf16_f32 v134, v192, v193
v_cvt_pk_bf16_f32 v135, v194, v195
v_pk_fma_f32 v[180:181], v[196:197], v[188:189], v[180:181] op_sel_hi:[0,1,1] neg_lo:[0,0,1] neg_hi:[0,0,1]
v_pk_fma_f32 v[182:183], v[196:197], v[190:191], v[182:183] op_sel_hi:[0,1,1] neg_lo:[0,0,1] neg_hi:[0,0,1]
v_pk_fma_f32 v[184:185], v[196:197], v[192:193], v[184:185] op_sel_hi:[0,1,1] neg_lo:[0,0,1] neg_hi:[0,0,1]
v_pk_fma_f32 v[186:187], v[196:197], v[194:195], v[186:187] op_sel_hi:[0,1,1] neg_lo:[0,0,1] neg_hi:[0,0,1]
v_cvt_pk_bf16_f32 v136, v180, v181
v_cvt_pk_bf16_f32 v137, v182, v183
v_cvt_pk_bf16_f32 v138, v184, v185
v_cvt_pk_bf16_f32 v139, v186, v187
v_pk_fma_f32 v[188:189], v[196:197], v[180:181], v[188:189] op_sel_hi:[0,1,1] neg_lo:[0,0,1] neg_hi:[0,0,1]
v_pk_fma_f32 v[190:191], v[196:197], v[182:183], v[190:191] op_sel_hi:[0,1,1] neg_lo:[0,0,1] neg_hi:[0,0,1]
v_pk_fma_f32 v[192:193], v[196:197], v[184:185], v[192:193] op_sel_hi:[0,1,1] neg_lo:[0,0,1] neg_hi:[0,0,1]
v_pk_fma_f32 v[194:195], v[196:197], v[186:187], v[194:195] op_sel_hi:[0,1,1] neg_lo:[0,0,1] neg_hi:[0,0,1]
v_cvt_pk_bf16_f32 v140, v188, v189
v_cvt_pk_bf16_f32 v141, v190, v191
v_cvt_pk_bf16_f32 v142, v192, v193
v_cvt_pk_bf16_f32 v143, v194, v195
v_pk_fma_f32 v[180:181], v[196:197], v[188:189], v[180:181] op_sel_hi:[0,1,1] neg_lo:[0,0,1] neg_hi:[0,0,1]
v_pk_fma_f32 v[182:183], v[196:197], v[190:191], v[182:183] op_sel_hi:[0,1,1] neg_lo:[0,0,1] neg_hi:[0,0,1]
v_pk_fma_f32 v[184:185], v[196:197], v[192:193], v[184:185] op_sel_hi:[0,1,1] neg_lo:[0,0,1] neg_hi:[0,0,1]
v_pk_fma_f32 v[186:187], v[196:197], v[194:195], v[186:187] op_sel_hi:[0,1,1] neg_lo:[0,0,1] neg_hi:[0,0,1]
v_cvt_pk_bf16_f32 v144, v180, v181
v_cvt_pk_bf16_f32 v145, v182, v183
v_cvt_pk_bf16_f32 v146, v184, v185
v_cvt_pk_bf16_f32 v147, v186, v187
v_pk_fma_f32 v[188:189], v[196:197], v[180:181], v[188:189] op_sel_hi:[0,1,1] neg_lo:[0,0,1] neg_hi:[0,0,1]
v_pk_fma_f32 v[190:191], v[196:197], v[182:183], v[190:191] op_sel_hi:[0,1,1] neg_lo:[0,0,1] neg_hi:[0,0,1]
v_pk_fma_f32 v[192:193], v[196:197], v[184:185], v[192:193] op_sel_hi:[0,1,1] neg_lo:[0,0,1] neg_hi:[0,0,1]
v_pk_fma_f32 v[194:195], v[196:197], v[186:187], v[194:195] op_sel_hi:[0,1,1] neg_lo:[0,0,1] neg_hi:[0,0,1]
v_cvt_pk_bf16_f32 v148, v188, v189
v_cvt_pk_bf16_f32 v149, v190, v191
v_cvt_pk_bf16_f32 v150, v192, v193
v_cvt_pk_bf16_f32 v151, v194, v195
v_pk_fma_f32 v[180:181], v[196:197], v[188:189], v[180:181] op_sel_hi:[0,1,1] neg_lo:[0,0,1] neg_hi:[0,0,1]
v_pk_fma_f32 v[182:183], v[196:197], v[190:191], v[182:183] op_sel_hi:[0,1,1] neg_lo:[0,0,1] neg_hi:[0,0,1]
v_pk_fma_f32 v[184:185], v[196:197], v[192:193], v[184:185] op_sel_hi:[0,1,1] neg_lo:[0,0,1] neg_hi:[0,0,1]
v_pk_fma_f32 v[186:187], v[196:197], v[194:195], v[186:187] op_sel_hi:[0,1,1] neg_lo:[0,0,1] neg_hi:[0,0,1]
v_cvt_pk_bf16_f32 v152, v180, v181
v_cvt_pk_bf16_f32 v153, v182, v183
v_cvt_pk_bf16_f32 v154, v184, v185
v_cvt_pk_bf16_f32 v155, v186, v187
v_pk_fma_f32 v[188:189], v[196:197], v[180:181], v[188:189] op_sel_hi:[0,1,1] neg_lo:[0,0,1] neg_hi:[0,0,1]
v_pk_fma_f32 v[190:191], v[196:197], v[182:183], v[190:191] op_sel_hi:[0,1,1] neg_lo:[0,0,1] neg_hi:[0,0,1]
v_pk_fma_f32 v[192:193], v[196:197], v[184:185], v[192:193] op_sel_hi:[0,1,1] neg_lo:[0,0,1] neg_hi:[0,0,1]
v_pk_fma_f32 v[194:195], v[196:197], v[186:187], v[194:195] op_sel_hi:[0,1,1] neg_lo:[0,0,1] neg_hi:[0,0,1]
v_cvt_pk_bf16_f32 v156, v188, v189
v_cvt_pk_bf16_f32 v157, v190, v191
v_cvt_pk_bf16_f32 v158, v192, v193
v_cvt_pk_bf16_f32 v159, v194, v195
v_pk_fma_f32 v[180:181], v[196:197], v[188:189], v[180:181] op_sel_hi:[0,1,1] neg_lo:[0,0,1] neg_hi:[0,0,1]
v_pk_fma_f32 v[182:183], v[196:197], v[190:191], v[182:183] op_sel_hi:[0,1,1] neg_lo:[0,0,1] neg_hi:[0,0,1]
v_pk_fma_f32 v[184:185], v[196:197], v[192:193], v[184:185] op_sel_hi:[0,1,1] neg_lo:[0,0,1] neg_hi:[0,0,1]
v_pk_fma_f32 v[186:187], v[196:197], v[194:195], v[186:187] op_sel_hi:[0,1,1] neg_lo:[0,0,1] neg_hi:[0,0,1]
v_cvt_pk_bf16_f32 v160, v180, v181
v_cvt_pk_bf16_f32 v161, v182, v183
v_cvt_pk_bf16_f32 v162, v184, v185
v_cvt_pk_bf16_f32 v163, v186, v187
v_pk_fma_f32 v[188:189], v[196:197], v[180:181], v[188:189] op_sel_hi:[0,1,1] neg_lo:[0,0,1] neg_hi:[0,0,1]
v_pk_fma_f32 v[190:191], v[196:197], v[182:183], v[190:191] op_sel_hi:[0,1,1] neg_lo:[0,0,1] neg_hi:[0,0,1]
v_pk_fma_f32 v[192:193], v[196:197], v[184:185], v[192:193] op_sel_hi:[0,1,1] neg_lo:[0,0,1] neg_hi:[0,0,1]
v_pk_fma_f32 v[194:195], v[196:197], v[186:187], v[194:195] op_sel_hi:[0,1,1] neg_lo:[0,0,1] neg_hi:[0,0,1]
v_cvt_pk_bf16_f32 v164, v188, v189
v_cvt_pk_bf16_f32 v165, v190, v191
v_cvt_pk_bf16_f32 v166, v192, v193
v_cvt_pk_bf16_f32 v167, v194, v195
v_pk_fma_f32 v[180:181], v[196:197], v[188:189], v[180:181] op_sel_hi:[0,1,1] neg_lo:[0,0,1] neg_hi:[0,0,1]
v_pk_fma_f32 v[182:183], v[196:197], v[190:191], v[182:183] op_sel_hi:[0,1,1] neg_lo:[0,0,1] neg_hi:[0,0,1]
v_pk_fma_f32 v[184:185], v[196:197], v[192:193], v[184:185] op_sel_hi:[0,1,1] neg_lo:[0,0,1] neg_hi:[0,0,1]
v_pk_fma_f32 v[186:187], v[196:197], v[194:195], v[186:187] op_sel_hi:[0,1,1] neg_lo:[0,0,1] neg_hi:[0,0,1]
v_cvt_pk_bf16_f32 v168, v180, v181
v_cvt_pk_bf16_f32 v169, v182, v183
v_cvt_pk_bf16_f32 v170, v184, v185
v_cvt_pk_bf16_f32 v171, v186, v187
v_pk_fma_f32 v[188:189], v[196:197], v[180:181], v[188:189] op_sel_hi:[0,1,1] neg_lo:[0,0,1] neg_hi:[0,0,1]
v_pk_fma_f32 v[190:191], v[196:197], v[182:183], v[190:191] op_sel_hi:[0,1,1] neg_lo:[0,0,1] neg_hi:[0,0,1]
v_pk_fma_f32 v[192:193], v[196:197], v[184:185], v[192:193] op_sel_hi:[0,1,1] neg_lo:[0,0,1] neg_hi:[0,0,1]
v_pk_fma_f32 v[194:195], v[196:197], v[186:187], v[194:195] op_sel_hi:[0,1,1] neg_lo:[0,0,1] neg_hi:[0,0,1]
v_cvt_pk_bf16_f32 v172, v188, v189
v_cvt_pk_bf16_f32 v173, v190, v191
v_cvt_pk_bf16_f32 v174, v192, v193
v_cvt_pk_bf16_f32 v175, v194, v195
v_mov_b32 v180, s24
v_mov_b32 v181, s24
v_mov_b32 v182, s24
v_mov_b32 v183, s24
s_nop 1
v_mfma_f32_32x32x16_bf16 v[184:199], v[180:183], v[16:19], 0
v_mfma_f32_32x32x16_bf16 v[184:199], v[180:183], v[20:23], v[184:199]
v_mfma_f32_32x32x16_bf16 v[184:199], v[180:183], v[24:27], v[184:199]
v_mfma_f32_32x32x16_bf16 v[184:199], v[180:183], v[28:31], v[184:199]
v_mfma_f32_32x32x16_bf16 v[184:199], v[180:183], v[32:35], v[184:199]
v_mfma_f32_32x32x16_bf16 v[184:199], v[180:183], v[36:39], v[184:199]
v_mfma_f32_32x32x16_bf16 v[184:199], v[180:183], v[40:43], v[184:199]
v_mfma_f32_32x32x16_bf16 v[184:199], v[180:183], v[44:47], v[184:199]
v_mfma_f32_32x32x16_bf16 v[184:199], v[180:183], v[48:51], v[184:199]
v_mfma_f32_32x32x16_bf16 v[184:199], v[180:183], v[52:55], v[184:199]
v_mfma_f32_32x32x16_bf16 v[184:199], v[180:183], v[56:59], v[184:199]
v_mfma_f32_32x32x16_bf16 v[184:199], v[180:183], v[60:63], v[184:199]
v_mfma_f32_32x32x16_bf16 v[184:199], v[180:183], v[64:67], v[184:199]
v_mfma_f32_32x32x16_bf16 v[184:199], v[180:183], v[68:71], v[184:199]
v_mfma_f32_32x32x16_bf16 v[184:199], v[180:183], v[72:75], v[184:199]
v_mfma_f32_32x32x16_bf16 v[184:199], v[180:183], v[76:79], v[184:199]
v_mfma_f32_32x32x16_bf16 v[184:199], v[180:183], v[80:83], v[184:199]
v_mfma_f32_32x32x16_bf16 v[184:199], v[180:183], v[84:87], v[184:199]
v_mfma_f32_32x32x16_bf16 v[184:199], v[180:183], v[88:91], v[184:199]
v_mfma_f32_32x32x16_bf16 v[184:199], v[180:183], v[92:95], v[184:199]
v_mfma_f32_32x32x16_bf16 v[184:199], v[180:183], v[96:99], v[184:199]
v_mfma_f32_32x32x16_bf16 v[184:199], v[180:183], v[100:103], v[184:199]
v_mfma_f32_32x32x16_bf16 v[184:199], v[180:183], v[104:107], v[184:199]
v_mfma_f32_32x32x16_bf16 v[184:199], v[180:183], v[108:111], v[184:199]
v_mfma_f32_32x32x16_bf16 v[184:199], v[180:183], v[112:115], v[184:199]
v_mfma_f32_32x32x16_bf16 v[184:199], v[180:183], v[116:119], v[184:199]
v_mfma_f32_32x32x16_bf16 v[184:199], v[180:183], v[120:123], v[184:199]
v_mfma_f32_32x32x16_bf16 v[184:199], v[180:183], v[124:127], v[184:199]
v_mfma_f32_32x32x16_bf16 v[184:199], v[180:183], v[128:131], v[184:199]
v_mfma_f32_32x32x16_bf16 v[184:199], v[180:183], v[132:135], v[184:199]
v_mfma_f32_32x32x16_bf16 v[184:199], v[180:183], v[136:139], v[184:199]
v_mfma_f32_32x32x16_bf16 v[184:199], v[180:183], v[140:143], v[184:199]
v_mfma_f32_32x32x16_bf16 v[184:199], v[180:183], v[144:147], v[184:199]
v_mfma_f32_32x32x16_bf16 v[184:199], v[180:183], v[148:151], v[184:199]
v_mfma_f32_32x32x16_bf16 v[184:199], v[180:183], v[152:155], v[184:199]
v_mfma_f32_32x32x16_bf16 v[184:199], v[180:183], v[156:159], v[184:199]
v_mfma_f32_32x32x16_bf16 v[184:199], v[180:183], v[160:163], v[184:199]
v_mfma_f32_32x32x16_bf16 v[184:199], v[180:183], v[164:167], v[184:199]
v_mfma_f32_32x32x16_bf16 v[184:199], v[180:183], v[168:171], v[184:199]
v_mfma_f32_32x32x16_bf16 v[184:199], v[180:183], v[172:175], v[184:199]
s_nop 11
v_mov_b32 v7, v184
s_lshl_b32 s18, s34, 2
s_add_u32 s18, s18, s13
s_lshl_b32 s33, s18, 11
s_mul_i32 s27, s50, 40960
s_add_u32 s27, s27, s33
s_add_u32 s27, s27, 97517568
s_mov_b32 s28, 0
s_waitcnt vmcnt(0)
p1_49:
s_barrier
s_lshl_b32 s18, s13, 5
v_xor_b32 v2, s18, v176
ds_read_b128 v[220:223], v2 offset:2048
ds_read_b128 v[224:227], v2 offset:6144
ds_read_b128 v[228:231], v2 offset:10240
ds_read_b128 v[200:203], v177 offset:2048
v_mov_b64 v[212:213], 0
ds_read_b128 v[232:235], v2 offset:14336
ds_read_b128 v[204:207], v178 offset:2048
ds_read_b128 v[196:199], v176 offset:2048
ds_read_b128 v[208:211], v179 offset:2048
s_waitcnt lgkmcnt(7)
v_dot2c_f32_bf16 v212, s24, v220
v_dot2c_f32_bf16 v213, v220, v220
v_dot2c_f32_bf16 v212, s24, v221
v_dot2c_f32_bf16 v213, v221, v221
s_waitcnt lgkmcnt(6)
v_dot2c_f32_bf16 v212, s24, v222
v_dot2c_f32_bf16 v213, v222, v222
v_dot2c_f32_bf16 v212, s24, v223
v_dot2c_f32_bf16 v213, v223, v223
v_dot2c_f32_bf16 v212, s24, v224
v_dot2c_f32_bf16 v213, v224, v224
v_dot2c_f32_bf16 v212, s24, v225
v_dot2c_f32_bf16 v213, v225, v225
v_dot2c_f32_bf16 v212, s24, v226
v_dot2c_f32_bf16 v213, v226, v226
v_dot2c_f32_bf16 v212, s24, v227
v_dot2c_f32_bf16 v213, v227, v227
s_waitcnt lgkmcnt(5)
s_waitcnt lgkmcnt(3)
ds_read_b128 v[220:223], v2 offset:18432
ds_read_b128 v[224:227], v2 offset:22528
v_dot2c_f32_bf16 v212, s24, v228
v_dot2c_f32_bf16 v213, v228, v228
v_dot2c_f32_bf16 v212, s24, v229
v_dot2c_f32_bf16 v213, v229, v229
v_dot2c_f32_bf16 v212, s24, v230
v_dot2c_f32_bf16 v213, v230, v230
v_dot2c_f32_bf16 v212, s24, v231
v_dot2c_f32_bf16 v213, v231, v231
v_dot2c_f32_bf16 v212, s24, v232
v_dot2c_f32_bf16 v213, v232, v232
v_dot2c_f32_bf16 v212, s24, v233
v_dot2c_f32_bf16 v213, v233, v233
v_dot2c_f32_bf16 v212, s24, v234
v_dot2c_f32_bf16 v213, v234, v234
v_dot2c_f32_bf16 v212, s24, v235
v_dot2c_f32_bf16 v213, v235, v235
s_waitcnt lgkmcnt(1)
ds_read_b128 v[232:235], v2 offset:30720
ds_read_b128 v[228:231], v2 offset:26624
v_dot2c_f32_bf16 v212, s24, v220
v_dot2c_f32_bf16 v213, v220, v220
v_dot2c_f32_bf16 v212, s24, v221
v_dot2c_f32_bf16 v213, v221, v221
v_dot2c_f32_bf16 v212, s24, v222
v_dot2c_f32_bf16 v213, v222, v222
s_waitcnt lgkmcnt(2)
v_dot2c_f32_bf16 v212, s24, v223
v_dot2c_f32_bf16 v213, v223, v223
v_dot2c_f32_bf16 v212, s24, v224
v_dot2c_f32_bf16 v213, v224, v224
v_dot2c_f32_bf16 v212, s24, v225
v_dot2c_f32_bf16 v213, v225, v225
v_dot2c_f32_bf16 v212, s24, v226
v_dot2c_f32_bf16 v213, v226, v226
v_dot2c_f32_bf16 v212, s24, v227
v_dot2c_f32_bf16 v213, v227, v227
s_waitcnt lgkmcnt(1)
s_waitcnt lgkmcnt(0)
ds_read_b128 v[220:223], v2 offset:34816
ds_read_b128 v[224:227], v2 offset:38912
v_dot2c_f32_bf16 v212, s24, v228
v_dot2c_f32_bf16 v213, v228, v228
v_dot2c_f32_bf16 v212, s24, v229
v_dot2c_f32_bf16 v213, v229, v229
v_dot2c_f32_bf16 v212, s24, v230
v_dot2c_f32_bf16 v213, v230, v230
v_dot2c_f32_bf16 v212, s24, v231
v_dot2c_f32_bf16 v213, v231, v231
v_dot2c_f32_bf16 v212, s24, v232
v_dot2c_f32_bf16 v213, v232, v232
v_dot2c_f32_bf16 v212, s24, v233
v_dot2c_f32_bf16 v213, v233, v233
v_dot2c_f32_bf16 v212, s24, v234
v_dot2c_f32_bf16 v213, v234, v234
v_dot2c_f32_bf16 v212, s24, v235
s_waitcnt lgkmcnt(1)
v_dot2c_f32_bf16 v213, v235, v235
v_dot2c_f32_bf16 v212, s24, v220
v_dot2c_f32_bf16 v213, v220, v220
v_dot2c_f32_bf16 v212, s24, v221
v_dot2c_f32_bf16 v213, v221, v221
s_waitcnt lgkmcnt(0)
v_dot2c_f32_bf16 v212, s24, v222
v_dot2c_f32_bf16 v213, v222, v222
v_dot2c_f32_bf16 v212, s24, v223
v_dot2c_f32_bf16 v213, v223, v223
v_dot2c_f32_bf16 v212, s24, v224
v_dot2c_f32_bf16 v213, v224, v224
v_dot2c_f32_bf16 v212, s24, v225
v_dot2c_f32_bf16 v213, v225, v225
v_dot2c_f32_bf16 v212, s24, v226
v_dot2c_f32_bf16 v213, v226, v226
v_dot2c_f32_bf16 v212, s24, v227
v_dot2c_f32_bf16 v213, v227, v227
v_mfma_f32_32x32x16_bf16 v[180:195], v[196:199], v[16:19], 0
v_and_b32 v2, 0x1ff, v0
ds_read_b128 v[196:199], v176 offset:6144
v_permlane32_swap_b32 v212, v213
v_mfma_f32_32x32x16_bf16 v[180:195], v[200:203], v[20:23], v[180:195]
v_add_f32 v212, v212, v213
v_lshl_add_u32 v213, s13, 2, v0
ds_write_b32 v213, v212 offset:0
v_mfma_f32_32x32x16_bf16 v[180:195], v[204:207], v[24:27], v[180:195]
ds_read_b128 v[200:203], v177 offset:6144
s_waitcnt lgkmcnt(2)
ds_read_b128 v[204:207], v178 offset:6144
v_mfma_f32_32x32x16_bf16 v[180:195], v[208:211], v[28:31], v[180:195]
ds_read_b128 v[208:211], v179 offset:6144
v_mfma_f32_32x32x16_bf16 v[180:195], v[196:199], v[32:35], v[180:195]
s_waitcnt lgkmcnt(3)
s_barrier
ds_read_b128 v[196:199], v176 offset:10240
s_waitcnt lgkmcnt(3)
v_mfma_f32_32x32x16_bf16 v[180:195], v[200:203], v[36:39], v[180:195]
ds_read_b128 v[212:215], v2 offset:0
s_waitcnt lgkmcnt(3)
s_waitcnt lgkmcnt(2)
ds_read_b128 v[200:203], v177 offset:10240
v_mfma_f32_32x32x16_bf16 v[180:195], v[204:207], v[40:43], v[180:195]
s_waitcnt lgkmcnt(2)
ds_read_b128 v[204:207], v178 offset:10240
v_mfma_f32_32x32x16_bf16 v[180:195], v[208:211], v[44:47], v[180:195]
ds_read_b128 v[216:219], v2 offset:512
s_waitcnt lgkmcnt(3)
s_waitcnt lgkmcnt(2)
v_mfma_f32_32x32x16_bf16 v[180:195], v[196:199], v[48:51], v[180:195]
ds_read_b128 v[208:211], v179 offset:10240
v_mfma_f32_32x32x16_bf16 v[180:195], v[200:203], v[52:55], v[180:195]
s_waitcnt lgkmcnt(2)
ds_read_b128 v[196:199], v176 offset:14336
v_add_f32 v212, v212, v213
v_add_f32 v214, v214, v215
v_lshrrev_b32 v213, 2, v0
v_mfma_f32_32x32x16_bf16 v[180:195], v[204:207], v[56:59], v[180:195]
s_waitcnt lgkmcnt(1)
ds_read_b128 v[200:203], v177 offset:14336
ds_read_b128 v[204:207], v178 offset:14336
v_add_f32 v212, v212, v214
v_mfma_f32_32x32x16_bf16 v[180:195], v[208:211], v[60:63], v[180:195]
ds_read_b128 v[208:211], v179 offset:14336
v_bfe_u32 v214, v0, 5, 5
s_waitcnt lgkmcnt(3)
v_and_b32 v214, 16, v214
v_mfma_f32_32x32x16_bf16 v[180:195], v[196:199], v[64:67], v[180:195]
ds_read_b128 v[196:199], v176 offset:18432
v_add_f32 v218, v218, v219
s_waitcnt lgkmcnt(3)
v_mul_f32 v212, 0x3acccccd, v212
v_add_f32 v216, v216, v217
v_mfma_f32_32x32x16_bf16 v[180:195], v[200:203], v[68:71], v[180:195]
ds_read_b128 v[200:203], v177 offset:18432
s_waitcnt lgkmcnt(2)
v_add_f32 v216, v216, v218
v_mul_f32 v216, 0x3acccccd, v216
v_fma_f32 v216, -v212, v212, v216
v_mfma_f32_32x32x16_bf16 v[180:195], v[204:207], v[72:75], v[180:195]
v_max_f32 v216, 0, v216
v_add_f32 v216, 0x3727c5ac, v216
v_mfma_f32_32x32x16_bf16 v[180:195], v[208:211], v[76:79], v[180:195]
s_waitcnt lgkmcnt(1)
ds_read_b128 v[208:211], v179 offset:18432
ds_read_b128 v[204:207], v178 offset:18432
v_lshl_add_u32 v214, s13, 8, v214
s_waitcnt lgkmcnt(2)
v_rsq_f32 v216, v216
v_mfma_f32_32x32x16_bf16 v[180:195], v[196:199], v[80:83], v[180:195]
v_mul_f32 v212, v216, v212
v_lshl_add_u32 v213, s13, 8, v213
s_nop 0
v_permlane32_swap_b32 v216, v212
v_mfma_f32_32x32x16_bf16 v[180:195], v[200:203], v[84:87], v[180:195]
ds_read_b128 v[196:199], v176 offset:22528
ds_read_b128 v[200:203], v177 offset:22528
s_waitcnt lgkmcnt(2)
v_mfma_f32_32x32x16_bf16 v[180:195], v[204:207], v[88:91], v[180:195]
ds_write_b32 v213, v216 offset:1024
ds_read_b128 v[240:243], v214 offset:1184
ds_read_b128 v[204:207], v178 offset:22528
ds_read_b128 v[232:235], v214 offset:1120
v_mfma_f32_32x32x16_bf16 v[180:195], v[208:211], v[92:95], v[180:195]
ds_read_b128 v[208:211], v179 offset:22528
s_waitcnt lgkmcnt(6)
v_mfma_f32_32x32x16_bf16 v[180:195], v[196:199], v[96:99], v[180:195]
s_waitcnt lgkmcnt(5)
ds_read_b128 v[196:199], v176 offset:26624
v_mfma_f32_32x32x16_bf16 v[180:195], v[200:203], v[100:103], v[180:195]
s_waitcnt lgkmcnt(3)
ds_read_b128 v[220:223], v214 offset:1024
v_mfma_f32_32x32x16_bf16 v[180:195], v[204:207], v[104:107], v[180:195]
s_waitcnt lgkmcnt(2)
ds_read_b128 v[204:207], v178 offset:26624
ds_read_b128 v[200:203], v177 offset:26624
ds_read_b128 v[228:231], v214 offset:1088
s_waitcnt lgkmcnt(4)
v_mfma_f32_32x32x16_bf16 v[180:195], v[208:211], v[108:111], v[180:195]
v_mfma_f32_32x32x16_bf16 v[180:195], v[196:199], v[112:115], v[180:195]
ds_read_b128 v[196:199], v176 offset:30720
ds_read_b128 v[208:211], v179 offset:26624
s_waitcnt lgkmcnt(4)
ds_read_b128 v[244:247], v214 offset:1216
s_waitcnt lgkmcnt(4)
ds_read_b128 v[236:239], v214 offset:1152
v_mfma_f32_32x32x16_bf16 v[180:195], v[200:203], v[116:119], v[180:195]
v_mul_f32 v243, v243, v7
ds_read_b128 v[248:251], v214 offset:1248
v_mfma_f32_32x32x16_bf16 v[180:195], v[204:207], v[120:123], v[180:195]
ds_read_b128 v[200:203], v177 offset:30720
s_waitcnt lgkmcnt(4)
v_mfma_f32_32x32x16_bf16 v[180:195], v[208:211], v[124:127], v[180:195]
ds_read_b128 v[208:211], v179 offset:30720
ds_read_b128 v[204:207], v178 offset:30720
v_mul_f32 v240, v240, v7
v_mfma_f32_32x32x16_bf16 v[180:195], v[196:199], v[128:131], v[180:195]
s_waitcnt lgkmcnt(2)
v_mfma_f32_32x32x16_bf16 v[180:195], v[200:203], v[132:135], v[180:195]
ds_read_b128 v[200:203], v177 offset:34816
ds_read_b128 v[196:199], v176 offset:34816
s_waitcnt lgkmcnt(3)
s_waitcnt lgkmcnt(2)
ds_read_b128 v[224:227], v214 offset:1056
v_mfma_f32_32x32x16_bf16 v[180:195], v[204:207], v[136:139], v[180:195]
v_mul_f32 v248, v248, v7
v_mfma_f32_32x32x16_bf16 v[180:195], v[208:211], v[140:143], v[180:195]
ds_read_b128 v[208:211], v179 offset:34816
ds_read_b128 v[204:207], v178 offset:34816
s_waitcnt lgkmcnt(3)
v_mfma_f32_32x32x16_bf16 v[180:195], v[196:199], v[144:147], v[180:195]
v_mfma_f32_32x32x16_bf16 v[180:195], v[200:203], v[148:151], v[180:195]
s_waitcnt lgkmcnt(0)
ds_read_b128 v[196:199], v176 offset:38912
v_mfma_f32_32x32x16_bf16 v[180:195], v[204:207], v[152:155], v[180:195]
ds_read_b128 v[204:207], v178 offset:38912
v_mul_f32 v238, v238, v7
v_mul_f32 v239, v239, v7
ds_read_b128 v[200:203], v177 offset:38912
v_mfma_f32_32x32x16_bf16 v[180:195], v[208:211], v[156:159], v[180:195]
v_mul_f32 v250, v250, v7
v_mul_f32 v247, v247, v7
s_waitcnt lgkmcnt(2)
v_mfma_f32_32x32x16_bf16 v[180:195], v[196:199], v[160:163], v[180:195]
ds_read_b128 v[208:211], v179 offset:38912
v_mul_f32 v249, v249, v7
v_mul_f32 v241, v241, v7
s_waitcnt lgkmcnt(1)
v_mfma_f32_32x32x16_bf16 v[180:195], v[200:203], v[164:167], v[180:195]
v_mul_f32 v237, v237, v7
v_mul_f32 v242, v242, v7
v_mul_f32 v244, v244, v7
v_mul_f32 v246, v246, v7
v_mul_f32 v251, v251, v7
v_mul_f32 v245, v245, v7
v_mfma_f32_32x32x16_bf16 v[180:195], v[204:207], v[168:171], v[180:195]
s_waitcnt lgkmcnt(0)
v_mul_f32 v236, v236, v7
v_mfma_f32_32x32x16_bf16 v[180:195], v[208:211], v[172:175], v[180:195]
s_nop 11
v_pk_fma_f32 v[184:185], v[184:185], v[224:225], v[240:241] neg_lo:[0,0,1] neg_hi:[0,0,1]
v_cvt_pk_bf16_f32 v198, v184, v185
v_pk_fma_f32 v[192:193], v[192:193], v[232:233], v[248:249] neg_lo:[0,0,1] neg_hi:[0,0,1]
v_pk_fma_f32 v[182:183], v[182:183], v[222:223], v[238:239] neg_lo:[0,0,1] neg_hi:[0,0,1]
v_pk_fma_f32 v[194:195], v[194:195], v[234:235], v[250:251] neg_lo:[0,0,1] neg_hi:[0,0,1]
v_pk_fma_f32 v[188:189], v[188:189], v[228:229], v[244:245] neg_lo:[0,0,1] neg_hi:[0,0,1]
v_pk_fma_f32 v[190:191], v[190:191], v[230:231], v[246:247] neg_lo:[0,0,1] neg_hi:[0,0,1]
v_pk_fma_f32 v[186:187], v[186:187], v[226:227], v[242:243] neg_lo:[0,0,1] neg_hi:[0,0,1]
v_cvt_pk_bf16_f32 v203, v194, v195
v_cvt_pk_bf16_f32 v199, v186, v187
v_pk_fma_f32 v[180:181], v[180:181], v[220:221], v[236:237] neg_lo:[0,0,1] neg_hi:[0,0,1]
v_cvt_pk_bf16_f32 v200, v188, v189
v_cvt_pk_bf16_f32 v202, v192, v193
v_cvt_pk_bf16_f32 v197, v182, v183
v_cvt_pk_bf16_f32 v196, v180, v181
v_cvt_pk_bf16_f32 v201, v190, v191
buffer_store_dwordx4 v[196:199], v6, s[4:7], s27 offen offset:0 sc1
buffer_store_dwordx4 v[200:203], v6, s[4:7], s27 offen offset:1024 sc1
v_add_u32 v176, 40960, v176
v_add_u32 v177, 40960, v177
v_add_u32 v178, 40960, v178
v_add_u32 v179, 40960, v179
s_add_u32 s27, s27, 1310720
s_add_u32 s28, s28, 1
s_cmp_lt_u32 s28, 2
s_cbranch_scc1 p1_49
s_lshl_b32 s18, s39, 7
s_add_u32 s18, s18, 11571200
s_cmp_eq_u32 s13, 0
s_cselect_b32 s22, s18, s6
s_mov_b32 s23, 1
alay_50:
v_bfe_u32 v96, v0, 4, 4
v_lshrrev_b32 v97, 8, v0
v_lshlrev_b32 v97, 2, v97
v_lshl_add_u32 v98, s13, 4, v96
v_add_u32 v99, 0, v97
v_mul_u32_u24 v99, v99, v98
v_and_b32 v99, 63, v99
v_cvt_f32_u32 v99, v99
v_mul_f32 v99, 0x3c800000, v99
v_cos_f32 v104, v99
v_sin_f32 v112, v99
v_add_u32 v99, 1, v97
v_mul_u32_u24 v99, v99, v98
v_and_b32 v99, 63, v99
v_cvt_f32_u32 v99, v99
v_mul_f32 v99, 0x3c800000, v99
v_cos_f32 v105, v99
v_sin_f32 v113, v99
v_add_u32 v99, 2, v97
v_mul_u32_u24 v99, v99, v98
v_and_b32 v99, 63, v99
v_cvt_f32_u32 v99, v99
v_mul_f32 v99, 0x3c800000, v99
v_cos_f32 v106, v99
v_sin_f32 v114, v99
v_add_u32 v99, 3, v97
v_mul_u32_u24 v99, v99, v98
v_and_b32 v99, 63, v99
v_cvt_f32_u32 v99, v99
v_mul_f32 v99, 0x3c800000, v99
v_cos_f32 v107, v99
v_sin_f32 v115, v99
v_add_u32 v99, 16, v97
v_mul_u32_u24 v99, v99, v98
v_and_b32 v99, 63, v99
v_cvt_f32_u32 v99, v99
v_mul_f32 v99, 0x3c800000, v99
v_cos_f32 v108, v99
v_sin_f32 v116, v99
v_add_u32 v99, 17, v97
v_mul_u32_u24 v99, v99, v98
v_and_b32 v99, 63, v99
v_cvt_f32_u32 v99, v99
v_mul_f32 v99, 0x3c800000, v99
v_cos_f32 v109, v99
v_sin_f32 v117, v99
v_add_u32 v99, 18, v97
v_mul_u32_u24 v99, v99, v98
v_and_b32 v99, 63, v99
v_cvt_f32_u32 v99, v99
v_mul_f32 v99, 0x3c800000, v99
v_cos_f32 v110, v99
v_sin_f32 v118, v99
v_add_u32 v99, 19, v97
v_mul_u32_u24 v99, v99, v98
v_and_b32 v99, 63, v99
v_cvt_f32_u32 v99, v99
v_mul_f32 v99, 0x3c800000, v99
v_cos_f32 v111, v99
v_sin_f32 v119, v99
v_cvt_pk_bf16_f32 v16, v104, v105
v_cvt_pk_bf16_f32 v24, v112, v113
v_xor_b32 v32, 0x80008000, v24
v_cvt_pk_bf16_f32 v17, v106, v107
v_cvt_pk_bf16_f32 v25, v114, v115
v_xor_b32 v33, 0x80008000, v25
v_cvt_pk_bf16_f32 v18, v108, v109
v_cvt_pk_bf16_f32 v26, v116, v117
v_xor_b32 v34, 0x80008000, v26
v_cvt_pk_bf16_f32 v19, v110, v111
v_cvt_pk_bf16_f32 v27, v118, v119
v_xor_b32 v35, 0x80008000, v27
v_add_u32 v99, 32, v97
v_mul_u32_u24 v99, v99, v98
v_and_b32 v99, 63, v99
v_cvt_f32_u32 v99, v99
v_mul_f32 v99, 0x3c800000, v99
v_cos_f32 v104, v99
v_sin_f32 v112, v99
v_add_u32 v99, 33, v97
v_mul_u32_u24 v99, v99, v98
v_and_b32 v99, 63, v99
v_cvt_f32_u32 v99, v99
v_mul_f32 v99, 0x3c800000, v99
v_cos_f32 v105, v99
v_sin_f32 v113, v99
v_add_u32 v99, 34, v97
v_mul_u32_u24 v99, v99, v98
v_and_b32 v99, 63, v99
v_cvt_f32_u32 v99, v99
v_mul_f32 v99, 0x3c800000, v99
v_cos_f32 v106, v99
v_sin_f32 v114, v99
v_add_u32 v99, 35, v97
v_mul_u32_u24 v99, v99, v98
v_and_b32 v99, 63, v99
v_cvt_f32_u32 v99, v99
v_mul_f32 v99, 0x3c800000, v99
v_cos_f32 v107, v99
v_sin_f32 v115, v99
v_add_u32 v99, 48, v97
v_mul_u32_u24 v99, v99, v98
v_and_b32 v99, 63, v99
v_cvt_f32_u32 v99, v99
v_mul_f32 v99, 0x3c800000, v99
v_cos_f32 v108, v99
v_sin_f32 v116, v99
v_add_u32 v99, 49, v97
v_mul_u32_u24 v99, v99, v98
v_and_b32 v99, 63, v99
v_cvt_f32_u32 v99, v99
v_mul_f32 v99, 0x3c800000, v99
v_cos_f32 v109, v99
v_sin_f32 v117, v99
v_add_u32 v99, 50, v97
v_mul_u32_u24 v99, v99, v98
v_and_b32 v99, 63, v99
v_cvt_f32_u32 v99, v99
v_mul_f32 v99, 0x3c800000, v99
v_cos_f32 v110, v99
v_sin_f32 v118, v99
v_add_u32 v99, 51, v97
v_mul_u32_u24 v99, v99, v98
v_and_b32 v99, 63, v99
v_cvt_f32_u32 v99, v99
v_mul_f32 v99, 0x3c800000, v99
v_cos_f32 v111, v99
v_sin_f32 v119, v99
v_cvt_pk_bf16_f32 v20, v104, v105
v_cvt_pk_bf16_f32 v28, v112, v113
v_xor_b32 v36, 0x80008000, v28
v_cvt_pk_bf16_f32 v21, v106, v107
v_cvt_pk_bf16_f32 v29, v114, v115
v_xor_b32 v37, 0x80008000, v29
v_cvt_pk_bf16_f32 v22, v108, v109
v_cvt_pk_bf16_f32 v30, v116, v117
v_xor_b32 v38, 0x80008000, v30
v_cvt_pk_bf16_f32 v23, v110, v111
v_cvt_pk_bf16_f32 v31, v118, v119
v_xor_b32 v39, 0x80008000, v31
s_waitcnt vmcnt(0)
s_barrier
v_mov_b32 v3, s23
s_mov_b64 exec, 1
buffer_store_dword v3, off, s[4:7], s22 sc1
s_mov_b64 exec, -1
s_mov_b32 s22, s6
v_add_u32 v99, 0, v97
v_mul_u32_u24 v99, v99, v98
v_and_b32 v99, 2047, v99
v_cvt_f32_u32 v99, v99
v_mul_f32 v99, 0x3a000000, v99
v_cos_f32 v64, v99
v_sin_f32 v72, v99
v_add_u32 v99, 1, v97
v_mul_u32_u24 v99, v99, v98
v_and_b32 v99, 2047, v99
v_cvt_f32_u32 v99, v99
v_mul_f32 v99, 0x3a000000, v99
v_cos_f32 v65, v99
v_sin_f32 v73, v99
v_add_u32 v99, 2, v97
v_mul_u32_u24 v99, v99, v98
v_and_b32 v99, 2047, v99
v_cvt_f32_u32 v99, v99
v_mul_f32 v99, 0x3a000000, v99
v_cos_f32 v66, v99
v_sin_f32 v74, v99
v_add_u32 v99, 3, v97
v_mul_u32_u24 v99, v99, v98
v_and_b32 v99, 2047, v99
v_cvt_f32_u32 v99, v99
v_mul_f32 v99, 0x3a000000, v99
v_cos_f32 v67, v99
v_sin_f32 v75, v99
v_add_u32 v99, 16, v97
v_mul_u32_u24 v99, v99, v98
v_and_b32 v99, 2047, v99
v_cvt_f32_u32 v99, v99
v_mul_f32 v99, 0x3a000000, v99
v_cos_f32 v68, v99
v_sin_f32 v76, v99
v_add_u32 v99, 17, v97
v_mul_u32_u24 v99, v99, v98
v_and_b32 v99, 2047, v99
v_cvt_f32_u32 v99, v99
v_mul_f32 v99, 0x3a000000, v99
v_cos_f32 v69, v99
v_sin_f32 v77, v99
v_add_u32 v99, 18, v97
v_mul_u32_u24 v99, v99, v98
v_and_b32 v99, 2047, v99
v_cvt_f32_u32 v99, v99
v_mul_f32 v99, 0x3a000000, v99
v_cos_f32 v70, v99
v_sin_f32 v78, v99
v_add_u32 v99, 19, v97
v_mul_u32_u24 v99, v99, v98
v_and_b32 v99, 2047, v99
v_cvt_f32_u32 v99, v99
v_mul_f32 v99, 0x3a000000, v99
v_cos_f32 v71, v99
v_sin_f32 v79, v99
v_lshl_add_u32 v100, s13, 4, v97
v_add_u32 v98, 0, v96
v_add_u32 v99, 0, v97
v_mul_u32_u24 v99, v99, v98
v_and_b32 v99, 31, v99
v_cvt_f32_u32 v99, v99
v_mul_f32 v99, 0x3d000000, v99
v_cos_f32 v104, v99
v_sin_f32 v112, v99
v_add_u32 v99, 1, v97
v_mul_u32_u24 v99, v99, v98
v_and_b32 v99, 31, v99
v_cvt_f32_u32 v99, v99
v_mul_f32 v99, 0x3d000000, v99
v_cos_f32 v105, v99
v_sin_f32 v113, v99
v_add_u32 v99, 2, v97
v_mul_u32_u24 v99, v99, v98
v_and_b32 v99, 31, v99
v_cvt_f32_u32 v99, v99
v_mul_f32 v99, 0x3d000000, v99
v_cos_f32 v106, v99
v_sin_f32 v114, v99
v_add_u32 v99, 3, v97
v_mul_u32_u24 v99, v99, v98
v_and_b32 v99, 31, v99
v_cvt_f32_u32 v99, v99
v_mul_f32 v99, 0x3d000000, v99
v_cos_f32 v107, v99
v_sin_f32 v115, v99
v_add_u32 v99, 16, v97
v_mul_u32_u24 v99, v99, v98
v_and_b32 v99, 31, v99
v_cvt_f32_u32 v99, v99
v_mul_f32 v99, 0x3d000000, v99
v_cos_f32 v108, v99
v_sin_f32 v116, v99
v_add_u32 v99, 17, v97
v_mul_u32_u24 v99, v99, v98
v_and_b32 v99, 31, v99
v_cvt_f32_u32 v99, v99
v_mul_f32 v99, 0x3d000000, v99
v_cos_f32 v109, v99
v_sin_f32 v117, v99
v_add_u32 v99, 18, v97
v_mul_u32_u24 v99, v99, v98
v_and_b32 v99, 31, v99
v_cvt_f32_u32 v99, v99
v_mul_f32 v99, 0x3d000000, v99
v_cos_f32 v110, v99
v_sin_f32 v118, v99
v_add_u32 v99, 19, v97
v_mul_u32_u24 v99, v99, v98
v_and_b32 v99, 31, v99
v_cvt_f32_u32 v99, v99
v_mul_f32 v99, 0x3d000000, v99
v_cos_f32 v111, v99
v_sin_f32 v119, v99
v_cvt_pk_bf16_f32 v40, v104, v105
v_cvt_pk_bf16_f32 v48, v112, v113
v_xor_b32 v56, 0x80008000, v48
v_cvt_pk_bf16_f32 v41, v106, v107
v_cvt_pk_bf16_f32 v49, v114, v115
v_xor_b32 v57, 0x80008000, v49
v_cvt_pk_bf16_f32 v42, v108, v109
v_cvt_pk_bf16_f32 v50, v116, v117
v_xor_b32 v58, 0x80008000, v50
v_cvt_pk_bf16_f32 v43, v110, v111
v_cvt_pk_bf16_f32 v51, v118, v119
v_xor_b32 v59, 0x80008000, v51
v_add_u32 v99, 0, v100
v_mul_u32_u24 v99, v99, v98
v_and_b32 v99, 2047, v99
v_cvt_f32_u32 v99, v99
v_mul_f32 v99, 0x3a000000, v99
v_cos_f32 v80, v99
v_sin_f32 v88, v99
v_mul_f32 v80, 0x3a000000, v80
v_mul_f32 v88, 0x3a000000, v88
v_add_u32 v99, 1, v100
v_mul_u32_u24 v99, v99, v98
v_and_b32 v99, 2047, v99
v_cvt_f32_u32 v99, v99
v_mul_f32 v99, 0x3a000000, v99
v_cos_f32 v81, v99
v_sin_f32 v89, v99
v_mul_f32 v81, 0x3a000000, v81
v_mul_f32 v89, 0x3a000000, v89
v_add_u32 v99, 2, v100
v_mul_u32_u24 v99, v99, v98
v_and_b32 v99, 2047, v99
v_cvt_f32_u32 v99, v99
v_mul_f32 v99, 0x3a000000, v99
v_cos_f32 v82, v99
v_sin_f32 v90, v99
v_mul_f32 v82, 0x3a000000, v82
v_mul_f32 v90, 0x3a000000, v90
v_add_u32 v99, 3, v100
v_mul_u32_u24 v99, v99, v98
v_and_b32 v99, 2047, v99
v_cvt_f32_u32 v99, v99
v_mul_f32 v99, 0x3a000000, v99
v_cos_f32 v83, v99
v_sin_f32 v91, v99
v_mul_f32 v83, 0x3a000000, v83
v_mul_f32 v91, 0x3a000000, v91
v_add_u32 v98, 16, v96
v_add_u32 v99, 0, v97
v_mul_u32_u24 v99, v99, v98
v_and_b32 v99, 31, v99
v_cvt_f32_u32 v99, v99
v_mul_f32 v99, 0x3d000000, v99
v_cos_f32 v104, v99
v_sin_f32 v112, v99
v_add_u32 v99, 1, v97
v_mul_u32_u24 v99, v99, v98
v_and_b32 v99, 31, v99
v_cvt_f32_u32 v99, v99
v_mul_f32 v99, 0x3d000000, v99
v_cos_f32 v105, v99
v_sin_f32 v113, v99
v_add_u32 v99, 2, v97
v_mul_u32_u24 v99, v99, v98
v_and_b32 v99, 31, v99
v_cvt_f32_u32 v99, v99
v_mul_f32 v99, 0x3d000000, v99
v_cos_f32 v106, v99
v_sin_f32 v114, v99
v_add_u32 v99, 3, v97
v_mul_u32_u24 v99, v99, v98
v_and_b32 v99, 31, v99
v_cvt_f32_u32 v99, v99
v_mul_f32 v99, 0x3d000000, v99
v_cos_f32 v107, v99
v_sin_f32 v115, v99
v_add_u32 v99, 16, v97
v_mul_u32_u24 v99, v99, v98
v_and_b32 v99, 31, v99
v_cvt_f32_u32 v99, v99
v_mul_f32 v99, 0x3d000000, v99
v_cos_f32 v108, v99
v_sin_f32 v116, v99
v_add_u32 v99, 17, v97
v_mul_u32_u24 v99, v99, v98
v_and_b32 v99, 31, v99
v_cvt_f32_u32 v99, v99
v_mul_f32 v99, 0x3d000000, v99
v_cos_f32 v109, v99
v_sin_f32 v117, v99
v_add_u32 v99, 18, v97
v_mul_u32_u24 v99, v99, v98
v_and_b32 v99, 31, v99
v_cvt_f32_u32 v99, v99
v_mul_f32 v99, 0x3d000000, v99
v_cos_f32 v110, v99
v_sin_f32 v118, v99
v_add_u32 v99, 19, v97
v_mul_u32_u24 v99, v99, v98
v_and_b32 v99, 31, v99
v_cvt_f32_u32 v99, v99
v_mul_f32 v99, 0x3d000000, v99
v_cos_f32 v111, v99
v_sin_f32 v119, v99
v_cvt_pk_bf16_f32 v44, v104, v105
v_cvt_pk_bf16_f32 v52, v112, v113
v_xor_b32 v60, 0x80008000, v52
v_cvt_pk_bf16_f32 v45, v106, v107
v_cvt_pk_bf16_f32 v53, v114, v115
v_xor_b32 v61, 0x80008000, v53
v_cvt_pk_bf16_f32 v46, v108, v109
v_cvt_pk_bf16_f32 v54, v116, v117
v_xor_b32 v62, 0x80008000, v54
v_cvt_pk_bf16_f32 v47, v110, v111
v_cvt_pk_bf16_f32 v55, v118, v119
v_xor_b32 v63, 0x80008000, v55
v_add_u32 v99, 0, v100
v_mul_u32_u24 v99, v99, v98
v_and_b32 v99, 2047, v99
v_cvt_f32_u32 v99, v99
v_mul_f32 v99, 0x3a000000, v99
v_cos_f32 v84, v99
v_sin_f32 v92, v99
v_mul_f32 v84, 0x3a000000, v84
v_mul_f32 v92, 0x3a000000, v92
v_add_u32 v99, 1, v100
v_mul_u32_u24 v99, v99, v98
v_and_b32 v99, 2047, v99
v_cvt_f32_u32 v99, v99
v_mul_f32 v99, 0x3a000000, v99
v_cos_f32 v85, v99
v_sin_f32 v93, v99
v_mul_f32 v85, 0x3a000000, v85
v_mul_f32 v93, 0x3a000000, v93
v_add_u32 v99, 2, v100
v_mul_u32_u24 v99, v99, v98
v_and_b32 v99, 2047, v99
v_cvt_f32_u32 v99, v99
v_mul_f32 v99, 0x3a000000, v99
v_cos_f32 v86, v99
v_sin_f32 v94, v99
v_mul_f32 v86, 0x3a000000, v86
v_mul_f32 v94, 0x3a000000, v94
v_add_u32 v99, 3, v100
v_mul_u32_u24 v99, v99, v98
v_and_b32 v99, 2047, v99
v_cvt_f32_u32 v99, v99
v_mul_f32 v99, 0x3a000000, v99
v_cos_f32 v87, v99
v_sin_f32 v95, v99
v_mul_f32 v87, 0x3a000000, v87
v_mul_f32 v95, 0x3a000000, v95
v_lshrrev_b32 v98, 6, v0
v_and_b32 v99, 7, v98
v_lshlrev_b32 v99, 5, v99
v_lshl_add_u32 v98, v98, 8, v99
v_and_b32 v99, 16, v0
v_add_u32 v98, v98, v99
v_bfe_u32 v99, v0, 5, 1
v_lshl_add_u32 v224, v99, 3, v98
v_xor_b32 v225, 32, v224
v_xor_b32 v226, 64, v224
v_xor_b32 v227, 96, v224
v_xor_b32 v228, 128, v224
v_xor_b32 v229, 160, v224
v_xor_b32 v230, 192, v224
v_xor_b32 v231, 224, v224
v_lshrrev_b32 v98, 8, v0
v_bfe_u32 v99, v0, 5, 3
v_xor_b32 v99, v99, v98
v_mul_u32_u24 v98, 40960, v98
v_and_b32 v96, 16, v0
v_add_u32 v98, v98, v96
v_and_b32 v96, 3, v99
v_lshl_add_u32 v98, v96, 5, v98
v_lshrrev_b32 v99, 2, v99
v_lshl_add_u32 v232, v99, 10, v98
v_xor_b32 v99, 1, v99
v_lshl_add_u32 v233, v99, 10, v98
s_lshl_b32 s18, s13, 12
s_add_u32 s19, s18, 147456
v_add_u32 v220, s19, v0
s_mov_b32 s25, s18
s_mul_i32 s26, s16, 3145728
s_mul_i32 s19, s13, 655360
s_add_u32 s26, s26, s19
s_lshl_b32 s19, s39, 8
s_add_u32 s27, s26, s19
s_add_u32 s27, s27, 103809024
s_lshr_b32 s19, s39, 3
s_lshl_b32 s19, s19, 11
s_add_u32 s26, s26, s19
s_and_b32 s19, s39, 7
s_lshl_b32 s19, s19, 7
s_add_u32 s26, s26, s19
s_add_u32 s26, s26, 97517568
s_cmp_lg_u32 s16, 0
s_cbranch_scc1 cw_51
s_cmp_lg_u32 s13, 0
s_cbranch_scc1 polld_54
v_lshlrev_b32 v3, 3, v0
v_min_u32 v12, 3968, v3
s_mov_b32 s21, 11563008
s_mov_b32 s17, 0
poll_53:
buffer_load_dword v8, v3, s[4:7], s21 offen sc1
s_add_u32 s20, s21, 8192
buffer_load_dword v9, v3, s[4:7], s20 offen sc1
s_add_u32 s20, s21, 16384
buffer_load_dword v10, v3, s[4:7], s20 offen sc1
s_add_u32 s20, s21, 24576
buffer_load_dword v11, v12, s[4:7], s20 offen sc1
s_add_u32 s17, s17, 1
s_cmp_gt_u32 s17, 262144
s_cbranch_scc1 L_fail
s_waitcnt vmcnt(2)
v_min_u32 v8, v8, v9
s_waitcnt vmcnt(1)
v_min_u32 v8, v8, v10
s_waitcnt vmcnt(0)
v_min_u32 v8, v8, v11
v_cmp_gt_u32 vcc, 1, v8
s_cbranch_vccz polld_54
s_sleep 2
s_branch poll_53
polld_54:
s_barrier
s_add_u32 s18, s25, 145408
s_lshl_b32 s19, s39, 14
s_add_u32 s19, s19, s25
s_add_u32 s19, s19, 167772160
s_add_u32 m0, s18, 2048
s_add_u32 s20, s19, 0
buffer_load_dwordx4 v0, s[4:7], s20 offen sc1 lds
s_add_u32 m0, s18, 3072
s_add_u32 s20, s19, 1024
buffer_load_dwordx4 v0, s[4:7], s20 offen sc1 lds
s_add_u32 m0, s18, 4096
s_add_u32 s20, s19, 2048
buffer_load_dwordx4 v0, s[4:7], s20 offen sc1 lds
s_add_u32 m0, s18, 5120
s_add_u32 s20, s19, 3072
buffer_load_dwordx4 v0, s[4:7], s20 offen sc1 lds
s_branch cw_52
cw_51:
s_cmp_lg_u32 s13, 0
s_cbranch_scc1 polld_56
v_lshlrev_b32 v3, 3, v0
v_min_u32 v12, 4352, v3
s_mov_b32 s21, 11552768
s_mov_b32 s17, 0
poll_55:
buffer_load_dword v8, v12, s[4:7], s21 offen sc1
s_add_u32 s17, s17, 1
s_cmp_gt_u32 s17, 262144
s_cbranch_scc1 L_fail
s_waitcnt vmcnt(0)
v_cmp_gt_u32 vcc, 1, v8
s_cbranch_vccz polld_56
s_sleep 2
s_branch poll_55
polld_56:
s_barrier
cw_52:
s_add_u32 m0, s25, 0
s_add_u32 s20, s26, 0
buffer_load_dwordx4 v232, s[4:7], s20 offen sc1 lds
s_add_u32 m0, s25, 1024
s_add_u32 s20, s26, 163840
buffer_load_dwordx4 v233, s[4:7], s20 offen sc1 lds
s_add_u32 m0, s25, 2048
s_add_u32 s20, s26, 327680
buffer_load_dwordx4 v232, s[4:7], s20 offen sc1 lds
s_add_u32 m0, s25, 3072
s_add_u32 s20, s26, 491520
buffer_load_dwordx4 v233, s[4:7], s20 offen sc1 lds
s_lshr_b32 s18, s13, 1
s_lshl_b32 s18, s18, 10
s_and_b32 s19, s13, 1
s_lshl_b32 s19, s19, 3
s_add_u32 s18, s18, s19
v_add_u32 v234, s18, v0
v_bfe_u32 v235, v0, 4, 4
v_mul_u32_u24 v235, 40960, v235
v_lshrrev_b32 v99, 8, v0
v_lshl_add_u32 v235, v99, 4, v235
s_waitcnt vmcnt(0)
s_barrier
ds_read_b64_tr_b16 v[112:113], v225 offset:0
ds_read_b64_tr_b16 v[114:115], v225 offset:4096
ds_read_b64_tr_b16 v[98:99], v224 offset:4096
ds_read_b64_tr_b16 v[96:97], v224 offset:0
ds_read_b64_tr_b16 v[102:103], v224 offset:12288
ds_read_b64_tr_b16 v[144:145], v227 offset:0
ds_read_b64_tr_b16 v[130:131], v226 offset:4096
ds_read_b64_tr_b16 v[104:105], v228 offset:0
ds_read_b64_tr_b16 v[118:119], v225 offset:12288
ds_read_b64_tr_b16 v[100:101], v224 offset:8192
ds_read_b64_tr_b16 v[120:121], v229 offset:0
ds_read_b64_tr_b16 v[116:117], v225 offset:8192
ds_read_b64_tr_b16 v[110:111], v228 offset:12288
ds_read_b64_tr_b16 v[122:123], v229 offset:4096
ds_read_b64_tr_b16 v[108:109], v228 offset:8192
ds_read_b64_tr_b16 v[152:153], v231 offset:0
s_waitcnt lgkmcnt(14)
ds_read_b64_tr_b16 v[126:127], v229 offset:12288
v_mfma_f32_16x16x32_bf16 v[168:171], v[112:115], v[16:19], 0
s_waitcnt lgkmcnt(13)
ds_read_b64_tr_b16 v[106:107], v228 offset:4096
ds_read_b64_tr_b16 v[146:147], v227 offset:4096
v_mfma_f32_16x16x32_bf16 v[160:163], v[96:99], v[16:19], 0
ds_read_b64_tr_b16 v[128:129], v226 offset:0
ds_read_b64_tr_b16 v[134:135], v226 offset:12288
v_mfma_f32_16x16x32_bf16 v[168:171], v[96:99], v[32:35], v[168:171]
s_waitcnt lgkmcnt(13)
ds_read_b128 v[208:211], v220 offset:0
ds_read_b64_tr_b16 v[138:139], v230 offset:4096
v_mfma_f32_16x16x32_bf16 v[160:163], v[112:115], v[24:27], v[160:163]
s_waitcnt lgkmcnt(13)
ds_read_b64_tr_b16 v[136:137], v230 offset:0
ds_read_b64_tr_b16 v[140:141], v230 offset:8192
v_mfma_f32_16x16x32_bf16 v[160:163], v[100:103], v[20:23], v[160:163]
s_waitcnt lgkmcnt(13)
ds_read_b64_tr_b16 v[148:149], v227 offset:8192
ds_read_b64_tr_b16 v[124:125], v229 offset:8192
v_mfma_f32_16x16x32_bf16 v[160:163], v[116:119], v[28:31], v[160:163]
s_waitcnt lgkmcnt(13)
ds_read_b64_tr_b16 v[154:155], v231 offset:4096
ds_read_b64_tr_b16 v[142:143], v230 offset:12288
v_mfma_f32_16x16x32_bf16 v[168:171], v[116:119], v[20:23], v[168:171]
ds_read_b128 v[212:215], v220 offset:1024
ds_read_b128 v[216:219], v220 offset:2048
v_mfma_f32_16x16x32_bf16 v[168:171], v[100:103], v[36:39], v[168:171]
s_waitcnt lgkmcnt(13)
ds_read_b128 v[220:223], v220 offset:3072
v_mul_f32 v233, v161, v73
v_mfma_f32_16x16x32_bf16 v[172:175], v[120:123], v[16:19], 0
s_waitcnt lgkmcnt(13)
v_mul_f32 v232, v160, v72
v_mul_f32 v160, v160, v64
v_mfma_f32_16x16x32_bf16 v[164:167], v[104:107], v[16:19], 0
ds_read_b64_tr_b16 v[158:159], v231 offset:12288
ds_read_b64_tr_b16 v[150:151], v227 offset:12288
v_mfma_f32_16x16x32_bf16 v[172:175], v[104:107], v[32:35], v[172:175]
ds_read_b64_tr_b16 v[156:157], v231 offset:8192
v_fma_f32 v160, v168, v72, v160
v_mfma_f32_16x16x32_bf16 v[164:167], v[120:123], v[24:27], v[164:167]
s_waitcnt lgkmcnt(11)
ds_read_b64_tr_b16 v[132:133], v226 offset:8192
v_mul_f32 v161, v161, v65
v_mfma_f32_16x16x32_bf16 v[184:187], v[144:147], v[16:19], 0
s_waitcnt lgkmcnt(9)
v_fma_f32 v161, v169, v73, v161
v_fma_f32 v168, v168, v64, -v232
v_mfma_f32_16x16x32_bf16 v[164:167], v[108:111], v[20:23], v[164:167]
v_fma_f32 v169, v169, v65, -v233
v_mul_f32 v233, v163, v75
v_mfma_f32_16x16x32_bf16 v[172:175], v[124:127], v[20:23], v[172:175]
v_mul_f32 v232, v162, v74
v_mul_f32 v162, v162, v66
v_mfma_f32_16x16x32_bf16 v[164:167], v[124:127], v[28:31], v[164:167]
s_waitcnt lgkmcnt(7)
v_mul_f32 v163, v163, v67
v_cvt_pk_bf16_f32 v192, v160, v161
v_mfma_f32_16x16x32_bf16 v[172:175], v[108:111], v[36:39], v[172:175]
v_fma_f32 v162, v170, v74, v162
v_fma_f32 v170, v170, v66, -v232
v_mfma_f32_16x16x32_bf16 v[188:191], v[152:155], v[16:19], 0
s_waitcnt lgkmcnt(2)
v_fma_f32 v163, v171, v75, v163
v_mul_f32 v232, v164, v76
v_mfma_f32_16x16x32_bf16 v[180:183], v[136:139], v[16:19], 0
v_mul_f32 v164, v164, v68
v_fma_f32 v164, v172, v76, v164
v_mfma_f32_16x16x32_bf16 v[184:187], v[128:131], v[32:35], v[184:187]
v_fma_f32 v172, v172, v68, -v232
v_fma_f32 v171, v171, v67, -v233
v_mfma_f32_16x16x32_bf16 v[188:191], v[136:139], v[32:35], v[188:191]
s_waitcnt lgkmcnt(0)
v_mul_f32 v233, v165, v77
v_mul_f32 v165, v165, v69
v_mfma_f32_16x16x32_bf16 v[184:187], v[148:151], v[20:23], v[184:187]
v_fma_f32 v165, v173, v77, v165
v_mul_f32 v232, v166, v78
v_mfma_f32_16x16x32_bf16 v[176:179], v[128:131], v[16:19], 0
v_fma_f32 v173, v173, v69, -v233
v_mul_f32 v166, v166, v70
v_mfma_f32_16x16x32_bf16 v[180:183], v[152:155], v[24:27], v[180:183]
v_mul_f32 v233, v167, v79
v_fma_f32 v166, v174, v78, v166
v_mfma_f32_16x16x32_bf16 v[176:179], v[144:147], v[24:27], v[176:179]
v_cvt_pk_bf16_f32 v196, v168, v169
v_cvt_pk_bf16_f32 v198, v172, v173
v_mfma_f32_16x16x32_bf16 v[188:191], v[156:159], v[20:23], v[188:191]
v_mul_f32 v167, v167, v71
v_cvt_pk_bf16_f32 v193, v162, v163
v_mfma_f32_16x16x32_bf16 v[176:179], v[132:135], v[20:23], v[176:179]
v_cvt_pk_bf16_f32 v194, v164, v165
v_fma_f32 v167, v175, v79, v167
v_mfma_f32_16x16x32_bf16 v[176:179], v[148:151], v[28:31], v[176:179]
v_fma_f32 v175, v175, v71, -v233
v_fma_f32 v174, v174, v70, -v232
v_mfma_f32_16x16x32_bf16 v[188:191], v[140:143], v[36:39], v[188:191]
s_nop 0
v_cvt_pk_bf16_f32 v197, v170, v171
v_cvt_pk_bf16_f32 v195, v166, v167
v_mfma_f32_16x16x32_bf16 v[184:187], v[132:135], v[36:39], v[184:187]
s_nop 0
v_mul_f32 v232, v176, v72
v_mul_f32 v233, v177, v73
v_mfma_f32_16x16x32_bf16 v[164:167], v[44:47], v[192:195], 0
v_cvt_pk_bf16_f32 v199, v174, v175
v_mul_f32 v176, v176, v64
v_mfma_f32_16x16x32_bf16 v[180:183], v[140:143], v[20:23], v[180:183]
s_nop 0
v_fma_f32 v176, v184, v72, v176
v_fma_f32 v184, v184, v64, -v232
v_mfma_f32_16x16x32_bf16 v[164:167], v[52:55], v[196:199], v[164:167]
v_mul_f32 v232, v178, v74
v_mul_f32 v177, v177, v65
v_mfma_f32_16x16x32_bf16 v[168:171], v[40:43], v[196:199], 0
v_mul_f32 v178, v178, v66
v_fma_f32 v177, v185, v73, v177
v_mfma_f32_16x16x32_bf16 v[180:183], v[156:159], v[28:31], v[180:183]
v_fma_f32 v185, v185, v65, -v233
v_lshlrev_b32 v111, 16, v223
v_fma_f32 v178, v186, v74, v178
v_mfma_f32_16x16x32_bf16 v[172:175], v[44:47], v[196:199], 0
v_mul_f32 v233, v179, v75
v_mul_f32 v179, v179, v67
v_mfma_f32_16x16x32_bf16 v[168:171], v[56:59], v[192:195], v[168:171]
v_fma_f32 v179, v187, v75, v179
v_fma_f32 v186, v186, v66, -v232
v_mfma_f32_16x16x32_bf16 v[160:163], v[40:43], v[192:195], 0
v_fma_f32 v187, v187, v67, -v233
v_mul_f32 v233, v181, v77
v_mfma_f32_16x16x32_bf16 v[160:163], v[48:51], v[196:199], v[160:163]
v_cvt_pk_bf16_f32 v200, v176, v177
v_mul_f32 v232, v180, v76
v_mul_f32 v181, v181, v69
v_fma_f32 v181, v189, v77, v181
v_mul_f32 v180, v180, v68
v_fma_f32 v180, v188, v76, v180
v_mfma_f32_16x16x32_bf16 v[172:175], v[60:63], v[192:195], v[172:175]
v_fma_f32 v189, v189, v69, -v233
v_mul_f32 v233, v183, v79
v_lshlrev_b32 v97, 16, v216
v_fma_f32 v188, v188, v68, -v232
v_mul_f32 v183, v183, v71
v_fma_f32 v183, v191, v79, v183
v_cvt_pk_bf16_f32 v205, v186, v187
v_mul_f32 v232, v182, v78
v_mul_f32 v182, v182, v70
v_cvt_pk_bf16_f32 v201, v178, v179
v_fma_f32 v182, v190, v78, v182
v_cvt_pk_bf16_f32 v203, v182, v183
v_cvt_pk_bf16_f32 v202, v180, v181
v_cvt_pk_bf16_f32 v204, v184, v185
v_fma_f32 v190, v190, v70, -v232
v_mfma_f32_16x16x32_bf16 v[176:179], v[40:43], v[200:203], 0
v_lshlrev_b32 v98, 16, v209
v_lshlrev_b32 v99, 16, v217
v_mfma_f32_16x16x32_bf16 v[180:183], v[44:47], v[200:203], 0
v_mul_f32 v232, v160, v97
v_cvt_pk_bf16_f32 v206, v188, v189
v_fma_f32 v191, v191, v71, -v233
v_cvt_pk_bf16_f32 v207, v190, v191
v_lshlrev_b32 v106, 16, v213
v_and_b32 v118, 0xffff0000, v211
v_mfma_f32_16x16x32_bf16 v[188:191], v[44:47], v[204:207], 0
v_mul_f32 v233, v161, v99
v_mul_f32 v161, v161, v98
v_mfma_f32_16x16x32_bf16 v[176:179], v[48:51], v[204:207], v[176:179]
v_lshlrev_b32 v104, 16, v212
v_and_b32 v117, 0xffff0000, v218
v_lshlrev_b32 v96, 16, v208
v_mfma_f32_16x16x32_bf16 v[184:187], v[40:43], v[204:207], 0
v_mul_f32 v160, v160, v96
v_fma_f32 v161, v169, -v99, v161
v_mfma_f32_16x16x32_bf16 v[184:187], v[56:59], v[200:203], v[184:187]
v_fma_f32 v160, v168, -v97, v160
v_fma_f32 v169, v169, v98, v233
v_mfma_f32_16x16x32_bf16 v[188:191], v[60:63], v[200:203], v[188:191]
v_lshlrev_b32 v101, 16, v218
v_lshlrev_b32 v103, 16, v219
v_mfma_f32_16x16x32_bf16 v[180:183], v[52:55], v[204:207], v[180:183]
v_lshlrev_b32 v105, 16, v220
v_lshlrev_b32 v109, 16, v222
v_lshlrev_b32 v100, 16, v210
v_fma_f32 v168, v168, v96, v232
v_mul_f32 v233, v163, v103
v_lshlrev_b32 v102, 16, v211
v_mul_f32 v232, v162, v101
v_mul_f32 v163, v163, v102
v_mul_f32 v162, v162, v100
v_cvt_pk_bf16_f32 v196, v168, v169
v_fma_f32 v162, v170, -v101, v162
v_fma_f32 v163, v171, -v103, v163
v_fma_f32 v171, v171, v102, v233
v_fma_f32 v170, v170, v100, v232
v_and_b32 v126, 0xffff0000, v215
v_cvt_pk_bf16_f32 v193, v162, v163
v_and_b32 v112, 0xffff0000, v208
v_mul_f32 v232, v164, v105
v_mul_f32 v164, v164, v104
v_lshlrev_b32 v107, 16, v221
v_lshlrev_b32 v108, 16, v214
v_mul_f32 v233, v165, v107
v_mul_f32 v165, v165, v106
v_and_b32 v123, 0xffff0000, v221
v_cvt_pk_bf16_f32 v197, v170, v171
v_fma_f32 v164, v172, -v105, v164
v_fma_f32 v172, v172, v104, v232
v_fma_f32 v165, v173, -v107, v165
v_lshlrev_b32 v110, 16, v215
v_mul_f32 v232, v166, v109
v_mul_f32 v166, v166, v108
v_fma_f32 v166, v174, -v109, v166
v_fma_f32 v173, v173, v106, v233
v_mul_f32 v233, v167, v111
v_mul_f32 v167, v167, v110
v_and_b32 v113, 0xffff0000, v216
v_fma_f32 v167, v175, -v111, v167
v_and_b32 v115, 0xffff0000, v217
v_fma_f32 v174, v174, v108, v232
v_fma_f32 v175, v175, v110, v233
v_cvt_pk_bf16_f32 v192, v160, v161
v_cvt_pk_bf16_f32 v199, v174, v175
v_cvt_pk_bf16_f32 v198, v172, v173
v_mul_f32 v232, v176, v113
v_cvt_pk_bf16_f32 v194, v164, v165
v_mfma_f32_16x16x32_bf16 v[172:175], v[196:199], v[44:47], 0
v_mul_f32 v233, v177, v115
v_and_b32 v114, 0xffff0000, v209
v_mfma_f32_16x16x32_bf16 v[168:171], v[196:199], v[40:43], 0
v_cvt_pk_bf16_f32 v195, v166, v167
v_and_b32 v116, 0xffff0000, v210
v_mul_f32 v177, v177, v114
v_mfma_f32_16x16x32_bf16 v[160:163], v[192:195], v[40:43], 0
v_and_b32 v127, 0xffff0000, v223
v_mul_f32 v176, v176, v112
v_fma_f32 v176, v184, -v113, v176
v_mfma_f32_16x16x32_bf16 v[168:171], v[192:195], v[48:51], v[168:171]
v_fma_f32 v177, v185, -v115, v177
v_fma_f32 v184, v184, v112, v232
v_mfma_f32_16x16x32_bf16 v[160:163], v[196:199], v[56:59], v[160:163]
v_fma_f32 v185, v185, v114, v233
v_mul_f32 v232, v178, v117
v_and_b32 v119, 0xffff0000, v219
v_mul_f32 v178, v178, v116
v_and_b32 v125, 0xffff0000, v222
v_mfma_f32_16x16x32_bf16 v[172:175], v[192:195], v[52:55], v[172:175]
v_cvt_pk_bf16_f32 v204, v184, v185
v_mul_f32 v233, v179, v119
v_fma_f32 v178, v186, -v117, v178
v_mul_f32 v179, v179, v118
v_mfma_f32_16x16x32_bf16 v[164:167], v[192:195], v[44:47], 0
v_fma_f32 v179, v187, -v119, v179
v_fma_f32 v186, v186, v116, v232
v_and_b32 v122, 0xffff0000, v213
v_mfma_f32_16x16x32_bf16 v[164:167], v[196:199], v[60:63], v[164:167]
v_and_b32 v120, 0xffff0000, v212
v_and_b32 v121, 0xffff0000, v220
v_mul_f32 v232, v180, v121
v_and_b32 v124, 0xffff0000, v214
v_fma_f32 v187, v187, v118, v233
v_mul_f32 v233, v181, v123
v_cvt_pk_bf16_f32 v205, v186, v187
v_mul_f32 v180, v180, v120
v_mul_f32 v181, v181, v122
v_cvt_pk_bf16_f32 v201, v178, v179
v_fma_f32 v180, v188, -v121, v180
v_fma_f32 v188, v188, v120, v232
v_fma_f32 v181, v189, -v123, v181
v_fma_f32 v189, v189, v122, v233
v_mul_f32 v233, v183, v127
v_mul_f32 v232, v182, v125
v_mul_f32 v182, v182, v124
v_fma_f32 v182, v190, -v125, v182
v_mul_f32 v183, v183, v126
v_fma_f32 v183, v191, -v127, v183
v_cvt_pk_bf16_f32 v206, v188, v189
v_fma_f32 v190, v190, v124, v232
v_fma_f32 v191, v191, v126, v233
v_cvt_pk_bf16_f32 v207, v190, v191
v_cvt_pk_bf16_f32 v203, v182, v183
v_cvt_pk_bf16_f32 v200, v176, v177
v_cvt_pk_bf16_f32 v202, v180, v181
v_mul_f32 v233, v161, v89
v_mfma_f32_16x16x32_bf16 v[184:187], v[204:207], v[40:43], 0
v_mul_f32 v161, v161, v81
v_mul_f32 v232, v160, v88
v_mfma_f32_16x16x32_bf16 v[176:179], v[200:203], v[40:43], 0
v_fma_f32 v161, v169, -v89, v161
v_fma_f32 v169, v169, v81, v233
v_mfma_f32_16x16x32_bf16 v[188:191], v[204:207], v[44:47], 0
v_mul_f32 v160, v160, v80
v_fma_f32 v160, v168, -v88, v160
v_mfma_f32_16x16x32_bf16 v[176:179], v[204:207], v[56:59], v[176:179]
v_fma_f32 v168, v168, v80, v232
v_mul_f32 v233, v163, v91
v_mfma_f32_16x16x32_bf16 v[180:183], v[200:203], v[44:47], 0
v_mul_f32 v163, v163, v83
v_mul_f32 v232, v162, v90
v_fma_f32 v163, v171, -v91, v163
v_mfma_f32_16x16x32_bf16 v[180:183], v[204:207], v[60:63], v[180:183]
v_mul_f32 v162, v162, v82
v_fma_f32 v162, v170, -v90, v162
v_fma_f32 v171, v171, v83, v233
v_mfma_f32_16x16x32_bf16 v[184:187], v[200:203], v[48:51], v[184:187]
v_cvt_pk_bf16_f32 v196, v168, v169
v_mul_f32 v233, v165, v93
v_fma_f32 v170, v170, v82, v232
v_mul_f32 v232, v164, v92
v_mul_f32 v164, v164, v84
v_mul_f32 v165, v165, v85
v_fma_f32 v164, v172, -v92, v164
v_fma_f32 v165, v173, -v93, v165
v_fma_f32 v173, v173, v85, v233
v_fma_f32 v172, v172, v84, v232
v_mul_f32 v233, v167, v95
v_mul_f32 v232, v166, v94
v_mul_f32 v167, v167, v87
v_mul_f32 v166, v166, v86
v_fma_f32 v167, v175, -v95, v167
v_fma_f32 v166, v174, -v94, v166
v_fma_f32 v174, v174, v86, v232
v_mul_f32 v232, v176, v88
v_fma_f32 v175, v175, v87, v233
v_cvt_pk_bf16_f32 v194, v164, v165
v_mul_f32 v233, v177, v89
v_mul_f32 v176, v176, v80
v_mul_f32 v177, v177, v81
v_fma_f32 v176, v184, -v88, v176
v_cvt_pk_bf16_f32 v195, v166, v167
v_fma_f32 v184, v184, v80, v232
v_cvt_pk_bf16_f32 v197, v170, v171
v_mfma_f32_16x16x32_bf16 v[188:191], v[200:203], v[52:55], v[188:191]
ds_write_b64 v234, v[196:197] offset:20480
ds_write_b64 v234, v[194:195] offset:18432
v_cvt_pk_bf16_f32 v199, v174, v175
v_mul_f32 v232, v178, v90
v_mul_f32 v178, v178, v82
v_fma_f32 v177, v185, -v89, v177
v_fma_f32 v185, v185, v81, v233
v_cvt_pk_bf16_f32 v200, v176, v177
v_cvt_pk_bf16_f32 v193, v162, v163
v_fma_f32 v178, v186, -v90, v178
v_fma_f32 v186, v186, v82, v232
v_mul_f32 v233, v179, v91
v_mul_f32 v179, v179, v83
v_cvt_pk_bf16_f32 v204, v184, v185
v_mul_f32 v232, v180, v92
v_cvt_pk_bf16_f32 v192, v160, v161
v_cvt_pk_bf16_f32 v198, v172, v173
v_fma_f32 v179, v187, -v91, v179
v_fma_f32 v187, v187, v83, v233
v_mul_f32 v180, v180, v84
v_cvt_pk_bf16_f32 v205, v186, v187
v_fma_f32 v180, v188, -v92, v180
v_mul_f32 v233, v181, v93
ds_write_b64 v234, v[204:205] offset:28672
ds_write_b64 v234, v[198:199] offset:22528
ds_write_b64 v234, v[192:193] offset:16384
v_mul_f32 v181, v181, v85
v_fma_f32 v181, v189, -v93, v181
v_fma_f32 v189, v189, v85, v233
v_fma_f32 v188, v188, v84, v232
v_cvt_pk_bf16_f32 v202, v180, v181
v_mul_f32 v232, v182, v94
v_mul_f32 v233, v183, v95
v_mul_f32 v182, v182, v86
v_fma_f32 v182, v190, -v94, v182
v_mul_f32 v183, v183, v87
v_fma_f32 v183, v191, -v95, v183
v_cvt_pk_bf16_f32 v201, v178, v179
v_cvt_pk_bf16_f32 v203, v182, v183
s_waitcnt lgkmcnt(0)
ds_write_b64 v234, v[200:201] offset:24576
ds_write_b64 v234, v[202:203] offset:26624
v_fma_f32 v191, v191, v87, v233
v_fma_f32 v190, v190, v86, v232
v_cvt_pk_bf16_f32 v207, v190, v191
v_cvt_pk_bf16_f32 v206, v188, v189
s_waitcnt lgkmcnt(0)
ds_write_b64 v234, v[206:207] offset:30720
s_waitcnt lgkmcnt(0)
s_barrier
ds_read_b128 v[112:115], v0 offset:20480
ds_read_b128 v[96:99], v0 offset:16384
ds_read_b128 v[128:131], v0 offset:24576
ds_read_b128 v[104:107], v0 offset:18432
ds_read_b128 v[100:103], v0 offset:17408
ds_read_b128 v[144:147], v0 offset:28672
ds_read_b128 v[116:119], v0 offset:21504
ds_read_b128 v[120:123], v0 offset:22528
ds_read_b128 v[156:159], v0 offset:31744
s_waitcnt lgkmcnt(8)
v_mfma_f32_16x16x32_bf16 v[168:171], v[112:115], v[16:19], 0
s_waitcnt lgkmcnt(7)
v_mfma_f32_16x16x32_bf16 v[160:163], v[96:99], v[16:19], 0
ds_read_b128 v[124:127], v0 offset:23552
v_mfma_f32_16x16x32_bf16 v[168:171], v[96:99], v[24:27], v[168:171]
s_waitcnt lgkmcnt(7)
ds_read_b128 v[148:151], v0 offset:29696
v_mfma_f32_16x16x32_bf16 v[160:163], v[112:115], v[32:35], v[160:163]
v_mfma_f32_16x16x32_bf16 v[176:179], v[128:131], v[16:19], 0
s_waitcnt lgkmcnt(7)
ds_read_b128 v[152:155], v0 offset:30720
v_mfma_f32_16x16x32_bf16 v[164:167], v[104:107], v[16:19], 0
s_waitcnt lgkmcnt(6)
s_waitcnt lgkmcnt(5)
v_mfma_f32_16x16x32_bf16 v[184:187], v[144:147], v[16:19], 0
ds_read_b128 v[108:111], v0 offset:19456
v_mfma_f32_16x16x32_bf16 v[168:171], v[116:119], v[20:23], v[168:171]
v_mfma_f32_16x16x32_bf16 v[160:163], v[100:103], v[20:23], v[160:163]
ds_read_b128 v[140:143], v0 offset:27648
s_waitcnt lgkmcnt(4)
v_mfma_f32_16x16x32_bf16 v[168:171], v[100:103], v[28:31], v[168:171]
ds_read_b128 v[132:135], v0 offset:25600
v_mfma_f32_16x16x32_bf16 v[164:167], v[120:123], v[32:35], v[164:167]
v_mfma_f32_16x16x32_bf16 v[160:163], v[116:119], v[36:39], v[160:163]
s_nop 0
s_waitcnt lgkmcnt(2)
v_mfma_f32_16x16x32_bf16 v[172:175], v[120:123], v[16:19], 0
s_nop 0
ds_read_b128 v[136:139], v0 offset:26624
s_nop 0
v_mfma_f32_16x16x32_bf16 v[172:175], v[104:107], v[24:27], v[172:175]
s_nop 0
v_cvt_pk_bf16_f32 v192, v160, v161
v_mfma_f32_16x16x32_bf16 v[172:175], v[124:127], v[20:23], v[172:175]
v_mfma_f32_16x16x32_bf16 v[172:175], v[108:111], v[28:31], v[172:175]
v_mfma_f32_16x16x32_bf16 v[164:167], v[108:111], v[20:23], v[164:167]
s_waitcnt lgkmcnt(1)
v_cvt_pk_bf16_f32 v193, v162, v163
v_cvt_pk_bf16_f32 v197, v170, v171
v_mfma_f32_16x16x32_bf16 v[164:167], v[124:127], v[36:39], v[164:167]
v_mfma_f32_16x16x32_bf16 v[176:179], v[144:147], v[32:35], v[176:179]
v_cvt_pk_bf16_f32 v196, v168, v169
v_mfma_f32_16x16x32_bf16 v[176:179], v[132:135], v[20:23], v[176:179]
s_waitcnt lgkmcnt(0)
v_mfma_f32_16x16x32_bf16 v[176:179], v[148:151], v[36:39], v[176:179]
s_nop 1
v_mfma_f32_16x16x32_bf16 v[184:187], v[128:131], v[24:27], v[184:187]
s_nop 0
v_cvt_pk_bf16_f32 v195, v166, v167
s_nop 0
v_mfma_f32_16x16x32_bf16 v[180:183], v[136:139], v[16:19], 0
s_nop 0
v_cvt_pk_bf16_f32 v201, v178, v179
v_mfma_f32_16x16x32_bf16 v[180:183], v[152:155], v[32:35], v[180:183]
v_cvt_pk_bf16_f32 v199, v174, v175
v_mfma_f32_16x16x32_bf16 v[180:183], v[140:143], v[20:23], v[180:183]
v_cvt_pk_bf16_f32 v200, v176, v177
v_mfma_f32_16x16x32_bf16 v[180:183], v[156:159], v[36:39], v[180:183]
v_cvt_pk_bf16_f32 v198, v172, v173
v_mfma_f32_16x16x32_bf16 v[184:187], v[148:151], v[20:23], v[184:187]
s_nop 2
v_mfma_f32_16x16x32_bf16 v[184:187], v[132:135], v[28:31], v[184:187]
s_nop 0
v_cvt_pk_bf16_f32 v194, v164, v165
v_cvt_pk_bf16_f32 v203, v182, v183
v_mfma_f32_16x16x32_bf16 v[188:191], v[152:155], v[16:19], 0
v_cvt_pk_bf16_f32 v202, v180, v181
v_mfma_f32_16x16x32_bf16 v[188:191], v[136:139], v[24:27], v[188:191]
buffer_store_dwordx4 v[192:195], v235, s[4:7], s27 offen offset:0 sc1
v_mfma_f32_16x16x32_bf16 v[188:191], v[156:159], v[20:23], v[188:191]
v_cvt_pk_bf16_f32 v205, v186, v187
v_cvt_pk_bf16_f32 v204, v184, v185
v_mfma_f32_16x16x32_bf16 v[188:191], v[140:143], v[28:31], v[188:191]
buffer_store_dwordx4 v[196:199], v235, s[4:7], s27 offen offset:64 sc1
s_nop 2
buffer_store_dwordx4 v[200:203], v235, s[4:7], s27 offen offset:128 sc1
s_nop 2
v_cvt_pk_bf16_f32 v207, v190, v191
v_cvt_pk_bf16_f32 v206, v188, v189
buffer_store_dwordx4 v[204:207], v235, s[4:7], s27 offen offset:192 sc1
s_lshl_b32 s18, s39, 7
s_add_u32 s18, s18, 11591680
s_add_u32 s29, s16, 1
s_cmp_eq_u32 s13, 0
s_cselect_b32 s22, s18, s6
s_mov_b32 s23, s29
s_lshl_b32 s18, s34, 7
s_lshl_b32 s19, s13, 5
s_add_u32 s18, s18, s19
s_mov_b32 s19, 0x3acccccd
v_bfe_u32 v222, v0, 4, 5
v_lshrrev_b32 v217, 9, v0
v_and_b32 v220, 19, v222
v_bfe_u32 v223, v222, 2, 1
v_lshl_add_u32 v220, v223, 3, v220
v_bfe_u32 v223, v222, 3, 1
v_lshl_add_u32 v220, v223, 2, v220
v_add_u32 v220, s18, v220
v_lshlrev_b32 v217, 2, v217
v_mov_b32 v221, 0
v_mad_u32_u24 v221, v217, v220, v221
v_mad_u32_u24 v216, v220, 8, 0
v_cvt_f32_u32 v216, v216
v_mul_f32 v222, s19, v216
v_rndne_f32 v222, v222
v_fmac_f32 v216, 0xc4200000, v222
v_mul_f32 v216, s19, v216
v_cos_f32 v216, v216
s_nop 0
v_add_f32 v216, v216, v216
v_mad_u32_u24 v218, v220, 1, 0
v_cvt_f32_u32 v218, v218
v_mul_f32 v222, s19, v218
v_rndne_f32 v222, v222
v_fmac_f32 v218, 0xc4200000, v222
v_mul_f32 v218, s19, v218
v_cos_f32 v218, v218
s_nop 0
v_add_f32 v218, v218, v218
v_mad_u32_u24 v200, v220, 1, v221
v_cvt_f32_u32 v200, v200
v_mul_f32 v222, s19, v200
v_rndne_f32 v222, v222
v_fmac_f32 v200, 0xc4200000, v222
v_mul_f32 v200, s19, v200
v_sin_f32 v201, -v200
v_cos_f32 v200, v200
v_mad_u32_u24 v202, v220, 2, v221
v_cvt_f32_u32 v202, v202
v_mul_f32 v222, s19, v202
v_rndne_f32 v222, v222
v_fmac_f32 v202, 0xc4200000, v222
v_mul_f32 v202, s19, v202
v_sin_f32 v203, -v202
v_cos_f32 v202, v202
s_nop 0
v_pk_fma_f32 v[204:205], v[218:219], v[202:203], v[200:201] op_sel_hi:[0,1,1] neg_lo:[0,0,1] neg_hi:[0,0,1]
v_pk_fma_f32 v[206:207], v[218:219], v[204:205], v[202:203] op_sel_hi:[0,1,1] neg_lo:[0,0,1] neg_hi:[0,0,1]
v_cvt_pk_bf16_f32 v16, v200, v201
v_cvt_pk_bf16_f32 v17, v202, v203
v_cvt_pk_bf16_f32 v18, v204, v205
v_cvt_pk_bf16_f32 v19, v206, v207
v_mad_u32_u24 v208, v220, 9, v221
v_cvt_f32_u32 v208, v208
v_mul_f32 v222, s19, v208
v_rndne_f32 v222, v222
v_fmac_f32 v208, 0xc4200000, v222
v_mul_f32 v208, s19, v208
v_sin_f32 v209, -v208
v_cos_f32 v208, v208
v_mad_u32_u24 v210, v220, 10, v221
v_cvt_f32_u32 v210, v210
v_mul_f32 v222, s19, v210
v_rndne_f32 v222, v222
v_fmac_f32 v210, 0xc4200000, v222
v_mul_f32 v210, s19, v210
v_sin_f32 v211, -v210
v_cos_f32 v210, v210
s_nop 0
v_pk_fma_f32 v[212:213], v[218:219], v[210:211], v[208:209] op_sel_hi:[0,1,1] neg_lo:[0,0,1] neg_hi:[0,0,1]
v_pk_fma_f32 v[214:215], v[218:219], v[212:213], v[210:211] op_sel_hi:[0,1,1] neg_lo:[0,0,1] neg_hi:[0,0,1]
v_cvt_pk_bf16_f32 v20, v208, v209
v_cvt_pk_bf16_f32 v21, v210, v211
v_cvt_pk_bf16_f32 v22, v212, v213
v_cvt_pk_bf16_f32 v23, v214, v215
v_pk_fma_f32 v[200:201], v[216:217], v[208:209], v[200:201] op_sel_hi:[0,1,1] neg_lo:[0,0,1] neg_hi:[0,0,1]
v_pk_fma_f32 v[202:203], v[216:217], v[210:211], v[202:203] op_sel_hi:[0,1,1] neg_lo:[0,0,1] neg_hi:[0,0,1]
v_pk_fma_f32 v[204:205], v[216:217], v[212:213], v[204:205] op_sel_hi:[0,1,1] neg_lo:[0,0,1] neg_hi:[0,0,1]
v_pk_fma_f32 v[206:207], v[216:217], v[214:215], v[206:207] op_sel_hi:[0,1,1] neg_lo:[0,0,1] neg_hi:[0,0,1]
v_cvt_pk_bf16_f32 v24, v200, v201
v_cvt_pk_bf16_f32 v25, v202, v203
v_cvt_pk_bf16_f32 v26, v204, v205
v_cvt_pk_bf16_f32 v27, v206, v207
v_pk_fma_f32 v[208:209], v[216:217], v[200:201], v[208:209] op_sel_hi:[0,1,1] neg_lo:[0,0,1] neg_hi:[0,0,1]
v_pk_fma_f32 v[210:211], v[216:217], v[202:203], v[210:211] op_sel_hi:[0,1,1] neg_lo:[0,0,1] neg_hi:[0,0,1]
v_pk_fma_f32 v[212:213], v[216:217], v[204:205], v[212:213] op_sel_hi:[0,1,1] neg_lo:[0,0,1] neg_hi:[0,0,1]
v_pk_fma_f32 v[214:215], v[216:217], v[206:207], v[214:215] op_sel_hi:[0,1,1] neg_lo:[0,0,1] neg_hi:[0,0,1]
v_cvt_pk_bf16_f32 v28, v208, v209
v_cvt_pk_bf16_f32 v29, v210, v211
v_cvt_pk_bf16_f32 v30, v212, v213
v_cvt_pk_bf16_f32 v31, v214, v215
v_pk_fma_f32 v[200:201], v[216:217], v[208:209], v[200:201] op_sel_hi:[0,1,1] neg_lo:[0,0,1] neg_hi:[0,0,1]
v_pk_fma_f32 v[202:203], v[216:217], v[210:211], v[202:203] op_sel_hi:[0,1,1] neg_lo:[0,0,1] neg_hi:[0,0,1]
v_pk_fma_f32 v[204:205], v[216:217], v[212:213], v[204:205] op_sel_hi:[0,1,1] neg_lo:[0,0,1] neg_hi:[0,0,1]
v_pk_fma_f32 v[206:207], v[216:217], v[214:215], v[206:207] op_sel_hi:[0,1,1] neg_lo:[0,0,1] neg_hi:[0,0,1]
v_cvt_pk_bf16_f32 v32, v200, v201
v_cvt_pk_bf16_f32 v33, v202, v203
v_cvt_pk_bf16_f32 v34, v204, v205
v_cvt_pk_bf16_f32 v35, v206, v207
v_pk_fma_f32 v[208:209], v[216:217], v[200:201], v[208:209] op_sel_hi:[0,1,1] neg_lo:[0,0,1] neg_hi:[0,0,1]
v_pk_fma_f32 v[210:211], v[216:217], v[202:203], v[210:211] op_sel_hi:[0,1,1] neg_lo:[0,0,1] neg_hi:[0,0,1]
v_pk_fma_f32 v[212:213], v[216:217], v[204:205], v[212:213] op_sel_hi:[0,1,1] neg_lo:[0,0,1] neg_hi:[0,0,1]
v_pk_fma_f32 v[214:215], v[216:217], v[206:207], v[214:215] op_sel_hi:[0,1,1] neg_lo:[0,0,1] neg_hi:[0,0,1]
v_cvt_pk_bf16_f32 v36, v208, v209
v_cvt_pk_bf16_f32 v37, v210, v211
v_cvt_pk_bf16_f32 v38, v212, v213
v_cvt_pk_bf16_f32 v39, v214, v215
v_pk_fma_f32 v[200:201], v[216:217], v[208:209], v[200:201] op_sel_hi:[0,1,1] neg_lo:[0,0,1] neg_hi:[0,0,1]
v_pk_fma_f32 v[202:203], v[216:217], v[210:211], v[202:203] op_sel_hi:[0,1,1] neg_lo:[0,0,1] neg_hi:[0,0,1]
v_pk_fma_f32 v[204:205], v[216:217], v[212:213], v[204:205] op_sel_hi:[0,1,1] neg_lo:[0,0,1] neg_hi:[0,0,1]
v_pk_fma_f32 v[206:207], v[216:217], v[214:215], v[206:207] op_sel_hi:[0,1,1] neg_lo:[0,0,1] neg_hi:[0,0,1]
v_cvt_pk_bf16_f32 v40, v200, v201
v_cvt_pk_bf16_f32 v41, v202, v203
v_cvt_pk_bf16_f32 v42, v204, v205
v_cvt_pk_bf16_f32 v43, v206, v207
v_pk_fma_f32 v[208:209], v[216:217], v[200:201], v[208:209] op_sel_hi:[0,1,1] neg_lo:[0,0,1] neg_hi:[0,0,1]
v_pk_fma_f32 v[210:211], v[216:217], v[202:203], v[210:211] op_sel_hi:[0,1,1] neg_lo:[0,0,1] neg_hi:[0,0,1]
v_pk_fma_f32 v[212:213], v[216:217], v[204:205], v[212:213] op_sel_hi:[0,1,1] neg_lo:[0,0,1] neg_hi:[0,0,1]
v_pk_fma_f32 v[214:215], v[216:217], v[206:207], v[214:215] op_sel_hi:[0,1,1] neg_lo:[0,0,1] neg_hi:[0,0,1]
v_cvt_pk_bf16_f32 v44, v208, v209
v_cvt_pk_bf16_f32 v45, v210, v211
v_cvt_pk_bf16_f32 v46, v212, v213
v_cvt_pk_bf16_f32 v47, v214, v215
v_pk_fma_f32 v[200:201], v[216:217], v[208:209], v[200:201] op_sel_hi:[0,1,1] neg_lo:[0,0,1] neg_hi:[0,0,1]
v_pk_fma_f32 v[202:203], v[216:217], v[210:211], v[202:203] op_sel_hi:[0,1,1] neg_lo:[0,0,1] neg_hi:[0,0,1]
v_pk_fma_f32 v[204:205], v[216:217], v[212:213], v[204:205] op_sel_hi:[0,1,1] neg_lo:[0,0,1] neg_hi:[0,0,1]
v_pk_fma_f32 v[206:207], v[216:217], v[214:215], v[206:207] op_sel_hi:[0,1,1] neg_lo:[0,0,1] neg_hi:[0,0,1]
v_cvt_pk_bf16_f32 v48, v200, v201
v_cvt_pk_bf16_f32 v49, v202, v203
v_cvt_pk_bf16_f32 v50, v204, v205
v_cvt_pk_bf16_f32 v51, v206, v207
v_pk_fma_f32 v[208:209], v[216:217], v[200:201], v[208:209] op_sel_hi:[0,1,1] neg_lo:[0,0,1] neg_hi:[0,0,1]
v_pk_fma_f32 v[210:211], v[216:217], v[202:203], v[210:211] op_sel_hi:[0,1,1] neg_lo:[0,0,1] neg_hi:[0,0,1]
v_pk_fma_f32 v[212:213], v[216:217], v[204:205], v[212:213] op_sel_hi:[0,1,1] neg_lo:[0,0,1] neg_hi:[0,0,1]
v_pk_fma_f32 v[214:215], v[216:217], v[206:207], v[214:215] op_sel_hi:[0,1,1] neg_lo:[0,0,1] neg_hi:[0,0,1]
v_cvt_pk_bf16_f32 v52, v208, v209
v_cvt_pk_bf16_f32 v53, v210, v211
v_cvt_pk_bf16_f32 v54, v212, v213
v_cvt_pk_bf16_f32 v55, v214, v215
v_pk_fma_f32 v[200:201], v[216:217], v[208:209], v[200:201] op_sel_hi:[0,1,1] neg_lo:[0,0,1] neg_hi:[0,0,1]
v_pk_fma_f32 v[202:203], v[216:217], v[210:211], v[202:203] op_sel_hi:[0,1,1] neg_lo:[0,0,1] neg_hi:[0,0,1]
v_pk_fma_f32 v[204:205], v[216:217], v[212:213], v[204:205] op_sel_hi:[0,1,1] neg_lo:[0,0,1] neg_hi:[0,0,1]
v_pk_fma_f32 v[206:207], v[216:217], v[214:215], v[206:207] op_sel_hi:[0,1,1] neg_lo:[0,0,1] neg_hi:[0,0,1]
v_cvt_pk_bf16_f32 v56, v200, v201
v_cvt_pk_bf16_f32 v57, v202, v203
v_cvt_pk_bf16_f32 v58, v204, v205
v_cvt_pk_bf16_f32 v59, v206, v207
v_pk_fma_f32 v[208:209], v[216:217], v[200:201], v[208:209] op_sel_hi:[0,1,1] neg_lo:[0,0,1] neg_hi:[0,0,1]
v_pk_fma_f32 v[210:211], v[216:217], v[202:203], v[210:211] op_sel_hi:[0,1,1] neg_lo:[0,0,1] neg_hi:[0,0,1]
v_pk_fma_f32 v[212:213], v[216:217], v[204:205], v[212:213] op_sel_hi:[0,1,1] neg_lo:[0,0,1] neg_hi:[0,0,1]
v_pk_fma_f32 v[214:215], v[216:217], v[206:207], v[214:215] op_sel_hi:[0,1,1] neg_lo:[0,0,1] neg_hi:[0,0,1]
v_cvt_pk_bf16_f32 v60, v208, v209
v_cvt_pk_bf16_f32 v61, v210, v211
v_cvt_pk_bf16_f32 v62, v212, v213
v_cvt_pk_bf16_f32 v63, v214, v215
v_pk_fma_f32 v[200:201], v[216:217], v[208:209], v[200:201] op_sel_hi:[0,1,1] neg_lo:[0,0,1] neg_hi:[0,0,1]
v_pk_fma_f32 v[202:203], v[216:217], v[210:211], v[202:203] op_sel_hi:[0,1,1] neg_lo:[0,0,1] neg_hi:[0,0,1]
v_pk_fma_f32 v[204:205], v[216:217], v[212:213], v[204:205] op_sel_hi:[0,1,1] neg_lo:[0,0,1] neg_hi:[0,0,1]
v_pk_fma_f32 v[206:207], v[216:217], v[214:215], v[206:207] op_sel_hi:[0,1,1] neg_lo:[0,0,1] neg_hi:[0,0,1]
v_cvt_pk_bf16_f32 v64, v200, v201
v_cvt_pk_bf16_f32 v65, v202, v203
v_cvt_pk_bf16_f32 v66, v204, v205
v_cvt_pk_bf16_f32 v67, v206, v207
s_waitcnt vmcnt(0)
s_barrier
v_mov_b32 v3, s23
s_mov_b64 exec, 1
buffer_store_dword v3, off, s[4:7], s22 sc1
s_mov_b64 exec, -1
s_mov_b32 s22, s6
v_pk_fma_f32 v[208:209], v[216:217], v[200:201], v[208:209] op_sel_hi:[0,1,1] neg_lo:[0,0,1] neg_hi:[0,0,1]
v_pk_fma_f32 v[210:211], v[216:217], v[202:203], v[210:211] op_sel_hi:[0,1,1] neg_lo:[0,0,1] neg_hi:[0,0,1]
v_pk_fma_f32 v[212:213], v[216:217], v[204:205], v[212:213] op_sel_hi:[0,1,1] neg_lo:[0,0,1] neg_hi:[0,0,1]
v_pk_fma_f32 v[214:215], v[216:217], v[206:207], v[214:215] op_sel_hi:[0,1,1] neg_lo:[0,0,1] neg_hi:[0,0,1]
v_cvt_pk_bf16_f32 v68, v208, v209
v_cvt_pk_bf16_f32 v69, v210, v211
v_cvt_pk_bf16_f32 v70, v212, v213
v_cvt_pk_bf16_f32 v71, v214, v215
v_pk_fma_f32 v[200:201], v[216:217], v[208:209], v[200:201] op_sel_hi:[0,1,1] neg_lo:[0,0,1] neg_hi:[0,0,1]
v_pk_fma_f32 v[202:203], v[216:217], v[210:211], v[202:203] op_sel_hi:[0,1,1] neg_lo:[0,0,1] neg_hi:[0,0,1]
v_pk_fma_f32 v[204:205], v[216:217], v[212:213], v[204:205] op_sel_hi:[0,1,1] neg_lo:[0,0,1] neg_hi:[0,0,1]
v_pk_fma_f32 v[206:207], v[216:217], v[214:215], v[206:207] op_sel_hi:[0,1,1] neg_lo:[0,0,1] neg_hi:[0,0,1]
v_cvt_pk_bf16_f32 v72, v200, v201
v_cvt_pk_bf16_f32 v73, v202, v203
v_cvt_pk_bf16_f32 v74, v204, v205
v_cvt_pk_bf16_f32 v75, v206, v207
v_pk_fma_f32 v[208:209], v[216:217], v[200:201], v[208:209] op_sel_hi:[0,1,1] neg_lo:[0,0,1] neg_hi:[0,0,1]
v_pk_fma_f32 v[210:211], v[216:217], v[202:203], v[210:211] op_sel_hi:[0,1,1] neg_lo:[0,0,1] neg_hi:[0,0,1]
v_pk_fma_f32 v[212:213], v[216:217], v[204:205], v[212:213] op_sel_hi:[0,1,1] neg_lo:[0,0,1] neg_hi:[0,0,1]
v_pk_fma_f32 v[214:215], v[216:217], v[206:207], v[214:215] op_sel_hi:[0,1,1] neg_lo:[0,0,1] neg_hi:[0,0,1]
v_cvt_pk_bf16_f32 v76, v208, v209
v_cvt_pk_bf16_f32 v77, v210, v211
v_cvt_pk_bf16_f32 v78, v212, v213
v_cvt_pk_bf16_f32 v79, v214, v215
v_pk_fma_f32 v[200:201], v[216:217], v[208:209], v[200:201] op_sel_hi:[0,1,1] neg_lo:[0,0,1] neg_hi:[0,0,1]
v_pk_fma_f32 v[202:203], v[216:217], v[210:211], v[202:203] op_sel_hi:[0,1,1] neg_lo:[0,0,1] neg_hi:[0,0,1]
v_pk_fma_f32 v[204:205], v[216:217], v[212:213], v[204:205] op_sel_hi:[0,1,1] neg_lo:[0,0,1] neg_hi:[0,0,1]
v_pk_fma_f32 v[206:207], v[216:217], v[214:215], v[206:207] op_sel_hi:[0,1,1] neg_lo:[0,0,1] neg_hi:[0,0,1]
v_cvt_pk_bf16_f32 v80, v200, v201
v_cvt_pk_bf16_f32 v81, v202, v203
v_cvt_pk_bf16_f32 v82, v204, v205
v_cvt_pk_bf16_f32 v83, v206, v207
v_pk_fma_f32 v[208:209], v[216:217], v[200:201], v[208:209] op_sel_hi:[0,1,1] neg_lo:[0,0,1] neg_hi:[0,0,1]
v_pk_fma_f32 v[210:211], v[216:217], v[202:203], v[210:211] op_sel_hi:[0,1,1] neg_lo:[0,0,1] neg_hi:[0,0,1]
v_pk_fma_f32 v[212:213], v[216:217], v[204:205], v[212:213] op_sel_hi:[0,1,1] neg_lo:[0,0,1] neg_hi:[0,0,1]
v_pk_fma_f32 v[214:215], v[216:217], v[206:207], v[214:215] op_sel_hi:[0,1,1] neg_lo:[0,0,1] neg_hi:[0,0,1]
v_cvt_pk_bf16_f32 v84, v208, v209
v_cvt_pk_bf16_f32 v85, v210, v211
v_cvt_pk_bf16_f32 v86, v212, v213
v_cvt_pk_bf16_f32 v87, v214, v215
v_pk_fma_f32 v[200:201], v[216:217], v[208:209], v[200:201] op_sel_hi:[0,1,1] neg_lo:[0,0,1] neg_hi:[0,0,1]
v_pk_fma_f32 v[202:203], v[216:217], v[210:211], v[202:203] op_sel_hi:[0,1,1] neg_lo:[0,0,1] neg_hi:[0,0,1]
v_pk_fma_f32 v[204:205], v[216:217], v[212:213], v[204:205] op_sel_hi:[0,1,1] neg_lo:[0,0,1] neg_hi:[0,0,1]
v_pk_fma_f32 v[206:207], v[216:217], v[214:215], v[206:207] op_sel_hi:[0,1,1] neg_lo:[0,0,1] neg_hi:[0,0,1]
v_cvt_pk_bf16_f32 v88, v200, v201
v_cvt_pk_bf16_f32 v89, v202, v203
v_cvt_pk_bf16_f32 v90, v204, v205
v_cvt_pk_bf16_f32 v91, v206, v207
v_pk_fma_f32 v[208:209], v[216:217], v[200:201], v[208:209] op_sel_hi:[0,1,1] neg_lo:[0,0,1] neg_hi:[0,0,1]
v_pk_fma_f32 v[210:211], v[216:217], v[202:203], v[210:211] op_sel_hi:[0,1,1] neg_lo:[0,0,1] neg_hi:[0,0,1]
v_pk_fma_f32 v[212:213], v[216:217], v[204:205], v[212:213] op_sel_hi:[0,1,1] neg_lo:[0,0,1] neg_hi:[0,0,1]
v_pk_fma_f32 v[214:215], v[216:217], v[206:207], v[214:215] op_sel_hi:[0,1,1] neg_lo:[0,0,1] neg_hi:[0,0,1]
v_cvt_pk_bf16_f32 v92, v208, v209
v_cvt_pk_bf16_f32 v93, v210, v211
v_cvt_pk_bf16_f32 v94, v212, v213
v_cvt_pk_bf16_f32 v95, v214, v215
s_mov_b32 s20, 161
v_mad_u32_u24 v200, v220, s20, v221
v_cvt_f32_u32 v200, v200
v_mul_f32 v222, s19, v200
v_rndne_f32 v222, v222
v_fmac_f32 v200, 0xc4200000, v222
v_mul_f32 v200, s19, v200
v_sin_f32 v201, -v200
v_cos_f32 v200, v200
s_mov_b32 s20, 162
v_mad_u32_u24 v202, v220, s20, v221
v_cvt_f32_u32 v202, v202
v_mul_f32 v222, s19, v202
v_rndne_f32 v222, v222
v_fmac_f32 v202, 0xc4200000, v222
v_mul_f32 v202, s19, v202
v_sin_f32 v203, -v202
v_cos_f32 v202, v202
s_nop 0
v_pk_fma_f32 v[204:205], v[218:219], v[202:203], v[200:201] op_sel_hi:[0,1,1] neg_lo:[0,0,1] neg_hi:[0,0,1]
v_pk_fma_f32 v[206:207], v[218:219], v[204:205], v[202:203] op_sel_hi:[0,1,1] neg_lo:[0,0,1] neg_hi:[0,0,1]
v_cvt_pk_bf16_f32 v96, v200, v201
v_cvt_pk_bf16_f32 v97, v202, v203
v_cvt_pk_bf16_f32 v98, v204, v205
v_cvt_pk_bf16_f32 v99, v206, v207
s_mov_b32 s20, 169
v_mad_u32_u24 v208, v220, s20, v221
v_cvt_f32_u32 v208, v208
v_mul_f32 v222, s19, v208
v_rndne_f32 v222, v222
v_fmac_f32 v208, 0xc4200000, v222
v_mul_f32 v208, s19, v208
v_sin_f32 v209, -v208
v_cos_f32 v208, v208
s_mov_b32 s20, 170
v_mad_u32_u24 v210, v220, s20, v221
v_cvt_f32_u32 v210, v210
v_mul_f32 v222, s19, v210
v_rndne_f32 v222, v222
v_fmac_f32 v210, 0xc4200000, v222
v_mul_f32 v210, s19, v210
v_sin_f32 v211, -v210
v_cos_f32 v210, v210
s_nop 0
v_pk_fma_f32 v[212:213], v[218:219], v[210:211], v[208:209] op_sel_hi:[0,1,1] neg_lo:[0,0,1] neg_hi:[0,0,1]
v_pk_fma_f32 v[214:215], v[218:219], v[212:213], v[210:211] op_sel_hi:[0,1,1] neg_lo:[0,0,1] neg_hi:[0,0,1]
v_cvt_pk_bf16_f32 v100, v208, v209
v_cvt_pk_bf16_f32 v101, v210, v211
v_cvt_pk_bf16_f32 v102, v212, v213
v_cvt_pk_bf16_f32 v103, v214, v215
v_pk_fma_f32 v[200:201], v[216:217], v[208:209], v[200:201] op_sel_hi:[0,1,1] neg_lo:[0,0,1] neg_hi:[0,0,1]
v_pk_fma_f32 v[202:203], v[216:217], v[210:211], v[202:203] op_sel_hi:[0,1,1] neg_lo:[0,0,1] neg_hi:[0,0,1]
v_pk_fma_f32 v[204:205], v[216:217], v[212:213], v[204:205] op_sel_hi:[0,1,1] neg_lo:[0,0,1] neg_hi:[0,0,1]
v_pk_fma_f32 v[206:207], v[216:217], v[214:215], v[206:207] op_sel_hi:[0,1,1] neg_lo:[0,0,1] neg_hi:[0,0,1]
v_cvt_pk_bf16_f32 v104, v200, v201
v_cvt_pk_bf16_f32 v105, v202, v203
v_cvt_pk_bf16_f32 v106, v204, v205
v_cvt_pk_bf16_f32 v107, v206, v207
v_pk_fma_f32 v[208:209], v[216:217], v[200:201], v[208:209] op_sel_hi:[0,1,1] neg_lo:[0,0,1] neg_hi:[0,0,1]
v_pk_fma_f32 v[210:211], v[216:217], v[202:203], v[210:211] op_sel_hi:[0,1,1] neg_lo:[0,0,1] neg_hi:[0,0,1]
v_pk_fma_f32 v[212:213], v[216:217], v[204:205], v[212:213] op_sel_hi:[0,1,1] neg_lo:[0,0,1] neg_hi:[0,0,1]
v_pk_fma_f32 v[214:215], v[216:217], v[206:207], v[214:215] op_sel_hi:[0,1,1] neg_lo:[0,0,1] neg_hi:[0,0,1]
v_cvt_pk_bf16_f32 v108, v208, v209
v_cvt_pk_bf16_f32 v109, v210, v211
v_cvt_pk_bf16_f32 v110, v212, v213
v_cvt_pk_bf16_f32 v111, v214, v215
v_pk_fma_f32 v[200:201], v[216:217], v[208:209], v[200:201] op_sel_hi:[0,1,1] neg_lo:[0,0,1] neg_hi:[0,0,1]
v_pk_fma_f32 v[202:203], v[216:217], v[210:211], v[202:203] op_sel_hi:[0,1,1] neg_lo:[0,0,1] neg_hi:[0,0,1]
v_pk_fma_f32 v[204:205], v[216:217], v[212:213], v[204:205] op_sel_hi:[0,1,1] neg_lo:[0,0,1] neg_hi:[0,0,1]
v_pk_fma_f32 v[206:207], v[216:217], v[214:215], v[206:207] op_sel_hi:[0,1,1] neg_lo:[0,0,1] neg_hi:[0,0,1]
v_cvt_pk_bf16_f32 v112, v200, v201
v_cvt_pk_bf16_f32 v113, v202, v203
v_cvt_pk_bf16_f32 v114, v204, v205
v_cvt_pk_bf16_f32 v115, v206, v207
v_pk_fma_f32 v[208:209], v[216:217], v[200:201], v[208:209] op_sel_hi:[0,1,1] neg_lo:[0,0,1] neg_hi:[0,0,1]
v_pk_fma_f32 v[210:211], v[216:217], v[202:203], v[210:211] op_sel_hi:[0,1,1] neg_lo:[0,0,1] neg_hi:[0,0,1]
v_pk_fma_f32 v[212:213], v[216:217], v[204:205], v[212:213] op_sel_hi:[0,1,1] neg_lo:[0,0,1] neg_hi:[0,0,1]
v_pk_fma_f32 v[214:215], v[216:217], v[206:207], v[214:215] op_sel_hi:[0,1,1] neg_lo:[0,0,1] neg_hi:[0,0,1]
v_cvt_pk_bf16_f32 v116, v208, v209
v_cvt_pk_bf16_f32 v117, v210, v211
v_cvt_pk_bf16_f32 v118, v212, v213
v_cvt_pk_bf16_f32 v119, v214, v215
v_pk_fma_f32 v[200:201], v[216:217], v[208:209], v[200:201] op_sel_hi:[0,1,1] neg_lo:[0,0,1] neg_hi:[0,0,1]
v_pk_fma_f32 v[202:203], v[216:217], v[210:211], v[202:203] op_sel_hi:[0,1,1] neg_lo:[0,0,1] neg_hi:[0,0,1]
v_pk_fma_f32 v[204:205], v[216:217], v[212:213], v[204:205] op_sel_hi:[0,1,1] neg_lo:[0,0,1] neg_hi:[0,0,1]
v_pk_fma_f32 v[206:207], v[216:217], v[214:215], v[206:207] op_sel_hi:[0,1,1] neg_lo:[0,0,1] neg_hi:[0,0,1]
v_cvt_pk_bf16_f32 v120, v200, v201
v_cvt_pk_bf16_f32 v121, v202, v203
v_cvt_pk_bf16_f32 v122, v204, v205
v_cvt_pk_bf16_f32 v123, v206, v207
v_pk_fma_f32 v[208:209], v[216:217], v[200:201], v[208:209] op_sel_hi:[0,1,1] neg_lo:[0,0,1] neg_hi:[0,0,1]
v_pk_fma_f32 v[210:211], v[216:217], v[202:203], v[210:211] op_sel_hi:[0,1,1] neg_lo:[0,0,1] neg_hi:[0,0,1]
v_pk_fma_f32 v[212:213], v[216:217], v[204:205], v[212:213] op_sel_hi:[0,1,1] neg_lo:[0,0,1] neg_hi:[0,0,1]
v_pk_fma_f32 v[214:215], v[216:217], v[206:207], v[214:215] op_sel_hi:[0,1,1] neg_lo:[0,0,1] neg_hi:[0,0,1]
v_cvt_pk_bf16_f32 v124, v208, v209
v_cvt_pk_bf16_f32 v125, v210, v211
v_cvt_pk_bf16_f32 v126, v212, v213
v_cvt_pk_bf16_f32 v127, v214, v215
v_pk_fma_f32 v[200:201], v[216:217], v[208:209], v[200:201] op_sel_hi:[0,1,1] neg_lo:[0,0,1] neg_hi:[0,0,1]
v_pk_fma_f32 v[202:203], v[216:217], v[210:211], v[202:203] op_sel_hi:[0,1,1] neg_lo:[0,0,1] neg_hi:[0,0,1]
v_pk_fma_f32 v[204:205], v[216:217], v[212:213], v[204:205] op_sel_hi:[0,1,1] neg_lo:[0,0,1] neg_hi:[0,0,1]
v_pk_fma_f32 v[206:207], v[216:217], v[214:215], v[206:207] op_sel_hi:[0,1,1] neg_lo:[0,0,1] neg_hi:[0,0,1]
v_cvt_pk_bf16_f32 v128, v200, v201
v_cvt_pk_bf16_f32 v129, v202, v203
v_cvt_pk_bf16_f32 v130, v204, v205
v_cvt_pk_bf16_f32 v131, v206, v207
v_pk_fma_f32 v[208:209], v[216:217], v[200:201], v[208:209] op_sel_hi:[0,1,1] neg_lo:[0,0,1] neg_hi:[0,0,1]
v_pk_fma_f32 v[210:211], v[216:217], v[202:203], v[210:211] op_sel_hi:[0,1,1] neg_lo:[0,0,1] neg_hi:[0,0,1]
v_pk_fma_f32 v[212:213], v[216:217], v[204:205], v[212:213] op_sel_hi:[0,1,1] neg_lo:[0,0,1] neg_hi:[0,0,1]
v_pk_fma_f32 v[214:215], v[216:217], v[206:207], v[214:215] op_sel_hi:[0,1,1] neg_lo:[0,0,1] neg_hi:[0,0,1]
v_cvt_pk_bf16_f32 v132, v208, v209
v_cvt_pk_bf16_f32 v133, v210, v211
v_cvt_pk_bf16_f32 v134, v212, v213
v_cvt_pk_bf16_f32 v135, v214, v215
v_pk_fma_f32 v[200:201], v[216:217], v[208:209], v[200:201] op_sel_hi:[0,1,1] neg_lo:[0,0,1] neg_hi:[0,0,1]
v_pk_fma_f32 v[202:203], v[216:217], v[210:211], v[202:203] op_sel_hi:[0,1,1] neg_lo:[0,0,1] neg_hi:[0,0,1]
v_pk_fma_f32 v[204:205], v[216:217], v[212:213], v[204:205] op_sel_hi:[0,1,1] neg_lo:[0,0,1] neg_hi:[0,0,1]
v_pk_fma_f32 v[206:207], v[216:217], v[214:215], v[206:207] op_sel_hi:[0,1,1] neg_lo:[0,0,1] neg_hi:[0,0,1]
v_cvt_pk_bf16_f32 v136, v200, v201
v_cvt_pk_bf16_f32 v137, v202, v203
v_cvt_pk_bf16_f32 v138, v204, v205
v_cvt_pk_bf16_f32 v139, v206, v207
v_pk_fma_f32 v[208:209], v[216:217], v[200:201], v[208:209] op_sel_hi:[0,1,1] neg_lo:[0,0,1] neg_hi:[0,0,1]
v_pk_fma_f32 v[210:211], v[216:217], v[202:203], v[210:211] op_sel_hi:[0,1,1] neg_lo:[0,0,1] neg_hi:[0,0,1]
v_pk_fma_f32 v[212:213], v[216:217], v[204:205], v[212:213] op_sel_hi:[0,1,1] neg_lo:[0,0,1] neg_hi:[0,0,1]
v_pk_fma_f32 v[214:215], v[216:217], v[206:207], v[214:215] op_sel_hi:[0,1,1] neg_lo:[0,0,1] neg_hi:[0,0,1]
v_cvt_pk_bf16_f32 v140, v208, v209
v_cvt_pk_bf16_f32 v141, v210, v211
v_cvt_pk_bf16_f32 v142, v212, v213
v_cvt_pk_bf16_f32 v143, v214, v215
v_pk_fma_f32 v[200:201], v[216:217], v[208:209], v[200:201] op_sel_hi:[0,1,1] neg_lo:[0,0,1] neg_hi:[0,0,1]
v_pk_fma_f32 v[202:203], v[216:217], v[210:211], v[202:203] op_sel_hi:[0,1,1] neg_lo:[0,0,1] neg_hi:[0,0,1]
v_pk_fma_f32 v[204:205], v[216:217], v[212:213], v[204:205] op_sel_hi:[0,1,1] neg_lo:[0,0,1] neg_hi:[0,0,1]
v_pk_fma_f32 v[206:207], v[216:217], v[214:215], v[206:207] op_sel_hi:[0,1,1] neg_lo:[0,0,1] neg_hi:[0,0,1]
v_cvt_pk_bf16_f32 v144, v200, v201
v_cvt_pk_bf16_f32 v145, v202, v203
v_cvt_pk_bf16_f32 v146, v204, v205
v_cvt_pk_bf16_f32 v147, v206, v207
v_pk_fma_f32 v[208:209], v[216:217], v[200:201], v[208:209] op_sel_hi:[0,1,1] neg_lo:[0,0,1] neg_hi:[0,0,1]
v_pk_fma_f32 v[210:211], v[216:217], v[202:203], v[210:211] op_sel_hi:[0,1,1] neg_lo:[0,0,1] neg_hi:[0,0,1]
v_pk_fma_f32 v[212:213], v[216:217], v[204:205], v[212:213] op_sel_hi:[0,1,1] neg_lo:[0,0,1] neg_hi:[0,0,1]
v_pk_fma_f32 v[214:215], v[216:217], v[206:207], v[214:215] op_sel_hi:[0,1,1] neg_lo:[0,0,1] neg_hi:[0,0,1]
v_cvt_pk_bf16_f32 v148, v208, v209
v_cvt_pk_bf16_f32 v149, v210, v211
v_cvt_pk_bf16_f32 v150, v212, v213
v_cvt_pk_bf16_f32 v151, v214, v215
v_pk_fma_f32 v[200:201], v[216:217], v[208:209], v[200:201] op_sel_hi:[0,1,1] neg_lo:[0,0,1] neg_hi:[0,0,1]
v_pk_fma_f32 v[202:203], v[216:217], v[210:211], v[202:203] op_sel_hi:[0,1,1] neg_lo:[0,0,1] neg_hi:[0,0,1]
v_pk_fma_f32 v[204:205], v[216:217], v[212:213], v[204:205] op_sel_hi:[0,1,1] neg_lo:[0,0,1] neg_hi:[0,0,1]
v_pk_fma_f32 v[206:207], v[216:217], v[214:215], v[206:207] op_sel_hi:[0,1,1] neg_lo:[0,0,1] neg_hi:[0,0,1]
v_cvt_pk_bf16_f32 v152, v200, v201
v_cvt_pk_bf16_f32 v153, v202, v203
v_cvt_pk_bf16_f32 v154, v204, v205
v_cvt_pk_bf16_f32 v155, v206, v207
v_pk_fma_f32 v[208:209], v[216:217], v[200:201], v[208:209] op_sel_hi:[0,1,1] neg_lo:[0,0,1] neg_hi:[0,0,1]
v_pk_fma_f32 v[210:211], v[216:217], v[202:203], v[210:211] op_sel_hi:[0,1,1] neg_lo:[0,0,1] neg_hi:[0,0,1]
v_pk_fma_f32 v[212:213], v[216:217], v[204:205], v[212:213] op_sel_hi:[0,1,1] neg_lo:[0,0,1] neg_hi:[0,0,1]
v_pk_fma_f32 v[214:215], v[216:217], v[206:207], v[214:215] op_sel_hi:[0,1,1] neg_lo:[0,0,1] neg_hi:[0,0,1]
v_cvt_pk_bf16_f32 v156, v208, v209
v_cvt_pk_bf16_f32 v157, v210, v211
v_cvt_pk_bf16_f32 v158, v212, v213
v_cvt_pk_bf16_f32 v159, v214, v215
v_pk_fma_f32 v[200:201], v[216:217], v[208:209], v[200:201] op_sel_hi:[0,1,1] neg_lo:[0,0,1] neg_hi:[0,0,1]
v_pk_fma_f32 v[202:203], v[216:217], v[210:211], v[202:203] op_sel_hi:[0,1,1] neg_lo:[0,0,1] neg_hi:[0,0,1]
v_pk_fma_f32 v[204:205], v[216:217], v[212:213], v[204:205] op_sel_hi:[0,1,1] neg_lo:[0,0,1] neg_hi:[0,0,1]
v_pk_fma_f32 v[206:207], v[216:217], v[214:215], v[206:207] op_sel_hi:[0,1,1] neg_lo:[0,0,1] neg_hi:[0,0,1]
v_cvt_pk_bf16_f32 v160, v200, v201
v_cvt_pk_bf16_f32 v161, v202, v203
v_cvt_pk_bf16_f32 v162, v204, v205
v_cvt_pk_bf16_f32 v163, v206, v207
v_pk_fma_f32 v[208:209], v[216:217], v[200:201], v[208:209] op_sel_hi:[0,1,1] neg_lo:[0,0,1] neg_hi:[0,0,1]
v_pk_fma_f32 v[210:211], v[216:217], v[202:203], v[210:211] op_sel_hi:[0,1,1] neg_lo:[0,0,1] neg_hi:[0,0,1]
v_pk_fma_f32 v[212:213], v[216:217], v[204:205], v[212:213] op_sel_hi:[0,1,1] neg_lo:[0,0,1] neg_hi:[0,0,1]
v_pk_fma_f32 v[214:215], v[216:217], v[206:207], v[214:215] op_sel_hi:[0,1,1] neg_lo:[0,0,1] neg_hi:[0,0,1]
v_cvt_pk_bf16_f32 v164, v208, v209
v_cvt_pk_bf16_f32 v165, v210, v211
v_cvt_pk_bf16_f32 v166, v212, v213
v_cvt_pk_bf16_f32 v167, v214, v215
v_pk_fma_f32 v[200:201], v[216:217], v[208:209], v[200:201] op_sel_hi:[0,1,1] neg_lo:[0,0,1] neg_hi:[0,0,1]
v_pk_fma_f32 v[202:203], v[216:217], v[210:211], v[202:203] op_sel_hi:[0,1,1] neg_lo:[0,0,1] neg_hi:[0,0,1]
v_pk_fma_f32 v[204:205], v[216:217], v[212:213], v[204:205] op_sel_hi:[0,1,1] neg_lo:[0,0,1] neg_hi:[0,0,1]
v_pk_fma_f32 v[206:207], v[216:217], v[214:215], v[206:207] op_sel_hi:[0,1,1] neg_lo:[0,0,1] neg_hi:[0,0,1]
v_cvt_pk_bf16_f32 v168, v200, v201
v_cvt_pk_bf16_f32 v169, v202, v203
v_cvt_pk_bf16_f32 v170, v204, v205
v_cvt_pk_bf16_f32 v171, v206, v207
v_pk_fma_f32 v[208:209], v[216:217], v[200:201], v[208:209] op_sel_hi:[0,1,1] neg_lo:[0,0,1] neg_hi:[0,0,1]
v_pk_fma_f32 v[210:211], v[216:217], v[202:203], v[210:211] op_sel_hi:[0,1,1] neg_lo:[0,0,1] neg_hi:[0,0,1]
v_pk_fma_f32 v[212:213], v[216:217], v[204:205], v[212:213] op_sel_hi:[0,1,1] neg_lo:[0,0,1] neg_hi:[0,0,1]
v_pk_fma_f32 v[214:215], v[216:217], v[206:207], v[214:215] op_sel_hi:[0,1,1] neg_lo:[0,0,1] neg_hi:[0,0,1]
s_mov_b32 exec_lo, 0
v_mul_f32 v214, 0.5, v214
s_mov_b32 exec_lo, -1
v_cvt_pk_bf16_f32 v172, v208, v209
v_cvt_pk_bf16_f32 v173, v210, v211
v_cvt_pk_bf16_f32 v174, v212, v213
v_cvt_pk_bf16_f32 v175, v214, v215
v_and_b32 v1, 0x2f0, v0
v_bfe_u32 v3, v0, 8, 1
v_lshl_add_u32 v1, v3, 3, v1
s_mul_i32 s18, s50, 40960
s_mul_i32 s19, s16, 3145728
s_add_u32 s26, s18, s19
s_add_u32 s27, s26, s19
s_add_u32 s27, s27, s33
s_add_u32 s27, s27, 88080384
s_add_u32 s26, s26, s31
s_add_u32 s26, s26, 103809024
s_lshl_b32 s19, s16, 6
s_add_u32 s19, s19, s50
s_mul_i32 s19, s19, 5120
s_lshr_b32 s36, s33, 3
s_add_u32 s36, s36, s19
s_add_u32 s36, s36, 163577856
s_mov_b32 s43, 0x20000
s_cmp_lg_u32 s16, 0
s_cbranch_scc1 rs_57
s_mov_b64 s[40:41], s[44:45]
s_mov_b32 s42, s46
s_lshr_b32 s51, s33, 5
s_add_u32 s51, s51, s18
s_add_u32 s52, s51, 32
v_mov_b32 v13, v5
s_branch rs_58
rs_57:
s_mov_b64 s[40:41], s[4:5]
s_mov_b32 s42, s6
s_sub_u32 s51, s27, 3145728
s_add_u32 s52, s51, 1024
v_mov_b32 v13, v0
rs_58:
s_cmp_lg_u32 s13, 0
s_cbranch_scc1 polld_60
v_lshlrev_b32 v3, 3, v0
v_min_u32 v12, 3968, v3
s_mov_b32 s21, 11591680
s_mov_b32 s17, 0
poll_59:
buffer_load_dword v8, v3, s[4:7], s21 offen sc1
s_add_u32 s20, s21, 8192
buffer_load_dword v9, v3, s[4:7], s20 offen sc1
s_add_u32 s20, s21, 16384
buffer_load_dword v10, v12, s[4:7], s20 offen sc1
s_add_u32 s17, s17, 1
s_cmp_gt_u32 s17, 262144
s_cbranch_scc1 L_fail
s_waitcnt vmcnt(1)
v_min_u32 v8, v8, v9
s_waitcnt vmcnt(0)
v_min_u32 v8, v8, v10
v_cmp_gt_u32 vcc, s29, v8
s_cbranch_vccz polld_60
s_sleep 2
s_branch poll_59
polld_60:
s_barrier
s_add_u32 m0, s31, 2048
s_add_u32 s20, s26, 0
buffer_load_dwordx4 v0, s[4:7], s20 offen sc1 lds
s_add_u32 m0, s31, 3072
s_add_u32 s20, s26, 1024
buffer_load_dwordx4 v0, s[4:7], s20 offen sc1 lds
s_add_u32 m0, s31, 4096
s_add_u32 s20, s26, 2048
buffer_load_dwordx4 v0, s[4:7], s20 offen sc1 lds
s_add_u32 m0, s31, 5120
s_add_u32 s20, s26, 3072
buffer_load_dwordx4 v0, s[4:7], s20 offen sc1 lds
s_add_u32 m0, s31, 6144
s_add_u32 s20, s26, 4096
buffer_load_dwordx4 v0, s[4:7], s20 offen sc1 lds
s_add_u32 m0, s31, 7168
s_add_u32 s20, s26, 5120
buffer_load_dwordx4 v0, s[4:7], s20 offen sc1 lds
s_add_u32 m0, s31, 8192
s_add_u32 s20, s26, 6144
buffer_load_dwordx4 v0, s[4:7], s20 offen sc1 lds
s_add_u32 m0, s31, 9216
s_add_u32 s20, s26, 7168
buffer_load_dwordx4 v0, s[4:7], s20 offen sc1 lds
s_add_u32 m0, s31, 10240
s_add_u32 s20, s26, 8192
buffer_load_dwordx4 v0, s[4:7], s20 offen sc1 lds
s_add_u32 m0, s31, 11264
s_add_u32 s20, s26, 9216
buffer_load_dwordx4 v0, s[4:7], s20 offen sc1 lds
s_add_u32 s26, s26, 1310720
s_add_u32 s25, s31, 40960
s_mov_b32 s28, 0
s_waitcnt vmcnt(0)
p3_61:
s_barrier
ds_read_b64_tr_b16 v[216:217], v1 offset:2048
ds_read_b64_tr_b16 v[218:219], v1 offset:2304
ds_read_b64_tr_b16 v[222:223], v1 offset:3328
ds_read_b64_tr_b16 v[220:221], v1 offset:3072
buffer_load_dwordx4 v[176:179], v13, s[40:43], s51 offen sc1
ds_read_b64_tr_b16 v[224:225], v1 offset:4096
buffer_load_dwordx4 v[180:183], v13, s[40:43], s52 offen sc1
ds_read_b64_tr_b16 v[230:231], v1 offset:5376
ds_read_b64_tr_b16 v[226:227], v1 offset:4352
s_add_u32 m0, s25, 2048
s_add_u32 s20, s26, 0
buffer_load_dwordx4 v0, s[4:7], s20 offen sc1 lds
s_waitcnt lgkmcnt(5)
v_mfma_f32_32x32x16_bf16 v[200:215], v[16:19], v[216:219], 0
s_waitcnt lgkmcnt(4)
ds_read_b64_tr_b16 v[228:229], v1 offset:5120
ds_read_b64_tr_b16 v[218:219], v1 offset:6400
s_add_u32 m0, s25, 3072
s_add_u32 s20, s26, 1024
buffer_load_dwordx4 v0, s[4:7], s20 offen sc1 lds
s_waitcnt lgkmcnt(4)
v_mfma_f32_32x32x16_bf16 v[200:215], v[20:23], v[220:223], v[200:215]
s_add_u32 m0, s25, 4096
s_add_u32 s20, s26, 2048
buffer_load_dwordx4 v0, s[4:7], s20 offen sc1 lds
ds_read_b64_tr_b16 v[216:217], v1 offset:6144
s_waitcnt lgkmcnt(3)
ds_read_b64_tr_b16 v[222:223], v1 offset:7424
v_mfma_f32_32x32x16_bf16 v[200:215], v[24:27], v[224:227], v[200:215]
s_waitcnt lgkmcnt(3)
ds_read_b64_tr_b16 v[220:221], v1 offset:7168
ds_read_b64_tr_b16 v[224:225], v1 offset:8192
s_waitcnt lgkmcnt(4)
v_mfma_f32_32x32x16_bf16 v[200:215], v[28:31], v[228:231], v[200:215]
s_add_u32 m0, s25, 5120
s_add_u32 s20, s26, 3072
buffer_load_dwordx4 v0, s[4:7], s20 offen sc1 lds
s_waitcnt lgkmcnt(3)
ds_read_b64_tr_b16 v[226:227], v1 offset:8448
ds_read_b64_tr_b16 v[230:231], v1 offset:9472
ds_read_b64_tr_b16 v[228:229], v1 offset:9216
v_mfma_f32_32x32x16_bf16 v[200:215], v[32:35], v[216:219], v[200:215]
ds_read_b64_tr_b16 v[216:217], v1 offset:10240
s_waitcnt lgkmcnt(5)
v_mfma_f32_32x32x16_bf16 v[200:215], v[36:39], v[220:223], v[200:215]
ds_read_b64_tr_b16 v[220:221], v1 offset:11264
s_waitcnt lgkmcnt(4)
ds_read_b64_tr_b16 v[218:219], v1 offset:10496
v_mfma_f32_32x32x16_bf16 v[200:215], v[40:43], v[224:227], v[200:215]
ds_read_b64_tr_b16 v[222:223], v1 offset:11520
ds_read_b64_tr_b16 v[224:225], v1 offset:12288
s_waitcnt lgkmcnt(5)
v_mfma_f32_32x32x16_bf16 v[200:215], v[44:47], v[228:231], v[200:215]
ds_read_b64_tr_b16 v[228:229], v1 offset:13312
ds_read_b64_tr_b16 v[226:227], v1 offset:12544
s_waitcnt lgkmcnt(6)
s_waitcnt lgkmcnt(4)
ds_read_b64_tr_b16 v[230:231], v1 offset:13568
v_mfma_f32_32x32x16_bf16 v[200:215], v[48:51], v[216:219], v[200:215]
ds_read_b64_tr_b16 v[218:219], v1 offset:14592
s_add_u32 m0, s25, 6144
s_add_u32 s20, s26, 4096
buffer_load_dwordx4 v0, s[4:7], s20 offen sc1 lds
s_waitcnt lgkmcnt(5)
ds_read_b64_tr_b16 v[216:217], v1 offset:14336
v_mfma_f32_32x32x16_bf16 v[200:215], v[52:55], v[220:223], v[200:215]
ds_read_b64_tr_b16 v[222:223], v1 offset:15616
s_waitcnt lgkmcnt(4)
s_add_u32 m0, s25, 7168
s_add_u32 s20, s26, 5120
buffer_load_dwordx4 v0, s[4:7], s20 offen sc1 lds
ds_read_b64_tr_b16 v[220:221], v1 offset:15360
v_mfma_f32_32x32x16_bf16 v[200:215], v[56:59], v[224:227], v[200:215]
s_waitcnt lgkmcnt(4)
ds_read_b64_tr_b16 v[226:227], v1 offset:16640
ds_read_b64_tr_b16 v[224:225], v1 offset:16384
s_waitcnt lgkmcnt(5)
s_waitcnt lgkmcnt(4)
v_mfma_f32_32x32x16_bf16 v[200:215], v[60:63], v[228:231], v[200:215]
v_mfma_f32_32x32x16_bf16 v[200:215], v[64:67], v[216:219], v[200:215]
s_waitcnt lgkmcnt(2)
ds_read_b64_tr_b16 v[218:219], v1 offset:18688
s_waitcnt lgkmcnt(1)
ds_read_b64_tr_b16 v[230:231], v1 offset:17664
ds_read_b64_tr_b16 v[228:229], v1 offset:17408
ds_read_b64_tr_b16 v[216:217], v1 offset:18432
v_mfma_f32_32x32x16_bf16 v[200:215], v[68:71], v[220:223], v[200:215]
v_mfma_f32_32x32x16_bf16 v[200:215], v[72:75], v[224:227], v[200:215]
s_waitcnt lgkmcnt(3)
ds_read_b64_tr_b16 v[224:225], v1 offset:20480
ds_read_b64_tr_b16 v[226:227], v1 offset:20736
ds_read_b64_tr_b16 v[222:223], v1 offset:19712
s_waitcnt lgkmcnt(4)
ds_read_b64_tr_b16 v[220:221], v1 offset:19456
v_mfma_f32_32x32x16_bf16 v[200:215], v[76:79], v[228:231], v[200:215]
ds_read_b64_tr_b16 v[230:231], v1 offset:21760
s_waitcnt lgkmcnt(5)
ds_read_b64_tr_b16 v[228:229], v1 offset:21504
v_mfma_f32_32x32x16_bf16 v[200:215], v[80:83], v[216:219], v[200:215]
ds_read_b64_tr_b16 v[218:219], v1 offset:22784
s_waitcnt lgkmcnt(3)
ds_read_b64_tr_b16 v[216:217], v1 offset:22528
v_mfma_f32_32x32x16_bf16 v[200:215], v[84:87], v[220:223], v[200:215]
ds_read_b64_tr_b16 v[220:221], v1 offset:23552
s_waitcnt lgkmcnt(4)
ds_read_b64_tr_b16 v[222:223], v1 offset:23808
v_mfma_f32_32x32x16_bf16 v[200:215], v[88:91], v[224:227], v[200:215]
s_add_u32 m0, s25, 8192
s_add_u32 s20, s26, 6144
buffer_load_dwordx4 v0, s[4:7], s20 offen sc1 lds
s_waitcnt lgkmcnt(2)
ds_read_b64_tr_b16 v[224:225], v1 offset:24576
ds_read_b64_tr_b16 v[226:227], v1 offset:24832
v_mfma_f32_32x32x16_bf16 v[200:215], v[92:95], v[228:231], v[200:215]
s_waitcnt lgkmcnt(3)
ds_read_b64_tr_b16 v[230:231], v1 offset:25856
s_waitcnt lgkmcnt(3)
v_mfma_f32_32x32x16_bf16 v[200:215], v[96:99], v[216:219], v[200:215]
s_waitcnt lgkmcnt(2)
ds_read_b64_tr_b16 v[228:229], v1 offset:25600
ds_read_b64_tr_b16 v[218:219], v1 offset:26880
v_mfma_f32_32x32x16_bf16 v[200:215], v[100:103], v[220:223], v[200:215]
ds_read_b64_tr_b16 v[216:217], v1 offset:26624
ds_read_b64_tr_b16 v[222:223], v1 offset:27904
ds_read_b64_tr_b16 v[220:221], v1 offset:27648
s_waitcnt lgkmcnt(6)
v_mfma_f32_32x32x16_bf16 v[200:215], v[104:107], v[224:227], v[200:215]
s_waitcnt lgkmcnt(4)
ds_read_b64_tr_b16 v[224:225], v1 offset:28672
ds_read_b64_tr_b16 v[226:227], v1 offset:28928
s_waitcnt lgkmcnt(5)
v_mfma_f32_32x32x16_bf16 v[200:215], v[108:111], v[228:231], v[200:215]
ds_read_b64_tr_b16 v[228:229], v1 offset:29696
s_waitcnt lgkmcnt(5)
v_mfma_f32_32x32x16_bf16 v[200:215], v[112:115], v[216:219], v[200:215]
s_waitcnt lgkmcnt(4)
s_waitcnt lgkmcnt(1)
ds_read_b64_tr_b16 v[218:219], v1 offset:30976
ds_read_b64_tr_b16 v[230:231], v1 offset:29952
v_mfma_f32_32x32x16_bf16 v[200:215], v[116:119], v[220:223], v[200:215]
s_add_u32 m0, s25, 9216
s_add_u32 s20, s26, 7168
buffer_load_dwordx4 v0, s[4:7], s20 offen sc1 lds
ds_read_b64_tr_b16 v[216:217], v1 offset:30720
ds_read_b64_tr_b16 v[220:221], v1 offset:31744
s_waitcnt lgkmcnt(4)
v_mfma_f32_32x32x16_bf16 v[200:215], v[120:123], v[224:227], v[200:215]
ds_read_b64_tr_b16 v[226:227], v1 offset:33024
ds_read_b64_tr_b16 v[222:223], v1 offset:32000
ds_read_b64_tr_b16 v[224:225], v1 offset:32768
s_waitcnt lgkmcnt(5)
v_lshrrev_b32 v2, 2, v0
v_mfma_f32_32x32x16_bf16 v[200:215], v[124:127], v[228:231], v[200:215]
s_add_u32 m0, s25, 10240
s_add_u32 s20, s26, 8192
buffer_load_dwordx4 v0, s[4:7], s20 offen sc1 lds
s_waitcnt lgkmcnt(4)
ds_read_b64_tr_b16 v[228:229], v1 offset:33792
s_waitcnt lgkmcnt(4)
v_mfma_f32_32x32x16_bf16 v[200:215], v[128:131], v[216:219], v[200:215]
s_waitcnt lgkmcnt(3)
s_waitcnt lgkmcnt(2)
ds_read_b64_tr_b16 v[230:231], v1 offset:34048
ds_read_b64_tr_b16 v[216:217], v1 offset:34816
ds_read_b64_tr_b16 v[218:219], v1 offset:35072
v_mfma_f32_32x32x16_bf16 v[200:215], v[132:135], v[220:223], v[200:215]
s_waitcnt vmcnt(10)
s_waitcnt lgkmcnt(4)
ds_read_b64_tr_b16 v[220:221], v1 offset:35840
s_add_u32 m0, s25, 11264
s_add_u32 s20, s26, 9216
buffer_load_dwordx4 v0, s[4:7], s20 offen sc1 lds
v_mfma_f32_32x32x16_bf16 v[200:215], v[136:139], v[224:227], v[200:215]
ds_read_b64_tr_b16 v[222:223], v1 offset:36096
ds_read_b64_tr_b16 v[226:227], v1 offset:37120
v_and_b32 v187, 0xffff0000, v177
s_waitcnt lgkmcnt(5)
v_lshlrev_b32 v184, 16, v176
s_waitcnt vmcnt(10)
v_mfma_f32_32x32x16_bf16 v[200:215], v[140:143], v[228:231], v[200:215]
s_waitcnt lgkmcnt(3)
ds_read_b64_tr_b16 v[230:231], v1 offset:38144
ds_read_b64_tr_b16 v[224:225], v1 offset:36864
s_waitcnt lgkmcnt(4)
ds_read_b64_tr_b16 v[228:229], v1 offset:37888
v_mfma_f32_32x32x16_bf16 v[200:215], v[144:147], v[216:219], v[200:215]
s_waitcnt lgkmcnt(3)
ds_read_b64_tr_b16 v[218:219], v1 offset:39168
ds_read_b64_tr_b16 v[216:217], v1 offset:38912
v_and_b32 v199, 0xffff0000, v183
v_mfma_f32_32x32x16_bf16 v[200:215], v[148:151], v[220:223], v[200:215]
s_waitcnt lgkmcnt(4)
s_waitcnt lgkmcnt(3)
s_waitcnt lgkmcnt(2)
v_lshlrev_b32 v198, 16, v183
v_and_b32 v189, 0xffff0000, v178
v_and_b32 v197, 0xffff0000, v182
v_mfma_f32_32x32x16_bf16 v[200:215], v[152:155], v[224:227], v[200:215]
ds_read_b64_tr_b16 v[220:221], v1 offset:39936
s_waitcnt lgkmcnt(2)
ds_read_b64_tr_b16 v[224:225], v1 offset:40960
ds_read_b64_tr_b16 v[222:223], v1 offset:40192
v_mfma_f32_32x32x16_bf16 v[200:215], v[156:159], v[228:231], v[200:215]
s_waitcnt lgkmcnt(3)
ds_read_b64_tr_b16 v[230:231], v1 offset:42240
ds_read_b64_tr_b16 v[226:227], v1 offset:41216
v_mfma_f32_32x32x16_bf16 v[200:215], v[160:163], v[216:219], v[200:215]
ds_read_b64_tr_b16 v[228:229], v1 offset:41984
s_waitcnt lgkmcnt(3)
v_and_b32 v193, 0xffff0000, v180
v_lshlrev_b32 v186, 16, v177
v_and_b32 v191, 0xffff0000, v179
v_mfma_f32_32x32x16_bf16 v[200:215], v[164:167], v[220:223], v[200:215]
s_waitcnt lgkmcnt(1)
v_lshlrev_b32 v196, 16, v182
v_mfma_f32_32x32x16_bf16 v[200:215], v[168:171], v[224:227], v[200:215]
v_lshlrev_b32 v188, 16, v178
s_waitcnt lgkmcnt(0)
v_lshlrev_b32 v194, 16, v181
v_mfma_f32_32x32x16_bf16 v[200:215], v[172:175], v[228:231], v[200:215]
s_nop 0
v_lshlrev_b32 v190, 16, v179
v_lshlrev_b32 v192, 16, v180
v_and_b32 v185, 0xffff0000, v176
v_and_b32 v195, 0xffff0000, v181
v_mov_b32 v176, 0x3b4ccccd
s_nop 5
v_pk_fma_f32 v[200:201], v[200:201], v[176:177], v[184:185] op_sel_hi:[1,0,1]
v_pk_fma_f32 v[202:203], v[202:203], v[176:177], v[186:187] op_sel_hi:[1,0,1]
v_pk_fma_f32 v[204:205], v[204:205], v[176:177], v[188:189] op_sel_hi:[1,0,1]
v_pk_mul_f32 v[180:181], v[200:201], v[200:201]
v_pk_fma_f32 v[206:207], v[206:207], v[176:177], v[190:191] op_sel_hi:[1,0,1]
v_pk_add_f32 v[178:179], v[200:201], v[202:203]
v_pk_fma_f32 v[208:209], v[208:209], v[176:177], v[192:193] op_sel_hi:[1,0,1]
v_pk_add_f32 v[178:179], v[178:179], v[204:205]
v_pk_add_f32 v[178:179], v[178:179], v[206:207]
v_pk_fma_f32 v[180:181], v[202:203], v[202:203], v[180:181]
v_pk_fma_f32 v[180:181], v[204:205], v[204:205], v[180:181]
v_pk_fma_f32 v[210:211], v[210:211], v[176:177], v[194:195] op_sel_hi:[1,0,1]
v_pk_fma_f32 v[180:181], v[206:207], v[206:207], v[180:181]
v_pk_add_f32 v[178:179], v[178:179], v[208:209]
v_pk_fma_f32 v[180:181], v[208:209], v[208:209], v[180:181]
v_pk_add_f32 v[178:179], v[178:179], v[210:211]
v_pk_fma_f32 v[180:181], v[210:211], v[210:211], v[180:181]
v_pk_fma_f32 v[214:215], v[214:215], v[176:177], v[198:199] op_sel_hi:[1,0,1]
v_pk_fma_f32 v[212:213], v[212:213], v[176:177], v[196:197] op_sel_hi:[1,0,1]
v_pk_add_f32 v[178:179], v[178:179], v[212:213]
v_pk_add_f32 v[178:179], v[178:179], v[214:215]
v_pk_fma_f32 v[180:181], v[212:213], v[212:213], v[180:181]
v_add_f32 v178, v178, v179
v_pk_fma_f32 v[180:181], v[214:215], v[214:215], v[180:181]
v_add_f32 v180, v180, v181
v_cvt_pk_bf16_f32 v220, v208, v209
v_cvt_pk_bf16_f32 v221, v210, v211
v_permlane32_swap_b32 v178, v180
v_cvt_pk_bf16_f32 v223, v214, v215
v_cvt_pk_bf16_f32 v222, v212, v213
v_cvt_pk_bf16_f32 v219, v206, v207
v_cvt_pk_bf16_f32 v216, v200, v201
v_cvt_pk_bf16_f32 v218, v204, v205
v_add_f32 v178, v178, v180
v_cvt_pk_bf16_f32 v217, v202, v203
buffer_store_dwordx4 v[216:219], v0, s[4:7], s27 offen offset:0 sc1
buffer_store_dwordx4 v[220:223], v0, s[4:7], s27 offen offset:1024 sc1
buffer_store_dword v178, v2, s[4:7], s36 offen sc1
v_xor_b32 v1, 40960, v1
s_mov_b32 s26, s6
s_mov_b32 s25, s31
s_add_u32 s27, s27, 1310720
s_add_u32 s36, s36, 163840
s_add_u32 s51, s51, 1310720
s_add_u32 s52, s52, 1310720
s_add_u32 s28, s28, 1
s_lshl_b32 s18, s39, 7
s_add_u32 s18, s18, 11612160
s_lshl_b32 s19, s16, 1
s_add_u32 s19, s19, s28
s_cmp_eq_u32 s13, 0
s_cselect_b32 s22, s18, s6
s_mov_b32 s23, s19
s_waitcnt vmcnt(0)
s_barrier
v_mov_b32 v3, s23
s_mov_b64 exec, 1
buffer_store_dword v3, off, s[4:7], s22 sc1
s_mov_b64 exec, -1
s_mov_b32 s22, s6
s_cmp_lt_u32 s28, 2
s_cbranch_scc1 p3_61
s_cmp_ge_u32 s39, 144
s_cbranch_scc1 p1b_63
s_cmp_ge_u32 s39, 64
s_cbranch_scc1 wo_62
s_and_b32 s32, s39, 31
s_cmp_lg_u32 s16, 0
s_cbranch_scc1 qw_65
s_lshl_b32 s26, s32, 8
s_lshl_b32 s18, s13, 6
s_add_u32 s26, s26, s18
s_load_dwordx2 s[40:41], s[0:1], 40
s_mov_b32 s42, 5242880
s_mov_b32 s43, 0x20000
s_waitcnt lgkmcnt(0)
v_lshrrev_b32 v34, 6, v0
v_mul_u32_u24 v34, 8192, v34
v_and_b32 v35, 48, v0
v_add_u32 v32, v34, v35
v_bfe_u32 v34, v0, 6, 2
v_lshrrev_b32 v35, 9, v0
v_lshl_add_u32 v34, v35, 3, v34
v_lshlrev_b32 v33, 6, v34
v_and_b32 v34, 16, v0
v_add_u32 v33, v33, v34
v_bfe_u32 v34, v0, 5, 1
v_lshl_add_u32 v33, v34, 3, v33
v_bfe_u32 v34, v0, 8, 1
v_lshl_add_u32 v33, v34, 5, v33
s_mul_i32 s18, s13, 36864
v_add_u32 v33, s18, v33
s_barrier
s_add_u32 m0, s18, 0
s_add_u32 s19, s26, 0
buffer_load_dwordx4 v32, s[40:43], s19 offen lds
s_add_u32 m0, s18, 1024
s_add_u32 s19, s26, 131072
buffer_load_dwordx4 v32, s[40:43], s19 offen lds
s_add_u32 m0, s18, 2048
s_add_u32 s19, s26, 262144
buffer_load_dwordx4 v32, s[40:43], s19 offen lds
s_add_u32 m0, s18, 3072
s_add_u32 s19, s26, 393216
buffer_load_dwordx4 v32, s[40:43], s19 offen lds
s_add_u32 m0, s18, 4096
s_add_u32 s19, s26, 524288
buffer_load_dwordx4 v32, s[40:43], s19 offen lds
s_add_u32 m0, s18, 5120
s_add_u32 s19, s26, 655360
buffer_load_dwordx4 v32, s[40:43], s19 offen lds
s_add_u32 m0, s18, 6144
s_add_u32 s19, s26, 786432
buffer_load_dwordx4 v32, s[40:43], s19 offen lds
s_add_u32 m0, s18, 7168
s_add_u32 s19, s26, 917504
buffer_load_dwordx4 v32, s[40:43], s19 offen lds
s_add_u32 m0, s18, 8192
s_add_u32 s19, s26, 1048576
buffer_load_dwordx4 v32, s[40:43], s19 offen lds
s_add_u32 m0, s18, 9216
s_add_u32 s19, s26, 1179648
buffer_load_dwordx4 v32, s[40:43], s19 offen lds
s_add_u32 m0, s18, 10240
s_add_u32 s19, s26, 1310720
buffer_load_dwordx4 v32, s[40:43], s19 offen lds
s_add_u32 m0, s18, 11264
s_add_u32 s19, s26, 1441792
buffer_load_dwordx4 v32, s[40:43], s19 offen lds
s_add_u32 m0, s18, 12288
s_add_u32 s19, s26, 1572864
buffer_load_dwordx4 v32, s[40:43], s19 offen lds
s_add_u32 m0, s18, 13312
s_add_u32 s19, s26, 1703936
buffer_load_dwordx4 v32, s[40:43], s19 offen lds
s_add_u32 m0, s18, 14336
s_add_u32 s19, s26, 1835008
buffer_load_dwordx4 v32, s[40:43], s19 offen lds
s_add_u32 m0, s18, 15360
s_add_u32 s19, s26, 1966080
buffer_load_dwordx4 v32, s[40:43], s19 offen lds
s_add_u32 m0, s18, 16384
s_add_u32 s19, s26, 2097152
buffer_load_dwordx4 v32, s[40:43], s19 offen lds
s_add_u32 m0, s18, 17408
s_add_u32 s19, s26, 2228224
buffer_load_dwordx4 v32, s[40:43], s19 offen lds
s_add_u32 m0, s18, 18432
s_add_u32 s19, s26, 2359296
buffer_load_dwordx4 v32, s[40:43], s19 offen lds
s_add_u32 m0, s18, 19456
s_add_u32 s19, s26, 2490368
buffer_load_dwordx4 v32, s[40:43], s19 offen lds
s_add_u32 m0, s18, 20480
s_add_u32 s19, s26, 2621440
buffer_load_dwordx4 v32, s[40:43], s19 offen lds
s_add_u32 m0, s18, 21504
s_add_u32 s19, s26, 2752512
buffer_load_dwordx4 v32, s[40:43], s19 offen lds
s_add_u32 m0, s18, 22528
s_add_u32 s19, s26, 2883584
buffer_load_dwordx4 v32, s[40:43], s19 offen lds
s_add_u32 m0, s18, 23552
s_add_u32 s19, s26, 3014656
buffer_load_dwordx4 v32, s[40:43], s19 offen lds
s_add_u32 m0, s18, 24576
s_add_u32 s19, s26, 3145728
buffer_load_dwordx4 v32, s[40:43], s19 offen lds
s_add_u32 m0, s18, 25600
s_add_u32 s19, s26, 3276800
buffer_load_dwordx4 v32, s[40:43], s19 offen lds
s_add_u32 m0, s18, 26624
s_add_u32 s19, s26, 3407872
buffer_load_dwordx4 v32, s[40:43], s19 offen lds
s_add_u32 m0, s18, 27648
s_add_u32 s19, s26, 3538944
buffer_load_dwordx4 v32, s[40:43], s19 offen lds
s_add_u32 m0, s18, 28672
s_add_u32 s19, s26, 3670016
buffer_load_dwordx4 v32, s[40:43], s19 offen lds
s_add_u32 m0, s18, 29696
s_add_u32 s19, s26, 3801088
buffer_load_dwordx4 v32, s[40:43], s19 offen lds
s_add_u32 m0, s18, 30720
s_add_u32 s19, s26, 3932160
buffer_load_dwordx4 v32, s[40:43], s19 offen lds
s_add_u32 m0, s18, 31744
s_add_u32 s19, s26, 4063232
buffer_load_dwordx4 v32, s[40:43], s19 offen lds
s_add_u32 m0, s18, 32768
s_add_u32 s19, s26, 4194304
buffer_load_dwordx4 v32, s[40:43], s19 offen lds
s_add_u32 m0, s18, 33792
s_add_u32 s19, s26, 4325376
buffer_load_dwordx4 v32, s[40:43], s19 offen lds
s_add_u32 m0, s18, 34816
s_add_u32 s19, s26, 4456448
buffer_load_dwordx4 v32, s[40:43], s19 offen lds
s_add_u32 m0, s18, 35840
s_add_u32 s19, s26, 4587520
buffer_load_dwordx4 v32, s[40:43], s19 offen lds
s_waitcnt vmcnt(32)
ds_read_b64_tr_b16 a[0:1], v33 offset:0
ds_read_b64_tr_b16 a[2:3], v33 offset:256
ds_read_b64_tr_b16 a[4:5], v33 offset:1024
ds_read_b64_tr_b16 a[6:7], v33 offset:1280
ds_read_b64_tr_b16 a[8:9], v33 offset:2048
ds_read_b64_tr_b16 a[10:11], v33 offset:2304
ds_read_b64_tr_b16 a[12:13], v33 offset:3072
ds_read_b64_tr_b16 a[14:15], v33 offset:3328
s_waitcnt lgkmcnt(0)
s_add_u32 m0, s18, 0
s_add_u32 s19, s26, 4718592
buffer_load_dwordx4 v32, s[40:43], s19 offen lds
s_add_u32 m0, s18, 1024
s_add_u32 s19, s26, 4849664
buffer_load_dwordx4 v32, s[40:43], s19 offen lds
s_add_u32 m0, s18, 2048
s_add_u32 s19, s26, 4980736
buffer_load_dwordx4 v32, s[40:43], s19 offen lds
s_add_u32 m0, s18, 3072
s_add_u32 s19, s26, 5111808
buffer_load_dwordx4 v32, s[40:43], s19 offen lds
s_waitcnt vmcnt(32)
ds_read_b64_tr_b16 a[16:17], v33 offset:4096
ds_read_b64_tr_b16 a[18:19], v33 offset:4352
ds_read_b64_tr_b16 a[20:21], v33 offset:5120
ds_read_b64_tr_b16 a[22:23], v33 offset:5376
ds_read_b64_tr_b16 a[24:25], v33 offset:6144
ds_read_b64_tr_b16 a[26:27], v33 offset:6400
ds_read_b64_tr_b16 a[28:29], v33 offset:7168
ds_read_b64_tr_b16 a[30:31], v33 offset:7424
s_waitcnt vmcnt(28)
ds_read_b64_tr_b16 a[32:33], v33 offset:8192
ds_read_b64_tr_b16 a[34:35], v33 offset:8448
ds_read_b64_tr_b16 a[36:37], v33 offset:9216
ds_read_b64_tr_b16 a[38:39], v33 offset:9472
ds_read_b64_tr_b16 a[40:41], v33 offset:10240
ds_read_b64_tr_b16 a[42:43], v33 offset:10496
ds_read_b64_tr_b16 a[44:45], v33 offset:11264
ds_read_b64_tr_b16 a[46:47], v33 offset:11520
s_waitcnt vmcnt(24)
ds_read_b64_tr_b16 a[48:49], v33 offset:12288
ds_read_b64_tr_b16 a[50:51], v33 offset:12544
ds_read_b64_tr_b16 a[52:53], v33 offset:13312
ds_read_b64_tr_b16 a[54:55], v33 offset:13568
ds_read_b64_tr_b16 a[56:57], v33 offset:14336
ds_read_b64_tr_b16 a[58:59], v33 offset:14592
ds_read_b64_tr_b16 a[60:61], v33 offset:15360
ds_read_b64_tr_b16 a[62:63], v33 offset:15616
s_waitcnt vmcnt(20)
ds_read_b64_tr_b16 a[64:65], v33 offset:16384
ds_read_b64_tr_b16 a[66:67], v33 offset:16640
ds_read_b64_tr_b16 a[68:69], v33 offset:17408
ds_read_b64_tr_b16 a[70:71], v33 offset:17664
ds_read_b64_tr_b16 a[72:73], v33 offset:18432
ds_read_b64_tr_b16 a[74:75], v33 offset:18688
ds_read_b64_tr_b16 a[76:77], v33 offset:19456
ds_read_b64_tr_b16 a[78:79], v33 offset:19712
s_waitcnt vmcnt(16)
ds_read_b64_tr_b16 a[80:81], v33 offset:20480
ds_read_b64_tr_b16 a[82:83], v33 offset:20736
ds_read_b64_tr_b16 a[84:85], v33 offset:21504
ds_read_b64_tr_b16 a[86:87], v33 offset:21760
ds_read_b64_tr_b16 a[88:89], v33 offset:22528
ds_read_b64_tr_b16 a[90:91], v33 offset:22784
ds_read_b64_tr_b16 a[92:93], v33 offset:23552
ds_read_b64_tr_b16 a[94:95], v33 offset:23808
s_waitcnt vmcnt(12)
ds_read_b64_tr_b16 a[96:97], v33 offset:24576
ds_read_b64_tr_b16 a[98:99], v33 offset:24832
ds_read_b64_tr_b16 a[100:101], v33 offset:25600
ds_read_b64_tr_b16 a[102:103], v33 offset:25856
ds_read_b64_tr_b16 a[104:105], v33 offset:26624
ds_read_b64_tr_b16 a[106:107], v33 offset:26880
ds_read_b64_tr_b16 a[108:109], v33 offset:27648
ds_read_b64_tr_b16 a[110:111], v33 offset:27904
s_waitcnt vmcnt(8)
ds_read_b64_tr_b16 a[112:113], v33 offset:28672
ds_read_b64_tr_b16 a[114:115], v33 offset:28928
ds_read_b64_tr_b16 a[116:117], v33 offset:29696
ds_read_b64_tr_b16 a[118:119], v33 offset:29952
ds_read_b64_tr_b16 a[120:121], v33 offset:30720
ds_read_b64_tr_b16 a[122:123], v33 offset:30976
ds_read_b64_tr_b16 a[124:125], v33 offset:31744
ds_read_b64_tr_b16 a[126:127], v33 offset:32000
s_waitcnt vmcnt(4)
ds_read_b64_tr_b16 a[128:129], v33 offset:32768
ds_read_b64_tr_b16 a[130:131], v33 offset:33024
ds_read_b64_tr_b16 a[132:133], v33 offset:33792
ds_read_b64_tr_b16 a[134:135], v33 offset:34048
ds_read_b64_tr_b16 a[136:137], v33 offset:34816
ds_read_b64_tr_b16 a[138:139], v33 offset:35072
ds_read_b64_tr_b16 a[140:141], v33 offset:35840
ds_read_b64_tr_b16 a[142:143], v33 offset:36096
s_waitcnt vmcnt(0)
ds_read_b64_tr_b16 a[144:145], v33 offset:0
ds_read_b64_tr_b16 a[146:147], v33 offset:256
ds_read_b64_tr_b16 a[148:149], v33 offset:1024
ds_read_b64_tr_b16 a[150:151], v33 offset:1280
ds_read_b64_tr_b16 a[152:153], v33 offset:2048
ds_read_b64_tr_b16 a[154:155], v33 offset:2304
ds_read_b64_tr_b16 a[156:157], v33 offset:3072
ds_read_b64_tr_b16 a[158:159], v33 offset:3328
s_waitcnt lgkmcnt(0)
s_barrier
v_mov_b32 v32, s24
v_mov_b32 v33, s24
v_mov_b32 v34, s24
v_mov_b32 v35, s24
s_nop 1
v_mfma_f32_32x32x16_bf16 v[36:51], a[0:3], v[32:35], 0
v_mfma_f32_32x32x16_bf16 v[36:51], a[4:7], v[32:35], v[36:51]
v_mfma_f32_32x32x16_bf16 v[36:51], a[8:11], v[32:35], v[36:51]
v_mfma_f32_32x32x16_bf16 v[36:51], a[12:15], v[32:35], v[36:51]
v_mfma_f32_32x32x16_bf16 v[36:51], a[16:19], v[32:35], v[36:51]
v_mfma_f32_32x32x16_bf16 v[36:51], a[20:23], v[32:35], v[36:51]
v_mfma_f32_32x32x16_bf16 v[36:51], a[24:27], v[32:35], v[36:51]
v_mfma_f32_32x32x16_bf16 v[36:51], a[28:31], v[32:35], v[36:51]
v_mfma_f32_32x32x16_bf16 v[36:51], a[32:35], v[32:35], v[36:51]
v_mfma_f32_32x32x16_bf16 v[36:51], a[36:39], v[32:35], v[36:51]
v_mfma_f32_32x32x16_bf16 v[36:51], a[40:43], v[32:35], v[36:51]
v_mfma_f32_32x32x16_bf16 v[36:51], a[44:47], v[32:35], v[36:51]
v_mfma_f32_32x32x16_bf16 v[36:51], a[48:51], v[32:35], v[36:51]
v_mfma_f32_32x32x16_bf16 v[36:51], a[52:55], v[32:35], v[36:51]
v_mfma_f32_32x32x16_bf16 v[36:51], a[56:59], v[32:35], v[36:51]
v_mfma_f32_32x32x16_bf16 v[36:51], a[60:63], v[32:35], v[36:51]
v_mfma_f32_32x32x16_bf16 v[36:51], a[64:67], v[32:35], v[36:51]
v_mfma_f32_32x32x16_bf16 v[36:51], a[68:71], v[32:35], v[36:51]
v_mfma_f32_32x32x16_bf16 v[36:51], a[72:75], v[32:35], v[36:51]
v_mfma_f32_32x32x16_bf16 v[36:51], a[76:79], v[32:35], v[36:51]
v_mfma_f32_32x32x16_bf16 v[36:51], a[80:83], v[32:35], v[36:51]
v_mfma_f32_32x32x16_bf16 v[36:51], a[84:87], v[32:35], v[36:51]
v_mfma_f32_32x32x16_bf16 v[36:51], a[88:91], v[32:35], v[36:51]
v_mfma_f32_32x32x16_bf16 v[36:51], a[92:95], v[32:35], v[36:51]
v_mfma_f32_32x32x16_bf16 v[36:51], a[96:99], v[32:35], v[36:51]
v_mfma_f32_32x32x16_bf16 v[36:51], a[100:103], v[32:35], v[36:51]
v_mfma_f32_32x32x16_bf16 v[36:51], a[104:107], v[32:35], v[36:51]
v_mfma_f32_32x32x16_bf16 v[36:51], a[108:111], v[32:35], v[36:51]
v_mfma_f32_32x32x16_bf16 v[36:51], a[112:115], v[32:35], v[36:51]
v_mfma_f32_32x32x16_bf16 v[36:51], a[116:119], v[32:35], v[36:51]
v_mfma_f32_32x32x16_bf16 v[36:51], a[120:123], v[32:35], v[36:51]
v_mfma_f32_32x32x16_bf16 v[36:51], a[124:127], v[32:35], v[36:51]
v_mfma_f32_32x32x16_bf16 v[36:51], a[128:131], v[32:35], v[36:51]
v_mfma_f32_32x32x16_bf16 v[36:51], a[132:135], v[32:35], v[36:51]
v_mfma_f32_32x32x16_bf16 v[36:51], a[136:139], v[32:35], v[36:51]
v_mfma_f32_32x32x16_bf16 v[36:51], a[140:143], v[32:35], v[36:51]
v_mfma_f32_32x32x16_bf16 v[36:51], a[144:147], v[32:35], v[36:51]
v_mfma_f32_32x32x16_bf16 v[36:51], a[148:151], v[32:35], v[36:51]
v_mfma_f32_32x32x16_bf16 v[36:51], a[152:155], v[32:35], v[36:51]
v_mfma_f32_32x32x16_bf16 v[36:51], a[156:159], v[32:35], v[36:51]
s_nop 11
v_mov_b32 v16, v36
v_mov_b32 v17, v37
v_mov_b32 v18, v38
v_mov_b32 v19, v39
v_mov_b32 v20, v40
v_mov_b32 v21, v41
v_mov_b32 v22, v42
v_mov_b32 v23, v43
v_mov_b32 v24, v44
v_mov_b32 v25, v45
v_mov_b32 v26, v46
v_mov_b32 v27, v47
v_mov_b32 v28, v48
v_mov_b32 v29, v49
v_mov_b32 v30, v50
v_mov_b32 v31, v51
v_accvgpr_write_b32 a160, v16
v_accvgpr_write_b32 a161, v17
v_accvgpr_write_b32 a162, v18
v_accvgpr_write_b32 a163, v19
v_accvgpr_write_b32 a164, v20
v_accvgpr_write_b32 a165, v21
v_accvgpr_write_b32 a166, v22
v_accvgpr_write_b32 a167, v23
v_accvgpr_write_b32 a168, v24
v_accvgpr_write_b32 a169, v25
v_accvgpr_write_b32 a170, v26
v_accvgpr_write_b32 a171, v27
v_accvgpr_write_b32 a172, v28
v_accvgpr_write_b32 a173, v29
v_accvgpr_write_b32 a174, v30
v_accvgpr_write_b32 a175, v31
qw_65:
v_accvgpr_read_b32 v16, a160
v_accvgpr_read_b32 v17, a161
v_accvgpr_read_b32 v18, a162
v_accvgpr_read_b32 v19, a163
v_accvgpr_read_b32 v20, a164
v_accvgpr_read_b32 v21, a165
v_accvgpr_read_b32 v22, a166
v_accvgpr_read_b32 v23, a167
v_accvgpr_read_b32 v24, a168
v_accvgpr_read_b32 v25, a169
v_accvgpr_read_b32 v26, a170
v_accvgpr_read_b32 v27, a171
v_accvgpr_read_b32 v28, a172
v_accvgpr_read_b32 v29, a173
v_accvgpr_read_b32 v30, a174
v_accvgpr_read_b32 v31, a175
s_lshl_b32 s29, s16, 1
s_add_u32 s29, s29, 2
s_lshr_b32 s52, s39, 5
s_lshl_b32 s53, s32, 8
s_add_u32 s53, s53, 11534336
s_cmp_lg_u32 s13, 0
s_cbranch_scc1 polld_67
v_lshlrev_b32 v3, 3, v0
v_min_u32 v12, 3968, v3
s_mov_b32 s21, 11612160
s_mov_b32 s17, 0
poll_66:
buffer_load_dword v8, v3, s[4:7], s21 offen sc1
s_add_u32 s20, s21, 8192
buffer_load_dword v9, v3, s[4:7], s20 offen sc1
s_add_u32 s20, s21, 16384
buffer_load_dword v10, v12, s[4:7], s20 offen sc1
s_add_u32 s17, s17, 1
s_cmp_gt_u32 s17, 262144
s_cbranch_scc1 L_fail
s_waitcnt vmcnt(1)
v_min_u32 v8, v8, v9
s_waitcnt vmcnt(0)
v_min_u32 v8, v8, v10
v_cmp_gt_u32 vcc, s29, v8
s_cbranch_vccz polld_67
s_sleep 2
s_branch poll_66
polld_67:
s_barrier
qr_68:
s_mul_i32 s26, s16, 6291456
s_mul_i32 s18, s52, 163840
s_add_u32 s26, s26, s18
s_add_u32 s26, s26, s31
s_add_u32 s26, s26, 88080384
s_lshl_b32 s18, s16, 4
s_add_u32 s18, s18, s52
s_mul_i32 s18, s18, 20480
s_add_u32 s36, s18, 163577856
s_lshl_b32 s18, s13, 11
s_add_u32 s18, s18, 83968
v_add_u32 v13, s18, v0
s_mov_b32 s28, 0
v_xor_b32 v1, 40960, v0
s_mov_b32 s25, s31
s_mov_b32 s35, 131072
s_add_u32 m0, s25, 2048
s_add_u32 s20, s26, 0
buffer_load_dwordx4 v0, s[4:7], s20 offen sc1 lds
s_add_u32 m0, s25, 3072
s_add_u32 s20, s26, 1024
buffer_load_dwordx4 v0, s[4:7], s20 offen sc1 lds
s_add_u32 m0, s25, 4096
s_add_u32 s20, s26, 2048
buffer_load_dwordx4 v0, s[4:7], s20 offen sc1 lds
s_add_u32 m0, s25, 5120
s_add_u32 s20, s26, 3072
buffer_load_dwordx4 v0, s[4:7], s20 offen sc1 lds
s_add_u32 m0, s25, 6144
s_add_u32 s20, s26, 4096
buffer_load_dwordx4 v0, s[4:7], s20 offen sc1 lds
s_add_u32 m0, s25, 7168
s_add_u32 s20, s26, 5120
buffer_load_dwordx4 v0, s[4:7], s20 offen sc1 lds
s_add_u32 m0, s25, 8192
s_add_u32 s20, s26, 6144
buffer_load_dwordx4 v0, s[4:7], s20 offen sc1 lds
s_add_u32 m0, s25, 9216
s_add_u32 s20, s26, 7168
buffer_load_dwordx4 v0, s[4:7], s20 offen sc1 lds
s_add_u32 m0, s25, 10240
s_add_u32 s20, s26, 8192
buffer_load_dwordx4 v0, s[4:7], s20 offen sc1 lds
s_add_u32 m0, s25, 11264
s_add_u32 s20, s26, 9216
buffer_load_dwordx4 v0, s[4:7], s20 offen sc1 lds
s_add_u32 m0, s35, s37
s_add_u32 s20, s36, s37
buffer_load_dwordx4 v0, s[4:7], s20 offen sc1 lds
s_add_u32 m0, s35, 4096
s_add_u32 s20, s36, 4096
buffer_load_dwordx4 v0, s[4:7], s20 offen sc1 lds
s_waitcnt vmcnt(0)
qu_69:
v_xor_b32 v1, 40960, v1
s_sub_u32 s25, s25, s31
s_xor_b32 s25, s25, 40960
s_add_u32 s25, s25, s31
s_xor_b32 s35, s35, 8192
s_add_u32 s26, s26, 40960
s_add_u32 s36, s36, 5120
s_cmp_eq_u32 s28, 3
s_cselect_b32 s26, s6, s26
s_cselect_b32 s36, s6, s36
s_waitcnt vmcnt(0)
s_barrier
ds_read_b128 v[48:51], v1 offset:2048
ds_read_b128 v[52:55], v1 offset:3072
s_add_u32 m0, s25, 2048
s_add_u32 s20, s26, 0
buffer_load_dwordx4 v0, s[4:7], s20 offen sc1 lds
v_lshrrev_b32 v2, 2, v0
ds_read_b128 v[56:59], v1 offset:4096
ds_read_b128 v[60:63], v1 offset:5120
s_xor_b32 s18, s35, 8192
v_add_u32 v2, s18, v2
ds_read2st64_b32 v[72:73], v2 offset0:4 offset1:5
s_waitcnt lgkmcnt(4)
v_mfma_f32_32x32x16_bf16 v[32:47], a[0:3], v[48:51], 0
s_add_u32 m0, s25, 3072
s_add_u32 s20, s26, 1024
buffer_load_dwordx4 v0, s[4:7], s20 offen sc1 lds
ds_read_b128 v[48:51], v1 offset:6144
ds_read2st64_b32 v[66:67], v2 offset0:2 offset1:3
s_waitcnt lgkmcnt(4)
v_mfma_f32_32x32x16_bf16 v[32:47], a[4:7], v[52:55], v[32:47]
ds_read_b128 v[52:55], v1 offset:7168
ds_read2st64_b32 v[78:79], v2 offset0:10 offset1:11
s_add_u32 m0, s25, 4096
s_add_u32 s20, s26, 2048
buffer_load_dwordx4 v0, s[4:7], s20 offen sc1 lds
v_mfma_f32_32x32x16_bf16 v[32:47], a[8:11], v[56:59], v[32:47]
s_waitcnt lgkmcnt(3)
ds_read_b128 v[56:59], v1 offset:8192
ds_read2st64_b32 v[86:87], v2 offset0:18 offset1:19
v_mfma_f32_32x32x16_bf16 v[32:47], a[12:15], v[60:63], v[32:47]
ds_read_b128 v[60:63], v1 offset:9216
ds_read2st64_b32 v[64:65], v2 offset0:0 offset1:1
s_waitcnt lgkmcnt(5)
ds_read2st64_b32 v[74:75], v2 offset0:6 offset1:7
v_mfma_f32_32x32x16_bf16 v[32:47], a[16:19], v[48:51], v[32:47]
ds_read2st64_b32 v[80:81], v2 offset0:12 offset1:13
ds_read_b128 v[48:51], v1 offset:10240
ds_read2st64_b32 v[82:83], v2 offset0:14 offset1:15
ds_read2st64_b32 v[76:77], v2 offset0:8 offset1:9
v_mfma_f32_32x32x16_bf16 v[32:47], a[20:23], v[52:55], v[32:47]
ds_read_b128 v[52:55], v1 offset:11264
s_waitcnt lgkmcnt(9)
s_add_u32 m0, s25, 5120
s_add_u32 s20, s26, 3072
buffer_load_dwordx4 v0, s[4:7], s20 offen sc1 lds
v_mfma_f32_32x32x16_bf16 v[32:47], a[24:27], v[56:59], v[32:47]
s_waitcnt lgkmcnt(7)
s_add_u32 m0, s25, 6144
s_add_u32 s20, s26, 4096
buffer_load_dwordx4 v0, s[4:7], s20 offen sc1 lds
s_waitcnt lgkmcnt(6)
v_add_f32 v64, v64, v66
v_mfma_f32_32x32x16_bf16 v[32:47], a[28:31], v[60:63], v[32:47]
ds_read_b128 v[56:59], v1 offset:12288
ds_read_b128 v[60:63], v1 offset:13312
v_add_f32 v65, v65, v67
s_waitcnt lgkmcnt(5)
v_mfma_f32_32x32x16_bf16 v[32:47], a[32:35], v[48:51], v[32:47]
ds_read_b128 v[48:51], v1 offset:14336
v_add_f32 v65, v65, v73
s_waitcnt lgkmcnt(3)
v_add_f32 v65, v65, v75
v_mfma_f32_32x32x16_bf16 v[32:47], a[36:39], v[52:55], v[32:47]
s_add_u32 m0, s25, 7168
s_add_u32 s20, s26, 5120
buffer_load_dwordx4 v0, s[4:7], s20 offen sc1 lds
ds_read2st64_b32 v[84:85], v2 offset0:16 offset1:17
v_add_f32 v64, v64, v72
s_waitcnt lgkmcnt(3)
v_add_f32 v65, v65, v77
v_mfma_f32_32x32x16_bf16 v[32:47], a[40:43], v[56:59], v[32:47]
s_waitcnt lgkmcnt(2)
ds_read_b128 v[56:59], v1 offset:16384
ds_read_b128 v[52:55], v1 offset:15360
v_add_f32 v64, v64, v74
v_add_f32 v64, v64, v76
v_mfma_f32_32x32x16_bf16 v[32:47], a[44:47], v[60:63], v[32:47]
s_waitcnt lgkmcnt(3)
ds_read_b128 v[60:63], v1 offset:17408
v_add_f32 v65, v65, v79
v_mfma_f32_32x32x16_bf16 v[32:47], a[48:51], v[48:51], v[32:47]
v_add_f32 v64, v64, v78
s_add_u32 m0, s25, 8192
s_add_u32 s20, s26, 6144
buffer_load_dwordx4 v0, s[4:7], s20 offen sc1 lds
s_waitcnt lgkmcnt(1)
v_mfma_f32_32x32x16_bf16 v[32:47], a[52:55], v[52:55], v[32:47]
ds_read_b128 v[48:51], v1 offset:18432
v_add_f32 v65, v65, v81
s_waitcnt lgkmcnt(1)
ds_read_b128 v[52:55], v1 offset:19456
v_mfma_f32_32x32x16_bf16 v[32:47], a[56:59], v[56:59], v[32:47]
s_add_u32 m0, s25, 9216
s_add_u32 s20, s26, 7168
buffer_load_dwordx4 v0, s[4:7], s20 offen sc1 lds
v_mfma_f32_32x32x16_bf16 v[32:47], a[60:63], v[60:63], v[32:47]
ds_read_b128 v[60:63], v1 offset:21504
s_waitcnt lgkmcnt(2)
ds_read_b128 v[56:59], v1 offset:20480
v_mfma_f32_32x32x16_bf16 v[32:47], a[64:67], v[48:51], v[32:47]
v_add_f32 v65, v65, v83
s_waitcnt lgkmcnt(2)
ds_read_b128 v[48:51], v1 offset:22528
v_mfma_f32_32x32x16_bf16 v[32:47], a[68:71], v[52:55], v[32:47]
v_add_f32 v65, v65, v85
v_add_f32 v64, v64, v80
v_add_f32 v64, v64, v82
s_waitcnt lgkmcnt(2)
s_waitcnt lgkmcnt(1)
v_mfma_f32_32x32x16_bf16 v[32:47], a[72:75], v[56:59], v[32:47]
s_add_u32 m0, s25, 10240
s_add_u32 s20, s26, 8192
buffer_load_dwordx4 v0, s[4:7], s20 offen sc1 lds
ds_read_b128 v[52:55], v1 offset:23552
v_add_f32 v64, v64, v84
v_add_f32 v65, v65, v87
s_waitcnt lgkmcnt(1)
v_mfma_f32_32x32x16_bf16 v[32:47], a[76:79], v[60:63], v[32:47]
v_add_f32 v64, v64, v86
ds_read_b128 v[56:59], v1 offset:24576
v_mfma_f32_32x32x16_bf16 v[32:47], a[80:83], v[48:51], v[32:47]
ds_read_b128 v[60:63], v1 offset:25600
ds_read_b128 v[48:51], v1 offset:26624
v_add_f32 v64, v64, v65
v_mov_b32 v68, v64
s_waitcnt lgkmcnt(3)
v_mfma_f32_32x32x16_bf16 v[32:47], a[84:87], v[52:55], v[32:47]
s_add_u32 m0, s25, 11264
s_add_u32 s20, s26, 9216
buffer_load_dwordx4 v0, s[4:7], s20 offen sc1 lds
s_waitcnt lgkmcnt(2)
v_permlane32_swap_b32 v64, v68
v_mfma_f32_32x32x16_bf16 v[32:47], a[88:91], v[56:59], v[32:47]
ds_read_b128 v[56:59], v1 offset:28672
ds_read_b128 v[52:55], v1 offset:27648
v_mul_f32 v68, 0x3acccccd, v68
s_waitcnt lgkmcnt(3)
v_mul_f32 v64, 0x3acccccd, v64
v_fma_f32 v68, -v64, v64, v68
v_mfma_f32_32x32x16_bf16 v[32:47], a[92:95], v[60:63], v[32:47]
s_add_u32 m0, s35, s37
s_add_u32 s20, s36, s37
buffer_load_dwordx4 v0, s[4:7], s20 offen sc1 lds
ds_read_b128 v[60:63], v1 offset:29696
s_waitcnt lgkmcnt(3)
v_max_f32 v68, 0, v68
v_add_f32 v68, 0x3727c5ac, v68
v_mfma_f32_32x32x16_bf16 v[32:47], a[96:99], v[48:51], v[32:47]
ds_read_b128 v[48:51], v1 offset:30720
v_rsq_f32 v68, v68
s_waitcnt lgkmcnt(2)
v_mul_f32 v68, 0x3e0293ee, v68
v_mfma_f32_32x32x16_bf16 v[32:47], a[100:103], v[52:55], v[32:47]
s_add_u32 m0, s35, 4096
s_add_u32 s20, s36, 4096
buffer_load_dwordx4 v0, s[4:7], s20 offen sc1 lds
v_mul_f32 v64, v68, v64
s_waitcnt lgkmcnt(1)
v_mfma_f32_32x32x16_bf16 v[32:47], a[104:107], v[56:59], v[32:47]
v_mul_f32 v82, v64, v26
s_waitcnt lgkmcnt(0)
ds_read_b128 v[52:55], v1 offset:31744
ds_read_b128 v[56:59], v1 offset:32768
v_mfma_f32_32x32x16_bf16 v[32:47], a[108:111], v[60:63], v[32:47]
ds_read_b128 v[60:63], v1 offset:33792
v_mfma_f32_32x32x16_bf16 v[32:47], a[112:115], v[48:51], v[32:47]
s_waitcnt lgkmcnt(2)
v_mul_f32 v84, v64, v28
v_mul_f32 v73, v64, v17
v_mfma_f32_32x32x16_bf16 v[32:47], a[116:119], v[52:55], v[32:47]
ds_read_b128 v[52:55], v1 offset:35840
s_waitcnt lgkmcnt(2)
ds_read_b128 v[48:51], v1 offset:34816
v_mfma_f32_32x32x16_bf16 v[32:47], a[120:123], v[56:59], v[32:47]
v_mul_f32 v87, v64, v31
v_mul_f32 v77, v64, v21
v_mul_f32 v81, v64, v25
s_waitcnt lgkmcnt(2)
v_mfma_f32_32x32x16_bf16 v[32:47], a[124:127], v[60:63], v[32:47]
ds_read_b128 v[60:63], v1 offset:37888
s_waitcnt lgkmcnt(2)
s_waitcnt lgkmcnt(1)
ds_read_b128 v[56:59], v1 offset:36864
v_mfma_f32_32x32x16_bf16 v[32:47], a[128:131], v[48:51], v[32:47]
ds_read_b128 v[48:51], v1 offset:38912
v_mul_f32 v75, v64, v19
v_mfma_f32_32x32x16_bf16 v[32:47], a[132:135], v[52:55], v[32:47]
s_waitcnt lgkmcnt(1)
v_mfma_f32_32x32x16_bf16 v[32:47], a[136:139], v[56:59], v[32:47]
ds_read_b128 v[56:59], v1 offset:40960
ds_read_b128 v[52:55], v1 offset:39936
v_mul_f32 v79, v64, v23
v_mul_f32 v85, v64, v29
v_mul_f32 v76, v64, v20
v_mfma_f32_32x32x16_bf16 v[32:47], a[140:143], v[60:63], v[32:47]
s_waitcnt lgkmcnt(2)
ds_read_b128 v[60:63], v1 offset:41984
v_mul_f32 v74, v64, v18
v_mul_f32 v86, v64, v30
v_mfma_f32_32x32x16_bf16 v[32:47], a[144:147], v[48:51], v[32:47]
s_waitcnt lgkmcnt(1)
v_mfma_f32_32x32x16_bf16 v[32:47], a[148:151], v[52:55], v[32:47]
s_waitcnt lgkmcnt(0)
v_mfma_f32_32x32x16_bf16 v[32:47], a[152:155], v[56:59], v[32:47]
v_mfma_f32_32x32x16_bf16 v[32:47], a[156:159], v[60:63], v[32:47]
s_nop 0
v_mul_f32 v72, v64, v16
v_mul_f32 v78, v64, v22
v_mul_f32 v83, v64, v27
v_mul_f32 v80, v64, v24
s_nop 6
v_pk_fma_f32 v[44:45], v[44:45], v[68:69], v[84:85] op_sel_hi:[1,0,1] neg_lo:[0,0,1] neg_hi:[0,0,1]
v_pk_fma_f32 v[38:39], v[38:39], v[68:69], v[78:79] op_sel_hi:[1,0,1] neg_lo:[0,0,1] neg_hi:[0,0,1]
v_pk_fma_f32 v[42:43], v[42:43], v[68:69], v[82:83] op_sel_hi:[1,0,1] neg_lo:[0,0,1] neg_hi:[0,0,1]
v_pk_fma_f32 v[46:47], v[46:47], v[68:69], v[86:87] op_sel_hi:[1,0,1] neg_lo:[0,0,1] neg_hi:[0,0,1]
v_pk_fma_f32 v[34:35], v[34:35], v[68:69], v[74:75] op_sel_hi:[1,0,1] neg_lo:[0,0,1] neg_hi:[0,0,1]
v_pk_fma_f32 v[32:33], v[32:33], v[68:69], v[72:73] op_sel_hi:[1,0,1] neg_lo:[0,0,1] neg_hi:[0,0,1]
v_cvt_pk_bf16_f32 v51, v38, v39
v_cvt_pk_bf16_f32 v49, v34, v35
v_pk_fma_f32 v[36:37], v[36:37], v[68:69], v[76:77] op_sel_hi:[1,0,1] neg_lo:[0,0,1] neg_hi:[0,0,1]
v_cvt_pk_bf16_f32 v54, v44, v45
v_cvt_pk_bf16_f32 v50, v36, v37
v_cvt_pk_bf16_f32 v48, v32, v33
v_pk_fma_f32 v[40:41], v[40:41], v[68:69], v[80:81] op_sel_hi:[1,0,1] neg_lo:[0,0,1] neg_hi:[0,0,1]
v_cvt_pk_bf16_f32 v55, v46, v47
v_cvt_pk_bf16_f32 v53, v42, v43
v_cvt_pk_bf16_f32 v52, v40, v41
ds_write_b128 v13, v[48:51] offset:0
ds_write_b128 v13, v[52:55] offset:1024
v_add_u32 v13, 8192, v13
s_add_u32 s28, s28, 1
s_cmp_lt_u32 s28, 4
s_cbranch_scc1 qu_69
s_waitcnt lgkmcnt(0)
s_barrier
s_lshl_b32 s30, s52, 2
s_add_u32 s30, s30, s13
s_lshl_b32 s18, s16, 6
s_add_u32 s29, s18, s30
s_lshl_b32 s27, s29, 18
s_lshl_b32 s19, s32, 13
s_add_u32 s27, s27, s19
s_add_u32 s27, s27, 127926272
s_mul_i32 s18, s16, 35651584
s_mul_i32 s19, s30, 524288
s_add_u32 s18, s18, s19
s_mul_i32 s19, s32, 16384
s_add_u32 s18, s18, s19
s_add_u32 s29, s29, 1
s_mov_b32 s28, s29
s_lshl_b32 s19, s13, 13
s_add_u32 s19, s19, 83968
v_add_u32 v200, s19, v0
s_add_u32 s54, s18, 16777216
s_add_u32 s55, s18, 16781312
s_add_u32 s56, s18, 16785408
s_add_u32 s57, s18, 16789504
ds_read_b128 v[32:35], v200 offset:0
ds_read_b128 v[36:39], v200 offset:1024
ds_read_b128 v[40:43], v200 offset:2048
ds_read_b128 v[44:47], v200 offset:3072
ds_read_b128 v[48:51], v200 offset:4096
ds_read_b128 v[52:55], v200 offset:5120
ds_read_b128 v[56:59], v200 offset:6144
ds_read_b128 v[60:63], v200 offset:7168
v_and_b32 v14, 0x70, v0
v_lshrrev_b32 v200, 8, v0
v_lshl_add_u32 v14, v200, 7, v14
v_bfe_u32 v200, v0, 7, 1
v_lshl_add_u32 v14, v200, 12, v14
v_and_b32 v15, 0x70, v0
v_lshrrev_b32 v200, 8, v0
v_lshl_add_u32 v15, v200, 7, v15
v_bfe_u32 v200, v0, 7, 1
v_lshl_add_u32 v15, v200, 10, v15
v_bfe_u32 v200, v0, 4, 5
v_lshrrev_b32 v144, 9, v0
v_lshlrev_b32 v144, 2, v144
v_sub_u32 v200, v200, v144
v_mov_b32 v145, 0xf149f2ca
v_cmp_gt_i32 vcc, 0, v200
s_nop 1
v_cndmask_b32 v128, 0, v145, vcc
v_cmp_gt_i32 vcc, 1, v200
s_nop 1
v_cndmask_b32 v129, 0, v145, vcc
v_cmp_gt_i32 vcc, 2, v200
s_nop 1
v_cndmask_b32 v130, 0, v145, vcc
v_cmp_gt_i32 vcc, 3, v200
s_nop 1
v_cndmask_b32 v131, 0, v145, vcc
v_cmp_gt_i32 vcc, 8, v200
s_nop 1
v_cndmask_b32 v132, 0, v145, vcc
v_cmp_gt_i32 vcc, 9, v200
s_nop 1
v_cndmask_b32 v133, 0, v145, vcc
v_cmp_gt_i32 vcc, 10, v200
s_nop 1
v_cndmask_b32 v134, 0, v145, vcc
v_cmp_gt_i32 vcc, 11, v200
s_nop 1
v_cndmask_b32 v135, 0, v145, vcc
v_cmp_gt_i32 vcc, 16, v200
s_nop 1
v_cndmask_b32 v136, 0, v145, vcc
v_cmp_gt_i32 vcc, 17, v200
s_nop 1
v_cndmask_b32 v137, 0, v145, vcc
v_cmp_gt_i32 vcc, 18, v200
s_nop 1
v_cndmask_b32 v138, 0, v145, vcc
v_cmp_gt_i32 vcc, 19, v200
s_nop 1
v_cndmask_b32 v139, 0, v145, vcc
v_cmp_gt_i32 vcc, 24, v200
s_nop 1
v_cndmask_b32 v140, 0, v145, vcc
v_cmp_gt_i32 vcc, 25, v200
s_nop 1
v_cndmask_b32 v141, 0, v145, vcc
v_cmp_gt_i32 vcc, 26, v200
s_nop 1
v_cndmask_b32 v142, 0, v145, vcc
v_cmp_gt_i32 vcc, 27, v200
s_nop 1
v_cndmask_b32 v143, 0, v145, vcc
v_lshlrev_b32 v3, 3, v0
v_min_u32 v12, 128, v3
s_mov_b32 s17, 0
poll_70:
buffer_load_dword v8, v12, s[4:7], s53 offen sc1
s_add_u32 s17, s17, 1
s_cmp_gt_u32 s17, 262144
s_cbranch_scc1 L_fail
s_waitcnt vmcnt(0)
v_cmp_gt_u32 vcc, s29, v8
s_cbranch_vccz polld_71
s_sleep 2
s_branch poll_70
polld_71:
buffer_load_dwordx4 v[64:67], v14, s[4:7], s54 offen offset:0 sc1
buffer_load_dwordx4 v[68:71], v14, s[4:7], s54 offen offset:512 sc1
buffer_load_dwordx4 v[72:75], v14, s[4:7], s54 offen offset:1024 sc1
buffer_load_dwordx4 v[76:79], v14, s[4:7], s54 offen offset:1536 sc1
buffer_load_dwordx4 v[80:83], v14, s[4:7], s56 offen offset:0 sc1
buffer_load_dwordx4 v[84:87], v14, s[4:7], s56 offen offset:512 sc1
buffer_load_dwordx4 v[88:91], v14, s[4:7], s56 offen offset:1024 sc1
buffer_load_dwordx4 v[92:95], v14, s[4:7], s56 offen offset:1536 sc1
buffer_load_dwordx4 v[96:99], v15, s[4:7], s54 offen offset:2048 sc1
buffer_load_dwordx4 v[100:103], v15, s[4:7], s54 offen offset:2560 sc1
buffer_load_dwordx4 v[104:107], v15, s[4:7], s55 offen offset:2048 sc1
buffer_load_dwordx4 v[108:111], v15, s[4:7], s55 offen offset:2560 sc1
buffer_load_dwordx4 v[112:115], v15, s[4:7], s56 offen offset:2048 sc1
buffer_load_dwordx4 v[116:119], v15, s[4:7], s56 offen offset:2560 sc1
buffer_load_dwordx4 v[120:123], v15, s[4:7], s57 offen offset:2048 sc1
buffer_load_dwordx4 v[124:127], v15, s[4:7], s57 offen offset:2560 sc1
s_waitcnt vmcnt(15) lgkmcnt(7)
v_mfma_f32_32x32x16_bf16 v[128:143], v[64:67], v[32:35], v[128:143]
s_waitcnt vmcnt(14) lgkmcnt(6)
v_mfma_f32_32x32x16_bf16 v[128:143], v[68:71], v[36:39], v[128:143]
s_waitcnt vmcnt(13) lgkmcnt(5)
v_mfma_f32_32x32x16_bf16 v[128:143], v[72:75], v[40:43], v[128:143]
s_waitcnt vmcnt(12) lgkmcnt(4)
v_mfma_f32_32x32x16_bf16 v[128:143], v[76:79], v[44:47], v[128:143]
s_waitcnt vmcnt(11) lgkmcnt(3)
v_mfma_f32_32x32x16_bf16 v[128:143], v[80:83], v[48:51], v[128:143]
s_waitcnt vmcnt(10) lgkmcnt(2)
v_mfma_f32_32x32x16_bf16 v[128:143], v[84:87], v[52:55], v[128:143]
s_waitcnt vmcnt(9) lgkmcnt(1)
v_mfma_f32_32x32x16_bf16 v[128:143], v[88:91], v[56:59], v[128:143]
s_waitcnt vmcnt(8) lgkmcnt(0)
v_mfma_f32_32x32x16_bf16 v[128:143], v[92:95], v[60:63], v[128:143]
s_lshl_b32 s18, s16, 4
s_add_u32 s29, s18, s52
s_lshl_b32 s18, s29, 19
s_lshl_b32 s19, s32, 14
s_add_u32 s18, s18, s19
s_add_u32 s29, s29, 1
s_and_b32 s19, s13, 1
s_lshr_b32 s20, s13, 1
v_and_b32 v14, 0x170, v14
v_lshl_add_u32 v14, s19, 12, v14
v_lshl_add_u32 v14, s20, 7, v14
v_lshl_add_u32 v15, s19, 3, v15
v_lshl_add_u32 v15, s20, 9, v15
s_add_u32 s54, s18, 110100480
s_add_u32 s55, s18, 110104576
s_add_u32 s56, s18, 110108672
s_add_u32 s57, s18, 110112768
v_max3_f32 v200, v128, v129, v130
v_max3_f32 v200, v200, v131, v132
v_max3_f32 v200, v200, v133, v134
v_max3_f32 v200, v200, v135, v136
v_max3_f32 v200, v200, v137, v138
v_max3_f32 v200, v200, v139, v140
v_max3_f32 v200, v200, v141, v142
v_max_f32 v200, v200, v143
s_add_u32 s18, s53, 8192
v_lshlrev_b32 v3, 3, v0
v_min_u32 v12, 128, v3
s_mov_b32 s17, 0
poll_72:
buffer_load_dword v8, v12, s[4:7], s18 offen sc1
s_add_u32 s17, s17, 1
s_cmp_gt_u32 s17, 262144
s_cbranch_scc1 L_fail
s_waitcnt vmcnt(0)
v_cmp_gt_u32 vcc, s29, v8
s_cbranch_vccz polld_73
s_sleep 2
s_branch poll_72
polld_73:
buffer_load_dwordx4 v[64:67], v14, s[4:7], s54 offen offset:0 sc1
buffer_load_dwordx4 v[68:71], v14, s[4:7], s54 offen offset:512 sc1
buffer_load_dwordx4 v[72:75], v14, s[4:7], s54 offen offset:1024 sc1
buffer_load_dwordx4 v[76:79], v14, s[4:7], s54 offen offset:1536 sc1
buffer_load_dwordx4 v[80:83], v14, s[4:7], s56 offen offset:0 sc1
buffer_load_dwordx4 v[84:87], v14, s[4:7], s56 offen offset:512 sc1
buffer_load_dwordx4 v[88:91], v14, s[4:7], s56 offen offset:1024 sc1
buffer_load_dwordx4 v[92:95], v14, s[4:7], s56 offen offset:1536 sc1
buffer_load_dwordx2 v[192:193], v15, s[4:7], s54 offen offset:2048 sc1
buffer_load_dwordx2 v[194:195], v15, s[4:7], s55 offen offset:2048 sc1
buffer_load_dwordx2 v[196:197], v15, s[4:7], s56 offen offset:2048 sc1
buffer_load_dwordx2 v[198:199], v15, s[4:7], s57 offen offset:2048 sc1
s_waitcnt vmcnt(11)
v_mfma_f32_32x32x16_bf16 v[144:159], v[64:67], v[32:35], 0
s_waitcnt vmcnt(10)
v_mfma_f32_32x32x16_bf16 v[144:159], v[68:71], v[36:39], v[144:159]
s_waitcnt vmcnt(9)
v_mfma_f32_32x32x16_bf16 v[144:159], v[72:75], v[40:43], v[144:159]
s_waitcnt vmcnt(8)
v_mfma_f32_32x32x16_bf16 v[144:159], v[76:79], v[44:47], v[144:159]
s_waitcnt vmcnt(7)
v_mfma_f32_32x32x16_bf16 v[144:159], v[80:83], v[48:51], v[144:159]
s_waitcnt vmcnt(6)
v_mfma_f32_32x32x16_bf16 v[144:159], v[84:87], v[52:55], v[144:159]
s_waitcnt vmcnt(5)
v_mfma_f32_32x32x16_bf16 v[144:159], v[88:91], v[56:59], v[144:159]
s_waitcnt vmcnt(4)
v_mfma_f32_32x32x16_bf16 v[144:159], v[92:95], v[60:63], v[144:159]
s_nop 11
v_max3_f32 v148, v200, v144, v145
v_max3_f32 v148, v148, v146, v147
v_mov_b32 v150, v148
s_nop 1
v_permlane32_swap_b32 v148, v150
v_max_f32 v148, v148, v150
v_sub_f32 v145, v145, v148
v_sub_f32 v146, v146, v148
v_sub_f32 v144, v144, v148
v_exp_f32 v145, v145
v_sub_f32 v147, v147, v148
v_exp_f32 v146, v146
v_exp_f32 v144, v144
v_exp_f32 v147, v147
v_cvt_pk_bf16_f32 v40, v144, v145
v_cvt_pk_bf16_f32 v41, v146, v147
v_sub_f32 v132, v132, v148
v_sub_f32 v128, v128, v148
s_waitcnt vmcnt(3)
v_mfma_f32_32x32x8_bf16 v[160:175], v[192:193], v[40:41], 0
v_sub_f32 v133, v133, v148
v_sub_f32 v130, v130, v148
v_sub_f32 v134, v134, v148
v_sub_f32 v131, v131, v148
v_exp_f32 v132, v132
s_waitcnt vmcnt(0)
v_mfma_f32_32x32x8_bf16 v[80:95], v[198:199], v[40:41], 0
v_sub_f32 v129, v129, v148
v_sub_f32 v135, v135, v148
v_exp_f32 v128, v128
v_exp_f32 v133, v133
v_mfma_f32_32x32x8_bf16 v[176:191], v[194:195], v[40:41], 0
v_exp_f32 v130, v130
v_exp_f32 v135, v135
v_exp_f32 v131, v131
v_mfma_f32_32x32x8_bf16 v[64:79], v[196:197], v[40:41], 0
v_exp_f32 v129, v129
v_cvt_pk_bf16_f32 v33, v130, v131
v_cvt_pk_bf16_f32 v34, v132, v133
v_exp_f32 v134, v134
v_cvt_pk_bf16_f32 v32, v128, v129
v_cvt_pk_bf16_f32 v35, v134, v135
v_sub_f32 v136, v136, v148
v_sub_f32 v140, v140, v148
v_mfma_f32_32x32x16_bf16 v[176:191], v[104:107], v[32:35], v[176:191]
v_sub_f32 v141, v141, v148
v_sub_f32 v142, v142, v148
v_sub_f32 v139, v139, v148
v_sub_f32 v138, v138, v148
v_sub_f32 v137, v137, v148
v_sub_f32 v143, v143, v148
v_mfma_f32_32x32x16_bf16 v[64:79], v[112:115], v[32:35], v[64:79]
v_exp_f32 v139, v139
v_exp_f32 v136, v136
v_exp_f32 v141, v141
v_mfma_f32_32x32x16_bf16 v[160:175], v[96:99], v[32:35], v[160:175]
s_add_u32 s19, s27, 4096
v_exp_f32 v142, v142
v_exp_f32 v143, v143
v_exp_f32 v138, v138
v_mfma_f32_32x32x16_bf16 v[80:95], v[120:123], v[32:35], v[80:95]
v_exp_f32 v137, v137
v_cvt_pk_bf16_f32 v37, v138, v139
v_cvt_pk_bf16_f32 v36, v136, v137
v_exp_f32 v140, v140
v_cvt_pk_bf16_f32 v39, v142, v143
v_cvt_pk_bf16_f32 v38, v140, v141
v_add_f32 v149, v128, v129
v_add_f32 v149, v149, v130
v_mfma_f32_32x32x16_bf16 v[160:175], v[100:103], v[36:39], v[160:175]
v_add_f32 v149, v149, v131
v_add_f32 v149, v149, v132
v_add_f32 v149, v149, v133
v_add_f32 v149, v149, v134
v_add_f32 v149, v149, v135
v_add_f32 v149, v149, v136
v_mfma_f32_32x32x16_bf16 v[176:191], v[108:111], v[36:39], v[176:191]
v_add_f32 v149, v149, v137
v_add_f32 v149, v149, v138
v_add_f32 v149, v149, v139
v_add_f32 v149, v149, v140
v_add_f32 v149, v149, v141
v_add_f32 v149, v149, v142
v_mfma_f32_32x32x16_bf16 v[80:95], v[124:127], v[36:39], v[80:95]
v_add_f32 v149, v149, v143
v_add_f32 v149, v149, v144
v_add_f32 v149, v149, v145
v_add_f32 v149, v149, v146
v_add_f32 v149, v149, v147
v_mov_b32 v150, v149
v_mfma_f32_32x32x16_bf16 v[64:79], v[116:119], v[36:39], v[64:79]
s_nop 0
v_permlane32_swap_b32 v149, v150
v_add_f32 v149, v149, v150
v_rcp_f32 v149, v149
s_nop 0
v_mul_f32 v171, v171, v149
v_mul_f32 v167, v167, v149
v_mul_f32 v160, v160, v149
v_mul_f32 v178, v178, v149
v_mul_f32 v191, v191, v149
v_mul_f32 v172, v172, v149
v_mul_f32 v162, v162, v149
v_mul_f32 v76, v76, v149
v_mul_f32 v161, v161, v149
v_mul_f32 v78, v78, v149
v_mul_f32 v163, v163, v149
v_mul_f32 v90, v90, v149
v_mul_f32 v177, v177, v149
v_mul_f32 v71, v71, v149
v_mul_f32 v174, v174, v149
v_mul_f32 v79, v79, v149
v_cvt_pk_bf16_f32 v160, v160, v161
v_mul_f32 v190, v190, v149
v_mul_f32 v181, v181, v149
v_mul_f32 v85, v85, v149
v_mul_f32 v176, v176, v149
v_mul_f32 v179, v179, v149
v_mul_f32 v80, v80, v149
v_mul_f32 v64, v64, v149
v_mul_f32 v73, v73, v149
v_mul_f32 v168, v168, v149
v_mul_f32 v87, v87, v149
v_mul_f32 v175, v175, v149
v_mul_f32 v188, v188, v149
v_mul_f32 v86, v86, v149
v_mul_f32 v182, v182, v149
v_mul_f32 v165, v165, v149
v_mul_f32 v65, v65, v149
v_mul_f32 v180, v180, v149
v_mul_f32 v164, v164, v149
v_mul_f32 v84, v84, v149
v_mul_f32 v170, v170, v149
v_cvt_pk_bf16_f32 v176, v176, v177
v_cvt_pk_bf16_f32 v177, v178, v179
v_mul_f32 v166, v166, v149
v_mul_f32 v169, v169, v149
v_mul_f32 v184, v184, v149
v_cvt_pk_bf16_f32 v161, v162, v163
v_cvt_pk_bf16_f32 v163, v166, v167
v_mul_f32 v173, v173, v149
v_mul_f32 v88, v88, v149
v_cvt_pk_bf16_f32 v162, v164, v165
v_mul_f32 v189, v189, v149
v_mul_f32 v74, v74, v149
v_mul_f32 v82, v82, v149
v_mul_f32 v81, v81, v149
v_mul_f32 v77, v77, v149
v_cvt_pk_bf16_f32 v64, v64, v65
v_mul_f32 v183, v183, v149
v_mul_f32 v185, v185, v149
v_cvt_pk_bf16_f32 v164, v168, v169
v_mul_f32 v68, v68, v149
v_cvt_pk_bf16_f32 v179, v182, v183
v_cvt_pk_bf16_f32 v167, v174, v175
v_cvt_pk_bf16_f32 v178, v180, v181
v_mul_f32 v93, v93, v149
v_mul_f32 v187, v187, v149
v_cvt_pk_bf16_f32 v166, v172, v173
v_mul_f32 v66, v66, v149
v_cvt_pk_bf16_f32 v165, v170, v171
v_mul_f32 v67, v67, v149
v_mul_f32 v69, v69, v149
v_mul_f32 v83, v83, v149
buffer_store_dwordx4 v[160:163], v0, s[4:7], s27 offen offset:0 sc1
buffer_store_dwordx4 v[164:167], v0, s[4:7], s27 offen offset:1024 sc1
buffer_store_dwordx4 v[176:179], v0, s[4:7], s27 offen offset:2048 sc1
v_mul_f32 v94, v94, v149
v_cvt_pk_bf16_f32 v180, v184, v185
v_mul_f32 v89, v89, v149
v_cvt_pk_bf16_f32 v65, v66, v67
v_cvt_pk_bf16_f32 v182, v188, v189
v_mul_f32 v72, v72, v149
v_mul_f32 v95, v95, v149
v_mul_f32 v186, v186, v149
v_mul_f32 v92, v92, v149
v_mul_f32 v70, v70, v149
v_mul_f32 v75, v75, v149
v_cvt_pk_bf16_f32 v80, v80, v81
v_cvt_pk_bf16_f32 v81, v82, v83
v_cvt_pk_bf16_f32 v67, v70, v71
v_cvt_pk_bf16_f32 v66, v68, v69
v_cvt_pk_bf16_f32 v83, v86, v87
v_cvt_pk_bf16_f32 v183, v190, v191
v_cvt_pk_bf16_f32 v70, v76, v77
v_cvt_pk_bf16_f32 v82, v84, v85
v_cvt_pk_bf16_f32 v71, v78, v79
v_cvt_pk_bf16_f32 v87, v94, v95
v_cvt_pk_bf16_f32 v69, v74, v75
v_cvt_pk_bf16_f32 v84, v88, v89
v_mul_f32 v91, v91, v149
v_cvt_pk_bf16_f32 v86, v92, v93
v_cvt_pk_bf16_f32 v85, v90, v91
v_cvt_pk_bf16_f32 v68, v72, v73
v_cvt_pk_bf16_f32 v181, v186, v187
buffer_store_dwordx4 v[180:183], v0, s[4:7], s27 offen offset:3072 sc1
buffer_store_dwordx4 v[64:67], v0, s[4:7], s19 offen offset:0 sc1
buffer_store_dwordx4 v[68:71], v0, s[4:7], s19 offen offset:1024 sc1
buffer_store_dwordx4 v[80:83], v0, s[4:7], s19 offen offset:2048 sc1
buffer_store_dwordx4 v[84:87], v0, s[4:7], s19 offen offset:3072 sc1
s_and_b32 s18, s30, 7
s_lshl_b32 s18, s18, 5
s_add_u32 s18, s18, s32
s_lshl_b32 s18, s18, 7
s_add_u32 s18, s18, 11632640
s_waitcnt vmcnt(0)
v_mov_b32 v3, s28
s_mov_b64 exec, 1
buffer_store_dword v3, off, s[4:7], s18 sc1
s_mov_b64 exec, -1
s_add_u32 s52, s52, 2
s_cmp_lt_u32 s52, 16
s_cbranch_scc1 qr_68
s_barrier
s_branch aend_64
wo_62:
s_sub_u32 s18, s39, 64
s_mul_i32 s30, s18, 3277
s_lshr_b32 s30, s30, 16
s_mul_i32 s19, s30, 20
s_sub_u32 s52, s18, s19
s_cmp_lg_u32 s16, 0
s_cbranch_scc1 ww_74
s_mul_i32 s26, s13, 1310720
s_lshl_b32 s18, s52, 6
s_add_u32 s26, s26, s18
s_load_dwordx2 s[40:41], s[0:1], 64
s_mov_b32 s42, 5242880
s_mov_b32 s43, 0x20000
s_waitcnt lgkmcnt(0)
v_lshrrev_b32 v214, 6, v0
v_mul_u32_u24 v214, 1280, v214
v_and_b32 v215, 48, v0
v_add_u32 v212, v214, v215
v_bfe_u32 v214, v0, 6, 2
v_lshrrev_b32 v215, 9, v0
v_lshl_add_u32 v214, v215, 3, v214
v_lshlrev_b32 v213, 6, v214
v_and_b32 v214, 16, v0
v_add_u32 v213, v213, v214
v_bfe_u32 v214, v0, 5, 1
v_lshl_add_u32 v213, v214, 3, v213
v_bfe_u32 v214, v0, 8, 1
v_lshl_add_u32 v213, v214, 5, v213
s_mul_i32 s18, s13, 36864
v_add_u32 v213, s18, v213
s_barrier
s_add_u32 m0, s18, 0
s_add_u32 s19, s26, 0
buffer_load_dwordx4 v212, s[40:43], s19 offen lds
s_add_u32 m0, s18, 1024
s_add_u32 s19, s26, 20480
buffer_load_dwordx4 v212, s[40:43], s19 offen lds
s_add_u32 m0, s18, 2048
s_add_u32 s19, s26, 40960
buffer_load_dwordx4 v212, s[40:43], s19 offen lds
s_add_u32 m0, s18, 3072
s_add_u32 s19, s26, 61440
buffer_load_dwordx4 v212, s[40:43], s19 offen lds
s_add_u32 m0, s18, 4096
s_add_u32 s19, s26, 81920
buffer_load_dwordx4 v212, s[40:43], s19 offen lds
s_add_u32 m0, s18, 5120
s_add_u32 s19, s26, 102400
buffer_load_dwordx4 v212, s[40:43], s19 offen lds
s_add_u32 m0, s18, 6144
s_add_u32 s19, s26, 122880
buffer_load_dwordx4 v212, s[40:43], s19 offen lds
s_add_u32 m0, s18, 7168
s_add_u32 s19, s26, 143360
buffer_load_dwordx4 v212, s[40:43], s19 offen lds
s_add_u32 m0, s18, 8192
s_add_u32 s19, s26, 163840
buffer_load_dwordx4 v212, s[40:43], s19 offen lds
s_add_u32 m0, s18, 9216
s_add_u32 s19, s26, 184320
buffer_load_dwordx4 v212, s[40:43], s19 offen lds
s_add_u32 m0, s18, 10240
s_add_u32 s19, s26, 204800
buffer_load_dwordx4 v212, s[40:43], s19 offen lds
s_add_u32 m0, s18, 11264
s_add_u32 s19, s26, 225280
buffer_load_dwordx4 v212, s[40:43], s19 offen lds
s_add_u32 m0, s18, 12288
s_add_u32 s19, s26, 245760
buffer_load_dwordx4 v212, s[40:43], s19 offen lds
s_add_u32 m0, s18, 13312
s_add_u32 s19, s26, 266240
buffer_load_dwordx4 v212, s[40:43], s19 offen lds
s_add_u32 m0, s18, 14336
s_add_u32 s19, s26, 286720
buffer_load_dwordx4 v212, s[40:43], s19 offen lds
s_add_u32 m0, s18, 15360
s_add_u32 s19, s26, 307200
buffer_load_dwordx4 v212, s[40:43], s19 offen lds
s_add_u32 m0, s18, 16384
s_add_u32 s19, s26, 327680
buffer_load_dwordx4 v212, s[40:43], s19 offen lds
s_add_u32 m0, s18, 17408
s_add_u32 s19, s26, 348160
buffer_load_dwordx4 v212, s[40:43], s19 offen lds
s_add_u32 m0, s18, 18432
s_add_u32 s19, s26, 368640
buffer_load_dwordx4 v212, s[40:43], s19 offen lds
s_add_u32 m0, s18, 19456
s_add_u32 s19, s26, 389120
buffer_load_dwordx4 v212, s[40:43], s19 offen lds
s_add_u32 m0, s18, 20480
s_add_u32 s19, s26, 409600
buffer_load_dwordx4 v212, s[40:43], s19 offen lds
s_add_u32 m0, s18, 21504
s_add_u32 s19, s26, 430080
buffer_load_dwordx4 v212, s[40:43], s19 offen lds
s_add_u32 m0, s18, 22528
s_add_u32 s19, s26, 450560
buffer_load_dwordx4 v212, s[40:43], s19 offen lds
s_add_u32 m0, s18, 23552
s_add_u32 s19, s26, 471040
buffer_load_dwordx4 v212, s[40:43], s19 offen lds
s_add_u32 m0, s18, 24576
s_add_u32 s19, s26, 491520
buffer_load_dwordx4 v212, s[40:43], s19 offen lds
s_add_u32 m0, s18, 25600
s_add_u32 s19, s26, 512000
buffer_load_dwordx4 v212, s[40:43], s19 offen lds
s_add_u32 m0, s18, 26624
s_add_u32 s19, s26, 532480
buffer_load_dwordx4 v212, s[40:43], s19 offen lds
s_add_u32 m0, s18, 27648
s_add_u32 s19, s26, 552960
buffer_load_dwordx4 v212, s[40:43], s19 offen lds
s_add_u32 m0, s18, 28672
s_add_u32 s19, s26, 573440
buffer_load_dwordx4 v212, s[40:43], s19 offen lds
s_add_u32 m0, s18, 29696
s_add_u32 s19, s26, 593920
buffer_load_dwordx4 v212, s[40:43], s19 offen lds
s_add_u32 m0, s18, 30720
s_add_u32 s19, s26, 614400
buffer_load_dwordx4 v212, s[40:43], s19 offen lds
s_add_u32 m0, s18, 31744
s_add_u32 s19, s26, 634880
buffer_load_dwordx4 v212, s[40:43], s19 offen lds
s_add_u32 m0, s18, 32768
s_add_u32 s19, s26, 655360
buffer_load_dwordx4 v212, s[40:43], s19 offen lds
s_add_u32 m0, s18, 33792
s_add_u32 s19, s26, 675840
buffer_load_dwordx4 v212, s[40:43], s19 offen lds
s_add_u32 m0, s18, 34816
s_add_u32 s19, s26, 696320
buffer_load_dwordx4 v212, s[40:43], s19 offen lds
s_add_u32 m0, s18, 35840
s_add_u32 s19, s26, 716800
buffer_load_dwordx4 v212, s[40:43], s19 offen lds
s_waitcnt vmcnt(32)
ds_read_b64_tr_b16 a[0:1], v213 offset:0
ds_read_b64_tr_b16 a[2:3], v213 offset:256
ds_read_b64_tr_b16 a[4:5], v213 offset:1024
ds_read_b64_tr_b16 a[6:7], v213 offset:1280
ds_read_b64_tr_b16 a[8:9], v213 offset:2048
ds_read_b64_tr_b16 a[10:11], v213 offset:2304
ds_read_b64_tr_b16 a[12:13], v213 offset:3072
ds_read_b64_tr_b16 a[14:15], v213 offset:3328
s_waitcnt lgkmcnt(0)
s_add_u32 m0, s18, 0
s_add_u32 s19, s26, 737280
buffer_load_dwordx4 v212, s[40:43], s19 offen lds
s_add_u32 m0, s18, 1024
s_add_u32 s19, s26, 757760
buffer_load_dwordx4 v212, s[40:43], s19 offen lds
s_add_u32 m0, s18, 2048
s_add_u32 s19, s26, 778240
buffer_load_dwordx4 v212, s[40:43], s19 offen lds
s_add_u32 m0, s18, 3072
s_add_u32 s19, s26, 798720
buffer_load_dwordx4 v212, s[40:43], s19 offen lds
s_waitcnt vmcnt(32)
ds_read_b64_tr_b16 a[16:17], v213 offset:4096
ds_read_b64_tr_b16 a[18:19], v213 offset:4352
ds_read_b64_tr_b16 a[20:21], v213 offset:5120
ds_read_b64_tr_b16 a[22:23], v213 offset:5376
ds_read_b64_tr_b16 a[24:25], v213 offset:6144
ds_read_b64_tr_b16 a[26:27], v213 offset:6400
ds_read_b64_tr_b16 a[28:29], v213 offset:7168
ds_read_b64_tr_b16 a[30:31], v213 offset:7424
s_waitcnt lgkmcnt(0)
s_add_u32 m0, s18, 4096
s_add_u32 s19, s26, 819200
buffer_load_dwordx4 v212, s[40:43], s19 offen lds
s_add_u32 m0, s18, 5120
s_add_u32 s19, s26, 839680
buffer_load_dwordx4 v212, s[40:43], s19 offen lds
s_add_u32 m0, s18, 6144
s_add_u32 s19, s26, 860160
buffer_load_dwordx4 v212, s[40:43], s19 offen lds
s_add_u32 m0, s18, 7168
s_add_u32 s19, s26, 880640
buffer_load_dwordx4 v212, s[40:43], s19 offen lds
s_waitcnt vmcnt(32)
ds_read_b64_tr_b16 a[32:33], v213 offset:8192
ds_read_b64_tr_b16 a[34:35], v213 offset:8448
ds_read_b64_tr_b16 a[36:37], v213 offset:9216
ds_read_b64_tr_b16 a[38:39], v213 offset:9472
ds_read_b64_tr_b16 a[40:41], v213 offset:10240
ds_read_b64_tr_b16 a[42:43], v213 offset:10496
ds_read_b64_tr_b16 a[44:45], v213 offset:11264
ds_read_b64_tr_b16 a[46:47], v213 offset:11520
s_waitcnt lgkmcnt(0)
s_add_u32 m0, s18, 8192
s_add_u32 s19, s26, 901120
buffer_load_dwordx4 v212, s[40:43], s19 offen lds
s_add_u32 m0, s18, 9216
s_add_u32 s19, s26, 921600
buffer_load_dwordx4 v212, s[40:43], s19 offen lds
s_add_u32 m0, s18, 10240
s_add_u32 s19, s26, 942080
buffer_load_dwordx4 v212, s[40:43], s19 offen lds
s_add_u32 m0, s18, 11264
s_add_u32 s19, s26, 962560
buffer_load_dwordx4 v212, s[40:43], s19 offen lds
s_waitcnt vmcnt(32)
ds_read_b64_tr_b16 a[48:49], v213 offset:12288
ds_read_b64_tr_b16 a[50:51], v213 offset:12544
ds_read_b64_tr_b16 a[52:53], v213 offset:13312
ds_read_b64_tr_b16 a[54:55], v213 offset:13568
ds_read_b64_tr_b16 a[56:57], v213 offset:14336
ds_read_b64_tr_b16 a[58:59], v213 offset:14592
ds_read_b64_tr_b16 a[60:61], v213 offset:15360
ds_read_b64_tr_b16 a[62:63], v213 offset:15616
s_waitcnt lgkmcnt(0)
s_add_u32 m0, s18, 12288
s_add_u32 s19, s26, 983040
buffer_load_dwordx4 v212, s[40:43], s19 offen lds
s_add_u32 m0, s18, 13312
s_add_u32 s19, s26, 1003520
buffer_load_dwordx4 v212, s[40:43], s19 offen lds
s_add_u32 m0, s18, 14336
s_add_u32 s19, s26, 1024000
buffer_load_dwordx4 v212, s[40:43], s19 offen lds
s_add_u32 m0, s18, 15360
s_add_u32 s19, s26, 1044480
buffer_load_dwordx4 v212, s[40:43], s19 offen lds
s_waitcnt vmcnt(32)
ds_read_b64_tr_b16 a[64:65], v213 offset:16384
ds_read_b64_tr_b16 a[66:67], v213 offset:16640
ds_read_b64_tr_b16 a[68:69], v213 offset:17408
ds_read_b64_tr_b16 a[70:71], v213 offset:17664
ds_read_b64_tr_b16 a[72:73], v213 offset:18432
ds_read_b64_tr_b16 a[74:75], v213 offset:18688
ds_read_b64_tr_b16 a[76:77], v213 offset:19456
ds_read_b64_tr_b16 a[78:79], v213 offset:19712
s_waitcnt lgkmcnt(0)
s_add_u32 m0, s18, 16384
s_add_u32 s19, s26, 1064960
buffer_load_dwordx4 v212, s[40:43], s19 offen lds
s_add_u32 m0, s18, 17408
s_add_u32 s19, s26, 1085440
buffer_load_dwordx4 v212, s[40:43], s19 offen lds
s_add_u32 m0, s18, 18432
s_add_u32 s19, s26, 1105920
buffer_load_dwordx4 v212, s[40:43], s19 offen lds
s_add_u32 m0, s18, 19456
s_add_u32 s19, s26, 1126400
buffer_load_dwordx4 v212, s[40:43], s19 offen lds
s_waitcnt vmcnt(32)
ds_read_b64_tr_b16 a[80:81], v213 offset:20480
ds_read_b64_tr_b16 a[82:83], v213 offset:20736
ds_read_b64_tr_b16 a[84:85], v213 offset:21504
ds_read_b64_tr_b16 a[86:87], v213 offset:21760
ds_read_b64_tr_b16 a[88:89], v213 offset:22528
ds_read_b64_tr_b16 a[90:91], v213 offset:22784
ds_read_b64_tr_b16 a[92:93], v213 offset:23552
ds_read_b64_tr_b16 a[94:95], v213 offset:23808
s_waitcnt lgkmcnt(0)
s_add_u32 m0, s18, 20480
s_add_u32 s19, s26, 1146880
buffer_load_dwordx4 v212, s[40:43], s19 offen lds
s_add_u32 m0, s18, 21504
s_add_u32 s19, s26, 1167360
buffer_load_dwordx4 v212, s[40:43], s19 offen lds
s_add_u32 m0, s18, 22528
s_add_u32 s19, s26, 1187840
buffer_load_dwordx4 v212, s[40:43], s19 offen lds
s_add_u32 m0, s18, 23552
s_add_u32 s19, s26, 1208320
buffer_load_dwordx4 v212, s[40:43], s19 offen lds
s_waitcnt vmcnt(32)
ds_read_b64_tr_b16 a[96:97], v213 offset:24576
ds_read_b64_tr_b16 a[98:99], v213 offset:24832
ds_read_b64_tr_b16 a[100:101], v213 offset:25600
ds_read_b64_tr_b16 a[102:103], v213 offset:25856
ds_read_b64_tr_b16 a[104:105], v213 offset:26624
ds_read_b64_tr_b16 a[106:107], v213 offset:26880
ds_read_b64_tr_b16 a[108:109], v213 offset:27648
ds_read_b64_tr_b16 a[110:111], v213 offset:27904
s_waitcnt lgkmcnt(0)
s_add_u32 m0, s18, 24576
s_add_u32 s19, s26, 1228800
buffer_load_dwordx4 v212, s[40:43], s19 offen lds
s_add_u32 m0, s18, 25600
s_add_u32 s19, s26, 1249280
buffer_load_dwordx4 v212, s[40:43], s19 offen lds
s_add_u32 m0, s18, 26624
s_add_u32 s19, s26, 1269760
buffer_load_dwordx4 v212, s[40:43], s19 offen lds
s_add_u32 m0, s18, 27648
s_add_u32 s19, s26, 1290240
buffer_load_dwordx4 v212, s[40:43], s19 offen lds
s_waitcnt vmcnt(32)
ds_read_b64_tr_b16 a[112:113], v213 offset:28672
ds_read_b64_tr_b16 a[114:115], v213 offset:28928
ds_read_b64_tr_b16 a[116:117], v213 offset:29696
ds_read_b64_tr_b16 a[118:119], v213 offset:29952
ds_read_b64_tr_b16 a[120:121], v213 offset:30720
ds_read_b64_tr_b16 a[122:123], v213 offset:30976
ds_read_b64_tr_b16 a[124:125], v213 offset:31744
ds_read_b64_tr_b16 a[126:127], v213 offset:32000
s_waitcnt vmcnt(28)
ds_read_b64_tr_b16 a[128:129], v213 offset:32768
ds_read_b64_tr_b16 a[130:131], v213 offset:33024
ds_read_b64_tr_b16 a[132:133], v213 offset:33792
ds_read_b64_tr_b16 a[134:135], v213 offset:34048
ds_read_b64_tr_b16 a[136:137], v213 offset:34816
ds_read_b64_tr_b16 a[138:139], v213 offset:35072
ds_read_b64_tr_b16 a[140:141], v213 offset:35840
ds_read_b64_tr_b16 a[142:143], v213 offset:36096
s_waitcnt vmcnt(24)
ds_read_b64_tr_b16 a[144:145], v213 offset:0
ds_read_b64_tr_b16 a[146:147], v213 offset:256
ds_read_b64_tr_b16 a[148:149], v213 offset:1024
ds_read_b64_tr_b16 a[150:151], v213 offset:1280
ds_read_b64_tr_b16 a[152:153], v213 offset:2048
ds_read_b64_tr_b16 a[154:155], v213 offset:2304
ds_read_b64_tr_b16 a[156:157], v213 offset:3072
ds_read_b64_tr_b16 a[158:159], v213 offset:3328
s_waitcnt vmcnt(20)
ds_read_b64_tr_b16 a[160:161], v213 offset:4096
ds_read_b64_tr_b16 a[162:163], v213 offset:4352
ds_read_b64_tr_b16 a[164:165], v213 offset:5120
ds_read_b64_tr_b16 a[166:167], v213 offset:5376
ds_read_b64_tr_b16 a[168:169], v213 offset:6144
ds_read_b64_tr_b16 a[170:171], v213 offset:6400
ds_read_b64_tr_b16 a[172:173], v213 offset:7168
ds_read_b64_tr_b16 a[174:175], v213 offset:7424
s_waitcnt vmcnt(16)
ds_read_b64_tr_b16 a[176:177], v213 offset:8192
ds_read_b64_tr_b16 a[178:179], v213 offset:8448
ds_read_b64_tr_b16 a[180:181], v213 offset:9216
ds_read_b64_tr_b16 a[182:183], v213 offset:9472
ds_read_b64_tr_b16 a[184:185], v213 offset:10240
ds_read_b64_tr_b16 a[186:187], v213 offset:10496
ds_read_b64_tr_b16 a[188:189], v213 offset:11264
ds_read_b64_tr_b16 a[190:191], v213 offset:11520
s_waitcnt vmcnt(12)
ds_read_b64_tr_b16 a[192:193], v213 offset:12288
ds_read_b64_tr_b16 a[194:195], v213 offset:12544
ds_read_b64_tr_b16 a[196:197], v213 offset:13312
ds_read_b64_tr_b16 a[198:199], v213 offset:13568
ds_read_b64_tr_b16 a[200:201], v213 offset:14336
ds_read_b64_tr_b16 a[202:203], v213 offset:14592
ds_read_b64_tr_b16 a[204:205], v213 offset:15360
ds_read_b64_tr_b16 a[206:207], v213 offset:15616
s_waitcnt vmcnt(8)
ds_read_b64_tr_b16 a[208:209], v213 offset:16384
ds_read_b64_tr_b16 a[210:211], v213 offset:16640
ds_read_b64_tr_b16 a[212:213], v213 offset:17408
ds_read_b64_tr_b16 a[214:215], v213 offset:17664
ds_read_b64_tr_b16 a[216:217], v213 offset:18432
ds_read_b64_tr_b16 a[218:219], v213 offset:18688
ds_read_b64_tr_b16 a[220:221], v213 offset:19456
ds_read_b64_tr_b16 a[222:223], v213 offset:19712
s_waitcnt vmcnt(4)
ds_read_b64_tr_b16 a[224:225], v213 offset:20480
ds_read_b64_tr_b16 a[226:227], v213 offset:20736
ds_read_b64_tr_b16 a[228:229], v213 offset:21504
ds_read_b64_tr_b16 a[230:231], v213 offset:21760
ds_read_b64_tr_b16 a[232:233], v213 offset:22528
ds_read_b64_tr_b16 a[234:235], v213 offset:22784
ds_read_b64_tr_b16 a[236:237], v213 offset:23552
ds_read_b64_tr_b16 a[238:239], v213 offset:23808
s_waitcnt vmcnt(0)
ds_read_b64_tr_b16 a[240:241], v213 offset:24576
ds_read_b64_tr_b16 a[242:243], v213 offset:24832
ds_read_b64_tr_b16 a[244:245], v213 offset:25600
ds_read_b64_tr_b16 a[246:247], v213 offset:25856
ds_read_b64_tr_b16 a[248:249], v213 offset:26624
ds_read_b64_tr_b16 a[250:251], v213 offset:26880
ds_read_b64_tr_b16 a[252:253], v213 offset:27648
ds_read_b64_tr_b16 a[254:255], v213 offset:27904
s_waitcnt lgkmcnt(0)
s_barrier
ww_74:
s_load_dwordx2 s[56:57], s[0:1], 80
s_mov_b32 s58, 2621440
s_mov_b32 s59, 0x20000
s_waitcnt lgkmcnt(0)
s_lshl_b32 s18, s13, 12
v_add_u32 v13, s18, v0
s_lshl_b32 s18, s13, 11
v_add_u32 v14, s18, v0
s_add_u32 s53, s30, 56
s_cmp_eq_u32 s30, 3
s_cselect_b32 s30, s53, s30
ws_75:
s_lshl_b32 s18, s16, 6
s_add_u32 s18, s18, s30
s_lshl_b32 s26, s18, 18
s_lshl_b32 s19, s13, 16
s_add_u32 s26, s26, s19
s_add_u32 s26, s26, 127926272
s_add_u32 s38, s18, 1
s_and_b32 s18, s18, 7
s_lshl_b32 s18, s18, 12
s_add_u32 s18, s18, s37
s_add_u32 s28, s18, 11632640
s_mul_i32 s27, s30, 40960
s_and_b32 s18, s13, 1
s_lshl_b32 s19, s52, 1
s_add_u32 s29, s18, s19
v_lshlrev_b32 v3, 3, v0
v_min_u32 v12, 896, v3
s_mov_b32 s17, 0
poll_79:
buffer_load_dword v8, v12, s[4:7], s28 offen sc1
s_add_u32 s17, s17, 1
s_cmp_gt_u32 s17, 262144
s_cbranch_scc1 L_fail
s_waitcnt vmcnt(0)
v_cmp_gt_u32 vcc, s38, v8
s_cbranch_vccz polld_80
s_sleep 2
s_branch poll_79
polld_80:
s_lshl_b32 s18, s29, 10
s_add_u32 s18, s18, s27
s_mul_i32 s19, s16, 6291456
s_add_u32 s18, s18, s19
s_add_u32 s18, s18, 88080384
s_add_u32 s19, s26, 0
buffer_load_dwordx4 v[16:19], v0, s[4:7], s19 offen offset:0 sc1
buffer_load_dwordx4 v[20:23], v0, s[4:7], s19 offen offset:1024 sc1
buffer_load_dwordx4 v[24:27], v0, s[4:7], s19 offen offset:2048 sc1
buffer_load_dwordx4 v[28:31], v0, s[4:7], s19 offen offset:3072 sc1
s_add_u32 s19, s26, 4096
buffer_load_dwordx4 v[32:35], v0, s[4:7], s19 offen offset:0 sc1
buffer_load_dwordx4 v[36:39], v0, s[4:7], s19 offen offset:1024 sc1
buffer_load_dwordx4 v[40:43], v0, s[4:7], s19 offen offset:2048 sc1
buffer_load_dwordx4 v[44:47], v0, s[4:7], s19 offen offset:3072 sc1
s_add_u32 s19, s26, 8192
buffer_load_dwordx4 v[48:51], v0, s[4:7], s19 offen offset:0 sc1
buffer_load_dwordx4 v[52:55], v0, s[4:7], s19 offen offset:1024 sc1
buffer_load_dwordx4 v[56:59], v0, s[4:7], s19 offen offset:2048 sc1
buffer_load_dwordx4 v[60:63], v0, s[4:7], s19 offen offset:3072 sc1
s_add_u32 s19, s26, 12288
buffer_load_dwordx4 v[64:67], v0, s[4:7], s19 offen offset:0 sc1
buffer_load_dwordx4 v[68:71], v0, s[4:7], s19 offen offset:1024 sc1
buffer_load_dwordx4 v[72:75], v0, s[4:7], s19 offen offset:2048 sc1
buffer_load_dwordx4 v[76:79], v0, s[4:7], s19 offen offset:3072 sc1
s_add_u32 s19, s26, 16384
buffer_load_dwordx4 v[80:83], v0, s[4:7], s19 offen offset:0 sc1
buffer_load_dwordx4 v[84:87], v0, s[4:7], s19 offen offset:1024 sc1
buffer_load_dwordx4 v[88:91], v0, s[4:7], s19 offen offset:2048 sc1
buffer_load_dwordx4 v[92:95], v0, s[4:7], s19 offen offset:3072 sc1
s_add_u32 s19, s26, 20480
buffer_load_dwordx4 v[96:99], v0, s[4:7], s19 offen offset:0 sc1
buffer_load_dwordx4 v[100:103], v0, s[4:7], s19 offen offset:1024 sc1
buffer_load_dwordx4 v[104:107], v0, s[4:7], s19 offen offset:2048 sc1
buffer_load_dwordx4 v[108:111], v0, s[4:7], s19 offen offset:3072 sc1
s_add_u32 s19, s26, 24576
buffer_load_dwordx4 v[112:115], v0, s[4:7], s19 offen offset:0 sc1
buffer_load_dwordx4 v[116:119], v0, s[4:7], s19 offen offset:1024 sc1
buffer_load_dwordx4 v[120:123], v0, s[4:7], s19 offen offset:2048 sc1
buffer_load_dwordx4 v[124:127], v0, s[4:7], s19 offen offset:3072 sc1
s_add_u32 s19, s26, 28672
buffer_load_dwordx4 v[128:131], v0, s[4:7], s19 offen offset:0 sc1
buffer_load_dwordx4 v[132:135], v0, s[4:7], s19 offen offset:1024 sc1
buffer_load_dwordx4 v[136:139], v0, s[4:7], s19 offen offset:2048 sc1
buffer_load_dwordx4 v[140:143], v0, s[4:7], s19 offen offset:3072 sc1
s_add_u32 s19, s26, 32768
buffer_load_dwordx4 v[144:147], v0, s[4:7], s19 offen offset:0 sc1
buffer_load_dwordx4 v[148:151], v0, s[4:7], s19 offen offset:1024 sc1
buffer_load_dwordx4 v[152:155], v0, s[4:7], s19 offen offset:2048 sc1
buffer_load_dwordx4 v[156:159], v0, s[4:7], s19 offen offset:3072 sc1
s_add_u32 s19, s26, 36864
buffer_load_dwordx4 v[160:163], v0, s[4:7], s19 offen offset:0 sc1
buffer_load_dwordx4 v[164:167], v0, s[4:7], s19 offen offset:1024 sc1
buffer_load_dwordx4 v[168:171], v0, s[4:7], s19 offen offset:2048 sc1
buffer_load_dwordx4 v[172:175], v0, s[4:7], s19 offen offset:3072 sc1
s_add_u32 s19, s26, 40960
buffer_load_dwordx4 v[176:179], v0, s[4:7], s19 offen offset:0 sc1
buffer_load_dwordx4 v[180:183], v0, s[4:7], s19 offen offset:1024 sc1
buffer_load_dwordx4 v[184:187], v0, s[4:7], s19 offen offset:2048 sc1
buffer_load_dwordx4 v[188:191], v0, s[4:7], s19 offen offset:3072 sc1
s_waitcnt vmcnt(43)
v_mfma_f32_32x32x16_bf16 v[192:207], a[0:3], v[16:19], 0
s_add_u32 s19, s26, 45056
buffer_load_dwordx4 v[16:19], v0, s[4:7], s19 offen offset:0 sc1
s_waitcnt vmcnt(43)
v_mfma_f32_32x32x16_bf16 v[192:207], a[4:7], v[20:23], v[192:207]
buffer_load_dwordx4 v[20:23], v0, s[4:7], s19 offen offset:1024 sc1
s_waitcnt vmcnt(43)
v_mfma_f32_32x32x16_bf16 v[192:207], a[8:11], v[24:27], v[192:207]
buffer_load_dwordx4 v[24:27], v0, s[4:7], s19 offen offset:2048 sc1
s_waitcnt vmcnt(43)
v_mfma_f32_32x32x16_bf16 v[192:207], a[12:15], v[28:31], v[192:207]
buffer_load_dwordx4 v[28:31], v0, s[4:7], s19 offen offset:3072 sc1
s_waitcnt vmcnt(43)
v_mfma_f32_32x32x16_bf16 v[192:207], a[16:19], v[32:35], v[192:207]
s_add_u32 s19, s26, 49152
buffer_load_dwordx4 v[32:35], v0, s[4:7], s19 offen offset:0 sc1
s_waitcnt vmcnt(43)
v_mfma_f32_32x32x16_bf16 v[192:207], a[20:23], v[36:39], v[192:207]
buffer_load_dwordx4 v[36:39], v0, s[4:7], s19 offen offset:1024 sc1
s_waitcnt vmcnt(43)
v_mfma_f32_32x32x16_bf16 v[192:207], a[24:27], v[40:43], v[192:207]
buffer_load_dwordx4 v[40:43], v0, s[4:7], s19 offen offset:2048 sc1
s_waitcnt vmcnt(43)
v_mfma_f32_32x32x16_bf16 v[192:207], a[28:31], v[44:47], v[192:207]
buffer_load_dwordx4 v[44:47], v0, s[4:7], s19 offen offset:3072 sc1
s_waitcnt vmcnt(43)
v_mfma_f32_32x32x16_bf16 v[192:207], a[32:35], v[48:51], v[192:207]
s_add_u32 s19, s26, 53248
buffer_load_dwordx4 v[48:51], v0, s[4:7], s19 offen offset:0 sc1
s_waitcnt vmcnt(43)
v_mfma_f32_32x32x16_bf16 v[192:207], a[36:39], v[52:55], v[192:207]
buffer_load_dwordx4 v[52:55], v0, s[4:7], s19 offen offset:1024 sc1
s_waitcnt vmcnt(43)
v_mfma_f32_32x32x16_bf16 v[192:207], a[40:43], v[56:59], v[192:207]
buffer_load_dwordx4 v[56:59], v0, s[4:7], s19 offen offset:2048 sc1
s_waitcnt vmcnt(43)
v_mfma_f32_32x32x16_bf16 v[192:207], a[44:47], v[60:63], v[192:207]
buffer_load_dwordx4 v[60:63], v0, s[4:7], s19 offen offset:3072 sc1
s_waitcnt vmcnt(43)
v_mfma_f32_32x32x16_bf16 v[192:207], a[48:51], v[64:67], v[192:207]
s_add_u32 s19, s26, 57344
buffer_load_dwordx4 v[64:67], v0, s[4:7], s19 offen offset:0 sc1
s_waitcnt vmcnt(43)
v_mfma_f32_32x32x16_bf16 v[192:207], a[52:55], v[68:71], v[192:207]
buffer_load_dwordx4 v[68:71], v0, s[4:7], s19 offen offset:1024 sc1
s_waitcnt vmcnt(43)
v_mfma_f32_32x32x16_bf16 v[192:207], a[56:59], v[72:75], v[192:207]
buffer_load_dwordx4 v[72:75], v0, s[4:7], s19 offen offset:2048 sc1
s_waitcnt vmcnt(43)
v_mfma_f32_32x32x16_bf16 v[192:207], a[60:63], v[76:79], v[192:207]
buffer_load_dwordx4 v[76:79], v0, s[4:7], s19 offen offset:3072 sc1
s_waitcnt vmcnt(43)
v_mfma_f32_32x32x16_bf16 v[192:207], a[64:67], v[80:83], v[192:207]
s_add_u32 s19, s26, 61440
buffer_load_dwordx4 v[80:83], v0, s[4:7], s19 offen offset:0 sc1
s_waitcnt vmcnt(43)
v_mfma_f32_32x32x16_bf16 v[192:207], a[68:71], v[84:87], v[192:207]
buffer_load_dwordx4 v[84:87], v0, s[4:7], s19 offen offset:1024 sc1
s_waitcnt vmcnt(43)
v_mfma_f32_32x32x16_bf16 v[192:207], a[72:75], v[88:91], v[192:207]
buffer_load_dwordx4 v[88:91], v0, s[4:7], s19 offen offset:2048 sc1
s_waitcnt vmcnt(43)
v_mfma_f32_32x32x16_bf16 v[192:207], a[76:79], v[92:95], v[192:207]
buffer_load_dwordx4 v[92:95], v0, s[4:7], s19 offen offset:3072 sc1
s_waitcnt vmcnt(43)
v_mfma_f32_32x32x16_bf16 v[192:207], a[80:83], v[96:99], v[192:207]
buffer_load_dwordx4 v[208:211], v0, s[4:7], s18 offen sc1
s_waitcnt vmcnt(43)
v_mfma_f32_32x32x16_bf16 v[192:207], a[84:87], v[100:103], v[192:207]
s_waitcnt vmcnt(42)
v_mfma_f32_32x32x16_bf16 v[192:207], a[88:91], v[104:107], v[192:207]
s_waitcnt vmcnt(41)
v_mfma_f32_32x32x16_bf16 v[192:207], a[92:95], v[108:111], v[192:207]
s_waitcnt vmcnt(40)
v_mfma_f32_32x32x16_bf16 v[192:207], a[96:99], v[112:115], v[192:207]
s_waitcnt vmcnt(39)
v_mfma_f32_32x32x16_bf16 v[192:207], a[100:103], v[116:119], v[192:207]
s_waitcnt vmcnt(38)
v_mfma_f32_32x32x16_bf16 v[192:207], a[104:107], v[120:123], v[192:207]
s_waitcnt vmcnt(37)
v_mfma_f32_32x32x16_bf16 v[192:207], a[108:111], v[124:127], v[192:207]
s_waitcnt vmcnt(36)
v_mfma_f32_32x32x16_bf16 v[192:207], a[112:115], v[128:131], v[192:207]
s_waitcnt vmcnt(35)
v_mfma_f32_32x32x16_bf16 v[192:207], a[116:119], v[132:135], v[192:207]
s_waitcnt vmcnt(34)
v_mfma_f32_32x32x16_bf16 v[192:207], a[120:123], v[136:139], v[192:207]
s_waitcnt vmcnt(33)
v_mfma_f32_32x32x16_bf16 v[192:207], a[124:127], v[140:143], v[192:207]
s_waitcnt vmcnt(32)
v_mfma_f32_32x32x16_bf16 v[192:207], a[128:131], v[144:147], v[192:207]
s_waitcnt vmcnt(31)
v_mfma_f32_32x32x16_bf16 v[192:207], a[132:135], v[148:151], v[192:207]
s_waitcnt vmcnt(30)
v_mfma_f32_32x32x16_bf16 v[192:207], a[136:139], v[152:155], v[192:207]
s_waitcnt vmcnt(29)
v_mfma_f32_32x32x16_bf16 v[192:207], a[140:143], v[156:159], v[192:207]
s_waitcnt vmcnt(28)
v_mfma_f32_32x32x16_bf16 v[192:207], a[144:147], v[160:163], v[192:207]
s_waitcnt vmcnt(27)
v_mfma_f32_32x32x16_bf16 v[192:207], a[148:151], v[164:167], v[192:207]
s_waitcnt vmcnt(26)
v_mfma_f32_32x32x16_bf16 v[192:207], a[152:155], v[168:171], v[192:207]
s_waitcnt vmcnt(25)
v_mfma_f32_32x32x16_bf16 v[192:207], a[156:159], v[172:175], v[192:207]
s_waitcnt vmcnt(24)
v_mfma_f32_32x32x16_bf16 v[192:207], a[160:163], v[176:179], v[192:207]
s_waitcnt vmcnt(23)
v_mfma_f32_32x32x16_bf16 v[192:207], a[164:167], v[180:183], v[192:207]
s_waitcnt vmcnt(22)
v_mfma_f32_32x32x16_bf16 v[192:207], a[168:171], v[184:187], v[192:207]
s_waitcnt vmcnt(21)
v_mfma_f32_32x32x16_bf16 v[192:207], a[172:175], v[188:191], v[192:207]
s_waitcnt vmcnt(20)
v_mfma_f32_32x32x16_bf16 v[192:207], a[176:179], v[16:19], v[192:207]
s_waitcnt vmcnt(19)
v_mfma_f32_32x32x16_bf16 v[192:207], a[180:183], v[20:23], v[192:207]
s_waitcnt vmcnt(18)
v_mfma_f32_32x32x16_bf16 v[192:207], a[184:187], v[24:27], v[192:207]
s_waitcnt vmcnt(17)
v_mfma_f32_32x32x16_bf16 v[192:207], a[188:191], v[28:31], v[192:207]
s_waitcnt vmcnt(16)
v_mfma_f32_32x32x16_bf16 v[192:207], a[192:195], v[32:35], v[192:207]
s_waitcnt vmcnt(15)
v_mfma_f32_32x32x16_bf16 v[192:207], a[196:199], v[36:39], v[192:207]
s_waitcnt vmcnt(14)
v_mfma_f32_32x32x16_bf16 v[192:207], a[200:203], v[40:43], v[192:207]
s_waitcnt vmcnt(13)
v_mfma_f32_32x32x16_bf16 v[192:207], a[204:207], v[44:47], v[192:207]
s_waitcnt vmcnt(12)
v_mfma_f32_32x32x16_bf16 v[192:207], a[208:211], v[48:51], v[192:207]
s_waitcnt vmcnt(11)
v_mfma_f32_32x32x16_bf16 v[192:207], a[212:215], v[52:55], v[192:207]
s_waitcnt vmcnt(10)
v_mfma_f32_32x32x16_bf16 v[192:207], a[216:219], v[56:59], v[192:207]
s_waitcnt vmcnt(9)
v_mfma_f32_32x32x16_bf16 v[192:207], a[220:223], v[60:63], v[192:207]
s_waitcnt vmcnt(8)
v_mfma_f32_32x32x16_bf16 v[192:207], a[224:227], v[64:67], v[192:207]
s_waitcnt vmcnt(7)
v_mfma_f32_32x32x16_bf16 v[192:207], a[228:231], v[68:71], v[192:207]
s_waitcnt vmcnt(6)
v_mfma_f32_32x32x16_bf16 v[192:207], a[232:235], v[72:75], v[192:207]
s_waitcnt vmcnt(5)
v_mfma_f32_32x32x16_bf16 v[192:207], a[236:239], v[76:79], v[192:207]
s_waitcnt vmcnt(4)
v_mfma_f32_32x32x16_bf16 v[192:207], a[240:243], v[80:83], v[192:207]
s_waitcnt vmcnt(3)
v_mfma_f32_32x32x16_bf16 v[192:207], a[244:247], v[84:87], v[192:207]
s_waitcnt vmcnt(2)
v_mfma_f32_32x32x16_bf16 v[192:207], a[248:251], v[88:91], v[192:207]
s_waitcnt vmcnt(1)
v_mfma_f32_32x32x16_bf16 v[192:207], a[252:255], v[92:95], v[192:207]
s_nop 11
ds_write_b128 v13, v[192:195] offset:0
ds_write_b128 v13, v[196:199] offset:1024
ds_write_b128 v13, v[200:203] offset:2048
ds_write_b128 v13, v[204:207] offset:3072
s_waitcnt lgkmcnt(0)
s_barrier
s_cmp_ge_u32 s13, 2
s_cbranch_scc1 wn_76
ds_read_b128 v[16:19], v14 offset:0
ds_read_b128 v[20:23], v14 offset:1024
ds_read_b128 v[24:27], v14 offset:4096
ds_read_b128 v[28:31], v14 offset:5120
ds_read_b128 v[32:35], v14 offset:8192
ds_read_b128 v[36:39], v14 offset:9216
ds_read_b128 v[40:43], v14 offset:12288
ds_read_b128 v[44:47], v14 offset:13312
s_waitcnt vmcnt(0)
v_lshlrev_b32 v192, 16, v208
v_and_b32 v193, 0xffff0000, v208
v_lshlrev_b32 v194, 16, v209
v_and_b32 v195, 0xffff0000, v209
v_lshlrev_b32 v196, 16, v210
v_and_b32 v197, 0xffff0000, v210
v_lshlrev_b32 v198, 16, v211
v_and_b32 v199, 0xffff0000, v211
s_waitcnt lgkmcnt(5)
v_add_f32 v16, v16, v24
s_waitcnt lgkmcnt(1)
v_add_f32 v32, v32, v40
v_add_f32 v17, v17, v25
v_add_f32 v33, v33, v41
v_add_f32 v18, v18, v26
v_add_f32 v34, v34, v42
v_add_f32 v19, v19, v27
v_add_f32 v35, v35, v43
v_add_f32 v20, v20, v28
s_waitcnt lgkmcnt(0)
v_add_f32 v36, v36, v44
v_add_f32 v21, v21, v29
v_add_f32 v37, v37, v45
v_add_f32 v22, v22, v30
v_add_f32 v38, v38, v46
v_add_f32 v23, v23, v31
v_add_f32 v39, v39, v47
v_add_f32 v16, v16, v32
v_add_f32 v17, v17, v33
v_add_f32 v18, v18, v34
v_add_f32 v19, v19, v35
v_add_f32 v20, v20, v36
v_add_f32 v21, v21, v37
v_add_f32 v22, v22, v38
v_add_f32 v23, v23, v39
v_add_f32 v16, v16, v192
v_add_f32 v17, v17, v193
v_add_f32 v18, v18, v194
v_add_f32 v19, v19, v195
v_add_f32 v20, v20, v196
v_add_f32 v21, v21, v197
v_add_f32 v22, v22, v198
v_add_f32 v23, v23, v199
v_cvt_pk_bf16_f32 v208, v16, v17
v_cvt_pk_bf16_f32 v209, v18, v19
v_cvt_pk_bf16_f32 v210, v20, v21
v_cvt_pk_bf16_f32 v211, v22, v23
s_cmp_lg_u32 s16, 0
s_cbranch_scc1 wo_77
s_add_u32 s18, s18, 3145728
buffer_store_dwordx4 v[208:211], v0, s[4:7], s18 offen sc1
s_branch wn_76
wo_77:
s_lshl_b32 s18, s29, 5
s_add_u32 s18, s18, s27
buffer_store_dwordx4 v[208:211], v5, s[56:59], s18 offen
wn_76:
s_lshl_b32 s18, s39, 7
s_add_u32 s18, s18, 11657216
s_cmp_eq_u32 s13, 0
s_cselect_b32 s22, s18, s6
s_mov_b32 s23, s38
s_waitcnt vmcnt(0)
s_barrier
v_mov_b32 v3, s23
s_mov_b64 exec, 1
buffer_store_dword v3, off, s[4:7], s22 sc1
s_mov_b64 exec, -1
s_mov_b32 s22, s6
s_add_u32 s18, s30, 3
s_cmp_lt_u32 s18, 56
s_cselect_b32 s18, s18, s53
s_add_u32 s19, s30, 4
s_cmp_lt_u32 s30, 56
s_cselect_b32 s30, s18, s19
s_cmp_lt_u32 s30, 64
s_cbranch_scc1 ws_75
s_branch aend_64
p1b_63:
s_cmp_eq_u32 s39, 144
s_cbranch_scc1 aend_64
s_cmp_lg_u32 s16, 0
s_cbranch_scc1 aend_64
s_sub_u32 s30, s50, 29
s_sub_u32 s51, s39, 145
s_lshl_b32 s18, s34, 7
s_lshl_b32 s19, s13, 5
s_add_u32 s18, s18, s19
s_mov_b32 s19, 0x3acccccd
v_bfe_u32 v198, v0, 4, 5
v_lshrrev_b32 v193, 9, v0
v_add_u32 v198, s18, v198
v_and_b32 v197, 1, v198
v_mul_u32_u24 v197, 160, v197
v_lshrrev_b32 v196, 1, v198
v_add_u32 v196, 1, v196
v_lshlrev_b32 v193, 3, v193
v_mad_u32_u24 v197, v193, v196, v197
v_mad_u32_u24 v192, v196, 16, 0
v_cvt_f32_u32 v192, v192
v_mul_f32 v198, s19, v192
v_rndne_f32 v198, v198
v_fmac_f32 v192, 0xc4200000, v198
v_mul_f32 v192, s19, v192
v_cos_f32 v192, v192
s_nop 0
v_add_f32 v192, v192, v192
v_mad_u32_u24 v194, v196, 1, 0
v_cvt_f32_u32 v194, v194
v_mul_f32 v198, s19, v194
v_rndne_f32 v198, v198
v_fmac_f32 v194, 0xc4200000, v198
v_mul_f32 v194, s19, v194
v_cos_f32 v194, v194
s_nop 0
v_add_f32 v194, v194, v194
v_mad_u32_u24 v179, v196, 3, v197
v_cvt_f32_u32 v179, v179
v_mul_f32 v198, s19, v179
v_rndne_f32 v198, v198
v_fmac_f32 v179, 0xc4200000, v198
v_mul_f32 v179, s19, v179
v_cos_f32 v179, v179
v_mad_u32_u24 v180, v196, 4, v197
v_cvt_f32_u32 v180, v180
v_mul_f32 v198, s19, v180
v_rndne_f32 v198, v198
v_fmac_f32 v180, 0xc4200000, v198
v_mul_f32 v180, s19, v180
v_cos_f32 v180, v180
s_nop 0
v_fma_f32 v181, v194, v180, -v179
v_fma_f32 v178, v194, v179, -v180
v_fma_f32 v182, v194, v181, -v180
v_fma_f32 v177, v194, v178, -v179
v_fma_f32 v183, v194, v182, -v181
v_fma_f32 v176, v194, v177, -v178
v_cvt_pk_bf16_f32 v16, v176, v177
v_cvt_pk_bf16_f32 v17, v178, v179
v_cvt_pk_bf16_f32 v18, v180, v181
v_cvt_pk_bf16_f32 v19, v182, v183
v_mad_u32_u24 v187, v196, 19, v197
v_cvt_f32_u32 v187, v187
v_mul_f32 v198, s19, v187
v_rndne_f32 v198, v198
v_fmac_f32 v187, 0xc4200000, v198
v_mul_f32 v187, s19, v187
v_cos_f32 v187, v187
v_mad_u32_u24 v188, v196, 20, v197
v_cvt_f32_u32 v188, v188
v_mul_f32 v198, s19, v188
v_rndne_f32 v198, v198
v_fmac_f32 v188, 0xc4200000, v198
v_mul_f32 v188, s19, v188
v_cos_f32 v188, v188
s_nop 0
v_fma_f32 v189, v194, v188, -v187
v_fma_f32 v186, v194, v187, -v188
v_fma_f32 v190, v194, v189, -v188
v_fma_f32 v185, v194, v186, -v187
v_fma_f32 v191, v194, v190, -v189
v_fma_f32 v184, v194, v185, -v186
v_cvt_pk_bf16_f32 v20, v184, v185
v_cvt_pk_bf16_f32 v21, v186, v187
v_cvt_pk_bf16_f32 v22, v188, v189
v_cvt_pk_bf16_f32 v23, v190, v191
v_pk_fma_f32 v[176:177], v[192:193], v[184:185], v[176:177] op_sel_hi:[0,1,1] neg_lo:[0,0,1] neg_hi:[0,0,1]
v_pk_fma_f32 v[178:179], v[192:193], v[186:187], v[178:179] op_sel_hi:[0,1,1] neg_lo:[0,0,1] neg_hi:[0,0,1]
v_pk_fma_f32 v[180:181], v[192:193], v[188:189], v[180:181] op_sel_hi:[0,1,1] neg_lo:[0,0,1] neg_hi:[0,0,1]
v_pk_fma_f32 v[182:183], v[192:193], v[190:191], v[182:183] op_sel_hi:[0,1,1] neg_lo:[0,0,1] neg_hi:[0,0,1]
v_cvt_pk_bf16_f32 v24, v176, v177
v_cvt_pk_bf16_f32 v25, v178, v179
v_cvt_pk_bf16_f32 v26, v180, v181
v_cvt_pk_bf16_f32 v27, v182, v183
v_pk_fma_f32 v[184:185], v[192:193], v[176:177], v[184:185] op_sel_hi:[0,1,1] neg_lo:[0,0,1] neg_hi:[0,0,1]
v_pk_fma_f32 v[186:187], v[192:193], v[178:179], v[186:187] op_sel_hi:[0,1,1] neg_lo:[0,0,1] neg_hi:[0,0,1]
v_pk_fma_f32 v[188:189], v[192:193], v[180:181], v[188:189] op_sel_hi:[0,1,1] neg_lo:[0,0,1] neg_hi:[0,0,1]
v_pk_fma_f32 v[190:191], v[192:193], v[182:183], v[190:191] op_sel_hi:[0,1,1] neg_lo:[0,0,1] neg_hi:[0,0,1]
v_cvt_pk_bf16_f32 v28, v184, v185
v_cvt_pk_bf16_f32 v29, v186, v187
v_cvt_pk_bf16_f32 v30, v188, v189
v_cvt_pk_bf16_f32 v31, v190, v191
v_pk_fma_f32 v[176:177], v[192:193], v[184:185], v[176:177] op_sel_hi:[0,1,1] neg_lo:[0,0,1] neg_hi:[0,0,1]
v_pk_fma_f32 v[178:179], v[192:193], v[186:187], v[178:179] op_sel_hi:[0,1,1] neg_lo:[0,0,1] neg_hi:[0,0,1]
v_pk_fma_f32 v[180:181], v[192:193], v[188:189], v[180:181] op_sel_hi:[0,1,1] neg_lo:[0,0,1] neg_hi:[0,0,1]
v_pk_fma_f32 v[182:183], v[192:193], v[190:191], v[182:183] op_sel_hi:[0,1,1] neg_lo:[0,0,1] neg_hi:[0,0,1]
v_cvt_pk_bf16_f32 v32, v176, v177
v_cvt_pk_bf16_f32 v33, v178, v179
v_cvt_pk_bf16_f32 v34, v180, v181
v_cvt_pk_bf16_f32 v35, v182, v183
v_pk_fma_f32 v[184:185], v[192:193], v[176:177], v[184:185] op_sel_hi:[0,1,1] neg_lo:[0,0,1] neg_hi:[0,0,1]
v_pk_fma_f32 v[186:187], v[192:193], v[178:179], v[186:187] op_sel_hi:[0,1,1] neg_lo:[0,0,1] neg_hi:[0,0,1]
v_pk_fma_f32 v[188:189], v[192:193], v[180:181], v[188:189] op_sel_hi:[0,1,1] neg_lo:[0,0,1] neg_hi:[0,0,1]
v_pk_fma_f32 v[190:191], v[192:193], v[182:183], v[190:191] op_sel_hi:[0,1,1] neg_lo:[0,0,1] neg_hi:[0,0,1]
v_cvt_pk_bf16_f32 v36, v184, v185
v_cvt_pk_bf16_f32 v37, v186, v187
v_cvt_pk_bf16_f32 v38, v188, v189
v_cvt_pk_bf16_f32 v39, v190, v191
v_pk_fma_f32 v[176:177], v[192:193], v[184:185], v[176:177] op_sel_hi:[0,1,1] neg_lo:[0,0,1] neg_hi:[0,0,1]
v_pk_fma_f32 v[178:179], v[192:193], v[186:187], v[178:179] op_sel_hi:[0,1,1] neg_lo:[0,0,1] neg_hi:[0,0,1]
v_pk_fma_f32 v[180:181], v[192:193], v[188:189], v[180:181] op_sel_hi:[0,1,1] neg_lo:[0,0,1] neg_hi:[0,0,1]
v_pk_fma_f32 v[182:183], v[192:193], v[190:191], v[182:183] op_sel_hi:[0,1,1] neg_lo:[0,0,1] neg_hi:[0,0,1]
v_cvt_pk_bf16_f32 v40, v176, v177
v_cvt_pk_bf16_f32 v41, v178, v179
v_cvt_pk_bf16_f32 v42, v180, v181
v_cvt_pk_bf16_f32 v43, v182, v183
v_pk_fma_f32 v[184:185], v[192:193], v[176:177], v[184:185] op_sel_hi:[0,1,1] neg_lo:[0,0,1] neg_hi:[0,0,1]
v_pk_fma_f32 v[186:187], v[192:193], v[178:179], v[186:187] op_sel_hi:[0,1,1] neg_lo:[0,0,1] neg_hi:[0,0,1]
v_pk_fma_f32 v[188:189], v[192:193], v[180:181], v[188:189] op_sel_hi:[0,1,1] neg_lo:[0,0,1] neg_hi:[0,0,1]
v_pk_fma_f32 v[190:191], v[192:193], v[182:183], v[190:191] op_sel_hi:[0,1,1] neg_lo:[0,0,1] neg_hi:[0,0,1]
v_cvt_pk_bf16_f32 v44, v184, v185
v_cvt_pk_bf16_f32 v45, v186, v187
v_cvt_pk_bf16_f32 v46, v188, v189
v_cvt_pk_bf16_f32 v47, v190, v191
v_pk_fma_f32 v[176:177], v[192:193], v[184:185], v[176:177] op_sel_hi:[0,1,1] neg_lo:[0,0,1] neg_hi:[0,0,1]
v_pk_fma_f32 v[178:179], v[192:193], v[186:187], v[178:179] op_sel_hi:[0,1,1] neg_lo:[0,0,1] neg_hi:[0,0,1]
v_pk_fma_f32 v[180:181], v[192:193], v[188:189], v[180:181] op_sel_hi:[0,1,1] neg_lo:[0,0,1] neg_hi:[0,0,1]
v_pk_fma_f32 v[182:183], v[192:193], v[190:191], v[182:183] op_sel_hi:[0,1,1] neg_lo:[0,0,1] neg_hi:[0,0,1]
v_cvt_pk_bf16_f32 v48, v176, v177
v_cvt_pk_bf16_f32 v49, v178, v179
v_cvt_pk_bf16_f32 v50, v180, v181
v_cvt_pk_bf16_f32 v51, v182, v183
v_pk_fma_f32 v[184:185], v[192:193], v[176:177], v[184:185] op_sel_hi:[0,1,1] neg_lo:[0,0,1] neg_hi:[0,0,1]
v_pk_fma_f32 v[186:187], v[192:193], v[178:179], v[186:187] op_sel_hi:[0,1,1] neg_lo:[0,0,1] neg_hi:[0,0,1]
v_pk_fma_f32 v[188:189], v[192:193], v[180:181], v[188:189] op_sel_hi:[0,1,1] neg_lo:[0,0,1] neg_hi:[0,0,1]
v_pk_fma_f32 v[190:191], v[192:193], v[182:183], v[190:191] op_sel_hi:[0,1,1] neg_lo:[0,0,1] neg_hi:[0,0,1]
v_cvt_pk_bf16_f32 v52, v184, v185
v_cvt_pk_bf16_f32 v53, v186, v187
v_cvt_pk_bf16_f32 v54, v188, v189
v_cvt_pk_bf16_f32 v55, v190, v191
v_pk_fma_f32 v[176:177], v[192:193], v[184:185], v[176:177] op_sel_hi:[0,1,1] neg_lo:[0,0,1] neg_hi:[0,0,1]
v_pk_fma_f32 v[178:179], v[192:193], v[186:187], v[178:179] op_sel_hi:[0,1,1] neg_lo:[0,0,1] neg_hi:[0,0,1]
v_pk_fma_f32 v[180:181], v[192:193], v[188:189], v[180:181] op_sel_hi:[0,1,1] neg_lo:[0,0,1] neg_hi:[0,0,1]
v_pk_fma_f32 v[182:183], v[192:193], v[190:191], v[182:183] op_sel_hi:[0,1,1] neg_lo:[0,0,1] neg_hi:[0,0,1]
v_cvt_pk_bf16_f32 v56, v176, v177
v_cvt_pk_bf16_f32 v57, v178, v179
v_cvt_pk_bf16_f32 v58, v180, v181
v_cvt_pk_bf16_f32 v59, v182, v183
v_pk_fma_f32 v[184:185], v[192:193], v[176:177], v[184:185] op_sel_hi:[0,1,1] neg_lo:[0,0,1] neg_hi:[0,0,1]
v_pk_fma_f32 v[186:187], v[192:193], v[178:179], v[186:187] op_sel_hi:[0,1,1] neg_lo:[0,0,1] neg_hi:[0,0,1]
v_pk_fma_f32 v[188:189], v[192:193], v[180:181], v[188:189] op_sel_hi:[0,1,1] neg_lo:[0,0,1] neg_hi:[0,0,1]
v_pk_fma_f32 v[190:191], v[192:193], v[182:183], v[190:191] op_sel_hi:[0,1,1] neg_lo:[0,0,1] neg_hi:[0,0,1]
v_cvt_pk_bf16_f32 v60, v184, v185
v_cvt_pk_bf16_f32 v61, v186, v187
v_cvt_pk_bf16_f32 v62, v188, v189
v_cvt_pk_bf16_f32 v63, v190, v191
v_pk_fma_f32 v[176:177], v[192:193], v[184:185], v[176:177] op_sel_hi:[0,1,1] neg_lo:[0,0,1] neg_hi:[0,0,1]
v_pk_fma_f32 v[178:179], v[192:193], v[186:187], v[178:179] op_sel_hi:[0,1,1] neg_lo:[0,0,1] neg_hi:[0,0,1]
v_pk_fma_f32 v[180:181], v[192:193], v[188:189], v[180:181] op_sel_hi:[0,1,1] neg_lo:[0,0,1] neg_hi:[0,0,1]
v_pk_fma_f32 v[182:183], v[192:193], v[190:191], v[182:183] op_sel_hi:[0,1,1] neg_lo:[0,0,1] neg_hi:[0,0,1]
v_cvt_pk_bf16_f32 v64, v176, v177
v_cvt_pk_bf16_f32 v65, v178, v179
v_cvt_pk_bf16_f32 v66, v180, v181
v_cvt_pk_bf16_f32 v67, v182, v183
v_pk_fma_f32 v[184:185], v[192:193], v[176:177], v[184:185] op_sel_hi:[0,1,1] neg_lo:[0,0,1] neg_hi:[0,0,1]
v_pk_fma_f32 v[186:187], v[192:193], v[178:179], v[186:187] op_sel_hi:[0,1,1] neg_lo:[0,0,1] neg_hi:[0,0,1]
v_pk_fma_f32 v[188:189], v[192:193], v[180:181], v[188:189] op_sel_hi:[0,1,1] neg_lo:[0,0,1] neg_hi:[0,0,1]
v_pk_fma_f32 v[190:191], v[192:193], v[182:183], v[190:191] op_sel_hi:[0,1,1] neg_lo:[0,0,1] neg_hi:[0,0,1]
v_cvt_pk_bf16_f32 v68, v184, v185
v_cvt_pk_bf16_f32 v69, v186, v187
v_cvt_pk_bf16_f32 v70, v188, v189
v_cvt_pk_bf16_f32 v71, v190, v191
v_pk_fma_f32 v[176:177], v[192:193], v[184:185], v[176:177] op_sel_hi:[0,1,1] neg_lo:[0,0,1] neg_hi:[0,0,1]
v_pk_fma_f32 v[178:179], v[192:193], v[186:187], v[178:179] op_sel_hi:[0,1,1] neg_lo:[0,0,1] neg_hi:[0,0,1]
v_pk_fma_f32 v[180:181], v[192:193], v[188:189], v[180:181] op_sel_hi:[0,1,1] neg_lo:[0,0,1] neg_hi:[0,0,1]
v_pk_fma_f32 v[182:183], v[192:193], v[190:191], v[182:183] op_sel_hi:[0,1,1] neg_lo:[0,0,1] neg_hi:[0,0,1]
v_cvt_pk_bf16_f32 v72, v176, v177
v_cvt_pk_bf16_f32 v73, v178, v179
v_cvt_pk_bf16_f32 v74, v180, v181
v_cvt_pk_bf16_f32 v75, v182, v183
v_pk_fma_f32 v[184:185], v[192:193], v[176:177], v[184:185] op_sel_hi:[0,1,1] neg_lo:[0,0,1] neg_hi:[0,0,1]
v_pk_fma_f32 v[186:187], v[192:193], v[178:179], v[186:187] op_sel_hi:[0,1,1] neg_lo:[0,0,1] neg_hi:[0,0,1]
v_pk_fma_f32 v[188:189], v[192:193], v[180:181], v[188:189] op_sel_hi:[0,1,1] neg_lo:[0,0,1] neg_hi:[0,0,1]
v_pk_fma_f32 v[190:191], v[192:193], v[182:183], v[190:191] op_sel_hi:[0,1,1] neg_lo:[0,0,1] neg_hi:[0,0,1]
v_cvt_pk_bf16_f32 v76, v184, v185
v_cvt_pk_bf16_f32 v77, v186, v187
v_cvt_pk_bf16_f32 v78, v188, v189
v_cvt_pk_bf16_f32 v79, v190, v191
v_pk_fma_f32 v[176:177], v[192:193], v[184:185], v[176:177] op_sel_hi:[0,1,1] neg_lo:[0,0,1] neg_hi:[0,0,1]
v_pk_fma_f32 v[178:179], v[192:193], v[186:187], v[178:179] op_sel_hi:[0,1,1] neg_lo:[0,0,1] neg_hi:[0,0,1]
v_pk_fma_f32 v[180:181], v[192:193], v[188:189], v[180:181] op_sel_hi:[0,1,1] neg_lo:[0,0,1] neg_hi:[0,0,1]
v_pk_fma_f32 v[182:183], v[192:193], v[190:191], v[182:183] op_sel_hi:[0,1,1] neg_lo:[0,0,1] neg_hi:[0,0,1]
v_cvt_pk_bf16_f32 v80, v176, v177
v_cvt_pk_bf16_f32 v81, v178, v179
v_cvt_pk_bf16_f32 v82, v180, v181
v_cvt_pk_bf16_f32 v83, v182, v183
v_pk_fma_f32 v[184:185], v[192:193], v[176:177], v[184:185] op_sel_hi:[0,1,1] neg_lo:[0,0,1] neg_hi:[0,0,1]
v_pk_fma_f32 v[186:187], v[192:193], v[178:179], v[186:187] op_sel_hi:[0,1,1] neg_lo:[0,0,1] neg_hi:[0,0,1]
v_pk_fma_f32 v[188:189], v[192:193], v[180:181], v[188:189] op_sel_hi:[0,1,1] neg_lo:[0,0,1] neg_hi:[0,0,1]
v_pk_fma_f32 v[190:191], v[192:193], v[182:183], v[190:191] op_sel_hi:[0,1,1] neg_lo:[0,0,1] neg_hi:[0,0,1]
v_cvt_pk_bf16_f32 v84, v184, v185
v_cvt_pk_bf16_f32 v85, v186, v187
v_cvt_pk_bf16_f32 v86, v188, v189
v_cvt_pk_bf16_f32 v87, v190, v191
v_pk_fma_f32 v[176:177], v[192:193], v[184:185], v[176:177] op_sel_hi:[0,1,1] neg_lo:[0,0,1] neg_hi:[0,0,1]
v_pk_fma_f32 v[178:179], v[192:193], v[186:187], v[178:179] op_sel_hi:[0,1,1] neg_lo:[0,0,1] neg_hi:[0,0,1]
v_pk_fma_f32 v[180:181], v[192:193], v[188:189], v[180:181] op_sel_hi:[0,1,1] neg_lo:[0,0,1] neg_hi:[0,0,1]
v_pk_fma_f32 v[182:183], v[192:193], v[190:191], v[182:183] op_sel_hi:[0,1,1] neg_lo:[0,0,1] neg_hi:[0,0,1]
v_cvt_pk_bf16_f32 v88, v176, v177
v_cvt_pk_bf16_f32 v89, v178, v179
v_cvt_pk_bf16_f32 v90, v180, v181
v_cvt_pk_bf16_f32 v91, v182, v183
v_pk_fma_f32 v[184:185], v[192:193], v[176:177], v[184:185] op_sel_hi:[0,1,1] neg_lo:[0,0,1] neg_hi:[0,0,1]
v_pk_fma_f32 v[186:187], v[192:193], v[178:179], v[186:187] op_sel_hi:[0,1,1] neg_lo:[0,0,1] neg_hi:[0,0,1]
v_pk_fma_f32 v[188:189], v[192:193], v[180:181], v[188:189] op_sel_hi:[0,1,1] neg_lo:[0,0,1] neg_hi:[0,0,1]
v_pk_fma_f32 v[190:191], v[192:193], v[182:183], v[190:191] op_sel_hi:[0,1,1] neg_lo:[0,0,1] neg_hi:[0,0,1]
v_cvt_pk_bf16_f32 v92, v184, v185
v_cvt_pk_bf16_f32 v93, v186, v187
v_cvt_pk_bf16_f32 v94, v188, v189
v_cvt_pk_bf16_f32 v95, v190, v191
s_mov_b32 s20, 323
v_mad_u32_u24 v179, v196, s20, v197
v_cvt_f32_u32 v179, v179
v_mul_f32 v198, s19, v179
v_rndne_f32 v198, v198
v_fmac_f32 v179, 0xc4200000, v198
v_mul_f32 v179, s19, v179
v_cos_f32 v179, v179
s_mov_b32 s20, 324
v_mad_u32_u24 v180, v196, s20, v197
v_cvt_f32_u32 v180, v180
v_mul_f32 v198, s19, v180
v_rndne_f32 v198, v198
v_fmac_f32 v180, 0xc4200000, v198
v_mul_f32 v180, s19, v180
v_cos_f32 v180, v180
s_nop 0
v_fma_f32 v181, v194, v180, -v179
v_fma_f32 v178, v194, v179, -v180
v_fma_f32 v182, v194, v181, -v180
v_fma_f32 v177, v194, v178, -v179
v_fma_f32 v183, v194, v182, -v181
v_fma_f32 v176, v194, v177, -v178
v_cvt_pk_bf16_f32 v96, v176, v177
v_cvt_pk_bf16_f32 v97, v178, v179
v_cvt_pk_bf16_f32 v98, v180, v181
v_cvt_pk_bf16_f32 v99, v182, v183
s_mov_b32 s20, 339
v_mad_u32_u24 v187, v196, s20, v197
v_cvt_f32_u32 v187, v187
v_mul_f32 v198, s19, v187
v_rndne_f32 v198, v198
v_fmac_f32 v187, 0xc4200000, v198
v_mul_f32 v187, s19, v187
v_cos_f32 v187, v187
s_mov_b32 s20, 340
v_mad_u32_u24 v188, v196, s20, v197
v_cvt_f32_u32 v188, v188
v_mul_f32 v198, s19, v188
v_rndne_f32 v198, v198
v_fmac_f32 v188, 0xc4200000, v198
v_mul_f32 v188, s19, v188
v_cos_f32 v188, v188
s_nop 0
v_fma_f32 v189, v194, v188, -v187
v_fma_f32 v186, v194, v187, -v188
v_fma_f32 v190, v194, v189, -v188
v_fma_f32 v185, v194, v186, -v187
v_fma_f32 v191, v194, v190, -v189
v_fma_f32 v184, v194, v185, -v186
v_cvt_pk_bf16_f32 v100, v184, v185
v_cvt_pk_bf16_f32 v101, v186, v187
v_cvt_pk_bf16_f32 v102, v188, v189
v_cvt_pk_bf16_f32 v103, v190, v191
v_pk_fma_f32 v[176:177], v[192:193], v[184:185], v[176:177] op_sel_hi:[0,1,1] neg_lo:[0,0,1] neg_hi:[0,0,1]
v_pk_fma_f32 v[178:179], v[192:193], v[186:187], v[178:179] op_sel_hi:[0,1,1] neg_lo:[0,0,1] neg_hi:[0,0,1]
v_pk_fma_f32 v[180:181], v[192:193], v[188:189], v[180:181] op_sel_hi:[0,1,1] neg_lo:[0,0,1] neg_hi:[0,0,1]
v_pk_fma_f32 v[182:183], v[192:193], v[190:191], v[182:183] op_sel_hi:[0,1,1] neg_lo:[0,0,1] neg_hi:[0,0,1]
v_cvt_pk_bf16_f32 v104, v176, v177
v_cvt_pk_bf16_f32 v105, v178, v179
v_cvt_pk_bf16_f32 v106, v180, v181
v_cvt_pk_bf16_f32 v107, v182, v183
v_pk_fma_f32 v[184:185], v[192:193], v[176:177], v[184:185] op_sel_hi:[0,1,1] neg_lo:[0,0,1] neg_hi:[0,0,1]
v_pk_fma_f32 v[186:187], v[192:193], v[178:179], v[186:187] op_sel_hi:[0,1,1] neg_lo:[0,0,1] neg_hi:[0,0,1]
v_pk_fma_f32 v[188:189], v[192:193], v[180:181], v[188:189] op_sel_hi:[0,1,1] neg_lo:[0,0,1] neg_hi:[0,0,1]
v_pk_fma_f32 v[190:191], v[192:193], v[182:183], v[190:191] op_sel_hi:[0,1,1] neg_lo:[0,0,1] neg_hi:[0,0,1]
v_cvt_pk_bf16_f32 v108, v184, v185
v_cvt_pk_bf16_f32 v109, v186, v187
v_cvt_pk_bf16_f32 v110, v188, v189
v_cvt_pk_bf16_f32 v111, v190, v191
v_pk_fma_f32 v[176:177], v[192:193], v[184:185], v[176:177] op_sel_hi:[0,1,1] neg_lo:[0,0,1] neg_hi:[0,0,1]
v_pk_fma_f32 v[178:179], v[192:193], v[186:187], v[178:179] op_sel_hi:[0,1,1] neg_lo:[0,0,1] neg_hi:[0,0,1]
v_pk_fma_f32 v[180:181], v[192:193], v[188:189], v[180:181] op_sel_hi:[0,1,1] neg_lo:[0,0,1] neg_hi:[0,0,1]
v_pk_fma_f32 v[182:183], v[192:193], v[190:191], v[182:183] op_sel_hi:[0,1,1] neg_lo:[0,0,1] neg_hi:[0,0,1]
v_cvt_pk_bf16_f32 v112, v176, v177
v_cvt_pk_bf16_f32 v113, v178, v179
v_cvt_pk_bf16_f32 v114, v180, v181
v_cvt_pk_bf16_f32 v115, v182, v183
v_pk_fma_f32 v[184:185], v[192:193], v[176:177], v[184:185] op_sel_hi:[0,1,1] neg_lo:[0,0,1] neg_hi:[0,0,1]
v_pk_fma_f32 v[186:187], v[192:193], v[178:179], v[186:187] op_sel_hi:[0,1,1] neg_lo:[0,0,1] neg_hi:[0,0,1]
v_pk_fma_f32 v[188:189], v[192:193], v[180:181], v[188:189] op_sel_hi:[0,1,1] neg_lo:[0,0,1] neg_hi:[0,0,1]
v_pk_fma_f32 v[190:191], v[192:193], v[182:183], v[190:191] op_sel_hi:[0,1,1] neg_lo:[0,0,1] neg_hi:[0,0,1]
v_cvt_pk_bf16_f32 v116, v184, v185
v_cvt_pk_bf16_f32 v117, v186, v187
v_cvt_pk_bf16_f32 v118, v188, v189
v_cvt_pk_bf16_f32 v119, v190, v191
v_pk_fma_f32 v[176:177], v[192:193], v[184:185], v[176:177] op_sel_hi:[0,1,1] neg_lo:[0,0,1] neg_hi:[0,0,1]
v_pk_fma_f32 v[178:179], v[192:193], v[186:187], v[178:179] op_sel_hi:[0,1,1] neg_lo:[0,0,1] neg_hi:[0,0,1]
v_pk_fma_f32 v[180:181], v[192:193], v[188:189], v[180:181] op_sel_hi:[0,1,1] neg_lo:[0,0,1] neg_hi:[0,0,1]
v_pk_fma_f32 v[182:183], v[192:193], v[190:191], v[182:183] op_sel_hi:[0,1,1] neg_lo:[0,0,1] neg_hi:[0,0,1]
v_cvt_pk_bf16_f32 v120, v176, v177
v_cvt_pk_bf16_f32 v121, v178, v179
v_cvt_pk_bf16_f32 v122, v180, v181
v_cvt_pk_bf16_f32 v123, v182, v183
v_pk_fma_f32 v[184:185], v[192:193], v[176:177], v[184:185] op_sel_hi:[0,1,1] neg_lo:[0,0,1] neg_hi:[0,0,1]
v_pk_fma_f32 v[186:187], v[192:193], v[178:179], v[186:187] op_sel_hi:[0,1,1] neg_lo:[0,0,1] neg_hi:[0,0,1]
v_pk_fma_f32 v[188:189], v[192:193], v[180:181], v[188:189] op_sel_hi:[0,1,1] neg_lo:[0,0,1] neg_hi:[0,0,1]
v_pk_fma_f32 v[190:191], v[192:193], v[182:183], v[190:191] op_sel_hi:[0,1,1] neg_lo:[0,0,1] neg_hi:[0,0,1]
v_cvt_pk_bf16_f32 v124, v184, v185
v_cvt_pk_bf16_f32 v125, v186, v187
v_cvt_pk_bf16_f32 v126, v188, v189
v_cvt_pk_bf16_f32 v127, v190, v191
v_pk_fma_f32 v[176:177], v[192:193], v[184:185], v[176:177] op_sel_hi:[0,1,1] neg_lo:[0,0,1] neg_hi:[0,0,1]
v_pk_fma_f32 v[178:179], v[192:193], v[186:187], v[178:179] op_sel_hi:[0,1,1] neg_lo:[0,0,1] neg_hi:[0,0,1]
v_pk_fma_f32 v[180:181], v[192:193], v[188:189], v[180:181] op_sel_hi:[0,1,1] neg_lo:[0,0,1] neg_hi:[0,0,1]
v_pk_fma_f32 v[182:183], v[192:193], v[190:191], v[182:183] op_sel_hi:[0,1,1] neg_lo:[0,0,1] neg_hi:[0,0,1]
v_cvt_pk_bf16_f32 v128, v176, v177
v_cvt_pk_bf16_f32 v129, v178, v179
v_cvt_pk_bf16_f32 v130, v180, v181
v_cvt_pk_bf16_f32 v131, v182, v183
v_pk_fma_f32 v[184:185], v[192:193], v[176:177], v[184:185] op_sel_hi:[0,1,1] neg_lo:[0,0,1] neg_hi:[0,0,1]
v_pk_fma_f32 v[186:187], v[192:193], v[178:179], v[186:187] op_sel_hi:[0,1,1] neg_lo:[0,0,1] neg_hi:[0,0,1]
v_pk_fma_f32 v[188:189], v[192:193], v[180:181], v[188:189] op_sel_hi:[0,1,1] neg_lo:[0,0,1] neg_hi:[0,0,1]
v_pk_fma_f32 v[190:191], v[192:193], v[182:183], v[190:191] op_sel_hi:[0,1,1] neg_lo:[0,0,1] neg_hi:[0,0,1]
v_cvt_pk_bf16_f32 v132, v184, v185
v_cvt_pk_bf16_f32 v133, v186, v187
v_cvt_pk_bf16_f32 v134, v188, v189
v_cvt_pk_bf16_f32 v135, v190, v191
v_pk_fma_f32 v[176:177], v[192:193], v[184:185], v[176:177] op_sel_hi:[0,1,1] neg_lo:[0,0,1] neg_hi:[0,0,1]
v_pk_fma_f32 v[178:179], v[192:193], v[186:187], v[178:179] op_sel_hi:[0,1,1] neg_lo:[0,0,1] neg_hi:[0,0,1]
v_pk_fma_f32 v[180:181], v[192:193], v[188:189], v[180:181] op_sel_hi:[0,1,1] neg_lo:[0,0,1] neg_hi:[0,0,1]
v_pk_fma_f32 v[182:183], v[192:193], v[190:191], v[182:183] op_sel_hi:[0,1,1] neg_lo:[0,0,1] neg_hi:[0,0,1]
v_cvt_pk_bf16_f32 v136, v176, v177
v_cvt_pk_bf16_f32 v137, v178, v179
v_cvt_pk_bf16_f32 v138, v180, v181
v_cvt_pk_bf16_f32 v139, v182, v183
v_pk_fma_f32 v[184:185], v[192:193], v[176:177], v[184:185] op_sel_hi:[0,1,1] neg_lo:[0,0,1] neg_hi:[0,0,1]
v_pk_fma_f32 v[186:187], v[192:193], v[178:179], v[186:187] op_sel_hi:[0,1,1] neg_lo:[0,0,1] neg_hi:[0,0,1]
v_pk_fma_f32 v[188:189], v[192:193], v[180:181], v[188:189] op_sel_hi:[0,1,1] neg_lo:[0,0,1] neg_hi:[0,0,1]
v_pk_fma_f32 v[190:191], v[192:193], v[182:183], v[190:191] op_sel_hi:[0,1,1] neg_lo:[0,0,1] neg_hi:[0,0,1]
v_cvt_pk_bf16_f32 v140, v184, v185
v_cvt_pk_bf16_f32 v141, v186, v187
v_cvt_pk_bf16_f32 v142, v188, v189
v_cvt_pk_bf16_f32 v143, v190, v191
v_pk_fma_f32 v[176:177], v[192:193], v[184:185], v[176:177] op_sel_hi:[0,1,1] neg_lo:[0,0,1] neg_hi:[0,0,1]
v_pk_fma_f32 v[178:179], v[192:193], v[186:187], v[178:179] op_sel_hi:[0,1,1] neg_lo:[0,0,1] neg_hi:[0,0,1]
v_pk_fma_f32 v[180:181], v[192:193], v[188:189], v[180:181] op_sel_hi:[0,1,1] neg_lo:[0,0,1] neg_hi:[0,0,1]
v_pk_fma_f32 v[182:183], v[192:193], v[190:191], v[182:183] op_sel_hi:[0,1,1] neg_lo:[0,0,1] neg_hi:[0,0,1]
v_cvt_pk_bf16_f32 v144, v176, v177
v_cvt_pk_bf16_f32 v145, v178, v179
v_cvt_pk_bf16_f32 v146, v180, v181
v_cvt_pk_bf16_f32 v147, v182, v183
v_pk_fma_f32 v[184:185], v[192:193], v[176:177], v[184:185] op_sel_hi:[0,1,1] neg_lo:[0,0,1] neg_hi:[0,0,1]
v_pk_fma_f32 v[186:187], v[192:193], v[178:179], v[186:187] op_sel_hi:[0,1,1] neg_lo:[0,0,1] neg_hi:[0,0,1]
v_pk_fma_f32 v[188:189], v[192:193], v[180:181], v[188:189] op_sel_hi:[0,1,1] neg_lo:[0,0,1] neg_hi:[0,0,1]
v_pk_fma_f32 v[190:191], v[192:193], v[182:183], v[190:191] op_sel_hi:[0,1,1] neg_lo:[0,0,1] neg_hi:[0,0,1]
v_cvt_pk_bf16_f32 v148, v184, v185
v_cvt_pk_bf16_f32 v149, v186, v187
v_cvt_pk_bf16_f32 v150, v188, v189
v_cvt_pk_bf16_f32 v151, v190, v191
v_pk_fma_f32 v[176:177], v[192:193], v[184:185], v[176:177] op_sel_hi:[0,1,1] neg_lo:[0,0,1] neg_hi:[0,0,1]
v_pk_fma_f32 v[178:179], v[192:193], v[186:187], v[178:179] op_sel_hi:[0,1,1] neg_lo:[0,0,1] neg_hi:[0,0,1]
v_pk_fma_f32 v[180:181], v[192:193], v[188:189], v[180:181] op_sel_hi:[0,1,1] neg_lo:[0,0,1] neg_hi:[0,0,1]
v_pk_fma_f32 v[182:183], v[192:193], v[190:191], v[182:183] op_sel_hi:[0,1,1] neg_lo:[0,0,1] neg_hi:[0,0,1]
v_cvt_pk_bf16_f32 v152, v176, v177
v_cvt_pk_bf16_f32 v153, v178, v179
v_cvt_pk_bf16_f32 v154, v180, v181
v_cvt_pk_bf16_f32 v155, v182, v183
v_pk_fma_f32 v[184:185], v[192:193], v[176:177], v[184:185] op_sel_hi:[0,1,1] neg_lo:[0,0,1] neg_hi:[0,0,1]
v_pk_fma_f32 v[186:187], v[192:193], v[178:179], v[186:187] op_sel_hi:[0,1,1] neg_lo:[0,0,1] neg_hi:[0,0,1]
v_pk_fma_f32 v[188:189], v[192:193], v[180:181], v[188:189] op_sel_hi:[0,1,1] neg_lo:[0,0,1] neg_hi:[0,0,1]
v_pk_fma_f32 v[190:191], v[192:193], v[182:183], v[190:191] op_sel_hi:[0,1,1] neg_lo:[0,0,1] neg_hi:[0,0,1]
v_cvt_pk_bf16_f32 v156, v184, v185
v_cvt_pk_bf16_f32 v157, v186, v187
v_cvt_pk_bf16_f32 v158, v188, v189
v_cvt_pk_bf16_f32 v159, v190, v191
v_pk_fma_f32 v[176:177], v[192:193], v[184:185], v[176:177] op_sel_hi:[0,1,1] neg_lo:[0,0,1] neg_hi:[0,0,1]
v_pk_fma_f32 v[178:179], v[192:193], v[186:187], v[178:179] op_sel_hi:[0,1,1] neg_lo:[0,0,1] neg_hi:[0,0,1]
v_pk_fma_f32 v[180:181], v[192:193], v[188:189], v[180:181] op_sel_hi:[0,1,1] neg_lo:[0,0,1] neg_hi:[0,0,1]
v_pk_fma_f32 v[182:183], v[192:193], v[190:191], v[182:183] op_sel_hi:[0,1,1] neg_lo:[0,0,1] neg_hi:[0,0,1]
v_cvt_pk_bf16_f32 v160, v176, v177
v_cvt_pk_bf16_f32 v161, v178, v179
v_cvt_pk_bf16_f32 v162, v180, v181
v_cvt_pk_bf16_f32 v163, v182, v183
v_pk_fma_f32 v[184:185], v[192:193], v[176:177], v[184:185] op_sel_hi:[0,1,1] neg_lo:[0,0,1] neg_hi:[0,0,1]
v_pk_fma_f32 v[186:187], v[192:193], v[178:179], v[186:187] op_sel_hi:[0,1,1] neg_lo:[0,0,1] neg_hi:[0,0,1]
v_pk_fma_f32 v[188:189], v[192:193], v[180:181], v[188:189] op_sel_hi:[0,1,1] neg_lo:[0,0,1] neg_hi:[0,0,1]
v_pk_fma_f32 v[190:191], v[192:193], v[182:183], v[190:191] op_sel_hi:[0,1,1] neg_lo:[0,0,1] neg_hi:[0,0,1]
v_cvt_pk_bf16_f32 v164, v184, v185
v_cvt_pk_bf16_f32 v165, v186, v187
v_cvt_pk_bf16_f32 v166, v188, v189
v_cvt_pk_bf16_f32 v167, v190, v191
v_pk_fma_f32 v[176:177], v[192:193], v[184:185], v[176:177] op_sel_hi:[0,1,1] neg_lo:[0,0,1] neg_hi:[0,0,1]
v_pk_fma_f32 v[178:179], v[192:193], v[186:187], v[178:179] op_sel_hi:[0,1,1] neg_lo:[0,0,1] neg_hi:[0,0,1]
v_pk_fma_f32 v[180:181], v[192:193], v[188:189], v[180:181] op_sel_hi:[0,1,1] neg_lo:[0,0,1] neg_hi:[0,0,1]
v_pk_fma_f32 v[182:183], v[192:193], v[190:191], v[182:183] op_sel_hi:[0,1,1] neg_lo:[0,0,1] neg_hi:[0,0,1]
v_cvt_pk_bf16_f32 v168, v176, v177
v_cvt_pk_bf16_f32 v169, v178, v179
v_cvt_pk_bf16_f32 v170, v180, v181
v_cvt_pk_bf16_f32 v171, v182, v183
v_pk_fma_f32 v[184:185], v[192:193], v[176:177], v[184:185] op_sel_hi:[0,1,1] neg_lo:[0,0,1] neg_hi:[0,0,1]
v_pk_fma_f32 v[186:187], v[192:193], v[178:179], v[186:187] op_sel_hi:[0,1,1] neg_lo:[0,0,1] neg_hi:[0,0,1]
v_pk_fma_f32 v[188:189], v[192:193], v[180:181], v[188:189] op_sel_hi:[0,1,1] neg_lo:[0,0,1] neg_hi:[0,0,1]
v_pk_fma_f32 v[190:191], v[192:193], v[182:183], v[190:191] op_sel_hi:[0,1,1] neg_lo:[0,0,1] neg_hi:[0,0,1]
v_cvt_pk_bf16_f32 v172, v184, v185
v_cvt_pk_bf16_f32 v173, v186, v187
v_cvt_pk_bf16_f32 v174, v188, v189
v_cvt_pk_bf16_f32 v175, v190, v191
p1q_81:
s_mul_i32 s18, s30, 21846
s_lshr_b32 s18, s18, 16
s_mul_i32 s18, s18, 3
s_sub_u32 s18, s30, s18
s_and_b32 s19, s30, 3
s_cmp_lt_u32 s30, 56
s_cselect_b32 s18, s18, s19
s_mul_i32 s18, s18, 2560
s_add_u32 s18, s18, 11665408
s_add_u32 s29, s30, 1
s_cmp_lg_u32 s13, 0
s_cbranch_scc1 polld_83
v_lshlrev_b32 v3, 3, v0
v_min_u32 v12, 2432, v3
s_mov_b32 s17, 0
poll_82:
buffer_load_dword v8, v12, s[4:7], s18 offen sc1
s_add_u32 s17, s17, 1
s_cmp_gt_u32 s17, 262144
s_cbranch_scc1 L_fail
s_waitcnt vmcnt(0)
v_cmp_gt_u32 vcc, s29, v8
s_cbranch_vccz polld_83
s_sleep 2
s_branch poll_82
polld_83:
s_barrier
s_mul_i32 s18, s30, 40960
s_add_u32 s26, s18, 91226112
s_add_u32 s26, s26, s31
s_add_u32 s27, s18, 100663296
s_add_u32 s27, s27, s33
s_add_u32 m0, s31, 2048
s_add_u32 s20, s26, 0
buffer_load_dwordx4 v0, s[4:7], s20 offen sc1 lds
s_add_u32 m0, s31, 3072
s_add_u32 s20, s26, 1024
buffer_load_dwordx4 v0, s[4:7], s20 offen sc1 lds
s_add_u32 m0, s31, 4096
s_add_u32 s20, s26, 2048
buffer_load_dwordx4 v0, s[4:7], s20 offen sc1 lds
s_add_u32 m0, s31, 5120
s_add_u32 s20, s26, 3072
buffer_load_dwordx4 v0, s[4:7], s20 offen sc1 lds
s_add_u32 m0, s31, 6144
s_add_u32 s20, s26, 4096
buffer_load_dwordx4 v0, s[4:7], s20 offen sc1 lds
s_add_u32 m0, s31, 7168
s_add_u32 s20, s26, 5120
buffer_load_dwordx4 v0, s[4:7], s20 offen sc1 lds
s_add_u32 m0, s31, 8192
s_add_u32 s20, s26, 6144
buffer_load_dwordx4 v0, s[4:7], s20 offen sc1 lds
s_add_u32 m0, s31, 9216
s_add_u32 s20, s26, 7168
buffer_load_dwordx4 v0, s[4:7], s20 offen sc1 lds
s_add_u32 m0, s31, 10240
s_add_u32 s20, s26, 8192
buffer_load_dwordx4 v0, s[4:7], s20 offen sc1 lds
s_add_u32 m0, s31, 11264
s_add_u32 s20, s26, 9216
buffer_load_dwordx4 v0, s[4:7], s20 offen sc1 lds
s_waitcnt vmcnt(0)
s_barrier
v_add_u32 v2, s31, v0
ds_read_b128 v[216:219], v2 offset:2048
ds_read_b128 v[220:223], v2 offset:3072
ds_read_b128 v[224:227], v2 offset:4096
ds_read_b128 v[196:199], v0 offset:3072
ds_read_b128 v[228:231], v2 offset:5120
ds_read_b128 v[192:195], v0 offset:2048
v_mov_b64 v[208:209], 0
ds_read_b128 v[200:203], v0 offset:4096
ds_read_b128 v[204:207], v0 offset:5120
s_waitcnt lgkmcnt(7)
v_dot2c_f32_bf16 v208, s24, v216
v_dot2c_f32_bf16 v209, v216, v216
v_dot2c_f32_bf16 v208, s24, v217
v_dot2c_f32_bf16 v209, v217, v217
v_dot2c_f32_bf16 v208, s24, v218
v_dot2c_f32_bf16 v209, v218, v218
v_dot2c_f32_bf16 v208, s24, v219
s_waitcnt lgkmcnt(5)
v_dot2c_f32_bf16 v209, v219, v219
v_dot2c_f32_bf16 v208, s24, v220
v_dot2c_f32_bf16 v209, v220, v220
v_dot2c_f32_bf16 v208, s24, v221
v_dot2c_f32_bf16 v209, v221, v221
v_dot2c_f32_bf16 v208, s24, v222
v_dot2c_f32_bf16 v209, v222, v222
v_dot2c_f32_bf16 v208, s24, v223
v_dot2c_f32_bf16 v209, v223, v223
v_dot2c_f32_bf16 v208, s24, v224
v_dot2c_f32_bf16 v209, v224, v224
s_waitcnt lgkmcnt(3)
ds_read_b128 v[216:219], v2 offset:6144
ds_read_b128 v[220:223], v2 offset:7168
v_dot2c_f32_bf16 v208, s24, v225
v_dot2c_f32_bf16 v209, v225, v225
v_dot2c_f32_bf16 v208, s24, v226
v_dot2c_f32_bf16 v209, v226, v226
v_dot2c_f32_bf16 v208, s24, v227
v_dot2c_f32_bf16 v209, v227, v227
v_dot2c_f32_bf16 v208, s24, v228
v_dot2c_f32_bf16 v209, v228, v228
v_dot2c_f32_bf16 v208, s24, v229
v_dot2c_f32_bf16 v209, v229, v229
v_dot2c_f32_bf16 v208, s24, v230
v_dot2c_f32_bf16 v209, v230, v230
v_dot2c_f32_bf16 v208, s24, v231
v_dot2c_f32_bf16 v209, v231, v231
s_waitcnt lgkmcnt(1)
ds_read_b128 v[228:231], v2 offset:9216
ds_read_b128 v[224:227], v2 offset:8192
v_dot2c_f32_bf16 v208, s24, v216
v_dot2c_f32_bf16 v209, v216, v216
v_dot2c_f32_bf16 v208, s24, v217
s_waitcnt lgkmcnt(2)
v_dot2c_f32_bf16 v209, v217, v217
v_dot2c_f32_bf16 v208, s24, v218
v_dot2c_f32_bf16 v209, v218, v218
v_dot2c_f32_bf16 v208, s24, v219
v_dot2c_f32_bf16 v209, v219, v219
v_dot2c_f32_bf16 v208, s24, v220
v_dot2c_f32_bf16 v209, v220, v220
v_dot2c_f32_bf16 v208, s24, v221
v_dot2c_f32_bf16 v209, v221, v221
v_dot2c_f32_bf16 v208, s24, v222
v_dot2c_f32_bf16 v209, v222, v222
v_dot2c_f32_bf16 v208, s24, v223
v_dot2c_f32_bf16 v209, v223, v223
s_waitcnt lgkmcnt(0)
ds_read_b128 v[216:219], v2 offset:10240
ds_read_b128 v[220:223], v2 offset:11264
v_dot2c_f32_bf16 v208, s24, v224
v_dot2c_f32_bf16 v209, v224, v224
v_dot2c_f32_bf16 v208, s24, v225
v_dot2c_f32_bf16 v209, v225, v225
v_dot2c_f32_bf16 v208, s24, v226
v_dot2c_f32_bf16 v209, v226, v226
v_dot2c_f32_bf16 v208, s24, v227
v_dot2c_f32_bf16 v209, v227, v227
v_dot2c_f32_bf16 v208, s24, v228
v_dot2c_f32_bf16 v209, v228, v228
v_dot2c_f32_bf16 v208, s24, v229
v_dot2c_f32_bf16 v209, v229, v229
v_dot2c_f32_bf16 v208, s24, v230
v_dot2c_f32_bf16 v209, v230, v230
s_waitcnt lgkmcnt(1)
v_dot2c_f32_bf16 v208, s24, v231
v_dot2c_f32_bf16 v209, v231, v231
v_dot2c_f32_bf16 v208, s24, v216
s_waitcnt lgkmcnt(0)
v_dot2c_f32_bf16 v209, v216, v216
v_dot2c_f32_bf16 v208, s24, v217
v_dot2c_f32_bf16 v209, v217, v217
v_dot2c_f32_bf16 v208, s24, v218
v_dot2c_f32_bf16 v209, v218, v218
v_dot2c_f32_bf16 v208, s24, v219
v_dot2c_f32_bf16 v209, v219, v219
v_dot2c_f32_bf16 v208, s24, v220
v_dot2c_f32_bf16 v209, v220, v220
v_dot2c_f32_bf16 v208, s24, v221
v_dot2c_f32_bf16 v209, v221, v221
v_dot2c_f32_bf16 v208, s24, v222
v_dot2c_f32_bf16 v209, v222, v222
v_dot2c_f32_bf16 v208, s24, v223
v_dot2c_f32_bf16 v209, v223, v223
v_mfma_f32_32x32x16_bf16 v[176:191], v[192:195], v[16:19], 0
s_nop 1
v_permlane32_swap_b32 v208, v209
ds_read_b128 v[192:195], v0 offset:6144
v_mfma_f32_32x32x16_bf16 v[176:191], v[196:199], v[20:23], v[176:191]
v_and_b32 v2, 0x1ff, v0
v_add_f32 v208, v208, v209
v_mfma_f32_32x32x16_bf16 v[176:191], v[200:203], v[24:27], v[176:191]
v_lshl_add_u32 v209, s13, 2, v0
ds_read_b128 v[196:199], v0 offset:7168
ds_write_b32 v209, v208 offset:0
v_mfma_f32_32x32x16_bf16 v[176:191], v[204:207], v[28:31], v[176:191]
s_waitcnt lgkmcnt(2)
ds_read_b128 v[200:203], v0 offset:8192
ds_read_b128 v[204:207], v0 offset:9216
v_mfma_f32_32x32x16_bf16 v[176:191], v[192:195], v[32:35], v[176:191]
s_waitcnt lgkmcnt(3)
v_mfma_f32_32x32x16_bf16 v[176:191], v[196:199], v[36:39], v[176:191]
s_waitcnt lgkmcnt(2)
ds_read_b128 v[192:195], v0 offset:10240
s_waitcnt lgkmcnt(2)
s_waitcnt lgkmcnt(1)
v_mfma_f32_32x32x16_bf16 v[176:191], v[200:203], v[40:43], v[176:191]
ds_read_b128 v[196:199], v0 offset:11264
s_barrier
ds_read_b128 v[208:211], v2 offset:0
v_mfma_f32_32x32x16_bf16 v[176:191], v[204:207], v[44:47], v[176:191]
ds_read_b128 v[204:207], v0 offset:13312
ds_read_b128 v[200:203], v0 offset:12288
s_waitcnt lgkmcnt(4)
v_mfma_f32_32x32x16_bf16 v[176:191], v[192:195], v[48:51], v[176:191]
s_waitcnt lgkmcnt(3)
ds_read_b128 v[212:215], v2 offset:512
ds_read_b128 v[192:195], v0 offset:14336
v_mfma_f32_32x32x16_bf16 v[176:191], v[196:199], v[52:55], v[176:191]
s_waitcnt lgkmcnt(2)
v_mfma_f32_32x32x16_bf16 v[176:191], v[200:203], v[56:59], v[176:191]
ds_read_b128 v[196:199], v0 offset:15360
ds_read_b128 v[200:203], v0 offset:16384
v_add_f32 v208, v208, v209
v_add_f32 v210, v210, v211
s_waitcnt lgkmcnt(3)
v_mfma_f32_32x32x16_bf16 v[176:191], v[204:207], v[60:63], v[176:191]
s_waitcnt lgkmcnt(2)
ds_read_b128 v[204:207], v0 offset:17408
v_add_f32 v212, v212, v213
v_add_f32 v208, v208, v210
v_mfma_f32_32x32x16_bf16 v[176:191], v[192:195], v[64:67], v[176:191]
s_waitcnt lgkmcnt(2)
v_mfma_f32_32x32x16_bf16 v[176:191], v[196:199], v[68:71], v[176:191]
v_mul_f32 v208, 0x3acccccd, v208
s_waitcnt lgkmcnt(1)
ds_read_b128 v[192:195], v0 offset:18432
v_add_f32 v214, v214, v215
s_waitcnt lgkmcnt(1)
v_mfma_f32_32x32x16_bf16 v[176:191], v[200:203], v[72:75], v[176:191]
v_lshrrev_b32 v209, 2, v0
ds_read_b128 v[196:199], v0 offset:19456
v_mfma_f32_32x32x16_bf16 v[176:191], v[204:207], v[76:79], v[176:191]
ds_read_b128 v[200:203], v0 offset:20480
ds_read_b128 v[204:207], v0 offset:21504
v_add_f32 v212, v212, v214
v_mul_f32 v212, 0x3acccccd, v212
s_waitcnt lgkmcnt(3)
v_mfma_f32_32x32x16_bf16 v[176:191], v[192:195], v[80:83], v[176:191]
v_fma_f32 v212, -v208, v208, v212
s_waitcnt lgkmcnt(2)
v_max_f32 v212, 0, v212
v_add_f32 v212, 0x3727c5ac, v212
v_mfma_f32_32x32x16_bf16 v[176:191], v[196:199], v[84:87], v[176:191]
ds_read_b128 v[192:195], v0 offset:22528
s_waitcnt lgkmcnt(2)
v_bfe_u32 v210, v0, 5, 5
v_lshl_add_u32 v209, s13, 8, v209
v_mfma_f32_32x32x16_bf16 v[176:191], v[200:203], v[88:91], v[176:191]
ds_read_b128 v[196:199], v0 offset:23552
ds_read_b128 v[200:203], v0 offset:24576
v_rsq_f32 v212, v212
s_waitcnt lgkmcnt(3)
v_and_b32 v210, 16, v210
v_mfma_f32_32x32x16_bf16 v[176:191], v[204:207], v[92:95], v[176:191]
ds_read_b128 v[204:207], v0 offset:25600
s_waitcnt lgkmcnt(3)
v_mul_f32 v208, v212, v208
v_mfma_f32_32x32x16_bf16 v[176:191], v[192:195], v[96:99], v[176:191]
v_lshl_add_u32 v210, s13, 8, v210
v_permlane32_swap_b32 v212, v208
s_waitcnt lgkmcnt(2)
ds_read_b128 v[192:195], v0 offset:26624
v_mfma_f32_32x32x16_bf16 v[176:191], v[196:199], v[100:103], v[176:191]
ds_write_b32 v209, v212 offset:1024
s_waitcnt lgkmcnt(3)
s_waitcnt lgkmcnt(2)
v_mfma_f32_32x32x16_bf16 v[176:191], v[200:203], v[104:107], v[176:191]
ds_read_b128 v[240:243], v210 offset:1216
ds_read_b128 v[196:199], v0 offset:27648
v_mfma_f32_32x32x16_bf16 v[176:191], v[204:207], v[108:111], v[176:191]
ds_read_b128 v[200:203], v0 offset:28672
s_waitcnt lgkmcnt(4)
ds_read_b128 v[232:235], v210 offset:1152
v_mfma_f32_32x32x16_bf16 v[176:191], v[192:195], v[112:115], v[176:191]
ds_read_b128 v[204:207], v0 offset:29696
ds_read_b128 v[192:195], v0 offset:30720
s_waitcnt lgkmcnt(4)
v_mfma_f32_32x32x16_bf16 v[176:191], v[196:199], v[116:119], v[176:191]
ds_read_b128 v[228:231], v210 offset:1120
s_waitcnt lgkmcnt(4)
ds_read_b128 v[216:219], v210 offset:1024
ds_read_b128 v[196:199], v0 offset:31744
v_mfma_f32_32x32x16_bf16 v[176:191], v[200:203], v[120:123], v[176:191]
v_mul_f32 v241, v241, v7
s_waitcnt lgkmcnt(3)
ds_read_b128 v[200:203], v0 offset:32768
v_mfma_f32_32x32x16_bf16 v[176:191], v[204:207], v[124:127], v[176:191]
ds_read_b128 v[220:223], v210 offset:1056
v_mfma_f32_32x32x16_bf16 v[176:191], v[192:195], v[128:131], v[176:191]
ds_read_b128 v[204:207], v0 offset:33792
s_waitcnt lgkmcnt(3)
v_mfma_f32_32x32x16_bf16 v[176:191], v[196:199], v[132:135], v[176:191]
s_waitcnt lgkmcnt(2)
ds_read_b128 v[192:195], v0 offset:34816
ds_read_b128 v[224:227], v210 offset:1088
ds_read_b128 v[196:199], v0 offset:35840
ds_read_b128 v[244:247], v210 offset:1248
v_mfma_f32_32x32x16_bf16 v[176:191], v[200:203], v[136:139], v[176:191]
s_waitcnt lgkmcnt(4)
ds_read_b128 v[200:203], v0 offset:36864
v_mfma_f32_32x32x16_bf16 v[176:191], v[204:207], v[140:143], v[176:191]
v_mul_f32 v242, v242, v7
ds_read_b128 v[236:239], v210 offset:1184
s_waitcnt lgkmcnt(5)
v_mfma_f32_32x32x16_bf16 v[176:191], v[192:195], v[144:147], v[176:191]
ds_read_b128 v[204:207], v0 offset:37888
s_waitcnt lgkmcnt(3)
ds_read_b128 v[192:195], v0 offset:38912
v_mfma_f32_32x32x16_bf16 v[176:191], v[196:199], v[148:151], v[176:191]
ds_read_b128 v[196:199], v0 offset:39936
s_waitcnt lgkmcnt(4)
s_waitcnt lgkmcnt(3)
v_mul_f32 v240, v240, v7
v_mfma_f32_32x32x16_bf16 v[176:191], v[200:203], v[152:155], v[176:191]
v_mul_f32 v247, v247, v7
v_mul_f32 v245, v245, v7
v_mul_f32 v233, v233, v7
s_waitcnt lgkmcnt(2)
v_mfma_f32_32x32x16_bf16 v[176:191], v[204:207], v[156:159], v[176:191]
ds_read_b128 v[200:203], v0 offset:40960
s_waitcnt lgkmcnt(1)
ds_read_b128 v[204:207], v0 offset:41984
v_mul_f32 v232, v232, v7
v_mfma_f32_32x32x16_bf16 v[176:191], v[192:195], v[160:163], v[176:191]
v_mul_f32 v246, v246, v7
v_mul_f32 v244, v244, v7
v_mul_f32 v236, v236, v7
v_mfma_f32_32x32x16_bf16 v[176:191], v[196:199], v[164:167], v[176:191]
s_waitcnt lgkmcnt(0)
v_mul_f32 v239, v239, v7
v_mfma_f32_32x32x16_bf16 v[176:191], v[200:203], v[168:171], v[176:191]
v_mul_f32 v238, v238, v7
v_mfma_f32_32x32x16_bf16 v[176:191], v[204:207], v[172:175], v[176:191]
s_nop 0
v_mul_f32 v237, v237, v7
v_mul_f32 v235, v235, v7
v_mul_f32 v234, v234, v7
v_mul_f32 v243, v243, v7
s_nop 6
v_pk_fma_f32 v[184:185], v[184:185], v[224:225], v[240:241] neg_lo:[0,0,1] neg_hi:[0,0,1]
v_pk_fma_f32 v[182:183], v[182:183], v[222:223], v[238:239] neg_lo:[0,0,1] neg_hi:[0,0,1]
v_pk_fma_f32 v[180:181], v[180:181], v[220:221], v[236:237] neg_lo:[0,0,1] neg_hi:[0,0,1]
v_pk_fma_f32 v[188:189], v[188:189], v[228:229], v[244:245] neg_lo:[0,0,1] neg_hi:[0,0,1]
v_pk_fma_f32 v[176:177], v[176:177], v[216:217], v[232:233] neg_lo:[0,0,1] neg_hi:[0,0,1]
v_cvt_pk_bf16_f32 v194, v180, v181
v_pk_fma_f32 v[178:179], v[178:179], v[218:219], v[234:235] neg_lo:[0,0,1] neg_hi:[0,0,1]
v_cvt_pk_bf16_f32 v198, v188, v189
v_pk_fma_f32 v[190:191], v[190:191], v[230:231], v[246:247] neg_lo:[0,0,1] neg_hi:[0,0,1]
v_cvt_pk_bf16_f32 v199, v190, v191
v_cvt_pk_bf16_f32 v195, v182, v183
v_pk_fma_f32 v[186:187], v[186:187], v[226:227], v[242:243] neg_lo:[0,0,1] neg_hi:[0,0,1]
v_cvt_pk_bf16_f32 v193, v178, v179
v_cvt_pk_bf16_f32 v196, v184, v185
v_cvt_pk_bf16_f32 v197, v186, v187
v_cvt_pk_bf16_f32 v192, v176, v177
buffer_store_dwordx4 v[192:195], v6, s[4:7], s27 offen offset:0 sc1
buffer_store_dwordx4 v[196:199], v6, s[4:7], s27 offen offset:1024 sc1
s_add_u32 s30, s30, 3
s_cmp_lt_u32 s30, 60
s_cbranch_scc1 p1q_81
s_lshl_b32 s18, s51, 7
s_add_u32 s18, s18, 11552768
s_cmp_eq_u32 s13, 0
s_cselect_b32 s22, s18, s6
s_mov_b32 s23, 1
s_waitcnt vmcnt(0)
s_barrier
v_mov_b32 v3, s23
s_mov_b64 exec, 1
buffer_store_dword v3, off, s[4:7], s22 sc1
s_mov_b64 exec, -1
s_mov_b32 s22, s6
aend_64:
s_add_u32 s16, s16, 1
s_cmp_lt_u32 s16, 2
s_cbranch_scc1 alay_50
s_endpgm
L_fail:
s_mov_b64 exec, 1
v_mov_b32 v1, 0xdead
buffer_store_dword v1, off, s[8:11], 0 offset:4 sc1
L_end:
s_endpgm
L_chain:
s_waitcnt vmcnt(0)
s_nop 4
s_bitcmp1_b32 0xb5b5b5b5, s14
s_cbranch_scc0 grp_10001
s_bfm_b32 s24, s14, 0
s_and_b32 s24, s24, 0xb5b5b5b5
s_bcnt1_i32_b32 s24, s24
v_and_b32 v64, 63, v0
v_and_b32 v65, 15, v64
v_lshrrev_b32 v66, 4, v64
v_lshlrev_b32 v0, 4, v64
v_and_b32 v67, 2, v64
v_mov_b32 v68, 0x4444
v_mov_b32 v69, 0xeeee
v_cmp_eq_u32 vcc, 0, v67
s_nop 1
v_cndmask_b32 v1, v69, v68, vcc
s_mul_i32 s26, s13, 24576
s_add_u32 s26, s26, 65536
v_add_u32 v2, s26, v0
v_lshrrev_b32 v67, 2, v65
v_xor_b32 v68, v66, v67
v_lshlrev_b32 v68, 3, v68
v_lshl_add_u32 v68, v65, 5, v68
s_lshl_b32 s26, s13, 10
s_add_u32 s26, s26, 10240
v_add_u32 v3, s26, v68
v_lshl_add_u32 v68, v66, 2, v67
v_and_b32 v69, 3, v65
v_xor_b32 v69, v69, v66
v_lshlrev_b32 v69, 3, v69
v_lshl_add_u32 v68, v68, 5, v69
v_add_u32 v4, 10240, v68
v_and_b32 v69, 1, v65
v_lshl_add_u32 v68, v67, 1, v69
v_lshlrev_b32 v68, 4, v68
v_lshl_add_u32 v68, v66, 7, v68
v_add_u32 v5, 8192, v68
v_bfe_u32 v69, v65, 1, 1
v_mul_u32_u24 v69, 640, v69
v_xor_b32 v6, v69, v5
s_mov_b32 s42, 0x33333333
s_mov_b32 s43, 0x33333333
s_mov_b32 s44, 0x3f803f80
s_mov_b32 s45, 0x3f803f80
s_mov_b32 s46, 0x3f803f80
s_mov_b32 s47, 0
s_mov_b32 s37, 729808896
s_mov_b32 s38, 671088640
v_lshlrev_b32 v68, 3, v65
v_lshl_add_u32 v7, v66, 12, v68
s_lshl_b32 s26, s13, 14
s_lshl_b32 s27, s14, 7
s_add_u32 s26, s26, s27
s_add_u32 s90, s26, 65536
s_lshl_b32 s26, s13, 5
s_add_u32 s93, s26, s14
s_lshl_b32 s26, s93, 12
s_add_u32 s91, s26, 65536
s_lshr_b32 s26, s93, 2
s_lshl_b32 s26, s26, 9
s_and_b32 s27, s93, 3
s_lshl_b32 s27, s27, 6
s_add_u32 s26, s26, s27
s_add_u32 s92, s26, 393216
s_lshl_b32 s26, s14, 8
s_add_u32 s22, s26, 11534336
s_lshl_b32 s26, s24, 7
s_add_u32 s26, s26, 11550720
s_cmp_lt_u32 s24, 10
s_cselect_b32 s23, s26, 268435456
s_cselect_b32 s24, s24, 0
s_cselect_b32 s25, 12582912, s23
s_lshl_b32 s24, s24, 10
s_and_b32 s26, s14, 0
s_lshl_b32 s26, s26, 12
s_add_u32 s94, s26, 425984
s_lshl_b32 s26, s14, 7
s_add_u32 s95, s26, 425984
s_mov_b32 s35, 0x3e0293ee
s_lshl_b32 s26, s14, 2
s_add_u32 s26, s26, s13
s_mul_i32 s27, s26, 18432
s_add_u32 s89, s27, 1048576
s_add_u32 s48, s4, s90
s_addc_u32 s49, s5, 0
s_add_u32 s50, s90, 65536
s_add_u32 s50, s4, s50
s_addc_u32 s51, s5, 0
s_add_u32 s52, s90, 131072
s_add_u32 s52, s4, s52
s_addc_u32 s53, s5, 0
s_add_u32 s54, s90, 196608
s_add_u32 s54, s4, s54
s_addc_u32 s55, s5, 0
s_add_u32 s56, s90, 262144
s_add_u32 s56, s4, s56
s_addc_u32 s57, s5, 0
s_add_u32 s76, s89, 4096
s_add_u32 s76, s4, s76
s_addc_u32 s77, s5, 0
s_add_u32 s78, s89, 12288
s_add_u32 s78, s4, s78
s_addc_u32 s79, s5, 0
s_add_u32 s80, s89, 20480
s_add_u32 s80, s4, s80
s_addc_u32 s81, s5, 0
s_add_u32 s60, s4, s94
s_addc_u32 s61, s5, 0
s_add_u32 s62, s4, s95
s_addc_u32 s63, s5, 0
s_add_u32 s64, s4, s91
s_addc_u32 s65, s5, 0
s_add_u32 s66, s4, s92
s_addc_u32 s67, s5, 0
v_mov_b32 v72, 0
v_mov_b32 v73, 0
s_mov_b32 s26, s90
buffer_store_dwordx2 v[72:73], v7, s[4:7], s26 offen
s_add_u32 s26, s26, 65536
buffer_store_dwordx2 v[72:73], v7, s[4:7], s26 offen
s_add_u32 s26, s26, 65536
buffer_store_dwordx2 v[72:73], v7, s[4:7], s26 offen
s_add_u32 s26, s26, 65536
buffer_store_dwordx2 v[72:73], v7, s[4:7], s26 offen
s_add_u32 s26, s26, 65536
buffer_store_dwordx2 v[72:73], v7, s[4:7], s26 offen
s_add_u32 s26, s26, 65536
buffer_store_dword v72, off, s[4:7], s95 offset:0
s_load_dwordx2 s[96:97], s[0:1], 32
s_mov_b32 s98, 10240
s_mov_b32 s99, 0x20000
s_cmp_ge_u32 s93, 80
s_cbranch_scc1 nm0_10002
s_and_b32 s26, s93, 3
s_mul_i32 s26, s26, 2560
s_lshr_b32 s27, s93, 2
s_lshl_b32 s27, s27, 6
s_add_u32 s26, s26, s27
v_bfe_u32 v68, v65, 1, 2
v_lshlrev_b32 v68, 4, v68
v_and_b32 v69, 1, v65
v_lshl_add_u32 v68, v69, 2, v68
v_and_b32 v69, 1, v66
v_mul_u32_u24 v69, 1280, v69
v_add_u32 v68, v68, v69
s_waitcnt lgkmcnt(0)
buffer_load_dword v74, v68, s[96:99], s26 offen
buffer_load_dword v75, v68, s[96:99], s26 offen offset:8
v_and_b32 v68, 32, v0
v_bfe_u32 v69, v0, 6, 1
v_lshl_add_u32 v68, v69, 8, v68
v_bfe_u32 v69, v0, 8, 1
v_lshl_add_u32 v68, v69, 4, v68
v_bfe_u32 v69, v0, 4, 1
v_lshl_add_u32 v68, v69, 3, v68
s_add_u32 s27, s92, 16384
buffer_store_dwordx2 v[72:73], v68, s[4:7], s92 offen
s_waitcnt vmcnt(1)
buffer_store_dwordx2 v[74:75], v68, s[4:7], s27 offen
nm0_10002:
s_waitcnt vmcnt(0) lgkmcnt(0)
s_barrier
s_cmp_eq_u32 s13, 0
s_cselect_b32 s26, 144, s10
v_mov_b32 v74, 1
s_mov_b64 exec, 1
buffer_atomic_add v74, off, s[8:11], s26
s_mov_b64 exec, -1
v_lshrrev_b32 v67, 3, v64
v_and_b32 v68, 7, v64
v_lshlrev_b32 v68, 4, v68
v_lshl_add_u32 v32, v67, 13, v68
v_mul_u32_u24 v67, 1280, v67
v_add_u32 v36, v67, v68
v_lshrrev_b32 v67, 1, v66
v_lshlrev_b32 v67, 4, v67
v_and_b32 v68, 1, v66
v_lshl_add_u32 v67, v68, 1, v67
v_lshrrev_b32 v68, 3, v65
v_lshl_add_u32 v67, v68, 3, v67
v_bfe_u32 v68, v65, 2, 1
v_add_u32 v67, v67, v68
v_and_b32 v69, 3, v65
v_lshlrev_b32 v40, 4, v69
v_lshl_add_u32 v40, v67, 7, v40
v_lshl_add_u32 v67, v66, 2, v68
v_lshlrev_b32 v42, 4, v69
v_lshl_add_u32 v42, v67, 7, v42
v_lshrrev_b32 v68, 3, v65
v_lshl_add_u32 v42, v68, 3, v42
s_lshl_b32 s29, s13, 12
s_and_b32 s26, s13, 1
s_lshl_b32 s26, s26, 6
s_add_u32 s26, s26, s29
v_add_u32 v40, s26, v40
v_add_u32 v42, s26, v42
v_xor_b32 v41, 4096, v40
v_xor_b32 v43, 4096, v42
v_add_u32 v33, 64512, v32
v_add_u32 v37, 9216, v36
v_add_u32 v34, 129024, v32
v_add_u32 v38, 18432, v36
v_add_u32 v35, 193536, v32
v_add_u32 v39, 27648, v36
s_lshr_b32 s28, s13, 1
s_lshl_b32 s28, s28, 7
s_lshl_b32 s27, s14, 8
s_add_u32 s27, s27, s28
s_xor_b32 s26, s13, 0
s_lshl_b32 s82, s26, 19
s_add_u32 s82, s82, s27
s_lshl_b32 s85, s14, 2
s_add_u32 s85, s85, s26
s_mul_i32 s85, s85, 40960
s_add_u32 s85, s85, s28
s_xor_b32 s26, s13, 2
s_lshl_b32 s83, s26, 19
s_add_u32 s83, s83, s27
s_lshl_b32 s86, s14, 2
s_add_u32 s86, s86, s26
s_mul_i32 s86, s86, 40960
s_add_u32 s86, s86, s28
s_and_b32 s26, s13, 1
s_add_u32 s26, s26, 8
s_lshl_b32 s84, s26, 19
s_add_u32 s84, s84, s27
s_load_dwordx2 s[68:69], s[0:1], 40
s_load_dwordx2 s[70:71], s[0:1], 48
s_load_dwordx2 s[72:73], s[0:1], 56
s_load_dwordx2 s[74:75], s[0:1], 64
s_mov_b32 s98, 5242880
s_waitcnt lgkmcnt(0)
s_mov_b64 s[96:97], s[70:71]
s_add_u32 m0, s29, 0
s_add_u32 s26, s82, 0
buffer_load_dwordx4 v32, s[96:99], s26 offen offset:0 lds
buffer_load_dwordx4 v33, s[96:99], s26 offen offset:1024 lds
buffer_load_dwordx4 v34, s[96:99], s26 offen offset:2048 lds
buffer_load_dwordx4 v35, s[96:99], s26 offen offset:3072 lds
s_add_u32 m0, s29, 16384
s_add_u32 s26, s82, 262144
buffer_load_dwordx4 v32, s[96:99], s26 offen offset:0 lds
buffer_load_dwordx4 v33, s[96:99], s26 offen offset:1024 lds
buffer_load_dwordx4 v34, s[96:99], s26 offen offset:2048 lds
buffer_load_dwordx4 v35, s[96:99], s26 offen offset:3072 lds
s_add_u32 m0, s29, 32768
s_add_u32 s26, s82, 2097152
buffer_load_dwordx4 v32, s[96:99], s26 offen offset:0 lds
buffer_load_dwordx4 v33, s[96:99], s26 offen offset:1024 lds
buffer_load_dwordx4 v34, s[96:99], s26 offen offset:2048 lds
buffer_load_dwordx4 v35, s[96:99], s26 offen offset:3072 lds
s_waitcnt vmcnt(8)
s_barrier
s_add_u32 m0, s29, 49152
s_add_u32 s26, s82, 2359296
buffer_load_dwordx4 v32, s[96:99], s26 offen offset:0 lds
buffer_load_dwordx4 v33, s[96:99], s26 offen offset:1024 lds
buffer_load_dwordx4 v34, s[96:99], s26 offen offset:2048 lds
buffer_load_dwordx4 v35, s[96:99], s26 offen offset:3072 lds
ds_read_b64_tr_b16 a[0:1], v40 offset:0
ds_read_b64_tr_b16 a[2:3], v40 offset:512
ds_read_b64_tr_b16 v[72:73], v40 offset:8
ds_read_b64_tr_b16 v[74:75], v40 offset:520
ds_read_b64_tr_b16 a[104:105], v41 offset:0
ds_read_b64_tr_b16 a[106:107], v41 offset:512
ds_read_b64_tr_b16 a[112:113], v41 offset:8
ds_read_b64_tr_b16 a[114:115], v41 offset:520
s_waitcnt lgkmcnt(4)
global_store_dwordx4 v0, v[72:75], s[76:77] offset:0
s_waitcnt vmcnt(9) lgkmcnt(0)
s_barrier
s_add_u32 m0, s29, 0
s_add_u32 s26, s83, 0
buffer_load_dwordx4 v32, s[96:99], s26 offen offset:0 lds
buffer_load_dwordx4 v33, s[96:99], s26 offen offset:1024 lds
buffer_load_dwordx4 v34, s[96:99], s26 offen offset:2048 lds
buffer_load_dwordx4 v35, s[96:99], s26 offen offset:3072 lds
ds_read_b64_tr_b16 a[4:5], v40 offset:16384
ds_read_b64_tr_b16 a[6:7], v40 offset:16896
ds_read_b64_tr_b16 v[72:73], v40 offset:16392
ds_read_b64_tr_b16 v[74:75], v40 offset:16904
ds_read_b64_tr_b16 a[108:109], v41 offset:16384
ds_read_b64_tr_b16 a[110:111], v41 offset:16896
ds_read_b64_tr_b16 a[116:117], v41 offset:16392
ds_read_b64_tr_b16 a[118:119], v41 offset:16904
s_waitcnt lgkmcnt(4)
global_store_dwordx4 v0, v[72:75], s[76:77] offset:1024
s_waitcnt vmcnt(10) lgkmcnt(0)
s_barrier
s_add_u32 m0, s29, 16384
s_add_u32 s26, s83, 262144
buffer_load_dwordx4 v32, s[96:99], s26 offen offset:0 lds
buffer_load_dwordx4 v33, s[96:99], s26 offen offset:1024 lds
buffer_load_dwordx4 v34, s[96:99], s26 offen offset:2048 lds
buffer_load_dwordx4 v35, s[96:99], s26 offen offset:3072 lds
ds_read_b64_tr_b16 a[16:17], v40 offset:32768
ds_read_b64_tr_b16 a[18:19], v40 offset:33280
ds_read_b64_tr_b16 a[24:25], v40 offset:32776
ds_read_b64_tr_b16 a[26:27], v40 offset:33288
ds_read_b64_tr_b16 v[72:73], v41 offset:32768
ds_read_b64_tr_b16 v[74:75], v41 offset:33280
ds_read_b64_tr_b16 v[76:77], v41 offset:32776
ds_read_b64_tr_b16 v[78:79], v41 offset:33288
s_waitcnt lgkmcnt(2)
ds_write_b128 v2, v[72:75] offset:12288
s_waitcnt lgkmcnt(1)
global_store_dwordx4 v0, v[76:79], s[78:79] offset:-2048
s_waitcnt vmcnt(11)
s_barrier
s_add_u32 m0, s29, 32768
s_add_u32 s26, s83, 2097152
buffer_load_dwordx4 v32, s[96:99], s26 offen offset:0 lds
buffer_load_dwordx4 v33, s[96:99], s26 offen offset:1024 lds
buffer_load_dwordx4 v34, s[96:99], s26 offen offset:2048 lds
buffer_load_dwordx4 v35, s[96:99], s26 offen offset:3072 lds
ds_read_b64_tr_b16 a[20:21], v40 offset:49152
ds_read_b64_tr_b16 a[22:23], v40 offset:49664
ds_read_b64_tr_b16 a[28:29], v40 offset:49160
ds_read_b64_tr_b16 a[30:31], v40 offset:49672
ds_read_b64_tr_b16 v[72:73], v41 offset:49152
ds_read_b64_tr_b16 v[74:75], v41 offset:49664
ds_read_b64_tr_b16 v[76:77], v41 offset:49160
ds_read_b64_tr_b16 v[78:79], v41 offset:49672
s_waitcnt lgkmcnt(2)
ds_write_b128 v2, v[72:75] offset:13312
s_waitcnt lgkmcnt(1)
global_store_dwordx4 v0, v[76:79], s[78:79] offset:-1024
s_waitcnt vmcnt(11)
s_barrier
s_add_u32 m0, s29, 49152
s_add_u32 s26, s83, 2359296
buffer_load_dwordx4 v32, s[96:99], s26 offen offset:0 lds
buffer_load_dwordx4 v33, s[96:99], s26 offen offset:1024 lds
buffer_load_dwordx4 v34, s[96:99], s26 offen offset:2048 lds
buffer_load_dwordx4 v35, s[96:99], s26 offen offset:3072 lds
ds_read_b64_tr_b16 a[120:121], v40 offset:0
ds_read_b64_tr_b16 a[122:123], v40 offset:512
ds_read_b64_tr_b16 a[128:129], v40 offset:8
ds_read_b64_tr_b16 a[130:131], v40 offset:520
ds_read_b64_tr_b16 a[152:153], v41 offset:0
ds_read_b64_tr_b16 a[154:155], v41 offset:512
ds_read_b64_tr_b16 a[160:161], v41 offset:8
ds_read_b64_tr_b16 a[162:163], v41 offset:520
s_waitcnt vmcnt(10) lgkmcnt(0)
s_barrier
s_add_u32 m0, s29, 0
s_add_u32 s26, s84, 0
buffer_load_dwordx4 v32, s[96:99], s26 offen offset:0 lds
buffer_load_dwordx4 v33, s[96:99], s26 offen offset:1024 lds
buffer_load_dwordx4 v34, s[96:99], s26 offen offset:2048 lds
buffer_load_dwordx4 v35, s[96:99], s26 offen offset:3072 lds
ds_read_b64_tr_b16 a[124:125], v40 offset:16384
ds_read_b64_tr_b16 a[126:127], v40 offset:16896
ds_read_b64_tr_b16 a[132:133], v40 offset:16392
ds_read_b64_tr_b16 a[134:135], v40 offset:16904
ds_read_b64_tr_b16 a[156:157], v41 offset:16384
ds_read_b64_tr_b16 a[158:159], v41 offset:16896
ds_read_b64_tr_b16 a[164:165], v41 offset:16392
ds_read_b64_tr_b16 a[166:167], v41 offset:16904
s_waitcnt vmcnt(9) lgkmcnt(0)
s_barrier
s_add_u32 m0, s29, 16384
s_add_u32 s26, s84, 262144
buffer_load_dwordx4 v32, s[96:99], s26 offen offset:0 lds
buffer_load_dwordx4 v33, s[96:99], s26 offen offset:1024 lds
buffer_load_dwordx4 v34, s[96:99], s26 offen offset:2048 lds
buffer_load_dwordx4 v35, s[96:99], s26 offen offset:3072 lds
ds_read_b64_tr_b16 a[136:137], v40 offset:32768
ds_read_b64_tr_b16 a[138:139], v40 offset:33280
ds_read_b64_tr_b16 a[144:145], v40 offset:32776
ds_read_b64_tr_b16 a[146:147], v40 offset:33288
ds_read_b64_tr_b16 a[168:169], v41 offset:32768
ds_read_b64_tr_b16 a[170:171], v41 offset:33280
ds_read_b64_tr_b16 v[72:73], v41 offset:32776
ds_read_b64_tr_b16 v[74:75], v41 offset:33288
s_waitcnt lgkmcnt(0)
ds_write_b128 v2, v[72:75] offset:14336
s_waitcnt vmcnt(8)
s_barrier
s_mov_b64 s[96:97], s[72:73]
s_add_u32 m0, s29, 32768
s_add_u32 s26, s82, 0
buffer_load_dwordx4 v32, s[96:99], s26 offen offset:0 lds
buffer_load_dwordx4 v33, s[96:99], s26 offen offset:1024 lds
buffer_load_dwordx4 v34, s[96:99], s26 offen offset:2048 lds
buffer_load_dwordx4 v35, s[96:99], s26 offen offset:3072 lds
ds_read_b64_tr_b16 a[140:141], v40 offset:49152
ds_read_b64_tr_b16 a[142:143], v40 offset:49664
ds_read_b64_tr_b16 a[148:149], v40 offset:49160
ds_read_b64_tr_b16 a[150:151], v40 offset:49672
ds_read_b64_tr_b16 a[172:173], v41 offset:49152
ds_read_b64_tr_b16 a[174:175], v41 offset:49664
ds_read_b64_tr_b16 v[72:73], v41 offset:49160
ds_read_b64_tr_b16 v[74:75], v41 offset:49672
s_waitcnt lgkmcnt(0)
ds_write_b128 v2, v[72:75] offset:15360
s_waitcnt vmcnt(8)
s_barrier
s_add_u32 m0, s29, 49152
s_add_u32 s26, s82, 262144
buffer_load_dwordx4 v32, s[96:99], s26 offen offset:0 lds
buffer_load_dwordx4 v33, s[96:99], s26 offen offset:1024 lds
buffer_load_dwordx4 v34, s[96:99], s26 offen offset:2048 lds
buffer_load_dwordx4 v35, s[96:99], s26 offen offset:3072 lds
ds_read_b64_tr_b16 a[176:177], v40 offset:0
ds_read_b64_tr_b16 a[178:179], v40 offset:512
ds_read_b64_tr_b16 v[72:73], v40 offset:8
ds_read_b64_tr_b16 v[74:75], v40 offset:520
ds_read_b64_tr_b16 a[184:185], v41 offset:0
ds_read_b64_tr_b16 a[186:187], v41 offset:512
ds_read_b64_tr_b16 a[192:193], v41 offset:8
ds_read_b64_tr_b16 a[194:195], v41 offset:520
s_waitcnt lgkmcnt(4)
ds_write_b128 v2, v[72:75] offset:16384
s_waitcnt vmcnt(8) lgkmcnt(1)
s_barrier
s_add_u32 m0, s29, 0
s_add_u32 s26, s82, 2097152
buffer_load_dwordx4 v32, s[96:99], s26 offen offset:0 lds
buffer_load_dwordx4 v33, s[96:99], s26 offen offset:1024 lds
buffer_load_dwordx4 v34, s[96:99], s26 offen offset:2048 lds
buffer_load_dwordx4 v35, s[96:99], s26 offen offset:3072 lds
ds_read_b64_tr_b16 a[180:181], v40 offset:16384
ds_read_b64_tr_b16 a[182:183], v40 offset:16896
ds_read_b64_tr_b16 v[72:73], v40 offset:16392
ds_read_b64_tr_b16 v[74:75], v40 offset:16904
ds_read_b64_tr_b16 a[188:189], v41 offset:16384
ds_read_b64_tr_b16 a[190:191], v41 offset:16896
ds_read_b64_tr_b16 a[196:197], v41 offset:16392
ds_read_b64_tr_b16 a[198:199], v41 offset:16904
s_waitcnt lgkmcnt(4)
ds_write_b128 v2, v[72:75] offset:17408
s_waitcnt vmcnt(8) lgkmcnt(1)
s_barrier
s_add_u32 m0, s29, 16384
s_add_u32 s26, s82, 2359296
buffer_load_dwordx4 v32, s[96:99], s26 offen offset:0 lds
buffer_load_dwordx4 v33, s[96:99], s26 offen offset:1024 lds
buffer_load_dwordx4 v34, s[96:99], s26 offen offset:2048 lds
buffer_load_dwordx4 v35, s[96:99], s26 offen offset:3072 lds
ds_read_b64_tr_b16 v[72:73], v40 offset:32768
ds_read_b64_tr_b16 v[74:75], v40 offset:33280
ds_read_b64_tr_b16 a[224:225], v40 offset:32776
ds_read_b64_tr_b16 a[226:227], v40 offset:33288
ds_read_b64_tr_b16 v[76:77], v41 offset:32768
ds_read_b64_tr_b16 v[78:79], v41 offset:33280
ds_read_b64_tr_b16 v[8:9], v41 offset:32776
ds_read_b64_tr_b16 v[10:11], v41 offset:33288
s_waitcnt lgkmcnt(6)
ds_write_b128 v2, v[72:75] offset:20480
s_waitcnt lgkmcnt(3)
ds_write_b128 v2, v[76:79] offset:22528
s_waitcnt vmcnt(8) lgkmcnt(2)
s_barrier
s_add_u32 m0, s29, 32768
s_add_u32 s26, s83, 0
buffer_load_dwordx4 v32, s[96:99], s26 offen offset:0 lds
buffer_load_dwordx4 v33, s[96:99], s26 offen offset:1024 lds
buffer_load_dwordx4 v34, s[96:99], s26 offen offset:2048 lds
buffer_load_dwordx4 v35, s[96:99], s26 offen offset:3072 lds
ds_read_b64_tr_b16 v[72:73], v40 offset:49152
ds_read_b64_tr_b16 v[74:75], v40 offset:49664
ds_read_b64_tr_b16 a[228:229], v40 offset:49160
ds_read_b64_tr_b16 a[230:231], v40 offset:49672
ds_read_b64_tr_b16 v[76:77], v41 offset:49152
ds_read_b64_tr_b16 v[78:79], v41 offset:49664
ds_read_b64_tr_b16 v[12:13], v41 offset:49160
ds_read_b64_tr_b16 v[14:15], v41 offset:49672
s_waitcnt lgkmcnt(6)
ds_write_b128 v2, v[72:75] offset:21504
s_waitcnt lgkmcnt(3)
ds_write_b128 v2, v[76:79] offset:23552
s_waitcnt vmcnt(8) lgkmcnt(2)
s_barrier
s_add_u32 m0, s29, 49152
s_add_u32 s26, s83, 262144
buffer_load_dwordx4 v32, s[96:99], s26 offen offset:0 lds
buffer_load_dwordx4 v33, s[96:99], s26 offen offset:1024 lds
buffer_load_dwordx4 v34, s[96:99], s26 offen offset:2048 lds
buffer_load_dwordx4 v35, s[96:99], s26 offen offset:3072 lds
ds_read_b64_tr_b16 a[232:233], v40 offset:0
ds_read_b64_tr_b16 a[234:235], v40 offset:512
ds_read_b64_tr_b16 a[240:241], v40 offset:8
ds_read_b64_tr_b16 a[242:243], v40 offset:520
ds_read_b64_tr_b16 a[248:249], v41 offset:0
ds_read_b64_tr_b16 a[250:251], v41 offset:512
ds_read_b64_tr_b16 v[88:89], v41 offset:8
ds_read_b64_tr_b16 v[90:91], v41 offset:520
s_waitcnt vmcnt(8) lgkmcnt(0)
s_barrier
s_add_u32 m0, s29, 0
s_add_u32 s26, s83, 2097152
buffer_load_dwordx4 v32, s[96:99], s26 offen offset:0 lds
buffer_load_dwordx4 v33, s[96:99], s26 offen offset:1024 lds
buffer_load_dwordx4 v34, s[96:99], s26 offen offset:2048 lds
buffer_load_dwordx4 v35, s[96:99], s26 offen offset:3072 lds
ds_read_b64_tr_b16 a[236:237], v40 offset:16384
ds_read_b64_tr_b16 a[238:239], v40 offset:16896
ds_read_b64_tr_b16 a[244:245], v40 offset:16392
ds_read_b64_tr_b16 a[246:247], v40 offset:16904
ds_read_b64_tr_b16 a[252:253], v41 offset:16384
ds_read_b64_tr_b16 a[254:255], v41 offset:16896
ds_read_b64_tr_b16 v[92:93], v41 offset:16392
ds_read_b64_tr_b16 v[94:95], v41 offset:16904
s_waitcnt vmcnt(8) lgkmcnt(0)
s_barrier
s_add_u32 m0, s29, 16384
s_add_u32 s26, s83, 2359296
buffer_load_dwordx4 v32, s[96:99], s26 offen offset:0 lds
buffer_load_dwordx4 v33, s[96:99], s26 offen offset:1024 lds
buffer_load_dwordx4 v34, s[96:99], s26 offen offset:2048 lds
buffer_load_dwordx4 v35, s[96:99], s26 offen offset:3072 lds
ds_read_b64_tr_b16 v[96:97], v40 offset:32768
ds_read_b64_tr_b16 v[98:99], v40 offset:33280
ds_read_b64_tr_b16 v[104:105], v40 offset:32776
ds_read_b64_tr_b16 v[106:107], v40 offset:33288
ds_read_b64_tr_b16 v[128:129], v41 offset:32768
ds_read_b64_tr_b16 v[130:131], v41 offset:33280
ds_read_b64_tr_b16 v[136:137], v41 offset:32776
ds_read_b64_tr_b16 v[138:139], v41 offset:33288
s_waitcnt vmcnt(8) lgkmcnt(0)
s_barrier
s_add_u32 m0, s29, 32768
s_add_u32 s26, s84, 0
buffer_load_dwordx4 v32, s[96:99], s26 offen offset:0 lds
buffer_load_dwordx4 v33, s[96:99], s26 offen offset:1024 lds
buffer_load_dwordx4 v34, s[96:99], s26 offen offset:2048 lds
buffer_load_dwordx4 v35, s[96:99], s26 offen offset:3072 lds
ds_read_b64_tr_b16 v[100:101], v40 offset:49152
ds_read_b64_tr_b16 v[102:103], v40 offset:49664
ds_read_b64_tr_b16 v[108:109], v40 offset:49160
ds_read_b64_tr_b16 v[110:111], v40 offset:49672
ds_read_b64_tr_b16 v[132:133], v41 offset:49152
ds_read_b64_tr_b16 v[134:135], v41 offset:49664
ds_read_b64_tr_b16 v[140:141], v41 offset:49160
ds_read_b64_tr_b16 v[142:143], v41 offset:49672
s_waitcnt vmcnt(8) lgkmcnt(0)
s_barrier
s_add_u32 m0, s29, 49152
s_add_u32 s26, s84, 262144
buffer_load_dwordx4 v32, s[96:99], s26 offen offset:0 lds
buffer_load_dwordx4 v33, s[96:99], s26 offen offset:1024 lds
buffer_load_dwordx4 v34, s[96:99], s26 offen offset:2048 lds
buffer_load_dwordx4 v35, s[96:99], s26 offen offset:3072 lds
ds_read_b64_tr_b16 v[112:113], v40 offset:0
ds_read_b64_tr_b16 v[114:115], v40 offset:512
ds_read_b64_tr_b16 v[120:121], v40 offset:8
ds_read_b64_tr_b16 v[122:123], v40 offset:520
ds_read_b64_tr_b16 v[144:145], v41 offset:0
ds_read_b64_tr_b16 v[146:147], v41 offset:512
ds_read_b64_tr_b16 v[152:153], v41 offset:8
ds_read_b64_tr_b16 v[154:155], v41 offset:520
s_waitcnt vmcnt(8) lgkmcnt(0)
s_barrier
s_mov_b64 s[96:97], s[68:69]
s_add_u32 m0, s29, 0
s_add_u32 s26, s82, 0
buffer_load_dwordx4 v32, s[96:99], s26 offen offset:0 lds
buffer_load_dwordx4 v33, s[96:99], s26 offen offset:1024 lds
buffer_load_dwordx4 v34, s[96:99], s26 offen offset:2048 lds
buffer_load_dwordx4 v35, s[96:99], s26 offen offset:3072 lds
ds_read_b64_tr_b16 v[116:117], v40 offset:16384
ds_read_b64_tr_b16 v[118:119], v40 offset:16896
ds_read_b64_tr_b16 v[124:125], v40 offset:16392
ds_read_b64_tr_b16 v[126:127], v40 offset:16904
ds_read_b64_tr_b16 v[148:149], v41 offset:16384
ds_read_b64_tr_b16 v[150:151], v41 offset:16896
ds_read_b64_tr_b16 v[156:157], v41 offset:16392
ds_read_b64_tr_b16 v[158:159], v41 offset:16904
s_waitcnt vmcnt(8) lgkmcnt(0)
s_barrier
s_add_u32 m0, s29, 16384
s_add_u32 s26, s82, 262144
buffer_load_dwordx4 v32, s[96:99], s26 offen offset:0 lds
buffer_load_dwordx4 v33, s[96:99], s26 offen offset:1024 lds
buffer_load_dwordx4 v34, s[96:99], s26 offen offset:2048 lds
buffer_load_dwordx4 v35, s[96:99], s26 offen offset:3072 lds
ds_read_b64_tr_b16 a[200:201], v40 offset:32768
ds_read_b64_tr_b16 a[202:203], v40 offset:33280
ds_read_b64_tr_b16 a[208:209], v40 offset:32776
ds_read_b64_tr_b16 a[210:211], v40 offset:33288
ds_read_b64_tr_b16 v[72:73], v41 offset:32768
ds_read_b64_tr_b16 v[74:75], v41 offset:33280
ds_read_b64_tr_b16 a[216:217], v41 offset:32776
ds_read_b64_tr_b16 a[218:219], v41 offset:33288
s_waitcnt lgkmcnt(2)
ds_write_b128 v2, v[72:75] offset:18432
s_waitcnt vmcnt(8) lgkmcnt(1)
s_barrier
s_add_u32 m0, s29, 32768
s_add_u32 s26, s82, 2097152
buffer_load_dwordx4 v32, s[96:99], s26 offen offset:0 lds
buffer_load_dwordx4 v33, s[96:99], s26 offen offset:1024 lds
buffer_load_dwordx4 v34, s[96:99], s26 offen offset:2048 lds
buffer_load_dwordx4 v35, s[96:99], s26 offen offset:3072 lds
ds_read_b64_tr_b16 a[204:205], v40 offset:49152
ds_read_b64_tr_b16 a[206:207], v40 offset:49664
ds_read_b64_tr_b16 a[212:213], v40 offset:49160
ds_read_b64_tr_b16 a[214:215], v40 offset:49672
ds_read_b64_tr_b16 v[72:73], v41 offset:49152
ds_read_b64_tr_b16 v[74:75], v41 offset:49664
ds_read_b64_tr_b16 a[220:221], v41 offset:49160
ds_read_b64_tr_b16 a[222:223], v41 offset:49672
s_waitcnt lgkmcnt(2)
ds_write_b128 v2, v[72:75] offset:19456
s_waitcnt vmcnt(8) lgkmcnt(1)
s_barrier
s_add_u32 m0, s29, 49152
s_add_u32 s26, s82, 2359296
buffer_load_dwordx4 v32, s[96:99], s26 offen offset:0 lds
buffer_load_dwordx4 v33, s[96:99], s26 offen offset:1024 lds
buffer_load_dwordx4 v34, s[96:99], s26 offen offset:2048 lds
buffer_load_dwordx4 v35, s[96:99], s26 offen offset:3072 lds
ds_read_b64_tr_b16 v[72:73], v40 offset:0
ds_read_b64_tr_b16 v[74:75], v40 offset:512
ds_read_b64_tr_b16 v[76:77], v40 offset:8
ds_read_b64_tr_b16 v[78:79], v40 offset:520
ds_read_b64_tr_b16 v[80:81], v41 offset:0
ds_read_b64_tr_b16 v[82:83], v41 offset:512
ds_read_b64_tr_b16 a[32:33], v41 offset:8
ds_read_b64_tr_b16 a[34:35], v41 offset:520
s_waitcnt lgkmcnt(6)
global_store_dwordx4 v0, v[72:75], s[76:77] offset:-4096
s_waitcnt lgkmcnt(4)
global_store_dwordx4 v0, v[76:79], s[76:77] offset:-2048
s_waitcnt lgkmcnt(2)
ds_write_b128 v2, v[80:83] offset:0
s_waitcnt vmcnt(10) lgkmcnt(1)
s_barrier
s_add_u32 m0, s29, 0
s_add_u32 s26, s83, 0
buffer_load_dwordx4 v32, s[96:99], s26 offen offset:0 lds
buffer_load_dwordx4 v33, s[96:99], s26 offen offset:1024 lds
buffer_load_dwordx4 v34, s[96:99], s26 offen offset:2048 lds
buffer_load_dwordx4 v35, s[96:99], s26 offen offset:3072 lds
ds_read_b64_tr_b16 v[72:73], v40 offset:16384
ds_read_b64_tr_b16 v[74:75], v40 offset:16896
ds_read_b64_tr_b16 v[76:77], v40 offset:16392
ds_read_b64_tr_b16 v[78:79], v40 offset:16904
ds_read_b64_tr_b16 v[80:81], v41 offset:16384
ds_read_b64_tr_b16 v[82:83], v41 offset:16896
ds_read_b64_tr_b16 a[36:37], v41 offset:16392
ds_read_b64_tr_b16 a[38:39], v41 offset:16904
s_waitcnt lgkmcnt(6)
global_store_dwordx4 v0, v[72:75], s[76:77] offset:-3072
s_waitcnt lgkmcnt(4)
global_store_dwordx4 v0, v[76:79], s[76:77] offset:-1024
s_waitcnt lgkmcnt(2)
ds_write_b128 v2, v[80:83] offset:1024
s_waitcnt vmcnt(12) lgkmcnt(1)
s_barrier
s_add_u32 m0, s29, 16384
s_add_u32 s26, s83, 262144
buffer_load_dwordx4 v32, s[96:99], s26 offen offset:0 lds
buffer_load_dwordx4 v33, s[96:99], s26 offen offset:1024 lds
buffer_load_dwordx4 v34, s[96:99], s26 offen offset:2048 lds
buffer_load_dwordx4 v35, s[96:99], s26 offen offset:3072 lds
ds_read_b64_tr_b16 v[72:73], v40 offset:32768
ds_read_b64_tr_b16 v[74:75], v40 offset:33280
ds_read_b64_tr_b16 a[8:9], v40 offset:32776
ds_read_b64_tr_b16 a[10:11], v40 offset:33288
ds_read_b64_tr_b16 a[40:41], v41 offset:32768
ds_read_b64_tr_b16 a[42:43], v41 offset:33280
ds_read_b64_tr_b16 v[76:77], v41 offset:32776
ds_read_b64_tr_b16 v[78:79], v41 offset:33288
s_waitcnt lgkmcnt(6)
global_store_dwordx4 v0, v[72:75], s[76:77] offset:2048
s_waitcnt lgkmcnt(0)
global_store_dwordx4 v0, v[76:79], s[78:79] offset:-4096
s_waitcnt vmcnt(14)
s_barrier
s_add_u32 m0, s29, 32768
s_add_u32 s26, s83, 2097152
buffer_load_dwordx4 v32, s[96:99], s26 offen offset:0 lds
buffer_load_dwordx4 v33, s[96:99], s26 offen offset:1024 lds
buffer_load_dwordx4 v34, s[96:99], s26 offen offset:2048 lds
buffer_load_dwordx4 v35, s[96:99], s26 offen offset:3072 lds
ds_read_b64_tr_b16 v[72:73], v40 offset:49152
ds_read_b64_tr_b16 v[74:75], v40 offset:49664
ds_read_b64_tr_b16 a[12:13], v40 offset:49160
ds_read_b64_tr_b16 a[14:15], v40 offset:49672
ds_read_b64_tr_b16 a[44:45], v41 offset:49152
ds_read_b64_tr_b16 a[46:47], v41 offset:49664
ds_read_b64_tr_b16 v[76:77], v41 offset:49160
ds_read_b64_tr_b16 v[78:79], v41 offset:49672
s_waitcnt lgkmcnt(6)
global_store_dwordx4 v0, v[72:75], s[76:77] offset:3072
s_waitcnt lgkmcnt(0)
global_store_dwordx4 v0, v[76:79], s[78:79] offset:-3072
s_waitcnt vmcnt(14)
s_barrier
s_add_u32 m0, s29, 49152
s_add_u32 s26, s83, 2359296
buffer_load_dwordx4 v32, s[96:99], s26 offen offset:0 lds
buffer_load_dwordx4 v33, s[96:99], s26 offen offset:1024 lds
buffer_load_dwordx4 v34, s[96:99], s26 offen offset:2048 lds
buffer_load_dwordx4 v35, s[96:99], s26 offen offset:3072 lds
ds_read_b64_tr_b16 a[48:49], v40 offset:0
ds_read_b64_tr_b16 a[50:51], v40 offset:512
ds_read_b64_tr_b16 a[56:57], v40 offset:8
ds_read_b64_tr_b16 a[58:59], v40 offset:520
ds_read_b64_tr_b16 v[72:73], v41 offset:0
ds_read_b64_tr_b16 v[74:75], v41 offset:512
ds_read_b64_tr_b16 v[76:77], v41 offset:8
ds_read_b64_tr_b16 v[78:79], v41 offset:520
s_waitcnt lgkmcnt(2)
ds_write_b128 v2, v[72:75] offset:4096
s_waitcnt lgkmcnt(1)
ds_write_b128 v2, v[76:79] offset:6144
s_waitcnt vmcnt(12)
s_barrier
s_add_u32 m0, s29, 0
s_add_u32 s26, s84, 0
buffer_load_dwordx4 v32, s[96:99], s26 offen offset:0 lds
buffer_load_dwordx4 v33, s[96:99], s26 offen offset:1024 lds
buffer_load_dwordx4 v34, s[96:99], s26 offen offset:2048 lds
buffer_load_dwordx4 v35, s[96:99], s26 offen offset:3072 lds
ds_read_b64_tr_b16 a[52:53], v40 offset:16384
ds_read_b64_tr_b16 a[54:55], v40 offset:16896
ds_read_b64_tr_b16 a[60:61], v40 offset:16392
ds_read_b64_tr_b16 a[62:63], v40 offset:16904
ds_read_b64_tr_b16 v[72:73], v41 offset:16384
ds_read_b64_tr_b16 v[74:75], v41 offset:16896
ds_read_b64_tr_b16 v[76:77], v41 offset:16392
ds_read_b64_tr_b16 v[78:79], v41 offset:16904
s_waitcnt lgkmcnt(2)
ds_write_b128 v2, v[72:75] offset:5120
s_waitcnt lgkmcnt(1)
ds_write_b128 v2, v[76:79] offset:7168
s_waitcnt vmcnt(10)
s_barrier
s_add_u32 m0, s29, 16384
s_add_u32 s26, s84, 262144
buffer_load_dwordx4 v32, s[96:99], s26 offen offset:0 lds
buffer_load_dwordx4 v33, s[96:99], s26 offen offset:1024 lds
buffer_load_dwordx4 v34, s[96:99], s26 offen offset:2048 lds
buffer_load_dwordx4 v35, s[96:99], s26 offen offset:3072 lds
ds_read_b64_tr_b16 v[72:73], v40 offset:32768
ds_read_b64_tr_b16 v[74:75], v40 offset:33280
ds_read_b64_tr_b16 a[64:65], v40 offset:32776
ds_read_b64_tr_b16 a[66:67], v40 offset:33288
ds_read_b64_tr_b16 a[72:73], v41 offset:32768
ds_read_b64_tr_b16 a[74:75], v41 offset:33280
ds_read_b64_tr_b16 a[80:81], v41 offset:32776
ds_read_b64_tr_b16 a[82:83], v41 offset:33288
s_waitcnt lgkmcnt(6)
ds_write_b128 v2, v[72:75] offset:2048
s_waitcnt vmcnt(8) lgkmcnt(1)
s_barrier
s_mov_b64 s[96:97], s[74:75]
s_add_u32 m0, s29, 32768
s_add_u32 s26, s85, 0
buffer_load_dwordx4 v36, s[96:99], s26 offen offset:0 lds
buffer_load_dwordx4 v37, s[96:99], s26 offen offset:1024 lds
buffer_load_dwordx4 v38, s[96:99], s26 offen offset:2048 lds
buffer_load_dwordx4 v39, s[96:99], s26 offen offset:3072 lds
ds_read_b64_tr_b16 v[72:73], v40 offset:49152
ds_read_b64_tr_b16 v[74:75], v40 offset:49664
ds_read_b64_tr_b16 a[68:69], v40 offset:49160
ds_read_b64_tr_b16 a[70:71], v40 offset:49672
ds_read_b64_tr_b16 a[76:77], v41 offset:49152
ds_read_b64_tr_b16 a[78:79], v41 offset:49664
ds_read_b64_tr_b16 a[84:85], v41 offset:49160
ds_read_b64_tr_b16 a[86:87], v41 offset:49672
s_waitcnt lgkmcnt(6)
ds_write_b128 v2, v[72:75] offset:3072
s_waitcnt vmcnt(8) lgkmcnt(1)
s_barrier
s_add_u32 m0, s29, 49152
s_add_u32 s26, s86, 0
buffer_load_dwordx4 v36, s[96:99], s26 offen offset:0 lds
buffer_load_dwordx4 v37, s[96:99], s26 offen offset:1024 lds
buffer_load_dwordx4 v38, s[96:99], s26 offen offset:2048 lds
buffer_load_dwordx4 v39, s[96:99], s26 offen offset:3072 lds
ds_read_b64_tr_b16 v[72:73], v40 offset:0
ds_read_b64_tr_b16 v[74:75], v40 offset:512
ds_read_b64_tr_b16 a[88:89], v40 offset:8
ds_read_b64_tr_b16 a[90:91], v40 offset:520
ds_read_b64_tr_b16 a[96:97], v41 offset:0
ds_read_b64_tr_b16 a[98:99], v41 offset:512
ds_read_b64_tr_b16 v[76:77], v41 offset:8
ds_read_b64_tr_b16 v[78:79], v41 offset:520
s_waitcnt lgkmcnt(6)
ds_write_b128 v2, v[72:75] offset:8192
s_waitcnt lgkmcnt(1)
ds_write_b128 v2, v[76:79] offset:10240
s_waitcnt vmcnt(8)
s_barrier
s_add_u32 m0, s29, 0
s_add_u32 s26, s85, 256
buffer_load_dwordx4 v36, s[96:99], s26 offen offset:0 lds
buffer_load_dwordx4 v37, s[96:99], s26 offen offset:1024 lds
buffer_load_dwordx4 v38, s[96:99], s26 offen offset:2048 lds
buffer_load_dwordx4 v39, s[96:99], s26 offen offset:3072 lds
ds_read_b64_tr_b16 v[72:73], v40 offset:16384
ds_read_b64_tr_b16 v[74:75], v40 offset:16896
ds_read_b64_tr_b16 a[92:93], v40 offset:16392
ds_read_b64_tr_b16 a[94:95], v40 offset:16904
ds_read_b64_tr_b16 a[100:101], v41 offset:16384
ds_read_b64_tr_b16 a[102:103], v41 offset:16896
ds_read_b64_tr_b16 v[76:77], v41 offset:16392
ds_read_b64_tr_b16 v[78:79], v41 offset:16904
s_waitcnt lgkmcnt(6)
ds_write_b128 v2, v[72:75] offset:9216
s_waitcnt lgkmcnt(1)
ds_write_b128 v2, v[76:79] offset:11264
s_waitcnt vmcnt(8)
s_barrier
s_add_u32 m0, s29, 16384
s_add_u32 s26, s86, 256
buffer_load_dwordx4 v36, s[96:99], s26 offen offset:0 lds
buffer_load_dwordx4 v37, s[96:99], s26 offen offset:1024 lds
buffer_load_dwordx4 v38, s[96:99], s26 offen offset:2048 lds
buffer_load_dwordx4 v39, s[96:99], s26 offen offset:3072 lds
ds_read_b64_tr_b16 v[160:161], v42 offset:32768
ds_read_b64_tr_b16 v[162:163], v42 offset:33024
ds_read_b64_tr_b16 v[164:165], v42 offset:34816
ds_read_b64_tr_b16 v[166:167], v42 offset:35072
ds_read_b64_tr_b16 v[184:185], v43 offset:32768
ds_read_b64_tr_b16 v[186:187], v43 offset:33024
ds_read_b64_tr_b16 v[188:189], v43 offset:34816
ds_read_b64_tr_b16 v[190:191], v43 offset:35072
s_waitcnt vmcnt(8) lgkmcnt(0)
s_barrier
s_add_u32 m0, s29, 32768
s_add_u32 s26, s85, 512
buffer_load_dwordx4 v36, s[96:99], s26 offen offset:0 lds
buffer_load_dwordx4 v37, s[96:99], s26 offen offset:1024 lds
buffer_load_dwordx4 v38, s[96:99], s26 offen offset:2048 lds
buffer_load_dwordx4 v39, s[96:99], s26 offen offset:3072 lds
ds_read_b64_tr_b16 v[16:17], v42 offset:49152
ds_read_b64_tr_b16 v[18:19], v42 offset:49408
ds_read_b64_tr_b16 v[20:21], v42 offset:51200
ds_read_b64_tr_b16 v[22:23], v42 offset:51456
ds_read_b64_tr_b16 v[24:25], v43 offset:49152
ds_read_b64_tr_b16 v[26:27], v43 offset:49408
ds_read_b64_tr_b16 v[28:29], v43 offset:51200
ds_read_b64_tr_b16 v[30:31], v43 offset:51456
s_waitcnt vmcnt(8) lgkmcnt(0)
s_barrier
s_add_u32 m0, s29, 49152
s_add_u32 s26, s86, 512
buffer_load_dwordx4 v36, s[96:99], s26 offen offset:0 lds
buffer_load_dwordx4 v37, s[96:99], s26 offen offset:1024 lds
buffer_load_dwordx4 v38, s[96:99], s26 offen offset:2048 lds
buffer_load_dwordx4 v39, s[96:99], s26 offen offset:3072 lds
ds_read_b64_tr_b16 v[72:73], v42 offset:0
ds_read_b64_tr_b16 v[74:75], v42 offset:256
ds_read_b64_tr_b16 v[76:77], v42 offset:2048
ds_read_b64_tr_b16 v[78:79], v42 offset:2304
ds_read_b64_tr_b16 v[192:193], v43 offset:0
ds_read_b64_tr_b16 v[194:195], v43 offset:256
ds_read_b64_tr_b16 v[196:197], v43 offset:2048
ds_read_b64_tr_b16 v[198:199], v43 offset:2304
s_waitcnt lgkmcnt(6)
global_store_dwordx4 v0, v[72:75], s[78:79] offset:0
s_waitcnt lgkmcnt(4)
global_store_dwordx4 v0, v[76:79], s[78:79] offset:1024
s_waitcnt vmcnt(10) lgkmcnt(0)
s_barrier
s_add_u32 m0, s29, 0
s_add_u32 s26, s85, 768
buffer_load_dwordx4 v36, s[96:99], s26 offen offset:0 lds
buffer_load_dwordx4 v37, s[96:99], s26 offen offset:1024 lds
buffer_load_dwordx4 v38, s[96:99], s26 offen offset:2048 lds
buffer_load_dwordx4 v39, s[96:99], s26 offen offset:3072 lds
ds_read_b64_tr_b16 v[72:73], v42 offset:16384
ds_read_b64_tr_b16 v[74:75], v42 offset:16640
ds_read_b64_tr_b16 v[76:77], v42 offset:18432
ds_read_b64_tr_b16 v[78:79], v42 offset:18688
ds_read_b64_tr_b16 v[48:49], v43 offset:16384
ds_read_b64_tr_b16 v[50:51], v43 offset:16640
ds_read_b64_tr_b16 v[52:53], v43 offset:18432
ds_read_b64_tr_b16 v[54:55], v43 offset:18688
s_waitcnt lgkmcnt(6)
global_store_dwordx4 v0, v[72:75], s[80:81] offset:-4096
s_waitcnt lgkmcnt(4)
global_store_dwordx4 v0, v[76:79], s[80:81] offset:-3072
s_waitcnt vmcnt(12) lgkmcnt(0)
s_barrier
s_add_u32 m0, s29, 16384
s_add_u32 s26, s86, 768
buffer_load_dwordx4 v36, s[96:99], s26 offen offset:0 lds
buffer_load_dwordx4 v37, s[96:99], s26 offen offset:1024 lds
buffer_load_dwordx4 v38, s[96:99], s26 offen offset:2048 lds
buffer_load_dwordx4 v39, s[96:99], s26 offen offset:3072 lds
ds_read_b64_tr_b16 v[168:169], v42 offset:32768
ds_read_b64_tr_b16 v[170:171], v42 offset:33024
ds_read_b64_tr_b16 v[172:173], v42 offset:34816
ds_read_b64_tr_b16 v[174:175], v42 offset:35072
ds_read_b64_tr_b16 v[200:201], v43 offset:32768
ds_read_b64_tr_b16 v[202:203], v43 offset:33024
ds_read_b64_tr_b16 v[204:205], v43 offset:34816
ds_read_b64_tr_b16 v[206:207], v43 offset:35072
s_waitcnt vmcnt(12) lgkmcnt(0)
s_barrier
s_add_u32 m0, s29, 32768
s_add_u32 s26, s85, 1024
buffer_load_dwordx4 v36, s[96:99], s26 offen offset:0 lds
buffer_load_dwordx4 v37, s[96:99], s26 offen offset:1024 lds
buffer_load_dwordx4 v38, s[96:99], s26 offen offset:2048 lds
buffer_load_dwordx4 v39, s[96:99], s26 offen offset:3072 lds
ds_read_b64_tr_b16 v[208:209], v42 offset:49152
ds_read_b64_tr_b16 v[210:211], v42 offset:49408
ds_read_b64_tr_b16 v[212:213], v42 offset:51200
ds_read_b64_tr_b16 v[214:215], v42 offset:51456
ds_read_b64_tr_b16 v[56:57], v43 offset:49152
ds_read_b64_tr_b16 v[58:59], v43 offset:49408
ds_read_b64_tr_b16 v[60:61], v43 offset:51200
ds_read_b64_tr_b16 v[62:63], v43 offset:51456
v_lshrrev_b32 v44, 4, v0
v_and_b32 v44, 15, v44
v_lshlrev_b32 v44, 4, v44
buffer_load_dword v45, v44, s[8:11], 0 offen sc1
s_waitcnt vmcnt(11) lgkmcnt(0)
s_barrier
s_add_u32 m0, s29, 49152
s_add_u32 s26, s86, 1024
buffer_load_dwordx4 v36, s[96:99], s26 offen offset:0 lds
buffer_load_dwordx4 v37, s[96:99], s26 offen offset:1024 lds
buffer_load_dwordx4 v38, s[96:99], s26 offen offset:2048 lds
buffer_load_dwordx4 v39, s[96:99], s26 offen offset:3072 lds
ds_read_b64_tr_b16 v[176:177], v42 offset:0
ds_read_b64_tr_b16 v[178:179], v42 offset:256
ds_read_b64_tr_b16 v[180:181], v42 offset:2048
ds_read_b64_tr_b16 v[182:183], v42 offset:2304
ds_read_b64_tr_b16 v[216:217], v43 offset:0
ds_read_b64_tr_b16 v[218:219], v43 offset:256
ds_read_b64_tr_b16 v[220:221], v43 offset:2048
ds_read_b64_tr_b16 v[222:223], v43 offset:2304
s_waitcnt vmcnt(9) lgkmcnt(0)
s_barrier
ds_read_b64_tr_b16 v[224:225], v42 offset:16384
ds_read_b64_tr_b16 v[226:227], v42 offset:16640
ds_read_b64_tr_b16 v[228:229], v42 offset:18432
ds_read_b64_tr_b16 v[230:231], v42 offset:18688
ds_read_b64_tr_b16 v[232:233], v43 offset:16384
ds_read_b64_tr_b16 v[234:235], v43 offset:16640
ds_read_b64_tr_b16 v[236:237], v43 offset:18432
ds_read_b64_tr_b16 v[238:239], v43 offset:18688
s_waitcnt vmcnt(5) lgkmcnt(0)
s_barrier
ds_read_b64_tr_b16 v[72:73], v42 offset:32768
ds_read_b64_tr_b16 v[74:75], v42 offset:33024
ds_read_b64_tr_b16 v[76:77], v42 offset:34816
ds_read_b64_tr_b16 v[78:79], v42 offset:35072
ds_read_b64_tr_b16 v[240:241], v43 offset:32768
ds_read_b64_tr_b16 v[242:243], v43 offset:33024
ds_read_b64_tr_b16 v[244:245], v43 offset:34816
ds_read_b64_tr_b16 v[246:247], v43 offset:35072
s_waitcnt lgkmcnt(6)
global_store_dwordx4 v0, v[72:75], s[78:79] offset:2048
s_waitcnt lgkmcnt(4)
global_store_dwordx4 v0, v[76:79], s[78:79] offset:3072
s_waitcnt vmcnt(2) lgkmcnt(0)
s_barrier
ds_read_b64_tr_b16 v[248:249], v42 offset:49152
ds_read_b64_tr_b16 v[250:251], v42 offset:49408
ds_read_b64_tr_b16 v[252:253], v42 offset:51200
ds_read_b64_tr_b16 v[254:255], v42 offset:51456
ds_read_b64_tr_b16 v[64:65], v43 offset:49152
ds_read_b64_tr_b16 v[66:67], v43 offset:49408
ds_read_b64_tr_b16 v[68:69], v43 offset:51200
ds_read_b64_tr_b16 v[70:71], v43 offset:51456
s_waitcnt lgkmcnt(0)
s_barrier
s_mul_i32 s26, s13, 12288
v_add_u32 v47, s26, v0
ds_write_b128 v47, v[8:11] offset:16384
ds_write_b128 v47, v[12:15] offset:17408
ds_write_b128 v47, v[16:19] offset:18432
ds_write_b128 v47, v[20:23] offset:19456
ds_write_b128 v47, v[24:27] offset:20480
ds_write_b128 v47, v[28:31] offset:21504
ds_write_b128 v47, v[48:51] offset:22528
ds_write_b128 v47, v[52:55] offset:23552
ds_write_b128 v47, v[56:59] offset:24576
ds_write_b128 v47, v[60:63] offset:25600
ds_write_b128 v47, v[64:67] offset:26624
ds_write_b128 v47, v[68:71] offset:27648
s_mov_b32 s30, 0
s_branch all_10004
all_10003:
buffer_load_dword v45, v44, s[8:11], 0 offen sc1
s_add_u32 s30, s30, 1
s_cmp_gt_u32 s30, 262144
s_cbranch_scc1 L_fail
all_10004:
s_waitcnt vmcnt(0)
v_add_u32_dpp v46, v45, v45 quad_perm:[1,0,3,2] row_mask:0xf bank_mask:0xf
s_nop 1
v_add_u32_dpp v46, v46, v46 quad_perm:[2,3,0,1] row_mask:0xf bank_mask:0xf
s_nop 1
v_add_u32_dpp v46, v46, v46 row_ror:4 row_mask:0xf bank_mask:0xf
s_nop 1
v_add_u32_dpp v46, v46, v46 row_ror:8 row_mask:0xf bank_mask:0xf
v_cmp_ne_u32 vcc, 306, v46
s_cbranch_vccnz all_10003
s_waitcnt vmcnt(0) lgkmcnt(0)
s_barrier
s_mov_b32 s18, 0
s_mov_b32 s36, 0
s_cmp_eq_u32 s13, 1
s_cbranch_scc1 wave_10006
s_cmp_eq_u32 s13, 2
s_cbranch_scc1 wave_10007
s_cmp_eq_u32 s13, 3
s_cbranch_scc1 wave_10008
wave_10005:
layer_10009:
s_lshl_b32 s17, s36, 6
s_mul_i32 s27, s36, 35651584
s_mul_i32 s28, s14, 16384
s_add_u32 s27, s27, s28
s_add_u32 s20, s27, 16777216
s_mul_i32 s27, s17, 10240
s_add_u32 s27, s27, s24
s_add_u32 s21, s27, s25
s_mov_b32 s19, 0
s_mov_b32 s33, s6
s_add_u32 s34, s17, 1
s_add_u32 s31, s17, 63
s_add_u32 s32, s17, 64
s_mov_b32 s27, s20
v_mov_b32 v7, 0
s_add_u32 s68, s4, 413696
s_addc_u32 s69, s5, 0
s_add_u32 s72, s4, 397312
s_addc_u32 s73, s5, 0
s_add_u32 s70, s4, 417792
s_addc_u32 s71, s5, 0
s_add_u32 s74, s4, 401408
s_addc_u32 s75, s5, 0
s_add_u32 s58, s4, s20
s_addc_u32 s59, s5, 0
global_load_dwordx4 v[64:67], v0, s[76:77] offset:-4096 sc1
global_load_dwordx4 v[68:71], v0, s[76:77] offset:-3072 sc1
global_load_dwordx4 v[72:75], v0, s[76:77] offset:0 sc1
global_load_dwordx4 v[76:79], v0, s[76:77] offset:1024 sc1
global_load_dwordx4 v[80:83], v0, s[76:77] offset:2048 sc1
global_load_dwordx4 v[84:87], v0, s[76:77] offset:3072 sc1
global_load_dwordx4 v[56:59], v0, s[76:77] offset:-2048 sc1
global_load_dwordx4 v[60:63], v0, s[76:77] offset:-1024 sc1
global_load_dwordx4 v[24:27], v0, s[78:79] offset:-4096 sc1
global_load_dwordx4 v[28:31], v0, s[78:79] offset:-3072 sc1
v_mov_b64 v[8:9], 0
v_mov_b64 v[10:11], 0
v_mov_b64 v[12:13], 0
v_mov_b64 v[14:15], 0
v_mov_b64 v[16:17], 0
v_mov_b64 v[18:19], 0
v_mov_b64 v[20:21], 0
v_mov_b64 v[22:23], 0
v_cmp_gt_u32 vcc, s34, v7
s_cmp_eq_u32 vcc_hi, 0
s_cbranch_scc1 kv_10020
s_mov_b32 s30, 0
kv_10019:
v_and_b32 v7, 128, v0
buffer_load_dword v7, v7, s[4:7], s22 offen sc1
s_add_u32 s30, s30, 1
s_cmp_gt_u32 s30, 262144
s_cbranch_scc1 L_fail
s_waitcnt vmcnt(0)
v_cmp_gt_u32 vcc, s34, v7
s_cbranch_vccnz kv_10019
kv_10020:
s_barrier
global_load_dwordx4 v[48:51], v0, s[58:59] offset:0 nt sc1
global_load_dwordx4 v[52:55], v0, s[58:59] offset:1024 nt sc1
v_and_b32 v7, 255, v0
v_lshl_add_u32 v7, v7, 3, s27
global_load_dwordx4 v[32:35], v0, s[68:69] offset:-4096 sc1
global_load_dwordx4 v[36:39], v0, s[68:69] offset:0 sc1
global_load_dwordx4 v[40:43], v0, s[70:71] offset:0 sc1
s_mov_b32 s30, 0
s_waitcnt vmcnt(0)
.p2align 6
gather_10010:
s_waitcnt vmcnt(6)
rt_10015_b:
v_smfmac_f32_16x16x64_bf16 v[12:15], v[32:35], v[56:63], v1
ds_write_b128 v0, v[32:35] offset:0
v_smfmac_f32_16x16x64_bf16 v[20:23], v[32:35], v[72:79], v1
v_bitop3_b32 v44, v32, v34, s18 bitop3:0x7e
v_smfmac_f32_16x16x64_bf16 v[8:11], v[32:35], v[64:71], v1
s_waitcnt vmcnt(5)
ds_write_b128 v0, v[36:39] offset:4096
v_bitop3_b32 v45, v36, v38, s18 bitop3:0x7e
v_or_b32 v44, v44, v45
s_waitcnt vmcnt(4)
v_bitop3_b32 v45, v40, v42, s18 bitop3:0x7e
v_smfmac_f32_16x16x64_bf16 v[8:11], v[36:39], v[80:87], v1
ds_write_b128 v0, v[40:43] offset:8192
v_bitop3_b32 v44, v44, v45, s19 bitop3:0xa8
v_cmp_ne_u32 vcc, 0, v44
v_smfmac_f32_16x16x64_bf16 v[20:23], v[36:39], a[24:31], v1
s_cbranch_vccnz rt_10015
ds_read_b128 v[76:79], v2 offset:1024
global_load_dwordx4 v[64:67], v0, s[78:79] offset:-2048 sc1
ds_read_b128 v[72:75], v2 offset:0
global_load_dwordx4 v[68:71], v0, s[78:79] offset:-1024 sc1
ds_read_b128 v[84:87], v2 offset:5120
s_waitcnt lgkmcnt(3)
s_barrier
ds_read_b128 v[40:43], v0 offset:1024
v_smfmac_f32_16x16x64_bf16 v[16:19], v[32:35], a[0:7], v1
ds_read_b128 v[44:47], v0 offset:5120
global_load_dwordx4 v[56:59], v0, s[58:59] offset:2048 nt sc1
ds_read_b128 v[32:35], v0 offset:2048
v_smfmac_f32_16x16x64_bf16 v[12:15], v[36:39], a[8:15], v1
s_mov_b32 s30, 0
ds_read_b128 v[80:83], v2 offset:4096
v_smfmac_f32_16x16x64_bf16 v[16:19], v[36:39], a[16:23], v1
s_waitcnt lgkmcnt(5)
ds_read_b128 v[36:39], v0 offset:6144
global_load_dwordx4 v[60:63], v0, s[58:59] offset:3072 nt sc1
s_waitcnt lgkmcnt(4)
v_smfmac_f32_16x16x64_bf16 v[8:11], v[40:43], v[72:79], v1
ds_read_b128 v[72:75], v2 offset:2048
v_smfmac_f32_16x16x64_bf16 v[12:15], v[40:43], a[32:39], v1
s_waitcnt lgkmcnt(4)
ds_read_b128 v[40:43], v0 offset:3072
v_smfmac_f32_16x16x64_bf16 v[8:11], v[44:47], a[40:47], v1
s_waitcnt lgkmcnt(4)
ds_read_b128 v[76:79], v2 offset:3072
s_waitcnt vmcnt(6)
v_smfmac_f32_16x16x64_bf16 v[12:15], v[44:47], v[24:31], v1
ds_read_b128 v[28:31], v2 offset:7168
v_smfmac_f32_16x16x64_bf16 v[12:15], v[32:35], a[56:63], v1
s_mov_b32 s19, 1
ds_read_b128 v[24:27], v2 offset:6144
v_smfmac_f32_16x16x64_bf16 v[8:11], v[32:35], a[48:55], v1
s_waitcnt lgkmcnt(4)
ds_read_b128 v[44:47], v0 offset:7168
v_smfmac_f32_16x16x64_bf16 v[12:15], v[36:39], a[64:71], v1
ds_read_b128 v[32:35], v0 offset:8192
s_waitcnt lgkmcnt(4)
v_smfmac_f32_16x16x64_bf16 v[8:11], v[36:39], v[72:79], v1
ds_read_b128 v[36:39], v0 offset:9216
s_waitcnt lgkmcnt(4)
v_smfmac_f32_16x16x64_bf16 v[8:11], v[40:43], v[80:87], v1
ds_read_b128 v[84:87], v2 offset:9216
s_waitcnt lgkmcnt(4)
v_smfmac_f32_16x16x64_bf16 v[12:15], v[40:43], v[24:31], v1
ds_read_b128 v[80:83], v2 offset:8192
s_waitcnt lgkmcnt(4)
v_smfmac_f32_16x16x64_bf16 v[12:15], v[44:47], a[80:87], v1
ds_read_b128 v[76:79], v2 offset:11264
s_waitcnt lgkmcnt(4)
v_smfmac_f32_16x16x64_bf16 v[12:15], v[32:35], a[88:95], v1
ds_read_b128 v[72:75], v2 offset:10240
s_waitcnt lgkmcnt(4)
v_smfmac_f32_16x16x64_bf16 v[8:11], v[44:47], a[72:79], v1
ds_read_b128 v[40:43], v0 offset:1024
global_load_dword v7, v7, s[4:5] sc1
ds_read_b128 v[28:31], v2 offset:13312
s_waitcnt lgkmcnt(4)
v_smfmac_f32_16x16x64_bf16 v[8:11], v[32:35], v[80:87], v1
s_waitcnt vmcnt(3)
ds_read_b128 v[24:27], v2 offset:12288
v_smfmac_f32_16x16x64_bf16 v[8:11], v[36:39], a[96:103], v1
s_nop 0
ds_read_b128 v[32:35], v0 offset:5120
s_waitcnt lgkmcnt(4)
v_smfmac_f32_16x16x64_bf16 v[12:15], v[36:39], v[72:79], v1
s_nop 0
ds_read_b128 v[36:39], v0 offset:2048
s_waitcnt lgkmcnt(4)
ds_read_b128 v[72:75], v2 offset:16384
v_add_f32 v9, v9, v11
v_smfmac_f32_16x16x64_bf16 v[16:19], v[40:43], a[104:111], v1
s_xor_b32 s18, s18, 1
ds_read_b128 v[76:79], v2 offset:17408
v_add_f32 v8, v8, v10
v_smfmac_f32_16x16x64_bf16 v[20:23], v[40:43], a[112:119], v1
s_waitcnt lgkmcnt(5)
ds_read_b128 v[40:43], v0 offset:6144
v_add_f32 v12, v12, v14
v_mul_f32 v9, s35, v9
s_waitcnt lgkmcnt(4)
v_smfmac_f32_16x16x64_bf16 v[16:19], v[32:35], v[24:31], v1
ds_read_b128 v[84:87], v2 offset:15360
v_mul_f32 v8, s35, v8
v_cvt_pk_bf16_f32 v8, v8, v9
v_smfmac_f32_16x16x64_bf16 v[20:23], v[32:35], v[64:71], v1
s_waitcnt lgkmcnt(4)
ds_read_b128 v[80:83], v2 offset:14336
v_add_f32 v13, v13, v15
v_smfmac_f32_16x16x64_bf16 v[20:23], v[36:39], a[128:135], v1
ds_read_b128 v[32:35], v0 offset:3072
v_mul_f32 v12, s35, v12
v_mul_f32 v13, s35, v13
v_smfmac_f32_16x16x64_bf16 v[16:19], v[36:39], a[120:127], v1
s_waitcnt lgkmcnt(3)
ds_read_b128 v[36:39], v0 offset:7168
v_cvt_pk_bf16_f32 v12, v12, v13
v_smfmac_f32_16x16x64_bf16 v[20:23], v[40:43], a[144:151], v1
ds_write2_b32 v3, v8, v12 offset0:0 offset1:128
v_mov_b64 v[26:27], 0
v_smfmac_f32_16x16x64_bf16 v[16:19], v[40:43], a[136:143], v1
s_waitcnt lgkmcnt(2)
ds_read_b128 v[40:43], v0 offset:8192
v_smfmac_f32_16x16x64_bf16 v[16:19], v[32:35], a[152:159], v1
s_mov_b64 vcc, s[42:43]
ds_read_b128 v[68:71], v2 offset:19456
v_mov_b64 v[30:31], 0
v_smfmac_f32_16x16x64_bf16 v[20:23], v[32:35], a[160:167], v1
s_waitcnt lgkmcnt(3)
ds_read_b128 v[32:35], v0 offset:9216
v_mov_b64 v[24:25], 0
v_smfmac_f32_16x16x64_bf16 v[20:23], v[36:39], v[80:87], v1
s_add_u32 s20, s20, 524288
ds_read_b128 v[64:67], v2 offset:18432
v_mov_b64 v[28:29], 0
v_smfmac_f32_16x16x64_bf16 v[16:19], v[36:39], a[168:175], v1
ds_read_b128 v[36:39], v0 offset:8192
s_waitcnt lgkmcnt(4)
v_smfmac_f32_16x16x64_bf16 v[20:23], v[40:43], v[72:79], v1
s_barrier
ds_read_b64_tr_b16 v[8:9], v4 offset:0
v_smfmac_f32_16x16x64_bf16 v[16:19], v[40:43], a[176:183], v1
s_waitcnt lgkmcnt(3)
ds_read_b64_tr_b16 v[14:15], v4 offset:1536
ds_read_b64_tr_b16 v[10:11], v4 offset:512
v_smfmac_f32_16x16x64_bf16 v[16:19], v[32:35], a[184:191], v1
s_nop 0
ds_read_b64_tr_b16 v[12:13], v4 offset:1024
ds_read_b128 v[40:43], v0 offset:9216
v_smfmac_f32_16x16x64_bf16 v[20:23], v[32:35], a[192:199], v1
s_add_u32 s17, s17, 1
ds_read_b128 v[72:75], v2 offset:20480
s_waitcnt lgkmcnt(6)
ds_read_b128 v[80:83], v0 offset:16384
v_add_f32 v17, v17, v19
v_add_f32 v16, v16, v18
v_cvt_pk_bf16_f32 v16, v16, v17
v_smfmac_f32_16x16x64_bf16 v[24:27], v[36:39], a[200:207], v1
s_waitcnt lgkmcnt(6)
ds_read_b128 v[76:79], v2 offset:21504
s_waitcnt lgkmcnt(5)
v_mfma_f32_16x16x32_bf16 v[44:47], v[48:51], v[8:11], 0
s_waitcnt lgkmcnt(4)
ds_read_b128 v[84:87], v0 offset:17408
v_add_f32 v21, v21, v23
v_mfma_f32_16x16x32_bf16 v[44:47], v[52:55], v[12:15], v[44:47]
ds_read_b128 v[32:35], v0 offset:0
v_bfe_u32 v48, v0, 5, 1
v_add_f32 v20, v20, v22
v_cvt_pk_bf16_f32 v20, v20, v21
v_smfmac_f32_16x16x64_bf16 v[28:31], v[36:39], a[208:215], v1
s_waitcnt lgkmcnt(5)
ds_write2_b32 v3, v16, v20 offset0:1 offset1:129
v_lshl_add_u32 v48, v48, 3, v5
v_cndmask_b32_dpp v45, v47, v45, vcc quad_perm:[0,1,0,1] row_mask:0xf bank_mask:0xf
v_smfmac_f32_16x16x64_bf16 v[24:27], v[40:43], v[64:71], v1
s_add_u32 s21, s21, 10240
ds_read_b128 v[36:39], v0 offset:4096
v_cndmask_b32_dpp v44, v46, v44, vcc quad_perm:[0,1,0,1] row_mask:0xf bank_mask:0xf
v_smfmac_f32_16x16x64_bf16 v[28:31], v[40:43], a[216:223], v1
s_waitcnt lgkmcnt(2)
ds_write_b64 v48, v[44:45] offset:6144
v_smfmac_f32_16x16x64_bf16 v[24:27], v[32:35], v[72:79], v1
global_load_dwordx4 v[64:67], v0, s[78:79] offset:0 sc1
ds_read_b128 v[72:75], v2 offset:22528
v_smfmac_f32_16x16x64_bf16 v[28:31], v[32:35], a[224:231], v1
ds_read_b128 v[40:43], v0 offset:1024
s_waitcnt lgkmcnt(3)
v_smfmac_f32_16x16x64_bf16 v[28:31], v[36:39], a[240:247], v1
ds_read_b128 v[76:79], v2 offset:23552
global_load_dwordx4 v[68:71], v0, s[78:79] offset:1024 sc1
ds_read_b128 v[32:35], v0 offset:5120
v_smfmac_f32_16x16x64_bf16 v[24:27], v[36:39], a[232:239], v1
s_waitcnt lgkmcnt(4)
ds_read_b128 v[36:39], v0 offset:2048
s_barrier
ds_read_b128 v[48:51], v6 offset:6144
s_waitcnt lgkmcnt(4)
v_smfmac_f32_16x16x64_bf16 v[28:31], v[40:43], v[80:87], v1
s_add_u32 s34, s17, 2
ds_read_b64_tr_b16 v[22:23], v4 offset:3584
s_waitcnt lgkmcnt(4)
ds_read_b128 v[52:55], v6 offset:7168
v_smfmac_f32_16x16x64_bf16 v[24:27], v[40:43], v[72:79], v1
ds_read_b128 v[40:43], v0 offset:6144
s_waitcnt lgkmcnt(5)
ds_read_b64_tr_b16 v[8:9], v4 offset:0
v_smfmac_f32_16x16x64_bf16 v[24:27], v[32:35], a[248:255], v1
s_waitcnt lgkmcnt(5)
ds_read_b64_tr_b16 v[16:17], v4 offset:2048
global_load_dwordx4 v[72:75], v0, s[78:79] offset:2048 sc1
ds_read_b64_tr_b16 v[18:19], v4 offset:2560
v_smfmac_f32_16x16x64_bf16 v[28:31], v[32:35], v[88:95], v1
global_load_dwordx4 v[76:79], v0, s[78:79] offset:3072 sc1
ds_read_b128 v[32:35], v0 offset:3072
v_smfmac_f32_16x16x64_bf16 v[24:27], v[36:39], v[96:103], v1
s_waitcnt lgkmcnt(5)
ds_read_b64_tr_b16 v[10:11], v4 offset:512
v_add_f32 v49, v49, v53
v_smfmac_f32_16x16x64_bf16 v[28:31], v[36:39], v[104:111], v1
s_waitcnt lgkmcnt(5)
ds_read_b64_tr_b16 v[12:13], v4 offset:1024
v_add_f32 v48, v48, v52
v_add_f32 v50, v50, v54
v_smfmac_f32_16x16x64_bf16 v[24:27], v[40:43], v[112:119], v1
ds_read_b128 v[36:39], v0 offset:7168
v_exp_f32 v49, v49
v_smfmac_f32_16x16x64_bf16 v[28:31], v[40:43], v[120:127], v1
s_waitcnt lgkmcnt(3)
ds_read_b64_tr_b16 v[14:15], v4 offset:1536
v_add_f32 v51, v51, v55
v_smfmac_f32_16x16x64_bf16 v[28:31], v[32:35], v[136:143], v1
s_waitcnt lgkmcnt(3)
ds_read_b64_tr_b16 v[20:21], v4 offset:3072
v_exp_f32 v51, v51
v_mfma_f32_16x16x32_bf16 v[44:47], v[8:11], v[8:11], 0
v_exp_f32 v48, v48
v_exp_f32 v50, v50
v_smfmac_f32_16x16x64_bf16 v[24:27], v[32:35], v[128:135], v1
s_waitcnt lgkmcnt(1)
s_min_u32 s34, s34, s32
v_cvt_pk_bf16_f32 v55, v50, v51
v_mfma_f32_16x16x32_bf16 v[44:47], v[12:15], v[12:15], v[44:47]
s_nop 0
v_mov_b32_dpp v51, v55 quad_perm:[2,3,2,3] row_mask:0xf bank_mask:0xf
v_cvt_pk_bf16_f32 v54, v48, v49
v_mfma_f32_16x16x32_bf16 v[44:47], v[16:19], v[16:19], v[44:47]
s_waitcnt lgkmcnt(0)
v_mov_b32_dpp v48, v54 quad_perm:[0,1,0,1] row_mask:0xf bank_mask:0xf
v_mov_b32_dpp v49, v55 quad_perm:[0,1,0,1] row_mask:0xf bank_mask:0xf
v_mov_b32_dpp v50, v54 quad_perm:[2,3,2,3] row_mask:0xf bank_mask:0xf
v_mfma_f32_16x16x32_bf16 v[44:47], v[20:23], v[20:23], v[44:47]
s_add_u32 s27, s20, 524288
v_mov_b64 v[20:21], s[44:45]
v_mov_b64 v[22:23], s[44:45]
v_smfmac_f32_16x16x64_bf16 v[24:27], v[36:39], v[144:151], v1
s_waitcnt vmcnt(5)
global_load_dwordx4 v[80:83], v0, s[80:81] offset:-4096 sc1
v_mfma_f32_16x16x32_bf16 v[16:19], v[20:23], v[48:51], 0
s_nop 0
v_exp_f32_dpp v44, v46 quad_perm:[0,1,0,1] row_mask:0xf bank_mask:0xf
v_mfma_f32_16x16x32_bf16 v[8:11], v[56:59], v[48:51], 0
v_exp_f32_dpp v45, v47 quad_perm:[0,1,0,1] row_mask:0xf bank_mask:0xf
v_mov_b64 v[54:55], s[46:47]
v_smfmac_f32_16x16x64_bf16 v[28:31], v[36:39], v[152:159], v1
global_load_dwordx4 v[84:87], v0, s[80:81] offset:-3072 sc1
v_cvt_pk_bf16_f32 v52, v44, v45
v_mfma_f32_16x16x32_bf16 v[12:15], v[60:63], v[48:51], 0
v_cvt_pk_bf16_f32 v53, v44, v45
v_cvt_pk_bf16_f32 v24, v24, v25
v_cvt_pk_bf16_f32 v25, v26, v27
v_mfma_f32_16x16x16_bf16 v[16:19], v[54:55], v[52:53], v[16:19]
s_nop 0
v_cvt_pk_bf16_f32 v27, v30, v31
v_cvt_pk_bf16_f32 v26, v28, v29
v_mfma_f32_16x16x16_bf16 v[8:11], v[24:25], v[52:53], v[8:11]
v_bfe_u32 v32, v0, 5, 1
v_mov_b64 v[38:39], 0
v_mfma_f32_16x16x16_bf16 v[12:15], v[26:27], v[52:53], v[12:15]
s_nop 0
v_mov_b64 v[42:43], 0
v_subrev_u32 v17, s37, v16
v_cmp_lt_u32 vcc, s38, v17
v_rcp_f32 v18, v16
v_mov_b64 v[36:37], 0
v_lshl_add_u32 v32, v32, 3, v5
v_mov_b64 v[40:41], 0
v_cndmask_b32 v11, v15, v11, s[42:43]
v_cndmask_b32 v8, v12, v8, s[42:43]
v_cndmask_b32 v9, v13, v9, s[42:43]
v_cndmask_b32 v10, v14, v10, s[42:43]
v_mul_f32 v8, v8, v18
v_mul_f32 v9, v9, v18
v_mul_f32 v11, v11, v18
v_mul_f32 v10, v10, v18
v_cvt_pk_bf16_f32 v13, v10, v11
v_cvt_pk_bf16_f32 v12, v8, v9
s_cbranch_vccnz rare_10011
back_10012:
ds_write_b64 v32, v[12:13] offset:0
v_mov_b32_dpp v11, v13 quad_perm:[2,3,2,3] row_mask:0xf bank_mask:0xf
v_mov_b64 v[52:53], 0
v_mov_b32_dpp v9, v13 quad_perm:[0,1,0,1] row_mask:0xf bank_mask:0xf
v_mov_b32_dpp v10, v12 quad_perm:[2,3,2,3] row_mask:0xf bank_mask:0xf
v_mov_b32_dpp v8, v12 quad_perm:[0,1,0,1] row_mask:0xf bank_mask:0xf
v_mov_b64 v[48:49], 0
s_waitcnt vmcnt(4)
v_mov_b64 v[54:55], 0
v_smfmac_f32_16x16x64_bf16 v[40:43], v[8:11], v[64:71], v1
ds_read_b128 v[16:19], v0 offset:18432
global_load_dwordx4 v[64:67], v0, s[76:77] offset:-4096 sc1
ds_read_b128 v[20:23], v0 offset:19456
v_mov_b64 v[32:33], 0
v_smfmac_f32_16x16x64_bf16 v[52:55], v[8:11], v[176:183], v1
s_waitcnt lgkmcnt(2)
ds_read_b128 v[28:31], v0 offset:21504
ds_read_b128 v[24:27], v0 offset:20480
s_barrier
global_load_dwordx4 v[68:71], v0, s[76:77] offset:-3072 sc1
ds_read_b128 v[56:59], v5 offset:512
v_mov_b64 v[50:51], 0
v_lshrrev_b32 v44, 8, v0
v_smfmac_f32_16x16x64_bf16 v[36:39], v[8:11], v[160:167], v1
s_waitcnt vmcnt(5)
ds_read_b128 v[60:63], v5 offset:1024
v_mov_b64 v[34:35], 0
v_smfmac_f32_16x16x64_bf16 v[48:51], v[8:11], v[168:175], v1
ds_read_b128 v[12:15], v5 offset:1536
v_bfe_u32 v45, v0, 1, 7
s_waitcnt vmcnt(4)
v_smfmac_f32_16x16x64_bf16 v[32:35], v[8:11], v[72:79], v1
global_load_dwordx4 v[72:75], v0, s[76:77] offset:0 sc1
s_waitcnt lgkmcnt(2)
v_smfmac_f32_16x16x64_bf16 v[36:39], v[56:59], v[184:191], v1
global_load_dwordx4 v[76:79], v0, s[76:77] offset:1024 sc1
s_waitcnt lgkmcnt(1)
v_smfmac_f32_16x16x64_bf16 v[36:39], v[60:63], v[16:23], v1
s_waitcnt lgkmcnt(0)
v_smfmac_f32_16x16x64_bf16 v[36:39], v[12:15], v[24:31], v1
ds_read_b128 v[24:27], v0 offset:22528
v_lshl_or_b32 v44, v44, 12, v45
v_smfmac_f32_16x16x64_bf16 v[40:43], v[56:59], v[192:199], v1
ds_read_b128 v[28:31], v0 offset:23552
s_waitcnt vmcnt(5)
v_smfmac_f32_16x16x64_bf16 v[32:35], v[56:59], v[240:247], v1
s_nop 0
ds_read_b128 v[20:23], v0 offset:25600
v_cvt_pk_bf16_f32 v36, v36, v37
v_smfmac_f32_16x16x64_bf16 v[48:51], v[56:59], v[200:207], v1
ds_read_b128 v[16:19], v0 offset:24576
v_and_or_b32 v36, v36, -2, s18
v_cvt_pk_bf16_f32 v37, v38, v39
s_waitcnt vmcnt(4)
v_smfmac_f32_16x16x64_bf16 v[40:43], v[60:63], v[80:87], v1
global_store_dwordx2 v44, v[36:37], s[48:49]
s_waitcnt lgkmcnt(2)
v_smfmac_f32_16x16x64_bf16 v[40:43], v[12:15], v[24:31], v1
s_mov_b64 s[70:71], s[74:75]
ds_read_b128 v[24:27], v0 offset:26624
s_add_u32 s58, s4, s20
v_smfmac_f32_16x16x64_bf16 v[48:51], v[60:63], v[208:215], v1
s_waitcnt lgkmcnt(2)
s_waitcnt lgkmcnt(1)
v_smfmac_f32_16x16x64_bf16 v[48:51], v[12:15], v[16:23], v1
ds_read_b128 v[28:31], v0 offset:27648
v_cvt_pk_bf16_f32 v40, v40, v41
v_and_or_b32 v40, v40, -2, s18
v_cvt_pk_bf16_f32 v41, v42, v43
v_smfmac_f32_16x16x64_bf16 v[52:55], v[56:59], v[216:223], v1
global_store_dwordx2 v44, v[40:41], s[50:51]
v_smfmac_f32_16x16x64_bf16 v[52:55], v[60:63], v[224:231], v1
s_mov_b64 s[68:69], s[72:73]
v_cvt_pk_bf16_f32 v48, v48, v49
v_smfmac_f32_16x16x64_bf16 v[52:55], v[12:15], v[232:239], v1
s_nop 0
s_waitcnt lgkmcnt(0)
v_and_or_b32 v48, v48, -2, s18
v_cvt_pk_bf16_f32 v49, v50, v51
v_smfmac_f32_16x16x64_bf16 v[32:35], v[60:63], v[248:255], v1
s_nop 0
global_store_dwordx2 v44, v[48:49], s[52:53]
s_nop 0
v_cvt_pk_bf16_f32 v52, v52, v53
v_cvt_pk_bf16_f32 v53, v54, v55
v_smfmac_f32_16x16x64_bf16 v[32:35], v[12:15], v[24:31], v1
s_nop 1
v_and_or_b32 v52, v52, -2, s18
s_nop 1
global_store_dwordx2 v44, v[52:53], s[54:55]
s_addc_u32 s59, s5, 0
s_nop 0
v_cvt_pk_bf16_f32 v32, v32, v33
v_and_or_b32 v32, v32, -2, s18
v_cvt_pk_bf16_f32 v33, v34, v35
global_store_dwordx2 v44, v[32:33], s[56:57]
v_bfe_u32 v32, v0, 6, 1
v_lshlrev_b32 v32, 4, v32
v_mov_b32 v33, 0x3f80
v_lshlrev_b32 v32, v32, v33
v_bfe_i32 v33, v0, 4, 1
v_and_b32 v45, v32, v33
v_and_b32 v47, v32, v33
v_xor_b32 v44, v32, v45
v_xor_b32 v46, v32, v45
v_and_b32 v36, 32, v0
v_bfe_u32 v37, v0, 6, 1
v_lshl_add_u32 v36, v37, 8, v36
v_bfe_u32 v37, v0, 8, 1
v_lshl_add_u32 v36, v37, 4, v36
v_bfe_u32 v37, v0, 4, 1
v_lshl_add_u32 v36, v37, 3, v36
v_and_b32 v7, 255, v0
v_lshl_add_u32 v7, v7, 3, s27
s_nop 15
s_nop 15
s_nop 15
s_nop 8
global_load_dwordx4 v[8:11], v0, s[64:65] offset:0 sc1
global_load_dwordx4 v[12:15], v0, s[64:65] offset:1024 sc1
global_load_dwordx4 v[16:19], v0, s[64:65] offset:2048 sc1
global_load_dwordx4 v[20:23], v0, s[64:65] offset:3072 sc1
chk_10023:
v_mov_b64 v[40:41], 0
v_mov_b64 v[42:43], 0
s_waitcnt vmcnt(2)
s_nop 0
v_smfmac_f32_16x16x64_bf16 v[40:43], v[44:47], v[8:15], v1
v_bitop3_b32 v32, v8, v10, s18 bitop3:0x7e
v_bitop3_b32 v33, v12, v14, s18 bitop3:0x7e
s_waitcnt vmcnt(0)
v_smfmac_f32_16x16x64_bf16 v[40:43], v[44:47], v[16:23], v1
v_bitop3_b32 v34, v16, v18, s18 bitop3:0x7e
v_bitop3_b32 v35, v20, v22, s18 bitop3:0x7e
v_or3_b32 v37, v32, v33, v34
v_bitop3_b32 v37, v37, v35, 1 bitop3:0xa8
v_cmp_ne_u32 vcc, 0, v37
s_cbranch_vccnz chk_10023_f
s_nop 1
v_add_f32_dpp v40, v40, v40 row_ror:8 row_mask:0xf bank_mask:0xf
v_add_f32_dpp v41, v41, v41 row_ror:8 row_mask:0xf bank_mask:0xf
v_add_f32_dpp v42, v42, v42 row_ror:8 row_mask:0xf bank_mask:0xf
v_add_f32_dpp v43, v43, v43 row_ror:8 row_mask:0xf bank_mask:0xf
v_cvt_pk_bf16_f32 v40, v40, v41
v_cvt_pk_bf16_f32 v41, v42, v43
v_and_or_b32 v40, v40, -2, s18
s_mov_b64 exec, 0x00ff00ff
global_store_dwordx2 v36, v[40:41], s[66:67]
s_mov_b64 exec, -1
s_branch join_10022
chk_10023_f:
global_load_dwordx4 v[8:11], v0, s[64:65] offset:0 sc1
global_load_dwordx4 v[12:15], v0, s[64:65] offset:1024 sc1
global_load_dwordx4 v[16:19], v0, s[64:65] offset:2048 sc1
global_load_dwordx4 v[20:23], v0, s[64:65] offset:3072 sc1
s_add_u32 s30, s30, 1
s_cmp_le_u32 s30, 262144
s_cbranch_scc1 chk_10023
s_branch L_fail
nored_10021:
join_10022:
s_nop 11
s_barrier
global_load_dwordx4 v[56:59], v0, s[76:77] offset:-2048 sc1
global_load_dwordx4 v[60:63], v0, s[76:77] offset:-1024 sc1
global_load_dwordx4 v[80:83], v0, s[76:77] offset:2048 sc1
global_load_dwordx4 v[84:87], v0, s[76:77] offset:3072 sc1
s_nop 15
s_nop 15
s_nop 13
s_barrier
global_load_dwordx4 v[32:35], v0, s[68:69] offset:-4096 sc1
s_nop 10
global_load_dwordx4 v[36:39], v0, s[68:69] offset:0 sc1
s_nop 10
global_load_dwordx4 v[40:43], v0, s[70:71] offset:0 sc1
s_barrier
global_load_dwordx4 v[24:27], v0, s[78:79] offset:-4096 sc1
global_load_dwordx4 v[28:31], v0, s[78:79] offset:-3072 sc1
global_load_dwordx4 v[48:51], v0, s[58:59] offset:0 nt sc1
global_load_dwordx4 v[52:55], v0, s[58:59] offset:1024 nt sc1
v_mov_b64 v[8:9], 0
v_mov_b64 v[10:11], 0
v_mov_b64 v[12:13], 0
v_mov_b64 v[14:15], 0
v_mov_b64 v[16:17], 0
v_mov_b64 v[18:19], 0
v_mov_b64 v[20:21], 0
v_mov_b64 v[22:23], 0
s_mov_b32 s30, 0
s_cmp_eq_u32 s17, s31
s_cbranch_scc0 gather_10010
s_branch exit_10013
rt_10015:
global_load_dwordx4 v[32:35], v0, s[68:69] offset:-4096 sc1
global_load_dwordx4 v[36:39], v0, s[68:69] offset:0 sc1
global_load_dwordx4 v[40:43], v0, s[70:71] offset:0 sc1
s_add_u32 s30, s30, 1
s_cmp_gt_u32 s30, 262144
s_cbranch_scc1 L_fail
s_mov_b64 exec, 1
global_store_dword v0, v0, s[62:63]
global_store_dword v0, v0, s[62:63]
global_store_dword v0, v0, s[62:63]
global_store_dword v0, v0, s[62:63]
s_mov_b64 exec, -1
v_mov_b64 v[8:9], 0
v_mov_b64 v[10:11], 0
v_mov_b64 v[12:13], 0
v_mov_b64 v[14:15], 0
v_mov_b64 v[16:17], 0
v_mov_b64 v[18:19], 0
v_mov_b64 v[20:21], 0
v_mov_b64 v[22:23], 0
s_branch gather_10010
rare_10011:
ds_read_b128 v[48:51], v6 offset:6144
ds_read_b128 v[52:55], v6 offset:7168
s_waitcnt lgkmcnt(0)
v_add_f32 v48, v48, v52
v_add_f32 v49, v49, v53
v_add_f32 v50, v50, v54
v_add_f32 v51, v51, v55
v_mov_b32_dpp v46, v46 quad_perm:[0,1,0,1] row_mask:0xf bank_mask:0xf
v_mov_b32_dpp v47, v47 quad_perm:[0,1,0,1] row_mask:0xf bank_mask:0xf
v_max3_f32 v19, v48, v49, v50
v_max3_f32 v19, v19, v51, v46
v_max_f32 v19, v19, v47
s_nop 1
v_max_f32_dpp v19, v19, v19 quad_perm:[2,3,0,1] row_mask:0xf bank_mask:0xf
v_mov_b32 v44, v19
s_nop 1
v_permlane32_swap_b32 v19, v44
v_max_f32 v19, v19, v44
v_mov_b32 v44, v19
s_nop 1
v_permlane16_swap_b32 v19, v44
v_max_f32 v19, v19, v44
v_sub_f32 v48, v48, v19
v_sub_f32 v49, v49, v19
v_sub_f32 v50, v50, v19
v_sub_f32 v51, v51, v19
v_sub_f32 v46, v46, v19
v_sub_f32 v47, v47, v19
v_exp_f32 v48, v48
v_exp_f32 v49, v49
v_exp_f32 v50, v50
v_exp_f32 v51, v51
v_cvt_pk_bf16_f32 v54, v48, v49
v_cvt_pk_bf16_f32 v55, v50, v51
s_nop 0
v_mov_b32_dpp v48, v54 quad_perm:[0,1,0,1] row_mask:0xf bank_mask:0xf
v_mov_b32_dpp v49, v55 quad_perm:[0,1,0,1] row_mask:0xf bank_mask:0xf
v_mov_b32_dpp v50, v54 quad_perm:[2,3,2,3] row_mask:0xf bank_mask:0xf
v_mov_b32_dpp v51, v55 quad_perm:[2,3,2,3] row_mask:0xf bank_mask:0xf
v_mov_b64 v[20:21], s[44:45]
v_mov_b64 v[22:23], s[44:45]
v_mfma_f32_16x16x32_bf16 v[8:11], v[56:59], v[48:51], 0
v_mfma_f32_16x16x32_bf16 v[12:15], v[60:63], v[48:51], 0
v_mfma_f32_16x16x32_bf16 v[16:19], v[20:23], v[48:51], 0
v_mov_b64 v[54:55], s[46:47]
v_exp_f32_dpp v44, v46 quad_perm:[0,1,0,1] row_mask:0xf bank_mask:0xf
v_exp_f32_dpp v45, v47 quad_perm:[0,1,0,1] row_mask:0xf bank_mask:0xf
s_nop 0
v_cvt_pk_bf16_f32 v52, v44, v45
v_cvt_pk_bf16_f32 v53, v44, v45
s_nop 1
v_mfma_f32_16x16x16_bf16 v[16:19], v[54:55], v[52:53], v[16:19]
v_mfma_f32_16x16x16_bf16 v[8:11], v[24:25], v[52:53], v[8:11]
v_mfma_f32_16x16x16_bf16 v[12:15], v[26:27], v[52:53], v[12:15]
s_nop 5
v_rcp_f32 v18, v16
s_nop 0
v_cndmask_b32 v8, v12, v8, s[42:43]
v_mul_f32 v8, v8, v18
v_cndmask_b32 v9, v13, v9, s[42:43]
v_mul_f32 v9, v9, v18
v_cndmask_b32 v10, v14, v10, s[42:43]
v_mul_f32 v10, v10, v18
v_cndmask_b32 v11, v15, v11, s[42:43]
v_mul_f32 v11, v11, v18
v_cvt_pk_bf16_f32 v12, v8, v9
v_cvt_pk_bf16_f32 v13, v10, v11
s_branch back_10012
exit_10013:
global_load_dwordx4 v[32:35], v0, s[68:69] offset:-4096 sc1
global_load_dwordx4 v[36:39], v0, s[68:69] offset:0 sc1
global_load_dwordx4 v[40:43], v0, s[70:71] offset:0 sc1
s_add_u32 s30, s30, 1
s_cmp_gt_u32 s30, 262144
s_cbranch_scc1 L_fail
s_waitcnt vmcnt(2)
v_bitop3_b32 v44, v32, v34, s18 bitop3:0x7e
s_waitcnt vmcnt(1)
v_bitop3_b32 v45, v36, v38, s18 bitop3:0x7e
v_or_b32 v44, v44, v45
s_waitcnt vmcnt(0)
v_bitop3_b32 v46, v40, v42, s18 bitop3:0x7e
v_bitop3_b32 v44, v44, v46, s19 bitop3:0xa8
v_cmp_ne_u32 vcc, 0, v44
s_cbranch_vccnz exit_10013
s_add_u32 s36, s36, 1
s_cmp_lt_u32 s36, 2
s_cbranch_scc1 layer_10009
s_endpgm
wave_10006:
layer_10024:
s_lshl_b32 s17, s36, 6
s_mul_i32 s27, s36, 35651584
s_mul_i32 s28, s14, 16384
s_add_u32 s27, s27, s28
s_add_u32 s20, s27, 16781312
s_mul_i32 s27, s17, 10240
s_add_u32 s27, s27, s24
s_add_u32 s21, s27, s25
s_mov_b32 s19, 0
s_mov_b32 s33, s6
s_add_u32 s34, s17, 1
s_add_u32 s31, s17, 63
s_add_u32 s32, s17, 64
s_mov_b32 s27, s20
v_mov_b32 v7, 0
s_add_u32 s68, s4, 414720
s_addc_u32 s69, s5, 0
s_add_u32 s72, s4, 398336
s_addc_u32 s73, s5, 0
s_add_u32 s70, s4, 418816
s_addc_u32 s71, s5, 0
s_add_u32 s74, s4, 402432
s_addc_u32 s75, s5, 0
s_add_u32 s58, s4, s20
s_addc_u32 s59, s5, 0
global_load_dwordx4 v[64:67], v0, s[76:77] offset:-4096 sc1
global_load_dwordx4 v[68:71], v0, s[76:77] offset:-3072 sc1
global_load_dwordx4 v[72:75], v0, s[76:77] offset:0 sc1
global_load_dwordx4 v[76:79], v0, s[76:77] offset:1024 sc1
global_load_dwordx4 v[80:83], v0, s[76:77] offset:2048 sc1
global_load_dwordx4 v[84:87], v0, s[76:77] offset:3072 sc1
global_load_dwordx4 v[56:59], v0, s[76:77] offset:-2048 sc1
global_load_dwordx4 v[60:63], v0, s[76:77] offset:-1024 sc1
global_load_dwordx4 v[24:27], v0, s[78:79] offset:-4096 sc1
global_load_dwordx4 v[28:31], v0, s[78:79] offset:-3072 sc1
v_mov_b64 v[8:9], 0
v_mov_b64 v[10:11], 0
v_mov_b64 v[12:13], 0
v_mov_b64 v[14:15], 0
v_mov_b64 v[16:17], 0
v_mov_b64 v[18:19], 0
v_mov_b64 v[20:21], 0
v_mov_b64 v[22:23], 0
s_barrier
global_load_dwordx4 v[48:51], v0, s[58:59] offset:0 nt sc1
global_load_dwordx4 v[52:55], v0, s[58:59] offset:1024 nt sc1
v_and_b32 v7, 255, v0
v_lshl_add_u32 v7, v7, 3, s27
global_load_dwordx4 v[32:35], v0, s[68:69] offset:-4096 sc1
global_load_dwordx4 v[36:39], v0, s[68:69] offset:0 sc1
global_load_dwordx4 v[40:43], v0, s[70:71] offset:0 sc1
s_mov_b32 s30, 0
s_waitcnt vmcnt(0)
.p2align 6
gather_10025:
s_waitcnt vmcnt(6)
rt_10030_b:
v_smfmac_f32_16x16x64_bf16 v[12:15], v[32:35], v[56:63], v1
ds_write_b128 v0, v[32:35] offset:1024
v_smfmac_f32_16x16x64_bf16 v[20:23], v[32:35], v[72:79], v1
v_bitop3_b32 v44, v32, v34, s18 bitop3:0x7e
v_smfmac_f32_16x16x64_bf16 v[8:11], v[32:35], v[64:71], v1
s_waitcnt vmcnt(5)
ds_write_b128 v0, v[36:39] offset:5120
v_bitop3_b32 v45, v36, v38, s18 bitop3:0x7e
v_or_b32 v44, v44, v45
s_waitcnt vmcnt(4)
v_bitop3_b32 v45, v40, v42, s18 bitop3:0x7e
v_smfmac_f32_16x16x64_bf16 v[8:11], v[36:39], v[80:87], v1
ds_write_b128 v0, v[40:43] offset:9216
v_bitop3_b32 v44, v44, v45, s19 bitop3:0xa8
v_cmp_ne_u32 vcc, 0, v44
v_smfmac_f32_16x16x64_bf16 v[20:23], v[36:39], a[24:31], v1
s_cbranch_vccnz rt_10030
ds_read_b128 v[76:79], v2 offset:1024
global_load_dwordx4 v[64:67], v0, s[78:79] offset:-2048 sc1
ds_read_b128 v[72:75], v2 offset:0
global_load_dwordx4 v[68:71], v0, s[78:79] offset:-1024 sc1
ds_read_b128 v[84:87], v2 offset:5120
s_waitcnt lgkmcnt(3)
s_barrier
ds_read_b128 v[40:43], v0 offset:0
v_smfmac_f32_16x16x64_bf16 v[16:19], v[32:35], a[0:7], v1
ds_read_b128 v[44:47], v0 offset:4096
global_load_dwordx4 v[56:59], v0, s[58:59] offset:2048 nt sc1
ds_read_b128 v[32:35], v0 offset:3072
v_smfmac_f32_16x16x64_bf16 v[12:15], v[36:39], a[8:15], v1
s_mov_b32 s30, 0
ds_read_b128 v[80:83], v2 offset:4096
v_smfmac_f32_16x16x64_bf16 v[16:19], v[36:39], a[16:23], v1
s_waitcnt lgkmcnt(5)
ds_read_b128 v[36:39], v0 offset:7168
global_load_dwordx4 v[60:63], v0, s[58:59] offset:3072 nt sc1
s_waitcnt lgkmcnt(4)
v_smfmac_f32_16x16x64_bf16 v[8:11], v[40:43], v[72:79], v1
ds_read_b128 v[72:75], v2 offset:2048
v_smfmac_f32_16x16x64_bf16 v[12:15], v[40:43], a[32:39], v1
s_waitcnt lgkmcnt(4)
ds_read_b128 v[40:43], v0 offset:2048
v_smfmac_f32_16x16x64_bf16 v[8:11], v[44:47], a[40:47], v1
s_waitcnt lgkmcnt(4)
ds_read_b128 v[76:79], v2 offset:3072
s_waitcnt vmcnt(6)
v_smfmac_f32_16x16x64_bf16 v[12:15], v[44:47], v[24:31], v1
ds_read_b128 v[28:31], v2 offset:7168
v_smfmac_f32_16x16x64_bf16 v[12:15], v[32:35], a[56:63], v1
s_mov_b32 s19, 1
ds_read_b128 v[24:27], v2 offset:6144
v_smfmac_f32_16x16x64_bf16 v[8:11], v[32:35], a[48:55], v1
s_waitcnt lgkmcnt(4)
ds_read_b128 v[44:47], v0 offset:6144
v_smfmac_f32_16x16x64_bf16 v[12:15], v[36:39], a[64:71], v1
ds_read_b128 v[32:35], v0 offset:9216
s_waitcnt lgkmcnt(4)
v_smfmac_f32_16x16x64_bf16 v[8:11], v[36:39], v[72:79], v1
ds_read_b128 v[36:39], v0 offset:8192
s_waitcnt lgkmcnt(4)
v_smfmac_f32_16x16x64_bf16 v[8:11], v[40:43], v[80:87], v1
ds_read_b128 v[84:87], v2 offset:9216
s_waitcnt lgkmcnt(4)
v_smfmac_f32_16x16x64_bf16 v[12:15], v[40:43], v[24:31], v1
ds_read_b128 v[80:83], v2 offset:8192
s_waitcnt lgkmcnt(4)
v_smfmac_f32_16x16x64_bf16 v[12:15], v[44:47], a[80:87], v1
ds_read_b128 v[76:79], v2 offset:11264
s_waitcnt lgkmcnt(4)
v_smfmac_f32_16x16x64_bf16 v[12:15], v[32:35], a[88:95], v1
ds_read_b128 v[72:75], v2 offset:10240
s_waitcnt lgkmcnt(4)
v_smfmac_f32_16x16x64_bf16 v[8:11], v[44:47], a[72:79], v1
ds_read_b128 v[40:43], v0 offset:0
global_load_dword v7, v7, s[4:5] sc1
ds_read_b128 v[28:31], v2 offset:13312
s_waitcnt lgkmcnt(4)
v_smfmac_f32_16x16x64_bf16 v[8:11], v[32:35], v[80:87], v1
s_waitcnt vmcnt(3)
ds_read_b128 v[24:27], v2 offset:12288
v_smfmac_f32_16x16x64_bf16 v[8:11], v[36:39], a[96:103], v1
s_nop 0
ds_read_b128 v[32:35], v0 offset:4096
s_waitcnt lgkmcnt(4)
v_smfmac_f32_16x16x64_bf16 v[12:15], v[36:39], v[72:79], v1
s_nop 0
ds_read_b128 v[36:39], v0 offset:3072
s_waitcnt lgkmcnt(4)
ds_read_b128 v[72:75], v2 offset:16384
v_add_f32 v9, v9, v11
v_smfmac_f32_16x16x64_bf16 v[16:19], v[40:43], a[104:111], v1
s_xor_b32 s18, s18, 1
ds_read_b128 v[76:79], v2 offset:17408
v_add_f32 v8, v8, v10
v_smfmac_f32_16x16x64_bf16 v[20:23], v[40:43], a[112:119], v1
s_waitcnt lgkmcnt(5)
ds_read_b128 v[40:43], v0 offset:7168
v_add_f32 v12, v12, v14
v_mul_f32 v9, s35, v9
s_waitcnt lgkmcnt(4)
v_smfmac_f32_16x16x64_bf16 v[16:19], v[32:35], v[24:31], v1
ds_read_b128 v[84:87], v2 offset:15360
v_mul_f32 v8, s35, v8
v_cvt_pk_bf16_f32 v8, v8, v9
v_smfmac_f32_16x16x64_bf16 v[20:23], v[32:35], v[64:71], v1
s_waitcnt lgkmcnt(4)
ds_read_b128 v[80:83], v2 offset:14336
v_add_f32 v13, v13, v15
v_smfmac_f32_16x16x64_bf16 v[20:23], v[36:39], a[128:135], v1
ds_read_b128 v[32:35], v0 offset:2048
v_mul_f32 v12, s35, v12
v_mul_f32 v13, s35, v13
v_smfmac_f32_16x16x64_bf16 v[16:19], v[36:39], a[120:127], v1
s_waitcnt lgkmcnt(3)
ds_read_b128 v[36:39], v0 offset:6144
v_cvt_pk_bf16_f32 v12, v12, v13
v_smfmac_f32_16x16x64_bf16 v[20:23], v[40:43], a[144:151], v1
ds_write2_b32 v3, v8, v12 offset0:0 offset1:128
v_mov_b64 v[26:27], 0
v_smfmac_f32_16x16x64_bf16 v[16:19], v[40:43], a[136:143], v1
s_waitcnt lgkmcnt(2)
ds_read_b128 v[40:43], v0 offset:9216
v_smfmac_f32_16x16x64_bf16 v[16:19], v[32:35], a[152:159], v1
s_mov_b64 vcc, s[42:43]
ds_read_b128 v[68:71], v2 offset:19456
v_mov_b64 v[30:31], 0
v_smfmac_f32_16x16x64_bf16 v[20:23], v[32:35], a[160:167], v1
s_waitcnt lgkmcnt(3)
ds_read_b128 v[32:35], v0 offset:8192
v_mov_b64 v[24:25], 0
v_smfmac_f32_16x16x64_bf16 v[20:23], v[36:39], v[80:87], v1
s_add_u32 s20, s20, 524288
ds_read_b128 v[64:67], v2 offset:18432
v_mov_b64 v[28:29], 0
v_smfmac_f32_16x16x64_bf16 v[16:19], v[36:39], a[168:175], v1
ds_read_b128 v[36:39], v0 offset:9216
s_waitcnt lgkmcnt(4)
v_smfmac_f32_16x16x64_bf16 v[20:23], v[40:43], v[72:79], v1
s_barrier
ds_read_b64_tr_b16 v[8:9], v4 offset:0
v_smfmac_f32_16x16x64_bf16 v[16:19], v[40:43], a[176:183], v1
s_waitcnt lgkmcnt(3)
ds_read_b64_tr_b16 v[14:15], v4 offset:1536
ds_read_b64_tr_b16 v[10:11], v4 offset:512
v_smfmac_f32_16x16x64_bf16 v[16:19], v[32:35], a[184:191], v1
s_nop 0
ds_read_b64_tr_b16 v[12:13], v4 offset:1024
ds_read_b128 v[40:43], v0 offset:8192
v_smfmac_f32_16x16x64_bf16 v[20:23], v[32:35], a[192:199], v1
s_add_u32 s17, s17, 1
ds_read_b128 v[72:75], v2 offset:20480
s_waitcnt lgkmcnt(6)
ds_read_b128 v[80:83], v0 offset:28672
v_add_f32 v17, v17, v19
v_add_f32 v16, v16, v18
v_cvt_pk_bf16_f32 v16, v16, v17
v_smfmac_f32_16x16x64_bf16 v[24:27], v[36:39], a[200:207], v1
s_waitcnt lgkmcnt(6)
ds_read_b128 v[76:79], v2 offset:21504
s_waitcnt lgkmcnt(5)
v_mfma_f32_16x16x32_bf16 v[44:47], v[48:51], v[8:11], 0
s_waitcnt lgkmcnt(4)
ds_read_b128 v[84:87], v0 offset:29696
v_add_f32 v21, v21, v23
v_mfma_f32_16x16x32_bf16 v[44:47], v[52:55], v[12:15], v[44:47]
ds_read_b128 v[32:35], v0 offset:1024
v_bfe_u32 v48, v0, 5, 1
v_add_f32 v20, v20, v22
v_cvt_pk_bf16_f32 v20, v20, v21
v_smfmac_f32_16x16x64_bf16 v[28:31], v[36:39], a[208:215], v1
s_waitcnt lgkmcnt(5)
ds_write2_b32 v3, v16, v20 offset0:1 offset1:129
v_lshl_add_u32 v48, v48, 3, v5
v_cndmask_b32_dpp v45, v47, v45, vcc quad_perm:[0,1,0,1] row_mask:0xf bank_mask:0xf
v_smfmac_f32_16x16x64_bf16 v[24:27], v[40:43], v[64:71], v1
s_add_u32 s21, s21, 10240
ds_read_b128 v[36:39], v0 offset:5120
v_cndmask_b32_dpp v44, v46, v44, vcc quad_perm:[0,1,0,1] row_mask:0xf bank_mask:0xf
v_xor_b32 v48, 128, v48
v_smfmac_f32_16x16x64_bf16 v[28:31], v[40:43], a[216:223], v1
s_waitcnt lgkmcnt(2)
ds_write_b64 v48, v[44:45] offset:6656
v_smfmac_f32_16x16x64_bf16 v[24:27], v[32:35], v[72:79], v1
global_load_dwordx4 v[64:67], v0, s[78:79] offset:0 sc1
ds_read_b128 v[72:75], v2 offset:22528
v_smfmac_f32_16x16x64_bf16 v[28:31], v[32:35], a[224:231], v1
ds_read_b128 v[40:43], v0 offset:0
s_waitcnt lgkmcnt(3)
v_smfmac_f32_16x16x64_bf16 v[28:31], v[36:39], a[240:247], v1
ds_read_b128 v[76:79], v2 offset:23552
global_load_dwordx4 v[68:71], v0, s[78:79] offset:1024 sc1
ds_read_b128 v[32:35], v0 offset:4096
v_smfmac_f32_16x16x64_bf16 v[24:27], v[36:39], a[232:239], v1
s_waitcnt lgkmcnt(4)
ds_read_b128 v[36:39], v0 offset:3072
s_barrier
ds_read_b128 v[48:51], v6 offset:6144
s_waitcnt lgkmcnt(4)
v_smfmac_f32_16x16x64_bf16 v[28:31], v[40:43], v[80:87], v1
s_add_u32 s34, s17, 2
ds_read_b64_tr_b16 v[22:23], v4 offset:3584
s_waitcnt lgkmcnt(4)
ds_read_b128 v[52:55], v6 offset:7168
v_smfmac_f32_16x16x64_bf16 v[24:27], v[40:43], v[72:79], v1
ds_read_b128 v[40:43], v0 offset:7168
s_waitcnt lgkmcnt(5)
ds_read_b64_tr_b16 v[8:9], v4 offset:0
v_smfmac_f32_16x16x64_bf16 v[24:27], v[32:35], a[248:255], v1
s_waitcnt lgkmcnt(5)
ds_read_b64_tr_b16 v[16:17], v4 offset:2048
global_load_dwordx4 v[72:75], v0, s[78:79] offset:2048 sc1
ds_read_b64_tr_b16 v[18:19], v4 offset:2560
v_smfmac_f32_16x16x64_bf16 v[28:31], v[32:35], v[88:95], v1
global_load_dwordx4 v[76:79], v0, s[78:79] offset:3072 sc1
ds_read_b128 v[32:35], v0 offset:2048
v_smfmac_f32_16x16x64_bf16 v[24:27], v[36:39], v[96:103], v1
s_waitcnt lgkmcnt(5)
ds_read_b64_tr_b16 v[10:11], v4 offset:512
v_add_f32 v49, v49, v53
v_smfmac_f32_16x16x64_bf16 v[28:31], v[36:39], v[104:111], v1
s_waitcnt lgkmcnt(5)
ds_read_b64_tr_b16 v[12:13], v4 offset:1024
v_add_f32 v48, v48, v52
v_add_f32 v50, v50, v54
v_smfmac_f32_16x16x64_bf16 v[24:27], v[40:43], v[112:119], v1
ds_read_b128 v[36:39], v0 offset:6144
v_exp_f32 v49, v49
v_smfmac_f32_16x16x64_bf16 v[28:31], v[40:43], v[120:127], v1
s_waitcnt lgkmcnt(3)
ds_read_b64_tr_b16 v[14:15], v4 offset:1536
v_add_f32 v51, v51, v55
v_smfmac_f32_16x16x64_bf16 v[28:31], v[32:35], v[136:143], v1
s_waitcnt lgkmcnt(3)
ds_read_b64_tr_b16 v[20:21], v4 offset:3072
v_exp_f32 v51, v51
v_mfma_f32_16x16x32_bf16 v[44:47], v[8:11], v[8:11], 0
v_exp_f32 v48, v48
v_exp_f32 v50, v50
v_smfmac_f32_16x16x64_bf16 v[24:27], v[32:35], v[128:135], v1
s_waitcnt lgkmcnt(1)
s_min_u32 s34, s34, s32
v_cvt_pk_bf16_f32 v55, v50, v51
v_mfma_f32_16x16x32_bf16 v[44:47], v[12:15], v[12:15], v[44:47]
s_nop 0
v_mov_b32_dpp v51, v55 quad_perm:[2,3,2,3] row_mask:0xf bank_mask:0xf
v_cvt_pk_bf16_f32 v54, v48, v49
v_mfma_f32_16x16x32_bf16 v[44:47], v[16:19], v[16:19], v[44:47]
s_waitcnt lgkmcnt(0)
v_mov_b32_dpp v48, v54 quad_perm:[0,1,0,1] row_mask:0xf bank_mask:0xf
v_mov_b32_dpp v49, v55 quad_perm:[0,1,0,1] row_mask:0xf bank_mask:0xf
v_mov_b32_dpp v50, v54 quad_perm:[2,3,2,3] row_mask:0xf bank_mask:0xf
v_mfma_f32_16x16x32_bf16 v[44:47], v[20:23], v[20:23], v[44:47]
s_add_u32 s27, s20, 524288
v_mov_b64 v[20:21], s[44:45]
v_mov_b64 v[22:23], s[44:45]
v_smfmac_f32_16x16x64_bf16 v[24:27], v[36:39], v[144:151], v1
s_waitcnt vmcnt(5)
global_load_dwordx4 v[80:83], v0, s[80:81] offset:-4096 sc1
v_mfma_f32_16x16x32_bf16 v[16:19], v[20:23], v[48:51], 0
s_nop 0
v_exp_f32_dpp v44, v46 quad_perm:[0,1,0,1] row_mask:0xf bank_mask:0xf
v_mfma_f32_16x16x32_bf16 v[8:11], v[56:59], v[48:51], 0
v_exp_f32_dpp v45, v47 quad_perm:[0,1,0,1] row_mask:0xf bank_mask:0xf
v_mov_b64 v[54:55], s[46:47]
v_smfmac_f32_16x16x64_bf16 v[28:31], v[36:39], v[152:159], v1
global_load_dwordx4 v[84:87], v0, s[80:81] offset:-3072 sc1
v_cvt_pk_bf16_f32 v52, v44, v45
v_mfma_f32_16x16x32_bf16 v[12:15], v[60:63], v[48:51], 0
v_cvt_pk_bf16_f32 v53, v44, v45
v_cvt_pk_bf16_f32 v24, v24, v25
v_cvt_pk_bf16_f32 v25, v26, v27
v_mfma_f32_16x16x16_bf16 v[16:19], v[54:55], v[52:53], v[16:19]
s_nop 0
v_cvt_pk_bf16_f32 v27, v30, v31
v_cvt_pk_bf16_f32 v26, v28, v29
v_mfma_f32_16x16x16_bf16 v[8:11], v[24:25], v[52:53], v[8:11]
v_bfe_u32 v32, v0, 5, 1
v_mov_b64 v[38:39], 0
v_mfma_f32_16x16x16_bf16 v[12:15], v[26:27], v[52:53], v[12:15]
s_nop 0
v_mov_b64 v[42:43], 0
v_subrev_u32 v17, s37, v16
v_cmp_lt_u32 vcc, s38, v17
v_rcp_f32 v18, v16
v_mov_b64 v[36:37], 0
v_lshl_add_u32 v32, v32, 3, v5
v_mov_b64 v[40:41], 0
v_cndmask_b32 v11, v15, v11, s[42:43]
v_cndmask_b32 v8, v12, v8, s[42:43]
v_cndmask_b32 v9, v13, v9, s[42:43]
v_cndmask_b32 v10, v14, v10, s[42:43]
v_mul_f32 v8, v8, v18
v_mul_f32 v9, v9, v18
v_mul_f32 v11, v11, v18
v_mul_f32 v10, v10, v18
v_cvt_pk_bf16_f32 v13, v10, v11
v_cvt_pk_bf16_f32 v12, v8, v9
s_cbranch_vccnz rare_10026
back_10027:
ds_write_b64 v32, v[12:13] offset:512
v_mov_b32_dpp v11, v13 quad_perm:[2,3,2,3] row_mask:0xf bank_mask:0xf
v_mov_b64 v[52:53], 0
v_mov_b32_dpp v9, v13 quad_perm:[0,1,0,1] row_mask:0xf bank_mask:0xf
v_mov_b32_dpp v10, v12 quad_perm:[2,3,2,3] row_mask:0xf bank_mask:0xf
v_mov_b32_dpp v8, v12 quad_perm:[0,1,0,1] row_mask:0xf bank_mask:0xf
v_mov_b64 v[48:49], 0
s_waitcnt vmcnt(4)
v_mov_b64 v[54:55], 0
v_smfmac_f32_16x16x64_bf16 v[40:43], v[8:11], v[64:71], v1
ds_read_b128 v[16:19], v0 offset:30720
global_load_dwordx4 v[64:67], v0, s[76:77] offset:-4096 sc1
ds_read_b128 v[20:23], v0 offset:31744
v_mov_b64 v[32:33], 0
v_smfmac_f32_16x16x64_bf16 v[52:55], v[8:11], v[176:183], v1
s_waitcnt lgkmcnt(2)
ds_read_b128 v[28:31], v0 offset:33792
ds_read_b128 v[24:27], v0 offset:32768
s_barrier
global_load_dwordx4 v[68:71], v0, s[76:77] offset:-3072 sc1
ds_read_b128 v[56:59], v5 offset:0
v_mov_b64 v[50:51], 0
v_lshrrev_b32 v44, 8, v0
v_smfmac_f32_16x16x64_bf16 v[36:39], v[8:11], v[160:167], v1
s_waitcnt vmcnt(5)
ds_read_b128 v[60:63], v5 offset:1536
v_mov_b64 v[34:35], 0
v_smfmac_f32_16x16x64_bf16 v[48:51], v[8:11], v[168:175], v1
ds_read_b128 v[12:15], v5 offset:1024
v_bfe_u32 v45, v0, 1, 7
s_waitcnt vmcnt(4)
v_smfmac_f32_16x16x64_bf16 v[32:35], v[8:11], v[72:79], v1
global_load_dwordx4 v[72:75], v0, s[76:77] offset:0 sc1
s_waitcnt lgkmcnt(2)
v_smfmac_f32_16x16x64_bf16 v[36:39], v[56:59], v[184:191], v1
global_load_dwordx4 v[76:79], v0, s[76:77] offset:1024 sc1
s_waitcnt lgkmcnt(1)
v_smfmac_f32_16x16x64_bf16 v[36:39], v[60:63], v[16:23], v1
s_waitcnt lgkmcnt(0)
v_smfmac_f32_16x16x64_bf16 v[36:39], v[12:15], v[24:31], v1
ds_read_b128 v[24:27], v0 offset:34816
v_lshl_or_b32 v44, v44, 12, v45
v_smfmac_f32_16x16x64_bf16 v[40:43], v[56:59], v[192:199], v1
ds_read_b128 v[28:31], v0 offset:35840
s_waitcnt vmcnt(5)
v_smfmac_f32_16x16x64_bf16 v[32:35], v[56:59], v[240:247], v1
s_nop 0
ds_read_b128 v[20:23], v0 offset:37888
v_cvt_pk_bf16_f32 v36, v36, v37
v_smfmac_f32_16x16x64_bf16 v[48:51], v[56:59], v[200:207], v1
ds_read_b128 v[16:19], v0 offset:36864
v_and_or_b32 v36, v36, -2, s18
v_cvt_pk_bf16_f32 v37, v38, v39
s_waitcnt vmcnt(4)
v_smfmac_f32_16x16x64_bf16 v[40:43], v[60:63], v[80:87], v1
global_store_dwordx2 v44, v[36:37], s[48:49]
s_waitcnt lgkmcnt(2)
v_smfmac_f32_16x16x64_bf16 v[40:43], v[12:15], v[24:31], v1
s_mov_b64 s[70:71], s[74:75]
ds_read_b128 v[24:27], v0 offset:38912
s_add_u32 s58, s4, s20
v_smfmac_f32_16x16x64_bf16 v[48:51], v[60:63], v[208:215], v1
s_waitcnt lgkmcnt(2)
s_waitcnt lgkmcnt(1)
v_smfmac_f32_16x16x64_bf16 v[48:51], v[12:15], v[16:23], v1
ds_read_b128 v[28:31], v0 offset:39936
v_cvt_pk_bf16_f32 v40, v40, v41
v_and_or_b32 v40, v40, -2, s18
v_cvt_pk_bf16_f32 v41, v42, v43
v_smfmac_f32_16x16x64_bf16 v[52:55], v[56:59], v[216:223], v1
global_store_dwordx2 v44, v[40:41], s[50:51]
v_smfmac_f32_16x16x64_bf16 v[52:55], v[60:63], v[224:231], v1
s_mov_b64 s[68:69], s[72:73]
v_cvt_pk_bf16_f32 v48, v48, v49
v_smfmac_f32_16x16x64_bf16 v[52:55], v[12:15], v[232:239], v1
s_nop 0
s_waitcnt lgkmcnt(0)
v_and_or_b32 v48, v48, -2, s18
v_cvt_pk_bf16_f32 v49, v50, v51
v_smfmac_f32_16x16x64_bf16 v[32:35], v[60:63], v[248:255], v1
s_nop 0
global_store_dwordx2 v44, v[48:49], s[52:53]
s_nop 0
v_cvt_pk_bf16_f32 v52, v52, v53
v_cvt_pk_bf16_f32 v53, v54, v55
v_smfmac_f32_16x16x64_bf16 v[32:35], v[12:15], v[24:31], v1
s_nop 1
v_and_or_b32 v52, v52, -2, s18
s_nop 1
global_store_dwordx2 v44, v[52:53], s[54:55]
s_addc_u32 s59, s5, 0
s_nop 0
v_cvt_pk_bf16_f32 v32, v32, v33
v_and_or_b32 v32, v32, -2, s18
v_cvt_pk_bf16_f32 v33, v34, v35
global_store_dwordx2 v44, v[32:33], s[56:57]
v_bfe_u32 v32, v0, 6, 1
v_lshlrev_b32 v32, 4, v32
v_mov_b32 v33, 0x3f80
v_lshlrev_b32 v32, v32, v33
v_bfe_i32 v33, v0, 4, 1
v_and_b32 v45, v32, v33
v_and_b32 v47, v32, v33
v_xor_b32 v44, v32, v45
v_xor_b32 v46, v32, v45
v_and_b32 v36, 32, v0
v_bfe_u32 v37, v0, 6, 1
v_lshl_add_u32 v36, v37, 8, v36
v_bfe_u32 v37, v0, 8, 1
v_lshl_add_u32 v36, v37, 4, v36
v_bfe_u32 v37, v0, 4, 1
v_lshl_add_u32 v36, v37, 3, v36
v_and_b32 v7, 255, v0
v_lshl_add_u32 v7, v7, 3, s27
s_nop 15
s_nop 15
s_nop 15
s_nop 15
global_load_dwordx4 v[8:11], v0, s[64:65] offset:0 sc1
global_load_dwordx4 v[12:15], v0, s[64:65] offset:1024 sc1
global_load_dwordx4 v[16:19], v0, s[64:65] offset:2048 sc1
global_load_dwordx4 v[20:23], v0, s[64:65] offset:3072 sc1
s_nop 15
s_nop 15
s_nop 5
global_load_dwordx4 v[24:27], v0, s[64:65] offset:0 sc1
global_load_dwordx4 v[28:31], v0, s[64:65] offset:1024 sc1
global_load_dwordx4 v[48:51], v0, s[64:65] offset:2048 sc1
global_load_dwordx4 v[52:55], v0, s[64:65] offset:3072 sc1
chk_10035:
v_mov_b64 v[40:41], 0
v_mov_b64 v[42:43], 0
s_waitcnt vmcnt(6)
s_nop 0
v_smfmac_f32_16x16x64_bf16 v[40:43], v[44:47], v[8:15], v1
v_bitop3_b32 v32, v8, v10, s18 bitop3:0x7e
v_bitop3_b32 v33, v12, v14, s18 bitop3:0x7e
s_waitcnt vmcnt(4)
v_smfmac_f32_16x16x64_bf16 v[40:43], v[44:47], v[16:23], v1
v_bitop3_b32 v34, v16, v18, s18 bitop3:0x7e
v_bitop3_b32 v35, v20, v22, s18 bitop3:0x7e
v_or3_b32 v37, v32, v33, v34
v_bitop3_b32 v37, v37, v35, 1 bitop3:0xa8
v_cmp_ne_u32 vcc, 0, v37
s_cbranch_vccnz chk_10035_f
s_nop 1
v_add_f32_dpp v40, v40, v40 row_ror:8 row_mask:0xf bank_mask:0xf
v_add_f32_dpp v41, v41, v41 row_ror:8 row_mask:0xf bank_mask:0xf
v_add_f32_dpp v42, v42, v42 row_ror:8 row_mask:0xf bank_mask:0xf
v_add_f32_dpp v43, v43, v43 row_ror:8 row_mask:0xf bank_mask:0xf
v_cvt_pk_bf16_f32 v40, v40, v41
v_cvt_pk_bf16_f32 v41, v42, v43
v_and_or_b32 v40, v40, -2, s18
s_mov_b64 exec, 0x00ff00ff
global_store_dwordx2 v36, v[40:41], s[66:67]
s_mov_b64 exec, -1
s_branch join_10034
chk_10035_f:
global_load_dwordx4 v[8:11], v0, s[64:65] offset:0 sc1
global_load_dwordx4 v[12:15], v0, s[64:65] offset:1024 sc1
global_load_dwordx4 v[16:19], v0, s[64:65] offset:2048 sc1
global_load_dwordx4 v[20:23], v0, s[64:65] offset:3072 sc1
chk_10036:
v_mov_b64 v[40:41], 0
v_mov_b64 v[42:43], 0
s_waitcnt vmcnt(6)
s_nop 0
v_smfmac_f32_16x16x64_bf16 v[40:43], v[44:47], v[24:31], v1
v_bitop3_b32 v32, v24, v26, s18 bitop3:0x7e
v_bitop3_b32 v33, v28, v30, s18 bitop3:0x7e
s_waitcnt vmcnt(4)
v_smfmac_f32_16x16x64_bf16 v[40:43], v[44:47], v[48:55], v1
v_bitop3_b32 v34, v48, v50, s18 bitop3:0x7e
v_bitop3_b32 v35, v52, v54, s18 bitop3:0x7e
v_or3_b32 v37, v32, v33, v34
v_bitop3_b32 v37, v37, v35, 1 bitop3:0xa8
v_cmp_ne_u32 vcc, 0, v37
s_cbranch_vccnz chk_10036_f
s_nop 1
v_add_f32_dpp v40, v40, v40 row_ror:8 row_mask:0xf bank_mask:0xf
v_add_f32_dpp v41, v41, v41 row_ror:8 row_mask:0xf bank_mask:0xf
v_add_f32_dpp v42, v42, v42 row_ror:8 row_mask:0xf bank_mask:0xf
v_add_f32_dpp v43, v43, v43 row_ror:8 row_mask:0xf bank_mask:0xf
v_cvt_pk_bf16_f32 v40, v40, v41
v_cvt_pk_bf16_f32 v41, v42, v43
v_and_or_b32 v40, v40, -2, s18
s_mov_b64 exec, 0x00ff00ff
global_store_dwordx2 v36, v[40:41], s[66:67]
s_mov_b64 exec, -1
s_branch join_10034
chk_10036_f:
global_load_dwordx4 v[24:27], v0, s[64:65] offset:0 sc1
global_load_dwordx4 v[28:31], v0, s[64:65] offset:1024 sc1
global_load_dwordx4 v[48:51], v0, s[64:65] offset:2048 sc1
global_load_dwordx4 v[52:55], v0, s[64:65] offset:3072 sc1
s_add_u32 s30, s30, 1
s_cmp_le_u32 s30, 262144
s_cbranch_scc1 chk_10035
s_branch L_fail
nored_10033:
join_10034:
s_barrier
global_load_dwordx4 v[56:59], v0, s[76:77] offset:-2048 sc1
global_load_dwordx4 v[60:63], v0, s[76:77] offset:-1024 sc1
global_load_dwordx4 v[80:83], v0, s[76:77] offset:2048 sc1
global_load_dwordx4 v[84:87], v0, s[76:77] offset:3072 sc1
s_nop 15
s_nop 15
s_nop 13
s_barrier
global_load_dwordx4 v[32:35], v0, s[68:69] offset:-4096 sc1
s_nop 10
global_load_dwordx4 v[36:39], v0, s[68:69] offset:0 sc1
s_nop 10
global_load_dwordx4 v[40:43], v0, s[70:71] offset:0 sc1
s_barrier
global_load_dwordx4 v[24:27], v0, s[78:79] offset:-4096 sc1
global_load_dwordx4 v[28:31], v0, s[78:79] offset:-3072 sc1
global_load_dwordx4 v[48:51], v0, s[58:59] offset:0 nt sc1
global_load_dwordx4 v[52:55], v0, s[58:59] offset:1024 nt sc1
s_waitcnt vmcnt(15)
v_mov_b64 v[8:9], 0
v_mov_b64 v[10:11], 0
s_waitcnt vmcnt(14)
v_mov_b64 v[12:13], 0
v_mov_b64 v[14:15], 0
s_waitcnt vmcnt(13)
v_mov_b64 v[16:17], 0
v_mov_b64 v[18:19], 0
s_waitcnt vmcnt(12)
v_mov_b64 v[20:21], 0
v_mov_b64 v[22:23], 0
s_mov_b32 s30, 0
s_cmp_eq_u32 s17, s31
s_cbranch_scc0 gather_10025
s_branch exit_10028
rt_10030:
global_load_dwordx4 v[32:35], v0, s[68:69] offset:-4096 sc1
global_load_dwordx4 v[36:39], v0, s[68:69] offset:0 sc1
global_load_dwordx4 v[40:43], v0, s[70:71] offset:0 sc1
s_add_u32 s30, s30, 1
s_cmp_gt_u32 s30, 262144
s_cbranch_scc1 L_fail
s_mov_b64 exec, 1
global_store_dword v0, v0, s[62:63]
global_store_dword v0, v0, s[62:63]
global_store_dword v0, v0, s[62:63]
global_store_dword v0, v0, s[62:63]
s_mov_b64 exec, -1
v_mov_b64 v[8:9], 0
v_mov_b64 v[10:11], 0
v_mov_b64 v[12:13], 0
v_mov_b64 v[14:15], 0
v_mov_b64 v[16:17], 0
v_mov_b64 v[18:19], 0
v_mov_b64 v[20:21], 0
v_mov_b64 v[22:23], 0
s_branch gather_10025
rare_10026:
ds_read_b128 v[48:51], v6 offset:6144
ds_read_b128 v[52:55], v6 offset:7168
s_waitcnt lgkmcnt(0)
v_add_f32 v48, v48, v52
v_add_f32 v49, v49, v53
v_add_f32 v50, v50, v54
v_add_f32 v51, v51, v55
v_mov_b32_dpp v46, v46 quad_perm:[0,1,0,1] row_mask:0xf bank_mask:0xf
v_mov_b32_dpp v47, v47 quad_perm:[0,1,0,1] row_mask:0xf bank_mask:0xf
v_max3_f32 v19, v48, v49, v50
v_max3_f32 v19, v19, v51, v46
v_max_f32 v19, v19, v47
s_nop 1
v_max_f32_dpp v19, v19, v19 quad_perm:[2,3,0,1] row_mask:0xf bank_mask:0xf
v_mov_b32 v44, v19
s_nop 1
v_permlane32_swap_b32 v19, v44
v_max_f32 v19, v19, v44
v_mov_b32 v44, v19
s_nop 1
v_permlane16_swap_b32 v19, v44
v_max_f32 v19, v19, v44
v_sub_f32 v48, v48, v19
v_sub_f32 v49, v49, v19
v_sub_f32 v50, v50, v19
v_sub_f32 v51, v51, v19
v_sub_f32 v46, v46, v19
v_sub_f32 v47, v47, v19
v_exp_f32 v48, v48
v_exp_f32 v49, v49
v_exp_f32 v50, v50
v_exp_f32 v51, v51
v_cvt_pk_bf16_f32 v54, v48, v49
v_cvt_pk_bf16_f32 v55, v50, v51
s_nop 0
v_mov_b32_dpp v48, v54 quad_perm:[0,1,0,1] row_mask:0xf bank_mask:0xf
v_mov_b32_dpp v49, v55 quad_perm:[0,1,0,1] row_mask:0xf bank_mask:0xf
v_mov_b32_dpp v50, v54 quad_perm:[2,3,2,3] row_mask:0xf bank_mask:0xf
v_mov_b32_dpp v51, v55 quad_perm:[2,3,2,3] row_mask:0xf bank_mask:0xf
v_mov_b64 v[20:21], s[44:45]
v_mov_b64 v[22:23], s[44:45]
v_mfma_f32_16x16x32_bf16 v[8:11], v[56:59], v[48:51], 0
v_mfma_f32_16x16x32_bf16 v[12:15], v[60:63], v[48:51], 0
v_mfma_f32_16x16x32_bf16 v[16:19], v[20:23], v[48:51], 0
v_mov_b64 v[54:55], s[46:47]
v_exp_f32_dpp v44, v46 quad_perm:[0,1,0,1] row_mask:0xf bank_mask:0xf
v_exp_f32_dpp v45, v47 quad_perm:[0,1,0,1] row_mask:0xf bank_mask:0xf
s_nop 0
v_cvt_pk_bf16_f32 v52, v44, v45
v_cvt_pk_bf16_f32 v53, v44, v45
s_nop 1
v_mfma_f32_16x16x16_bf16 v[16:19], v[54:55], v[52:53], v[16:19]
v_mfma_f32_16x16x16_bf16 v[8:11], v[24:25], v[52:53], v[8:11]
v_mfma_f32_16x16x16_bf16 v[12:15], v[26:27], v[52:53], v[12:15]
s_nop 5
v_rcp_f32 v18, v16
s_nop 0
v_cndmask_b32 v8, v12, v8, s[42:43]
v_mul_f32 v8, v8, v18
v_cndmask_b32 v9, v13, v9, s[42:43]
v_mul_f32 v9, v9, v18
v_cndmask_b32 v10, v14, v10, s[42:43]
v_mul_f32 v10, v10, v18
v_cndmask_b32 v11, v15, v11, s[42:43]
v_mul_f32 v11, v11, v18
v_cvt_pk_bf16_f32 v12, v8, v9
v_cvt_pk_bf16_f32 v13, v10, v11
s_branch back_10027
exit_10028:
global_load_dwordx4 v[32:35], v0, s[68:69] offset:-4096 sc1
global_load_dwordx4 v[36:39], v0, s[68:69] offset:0 sc1
global_load_dwordx4 v[40:43], v0, s[70:71] offset:0 sc1
s_add_u32 s30, s30, 1
s_cmp_gt_u32 s30, 262144
s_cbranch_scc1 L_fail
s_waitcnt vmcnt(2)
v_bitop3_b32 v44, v32, v34, s18 bitop3:0x7e
s_waitcnt vmcnt(1)
v_bitop3_b32 v45, v36, v38, s18 bitop3:0x7e
v_or_b32 v44, v44, v45
s_waitcnt vmcnt(0)
v_bitop3_b32 v46, v40, v42, s18 bitop3:0x7e
v_bitop3_b32 v44, v44, v46, s19 bitop3:0xa8
v_cmp_ne_u32 vcc, 0, v44
s_cbranch_vccnz exit_10028
s_add_u32 s36, s36, 1
s_cmp_lt_u32 s36, 2
s_cbranch_scc1 layer_10024
s_endpgm
wave_10007:
layer_10037:
s_lshl_b32 s17, s36, 6
s_mul_i32 s27, s36, 35651584
s_mul_i32 s28, s14, 16384
s_add_u32 s27, s27, s28
s_add_u32 s20, s27, 16785408
s_mul_i32 s27, s17, 10240
s_add_u32 s27, s27, s24
s_add_u32 s21, s27, s25
s_mov_b32 s19, 0
s_mov_b32 s33, s6
s_add_u32 s34, s17, 1
s_add_u32 s31, s17, 63
s_add_u32 s32, s17, 64
s_mov_b32 s27, s20
v_mov_b32 v7, 0
s_add_u32 s68, s4, 415744
s_addc_u32 s69, s5, 0
s_add_u32 s72, s4, 399360
s_addc_u32 s73, s5, 0
s_add_u32 s70, s4, 419840
s_addc_u32 s71, s5, 0
s_add_u32 s74, s4, 403456
s_addc_u32 s75, s5, 0
s_add_u32 s58, s4, s20
s_addc_u32 s59, s5, 0
global_load_dwordx4 v[64:67], v0, s[76:77] offset:-4096 sc1
global_load_dwordx4 v[68:71], v0, s[76:77] offset:-3072 sc1
global_load_dwordx4 v[72:75], v0, s[76:77] offset:0 sc1
global_load_dwordx4 v[76:79], v0, s[76:77] offset:1024 sc1
global_load_dwordx4 v[80:83], v0, s[76:77] offset:2048 sc1
global_load_dwordx4 v[84:87], v0, s[76:77] offset:3072 sc1
global_load_dwordx4 v[56:59], v0, s[76:77] offset:-2048 sc1
global_load_dwordx4 v[60:63], v0, s[76:77] offset:-1024 sc1
global_load_dwordx4 v[24:27], v0, s[78:79] offset:-4096 sc1
global_load_dwordx4 v[28:31], v0, s[78:79] offset:-3072 sc1
v_mov_b64 v[8:9], 0
v_mov_b64 v[10:11], 0
v_mov_b64 v[12:13], 0
v_mov_b64 v[14:15], 0
v_mov_b64 v[16:17], 0
v_mov_b64 v[18:19], 0
v_mov_b64 v[20:21], 0
v_mov_b64 v[22:23], 0
s_barrier
global_load_dwordx4 v[48:51], v0, s[58:59] offset:0 nt sc1
global_load_dwordx4 v[52:55], v0, s[58:59] offset:1024 nt sc1
v_and_b32 v7, 255, v0
v_lshl_add_u32 v7, v7, 3, s27
global_load_dwordx4 v[32:35], v0, s[68:69] offset:-4096 sc1
global_load_dwordx4 v[36:39], v0, s[68:69] offset:0 sc1
v_mov_b32 v45, -1
s_mov_b32 s30, 0
s_waitcnt vmcnt(0)
.p2align 6
gather_10038:
s_waitcnt vmcnt(5)
rt_10043_b:
v_smfmac_f32_16x16x64_bf16 v[12:15], v[32:35], v[56:63], v1
ds_write_b128 v0, v[32:35] offset:2048
v_smfmac_f32_16x16x64_bf16 v[20:23], v[32:35], v[72:79], v1
v_bitop3_b32 v44, v32, v34, s18 bitop3:0x7e
v_smfmac_f32_16x16x64_bf16 v[8:11], v[32:35], v[64:71], v1
s_waitcnt vmcnt(4)
ds_write_b128 v0, v[36:39] offset:6144
v_bitop3_b32 v45, v36, v38, s18 bitop3:0x7e
v_smfmac_f32_16x16x64_bf16 v[8:11], v[36:39], v[80:87], v1
v_bitop3_b32 v44, v44, v45, s19 bitop3:0xa8
v_cmp_ne_u32 vcc, 0, v44
v_smfmac_f32_16x16x64_bf16 v[20:23], v[36:39], a[24:31], v1
s_cbranch_vccnz rt_10043
ds_read_b128 v[76:79], v2 offset:1024
global_load_dwordx4 v[64:67], v0, s[78:79] offset:-2048 sc1
ds_read_b128 v[72:75], v2 offset:0
global_load_dwordx4 v[68:71], v0, s[78:79] offset:-1024 sc1
ds_read_b128 v[84:87], v2 offset:5120
s_waitcnt lgkmcnt(3)
s_barrier
ds_read_b128 v[40:43], v0 offset:3072
v_smfmac_f32_16x16x64_bf16 v[16:19], v[32:35], a[0:7], v1
ds_read_b128 v[44:47], v0 offset:7168
global_load_dwordx4 v[56:59], v0, s[58:59] offset:2048 nt sc1
ds_read_b128 v[32:35], v0 offset:0
v_smfmac_f32_16x16x64_bf16 v[12:15], v[36:39], a[8:15], v1
s_mov_b32 s30, 0
ds_read_b128 v[80:83], v2 offset:4096
v_smfmac_f32_16x16x64_bf16 v[16:19], v[36:39], a[16:23], v1
s_waitcnt lgkmcnt(5)
ds_read_b128 v[36:39], v0 offset:4096
global_load_dwordx4 v[60:63], v0, s[58:59] offset:3072 nt sc1
s_waitcnt lgkmcnt(4)
v_smfmac_f32_16x16x64_bf16 v[8:11], v[40:43], v[72:79], v1
ds_read_b128 v[72:75], v2 offset:2048
v_smfmac_f32_16x16x64_bf16 v[12:15], v[40:43], a[32:39], v1
s_waitcnt lgkmcnt(4)
ds_read_b128 v[40:43], v0 offset:1024
v_smfmac_f32_16x16x64_bf16 v[8:11], v[44:47], a[40:47], v1
s_waitcnt lgkmcnt(4)
ds_read_b128 v[76:79], v2 offset:3072
s_waitcnt vmcnt(6)
v_smfmac_f32_16x16x64_bf16 v[12:15], v[44:47], v[24:31], v1
ds_read_b128 v[28:31], v2 offset:7168
v_smfmac_f32_16x16x64_bf16 v[12:15], v[32:35], a[56:63], v1
s_mov_b32 s19, 1
ds_read_b128 v[24:27], v2 offset:6144
v_smfmac_f32_16x16x64_bf16 v[8:11], v[32:35], a[48:55], v1
s_waitcnt lgkmcnt(4)
ds_read_b128 v[44:47], v0 offset:5120
v_smfmac_f32_16x16x64_bf16 v[12:15], v[36:39], a[64:71], v1
ds_read_b128 v[32:35], v0 offset:8192
s_waitcnt lgkmcnt(4)
v_smfmac_f32_16x16x64_bf16 v[8:11], v[36:39], v[72:79], v1
ds_read_b128 v[36:39], v0 offset:9216
s_waitcnt lgkmcnt(4)
v_smfmac_f32_16x16x64_bf16 v[8:11], v[40:43], v[80:87], v1
ds_read_b128 v[84:87], v2 offset:9216
s_waitcnt lgkmcnt(4)
v_smfmac_f32_16x16x64_bf16 v[12:15], v[40:43], v[24:31], v1
ds_read_b128 v[80:83], v2 offset:8192
s_waitcnt lgkmcnt(4)
v_smfmac_f32_16x16x64_bf16 v[12:15], v[44:47], a[80:87], v1
ds_read_b128 v[76:79], v2 offset:11264
s_waitcnt lgkmcnt(4)
v_smfmac_f32_16x16x64_bf16 v[12:15], v[32:35], a[88:95], v1
ds_read_b128 v[72:75], v2 offset:10240
s_waitcnt lgkmcnt(4)
v_smfmac_f32_16x16x64_bf16 v[8:11], v[44:47], a[72:79], v1
ds_read_b128 v[40:43], v0 offset:3072
global_load_dword v7, v7, s[4:5] sc1
ds_read_b128 v[28:31], v2 offset:13312
s_waitcnt lgkmcnt(4)
v_smfmac_f32_16x16x64_bf16 v[8:11], v[32:35], v[80:87], v1
s_waitcnt vmcnt(3)
ds_read_b128 v[24:27], v2 offset:12288
v_smfmac_f32_16x16x64_bf16 v[8:11], v[36:39], a[96:103], v1
s_nop 0
ds_read_b128 v[32:35], v0 offset:7168
s_waitcnt lgkmcnt(4)
v_smfmac_f32_16x16x64_bf16 v[12:15], v[36:39], v[72:79], v1
s_nop 0
ds_read_b128 v[36:39], v0 offset:0
s_waitcnt lgkmcnt(4)
ds_read_b128 v[72:75], v2 offset:16384
v_add_f32 v9, v9, v11
v_smfmac_f32_16x16x64_bf16 v[16:19], v[40:43], a[104:111], v1
s_xor_b32 s18, s18, 1
ds_read_b128 v[76:79], v2 offset:17408
v_add_f32 v8, v8, v10
v_smfmac_f32_16x16x64_bf16 v[20:23], v[40:43], a[112:119], v1
s_waitcnt lgkmcnt(5)
ds_read_b128 v[40:43], v0 offset:4096
v_add_f32 v12, v12, v14
v_mul_f32 v9, s35, v9
s_waitcnt lgkmcnt(4)
v_smfmac_f32_16x16x64_bf16 v[16:19], v[32:35], v[24:31], v1
ds_read_b128 v[84:87], v2 offset:15360
v_mul_f32 v8, s35, v8
v_cvt_pk_bf16_f32 v8, v8, v9
v_smfmac_f32_16x16x64_bf16 v[20:23], v[32:35], v[64:71], v1
s_waitcnt lgkmcnt(4)
ds_read_b128 v[80:83], v2 offset:14336
v_add_f32 v13, v13, v15
v_smfmac_f32_16x16x64_bf16 v[20:23], v[36:39], a[128:135], v1
ds_read_b128 v[32:35], v0 offset:1024
v_mul_f32 v12, s35, v12
v_mul_f32 v13, s35, v13
v_smfmac_f32_16x16x64_bf16 v[16:19], v[36:39], a[120:127], v1
s_waitcnt lgkmcnt(3)
ds_read_b128 v[36:39], v0 offset:5120
v_cvt_pk_bf16_f32 v12, v12, v13
v_smfmac_f32_16x16x64_bf16 v[20:23], v[40:43], a[144:151], v1
ds_write2_b32 v3, v8, v12 offset0:0 offset1:128
v_mov_b64 v[26:27], 0
v_smfmac_f32_16x16x64_bf16 v[16:19], v[40:43], a[136:143], v1
s_waitcnt lgkmcnt(2)
ds_read_b128 v[40:43], v0 offset:8192
v_smfmac_f32_16x16x64_bf16 v[16:19], v[32:35], a[152:159], v1
s_mov_b64 vcc, s[42:43]
ds_read_b128 v[68:71], v2 offset:19456
v_mov_b64 v[30:31], 0
v_smfmac_f32_16x16x64_bf16 v[20:23], v[32:35], a[160:167], v1
s_waitcnt lgkmcnt(3)
ds_read_b128 v[32:35], v0 offset:9216
v_mov_b64 v[24:25], 0
v_smfmac_f32_16x16x64_bf16 v[20:23], v[36:39], v[80:87], v1
s_add_u32 s20, s20, 524288
ds_read_b128 v[64:67], v2 offset:18432
v_mov_b64 v[28:29], 0
v_smfmac_f32_16x16x64_bf16 v[16:19], v[36:39], a[168:175], v1
ds_read_b128 v[36:39], v0 offset:8192
s_waitcnt lgkmcnt(4)
v_smfmac_f32_16x16x64_bf16 v[20:23], v[40:43], v[72:79], v1
s_barrier
ds_read_b64_tr_b16 v[8:9], v4 offset:2048
v_smfmac_f32_16x16x64_bf16 v[16:19], v[40:43], a[176:183], v1
s_waitcnt lgkmcnt(3)
ds_read_b64_tr_b16 v[14:15], v4 offset:3584
ds_read_b64_tr_b16 v[10:11], v4 offset:2560
v_smfmac_f32_16x16x64_bf16 v[16:19], v[32:35], a[184:191], v1
s_nop 0
ds_read_b64_tr_b16 v[12:13], v4 offset:3072
ds_read_b128 v[40:43], v0 offset:9216
v_smfmac_f32_16x16x64_bf16 v[20:23], v[32:35], a[192:199], v1
s_add_u32 s17, s17, 1
ds_read_b128 v[72:75], v2 offset:20480
s_waitcnt lgkmcnt(6)
ds_read_b128 v[80:83], v0 offset:40960
v_add_f32 v17, v17, v19
v_add_f32 v16, v16, v18
v_cvt_pk_bf16_f32 v16, v16, v17
v_smfmac_f32_16x16x64_bf16 v[24:27], v[36:39], a[200:207], v1
s_waitcnt lgkmcnt(6)
ds_read_b128 v[76:79], v2 offset:21504
s_waitcnt lgkmcnt(5)
v_mfma_f32_16x16x32_bf16 v[44:47], v[48:51], v[8:11], 0
s_waitcnt lgkmcnt(4)
ds_read_b128 v[84:87], v0 offset:41984
v_add_f32 v21, v21, v23
v_mfma_f32_16x16x32_bf16 v[44:47], v[52:55], v[12:15], v[44:47]
ds_read_b128 v[32:35], v0 offset:2048
v_bfe_u32 v48, v0, 5, 1
v_add_f32 v20, v20, v22
v_cvt_pk_bf16_f32 v20, v20, v21
v_smfmac_f32_16x16x64_bf16 v[28:31], v[36:39], a[208:215], v1
s_waitcnt lgkmcnt(5)
ds_write2_b32 v3, v16, v20 offset0:1 offset1:129
v_lshl_add_u32 v48, v48, 3, v5
v_cndmask_b32_dpp v45, v47, v45, vcc quad_perm:[0,1,0,1] row_mask:0xf bank_mask:0xf
v_smfmac_f32_16x16x64_bf16 v[24:27], v[40:43], v[64:71], v1
s_add_u32 s21, s21, 10240
ds_read_b128 v[36:39], v0 offset:6144
v_cndmask_b32_dpp v44, v46, v44, vcc quad_perm:[0,1,0,1] row_mask:0xf bank_mask:0xf
v_smfmac_f32_16x16x64_bf16 v[28:31], v[40:43], a[216:223], v1
s_waitcnt lgkmcnt(2)
ds_write_b64 v48, v[44:45] offset:7168
v_smfmac_f32_16x16x64_bf16 v[24:27], v[32:35], v[72:79], v1
global_load_dwordx4 v[64:67], v0, s[78:79] offset:0 sc1
ds_read_b128 v[72:75], v2 offset:22528
v_smfmac_f32_16x16x64_bf16 v[28:31], v[32:35], a[224:231], v1
ds_read_b128 v[40:43], v0 offset:3072
s_waitcnt lgkmcnt(3)
v_smfmac_f32_16x16x64_bf16 v[28:31], v[36:39], a[240:247], v1
ds_read_b128 v[76:79], v2 offset:23552
global_load_dwordx4 v[68:71], v0, s[78:79] offset:1024 sc1
ds_read_b128 v[32:35], v0 offset:7168
v_smfmac_f32_16x16x64_bf16 v[24:27], v[36:39], a[232:239], v1
s_waitcnt lgkmcnt(4)
ds_read_b128 v[36:39], v0 offset:0
s_barrier
ds_read_b128 v[48:51], v6 offset:6144
s_waitcnt lgkmcnt(4)
v_smfmac_f32_16x16x64_bf16 v[28:31], v[40:43], v[80:87], v1
s_add_u32 s34, s17, 2
ds_read_b64_tr_b16 v[22:23], v4 offset:3584
s_waitcnt lgkmcnt(4)
ds_read_b128 v[52:55], v6 offset:7168
v_smfmac_f32_16x16x64_bf16 v[24:27], v[40:43], v[72:79], v1
ds_read_b128 v[40:43], v0 offset:4096
s_waitcnt lgkmcnt(5)
ds_read_b64_tr_b16 v[8:9], v4 offset:0
v_smfmac_f32_16x16x64_bf16 v[24:27], v[32:35], a[248:255], v1
s_waitcnt lgkmcnt(5)
ds_read_b64_tr_b16 v[16:17], v4 offset:2048
global_load_dwordx4 v[72:75], v0, s[78:79] offset:2048 sc1
ds_read_b64_tr_b16 v[18:19], v4 offset:2560
v_smfmac_f32_16x16x64_bf16 v[28:31], v[32:35], v[88:95], v1
global_load_dwordx4 v[76:79], v0, s[78:79] offset:3072 sc1
ds_read_b128 v[32:35], v0 offset:1024
v_smfmac_f32_16x16x64_bf16 v[24:27], v[36:39], v[96:103], v1
s_waitcnt lgkmcnt(5)
ds_read_b64_tr_b16 v[10:11], v4 offset:512
v_add_f32 v49, v49, v53
v_smfmac_f32_16x16x64_bf16 v[28:31], v[36:39], v[104:111], v1
s_waitcnt lgkmcnt(5)
ds_read_b64_tr_b16 v[12:13], v4 offset:1024
v_add_f32 v48, v48, v52
v_add_f32 v50, v50, v54
v_smfmac_f32_16x16x64_bf16 v[24:27], v[40:43], v[112:119], v1
ds_read_b128 v[36:39], v0 offset:5120
v_exp_f32 v49, v49
v_smfmac_f32_16x16x64_bf16 v[28:31], v[40:43], v[120:127], v1
s_waitcnt lgkmcnt(3)
ds_read_b64_tr_b16 v[14:15], v4 offset:1536
v_add_f32 v51, v51, v55
v_smfmac_f32_16x16x64_bf16 v[28:31], v[32:35], v[136:143], v1
s_waitcnt lgkmcnt(3)
ds_read_b64_tr_b16 v[20:21], v4 offset:3072
v_exp_f32 v51, v51
v_mfma_f32_16x16x32_bf16 v[44:47], v[8:11], v[8:11], 0
v_exp_f32 v48, v48
v_exp_f32 v50, v50
v_smfmac_f32_16x16x64_bf16 v[24:27], v[32:35], v[128:135], v1
s_waitcnt lgkmcnt(1)
s_min_u32 s34, s34, s32
v_cvt_pk_bf16_f32 v55, v50, v51
v_mfma_f32_16x16x32_bf16 v[44:47], v[12:15], v[12:15], v[44:47]
s_nop 0
v_mov_b32_dpp v51, v55 quad_perm:[2,3,2,3] row_mask:0xf bank_mask:0xf
v_cvt_pk_bf16_f32 v54, v48, v49
v_mfma_f32_16x16x32_bf16 v[44:47], v[16:19], v[16:19], v[44:47]
s_waitcnt lgkmcnt(0)
v_mov_b32_dpp v48, v54 quad_perm:[0,1,0,1] row_mask:0xf bank_mask:0xf
v_mov_b32_dpp v49, v55 quad_perm:[0,1,0,1] row_mask:0xf bank_mask:0xf
v_mov_b32_dpp v50, v54 quad_perm:[2,3,2,3] row_mask:0xf bank_mask:0xf
v_mfma_f32_16x16x32_bf16 v[44:47], v[20:23], v[20:23], v[44:47]
s_add_u32 s27, s20, 524288
v_mov_b64 v[20:21], s[44:45]
v_mov_b64 v[22:23], s[44:45]
v_smfmac_f32_16x16x64_bf16 v[24:27], v[36:39], v[144:151], v1
s_waitcnt vmcnt(5)
global_load_dwordx4 v[80:83], v0, s[80:81] offset:-4096 sc1
v_mfma_f32_16x16x32_bf16 v[16:19], v[20:23], v[48:51], 0
s_nop 0
v_exp_f32_dpp v44, v46 quad_perm:[0,1,0,1] row_mask:0xf bank_mask:0xf
v_mfma_f32_16x16x32_bf16 v[8:11], v[56:59], v[48:51], 0
v_exp_f32_dpp v45, v47 quad_perm:[0,1,0,1] row_mask:0xf bank_mask:0xf
v_mov_b64 v[54:55], s[46:47]
v_smfmac_f32_16x16x64_bf16 v[28:31], v[36:39], v[152:159], v1
global_load_dwordx4 v[84:87], v0, s[80:81] offset:-3072 sc1
v_cvt_pk_bf16_f32 v52, v44, v45
v_mfma_f32_16x16x32_bf16 v[12:15], v[60:63], v[48:51], 0
v_cvt_pk_bf16_f32 v53, v44, v45
v_cvt_pk_bf16_f32 v24, v24, v25
v_cvt_pk_bf16_f32 v25, v26, v27
v_mfma_f32_16x16x16_bf16 v[16:19], v[54:55], v[52:53], v[16:19]
s_nop 0
v_cvt_pk_bf16_f32 v27, v30, v31
v_cvt_pk_bf16_f32 v26, v28, v29
v_mfma_f32_16x16x16_bf16 v[8:11], v[24:25], v[52:53], v[8:11]
v_bfe_u32 v32, v0, 5, 1
v_mov_b64 v[38:39], 0
v_mfma_f32_16x16x16_bf16 v[12:15], v[26:27], v[52:53], v[12:15]
s_nop 0
v_mov_b64 v[42:43], 0
v_subrev_u32 v17, s37, v16
v_cmp_lt_u32 vcc, s38, v17
v_rcp_f32 v18, v16
v_mov_b64 v[36:37], 0
v_lshl_add_u32 v32, v32, 3, v5
v_mov_b64 v[40:41], 0
v_cndmask_b32 v11, v15, v11, s[42:43]
v_cndmask_b32 v8, v12, v8, s[42:43]
v_cndmask_b32 v9, v13, v9, s[42:43]
v_cndmask_b32 v10, v14, v10, s[42:43]
v_mul_f32 v8, v8, v18
v_mul_f32 v9, v9, v18
v_mul_f32 v11, v11, v18
v_mul_f32 v10, v10, v18
v_cvt_pk_bf16_f32 v13, v10, v11
v_cvt_pk_bf16_f32 v12, v8, v9
s_cbranch_vccnz rare_10039
back_10040:
ds_write_b64 v32, v[12:13] offset:1024
v_mov_b32_dpp v11, v13 quad_perm:[2,3,2,3] row_mask:0xf bank_mask:0xf
v_mov_b64 v[52:53], 0
v_mov_b32_dpp v9, v13 quad_perm:[0,1,0,1] row_mask:0xf bank_mask:0xf
v_mov_b32_dpp v10, v12 quad_perm:[2,3,2,3] row_mask:0xf bank_mask:0xf
v_mov_b32_dpp v8, v12 quad_perm:[0,1,0,1] row_mask:0xf bank_mask:0xf
v_mov_b64 v[48:49], 0
s_waitcnt vmcnt(4)
v_mov_b64 v[54:55], 0
v_smfmac_f32_16x16x64_bf16 v[40:43], v[8:11], v[64:71], v1
ds_read_b128 v[16:19], v0 offset:43008
global_load_dwordx4 v[64:67], v0, s[76:77] offset:-4096 sc1
ds_read_b128 v[20:23], v0 offset:44032
v_mov_b64 v[32:33], 0
v_smfmac_f32_16x16x64_bf16 v[52:55], v[8:11], v[176:183], v1
s_waitcnt lgkmcnt(2)
ds_read_b128 v[28:31], v0 offset:46080
ds_read_b128 v[24:27], v0 offset:45056
s_barrier
global_load_dwordx4 v[68:71], v0, s[76:77] offset:-3072 sc1
ds_read_b128 v[56:59], v5 offset:1536
v_mov_b64 v[50:51], 0
v_lshrrev_b32 v44, 8, v0
v_smfmac_f32_16x16x64_bf16 v[36:39], v[8:11], v[160:167], v1
s_waitcnt vmcnt(5)
ds_read_b128 v[60:63], v5 offset:0
v_mov_b64 v[34:35], 0
v_smfmac_f32_16x16x64_bf16 v[48:51], v[8:11], v[168:175], v1
ds_read_b128 v[12:15], v5 offset:512
v_bfe_u32 v45, v0, 1, 7
s_waitcnt vmcnt(4)
v_smfmac_f32_16x16x64_bf16 v[32:35], v[8:11], v[72:79], v1
global_load_dwordx4 v[72:75], v0, s[76:77] offset:0 sc1
s_waitcnt lgkmcnt(2)
v_smfmac_f32_16x16x64_bf16 v[36:39], v[56:59], v[184:191], v1
global_load_dwordx4 v[76:79], v0, s[76:77] offset:1024 sc1
s_waitcnt lgkmcnt(1)
v_smfmac_f32_16x16x64_bf16 v[36:39], v[60:63], v[16:23], v1
s_waitcnt lgkmcnt(0)
v_smfmac_f32_16x16x64_bf16 v[36:39], v[12:15], v[24:31], v1
ds_read_b128 v[24:27], v0 offset:47104
v_lshl_or_b32 v44, v44, 12, v45
v_smfmac_f32_16x16x64_bf16 v[40:43], v[56:59], v[192:199], v1
ds_read_b128 v[28:31], v0 offset:48128
s_waitcnt vmcnt(5)
v_smfmac_f32_16x16x64_bf16 v[32:35], v[56:59], v[240:247], v1
s_nop 0
ds_read_b128 v[20:23], v0 offset:50176
v_cvt_pk_bf16_f32 v36, v36, v37
v_smfmac_f32_16x16x64_bf16 v[48:51], v[56:59], v[200:207], v1
ds_read_b128 v[16:19], v0 offset:49152
v_and_or_b32 v36, v36, -2, s18
v_cvt_pk_bf16_f32 v37, v38, v39
s_waitcnt vmcnt(4)
v_smfmac_f32_16x16x64_bf16 v[40:43], v[60:63], v[80:87], v1
global_store_dwordx2 v44, v[36:37], s[48:49]
s_waitcnt lgkmcnt(2)
v_smfmac_f32_16x16x64_bf16 v[40:43], v[12:15], v[24:31], v1
ds_read_b128 v[24:27], v0 offset:51200
s_add_u32 s58, s4, s20
v_smfmac_f32_16x16x64_bf16 v[48:51], v[60:63], v[208:215], v1
s_waitcnt lgkmcnt(2)
s_waitcnt lgkmcnt(1)
v_smfmac_f32_16x16x64_bf16 v[48:51], v[12:15], v[16:23], v1
s_nop 0
ds_read_b128 v[28:31], v0 offset:52224
v_cvt_pk_bf16_f32 v40, v40, v41
v_and_or_b32 v40, v40, -2, s18
v_cvt_pk_bf16_f32 v41, v42, v43
v_smfmac_f32_16x16x64_bf16 v[52:55], v[56:59], v[216:223], v1
global_store_dwordx2 v44, v[40:41], s[50:51]
v_smfmac_f32_16x16x64_bf16 v[52:55], v[60:63], v[224:231], v1
s_mov_b64 s[68:69], s[72:73]
v_cvt_pk_bf16_f32 v48, v48, v49
v_smfmac_f32_16x16x64_bf16 v[52:55], v[12:15], v[232:239], v1
s_nop 0
s_waitcnt lgkmcnt(0)
v_and_or_b32 v48, v48, -2, s18
v_cvt_pk_bf16_f32 v49, v50, v51
v_smfmac_f32_16x16x64_bf16 v[32:35], v[60:63], v[248:255], v1
s_nop 0
global_store_dwordx2 v44, v[48:49], s[52:53]
s_nop 0
v_cvt_pk_bf16_f32 v52, v52, v53
v_cvt_pk_bf16_f32 v53, v54, v55
v_smfmac_f32_16x16x64_bf16 v[32:35], v[12:15], v[24:31], v1
s_nop 1
v_and_or_b32 v52, v52, -2, s18
s_nop 1
global_store_dwordx2 v44, v[52:53], s[54:55]
s_addc_u32 s59, s5, 0
s_nop 0
v_cvt_pk_bf16_f32 v32, v32, v33
v_and_or_b32 v32, v32, -2, s18
v_cvt_pk_bf16_f32 v33, v34, v35
global_store_dwordx2 v44, v[32:33], s[56:57]
s_cmp_ge_u32 s14, 16
s_cbranch_scc1 nored_10046
v_bfe_u32 v32, v0, 6, 1
v_lshlrev_b32 v32, 4, v32
v_mov_b32 v33, 0x3f80
v_lshlrev_b32 v32, v32, v33
v_bfe_i32 v33, v0, 4, 1
v_and_b32 v45, v32, v33
v_and_b32 v47, v32, v33
v_xor_b32 v44, v32, v45
v_xor_b32 v46, v32, v45
v_and_b32 v36, 32, v0
v_bfe_u32 v37, v0, 6, 1
v_lshl_add_u32 v36, v37, 8, v36
v_bfe_u32 v37, v0, 8, 1
v_lshl_add_u32 v36, v37, 4, v36
v_bfe_u32 v37, v0, 4, 1
v_lshl_add_u32 v36, v37, 3, v36
v_and_b32 v7, 255, v0
v_lshl_add_u32 v7, v7, 3, s27
s_nop 15
s_nop 15
s_nop 15
s_nop 15
s_nop 12
global_load_dwordx4 v[8:11], v0, s[64:65] offset:0 sc1
global_load_dwordx4 v[12:15], v0, s[64:65] offset:1024 sc1
global_load_dwordx4 v[16:19], v0, s[64:65] offset:2048 sc1
global_load_dwordx4 v[20:23], v0, s[64:65] offset:3072 sc1
s_nop 15
s_nop 15
s_nop 5
global_load_dwordx4 v[24:27], v0, s[64:65] offset:0 sc1
global_load_dwordx4 v[28:31], v0, s[64:65] offset:1024 sc1
global_load_dwordx4 v[48:51], v0, s[64:65] offset:2048 sc1
global_load_dwordx4 v[52:55], v0, s[64:65] offset:3072 sc1
chk_10048:
v_mov_b64 v[40:41], 0
v_mov_b64 v[42:43], 0
s_waitcnt vmcnt(6)
s_nop 0
v_smfmac_f32_16x16x64_bf16 v[40:43], v[44:47], v[8:15], v1
v_bitop3_b32 v32, v8, v10, s18 bitop3:0x7e
v_bitop3_b32 v33, v12, v14, s18 bitop3:0x7e
s_waitcnt vmcnt(4)
v_smfmac_f32_16x16x64_bf16 v[40:43], v[44:47], v[16:23], v1
v_bitop3_b32 v34, v16, v18, s18 bitop3:0x7e
v_bitop3_b32 v35, v20, v22, s18 bitop3:0x7e
v_or3_b32 v37, v32, v33, v34
v_bitop3_b32 v37, v37, v35, 1 bitop3:0xa8
v_cmp_ne_u32 vcc, 0, v37
s_cbranch_vccnz chk_10048_f
s_nop 1
v_add_f32_dpp v40, v40, v40 row_ror:8 row_mask:0xf bank_mask:0xf
v_add_f32_dpp v41, v41, v41 row_ror:8 row_mask:0xf bank_mask:0xf
v_add_f32_dpp v42, v42, v42 row_ror:8 row_mask:0xf bank_mask:0xf
v_add_f32_dpp v43, v43, v43 row_ror:8 row_mask:0xf bank_mask:0xf
v_cvt_pk_bf16_f32 v40, v40, v41
v_cvt_pk_bf16_f32 v41, v42, v43
v_and_or_b32 v40, v40, -2, s18
s_mov_b64 exec, 0x00ff00ff
global_store_dwordx2 v36, v[40:41], s[66:67]
s_mov_b64 exec, -1
s_branch join_10047
chk_10048_f:
global_load_dwordx4 v[8:11], v0, s[64:65] offset:0 sc1
global_load_dwordx4 v[12:15], v0, s[64:65] offset:1024 sc1
global_load_dwordx4 v[16:19], v0, s[64:65] offset:2048 sc1
global_load_dwordx4 v[20:23], v0, s[64:65] offset:3072 sc1
chk_10049:
v_mov_b64 v[40:41], 0
v_mov_b64 v[42:43], 0
s_waitcnt vmcnt(6)
s_nop 0
v_smfmac_f32_16x16x64_bf16 v[40:43], v[44:47], v[24:31], v1
v_bitop3_b32 v32, v24, v26, s18 bitop3:0x7e
v_bitop3_b32 v33, v28, v30, s18 bitop3:0x7e
s_waitcnt vmcnt(4)
v_smfmac_f32_16x16x64_bf16 v[40:43], v[44:47], v[48:55], v1
v_bitop3_b32 v34, v48, v50, s18 bitop3:0x7e
v_bitop3_b32 v35, v52, v54, s18 bitop3:0x7e
v_or3_b32 v37, v32, v33, v34
v_bitop3_b32 v37, v37, v35, 1 bitop3:0xa8
v_cmp_ne_u32 vcc, 0, v37
s_cbranch_vccnz chk_10049_f
s_nop 1
v_add_f32_dpp v40, v40, v40 row_ror:8 row_mask:0xf bank_mask:0xf
v_add_f32_dpp v41, v41, v41 row_ror:8 row_mask:0xf bank_mask:0xf
v_add_f32_dpp v42, v42, v42 row_ror:8 row_mask:0xf bank_mask:0xf
v_add_f32_dpp v43, v43, v43 row_ror:8 row_mask:0xf bank_mask:0xf
v_cvt_pk_bf16_f32 v40, v40, v41
v_cvt_pk_bf16_f32 v41, v42, v43
v_and_or_b32 v40, v40, -2, s18
s_mov_b64 exec, 0x00ff00ff
global_store_dwordx2 v36, v[40:41], s[66:67]
s_mov_b64 exec, -1
s_branch join_10047
chk_10049_f:
global_load_dwordx4 v[24:27], v0, s[64:65] offset:0 sc1
global_load_dwordx4 v[28:31], v0, s[64:65] offset:1024 sc1
global_load_dwordx4 v[48:51], v0, s[64:65] offset:2048 sc1
global_load_dwordx4 v[52:55], v0, s[64:65] offset:3072 sc1
s_add_u32 s30, s30, 1
s_cmp_le_u32 s30, 262144
s_cbranch_scc1 chk_10048
s_branch L_fail
nored_10046:
v_and_b32 v7, 255, v0
v_lshl_add_u32 v7, v7, 3, s27
join_10047:
s_barrier
global_load_dwordx4 v[56:59], v0, s[76:77] offset:-2048 sc1
global_load_dwordx4 v[60:63], v0, s[76:77] offset:-1024 sc1
global_load_dwordx4 v[80:83], v0, s[76:77] offset:2048 sc1
global_load_dwordx4 v[84:87], v0, s[76:77] offset:3072 sc1
s_nop 15
s_nop 15
s_nop 13
s_barrier
global_load_dwordx4 v[32:35], v0, s[68:69] offset:-4096 sc1
s_nop 10
global_load_dwordx4 v[36:39], v0, s[68:69] offset:0 sc1
s_barrier
global_load_dwordx4 v[24:27], v0, s[78:79] offset:-4096 sc1
global_load_dwordx4 v[28:31], v0, s[78:79] offset:-3072 sc1
global_load_dwordx4 v[48:51], v0, s[58:59] offset:0 nt sc1
global_load_dwordx4 v[52:55], v0, s[58:59] offset:1024 nt sc1
s_waitcnt vmcnt(14)
v_mov_b64 v[8:9], 0
v_mov_b64 v[10:11], 0
s_waitcnt vmcnt(13)
v_mov_b64 v[12:13], 0
v_mov_b64 v[14:15], 0
s_waitcnt vmcnt(12)
v_mov_b64 v[16:17], 0
v_mov_b64 v[18:19], 0
s_waitcnt vmcnt(11)
v_mov_b64 v[20:21], 0
v_mov_b64 v[22:23], 0
s_mov_b32 s30, 0
s_cmp_eq_u32 s17, s31
s_cbranch_scc0 gather_10038
s_branch exit_10041
rt_10043:
global_load_dwordx4 v[32:35], v0, s[68:69] offset:-4096 sc1
global_load_dwordx4 v[36:39], v0, s[68:69] offset:0 sc1
s_add_u32 s30, s30, 1
s_cmp_gt_u32 s30, 262144
s_cbranch_scc1 L_fail
s_mov_b64 exec, 1
global_store_dword v0, v0, s[62:63]
global_store_dword v0, v0, s[62:63]
global_store_dword v0, v0, s[62:63]
global_store_dword v0, v0, s[62:63]
s_mov_b64 exec, -1
v_mov_b64 v[8:9], 0
v_mov_b64 v[10:11], 0
v_mov_b64 v[12:13], 0
v_mov_b64 v[14:15], 0
v_mov_b64 v[16:17], 0
v_mov_b64 v[18:19], 0
v_mov_b64 v[20:21], 0
v_mov_b64 v[22:23], 0
s_branch gather_10038
rare_10039:
ds_read_b128 v[48:51], v6 offset:6144
ds_read_b128 v[52:55], v6 offset:7168
s_waitcnt lgkmcnt(0)
v_add_f32 v48, v48, v52
v_add_f32 v49, v49, v53
v_add_f32 v50, v50, v54
v_add_f32 v51, v51, v55
v_mov_b32_dpp v46, v46 quad_perm:[0,1,0,1] row_mask:0xf bank_mask:0xf
v_mov_b32_dpp v47, v47 quad_perm:[0,1,0,1] row_mask:0xf bank_mask:0xf
v_max3_f32 v19, v48, v49, v50
v_max3_f32 v19, v19, v51, v46
v_max_f32 v19, v19, v47
s_nop 1
v_max_f32_dpp v19, v19, v19 quad_perm:[2,3,0,1] row_mask:0xf bank_mask:0xf
v_mov_b32 v44, v19
s_nop 1
v_permlane32_swap_b32 v19, v44
v_max_f32 v19, v19, v44
v_mov_b32 v44, v19
s_nop 1
v_permlane16_swap_b32 v19, v44
v_max_f32 v19, v19, v44
v_sub_f32 v48, v48, v19
v_sub_f32 v49, v49, v19
v_sub_f32 v50, v50, v19
v_sub_f32 v51, v51, v19
v_sub_f32 v46, v46, v19
v_sub_f32 v47, v47, v19
v_exp_f32 v48, v48
v_exp_f32 v49, v49
v_exp_f32 v50, v50
v_exp_f32 v51, v51
v_cvt_pk_bf16_f32 v54, v48, v49
v_cvt_pk_bf16_f32 v55, v50, v51
s_nop 0
v_mov_b32_dpp v48, v54 quad_perm:[0,1,0,1] row_mask:0xf bank_mask:0xf
v_mov_b32_dpp v49, v55 quad_perm:[0,1,0,1] row_mask:0xf bank_mask:0xf
v_mov_b32_dpp v50, v54 quad_perm:[2,3,2,3] row_mask:0xf bank_mask:0xf
v_mov_b32_dpp v51, v55 quad_perm:[2,3,2,3] row_mask:0xf bank_mask:0xf
v_mov_b64 v[20:21], s[44:45]
v_mov_b64 v[22:23], s[44:45]
v_mfma_f32_16x16x32_bf16 v[8:11], v[56:59], v[48:51], 0
v_mfma_f32_16x16x32_bf16 v[12:15], v[60:63], v[48:51], 0
v_mfma_f32_16x16x32_bf16 v[16:19], v[20:23], v[48:51], 0
v_mov_b64 v[54:55], s[46:47]
v_exp_f32_dpp v44, v46 quad_perm:[0,1,0,1] row_mask:0xf bank_mask:0xf
v_exp_f32_dpp v45, v47 quad_perm:[0,1,0,1] row_mask:0xf bank_mask:0xf
s_nop 0
v_cvt_pk_bf16_f32 v52, v44, v45
v_cvt_pk_bf16_f32 v53, v44, v45
s_nop 1
v_mfma_f32_16x16x16_bf16 v[16:19], v[54:55], v[52:53], v[16:19]
v_mfma_f32_16x16x16_bf16 v[8:11], v[24:25], v[52:53], v[8:11]
v_mfma_f32_16x16x16_bf16 v[12:15], v[26:27], v[52:53], v[12:15]
s_nop 5
v_rcp_f32 v18, v16
s_nop 0
v_cndmask_b32 v8, v12, v8, s[42:43]
v_mul_f32 v8, v8, v18
v_cndmask_b32 v9, v13, v9, s[42:43]
v_mul_f32 v9, v9, v18
v_cndmask_b32 v10, v14, v10, s[42:43]
v_mul_f32 v10, v10, v18
v_cndmask_b32 v11, v15, v11, s[42:43]
v_mul_f32 v11, v11, v18
v_cvt_pk_bf16_f32 v12, v8, v9
v_cvt_pk_bf16_f32 v13, v10, v11
s_branch back_10040
exit_10041:
global_load_dwordx4 v[32:35], v0, s[68:69] offset:-4096 sc1
global_load_dwordx4 v[36:39], v0, s[68:69] offset:0 sc1
s_add_u32 s30, s30, 1
s_cmp_gt_u32 s30, 262144
s_cbranch_scc1 L_fail
s_waitcnt vmcnt(1)
v_bitop3_b32 v44, v32, v34, s18 bitop3:0x7e
s_waitcnt vmcnt(0)
v_bitop3_b32 v45, v36, v38, s18 bitop3:0x7e
v_bitop3_b32 v44, v44, v45, s19 bitop3:0xa8
v_cmp_ne_u32 vcc, 0, v44
s_cbranch_vccnz exit_10041
s_add_u32 s36, s36, 1
s_cmp_lt_u32 s36, 2
s_cbranch_scc1 layer_10037
s_endpgm
wave_10008:
layer_10050:
s_lshl_b32 s17, s36, 6
s_mul_i32 s27, s36, 35651584
s_mul_i32 s28, s14, 16384
s_add_u32 s27, s27, s28
s_add_u32 s20, s27, 16789504
s_mul_i32 s27, s17, 10240
s_add_u32 s27, s27, s24
s_add_u32 s21, s27, s25
s_mov_b32 s19, 0
s_mov_b32 s33, s6
s_add_u32 s34, s17, 1
s_add_u32 s31, s17, 63
s_add_u32 s32, s17, 64
s_mov_b32 s27, s20
v_mov_b32 v7, 0
s_add_u32 s68, s4, 416768
s_addc_u32 s69, s5, 0
s_add_u32 s72, s4, 400384
s_addc_u32 s73, s5, 0
s_add_u32 s70, s4, 420864
s_addc_u32 s71, s5, 0
s_add_u32 s74, s4, 404480
s_addc_u32 s75, s5, 0
s_add_u32 s58, s4, s20
s_addc_u32 s59, s5, 0
global_load_dwordx4 v[64:67], v0, s[76:77] offset:-4096 sc1
global_load_dwordx4 v[68:71], v0, s[76:77] offset:-3072 sc1
global_load_dwordx4 v[72:75], v0, s[76:77] offset:0 sc1
global_load_dwordx4 v[76:79], v0, s[76:77] offset:1024 sc1
global_load_dwordx4 v[80:83], v0, s[76:77] offset:2048 sc1
global_load_dwordx4 v[84:87], v0, s[76:77] offset:3072 sc1
global_load_dwordx4 v[56:59], v0, s[76:77] offset:-2048 sc1
global_load_dwordx4 v[60:63], v0, s[76:77] offset:-1024 sc1
global_load_dwordx4 v[24:27], v0, s[78:79] offset:-4096 sc1
global_load_dwordx4 v[28:31], v0, s[78:79] offset:-3072 sc1
v_mov_b64 v[8:9], 0
v_mov_b64 v[10:11], 0
v_mov_b64 v[12:13], 0
v_mov_b64 v[14:15], 0
v_mov_b64 v[16:17], 0
v_mov_b64 v[18:19], 0
v_mov_b64 v[20:21], 0
v_mov_b64 v[22:23], 0
s_barrier
global_load_dwordx4 v[48:51], v0, s[58:59] offset:0 nt sc1
global_load_dwordx4 v[52:55], v0, s[58:59] offset:1024 nt sc1
v_and_b32 v7, 128, v0
v_add_u32 v7, s22, v7
s_mov_b32 exec_hi, 0
v_and_b32 v7, 255, v0
v_lshl_add_u32 v7, v7, 3, s27
s_mov_b32 exec_hi, -1
global_load_dwordx4 v[32:35], v0, s[68:69] offset:-4096 sc1
global_load_dwordx4 v[36:39], v0, s[68:69] offset:0 sc1
s_mov_b32 s30, 0
s_waitcnt vmcnt(0)
.p2align 6
gather_10051:
s_waitcnt vmcnt(5)
rt_10056_b:
v_smfmac_f32_16x16x64_bf16 v[12:15], v[32:35], v[56:63], v1
ds_write_b128 v0, v[32:35] offset:3072
v_smfmac_f32_16x16x64_bf16 v[20:23], v[32:35], v[72:79], v1
v_bitop3_b32 v44, v32, v34, s18 bitop3:0x7e
v_smfmac_f32_16x16x64_bf16 v[8:11], v[32:35], v[64:71], v1
s_waitcnt vmcnt(4)
ds_write_b128 v0, v[36:39] offset:7168
v_bitop3_b32 v45, v36, v38, s18 bitop3:0x7e
v_smfmac_f32_16x16x64_bf16 v[8:11], v[36:39], v[80:87], v1
v_bitop3_b32 v44, v44, v45, s19 bitop3:0xa8
v_cmp_ne_u32 vcc, 0, v44
v_smfmac_f32_16x16x64_bf16 v[20:23], v[36:39], a[24:31], v1
s_cbranch_vccnz rt_10056
ds_read_b128 v[76:79], v2 offset:1024
global_load_dwordx4 v[64:67], v0, s[78:79] offset:-2048 sc1
ds_read_b128 v[72:75], v2 offset:0
global_load_dwordx4 v[68:71], v0, s[78:79] offset:-1024 sc1
ds_read_b128 v[84:87], v2 offset:5120
s_waitcnt lgkmcnt(3)
s_barrier
ds_read_b128 v[40:43], v0 offset:2048
v_smfmac_f32_16x16x64_bf16 v[16:19], v[32:35], a[0:7], v1
ds_read_b128 v[44:47], v0 offset:6144
global_load_dwordx4 v[56:59], v0, s[58:59] offset:2048 nt sc1
ds_read_b128 v[32:35], v0 offset:1024
v_smfmac_f32_16x16x64_bf16 v[12:15], v[36:39], a[8:15], v1
s_mov_b32 s30, 0
ds_read_b128 v[80:83], v2 offset:4096
v_smfmac_f32_16x16x64_bf16 v[16:19], v[36:39], a[16:23], v1
s_waitcnt lgkmcnt(5)
ds_read_b128 v[36:39], v0 offset:5120
global_load_dwordx4 v[60:63], v0, s[58:59] offset:3072 nt sc1
s_waitcnt lgkmcnt(4)
v_smfmac_f32_16x16x64_bf16 v[8:11], v[40:43], v[72:79], v1
ds_read_b128 v[72:75], v2 offset:2048
v_smfmac_f32_16x16x64_bf16 v[12:15], v[40:43], a[32:39], v1
s_waitcnt lgkmcnt(4)
ds_read_b128 v[40:43], v0 offset:0
v_smfmac_f32_16x16x64_bf16 v[8:11], v[44:47], a[40:47], v1
s_waitcnt lgkmcnt(4)
ds_read_b128 v[76:79], v2 offset:3072
s_waitcnt vmcnt(6)
v_smfmac_f32_16x16x64_bf16 v[12:15], v[44:47], v[24:31], v1
ds_read_b128 v[28:31], v2 offset:7168
v_smfmac_f32_16x16x64_bf16 v[12:15], v[32:35], a[56:63], v1
s_mov_b32 s19, 1
ds_read_b128 v[24:27], v2 offset:6144
v_smfmac_f32_16x16x64_bf16 v[8:11], v[32:35], a[48:55], v1
s_waitcnt lgkmcnt(4)
ds_read_b128 v[44:47], v0 offset:4096
v_smfmac_f32_16x16x64_bf16 v[12:15], v[36:39], a[64:71], v1
ds_read_b128 v[32:35], v0 offset:9216
s_waitcnt lgkmcnt(4)
v_smfmac_f32_16x16x64_bf16 v[8:11], v[36:39], v[72:79], v1
ds_read_b128 v[36:39], v0 offset:8192
s_waitcnt lgkmcnt(4)
v_smfmac_f32_16x16x64_bf16 v[8:11], v[40:43], v[80:87], v1
ds_read_b128 v[84:87], v2 offset:9216
s_waitcnt lgkmcnt(4)
v_smfmac_f32_16x16x64_bf16 v[12:15], v[40:43], v[24:31], v1
ds_read_b128 v[80:83], v2 offset:8192
s_waitcnt lgkmcnt(4)
v_smfmac_f32_16x16x64_bf16 v[12:15], v[44:47], a[80:87], v1
ds_read_b128 v[76:79], v2 offset:11264
s_waitcnt lgkmcnt(4)
v_smfmac_f32_16x16x64_bf16 v[12:15], v[32:35], a[88:95], v1
ds_read_b128 v[72:75], v2 offset:10240
s_waitcnt lgkmcnt(4)
v_smfmac_f32_16x16x64_bf16 v[8:11], v[44:47], a[72:79], v1
ds_read_b128 v[40:43], v0 offset:2048
global_load_dword v7, v7, s[4:5] sc1
ds_read_b128 v[28:31], v2 offset:13312
s_waitcnt lgkmcnt(4)
v_smfmac_f32_16x16x64_bf16 v[8:11], v[32:35], v[80:87], v1
s_waitcnt vmcnt(3)
ds_read_b128 v[24:27], v2 offset:12288
v_smfmac_f32_16x16x64_bf16 v[8:11], v[36:39], a[96:103], v1
s_nop 0
ds_read_b128 v[32:35], v0 offset:6144
s_waitcnt lgkmcnt(4)
v_smfmac_f32_16x16x64_bf16 v[12:15], v[36:39], v[72:79], v1
s_nop 0
ds_read_b128 v[36:39], v0 offset:1024
s_waitcnt lgkmcnt(4)
ds_read_b128 v[72:75], v2 offset:16384
v_add_f32 v9, v9, v11
v_smfmac_f32_16x16x64_bf16 v[16:19], v[40:43], a[104:111], v1
s_xor_b32 s18, s18, 1
ds_read_b128 v[76:79], v2 offset:17408
v_add_f32 v8, v8, v10
v_smfmac_f32_16x16x64_bf16 v[20:23], v[40:43], a[112:119], v1
s_waitcnt lgkmcnt(5)
ds_read_b128 v[40:43], v0 offset:5120
v_add_f32 v12, v12, v14
v_mul_f32 v9, s35, v9
s_waitcnt lgkmcnt(4)
v_smfmac_f32_16x16x64_bf16 v[16:19], v[32:35], v[24:31], v1
ds_read_b128 v[84:87], v2 offset:15360
v_mul_f32 v8, s35, v8
v_cvt_pk_bf16_f32 v8, v8, v9
v_smfmac_f32_16x16x64_bf16 v[20:23], v[32:35], v[64:71], v1
s_waitcnt lgkmcnt(4)
ds_read_b128 v[80:83], v2 offset:14336
v_add_f32 v13, v13, v15
v_smfmac_f32_16x16x64_bf16 v[20:23], v[36:39], a[128:135], v1
ds_read_b128 v[32:35], v0 offset:0
v_mul_f32 v12, s35, v12
v_mul_f32 v13, s35, v13
v_smfmac_f32_16x16x64_bf16 v[16:19], v[36:39], a[120:127], v1
s_waitcnt lgkmcnt(3)
ds_read_b128 v[36:39], v0 offset:4096
v_cvt_pk_bf16_f32 v12, v12, v13
v_smfmac_f32_16x16x64_bf16 v[20:23], v[40:43], a[144:151], v1
ds_write2_b32 v3, v8, v12 offset0:0 offset1:128
v_mov_b64 v[26:27], 0
v_smfmac_f32_16x16x64_bf16 v[16:19], v[40:43], a[136:143], v1
s_waitcnt lgkmcnt(2)
ds_read_b128 v[40:43], v0 offset:9216
v_smfmac_f32_16x16x64_bf16 v[16:19], v[32:35], a[152:159], v1
s_mov_b64 vcc, s[42:43]
ds_read_b128 v[68:71], v2 offset:19456
v_mov_b64 v[30:31], 0
v_smfmac_f32_16x16x64_bf16 v[20:23], v[32:35], a[160:167], v1
s_waitcnt lgkmcnt(3)
ds_read_b128 v[32:35], v0 offset:8192
v_mov_b64 v[24:25], 0
v_smfmac_f32_16x16x64_bf16 v[20:23], v[36:39], v[80:87], v1
s_add_u32 s20, s20, 524288
ds_read_b128 v[64:67], v2 offset:18432
v_mov_b64 v[28:29], 0
v_smfmac_f32_16x16x64_bf16 v[16:19], v[36:39], a[168:175], v1
ds_read_b128 v[36:39], v0 offset:9216
s_waitcnt lgkmcnt(4)
v_smfmac_f32_16x16x64_bf16 v[20:23], v[40:43], v[72:79], v1
s_barrier
ds_read_b64_tr_b16 v[8:9], v4 offset:2048
v_smfmac_f32_16x16x64_bf16 v[16:19], v[40:43], a[176:183], v1
s_waitcnt lgkmcnt(3)
ds_read_b64_tr_b16 v[14:15], v4 offset:3584
ds_read_b64_tr_b16 v[10:11], v4 offset:2560
v_smfmac_f32_16x16x64_bf16 v[16:19], v[32:35], a[184:191], v1
s_nop 0
ds_read_b64_tr_b16 v[12:13], v4 offset:3072
ds_read_b128 v[40:43], v0 offset:8192
v_smfmac_f32_16x16x64_bf16 v[20:23], v[32:35], a[192:199], v1
s_add_u32 s17, s17, 1
ds_read_b128 v[72:75], v2 offset:20480
s_waitcnt lgkmcnt(6)
ds_read_b128 v[80:83], v0 offset:53248
v_add_f32 v17, v17, v19
v_add_f32 v16, v16, v18
v_cvt_pk_bf16_f32 v16, v16, v17
v_smfmac_f32_16x16x64_bf16 v[24:27], v[36:39], a[200:207], v1
s_waitcnt lgkmcnt(6)
ds_read_b128 v[76:79], v2 offset:21504
s_waitcnt lgkmcnt(5)
v_mfma_f32_16x16x32_bf16 v[44:47], v[48:51], v[8:11], 0
s_waitcnt lgkmcnt(4)
ds_read_b128 v[84:87], v0 offset:54272
v_add_f32 v21, v21, v23
v_mfma_f32_16x16x32_bf16 v[44:47], v[52:55], v[12:15], v[44:47]
ds_read_b128 v[32:35], v0 offset:3072
v_bfe_u32 v48, v0, 5, 1
v_add_f32 v20, v20, v22
v_cvt_pk_bf16_f32 v20, v20, v21
v_smfmac_f32_16x16x64_bf16 v[28:31], v[36:39], a[208:215], v1
s_waitcnt lgkmcnt(5)
ds_write2_b32 v3, v16, v20 offset0:1 offset1:129
v_lshl_add_u32 v48, v48, 3, v5
v_cndmask_b32_dpp v45, v47, v45, vcc quad_perm:[0,1,0,1] row_mask:0xf bank_mask:0xf
v_smfmac_f32_16x16x64_bf16 v[24:27], v[40:43], v[64:71], v1
s_add_u32 s21, s21, 10240
ds_read_b128 v[36:39], v0 offset:7168
v_cndmask_b32_dpp v44, v46, v44, vcc quad_perm:[0,1,0,1] row_mask:0xf bank_mask:0xf
v_xor_b32 v48, 128, v48
v_smfmac_f32_16x16x64_bf16 v[28:31], v[40:43], a[216:223], v1
s_waitcnt lgkmcnt(2)
ds_write_b64 v48, v[44:45] offset:7680
v_smfmac_f32_16x16x64_bf16 v[24:27], v[32:35], v[72:79], v1
global_load_dwordx4 v[64:67], v0, s[78:79] offset:0 sc1
ds_read_b128 v[72:75], v2 offset:22528
v_smfmac_f32_16x16x64_bf16 v[28:31], v[32:35], a[224:231], v1
ds_read_b128 v[40:43], v0 offset:2048
s_waitcnt lgkmcnt(3)
v_smfmac_f32_16x16x64_bf16 v[28:31], v[36:39], a[240:247], v1
ds_read_b128 v[76:79], v2 offset:23552
global_load_dwordx4 v[68:71], v0, s[78:79] offset:1024 sc1
ds_read_b128 v[32:35], v0 offset:6144
v_smfmac_f32_16x16x64_bf16 v[24:27], v[36:39], a[232:239], v1
s_waitcnt lgkmcnt(4)
ds_read_b128 v[36:39], v0 offset:1024
s_barrier
ds_read_b128 v[48:51], v6 offset:6144
s_waitcnt lgkmcnt(4)
v_smfmac_f32_16x16x64_bf16 v[28:31], v[40:43], v[80:87], v1
s_add_u32 s34, s17, 2
ds_read_b64_tr_b16 v[22:23], v4 offset:3584
s_waitcnt lgkmcnt(4)
ds_read_b128 v[52:55], v6 offset:7168
v_smfmac_f32_16x16x64_bf16 v[24:27], v[40:43], v[72:79], v1
ds_read_b128 v[40:43], v0 offset:5120
s_waitcnt lgkmcnt(5)
ds_read_b64_tr_b16 v[8:9], v4 offset:0
v_smfmac_f32_16x16x64_bf16 v[24:27], v[32:35], a[248:255], v1
s_waitcnt lgkmcnt(5)
ds_read_b64_tr_b16 v[16:17], v4 offset:2048
global_load_dwordx4 v[72:75], v0, s[78:79] offset:2048 sc1
ds_read_b64_tr_b16 v[18:19], v4 offset:2560
v_smfmac_f32_16x16x64_bf16 v[28:31], v[32:35], v[88:95], v1
global_load_dwordx4 v[76:79], v0, s[78:79] offset:3072 sc1
ds_read_b128 v[32:35], v0 offset:0
v_smfmac_f32_16x16x64_bf16 v[24:27], v[36:39], v[96:103], v1
s_waitcnt lgkmcnt(5)
ds_read_b64_tr_b16 v[10:11], v4 offset:512
v_add_f32 v49, v49, v53
v_smfmac_f32_16x16x64_bf16 v[28:31], v[36:39], v[104:111], v1
s_waitcnt lgkmcnt(5)
ds_read_b64_tr_b16 v[12:13], v4 offset:1024
v_add_f32 v48, v48, v52
v_add_f32 v50, v50, v54
v_smfmac_f32_16x16x64_bf16 v[24:27], v[40:43], v[112:119], v1
ds_read_b128 v[36:39], v0 offset:4096
v_exp_f32 v49, v49
v_smfmac_f32_16x16x64_bf16 v[28:31], v[40:43], v[120:127], v1
s_waitcnt lgkmcnt(3)
ds_read_b64_tr_b16 v[14:15], v4 offset:1536
v_add_f32 v51, v51, v55
v_smfmac_f32_16x16x64_bf16 v[28:31], v[32:35], v[136:143], v1
s_waitcnt lgkmcnt(3)
ds_read_b64_tr_b16 v[20:21], v4 offset:3072
v_exp_f32 v51, v51
v_mfma_f32_16x16x32_bf16 v[44:47], v[8:11], v[8:11], 0
v_exp_f32 v48, v48
v_exp_f32 v50, v50
v_smfmac_f32_16x16x64_bf16 v[24:27], v[32:35], v[128:135], v1
s_waitcnt lgkmcnt(1)
s_min_u32 s34, s34, s32
v_cvt_pk_bf16_f32 v55, v50, v51
v_mfma_f32_16x16x32_bf16 v[44:47], v[12:15], v[12:15], v[44:47]
s_nop 0
v_mov_b32_dpp v51, v55 quad_perm:[2,3,2,3] row_mask:0xf bank_mask:0xf
v_cvt_pk_bf16_f32 v54, v48, v49
v_mfma_f32_16x16x32_bf16 v[44:47], v[16:19], v[16:19], v[44:47]
s_waitcnt lgkmcnt(0)
v_mov_b32_dpp v48, v54 quad_perm:[0,1,0,1] row_mask:0xf bank_mask:0xf
v_mov_b32_dpp v49, v55 quad_perm:[0,1,0,1] row_mask:0xf bank_mask:0xf
v_mov_b32_dpp v50, v54 quad_perm:[2,3,2,3] row_mask:0xf bank_mask:0xf
v_mfma_f32_16x16x32_bf16 v[44:47], v[20:23], v[20:23], v[44:47]
s_add_u32 s27, s20, 524288
v_mov_b64 v[20:21], s[44:45]
v_mov_b64 v[22:23], s[44:45]
v_smfmac_f32_16x16x64_bf16 v[24:27], v[36:39], v[144:151], v1
s_waitcnt vmcnt(5)
global_load_dwordx4 v[80:83], v0, s[80:81] offset:-4096 sc1
v_mfma_f32_16x16x32_bf16 v[16:19], v[20:23], v[48:51], 0
s_nop 0
v_exp_f32_dpp v44, v46 quad_perm:[0,1,0,1] row_mask:0xf bank_mask:0xf
v_mfma_f32_16x16x32_bf16 v[8:11], v[56:59], v[48:51], 0
v_exp_f32_dpp v45, v47 quad_perm:[0,1,0,1] row_mask:0xf bank_mask:0xf
v_mov_b64 v[54:55], s[46:47]
v_smfmac_f32_16x16x64_bf16 v[28:31], v[36:39], v[152:159], v1
global_load_dwordx4 v[84:87], v0, s[80:81] offset:-3072 sc1
v_cvt_pk_bf16_f32 v52, v44, v45
v_mfma_f32_16x16x32_bf16 v[12:15], v[60:63], v[48:51], 0
v_cvt_pk_bf16_f32 v53, v44, v45
v_cvt_pk_bf16_f32 v24, v24, v25
v_cvt_pk_bf16_f32 v25, v26, v27
v_mfma_f32_16x16x16_bf16 v[16:19], v[54:55], v[52:53], v[16:19]
s_nop 0
v_cvt_pk_bf16_f32 v27, v30, v31
v_cvt_pk_bf16_f32 v26, v28, v29
v_mfma_f32_16x16x16_bf16 v[8:11], v[24:25], v[52:53], v[8:11]
v_bfe_u32 v32, v0, 5, 1
v_mov_b64 v[38:39], 0
v_mfma_f32_16x16x16_bf16 v[12:15], v[26:27], v[52:53], v[12:15]
s_nop 0
v_mov_b64 v[42:43], 0
v_subrev_u32 v17, s37, v16
v_cmp_lt_u32 vcc, s38, v17
v_rcp_f32 v18, v16
v_mov_b64 v[36:37], 0
v_lshl_add_u32 v32, v32, 3, v5
v_mov_b64 v[40:41], 0
v_cndmask_b32 v11, v15, v11, s[42:43]
v_cndmask_b32 v8, v12, v8, s[42:43]
v_cndmask_b32 v9, v13, v9, s[42:43]
v_cndmask_b32 v10, v14, v10, s[42:43]
v_mul_f32 v8, v8, v18
v_mul_f32 v9, v9, v18
v_mul_f32 v11, v11, v18
v_mul_f32 v10, v10, v18
v_cvt_pk_bf16_f32 v13, v10, v11
v_cvt_pk_bf16_f32 v12, v8, v9
s_cbranch_vccnz rare_10052
back_10053:
ds_write_b64 v32, v[12:13] offset:1536
v_mov_b32_dpp v11, v13 quad_perm:[2,3,2,3] row_mask:0xf bank_mask:0xf
v_mov_b64 v[52:53], 0
v_mov_b32_dpp v9, v13 quad_perm:[0,1,0,1] row_mask:0xf bank_mask:0xf
v_mov_b32_dpp v10, v12 quad_perm:[2,3,2,3] row_mask:0xf bank_mask:0xf
v_mov_b32_dpp v8, v12 quad_perm:[0,1,0,1] row_mask:0xf bank_mask:0xf
v_mov_b64 v[48:49], 0
s_waitcnt vmcnt(4)
v_mov_b64 v[54:55], 0
v_smfmac_f32_16x16x64_bf16 v[40:43], v[8:11], v[64:71], v1
ds_read_b128 v[16:19], v0 offset:55296
global_load_dwordx4 v[64:67], v0, s[76:77] offset:-4096 sc1
ds_read_b128 v[20:23], v0 offset:56320
v_mov_b64 v[32:33], 0
v_smfmac_f32_16x16x64_bf16 v[52:55], v[8:11], v[176:183], v1
s_waitcnt lgkmcnt(2)
ds_read_b128 v[28:31], v0 offset:58368
ds_read_b128 v[24:27], v0 offset:57344
s_barrier
global_load_dwordx4 v[68:71], v0, s[76:77] offset:-3072 sc1
ds_read_b128 v[56:59], v5 offset:1024
v_mov_b64 v[50:51], 0
v_lshrrev_b32 v44, 8, v0
v_smfmac_f32_16x16x64_bf16 v[36:39], v[8:11], v[160:167], v1
s_waitcnt vmcnt(5)
ds_read_b128 v[60:63], v5 offset:512
v_mov_b64 v[34:35], 0
v_smfmac_f32_16x16x64_bf16 v[48:51], v[8:11], v[168:175], v1
ds_read_b128 v[12:15], v5 offset:0
v_bfe_u32 v45, v0, 1, 7
s_waitcnt vmcnt(4)
v_smfmac_f32_16x16x64_bf16 v[32:35], v[8:11], v[72:79], v1
global_load_dwordx4 v[72:75], v0, s[76:77] offset:0 sc1
s_waitcnt lgkmcnt(2)
v_smfmac_f32_16x16x64_bf16 v[36:39], v[56:59], v[184:191], v1
global_load_dwordx4 v[76:79], v0, s[76:77] offset:1024 sc1
s_waitcnt lgkmcnt(1)
v_smfmac_f32_16x16x64_bf16 v[36:39], v[60:63], v[16:23], v1
s_waitcnt lgkmcnt(0)
v_smfmac_f32_16x16x64_bf16 v[36:39], v[12:15], v[24:31], v1
ds_read_b128 v[24:27], v0 offset:59392
v_lshl_or_b32 v44, v44, 12, v45
v_smfmac_f32_16x16x64_bf16 v[40:43], v[56:59], v[192:199], v1
ds_read_b128 v[28:31], v0 offset:60416
s_waitcnt vmcnt(5)
v_smfmac_f32_16x16x64_bf16 v[32:35], v[56:59], v[240:247], v1
s_nop 0
ds_read_b128 v[20:23], v0 offset:62464
v_cvt_pk_bf16_f32 v36, v36, v37
v_smfmac_f32_16x16x64_bf16 v[48:51], v[56:59], v[200:207], v1
ds_read_b128 v[16:19], v0 offset:61440
v_and_or_b32 v36, v36, -2, s18
v_cvt_pk_bf16_f32 v37, v38, v39
s_waitcnt vmcnt(4)
v_smfmac_f32_16x16x64_bf16 v[40:43], v[60:63], v[80:87], v1
global_store_dwordx2 v44, v[36:37], s[48:49]
s_waitcnt lgkmcnt(2)
v_smfmac_f32_16x16x64_bf16 v[40:43], v[12:15], v[24:31], v1
ds_read_b128 v[24:27], v0 offset:63488
s_add_u32 s58, s4, s20
v_smfmac_f32_16x16x64_bf16 v[48:51], v[60:63], v[208:215], v1
s_waitcnt lgkmcnt(2)
s_waitcnt lgkmcnt(1)
v_smfmac_f32_16x16x64_bf16 v[48:51], v[12:15], v[16:23], v1
s_nop 0
ds_read_b128 v[28:31], v0 offset:64512
v_cvt_pk_bf16_f32 v40, v40, v41
v_and_or_b32 v40, v40, -2, s18
v_cvt_pk_bf16_f32 v41, v42, v43
v_smfmac_f32_16x16x64_bf16 v[52:55], v[56:59], v[216:223], v1
global_store_dwordx2 v44, v[40:41], s[50:51]
v_smfmac_f32_16x16x64_bf16 v[52:55], v[60:63], v[224:231], v1
s_mov_b64 s[68:69], s[72:73]
v_cvt_pk_bf16_f32 v48, v48, v49
v_smfmac_f32_16x16x64_bf16 v[52:55], v[12:15], v[232:239], v1
s_nop 0
s_waitcnt lgkmcnt(0)
v_and_or_b32 v48, v48, -2, s18
v_cvt_pk_bf16_f32 v49, v50, v51
v_smfmac_f32_16x16x64_bf16 v[32:35], v[60:63], v[248:255], v1
s_nop 0
global_store_dwordx2 v44, v[48:49], s[52:53]
s_nop 0
v_cvt_pk_bf16_f32 v52, v52, v53
v_cvt_pk_bf16_f32 v53, v54, v55
v_smfmac_f32_16x16x64_bf16 v[32:35], v[12:15], v[24:31], v1
s_nop 1
v_and_or_b32 v52, v52, -2, s18
s_nop 1
global_store_dwordx2 v44, v[52:53], s[54:55]
s_addc_u32 s59, s5, 0
s_nop 0
v_cvt_pk_bf16_f32 v32, v32, v33
v_and_or_b32 v32, v32, -2, s18
v_cvt_pk_bf16_f32 v33, v34, v35
global_store_dwordx2 v44, v[32:33], s[56:57]
nored_10059:
v_cmp_gt_u32 vcc, s34, v7
s_cmp_eq_u32 vcc_hi, 0
s_cbranch_scc1 kv_10063
s_mov_b32 s30, 0
kv_10062:
v_and_b32 v7, 128, v0
buffer_load_dword v7, v7, s[4:7], s22 offen sc1
s_add_u32 s30, s30, 1
s_cmp_gt_u32 s30, 262144
s_cbranch_scc1 L_fail
s_waitcnt vmcnt(0)
v_cmp_gt_u32 vcc, s34, v7
s_cbranch_vccnz kv_10062
kv_10063:
v_and_b32 v7, 128, v0
v_add_u32 v7, s22, v7
s_mov_b32 exec_hi, 0
v_and_b32 v7, 255, v0
v_lshl_add_u32 v7, v7, 3, s27
s_mov_b32 exec_hi, -1
join_10060:
s_barrier
global_load_dwordx4 v[56:59], v0, s[76:77] offset:-2048 sc1
global_load_dwordx4 v[60:63], v0, s[76:77] offset:-1024 sc1
global_load_dwordx4 v[80:83], v0, s[76:77] offset:2048 sc1
global_load_dwordx4 v[84:87], v0, s[76:77] offset:3072 sc1
s_nop 15
s_nop 15
s_nop 13
s_barrier
global_load_dwordx4 v[32:35], v0, s[68:69] offset:-4096 sc1
s_nop 10
global_load_dwordx4 v[36:39], v0, s[68:69] offset:0 sc1
s_barrier
global_load_dwordx4 v[24:27], v0, s[78:79] offset:-4096 sc1
global_load_dwordx4 v[28:31], v0, s[78:79] offset:-3072 sc1
global_load_dwordx4 v[48:51], v0, s[58:59] offset:0 nt sc1
global_load_dwordx4 v[52:55], v0, s[58:59] offset:1024 nt sc1
v_mov_b64 v[8:9], 0
v_mov_b64 v[10:11], 0
v_mov_b64 v[12:13], 0
v_mov_b64 v[14:15], 0
v_mov_b64 v[16:17], 0
v_mov_b64 v[18:19], 0
v_mov_b64 v[20:21], 0
v_mov_b64 v[22:23], 0
s_mov_b32 s30, 0
s_cmp_eq_u32 s17, s31
s_cbranch_scc0 gather_10051
s_branch exit_10054
rt_10056:
global_load_dwordx4 v[32:35], v0, s[68:69] offset:-4096 sc1
global_load_dwordx4 v[36:39], v0, s[68:69] offset:0 sc1
s_add_u32 s30, s30, 1
s_cmp_gt_u32 s30, 262144
s_cbranch_scc1 L_fail
s_mov_b64 exec, 1
global_store_dword v0, v0, s[62:63]
global_store_dword v0, v0, s[62:63]
global_store_dword v0, v0, s[62:63]
global_store_dword v0, v0, s[62:63]
s_mov_b64 exec, -1
v_mov_b64 v[8:9], 0
v_mov_b64 v[10:11], 0
v_mov_b64 v[12:13], 0
v_mov_b64 v[14:15], 0
v_mov_b64 v[16:17], 0
v_mov_b64 v[18:19], 0
v_mov_b64 v[20:21], 0
v_mov_b64 v[22:23], 0
s_branch gather_10051
rare_10052:
ds_read_b128 v[48:51], v6 offset:6144
ds_read_b128 v[52:55], v6 offset:7168
s_waitcnt lgkmcnt(0)
v_add_f32 v48, v48, v52
v_add_f32 v49, v49, v53
v_add_f32 v50, v50, v54
v_add_f32 v51, v51, v55
v_mov_b32_dpp v46, v46 quad_perm:[0,1,0,1] row_mask:0xf bank_mask:0xf
v_mov_b32_dpp v47, v47 quad_perm:[0,1,0,1] row_mask:0xf bank_mask:0xf
v_max3_f32 v19, v48, v49, v50
v_max3_f32 v19, v19, v51, v46
v_max_f32 v19, v19, v47
s_nop 1
v_max_f32_dpp v19, v19, v19 quad_perm:[2,3,0,1] row_mask:0xf bank_mask:0xf
v_mov_b32 v44, v19
s_nop 1
v_permlane32_swap_b32 v19, v44
v_max_f32 v19, v19, v44
v_mov_b32 v44, v19
s_nop 1
v_permlane16_swap_b32 v19, v44
v_max_f32 v19, v19, v44
v_sub_f32 v48, v48, v19
v_sub_f32 v49, v49, v19
v_sub_f32 v50, v50, v19
v_sub_f32 v51, v51, v19
v_sub_f32 v46, v46, v19
v_sub_f32 v47, v47, v19
v_exp_f32 v48, v48
v_exp_f32 v49, v49
v_exp_f32 v50, v50
v_exp_f32 v51, v51
v_cvt_pk_bf16_f32 v54, v48, v49
v_cvt_pk_bf16_f32 v55, v50, v51
s_nop 0
v_mov_b32_dpp v48, v54 quad_perm:[0,1,0,1] row_mask:0xf bank_mask:0xf
v_mov_b32_dpp v49, v55 quad_perm:[0,1,0,1] row_mask:0xf bank_mask:0xf
v_mov_b32_dpp v50, v54 quad_perm:[2,3,2,3] row_mask:0xf bank_mask:0xf
v_mov_b32_dpp v51, v55 quad_perm:[2,3,2,3] row_mask:0xf bank_mask:0xf
v_mov_b64 v[20:21], s[44:45]
v_mov_b64 v[22:23], s[44:45]
v_mfma_f32_16x16x32_bf16 v[8:11], v[56:59], v[48:51], 0
v_mfma_f32_16x16x32_bf16 v[12:15], v[60:63], v[48:51], 0
v_mfma_f32_16x16x32_bf16 v[16:19], v[20:23], v[48:51], 0
v_mov_b64 v[54:55], s[46:47]
v_exp_f32_dpp v44, v46 quad_perm:[0,1,0,1] row_mask:0xf bank_mask:0xf
v_exp_f32_dpp v45, v47 quad_perm:[0,1,0,1] row_mask:0xf bank_mask:0xf
s_nop 0
v_cvt_pk_bf16_f32 v52, v44, v45
v_cvt_pk_bf16_f32 v53, v44, v45
s_nop 1
v_mfma_f32_16x16x16_bf16 v[16:19], v[54:55], v[52:53], v[16:19]
v_mfma_f32_16x16x16_bf16 v[8:11], v[24:25], v[52:53], v[8:11]
v_mfma_f32_16x16x16_bf16 v[12:15], v[26:27], v[52:53], v[12:15]
s_nop 5
v_rcp_f32 v18, v16
s_nop 0
v_cndmask_b32 v8, v12, v8, s[42:43]
v_mul_f32 v8, v8, v18
v_cndmask_b32 v9, v13, v9, s[42:43]
v_mul_f32 v9, v9, v18
v_cndmask_b32 v10, v14, v10, s[42:43]
v_mul_f32 v10, v10, v18
v_cndmask_b32 v11, v15, v11, s[42:43]
v_mul_f32 v11, v11, v18
v_cvt_pk_bf16_f32 v12, v8, v9
v_cvt_pk_bf16_f32 v13, v10, v11
s_branch back_10053
exit_10054:
global_load_dwordx4 v[32:35], v0, s[68:69] offset:-4096 sc1
global_load_dwordx4 v[36:39], v0, s[68:69] offset:0 sc1
s_add_u32 s30, s30, 1
s_cmp_gt_u32 s30, 262144
s_cbranch_scc1 L_fail
s_waitcnt vmcnt(1)
v_bitop3_b32 v44, v32, v34, s18 bitop3:0x7e
s_waitcnt vmcnt(0)
v_bitop3_b32 v45, v36, v38, s18 bitop3:0x7e
v_bitop3_b32 v44, v44, v45, s19 bitop3:0xa8
v_cmp_ne_u32 vcc, 0, v44
s_cbranch_vccnz exit_10054
s_add_u32 s36, s36, 1
s_cmp_lt_u32 s36, 2
s_cbranch_scc1 layer_10050
s_endpgm
grp_10001:
s_bfm_b32 s24, s14, 0
s_and_b32 s24, s24, 0x4a4a4a4a
s_bcnt1_i32_b32 s24, s24
v_and_b32 v64, 63, v0
v_and_b32 v65, 15, v64
v_lshrrev_b32 v66, 4, v64
v_lshlrev_b32 v0, 4, v64
v_and_b32 v67, 2, v64
v_mov_b32 v68, 0x4444
v_mov_b32 v69, 0xeeee
v_cmp_eq_u32 vcc, 0, v67
s_nop 1
v_cndmask_b32 v1, v69, v68, vcc
s_mul_i32 s26, s13, 24576
s_add_u32 s26, s26, 65536
v_add_u32 v2, s26, v0
v_lshrrev_b32 v67, 2, v65
v_xor_b32 v68, v66, v67
v_lshlrev_b32 v68, 3, v68
v_lshl_add_u32 v68, v65, 5, v68
s_lshl_b32 s26, s13, 10
s_add_u32 s26, s26, 10240
v_add_u32 v3, s26, v68
v_lshl_add_u32 v68, v66, 2, v67
v_and_b32 v69, 3, v65
v_xor_b32 v69, v69, v66
v_lshlrev_b32 v69, 3, v69
v_lshl_add_u32 v68, v68, 5, v69
v_add_u32 v4, 10240, v68
v_and_b32 v69, 1, v65
v_lshl_add_u32 v68, v67, 1, v69
v_lshlrev_b32 v68, 4, v68
v_lshl_add_u32 v68, v66, 7, v68
v_add_u32 v5, 8192, v68
v_bfe_u32 v69, v65, 1, 1
v_mul_u32_u24 v69, 640, v69
v_xor_b32 v6, v69, v5
s_mov_b32 s42, 0x33333333
s_mov_b32 s43, 0x33333333
s_mov_b32 s44, 0x3f803f80
s_mov_b32 s45, 0x3f803f80
s_mov_b32 s46, 0x3f803f80
s_mov_b32 s47, 0
s_mov_b32 s37, 729808896
s_mov_b32 s38, 671088640
v_lshlrev_b32 v68, 3, v65
v_lshl_add_u32 v7, v66, 12, v68
s_lshl_b32 s26, s13, 14
s_lshl_b32 s27, s14, 7
s_add_u32 s26, s26, s27
s_add_u32 s90, s26, 65536
s_lshl_b32 s26, s13, 5
s_add_u32 s93, s26, s14
s_lshl_b32 s26, s93, 12
s_add_u32 s91, s26, 65536
s_lshr_b32 s26, s93, 2
s_lshl_b32 s26, s26, 9
s_and_b32 s27, s93, 3
s_lshl_b32 s27, s27, 6
s_add_u32 s26, s26, s27
s_add_u32 s92, s26, 393216
s_lshl_b32 s26, s14, 8
s_add_u32 s22, s26, 11534336
s_lshl_b32 s26, s24, 7
s_add_u32 s26, s26, 11550720
s_cmp_lt_u32 s24, 10
s_cselect_b32 s23, s26, 268435456
s_cselect_b32 s24, s24, 0
s_cselect_b32 s25, 12582912, s23
s_lshl_b32 s24, s24, 10
s_and_b32 s26, s14, 0
s_lshl_b32 s26, s26, 12
s_add_u32 s94, s26, 425984
s_lshl_b32 s26, s14, 7
s_add_u32 s95, s26, 425984
s_mov_b32 s35, 0x3e0293ee
s_lshl_b32 s26, s14, 2
s_add_u32 s26, s26, s13
s_mul_i32 s27, s26, 18432
s_add_u32 s89, s27, 1048576
s_add_u32 s48, s4, s90
s_addc_u32 s49, s5, 0
s_add_u32 s50, s90, 65536
s_add_u32 s50, s4, s50
s_addc_u32 s51, s5, 0
s_add_u32 s52, s90, 131072
s_add_u32 s52, s4, s52
s_addc_u32 s53, s5, 0
s_add_u32 s54, s90, 196608
s_add_u32 s54, s4, s54
s_addc_u32 s55, s5, 0
s_add_u32 s56, s90, 262144
s_add_u32 s56, s4, s56
s_addc_u32 s57, s5, 0
s_add_u32 s76, s89, 4096
s_add_u32 s76, s4, s76
s_addc_u32 s77, s5, 0
s_add_u32 s78, s89, 12288
s_add_u32 s78, s4, s78
s_addc_u32 s79, s5, 0
s_add_u32 s60, s4, s94
s_addc_u32 s61, s5, 0
s_add_u32 s62, s4, s95
s_addc_u32 s63, s5, 0
s_add_u32 s64, s4, s91
s_addc_u32 s65, s5, 0
s_add_u32 s66, s4, s92
s_addc_u32 s67, s5, 0
v_mov_b32 v72, 0
v_mov_b32 v73, 0
s_mov_b32 s26, s90
buffer_store_dwordx2 v[72:73], v7, s[4:7], s26 offen
s_add_u32 s26, s26, 65536
buffer_store_dwordx2 v[72:73], v7, s[4:7], s26 offen
s_add_u32 s26, s26, 65536
buffer_store_dwordx2 v[72:73], v7, s[4:7], s26 offen
s_add_u32 s26, s26, 65536
buffer_store_dwordx2 v[72:73], v7, s[4:7], s26 offen
s_add_u32 s26, s26, 65536
buffer_store_dwordx2 v[72:73], v7, s[4:7], s26 offen
s_add_u32 s26, s26, 65536
buffer_store_dword v72, off, s[4:7], s95 offset:0
s_load_dwordx2 s[96:97], s[0:1], 32
s_mov_b32 s98, 10240
s_mov_b32 s99, 0x20000
s_cmp_ge_u32 s93, 80
s_cbranch_scc1 nm0_10065
s_and_b32 s26, s93, 3
s_mul_i32 s26, s26, 2560
s_lshr_b32 s27, s93, 2
s_lshl_b32 s27, s27, 6
s_add_u32 s26, s26, s27
v_bfe_u32 v68, v65, 1, 2
v_lshlrev_b32 v68, 4, v68
v_and_b32 v69, 1, v65
v_lshl_add_u32 v68, v69, 2, v68
v_and_b32 v69, 1, v66
v_mul_u32_u24 v69, 1280, v69
v_add_u32 v68, v68, v69
s_waitcnt lgkmcnt(0)
buffer_load_dword v74, v68, s[96:99], s26 offen
buffer_load_dword v75, v68, s[96:99], s26 offen offset:8
v_and_b32 v68, 32, v0
v_bfe_u32 v69, v0, 6, 1
v_lshl_add_u32 v68, v69, 8, v68
v_bfe_u32 v69, v0, 8, 1
v_lshl_add_u32 v68, v69, 4, v68
v_bfe_u32 v69, v0, 4, 1
v_lshl_add_u32 v68, v69, 3, v68
s_add_u32 s27, s92, 16384
buffer_store_dwordx2 v[72:73], v68, s[4:7], s92 offen
s_waitcnt vmcnt(1)
buffer_store_dwordx2 v[74:75], v68, s[4:7], s27 offen
nm0_10065:
s_waitcnt vmcnt(0) lgkmcnt(0)
s_barrier
s_cmp_eq_u32 s13, 0
s_cselect_b32 s26, 144, s10
v_mov_b32 v74, 1
s_mov_b64 exec, 1
buffer_atomic_add v74, off, s[8:11], s26
s_mov_b64 exec, -1
v_lshrrev_b32 v67, 3, v64
v_and_b32 v68, 7, v64
v_lshlrev_b32 v68, 4, v68
v_lshl_add_u32 v32, v67, 13, v68
v_mul_u32_u24 v67, 1280, v67
v_add_u32 v36, v67, v68
v_lshrrev_b32 v67, 1, v66
v_lshlrev_b32 v67, 4, v67
v_and_b32 v68, 1, v66
v_lshl_add_u32 v67, v68, 1, v67
v_lshrrev_b32 v68, 3, v65
v_lshl_add_u32 v67, v68, 3, v67
v_bfe_u32 v68, v65, 2, 1
v_add_u32 v67, v67, v68
v_and_b32 v69, 3, v65
v_lshlrev_b32 v40, 4, v69
v_lshl_add_u32 v40, v67, 7, v40
v_lshl_add_u32 v67, v66, 2, v68
v_lshlrev_b32 v42, 4, v69
v_lshl_add_u32 v42, v67, 7, v42
v_lshrrev_b32 v68, 3, v65
v_lshl_add_u32 v42, v68, 3, v42
s_lshl_b32 s29, s13, 12
s_and_b32 s26, s13, 1
s_lshl_b32 s26, s26, 6
s_add_u32 s26, s26, s29
v_add_u32 v40, s26, v40
v_add_u32 v42, s26, v42
v_xor_b32 v41, 4096, v40
v_xor_b32 v43, 4096, v42
v_add_u32 v33, 64512, v32
v_add_u32 v37, 9216, v36
v_add_u32 v34, 129024, v32
v_add_u32 v38, 18432, v36
v_add_u32 v35, 193536, v32
v_add_u32 v39, 27648, v36
s_lshr_b32 s28, s13, 1
s_lshl_b32 s28, s28, 7
s_lshl_b32 s27, s14, 8
s_add_u32 s27, s27, s28
s_xor_b32 s26, s13, 0
s_lshl_b32 s80, s26, 19
s_add_u32 s80, s80, s27
s_lshl_b32 s83, s14, 2
s_add_u32 s83, s83, s26
s_mul_i32 s83, s83, 40960
s_add_u32 s83, s83, s28
s_xor_b32 s26, s13, 2
s_lshl_b32 s81, s26, 19
s_add_u32 s81, s81, s27
s_lshl_b32 s84, s14, 2
s_add_u32 s84, s84, s26
s_mul_i32 s84, s84, 40960
s_add_u32 s84, s84, s28
s_and_b32 s26, s13, 1
s_add_u32 s26, s26, 8
s_lshl_b32 s82, s26, 19
s_add_u32 s82, s82, s27
s_load_dwordx2 s[68:69], s[0:1], 40
s_load_dwordx2 s[70:71], s[0:1], 48
s_load_dwordx2 s[72:73], s[0:1], 56
s_load_dwordx2 s[74:75], s[0:1], 64
s_mov_b32 s98, 5242880
s_waitcnt lgkmcnt(0)
s_mov_b64 s[96:97], s[70:71]
s_add_u32 m0, s29, 0
s_add_u32 s26, s80, 0
buffer_load_dwordx4 v32, s[96:99], s26 offen offset:0 lds
buffer_load_dwordx4 v33, s[96:99], s26 offen offset:1024 lds
buffer_load_dwordx4 v34, s[96:99], s26 offen offset:2048 lds
buffer_load_dwordx4 v35, s[96:99], s26 offen offset:3072 lds
s_add_u32 m0, s29, 16384
s_add_u32 s26, s80, 262144
buffer_load_dwordx4 v32, s[96:99], s26 offen offset:0 lds
buffer_load_dwordx4 v33, s[96:99], s26 offen offset:1024 lds
buffer_load_dwordx4 v34, s[96:99], s26 offen offset:2048 lds
buffer_load_dwordx4 v35, s[96:99], s26 offen offset:3072 lds
s_add_u32 m0, s29, 32768
s_add_u32 s26, s80, 2097152
buffer_load_dwordx4 v32, s[96:99], s26 offen offset:0 lds
buffer_load_dwordx4 v33, s[96:99], s26 offen offset:1024 lds
buffer_load_dwordx4 v34, s[96:99], s26 offen offset:2048 lds
buffer_load_dwordx4 v35, s[96:99], s26 offen offset:3072 lds
s_waitcnt vmcnt(8)
s_barrier
s_add_u32 m0, s29, 49152
s_add_u32 s26, s80, 2359296
buffer_load_dwordx4 v32, s[96:99], s26 offen offset:0 lds
buffer_load_dwordx4 v33, s[96:99], s26 offen offset:1024 lds
buffer_load_dwordx4 v34, s[96:99], s26 offen offset:2048 lds
buffer_load_dwordx4 v35, s[96:99], s26 offen offset:3072 lds
ds_read_b64_tr_b16 v[72:73], v40 offset:0
ds_read_b64_tr_b16 v[74:75], v40 offset:512
ds_read_b64_tr_b16 a[8:9], v40 offset:8
ds_read_b64_tr_b16 a[10:11], v40 offset:520
ds_read_b64_tr_b16 a[144:145], v41 offset:0
ds_read_b64_tr_b16 a[146:147], v41 offset:512
ds_read_b64_tr_b16 a[152:153], v41 offset:8
ds_read_b64_tr_b16 a[154:155], v41 offset:520
s_waitcnt lgkmcnt(6)
global_store_dwordx4 v0, v[72:75], s[76:77] offset:-2048
s_waitcnt vmcnt(9) lgkmcnt(0)
s_barrier
s_add_u32 m0, s29, 0
s_add_u32 s26, s81, 0
buffer_load_dwordx4 v32, s[96:99], s26 offen offset:0 lds
buffer_load_dwordx4 v33, s[96:99], s26 offen offset:1024 lds
buffer_load_dwordx4 v34, s[96:99], s26 offen offset:2048 lds
buffer_load_dwordx4 v35, s[96:99], s26 offen offset:3072 lds
ds_read_b64_tr_b16 v[72:73], v40 offset:16384
ds_read_b64_tr_b16 v[74:75], v40 offset:16896
ds_read_b64_tr_b16 a[12:13], v40 offset:16392
ds_read_b64_tr_b16 a[14:15], v40 offset:16904
ds_read_b64_tr_b16 a[148:149], v41 offset:16384
ds_read_b64_tr_b16 a[150:151], v41 offset:16896
ds_read_b64_tr_b16 a[156:157], v41 offset:16392
ds_read_b64_tr_b16 a[158:159], v41 offset:16904
s_waitcnt lgkmcnt(6)
global_store_dwordx4 v0, v[72:75], s[76:77] offset:-1024
s_waitcnt vmcnt(10) lgkmcnt(0)
s_barrier
s_add_u32 m0, s29, 16384
s_add_u32 s26, s81, 262144
buffer_load_dwordx4 v32, s[96:99], s26 offen offset:0 lds
buffer_load_dwordx4 v33, s[96:99], s26 offen offset:1024 lds
buffer_load_dwordx4 v34, s[96:99], s26 offen offset:2048 lds
buffer_load_dwordx4 v35, s[96:99], s26 offen offset:3072 lds
ds_read_b64_tr_b16 a[40:41], v40 offset:32768
ds_read_b64_tr_b16 a[42:43], v40 offset:33280
ds_read_b64_tr_b16 a[48:49], v40 offset:32776
ds_read_b64_tr_b16 a[50:51], v40 offset:33288
ds_read_b64_tr_b16 a[160:161], v41 offset:32768
ds_read_b64_tr_b16 a[162:163], v41 offset:33280
ds_read_b64_tr_b16 v[72:73], v41 offset:32776
ds_read_b64_tr_b16 v[74:75], v41 offset:33288
s_waitcnt lgkmcnt(0)
ds_write_b128 v2, v[72:75] offset:10240
s_waitcnt vmcnt(10)
s_barrier
s_add_u32 m0, s29, 32768
s_add_u32 s26, s81, 2097152
buffer_load_dwordx4 v32, s[96:99], s26 offen offset:0 lds
buffer_load_dwordx4 v33, s[96:99], s26 offen offset:1024 lds
buffer_load_dwordx4 v34, s[96:99], s26 offen offset:2048 lds
buffer_load_dwordx4 v35, s[96:99], s26 offen offset:3072 lds
ds_read_b64_tr_b16 a[44:45], v40 offset:49152
ds_read_b64_tr_b16 a[46:47], v40 offset:49664
ds_read_b64_tr_b16 a[52:53], v40 offset:49160
ds_read_b64_tr_b16 a[54:55], v40 offset:49672
ds_read_b64_tr_b16 a[164:165], v41 offset:49152
ds_read_b64_tr_b16 a[166:167], v41 offset:49664
ds_read_b64_tr_b16 v[72:73], v41 offset:49160
ds_read_b64_tr_b16 v[74:75], v41 offset:49672
s_waitcnt lgkmcnt(0)
ds_write_b128 v2, v[72:75] offset:11264
s_waitcnt vmcnt(9)
s_barrier
s_add_u32 m0, s29, 49152
s_add_u32 s26, s81, 2359296
buffer_load_dwordx4 v32, s[96:99], s26 offen offset:0 lds
buffer_load_dwordx4 v33, s[96:99], s26 offen offset:1024 lds
buffer_load_dwordx4 v34, s[96:99], s26 offen offset:2048 lds
buffer_load_dwordx4 v35, s[96:99], s26 offen offset:3072 lds
ds_read_b64_tr_b16 a[168:169], v40 offset:0
ds_read_b64_tr_b16 a[170:171], v40 offset:512
ds_read_b64_tr_b16 a[176:177], v40 offset:8
ds_read_b64_tr_b16 a[178:179], v40 offset:520
ds_read_b64_tr_b16 a[184:185], v41 offset:0
ds_read_b64_tr_b16 a[186:187], v41 offset:512
ds_read_b64_tr_b16 a[192:193], v41 offset:8
ds_read_b64_tr_b16 a[194:195], v41 offset:520
s_waitcnt vmcnt(8) lgkmcnt(0)
s_barrier
s_add_u32 m0, s29, 0
s_add_u32 s26, s82, 0
buffer_load_dwordx4 v32, s[96:99], s26 offen offset:0 lds
buffer_load_dwordx4 v33, s[96:99], s26 offen offset:1024 lds
buffer_load_dwordx4 v34, s[96:99], s26 offen offset:2048 lds
buffer_load_dwordx4 v35, s[96:99], s26 offen offset:3072 lds
ds_read_b64_tr_b16 a[172:173], v40 offset:16384
ds_read_b64_tr_b16 a[174:175], v40 offset:16896
ds_read_b64_tr_b16 a[180:181], v40 offset:16392
ds_read_b64_tr_b16 a[182:183], v40 offset:16904
ds_read_b64_tr_b16 a[188:189], v41 offset:16384
ds_read_b64_tr_b16 a[190:191], v41 offset:16896
ds_read_b64_tr_b16 a[196:197], v41 offset:16392
ds_read_b64_tr_b16 a[198:199], v41 offset:16904
s_waitcnt vmcnt(8) lgkmcnt(0)
s_barrier
s_add_u32 m0, s29, 16384
s_add_u32 s26, s82, 262144
buffer_load_dwordx4 v32, s[96:99], s26 offen offset:0 lds
buffer_load_dwordx4 v33, s[96:99], s26 offen offset:1024 lds
buffer_load_dwordx4 v34, s[96:99], s26 offen offset:2048 lds
buffer_load_dwordx4 v35, s[96:99], s26 offen offset:3072 lds
ds_read_b64_tr_b16 v[72:73], v40 offset:32768
ds_read_b64_tr_b16 v[74:75], v40 offset:33280
ds_read_b64_tr_b16 v[76:77], v40 offset:32776
ds_read_b64_tr_b16 v[78:79], v40 offset:33288
s_waitcnt lgkmcnt(2)
ds_write_b128 v2, v[72:75] offset:12288
s_waitcnt lgkmcnt(1)
global_store_dwordx4 v0, v[76:79], s[78:79] offset:-2048
ds_read_b64_tr_b16 a[200:201], v41 offset:32768
ds_read_b64_tr_b16 a[202:203], v41 offset:33280
ds_read_b64_tr_b16 a[208:209], v41 offset:32776
ds_read_b64_tr_b16 a[210:211], v41 offset:33288
s_waitcnt vmcnt(9) lgkmcnt(0)
s_barrier
s_mov_b64 s[96:97], s[72:73]
s_add_u32 m0, s29, 32768
s_add_u32 s26, s80, 0
buffer_load_dwordx4 v32, s[96:99], s26 offen offset:0 lds
buffer_load_dwordx4 v33, s[96:99], s26 offen offset:1024 lds
buffer_load_dwordx4 v34, s[96:99], s26 offen offset:2048 lds
buffer_load_dwordx4 v35, s[96:99], s26 offen offset:3072 lds
ds_read_b64_tr_b16 v[72:73], v40 offset:49152
ds_read_b64_tr_b16 v[74:75], v40 offset:49664
ds_read_b64_tr_b16 v[76:77], v40 offset:49160
ds_read_b64_tr_b16 v[78:79], v40 offset:49672
s_waitcnt lgkmcnt(2)
ds_write_b128 v2, v[72:75] offset:13312
s_waitcnt lgkmcnt(1)
global_store_dwordx4 v0, v[76:79], s[78:79] offset:-1024
ds_read_b64_tr_b16 a[204:205], v41 offset:49152
ds_read_b64_tr_b16 a[206:207], v41 offset:49664
ds_read_b64_tr_b16 a[212:213], v41 offset:49160
ds_read_b64_tr_b16 a[214:215], v41 offset:49672
s_waitcnt vmcnt(10) lgkmcnt(0)
s_barrier
s_add_u32 m0, s29, 49152
s_add_u32 s26, s80, 262144
buffer_load_dwordx4 v32, s[96:99], s26 offen offset:0 lds
buffer_load_dwordx4 v33, s[96:99], s26 offen offset:1024 lds
buffer_load_dwordx4 v34, s[96:99], s26 offen offset:2048 lds
buffer_load_dwordx4 v35, s[96:99], s26 offen offset:3072 lds
ds_read_b64_tr_b16 a[216:217], v40 offset:0
ds_read_b64_tr_b16 a[218:219], v40 offset:512
ds_read_b64_tr_b16 a[224:225], v40 offset:8
ds_read_b64_tr_b16 a[226:227], v40 offset:520
ds_read_b64_tr_b16 a[232:233], v41 offset:0
ds_read_b64_tr_b16 a[234:235], v41 offset:512
ds_read_b64_tr_b16 a[240:241], v41 offset:8
ds_read_b64_tr_b16 a[242:243], v41 offset:520
s_waitcnt vmcnt(10) lgkmcnt(0)
s_barrier
s_add_u32 m0, s29, 0
s_add_u32 s26, s80, 2097152
buffer_load_dwordx4 v32, s[96:99], s26 offen offset:0 lds
buffer_load_dwordx4 v33, s[96:99], s26 offen offset:1024 lds
buffer_load_dwordx4 v34, s[96:99], s26 offen offset:2048 lds
buffer_load_dwordx4 v35, s[96:99], s26 offen offset:3072 lds
ds_read_b64_tr_b16 a[220:221], v40 offset:16384
ds_read_b64_tr_b16 a[222:223], v40 offset:16896
ds_read_b64_tr_b16 a[228:229], v40 offset:16392
ds_read_b64_tr_b16 a[230:231], v40 offset:16904
ds_read_b64_tr_b16 a[236:237], v41 offset:16384
ds_read_b64_tr_b16 a[238:239], v41 offset:16896
ds_read_b64_tr_b16 a[244:245], v41 offset:16392
ds_read_b64_tr_b16 a[246:247], v41 offset:16904
s_waitcnt vmcnt(9) lgkmcnt(0)
s_barrier
s_add_u32 m0, s29, 16384
s_add_u32 s26, s80, 2359296
buffer_load_dwordx4 v32, s[96:99], s26 offen offset:0 lds
buffer_load_dwordx4 v33, s[96:99], s26 offen offset:1024 lds
buffer_load_dwordx4 v34, s[96:99], s26 offen offset:2048 lds
buffer_load_dwordx4 v35, s[96:99], s26 offen offset:3072 lds
ds_read_b64_tr_b16 a[16:17], v40 offset:32768
ds_read_b64_tr_b16 a[18:19], v40 offset:33280
ds_read_b64_tr_b16 v[72:73], v40 offset:32776
ds_read_b64_tr_b16 v[74:75], v40 offset:33288
ds_read_b64_tr_b16 v[88:89], v41 offset:32768
ds_read_b64_tr_b16 v[90:91], v41 offset:33280
ds_read_b64_tr_b16 v[96:97], v41 offset:32776
ds_read_b64_tr_b16 v[98:99], v41 offset:33288
s_waitcnt lgkmcnt(4)
global_store_dwordx4 v0, v[72:75], s[76:77] offset:0
s_waitcnt vmcnt(9) lgkmcnt(0)
s_barrier
s_add_u32 m0, s29, 32768
s_add_u32 s26, s81, 0
buffer_load_dwordx4 v32, s[96:99], s26 offen offset:0 lds
buffer_load_dwordx4 v33, s[96:99], s26 offen offset:1024 lds
buffer_load_dwordx4 v34, s[96:99], s26 offen offset:2048 lds
buffer_load_dwordx4 v35, s[96:99], s26 offen offset:3072 lds
ds_read_b64_tr_b16 a[20:21], v40 offset:49152
ds_read_b64_tr_b16 a[22:23], v40 offset:49664
ds_read_b64_tr_b16 v[72:73], v40 offset:49160
ds_read_b64_tr_b16 v[74:75], v40 offset:49672
ds_read_b64_tr_b16 v[92:93], v41 offset:49152
ds_read_b64_tr_b16 v[94:95], v41 offset:49664
ds_read_b64_tr_b16 v[100:101], v41 offset:49160
ds_read_b64_tr_b16 v[102:103], v41 offset:49672
s_waitcnt lgkmcnt(4)
global_store_dwordx4 v0, v[72:75], s[76:77] offset:1024
s_waitcnt vmcnt(10) lgkmcnt(0)
s_barrier
s_add_u32 m0, s29, 49152
s_add_u32 s26, s81, 262144
buffer_load_dwordx4 v32, s[96:99], s26 offen offset:0 lds
buffer_load_dwordx4 v33, s[96:99], s26 offen offset:1024 lds
buffer_load_dwordx4 v34, s[96:99], s26 offen offset:2048 lds
buffer_load_dwordx4 v35, s[96:99], s26 offen offset:3072 lds
ds_read_b64_tr_b16 a[56:57], v40 offset:0
ds_read_b64_tr_b16 a[58:59], v40 offset:512
ds_read_b64_tr_b16 v[72:73], v40 offset:8
ds_read_b64_tr_b16 v[74:75], v40 offset:520
ds_read_b64_tr_b16 v[76:77], v41 offset:0
ds_read_b64_tr_b16 v[78:79], v41 offset:512
s_waitcnt lgkmcnt(2)
ds_write_b128 v2, v[72:75] offset:0
s_waitcnt lgkmcnt(1)
global_store_dwordx4 v0, v[76:79], s[78:79] offset:0
ds_read_b64_tr_b16 v[104:105], v41 offset:8
ds_read_b64_tr_b16 v[106:107], v41 offset:520
s_waitcnt vmcnt(11) lgkmcnt(0)
s_barrier
s_add_u32 m0, s29, 0
s_add_u32 s26, s81, 2097152
buffer_load_dwordx4 v32, s[96:99], s26 offen offset:0 lds
buffer_load_dwordx4 v33, s[96:99], s26 offen offset:1024 lds
buffer_load_dwordx4 v34, s[96:99], s26 offen offset:2048 lds
buffer_load_dwordx4 v35, s[96:99], s26 offen offset:3072 lds
ds_read_b64_tr_b16 a[60:61], v40 offset:16384
ds_read_b64_tr_b16 a[62:63], v40 offset:16896
ds_read_b64_tr_b16 v[72:73], v40 offset:16392
ds_read_b64_tr_b16 v[74:75], v40 offset:16904
ds_read_b64_tr_b16 v[76:77], v41 offset:16384
ds_read_b64_tr_b16 v[78:79], v41 offset:16896
s_waitcnt lgkmcnt(2)
ds_write_b128 v2, v[72:75] offset:1024
s_waitcnt lgkmcnt(1)
global_store_dwordx4 v0, v[76:79], s[78:79] offset:1024
ds_read_b64_tr_b16 v[108:109], v41 offset:16392
ds_read_b64_tr_b16 v[110:111], v41 offset:16904
s_waitcnt vmcnt(11) lgkmcnt(0)
s_barrier
s_add_u32 m0, s29, 16384
s_add_u32 s26, s81, 2359296
buffer_load_dwordx4 v32, s[96:99], s26 offen offset:0 lds
buffer_load_dwordx4 v33, s[96:99], s26 offen offset:1024 lds
buffer_load_dwordx4 v34, s[96:99], s26 offen offset:2048 lds
buffer_load_dwordx4 v35, s[96:99], s26 offen offset:3072 lds
ds_read_b64_tr_b16 v[112:113], v40 offset:32768
ds_read_b64_tr_b16 v[114:115], v40 offset:33280
ds_read_b64_tr_b16 v[120:121], v40 offset:32776
ds_read_b64_tr_b16 v[122:123], v40 offset:33288
ds_read_b64_tr_b16 v[72:73], v41 offset:32768
ds_read_b64_tr_b16 v[74:75], v41 offset:33280
ds_read_b64_tr_b16 v[144:145], v41 offset:32776
ds_read_b64_tr_b16 v[146:147], v41 offset:33288
s_waitcnt lgkmcnt(2)
ds_write_b128 v2, v[72:75] offset:18432
s_waitcnt vmcnt(10) lgkmcnt(1)
s_barrier
s_add_u32 m0, s29, 32768
s_add_u32 s26, s82, 0
buffer_load_dwordx4 v32, s[96:99], s26 offen offset:0 lds
buffer_load_dwordx4 v33, s[96:99], s26 offen offset:1024 lds
buffer_load_dwordx4 v34, s[96:99], s26 offen offset:2048 lds
buffer_load_dwordx4 v35, s[96:99], s26 offen offset:3072 lds
ds_read_b64_tr_b16 v[116:117], v40 offset:49152
ds_read_b64_tr_b16 v[118:119], v40 offset:49664
ds_read_b64_tr_b16 v[124:125], v40 offset:49160
ds_read_b64_tr_b16 v[126:127], v40 offset:49672
ds_read_b64_tr_b16 v[72:73], v41 offset:49152
ds_read_b64_tr_b16 v[74:75], v41 offset:49664
ds_read_b64_tr_b16 v[148:149], v41 offset:49160
ds_read_b64_tr_b16 v[150:151], v41 offset:49672
s_waitcnt lgkmcnt(2)
ds_write_b128 v2, v[72:75] offset:19456
s_waitcnt vmcnt(9) lgkmcnt(1)
s_barrier
s_add_u32 m0, s29, 49152
s_add_u32 s26, s82, 262144
buffer_load_dwordx4 v32, s[96:99], s26 offen offset:0 lds
buffer_load_dwordx4 v33, s[96:99], s26 offen offset:1024 lds
buffer_load_dwordx4 v34, s[96:99], s26 offen offset:2048 lds
buffer_load_dwordx4 v35, s[96:99], s26 offen offset:3072 lds
ds_read_b64_tr_b16 v[128:129], v40 offset:0
ds_read_b64_tr_b16 v[130:131], v40 offset:512
ds_read_b64_tr_b16 v[136:137], v40 offset:8
ds_read_b64_tr_b16 v[138:139], v40 offset:520
ds_read_b64_tr_b16 v[72:73], v41 offset:0
ds_read_b64_tr_b16 v[74:75], v41 offset:512
ds_read_b64_tr_b16 v[152:153], v41 offset:8
ds_read_b64_tr_b16 v[154:155], v41 offset:520
s_waitcnt lgkmcnt(2)
global_store_dwordx4 v0, v[72:75], s[78:79] offset:2048
s_waitcnt vmcnt(9) lgkmcnt(0)
s_barrier
s_mov_b64 s[96:97], s[68:69]
s_add_u32 m0, s29, 0
s_add_u32 s26, s80, 0
buffer_load_dwordx4 v32, s[96:99], s26 offen offset:0 lds
buffer_load_dwordx4 v33, s[96:99], s26 offen offset:1024 lds
buffer_load_dwordx4 v34, s[96:99], s26 offen offset:2048 lds
buffer_load_dwordx4 v35, s[96:99], s26 offen offset:3072 lds
ds_read_b64_tr_b16 v[132:133], v40 offset:16384
ds_read_b64_tr_b16 v[134:135], v40 offset:16896
ds_read_b64_tr_b16 v[140:141], v40 offset:16392
ds_read_b64_tr_b16 v[142:143], v40 offset:16904
ds_read_b64_tr_b16 v[72:73], v41 offset:16384
ds_read_b64_tr_b16 v[74:75], v41 offset:16896
ds_read_b64_tr_b16 v[156:157], v41 offset:16392
ds_read_b64_tr_b16 v[158:159], v41 offset:16904
s_waitcnt lgkmcnt(2)
global_store_dwordx4 v0, v[72:75], s[78:79] offset:3072
s_waitcnt vmcnt(10) lgkmcnt(0)
s_barrier
s_add_u32 m0, s29, 16384
s_add_u32 s26, s80, 262144
buffer_load_dwordx4 v32, s[96:99], s26 offen offset:0 lds
buffer_load_dwordx4 v33, s[96:99], s26 offen offset:1024 lds
buffer_load_dwordx4 v34, s[96:99], s26 offen offset:2048 lds
buffer_load_dwordx4 v35, s[96:99], s26 offen offset:3072 lds
ds_read_b64_tr_b16 a[248:249], v40 offset:32768
ds_read_b64_tr_b16 a[250:251], v40 offset:33280
ds_read_b64_tr_b16 v[80:81], v40 offset:32776
ds_read_b64_tr_b16 v[82:83], v40 offset:33288
ds_read_b64_tr_b16 v[72:73], v41 offset:32768
ds_read_b64_tr_b16 v[74:75], v41 offset:33280
ds_read_b64_tr_b16 v[76:77], v41 offset:32776
ds_read_b64_tr_b16 v[78:79], v41 offset:33288
s_waitcnt lgkmcnt(2)
ds_write_b128 v2, v[72:75] offset:14336
s_waitcnt lgkmcnt(1)
ds_write_b128 v2, v[76:79] offset:16384
s_waitcnt vmcnt(10)
s_barrier
s_add_u32 m0, s29, 32768
s_add_u32 s26, s80, 2097152
buffer_load_dwordx4 v32, s[96:99], s26 offen offset:0 lds
buffer_load_dwordx4 v33, s[96:99], s26 offen offset:1024 lds
buffer_load_dwordx4 v34, s[96:99], s26 offen offset:2048 lds
buffer_load_dwordx4 v35, s[96:99], s26 offen offset:3072 lds
ds_read_b64_tr_b16 a[252:253], v40 offset:49152
ds_read_b64_tr_b16 a[254:255], v40 offset:49664
ds_read_b64_tr_b16 v[84:85], v40 offset:49160
ds_read_b64_tr_b16 v[86:87], v40 offset:49672
ds_read_b64_tr_b16 v[72:73], v41 offset:49152
ds_read_b64_tr_b16 v[74:75], v41 offset:49664
ds_read_b64_tr_b16 v[76:77], v41 offset:49160
ds_read_b64_tr_b16 v[78:79], v41 offset:49672
s_waitcnt lgkmcnt(2)
ds_write_b128 v2, v[72:75] offset:15360
s_waitcnt lgkmcnt(1)
ds_write_b128 v2, v[76:79] offset:17408
s_waitcnt vmcnt(9)
s_barrier
s_add_u32 m0, s29, 49152
s_add_u32 s26, s80, 2359296
buffer_load_dwordx4 v32, s[96:99], s26 offen offset:0 lds
buffer_load_dwordx4 v33, s[96:99], s26 offen offset:1024 lds
buffer_load_dwordx4 v34, s[96:99], s26 offen offset:2048 lds
buffer_load_dwordx4 v35, s[96:99], s26 offen offset:3072 lds
ds_read_b64_tr_b16 v[72:73], v40 offset:0
ds_read_b64_tr_b16 v[74:75], v40 offset:512
ds_read_b64_tr_b16 a[0:1], v40 offset:8
ds_read_b64_tr_b16 a[2:3], v40 offset:520
ds_read_b64_tr_b16 a[64:65], v41 offset:0
ds_read_b64_tr_b16 a[66:67], v41 offset:512
ds_read_b64_tr_b16 v[76:77], v41 offset:8
ds_read_b64_tr_b16 v[78:79], v41 offset:520
s_waitcnt lgkmcnt(6)
global_store_dwordx4 v0, v[72:75], s[76:77] offset:-4096
s_waitcnt lgkmcnt(0)
global_store_dwordx4 v0, v[76:79], s[76:77] offset:2048
s_waitcnt vmcnt(10)
s_barrier
s_add_u32 m0, s29, 0
s_add_u32 s26, s81, 0
buffer_load_dwordx4 v32, s[96:99], s26 offen offset:0 lds
buffer_load_dwordx4 v33, s[96:99], s26 offen offset:1024 lds
buffer_load_dwordx4 v34, s[96:99], s26 offen offset:2048 lds
buffer_load_dwordx4 v35, s[96:99], s26 offen offset:3072 lds
ds_read_b64_tr_b16 v[72:73], v40 offset:16384
ds_read_b64_tr_b16 v[74:75], v40 offset:16896
ds_read_b64_tr_b16 a[4:5], v40 offset:16392
ds_read_b64_tr_b16 a[6:7], v40 offset:16904
ds_read_b64_tr_b16 a[68:69], v41 offset:16384
ds_read_b64_tr_b16 a[70:71], v41 offset:16896
ds_read_b64_tr_b16 v[76:77], v41 offset:16392
ds_read_b64_tr_b16 v[78:79], v41 offset:16904
s_waitcnt lgkmcnt(6)
global_store_dwordx4 v0, v[72:75], s[76:77] offset:-3072
s_waitcnt lgkmcnt(0)
global_store_dwordx4 v0, v[76:79], s[76:77] offset:3072
s_waitcnt vmcnt(12)
s_barrier
s_add_u32 m0, s29, 16384
s_add_u32 s26, s81, 262144
buffer_load_dwordx4 v32, s[96:99], s26 offen offset:0 lds
buffer_load_dwordx4 v33, s[96:99], s26 offen offset:1024 lds
buffer_load_dwordx4 v34, s[96:99], s26 offen offset:2048 lds
buffer_load_dwordx4 v35, s[96:99], s26 offen offset:3072 lds
ds_read_b64_tr_b16 a[24:25], v40 offset:32768
ds_read_b64_tr_b16 a[26:27], v40 offset:33280
ds_read_b64_tr_b16 a[32:33], v40 offset:32776
ds_read_b64_tr_b16 a[34:35], v40 offset:33288
ds_read_b64_tr_b16 a[72:73], v41 offset:32768
ds_read_b64_tr_b16 a[74:75], v41 offset:33280
ds_read_b64_tr_b16 a[80:81], v41 offset:32776
ds_read_b64_tr_b16 a[82:83], v41 offset:33288
s_waitcnt vmcnt(12) lgkmcnt(0)
s_barrier
s_add_u32 m0, s29, 32768
s_add_u32 s26, s81, 2097152
buffer_load_dwordx4 v32, s[96:99], s26 offen offset:0 lds
buffer_load_dwordx4 v33, s[96:99], s26 offen offset:1024 lds
buffer_load_dwordx4 v34, s[96:99], s26 offen offset:2048 lds
buffer_load_dwordx4 v35, s[96:99], s26 offen offset:3072 lds
ds_read_b64_tr_b16 a[28:29], v40 offset:49152
ds_read_b64_tr_b16 a[30:31], v40 offset:49664
ds_read_b64_tr_b16 a[36:37], v40 offset:49160
ds_read_b64_tr_b16 a[38:39], v40 offset:49672
ds_read_b64_tr_b16 a[76:77], v41 offset:49152
ds_read_b64_tr_b16 a[78:79], v41 offset:49664
ds_read_b64_tr_b16 a[84:85], v41 offset:49160
ds_read_b64_tr_b16 a[86:87], v41 offset:49672
s_waitcnt vmcnt(10) lgkmcnt(0)
s_barrier
s_add_u32 m0, s29, 49152
s_add_u32 s26, s81, 2359296
buffer_load_dwordx4 v32, s[96:99], s26 offen offset:0 lds
buffer_load_dwordx4 v33, s[96:99], s26 offen offset:1024 lds
buffer_load_dwordx4 v34, s[96:99], s26 offen offset:2048 lds
buffer_load_dwordx4 v35, s[96:99], s26 offen offset:3072 lds
ds_read_b64_tr_b16 v[72:73], v40 offset:0
ds_read_b64_tr_b16 v[74:75], v40 offset:512
ds_read_b64_tr_b16 a[88:89], v40 offset:8
ds_read_b64_tr_b16 a[90:91], v40 offset:520
ds_read_b64_tr_b16 a[104:105], v41 offset:0
ds_read_b64_tr_b16 a[106:107], v41 offset:512
ds_read_b64_tr_b16 a[112:113], v41 offset:8
ds_read_b64_tr_b16 a[114:115], v41 offset:520
s_waitcnt lgkmcnt(6)
ds_write_b128 v2, v[72:75] offset:2048
s_waitcnt vmcnt(8) lgkmcnt(1)
s_barrier
s_add_u32 m0, s29, 0
s_add_u32 s26, s82, 0
buffer_load_dwordx4 v32, s[96:99], s26 offen offset:0 lds
buffer_load_dwordx4 v33, s[96:99], s26 offen offset:1024 lds
buffer_load_dwordx4 v34, s[96:99], s26 offen offset:2048 lds
buffer_load_dwordx4 v35, s[96:99], s26 offen offset:3072 lds
ds_read_b64_tr_b16 v[72:73], v40 offset:16384
ds_read_b64_tr_b16 v[74:75], v40 offset:16896
ds_read_b64_tr_b16 a[92:93], v40 offset:16392
ds_read_b64_tr_b16 a[94:95], v40 offset:16904
ds_read_b64_tr_b16 a[108:109], v41 offset:16384
ds_read_b64_tr_b16 a[110:111], v41 offset:16896
ds_read_b64_tr_b16 a[116:117], v41 offset:16392
ds_read_b64_tr_b16 a[118:119], v41 offset:16904
s_waitcnt lgkmcnt(6)
ds_write_b128 v2, v[72:75] offset:3072
s_waitcnt vmcnt(8) lgkmcnt(1)
s_barrier
s_add_u32 m0, s29, 16384
s_add_u32 s26, s82, 262144
buffer_load_dwordx4 v32, s[96:99], s26 offen offset:0 lds
buffer_load_dwordx4 v33, s[96:99], s26 offen offset:1024 lds
buffer_load_dwordx4 v34, s[96:99], s26 offen offset:2048 lds
buffer_load_dwordx4 v35, s[96:99], s26 offen offset:3072 lds
ds_read_b64_tr_b16 a[96:97], v40 offset:32768
ds_read_b64_tr_b16 a[98:99], v40 offset:33280
ds_read_b64_tr_b16 v[72:73], v40 offset:32776
ds_read_b64_tr_b16 v[74:75], v40 offset:33288
ds_read_b64_tr_b16 v[76:77], v41 offset:32768
ds_read_b64_tr_b16 v[78:79], v41 offset:33280
s_waitcnt lgkmcnt(2)
ds_write_b128 v2, v[72:75] offset:4096
s_waitcnt lgkmcnt(1)
global_store_dwordx4 v0, v[76:79], s[78:79] offset:-4096
ds_read_b64_tr_b16 v[72:73], v41 offset:32776
ds_read_b64_tr_b16 v[74:75], v41 offset:33288
s_waitcnt lgkmcnt(0)
ds_write_b128 v2, v[72:75] offset:6144
s_waitcnt vmcnt(9)
s_barrier
s_mov_b64 s[96:97], s[74:75]
s_add_u32 m0, s29, 32768
s_add_u32 s26, s83, 0
buffer_load_dwordx4 v36, s[96:99], s26 offen offset:0 lds
buffer_load_dwordx4 v37, s[96:99], s26 offen offset:1024 lds
buffer_load_dwordx4 v38, s[96:99], s26 offen offset:2048 lds
buffer_load_dwordx4 v39, s[96:99], s26 offen offset:3072 lds
ds_read_b64_tr_b16 a[100:101], v40 offset:49152
ds_read_b64_tr_b16 a[102:103], v40 offset:49664
ds_read_b64_tr_b16 v[72:73], v40 offset:49160
ds_read_b64_tr_b16 v[74:75], v40 offset:49672
ds_read_b64_tr_b16 v[76:77], v41 offset:49152
ds_read_b64_tr_b16 v[78:79], v41 offset:49664
s_waitcnt lgkmcnt(2)
ds_write_b128 v2, v[72:75] offset:5120
s_waitcnt lgkmcnt(1)
global_store_dwordx4 v0, v[76:79], s[78:79] offset:-3072
ds_read_b64_tr_b16 v[72:73], v41 offset:49160
ds_read_b64_tr_b16 v[74:75], v41 offset:49672
s_waitcnt lgkmcnt(0)
ds_write_b128 v2, v[72:75] offset:7168
s_waitcnt vmcnt(10)
s_barrier
s_add_u32 m0, s29, 49152
s_add_u32 s26, s84, 0
buffer_load_dwordx4 v36, s[96:99], s26 offen offset:0 lds
buffer_load_dwordx4 v37, s[96:99], s26 offen offset:1024 lds
buffer_load_dwordx4 v38, s[96:99], s26 offen offset:2048 lds
buffer_load_dwordx4 v39, s[96:99], s26 offen offset:3072 lds
ds_read_b64_tr_b16 a[120:121], v40 offset:0
ds_read_b64_tr_b16 a[122:123], v40 offset:512
ds_read_b64_tr_b16 v[72:73], v40 offset:8
ds_read_b64_tr_b16 v[74:75], v40 offset:520
ds_read_b64_tr_b16 a[128:129], v41 offset:0
ds_read_b64_tr_b16 a[130:131], v41 offset:512
ds_read_b64_tr_b16 a[136:137], v41 offset:8
ds_read_b64_tr_b16 a[138:139], v41 offset:520
s_waitcnt lgkmcnt(4)
ds_write_b128 v2, v[72:75] offset:8192
s_waitcnt vmcnt(10) lgkmcnt(1)
s_barrier
s_add_u32 m0, s29, 0
s_add_u32 s26, s83, 256
buffer_load_dwordx4 v36, s[96:99], s26 offen offset:0 lds
buffer_load_dwordx4 v37, s[96:99], s26 offen offset:1024 lds
buffer_load_dwordx4 v38, s[96:99], s26 offen offset:2048 lds
buffer_load_dwordx4 v39, s[96:99], s26 offen offset:3072 lds
ds_read_b64_tr_b16 a[124:125], v40 offset:16384
ds_read_b64_tr_b16 a[126:127], v40 offset:16896
ds_read_b64_tr_b16 v[72:73], v40 offset:16392
ds_read_b64_tr_b16 v[74:75], v40 offset:16904
ds_read_b64_tr_b16 a[132:133], v41 offset:16384
ds_read_b64_tr_b16 a[134:135], v41 offset:16896
ds_read_b64_tr_b16 a[140:141], v41 offset:16392
ds_read_b64_tr_b16 a[142:143], v41 offset:16904
s_waitcnt lgkmcnt(4)
ds_write_b128 v2, v[72:75] offset:9216
s_waitcnt vmcnt(9) lgkmcnt(1)
s_barrier
s_add_u32 m0, s29, 16384
s_add_u32 s26, s84, 256
buffer_load_dwordx4 v36, s[96:99], s26 offen offset:0 lds
buffer_load_dwordx4 v37, s[96:99], s26 offen offset:1024 lds
buffer_load_dwordx4 v38, s[96:99], s26 offen offset:2048 lds
buffer_load_dwordx4 v39, s[96:99], s26 offen offset:3072 lds
ds_read_b64_tr_b16 v[72:73], v42 offset:32768
ds_read_b64_tr_b16 v[74:75], v42 offset:33024
ds_read_b64_tr_b16 v[76:77], v42 offset:34816
ds_read_b64_tr_b16 v[78:79], v42 offset:35072
s_waitcnt lgkmcnt(2)
ds_write_b128 v2, v[72:75] offset:20480
s_waitcnt lgkmcnt(1)
ds_write_b128 v2, v[76:79] offset:21504
ds_read_b64_tr_b16 v[8:9], v43 offset:32768
ds_read_b64_tr_b16 v[10:11], v43 offset:33024
ds_read_b64_tr_b16 v[12:13], v43 offset:34816
ds_read_b64_tr_b16 v[14:15], v43 offset:35072
s_waitcnt vmcnt(8) lgkmcnt(0)
s_barrier
s_add_u32 m0, s29, 32768
s_add_u32 s26, s83, 512
buffer_load_dwordx4 v36, s[96:99], s26 offen offset:0 lds
buffer_load_dwordx4 v37, s[96:99], s26 offen offset:1024 lds
buffer_load_dwordx4 v38, s[96:99], s26 offen offset:2048 lds
buffer_load_dwordx4 v39, s[96:99], s26 offen offset:3072 lds
ds_read_b64_tr_b16 v[16:17], v42 offset:49152
ds_read_b64_tr_b16 v[18:19], v42 offset:49408
ds_read_b64_tr_b16 v[20:21], v42 offset:51200
ds_read_b64_tr_b16 v[22:23], v42 offset:51456
ds_read_b64_tr_b16 v[184:185], v43 offset:49152
ds_read_b64_tr_b16 v[186:187], v43 offset:49408
ds_read_b64_tr_b16 v[188:189], v43 offset:51200
ds_read_b64_tr_b16 v[190:191], v43 offset:51456
s_waitcnt vmcnt(8) lgkmcnt(0)
s_barrier
s_add_u32 m0, s29, 49152
s_add_u32 s26, s84, 512
buffer_load_dwordx4 v36, s[96:99], s26 offen offset:0 lds
buffer_load_dwordx4 v37, s[96:99], s26 offen offset:1024 lds
buffer_load_dwordx4 v38, s[96:99], s26 offen offset:2048 lds
buffer_load_dwordx4 v39, s[96:99], s26 offen offset:3072 lds
ds_read_b64_tr_b16 v[72:73], v42 offset:0
ds_read_b64_tr_b16 v[74:75], v42 offset:256
ds_read_b64_tr_b16 v[76:77], v42 offset:2048
ds_read_b64_tr_b16 v[78:79], v42 offset:2304
s_waitcnt lgkmcnt(2)
ds_write_b128 v2, v[72:75] offset:22528
s_waitcnt lgkmcnt(1)
ds_write_b128 v2, v[76:79] offset:23552
ds_read_b64_tr_b16 v[192:193], v43 offset:0
ds_read_b64_tr_b16 v[194:195], v43 offset:256
ds_read_b64_tr_b16 v[196:197], v43 offset:2048
ds_read_b64_tr_b16 v[198:199], v43 offset:2304
s_waitcnt vmcnt(8) lgkmcnt(0)
s_barrier
s_add_u32 m0, s29, 0
s_add_u32 s26, s83, 768
buffer_load_dwordx4 v36, s[96:99], s26 offen offset:0 lds
buffer_load_dwordx4 v37, s[96:99], s26 offen offset:1024 lds
buffer_load_dwordx4 v38, s[96:99], s26 offen offset:2048 lds
buffer_load_dwordx4 v39, s[96:99], s26 offen offset:3072 lds
ds_read_b64_tr_b16 v[200:201], v42 offset:16384
ds_read_b64_tr_b16 v[202:203], v42 offset:16640
ds_read_b64_tr_b16 v[204:205], v42 offset:18432
ds_read_b64_tr_b16 v[206:207], v42 offset:18688
ds_read_b64_tr_b16 v[24:25], v43 offset:16384
ds_read_b64_tr_b16 v[26:27], v43 offset:16640
ds_read_b64_tr_b16 v[28:29], v43 offset:18432
ds_read_b64_tr_b16 v[30:31], v43 offset:18688
s_waitcnt vmcnt(8) lgkmcnt(0)
s_barrier
s_add_u32 m0, s29, 16384
s_add_u32 s26, s84, 768
buffer_load_dwordx4 v36, s[96:99], s26 offen offset:0 lds
buffer_load_dwordx4 v37, s[96:99], s26 offen offset:1024 lds
buffer_load_dwordx4 v38, s[96:99], s26 offen offset:2048 lds
buffer_load_dwordx4 v39, s[96:99], s26 offen offset:3072 lds
ds_read_b64_tr_b16 v[160:161], v42 offset:32768
ds_read_b64_tr_b16 v[162:163], v42 offset:33024
ds_read_b64_tr_b16 v[164:165], v42 offset:34816
ds_read_b64_tr_b16 v[166:167], v42 offset:35072
ds_read_b64_tr_b16 v[208:209], v43 offset:32768
ds_read_b64_tr_b16 v[210:211], v43 offset:33024
ds_read_b64_tr_b16 v[212:213], v43 offset:34816
ds_read_b64_tr_b16 v[214:215], v43 offset:35072
s_waitcnt vmcnt(8) lgkmcnt(0)
s_barrier
s_add_u32 m0, s29, 32768
s_add_u32 s26, s83, 1024
buffer_load_dwordx4 v36, s[96:99], s26 offen offset:0 lds
buffer_load_dwordx4 v37, s[96:99], s26 offen offset:1024 lds
buffer_load_dwordx4 v38, s[96:99], s26 offen offset:2048 lds
buffer_load_dwordx4 v39, s[96:99], s26 offen offset:3072 lds
ds_read_b64_tr_b16 v[216:217], v42 offset:49152
ds_read_b64_tr_b16 v[218:219], v42 offset:49408
ds_read_b64_tr_b16 v[220:221], v42 offset:51200
ds_read_b64_tr_b16 v[222:223], v42 offset:51456
ds_read_b64_tr_b16 v[48:49], v43 offset:49152
ds_read_b64_tr_b16 v[50:51], v43 offset:49408
ds_read_b64_tr_b16 v[52:53], v43 offset:51200
ds_read_b64_tr_b16 v[54:55], v43 offset:51456
v_lshrrev_b32 v44, 4, v0
v_and_b32 v44, 15, v44
v_lshlrev_b32 v44, 4, v44
buffer_load_dword v45, v44, s[8:11], 0 offen sc1
s_waitcnt vmcnt(9) lgkmcnt(0)
s_barrier
s_add_u32 m0, s29, 49152
s_add_u32 s26, s84, 1024
buffer_load_dwordx4 v36, s[96:99], s26 offen offset:0 lds
buffer_load_dwordx4 v37, s[96:99], s26 offen offset:1024 lds
buffer_load_dwordx4 v38, s[96:99], s26 offen offset:2048 lds
buffer_load_dwordx4 v39, s[96:99], s26 offen offset:3072 lds
ds_read_b64_tr_b16 v[168:169], v42 offset:0
ds_read_b64_tr_b16 v[170:171], v42 offset:256
ds_read_b64_tr_b16 v[172:173], v42 offset:2048
ds_read_b64_tr_b16 v[174:175], v42 offset:2304
ds_read_b64_tr_b16 v[224:225], v43 offset:0
ds_read_b64_tr_b16 v[226:227], v43 offset:256
ds_read_b64_tr_b16 v[228:229], v43 offset:2048
ds_read_b64_tr_b16 v[230:231], v43 offset:2304
s_waitcnt vmcnt(9) lgkmcnt(0)
s_barrier
ds_read_b64_tr_b16 v[56:57], v42 offset:16384
ds_read_b64_tr_b16 v[58:59], v42 offset:16640
ds_read_b64_tr_b16 v[60:61], v42 offset:18432
ds_read_b64_tr_b16 v[62:63], v42 offset:18688
ds_read_b64_tr_b16 v[64:65], v43 offset:16384
ds_read_b64_tr_b16 v[66:67], v43 offset:16640
ds_read_b64_tr_b16 v[68:69], v43 offset:18432
ds_read_b64_tr_b16 v[70:71], v43 offset:18688
s_waitcnt vmcnt(5) lgkmcnt(0)
s_barrier
ds_read_b64_tr_b16 v[176:177], v42 offset:32768
ds_read_b64_tr_b16 v[178:179], v42 offset:33024
ds_read_b64_tr_b16 v[180:181], v42 offset:34816
ds_read_b64_tr_b16 v[182:183], v42 offset:35072
ds_read_b64_tr_b16 v[232:233], v43 offset:32768
ds_read_b64_tr_b16 v[234:235], v43 offset:33024
ds_read_b64_tr_b16 v[236:237], v43 offset:34816
ds_read_b64_tr_b16 v[238:239], v43 offset:35072
s_waitcnt vmcnt(0) lgkmcnt(0)
s_barrier
ds_read_b64_tr_b16 v[240:241], v42 offset:49152
ds_read_b64_tr_b16 v[242:243], v42 offset:49408
ds_read_b64_tr_b16 v[244:245], v42 offset:51200
ds_read_b64_tr_b16 v[246:247], v42 offset:51456
ds_read_b64_tr_b16 v[248:249], v43 offset:49152
ds_read_b64_tr_b16 v[250:251], v43 offset:49408
ds_read_b64_tr_b16 v[252:253], v43 offset:51200
ds_read_b64_tr_b16 v[254:255], v43 offset:51456
s_waitcnt lgkmcnt(0)
s_barrier
s_mul_i32 s26, s13, 12288
v_add_u32 v47, s26, v0
ds_write_b128 v47, v[8:11] offset:16384
ds_write_b128 v47, v[12:15] offset:17408
ds_write_b128 v47, v[16:19] offset:18432
ds_write_b128 v47, v[20:23] offset:19456
ds_write_b128 v47, v[24:27] offset:20480
ds_write_b128 v47, v[28:31] offset:21504
ds_write_b128 v47, v[48:51] offset:22528
ds_write_b128 v47, v[52:55] offset:23552
ds_write_b128 v47, v[56:59] offset:24576
ds_write_b128 v47, v[60:63] offset:25600
ds_write_b128 v47, v[64:67] offset:26624
ds_write_b128 v47, v[68:71] offset:27648
s_mov_b32 s30, 0
s_branch all_10067
all_10066:
buffer_load_dword v45, v44, s[8:11], 0 offen sc1
s_add_u32 s30, s30, 1
s_cmp_gt_u32 s30, 262144
s_cbranch_scc1 L_fail
all_10067:
s_waitcnt vmcnt(0)
v_add_u32_dpp v46, v45, v45 quad_perm:[1,0,3,2] row_mask:0xf bank_mask:0xf
s_nop 1
v_add_u32_dpp v46, v46, v46 quad_perm:[2,3,0,1] row_mask:0xf bank_mask:0xf
s_nop 1
v_add_u32_dpp v46, v46, v46 row_ror:4 row_mask:0xf bank_mask:0xf
s_nop 1
v_add_u32_dpp v46, v46, v46 row_ror:8 row_mask:0xf bank_mask:0xf
v_cmp_ne_u32 vcc, 306, v46
s_cbranch_vccnz all_10066
s_waitcnt vmcnt(0) lgkmcnt(0)
s_barrier
s_mov_b32 s18, 0
s_mov_b32 s36, 0
s_cmp_eq_u32 s13, 1
s_cbranch_scc1 wave_10069
s_cmp_eq_u32 s13, 2
s_cbranch_scc1 wave_10070
s_cmp_eq_u32 s13, 3
s_cbranch_scc1 wave_10071
wave_10068:
layer_10072:
s_lshl_b32 s17, s36, 6
s_mul_i32 s27, s36, 35651584
s_mul_i32 s28, s14, 16384
s_add_u32 s27, s27, s28
s_add_u32 s20, s27, 16777216
s_mul_i32 s27, s17, 10240
s_add_u32 s27, s27, s24
s_add_u32 s21, s27, s25
s_mov_b32 s19, 0
s_mov_b32 s33, s6
s_add_u32 s34, s17, 1
s_add_u32 s31, s17, 63
s_add_u32 s32, s17, 64
s_mov_b32 s27, s20
v_mov_b32 v7, 0
s_add_u32 s68, s4, 413696
s_addc_u32 s69, s5, 0
s_add_u32 s72, s4, 397312
s_addc_u32 s73, s5, 0
s_add_u32 s70, s4, 417792
s_addc_u32 s71, s5, 0
s_add_u32 s74, s4, 401408
s_addc_u32 s75, s5, 0
s_add_u32 s58, s4, s20
s_addc_u32 s59, s5, 0
global_load_dwordx4 v[64:67], v0, s[76:77] offset:-4096 sc1
global_load_dwordx4 v[68:71], v0, s[76:77] offset:-3072 sc1
global_load_dwordx4 v[72:75], v0, s[76:77] offset:0 sc1
global_load_dwordx4 v[76:79], v0, s[76:77] offset:1024 sc1
global_load_dwordx4 v[48:51], v0, s[76:77] offset:2048 sc1
global_load_dwordx4 v[52:55], v0, s[76:77] offset:3072 sc1
global_load_dwordx4 v[56:59], v0, s[76:77] offset:-2048 sc1
global_load_dwordx4 v[60:63], v0, s[76:77] offset:-1024 sc1
v_mov_b64 v[8:9], 0
v_mov_b64 v[10:11], 0
v_mov_b64 v[12:13], 0
v_mov_b64 v[14:15], 0
v_mov_b64 v[16:17], 0
v_mov_b64 v[18:19], 0
v_mov_b64 v[20:21], 0
v_mov_b64 v[22:23], 0
v_mov_b64 v[24:25], 0
v_mov_b64 v[26:27], 0
v_mov_b64 v[28:29], 0
v_mov_b64 v[30:31], 0
v_cmp_gt_u32 vcc, s34, v7
s_cmp_eq_u32 vcc_hi, 0
s_cbranch_scc1 kv_10083
s_mov_b32 s30, 0
kv_10082:
v_and_b32 v7, 128, v0
buffer_load_dword v7, v7, s[4:7], s22 offen sc1
s_add_u32 s30, s30, 1
s_cmp_gt_u32 s30, 262144
s_cbranch_scc1 L_fail
s_waitcnt vmcnt(0)
v_cmp_gt_u32 vcc, s34, v7
s_cbranch_vccnz kv_10082
kv_10083:
s_barrier
v_and_b32 v7, 511, v0
v_lshl_add_u32 v7, v7, 3, s27
global_load_dwordx4 v[32:35], v0, s[68:69] offset:-4096 sc1
global_load_dwordx4 v[36:39], v0, s[68:69] offset:0 sc1
global_load_dwordx4 v[40:43], v0, s[70:71] offset:0 sc1
s_mov_b32 s30, 0
s_waitcnt vmcnt(0)
.p2align 6
gather_10073:
s_waitcnt vmcnt(4)
rt_10078_b:
v_smfmac_f32_16x16x64_bf16 v[12:15], v[32:35], a[0:7], v1
ds_write_b128 v0, v[32:35] offset:0
v_smfmac_f32_16x16x64_bf16 v[20:23], v[32:35], a[8:15], v1
v_bitop3_b32 v44, v32, v34, s18 bitop3:0x7e
v_smfmac_f32_16x16x64_bf16 v[28:31], v[32:35], v[72:79], v1
s_waitcnt vmcnt(3)
ds_write_b128 v0, v[36:39] offset:4096
v_bitop3_b32 v45, v36, v38, s18 bitop3:0x7e
v_or_b32 v44, v44, v45
s_waitcnt vmcnt(2)
v_bitop3_b32 v45, v40, v42, s18 bitop3:0x7e
v_bitop3_b32 v44, v44, v45, s19 bitop3:0xa8
v_cmp_ne_u32 vcc, 0, v44
v_smfmac_f32_16x16x64_bf16 v[8:11], v[32:35], v[64:71], v1
s_cbranch_vccnz rt_10078
global_load_dwordx4 v[64:67], v0, s[78:79] offset:-4096 sc1
ds_write_b128 v0, v[40:43] offset:8192
v_smfmac_f32_16x16x64_bf16 v[16:19], v[32:35], v[56:63], v1
global_load_dwordx4 v[68:71], v0, s[78:79] offset:-3072 sc1
v_smfmac_f32_16x16x64_bf16 v[20:23], v[36:39], a[48:55], v1
s_waitcnt lgkmcnt(1)
ds_read_b128 v[60:63], v2 offset:1024
global_load_dwordx4 v[72:75], v0, s[78:79] offset:-2048 sc1
v_smfmac_f32_16x16x64_bf16 v[16:19], v[36:39], a[40:47], v1
ds_read_b128 v[56:59], v2 offset:0
s_waitcnt lgkmcnt(2)
v_smfmac_f32_16x16x64_bf16 v[24:27], v[32:35], a[16:23], v1
s_barrier
ds_read_b128 v[40:43], v0 offset:1024
v_smfmac_f32_16x16x64_bf16 v[12:15], v[36:39], a[32:39], v1
ds_read_b128 v[44:47], v0 offset:5120
s_waitcnt lgkmcnt(3)
v_smfmac_f32_16x16x64_bf16 v[8:11], v[36:39], a[24:31], v1
ds_read_b128 v[32:35], v0 offset:2048
s_waitcnt lgkmcnt(3)
v_smfmac_f32_16x16x64_bf16 v[28:31], v[36:39], v[56:63], v1
ds_read_b128 v[56:59], v2 offset:2048
v_smfmac_f32_16x16x64_bf16 v[24:27], v[36:39], a[56:63], v1
ds_read_b128 v[60:63], v2 offset:3072
s_waitcnt lgkmcnt(4)
v_smfmac_f32_16x16x64_bf16 v[8:11], v[40:43], a[64:71], v1
ds_read_b128 v[36:39], v0 offset:6144
s_waitcnt vmcnt(3)
v_smfmac_f32_16x16x64_bf16 v[12:15], v[40:43], v[48:55], v1
s_waitcnt lgkmcnt(4)
ds_read_b128 v[48:51], v2 offset:4096
v_smfmac_f32_16x16x64_bf16 v[8:11], v[44:47], a[72:79], v1
ds_read_b128 v[52:55], v2 offset:5120
s_waitcnt lgkmcnt(5)
v_smfmac_f32_16x16x64_bf16 v[12:15], v[44:47], a[80:87], v1
s_waitcnt lgkmcnt(4)
ds_read_b128 v[44:47], v0 offset:7168
s_waitcnt lgkmcnt(4)
v_smfmac_f32_16x16x64_bf16 v[12:15], v[32:35], a[88:95], v1
ds_read_b128 v[40:43], v0 offset:3072
s_waitcnt lgkmcnt(4)
v_smfmac_f32_16x16x64_bf16 v[8:11], v[32:35], v[56:63], v1
s_mov_b64 s[68:69], s[72:73]
ds_read_b128 v[56:59], v2 offset:6144
s_waitcnt lgkmcnt(4)
v_smfmac_f32_16x16x64_bf16 v[8:11], v[36:39], a[96:103], v1
ds_read_b128 v[32:35], v0 offset:8192
s_waitcnt vmcnt(2)
global_load_dwordx4 v[76:79], v0, s[78:79] offset:-1024 sc1
ds_read_b128 v[60:63], v2 offset:7168
s_waitcnt lgkmcnt(5)
v_smfmac_f32_16x16x64_bf16 v[12:15], v[36:39], v[48:55], v1
s_xor_b32 s18, s18, 1
s_waitcnt lgkmcnt(4)
ds_read_b128 v[52:55], v2 offset:9216
s_waitcnt lgkmcnt(4)
ds_read_b128 v[48:51], v2 offset:8192
v_smfmac_f32_16x16x64_bf16 v[8:11], v[40:43], a[104:111], v1
ds_read_b128 v[36:39], v0 offset:9216
s_waitcnt vmcnt(2)
v_smfmac_f32_16x16x64_bf16 v[8:11], v[44:47], v[64:71], v1
global_load_dwordx4 v[64:67], v0, s[78:79] offset:0 sc1
v_smfmac_f32_16x16x64_bf16 v[12:15], v[40:43], a[112:119], v1
s_waitcnt lgkmcnt(3)
ds_read_b128 v[40:43], v0 offset:1024
v_smfmac_f32_16x16x64_bf16 v[12:15], v[44:47], v[56:63], v1
s_mov_b64 vcc, s[42:43]
ds_read_b128 v[60:63], v2 offset:11264
ds_read_b128 v[56:59], v2 offset:10240
v_smfmac_f32_16x16x64_bf16 v[8:11], v[32:35], a[120:127], v1
s_waitcnt lgkmcnt(4)
global_load_dwordx4 v[68:71], v0, s[78:79] offset:1024 sc1
v_smfmac_f32_16x16x64_bf16 v[12:15], v[32:35], v[48:55], v1
s_waitcnt lgkmcnt(3)
ds_read_b128 v[32:35], v0 offset:5120
v_smfmac_f32_16x16x64_bf16 v[12:15], v[36:39], a[136:143], v1
s_nop 0
global_load_dwordx4 v[48:51], v0, s[58:59] offset:0 nt sc1
v_smfmac_f32_16x16x64_bf16 v[8:11], v[36:39], a[128:135], v1
s_waitcnt lgkmcnt(3)
ds_read_b128 v[36:39], v0 offset:2048
global_load_dwordx4 v[52:55], v0, s[58:59] offset:1024 nt sc1
v_smfmac_f32_16x16x64_bf16 v[20:23], v[40:43], a[152:159], v1
s_nop 0
v_add_f32 v13, v13, v15
v_smfmac_f32_16x16x64_bf16 v[16:19], v[40:43], a[144:151], v1
s_waitcnt lgkmcnt(1)
ds_read_b128 v[40:43], v0 offset:6144
v_add_f32 v9, v9, v11
v_smfmac_f32_16x16x64_bf16 v[20:23], v[32:35], v[56:63], v1
ds_read_b128 v[56:59], v2 offset:12288
ds_read_b128 v[60:63], v2 offset:13312
v_smfmac_f32_16x16x64_bf16 v[16:19], v[32:35], a[160:167], v1
s_waitcnt lgkmcnt(3)
v_add_f32 v8, v8, v10
v_smfmac_f32_16x16x64_bf16 v[20:23], v[36:39], a[176:183], v1
s_waitcnt vmcnt(5)
ds_read_b128 v[32:35], v0 offset:3072
v_mul_f32 v9, s35, v9
v_add_f32 v12, v12, v14
v_mul_f32 v13, s35, v13
v_mul_f32 v8, s35, v8
v_mul_f32 v12, s35, v12
v_cvt_pk_bf16_f32 v12, v12, v13
v_cvt_pk_bf16_f32 v8, v8, v9
v_smfmac_f32_16x16x64_bf16 v[16:19], v[36:39], a[168:175], v1
s_waitcnt lgkmcnt(2)
ds_read_b128 v[36:39], v0 offset:7168
ds_write2_b32 v3, v8, v12 offset0:0 offset1:128
s_waitcnt lgkmcnt(3)
v_smfmac_f32_16x16x64_bf16 v[16:19], v[40:43], v[56:63], v1
s_waitcnt vmcnt(4)
global_load_dwordx4 v[56:59], v0, s[58:59] offset:2048 nt sc1
v_smfmac_f32_16x16x64_bf16 v[20:23], v[40:43], v[72:79], v1
s_waitcnt lgkmcnt(2)
global_load_dwordx4 v[60:63], v0, s[58:59] offset:3072 nt sc1
ds_read_b128 v[40:43], v0 offset:8192
v_smfmac_f32_16x16x64_bf16 v[16:19], v[32:35], a[184:191], v1
global_load_dwordx4 v[72:75], v0, s[78:79] offset:2048 sc1
v_smfmac_f32_16x16x64_bf16 v[20:23], v[32:35], a[192:199], v1
s_waitcnt lgkmcnt(1)
ds_read_b128 v[32:35], v0 offset:9216
global_load_dwordx4 v[76:79], v0, s[78:79] offset:3072 sc1
v_smfmac_f32_16x16x64_bf16 v[16:19], v[36:39], a[200:207], v1
s_barrier
v_smfmac_f32_16x16x64_bf16 v[20:23], v[36:39], a[208:215], v1
s_waitcnt lgkmcnt(1)
ds_read_b64_tr_b16 v[8:9], v4 offset:0
ds_read_b64_tr_b16 v[10:11], v4 offset:512
v_smfmac_f32_16x16x64_bf16 v[16:19], v[40:43], a[216:223], v1
ds_read_b64_tr_b16 v[14:15], v4 offset:1536
s_waitcnt lgkmcnt(3)
ds_read_b64_tr_b16 v[12:13], v4 offset:1024
v_smfmac_f32_16x16x64_bf16 v[16:19], v[32:35], a[232:239], v1
s_add_u32 s20, s20, 524288
ds_read_b128 v[36:39], v0 offset:8192
v_smfmac_f32_16x16x64_bf16 v[20:23], v[40:43], a[224:231], v1
v_smfmac_f32_16x16x64_bf16 v[20:23], v[32:35], a[240:247], v1
s_waitcnt lgkmcnt(2)
ds_read_b128 v[40:43], v0 offset:9216
s_waitcnt vmcnt(5)
ds_read_b128 v[32:35], v0 offset:1024
v_mfma_f32_16x16x32_bf16 v[44:47], v[48:51], v[8:11], 0
s_waitcnt lgkmcnt(3)
ds_read_b128 v[8:11], v2 offset:14336
v_bfe_u32 v48, v0, 5, 1
v_add_f32 v16, v16, v18
v_add_f32 v17, v17, v19
s_waitcnt vmcnt(4)
v_mfma_f32_16x16x32_bf16 v[44:47], v[52:55], v[12:15], v[44:47]
s_waitcnt lgkmcnt(3)
ds_read_b128 v[12:15], v2 offset:15360
ds_read_b128 v[52:55], v2 offset:17408
v_lshl_add_u32 v48, v48, 3, v5
v_add_f32 v21, v21, v23
v_add_f32 v20, v20, v22
v_cvt_pk_bf16_f32 v16, v16, v17
s_nop 0
v_cndmask_b32_dpp v44, v46, v44, vcc quad_perm:[0,1,0,1] row_mask:0xf bank_mask:0xf
v_cndmask_b32_dpp v45, v47, v45, vcc quad_perm:[0,1,0,1] row_mask:0xf bank_mask:0xf
v_smfmac_f32_16x16x64_bf16 v[28:31], v[36:39], v[80:87], v1
ds_write_b64 v48, v[44:45] offset:6144
v_cvt_pk_bf16_f32 v20, v20, v21
v_smfmac_f32_16x16x64_bf16 v[24:27], v[36:39], a[248:255], v1
s_waitcnt lgkmcnt(2)
ds_read_b128 v[48:51], v2 offset:16384
global_load_dword v7, v7, s[4:5] sc1
ds_write2_b32 v3, v16, v20 offset0:1 offset1:129
v_smfmac_f32_16x16x64_bf16 v[24:27], v[40:43], v[8:15], v1
s_waitcnt lgkmcnt(3)
ds_read_b128 v[36:39], v0 offset:5120
s_mov_b64 s[70:71], s[74:75]
v_smfmac_f32_16x16x64_bf16 v[24:27], v[32:35], v[88:95], v1
s_waitcnt lgkmcnt(2)
v_smfmac_f32_16x16x64_bf16 v[28:31], v[40:43], v[48:55], v1
ds_read_b128 v[40:43], v0 offset:2048
v_smfmac_f32_16x16x64_bf16 v[28:31], v[32:35], v[96:103], v1
s_waitcnt lgkmcnt(2)
ds_read_b128 v[32:35], v0 offset:6144
s_barrier
ds_read_b64_tr_b16 v[12:13], v4 offset:1024
s_waitcnt lgkmcnt(3)
ds_read_b128 v[48:51], v6 offset:6144
v_smfmac_f32_16x16x64_bf16 v[28:31], v[36:39], v[104:111], v1
ds_read_b128 v[52:55], v6 offset:7168
s_waitcnt lgkmcnt(4)
ds_read_b64_tr_b16 v[10:11], v4 offset:512
v_smfmac_f32_16x16x64_bf16 v[24:27], v[36:39], v[64:71], v1
ds_read_b64_tr_b16 v[18:19], v4 offset:2560
s_add_u32 s17, s17, 1
ds_read_b64_tr_b16 v[8:9], v4 offset:0
v_smfmac_f32_16x16x64_bf16 v[24:27], v[40:43], v[112:119], v1
s_waitcnt lgkmcnt(6)
ds_read_b64_tr_b16 v[22:23], v4 offset:3584
s_mov_b32 s30, 0
ds_read_b64_tr_b16 v[16:17], v4 offset:2048
v_smfmac_f32_16x16x64_bf16 v[28:31], v[40:43], v[120:127], v1
s_waitcnt vmcnt(1)
ds_read_b64_tr_b16 v[14:15], v4 offset:1536
s_waitcnt lgkmcnt(8)
ds_read_b128 v[40:43], v0 offset:7168
v_smfmac_f32_16x16x64_bf16 v[24:27], v[32:35], v[128:135], v1
ds_read_b128 v[68:71], v2 offset:19456
s_waitcnt lgkmcnt(7)
ds_read_b128 v[36:39], v0 offset:3072
v_smfmac_f32_16x16x64_bf16 v[28:31], v[32:35], v[136:143], v1
s_waitcnt lgkmcnt(6)
ds_read_b64_tr_b16 v[20:21], v4 offset:3072
v_add_f32 v49, v49, v53
v_add_f32 v48, v48, v52
v_mfma_f32_16x16x32_bf16 v[44:47], v[8:11], v[8:11], 0
s_waitcnt lgkmcnt(4)
ds_read_b128 v[64:67], v2 offset:18432
v_add_f32 v50, v50, v54
v_mfma_f32_16x16x32_bf16 v[44:47], v[12:15], v[12:15], v[44:47]
s_add_u32 s21, s21, 10240
v_exp_f32 v50, v50
v_add_f32 v51, v51, v55
v_exp_f32 v48, v48
v_exp_f32 v49, v49
v_exp_f32 v51, v51
v_mfma_f32_16x16x32_bf16 v[44:47], v[16:19], v[16:19], v[44:47]
s_waitcnt lgkmcnt(1)
v_cvt_pk_bf16_f32 v55, v50, v51
v_cvt_pk_bf16_f32 v54, v48, v49
v_mfma_f32_16x16x32_bf16 v[44:47], v[20:23], v[20:23], v[44:47]
s_waitcnt lgkmcnt(0)
v_mov_b32_dpp v49, v55 quad_perm:[0,1,0,1] row_mask:0xf bank_mask:0xf
v_mov_b32_dpp v50, v54 quad_perm:[2,3,2,3] row_mask:0xf bank_mask:0xf
v_smfmac_f32_16x16x64_bf16 v[24:27], v[36:39], v[64:71], v1
ds_read_b128 v[64:67], v2 offset:20480
v_mov_b32_dpp v51, v55 quad_perm:[2,3,2,3] row_mask:0xf bank_mask:0xf
v_smfmac_f32_16x16x64_bf16 v[28:31], v[36:39], v[144:151], v1
ds_read_b128 v[68:71], v2 offset:21504
v_mov_b64 v[22:23], s[44:45]
v_smfmac_f32_16x16x64_bf16 v[24:27], v[40:43], v[72:79], v1
ds_read_b128 v[76:79], v2 offset:23552
v_mov_b32_dpp v48, v54 quad_perm:[0,1,0,1] row_mask:0xf bank_mask:0xf
v_smfmac_f32_16x16x64_bf16 v[28:31], v[40:43], v[152:159], v1
ds_read_b128 v[72:75], v2 offset:22528
v_mov_b64 v[20:21], s[44:45]
v_mfma_f32_16x16x32_bf16 v[12:15], v[60:63], v[48:51], 0
v_exp_f32_dpp v45, v47 quad_perm:[0,1,0,1] row_mask:0xf bank_mask:0xf
v_exp_f32_dpp v44, v46 quad_perm:[0,1,0,1] row_mask:0xf bank_mask:0xf
v_mfma_f32_16x16x32_bf16 v[16:19], v[20:23], v[48:51], 0
v_cvt_pk_bf16_f32 v52, v44, v45
v_mov_b64 v[54:55], s[46:47]
v_mfma_f32_16x16x32_bf16 v[8:11], v[56:59], v[48:51], 0
v_cvt_pk_bf16_f32 v53, v44, v45
v_cvt_pk_bf16_f32 v24, v24, v25
v_cvt_pk_bf16_f32 v25, v26, v27
v_mfma_f32_16x16x16_bf16 v[16:19], v[54:55], v[52:53], v[16:19]
s_waitcnt lgkmcnt(0)
v_cvt_pk_bf16_f32 v26, v28, v29
v_cvt_pk_bf16_f32 v27, v30, v31
v_mfma_f32_16x16x16_bf16 v[8:11], v[24:25], v[52:53], v[8:11]
ds_read_b128 v[28:31], v0 offset:19456
v_bfe_u32 v32, v0, 5, 1
v_mfma_f32_16x16x16_bf16 v[12:15], v[26:27], v[52:53], v[12:15]
s_nop 0
v_subrev_u32 v17, s37, v16
v_cmp_lt_u32 vcc, s38, v17
v_mov_b64 v[40:41], 0
v_lshl_add_u32 v32, v32, 3, v5
v_rcp_f32 v18, v16
v_mov_b64 v[36:37], 0
v_mov_b64 v[42:43], 0
v_cndmask_b32 v11, v15, v11, s[42:43]
v_mul_f32 v11, v11, v18
v_cndmask_b32 v10, v14, v10, s[42:43]
v_cndmask_b32 v8, v12, v8, s[42:43]
v_mul_f32 v8, v8, v18
v_cndmask_b32 v9, v13, v9, s[42:43]
v_mul_f32 v10, v10, v18
v_mul_f32 v9, v9, v18
v_cvt_pk_bf16_f32 v13, v10, v11
v_cvt_pk_bf16_f32 v12, v8, v9
s_cbranch_vccnz rare_10074
back_10075:
ds_write_b64 v32, v[12:13] offset:0
v_mov_b32_dpp v9, v13 quad_perm:[0,1,0,1] row_mask:0xf bank_mask:0xf
v_mov_b32_dpp v8, v12 quad_perm:[0,1,0,1] row_mask:0xf bank_mask:0xf
v_mov_b64 v[38:39], 0
v_mov_b64 v[32:33], 0
v_mov_b32_dpp v10, v12 quad_perm:[2,3,2,3] row_mask:0xf bank_mask:0xf
v_mov_b32_dpp v11, v13 quad_perm:[2,3,2,3] row_mask:0xf bank_mask:0xf
v_mov_b64 v[48:49], 0
v_mov_b64 v[50:51], 0
v_smfmac_f32_16x16x64_bf16 v[36:39], v[8:11], v[64:71], v1
s_add_u32 s34, s17, 2
ds_read_b128 v[24:27], v0 offset:18432
global_load_dwordx4 v[64:67], v0, s[76:77] offset:-4096 sc1
ds_read_b128 v[16:19], v0 offset:16384
v_mov_b64 v[34:35], 0
v_smfmac_f32_16x16x64_bf16 v[40:43], v[8:11], v[72:79], v1
s_waitcnt lgkmcnt(2)
ds_read_b128 v[20:23], v0 offset:17408
s_barrier
ds_read_b128 v[56:59], v5 offset:512
v_smfmac_f32_16x16x64_bf16 v[32:35], v[8:11], v[176:183], v1
global_load_dwordx4 v[68:71], v0, s[76:77] offset:-3072 sc1
s_waitcnt lgkmcnt(3)
ds_read_b128 v[60:63], v5 offset:1024
v_lshrrev_b32 v44, 8, v0
v_smfmac_f32_16x16x64_bf16 v[48:51], v[8:11], v[160:167], v1
ds_read_b128 v[12:15], v5 offset:1536
global_load_dwordx4 v[72:75], v0, s[76:77] offset:0 sc1
v_bfe_u32 v45, v0, 1, 7
v_mov_b64 v[54:55], 0
s_waitcnt lgkmcnt(2)
v_smfmac_f32_16x16x64_bf16 v[48:51], v[56:59], v[208:215], v1
s_min_u32 s34, s34, s32
global_load_dwordx4 v[76:79], v0, s[76:77] offset:1024 sc1
v_smfmac_f32_16x16x64_bf16 v[36:39], v[56:59], v[16:23], v1
s_waitcnt lgkmcnt(1)
ds_read_b128 v[16:19], v0 offset:20480
v_mov_b64 v[52:53], 0
v_smfmac_f32_16x16x64_bf16 v[36:39], v[60:63], v[24:31], v1
s_add_u32 s27, s20, 524288
ds_read_b128 v[20:23], v0 offset:21504
s_waitcnt lgkmcnt(2)
v_smfmac_f32_16x16x64_bf16 v[32:35], v[56:59], v[232:239], v1
ds_read_b128 v[28:31], v0 offset:23552
v_smfmac_f32_16x16x64_bf16 v[36:39], v[12:15], v[184:191], v1
v_lshl_or_b32 v44, v44, 12, v45
v_smfmac_f32_16x16x64_bf16 v[40:43], v[56:59], v[192:199], v1
s_mov_b32 s19, 1
ds_read_b128 v[24:27], v0 offset:22528
s_nop 0
v_smfmac_f32_16x16x64_bf16 v[40:43], v[60:63], v[200:207], v1
s_add_u32 s58, s4, s20
s_waitcnt lgkmcnt(2)
v_cvt_pk_bf16_f32 v36, v36, v37
v_smfmac_f32_16x16x64_bf16 v[40:43], v[12:15], v[16:23], v1
ds_read_b128 v[20:23], v0 offset:25600
v_and_or_b32 v36, v36, -2, s18
v_cvt_pk_bf16_f32 v37, v38, v39
v_smfmac_f32_16x16x64_bf16 v[32:35], v[60:63], v[240:247], v1
global_store_dwordx2 v44, v[36:37], s[48:49]
v_smfmac_f32_16x16x64_bf16 v[48:51], v[60:63], v[216:223], v1
s_waitcnt lgkmcnt(1)
ds_read_b128 v[16:19], v0 offset:24576
v_cvt_pk_bf16_f32 v40, v40, v41
v_smfmac_f32_16x16x64_bf16 v[48:51], v[12:15], v[24:31], v1
s_addc_u32 s59, s5, 0
ds_read_b128 v[24:27], v0 offset:26624
v_and_or_b32 v40, v40, -2, s18
v_cvt_pk_bf16_f32 v41, v42, v43
v_smfmac_f32_16x16x64_bf16 v[32:35], v[12:15], v[248:255], v1
global_store_dwordx2 v44, v[40:41], s[50:51]
ds_read_b128 v[28:31], v0 offset:27648
v_smfmac_f32_16x16x64_bf16 v[52:55], v[8:11], v[168:175], v1
v_cvt_pk_bf16_f32 v48, v48, v49
v_smfmac_f32_16x16x64_bf16 v[52:55], v[56:59], v[224:231], v1
s_waitcnt lgkmcnt(2)
v_and_or_b32 v48, v48, -2, s18
v_cvt_pk_bf16_f32 v49, v50, v51
v_smfmac_f32_16x16x64_bf16 v[52:55], v[60:63], v[16:23], v1
s_waitcnt lgkmcnt(1)
global_store_dwordx2 v44, v[48:49], s[52:53]
s_waitcnt lgkmcnt(0)
v_smfmac_f32_16x16x64_bf16 v[52:55], v[12:15], v[24:31], v1
s_nop 1
v_cvt_pk_bf16_f32 v32, v32, v33
v_and_or_b32 v32, v32, -2, s18
v_cvt_pk_bf16_f32 v33, v34, v35
s_nop 2
v_cvt_pk_bf16_f32 v52, v52, v53
v_and_or_b32 v52, v52, -2, s18
v_cvt_pk_bf16_f32 v53, v54, v55
global_store_dwordx2 v44, v[52:53], s[54:55]
global_store_dwordx2 v44, v[32:33], s[56:57]
v_bfe_u32 v32, v0, 6, 1
v_lshlrev_b32 v32, 4, v32
v_mov_b32 v33, 0x3f80
v_lshlrev_b32 v32, v32, v33
v_bfe_i32 v33, v0, 4, 1
v_and_b32 v45, v32, v33
v_and_b32 v47, v32, v33
v_xor_b32 v44, v32, v45
v_xor_b32 v46, v32, v45
v_and_b32 v36, 32, v0
v_bfe_u32 v37, v0, 6, 1
v_lshl_add_u32 v36, v37, 8, v36
v_bfe_u32 v37, v0, 8, 1
v_lshl_add_u32 v36, v37, 4, v36
v_bfe_u32 v37, v0, 4, 1
v_lshl_add_u32 v36, v37, 3, v36
s_waitcnt vmcnt(9)
v_and_b32 v7, 511, v0
v_lshl_add_u32 v7, v7, 3, s27
s_nop 15
s_nop 15
s_nop 15
s_nop 8
global_load_dwordx4 v[8:11], v0, s[64:65] offset:0 sc1
global_load_dwordx4 v[12:15], v0, s[64:65] offset:1024 sc1
global_load_dwordx4 v[16:19], v0, s[64:65] offset:2048 sc1
global_load_dwordx4 v[20:23], v0, s[64:65] offset:3072 sc1
chk_10086:
v_mov_b64 v[40:41], 0
v_mov_b64 v[42:43], 0
s_waitcnt vmcnt(2)
s_nop 0
v_smfmac_f32_16x16x64_bf16 v[40:43], v[44:47], v[8:15], v1
v_bitop3_b32 v32, v8, v10, s18 bitop3:0x7e
v_bitop3_b32 v33, v12, v14, s18 bitop3:0x7e
s_waitcnt vmcnt(0)
v_smfmac_f32_16x16x64_bf16 v[40:43], v[44:47], v[16:23], v1
v_bitop3_b32 v34, v16, v18, s18 bitop3:0x7e
v_bitop3_b32 v35, v20, v22, s18 bitop3:0x7e
v_or3_b32 v37, v32, v33, v34
v_bitop3_b32 v37, v37, v35, 1 bitop3:0xa8
v_cmp_ne_u32 vcc, 0, v37
s_cbranch_vccnz chk_10086_f
s_nop 1
v_add_f32_dpp v40, v40, v40 row_ror:8 row_mask:0xf bank_mask:0xf
v_add_f32_dpp v41, v41, v41 row_ror:8 row_mask:0xf bank_mask:0xf
v_add_f32_dpp v42, v42, v42 row_ror:8 row_mask:0xf bank_mask:0xf
v_add_f32_dpp v43, v43, v43 row_ror:8 row_mask:0xf bank_mask:0xf
v_cvt_pk_bf16_f32 v40, v40, v41
v_cvt_pk_bf16_f32 v41, v42, v43
v_and_or_b32 v40, v40, -2, s18
s_mov_b64 exec, 0x00ff00ff
global_store_dwordx2 v36, v[40:41], s[66:67]
s_mov_b64 exec, -1
s_branch join_10085
chk_10086_f:
global_load_dwordx4 v[8:11], v0, s[64:65] offset:0 sc1
global_load_dwordx4 v[12:15], v0, s[64:65] offset:1024 sc1
global_load_dwordx4 v[16:19], v0, s[64:65] offset:2048 sc1
global_load_dwordx4 v[20:23], v0, s[64:65] offset:3072 sc1
s_add_u32 s30, s30, 1
s_cmp_le_u32 s30, 262144
s_cbranch_scc1 chk_10086
s_branch L_fail
nored_10084:
join_10085:
s_nop 11
s_barrier
global_load_dwordx4 v[56:59], v0, s[76:77] offset:-2048 sc1
global_load_dwordx4 v[60:63], v0, s[76:77] offset:-1024 sc1
s_nop 15
s_nop 15
s_nop 15
s_barrier
global_load_dwordx4 v[32:35], v0, s[68:69] offset:-4096 sc1
s_nop 10
global_load_dwordx4 v[36:39], v0, s[68:69] offset:0 sc1
s_nop 10
global_load_dwordx4 v[40:43], v0, s[70:71] offset:0 sc1
s_barrier
global_load_dwordx4 v[48:51], v0, s[76:77] offset:2048 sc1
global_load_dwordx4 v[52:55], v0, s[76:77] offset:3072 sc1
v_mov_b64 v[8:9], 0
v_mov_b64 v[10:11], 0
v_mov_b64 v[12:13], 0
v_mov_b64 v[14:15], 0
v_mov_b64 v[16:17], 0
v_mov_b64 v[18:19], 0
v_mov_b64 v[20:21], 0
v_mov_b64 v[22:23], 0
v_mov_b64 v[24:25], 0
v_mov_b64 v[26:27], 0
v_mov_b64 v[28:29], 0
v_mov_b64 v[30:31], 0
s_mov_b32 s30, 0
s_cmp_eq_u32 s17, s31
s_cbranch_scc0 gather_10073
s_branch exit_10076
rt_10078:
global_load_dwordx4 v[32:35], v0, s[68:69] offset:-4096 sc1
global_load_dwordx4 v[36:39], v0, s[68:69] offset:0 sc1
global_load_dwordx4 v[40:43], v0, s[70:71] offset:0 sc1
s_add_u32 s30, s30, 1
s_cmp_gt_u32 s30, 262144
s_cbranch_scc1 L_fail
s_mov_b64 exec, 1
global_store_dword v0, v0, s[62:63]
global_store_dword v0, v0, s[62:63]
s_mov_b64 exec, -1
v_mov_b64 v[8:9], 0
v_mov_b64 v[10:11], 0
v_mov_b64 v[12:13], 0
v_mov_b64 v[14:15], 0
v_mov_b64 v[16:17], 0
v_mov_b64 v[18:19], 0
v_mov_b64 v[20:21], 0
v_mov_b64 v[22:23], 0
v_mov_b64 v[24:25], 0
v_mov_b64 v[26:27], 0
v_mov_b64 v[28:29], 0
v_mov_b64 v[30:31], 0
s_branch gather_10073
rare_10074:
ds_read_b128 v[48:51], v6 offset:6144
ds_read_b128 v[52:55], v6 offset:7168
s_waitcnt lgkmcnt(0)
v_add_f32 v48, v48, v52
v_add_f32 v49, v49, v53
v_add_f32 v50, v50, v54
v_add_f32 v51, v51, v55
v_mov_b32_dpp v46, v46 quad_perm:[0,1,0,1] row_mask:0xf bank_mask:0xf
v_mov_b32_dpp v47, v47 quad_perm:[0,1,0,1] row_mask:0xf bank_mask:0xf
v_max3_f32 v19, v48, v49, v50
v_max3_f32 v19, v19, v51, v46
v_max_f32 v19, v19, v47
s_nop 1
v_max_f32_dpp v19, v19, v19 quad_perm:[2,3,0,1] row_mask:0xf bank_mask:0xf
v_mov_b32 v44, v19
s_nop 1
v_permlane32_swap_b32 v19, v44
v_max_f32 v19, v19, v44
v_mov_b32 v44, v19
s_nop 1
v_permlane16_swap_b32 v19, v44
v_max_f32 v19, v19, v44
v_sub_f32 v48, v48, v19
v_sub_f32 v49, v49, v19
v_sub_f32 v50, v50, v19
v_sub_f32 v51, v51, v19
v_sub_f32 v46, v46, v19
v_sub_f32 v47, v47, v19
v_exp_f32 v48, v48
v_exp_f32 v49, v49
v_exp_f32 v50, v50
v_exp_f32 v51, v51
v_cvt_pk_bf16_f32 v54, v48, v49
v_cvt_pk_bf16_f32 v55, v50, v51
s_nop 0
v_mov_b32_dpp v48, v54 quad_perm:[0,1,0,1] row_mask:0xf bank_mask:0xf
v_mov_b32_dpp v49, v55 quad_perm:[0,1,0,1] row_mask:0xf bank_mask:0xf
v_mov_b32_dpp v50, v54 quad_perm:[2,3,2,3] row_mask:0xf bank_mask:0xf
v_mov_b32_dpp v51, v55 quad_perm:[2,3,2,3] row_mask:0xf bank_mask:0xf
v_mov_b64 v[20:21], s[44:45]
v_mov_b64 v[22:23], s[44:45]
v_mfma_f32_16x16x32_bf16 v[8:11], v[56:59], v[48:51], 0
v_mfma_f32_16x16x32_bf16 v[12:15], v[60:63], v[48:51], 0
v_mfma_f32_16x16x32_bf16 v[16:19], v[20:23], v[48:51], 0
v_mov_b64 v[54:55], s[46:47]
v_exp_f32_dpp v44, v46 quad_perm:[0,1,0,1] row_mask:0xf bank_mask:0xf
v_exp_f32_dpp v45, v47 quad_perm:[0,1,0,1] row_mask:0xf bank_mask:0xf
s_nop 0
v_cvt_pk_bf16_f32 v52, v44, v45
v_cvt_pk_bf16_f32 v53, v44, v45
s_nop 1
v_mfma_f32_16x16x16_bf16 v[16:19], v[54:55], v[52:53], v[16:19]
v_mfma_f32_16x16x16_bf16 v[8:11], v[24:25], v[52:53], v[8:11]
v_mfma_f32_16x16x16_bf16 v[12:15], v[26:27], v[52:53], v[12:15]
s_nop 5
v_rcp_f32 v18, v16
s_nop 0
v_cndmask_b32 v8, v12, v8, s[42:43]
v_mul_f32 v8, v8, v18
v_cndmask_b32 v9, v13, v9, s[42:43]
v_mul_f32 v9, v9, v18
v_cndmask_b32 v10, v14, v10, s[42:43]
v_mul_f32 v10, v10, v18
v_cndmask_b32 v11, v15, v11, s[42:43]
v_mul_f32 v11, v11, v18
v_cvt_pk_bf16_f32 v12, v8, v9
v_cvt_pk_bf16_f32 v13, v10, v11
s_branch back_10075
exit_10076:
global_load_dwordx4 v[32:35], v0, s[68:69] offset:-4096 sc1
global_load_dwordx4 v[36:39], v0, s[68:69] offset:0 sc1
global_load_dwordx4 v[40:43], v0, s[70:71] offset:0 sc1
s_add_u32 s30, s30, 1
s_cmp_gt_u32 s30, 262144
s_cbranch_scc1 L_fail
s_waitcnt vmcnt(2)
v_bitop3_b32 v44, v32, v34, s18 bitop3:0x7e
s_waitcnt vmcnt(1)
v_bitop3_b32 v45, v36, v38, s18 bitop3:0x7e
v_or_b32 v44, v44, v45
s_waitcnt vmcnt(0)
v_bitop3_b32 v46, v40, v42, s18 bitop3:0x7e
v_bitop3_b32 v44, v44, v46, s19 bitop3:0xa8
v_cmp_ne_u32 vcc, 0, v44
s_cbranch_vccnz exit_10076
ds_write_b128 v0, v[32:35] offset:0
ds_write_b128 v0, v[36:39] offset:4096
ds_write_b128 v0, v[40:43] offset:8192
s_waitcnt lgkmcnt(0)
s_barrier
s_barrier
s_add_u32 s36, s36, 1
s_cmp_lt_u32 s36, 2
s_cbranch_scc1 layer_10072
s_endpgm
wave_10069:
layer_10087:
s_lshl_b32 s17, s36, 6
s_mul_i32 s27, s36, 35651584
s_mul_i32 s28, s14, 16384
s_add_u32 s27, s27, s28
s_add_u32 s20, s27, 16781312
s_mul_i32 s27, s17, 10240
s_add_u32 s27, s27, s24
s_add_u32 s21, s27, s25
s_mov_b32 s19, 0
s_mov_b32 s33, s6
s_add_u32 s34, s17, 1
s_add_u32 s31, s17, 63
s_add_u32 s32, s17, 64
s_mov_b32 s27, s20
v_mov_b32 v7, 0
s_add_u32 s68, s4, 414720
s_addc_u32 s69, s5, 0
s_add_u32 s72, s4, 398336
s_addc_u32 s73, s5, 0
s_add_u32 s70, s4, 418816
s_addc_u32 s71, s5, 0
s_add_u32 s74, s4, 402432
s_addc_u32 s75, s5, 0
s_add_u32 s58, s4, s20
s_addc_u32 s59, s5, 0
global_load_dwordx4 v[64:67], v0, s[76:77] offset:-4096 sc1
global_load_dwordx4 v[68:71], v0, s[76:77] offset:-3072 sc1
global_load_dwordx4 v[72:75], v0, s[76:77] offset:0 sc1
global_load_dwordx4 v[76:79], v0, s[76:77] offset:1024 sc1
global_load_dwordx4 v[48:51], v0, s[76:77] offset:2048 sc1
global_load_dwordx4 v[52:55], v0, s[76:77] offset:3072 sc1
global_load_dwordx4 v[56:59], v0, s[76:77] offset:-2048 sc1
global_load_dwordx4 v[60:63], v0, s[76:77] offset:-1024 sc1
v_mov_b64 v[8:9], 0
v_mov_b64 v[10:11], 0
v_mov_b64 v[12:13], 0
v_mov_b64 v[14:15], 0
v_mov_b64 v[16:17], 0
v_mov_b64 v[18:19], 0
v_mov_b64 v[20:21], 0
v_mov_b64 v[22:23], 0
v_mov_b64 v[24:25], 0
v_mov_b64 v[26:27], 0
v_mov_b64 v[28:29], 0
v_mov_b64 v[30:31], 0
s_barrier
v_and_b32 v7, 511, v0
v_lshl_add_u32 v7, v7, 3, s27
global_load_dwordx4 v[32:35], v0, s[68:69] offset:-4096 sc1
global_load_dwordx4 v[36:39], v0, s[68:69] offset:0 sc1
global_load_dwordx4 v[40:43], v0, s[70:71] offset:0 sc1
s_mov_b32 s30, 0
s_waitcnt vmcnt(0)
.p2align 6
gather_10088:
s_waitcnt vmcnt(4)
rt_10093_b:
v_smfmac_f32_16x16x64_bf16 v[12:15], v[32:35], a[0:7], v1
ds_write_b128 v0, v[32:35] offset:1024
v_smfmac_f32_16x16x64_bf16 v[20:23], v[32:35], a[8:15], v1
v_bitop3_b32 v44, v32, v34, s18 bitop3:0x7e
v_smfmac_f32_16x16x64_bf16 v[28:31], v[32:35], v[72:79], v1
s_waitcnt vmcnt(3)
ds_write_b128 v0, v[36:39] offset:5120
v_bitop3_b32 v45, v36, v38, s18 bitop3:0x7e
v_or_b32 v44, v44, v45
s_waitcnt vmcnt(2)
v_bitop3_b32 v45, v40, v42, s18 bitop3:0x7e
v_bitop3_b32 v44, v44, v45, s19 bitop3:0xa8
v_cmp_ne_u32 vcc, 0, v44
v_smfmac_f32_16x16x64_bf16 v[8:11], v[32:35], v[64:71], v1
s_cbranch_vccnz rt_10093
global_load_dwordx4 v[64:67], v0, s[78:79] offset:-4096 sc1
ds_write_b128 v0, v[40:43] offset:9216
v_smfmac_f32_16x16x64_bf16 v[16:19], v[32:35], v[56:63], v1
global_load_dwordx4 v[68:71], v0, s[78:79] offset:-3072 sc1
v_smfmac_f32_16x16x64_bf16 v[20:23], v[36:39], a[48:55], v1
s_waitcnt lgkmcnt(1)
ds_read_b128 v[60:63], v2 offset:1024
global_load_dwordx4 v[72:75], v0, s[78:79] offset:-2048 sc1
v_smfmac_f32_16x16x64_bf16 v[16:19], v[36:39], a[40:47], v1
ds_read_b128 v[56:59], v2 offset:0
s_waitcnt lgkmcnt(2)
v_smfmac_f32_16x16x64_bf16 v[24:27], v[32:35], a[16:23], v1
s_barrier
ds_read_b128 v[40:43], v0 offset:0
v_smfmac_f32_16x16x64_bf16 v[12:15], v[36:39], a[32:39], v1
ds_read_b128 v[44:47], v0 offset:4096
s_waitcnt lgkmcnt(3)
v_smfmac_f32_16x16x64_bf16 v[8:11], v[36:39], a[24:31], v1
ds_read_b128 v[32:35], v0 offset:3072
s_waitcnt lgkmcnt(3)
v_smfmac_f32_16x16x64_bf16 v[28:31], v[36:39], v[56:63], v1
ds_read_b128 v[56:59], v2 offset:2048
v_smfmac_f32_16x16x64_bf16 v[24:27], v[36:39], a[56:63], v1
ds_read_b128 v[60:63], v2 offset:3072
s_waitcnt lgkmcnt(4)
v_smfmac_f32_16x16x64_bf16 v[8:11], v[40:43], a[64:71], v1
ds_read_b128 v[36:39], v0 offset:7168
s_waitcnt vmcnt(3)
v_smfmac_f32_16x16x64_bf16 v[12:15], v[40:43], v[48:55], v1
s_waitcnt lgkmcnt(4)
ds_read_b128 v[48:51], v2 offset:4096
v_smfmac_f32_16x16x64_bf16 v[8:11], v[44:47], a[72:79], v1
ds_read_b128 v[52:55], v2 offset:5120
s_waitcnt lgkmcnt(5)
v_smfmac_f32_16x16x64_bf16 v[12:15], v[44:47], a[80:87], v1
s_waitcnt lgkmcnt(4)
ds_read_b128 v[44:47], v0 offset:6144
s_waitcnt lgkmcnt(4)
v_smfmac_f32_16x16x64_bf16 v[12:15], v[32:35], a[88:95], v1
ds_read_b128 v[40:43], v0 offset:2048
s_waitcnt lgkmcnt(4)
v_smfmac_f32_16x16x64_bf16 v[8:11], v[32:35], v[56:63], v1
s_mov_b64 s[68:69], s[72:73]
ds_read_b128 v[56:59], v2 offset:6144
s_waitcnt lgkmcnt(4)
v_smfmac_f32_16x16x64_bf16 v[8:11], v[36:39], a[96:103], v1
ds_read_b128 v[32:35], v0 offset:9216
s_waitcnt vmcnt(2)
global_load_dwordx4 v[76:79], v0, s[78:79] offset:-1024 sc1
ds_read_b128 v[60:63], v2 offset:7168
s_waitcnt lgkmcnt(5)
v_smfmac_f32_16x16x64_bf16 v[12:15], v[36:39], v[48:55], v1
s_xor_b32 s18, s18, 1
s_waitcnt lgkmcnt(4)
ds_read_b128 v[52:55], v2 offset:9216
s_waitcnt lgkmcnt(4)
ds_read_b128 v[48:51], v2 offset:8192
v_smfmac_f32_16x16x64_bf16 v[8:11], v[40:43], a[104:111], v1
ds_read_b128 v[36:39], v0 offset:8192
s_waitcnt vmcnt(2)
v_smfmac_f32_16x16x64_bf16 v[8:11], v[44:47], v[64:71], v1
global_load_dwordx4 v[64:67], v0, s[78:79] offset:0 sc1
v_smfmac_f32_16x16x64_bf16 v[12:15], v[40:43], a[112:119], v1
s_waitcnt lgkmcnt(3)
ds_read_b128 v[40:43], v0 offset:0
v_smfmac_f32_16x16x64_bf16 v[12:15], v[44:47], v[56:63], v1
s_mov_b64 vcc, s[42:43]
ds_read_b128 v[60:63], v2 offset:11264
ds_read_b128 v[56:59], v2 offset:10240
v_smfmac_f32_16x16x64_bf16 v[8:11], v[32:35], a[120:127], v1
s_waitcnt lgkmcnt(4)
global_load_dwordx4 v[68:71], v0, s[78:79] offset:1024 sc1
v_smfmac_f32_16x16x64_bf16 v[12:15], v[32:35], v[48:55], v1
s_waitcnt lgkmcnt(3)
ds_read_b128 v[32:35], v0 offset:4096
v_smfmac_f32_16x16x64_bf16 v[12:15], v[36:39], a[136:143], v1
s_nop 0
global_load_dwordx4 v[48:51], v0, s[58:59] offset:0 nt sc1
v_smfmac_f32_16x16x64_bf16 v[8:11], v[36:39], a[128:135], v1
s_waitcnt lgkmcnt(3)
ds_read_b128 v[36:39], v0 offset:3072
global_load_dwordx4 v[52:55], v0, s[58:59] offset:1024 nt sc1
v_smfmac_f32_16x16x64_bf16 v[20:23], v[40:43], a[152:159], v1
s_nop 0
v_add_f32 v13, v13, v15
v_smfmac_f32_16x16x64_bf16 v[16:19], v[40:43], a[144:151], v1
s_waitcnt lgkmcnt(1)
ds_read_b128 v[40:43], v0 offset:7168
v_add_f32 v9, v9, v11
v_smfmac_f32_16x16x64_bf16 v[20:23], v[32:35], v[56:63], v1
ds_read_b128 v[56:59], v2 offset:12288
ds_read_b128 v[60:63], v2 offset:13312
v_smfmac_f32_16x16x64_bf16 v[16:19], v[32:35], a[160:167], v1
s_waitcnt lgkmcnt(3)
v_add_f32 v8, v8, v10
v_smfmac_f32_16x16x64_bf16 v[20:23], v[36:39], a[176:183], v1
s_waitcnt vmcnt(5)
ds_read_b128 v[32:35], v0 offset:2048
v_mul_f32 v9, s35, v9
v_add_f32 v12, v12, v14
v_mul_f32 v13, s35, v13
v_mul_f32 v8, s35, v8
v_mul_f32 v12, s35, v12
v_cvt_pk_bf16_f32 v12, v12, v13
v_cvt_pk_bf16_f32 v8, v8, v9
v_smfmac_f32_16x16x64_bf16 v[16:19], v[36:39], a[168:175], v1
s_waitcnt lgkmcnt(2)
ds_read_b128 v[36:39], v0 offset:6144
ds_write2_b32 v3, v8, v12 offset0:0 offset1:128
s_waitcnt lgkmcnt(3)
v_smfmac_f32_16x16x64_bf16 v[16:19], v[40:43], v[56:63], v1
s_waitcnt vmcnt(4)
global_load_dwordx4 v[56:59], v0, s[58:59] offset:2048 nt sc1
v_smfmac_f32_16x16x64_bf16 v[20:23], v[40:43], v[72:79], v1
s_waitcnt lgkmcnt(2)
global_load_dwordx4 v[60:63], v0, s[58:59] offset:3072 nt sc1
ds_read_b128 v[40:43], v0 offset:9216
v_smfmac_f32_16x16x64_bf16 v[16:19], v[32:35], a[184:191], v1
global_load_dwordx4 v[72:75], v0, s[78:79] offset:2048 sc1
v_smfmac_f32_16x16x64_bf16 v[20:23], v[32:35], a[192:199], v1
s_waitcnt lgkmcnt(1)
ds_read_b128 v[32:35], v0 offset:8192
global_load_dwordx4 v[76:79], v0, s[78:79] offset:3072 sc1
v_smfmac_f32_16x16x64_bf16 v[16:19], v[36:39], a[200:207], v1
s_barrier
v_smfmac_f32_16x16x64_bf16 v[20:23], v[36:39], a[208:215], v1
s_waitcnt lgkmcnt(1)
ds_read_b64_tr_b16 v[8:9], v4 offset:0
ds_read_b64_tr_b16 v[10:11], v4 offset:512
v_smfmac_f32_16x16x64_bf16 v[16:19], v[40:43], a[216:223], v1
ds_read_b64_tr_b16 v[14:15], v4 offset:1536
s_waitcnt lgkmcnt(3)
ds_read_b64_tr_b16 v[12:13], v4 offset:1024
v_smfmac_f32_16x16x64_bf16 v[16:19], v[32:35], a[232:239], v1
s_add_u32 s20, s20, 524288
ds_read_b128 v[36:39], v0 offset:9216
v_smfmac_f32_16x16x64_bf16 v[20:23], v[40:43], a[224:231], v1
v_smfmac_f32_16x16x64_bf16 v[20:23], v[32:35], a[240:247], v1
s_waitcnt lgkmcnt(2)
ds_read_b128 v[40:43], v0 offset:8192
s_waitcnt vmcnt(5)
ds_read_b128 v[32:35], v0 offset:0
v_mfma_f32_16x16x32_bf16 v[44:47], v[48:51], v[8:11], 0
s_waitcnt lgkmcnt(3)
ds_read_b128 v[8:11], v2 offset:14336
v_bfe_u32 v48, v0, 5, 1
v_add_f32 v16, v16, v18
v_add_f32 v17, v17, v19
s_waitcnt vmcnt(4)
v_mfma_f32_16x16x32_bf16 v[44:47], v[52:55], v[12:15], v[44:47]
s_waitcnt lgkmcnt(3)
ds_read_b128 v[12:15], v2 offset:15360
ds_read_b128 v[52:55], v2 offset:17408
v_lshl_add_u32 v48, v48, 3, v5
v_add_f32 v21, v21, v23
v_add_f32 v20, v20, v22
v_cvt_pk_bf16_f32 v16, v16, v17
v_xor_b32 v48, 128, v48
v_cndmask_b32_dpp v44, v46, v44, vcc quad_perm:[0,1,0,1] row_mask:0xf bank_mask:0xf
v_cndmask_b32_dpp v45, v47, v45, vcc quad_perm:[0,1,0,1] row_mask:0xf bank_mask:0xf
v_smfmac_f32_16x16x64_bf16 v[28:31], v[36:39], v[80:87], v1
ds_write_b64 v48, v[44:45] offset:6656
v_cvt_pk_bf16_f32 v20, v20, v21
v_smfmac_f32_16x16x64_bf16 v[24:27], v[36:39], a[248:255], v1
s_waitcnt lgkmcnt(2)
ds_read_b128 v[48:51], v2 offset:16384
global_load_dword v7, v7, s[4:5] sc1
ds_write2_b32 v3, v16, v20 offset0:1 offset1:129
v_smfmac_f32_16x16x64_bf16 v[24:27], v[40:43], v[8:15], v1
s_waitcnt lgkmcnt(3)
ds_read_b128 v[36:39], v0 offset:4096
s_mov_b64 s[70:71], s[74:75]
v_smfmac_f32_16x16x64_bf16 v[24:27], v[32:35], v[88:95], v1
s_waitcnt lgkmcnt(2)
v_smfmac_f32_16x16x64_bf16 v[28:31], v[40:43], v[48:55], v1
ds_read_b128 v[40:43], v0 offset:3072
v_smfmac_f32_16x16x64_bf16 v[28:31], v[32:35], v[96:103], v1
s_waitcnt lgkmcnt(2)
ds_read_b128 v[32:35], v0 offset:7168
s_barrier
ds_read_b64_tr_b16 v[12:13], v4 offset:1024
s_waitcnt lgkmcnt(3)
ds_read_b128 v[48:51], v6 offset:6144
v_smfmac_f32_16x16x64_bf16 v[28:31], v[36:39], v[104:111], v1
ds_read_b128 v[52:55], v6 offset:7168
s_waitcnt lgkmcnt(4)
ds_read_b64_tr_b16 v[10:11], v4 offset:512
v_smfmac_f32_16x16x64_bf16 v[24:27], v[36:39], v[64:71], v1
ds_read_b64_tr_b16 v[18:19], v4 offset:2560
s_add_u32 s17, s17, 1
ds_read_b64_tr_b16 v[8:9], v4 offset:0
v_smfmac_f32_16x16x64_bf16 v[24:27], v[40:43], v[112:119], v1
s_waitcnt lgkmcnt(6)
ds_read_b64_tr_b16 v[22:23], v4 offset:3584
s_mov_b32 s30, 0
ds_read_b64_tr_b16 v[16:17], v4 offset:2048
v_smfmac_f32_16x16x64_bf16 v[28:31], v[40:43], v[120:127], v1
s_waitcnt vmcnt(1)
ds_read_b64_tr_b16 v[14:15], v4 offset:1536
s_waitcnt lgkmcnt(8)
ds_read_b128 v[40:43], v0 offset:6144
v_smfmac_f32_16x16x64_bf16 v[24:27], v[32:35], v[128:135], v1
ds_read_b128 v[68:71], v2 offset:19456
s_waitcnt lgkmcnt(7)
ds_read_b128 v[36:39], v0 offset:2048
v_smfmac_f32_16x16x64_bf16 v[28:31], v[32:35], v[136:143], v1
s_waitcnt lgkmcnt(6)
ds_read_b64_tr_b16 v[20:21], v4 offset:3072
v_add_f32 v49, v49, v53
v_add_f32 v48, v48, v52
v_mfma_f32_16x16x32_bf16 v[44:47], v[8:11], v[8:11], 0
s_waitcnt lgkmcnt(4)
ds_read_b128 v[64:67], v2 offset:18432
v_add_f32 v50, v50, v54
v_mfma_f32_16x16x32_bf16 v[44:47], v[12:15], v[12:15], v[44:47]
s_add_u32 s21, s21, 10240
v_exp_f32 v50, v50
v_add_f32 v51, v51, v55
v_exp_f32 v48, v48
v_exp_f32 v49, v49
v_exp_f32 v51, v51
v_mfma_f32_16x16x32_bf16 v[44:47], v[16:19], v[16:19], v[44:47]
s_waitcnt lgkmcnt(1)
v_cvt_pk_bf16_f32 v55, v50, v51
v_cvt_pk_bf16_f32 v54, v48, v49
v_mfma_f32_16x16x32_bf16 v[44:47], v[20:23], v[20:23], v[44:47]
s_waitcnt lgkmcnt(0)
v_mov_b32_dpp v49, v55 quad_perm:[0,1,0,1] row_mask:0xf bank_mask:0xf
v_mov_b32_dpp v50, v54 quad_perm:[2,3,2,3] row_mask:0xf bank_mask:0xf
v_smfmac_f32_16x16x64_bf16 v[24:27], v[36:39], v[64:71], v1
ds_read_b128 v[64:67], v2 offset:20480
v_mov_b32_dpp v51, v55 quad_perm:[2,3,2,3] row_mask:0xf bank_mask:0xf
v_smfmac_f32_16x16x64_bf16 v[28:31], v[36:39], v[144:151], v1
ds_read_b128 v[68:71], v2 offset:21504
v_mov_b64 v[22:23], s[44:45]
v_smfmac_f32_16x16x64_bf16 v[24:27], v[40:43], v[72:79], v1
ds_read_b128 v[76:79], v2 offset:23552
v_mov_b32_dpp v48, v54 quad_perm:[0,1,0,1] row_mask:0xf bank_mask:0xf
v_smfmac_f32_16x16x64_bf16 v[28:31], v[40:43], v[152:159], v1
ds_read_b128 v[72:75], v2 offset:22528
v_mov_b64 v[20:21], s[44:45]
v_mfma_f32_16x16x32_bf16 v[12:15], v[60:63], v[48:51], 0
v_exp_f32_dpp v45, v47 quad_perm:[0,1,0,1] row_mask:0xf bank_mask:0xf
v_exp_f32_dpp v44, v46 quad_perm:[0,1,0,1] row_mask:0xf bank_mask:0xf
v_mfma_f32_16x16x32_bf16 v[16:19], v[20:23], v[48:51], 0
v_cvt_pk_bf16_f32 v52, v44, v45
v_mov_b64 v[54:55], s[46:47]
v_mfma_f32_16x16x32_bf16 v[8:11], v[56:59], v[48:51], 0
v_cvt_pk_bf16_f32 v53, v44, v45
v_cvt_pk_bf16_f32 v24, v24, v25
v_cvt_pk_bf16_f32 v25, v26, v27
v_mfma_f32_16x16x16_bf16 v[16:19], v[54:55], v[52:53], v[16:19]
s_waitcnt lgkmcnt(0)
v_cvt_pk_bf16_f32 v26, v28, v29
v_cvt_pk_bf16_f32 v27, v30, v31
v_mfma_f32_16x16x16_bf16 v[8:11], v[24:25], v[52:53], v[8:11]
ds_read_b128 v[28:31], v0 offset:31744
v_bfe_u32 v32, v0, 5, 1
v_mfma_f32_16x16x16_bf16 v[12:15], v[26:27], v[52:53], v[12:15]
s_nop 0
v_subrev_u32 v17, s37, v16
v_cmp_lt_u32 vcc, s38, v17
v_mov_b64 v[40:41], 0
v_lshl_add_u32 v32, v32, 3, v5
v_rcp_f32 v18, v16
v_mov_b64 v[36:37], 0
v_mov_b64 v[42:43], 0
v_cndmask_b32 v11, v15, v11, s[42:43]
v_mul_f32 v11, v11, v18
v_cndmask_b32 v10, v14, v10, s[42:43]
v_cndmask_b32 v8, v12, v8, s[42:43]
v_mul_f32 v8, v8, v18
v_cndmask_b32 v9, v13, v9, s[42:43]
v_mul_f32 v10, v10, v18
v_mul_f32 v9, v9, v18
v_cvt_pk_bf16_f32 v13, v10, v11
v_cvt_pk_bf16_f32 v12, v8, v9
s_cbranch_vccnz rare_10089
back_10090:
ds_write_b64 v32, v[12:13] offset:512
v_mov_b32_dpp v9, v13 quad_perm:[0,1,0,1] row_mask:0xf bank_mask:0xf
v_mov_b32_dpp v8, v12 quad_perm:[0,1,0,1] row_mask:0xf bank_mask:0xf
v_mov_b64 v[38:39], 0
v_mov_b64 v[32:33], 0
v_mov_b32_dpp v10, v12 quad_perm:[2,3,2,3] row_mask:0xf bank_mask:0xf
v_mov_b32_dpp v11, v13 quad_perm:[2,3,2,3] row_mask:0xf bank_mask:0xf
v_mov_b64 v[48:49], 0
v_mov_b64 v[50:51], 0
v_smfmac_f32_16x16x64_bf16 v[36:39], v[8:11], v[64:71], v1
s_add_u32 s34, s17, 2
ds_read_b128 v[24:27], v0 offset:30720
global_load_dwordx4 v[64:67], v0, s[76:77] offset:-4096 sc1
ds_read_b128 v[16:19], v0 offset:28672
v_mov_b64 v[34:35], 0
v_smfmac_f32_16x16x64_bf16 v[40:43], v[8:11], v[72:79], v1
s_waitcnt lgkmcnt(2)
ds_read_b128 v[20:23], v0 offset:29696
s_barrier
ds_read_b128 v[56:59], v5 offset:0
v_smfmac_f32_16x16x64_bf16 v[32:35], v[8:11], v[176:183], v1
global_load_dwordx4 v[68:71], v0, s[76:77] offset:-3072 sc1
s_waitcnt lgkmcnt(3)
ds_read_b128 v[60:63], v5 offset:1536
v_lshrrev_b32 v44, 8, v0
v_smfmac_f32_16x16x64_bf16 v[48:51], v[8:11], v[160:167], v1
ds_read_b128 v[12:15], v5 offset:1024
global_load_dwordx4 v[72:75], v0, s[76:77] offset:0 sc1
v_bfe_u32 v45, v0, 1, 7
v_mov_b64 v[54:55], 0
s_waitcnt lgkmcnt(2)
v_smfmac_f32_16x16x64_bf16 v[48:51], v[56:59], v[208:215], v1
s_min_u32 s34, s34, s32
global_load_dwordx4 v[76:79], v0, s[76:77] offset:1024 sc1
v_smfmac_f32_16x16x64_bf16 v[36:39], v[56:59], v[16:23], v1
s_waitcnt lgkmcnt(1)
ds_read_b128 v[16:19], v0 offset:32768
v_mov_b64 v[52:53], 0
v_smfmac_f32_16x16x64_bf16 v[36:39], v[60:63], v[24:31], v1
s_add_u32 s27, s20, 524288
ds_read_b128 v[20:23], v0 offset:33792
s_waitcnt lgkmcnt(2)
v_smfmac_f32_16x16x64_bf16 v[32:35], v[56:59], v[232:239], v1
ds_read_b128 v[28:31], v0 offset:35840
v_smfmac_f32_16x16x64_bf16 v[36:39], v[12:15], v[184:191], v1
v_lshl_or_b32 v44, v44, 12, v45
v_smfmac_f32_16x16x64_bf16 v[40:43], v[56:59], v[192:199], v1
s_mov_b32 s19, 1
ds_read_b128 v[24:27], v0 offset:34816
s_nop 0
v_smfmac_f32_16x16x64_bf16 v[40:43], v[60:63], v[200:207], v1
s_add_u32 s58, s4, s20
s_waitcnt lgkmcnt(2)
v_cvt_pk_bf16_f32 v36, v36, v37
v_smfmac_f32_16x16x64_bf16 v[40:43], v[12:15], v[16:23], v1
ds_read_b128 v[20:23], v0 offset:37888
v_and_or_b32 v36, v36, -2, s18
v_cvt_pk_bf16_f32 v37, v38, v39
v_smfmac_f32_16x16x64_bf16 v[32:35], v[60:63], v[240:247], v1
global_store_dwordx2 v44, v[36:37], s[48:49]
v_smfmac_f32_16x16x64_bf16 v[48:51], v[60:63], v[216:223], v1
s_waitcnt lgkmcnt(1)
ds_read_b128 v[16:19], v0 offset:36864
v_cvt_pk_bf16_f32 v40, v40, v41
v_smfmac_f32_16x16x64_bf16 v[48:51], v[12:15], v[24:31], v1
s_addc_u32 s59, s5, 0
ds_read_b128 v[24:27], v0 offset:38912
v_and_or_b32 v40, v40, -2, s18
v_cvt_pk_bf16_f32 v41, v42, v43
v_smfmac_f32_16x16x64_bf16 v[32:35], v[12:15], v[248:255], v1
global_store_dwordx2 v44, v[40:41], s[50:51]
ds_read_b128 v[28:31], v0 offset:39936
v_smfmac_f32_16x16x64_bf16 v[52:55], v[8:11], v[168:175], v1
v_cvt_pk_bf16_f32 v48, v48, v49
v_smfmac_f32_16x16x64_bf16 v[52:55], v[56:59], v[224:231], v1
s_waitcnt lgkmcnt(2)
v_and_or_b32 v48, v48, -2, s18
v_cvt_pk_bf16_f32 v49, v50, v51
v_smfmac_f32_16x16x64_bf16 v[52:55], v[60:63], v[16:23], v1
s_waitcnt lgkmcnt(1)
global_store_dwordx2 v44, v[48:49], s[52:53]
s_waitcnt lgkmcnt(0)
v_smfmac_f32_16x16x64_bf16 v[52:55], v[12:15], v[24:31], v1
s_nop 1
v_cvt_pk_bf16_f32 v32, v32, v33
v_and_or_b32 v32, v32, -2, s18
v_cvt_pk_bf16_f32 v33, v34, v35
s_nop 2
v_cvt_pk_bf16_f32 v52, v52, v53
v_and_or_b32 v52, v52, -2, s18
v_cvt_pk_bf16_f32 v53, v54, v55
global_store_dwordx2 v44, v[52:53], s[54:55]
global_store_dwordx2 v44, v[32:33], s[56:57]
v_bfe_u32 v32, v0, 6, 1
v_lshlrev_b32 v32, 4, v32
v_mov_b32 v33, 0x3f80
v_lshlrev_b32 v32, v32, v33
v_bfe_i32 v33, v0, 4, 1
v_and_b32 v45, v32, v33
v_and_b32 v47, v32, v33
v_xor_b32 v44, v32, v45
v_xor_b32 v46, v32, v45
v_and_b32 v36, 32, v0
v_bfe_u32 v37, v0, 6, 1
v_lshl_add_u32 v36, v37, 8, v36
v_bfe_u32 v37, v0, 8, 1
v_lshl_add_u32 v36, v37, 4, v36
v_bfe_u32 v37, v0, 4, 1
v_lshl_add_u32 v36, v37, 3, v36
s_waitcnt vmcnt(9)
v_and_b32 v7, 511, v0
v_lshl_add_u32 v7, v7, 3, s27
s_nop 15
s_nop 15
s_nop 15
s_nop 15
global_load_dwordx4 v[8:11], v0, s[64:65] offset:0 sc1
global_load_dwordx4 v[12:15], v0, s[64:65] offset:1024 sc1
global_load_dwordx4 v[16:19], v0, s[64:65] offset:2048 sc1
global_load_dwordx4 v[20:23], v0, s[64:65] offset:3072 sc1
s_nop 15
s_nop 15
s_nop 5
global_load_dwordx4 v[24:27], v0, s[64:65] offset:0 sc1
global_load_dwordx4 v[28:31], v0, s[64:65] offset:1024 sc1
global_load_dwordx4 v[48:51], v0, s[64:65] offset:2048 sc1
global_load_dwordx4 v[52:55], v0, s[64:65] offset:3072 sc1
chk_10098:
v_mov_b64 v[40:41], 0
v_mov_b64 v[42:43], 0
s_waitcnt vmcnt(6)
s_nop 0
v_smfmac_f32_16x16x64_bf16 v[40:43], v[44:47], v[8:15], v1
v_bitop3_b32 v32, v8, v10, s18 bitop3:0x7e
v_bitop3_b32 v33, v12, v14, s18 bitop3:0x7e
s_waitcnt vmcnt(4)
v_smfmac_f32_16x16x64_bf16 v[40:43], v[44:47], v[16:23], v1
v_bitop3_b32 v34, v16, v18, s18 bitop3:0x7e
v_bitop3_b32 v35, v20, v22, s18 bitop3:0x7e
v_or3_b32 v37, v32, v33, v34
v_bitop3_b32 v37, v37, v35, 1 bitop3:0xa8
v_cmp_ne_u32 vcc, 0, v37
s_cbranch_vccnz chk_10098_f
s_nop 1
v_add_f32_dpp v40, v40, v40 row_ror:8 row_mask:0xf bank_mask:0xf
v_add_f32_dpp v41, v41, v41 row_ror:8 row_mask:0xf bank_mask:0xf
v_add_f32_dpp v42, v42, v42 row_ror:8 row_mask:0xf bank_mask:0xf
v_add_f32_dpp v43, v43, v43 row_ror:8 row_mask:0xf bank_mask:0xf
v_cvt_pk_bf16_f32 v40, v40, v41
v_cvt_pk_bf16_f32 v41, v42, v43
v_and_or_b32 v40, v40, -2, s18
s_mov_b64 exec, 0x00ff00ff
global_store_dwordx2 v36, v[40:41], s[66:67]
s_mov_b64 exec, -1
s_branch join_10097
chk_10098_f:
global_load_dwordx4 v[8:11], v0, s[64:65] offset:0 sc1
global_load_dwordx4 v[12:15], v0, s[64:65] offset:1024 sc1
global_load_dwordx4 v[16:19], v0, s[64:65] offset:2048 sc1
global_load_dwordx4 v[20:23], v0, s[64:65] offset:3072 sc1
chk_10099:
v_mov_b64 v[40:41], 0
v_mov_b64 v[42:43], 0
s_waitcnt vmcnt(6)
s_nop 0
v_smfmac_f32_16x16x64_bf16 v[40:43], v[44:47], v[24:31], v1
v_bitop3_b32 v32, v24, v26, s18 bitop3:0x7e
v_bitop3_b32 v33, v28, v30, s18 bitop3:0x7e
s_waitcnt vmcnt(4)
v_smfmac_f32_16x16x64_bf16 v[40:43], v[44:47], v[48:55], v1
v_bitop3_b32 v34, v48, v50, s18 bitop3:0x7e
v_bitop3_b32 v35, v52, v54, s18 bitop3:0x7e
v_or3_b32 v37, v32, v33, v34
v_bitop3_b32 v37, v37, v35, 1 bitop3:0xa8
v_cmp_ne_u32 vcc, 0, v37
s_cbranch_vccnz chk_10099_f
s_nop 1
v_add_f32_dpp v40, v40, v40 row_ror:8 row_mask:0xf bank_mask:0xf
v_add_f32_dpp v41, v41, v41 row_ror:8 row_mask:0xf bank_mask:0xf
v_add_f32_dpp v42, v42, v42 row_ror:8 row_mask:0xf bank_mask:0xf
v_add_f32_dpp v43, v43, v43 row_ror:8 row_mask:0xf bank_mask:0xf
v_cvt_pk_bf16_f32 v40, v40, v41
v_cvt_pk_bf16_f32 v41, v42, v43
v_and_or_b32 v40, v40, -2, s18
s_mov_b64 exec, 0x00ff00ff
global_store_dwordx2 v36, v[40:41], s[66:67]
s_mov_b64 exec, -1
s_branch join_10097
chk_10099_f:
global_load_dwordx4 v[24:27], v0, s[64:65] offset:0 sc1
global_load_dwordx4 v[28:31], v0, s[64:65] offset:1024 sc1
global_load_dwordx4 v[48:51], v0, s[64:65] offset:2048 sc1
global_load_dwordx4 v[52:55], v0, s[64:65] offset:3072 sc1
s_add_u32 s30, s30, 1
s_cmp_le_u32 s30, 262144
s_cbranch_scc1 chk_10098
s_branch L_fail
nored_10096:
join_10097:
s_barrier
global_load_dwordx4 v[56:59], v0, s[76:77] offset:-2048 sc1
global_load_dwordx4 v[60:63], v0, s[76:77] offset:-1024 sc1
s_nop 15
s_nop 15
s_nop 15
s_barrier
global_load_dwordx4 v[32:35], v0, s[68:69] offset:-4096 sc1
s_nop 10
global_load_dwordx4 v[36:39], v0, s[68:69] offset:0 sc1
s_nop 10
global_load_dwordx4 v[40:43], v0, s[70:71] offset:0 sc1
s_barrier
global_load_dwordx4 v[48:51], v0, s[76:77] offset:2048 sc1
global_load_dwordx4 v[52:55], v0, s[76:77] offset:3072 sc1
s_waitcnt vmcnt(11)
v_mov_b64 v[8:9], 0
v_mov_b64 v[10:11], 0
s_waitcnt vmcnt(10)
v_mov_b64 v[12:13], 0
v_mov_b64 v[14:15], 0
s_waitcnt vmcnt(9)
v_mov_b64 v[16:17], 0
v_mov_b64 v[18:19], 0
s_waitcnt vmcnt(8)
v_mov_b64 v[20:21], 0
v_mov_b64 v[22:23], 0
v_mov_b64 v[24:25], 0
v_mov_b64 v[26:27], 0
v_mov_b64 v[28:29], 0
v_mov_b64 v[30:31], 0
s_mov_b32 s30, 0
s_cmp_eq_u32 s17, s31
s_cbranch_scc0 gather_10088
s_branch exit_10091
rt_10093:
global_load_dwordx4 v[32:35], v0, s[68:69] offset:-4096 sc1
global_load_dwordx4 v[36:39], v0, s[68:69] offset:0 sc1
global_load_dwordx4 v[40:43], v0, s[70:71] offset:0 sc1
s_add_u32 s30, s30, 1
s_cmp_gt_u32 s30, 262144
s_cbranch_scc1 L_fail
s_mov_b64 exec, 1
global_store_dword v0, v0, s[62:63]
global_store_dword v0, v0, s[62:63]
s_mov_b64 exec, -1
v_mov_b64 v[8:9], 0
v_mov_b64 v[10:11], 0
v_mov_b64 v[12:13], 0
v_mov_b64 v[14:15], 0
v_mov_b64 v[16:17], 0
v_mov_b64 v[18:19], 0
v_mov_b64 v[20:21], 0
v_mov_b64 v[22:23], 0
v_mov_b64 v[24:25], 0
v_mov_b64 v[26:27], 0
v_mov_b64 v[28:29], 0
v_mov_b64 v[30:31], 0
s_branch gather_10088
rare_10089:
ds_read_b128 v[48:51], v6 offset:6144
ds_read_b128 v[52:55], v6 offset:7168
s_waitcnt lgkmcnt(0)
v_add_f32 v48, v48, v52
v_add_f32 v49, v49, v53
v_add_f32 v50, v50, v54
v_add_f32 v51, v51, v55
v_mov_b32_dpp v46, v46 quad_perm:[0,1,0,1] row_mask:0xf bank_mask:0xf
v_mov_b32_dpp v47, v47 quad_perm:[0,1,0,1] row_mask:0xf bank_mask:0xf
v_max3_f32 v19, v48, v49, v50
v_max3_f32 v19, v19, v51, v46
v_max_f32 v19, v19, v47
s_nop 1
v_max_f32_dpp v19, v19, v19 quad_perm:[2,3,0,1] row_mask:0xf bank_mask:0xf
v_mov_b32 v44, v19
s_nop 1
v_permlane32_swap_b32 v19, v44
v_max_f32 v19, v19, v44
v_mov_b32 v44, v19
s_nop 1
v_permlane16_swap_b32 v19, v44
v_max_f32 v19, v19, v44
v_sub_f32 v48, v48, v19
v_sub_f32 v49, v49, v19
v_sub_f32 v50, v50, v19
v_sub_f32 v51, v51, v19
v_sub_f32 v46, v46, v19
v_sub_f32 v47, v47, v19
v_exp_f32 v48, v48
v_exp_f32 v49, v49
v_exp_f32 v50, v50
v_exp_f32 v51, v51
v_cvt_pk_bf16_f32 v54, v48, v49
v_cvt_pk_bf16_f32 v55, v50, v51
s_nop 0
v_mov_b32_dpp v48, v54 quad_perm:[0,1,0,1] row_mask:0xf bank_mask:0xf
v_mov_b32_dpp v49, v55 quad_perm:[0,1,0,1] row_mask:0xf bank_mask:0xf
v_mov_b32_dpp v50, v54 quad_perm:[2,3,2,3] row_mask:0xf bank_mask:0xf
v_mov_b32_dpp v51, v55 quad_perm:[2,3,2,3] row_mask:0xf bank_mask:0xf
v_mov_b64 v[20:21], s[44:45]
v_mov_b64 v[22:23], s[44:45]
v_mfma_f32_16x16x32_bf16 v[8:11], v[56:59], v[48:51], 0
v_mfma_f32_16x16x32_bf16 v[12:15], v[60:63], v[48:51], 0
v_mfma_f32_16x16x32_bf16 v[16:19], v[20:23], v[48:51], 0
v_mov_b64 v[54:55], s[46:47]
v_exp_f32_dpp v44, v46 quad_perm:[0,1,0,1] row_mask:0xf bank_mask:0xf
v_exp_f32_dpp v45, v47 quad_perm:[0,1,0,1] row_mask:0xf bank_mask:0xf
s_nop 0
v_cvt_pk_bf16_f32 v52, v44, v45
v_cvt_pk_bf16_f32 v53, v44, v45
s_nop 1
v_mfma_f32_16x16x16_bf16 v[16:19], v[54:55], v[52:53], v[16:19]
v_mfma_f32_16x16x16_bf16 v[8:11], v[24:25], v[52:53], v[8:11]
v_mfma_f32_16x16x16_bf16 v[12:15], v[26:27], v[52:53], v[12:15]
s_nop 5
v_rcp_f32 v18, v16
s_nop 0
v_cndmask_b32 v8, v12, v8, s[42:43]
v_mul_f32 v8, v8, v18
v_cndmask_b32 v9, v13, v9, s[42:43]
v_mul_f32 v9, v9, v18
v_cndmask_b32 v10, v14, v10, s[42:43]
v_mul_f32 v10, v10, v18
v_cndmask_b32 v11, v15, v11, s[42:43]
v_mul_f32 v11, v11, v18
v_cvt_pk_bf16_f32 v12, v8, v9
v_cvt_pk_bf16_f32 v13, v10, v11
s_branch back_10090
exit_10091:
global_load_dwordx4 v[32:35], v0, s[68:69] offset:-4096 sc1
global_load_dwordx4 v[36:39], v0, s[68:69] offset:0 sc1
global_load_dwordx4 v[40:43], v0, s[70:71] offset:0 sc1
s_add_u32 s30, s30, 1
s_cmp_gt_u32 s30, 262144
s_cbranch_scc1 L_fail
s_waitcnt vmcnt(2)
v_bitop3_b32 v44, v32, v34, s18 bitop3:0x7e
s_waitcnt vmcnt(1)
v_bitop3_b32 v45, v36, v38, s18 bitop3:0x7e
v_or_b32 v44, v44, v45
s_waitcnt vmcnt(0)
v_bitop3_b32 v46, v40, v42, s18 bitop3:0x7e
v_bitop3_b32 v44, v44, v46, s19 bitop3:0xa8
v_cmp_ne_u32 vcc, 0, v44
s_cbranch_vccnz exit_10091
ds_write_b128 v0, v[32:35] offset:1024
ds_write_b128 v0, v[36:39] offset:5120
ds_write_b128 v0, v[40:43] offset:9216
s_waitcnt lgkmcnt(0)
s_barrier
s_barrier
s_add_u32 s36, s36, 1
s_cmp_lt_u32 s36, 2
s_cbranch_scc1 layer_10087
s_endpgm
wave_10070:
layer_10100:
s_lshl_b32 s17, s36, 6
s_mul_i32 s27, s36, 35651584
s_mul_i32 s28, s14, 16384
s_add_u32 s27, s27, s28
s_add_u32 s20, s27, 16785408
s_mul_i32 s27, s17, 10240
s_add_u32 s27, s27, s24
s_add_u32 s21, s27, s25
s_mov_b32 s19, 0
s_mov_b32 s33, s6
s_add_u32 s34, s17, 1
s_add_u32 s31, s17, 63
s_add_u32 s32, s17, 64
s_mov_b32 s27, s20
v_mov_b32 v7, 0
s_add_u32 s68, s4, 415744
s_addc_u32 s69, s5, 0
s_add_u32 s72, s4, 399360
s_addc_u32 s73, s5, 0
s_add_u32 s70, s4, 419840
s_addc_u32 s71, s5, 0
s_add_u32 s74, s4, 403456
s_addc_u32 s75, s5, 0
s_add_u32 s58, s4, s20
s_addc_u32 s59, s5, 0
global_load_dwordx4 v[64:67], v0, s[76:77] offset:-4096 sc1
global_load_dwordx4 v[68:71], v0, s[76:77] offset:-3072 sc1
global_load_dwordx4 v[72:75], v0, s[76:77] offset:0 sc1
global_load_dwordx4 v[76:79], v0, s[76:77] offset:1024 sc1
global_load_dwordx4 v[48:51], v0, s[76:77] offset:2048 sc1
global_load_dwordx4 v[52:55], v0, s[76:77] offset:3072 sc1
global_load_dwordx4 v[56:59], v0, s[76:77] offset:-2048 sc1
global_load_dwordx4 v[60:63], v0, s[76:77] offset:-1024 sc1
v_mov_b64 v[8:9], 0
v_mov_b64 v[10:11], 0
v_mov_b64 v[12:13], 0
v_mov_b64 v[14:15], 0
v_mov_b64 v[16:17], 0
v_mov_b64 v[18:19], 0
v_mov_b64 v[20:21], 0
v_mov_b64 v[22:23], 0
v_mov_b64 v[24:25], 0
v_mov_b64 v[26:27], 0
v_mov_b64 v[28:29], 0
v_mov_b64 v[30:31], 0
s_barrier
v_and_b32 v7, 511, v0
v_lshl_add_u32 v7, v7, 3, s27
global_load_dwordx4 v[32:35], v0, s[68:69] offset:-4096 sc1
global_load_dwordx4 v[36:39], v0, s[68:69] offset:0 sc1
v_mov_b32 v45, -1
s_mov_b32 s30, 0
s_waitcnt vmcnt(0)
.p2align 6
gather_10101:
s_waitcnt vmcnt(3)
rt_10106_b:
v_smfmac_f32_16x16x64_bf16 v[12:15], v[32:35], a[0:7], v1
ds_write_b128 v0, v[32:35] offset:2048
v_smfmac_f32_16x16x64_bf16 v[20:23], v[32:35], a[8:15], v1
v_bitop3_b32 v44, v32, v34, s18 bitop3:0x7e
v_smfmac_f32_16x16x64_bf16 v[28:31], v[32:35], v[72:79], v1
s_waitcnt vmcnt(2)
ds_write_b128 v0, v[36:39] offset:6144
v_bitop3_b32 v45, v36, v38, s18 bitop3:0x7e
v_bitop3_b32 v44, v44, v45, s19 bitop3:0xa8
v_cmp_ne_u32 vcc, 0, v44
v_smfmac_f32_16x16x64_bf16 v[8:11], v[32:35], v[64:71], v1
s_cbranch_vccnz rt_10106
global_load_dwordx4 v[64:67], v0, s[78:79] offset:-4096 sc1
v_smfmac_f32_16x16x64_bf16 v[16:19], v[32:35], v[56:63], v1
global_load_dwordx4 v[68:71], v0, s[78:79] offset:-3072 sc1
v_smfmac_f32_16x16x64_bf16 v[20:23], v[36:39], a[48:55], v1
s_waitcnt lgkmcnt(0)
ds_read_b128 v[60:63], v2 offset:1024
global_load_dwordx4 v[72:75], v0, s[78:79] offset:-2048 sc1
v_smfmac_f32_16x16x64_bf16 v[16:19], v[36:39], a[40:47], v1
ds_read_b128 v[56:59], v2 offset:0
v_smfmac_f32_16x16x64_bf16 v[24:27], v[32:35], a[16:23], v1
s_barrier
ds_read_b128 v[40:43], v0 offset:3072
v_smfmac_f32_16x16x64_bf16 v[12:15], v[36:39], a[32:39], v1
ds_read_b128 v[44:47], v0 offset:7168
s_waitcnt lgkmcnt(3)
v_smfmac_f32_16x16x64_bf16 v[8:11], v[36:39], a[24:31], v1
ds_read_b128 v[32:35], v0 offset:0
s_waitcnt lgkmcnt(3)
v_smfmac_f32_16x16x64_bf16 v[28:31], v[36:39], v[56:63], v1
ds_read_b128 v[56:59], v2 offset:2048
v_smfmac_f32_16x16x64_bf16 v[24:27], v[36:39], a[56:63], v1
ds_read_b128 v[60:63], v2 offset:3072
s_waitcnt lgkmcnt(4)
v_smfmac_f32_16x16x64_bf16 v[8:11], v[40:43], a[64:71], v1
ds_read_b128 v[36:39], v0 offset:4096
s_waitcnt vmcnt(3)
v_smfmac_f32_16x16x64_bf16 v[12:15], v[40:43], v[48:55], v1
s_waitcnt lgkmcnt(4)
ds_read_b128 v[48:51], v2 offset:4096
v_smfmac_f32_16x16x64_bf16 v[8:11], v[44:47], a[72:79], v1
ds_read_b128 v[52:55], v2 offset:5120
s_waitcnt lgkmcnt(5)
v_smfmac_f32_16x16x64_bf16 v[12:15], v[44:47], a[80:87], v1
s_waitcnt lgkmcnt(4)
ds_read_b128 v[44:47], v0 offset:5120
s_waitcnt lgkmcnt(4)
v_smfmac_f32_16x16x64_bf16 v[12:15], v[32:35], a[88:95], v1
ds_read_b128 v[40:43], v0 offset:1024
s_waitcnt lgkmcnt(4)
v_smfmac_f32_16x16x64_bf16 v[8:11], v[32:35], v[56:63], v1
s_mov_b64 s[68:69], s[72:73]
ds_read_b128 v[56:59], v2 offset:6144
s_waitcnt lgkmcnt(4)
v_smfmac_f32_16x16x64_bf16 v[8:11], v[36:39], a[96:103], v1
ds_read_b128 v[32:35], v0 offset:8192
s_waitcnt vmcnt(2)
global_load_dwordx4 v[76:79], v0, s[78:79] offset:-1024 sc1
ds_read_b128 v[60:63], v2 offset:7168
s_waitcnt lgkmcnt(5)
v_smfmac_f32_16x16x64_bf16 v[12:15], v[36:39], v[48:55], v1
s_xor_b32 s18, s18, 1
s_waitcnt lgkmcnt(4)
ds_read_b128 v[52:55], v2 offset:9216
s_waitcnt lgkmcnt(4)
ds_read_b128 v[48:51], v2 offset:8192
v_smfmac_f32_16x16x64_bf16 v[8:11], v[40:43], a[104:111], v1
ds_read_b128 v[36:39], v0 offset:9216
s_waitcnt vmcnt(2)
v_smfmac_f32_16x16x64_bf16 v[8:11], v[44:47], v[64:71], v1
global_load_dwordx4 v[64:67], v0, s[78:79] offset:0 sc1
v_smfmac_f32_16x16x64_bf16 v[12:15], v[40:43], a[112:119], v1
s_waitcnt lgkmcnt(3)
ds_read_b128 v[40:43], v0 offset:3072
v_smfmac_f32_16x16x64_bf16 v[12:15], v[44:47], v[56:63], v1
s_mov_b64 vcc, s[42:43]
ds_read_b128 v[60:63], v2 offset:11264
ds_read_b128 v[56:59], v2 offset:10240
v_smfmac_f32_16x16x64_bf16 v[8:11], v[32:35], a[120:127], v1
s_waitcnt lgkmcnt(4)
global_load_dwordx4 v[68:71], v0, s[78:79] offset:1024 sc1
v_smfmac_f32_16x16x64_bf16 v[12:15], v[32:35], v[48:55], v1
s_waitcnt lgkmcnt(3)
ds_read_b128 v[32:35], v0 offset:7168
v_smfmac_f32_16x16x64_bf16 v[12:15], v[36:39], a[136:143], v1
s_nop 0
global_load_dwordx4 v[48:51], v0, s[58:59] offset:0 nt sc1
v_smfmac_f32_16x16x64_bf16 v[8:11], v[36:39], a[128:135], v1
s_waitcnt lgkmcnt(3)
ds_read_b128 v[36:39], v0 offset:0
global_load_dwordx4 v[52:55], v0, s[58:59] offset:1024 nt sc1
v_smfmac_f32_16x16x64_bf16 v[20:23], v[40:43], a[152:159], v1
s_nop 0
v_add_f32 v13, v13, v15
v_smfmac_f32_16x16x64_bf16 v[16:19], v[40:43], a[144:151], v1
s_waitcnt lgkmcnt(1)
ds_read_b128 v[40:43], v0 offset:4096
v_add_f32 v9, v9, v11
v_smfmac_f32_16x16x64_bf16 v[20:23], v[32:35], v[56:63], v1
ds_read_b128 v[56:59], v2 offset:12288
ds_read_b128 v[60:63], v2 offset:13312
v_smfmac_f32_16x16x64_bf16 v[16:19], v[32:35], a[160:167], v1
s_waitcnt lgkmcnt(3)
v_add_f32 v8, v8, v10
v_smfmac_f32_16x16x64_bf16 v[20:23], v[36:39], a[176:183], v1
s_waitcnt vmcnt(5)
ds_read_b128 v[32:35], v0 offset:1024
v_mul_f32 v9, s35, v9
v_add_f32 v12, v12, v14
v_mul_f32 v13, s35, v13
v_mul_f32 v8, s35, v8
v_mul_f32 v12, s35, v12
v_cvt_pk_bf16_f32 v12, v12, v13
v_cvt_pk_bf16_f32 v8, v8, v9
v_smfmac_f32_16x16x64_bf16 v[16:19], v[36:39], a[168:175], v1
s_waitcnt lgkmcnt(2)
ds_read_b128 v[36:39], v0 offset:5120
ds_write2_b32 v3, v8, v12 offset0:0 offset1:128
s_waitcnt lgkmcnt(3)
v_smfmac_f32_16x16x64_bf16 v[16:19], v[40:43], v[56:63], v1
s_waitcnt vmcnt(4)
global_load_dwordx4 v[56:59], v0, s[58:59] offset:2048 nt sc1
v_smfmac_f32_16x16x64_bf16 v[20:23], v[40:43], v[72:79], v1
s_waitcnt lgkmcnt(2)
global_load_dwordx4 v[60:63], v0, s[58:59] offset:3072 nt sc1
ds_read_b128 v[40:43], v0 offset:8192
v_smfmac_f32_16x16x64_bf16 v[16:19], v[32:35], a[184:191], v1
global_load_dwordx4 v[72:75], v0, s[78:79] offset:2048 sc1
v_smfmac_f32_16x16x64_bf16 v[20:23], v[32:35], a[192:199], v1
s_waitcnt lgkmcnt(1)
ds_read_b128 v[32:35], v0 offset:9216
global_load_dwordx4 v[76:79], v0, s[78:79] offset:3072 sc1
v_smfmac_f32_16x16x64_bf16 v[16:19], v[36:39], a[200:207], v1
s_barrier
v_smfmac_f32_16x16x64_bf16 v[20:23], v[36:39], a[208:215], v1
s_waitcnt lgkmcnt(1)
ds_read_b64_tr_b16 v[8:9], v4 offset:2048
ds_read_b64_tr_b16 v[10:11], v4 offset:2560
v_smfmac_f32_16x16x64_bf16 v[16:19], v[40:43], a[216:223], v1
ds_read_b64_tr_b16 v[14:15], v4 offset:3584
s_waitcnt lgkmcnt(3)
ds_read_b64_tr_b16 v[12:13], v4 offset:3072
v_smfmac_f32_16x16x64_bf16 v[16:19], v[32:35], a[232:239], v1
s_add_u32 s20, s20, 524288
ds_read_b128 v[36:39], v0 offset:8192
v_smfmac_f32_16x16x64_bf16 v[20:23], v[40:43], a[224:231], v1
v_smfmac_f32_16x16x64_bf16 v[20:23], v[32:35], a[240:247], v1
s_waitcnt lgkmcnt(2)
ds_read_b128 v[40:43], v0 offset:9216
s_waitcnt vmcnt(5)
ds_read_b128 v[32:35], v0 offset:3072
v_mfma_f32_16x16x32_bf16 v[44:47], v[48:51], v[8:11], 0
s_waitcnt lgkmcnt(3)
ds_read_b128 v[8:11], v2 offset:14336
v_bfe_u32 v48, v0, 5, 1
v_add_f32 v16, v16, v18
v_add_f32 v17, v17, v19
s_waitcnt vmcnt(4)
v_mfma_f32_16x16x32_bf16 v[44:47], v[52:55], v[12:15], v[44:47]
s_waitcnt lgkmcnt(3)
ds_read_b128 v[12:15], v2 offset:15360
ds_read_b128 v[52:55], v2 offset:17408
v_lshl_add_u32 v48, v48, 3, v5
v_add_f32 v21, v21, v23
v_add_f32 v20, v20, v22
v_cvt_pk_bf16_f32 v16, v16, v17
s_nop 0
v_cndmask_b32_dpp v44, v46, v44, vcc quad_perm:[0,1,0,1] row_mask:0xf bank_mask:0xf
v_cndmask_b32_dpp v45, v47, v45, vcc quad_perm:[0,1,0,1] row_mask:0xf bank_mask:0xf
v_smfmac_f32_16x16x64_bf16 v[28:31], v[36:39], v[80:87], v1
ds_write_b64 v48, v[44:45] offset:7168
v_cvt_pk_bf16_f32 v20, v20, v21
v_smfmac_f32_16x16x64_bf16 v[24:27], v[36:39], a[248:255], v1
s_waitcnt lgkmcnt(2)
ds_read_b128 v[48:51], v2 offset:16384
global_load_dword v7, v7, s[4:5] sc1
ds_write2_b32 v3, v16, v20 offset0:1 offset1:129
v_smfmac_f32_16x16x64_bf16 v[24:27], v[40:43], v[8:15], v1
s_waitcnt lgkmcnt(3)
ds_read_b128 v[36:39], v0 offset:7168
v_smfmac_f32_16x16x64_bf16 v[24:27], v[32:35], v[88:95], v1
s_waitcnt lgkmcnt(2)
v_smfmac_f32_16x16x64_bf16 v[28:31], v[40:43], v[48:55], v1
ds_read_b128 v[40:43], v0 offset:0
v_smfmac_f32_16x16x64_bf16 v[28:31], v[32:35], v[96:103], v1
s_waitcnt lgkmcnt(2)
ds_read_b128 v[32:35], v0 offset:4096
s_barrier
ds_read_b64_tr_b16 v[12:13], v4 offset:1024
s_waitcnt lgkmcnt(3)
ds_read_b128 v[48:51], v6 offset:6144
v_smfmac_f32_16x16x64_bf16 v[28:31], v[36:39], v[104:111], v1
ds_read_b128 v[52:55], v6 offset:7168
s_waitcnt lgkmcnt(4)
ds_read_b64_tr_b16 v[10:11], v4 offset:512
v_smfmac_f32_16x16x64_bf16 v[24:27], v[36:39], v[64:71], v1
ds_read_b64_tr_b16 v[18:19], v4 offset:2560
s_add_u32 s17, s17, 1
ds_read_b64_tr_b16 v[8:9], v4 offset:0
v_smfmac_f32_16x16x64_bf16 v[24:27], v[40:43], v[112:119], v1
s_waitcnt lgkmcnt(6)
ds_read_b64_tr_b16 v[22:23], v4 offset:3584
s_mov_b32 s30, 0
ds_read_b64_tr_b16 v[16:17], v4 offset:2048
v_smfmac_f32_16x16x64_bf16 v[28:31], v[40:43], v[120:127], v1
s_waitcnt vmcnt(1)
ds_read_b64_tr_b16 v[14:15], v4 offset:1536
s_waitcnt lgkmcnt(8)
ds_read_b128 v[40:43], v0 offset:5120
v_smfmac_f32_16x16x64_bf16 v[24:27], v[32:35], v[128:135], v1
ds_read_b128 v[68:71], v2 offset:19456
s_waitcnt lgkmcnt(7)
ds_read_b128 v[36:39], v0 offset:1024
v_smfmac_f32_16x16x64_bf16 v[28:31], v[32:35], v[136:143], v1
s_waitcnt lgkmcnt(6)
ds_read_b64_tr_b16 v[20:21], v4 offset:3072
v_add_f32 v49, v49, v53
v_add_f32 v48, v48, v52
v_mfma_f32_16x16x32_bf16 v[44:47], v[8:11], v[8:11], 0
s_waitcnt lgkmcnt(4)
ds_read_b128 v[64:67], v2 offset:18432
v_add_f32 v50, v50, v54
v_mfma_f32_16x16x32_bf16 v[44:47], v[12:15], v[12:15], v[44:47]
s_add_u32 s21, s21, 10240
v_exp_f32 v50, v50
v_add_f32 v51, v51, v55
v_exp_f32 v48, v48
v_exp_f32 v49, v49
v_exp_f32 v51, v51
v_mfma_f32_16x16x32_bf16 v[44:47], v[16:19], v[16:19], v[44:47]
s_waitcnt lgkmcnt(1)
v_cvt_pk_bf16_f32 v55, v50, v51
v_cvt_pk_bf16_f32 v54, v48, v49
v_mfma_f32_16x16x32_bf16 v[44:47], v[20:23], v[20:23], v[44:47]
s_waitcnt lgkmcnt(0)
v_mov_b32_dpp v49, v55 quad_perm:[0,1,0,1] row_mask:0xf bank_mask:0xf
v_mov_b32_dpp v50, v54 quad_perm:[2,3,2,3] row_mask:0xf bank_mask:0xf
v_smfmac_f32_16x16x64_bf16 v[24:27], v[36:39], v[64:71], v1
ds_read_b128 v[64:67], v2 offset:20480
v_mov_b32_dpp v51, v55 quad_perm:[2,3,2,3] row_mask:0xf bank_mask:0xf
v_smfmac_f32_16x16x64_bf16 v[28:31], v[36:39], v[144:151], v1
ds_read_b128 v[68:71], v2 offset:21504
v_mov_b64 v[22:23], s[44:45]
v_smfmac_f32_16x16x64_bf16 v[24:27], v[40:43], v[72:79], v1
ds_read_b128 v[76:79], v2 offset:23552
v_mov_b32_dpp v48, v54 quad_perm:[0,1,0,1] row_mask:0xf bank_mask:0xf
v_smfmac_f32_16x16x64_bf16 v[28:31], v[40:43], v[152:159], v1
ds_read_b128 v[72:75], v2 offset:22528
v_mov_b64 v[20:21], s[44:45]
v_mfma_f32_16x16x32_bf16 v[12:15], v[60:63], v[48:51], 0
v_exp_f32_dpp v45, v47 quad_perm:[0,1,0,1] row_mask:0xf bank_mask:0xf
v_exp_f32_dpp v44, v46 quad_perm:[0,1,0,1] row_mask:0xf bank_mask:0xf
v_mfma_f32_16x16x32_bf16 v[16:19], v[20:23], v[48:51], 0
v_cvt_pk_bf16_f32 v52, v44, v45
v_mov_b64 v[54:55], s[46:47]
v_mfma_f32_16x16x32_bf16 v[8:11], v[56:59], v[48:51], 0
v_cvt_pk_bf16_f32 v53, v44, v45
v_cvt_pk_bf16_f32 v24, v24, v25
v_cvt_pk_bf16_f32 v25, v26, v27
v_mfma_f32_16x16x16_bf16 v[16:19], v[54:55], v[52:53], v[16:19]
s_waitcnt lgkmcnt(0)
v_cvt_pk_bf16_f32 v26, v28, v29
v_cvt_pk_bf16_f32 v27, v30, v31
v_mfma_f32_16x16x16_bf16 v[8:11], v[24:25], v[52:53], v[8:11]
ds_read_b128 v[28:31], v0 offset:44032
v_bfe_u32 v32, v0, 5, 1
v_mfma_f32_16x16x16_bf16 v[12:15], v[26:27], v[52:53], v[12:15]
s_nop 0
v_subrev_u32 v17, s37, v16
v_cmp_lt_u32 vcc, s38, v17
v_mov_b64 v[40:41], 0
v_lshl_add_u32 v32, v32, 3, v5
v_rcp_f32 v18, v16
v_mov_b64 v[36:37], 0
v_mov_b64 v[42:43], 0
v_cndmask_b32 v11, v15, v11, s[42:43]
v_mul_f32 v11, v11, v18
v_cndmask_b32 v10, v14, v10, s[42:43]
v_cndmask_b32 v8, v12, v8, s[42:43]
v_mul_f32 v8, v8, v18
v_cndmask_b32 v9, v13, v9, s[42:43]
v_mul_f32 v10, v10, v18
v_mul_f32 v9, v9, v18
v_cvt_pk_bf16_f32 v13, v10, v11
v_cvt_pk_bf16_f32 v12, v8, v9
s_cbranch_vccnz rare_10102
back_10103:
ds_write_b64 v32, v[12:13] offset:1024
v_mov_b32_dpp v9, v13 quad_perm:[0,1,0,1] row_mask:0xf bank_mask:0xf
v_mov_b32_dpp v8, v12 quad_perm:[0,1,0,1] row_mask:0xf bank_mask:0xf
v_mov_b64 v[38:39], 0
v_mov_b64 v[32:33], 0
v_mov_b32_dpp v10, v12 quad_perm:[2,3,2,3] row_mask:0xf bank_mask:0xf
v_mov_b32_dpp v11, v13 quad_perm:[2,3,2,3] row_mask:0xf bank_mask:0xf
v_mov_b64 v[48:49], 0
v_mov_b64 v[50:51], 0
v_smfmac_f32_16x16x64_bf16 v[36:39], v[8:11], v[64:71], v1
s_add_u32 s34, s17, 2
ds_read_b128 v[24:27], v0 offset:43008
global_load_dwordx4 v[64:67], v0, s[76:77] offset:-4096 sc1
ds_read_b128 v[16:19], v0 offset:40960
v_mov_b64 v[34:35], 0
v_smfmac_f32_16x16x64_bf16 v[40:43], v[8:11], v[72:79], v1
s_waitcnt lgkmcnt(2)
ds_read_b128 v[20:23], v0 offset:41984
s_barrier
ds_read_b128 v[56:59], v5 offset:1536
v_smfmac_f32_16x16x64_bf16 v[32:35], v[8:11], v[176:183], v1
global_load_dwordx4 v[68:71], v0, s[76:77] offset:-3072 sc1
s_waitcnt lgkmcnt(3)
ds_read_b128 v[60:63], v5 offset:0
v_lshrrev_b32 v44, 8, v0
v_smfmac_f32_16x16x64_bf16 v[48:51], v[8:11], v[160:167], v1
ds_read_b128 v[12:15], v5 offset:512
global_load_dwordx4 v[72:75], v0, s[76:77] offset:0 sc1
v_bfe_u32 v45, v0, 1, 7
v_mov_b64 v[54:55], 0
s_waitcnt lgkmcnt(2)
v_smfmac_f32_16x16x64_bf16 v[48:51], v[56:59], v[208:215], v1
s_min_u32 s34, s34, s32
global_load_dwordx4 v[76:79], v0, s[76:77] offset:1024 sc1
v_smfmac_f32_16x16x64_bf16 v[36:39], v[56:59], v[16:23], v1
s_waitcnt lgkmcnt(1)
ds_read_b128 v[16:19], v0 offset:45056
v_mov_b64 v[52:53], 0
v_smfmac_f32_16x16x64_bf16 v[36:39], v[60:63], v[24:31], v1
s_add_u32 s27, s20, 524288
ds_read_b128 v[20:23], v0 offset:46080
s_waitcnt lgkmcnt(2)
v_smfmac_f32_16x16x64_bf16 v[32:35], v[56:59], v[232:239], v1
ds_read_b128 v[28:31], v0 offset:48128
v_smfmac_f32_16x16x64_bf16 v[36:39], v[12:15], v[184:191], v1
v_lshl_or_b32 v44, v44, 12, v45
v_smfmac_f32_16x16x64_bf16 v[40:43], v[56:59], v[192:199], v1
s_mov_b32 s19, 1
ds_read_b128 v[24:27], v0 offset:47104
s_nop 0
v_smfmac_f32_16x16x64_bf16 v[40:43], v[60:63], v[200:207], v1
s_add_u32 s58, s4, s20
s_waitcnt lgkmcnt(2)
v_cvt_pk_bf16_f32 v36, v36, v37
v_smfmac_f32_16x16x64_bf16 v[40:43], v[12:15], v[16:23], v1
ds_read_b128 v[20:23], v0 offset:50176
v_and_or_b32 v36, v36, -2, s18
v_cvt_pk_bf16_f32 v37, v38, v39
v_smfmac_f32_16x16x64_bf16 v[32:35], v[60:63], v[240:247], v1
global_store_dwordx2 v44, v[36:37], s[48:49]
v_smfmac_f32_16x16x64_bf16 v[48:51], v[60:63], v[216:223], v1
s_waitcnt lgkmcnt(1)
ds_read_b128 v[16:19], v0 offset:49152
v_cvt_pk_bf16_f32 v40, v40, v41
v_smfmac_f32_16x16x64_bf16 v[48:51], v[12:15], v[24:31], v1
s_addc_u32 s59, s5, 0
ds_read_b128 v[24:27], v0 offset:51200
v_and_or_b32 v40, v40, -2, s18
v_cvt_pk_bf16_f32 v41, v42, v43
v_smfmac_f32_16x16x64_bf16 v[32:35], v[12:15], v[248:255], v1
global_store_dwordx2 v44, v[40:41], s[50:51]
ds_read_b128 v[28:31], v0 offset:52224
v_smfmac_f32_16x16x64_bf16 v[52:55], v[8:11], v[168:175], v1
v_cvt_pk_bf16_f32 v48, v48, v49
v_smfmac_f32_16x16x64_bf16 v[52:55], v[56:59], v[224:231], v1
s_waitcnt lgkmcnt(2)
v_and_or_b32 v48, v48, -2, s18
v_cvt_pk_bf16_f32 v49, v50, v51
v_smfmac_f32_16x16x64_bf16 v[52:55], v[60:63], v[16:23], v1
s_waitcnt lgkmcnt(1)
global_store_dwordx2 v44, v[48:49], s[52:53]
s_waitcnt lgkmcnt(0)
v_smfmac_f32_16x16x64_bf16 v[52:55], v[12:15], v[24:31], v1
s_nop 1
v_cvt_pk_bf16_f32 v32, v32, v33
v_and_or_b32 v32, v32, -2, s18
v_cvt_pk_bf16_f32 v33, v34, v35
s_nop 2
v_cvt_pk_bf16_f32 v52, v52, v53
v_and_or_b32 v52, v52, -2, s18
v_cvt_pk_bf16_f32 v53, v54, v55
global_store_dwordx2 v44, v[52:53], s[54:55]
global_store_dwordx2 v44, v[32:33], s[56:57]
s_cmp_ge_u32 s14, 16
s_cbranch_scc1 nored_10109
v_bfe_u32 v32, v0, 6, 1
v_lshlrev_b32 v32, 4, v32
v_mov_b32 v33, 0x3f80
v_lshlrev_b32 v32, v32, v33
v_bfe_i32 v33, v0, 4, 1
v_and_b32 v45, v32, v33
v_and_b32 v47, v32, v33
v_xor_b32 v44, v32, v45
v_xor_b32 v46, v32, v45
v_and_b32 v36, 32, v0
v_bfe_u32 v37, v0, 6, 1
v_lshl_add_u32 v36, v37, 8, v36
v_bfe_u32 v37, v0, 8, 1
v_lshl_add_u32 v36, v37, 4, v36
v_bfe_u32 v37, v0, 4, 1
v_lshl_add_u32 v36, v37, 3, v36
s_waitcnt vmcnt(9)
v_and_b32 v7, 511, v0
v_lshl_add_u32 v7, v7, 3, s27
s_nop 15
s_nop 15
s_nop 15
s_nop 15
s_nop 12
global_load_dwordx4 v[8:11], v0, s[64:65] offset:0 sc1
global_load_dwordx4 v[12:15], v0, s[64:65] offset:1024 sc1
global_load_dwordx4 v[16:19], v0, s[64:65] offset:2048 sc1
global_load_dwordx4 v[20:23], v0, s[64:65] offset:3072 sc1
s_nop 15
s_nop 15
s_nop 5
global_load_dwordx4 v[24:27], v0, s[64:65] offset:0 sc1
global_load_dwordx4 v[28:31], v0, s[64:65] offset:1024 sc1
global_load_dwordx4 v[48:51], v0, s[64:65] offset:2048 sc1
global_load_dwordx4 v[52:55], v0, s[64:65] offset:3072 sc1
chk_10111:
v_mov_b64 v[40:41], 0
v_mov_b64 v[42:43], 0
s_waitcnt vmcnt(6)
s_nop 0
v_smfmac_f32_16x16x64_bf16 v[40:43], v[44:47], v[8:15], v1
v_bitop3_b32 v32, v8, v10, s18 bitop3:0x7e
v_bitop3_b32 v33, v12, v14, s18 bitop3:0x7e
s_waitcnt vmcnt(4)
v_smfmac_f32_16x16x64_bf16 v[40:43], v[44:47], v[16:23], v1
v_bitop3_b32 v34, v16, v18, s18 bitop3:0x7e
v_bitop3_b32 v35, v20, v22, s18 bitop3:0x7e
v_or3_b32 v37, v32, v33, v34
v_bitop3_b32 v37, v37, v35, 1 bitop3:0xa8
v_cmp_ne_u32 vcc, 0, v37
s_cbranch_vccnz chk_10111_f
s_nop 1
v_add_f32_dpp v40, v40, v40 row_ror:8 row_mask:0xf bank_mask:0xf
v_add_f32_dpp v41, v41, v41 row_ror:8 row_mask:0xf bank_mask:0xf
v_add_f32_dpp v42, v42, v42 row_ror:8 row_mask:0xf bank_mask:0xf
v_add_f32_dpp v43, v43, v43 row_ror:8 row_mask:0xf bank_mask:0xf
v_cvt_pk_bf16_f32 v40, v40, v41
v_cvt_pk_bf16_f32 v41, v42, v43
v_and_or_b32 v40, v40, -2, s18
s_mov_b64 exec, 0x00ff00ff
global_store_dwordx2 v36, v[40:41], s[66:67]
s_mov_b64 exec, -1
s_branch join_10110
chk_10111_f:
global_load_dwordx4 v[8:11], v0, s[64:65] offset:0 sc1
global_load_dwordx4 v[12:15], v0, s[64:65] offset:1024 sc1
global_load_dwordx4 v[16:19], v0, s[64:65] offset:2048 sc1
global_load_dwordx4 v[20:23], v0, s[64:65] offset:3072 sc1
chk_10112:
v_mov_b64 v[40:41], 0
v_mov_b64 v[42:43], 0
s_waitcnt vmcnt(6)
s_nop 0
v_smfmac_f32_16x16x64_bf16 v[40:43], v[44:47], v[24:31], v1
v_bitop3_b32 v32, v24, v26, s18 bitop3:0x7e
v_bitop3_b32 v33, v28, v30, s18 bitop3:0x7e
s_waitcnt vmcnt(4)
v_smfmac_f32_16x16x64_bf16 v[40:43], v[44:47], v[48:55], v1
v_bitop3_b32 v34, v48, v50, s18 bitop3:0x7e
v_bitop3_b32 v35, v52, v54, s18 bitop3:0x7e
v_or3_b32 v37, v32, v33, v34
v_bitop3_b32 v37, v37, v35, 1 bitop3:0xa8
v_cmp_ne_u32 vcc, 0, v37
s_cbranch_vccnz chk_10112_f
s_nop 1
v_add_f32_dpp v40, v40, v40 row_ror:8 row_mask:0xf bank_mask:0xf
v_add_f32_dpp v41, v41, v41 row_ror:8 row_mask:0xf bank_mask:0xf
v_add_f32_dpp v42, v42, v42 row_ror:8 row_mask:0xf bank_mask:0xf
v_add_f32_dpp v43, v43, v43 row_ror:8 row_mask:0xf bank_mask:0xf
v_cvt_pk_bf16_f32 v40, v40, v41
v_cvt_pk_bf16_f32 v41, v42, v43
v_and_or_b32 v40, v40, -2, s18
s_mov_b64 exec, 0x00ff00ff
global_store_dwordx2 v36, v[40:41], s[66:67]
s_mov_b64 exec, -1
s_branch join_10110
chk_10112_f:
global_load_dwordx4 v[24:27], v0, s[64:65] offset:0 sc1
global_load_dwordx4 v[28:31], v0, s[64:65] offset:1024 sc1
global_load_dwordx4 v[48:51], v0, s[64:65] offset:2048 sc1
global_load_dwordx4 v[52:55], v0, s[64:65] offset:3072 sc1
s_add_u32 s30, s30, 1
s_cmp_le_u32 s30, 262144
s_cbranch_scc1 chk_10111
s_branch L_fail
nored_10109:
s_waitcnt vmcnt(9)
v_and_b32 v7, 511, v0
v_lshl_add_u32 v7, v7, 3, s27
join_10110:
s_barrier
global_load_dwordx4 v[56:59], v0, s[76:77] offset:-2048 sc1
global_load_dwordx4 v[60:63], v0, s[76:77] offset:-1024 sc1
s_nop 15
s_nop 15
s_nop 15
s_barrier
global_load_dwordx4 v[32:35], v0, s[68:69] offset:-4096 sc1
s_nop 10
global_load_dwordx4 v[36:39], v0, s[68:69] offset:0 sc1
s_barrier
global_load_dwordx4 v[48:51], v0, s[76:77] offset:2048 sc1
global_load_dwordx4 v[52:55], v0, s[76:77] offset:3072 sc1
s_waitcnt vmcnt(10)
v_mov_b64 v[8:9], 0
v_mov_b64 v[10:11], 0
s_waitcnt vmcnt(9)
v_mov_b64 v[12:13], 0
v_mov_b64 v[14:15], 0
s_waitcnt vmcnt(8)
v_mov_b64 v[16:17], 0
v_mov_b64 v[18:19], 0
s_waitcnt vmcnt(7)
v_mov_b64 v[20:21], 0
v_mov_b64 v[22:23], 0
v_mov_b64 v[24:25], 0
v_mov_b64 v[26:27], 0
v_mov_b64 v[28:29], 0
v_mov_b64 v[30:31], 0
s_mov_b32 s30, 0
s_cmp_eq_u32 s17, s31
s_cbranch_scc0 gather_10101
s_branch exit_10104
rt_10106:
global_load_dwordx4 v[32:35], v0, s[68:69] offset:-4096 sc1
global_load_dwordx4 v[36:39], v0, s[68:69] offset:0 sc1
s_add_u32 s30, s30, 1
s_cmp_gt_u32 s30, 262144
s_cbranch_scc1 L_fail
s_mov_b64 exec, 1
global_store_dword v0, v0, s[62:63]
global_store_dword v0, v0, s[62:63]
s_mov_b64 exec, -1
v_mov_b64 v[8:9], 0
v_mov_b64 v[10:11], 0
v_mov_b64 v[12:13], 0
v_mov_b64 v[14:15], 0
v_mov_b64 v[16:17], 0
v_mov_b64 v[18:19], 0
v_mov_b64 v[20:21], 0
v_mov_b64 v[22:23], 0
v_mov_b64 v[24:25], 0
v_mov_b64 v[26:27], 0
v_mov_b64 v[28:29], 0
v_mov_b64 v[30:31], 0
s_branch gather_10101
rare_10102:
ds_read_b128 v[48:51], v6 offset:6144
ds_read_b128 v[52:55], v6 offset:7168
s_waitcnt lgkmcnt(0)
v_add_f32 v48, v48, v52
v_add_f32 v49, v49, v53
v_add_f32 v50, v50, v54
v_add_f32 v51, v51, v55
v_mov_b32_dpp v46, v46 quad_perm:[0,1,0,1] row_mask:0xf bank_mask:0xf
v_mov_b32_dpp v47, v47 quad_perm:[0,1,0,1] row_mask:0xf bank_mask:0xf
v_max3_f32 v19, v48, v49, v50
v_max3_f32 v19, v19, v51, v46
v_max_f32 v19, v19, v47
s_nop 1
v_max_f32_dpp v19, v19, v19 quad_perm:[2,3,0,1] row_mask:0xf bank_mask:0xf
v_mov_b32 v44, v19
s_nop 1
v_permlane32_swap_b32 v19, v44
v_max_f32 v19, v19, v44
v_mov_b32 v44, v19
s_nop 1
v_permlane16_swap_b32 v19, v44
v_max_f32 v19, v19, v44
v_sub_f32 v48, v48, v19
v_sub_f32 v49, v49, v19
v_sub_f32 v50, v50, v19
v_sub_f32 v51, v51, v19
v_sub_f32 v46, v46, v19
v_sub_f32 v47, v47, v19
v_exp_f32 v48, v48
v_exp_f32 v49, v49
v_exp_f32 v50, v50
v_exp_f32 v51, v51
v_cvt_pk_bf16_f32 v54, v48, v49
v_cvt_pk_bf16_f32 v55, v50, v51
s_nop 0
v_mov_b32_dpp v48, v54 quad_perm:[0,1,0,1] row_mask:0xf bank_mask:0xf
v_mov_b32_dpp v49, v55 quad_perm:[0,1,0,1] row_mask:0xf bank_mask:0xf
v_mov_b32_dpp v50, v54 quad_perm:[2,3,2,3] row_mask:0xf bank_mask:0xf
v_mov_b32_dpp v51, v55 quad_perm:[2,3,2,3] row_mask:0xf bank_mask:0xf
v_mov_b64 v[20:21], s[44:45]
v_mov_b64 v[22:23], s[44:45]
v_mfma_f32_16x16x32_bf16 v[8:11], v[56:59], v[48:51], 0
v_mfma_f32_16x16x32_bf16 v[12:15], v[60:63], v[48:51], 0
v_mfma_f32_16x16x32_bf16 v[16:19], v[20:23], v[48:51], 0
v_mov_b64 v[54:55], s[46:47]
v_exp_f32_dpp v44, v46 quad_perm:[0,1,0,1] row_mask:0xf bank_mask:0xf
v_exp_f32_dpp v45, v47 quad_perm:[0,1,0,1] row_mask:0xf bank_mask:0xf
s_nop 0
v_cvt_pk_bf16_f32 v52, v44, v45
v_cvt_pk_bf16_f32 v53, v44, v45
s_nop 1
v_mfma_f32_16x16x16_bf16 v[16:19], v[54:55], v[52:53], v[16:19]
v_mfma_f32_16x16x16_bf16 v[8:11], v[24:25], v[52:53], v[8:11]
v_mfma_f32_16x16x16_bf16 v[12:15], v[26:27], v[52:53], v[12:15]
s_nop 5
v_rcp_f32 v18, v16
s_nop 0
v_cndmask_b32 v8, v12, v8, s[42:43]
v_mul_f32 v8, v8, v18
v_cndmask_b32 v9, v13, v9, s[42:43]
v_mul_f32 v9, v9, v18
v_cndmask_b32 v10, v14, v10, s[42:43]
v_mul_f32 v10, v10, v18
v_cndmask_b32 v11, v15, v11, s[42:43]
v_mul_f32 v11, v11, v18
v_cvt_pk_bf16_f32 v12, v8, v9
v_cvt_pk_bf16_f32 v13, v10, v11
s_branch back_10103
exit_10104:
global_load_dwordx4 v[32:35], v0, s[68:69] offset:-4096 sc1
global_load_dwordx4 v[36:39], v0, s[68:69] offset:0 sc1
s_add_u32 s30, s30, 1
s_cmp_gt_u32 s30, 262144
s_cbranch_scc1 L_fail
s_waitcnt vmcnt(1)
v_bitop3_b32 v44, v32, v34, s18 bitop3:0x7e
s_waitcnt vmcnt(0)
v_bitop3_b32 v45, v36, v38, s18 bitop3:0x7e
v_bitop3_b32 v44, v44, v45, s19 bitop3:0xa8
v_cmp_ne_u32 vcc, 0, v44
s_cbranch_vccnz exit_10104
ds_write_b128 v0, v[32:35] offset:2048
ds_write_b128 v0, v[36:39] offset:6144
s_waitcnt lgkmcnt(0)
s_barrier
s_barrier
s_add_u32 s36, s36, 1
s_cmp_lt_u32 s36, 2
s_cbranch_scc1 layer_10100
s_endpgm
wave_10071:
layer_10113:
s_lshl_b32 s17, s36, 6
s_mul_i32 s27, s36, 35651584
s_mul_i32 s28, s14, 16384
s_add_u32 s27, s27, s28
s_add_u32 s20, s27, 16789504
s_mul_i32 s27, s17, 10240
s_add_u32 s27, s27, s24
s_add_u32 s21, s27, s25
s_mov_b32 s19, 0
s_mov_b32 s33, s6
s_add_u32 s34, s17, 1
s_add_u32 s31, s17, 63
s_add_u32 s32, s17, 64
s_mov_b32 s27, s20
v_mov_b32 v7, 0
s_add_u32 s68, s4, 416768
s_addc_u32 s69, s5, 0
s_add_u32 s72, s4, 400384
s_addc_u32 s73, s5, 0
s_add_u32 s70, s4, 420864
s_addc_u32 s71, s5, 0
s_add_u32 s74, s4, 404480
s_addc_u32 s75, s5, 0
s_add_u32 s58, s4, s20
s_addc_u32 s59, s5, 0
global_load_dwordx4 v[64:67], v0, s[76:77] offset:-4096 sc1
global_load_dwordx4 v[68:71], v0, s[76:77] offset:-3072 sc1
global_load_dwordx4 v[72:75], v0, s[76:77] offset:0 sc1
global_load_dwordx4 v[76:79], v0, s[76:77] offset:1024 sc1
global_load_dwordx4 v[48:51], v0, s[76:77] offset:2048 sc1
global_load_dwordx4 v[52:55], v0, s[76:77] offset:3072 sc1
global_load_dwordx4 v[56:59], v0, s[76:77] offset:-2048 sc1
global_load_dwordx4 v[60:63], v0, s[76:77] offset:-1024 sc1
v_mov_b64 v[8:9], 0
v_mov_b64 v[10:11], 0
v_mov_b64 v[12:13], 0
v_mov_b64 v[14:15], 0
v_mov_b64 v[16:17], 0
v_mov_b64 v[18:19], 0
v_mov_b64 v[20:21], 0
v_mov_b64 v[22:23], 0
v_mov_b64 v[24:25], 0
v_mov_b64 v[26:27], 0
v_mov_b64 v[28:29], 0
v_mov_b64 v[30:31], 0
s_barrier
v_and_b32 v7, 128, v0
v_add_u32 v7, s22, v7
s_mov_b32 exec_hi, 0
v_and_b32 v7, 511, v0
v_lshl_add_u32 v7, v7, 3, s27
s_mov_b32 exec_hi, -1
global_load_dwordx4 v[32:35], v0, s[68:69] offset:-4096 sc1
global_load_dwordx4 v[36:39], v0, s[68:69] offset:0 sc1
s_mov_b32 s30, 0
s_waitcnt vmcnt(0)
.p2align 6
gather_10114:
s_waitcnt vmcnt(3)
rt_10119_b:
v_smfmac_f32_16x16x64_bf16 v[12:15], v[32:35], a[0:7], v1
ds_write_b128 v0, v[32:35] offset:3072
v_smfmac_f32_16x16x64_bf16 v[20:23], v[32:35], a[8:15], v1
v_bitop3_b32 v44, v32, v34, s18 bitop3:0x7e
v_smfmac_f32_16x16x64_bf16 v[28:31], v[32:35], v[72:79], v1
s_waitcnt vmcnt(2)
ds_write_b128 v0, v[36:39] offset:7168
v_bitop3_b32 v45, v36, v38, s18 bitop3:0x7e
v_bitop3_b32 v44, v44, v45, s19 bitop3:0xa8
v_cmp_ne_u32 vcc, 0, v44
v_smfmac_f32_16x16x64_bf16 v[8:11], v[32:35], v[64:71], v1
s_cbranch_vccnz rt_10119
global_load_dwordx4 v[64:67], v0, s[78:79] offset:-4096 sc1
v_smfmac_f32_16x16x64_bf16 v[16:19], v[32:35], v[56:63], v1
global_load_dwordx4 v[68:71], v0, s[78:79] offset:-3072 sc1
v_smfmac_f32_16x16x64_bf16 v[20:23], v[36:39], a[48:55], v1
s_waitcnt lgkmcnt(0)
ds_read_b128 v[60:63], v2 offset:1024
global_load_dwordx4 v[72:75], v0, s[78:79] offset:-2048 sc1
v_smfmac_f32_16x16x64_bf16 v[16:19], v[36:39], a[40:47], v1
ds_read_b128 v[56:59], v2 offset:0
v_smfmac_f32_16x16x64_bf16 v[24:27], v[32:35], a[16:23], v1
s_barrier
ds_read_b128 v[40:43], v0 offset:2048
v_smfmac_f32_16x16x64_bf16 v[12:15], v[36:39], a[32:39], v1
ds_read_b128 v[44:47], v0 offset:6144
s_waitcnt lgkmcnt(3)
v_smfmac_f32_16x16x64_bf16 v[8:11], v[36:39], a[24:31], v1
ds_read_b128 v[32:35], v0 offset:1024
s_waitcnt lgkmcnt(3)
v_smfmac_f32_16x16x64_bf16 v[28:31], v[36:39], v[56:63], v1
ds_read_b128 v[56:59], v2 offset:2048
v_smfmac_f32_16x16x64_bf16 v[24:27], v[36:39], a[56:63], v1
ds_read_b128 v[60:63], v2 offset:3072
s_waitcnt lgkmcnt(4)
v_smfmac_f32_16x16x64_bf16 v[8:11], v[40:43], a[64:71], v1
ds_read_b128 v[36:39], v0 offset:5120
s_waitcnt vmcnt(3)
v_smfmac_f32_16x16x64_bf16 v[12:15], v[40:43], v[48:55], v1
s_waitcnt lgkmcnt(4)
ds_read_b128 v[48:51], v2 offset:4096
v_smfmac_f32_16x16x64_bf16 v[8:11], v[44:47], a[72:79], v1
ds_read_b128 v[52:55], v2 offset:5120
s_waitcnt lgkmcnt(5)
v_smfmac_f32_16x16x64_bf16 v[12:15], v[44:47], a[80:87], v1
s_waitcnt lgkmcnt(4)
ds_read_b128 v[44:47], v0 offset:4096
s_waitcnt lgkmcnt(4)
v_smfmac_f32_16x16x64_bf16 v[12:15], v[32:35], a[88:95], v1
ds_read_b128 v[40:43], v0 offset:0
s_waitcnt lgkmcnt(4)
v_smfmac_f32_16x16x64_bf16 v[8:11], v[32:35], v[56:63], v1
s_mov_b64 s[68:69], s[72:73]
ds_read_b128 v[56:59], v2 offset:6144
s_waitcnt lgkmcnt(4)
v_smfmac_f32_16x16x64_bf16 v[8:11], v[36:39], a[96:103], v1
ds_read_b128 v[32:35], v0 offset:9216
s_waitcnt vmcnt(2)
global_load_dwordx4 v[76:79], v0, s[78:79] offset:-1024 sc1
ds_read_b128 v[60:63], v2 offset:7168
s_waitcnt lgkmcnt(5)
v_smfmac_f32_16x16x64_bf16 v[12:15], v[36:39], v[48:55], v1
s_xor_b32 s18, s18, 1
s_waitcnt lgkmcnt(4)
ds_read_b128 v[52:55], v2 offset:9216
s_waitcnt lgkmcnt(4)
ds_read_b128 v[48:51], v2 offset:8192
v_smfmac_f32_16x16x64_bf16 v[8:11], v[40:43], a[104:111], v1
ds_read_b128 v[36:39], v0 offset:8192
s_waitcnt vmcnt(2)
v_smfmac_f32_16x16x64_bf16 v[8:11], v[44:47], v[64:71], v1
global_load_dwordx4 v[64:67], v0, s[78:79] offset:0 sc1
v_smfmac_f32_16x16x64_bf16 v[12:15], v[40:43], a[112:119], v1
s_waitcnt lgkmcnt(3)
ds_read_b128 v[40:43], v0 offset:2048
v_smfmac_f32_16x16x64_bf16 v[12:15], v[44:47], v[56:63], v1
s_mov_b64 vcc, s[42:43]
ds_read_b128 v[60:63], v2 offset:11264
ds_read_b128 v[56:59], v2 offset:10240
v_smfmac_f32_16x16x64_bf16 v[8:11], v[32:35], a[120:127], v1
s_waitcnt lgkmcnt(4)
global_load_dwordx4 v[68:71], v0, s[78:79] offset:1024 sc1
v_smfmac_f32_16x16x64_bf16 v[12:15], v[32:35], v[48:55], v1
s_waitcnt lgkmcnt(3)
ds_read_b128 v[32:35], v0 offset:6144
v_add_u32 v44, s24, v0
v_smfmac_f32_16x16x64_bf16 v[12:15], v[36:39], a[136:143], v1
global_load_dwordx4 v[48:51], v0, s[58:59] offset:0 nt sc1
v_smfmac_f32_16x16x64_bf16 v[8:11], v[36:39], a[128:135], v1
s_waitcnt lgkmcnt(3)
ds_read_b128 v[36:39], v0 offset:1024
global_load_dwordx4 v[52:55], v0, s[58:59] offset:1024 nt sc1
v_smfmac_f32_16x16x64_bf16 v[20:23], v[40:43], a[152:159], v1
s_nop 0
ds_read_b128 v[44:47], v44
v_add_f32 v13, v13, v15
v_smfmac_f32_16x16x64_bf16 v[16:19], v[40:43], a[144:151], v1
s_waitcnt lgkmcnt(2)
ds_read_b128 v[40:43], v0 offset:5120
v_add_f32 v9, v9, v11
v_smfmac_f32_16x16x64_bf16 v[20:23], v[32:35], v[56:63], v1
ds_read_b128 v[56:59], v2 offset:12288
ds_read_b128 v[60:63], v2 offset:13312
v_smfmac_f32_16x16x64_bf16 v[16:19], v[32:35], a[160:167], v1
s_waitcnt lgkmcnt(4)
v_add_f32 v8, v8, v10
v_smfmac_f32_16x16x64_bf16 v[20:23], v[36:39], a[176:183], v1
s_waitcnt vmcnt(5)
ds_read_b128 v[32:35], v0 offset:0
v_mul_f32 v9, s35, v9
v_add_f32 v12, v12, v14
v_mul_f32 v13, s35, v13
v_mul_f32 v8, s35, v8
v_mul_f32 v12, s35, v12
v_cvt_pk_bf16_f32 v12, v12, v13
v_cvt_pk_bf16_f32 v8, v8, v9
v_smfmac_f32_16x16x64_bf16 v[16:19], v[36:39], a[168:175], v1
s_waitcnt lgkmcnt(2)
ds_read_b128 v[36:39], v0 offset:4096
ds_write2_b32 v3, v8, v12 offset0:0 offset1:128
s_waitcnt lgkmcnt(3)
v_smfmac_f32_16x16x64_bf16 v[16:19], v[40:43], v[56:63], v1
s_waitcnt vmcnt(4)
global_load_dwordx4 v[56:59], v0, s[58:59] offset:2048 nt sc1
v_smfmac_f32_16x16x64_bf16 v[20:23], v[40:43], v[72:79], v1
s_waitcnt lgkmcnt(2)
global_load_dwordx4 v[60:63], v0, s[58:59] offset:3072 nt sc1
ds_read_b128 v[40:43], v0 offset:9216
v_smfmac_f32_16x16x64_bf16 v[16:19], v[32:35], a[184:191], v1
global_load_dwordx4 v[72:75], v0, s[78:79] offset:2048 sc1
v_swap_b32 v45, v46
v_smfmac_f32_16x16x64_bf16 v[20:23], v[32:35], a[192:199], v1
s_waitcnt lgkmcnt(1)
ds_read_b128 v[32:35], v0 offset:8192
global_load_dwordx4 v[76:79], v0, s[78:79] offset:3072 sc1
v_smfmac_f32_16x16x64_bf16 v[16:19], v[36:39], a[200:207], v1
s_barrier
v_smfmac_f32_16x16x64_bf16 v[20:23], v[36:39], a[208:215], v1
s_waitcnt lgkmcnt(1)
ds_read_b64_tr_b16 v[8:9], v4 offset:2048
ds_read_b64_tr_b16 v[10:11], v4 offset:2560
v_smfmac_f32_16x16x64_bf16 v[16:19], v[40:43], a[216:223], v1
ds_read_b64_tr_b16 v[14:15], v4 offset:3584
buffer_store_dwordx4 v[44:47], v0, s[4:7], s21 offen sc1
s_waitcnt lgkmcnt(3)
ds_read_b64_tr_b16 v[12:13], v4 offset:3072
v_smfmac_f32_16x16x64_bf16 v[16:19], v[32:35], a[232:239], v1
s_add_u32 s20, s20, 524288
ds_read_b128 v[36:39], v0 offset:9216
v_mov_b32 v47, s17
v_smfmac_f32_16x16x64_bf16 v[20:23], v[40:43], a[224:231], v1
s_mov_b64 exec, 1
buffer_store_dword v47, off, s[4:7], s33 sc1
s_mov_b64 exec, -1
v_smfmac_f32_16x16x64_bf16 v[20:23], v[32:35], a[240:247], v1
s_waitcnt lgkmcnt(2)
ds_read_b128 v[40:43], v0 offset:8192
s_waitcnt vmcnt(7)
ds_read_b128 v[32:35], v0 offset:2048
v_mfma_f32_16x16x32_bf16 v[44:47], v[48:51], v[8:11], 0
s_waitcnt lgkmcnt(3)
ds_read_b128 v[8:11], v2 offset:14336
v_bfe_u32 v48, v0, 5, 1
v_add_f32 v16, v16, v18
v_add_f32 v17, v17, v19
s_waitcnt vmcnt(6)
v_mfma_f32_16x16x32_bf16 v[44:47], v[52:55], v[12:15], v[44:47]
s_waitcnt lgkmcnt(3)
ds_read_b128 v[12:15], v2 offset:15360
ds_read_b128 v[52:55], v2 offset:17408
v_lshl_add_u32 v48, v48, 3, v5
v_add_f32 v21, v21, v23
v_add_f32 v20, v20, v22
v_cvt_pk_bf16_f32 v16, v16, v17
v_xor_b32 v48, 128, v48
v_cndmask_b32_dpp v44, v46, v44, vcc quad_perm:[0,1,0,1] row_mask:0xf bank_mask:0xf
v_cndmask_b32_dpp v45, v47, v45, vcc quad_perm:[0,1,0,1] row_mask:0xf bank_mask:0xf
v_smfmac_f32_16x16x64_bf16 v[28:31], v[36:39], v[80:87], v1
ds_write_b64 v48, v[44:45] offset:7680
v_cvt_pk_bf16_f32 v20, v20, v21
v_smfmac_f32_16x16x64_bf16 v[24:27], v[36:39], a[248:255], v1
s_waitcnt lgkmcnt(2)
ds_read_b128 v[48:51], v2 offset:16384
global_load_dword v7, v7, s[4:5] sc1
ds_write2_b32 v3, v16, v20 offset0:1 offset1:129
v_smfmac_f32_16x16x64_bf16 v[24:27], v[40:43], v[8:15], v1
s_waitcnt lgkmcnt(3)
ds_read_b128 v[36:39], v0 offset:6144
v_smfmac_f32_16x16x64_bf16 v[24:27], v[32:35], v[88:95], v1
s_waitcnt lgkmcnt(2)
v_smfmac_f32_16x16x64_bf16 v[28:31], v[40:43], v[48:55], v1
ds_read_b128 v[40:43], v0 offset:1024
v_smfmac_f32_16x16x64_bf16 v[28:31], v[32:35], v[96:103], v1
s_waitcnt lgkmcnt(2)
ds_read_b128 v[32:35], v0 offset:5120
s_barrier
ds_read_b64_tr_b16 v[12:13], v4 offset:1024
s_waitcnt lgkmcnt(3)
ds_read_b128 v[48:51], v6 offset:6144
v_smfmac_f32_16x16x64_bf16 v[28:31], v[36:39], v[104:111], v1
ds_read_b128 v[52:55], v6 offset:7168
s_waitcnt lgkmcnt(4)
ds_read_b64_tr_b16 v[10:11], v4 offset:512
v_smfmac_f32_16x16x64_bf16 v[24:27], v[36:39], v[64:71], v1
ds_read_b64_tr_b16 v[18:19], v4 offset:2560
s_add_u32 s17, s17, 1
ds_read_b64_tr_b16 v[8:9], v4 offset:0
v_smfmac_f32_16x16x64_bf16 v[24:27], v[40:43], v[112:119], v1
s_waitcnt lgkmcnt(6)
ds_read_b64_tr_b16 v[22:23], v4 offset:3584
s_mov_b32 s30, 0
ds_read_b64_tr_b16 v[16:17], v4 offset:2048
v_smfmac_f32_16x16x64_bf16 v[28:31], v[40:43], v[120:127], v1
s_waitcnt vmcnt(3)
ds_read_b64_tr_b16 v[14:15], v4 offset:1536
s_waitcnt lgkmcnt(8)
ds_read_b128 v[40:43], v0 offset:4096
v_smfmac_f32_16x16x64_bf16 v[24:27], v[32:35], v[128:135], v1
ds_read_b128 v[68:71], v2 offset:19456
s_waitcnt lgkmcnt(7)
ds_read_b128 v[36:39], v0 offset:0
v_smfmac_f32_16x16x64_bf16 v[28:31], v[32:35], v[136:143], v1
s_waitcnt lgkmcnt(6)
ds_read_b64_tr_b16 v[20:21], v4 offset:3072
v_add_f32 v49, v49, v53
v_add_f32 v48, v48, v52
v_mfma_f32_16x16x32_bf16 v[44:47], v[8:11], v[8:11], 0
s_waitcnt lgkmcnt(4)
ds_read_b128 v[64:67], v2 offset:18432
v_add_f32 v50, v50, v54
v_mfma_f32_16x16x32_bf16 v[44:47], v[12:15], v[12:15], v[44:47]
s_add_u32 s21, s21, 10240
v_exp_f32 v50, v50
v_add_f32 v51, v51, v55
v_exp_f32 v48, v48
v_exp_f32 v49, v49
v_exp_f32 v51, v51
v_mfma_f32_16x16x32_bf16 v[44:47], v[16:19], v[16:19], v[44:47]
s_waitcnt lgkmcnt(1)
v_cvt_pk_bf16_f32 v55, v50, v51
v_cvt_pk_bf16_f32 v54, v48, v49
v_mfma_f32_16x16x32_bf16 v[44:47], v[20:23], v[20:23], v[44:47]
s_waitcnt lgkmcnt(0)
v_mov_b32_dpp v49, v55 quad_perm:[0,1,0,1] row_mask:0xf bank_mask:0xf
v_mov_b32_dpp v50, v54 quad_perm:[2,3,2,3] row_mask:0xf bank_mask:0xf
v_smfmac_f32_16x16x64_bf16 v[24:27], v[36:39], v[64:71], v1
ds_read_b128 v[64:67], v2 offset:20480
v_mov_b32_dpp v51, v55 quad_perm:[2,3,2,3] row_mask:0xf bank_mask:0xf
v_smfmac_f32_16x16x64_bf16 v[28:31], v[36:39], v[144:151], v1
ds_read_b128 v[68:71], v2 offset:21504
v_mov_b64 v[22:23], s[44:45]
v_smfmac_f32_16x16x64_bf16 v[24:27], v[40:43], v[72:79], v1
ds_read_b128 v[76:79], v2 offset:23552
v_mov_b32_dpp v48, v54 quad_perm:[0,1,0,1] row_mask:0xf bank_mask:0xf
v_smfmac_f32_16x16x64_bf16 v[28:31], v[40:43], v[152:159], v1
ds_read_b128 v[72:75], v2 offset:22528
v_mov_b64 v[20:21], s[44:45]
v_mfma_f32_16x16x32_bf16 v[12:15], v[60:63], v[48:51], 0
v_exp_f32_dpp v45, v47 quad_perm:[0,1,0,1] row_mask:0xf bank_mask:0xf
v_exp_f32_dpp v44, v46 quad_perm:[0,1,0,1] row_mask:0xf bank_mask:0xf
v_mfma_f32_16x16x32_bf16 v[16:19], v[20:23], v[48:51], 0
v_cvt_pk_bf16_f32 v52, v44, v45
v_mov_b64 v[54:55], s[46:47]
v_mfma_f32_16x16x32_bf16 v[8:11], v[56:59], v[48:51], 0
v_cvt_pk_bf16_f32 v53, v44, v45
v_cvt_pk_bf16_f32 v24, v24, v25
v_cvt_pk_bf16_f32 v25, v26, v27
v_mfma_f32_16x16x16_bf16 v[16:19], v[54:55], v[52:53], v[16:19]
s_waitcnt lgkmcnt(0)
v_cvt_pk_bf16_f32 v26, v28, v29
v_cvt_pk_bf16_f32 v27, v30, v31
v_mfma_f32_16x16x16_bf16 v[8:11], v[24:25], v[52:53], v[8:11]
ds_read_b128 v[28:31], v0 offset:56320
v_bfe_u32 v32, v0, 5, 1
v_mfma_f32_16x16x16_bf16 v[12:15], v[26:27], v[52:53], v[12:15]
s_nop 0
v_subrev_u32 v17, s37, v16
v_cmp_lt_u32 vcc, s38, v17
v_mov_b64 v[40:41], 0
v_lshl_add_u32 v32, v32, 3, v5
v_rcp_f32 v18, v16
v_mov_b64 v[36:37], 0
v_mov_b64 v[42:43], 0
v_cndmask_b32 v11, v15, v11, s[42:43]
v_mul_f32 v11, v11, v18
v_cndmask_b32 v10, v14, v10, s[42:43]
v_cndmask_b32 v8, v12, v8, s[42:43]
v_mul_f32 v8, v8, v18
v_cndmask_b32 v9, v13, v9, s[42:43]
v_mul_f32 v10, v10, v18
v_mul_f32 v9, v9, v18
v_cvt_pk_bf16_f32 v13, v10, v11
v_cvt_pk_bf16_f32 v12, v8, v9
s_cbranch_vccnz rare_10115
back_10116:
ds_write_b64 v32, v[12:13] offset:1536
v_mov_b32_dpp v9, v13 quad_perm:[0,1,0,1] row_mask:0xf bank_mask:0xf
v_mov_b32_dpp v8, v12 quad_perm:[0,1,0,1] row_mask:0xf bank_mask:0xf
v_mov_b64 v[38:39], 0
v_mov_b64 v[32:33], 0
v_mov_b32_dpp v10, v12 quad_perm:[2,3,2,3] row_mask:0xf bank_mask:0xf
v_mov_b32_dpp v11, v13 quad_perm:[2,3,2,3] row_mask:0xf bank_mask:0xf
v_mov_b64 v[48:49], 0
v_mov_b64 v[50:51], 0
v_smfmac_f32_16x16x64_bf16 v[36:39], v[8:11], v[64:71], v1
s_add_u32 s34, s17, 2
ds_read_b128 v[24:27], v0 offset:55296
global_load_dwordx4 v[64:67], v0, s[76:77] offset:-4096 sc1
ds_read_b128 v[16:19], v0 offset:53248
v_mov_b64 v[34:35], 0
v_smfmac_f32_16x16x64_bf16 v[40:43], v[8:11], v[72:79], v1
s_waitcnt lgkmcnt(2)
ds_read_b128 v[20:23], v0 offset:54272
s_barrier
ds_read_b128 v[56:59], v5 offset:1024
v_smfmac_f32_16x16x64_bf16 v[32:35], v[8:11], v[176:183], v1
global_load_dwordx4 v[68:71], v0, s[76:77] offset:-3072 sc1
s_waitcnt lgkmcnt(3)
ds_read_b128 v[60:63], v5 offset:512
v_lshrrev_b32 v44, 8, v0
v_smfmac_f32_16x16x64_bf16 v[48:51], v[8:11], v[160:167], v1
ds_read_b128 v[12:15], v5 offset:0
global_load_dwordx4 v[72:75], v0, s[76:77] offset:0 sc1
v_bfe_u32 v45, v0, 1, 7
v_mov_b64 v[54:55], 0
s_waitcnt lgkmcnt(2)
v_smfmac_f32_16x16x64_bf16 v[48:51], v[56:59], v[208:215], v1
s_min_u32 s34, s34, s32
global_load_dwordx4 v[76:79], v0, s[76:77] offset:1024 sc1
v_smfmac_f32_16x16x64_bf16 v[36:39], v[56:59], v[16:23], v1
s_waitcnt lgkmcnt(1)
ds_read_b128 v[16:19], v0 offset:57344
v_mov_b64 v[52:53], 0
v_smfmac_f32_16x16x64_bf16 v[36:39], v[60:63], v[24:31], v1
s_add_u32 s27, s20, 524288
ds_read_b128 v[20:23], v0 offset:58368
s_waitcnt lgkmcnt(2)
v_smfmac_f32_16x16x64_bf16 v[32:35], v[56:59], v[232:239], v1
ds_read_b128 v[28:31], v0 offset:60416
v_smfmac_f32_16x16x64_bf16 v[36:39], v[12:15], v[184:191], v1
v_lshl_or_b32 v44, v44, 12, v45
v_smfmac_f32_16x16x64_bf16 v[40:43], v[56:59], v[192:199], v1
s_mov_b32 s19, 1
ds_read_b128 v[24:27], v0 offset:59392
s_nop 0
v_smfmac_f32_16x16x64_bf16 v[40:43], v[60:63], v[200:207], v1
s_add_u32 s58, s4, s20
s_waitcnt lgkmcnt(2)
v_cvt_pk_bf16_f32 v36, v36, v37
v_smfmac_f32_16x16x64_bf16 v[40:43], v[12:15], v[16:23], v1
ds_read_b128 v[20:23], v0 offset:62464
v_and_or_b32 v36, v36, -2, s18
v_cvt_pk_bf16_f32 v37, v38, v39
v_smfmac_f32_16x16x64_bf16 v[32:35], v[60:63], v[240:247], v1
global_store_dwordx2 v44, v[36:37], s[48:49]
v_smfmac_f32_16x16x64_bf16 v[48:51], v[60:63], v[216:223], v1
s_waitcnt lgkmcnt(1)
ds_read_b128 v[16:19], v0 offset:61440
v_cvt_pk_bf16_f32 v40, v40, v41
v_smfmac_f32_16x16x64_bf16 v[48:51], v[12:15], v[24:31], v1
s_addc_u32 s59, s5, 0
ds_read_b128 v[24:27], v0 offset:63488
v_and_or_b32 v40, v40, -2, s18
v_cvt_pk_bf16_f32 v41, v42, v43
v_smfmac_f32_16x16x64_bf16 v[32:35], v[12:15], v[248:255], v1
global_store_dwordx2 v44, v[40:41], s[50:51]
ds_read_b128 v[28:31], v0 offset:64512
v_smfmac_f32_16x16x64_bf16 v[52:55], v[8:11], v[168:175], v1
v_cvt_pk_bf16_f32 v48, v48, v49
v_smfmac_f32_16x16x64_bf16 v[52:55], v[56:59], v[224:231], v1
s_waitcnt lgkmcnt(2)
v_and_or_b32 v48, v48, -2, s18
v_cvt_pk_bf16_f32 v49, v50, v51
v_smfmac_f32_16x16x64_bf16 v[52:55], v[60:63], v[16:23], v1
s_and_b32 s33, s17, 3
s_waitcnt lgkmcnt(1)
global_store_dwordx2 v44, v[48:49], s[52:53]
s_waitcnt lgkmcnt(0)
v_smfmac_f32_16x16x64_bf16 v[52:55], v[12:15], v[24:31], v1
s_nop 1
v_cvt_pk_bf16_f32 v32, v32, v33
v_and_or_b32 v32, v32, -2, s18
v_cvt_pk_bf16_f32 v33, v34, v35
s_nop 2
v_cvt_pk_bf16_f32 v52, v52, v53
v_and_or_b32 v52, v52, -2, s18
v_cvt_pk_bf16_f32 v53, v54, v55
s_cselect_b32 s33, s6, s23
global_store_dwordx2 v44, v[52:53], s[54:55]
global_store_dwordx2 v44, v[32:33], s[56:57]
nored_10122:
s_waitcnt vmcnt(9)
v_cmp_gt_u32 vcc, s34, v7
s_cmp_eq_u32 vcc_hi, 0
s_cbranch_scc1 kv_10126
s_mov_b32 s30, 0
kv_10125:
v_and_b32 v7, 128, v0
buffer_load_dword v7, v7, s[4:7], s22 offen sc1
s_add_u32 s30, s30, 1
s_cmp_gt_u32 s30, 262144
s_cbranch_scc1 L_fail
s_waitcnt vmcnt(0)
v_cmp_gt_u32 vcc, s34, v7
s_cbranch_vccnz kv_10125
kv_10126:
v_and_b32 v7, 128, v0
v_add_u32 v7, s22, v7
s_mov_b32 exec_hi, 0
v_and_b32 v7, 511, v0
v_lshl_add_u32 v7, v7, 3, s27
s_mov_b32 exec_hi, -1
join_10123:
s_barrier
global_load_dwordx4 v[56:59], v0, s[76:77] offset:-2048 sc1
global_load_dwordx4 v[60:63], v0, s[76:77] offset:-1024 sc1
s_nop 15
s_nop 15
s_nop 15
s_barrier
global_load_dwordx4 v[32:35], v0, s[68:69] offset:-4096 sc1
s_nop 10
global_load_dwordx4 v[36:39], v0, s[68:69] offset:0 sc1
s_barrier
global_load_dwordx4 v[48:51], v0, s[76:77] offset:2048 sc1
global_load_dwordx4 v[52:55], v0, s[76:77] offset:3072 sc1
v_mov_b64 v[8:9], 0
v_mov_b64 v[10:11], 0
v_mov_b64 v[12:13], 0
v_mov_b64 v[14:15], 0
v_mov_b64 v[16:17], 0
v_mov_b64 v[18:19], 0
v_mov_b64 v[20:21], 0
v_mov_b64 v[22:23], 0
v_mov_b64 v[24:25], 0
v_mov_b64 v[26:27], 0
v_mov_b64 v[28:29], 0
v_mov_b64 v[30:31], 0
s_mov_b32 s30, 0
s_cmp_eq_u32 s17, s31
s_cbranch_scc0 gather_10114
s_branch exit_10117
rt_10119:
global_load_dwordx4 v[32:35], v0, s[68:69] offset:-4096 sc1
global_load_dwordx4 v[36:39], v0, s[68:69] offset:0 sc1
s_add_u32 s30, s30, 1
s_cmp_gt_u32 s30, 262144
s_cbranch_scc1 L_fail
s_mov_b64 exec, 1
global_store_dword v0, v0, s[62:63]
global_store_dword v0, v0, s[62:63]
s_mov_b64 exec, -1
v_mov_b64 v[8:9], 0
v_mov_b64 v[10:11], 0
v_mov_b64 v[12:13], 0
v_mov_b64 v[14:15], 0
v_mov_b64 v[16:17], 0
v_mov_b64 v[18:19], 0
v_mov_b64 v[20:21], 0
v_mov_b64 v[22:23], 0
v_mov_b64 v[24:25], 0
v_mov_b64 v[26:27], 0
v_mov_b64 v[28:29], 0
v_mov_b64 v[30:31], 0
s_branch gather_10114
rare_10115:
ds_read_b128 v[48:51], v6 offset:6144
ds_read_b128 v[52:55], v6 offset:7168
s_waitcnt lgkmcnt(0)
v_add_f32 v48, v48, v52
v_add_f32 v49, v49, v53
v_add_f32 v50, v50, v54
v_add_f32 v51, v51, v55
v_mov_b32_dpp v46, v46 quad_perm:[0,1,0,1] row_mask:0xf bank_mask:0xf
v_mov_b32_dpp v47, v47 quad_perm:[0,1,0,1] row_mask:0xf bank_mask:0xf
v_max3_f32 v19, v48, v49, v50
v_max3_f32 v19, v19, v51, v46
v_max_f32 v19, v19, v47
s_nop 1
v_max_f32_dpp v19, v19, v19 quad_perm:[2,3,0,1] row_mask:0xf bank_mask:0xf
v_mov_b32 v44, v19
s_nop 1
v_permlane32_swap_b32 v19, v44
v_max_f32 v19, v19, v44
v_mov_b32 v44, v19
s_nop 1
v_permlane16_swap_b32 v19, v44
v_max_f32 v19, v19, v44
v_sub_f32 v48, v48, v19
v_sub_f32 v49, v49, v19
v_sub_f32 v50, v50, v19
v_sub_f32 v51, v51, v19
v_sub_f32 v46, v46, v19
v_sub_f32 v47, v47, v19
v_exp_f32 v48, v48
v_exp_f32 v49, v49
v_exp_f32 v50, v50
v_exp_f32 v51, v51
v_cvt_pk_bf16_f32 v54, v48, v49
v_cvt_pk_bf16_f32 v55, v50, v51
s_nop 0
v_mov_b32_dpp v48, v54 quad_perm:[0,1,0,1] row_mask:0xf bank_mask:0xf
v_mov_b32_dpp v49, v55 quad_perm:[0,1,0,1] row_mask:0xf bank_mask:0xf
v_mov_b32_dpp v50, v54 quad_perm:[2,3,2,3] row_mask:0xf bank_mask:0xf
v_mov_b32_dpp v51, v55 quad_perm:[2,3,2,3] row_mask:0xf bank_mask:0xf
v_mov_b64 v[20:21], s[44:45]
v_mov_b64 v[22:23], s[44:45]
v_mfma_f32_16x16x32_bf16 v[8:11], v[56:59], v[48:51], 0
v_mfma_f32_16x16x32_bf16 v[12:15], v[60:63], v[48:51], 0
v_mfma_f32_16x16x32_bf16 v[16:19], v[20:23], v[48:51], 0
v_mov_b64 v[54:55], s[46:47]
v_exp_f32_dpp v44, v46 quad_perm:[0,1,0,1] row_mask:0xf bank_mask:0xf
v_exp_f32_dpp v45, v47 quad_perm:[0,1,0,1] row_mask:0xf bank_mask:0xf
s_nop 0
v_cvt_pk_bf16_f32 v52, v44, v45
v_cvt_pk_bf16_f32 v53, v44, v45
s_nop 1
v_mfma_f32_16x16x16_bf16 v[16:19], v[54:55], v[52:53], v[16:19]
v_mfma_f32_16x16x16_bf16 v[8:11], v[24:25], v[52:53], v[8:11]
v_mfma_f32_16x16x16_bf16 v[12:15], v[26:27], v[52:53], v[12:15]
s_nop 5
v_rcp_f32 v18, v16
s_nop 0
v_cndmask_b32 v8, v12, v8, s[42:43]
v_mul_f32 v8, v8, v18
v_cndmask_b32 v9, v13, v9, s[42:43]
v_mul_f32 v9, v9, v18
v_cndmask_b32 v10, v14, v10, s[42:43]
v_mul_f32 v10, v10, v18
v_cndmask_b32 v11, v15, v11, s[42:43]
v_mul_f32 v11, v11, v18
v_cvt_pk_bf16_f32 v12, v8, v9
v_cvt_pk_bf16_f32 v13, v10, v11
s_branch back_10116
exit_10117:
global_load_dwordx4 v[32:35], v0, s[68:69] offset:-4096 sc1
global_load_dwordx4 v[36:39], v0, s[68:69] offset:0 sc1
s_add_u32 s30, s30, 1
s_cmp_gt_u32 s30, 262144
s_cbranch_scc1 L_fail
s_waitcnt vmcnt(1)
v_bitop3_b32 v44, v32, v34, s18 bitop3:0x7e
s_waitcnt vmcnt(0)
v_bitop3_b32 v45, v36, v38, s18 bitop3:0x7e
v_bitop3_b32 v44, v44, v45, s19 bitop3:0xa8
v_cmp_ne_u32 vcc, 0, v44
s_cbranch_vccnz exit_10117
ds_write_b128 v0, v[32:35] offset:3072
ds_write_b128 v0, v[36:39] offset:7168
s_waitcnt lgkmcnt(0)
s_barrier
v_add_u32 v44, s24, v0
ds_read_b128 v[44:47], v44
s_waitcnt lgkmcnt(0)
v_swap_b32 v45, v46
buffer_store_dwordx4 v[44:47], v0, s[4:7], s21 offen sc1
s_add_u32 s26, s17, 1
s_waitcnt vmcnt(0)
v_mov_b32 v44, s26
s_mov_b64 exec, 1
buffer_store_dword v44, off, s[4:7], s23 sc1
s_mov_b64 exec, -1
s_barrier
s_add_u32 s36, s36, 1
s_cmp_lt_u32 s36, 2
s_cbranch_scc1 layer_10113
s_endpgm
grp_10064:
L_last:
s_endpgm

.section .rodata,"a"
.p2align 6
.amdhsa_kernel interleave_layers__spectral_gfnet__memory_aug_recurrent_mem_tr__prompt_kernel
  .amdhsa_next_free_vgpr 512
  .amdhsa_next_free_sgpr 102
  .amdhsa_accum_offset 256
  .amdhsa_group_segment_fixed_size 0
  .amdhsa_kernarg_size 104
  .amdhsa_user_sgpr_count 2
  .amdhsa_user_sgpr_kernarg_segment_ptr 1
  .amdhsa_system_sgpr_workgroup_id_x 1
  .amdhsa_float_denorm_mode_32 3
  .amdhsa_ieee_mode 0
.end_amdhsa_kernel
```
